```python
import torch

def _softmax(x, axis=-1):
    return torch.softmax(x, dim=axis)
def _gelu(x):
    return torch.nn.functional.gelu(x, approximate="tanh")
def _silu(x):
    return torch.nn.functional.silu(x)
def _sigmoid(x):
    return torch.sigmoid(x)
def _layernorm(x, axis=-1, eps=1e-5):
    m = x.mean(dim=axis, keepdim=True)
    v = x.var(dim=axis, keepdim=True, unbiased=False)
    return (x - m) / torch.sqrt(v + eps)
def _scatter_add(tgt, idx, src, axis=0):
    return tgt.clone().index_add_(axis, idx, src)
def _segment_sum(src, seg, n):
    out = torch.zeros((n,) + src.shape[1:], dtype=src.dtype)
    return out.index_add_(0, seg, src)
def _pad(x, pw):
    flat = tuple(v for pair in reversed(pw) for v in pair)
    return torch.nn.functional.pad(x, flat)

kernel_name = 'interleave_layers__softmax_full_mha__moe_arch_mod__prompt'

def setup_inputs():

    _w = (lambda a: (lambda t: t.to(torch.bfloat16) if t.is_floating_point() else t)(torch.as_tensor(a)))
    def _A_setup():
        B, S, D = 1, 2048, 1024
        return {
            "x": _w((lambda *s: torch.randn(*s, dtype=torch.bfloat16) * 0.05)(B, S, D)),
            "wqkv": _w((lambda *s: torch.randn(*s, dtype=torch.bfloat16) * 0.05)(D, 3 * D)),
            "wo": _w((lambda *s: torch.randn(*s, dtype=torch.bfloat16) * 0.05)(D, D)),
        }
    _A_in = _A_setup()

    def _B_setup():
        B, S, D, F, C = 1, 2048, 1024, 3584, 1
        return {
            "x": _w((lambda *s: torch.randn(*s, dtype=torch.bfloat16) * 0.05)(B, S, D)),
            "w_r": _w((lambda *s: torch.randn(*s, dtype=torch.bfloat16) * 0.05)(D)),
            "w_gate": _w((lambda *s: torch.randn(*s, dtype=torch.bfloat16) * 0.05)(D, F)),
            "w_up": _w((lambda *s: torch.randn(*s, dtype=torch.bfloat16) * 0.05)(D, F)),
            "w_down": _w((lambda *s: torch.randn(*s, dtype=torch.bfloat16) * 0.05)(F, D)),
        }
    _B_in = _B_setup()

    return {
        "A_x": _A_in["x"],
        "A_wqkv": _A_in["wqkv"],
        "A_wo": _A_in["wo"],
        "B_x": _B_in["x"],
        "B_w_r": _B_in["w_r"],
        "B_w_gate": _B_in["w_gate"],
        "B_w_up": _B_in["w_up"],
        "B_w_down": _B_in["w_down"],
    }

def reference(A_x, A_wqkv, A_wo, B_x, B_w_r, B_w_gate, B_w_up, B_w_down):
    def _A_ref(x, wqkv, wo):
        B, S, D = x.shape
        H = 32; Dh = D // H
        qkv = (lambda x, *d: x.permute(*d))((x @ wqkv).reshape(B, S, 3, H, Dh), 2, 0, 3, 1, 4)
        q, k, v = qkv[0], qkv[1], qkv[2]
        scale = Dh ** -0.5
        scores = torch.einsum("bhqd,bhkd->bhqk", q, k) * scale
        p = _softmax(scores, axis=-1)
        o = torch.einsum("bhqk,bhkd->bhqd", p, v)
        return (lambda x, *d: x.permute(*d))(o, 0, 2, 1, 3).reshape(B, S, D) @ wo

    def _B_ref(x, w_r, w_gate, w_up, w_down):
        B, S, D = x.shape
        C = 1
        r = x @ w_r
        idx = torch.argsort(-r, axis=-1)[:, :C]
        idx_e = (lambda x, n, axis: torch.repeat_interleave(x, n, dim=axis))(idx.reshape(B, C, 1), D, axis=2)
        x_sel = (lambda x, i, axis: torch.take_along_dim(x, i, dim=axis))(x, idx_e, axis=1)
        g = _silu(x_sel @ w_gate)
        u = x_sel @ w_up
        y = (g * u) @ w_down
        r_sel = _sigmoid((lambda x, i, axis: torch.take_along_dim(x, i, dim=axis))(r, idx, axis=1))
        y = y * r_sel.reshape(B, C, 1)
        b_off = (torch.arange(B) * S).reshape(B, 1)
        flat_idx = (idx + b_off).reshape(B * C)
        zero = (x * 0.0).reshape(B * S, D)
        upd = _scatter_add(zero, flat_idx, y.reshape(B * C, D), axis=0)
        return x + upd.reshape(B, S, D)

    x = A_x
    x = x + _A_ref(_layernorm(x, axis=-1), A_wqkv, A_wo)
    x = x + _B_ref(_layernorm(x, axis=-1), B_w_r, B_w_gate, B_w_up, B_w_down)
    x = x + _A_ref(_layernorm(x, axis=-1), A_wqkv, A_wo)
    x = x + _B_ref(_layernorm(x, axis=-1), B_w_r, B_w_gate, B_w_up, B_w_down)
    return x
```

```asm
; @launch kernel=fz_kernel grid=(256,1,1) block=(512,1,1) lds=163840
.amdgcn_target "amdgcn-amd-amdhsa--gfx950"
.text
.globl fz_kernel
.p2align 8
.type fz_kernel,@function
fz_kernel:
  s_cmp_ge_u32 s2, 256
  s_cbranch_scc1 .fz_kernel_end
  s_load_dwordx16 s[40:55], s[0:1], 0
  s_load_dwordx4 s[56:59], s[0:1], 64
  s_load_dwordx2 s[60:61], s[0:1], 80
  s_getpc_b64 s[8:9]
.fz_kernel_pc:
  s_mov_b32 s10, .fz_kernel_cend-.fz_kernel_pc
  s_mov_b32 s11, 0x00020000
  s_lshl_b32 s12, s2, 10
  s_and_b32 s12, s12, 0xe000
  v_lshrrev_b32 v1, 3, v0
  v_and_b32 v2, 7, v0
  v_and_b32 v1, 0x38, v1
  v_add_lshl_u32 v1, v1, v2, 7
  s_mov_b64 exec, 0xff
  buffer_load_dword v255, v1, s[8:11], s12 offen
  s_mov_b64 exec, -1
  v_lshrrev_b32 v1, 6, v0
  v_and_b32 v2, 63, v0
  v_readfirstlane_b32 s16, v1
  s_and_b32 s21, s2, 7
  s_lshr_b32 s22, s2, 3
  s_and_b32 s23, s21, 3
  s_lshl_b32 s23, s23, 2
  s_and_b32 s24, s22, 3
  s_add_u32 s18, s23, s24
  s_lshr_b32 s24, s21, 2
  s_lshl_b32 s24, s24, 3
  s_lshr_b32 s25, s22, 2
  s_add_u32 s17, s24, s25
  s_lshl_b32 s19, s18, 4
  s_add_u32 s19, s19, s17
  s_lshl_b32 s19, s19, 7
  s_lshl_b32 s70, s19, 1
  s_add_u32 s70, s70, 0x1900000
  s_add_u32 s19, s19, 0x1800000
  v_lshlrev_b32 v3, 4, v2
  v_mov_b32 v4, 0
  v_mov_b32 v5, 1
  s_waitcnt lgkmcnt(0)
  s_mov_b32 s4, s60
  s_mov_b32 s5, s61
  s_mov_b32 s6, 0x2c00000
  s_mov_b32 s7, 0x00020000
  s_mov_b32 s62, 0
  s_mov_b32 s63, 0x400000
  s_mov_b32 s64, 0xc00000
  s_mov_b32 s65, 0x1000000
  s_mov_b32 s66, 0x1c00000
  s_mov_b32 s67, 0
  s_mov_b32 s71, 159744
  v_mov_b32 v6, 159808
  s_cmp_ge_u32 s16, 4
  s_cbranch_scc1 .fz_kernel_q_prod1
  v_lshlrev_b32 v20, 2, v0
  v_add_u32 v20, 159744, v20
  s_cmp_ge_u32 s16, 2
  s_cbranch_scc1 .fz_kernel_q_nz
  ds_write_b32 v20, v4
.fz_kernel_q_nz:
  v_and_b32 v124, 31, v2
  v_lshrrev_b32 v125, 5, v2
  s_lshl_b32 s28, s16, 12
  s_add_u32 s28, s28, 0x8000
  v_bfe_u32 v21, v2, 1, 3
  v_lshlrev_b32 v22, 7, v124
  v_add_u32 v22, s28, v22
  v_add_u32 v23, 0, v125
  v_xor_b32 v23, v23, v21
  v_lshl_add_u32 v8, v23, 4, v22
  v_xor_b32 v120, 0x1000, v8
  v_add_u32 v23, 2, v125
  v_xor_b32 v23, v23, v21
  v_lshl_add_u32 v9, v23, 4, v22
  v_xor_b32 v121, 0x1000, v9
  v_add_u32 v23, 4, v125
  v_xor_b32 v23, v23, v21
  v_lshl_add_u32 v10, v23, 4, v22
  v_xor_b32 v122, 0x1000, v10
  v_add_u32 v23, 6, v125
  v_xor_b32 v23, v23, v21
  v_lshl_add_u32 v11, v23, 4, v22
  v_xor_b32 v123, 0x1000, v11
.fz_kernel_q_cs:
  s_lshr_b32 s26, s16, 1
  s_and_b32 s27, s16, 1
  v_bfe_u32 v31, v2, 2, 2
  v_lshl_add_u32 v32, v125, 3, v31
  v_lshlrev_b32 v32, 7, v32
  v_lshrrev_b32 v33, 1, v31
  v_xor_b32 v33, s27, v33
  v_lshl_add_u32 v32, v33, 6, v32
  v_bfe_u32 v33, v2, 4, 1
  v_lshl_add_u32 v32, v33, 5, v32
  v_and_b32 v33, 3, v2
  v_lshl_add_u32 v32, v33, 3, v32
  v_add_u32 v12, 65536, v32
  v_add_u32 v13, 65536, v32
  v_and_b32 v33, 1, v2
  v_lshlrev_b32 v33, 2, v33
  v_add_u32 v126, s71, v33
  s_cmp_lg_u32 s62, 0
  s_cbranch_scc1 .fz_kernel_q_init
  s_mov_b32 m0, 160240
  s_mov_b32 s31, s70
  v_mov_b32 v19, -16
  s_mov_b32 s29, -1
  s_mov_b32 s30, 0
  s_waitcnt lgkmcnt(0)
  s_barrier
  .p2align 6
.fz_kernel_q_loop:
  s_waitcnt lgkmcnt(5)
  v_mfma_f32_32x32x16_bf16 v[128:143], v[92:95], v[84:87], v[128:143]
  ds_read_b128 v[64:67], v8 offset:0
  ds_read_b64_tr_b16 v[72:73], v12 offset:0
  s_waitcnt lgkmcnt(6)
  v_mfma_f32_32x32x16_bf16 v[144:159], v[92:95], v[88:91], v[144:159]
  ds_read_b64_tr_b16 v[74:75], v12 offset:512
  ds_read_b128 v[68:71], v120 offset:0
  s_waitcnt lgkmcnt(6)
  v_mfma_f32_32x32x16_bf16 v[160:175], v[96:99], v[84:87], v[160:175]
  ds_read_b64_tr_b16 v[76:77], v12 offset:4096
  ds_read_b64_tr_b16 v[78:79], v12 offset:4608
  v_mfma_f32_32x32x16_bf16 v[176:191], v[96:99], v[88:91], v[176:191]
  ds_read_b64_tr_b16 v[80:81], v12 offset:8192
  ds_read_b64_tr_b16 v[82:83], v12 offset:8704
  ds_read_b32 v127, v126
  s_waitcnt lgkmcnt(9)
  v_mfma_f32_32x32x16_bf16 v[192:207], v[84:87], v[100:103], v[192:207]
  s_mov_b64 exec, 1
  buffer_load_dword v4, s[4:7], s31 offen lds
  s_mov_b64 exec, -1
  s_add_u32 s31, s31, 4
  v_mfma_f32_32x32x16_bf16 v[208:223], v[88:91], v[100:103], v[208:223]
  s_waitcnt lgkmcnt(6)
  v_mfma_f32_32x32x16_bf16 v[128:143], v[72:75], v[64:67], v[128:143]
  ds_read_b128 v[84:87], v9 offset:0
  ds_read_b64_tr_b16 v[92:93], v12 offset:2048
  s_waitcnt lgkmcnt(7)
  v_mfma_f32_32x32x16_bf16 v[144:159], v[72:75], v[68:71], v[144:159]
  ds_read_b64_tr_b16 v[94:95], v12 offset:2560
  ds_read_b128 v[88:91], v121 offset:0
  s_waitcnt lgkmcnt(7)
  v_mfma_f32_32x32x16_bf16 v[160:175], v[76:79], v[64:67], v[160:175]
  ds_read_b64_tr_b16 v[96:97], v12 offset:6144
  ds_read_b64_tr_b16 v[98:99], v12 offset:6656
  s_add_u32 s30, s30, 12288
  s_cmp_eq_u32 s30, 86016
  s_cselect_b32 s30, 0, s30
  v_mfma_f32_32x32x16_bf16 v[176:191], v[76:79], v[68:71], v[176:191]
  ds_read_b64_tr_b16 v[100:101], v12 offset:10240
  ds_read_b64_tr_b16 v[102:103], v12 offset:10752
  v_add_u32 v19, 1, v19
  v_add_u32 v12, s30, v13
  s_waitcnt lgkmcnt(8)
  v_mfma_f32_32x32x16_bf16 v[192:207], v[64:67], v[80:83], v[192:207]
  v_cmp_le_i32 vcc, v127, v19
  v_mfma_f32_32x32x16_bf16 v[208:223], v[68:71], v[80:83], v[208:223]
  s_cbranch_vccnz .fz_kernel_q_w0
.fz_kernel_q_back0:
  s_waitcnt lgkmcnt(5)
  v_mfma_f32_32x32x16_bf16 v[128:143], v[92:95], v[84:87], v[128:143]
  ds_read_b128 v[64:67], v10 offset:0
  ds_read_b64_tr_b16 v[72:73], v12 offset:0
  s_waitcnt lgkmcnt(6)
  v_mfma_f32_32x32x16_bf16 v[144:159], v[92:95], v[88:91], v[144:159]
  ds_read_b64_tr_b16 v[74:75], v12 offset:512
  ds_read_b128 v[68:71], v122 offset:0
  s_waitcnt lgkmcnt(6)
  v_mfma_f32_32x32x16_bf16 v[160:175], v[96:99], v[84:87], v[160:175]
  ds_read_b64_tr_b16 v[76:77], v12 offset:4096
  ds_read_b64_tr_b16 v[78:79], v12 offset:4608
  v_mfma_f32_32x32x16_bf16 v[176:191], v[96:99], v[88:91], v[176:191]
  ds_read_b64_tr_b16 v[80:81], v12 offset:8192
  ds_read_b64_tr_b16 v[82:83], v12 offset:8704
  ds_read_b32 v127, v126
  s_waitcnt lgkmcnt(9)
  v_mfma_f32_32x32x16_bf16 v[192:207], v[84:87], v[100:103], v[192:207]
  s_mov_b64 exec, 1
  buffer_load_dword v4, s[4:7], s31 offen lds
  s_mov_b64 exec, -1
  s_add_u32 s31, s31, 4
  v_mfma_f32_32x32x16_bf16 v[208:223], v[88:91], v[100:103], v[208:223]
  s_waitcnt lgkmcnt(6)
  v_mfma_f32_32x32x16_bf16 v[128:143], v[72:75], v[64:67], v[128:143]
  ds_read_b128 v[84:87], v11 offset:0
  ds_read_b64_tr_b16 v[92:93], v12 offset:2048
  s_waitcnt lgkmcnt(7)
  v_mfma_f32_32x32x16_bf16 v[144:159], v[72:75], v[68:71], v[144:159]
  ds_read_b64_tr_b16 v[94:95], v12 offset:2560
  ds_read_b128 v[88:91], v123 offset:0
  s_waitcnt lgkmcnt(7)
  v_mfma_f32_32x32x16_bf16 v[160:175], v[76:79], v[64:67], v[160:175]
  ds_read_b64_tr_b16 v[96:97], v12 offset:6144
  ds_read_b64_tr_b16 v[98:99], v12 offset:6656
  s_add_u32 s30, s30, 12288
  s_cmp_eq_u32 s30, 86016
  s_cselect_b32 s30, 0, s30
  v_mfma_f32_32x32x16_bf16 v[176:191], v[76:79], v[68:71], v[176:191]
  ds_read_b64_tr_b16 v[100:101], v12 offset:10240
  ds_read_b64_tr_b16 v[102:103], v12 offset:10752
  v_add_u32 v19, 1, v19
  v_add_u32 v12, s30, v13
  s_waitcnt lgkmcnt(8)
  v_mfma_f32_32x32x16_bf16 v[192:207], v[64:67], v[80:83], v[192:207]
  v_cmp_le_i32 vcc, v127, v19
  v_mfma_f32_32x32x16_bf16 v[208:223], v[68:71], v[80:83], v[208:223]
  s_cbranch_vccnz .fz_kernel_q_w2
.fz_kernel_q_back2:
  s_waitcnt lgkmcnt(5)
  v_mfma_f32_32x32x16_bf16 v[128:143], v[92:95], v[84:87], v[128:143]
  ds_read_b128 v[64:67], v8 offset:16384
  ds_read_b64_tr_b16 v[72:73], v12 offset:0
  s_waitcnt lgkmcnt(6)
  v_mfma_f32_32x32x16_bf16 v[144:159], v[92:95], v[88:91], v[144:159]
  ds_read_b64_tr_b16 v[74:75], v12 offset:512
  ds_read_b128 v[68:71], v120 offset:16384
  s_waitcnt lgkmcnt(6)
  v_mfma_f32_32x32x16_bf16 v[160:175], v[96:99], v[84:87], v[160:175]
  ds_read_b64_tr_b16 v[76:77], v12 offset:4096
  ds_read_b64_tr_b16 v[78:79], v12 offset:4608
  v_xor_b32 v8, 0x8000, v8
  v_xor_b32 v120, 0x8000, v120
  v_mfma_f32_32x32x16_bf16 v[176:191], v[96:99], v[88:91], v[176:191]
  ds_read_b64_tr_b16 v[80:81], v12 offset:8192
  ds_read_b64_tr_b16 v[82:83], v12 offset:8704
  ds_read_b32 v127, v126
  s_waitcnt lgkmcnt(9)
  v_mfma_f32_32x32x16_bf16 v[192:207], v[84:87], v[100:103], v[192:207]
  s_mov_b64 exec, 1
  buffer_load_dword v4, s[4:7], s31 offen lds
  s_mov_b64 exec, -1
  s_add_u32 s31, s31, 4
  v_mfma_f32_32x32x16_bf16 v[208:223], v[88:91], v[100:103], v[208:223]
  s_waitcnt lgkmcnt(6)
  v_mfma_f32_32x32x16_bf16 v[128:143], v[72:75], v[64:67], v[128:143]
  ds_read_b128 v[84:87], v9 offset:16384
  ds_read_b64_tr_b16 v[92:93], v12 offset:2048
  s_waitcnt lgkmcnt(7)
  v_mfma_f32_32x32x16_bf16 v[144:159], v[72:75], v[68:71], v[144:159]
  ds_read_b64_tr_b16 v[94:95], v12 offset:2560
  ds_read_b128 v[88:91], v121 offset:16384
  s_waitcnt lgkmcnt(7)
  v_mfma_f32_32x32x16_bf16 v[160:175], v[76:79], v[64:67], v[160:175]
  ds_read_b64_tr_b16 v[96:97], v12 offset:6144
  ds_read_b64_tr_b16 v[98:99], v12 offset:6656
  v_xor_b32 v9, 0x8000, v9
  v_xor_b32 v121, 0x8000, v121
  s_add_u32 s30, s30, 12288
  s_cmp_eq_u32 s30, 86016
  s_cselect_b32 s30, 0, s30
  v_mfma_f32_32x32x16_bf16 v[176:191], v[76:79], v[68:71], v[176:191]
  ds_read_b64_tr_b16 v[100:101], v12 offset:10240
  ds_read_b64_tr_b16 v[102:103], v12 offset:10752
  v_add_u32 v19, 1, v19
  v_add_u32 v12, s30, v13
  s_waitcnt lgkmcnt(8)
  v_mfma_f32_32x32x16_bf16 v[192:207], v[64:67], v[80:83], v[192:207]
  v_cmp_le_i32 vcc, v127, v19
  v_mfma_f32_32x32x16_bf16 v[208:223], v[68:71], v[80:83], v[208:223]
  s_cbranch_vccnz .fz_kernel_q_w4
.fz_kernel_q_back4:
  s_waitcnt lgkmcnt(5)
  v_mfma_f32_32x32x16_bf16 v[128:143], v[92:95], v[84:87], v[128:143]
  ds_read_b128 v[64:67], v10 offset:16384
  ds_read_b64_tr_b16 v[72:73], v12 offset:0
  s_waitcnt lgkmcnt(6)
  v_mfma_f32_32x32x16_bf16 v[144:159], v[92:95], v[88:91], v[144:159]
  ds_read_b64_tr_b16 v[74:75], v12 offset:512
  ds_read_b128 v[68:71], v122 offset:16384
  s_waitcnt lgkmcnt(6)
  v_mfma_f32_32x32x16_bf16 v[160:175], v[96:99], v[84:87], v[160:175]
  ds_read_b64_tr_b16 v[76:77], v12 offset:4096
  ds_read_b64_tr_b16 v[78:79], v12 offset:4608
  v_xor_b32 v10, 0x8000, v10
  v_xor_b32 v122, 0x8000, v122
  v_mfma_f32_32x32x16_bf16 v[176:191], v[96:99], v[88:91], v[176:191]
  ds_read_b64_tr_b16 v[80:81], v12 offset:8192
  ds_read_b64_tr_b16 v[82:83], v12 offset:8704
  ds_read_b32 v127, v126
  s_waitcnt lgkmcnt(9)
  v_mfma_f32_32x32x16_bf16 v[192:207], v[84:87], v[100:103], v[192:207]
  s_mov_b64 exec, 1
  buffer_load_dword v4, s[4:7], s31 offen lds
  s_mov_b64 exec, -1
  s_add_u32 s31, s31, 4
  v_mfma_f32_32x32x16_bf16 v[208:223], v[88:91], v[100:103], v[208:223]
  s_waitcnt lgkmcnt(6)
  v_mfma_f32_32x32x16_bf16 v[128:143], v[72:75], v[64:67], v[128:143]
  ds_read_b128 v[84:87], v11 offset:16384
  ds_read_b64_tr_b16 v[92:93], v12 offset:2048
  s_waitcnt lgkmcnt(7)
  v_mfma_f32_32x32x16_bf16 v[144:159], v[72:75], v[68:71], v[144:159]
  ds_read_b64_tr_b16 v[94:95], v12 offset:2560
  ds_read_b128 v[88:91], v123 offset:16384
  s_waitcnt lgkmcnt(7)
  v_mfma_f32_32x32x16_bf16 v[160:175], v[76:79], v[64:67], v[160:175]
  ds_read_b64_tr_b16 v[96:97], v12 offset:6144
  ds_read_b64_tr_b16 v[98:99], v12 offset:6656
  v_xor_b32 v11, 0x8000, v11
  v_xor_b32 v123, 0x8000, v123
  s_add_u32 s30, s30, 12288
  s_cmp_eq_u32 s30, 86016
  s_cselect_b32 s30, 0, s30
  v_mfma_f32_32x32x16_bf16 v[176:191], v[76:79], v[68:71], v[176:191]
  ds_read_b64_tr_b16 v[100:101], v12 offset:10240
  ds_read_b64_tr_b16 v[102:103], v12 offset:10752
  v_add_u32 v19, 1, v19
  v_add_u32 v12, s30, v13
  s_waitcnt lgkmcnt(8)
  v_mfma_f32_32x32x16_bf16 v[192:207], v[64:67], v[80:83], v[192:207]
  v_cmp_le_i32 vcc, v127, v19
  s_add_u32 s29, s29, 1
  v_mfma_f32_32x32x16_bf16 v[208:223], v[68:71], v[80:83], v[208:223]
  s_cbranch_vccnz .fz_kernel_q_w6
.fz_kernel_q_back6:
  s_and_b32 s28, s29, 7
  s_cbranch_scc1 .fz_kernel_q_loop
  s_cmp_lg_u32 s29, 0
  s_cbranch_scc1 .fz_kernel_q_last
  s_waitcnt lgkmcnt(0)
.fz_kernel_q_init:
  s_lshl_b32 s28, s16, 2
  s_add_u32 s28, s28, s71
  s_add_u32 m0, s28, 16
  s_add_u32 s31, s70, 0
  v_mov_b32 v19, 0
  v_mov_b32 v12, v13
  s_mov_b32 s29, 0
  s_mov_b32 s30, 0
  v_mov_b32 v84, 0
  v_mov_b32 v85, 0
  v_mov_b32 v86, 0
  v_mov_b32 v87, 0
  v_mov_b32 v88, 0
  v_mov_b32 v89, 0
  v_mov_b32 v90, 0
  v_mov_b32 v91, 0
  v_mov_b32 v92, 0
  v_mov_b32 v93, 0
  v_mov_b32 v94, 0
  v_mov_b32 v95, 0
  v_mov_b32 v96, 0
  v_mov_b32 v97, 0
  v_mov_b32 v98, 0
  v_mov_b32 v99, 0
  v_mov_b32 v100, 0
  v_mov_b32 v101, 0
  v_mov_b32 v102, 0
  v_mov_b32 v103, 0
  v_mov_b32 v128, 0
  v_mov_b32 v129, 0
  v_mov_b32 v130, 0
  v_mov_b32 v131, 0
  v_mov_b32 v132, 0
  v_mov_b32 v133, 0
  v_mov_b32 v134, 0
  v_mov_b32 v135, 0
  v_mov_b32 v136, 0
  v_mov_b32 v137, 0
  v_mov_b32 v138, 0
  v_mov_b32 v139, 0
  v_mov_b32 v140, 0
  v_mov_b32 v141, 0
  v_mov_b32 v142, 0
  v_mov_b32 v143, 0
  v_mov_b32 v144, 0
  v_mov_b32 v145, 0
  v_mov_b32 v146, 0
  v_mov_b32 v147, 0
  v_mov_b32 v148, 0
  v_mov_b32 v149, 0
  v_mov_b32 v150, 0
  v_mov_b32 v151, 0
  v_mov_b32 v152, 0
  v_mov_b32 v153, 0
  v_mov_b32 v154, 0
  v_mov_b32 v155, 0
  v_mov_b32 v156, 0
  v_mov_b32 v157, 0
  v_mov_b32 v158, 0
  v_mov_b32 v159, 0
  v_mov_b32 v160, 0
  v_mov_b32 v161, 0
  v_mov_b32 v162, 0
  v_mov_b32 v163, 0
  v_mov_b32 v164, 0
  v_mov_b32 v165, 0
  v_mov_b32 v166, 0
  v_mov_b32 v167, 0
  v_mov_b32 v168, 0
  v_mov_b32 v169, 0
  v_mov_b32 v170, 0
  v_mov_b32 v171, 0
  v_mov_b32 v172, 0
  v_mov_b32 v173, 0
  v_mov_b32 v174, 0
  v_mov_b32 v175, 0
  v_mov_b32 v176, 0
  v_mov_b32 v177, 0
  v_mov_b32 v178, 0
  v_mov_b32 v179, 0
  v_mov_b32 v180, 0
  v_mov_b32 v181, 0
  v_mov_b32 v182, 0
  v_mov_b32 v183, 0
  v_mov_b32 v184, 0
  v_mov_b32 v185, 0
  v_mov_b32 v186, 0
  v_mov_b32 v187, 0
  v_mov_b32 v188, 0
  v_mov_b32 v189, 0
  v_mov_b32 v190, 0
  v_mov_b32 v191, 0
  v_mov_b32 v192, 0
  v_mov_b32 v193, 0
  v_mov_b32 v194, 0
  v_mov_b32 v195, 0
  v_mov_b32 v196, 0
  v_mov_b32 v197, 0
  v_mov_b32 v198, 0
  v_mov_b32 v199, 0
  v_mov_b32 v200, 0
  v_mov_b32 v201, 0
  v_mov_b32 v202, 0
  v_mov_b32 v203, 0
  v_mov_b32 v204, 0
  v_mov_b32 v205, 0
  v_mov_b32 v206, 0
  v_mov_b32 v207, 0
  v_mov_b32 v208, 0
  v_mov_b32 v209, 0
  v_mov_b32 v210, 0
  v_mov_b32 v211, 0
  v_mov_b32 v212, 0
  v_mov_b32 v213, 0
  v_mov_b32 v214, 0
  v_mov_b32 v215, 0
  v_mov_b32 v216, 0
  v_mov_b32 v217, 0
  v_mov_b32 v218, 0
  v_mov_b32 v219, 0
  v_mov_b32 v220, 0
  v_mov_b32 v221, 0
  v_mov_b32 v222, 0
  v_mov_b32 v223, 0
  s_cmp_eq_u32 s62, 0
  s_cbranch_scc1 .fz_kernel_q_i1
  s_waitcnt vmcnt(0)
  s_barrier
.fz_kernel_q_i1:
  s_call_b64 s[68:69], .fz_kernel_q_spin
  s_branch .fz_kernel_q_loop
.fz_kernel_q_last:
  s_waitcnt lgkmcnt(5)
  v_mfma_f32_32x32x16_bf16 v[128:143], v[92:95], v[84:87], v[128:143]
  s_waitcnt lgkmcnt(4)
  v_mfma_f32_32x32x16_bf16 v[144:159], v[92:95], v[88:91], v[144:159]
  s_waitcnt lgkmcnt(2)
  v_mfma_f32_32x32x16_bf16 v[160:175], v[96:99], v[84:87], v[160:175]
  v_mfma_f32_32x32x16_bf16 v[176:191], v[96:99], v[88:91], v[176:191]
  s_waitcnt lgkmcnt(0)
  v_mfma_f32_32x32x16_bf16 v[192:207], v[84:87], v[100:103], v[192:207]
  v_mfma_f32_32x32x16_bf16 v[208:223], v[88:91], v[100:103], v[208:223]
  s_lshl_b32 s33, s27, 7
  s_add_u32 s33, s33, 155648
  v_lshlrev_b32 v25, 2, v124
  v_mov_b32 v1, 159952
  v_add_u32 v26, s33, v25
  s_lshl_b32 s31, s16, 7
  s_xor_b32 s38, s31, 128
  s_add_u32 s31, s31, 155648
  s_add_u32 s38, s38, 155648
  v_add_u32 v24, s38, v25
  v_add_u32 v25, s31, v25
  v_lshlrev_b32 v27, 4, v125
  v_add_u32 v29, s33, v27
  s_barrier
  ds_read_b32 v1, v1
  ds_read_b32 v28, v25 offset:4608
  ds_read_b32 v30, v25 offset:5120
  ds_read_b32 v32, v24 offset:4608
  ds_read_b32 v34, v24 offset:5120
  ds_read_b128 v[52:55], v29 offset:5888
  ds_read_b128 v[56:59], v29 offset:5920
  ds_read_b128 v[60:63], v29 offset:5952
  ds_read_b128 v[64:67], v29 offset:5984
  ds_read_b128 v[36:39], v29 offset:5632
  ds_read_b128 v[40:43], v29 offset:5664
  ds_read_b128 v[44:47], v29 offset:5696
  ds_read_b128 v[48:51], v29 offset:5728
  ds_read_b32 v68, v26 offset:6144
  v_add_u32 v22, s31, v27
  v_add_u32 v23, s38, v27
  s_lshl_b32 s34, s18, 1
  s_add_u32 s34, s34, s27
  s_lshl_b32 s34, s34, 6
  s_lshl_b32 s35, s17, 2
  s_add_u32 s34, s34, s35
  s_add_u32 s34, s34, s16
  s_lshl_b32 s36, s34, 12
  s_xor_b32 s37, s36, 4096
  s_add_u32 s36, s36, s63
  s_add_u32 s37, s37, s63
  s_lshl_b32 s34, s27, 2
  s_add_u32 s34, s34, s16
  s_lshl_b32 s35, s34, 11
  v_add_u32 v20, s35, v3
  v_xor_b32 v21, 2048, v20
  s_lshl_b32 s35, s34, 12
  s_add_u32 s35, s35, 73728
  v_add_u32 v31, s35, v3
  s_xor_b32 s34, s34, 1
  s_lshl_b32 s35, s34, 12
  s_add_u32 s35, s35, 73728
  v_add_u32 v33, s35, v3
  ds_read_b128 v[72:75], v22 offset:4608
  ds_read_b128 v[88:91], v22 offset:5120
  ds_read_b128 v[76:79], v22 offset:4640
  ds_read_b128 v[92:95], v22 offset:5152
  ds_read_b128 v[80:83], v22 offset:4672
  ds_read_b128 v[96:99], v22 offset:5184
  ds_read_b128 v[84:87], v22 offset:4704
  ds_read_b128 v[100:103], v22 offset:5216
  s_waitcnt lgkmcnt(13)
  v_cmp_ne_u32 vcc, 0, v1
  s_cbranch_vccnz .fz_kernel_q_patch
.fz_kernel_q_pback:
  v_pk_mul_f32 v[112:113], v[52:53], v[30:31] op_sel_hi:[1,0]
  v_pk_fma_f32 v[160:161], v[160:161], v[28:29], v[112:113] op_sel_hi:[1,0,1]
  v_pk_mul_f32 v[114:115], v[54:55], v[30:31] op_sel_hi:[1,0]
  v_pk_fma_f32 v[162:163], v[162:163], v[28:29], v[114:115] op_sel_hi:[1,0,1]
  v_pk_mul_f32 v[116:117], v[56:57], v[30:31] op_sel_hi:[1,0]
  v_pk_fma_f32 v[164:165], v[164:165], v[28:29], v[116:117] op_sel_hi:[1,0,1]
  v_pk_mul_f32 v[118:119], v[58:59], v[30:31] op_sel_hi:[1,0]
  v_pk_fma_f32 v[166:167], v[166:167], v[28:29], v[118:119] op_sel_hi:[1,0,1]
  v_pk_mul_f32 v[112:113], v[60:61], v[30:31] op_sel_hi:[1,0]
  v_pk_fma_f32 v[168:169], v[168:169], v[28:29], v[112:113] op_sel_hi:[1,0,1]
  v_pk_mul_f32 v[114:115], v[62:63], v[30:31] op_sel_hi:[1,0]
  v_pk_fma_f32 v[170:171], v[170:171], v[28:29], v[114:115] op_sel_hi:[1,0,1]
  v_pk_mul_f32 v[116:117], v[64:65], v[30:31] op_sel_hi:[1,0]
  v_pk_fma_f32 v[172:173], v[172:173], v[28:29], v[116:117] op_sel_hi:[1,0,1]
  v_pk_mul_f32 v[118:119], v[66:67], v[30:31] op_sel_hi:[1,0]
  v_pk_fma_f32 v[174:175], v[174:175], v[28:29], v[118:119] op_sel_hi:[1,0,1]
  v_cvt_pk_bf16_f32 v160, v160, v161
  v_cvt_pk_bf16_f32 v161, v162, v163
  v_cvt_pk_bf16_f32 v162, v164, v165
  v_cvt_pk_bf16_f32 v163, v166, v167
  v_cvt_pk_bf16_f32 v164, v168, v169
  v_cvt_pk_bf16_f32 v165, v170, v171
  v_cvt_pk_bf16_f32 v166, v172, v173
  v_cvt_pk_bf16_f32 v167, v174, v175
  buffer_store_dwordx4 v[160:163], v3, s[4:7], s36 offen offset:0 sc1
  buffer_store_dwordx4 v[164:167], v3, s[4:7], s36 offen offset:1024 sc1
  ds_write_b128 v31, v[160:163] offset:0
  ds_write_b128 v31, v[164:167] offset:1024
  v_pk_mul_f32 v[112:113], v[52:53], v[34:35] op_sel_hi:[1,0]
  v_pk_fma_f32 v[176:177], v[176:177], v[32:33], v[112:113] op_sel_hi:[1,0,1]
  v_pk_mul_f32 v[114:115], v[54:55], v[34:35] op_sel_hi:[1,0]
  v_pk_fma_f32 v[178:179], v[178:179], v[32:33], v[114:115] op_sel_hi:[1,0,1]
  v_pk_mul_f32 v[116:117], v[56:57], v[34:35] op_sel_hi:[1,0]
  v_pk_fma_f32 v[180:181], v[180:181], v[32:33], v[116:117] op_sel_hi:[1,0,1]
  v_pk_mul_f32 v[118:119], v[58:59], v[34:35] op_sel_hi:[1,0]
  v_pk_fma_f32 v[182:183], v[182:183], v[32:33], v[118:119] op_sel_hi:[1,0,1]
  v_pk_mul_f32 v[112:113], v[60:61], v[34:35] op_sel_hi:[1,0]
  v_pk_fma_f32 v[184:185], v[184:185], v[32:33], v[112:113] op_sel_hi:[1,0,1]
  v_pk_mul_f32 v[114:115], v[62:63], v[34:35] op_sel_hi:[1,0]
  v_pk_fma_f32 v[186:187], v[186:187], v[32:33], v[114:115] op_sel_hi:[1,0,1]
  v_pk_mul_f32 v[116:117], v[64:65], v[34:35] op_sel_hi:[1,0]
  v_pk_fma_f32 v[188:189], v[188:189], v[32:33], v[116:117] op_sel_hi:[1,0,1]
  v_pk_mul_f32 v[118:119], v[66:67], v[34:35] op_sel_hi:[1,0]
  v_pk_fma_f32 v[190:191], v[190:191], v[32:33], v[118:119] op_sel_hi:[1,0,1]
  v_cvt_pk_bf16_f32 v176, v176, v177
  v_cvt_pk_bf16_f32 v177, v178, v179
  v_cvt_pk_bf16_f32 v178, v180, v181
  v_cvt_pk_bf16_f32 v179, v182, v183
  v_cvt_pk_bf16_f32 v180, v184, v185
  v_cvt_pk_bf16_f32 v181, v186, v187
  v_cvt_pk_bf16_f32 v182, v188, v189
  v_cvt_pk_bf16_f32 v183, v190, v191
  buffer_store_dwordx4 v[176:179], v3, s[4:7], s37 offen offset:0 sc1
  buffer_store_dwordx4 v[180:183], v3, s[4:7], s37 offen offset:1024 sc1
  ds_write_b128 v33, v[176:179] offset:0
  ds_write_b128 v33, v[180:183] offset:1024
  s_waitcnt lgkmcnt(4)
  v_pk_mul_f32 v[112:113], v[88:89], v[68:69] op_sel_hi:[1,0]
  v_pk_fma_f32 v[192:193], v[192:193], v[72:73], v[112:113]
  v_pk_mul_f32 v[114:115], v[90:91], v[68:69] op_sel_hi:[1,0]
  v_pk_fma_f32 v[194:195], v[194:195], v[74:75], v[114:115]
  v_pk_mul_f32 v[116:117], v[92:93], v[68:69] op_sel_hi:[1,0]
  v_pk_fma_f32 v[196:197], v[196:197], v[76:77], v[116:117]
  v_pk_mul_f32 v[118:119], v[94:95], v[68:69] op_sel_hi:[1,0]
  v_pk_fma_f32 v[198:199], v[198:199], v[78:79], v[118:119]
  v_pk_mul_f32 v[112:113], v[96:97], v[68:69] op_sel_hi:[1,0]
  v_pk_fma_f32 v[200:201], v[200:201], v[80:81], v[112:113]
  v_pk_mul_f32 v[114:115], v[98:99], v[68:69] op_sel_hi:[1,0]
  v_pk_fma_f32 v[202:203], v[202:203], v[82:83], v[114:115]
  v_pk_mul_f32 v[116:117], v[100:101], v[68:69] op_sel_hi:[1,0]
  v_pk_fma_f32 v[204:205], v[204:205], v[84:85], v[116:117]
  v_pk_mul_f32 v[118:119], v[102:103], v[68:69] op_sel_hi:[1,0]
  v_pk_fma_f32 v[206:207], v[206:207], v[86:87], v[118:119]
  v_cvt_pk_bf16_f32 v192, v192, v193
  v_cvt_pk_bf16_f32 v193, v194, v195
  v_cvt_pk_bf16_f32 v194, v196, v197
  v_cvt_pk_bf16_f32 v195, v198, v199
  v_cvt_pk_bf16_f32 v196, v200, v201
  v_cvt_pk_bf16_f32 v197, v202, v203
  v_cvt_pk_bf16_f32 v198, v204, v205
  v_cvt_pk_bf16_f32 v199, v206, v207
  buffer_store_dwordx4 v[192:195], v3, s[4:7], s36 offen offset:2048 sc1
  buffer_store_dwordx4 v[196:199], v3, s[4:7], s36 offen offset:3072 sc1
  ds_write_b128 v31, v[192:195] offset:2048
  ds_write_b128 v31, v[196:199] offset:3072
  ds_read_b128 v[72:75], v23 offset:4608
  ds_read_b128 v[88:91], v23 offset:5120
  ds_read_b128 v[76:79], v23 offset:4640
  ds_read_b128 v[92:95], v23 offset:5152
  ds_read_b128 v[80:83], v23 offset:4672
  ds_read_b128 v[96:99], v23 offset:5184
  ds_read_b128 v[84:87], v23 offset:4704
  ds_read_b128 v[100:103], v23 offset:5216
  v_mul_f32 v104, 0.25503486164919736, v28
  v_mul_f32 v106, 0.25503486164919736, v30
  v_mul_f32 v108, 0.25503486164919736, v32
  v_mul_f32 v110, 0.25503486164919736, v34
  s_waitcnt lgkmcnt(0)
  v_pk_mul_f32 v[112:113], v[88:89], v[68:69] op_sel_hi:[1,0]
  v_pk_fma_f32 v[208:209], v[208:209], v[72:73], v[112:113]
  v_pk_mul_f32 v[114:115], v[90:91], v[68:69] op_sel_hi:[1,0]
  v_pk_fma_f32 v[210:211], v[210:211], v[74:75], v[114:115]
  v_pk_mul_f32 v[116:117], v[92:93], v[68:69] op_sel_hi:[1,0]
  v_pk_fma_f32 v[212:213], v[212:213], v[76:77], v[116:117]
  v_pk_mul_f32 v[118:119], v[94:95], v[68:69] op_sel_hi:[1,0]
  v_pk_fma_f32 v[214:215], v[214:215], v[78:79], v[118:119]
  v_pk_mul_f32 v[112:113], v[96:97], v[68:69] op_sel_hi:[1,0]
  v_pk_fma_f32 v[216:217], v[216:217], v[80:81], v[112:113]
  v_pk_mul_f32 v[114:115], v[98:99], v[68:69] op_sel_hi:[1,0]
  v_pk_fma_f32 v[218:219], v[218:219], v[82:83], v[114:115]
  v_pk_mul_f32 v[116:117], v[100:101], v[68:69] op_sel_hi:[1,0]
  v_pk_fma_f32 v[220:221], v[220:221], v[84:85], v[116:117]
  v_pk_mul_f32 v[118:119], v[102:103], v[68:69] op_sel_hi:[1,0]
  v_pk_fma_f32 v[222:223], v[222:223], v[86:87], v[118:119]
  v_cvt_pk_bf16_f32 v208, v208, v209
  v_cvt_pk_bf16_f32 v209, v210, v211
  v_cvt_pk_bf16_f32 v210, v212, v213
  v_cvt_pk_bf16_f32 v211, v214, v215
  v_cvt_pk_bf16_f32 v212, v216, v217
  v_cvt_pk_bf16_f32 v213, v218, v219
  v_cvt_pk_bf16_f32 v214, v220, v221
  v_cvt_pk_bf16_f32 v215, v222, v223
  buffer_store_dwordx4 v[208:211], v3, s[4:7], s37 offen offset:2048 sc1
  buffer_store_dwordx4 v[212:215], v3, s[4:7], s37 offen offset:3072 sc1
  ds_write_b128 v33, v[208:211] offset:2048
  ds_write_b128 v33, v[212:215] offset:3072
  v_pk_mul_f32 v[112:113], v[36:37], v[106:107] op_sel_hi:[1,0]
  v_pk_fma_f32 v[128:129], v[128:129], v[104:105], v[112:113] op_sel_hi:[1,0,1]
  v_pk_mul_f32 v[114:115], v[38:39], v[106:107] op_sel_hi:[1,0]
  v_pk_fma_f32 v[130:131], v[130:131], v[104:105], v[114:115] op_sel_hi:[1,0,1]
  v_pk_mul_f32 v[116:117], v[40:41], v[106:107] op_sel_hi:[1,0]
  v_pk_fma_f32 v[132:133], v[132:133], v[104:105], v[116:117] op_sel_hi:[1,0,1]
  v_pk_mul_f32 v[118:119], v[42:43], v[106:107] op_sel_hi:[1,0]
  v_pk_fma_f32 v[134:135], v[134:135], v[104:105], v[118:119] op_sel_hi:[1,0,1]
  v_pk_mul_f32 v[112:113], v[44:45], v[106:107] op_sel_hi:[1,0]
  v_pk_fma_f32 v[136:137], v[136:137], v[104:105], v[112:113] op_sel_hi:[1,0,1]
  v_pk_mul_f32 v[114:115], v[46:47], v[106:107] op_sel_hi:[1,0]
  v_pk_fma_f32 v[138:139], v[138:139], v[104:105], v[114:115] op_sel_hi:[1,0,1]
  v_pk_mul_f32 v[116:117], v[48:49], v[106:107] op_sel_hi:[1,0]
  v_pk_fma_f32 v[140:141], v[140:141], v[104:105], v[116:117] op_sel_hi:[1,0,1]
  v_pk_mul_f32 v[118:119], v[50:51], v[106:107] op_sel_hi:[1,0]
  v_pk_fma_f32 v[142:143], v[142:143], v[104:105], v[118:119] op_sel_hi:[1,0,1]
  v_cvt_pk_bf16_f32 v128, v128, v129
  v_cvt_pk_bf16_f32 v129, v130, v131
  v_cvt_pk_bf16_f32 v130, v132, v133
  v_cvt_pk_bf16_f32 v131, v134, v135
  v_cvt_pk_bf16_f32 v132, v136, v137
  v_cvt_pk_bf16_f32 v133, v138, v139
  v_cvt_pk_bf16_f32 v134, v140, v141
  v_cvt_pk_bf16_f32 v135, v142, v143
  ds_write_b128 v20, v[128:131] offset:57344
  ds_write_b128 v20, v[132:135] offset:58368
  v_pk_mul_f32 v[112:113], v[36:37], v[110:111] op_sel_hi:[1,0]
  v_pk_fma_f32 v[144:145], v[144:145], v[108:109], v[112:113] op_sel_hi:[1,0,1]
  v_pk_mul_f32 v[114:115], v[38:39], v[110:111] op_sel_hi:[1,0]
  v_pk_fma_f32 v[146:147], v[146:147], v[108:109], v[114:115] op_sel_hi:[1,0,1]
  v_pk_mul_f32 v[116:117], v[40:41], v[110:111] op_sel_hi:[1,0]
  v_pk_fma_f32 v[148:149], v[148:149], v[108:109], v[116:117] op_sel_hi:[1,0,1]
  v_pk_mul_f32 v[118:119], v[42:43], v[110:111] op_sel_hi:[1,0]
  v_pk_fma_f32 v[150:151], v[150:151], v[108:109], v[118:119] op_sel_hi:[1,0,1]
  v_pk_mul_f32 v[112:113], v[44:45], v[110:111] op_sel_hi:[1,0]
  v_pk_fma_f32 v[152:153], v[152:153], v[108:109], v[112:113] op_sel_hi:[1,0,1]
  v_pk_mul_f32 v[114:115], v[46:47], v[110:111] op_sel_hi:[1,0]
  v_pk_fma_f32 v[154:155], v[154:155], v[108:109], v[114:115] op_sel_hi:[1,0,1]
  v_pk_mul_f32 v[116:117], v[48:49], v[110:111] op_sel_hi:[1,0]
  v_pk_fma_f32 v[156:157], v[156:157], v[108:109], v[116:117] op_sel_hi:[1,0,1]
  v_pk_mul_f32 v[118:119], v[50:51], v[110:111] op_sel_hi:[1,0]
  v_pk_fma_f32 v[158:159], v[158:159], v[108:109], v[118:119] op_sel_hi:[1,0,1]
  v_cvt_pk_bf16_f32 v144, v144, v145
  v_cvt_pk_bf16_f32 v145, v146, v147
  v_cvt_pk_bf16_f32 v146, v148, v149
  v_cvt_pk_bf16_f32 v147, v150, v151
  v_cvt_pk_bf16_f32 v148, v152, v153
  v_cvt_pk_bf16_f32 v149, v154, v155
  v_cvt_pk_bf16_f32 v150, v156, v157
  v_cvt_pk_bf16_f32 v151, v158, v159
  ds_write_b128 v21, v[144:147] offset:57344
  ds_write_b128 v21, v[148:151] offset:58368
  s_lshl_b32 s31, s62, 2
  s_add_u32 s31, s31, 159936
  v_mov_b32 v8, s31
  s_waitcnt lgkmcnt(0)
  s_barrier
  s_mov_b64 exec, 1
  s_waitcnt vmcnt(0)
  ds_add_rtn_u32 v9, v8, v5
  s_waitcnt lgkmcnt(0)
  v_readfirstlane_b32 s31, v9
  s_mov_b64 exec, -1
  s_cmp_lg_u32 s31, 3
  s_cbranch_scc1 .fz_kernel_att
  v_lshlrev_b32 v7, 7, v2
  s_lshl_b32 s31, s18, 11
  s_lshl_b32 s33, 1, s17
  s_add_u32 s31, s31, s67
  s_add_u32 s31, s31, 0x1800000
  v_mov_b32 v8, s33
  s_mov_b64 exec, 0xffff
  buffer_atomic_or v8, v7, s[4:7], s31 offen sc1
  s_mov_b64 exec, -1
  s_branch .fz_kernel_att
.fz_kernel_q_prod1:
  s_cmp_ge_u32 s16, 6
  s_cbranch_scc1 .fz_kernel_q_help1
  s_cmp_eq_u32 s16, 5
  s_cbranch_scc1 .fz_kernel_q_pw
  s_mov_b32 s8, s40
  s_mov_b32 s9, s41
  s_mov_b32 s10, 0x400000
  s_mov_b32 s11, 0x00020000
  v_lshrrev_b32 v20, 3, v2
  v_and_b32 v21, 7, v2
  v_lshrrev_b32 v22, 4, v2
  v_xor_b32 v23, v21, v22
  v_lshlrev_b32 v23, 4, v23
  v_lshl_add_u32 v24, v20, 11, v23
  v_xor_b32 v25, 64, v24
  s_lshl_b32 s33, s17, 18
  v_add_u32 v32, 0, v24
  v_add_u32 v33, 15360, v25
  v_add_u32 v34, 30720, v24
  v_add_u32 v35, 46080, v25
  v_add_u32 v36, 65536, v24
  v_add_u32 v37, 80896, v25
  v_add_u32 v38, 96256, v24
  v_add_u32 v39, 111616, v25
  v_add_u32 v40, 131072, v24
  v_add_u32 v41, 146432, v25
  v_add_u32 v42, 161792, v24
  v_add_u32 v43, 177152, v25
  v_add_u32 v44, 196608, v24
  v_add_u32 v45, 211968, v25
  v_add_u32 v46, 227328, v24
  v_add_u32 v47, 242688, v25
  v_and_b32 v1, 3, v2
  v_lshlrev_b32 v1, 2, v1
  s_add_u32 s34, s71, 16
  v_add_u32 v1, s34, v1
  s_add_u32 s39, s71, 0
  v_mov_b32 v10, 0
  s_mov_b32 s34, -6
  s_add_u32 s35, s70, 8
  s_mov_b32 s30, 0
  .p2align 6
.fz_kernel_q_px1_l:
  s_waitcnt vmcnt(63) lgkmcnt(0)
  v_cmp_gt_i32 vcc, s34, v10
  s_cbranch_vccnz .fz_kernel_q_px1_w
.fz_kernel_q_px1_i:
  s_add_u32 m0, s30, 0
  s_nop 0
  buffer_load_dwordx4 v32, s[8:11], s33 offen offset:0 lds
  buffer_load_dwordx4 v33, s[8:11], s33 offen offset:1024 lds
  buffer_load_dwordx4 v34, s[8:11], s33 offen offset:2048 lds
  buffer_load_dwordx4 v35, s[8:11], s33 offen offset:3072 lds
  s_add_u32 m0, s30, 4096
  s_nop 0
  buffer_load_dwordx4 v36, s[8:11], s33 offen offset:0 lds
  buffer_load_dwordx4 v37, s[8:11], s33 offen offset:1024 lds
  buffer_load_dwordx4 v38, s[8:11], s33 offen offset:2048 lds
  buffer_load_dwordx4 v39, s[8:11], s33 offen offset:3072 lds
  s_add_u32 m0, s30, 8192
  s_nop 0
  buffer_load_dwordx4 v40, s[8:11], s33 offen offset:0 lds
  buffer_load_dwordx4 v41, s[8:11], s33 offen offset:1024 lds
  buffer_load_dwordx4 v42, s[8:11], s33 offen offset:2048 lds
  buffer_load_dwordx4 v43, s[8:11], s33 offen offset:3072 lds
  s_add_u32 m0, s30, 12288
  s_nop 0
  buffer_load_dwordx4 v44, s[8:11], s33 offen offset:0 lds
  buffer_load_dwordx4 v45, s[8:11], s33 offen offset:1024 lds
  buffer_load_dwordx4 v46, s[8:11], s33 offen offset:2048 lds
  buffer_load_dwordx4 v47, s[8:11], s33 offen offset:3072 lds
  s_add_u32 s33, s33, 128
  s_cmp_lg_u32 s34, 4294967290
  s_cbranch_scc1 .fz_kernel_q_px1_nb
  s_waitcnt vmcnt(16)
  s_barrier
.fz_kernel_q_px1_nb:
  ds_read_b32 v10, v1
  s_mov_b32 m0, s39
  s_mov_b64 exec, 1
  buffer_load_dword v4, s[4:7], s35 offen lds
  s_mov_b64 exec, -1
  s_add_u32 s30, s30, 16384
  s_cmp_eq_u32 s30, 65536
  s_cselect_b32 s30, 0, s30
  s_add_u32 s34, s34, 2
  s_add_u32 s35, s35, 8
  s_cmp_lt_i32 s34, 26
  s_cbranch_scc1 .fz_kernel_q_px1_l
  s_branch .fz_kernel_q_pe
.fz_kernel_q_px2:
  s_lshl_b32 s32, s17, 18
  s_add_u32 s32, s32, s73
  s_mov_b32 s29, s18
  s_lshl_b32 s36, 1, s18
  s_add_u32 s37, s19, s74
  s_add_u32 s37, s37, 8
  v_add_u32 v32, 0, v3
  v_add_u32 v33, 65536, v3
  v_add_u32 v34, 131072, v3
  v_add_u32 v35, 196608, v3
  s_waitcnt vmcnt(0)
  s_barrier
  v_and_b32 v1, 3, v2
  v_lshlrev_b32 v1, 2, v1
  s_add_u32 s34, s71, 16
  v_add_u32 v1, s34, v1
  s_add_u32 s39, s71, 0
  v_mov_b32 v10, 0
  s_mov_b32 s34, -6
  s_add_u32 s35, s70, 8
  s_mov_b32 s30, 0
  .p2align 6
.fz_kernel_q_px2_l:
  s_waitcnt vmcnt(63) lgkmcnt(0)
  v_cmp_gt_i32 vcc, s34, v10
  s_cbranch_vccnz .fz_kernel_q_px2_w
.fz_kernel_q_px2_i:
  s_bitcmp1_b32 s36, s29
  s_cbranch_scc0 .fz_kernel_q_xw
.fz_kernel_q_xok:
  s_lshl_b32 s33, s29, 12
  s_add_u32 s33, s33, s32
  s_add_u32 s29, s29, 1
  s_and_b32 s29, s29, 15
  s_add_u32 m0, s30, 0
  s_nop 0
  buffer_load_dwordx4 v32, s[4:7], s33 offen offset:0 lds
  buffer_load_dwordx4 v32, s[4:7], s33 offen offset:1024 lds
  buffer_load_dwordx4 v32, s[4:7], s33 offen offset:2048 lds
  buffer_load_dwordx4 v32, s[4:7], s33 offen offset:3072 lds
  s_add_u32 m0, s30, 4096
  s_nop 0
  buffer_load_dwordx4 v33, s[4:7], s33 offen offset:0 lds
  buffer_load_dwordx4 v33, s[4:7], s33 offen offset:1024 lds
  buffer_load_dwordx4 v33, s[4:7], s33 offen offset:2048 lds
  buffer_load_dwordx4 v33, s[4:7], s33 offen offset:3072 lds
  s_add_u32 m0, s30, 8192
  s_nop 0
  buffer_load_dwordx4 v34, s[4:7], s33 offen offset:0 lds
  buffer_load_dwordx4 v34, s[4:7], s33 offen offset:1024 lds
  buffer_load_dwordx4 v34, s[4:7], s33 offen offset:2048 lds
  buffer_load_dwordx4 v34, s[4:7], s33 offen offset:3072 lds
  s_add_u32 m0, s30, 12288
  s_nop 0
  buffer_load_dwordx4 v35, s[4:7], s33 offen offset:0 lds
  buffer_load_dwordx4 v35, s[4:7], s33 offen offset:1024 lds
  buffer_load_dwordx4 v35, s[4:7], s33 offen offset:2048 lds
  buffer_load_dwordx4 v35, s[4:7], s33 offen offset:3072 lds
  ds_read_b32 v10, v1
  s_mov_b32 m0, s39
  s_mov_b64 exec, 1
  buffer_load_dword v4, s[4:7], s35 offen lds
  s_mov_b64 exec, -1
  s_add_u32 s30, s30, 16384
  s_cmp_eq_u32 s30, 65536
  s_cselect_b32 s30, 0, s30
  s_add_u32 s34, s34, 2
  s_add_u32 s35, s35, 8
  s_cmp_lt_i32 s34, 26
  s_cbranch_scc1 .fz_kernel_q_px2_l
  s_branch .fz_kernel_q_pe
.fz_kernel_q_pw:
  s_mov_b32 s12, s42
  s_mov_b32 s13, s43
  s_mov_b32 s14, 0x600000
  s_mov_b32 s15, 0x00020000
  v_lshrrev_b32 v28, 3, v2
  v_and_b32 v29, 7, v2
  v_bfe_u32 v30, v2, 4, 1
  v_lshlrev_b32 v30, 2, v30
  v_xor_b32 v31, v29, v30
  v_lshlrev_b32 v31, 4, v31
  v_mul_u32_u24 v28, 6144, v28
  v_add_u32 v28, v28, v31
  s_lshl_b32 s32, s18, 7
  s_add_u32 s36, s32, 6291456
  s_mul_i32 s33, s18, 393216
  s_mul_i32 s33, s33, s62
  s_add_u32 s33, s33, s32
  v_add_u32 v32, 0, v28
  v_add_u32 v33, 48128, v28
  v_add_u32 v34, 96256, v28
  v_add_u32 v35, 144384, v28
  v_add_u32 v36, 2048, v28
  v_add_u32 v37, 50176, v28
  v_add_u32 v38, 98304, v28
  v_add_u32 v39, 146432, v28
  v_add_u32 v40, 4096, v28
  v_add_u32 v41, 52224, v28
  v_add_u32 v42, 100352, v28
  v_add_u32 v43, 148480, v28
  v_and_b32 v1, 3, v2
  v_lshlrev_b32 v1, 2, v1
  s_add_u32 s34, s71, 16
  v_add_u32 v1, s34, v1
  s_add_u32 s39, s71, 4
  v_mov_b32 v10, 0
  s_mov_b32 s34, -6
  s_add_u32 s35, s70, 4
  s_mov_b32 s30, 0
  .p2align 6
.fz_kernel_q_pw_l:
  s_waitcnt vmcnt(63) lgkmcnt(0)
  v_cmp_gt_i32 vcc, s34, v10
  s_cbranch_vccnz .fz_kernel_q_pw_w
.fz_kernel_q_pw_i:
  s_add_u32 m0, s30, 65536
  s_nop 0
  buffer_load_dwordx4 v32, s[12:15], s33 offen offset:0 lds
  buffer_load_dwordx4 v33, s[12:15], s33 offen offset:1024 lds
  buffer_load_dwordx4 v34, s[12:15], s33 offen offset:2048 lds
  buffer_load_dwordx4 v35, s[12:15], s33 offen offset:3072 lds
  s_add_u32 m0, s30, 69632
  s_nop 0
  buffer_load_dwordx4 v36, s[12:15], s33 offen offset:0 lds
  buffer_load_dwordx4 v37, s[12:15], s33 offen offset:1024 lds
  buffer_load_dwordx4 v38, s[12:15], s33 offen offset:2048 lds
  buffer_load_dwordx4 v39, s[12:15], s33 offen offset:3072 lds
  s_add_u32 m0, s30, 73728
  s_nop 0
  buffer_load_dwordx4 v40, s[12:15], s33 offen offset:0 lds
  buffer_load_dwordx4 v41, s[12:15], s33 offen offset:1024 lds
  buffer_load_dwordx4 v42, s[12:15], s33 offen offset:2048 lds
  buffer_load_dwordx4 v43, s[12:15], s33 offen offset:3072 lds
  s_add_u32 s33, s33, 196608
  s_cmp_eq_u32 s33, s36
  s_cselect_b32 s33, s32, s33
  s_cmp_lg_u32 s34, 4294967290
  s_cbranch_scc1 .fz_kernel_q_pw_nb
  s_waitcnt vmcnt(12)
  s_barrier
.fz_kernel_q_pw_nb:
  ds_read_b32 v10, v1
  s_mov_b32 m0, s39
  s_mov_b64 exec, 1
  buffer_load_dword v4, s[4:7], s35 offen lds
  s_mov_b64 exec, -1
  s_add_u32 s30, s30, 12288
  s_cmp_eq_u32 s30, 86016
  s_cselect_b32 s30, 0, s30
  s_add_u32 s34, s34, 1
  s_add_u32 s35, s35, 4
  s_cmp_lt_i32 s34, 26
  s_cbranch_scc1 .fz_kernel_q_pw_l
.fz_kernel_q_pe:
  s_waitcnt lgkmcnt(0)
  s_barrier
  s_barrier
  s_branch .fz_kernel_att
.fz_kernel_q_help1:
  s_cmp_eq_u32 s16, 7
  s_cbranch_scc1 .fz_kernel_q_h7
  v_cmp_gt_u32 vcc, 32, v2
  s_nop 1
  v_cndmask_b32 v8, 64, v2, vcc
  v_lshlrev_b32 v9, 2, v2
  buffer_store_dword v8, v9, s[4:7], s70 offen
  s_waitcnt vmcnt(0)
  s_barrier
  s_mov_b32 s8, s40
  s_mov_b32 s9, s41
  s_mov_b32 s10, 0x400000
  s_mov_b32 s11, 0x00020000
  s_mov_b32 s12, s58
  s_mov_b32 s13, s59
  s_mov_b32 s14, 0x100
  s_mov_b32 s15, 0x00020000
  v_lshrrev_b32 v20, 3, v2
  v_and_b32 v21, 7, v2
  v_lshlrev_b32 v21, 4, v21
  v_lshl_add_u32 v21, v20, 11, v21
  v_lshlrev_b32 v20, 3, v20
  s_lshl_b32 s30, s17, 18
  s_lshl_b32 s31, s18, 7
  s_add_u32 s30, s30, s31
  buffer_load_dwordx4 v[64:67], v21, s[8:11], s30 offen
  s_add_u32 s30, s30, 16384
  buffer_load_dwordx4 v[68:71], v21, s[8:11], s30 offen
  s_add_u32 s30, s30, 16384
  buffer_load_dwordx4 v[72:75], v21, s[8:11], s30 offen
  s_add_u32 s30, s30, 16384
  buffer_load_dwordx4 v[76:79], v21, s[8:11], s30 offen
  s_add_u32 s30, s30, 16384
  buffer_load_dwordx4 v[80:83], v21, s[8:11], s30 offen
  s_add_u32 s30, s30, 16384
  buffer_load_dwordx4 v[84:87], v21, s[8:11], s30 offen
  s_add_u32 s30, s30, 16384
  buffer_load_dwordx4 v[88:91], v21, s[8:11], s30 offen
  s_add_u32 s30, s30, 16384
  buffer_load_dwordx4 v[92:95], v21, s[8:11], s30 offen
  s_add_u32 s30, s30, 16384
  buffer_load_dwordx4 v[96:99], v21, s[8:11], s30 offen
  s_add_u32 s30, s30, 16384
  buffer_load_dwordx4 v[100:103], v21, s[8:11], s30 offen
  s_add_u32 s30, s30, 16384
  buffer_load_dwordx4 v[104:107], v21, s[8:11], s30 offen
  s_add_u32 s30, s30, 16384
  buffer_load_dwordx4 v[108:111], v21, s[8:11], s30 offen
  s_add_u32 s30, s30, 16384
  buffer_load_dwordx4 v[112:115], v21, s[8:11], s30 offen
  s_add_u32 s30, s30, 16384
  buffer_load_dwordx4 v[116:119], v21, s[8:11], s30 offen
  s_add_u32 s30, s30, 16384
  buffer_load_dwordx4 v[120:123], v21, s[8:11], s30 offen
  s_add_u32 s30, s30, 16384
  buffer_load_dwordx4 v[124:127], v21, s[8:11], s30 offen
  s_add_u32 s30, s30, 16384
  s_lshl_b32 s30, s17, 4
  s_add_u32 s30, s30, s18
  s_lshl_b32 s30, s30, 10
  s_add_u32 s30, s30, 0x1880000
  s_mov_b32 s34, 0x01010101
  s_mov_b32 s35, 0x01010101
  s_waitcnt vmcnt(15)
  v_lshlrev_b32 v22, 16, v64
  v_and_b32 v64, 0xffff0000, v64
  v_add_f32 v128, v22, v64
  v_mul_f32 v129, v22, v22
  v_fmac_f32 v129, v64, v64
  v_lshlrev_b32 v22, 16, v65
  v_and_b32 v65, 0xffff0000, v65
  v_add_f32 v128, v128, v22
  v_fmac_f32 v129, v22, v22
  v_add_f32 v128, v128, v65
  v_fmac_f32 v129, v65, v65
  v_lshlrev_b32 v22, 16, v66
  v_and_b32 v66, 0xffff0000, v66
  v_add_f32 v128, v128, v22
  v_fmac_f32 v129, v22, v22
  v_add_f32 v128, v128, v66
  v_fmac_f32 v129, v66, v66
  v_lshlrev_b32 v22, 16, v67
  v_and_b32 v67, 0xffff0000, v67
  v_add_f32 v128, v128, v22
  v_fmac_f32 v129, v22, v22
  v_add_f32 v128, v128, v67
  v_fmac_f32 v129, v67, v67
  s_waitcnt vmcnt(14)
  v_lshlrev_b32 v22, 16, v68
  v_and_b32 v68, 0xffff0000, v68
  v_add_f32 v130, v22, v68
  v_mul_f32 v131, v22, v22
  v_fmac_f32 v131, v68, v68
  v_lshlrev_b32 v22, 16, v69
  v_and_b32 v69, 0xffff0000, v69
  v_add_f32 v130, v130, v22
  v_fmac_f32 v131, v22, v22
  v_add_f32 v130, v130, v69
  v_fmac_f32 v131, v69, v69
  v_lshlrev_b32 v22, 16, v70
  v_and_b32 v70, 0xffff0000, v70
  v_add_f32 v130, v130, v22
  v_fmac_f32 v131, v22, v22
  v_add_f32 v130, v130, v70
  v_fmac_f32 v131, v70, v70
  v_lshlrev_b32 v22, 16, v71
  v_and_b32 v71, 0xffff0000, v71
  v_add_f32 v130, v130, v22
  v_fmac_f32 v131, v22, v22
  v_add_f32 v130, v130, v71
  v_fmac_f32 v131, v71, v71
  s_waitcnt vmcnt(13)
  v_lshlrev_b32 v22, 16, v72
  v_and_b32 v72, 0xffff0000, v72
  v_add_f32 v132, v22, v72
  v_mul_f32 v133, v22, v22
  v_fmac_f32 v133, v72, v72
  v_lshlrev_b32 v22, 16, v73
  v_and_b32 v73, 0xffff0000, v73
  v_add_f32 v132, v132, v22
  v_fmac_f32 v133, v22, v22
  v_add_f32 v132, v132, v73
  v_fmac_f32 v133, v73, v73
  v_lshlrev_b32 v22, 16, v74
  v_and_b32 v74, 0xffff0000, v74
  v_add_f32 v132, v132, v22
  v_fmac_f32 v133, v22, v22
  v_add_f32 v132, v132, v74
  v_fmac_f32 v133, v74, v74
  v_lshlrev_b32 v22, 16, v75
  v_and_b32 v75, 0xffff0000, v75
  v_add_f32 v132, v132, v22
  v_fmac_f32 v133, v22, v22
  v_add_f32 v132, v132, v75
  v_fmac_f32 v133, v75, v75
  s_waitcnt vmcnt(12)
  v_lshlrev_b32 v22, 16, v76
  v_and_b32 v76, 0xffff0000, v76
  v_add_f32 v134, v22, v76
  v_mul_f32 v135, v22, v22
  v_fmac_f32 v135, v76, v76
  v_lshlrev_b32 v22, 16, v77
  v_and_b32 v77, 0xffff0000, v77
  v_add_f32 v134, v134, v22
  v_fmac_f32 v135, v22, v22
  v_add_f32 v134, v134, v77
  v_fmac_f32 v135, v77, v77
  v_lshlrev_b32 v22, 16, v78
  v_and_b32 v78, 0xffff0000, v78
  v_add_f32 v134, v134, v22
  v_fmac_f32 v135, v22, v22
  v_add_f32 v134, v134, v78
  v_fmac_f32 v135, v78, v78
  v_lshlrev_b32 v22, 16, v79
  v_and_b32 v79, 0xffff0000, v79
  v_add_f32 v134, v134, v22
  v_fmac_f32 v135, v22, v22
  v_add_f32 v134, v134, v79
  v_fmac_f32 v135, v79, v79
  s_waitcnt vmcnt(11)
  v_lshlrev_b32 v22, 16, v80
  v_and_b32 v80, 0xffff0000, v80
  v_add_f32 v136, v22, v80
  v_mul_f32 v137, v22, v22
  v_fmac_f32 v137, v80, v80
  v_lshlrev_b32 v22, 16, v81
  v_and_b32 v81, 0xffff0000, v81
  v_add_f32 v136, v136, v22
  v_fmac_f32 v137, v22, v22
  v_add_f32 v136, v136, v81
  v_fmac_f32 v137, v81, v81
  v_lshlrev_b32 v22, 16, v82
  v_and_b32 v82, 0xffff0000, v82
  v_add_f32 v136, v136, v22
  v_fmac_f32 v137, v22, v22
  v_add_f32 v136, v136, v82
  v_fmac_f32 v137, v82, v82
  v_lshlrev_b32 v22, 16, v83
  v_and_b32 v83, 0xffff0000, v83
  v_add_f32 v136, v136, v22
  v_fmac_f32 v137, v22, v22
  v_add_f32 v136, v136, v83
  v_fmac_f32 v137, v83, v83
  s_waitcnt vmcnt(10)
  v_lshlrev_b32 v22, 16, v84
  v_and_b32 v84, 0xffff0000, v84
  v_add_f32 v138, v22, v84
  v_mul_f32 v139, v22, v22
  v_fmac_f32 v139, v84, v84
  v_lshlrev_b32 v22, 16, v85
  v_and_b32 v85, 0xffff0000, v85
  v_add_f32 v138, v138, v22
  v_fmac_f32 v139, v22, v22
  v_add_f32 v138, v138, v85
  v_fmac_f32 v139, v85, v85
  v_lshlrev_b32 v22, 16, v86
  v_and_b32 v86, 0xffff0000, v86
  v_add_f32 v138, v138, v22
  v_fmac_f32 v139, v22, v22
  v_add_f32 v138, v138, v86
  v_fmac_f32 v139, v86, v86
  v_lshlrev_b32 v22, 16, v87
  v_and_b32 v87, 0xffff0000, v87
  v_add_f32 v138, v138, v22
  v_fmac_f32 v139, v22, v22
  v_add_f32 v138, v138, v87
  v_fmac_f32 v139, v87, v87
  s_waitcnt vmcnt(9)
  v_lshlrev_b32 v22, 16, v88
  v_and_b32 v88, 0xffff0000, v88
  v_add_f32 v140, v22, v88
  v_mul_f32 v141, v22, v22
  v_fmac_f32 v141, v88, v88
  v_lshlrev_b32 v22, 16, v89
  v_and_b32 v89, 0xffff0000, v89
  v_add_f32 v140, v140, v22
  v_fmac_f32 v141, v22, v22
  v_add_f32 v140, v140, v89
  v_fmac_f32 v141, v89, v89
  v_lshlrev_b32 v22, 16, v90
  v_and_b32 v90, 0xffff0000, v90
  v_add_f32 v140, v140, v22
  v_fmac_f32 v141, v22, v22
  v_add_f32 v140, v140, v90
  v_fmac_f32 v141, v90, v90
  v_lshlrev_b32 v22, 16, v91
  v_and_b32 v91, 0xffff0000, v91
  v_add_f32 v140, v140, v22
  v_fmac_f32 v141, v22, v22
  v_add_f32 v140, v140, v91
  v_fmac_f32 v141, v91, v91
  s_waitcnt vmcnt(8)
  v_lshlrev_b32 v22, 16, v92
  v_and_b32 v92, 0xffff0000, v92
  v_add_f32 v142, v22, v92
  v_mul_f32 v143, v22, v22
  v_fmac_f32 v143, v92, v92
  v_lshlrev_b32 v22, 16, v93
  v_and_b32 v93, 0xffff0000, v93
  v_add_f32 v142, v142, v22
  v_fmac_f32 v143, v22, v22
  v_add_f32 v142, v142, v93
  v_fmac_f32 v143, v93, v93
  v_lshlrev_b32 v22, 16, v94
  v_and_b32 v94, 0xffff0000, v94
  v_add_f32 v142, v142, v22
  v_fmac_f32 v143, v22, v22
  v_add_f32 v142, v142, v94
  v_fmac_f32 v143, v94, v94
  v_lshlrev_b32 v22, 16, v95
  v_and_b32 v95, 0xffff0000, v95
  v_add_f32 v142, v142, v22
  v_fmac_f32 v143, v22, v22
  v_add_f32 v142, v142, v95
  v_fmac_f32 v143, v95, v95
  s_waitcnt vmcnt(7)
  v_lshlrev_b32 v22, 16, v96
  v_and_b32 v96, 0xffff0000, v96
  v_add_f32 v144, v22, v96
  v_mul_f32 v145, v22, v22
  v_fmac_f32 v145, v96, v96
  v_lshlrev_b32 v22, 16, v97
  v_and_b32 v97, 0xffff0000, v97
  v_add_f32 v144, v144, v22
  v_fmac_f32 v145, v22, v22
  v_add_f32 v144, v144, v97
  v_fmac_f32 v145, v97, v97
  v_lshlrev_b32 v22, 16, v98
  v_and_b32 v98, 0xffff0000, v98
  v_add_f32 v144, v144, v22
  v_fmac_f32 v145, v22, v22
  v_add_f32 v144, v144, v98
  v_fmac_f32 v145, v98, v98
  v_lshlrev_b32 v22, 16, v99
  v_and_b32 v99, 0xffff0000, v99
  v_add_f32 v144, v144, v22
  v_fmac_f32 v145, v22, v22
  v_add_f32 v144, v144, v99
  v_fmac_f32 v145, v99, v99
  s_waitcnt vmcnt(6)
  v_lshlrev_b32 v22, 16, v100
  v_and_b32 v100, 0xffff0000, v100
  v_add_f32 v146, v22, v100
  v_mul_f32 v147, v22, v22
  v_fmac_f32 v147, v100, v100
  v_lshlrev_b32 v22, 16, v101
  v_and_b32 v101, 0xffff0000, v101
  v_add_f32 v146, v146, v22
  v_fmac_f32 v147, v22, v22
  v_add_f32 v146, v146, v101
  v_fmac_f32 v147, v101, v101
  v_lshlrev_b32 v22, 16, v102
  v_and_b32 v102, 0xffff0000, v102
  v_add_f32 v146, v146, v22
  v_fmac_f32 v147, v22, v22
  v_add_f32 v146, v146, v102
  v_fmac_f32 v147, v102, v102
  v_lshlrev_b32 v22, 16, v103
  v_and_b32 v103, 0xffff0000, v103
  v_add_f32 v146, v146, v22
  v_fmac_f32 v147, v22, v22
  v_add_f32 v146, v146, v103
  v_fmac_f32 v147, v103, v103
  s_waitcnt vmcnt(5)
  v_lshlrev_b32 v22, 16, v104
  v_and_b32 v104, 0xffff0000, v104
  v_add_f32 v148, v22, v104
  v_mul_f32 v149, v22, v22
  v_fmac_f32 v149, v104, v104
  v_lshlrev_b32 v22, 16, v105
  v_and_b32 v105, 0xffff0000, v105
  v_add_f32 v148, v148, v22
  v_fmac_f32 v149, v22, v22
  v_add_f32 v148, v148, v105
  v_fmac_f32 v149, v105, v105
  v_lshlrev_b32 v22, 16, v106
  v_and_b32 v106, 0xffff0000, v106
  v_add_f32 v148, v148, v22
  v_fmac_f32 v149, v22, v22
  v_add_f32 v148, v148, v106
  v_fmac_f32 v149, v106, v106
  v_lshlrev_b32 v22, 16, v107
  v_and_b32 v107, 0xffff0000, v107
  v_add_f32 v148, v148, v22
  v_fmac_f32 v149, v22, v22
  v_add_f32 v148, v148, v107
  v_fmac_f32 v149, v107, v107
  s_waitcnt vmcnt(4)
  v_lshlrev_b32 v22, 16, v108
  v_and_b32 v108, 0xffff0000, v108
  v_add_f32 v150, v22, v108
  v_mul_f32 v151, v22, v22
  v_fmac_f32 v151, v108, v108
  v_lshlrev_b32 v22, 16, v109
  v_and_b32 v109, 0xffff0000, v109
  v_add_f32 v150, v150, v22
  v_fmac_f32 v151, v22, v22
  v_add_f32 v150, v150, v109
  v_fmac_f32 v151, v109, v109
  v_lshlrev_b32 v22, 16, v110
  v_and_b32 v110, 0xffff0000, v110
  v_add_f32 v150, v150, v22
  v_fmac_f32 v151, v22, v22
  v_add_f32 v150, v150, v110
  v_fmac_f32 v151, v110, v110
  v_lshlrev_b32 v22, 16, v111
  v_and_b32 v111, 0xffff0000, v111
  v_add_f32 v150, v150, v22
  v_fmac_f32 v151, v22, v22
  v_add_f32 v150, v150, v111
  v_fmac_f32 v151, v111, v111
  s_waitcnt vmcnt(3)
  v_lshlrev_b32 v22, 16, v112
  v_and_b32 v112, 0xffff0000, v112
  v_add_f32 v152, v22, v112
  v_mul_f32 v153, v22, v22
  v_fmac_f32 v153, v112, v112
  v_lshlrev_b32 v22, 16, v113
  v_and_b32 v113, 0xffff0000, v113
  v_add_f32 v152, v152, v22
  v_fmac_f32 v153, v22, v22
  v_add_f32 v152, v152, v113
  v_fmac_f32 v153, v113, v113
  v_lshlrev_b32 v22, 16, v114
  v_and_b32 v114, 0xffff0000, v114
  v_add_f32 v152, v152, v22
  v_fmac_f32 v153, v22, v22
  v_add_f32 v152, v152, v114
  v_fmac_f32 v153, v114, v114
  v_lshlrev_b32 v22, 16, v115
  v_and_b32 v115, 0xffff0000, v115
  v_add_f32 v152, v152, v22
  v_fmac_f32 v153, v22, v22
  v_add_f32 v152, v152, v115
  v_fmac_f32 v153, v115, v115
  s_waitcnt vmcnt(2)
  v_lshlrev_b32 v22, 16, v116
  v_and_b32 v116, 0xffff0000, v116
  v_add_f32 v154, v22, v116
  v_mul_f32 v155, v22, v22
  v_fmac_f32 v155, v116, v116
  v_lshlrev_b32 v22, 16, v117
  v_and_b32 v117, 0xffff0000, v117
  v_add_f32 v154, v154, v22
  v_fmac_f32 v155, v22, v22
  v_add_f32 v154, v154, v117
  v_fmac_f32 v155, v117, v117
  v_lshlrev_b32 v22, 16, v118
  v_and_b32 v118, 0xffff0000, v118
  v_add_f32 v154, v154, v22
  v_fmac_f32 v155, v22, v22
  v_add_f32 v154, v154, v118
  v_fmac_f32 v155, v118, v118
  v_lshlrev_b32 v22, 16, v119
  v_and_b32 v119, 0xffff0000, v119
  v_add_f32 v154, v154, v22
  v_fmac_f32 v155, v22, v22
  v_add_f32 v154, v154, v119
  v_fmac_f32 v155, v119, v119
  s_waitcnt vmcnt(1)
  v_lshlrev_b32 v22, 16, v120
  v_and_b32 v120, 0xffff0000, v120
  v_add_f32 v156, v22, v120
  v_mul_f32 v157, v22, v22
  v_fmac_f32 v157, v120, v120
  v_lshlrev_b32 v22, 16, v121
  v_and_b32 v121, 0xffff0000, v121
  v_add_f32 v156, v156, v22
  v_fmac_f32 v157, v22, v22
  v_add_f32 v156, v156, v121
  v_fmac_f32 v157, v121, v121
  v_lshlrev_b32 v22, 16, v122
  v_and_b32 v122, 0xffff0000, v122
  v_add_f32 v156, v156, v22
  v_fmac_f32 v157, v22, v22
  v_add_f32 v156, v156, v122
  v_fmac_f32 v157, v122, v122
  v_lshlrev_b32 v22, 16, v123
  v_and_b32 v123, 0xffff0000, v123
  v_add_f32 v156, v156, v22
  v_fmac_f32 v157, v22, v22
  v_add_f32 v156, v156, v123
  v_fmac_f32 v157, v123, v123
  s_waitcnt vmcnt(0)
  v_lshlrev_b32 v22, 16, v124
  v_and_b32 v124, 0xffff0000, v124
  v_add_f32 v158, v22, v124
  v_mul_f32 v159, v22, v22
  v_fmac_f32 v159, v124, v124
  v_lshlrev_b32 v22, 16, v125
  v_and_b32 v125, 0xffff0000, v125
  v_add_f32 v158, v158, v22
  v_fmac_f32 v159, v22, v22
  v_add_f32 v158, v158, v125
  v_fmac_f32 v159, v125, v125
  v_lshlrev_b32 v22, 16, v126
  v_and_b32 v126, 0xffff0000, v126
  v_add_f32 v158, v158, v22
  v_fmac_f32 v159, v22, v22
  v_add_f32 v158, v158, v126
  v_fmac_f32 v159, v126, v126
  v_lshlrev_b32 v22, 16, v127
  v_and_b32 v127, 0xffff0000, v127
  v_add_f32 v158, v158, v22
  v_fmac_f32 v159, v22, v22
  v_add_f32 v158, v158, v127
  v_fmac_f32 v159, v127, v127
  v_add_f32 v128, v128, v128 quad_perm:[1,0,3,2] row_mask:0xf bank_mask:0xf
  v_add_f32 v129, v129, v129 quad_perm:[1,0,3,2] row_mask:0xf bank_mask:0xf
  v_add_f32 v130, v130, v130 quad_perm:[1,0,3,2] row_mask:0xf bank_mask:0xf
  v_add_f32 v131, v131, v131 quad_perm:[1,0,3,2] row_mask:0xf bank_mask:0xf
  v_add_f32 v132, v132, v132 quad_perm:[1,0,3,2] row_mask:0xf bank_mask:0xf
  v_add_f32 v133, v133, v133 quad_perm:[1,0,3,2] row_mask:0xf bank_mask:0xf
  v_add_f32 v134, v134, v134 quad_perm:[1,0,3,2] row_mask:0xf bank_mask:0xf
  v_add_f32 v135, v135, v135 quad_perm:[1,0,3,2] row_mask:0xf bank_mask:0xf
  v_add_f32 v136, v136, v136 quad_perm:[1,0,3,2] row_mask:0xf bank_mask:0xf
  v_add_f32 v137, v137, v137 quad_perm:[1,0,3,2] row_mask:0xf bank_mask:0xf
  v_add_f32 v138, v138, v138 quad_perm:[1,0,3,2] row_mask:0xf bank_mask:0xf
  v_add_f32 v139, v139, v139 quad_perm:[1,0,3,2] row_mask:0xf bank_mask:0xf
  v_add_f32 v140, v140, v140 quad_perm:[1,0,3,2] row_mask:0xf bank_mask:0xf
  v_add_f32 v141, v141, v141 quad_perm:[1,0,3,2] row_mask:0xf bank_mask:0xf
  v_add_f32 v142, v142, v142 quad_perm:[1,0,3,2] row_mask:0xf bank_mask:0xf
  v_add_f32 v143, v143, v143 quad_perm:[1,0,3,2] row_mask:0xf bank_mask:0xf
  v_add_f32 v144, v144, v144 quad_perm:[1,0,3,2] row_mask:0xf bank_mask:0xf
  v_add_f32 v145, v145, v145 quad_perm:[1,0,3,2] row_mask:0xf bank_mask:0xf
  v_add_f32 v146, v146, v146 quad_perm:[1,0,3,2] row_mask:0xf bank_mask:0xf
  v_add_f32 v147, v147, v147 quad_perm:[1,0,3,2] row_mask:0xf bank_mask:0xf
  v_add_f32 v148, v148, v148 quad_perm:[1,0,3,2] row_mask:0xf bank_mask:0xf
  v_add_f32 v149, v149, v149 quad_perm:[1,0,3,2] row_mask:0xf bank_mask:0xf
  v_add_f32 v150, v150, v150 quad_perm:[1,0,3,2] row_mask:0xf bank_mask:0xf
  v_add_f32 v151, v151, v151 quad_perm:[1,0,3,2] row_mask:0xf bank_mask:0xf
  v_add_f32 v152, v152, v152 quad_perm:[1,0,3,2] row_mask:0xf bank_mask:0xf
  v_add_f32 v153, v153, v153 quad_perm:[1,0,3,2] row_mask:0xf bank_mask:0xf
  v_add_f32 v154, v154, v154 quad_perm:[1,0,3,2] row_mask:0xf bank_mask:0xf
  v_add_f32 v155, v155, v155 quad_perm:[1,0,3,2] row_mask:0xf bank_mask:0xf
  v_add_f32 v156, v156, v156 quad_perm:[1,0,3,2] row_mask:0xf bank_mask:0xf
  v_add_f32 v157, v157, v157 quad_perm:[1,0,3,2] row_mask:0xf bank_mask:0xf
  v_add_f32 v158, v158, v158 quad_perm:[1,0,3,2] row_mask:0xf bank_mask:0xf
  v_add_f32 v159, v159, v159 quad_perm:[1,0,3,2] row_mask:0xf bank_mask:0xf
  v_add_f32 v128, v128, v128 quad_perm:[2,3,0,1] row_mask:0xf bank_mask:0xf
  v_add_f32 v129, v129, v129 quad_perm:[2,3,0,1] row_mask:0xf bank_mask:0xf
  v_add_f32 v130, v130, v130 quad_perm:[2,3,0,1] row_mask:0xf bank_mask:0xf
  v_add_f32 v131, v131, v131 quad_perm:[2,3,0,1] row_mask:0xf bank_mask:0xf
  v_add_f32 v132, v132, v132 quad_perm:[2,3,0,1] row_mask:0xf bank_mask:0xf
  v_add_f32 v133, v133, v133 quad_perm:[2,3,0,1] row_mask:0xf bank_mask:0xf
  v_add_f32 v134, v134, v134 quad_perm:[2,3,0,1] row_mask:0xf bank_mask:0xf
  v_add_f32 v135, v135, v135 quad_perm:[2,3,0,1] row_mask:0xf bank_mask:0xf
  v_add_f32 v136, v136, v136 quad_perm:[2,3,0,1] row_mask:0xf bank_mask:0xf
  v_add_f32 v137, v137, v137 quad_perm:[2,3,0,1] row_mask:0xf bank_mask:0xf
  v_add_f32 v138, v138, v138 quad_perm:[2,3,0,1] row_mask:0xf bank_mask:0xf
  v_add_f32 v139, v139, v139 quad_perm:[2,3,0,1] row_mask:0xf bank_mask:0xf
  v_add_f32 v140, v140, v140 quad_perm:[2,3,0,1] row_mask:0xf bank_mask:0xf
  v_add_f32 v141, v141, v141 quad_perm:[2,3,0,1] row_mask:0xf bank_mask:0xf
  v_add_f32 v142, v142, v142 quad_perm:[2,3,0,1] row_mask:0xf bank_mask:0xf
  v_add_f32 v143, v143, v143 quad_perm:[2,3,0,1] row_mask:0xf bank_mask:0xf
  v_add_f32 v144, v144, v144 quad_perm:[2,3,0,1] row_mask:0xf bank_mask:0xf
  v_add_f32 v145, v145, v145 quad_perm:[2,3,0,1] row_mask:0xf bank_mask:0xf
  v_add_f32 v146, v146, v146 quad_perm:[2,3,0,1] row_mask:0xf bank_mask:0xf
  v_add_f32 v147, v147, v147 quad_perm:[2,3,0,1] row_mask:0xf bank_mask:0xf
  v_add_f32 v148, v148, v148 quad_perm:[2,3,0,1] row_mask:0xf bank_mask:0xf
  v_add_f32 v149, v149, v149 quad_perm:[2,3,0,1] row_mask:0xf bank_mask:0xf
  v_add_f32 v150, v150, v150 quad_perm:[2,3,0,1] row_mask:0xf bank_mask:0xf
  v_add_f32 v151, v151, v151 quad_perm:[2,3,0,1] row_mask:0xf bank_mask:0xf
  v_add_f32 v152, v152, v152 quad_perm:[2,3,0,1] row_mask:0xf bank_mask:0xf
  v_add_f32 v153, v153, v153 quad_perm:[2,3,0,1] row_mask:0xf bank_mask:0xf
  v_add_f32 v154, v154, v154 quad_perm:[2,3,0,1] row_mask:0xf bank_mask:0xf
  v_add_f32 v155, v155, v155 quad_perm:[2,3,0,1] row_mask:0xf bank_mask:0xf
  v_add_f32 v156, v156, v156 quad_perm:[2,3,0,1] row_mask:0xf bank_mask:0xf
  v_add_f32 v157, v157, v157 quad_perm:[2,3,0,1] row_mask:0xf bank_mask:0xf
  v_add_f32 v158, v158, v158 quad_perm:[2,3,0,1] row_mask:0xf bank_mask:0xf
  v_add_f32 v159, v159, v159 quad_perm:[2,3,0,1] row_mask:0xf bank_mask:0xf
  v_add_f32 v128, v128, v128 row_half_mirror row_mask:0xf bank_mask:0xf
  v_add_f32 v129, v129, v129 row_half_mirror row_mask:0xf bank_mask:0xf
  v_add_f32 v130, v130, v130 row_half_mirror row_mask:0xf bank_mask:0xf
  v_add_f32 v131, v131, v131 row_half_mirror row_mask:0xf bank_mask:0xf
  v_add_f32 v132, v132, v132 row_half_mirror row_mask:0xf bank_mask:0xf
  v_add_f32 v133, v133, v133 row_half_mirror row_mask:0xf bank_mask:0xf
  v_add_f32 v134, v134, v134 row_half_mirror row_mask:0xf bank_mask:0xf
  v_add_f32 v135, v135, v135 row_half_mirror row_mask:0xf bank_mask:0xf
  v_add_f32 v136, v136, v136 row_half_mirror row_mask:0xf bank_mask:0xf
  v_add_f32 v137, v137, v137 row_half_mirror row_mask:0xf bank_mask:0xf
  v_add_f32 v138, v138, v138 row_half_mirror row_mask:0xf bank_mask:0xf
  v_add_f32 v139, v139, v139 row_half_mirror row_mask:0xf bank_mask:0xf
  v_add_f32 v140, v140, v140 row_half_mirror row_mask:0xf bank_mask:0xf
  v_add_f32 v141, v141, v141 row_half_mirror row_mask:0xf bank_mask:0xf
  v_add_f32 v142, v142, v142 row_half_mirror row_mask:0xf bank_mask:0xf
  v_add_f32 v143, v143, v143 row_half_mirror row_mask:0xf bank_mask:0xf
  v_add_f32 v144, v144, v144 row_half_mirror row_mask:0xf bank_mask:0xf
  v_add_f32 v145, v145, v145 row_half_mirror row_mask:0xf bank_mask:0xf
  v_add_f32 v146, v146, v146 row_half_mirror row_mask:0xf bank_mask:0xf
  v_add_f32 v147, v147, v147 row_half_mirror row_mask:0xf bank_mask:0xf
  v_add_f32 v148, v148, v148 row_half_mirror row_mask:0xf bank_mask:0xf
  v_add_f32 v149, v149, v149 row_half_mirror row_mask:0xf bank_mask:0xf
  v_add_f32 v150, v150, v150 row_half_mirror row_mask:0xf bank_mask:0xf
  v_add_f32 v151, v151, v151 row_half_mirror row_mask:0xf bank_mask:0xf
  v_add_f32 v152, v152, v152 row_half_mirror row_mask:0xf bank_mask:0xf
  v_add_f32 v153, v153, v153 row_half_mirror row_mask:0xf bank_mask:0xf
  v_add_f32 v154, v154, v154 row_half_mirror row_mask:0xf bank_mask:0xf
  v_add_f32 v155, v155, v155 row_half_mirror row_mask:0xf bank_mask:0xf
  v_add_f32 v156, v156, v156 row_half_mirror row_mask:0xf bank_mask:0xf
  v_add_f32 v157, v157, v157 row_half_mirror row_mask:0xf bank_mask:0xf
  v_add_f32 v158, v158, v158 row_half_mirror row_mask:0xf bank_mask:0xf
  v_add_f32 v159, v159, v159 row_half_mirror row_mask:0xf bank_mask:0xf
  s_mov_b64 exec, s[34:35]
  buffer_store_dwordx2 v[128:129], v20, s[4:7], s30 offen offset:0 sc1
  buffer_store_dwordx2 v[130:131], v20, s[4:7], s30 offen offset:64 sc1
  buffer_store_dwordx2 v[132:133], v20, s[4:7], s30 offen offset:128 sc1
  buffer_store_dwordx2 v[134:135], v20, s[4:7], s30 offen offset:192 sc1
  buffer_store_dwordx2 v[136:137], v20, s[4:7], s30 offen offset:256 sc1
  buffer_store_dwordx2 v[138:139], v20, s[4:7], s30 offen offset:320 sc1
  buffer_store_dwordx2 v[140:141], v20, s[4:7], s30 offen offset:384 sc1
  buffer_store_dwordx2 v[142:143], v20, s[4:7], s30 offen offset:448 sc1
  buffer_store_dwordx2 v[144:145], v20, s[4:7], s30 offen offset:512 sc1
  buffer_store_dwordx2 v[146:147], v20, s[4:7], s30 offen offset:576 sc1
  buffer_store_dwordx2 v[148:149], v20, s[4:7], s30 offen offset:640 sc1
  buffer_store_dwordx2 v[150:151], v20, s[4:7], s30 offen offset:704 sc1
  buffer_store_dwordx2 v[152:153], v20, s[4:7], s30 offen offset:768 sc1
  buffer_store_dwordx2 v[154:155], v20, s[4:7], s30 offen offset:832 sc1
  buffer_store_dwordx2 v[156:157], v20, s[4:7], s30 offen offset:896 sc1
  buffer_store_dwordx2 v[158:159], v20, s[4:7], s30 offen offset:960 sc1
  buffer_load_dword v9, v4, s[12:15], 0 offen sc1
  s_mov_b64 exec, 1
  s_mov_b32 s38, 0
.fz_kernel_pw1:
  s_waitcnt vmcnt(0)
  v_readfirstlane_b32 s31, v9
  s_cmp_eq_u32 s31, 32
  s_cbranch_scc1 .fz_kernel_pw1d
  s_sleep 4
  buffer_load_dword v9, v4, s[12:15], 0 offen sc1
  s_add_u32 s38, s38, 1
  s_cmp_lt_u32 s38, 131072
  s_cbranch_scc1 .fz_kernel_pw1
  s_waitcnt vmcnt(0)
.fz_kernel_pw1d:
  s_mov_b64 exec, -1
  v_lshlrev_b32 v7, 11, v2
  s_lshl_b32 s31, s17, 7
  s_lshl_b32 s33, 1, s18
  s_add_u32 s31, s31, s67
  s_add_u32 s31, s31, 0x1800018
  v_mov_b32 v8, s33
  s_mov_b64 exec, 0xffff
  buffer_atomic_or v8, v7, s[4:7], s31 offen sc1
  s_mov_b64 exec, -1
  s_mov_b32 s20, s48
  s_mov_b32 s21, s49
  s_mov_b32 s22, 0x800
  s_mov_b32 s23, 0x00020000
  v_lshlrev_b32 v20, 5, v2
  buffer_load_dwordx4 v[24:27], v20, s[20:23], 0 offen
  buffer_load_dwordx4 v[28:31], v20, s[20:23], 0 offen offset:16
  v_mov_b32 v20, 0
  s_waitcnt vmcnt(0)
  v_lshlrev_b32 v21, 16, v24
  v_and_b32 v22, 0xffff0000, v24
  v_add_f32 v20, v20, v21
  v_add_f32 v20, v20, v22
  v_lshlrev_b32 v21, 16, v25
  v_and_b32 v22, 0xffff0000, v25
  v_add_f32 v20, v20, v21
  v_add_f32 v20, v20, v22
  v_lshlrev_b32 v21, 16, v26
  v_and_b32 v22, 0xffff0000, v26
  v_add_f32 v20, v20, v21
  v_add_f32 v20, v20, v22
  v_lshlrev_b32 v21, 16, v27
  v_and_b32 v22, 0xffff0000, v27
  v_add_f32 v20, v20, v21
  v_add_f32 v20, v20, v22
  v_lshlrev_b32 v21, 16, v28
  v_and_b32 v22, 0xffff0000, v28
  v_add_f32 v20, v20, v21
  v_add_f32 v20, v20, v22
  v_lshlrev_b32 v21, 16, v29
  v_and_b32 v22, 0xffff0000, v29
  v_add_f32 v20, v20, v21
  v_add_f32 v20, v20, v22
  v_lshlrev_b32 v21, 16, v30
  v_and_b32 v22, 0xffff0000, v30
  v_add_f32 v20, v20, v21
  v_add_f32 v20, v20, v22
  v_lshlrev_b32 v21, 16, v31
  v_and_b32 v22, 0xffff0000, v31
  v_add_f32 v20, v20, v21
  v_add_f32 v20, v20, v22
  s_nop 1
  v_add_f32 v20, v20, v20 quad_perm:[1,0,3,2] row_mask:0xf bank_mask:0xf
  s_nop 1
  v_add_f32 v20, v20, v20 quad_perm:[2,3,0,1] row_mask:0xf bank_mask:0xf
  s_nop 1
  v_add_f32 v20, v20, v20 row_half_mirror row_mask:0xf bank_mask:0xf
  s_nop 1
  v_add_f32 v20, v20, v20 row_mirror row_mask:0xf bank_mask:0xf
  s_nop 0
  v_readlane_b32 s20, v20, 16
  v_readlane_b32 s21, v20, 32
  v_readlane_b32 s22, v20, 48
  v_add_f32 v20, s20, v20
  v_add_f32 v20, s21, v20
  v_add_f32 v20, s22, v20
  v_mul_f32 v20, 0x3a800000, v20
  s_nop 0
  v_readfirstlane_b32 s76, v20
  s_add_u32 s37, s19, 24
  v_mov_b32 v9, 0
  s_mov_b64 exec, 1
  s_mov_b32 s38, 0
.fz_kernel_pw2:
  s_waitcnt vmcnt(0)
  v_readfirstlane_b32 s31, v9
  s_cmp_eq_u32 s31, 65535
  s_cbranch_scc1 .fz_kernel_pw2d
  s_sleep 4
  buffer_load_dword v9, v4, s[4:7], s37 offen sc1
  s_add_u32 s38, s38, 1
  s_cmp_lt_u32 s38, 131072
  s_cbranch_scc1 .fz_kernel_pw2
  s_waitcnt vmcnt(0)
.fz_kernel_pw2d:
  s_mov_b64 exec, -1
  s_lshl_b32 s30, s17, 14
  s_add_u32 s30, s30, 0x1880000
  buffer_load_dwordx4 v[64:67], v3, s[4:7], s30 offen offset:0
  buffer_load_dwordx4 v[68:71], v3, s[4:7], s30 offen offset:1024
  buffer_load_dwordx4 v[72:75], v3, s[4:7], s30 offen offset:2048
  buffer_load_dwordx4 v[76:79], v3, s[4:7], s30 offen offset:3072
  s_add_u32 s30, s30, 4096
  buffer_load_dwordx4 v[80:83], v3, s[4:7], s30 offen offset:0
  buffer_load_dwordx4 v[84:87], v3, s[4:7], s30 offen offset:1024
  buffer_load_dwordx4 v[88:91], v3, s[4:7], s30 offen offset:2048
  buffer_load_dwordx4 v[92:95], v3, s[4:7], s30 offen offset:3072
  s_add_u32 s30, s30, 4096
  buffer_load_dwordx4 v[96:99], v3, s[4:7], s30 offen offset:0
  buffer_load_dwordx4 v[100:103], v3, s[4:7], s30 offen offset:1024
  buffer_load_dwordx4 v[104:107], v3, s[4:7], s30 offen offset:2048
  buffer_load_dwordx4 v[108:111], v3, s[4:7], s30 offen offset:3072
  s_add_u32 s30, s30, 4096
  buffer_load_dwordx4 v[112:115], v3, s[4:7], s30 offen offset:0
  buffer_load_dwordx4 v[116:119], v3, s[4:7], s30 offen offset:1024
  buffer_load_dwordx4 v[120:123], v3, s[4:7], s30 offen offset:2048
  buffer_load_dwordx4 v[124:127], v3, s[4:7], s30 offen offset:3072
  s_add_u32 s30, s30, 4096
  s_waitcnt vmcnt(14)
  v_add_f32 v64, v64, v68
  v_add_f32 v65, v65, v69
  v_add_f32 v66, v66, v70
  v_add_f32 v67, v67, v71
  s_waitcnt vmcnt(13)
  v_add_f32 v64, v64, v72
  v_add_f32 v65, v65, v73
  v_add_f32 v66, v66, v74
  v_add_f32 v67, v67, v75
  s_waitcnt vmcnt(12)
  v_add_f32 v64, v64, v76
  v_add_f32 v65, v65, v77
  v_add_f32 v66, v66, v78
  v_add_f32 v67, v67, v79
  s_waitcnt vmcnt(11)
  v_add_f32 v64, v64, v80
  v_add_f32 v65, v65, v81
  v_add_f32 v66, v66, v82
  v_add_f32 v67, v67, v83
  s_waitcnt vmcnt(10)
  v_add_f32 v64, v64, v84
  v_add_f32 v65, v65, v85
  v_add_f32 v66, v66, v86
  v_add_f32 v67, v67, v87
  s_waitcnt vmcnt(9)
  v_add_f32 v64, v64, v88
  v_add_f32 v65, v65, v89
  v_add_f32 v66, v66, v90
  v_add_f32 v67, v67, v91
  s_waitcnt vmcnt(8)
  v_add_f32 v64, v64, v92
  v_add_f32 v65, v65, v93
  v_add_f32 v66, v66, v94
  v_add_f32 v67, v67, v95
  s_waitcnt vmcnt(7)
  v_add_f32 v64, v64, v96
  v_add_f32 v65, v65, v97
  v_add_f32 v66, v66, v98
  v_add_f32 v67, v67, v99
  s_waitcnt vmcnt(6)
  v_add_f32 v64, v64, v100
  v_add_f32 v65, v65, v101
  v_add_f32 v66, v66, v102
  v_add_f32 v67, v67, v103
  s_waitcnt vmcnt(5)
  v_add_f32 v64, v64, v104
  v_add_f32 v65, v65, v105
  v_add_f32 v66, v66, v106
  v_add_f32 v67, v67, v107
  s_waitcnt vmcnt(4)
  v_add_f32 v64, v64, v108
  v_add_f32 v65, v65, v109
  v_add_f32 v66, v66, v110
  v_add_f32 v67, v67, v111
  s_waitcnt vmcnt(3)
  v_add_f32 v64, v64, v112
  v_add_f32 v65, v65, v113
  v_add_f32 v66, v66, v114
  v_add_f32 v67, v67, v115
  s_waitcnt vmcnt(2)
  v_add_f32 v64, v64, v116
  v_add_f32 v65, v65, v117
  v_add_f32 v66, v66, v118
  v_add_f32 v67, v67, v119
  s_waitcnt vmcnt(1)
  v_add_f32 v64, v64, v120
  v_add_f32 v65, v65, v121
  v_add_f32 v66, v66, v122
  v_add_f32 v67, v67, v123
  s_waitcnt vmcnt(0)
  v_add_f32 v64, v64, v124
  v_add_f32 v65, v65, v125
  v_add_f32 v66, v66, v126
  v_add_f32 v67, v67, v127
  v_mov_b32 v26, 0.0009765625
  v_mul_f32 v20, v26, v64
  v_mul_f32 v27, v20, v20
  v_fma_f32 v22, v65, v26, -v27
  v_max_f32 v22, 0, v22
  v_add_f32 v22, 1e-05, v22
  v_rsq_f32 v22, v22
  s_nop 0
  v_mul_f32 v20, v20, v22
  v_sub_f32 v20, 0, v20
  v_mul_f32 v21, v26, v66
  v_mul_f32 v27, v21, v21
  v_fma_f32 v23, v67, v26, -v27
  v_max_f32 v23, 0, v23
  v_add_f32 v23, 1e-05, v23
  v_rsq_f32 v23, v23
  s_nop 0
  v_mul_f32 v21, v21, v23
  v_sub_f32 v21, 0, v21
  v_lshlrev_b32 v24, 3, v2
  v_add_u32 v24, 155648, v24
  ds_write_b64 v24, v[22:23] offset:4608
  ds_write_b64 v24, v[20:21] offset:5120
  v_mov_b32 v20, 1.0
  v_mov_b32 v21, 1.0
  v_mov_b32 v22, 0
  v_mov_b32 v23, 0
  ds_write_b64 v24, v[20:21] offset:6400
  ds_write_b64 v24, v[22:23] offset:6912
  v_mov_b32 v24, 159952
  v_mov_b32 v25, s76
  ds_write_b32 v24, v25 offset:8
  s_waitcnt lgkmcnt(0)
.fz_kernel_q_h6e:
  s_barrier
  s_add_u32 s37, s19, s67
  s_mov_b64 exec, 1
  buffer_load_dword v7, v4, s[4:7], s37 offen sc1
  s_waitcnt vmcnt(0)
  ds_or_b32 v6, v7
  s_mov_b64 exec, -1
  s_waitcnt lgkmcnt(0)
  s_barrier
  s_branch .fz_kernel_att
.fz_kernel_q_h7:
  s_mov_b32 s8, s58
  s_mov_b32 s9, s59
  s_mov_b32 s10, 0x100
  s_mov_b32 s11, 0x00020000
  v_mov_b32 v12, 0
  v_mov_b32 v13, 0
  v_mov_b32 v14, 0
  v_mov_b32 v15, 0
  s_cmp_ge_u32 s2, 32
  s_cbranch_scc1 .fz_kernel_q_nzero
  s_lshl_b32 s36, s2, 10
  s_add_u32 s36, s36, 0x1800000
  buffer_store_dwordx4 v[12:15], v3, s[4:7], s36 offen sc1
.fz_kernel_q_nzero:
  s_barrier
  s_cbranch_scc1 .fz_kernel_q_nzero2
  s_mov_b64 exec, 1
  s_waitcnt vmcnt(0)
  buffer_atomic_add v5, v4, s[8:11], 0 offen sc1
  s_mov_b64 exec, -1
.fz_kernel_q_nzero2:
  s_mov_b32 s12, s42
  s_mov_b32 s13, s43
  s_mov_b32 s14, 0x600000
  s_mov_b32 s15, 0x00020000
  v_lshrrev_b32 v20, 3, v2
  v_and_b32 v21, 7, v2
  v_mul_u32_u24 v20, 6144, v20
  v_lshl_add_u32 v20, v21, 4, v20
  s_mul_i32 s30, s17, 393216
  s_lshl_b32 s31, s18, 7
  s_add_u32 s30, s30, s31
  s_add_u32 s31, s30, 4096
  buffer_load_dwordx4 v[64:67], v20, s[12:15], s30 offen
  buffer_load_dwordx4 v[68:71], v20, s[12:15], s30 offen offset:2048
  buffer_load_dwordx4 v[72:75], v20, s[12:15], s31 offen
  s_add_u32 s30, s30, 49152
  s_add_u32 s31, s31, 49152
  buffer_load_dwordx4 v[76:79], v20, s[12:15], s30 offen
  buffer_load_dwordx4 v[80:83], v20, s[12:15], s30 offen offset:2048
  buffer_load_dwordx4 v[84:87], v20, s[12:15], s31 offen
  s_add_u32 s30, s30, 49152
  s_add_u32 s31, s31, 49152
  buffer_load_dwordx4 v[88:91], v20, s[12:15], s30 offen
  buffer_load_dwordx4 v[92:95], v20, s[12:15], s30 offen offset:2048
  buffer_load_dwordx4 v[96:99], v20, s[12:15], s31 offen
  s_add_u32 s30, s30, 49152
  s_add_u32 s31, s31, 49152
  buffer_load_dwordx4 v[100:103], v20, s[12:15], s30 offen
  buffer_load_dwordx4 v[104:107], v20, s[12:15], s30 offen offset:2048
  buffer_load_dwordx4 v[108:111], v20, s[12:15], s31 offen
  s_add_u32 s30, s30, 49152
  s_add_u32 s31, s31, 49152
  buffer_load_dwordx4 v[112:115], v20, s[12:15], s30 offen
  buffer_load_dwordx4 v[116:119], v20, s[12:15], s30 offen offset:2048
  buffer_load_dwordx4 v[120:123], v20, s[12:15], s31 offen
  s_add_u32 s30, s30, 49152
  s_add_u32 s31, s31, 49152
  buffer_load_dwordx4 v[124:127], v20, s[12:15], s30 offen
  buffer_load_dwordx4 v[128:131], v20, s[12:15], s30 offen offset:2048
  buffer_load_dwordx4 v[132:135], v20, s[12:15], s31 offen
  s_add_u32 s30, s30, 49152
  s_add_u32 s31, s31, 49152
  buffer_load_dwordx4 v[136:139], v20, s[12:15], s30 offen
  buffer_load_dwordx4 v[140:143], v20, s[12:15], s30 offen offset:2048
  buffer_load_dwordx4 v[144:147], v20, s[12:15], s31 offen
  s_add_u32 s30, s30, 49152
  s_add_u32 s31, s31, 49152
  buffer_load_dwordx4 v[148:151], v20, s[12:15], s30 offen
  buffer_load_dwordx4 v[152:155], v20, s[12:15], s30 offen offset:2048
  buffer_load_dwordx4 v[156:159], v20, s[12:15], s31 offen
  s_add_u32 s30, s30, 49152
  s_add_u32 s31, s31, 49152
  v_lshlrev_b32 v21, 5, v21
  v_lshrrev_b32 v22, 5, v2
  v_lshl_add_u32 v21, v22, 4, v21
  v_bfe_u32 v22, v2, 4, 1
  v_lshl_add_u32 v21, v22, 3, v21
  s_lshl_b32 s30, s18, 4
  s_add_u32 s30, s30, s17
  s_mul_i32 s30, s30, 768
  s_add_u32 s30, s30, 0x18c0000
  s_mov_b32 s34, 0x00ff00ff
  s_mov_b32 s35, 0x00ff00ff
  s_waitcnt vmcnt(23)
  v_lshlrev_b32 v160, 16, v64
  v_and_b32 v161, 0xffff0000, v64
  v_lshlrev_b32 v162, 16, v65
  v_and_b32 v163, 0xffff0000, v65
  v_lshlrev_b32 v164, 16, v66
  v_and_b32 v165, 0xffff0000, v66
  v_lshlrev_b32 v166, 16, v67
  v_and_b32 v167, 0xffff0000, v67
  s_waitcnt vmcnt(22)
  v_lshlrev_b32 v168, 16, v68
  v_and_b32 v169, 0xffff0000, v68
  v_lshlrev_b32 v170, 16, v69
  v_and_b32 v171, 0xffff0000, v69
  v_lshlrev_b32 v172, 16, v70
  v_and_b32 v173, 0xffff0000, v70
  v_lshlrev_b32 v174, 16, v71
  v_and_b32 v175, 0xffff0000, v71
  s_waitcnt vmcnt(21)
  v_lshlrev_b32 v176, 16, v72
  v_and_b32 v177, 0xffff0000, v72
  v_lshlrev_b32 v178, 16, v73
  v_and_b32 v179, 0xffff0000, v73
  v_lshlrev_b32 v180, 16, v74
  v_and_b32 v181, 0xffff0000, v74
  v_lshlrev_b32 v182, 16, v75
  v_and_b32 v183, 0xffff0000, v75
  s_waitcnt vmcnt(20)
  v_lshlrev_b32 v184, 16, v76
  v_and_b32 v185, 0xffff0000, v76
  v_lshlrev_b32 v186, 16, v77
  v_and_b32 v187, 0xffff0000, v77
  v_lshlrev_b32 v188, 16, v78
  v_and_b32 v189, 0xffff0000, v78
  v_lshlrev_b32 v190, 16, v79
  v_and_b32 v191, 0xffff0000, v79
  v_add_f32 v160, v160, v184
  v_add_f32 v161, v161, v185
  v_add_f32 v162, v162, v186
  v_add_f32 v163, v163, v187
  v_add_f32 v164, v164, v188
  v_add_f32 v165, v165, v189
  v_add_f32 v166, v166, v190
  v_add_f32 v167, v167, v191
  s_waitcnt vmcnt(19)
  v_lshlrev_b32 v184, 16, v80
  v_and_b32 v185, 0xffff0000, v80
  v_lshlrev_b32 v186, 16, v81
  v_and_b32 v187, 0xffff0000, v81
  v_lshlrev_b32 v188, 16, v82
  v_and_b32 v189, 0xffff0000, v82
  v_lshlrev_b32 v190, 16, v83
  v_and_b32 v191, 0xffff0000, v83
  v_add_f32 v168, v168, v184
  v_add_f32 v169, v169, v185
  v_add_f32 v170, v170, v186
  v_add_f32 v171, v171, v187
  v_add_f32 v172, v172, v188
  v_add_f32 v173, v173, v189
  v_add_f32 v174, v174, v190
  v_add_f32 v175, v175, v191
  s_waitcnt vmcnt(18)
  v_lshlrev_b32 v184, 16, v84
  v_and_b32 v185, 0xffff0000, v84
  v_lshlrev_b32 v186, 16, v85
  v_and_b32 v187, 0xffff0000, v85
  v_lshlrev_b32 v188, 16, v86
  v_and_b32 v189, 0xffff0000, v86
  v_lshlrev_b32 v190, 16, v87
  v_and_b32 v191, 0xffff0000, v87
  v_add_f32 v176, v176, v184
  v_add_f32 v177, v177, v185
  v_add_f32 v178, v178, v186
  v_add_f32 v179, v179, v187
  v_add_f32 v180, v180, v188
  v_add_f32 v181, v181, v189
  v_add_f32 v182, v182, v190
  v_add_f32 v183, v183, v191
  s_waitcnt vmcnt(17)
  v_lshlrev_b32 v184, 16, v88
  v_and_b32 v185, 0xffff0000, v88
  v_lshlrev_b32 v186, 16, v89
  v_and_b32 v187, 0xffff0000, v89
  v_lshlrev_b32 v188, 16, v90
  v_and_b32 v189, 0xffff0000, v90
  v_lshlrev_b32 v190, 16, v91
  v_and_b32 v191, 0xffff0000, v91
  v_add_f32 v160, v160, v184
  v_add_f32 v161, v161, v185
  v_add_f32 v162, v162, v186
  v_add_f32 v163, v163, v187
  v_add_f32 v164, v164, v188
  v_add_f32 v165, v165, v189
  v_add_f32 v166, v166, v190
  v_add_f32 v167, v167, v191
  s_waitcnt vmcnt(16)
  v_lshlrev_b32 v184, 16, v92
  v_and_b32 v185, 0xffff0000, v92
  v_lshlrev_b32 v186, 16, v93
  v_and_b32 v187, 0xffff0000, v93
  v_lshlrev_b32 v188, 16, v94
  v_and_b32 v189, 0xffff0000, v94
  v_lshlrev_b32 v190, 16, v95
  v_and_b32 v191, 0xffff0000, v95
  v_add_f32 v168, v168, v184
  v_add_f32 v169, v169, v185
  v_add_f32 v170, v170, v186
  v_add_f32 v171, v171, v187
  v_add_f32 v172, v172, v188
  v_add_f32 v173, v173, v189
  v_add_f32 v174, v174, v190
  v_add_f32 v175, v175, v191
  s_waitcnt vmcnt(15)
  v_lshlrev_b32 v184, 16, v96
  v_and_b32 v185, 0xffff0000, v96
  v_lshlrev_b32 v186, 16, v97
  v_and_b32 v187, 0xffff0000, v97
  v_lshlrev_b32 v188, 16, v98
  v_and_b32 v189, 0xffff0000, v98
  v_lshlrev_b32 v190, 16, v99
  v_and_b32 v191, 0xffff0000, v99
  v_add_f32 v176, v176, v184
  v_add_f32 v177, v177, v185
  v_add_f32 v178, v178, v186
  v_add_f32 v179, v179, v187
  v_add_f32 v180, v180, v188
  v_add_f32 v181, v181, v189
  v_add_f32 v182, v182, v190
  v_add_f32 v183, v183, v191
  s_waitcnt vmcnt(14)
  v_lshlrev_b32 v184, 16, v100
  v_and_b32 v185, 0xffff0000, v100
  v_lshlrev_b32 v186, 16, v101
  v_and_b32 v187, 0xffff0000, v101
  v_lshlrev_b32 v188, 16, v102
  v_and_b32 v189, 0xffff0000, v102
  v_lshlrev_b32 v190, 16, v103
  v_and_b32 v191, 0xffff0000, v103
  v_add_f32 v160, v160, v184
  v_add_f32 v161, v161, v185
  v_add_f32 v162, v162, v186
  v_add_f32 v163, v163, v187
  v_add_f32 v164, v164, v188
  v_add_f32 v165, v165, v189
  v_add_f32 v166, v166, v190
  v_add_f32 v167, v167, v191
  s_waitcnt vmcnt(13)
  v_lshlrev_b32 v184, 16, v104
  v_and_b32 v185, 0xffff0000, v104
  v_lshlrev_b32 v186, 16, v105
  v_and_b32 v187, 0xffff0000, v105
  v_lshlrev_b32 v188, 16, v106
  v_and_b32 v189, 0xffff0000, v106
  v_lshlrev_b32 v190, 16, v107
  v_and_b32 v191, 0xffff0000, v107
  v_add_f32 v168, v168, v184
  v_add_f32 v169, v169, v185
  v_add_f32 v170, v170, v186
  v_add_f32 v171, v171, v187
  v_add_f32 v172, v172, v188
  v_add_f32 v173, v173, v189
  v_add_f32 v174, v174, v190
  v_add_f32 v175, v175, v191
  s_waitcnt vmcnt(12)
  v_lshlrev_b32 v184, 16, v108
  v_and_b32 v185, 0xffff0000, v108
  v_lshlrev_b32 v186, 16, v109
  v_and_b32 v187, 0xffff0000, v109
  v_lshlrev_b32 v188, 16, v110
  v_and_b32 v189, 0xffff0000, v110
  v_lshlrev_b32 v190, 16, v111
  v_and_b32 v191, 0xffff0000, v111
  v_add_f32 v176, v176, v184
  v_add_f32 v177, v177, v185
  v_add_f32 v178, v178, v186
  v_add_f32 v179, v179, v187
  v_add_f32 v180, v180, v188
  v_add_f32 v181, v181, v189
  v_add_f32 v182, v182, v190
  v_add_f32 v183, v183, v191
  s_waitcnt vmcnt(11)
  v_lshlrev_b32 v184, 16, v112
  v_and_b32 v185, 0xffff0000, v112
  v_lshlrev_b32 v186, 16, v113
  v_and_b32 v187, 0xffff0000, v113
  v_lshlrev_b32 v188, 16, v114
  v_and_b32 v189, 0xffff0000, v114
  v_lshlrev_b32 v190, 16, v115
  v_and_b32 v191, 0xffff0000, v115
  v_add_f32 v160, v160, v184
  v_add_f32 v161, v161, v185
  v_add_f32 v162, v162, v186
  v_add_f32 v163, v163, v187
  v_add_f32 v164, v164, v188
  v_add_f32 v165, v165, v189
  v_add_f32 v166, v166, v190
  v_add_f32 v167, v167, v191
  s_waitcnt vmcnt(10)
  v_lshlrev_b32 v184, 16, v116
  v_and_b32 v185, 0xffff0000, v116
  v_lshlrev_b32 v186, 16, v117
  v_and_b32 v187, 0xffff0000, v117
  v_lshlrev_b32 v188, 16, v118
  v_and_b32 v189, 0xffff0000, v118
  v_lshlrev_b32 v190, 16, v119
  v_and_b32 v191, 0xffff0000, v119
  v_add_f32 v168, v168, v184
  v_add_f32 v169, v169, v185
  v_add_f32 v170, v170, v186
  v_add_f32 v171, v171, v187
  v_add_f32 v172, v172, v188
  v_add_f32 v173, v173, v189
  v_add_f32 v174, v174, v190
  v_add_f32 v175, v175, v191
  s_waitcnt vmcnt(9)
  v_lshlrev_b32 v184, 16, v120
  v_and_b32 v185, 0xffff0000, v120
  v_lshlrev_b32 v186, 16, v121
  v_and_b32 v187, 0xffff0000, v121
  v_lshlrev_b32 v188, 16, v122
  v_and_b32 v189, 0xffff0000, v122
  v_lshlrev_b32 v190, 16, v123
  v_and_b32 v191, 0xffff0000, v123
  v_add_f32 v176, v176, v184
  v_add_f32 v177, v177, v185
  v_add_f32 v178, v178, v186
  v_add_f32 v179, v179, v187
  v_add_f32 v180, v180, v188
  v_add_f32 v181, v181, v189
  v_add_f32 v182, v182, v190
  v_add_f32 v183, v183, v191
  s_waitcnt vmcnt(8)
  v_lshlrev_b32 v184, 16, v124
  v_and_b32 v185, 0xffff0000, v124
  v_lshlrev_b32 v186, 16, v125
  v_and_b32 v187, 0xffff0000, v125
  v_lshlrev_b32 v188, 16, v126
  v_and_b32 v189, 0xffff0000, v126
  v_lshlrev_b32 v190, 16, v127
  v_and_b32 v191, 0xffff0000, v127
  v_add_f32 v160, v160, v184
  v_add_f32 v161, v161, v185
  v_add_f32 v162, v162, v186
  v_add_f32 v163, v163, v187
  v_add_f32 v164, v164, v188
  v_add_f32 v165, v165, v189
  v_add_f32 v166, v166, v190
  v_add_f32 v167, v167, v191
  s_waitcnt vmcnt(7)
  v_lshlrev_b32 v184, 16, v128
  v_and_b32 v185, 0xffff0000, v128
  v_lshlrev_b32 v186, 16, v129
  v_and_b32 v187, 0xffff0000, v129
  v_lshlrev_b32 v188, 16, v130
  v_and_b32 v189, 0xffff0000, v130
  v_lshlrev_b32 v190, 16, v131
  v_and_b32 v191, 0xffff0000, v131
  v_add_f32 v168, v168, v184
  v_add_f32 v169, v169, v185
  v_add_f32 v170, v170, v186
  v_add_f32 v171, v171, v187
  v_add_f32 v172, v172, v188
  v_add_f32 v173, v173, v189
  v_add_f32 v174, v174, v190
  v_add_f32 v175, v175, v191
  s_waitcnt vmcnt(6)
  v_lshlrev_b32 v184, 16, v132
  v_and_b32 v185, 0xffff0000, v132
  v_lshlrev_b32 v186, 16, v133
  v_and_b32 v187, 0xffff0000, v133
  v_lshlrev_b32 v188, 16, v134
  v_and_b32 v189, 0xffff0000, v134
  v_lshlrev_b32 v190, 16, v135
  v_and_b32 v191, 0xffff0000, v135
  v_add_f32 v176, v176, v184
  v_add_f32 v177, v177, v185
  v_add_f32 v178, v178, v186
  v_add_f32 v179, v179, v187
  v_add_f32 v180, v180, v188
  v_add_f32 v181, v181, v189
  v_add_f32 v182, v182, v190
  v_add_f32 v183, v183, v191
  s_waitcnt vmcnt(5)
  v_lshlrev_b32 v184, 16, v136
  v_and_b32 v185, 0xffff0000, v136
  v_lshlrev_b32 v186, 16, v137
  v_and_b32 v187, 0xffff0000, v137
  v_lshlrev_b32 v188, 16, v138
  v_and_b32 v189, 0xffff0000, v138
  v_lshlrev_b32 v190, 16, v139
  v_and_b32 v191, 0xffff0000, v139
  v_add_f32 v160, v160, v184
  v_add_f32 v161, v161, v185
  v_add_f32 v162, v162, v186
  v_add_f32 v163, v163, v187
  v_add_f32 v164, v164, v188
  v_add_f32 v165, v165, v189
  v_add_f32 v166, v166, v190
  v_add_f32 v167, v167, v191
  s_waitcnt vmcnt(4)
  v_lshlrev_b32 v184, 16, v140
  v_and_b32 v185, 0xffff0000, v140
  v_lshlrev_b32 v186, 16, v141
  v_and_b32 v187, 0xffff0000, v141
  v_lshlrev_b32 v188, 16, v142
  v_and_b32 v189, 0xffff0000, v142
  v_lshlrev_b32 v190, 16, v143
  v_and_b32 v191, 0xffff0000, v143
  v_add_f32 v168, v168, v184
  v_add_f32 v169, v169, v185
  v_add_f32 v170, v170, v186
  v_add_f32 v171, v171, v187
  v_add_f32 v172, v172, v188
  v_add_f32 v173, v173, v189
  v_add_f32 v174, v174, v190
  v_add_f32 v175, v175, v191
  s_waitcnt vmcnt(3)
  v_lshlrev_b32 v184, 16, v144
  v_and_b32 v185, 0xffff0000, v144
  v_lshlrev_b32 v186, 16, v145
  v_and_b32 v187, 0xffff0000, v145
  v_lshlrev_b32 v188, 16, v146
  v_and_b32 v189, 0xffff0000, v146
  v_lshlrev_b32 v190, 16, v147
  v_and_b32 v191, 0xffff0000, v147
  v_add_f32 v176, v176, v184
  v_add_f32 v177, v177, v185
  v_add_f32 v178, v178, v186
  v_add_f32 v179, v179, v187
  v_add_f32 v180, v180, v188
  v_add_f32 v181, v181, v189
  v_add_f32 v182, v182, v190
  v_add_f32 v183, v183, v191
  s_waitcnt vmcnt(2)
  v_lshlrev_b32 v184, 16, v148
  v_and_b32 v185, 0xffff0000, v148
  v_lshlrev_b32 v186, 16, v149
  v_and_b32 v187, 0xffff0000, v149
  v_lshlrev_b32 v188, 16, v150
  v_and_b32 v189, 0xffff0000, v150
  v_lshlrev_b32 v190, 16, v151
  v_and_b32 v191, 0xffff0000, v151
  v_add_f32 v160, v160, v184
  v_add_f32 v161, v161, v185
  v_add_f32 v162, v162, v186
  v_add_f32 v163, v163, v187
  v_add_f32 v164, v164, v188
  v_add_f32 v165, v165, v189
  v_add_f32 v166, v166, v190
  v_add_f32 v167, v167, v191
  s_waitcnt vmcnt(1)
  v_lshlrev_b32 v184, 16, v152
  v_and_b32 v185, 0xffff0000, v152
  v_lshlrev_b32 v186, 16, v153
  v_and_b32 v187, 0xffff0000, v153
  v_lshlrev_b32 v188, 16, v154
  v_and_b32 v189, 0xffff0000, v154
  v_lshlrev_b32 v190, 16, v155
  v_and_b32 v191, 0xffff0000, v155
  v_add_f32 v168, v168, v184
  v_add_f32 v169, v169, v185
  v_add_f32 v170, v170, v186
  v_add_f32 v171, v171, v187
  v_add_f32 v172, v172, v188
  v_add_f32 v173, v173, v189
  v_add_f32 v174, v174, v190
  v_add_f32 v175, v175, v191
  s_waitcnt vmcnt(0)
  v_lshlrev_b32 v184, 16, v156
  v_and_b32 v185, 0xffff0000, v156
  v_lshlrev_b32 v186, 16, v157
  v_and_b32 v187, 0xffff0000, v157
  v_lshlrev_b32 v188, 16, v158
  v_and_b32 v189, 0xffff0000, v158
  v_lshlrev_b32 v190, 16, v159
  v_and_b32 v191, 0xffff0000, v159
  v_add_f32 v176, v176, v184
  v_add_f32 v177, v177, v185
  v_add_f32 v178, v178, v186
  v_add_f32 v179, v179, v187
  v_add_f32 v180, v180, v188
  v_add_f32 v181, v181, v189
  v_add_f32 v182, v182, v190
  v_add_f32 v183, v183, v191
  v_permlane32_swap_b32 v160, v164
  v_permlane32_swap_b32 v161, v165
  v_permlane32_swap_b32 v162, v166
  v_permlane32_swap_b32 v163, v167
  v_add_f32 v160, v160, v164
  v_add_f32 v161, v161, v165
  v_add_f32 v162, v162, v166
  v_add_f32 v163, v163, v167
  s_nop 0
  v_permlane16_swap_b32 v160, v162
  v_permlane16_swap_b32 v161, v163
  v_add_f32 v160, v160, v162
  v_add_f32 v161, v161, v163
  s_nop 0
  v_add_f32 v160, v160, v160 row_ror:8 row_mask:0xf bank_mask:0xf
  v_add_f32 v161, v161, v161 row_ror:8 row_mask:0xf bank_mask:0xf
  v_permlane32_swap_b32 v168, v172
  v_permlane32_swap_b32 v169, v173
  v_permlane32_swap_b32 v170, v174
  v_permlane32_swap_b32 v171, v175
  v_add_f32 v168, v168, v172
  v_add_f32 v169, v169, v173
  v_add_f32 v170, v170, v174
  v_add_f32 v171, v171, v175
  s_nop 0
  v_permlane16_swap_b32 v168, v170
  v_permlane16_swap_b32 v169, v171
  v_add_f32 v168, v168, v170
  v_add_f32 v169, v169, v171
  s_nop 0
  v_add_f32 v168, v168, v168 row_ror:8 row_mask:0xf bank_mask:0xf
  v_add_f32 v169, v169, v169 row_ror:8 row_mask:0xf bank_mask:0xf
  v_permlane32_swap_b32 v176, v180
  v_permlane32_swap_b32 v177, v181
  v_permlane32_swap_b32 v178, v182
  v_permlane32_swap_b32 v179, v183
  v_add_f32 v176, v176, v180
  v_add_f32 v177, v177, v181
  v_add_f32 v178, v178, v182
  v_add_f32 v179, v179, v183
  s_nop 0
  v_permlane16_swap_b32 v176, v178
  v_permlane16_swap_b32 v177, v179
  v_add_f32 v176, v176, v178
  v_add_f32 v177, v177, v179
  s_nop 0
  v_add_f32 v176, v176, v176 row_ror:8 row_mask:0xf bank_mask:0xf
  v_add_f32 v177, v177, v177 row_ror:8 row_mask:0xf bank_mask:0xf
  s_mov_b64 exec, s[34:35]
  buffer_store_dwordx2 v[160:161], v21, s[4:7], s30 offen offset:0 sc1
  buffer_store_dwordx2 v[168:169], v21, s[4:7], s30 offen offset:256 sc1
  buffer_store_dwordx2 v[176:177], v21, s[4:7], s30 offen offset:512 sc1
  buffer_load_dword v9, v4, s[8:11], 0 offen sc1
  s_mov_b64 exec, 1
  s_mov_b32 s38, 0
.fz_kernel_pw3:
  s_waitcnt vmcnt(0)
  v_readfirstlane_b32 s31, v9
  s_cmp_eq_u32 s31, 32
  s_cbranch_scc1 .fz_kernel_pw3d
  s_sleep 4
  buffer_load_dword v9, v4, s[8:11], 0 offen sc1
  s_add_u32 s38, s38, 1
  s_cmp_lt_u32 s38, 131072
  s_cbranch_scc1 .fz_kernel_pw3
  s_waitcnt vmcnt(0)
.fz_kernel_pw3d:
  s_mov_b64 exec, -1
  v_lshlrev_b32 v7, 7, v2
  s_lshl_b32 s31, s18, 11
  s_lshl_b32 s33, 1, s17
  s_add_u32 s31, s31, s67
  s_add_u32 s31, s31, 0x180001c
  v_mov_b32 v8, s33
  s_mov_b64 exec, 0xffff
  buffer_atomic_or v8, v7, s[4:7], s31 offen sc1
  s_mov_b64 exec, -1
  s_cmp_ge_u32 s2, 196
  s_cbranch_scc1 .fz_kernel_lz4
  s_lshl_b32 s36, s2, 12
  s_add_u32 s36, s36, 0x1c00000
  s_sub_u32 s31, s2, 66
  s_min_u32 s31, s31, s2
  s_sub_u32 s31, s31, 4
  s_cmp_lt_u32 s31, 6
  s_cbranch_scc1 .fz_kernel_lz4a
  buffer_store_dwordx4 v[12:15], v3, s[4:7], s36 offen sc1
  buffer_store_dwordx4 v[12:15], v3, s[4:7], s36 offen offset:1024 sc1
  buffer_store_dwordx4 v[12:15], v3, s[4:7], s36 offen offset:2048 sc1
  buffer_store_dwordx4 v[12:15], v3, s[4:7], s36 offen offset:3072 sc1
.fz_kernel_lz4:
  s_add_u32 s37, s19, 28
  v_mov_b32 v9, 0
  s_mov_b64 exec, 1
  s_mov_b32 s38, 0
.fz_kernel_pw5:
  s_waitcnt vmcnt(0)
  v_readfirstlane_b32 s31, v9
  s_cmp_eq_u32 s31, 65535
  s_cbranch_scc1 .fz_kernel_pw5d
  s_sleep 4
  buffer_load_dword v9, v4, s[4:7], s37 offen sc1
  s_add_u32 s38, s38, 1
  s_cmp_lt_u32 s38, 131072
  s_cbranch_scc1 .fz_kernel_pw5
  s_waitcnt vmcnt(0)
.fz_kernel_pw5d:
  s_mov_b64 exec, -1
  s_mul_i32 s30, s18, 12288
  s_add_u32 s30, s30, 0x18c0000
  buffer_load_dwordx4 v[64:67], v3, s[4:7], s30 offen offset:0
  buffer_load_dwordx4 v[68:71], v3, s[4:7], s30 offen offset:768
  buffer_load_dwordx4 v[72:75], v3, s[4:7], s30 offen offset:1536
  buffer_load_dwordx4 v[76:79], v3, s[4:7], s30 offen offset:2304
  s_add_u32 s30, s30, 3072
  buffer_load_dwordx4 v[80:83], v3, s[4:7], s30 offen offset:0
  buffer_load_dwordx4 v[84:87], v3, s[4:7], s30 offen offset:768
  buffer_load_dwordx4 v[88:91], v3, s[4:7], s30 offen offset:1536
  buffer_load_dwordx4 v[92:95], v3, s[4:7], s30 offen offset:2304
  s_add_u32 s30, s30, 3072
  buffer_load_dwordx4 v[96:99], v3, s[4:7], s30 offen offset:0
  buffer_load_dwordx4 v[100:103], v3, s[4:7], s30 offen offset:768
  buffer_load_dwordx4 v[104:107], v3, s[4:7], s30 offen offset:1536
  buffer_load_dwordx4 v[108:111], v3, s[4:7], s30 offen offset:2304
  s_add_u32 s30, s30, 3072
  buffer_load_dwordx4 v[112:115], v3, s[4:7], s30 offen offset:0
  buffer_load_dwordx4 v[116:119], v3, s[4:7], s30 offen offset:768
  buffer_load_dwordx4 v[120:123], v3, s[4:7], s30 offen offset:1536
  buffer_load_dwordx4 v[124:127], v3, s[4:7], s30 offen offset:2304
  s_add_u32 s30, s30, 3072
  s_waitcnt vmcnt(14)
  v_add_f32 v64, v64, v68
  v_add_f32 v65, v65, v69
  v_add_f32 v66, v66, v70
  v_add_f32 v67, v67, v71
  s_waitcnt vmcnt(13)
  v_add_f32 v64, v64, v72
  v_add_f32 v65, v65, v73
  v_add_f32 v66, v66, v74
  v_add_f32 v67, v67, v75
  s_waitcnt vmcnt(12)
  v_add_f32 v64, v64, v76
  v_add_f32 v65, v65, v77
  v_add_f32 v66, v66, v78
  v_add_f32 v67, v67, v79
  s_waitcnt vmcnt(11)
  v_add_f32 v64, v64, v80
  v_add_f32 v65, v65, v81
  v_add_f32 v66, v66, v82
  v_add_f32 v67, v67, v83
  s_waitcnt vmcnt(10)
  v_add_f32 v64, v64, v84
  v_add_f32 v65, v65, v85
  v_add_f32 v66, v66, v86
  v_add_f32 v67, v67, v87
  s_waitcnt vmcnt(9)
  v_add_f32 v64, v64, v88
  v_add_f32 v65, v65, v89
  v_add_f32 v66, v66, v90
  v_add_f32 v67, v67, v91
  s_waitcnt vmcnt(8)
  v_add_f32 v64, v64, v92
  v_add_f32 v65, v65, v93
  v_add_f32 v66, v66, v94
  v_add_f32 v67, v67, v95
  s_waitcnt vmcnt(7)
  v_add_f32 v64, v64, v96
  v_add_f32 v65, v65, v97
  v_add_f32 v66, v66, v98
  v_add_f32 v67, v67, v99
  s_waitcnt vmcnt(6)
  v_add_f32 v64, v64, v100
  v_add_f32 v65, v65, v101
  v_add_f32 v66, v66, v102
  v_add_f32 v67, v67, v103
  s_waitcnt vmcnt(5)
  v_add_f32 v64, v64, v104
  v_add_f32 v65, v65, v105
  v_add_f32 v66, v66, v106
  v_add_f32 v67, v67, v107
  s_waitcnt vmcnt(4)
  v_add_f32 v64, v64, v108
  v_add_f32 v65, v65, v109
  v_add_f32 v66, v66, v110
  v_add_f32 v67, v67, v111
  s_waitcnt vmcnt(3)
  v_add_f32 v64, v64, v112
  v_add_f32 v65, v65, v113
  v_add_f32 v66, v66, v114
  v_add_f32 v67, v67, v115
  s_waitcnt vmcnt(2)
  v_add_f32 v64, v64, v116
  v_add_f32 v65, v65, v117
  v_add_f32 v66, v66, v118
  v_add_f32 v67, v67, v119
  s_waitcnt vmcnt(1)
  v_add_f32 v64, v64, v120
  v_add_f32 v65, v65, v121
  v_add_f32 v66, v66, v122
  v_add_f32 v67, v67, v123
  s_waitcnt vmcnt(0)
  v_add_f32 v64, v64, v124
  v_add_f32 v65, v65, v125
  v_add_f32 v66, v66, v126
  v_add_f32 v67, v67, v127
  v_add_u32 v24, 155648, v3
  s_mov_b32 exec_hi, 0xffff
  ds_write_b128 v24, v[64:67] offset:5632
  s_mov_b64 exec, -1
  s_waitcnt lgkmcnt(0)
.fz_kernel_q_h7e:
  s_barrier
  s_barrier
  s_branch .fz_kernel_att
.fz_kernel_att:
  s_setprio 3
  ds_read_b32 v7, v6
  s_and_b32 s39, s16, 1
  s_lshr_b32 s32, s16, 1
  s_lshl_b32 s31, s39, 2
  s_add_u32 s31, s31, s32
  s_lshl_b32 s31, s31, 12
  s_add_u32 s31, s31, 73728
  v_add_u32 v8, s31, v3
  ds_read_b128 v[184:187], v8 offset:0
  ds_read_b128 v[188:191], v8 offset:1024
  s_add_u32 s31, s32, 0
  s_and_b32 s31, s31, 3
  s_lshl_b32 s33, s39, 2
  s_add_u32 s31, s31, s33
  s_lshl_b32 s31, s31, 11
  v_add_u32 v9, s31, v3
  ds_read_b128 v[32:35], v9 offset:57344
  ds_read_b128 v[36:39], v9 offset:58368
  ds_read_b128 v[192:195], v8 offset:2048
  ds_read_b128 v[196:199], v8 offset:3072
  s_add_u32 s31, s32, 1
  s_and_b32 s31, s31, 3
  s_lshl_b32 s33, s39, 2
  s_add_u32 s31, s31, s33
  s_lshl_b32 s31, s31, 11
  v_add_u32 v9, s31, v3
  ds_read_b128 v[40:43], v9 offset:57344
  ds_read_b128 v[44:47], v9 offset:58368
  s_add_u32 s31, s32, 2
  s_and_b32 s31, s31, 3
  s_lshl_b32 s33, s39, 2
  s_add_u32 s31, s31, s33
  s_lshl_b32 s31, s31, 11
  v_add_u32 v9, s31, v3
  ds_read_b128 v[48:51], v9 offset:57344
  ds_read_b128 v[52:55], v9 offset:58368
  s_add_u32 s31, s32, 3
  s_and_b32 s31, s31, 3
  s_lshl_b32 s33, s39, 2
  s_add_u32 s31, s31, s33
  s_lshl_b32 s31, s31, 11
  v_add_u32 v9, s31, v3
  ds_read_b128 v[56:59], v9 offset:57344
  ds_read_b128 v[60:63], v9 offset:58368
  s_mov_b32 s24, s44
  s_mov_b32 s25, s45
  s_mov_b32 s26, 0x200000
  s_mov_b32 s27, 0x00020000
  v_lshrrev_b32 v8, 3, v2
  v_and_b32 v9, 7, v2
  v_bfe_u32 v10, v2, 4, 1
  v_lshlrev_b32 v10, 2, v10
  v_xor_b32 v9, v9, v10
  v_lshlrev_b32 v9, 4, v9
  v_lshl_add_u32 v10, v8, 11, v9
  s_bitcmp1_b32 s18, 0
  s_cselect_b32 s8, s52, s50
  s_cselect_b32 s9, s53, s51
  s_mov_b32 s10, 0x700000
  s_mov_b32 s11, 0x00020000
  s_lshl_b32 s28, s16, 6
  s_and_b32 s28, s28, 511
  s_and_b32 s31, s18, 2
  s_lshl_b32 s31, s31, 8
  s_add_u32 s28, s28, s31
  s_mul_i32 s28, s28, 7168
  s_lshl_b32 s31, s17, 2
  s_lshr_b32 s33, s18, 2
  s_add_u32 s31, s31, s33
  s_lshl_b32 s31, s31, 7
  s_add_u32 s28, s28, s31
  v_lshrrev_b32 v15, 2, v2
  v_mul_u32_u24 v15, 7168, v15
  v_and_b32 v11, 3, v2
  v_lshl_add_u32 v15, v11, 5, v15
  s_mov_b32 s20, s54
  s_mov_b32 s21, s55
  s_mov_b32 s22, 0x700000
  s_mov_b32 s23, 0x00020000
  s_lshl_b32 s12, s17, 3
  s_add_u32 s12, s12, s16
  s_lshl_b32 s12, s12, 16
  s_lshl_b32 s31, s18, 7
  s_add_u32 s12, s12, s31
  s_and_b32 s29, s17, 3
  s_lshl_b32 s29, s29, 3
  s_add_u32 s29, s29, s16
  s_mul_i32 s29, s29, 3
  s_add_u32 s29, s29, 48
  s_lshl_b32 s29, s29, 14
  s_lshl_b32 s31, s18, 7
  s_add_u32 s29, s29, s31
  v_add_u32 v15, s28, v15
  v_add_u32 v14, s12, v10
  v_add_u32 v16, s29, v10
  v_bfrev_b32 v13, 2
  s_mul_i32 s14, s16, 6144
  s_lshl_b32 s13, s14, 4
  s_add_u32 s13, s13, s31
  s_lshl_b32 s35, s18, 1
  s_add_u32 s35, s35, s39
  s_lshl_b32 s35, s35, 6
  s_add_u32 s35, s35, s32
  s_lshl_b32 s35, s35, 12
  s_add_u32 s35, s35, s63
  s_add_u32 s37, s19, s67
  s_lshl_b32 s34, 1, s17
  v_and_b32 v11, 4, v2
  v_cmp_eq_u32 vcc, 0, v11
  v_mov_b32 v12, 0x3f803f80
  v_and_b32 v11, 1, v2
  v_cndmask_b32 v28, 0, v12, vcc
  v_cndmask_b32 v29, 0, v12, vcc
  v_cndmask_b32 v30, v12, 0, vcc
  v_cndmask_b32 v31, v12, 0, vcc
  v_mul_u32_u24 v27, 0xaaaa, v11
  v_add_u32 v27, 0x4444, v27
  v_mov_b32 v128, 0
  v_mov_b32 v129, 0
  v_mov_b32 v130, 0
  v_mov_b32 v131, 0
  v_mov_b32 v132, 0
  v_mov_b32 v133, 0
  v_mov_b32 v134, 0
  v_mov_b32 v135, 0
  v_mov_b32 v136, 0
  v_mov_b32 v137, 0
  v_mov_b32 v138, 0
  v_mov_b32 v139, 0
  v_mov_b32 v140, 0
  v_mov_b32 v141, 0
  v_mov_b32 v142, 0
  v_mov_b32 v143, 0
  s_waitcnt lgkmcnt(12)
  v_readfirstlane_b32 s36, v7
  s_andn2_b32 s33, s36, s34
  s_bcnt1_i32_b32 s39, s33
  s_cmp_lt_u32 s39, 3
  s_cbranch_scc1 .fz_kernel_a_p0
  s_andn2_b32 s33, s36, s34
  s_cbranch_scc1 .fz_kernel_pk6
  s_call_b64 s[68:69], .fz_kernel_pick
.fz_kernel_pk6:
  s_ff1_i32_b32 s33, s33
  s_bitset1_b32 s34, s33
  s_lshl_b32 s33, s33, 14
  s_add_u32 s30, s33, s35
  buffer_load_dwordx4 v[200:203], v3, s[4:7], s30 offen offset:0
  buffer_load_dwordx4 v[204:207], v3, s[4:7], s30 offen offset:1024
  buffer_load_dwordx4 v[208:211], v3, s[4:7], s30 offen offset:2048
  buffer_load_dwordx4 v[212:215], v3, s[4:7], s30 offen offset:3072
  buffer_load_dword v248, v3, s[4:7], s30 offen offset:3072
  s_andn2_b32 s33, s36, s34
  s_cbranch_scc1 .fz_kernel_pk7
  s_call_b64 s[68:69], .fz_kernel_pick
.fz_kernel_pk7:
  s_ff1_i32_b32 s33, s33
  s_bitset1_b32 s34, s33
  s_lshl_b32 s33, s33, 14
  s_add_u32 s30, s33, s35
  buffer_load_dwordx4 v[216:219], v3, s[4:7], s30 offen offset:0
  buffer_load_dwordx4 v[220:223], v3, s[4:7], s30 offen offset:1024
  buffer_load_dwordx4 v[224:227], v3, s[4:7], s30 offen offset:2048
  buffer_load_dwordx4 v[228:231], v3, s[4:7], s30 offen offset:3072
  buffer_load_dword v248, v3, s[4:7], s30 offen offset:3072
  s_andn2_b32 s33, s36, s34
  s_cbranch_scc1 .fz_kernel_pk8
  s_call_b64 s[68:69], .fz_kernel_pick
.fz_kernel_pk8:
  s_ff1_i32_b32 s33, s33
  s_bitset1_b32 s34, s33
  s_lshl_b32 s33, s33, 14
  s_add_u32 s30, s33, s35
  buffer_load_dwordx4 v[232:235], v3, s[4:7], s30 offen offset:0
  buffer_load_dwordx4 v[236:239], v3, s[4:7], s30 offen offset:1024
  buffer_load_dwordx4 v[240:243], v3, s[4:7], s30 offen offset:2048
  buffer_load_dwordx4 v[244:247], v3, s[4:7], s30 offen offset:3072
  buffer_load_dword v248, v3, s[4:7], s30 offen offset:3072
  buffer_load_dword v248, v3, s[4:7], s30 offen offset:3072
.fz_kernel_a_p0:
  s_waitcnt lgkmcnt(8)
  v_mfma_f32_32x32x16_bf16 v[144:159], v[184:187], v[32:35], 0
  v_mfma_f32_32x32x16_bf16 v[144:159], v[188:191], v[36:39], v[144:159]
  s_mov_b64 exec, 1
  s_waitcnt lgkmcnt(0)
  ds_add_u32 v6, v5 offset:0x100
  s_mov_b64 exec, -1
  v_mfma_f32_32x32x16_bf16 v[160:175], v[184:187], v[40:43], 0
  s_nop 6
  v_exp_f32 v144, v144
  v_exp_f32 v145, v145
  v_exp_f32 v146, v146
  v_exp_f32 v147, v147
  v_exp_f32 v148, v148
  v_exp_f32 v149, v149
  v_exp_f32 v150, v150
  v_exp_f32 v151, v151
  v_mfma_f32_32x32x16_bf16 v[160:175], v[188:191], v[44:47], v[160:175]
  v_cvt_pk_bf16_f32 v176, v144, v145
  v_cvt_pk_bf16_f32 v177, v146, v147
  v_cvt_pk_bf16_f32 v178, v148, v149
  v_cvt_pk_bf16_f32 v179, v150, v151
  v_exp_f32 v152, v152
  v_exp_f32 v153, v153
  v_exp_f32 v154, v154
  v_exp_f32 v155, v155
  v_mfma_f32_32x32x16_bf16 v[64:79], v[192:195], v[176:179], 0
  v_exp_f32 v156, v156
  v_exp_f32 v157, v157
  v_exp_f32 v158, v158
  v_exp_f32 v159, v159
  v_cvt_pk_bf16_f32 v180, v152, v153
  v_cvt_pk_bf16_f32 v181, v154, v155
  v_cvt_pk_bf16_f32 v182, v156, v157
  v_cvt_pk_bf16_f32 v183, v158, v159
  v_mfma_f32_32x32x16_bf16 v[144:159], v[184:187], v[48:51], 0
  v_exp_f32 v160, v160
  v_exp_f32 v161, v161
  v_exp_f32 v162, v162
  v_mfma_f32_32x32x16_bf16 v[64:79], v[196:199], v[180:183], v[64:79]
  v_exp_f32 v163, v163
  v_exp_f32 v164, v164
  v_exp_f32 v165, v165
  v_smfmac_f32_16x16x64_bf16 v[128:131], v[28:31], v[176:183], v27
  v_exp_f32 v166, v166
  v_exp_f32 v167, v167
  v_mfma_f32_32x32x16_bf16 v[144:159], v[188:191], v[52:55], v[144:159]
  v_cvt_pk_bf16_f32 v176, v160, v161
  v_cvt_pk_bf16_f32 v177, v162, v163
  v_cvt_pk_bf16_f32 v178, v164, v165
  v_cvt_pk_bf16_f32 v179, v166, v167
  v_exp_f32 v168, v168
  v_exp_f32 v169, v169
  v_exp_f32 v170, v170
  v_exp_f32 v171, v171
  v_mfma_f32_32x32x16_bf16 v[80:95], v[192:195], v[176:179], 0
  v_exp_f32 v172, v172
  v_exp_f32 v173, v173
  v_exp_f32 v174, v174
  v_exp_f32 v175, v175
  v_cvt_pk_bf16_f32 v180, v168, v169
  v_cvt_pk_bf16_f32 v181, v170, v171
  v_cvt_pk_bf16_f32 v182, v172, v173
  v_cvt_pk_bf16_f32 v183, v174, v175
  v_mfma_f32_32x32x16_bf16 v[160:175], v[184:187], v[56:59], 0
  v_exp_f32 v144, v144
  v_exp_f32 v145, v145
  v_exp_f32 v146, v146
  v_mfma_f32_32x32x16_bf16 v[80:95], v[196:199], v[180:183], v[80:95]
  v_exp_f32 v147, v147
  v_exp_f32 v148, v148
  v_exp_f32 v149, v149
  v_smfmac_f32_16x16x64_bf16 v[132:135], v[28:31], v[176:183], v27
  v_exp_f32 v150, v150
  v_exp_f32 v151, v151
  v_mfma_f32_32x32x16_bf16 v[160:175], v[188:191], v[60:63], v[160:175]
  v_cvt_pk_bf16_f32 v176, v144, v145
  v_cvt_pk_bf16_f32 v177, v146, v147
  v_cvt_pk_bf16_f32 v178, v148, v149
  v_cvt_pk_bf16_f32 v179, v150, v151
  v_exp_f32 v152, v152
  v_exp_f32 v153, v153
  v_exp_f32 v154, v154
  v_exp_f32 v155, v155
  v_mfma_f32_32x32x16_bf16 v[96:111], v[192:195], v[176:179], 0
  v_exp_f32 v156, v156
  v_exp_f32 v157, v157
  v_exp_f32 v158, v158
  v_exp_f32 v159, v159
  v_cvt_pk_bf16_f32 v180, v152, v153
  v_cvt_pk_bf16_f32 v181, v154, v155
  v_cvt_pk_bf16_f32 v182, v156, v157
  v_cvt_pk_bf16_f32 v183, v158, v159
  v_exp_f32 v160, v160
  v_exp_f32 v161, v161
  v_exp_f32 v162, v162
  v_mfma_f32_32x32x16_bf16 v[96:111], v[196:199], v[180:183], v[96:111]
  v_exp_f32 v163, v163
  v_exp_f32 v164, v164
  v_exp_f32 v165, v165
  v_smfmac_f32_16x16x64_bf16 v[136:139], v[28:31], v[176:183], v27
  v_exp_f32 v166, v166
  v_exp_f32 v167, v167
  v_cvt_pk_bf16_f32 v176, v160, v161
  v_cvt_pk_bf16_f32 v177, v162, v163
  v_cvt_pk_bf16_f32 v178, v164, v165
  v_cvt_pk_bf16_f32 v179, v166, v167
  v_exp_f32 v168, v168
  v_exp_f32 v169, v169
  v_exp_f32 v170, v170
  v_exp_f32 v171, v171
  v_mfma_f32_32x32x16_bf16 v[112:127], v[192:195], v[176:179], 0
  v_exp_f32 v172, v172
  v_exp_f32 v173, v173
  v_exp_f32 v174, v174
  v_exp_f32 v175, v175
  v_cvt_pk_bf16_f32 v180, v168, v169
  v_cvt_pk_bf16_f32 v181, v170, v171
  v_cvt_pk_bf16_f32 v182, v172, v173
  v_cvt_pk_bf16_f32 v183, v174, v175
  s_cmp_ge_u32 s39, 3
  s_cbranch_scc1 .fz_kernel_a_p1
  s_andn2_b32 s33, s36, s34
  s_cbranch_scc1 .fz_kernel_pk9
  s_call_b64 s[68:69], .fz_kernel_pick
.fz_kernel_pk9:
  s_ff1_i32_b32 s33, s33
  s_bitset1_b32 s34, s33
  s_lshl_b32 s33, s33, 14
  s_add_u32 s30, s33, s35
  buffer_load_dwordx4 v[200:203], v3, s[4:7], s30 offen offset:0
  buffer_load_dwordx4 v[204:207], v3, s[4:7], s30 offen offset:1024
  buffer_load_dwordx4 v[208:211], v3, s[4:7], s30 offen offset:2048
  buffer_load_dwordx4 v[212:215], v3, s[4:7], s30 offen offset:3072
  buffer_load_dword v248, v3, s[4:7], s30 offen offset:3072
  s_andn2_b32 s33, s36, s34
  s_cbranch_scc1 .fz_kernel_pk10
  s_call_b64 s[68:69], .fz_kernel_pick
.fz_kernel_pk10:
  s_ff1_i32_b32 s33, s33
  s_bitset1_b32 s34, s33
  s_lshl_b32 s33, s33, 14
  s_add_u32 s30, s33, s35
  buffer_load_dwordx4 v[216:219], v3, s[4:7], s30 offen offset:0
  buffer_load_dwordx4 v[220:223], v3, s[4:7], s30 offen offset:1024
  buffer_load_dwordx4 v[224:227], v3, s[4:7], s30 offen offset:2048
  buffer_load_dwordx4 v[228:231], v3, s[4:7], s30 offen offset:3072
  buffer_load_dword v248, v3, s[4:7], s30 offen offset:3072
  s_andn2_b32 s33, s36, s34
  s_cbranch_scc1 .fz_kernel_pk11
  s_call_b64 s[68:69], .fz_kernel_pick
.fz_kernel_pk11:
  s_ff1_i32_b32 s33, s33
  s_bitset1_b32 s34, s33
  s_lshl_b32 s33, s33, 14
  s_add_u32 s30, s33, s35
  buffer_load_dwordx4 v[232:235], v3, s[4:7], s30 offen offset:0
  buffer_load_dwordx4 v[236:239], v3, s[4:7], s30 offen offset:1024
  buffer_load_dwordx4 v[240:243], v3, s[4:7], s30 offen offset:2048
  buffer_load_dwordx4 v[244:247], v3, s[4:7], s30 offen offset:3072
  buffer_load_dword v248, v3, s[4:7], s30 offen offset:3072
  buffer_load_dword v248, v3, s[4:7], s30 offen offset:3072
.fz_kernel_a_p1:
  s_waitcnt vmcnt(14)
  v_mfma_f32_32x32x16_bf16 v[144:159], v[200:203], v[32:35], 0
  v_mfma_f32_32x32x16_bf16 v[144:159], v[204:207], v[36:39], v[144:159]
  s_waitcnt vmcnt(12)
  s_mov_b32 s32, 4
  s_nop 8
  s_branch .fz_kernel_a_b1
.fz_kernel_a_loop:
  s_cmp_lg_u32 s32, 1
  s_cbranch_scc1 .fz_kernel_pr12
  s_setprio 1
.fz_kernel_pr12:
  v_mfma_f32_32x32x16_bf16 v[160:175], v[184:187], v[40:43], 0
  v_exp_f32 v144, v144
  v_exp_f32 v145, v145
  v_exp_f32 v146, v146
  v_mfma_f32_32x32x16_bf16 v[112:127], v[244:247], v[180:183], v[112:127]
  v_exp_f32 v147, v147
  v_exp_f32 v148, v148
  v_exp_f32 v149, v149
  v_smfmac_f32_16x16x64_bf16 v[140:143], v[28:31], v[176:183], v27
  v_exp_f32 v150, v150
  v_exp_f32 v151, v151
  v_mfma_f32_32x32x16_bf16 v[160:175], v[188:191], v[44:47], v[160:175]
  s_andn2_b32 s33, s36, s34
  s_cbranch_scc1 .fz_kernel_pk13
  s_call_b64 s[68:69], .fz_kernel_pick
.fz_kernel_pk13:
  s_ff1_i32_b32 s33, s33
  s_bitset1_b32 s34, s33
  s_lshl_b32 s33, s33, 14
  s_add_u32 s30, s33, s35
  buffer_load_dwordx4 v[232:235], v3, s[4:7], s30 offen offset:0
  buffer_load_dwordx4 v[236:239], v3, s[4:7], s30 offen offset:1024
  buffer_load_dwordx4 v[240:243], v3, s[4:7], s30 offen offset:2048
  buffer_load_dwordx4 v[244:247], v3, s[4:7], s30 offen offset:3072
  s_mov_b32 m0, s14
  s_add_u32 s14, s14, 1024
  buffer_load_dwordx4 v10, s[24:27], s13 offen lds
  s_add_u32 s13, s13, 16384
  s_mov_b32 m0, s14
  s_add_u32 s14, s14, 1024
  buffer_load_dwordx4 v10, s[24:27], s13 offen lds
  s_add_u32 s13, s13, 16384
  v_cvt_pk_bf16_f32 v176, v144, v145
  v_cvt_pk_bf16_f32 v177, v146, v147
  v_cvt_pk_bf16_f32 v178, v148, v149
  v_cvt_pk_bf16_f32 v179, v150, v151
  v_exp_f32 v152, v152
  v_exp_f32 v153, v153
  v_exp_f32 v154, v154
  v_exp_f32 v155, v155
  v_mfma_f32_32x32x16_bf16 v[64:79], v[192:195], v[176:179], v[64:79]
  v_exp_f32 v156, v156
  v_exp_f32 v157, v157
  v_exp_f32 v158, v158
  v_exp_f32 v159, v159
  v_cvt_pk_bf16_f32 v180, v152, v153
  v_cvt_pk_bf16_f32 v181, v154, v155
  v_cvt_pk_bf16_f32 v182, v156, v157
  v_cvt_pk_bf16_f32 v183, v158, v159
  v_mfma_f32_32x32x16_bf16 v[144:159], v[184:187], v[48:51], 0
  v_exp_f32 v160, v160
  v_exp_f32 v161, v161
  v_exp_f32 v162, v162
  v_mfma_f32_32x32x16_bf16 v[64:79], v[196:199], v[180:183], v[64:79]
  v_exp_f32 v163, v163
  v_exp_f32 v164, v164
  v_exp_f32 v165, v165
  v_smfmac_f32_16x16x64_bf16 v[128:131], v[28:31], v[176:183], v27
  v_exp_f32 v166, v166
  v_exp_f32 v167, v167
  v_mfma_f32_32x32x16_bf16 v[144:159], v[188:191], v[52:55], v[144:159]
  v_cvt_pk_bf16_f32 v176, v160, v161
  v_cvt_pk_bf16_f32 v177, v162, v163
  v_cvt_pk_bf16_f32 v178, v164, v165
  v_cvt_pk_bf16_f32 v179, v166, v167
  v_exp_f32 v168, v168
  v_exp_f32 v169, v169
  v_exp_f32 v170, v170
  v_exp_f32 v171, v171
  v_mfma_f32_32x32x16_bf16 v[80:95], v[192:195], v[176:179], v[80:95]
  v_exp_f32 v172, v172
  v_exp_f32 v173, v173
  v_exp_f32 v174, v174
  v_exp_f32 v175, v175
  v_cvt_pk_bf16_f32 v180, v168, v169
  v_cvt_pk_bf16_f32 v181, v170, v171
  v_cvt_pk_bf16_f32 v182, v172, v173
  v_cvt_pk_bf16_f32 v183, v174, v175
  v_mfma_f32_32x32x16_bf16 v[160:175], v[184:187], v[56:59], 0
  v_exp_f32 v144, v144
  v_exp_f32 v145, v145
  v_exp_f32 v146, v146
  v_mfma_f32_32x32x16_bf16 v[80:95], v[196:199], v[180:183], v[80:95]
  v_exp_f32 v147, v147
  v_exp_f32 v148, v148
  v_exp_f32 v149, v149
  v_smfmac_f32_16x16x64_bf16 v[132:135], v[28:31], v[176:183], v27
  v_exp_f32 v150, v150
  v_exp_f32 v151, v151
  v_mfma_f32_32x32x16_bf16 v[160:175], v[188:191], v[60:63], v[160:175]
  v_cvt_pk_bf16_f32 v176, v144, v145
  v_cvt_pk_bf16_f32 v177, v146, v147
  v_cvt_pk_bf16_f32 v178, v148, v149
  v_cvt_pk_bf16_f32 v179, v150, v151
  v_exp_f32 v152, v152
  v_exp_f32 v153, v153
  v_exp_f32 v154, v154
  v_exp_f32 v155, v155
  v_mfma_f32_32x32x16_bf16 v[96:111], v[192:195], v[176:179], v[96:111]
  v_exp_f32 v156, v156
  v_exp_f32 v157, v157
  v_exp_f32 v158, v158
  v_exp_f32 v159, v159
  v_cvt_pk_bf16_f32 v180, v152, v153
  v_cvt_pk_bf16_f32 v181, v154, v155
  v_cvt_pk_bf16_f32 v182, v156, v157
  v_cvt_pk_bf16_f32 v183, v158, v159
  s_waitcnt vmcnt(12)
  v_mfma_f32_32x32x16_bf16 v[144:159], v[200:203], v[32:35], 0
  v_exp_f32 v160, v160
  v_exp_f32 v161, v161
  v_exp_f32 v162, v162
  v_mfma_f32_32x32x16_bf16 v[96:111], v[196:199], v[180:183], v[96:111]
  v_exp_f32 v163, v163
  v_exp_f32 v164, v164
  v_exp_f32 v165, v165
  v_smfmac_f32_16x16x64_bf16 v[136:139], v[28:31], v[176:183], v27
  v_exp_f32 v166, v166
  v_exp_f32 v167, v167
  v_mfma_f32_32x32x16_bf16 v[144:159], v[204:207], v[36:39], v[144:159]
  v_cvt_pk_bf16_f32 v176, v160, v161
  v_cvt_pk_bf16_f32 v177, v162, v163
  v_cvt_pk_bf16_f32 v178, v164, v165
  v_cvt_pk_bf16_f32 v179, v166, v167
  v_exp_f32 v168, v168
  v_exp_f32 v169, v169
  v_exp_f32 v170, v170
  v_exp_f32 v171, v171
  v_mfma_f32_32x32x16_bf16 v[112:127], v[192:195], v[176:179], v[112:127]
  v_exp_f32 v172, v172
  v_exp_f32 v173, v173
  v_exp_f32 v174, v174
  v_exp_f32 v175, v175
  v_cvt_pk_bf16_f32 v180, v168, v169
  v_cvt_pk_bf16_f32 v181, v170, v171
  v_cvt_pk_bf16_f32 v182, v172, v173
  v_cvt_pk_bf16_f32 v183, v174, v175
.fz_kernel_a_b1:
  v_mfma_f32_32x32x16_bf16 v[160:175], v[200:203], v[40:43], 0
  v_exp_f32 v144, v144
  v_exp_f32 v145, v145
  v_exp_f32 v146, v146
  v_mfma_f32_32x32x16_bf16 v[112:127], v[196:199], v[180:183], v[112:127]
  v_exp_f32 v147, v147
  v_exp_f32 v148, v148
  v_exp_f32 v149, v149
  v_smfmac_f32_16x16x64_bf16 v[140:143], v[28:31], v[176:183], v27
  v_exp_f32 v150, v150
  v_exp_f32 v151, v151
  v_mfma_f32_32x32x16_bf16 v[160:175], v[204:207], v[44:47], v[160:175]
  s_andn2_b32 s33, s36, s34
  s_cbranch_scc1 .fz_kernel_pk14
  s_call_b64 s[68:69], .fz_kernel_pick
.fz_kernel_pk14:
  s_ff1_i32_b32 s33, s33
  s_bitset1_b32 s34, s33
  s_lshl_b32 s33, s33, 14
  s_add_u32 s30, s33, s35
  buffer_load_dwordx4 v[184:187], v3, s[4:7], s30 offen offset:0
  buffer_load_dwordx4 v[188:191], v3, s[4:7], s30 offen offset:1024
  buffer_load_dwordx4 v[192:195], v3, s[4:7], s30 offen offset:2048
  buffer_load_dwordx4 v[196:199], v3, s[4:7], s30 offen offset:3072
  buffer_load_dword v248, v13, s[24:27], 0 offen
  v_cvt_pk_bf16_f32 v176, v144, v145
  v_cvt_pk_bf16_f32 v177, v146, v147
  v_cvt_pk_bf16_f32 v178, v148, v149
  v_cvt_pk_bf16_f32 v179, v150, v151
  v_exp_f32 v152, v152
  v_exp_f32 v153, v153
  v_exp_f32 v154, v154
  v_exp_f32 v155, v155
  v_mfma_f32_32x32x16_bf16 v[64:79], v[208:211], v[176:179], v[64:79]
  v_exp_f32 v156, v156
  v_exp_f32 v157, v157
  v_exp_f32 v158, v158
  v_exp_f32 v159, v159
  v_cvt_pk_bf16_f32 v180, v152, v153
  v_cvt_pk_bf16_f32 v181, v154, v155
  v_cvt_pk_bf16_f32 v182, v156, v157
  v_cvt_pk_bf16_f32 v183, v158, v159
  v_mfma_f32_32x32x16_bf16 v[144:159], v[200:203], v[48:51], 0
  v_exp_f32 v160, v160
  v_exp_f32 v161, v161
  v_exp_f32 v162, v162
  v_mfma_f32_32x32x16_bf16 v[64:79], v[212:215], v[180:183], v[64:79]
  v_exp_f32 v163, v163
  v_exp_f32 v164, v164
  v_exp_f32 v165, v165
  v_smfmac_f32_16x16x64_bf16 v[128:131], v[28:31], v[176:183], v27
  v_exp_f32 v166, v166
  v_exp_f32 v167, v167
  v_mfma_f32_32x32x16_bf16 v[144:159], v[204:207], v[52:55], v[144:159]
  v_cvt_pk_bf16_f32 v176, v160, v161
  v_cvt_pk_bf16_f32 v177, v162, v163
  v_cvt_pk_bf16_f32 v178, v164, v165
  v_cvt_pk_bf16_f32 v179, v166, v167
  v_exp_f32 v168, v168
  v_exp_f32 v169, v169
  v_exp_f32 v170, v170
  v_exp_f32 v171, v171
  v_mfma_f32_32x32x16_bf16 v[80:95], v[208:211], v[176:179], v[80:95]
  v_exp_f32 v172, v172
  v_exp_f32 v173, v173
  v_exp_f32 v174, v174
  v_exp_f32 v175, v175
  v_cvt_pk_bf16_f32 v180, v168, v169
  v_cvt_pk_bf16_f32 v181, v170, v171
  v_cvt_pk_bf16_f32 v182, v172, v173
  v_cvt_pk_bf16_f32 v183, v174, v175
  v_mfma_f32_32x32x16_bf16 v[160:175], v[200:203], v[56:59], 0
  v_exp_f32 v144, v144
  v_exp_f32 v145, v145
  v_exp_f32 v146, v146
  v_mfma_f32_32x32x16_bf16 v[80:95], v[212:215], v[180:183], v[80:95]
  v_exp_f32 v147, v147
  v_exp_f32 v148, v148
  v_exp_f32 v149, v149
  v_smfmac_f32_16x16x64_bf16 v[132:135], v[28:31], v[176:183], v27
  v_exp_f32 v150, v150
  v_exp_f32 v151, v151
  v_mfma_f32_32x32x16_bf16 v[160:175], v[204:207], v[60:63], v[160:175]
  v_cvt_pk_bf16_f32 v176, v144, v145
  v_cvt_pk_bf16_f32 v177, v146, v147
  v_cvt_pk_bf16_f32 v178, v148, v149
  v_cvt_pk_bf16_f32 v179, v150, v151
  v_exp_f32 v152, v152
  v_exp_f32 v153, v153
  v_exp_f32 v154, v154
  v_exp_f32 v155, v155
  v_mfma_f32_32x32x16_bf16 v[96:111], v[208:211], v[176:179], v[96:111]
  v_exp_f32 v156, v156
  v_exp_f32 v157, v157
  v_exp_f32 v158, v158
  v_exp_f32 v159, v159
  v_cvt_pk_bf16_f32 v180, v152, v153
  v_cvt_pk_bf16_f32 v181, v154, v155
  v_cvt_pk_bf16_f32 v182, v156, v157
  v_cvt_pk_bf16_f32 v183, v158, v159
  s_waitcnt vmcnt(12)
  v_mfma_f32_32x32x16_bf16 v[144:159], v[216:219], v[32:35], 0
  v_exp_f32 v160, v160
  v_exp_f32 v161, v161
  v_exp_f32 v162, v162
  v_mfma_f32_32x32x16_bf16 v[96:111], v[212:215], v[180:183], v[96:111]
  v_exp_f32 v163, v163
  v_exp_f32 v164, v164
  v_exp_f32 v165, v165
  v_smfmac_f32_16x16x64_bf16 v[136:139], v[28:31], v[176:183], v27
  v_exp_f32 v166, v166
  v_exp_f32 v167, v167
  v_mfma_f32_32x32x16_bf16 v[144:159], v[220:223], v[36:39], v[144:159]
  v_cvt_pk_bf16_f32 v176, v160, v161
  v_cvt_pk_bf16_f32 v177, v162, v163
  v_cvt_pk_bf16_f32 v178, v164, v165
  v_cvt_pk_bf16_f32 v179, v166, v167
  v_exp_f32 v168, v168
  v_exp_f32 v169, v169
  v_exp_f32 v170, v170
  v_exp_f32 v171, v171
  v_mfma_f32_32x32x16_bf16 v[112:127], v[208:211], v[176:179], v[112:127]
  v_exp_f32 v172, v172
  v_exp_f32 v173, v173
  v_exp_f32 v174, v174
  v_exp_f32 v175, v175
  v_cvt_pk_bf16_f32 v180, v168, v169
  v_cvt_pk_bf16_f32 v181, v170, v171
  v_cvt_pk_bf16_f32 v182, v172, v173
  v_cvt_pk_bf16_f32 v183, v174, v175
  v_mfma_f32_32x32x16_bf16 v[160:175], v[216:219], v[40:43], 0
  v_exp_f32 v144, v144
  v_exp_f32 v145, v145
  v_exp_f32 v146, v146
  v_mfma_f32_32x32x16_bf16 v[112:127], v[212:215], v[180:183], v[112:127]
  v_exp_f32 v147, v147
  v_exp_f32 v148, v148
  v_exp_f32 v149, v149
  v_smfmac_f32_16x16x64_bf16 v[140:143], v[28:31], v[176:183], v27
  v_exp_f32 v150, v150
  v_exp_f32 v151, v151
  v_mfma_f32_32x32x16_bf16 v[160:175], v[220:223], v[44:47], v[160:175]
  s_andn2_b32 s33, s36, s34
  s_cbranch_scc1 .fz_kernel_pk15
  s_call_b64 s[68:69], .fz_kernel_pick
.fz_kernel_pk15:
  s_ff1_i32_b32 s33, s33
  s_bitset1_b32 s34, s33
  s_lshl_b32 s33, s33, 14
  s_add_u32 s30, s33, s35
  buffer_load_dwordx4 v[200:203], v3, s[4:7], s30 offen offset:0
  buffer_load_dwordx4 v[204:207], v3, s[4:7], s30 offen offset:1024
  buffer_load_dwordx4 v[208:211], v3, s[4:7], s30 offen offset:2048
  buffer_load_dwordx4 v[212:215], v3, s[4:7], s30 offen offset:3072
  buffer_load_dword v248, v14, s[20:23], 0 offen
  v_cvt_pk_bf16_f32 v176, v144, v145
  v_cvt_pk_bf16_f32 v177, v146, v147
  v_cvt_pk_bf16_f32 v178, v148, v149
  v_cvt_pk_bf16_f32 v179, v150, v151
  v_exp_f32 v152, v152
  v_exp_f32 v153, v153
  v_exp_f32 v154, v154
  v_exp_f32 v155, v155
  v_mfma_f32_32x32x16_bf16 v[64:79], v[224:227], v[176:179], v[64:79]
  v_exp_f32 v156, v156
  v_exp_f32 v157, v157
  v_exp_f32 v158, v158
  v_exp_f32 v159, v159
  v_cvt_pk_bf16_f32 v180, v152, v153
  v_cvt_pk_bf16_f32 v181, v154, v155
  v_cvt_pk_bf16_f32 v182, v156, v157
  v_cvt_pk_bf16_f32 v183, v158, v159
  v_mfma_f32_32x32x16_bf16 v[144:159], v[216:219], v[48:51], 0
  v_exp_f32 v160, v160
  v_exp_f32 v161, v161
  v_exp_f32 v162, v162
  v_mfma_f32_32x32x16_bf16 v[64:79], v[228:231], v[180:183], v[64:79]
  v_exp_f32 v163, v163
  v_exp_f32 v164, v164
  v_exp_f32 v165, v165
  v_smfmac_f32_16x16x64_bf16 v[128:131], v[28:31], v[176:183], v27
  v_exp_f32 v166, v166
  v_exp_f32 v167, v167
  v_mfma_f32_32x32x16_bf16 v[144:159], v[220:223], v[52:55], v[144:159]
  v_cvt_pk_bf16_f32 v176, v160, v161
  v_cvt_pk_bf16_f32 v177, v162, v163
  v_cvt_pk_bf16_f32 v178, v164, v165
  v_cvt_pk_bf16_f32 v179, v166, v167
  v_exp_f32 v168, v168
  v_exp_f32 v169, v169
  v_exp_f32 v170, v170
  v_exp_f32 v171, v171
  v_mfma_f32_32x32x16_bf16 v[80:95], v[224:227], v[176:179], v[80:95]
  v_exp_f32 v172, v172
  v_exp_f32 v173, v173
  v_exp_f32 v174, v174
  v_exp_f32 v175, v175
  v_cvt_pk_bf16_f32 v180, v168, v169
  v_cvt_pk_bf16_f32 v181, v170, v171
  v_cvt_pk_bf16_f32 v182, v172, v173
  v_cvt_pk_bf16_f32 v183, v174, v175
  v_mfma_f32_32x32x16_bf16 v[160:175], v[216:219], v[56:59], 0
  v_exp_f32 v144, v144
  v_exp_f32 v145, v145
  v_exp_f32 v146, v146
  v_mfma_f32_32x32x16_bf16 v[80:95], v[228:231], v[180:183], v[80:95]
  v_exp_f32 v147, v147
  v_exp_f32 v148, v148
  v_exp_f32 v149, v149
  v_smfmac_f32_16x16x64_bf16 v[132:135], v[28:31], v[176:183], v27
  v_exp_f32 v150, v150
  v_exp_f32 v151, v151
  v_mfma_f32_32x32x16_bf16 v[160:175], v[220:223], v[60:63], v[160:175]
  v_cvt_pk_bf16_f32 v176, v144, v145
  v_cvt_pk_bf16_f32 v177, v146, v147
  v_cvt_pk_bf16_f32 v178, v148, v149
  v_cvt_pk_bf16_f32 v179, v150, v151
  v_exp_f32 v152, v152
  v_exp_f32 v153, v153
  v_exp_f32 v154, v154
  v_exp_f32 v155, v155
  v_mfma_f32_32x32x16_bf16 v[96:111], v[224:227], v[176:179], v[96:111]
  v_exp_f32 v156, v156
  v_exp_f32 v157, v157
  v_exp_f32 v158, v158
  v_exp_f32 v159, v159
  v_cvt_pk_bf16_f32 v180, v152, v153
  v_cvt_pk_bf16_f32 v181, v154, v155
  v_cvt_pk_bf16_f32 v182, v156, v157
  v_cvt_pk_bf16_f32 v183, v158, v159
  s_waitcnt vmcnt(12)
  v_mfma_f32_32x32x16_bf16 v[144:159], v[232:235], v[32:35], 0
  v_exp_f32 v160, v160
  v_exp_f32 v161, v161
  v_exp_f32 v162, v162
  v_mfma_f32_32x32x16_bf16 v[96:111], v[228:231], v[180:183], v[96:111]
  v_exp_f32 v163, v163
  v_exp_f32 v164, v164
  v_exp_f32 v165, v165
  v_smfmac_f32_16x16x64_bf16 v[136:139], v[28:31], v[176:183], v27
  v_exp_f32 v166, v166
  v_exp_f32 v167, v167
  v_mfma_f32_32x32x16_bf16 v[144:159], v[236:239], v[36:39], v[144:159]
  v_cvt_pk_bf16_f32 v176, v160, v161
  v_cvt_pk_bf16_f32 v177, v162, v163
  v_cvt_pk_bf16_f32 v178, v164, v165
  v_cvt_pk_bf16_f32 v179, v166, v167
  v_exp_f32 v168, v168
  v_exp_f32 v169, v169
  v_exp_f32 v170, v170
  v_exp_f32 v171, v171
  v_mfma_f32_32x32x16_bf16 v[112:127], v[224:227], v[176:179], v[112:127]
  v_exp_f32 v172, v172
  v_exp_f32 v173, v173
  v_exp_f32 v174, v174
  v_exp_f32 v175, v175
  v_cvt_pk_bf16_f32 v180, v168, v169
  v_cvt_pk_bf16_f32 v181, v170, v171
  v_cvt_pk_bf16_f32 v182, v172, v173
  v_cvt_pk_bf16_f32 v183, v174, v175
  s_cmp_lg_u32 s32, 3
  s_cbranch_scc1 .fz_kernel_pr16
  s_setprio 2
.fz_kernel_pr16:
  s_cmp_lg_u32 s32, 1
  s_cbranch_scc1 .fz_kernel_pr17
  s_setprio 0
.fz_kernel_pr17:
  v_mfma_f32_32x32x16_bf16 v[160:175], v[232:235], v[40:43], 0
  v_exp_f32 v144, v144
  v_exp_f32 v145, v145
  v_exp_f32 v146, v146
  v_mfma_f32_32x32x16_bf16 v[112:127], v[228:231], v[180:183], v[112:127]
  v_exp_f32 v147, v147
  v_exp_f32 v148, v148
  v_exp_f32 v149, v149
  v_smfmac_f32_16x16x64_bf16 v[140:143], v[28:31], v[176:183], v27
  v_exp_f32 v150, v150
  v_exp_f32 v151, v151
  v_mfma_f32_32x32x16_bf16 v[160:175], v[236:239], v[44:47], v[160:175]
  s_andn2_b32 s33, s36, s34
  s_cbranch_scc1 .fz_kernel_pk18
  s_call_b64 s[68:69], .fz_kernel_pick
.fz_kernel_pk18:
  s_ff1_i32_b32 s33, s33
  s_bitset1_b32 s34, s33
  s_lshl_b32 s33, s33, 14
  s_add_u32 s30, s33, s35
  buffer_load_dwordx4 v[216:219], v3, s[4:7], s30 offen offset:0
  buffer_load_dwordx4 v[220:223], v3, s[4:7], s30 offen offset:1024
  buffer_load_dwordx4 v[224:227], v3, s[4:7], s30 offen offset:2048
  buffer_load_dwordx4 v[228:231], v3, s[4:7], s30 offen offset:3072
  buffer_load_dword v248, v15, s[8:11], 0 offen
  v_cvt_pk_bf16_f32 v176, v144, v145
  v_cvt_pk_bf16_f32 v177, v146, v147
  v_cvt_pk_bf16_f32 v178, v148, v149
  v_cvt_pk_bf16_f32 v179, v150, v151
  v_exp_f32 v152, v152
  v_exp_f32 v153, v153
  v_exp_f32 v154, v154
  v_exp_f32 v155, v155
  v_mfma_f32_32x32x16_bf16 v[64:79], v[240:243], v[176:179], v[64:79]
  v_exp_f32 v156, v156
  v_exp_f32 v157, v157
  v_exp_f32 v158, v158
  v_exp_f32 v159, v159
  v_cvt_pk_bf16_f32 v180, v152, v153
  v_cvt_pk_bf16_f32 v181, v154, v155
  v_cvt_pk_bf16_f32 v182, v156, v157
  v_cvt_pk_bf16_f32 v183, v158, v159
  v_mfma_f32_32x32x16_bf16 v[144:159], v[232:235], v[48:51], 0
  v_exp_f32 v160, v160
  v_exp_f32 v161, v161
  v_exp_f32 v162, v162
  v_mfma_f32_32x32x16_bf16 v[64:79], v[244:247], v[180:183], v[64:79]
  v_exp_f32 v163, v163
  v_exp_f32 v164, v164
  v_exp_f32 v165, v165
  v_smfmac_f32_16x16x64_bf16 v[128:131], v[28:31], v[176:183], v27
  v_exp_f32 v166, v166
  v_exp_f32 v167, v167
  v_mfma_f32_32x32x16_bf16 v[144:159], v[236:239], v[52:55], v[144:159]
  v_cvt_pk_bf16_f32 v176, v160, v161
  v_cvt_pk_bf16_f32 v177, v162, v163
  v_cvt_pk_bf16_f32 v178, v164, v165
  v_cvt_pk_bf16_f32 v179, v166, v167
  v_exp_f32 v168, v168
  v_exp_f32 v169, v169
  v_exp_f32 v170, v170
  v_exp_f32 v171, v171
  v_mfma_f32_32x32x16_bf16 v[80:95], v[240:243], v[176:179], v[80:95]
  v_exp_f32 v172, v172
  v_exp_f32 v173, v173
  v_exp_f32 v174, v174
  v_exp_f32 v175, v175
  v_cvt_pk_bf16_f32 v180, v168, v169
  v_cvt_pk_bf16_f32 v181, v170, v171
  v_cvt_pk_bf16_f32 v182, v172, v173
  v_cvt_pk_bf16_f32 v183, v174, v175
  v_mfma_f32_32x32x16_bf16 v[160:175], v[232:235], v[56:59], 0
  v_exp_f32 v144, v144
  v_exp_f32 v145, v145
  v_exp_f32 v146, v146
  v_mfma_f32_32x32x16_bf16 v[80:95], v[244:247], v[180:183], v[80:95]
  v_exp_f32 v147, v147
  v_exp_f32 v148, v148
  v_exp_f32 v149, v149
  v_smfmac_f32_16x16x64_bf16 v[132:135], v[28:31], v[176:183], v27
  v_exp_f32 v150, v150
  v_exp_f32 v151, v151
  v_mfma_f32_32x32x16_bf16 v[160:175], v[236:239], v[60:63], v[160:175]
  v_cvt_pk_bf16_f32 v176, v144, v145
  v_cvt_pk_bf16_f32 v177, v146, v147
  v_cvt_pk_bf16_f32 v178, v148, v149
  v_cvt_pk_bf16_f32 v179, v150, v151
  v_exp_f32 v152, v152
  v_exp_f32 v153, v153
  v_exp_f32 v154, v154
  v_exp_f32 v155, v155
  v_mfma_f32_32x32x16_bf16 v[96:111], v[240:243], v[176:179], v[96:111]
  v_exp_f32 v156, v156
  v_exp_f32 v157, v157
  v_exp_f32 v158, v158
  v_exp_f32 v159, v159
  v_cvt_pk_bf16_f32 v180, v152, v153
  v_cvt_pk_bf16_f32 v181, v154, v155
  v_cvt_pk_bf16_f32 v182, v156, v157
  v_cvt_pk_bf16_f32 v183, v158, v159
  s_waitcnt vmcnt(11)
  v_mfma_f32_32x32x16_bf16 v[144:159], v[184:187], v[32:35], 0
  v_exp_f32 v160, v160
  v_exp_f32 v161, v161
  v_exp_f32 v162, v162
  v_mfma_f32_32x32x16_bf16 v[96:111], v[244:247], v[180:183], v[96:111]
  v_exp_f32 v163, v163
  v_exp_f32 v164, v164
  v_exp_f32 v165, v165
  v_smfmac_f32_16x16x64_bf16 v[136:139], v[28:31], v[176:183], v27
  v_exp_f32 v166, v166
  v_exp_f32 v167, v167
  v_mfma_f32_32x32x16_bf16 v[144:159], v[188:191], v[36:39], v[144:159]
  v_cvt_pk_bf16_f32 v176, v160, v161
  v_cvt_pk_bf16_f32 v177, v162, v163
  v_cvt_pk_bf16_f32 v178, v164, v165
  v_cvt_pk_bf16_f32 v179, v166, v167
  v_exp_f32 v168, v168
  v_exp_f32 v169, v169
  v_exp_f32 v170, v170
  v_exp_f32 v171, v171
  v_mfma_f32_32x32x16_bf16 v[112:127], v[240:243], v[176:179], v[112:127]
  v_exp_f32 v172, v172
  v_exp_f32 v173, v173
  v_exp_f32 v174, v174
  v_exp_f32 v175, v175
  v_cvt_pk_bf16_f32 v180, v168, v169
  v_cvt_pk_bf16_f32 v181, v170, v171
  v_cvt_pk_bf16_f32 v182, v172, v173
  v_cvt_pk_bf16_f32 v183, v174, v175
  v_mov_b32 v13, v16
  v_add_u32 v14, 0x4000, v14
  v_add_u32 v15, 114688, v15
  v_add_u32 v16, 0x4000, v16
  s_sub_u32 s32, s32, 1
  s_cmp_lg_u32 s32, 0
  s_cbranch_scc1 .fz_kernel_a_loop
  ds_read_b32 v7, v6 offset:0x100
  v_mfma_f32_32x32x16_bf16 v[112:127], v[244:247], v[180:183], v[112:127]
  v_smfmac_f32_16x16x64_bf16 v[140:143], v[28:31], v[176:183], v27
  s_waitcnt lgkmcnt(0)
  v_cmp_gt_u32 vcc, 8, v7
  s_cbranch_vccnz .fz_kernel_a_cw
.fz_kernel_a_cb:
  s_and_b32 s39, s16, 1
  s_lshr_b32 s32, s16, 1
  v_and_b32 v8, 16, v2
  v_cmp_ne_u32 s[34:35], 0, v8
  v_lshlrev_b32 v11, 2, v2
  s_add_u32 s31, s32, 1
  s_and_b32 s31, s31, 3
  s_lshl_b32 s31, s31, 1
  s_add_u32 s31, s31, s39
  s_mul_i32 s31, s31, 3
  s_add_u32 s31, s31, 0
  s_lshl_b32 s33, s31, 12
  s_add_u32 s33, s33, 55296
  v_add_u32 v12, s33, v3
  s_lshl_b32 s33, s31, 8
  s_add_u32 s33, s33, 153600
  v_add_u32 v13, s33, v11
  v_add_f32 v8, v132, v133
  ds_write_b128 v12, v[80:83] offset:0
  ds_write_b128 v12, v[84:87] offset:1024
  ds_write_b128 v12, v[88:91] offset:2048
  ds_write_b128 v12, v[92:95] offset:3072
  ds_write_b32 v13, v8
  s_add_u32 s31, s32, 2
  s_and_b32 s31, s31, 3
  s_lshl_b32 s31, s31, 1
  s_add_u32 s31, s31, s39
  s_mul_i32 s31, s31, 3
  s_add_u32 s31, s31, 1
  s_lshl_b32 s33, s31, 12
  s_add_u32 s33, s33, 55296
  v_add_u32 v12, s33, v3
  s_lshl_b32 s33, s31, 8
  s_add_u32 s33, s33, 153600
  v_add_u32 v13, s33, v11
  v_add_f32 v8, v136, v137
  ds_write_b128 v12, v[96:99] offset:0
  ds_write_b128 v12, v[100:103] offset:1024
  ds_write_b128 v12, v[104:107] offset:2048
  ds_write_b128 v12, v[108:111] offset:3072
  ds_write_b32 v13, v8
  s_add_u32 s31, s32, 3
  s_and_b32 s31, s31, 3
  s_lshl_b32 s31, s31, 1
  s_add_u32 s31, s31, s39
  s_mul_i32 s31, s31, 3
  s_add_u32 s31, s31, 2
  s_lshl_b32 s33, s31, 12
  s_add_u32 s33, s33, 55296
  v_add_u32 v12, s33, v3
  s_lshl_b32 s33, s31, 8
  s_add_u32 s33, s33, 153600
  v_add_u32 v13, s33, v11
  v_add_f32 v8, v140, v141
  ds_write_b128 v12, v[112:115] offset:0
  ds_write_b128 v12, v[116:119] offset:1024
  ds_write_b128 v12, v[120:123] offset:2048
  ds_write_b128 v12, v[124:127] offset:3072
  ds_write_b32 v13, v8
  v_add_f32 v9, v128, v129
  s_mul_i32 s31, s16, 3
  s_lshl_b32 s33, s31, 12
  s_add_u32 s33, s33, 55296
  v_add_u32 v12, s33, v3
  s_lshl_b32 s33, s31, 8
  s_add_u32 s33, s33, 153600
  v_add_u32 v13, s33, v11
  s_waitcnt lgkmcnt(0)
  s_barrier
  ds_read_b128 v[80:83], v12 offset:0
  ds_read_b128 v[84:87], v12 offset:1024
  ds_read_b128 v[88:91], v12 offset:2048
  ds_read_b128 v[92:95], v12 offset:3072
  ds_read_b32 v14, v13 offset:0
  ds_read_b128 v[96:99], v12 offset:4096
  ds_read_b128 v[100:103], v12 offset:5120
  ds_read_b128 v[104:107], v12 offset:6144
  ds_read_b128 v[108:111], v12 offset:7168
  ds_read_b32 v15, v13 offset:256
  ds_read_b128 v[112:115], v12 offset:8192
  ds_read_b128 v[116:119], v12 offset:9216
  ds_read_b128 v[120:123], v12 offset:10240
  ds_read_b128 v[124:127], v12 offset:11264
  ds_read_b32 v16, v13 offset:512
  s_mov_b32 s8, s48
  s_mov_b32 s9, s49
  s_mov_b32 s10, 0x800
  s_mov_b32 s11, 0x00020000
  s_mov_b32 s12, s40
  s_mov_b32 s13, s41
  s_mov_b32 s14, 0x400000
  s_mov_b32 s15, 0x00020000
  s_lshr_b32 s20, s16, 2
  s_and_b32 s21, s16, 3
  s_lshl_b32 s22, s17, 2
  s_add_u32 s21, s21, s22
  v_lshrrev_b32 v17, 5, v2
  v_and_b32 v18, 31, v2
  v_lshlrev_b32 v19, 4, v17
  s_lshl_b32 s22, s18, 7
  s_lshl_b32 s23, s20, 6
  s_add_u32 s22, s22, s23
  buffer_load_dwordx4 v[56:59], v19, s[8:11], s22 offen
  buffer_load_dwordx4 v[60:63], v19, s[8:11], s22 offen offset:32
  s_cmp_lg_u32 s62, 0
  s_cbranch_scc1 .fz_kernel_wx2
  v_lshl_add_u32 v19, v18, 11, v19
  s_lshl_b32 s23, s21, 16
  s_add_u32 s22, s22, s23
  buffer_load_dwordx4 v[48:51], v19, s[12:15], s22 offen
  buffer_load_dwordx4 v[52:55], v19, s[12:15], s22 offen offset:32
  s_branch .fz_kernel_wx3
.fz_kernel_wx2:
  s_lshl_b32 s22, s21, 6
  s_lshl_b32 s23, s18, 2
  s_add_u32 s22, s22, s23
  s_lshl_b32 s23, s20, 1
  s_add_u32 s22, s22, s23
  s_lshl_b32 s22, s22, 10
  s_add_u32 s22, s22, 0x1000000
  buffer_load_dwordx4 v[48:51], v3, s[4:7], s22 offen
  buffer_load_dwordx4 v[52:55], v3, s[4:7], s22 offen offset:1024
.fz_kernel_wx3:
  s_waitcnt lgkmcnt(10)
  v_pk_add_f32 v[64:65], v[64:65], v[80:81]
  v_pk_add_f32 v[66:67], v[66:67], v[82:83]
  v_pk_add_f32 v[68:69], v[68:69], v[84:85]
  v_pk_add_f32 v[70:71], v[70:71], v[86:87]
  v_pk_add_f32 v[72:73], v[72:73], v[88:89]
  v_pk_add_f32 v[74:75], v[74:75], v[90:91]
  v_pk_add_f32 v[76:77], v[76:77], v[92:93]
  v_pk_add_f32 v[78:79], v[78:79], v[94:95]
  v_add_f32 v9, v9, v14
  s_waitcnt lgkmcnt(5)
  v_pk_add_f32 v[64:65], v[64:65], v[96:97]
  v_pk_add_f32 v[66:67], v[66:67], v[98:99]
  v_pk_add_f32 v[68:69], v[68:69], v[100:101]
  v_pk_add_f32 v[70:71], v[70:71], v[102:103]
  v_pk_add_f32 v[72:73], v[72:73], v[104:105]
  v_pk_add_f32 v[74:75], v[74:75], v[106:107]
  v_pk_add_f32 v[76:77], v[76:77], v[108:109]
  v_pk_add_f32 v[78:79], v[78:79], v[110:111]
  v_add_f32 v9, v9, v15
  s_waitcnt lgkmcnt(0)
  s_barrier
  v_pk_add_f32 v[64:65], v[64:65], v[112:113]
  v_pk_add_f32 v[66:67], v[66:67], v[114:115]
  v_pk_add_f32 v[68:69], v[68:69], v[116:117]
  v_pk_add_f32 v[70:71], v[70:71], v[118:119]
  v_pk_add_f32 v[72:73], v[72:73], v[120:121]
  v_pk_add_f32 v[74:75], v[74:75], v[122:123]
  v_pk_add_f32 v[76:77], v[76:77], v[124:125]
  v_pk_add_f32 v[78:79], v[78:79], v[126:127]
  v_add_f32 v9, v9, v16
  v_max3_f32 v16, abs(v64), abs(v65), abs(v66)
  v_max3_f32 v11, abs(v67), abs(v68), abs(v69)
  v_max3_f32 v12, abs(v70), abs(v71), abs(v72)
  v_max3_f32 v13, abs(v73), abs(v74), abs(v75)
  v_max3_f32 v14, abs(v76), abs(v77), abs(v78)
  v_max3_f32 v16, v16, v11, abs(v79)
  v_max3_f32 v12, v12, v13, v14
  v_add_f32 v11, v64, v65
  v_add_f32 v13, v66, v67
  v_add_f32 v14, v68, v69
  v_add_f32 v15, v70, v71
  v_add_f32 v11, v11, v13
  v_add_f32 v14, v14, v15
  v_add_f32 v13, v72, v73
  v_add_f32 v15, v74, v75
  v_add_f32 v11, v11, v14
  v_add_f32 v13, v13, v15
  v_add_f32 v14, v76, v77
  v_add_f32 v15, v78, v79
  v_add_f32 v11, v11, v13
  v_add_f32 v14, v14, v15
  v_add_f32 v11, v11, v14
  v_max_f32 v16, v16, v12
  v_mov_b32 v12, 8.673617379884035e-19
  v_mov_b32 v13, 1.152921504606847e+18
  v_mov_b32 v14, 1.329227995784916e+36
  v_cmp_ge_f32 vcc, v9, v12
  v_cmp_le_f32 s[36:37], v9, v13
  v_cmp_le_f32 s[30:31], v16, v14
  v_cmp_o_f32 s[28:29], v11, v11
  s_and_b64 vcc, vcc, s[36:37]
  s_and_b64 s[30:31], s[30:31], s[28:29]
  s_and_b64 vcc, vcc, s[30:31]
  s_cmp_eq_u64 vcc, -1
  s_cbranch_scc0 .fz_kernel_a_slow
.fz_kernel_a_fin:
  v_rcp_f32 v12, v9
  s_lshl_b32 s31, s17, 2
  s_add_u32 s31, s31, s32
  s_lshl_b32 s31, s31, 6
  s_lshl_b32 s33, s18, 2
  s_add_u32 s31, s31, s33
  s_lshl_b32 s33, s39, 1
  s_add_u32 s31, s31, s33
  s_lshl_b32 s31, s31, 10
  s_add_u32 s31, s31, s64
  v_pk_mul_f32 v[64:65], v[64:65], v[12:13] op_sel_hi:[1,0]
  v_pk_mul_f32 v[66:67], v[66:67], v[12:13] op_sel_hi:[1,0]
  v_pk_mul_f32 v[68:69], v[68:69], v[12:13] op_sel_hi:[1,0]
  v_pk_mul_f32 v[70:71], v[70:71], v[12:13] op_sel_hi:[1,0]
  v_pk_mul_f32 v[72:73], v[72:73], v[12:13] op_sel_hi:[1,0]
  v_pk_mul_f32 v[74:75], v[74:75], v[12:13] op_sel_hi:[1,0]
  v_pk_mul_f32 v[76:77], v[76:77], v[12:13] op_sel_hi:[1,0]
  v_pk_mul_f32 v[78:79], v[78:79], v[12:13] op_sel_hi:[1,0]
  v_cvt_pk_bf16_f32 v64, v64, v65
  v_cvt_pk_bf16_f32 v65, v66, v67
  v_cvt_pk_bf16_f32 v66, v68, v69
  v_cvt_pk_bf16_f32 v67, v70, v71
  v_cvt_pk_bf16_f32 v68, v72, v73
  v_cvt_pk_bf16_f32 v69, v74, v75
  v_cvt_pk_bf16_f32 v70, v76, v77
  v_cvt_pk_bf16_f32 v71, v78, v79
  buffer_store_dwordx4 v[64:67], v3, s[4:7], s31 offen sc1
  buffer_store_dwordx4 v[68:71], v3, s[4:7], s31 offen offset:1024 sc1
  s_mul_i32 s31, s16, 10
  s_add_u32 s31, s31, 48
  s_lshl_b32 s33, s31, 14
  s_lshl_b32 s38, s18, 7
  s_add_u32 s38, s33, s38
  s_lshl_b32 s31, s31, 10
  s_add_u32 m0, s31, 0
  s_add_u32 s33, s38, 0
  buffer_load_dwordx4 v10, s[24:27], s33 offen lds
  s_add_u32 m0, s31, 1024
  s_add_u32 s33, s38, 16384
  buffer_load_dwordx4 v10, s[24:27], s33 offen lds
  s_add_u32 m0, s31, 2048
  s_add_u32 s33, s38, 32768
  buffer_load_dwordx4 v10, s[24:27], s33 offen lds
  s_add_u32 m0, s31, 3072
  s_add_u32 s33, s38, 49152
  buffer_load_dwordx4 v10, s[24:27], s33 offen lds
  s_add_u32 m0, s31, 4096
  s_add_u32 s33, s38, 65536
  buffer_load_dwordx4 v10, s[24:27], s33 offen lds
  s_add_u32 m0, s31, 5120
  s_add_u32 s33, s38, 81920
  buffer_load_dwordx4 v10, s[24:27], s33 offen lds
  s_add_u32 m0, s31, 6144
  s_add_u32 s33, s38, 98304
  buffer_load_dwordx4 v10, s[24:27], s33 offen lds
  s_add_u32 m0, s31, 7168
  s_add_u32 s33, s38, 114688
  buffer_load_dwordx4 v10, s[24:27], s33 offen lds
  s_add_u32 m0, s31, 8192
  s_add_u32 s33, s38, 131072
  buffer_load_dwordx4 v10, s[24:27], s33 offen lds
  s_add_u32 m0, s31, 9216
  s_add_u32 s33, s38, 147456
  buffer_load_dwordx4 v10, s[24:27], s33 offen lds
  s_lshr_b32 s39, s16, 2
  s_and_b32 s32, s16, 3
  s_lshl_b32 s31, s32, 5
  v_add_u32 v45, s31, v18
  v_lshlrev_b32 v11, 2, v45
  v_add_u32 v11, 155648, v11
  v_mov_b32 v44, 159952
  ds_read_b32 v40, v11 offset:6400
  ds_read_b32 v42, v11 offset:6912
  ds_read_b32 v46, v44 offset:8
  ds_read_b32 v44, v44
  v_mov_b32 v47, 0.16384
  v_add_u32 v45, 1, v45
  s_lshl_b32 s31, s17, 2
  s_add_u32 s32, s32, s31
  v_bfe_u32 v11, v2, 2, 2
  v_lshl_add_u32 v12, v17, 2, v11
  v_lshlrev_b32 v12, 7, v12
  v_lshrrev_b32 v13, 1, v11
  v_xor_b32 v13, s39, v13
  v_lshl_add_u32 v12, v13, 6, v12
  v_bfe_u32 v13, v2, 4, 1
  v_lshl_add_u32 v12, v13, 5, v12
  v_and_b32 v13, 1, v2
  v_lshl_add_u32 v12, v13, 4, v12
  v_bfe_u32 v13, v2, 1, 1
  v_lshl_add_u32 v14, v13, 3, v12
  v_xor_b32 v15, 64, v14
  s_lshl_b32 s35, s32, 16
  s_add_u32 s35, s35, s64
  s_lshl_b32 s31, s39, 3
  s_lshl_b32 s34, 0xff, s31
  s_xor_b32 s34, s34, 0xffff
  s_lshl_b32 s36, 1, s18
  s_add_u32 s37, s19, s67
  s_add_u32 s37, s37, 4
  v_add_u32 v6, 8, v6
  s_waitcnt vmcnt(0)
  s_barrier
  s_cmp_lg_u32 s16, 7
  s_cbranch_scc1 .fz_kernel_w_nf
  v_lshlrev_b32 v7, 11, v2
  s_lshl_b32 s31, s17, 7
  s_lshl_b32 s33, 1, s18
  s_add_u32 s31, s31, s67
  s_add_u32 s31, s31, 0x1800004
  v_mov_b32 v8, s33
  s_mov_b64 exec, 0xffff
  buffer_atomic_or v8, v7, s[4:7], s31 offen sc1
  s_mov_b64 exec, -1
.fz_kernel_w_nf:
  s_andn2_b32 s33, s36, s34
  s_cbranch_scc1 .fz_kernel_pk19
  s_call_b64 s[68:69], .fz_kernel_pick
.fz_kernel_pk19:
  s_ff1_i32_b32 s33, s33
  s_bitset1_b32 s34, s33
  s_lshl_b32 s20, s33, 13
  s_lshl_b32 s33, s33, 12
  s_add_u32 s30, s33, s35
  buffer_load_dwordx4 v[96:99], v3, s[4:7], s30 offen offset:0
  buffer_load_dwordx4 v[100:103], v3, s[4:7], s30 offen offset:1024
  buffer_load_dwordx4 v[104:107], v3, s[4:7], s30 offen offset:2048
  buffer_load_dwordx4 v[108:111], v3, s[4:7], s30 offen offset:3072
  v_add_u32 v10, s20, v14
  v_add_u32 v11, s20, v15
  ds_read_b64_tr_b16 v[224:225], v10 offset:0
  ds_read_b64_tr_b16 v[226:227], v10 offset:1024
  ds_read_b64_tr_b16 v[228:229], v11 offset:0
  ds_read_b64_tr_b16 v[230:231], v11 offset:1024
  s_andn2_b32 s33, s36, s34
  s_cbranch_scc1 .fz_kernel_pk20
  s_call_b64 s[68:69], .fz_kernel_pick
.fz_kernel_pk20:
  s_ff1_i32_b32 s33, s33
  s_bitset1_b32 s34, s33
  s_lshl_b32 s21, s33, 13
  s_lshl_b32 s33, s33, 12
  s_add_u32 s30, s33, s35
  buffer_load_dwordx4 v[112:115], v3, s[4:7], s30 offen offset:0
  buffer_load_dwordx4 v[116:119], v3, s[4:7], s30 offen offset:1024
  buffer_load_dwordx4 v[120:123], v3, s[4:7], s30 offen offset:2048
  buffer_load_dwordx4 v[124:127], v3, s[4:7], s30 offen offset:3072
  s_andn2_b32 s33, s36, s34
  s_cbranch_scc1 .fz_kernel_pk21
  s_call_b64 s[68:69], .fz_kernel_pick
.fz_kernel_pk21:
  s_ff1_i32_b32 s33, s33
  s_bitset1_b32 s34, s33
  s_lshl_b32 s22, s33, 13
  s_lshl_b32 s33, s33, 12
  s_add_u32 s30, s33, s35
  buffer_load_dwordx4 v[128:131], v3, s[4:7], s30 offen offset:0
  buffer_load_dwordx4 v[132:135], v3, s[4:7], s30 offen offset:1024
  buffer_load_dwordx4 v[136:139], v3, s[4:7], s30 offen offset:2048
  buffer_load_dwordx4 v[140:143], v3, s[4:7], s30 offen offset:3072
  s_andn2_b32 s33, s36, s34
  s_cbranch_scc1 .fz_kernel_pk22
  s_call_b64 s[68:69], .fz_kernel_pick
.fz_kernel_pk22:
  s_ff1_i32_b32 s33, s33
  s_bitset1_b32 s34, s33
  s_lshl_b32 s23, s33, 13
  s_lshl_b32 s33, s33, 12
  s_add_u32 s30, s33, s35
  buffer_load_dwordx4 v[144:147], v3, s[4:7], s30 offen offset:0
  buffer_load_dwordx4 v[148:151], v3, s[4:7], s30 offen offset:1024
  buffer_load_dwordx4 v[152:155], v3, s[4:7], s30 offen offset:2048
  buffer_load_dwordx4 v[156:159], v3, s[4:7], s30 offen offset:3072
  v_add_u32 v12, s21, v14
  v_add_u32 v13, s21, v15
  ds_read_b64_tr_b16 v[232:233], v10 offset:2048
  ds_read_b64_tr_b16 v[234:235], v10 offset:3072
  ds_read_b64_tr_b16 v[236:237], v11 offset:2048
  ds_read_b64_tr_b16 v[238:239], v11 offset:3072
  s_waitcnt vmcnt(15) lgkmcnt(4)
  v_mfma_f32_32x32x16_bf16 v[64:79], v[224:227], v[96:99], 0
  v_mfma_f32_32x32x16_bf16 v[80:95], v[228:231], v[96:99], 0
  ds_read_b64_tr_b16 v[224:225], v10 offset:4096
  ds_read_b64_tr_b16 v[226:227], v10 offset:5120
  ds_read_b64_tr_b16 v[228:229], v11 offset:4096
  ds_read_b64_tr_b16 v[230:231], v11 offset:5120
  s_waitcnt vmcnt(14) lgkmcnt(4)
  v_mfma_f32_32x32x16_bf16 v[64:79], v[232:235], v[100:103], v[64:79]
  v_mfma_f32_32x32x16_bf16 v[80:95], v[236:239], v[100:103], v[80:95]
  ds_read_b64_tr_b16 v[232:233], v10 offset:6144
  ds_read_b64_tr_b16 v[234:235], v10 offset:7168
  ds_read_b64_tr_b16 v[236:237], v11 offset:6144
  ds_read_b64_tr_b16 v[238:239], v11 offset:7168
  s_waitcnt vmcnt(13) lgkmcnt(4)
  v_mfma_f32_32x32x16_bf16 v[64:79], v[224:227], v[104:107], v[64:79]
  v_mfma_f32_32x32x16_bf16 v[80:95], v[228:231], v[104:107], v[80:95]
  ds_read_b64_tr_b16 v[224:225], v12 offset:0
  ds_read_b64_tr_b16 v[226:227], v12 offset:1024
  ds_read_b64_tr_b16 v[228:229], v13 offset:0
  ds_read_b64_tr_b16 v[230:231], v13 offset:1024
  s_waitcnt vmcnt(12) lgkmcnt(4)
  v_mfma_f32_32x32x16_bf16 v[64:79], v[232:235], v[108:111], v[64:79]
  v_mfma_f32_32x32x16_bf16 v[80:95], v[236:239], v[108:111], v[80:95]
  s_andn2_b32 s33, s36, s34
  s_cbranch_scc1 .fz_kernel_pk23
  s_call_b64 s[68:69], .fz_kernel_pick
.fz_kernel_pk23:
  s_ff1_i32_b32 s33, s33
  s_bitset1_b32 s34, s33
  s_lshl_b32 s24, s33, 13
  s_lshl_b32 s33, s33, 12
  s_add_u32 s30, s33, s35
  buffer_load_dwordx4 v[160:163], v3, s[4:7], s30 offen offset:0
  buffer_load_dwordx4 v[164:167], v3, s[4:7], s30 offen offset:1024
  buffer_load_dwordx4 v[168:171], v3, s[4:7], s30 offen offset:2048
  buffer_load_dwordx4 v[172:175], v3, s[4:7], s30 offen offset:3072
  v_add_u32 v10, s22, v14
  v_add_u32 v11, s22, v15
  ds_read_b64_tr_b16 v[232:233], v12 offset:2048
  ds_read_b64_tr_b16 v[234:235], v12 offset:3072
  ds_read_b64_tr_b16 v[236:237], v13 offset:2048
  ds_read_b64_tr_b16 v[238:239], v13 offset:3072
  s_waitcnt vmcnt(15) lgkmcnt(4)
  v_mfma_f32_32x32x16_bf16 v[64:79], v[224:227], v[112:115], v[64:79]
  v_mfma_f32_32x32x16_bf16 v[80:95], v[228:231], v[112:115], v[80:95]
  ds_read_b64_tr_b16 v[224:225], v12 offset:4096
  ds_read_b64_tr_b16 v[226:227], v12 offset:5120
  ds_read_b64_tr_b16 v[228:229], v13 offset:4096
  ds_read_b64_tr_b16 v[230:231], v13 offset:5120
  s_waitcnt vmcnt(14) lgkmcnt(4)
  v_mfma_f32_32x32x16_bf16 v[64:79], v[232:235], v[116:119], v[64:79]
  v_mfma_f32_32x32x16_bf16 v[80:95], v[236:239], v[116:119], v[80:95]
  ds_read_b64_tr_b16 v[232:233], v12 offset:6144
  ds_read_b64_tr_b16 v[234:235], v12 offset:7168
  ds_read_b64_tr_b16 v[236:237], v13 offset:6144
  ds_read_b64_tr_b16 v[238:239], v13 offset:7168
  s_waitcnt vmcnt(13) lgkmcnt(4)
  v_mfma_f32_32x32x16_bf16 v[64:79], v[224:227], v[120:123], v[64:79]
  v_mfma_f32_32x32x16_bf16 v[80:95], v[228:231], v[120:123], v[80:95]
  ds_read_b64_tr_b16 v[224:225], v10 offset:0
  ds_read_b64_tr_b16 v[226:227], v10 offset:1024
  ds_read_b64_tr_b16 v[228:229], v11 offset:0
  ds_read_b64_tr_b16 v[230:231], v11 offset:1024
  s_waitcnt vmcnt(12) lgkmcnt(4)
  v_mfma_f32_32x32x16_bf16 v[64:79], v[232:235], v[124:127], v[64:79]
  v_mfma_f32_32x32x16_bf16 v[80:95], v[236:239], v[124:127], v[80:95]
  s_andn2_b32 s33, s36, s34
  s_cbranch_scc1 .fz_kernel_pk24
  s_call_b64 s[68:69], .fz_kernel_pick
.fz_kernel_pk24:
  s_ff1_i32_b32 s33, s33
  s_bitset1_b32 s34, s33
  s_lshl_b32 s25, s33, 13
  s_lshl_b32 s33, s33, 12
  s_add_u32 s30, s33, s35
  buffer_load_dwordx4 v[176:179], v3, s[4:7], s30 offen offset:0
  buffer_load_dwordx4 v[180:183], v3, s[4:7], s30 offen offset:1024
  buffer_load_dwordx4 v[184:187], v3, s[4:7], s30 offen offset:2048
  buffer_load_dwordx4 v[188:191], v3, s[4:7], s30 offen offset:3072
  v_add_u32 v12, s23, v14
  v_add_u32 v13, s23, v15
  ds_read_b64_tr_b16 v[232:233], v10 offset:2048
  ds_read_b64_tr_b16 v[234:235], v10 offset:3072
  ds_read_b64_tr_b16 v[236:237], v11 offset:2048
  ds_read_b64_tr_b16 v[238:239], v11 offset:3072
  s_waitcnt vmcnt(15) lgkmcnt(4)
  v_mfma_f32_32x32x16_bf16 v[64:79], v[224:227], v[128:131], v[64:79]
  v_mfma_f32_32x32x16_bf16 v[80:95], v[228:231], v[128:131], v[80:95]
  ds_read_b64_tr_b16 v[224:225], v10 offset:4096
  ds_read_b64_tr_b16 v[226:227], v10 offset:5120
  ds_read_b64_tr_b16 v[228:229], v11 offset:4096
  ds_read_b64_tr_b16 v[230:231], v11 offset:5120
  s_waitcnt vmcnt(14) lgkmcnt(4)
  v_mfma_f32_32x32x16_bf16 v[64:79], v[232:235], v[132:135], v[64:79]
  v_mfma_f32_32x32x16_bf16 v[80:95], v[236:239], v[132:135], v[80:95]
  ds_read_b64_tr_b16 v[232:233], v10 offset:6144
  ds_read_b64_tr_b16 v[234:235], v10 offset:7168
  ds_read_b64_tr_b16 v[236:237], v11 offset:6144
  ds_read_b64_tr_b16 v[238:239], v11 offset:7168
  s_waitcnt vmcnt(13) lgkmcnt(4)
  v_mfma_f32_32x32x16_bf16 v[64:79], v[224:227], v[136:139], v[64:79]
  v_mfma_f32_32x32x16_bf16 v[80:95], v[228:231], v[136:139], v[80:95]
  ds_read_b64_tr_b16 v[224:225], v12 offset:0
  ds_read_b64_tr_b16 v[226:227], v12 offset:1024
  ds_read_b64_tr_b16 v[228:229], v13 offset:0
  ds_read_b64_tr_b16 v[230:231], v13 offset:1024
  s_waitcnt vmcnt(12) lgkmcnt(4)
  v_mfma_f32_32x32x16_bf16 v[64:79], v[232:235], v[140:143], v[64:79]
  v_mfma_f32_32x32x16_bf16 v[80:95], v[236:239], v[140:143], v[80:95]
  s_andn2_b32 s33, s36, s34
  s_cbranch_scc1 .fz_kernel_pk25
  s_call_b64 s[68:69], .fz_kernel_pick
.fz_kernel_pk25:
  s_ff1_i32_b32 s33, s33
  s_bitset1_b32 s34, s33
  s_lshl_b32 s26, s33, 13
  s_lshl_b32 s33, s33, 12
  s_add_u32 s30, s33, s35
  buffer_load_dwordx4 v[192:195], v3, s[4:7], s30 offen offset:0
  buffer_load_dwordx4 v[196:199], v3, s[4:7], s30 offen offset:1024
  buffer_load_dwordx4 v[200:203], v3, s[4:7], s30 offen offset:2048
  buffer_load_dwordx4 v[204:207], v3, s[4:7], s30 offen offset:3072
  v_add_u32 v10, s24, v14
  v_add_u32 v11, s24, v15
  ds_read_b64_tr_b16 v[232:233], v12 offset:2048
  ds_read_b64_tr_b16 v[234:235], v12 offset:3072
  ds_read_b64_tr_b16 v[236:237], v13 offset:2048
  ds_read_b64_tr_b16 v[238:239], v13 offset:3072
  s_waitcnt vmcnt(15) lgkmcnt(4)
  v_mfma_f32_32x32x16_bf16 v[64:79], v[224:227], v[144:147], v[64:79]
  v_mfma_f32_32x32x16_bf16 v[80:95], v[228:231], v[144:147], v[80:95]
  ds_read_b64_tr_b16 v[224:225], v12 offset:4096
  ds_read_b64_tr_b16 v[226:227], v12 offset:5120
  ds_read_b64_tr_b16 v[228:229], v13 offset:4096
  ds_read_b64_tr_b16 v[230:231], v13 offset:5120
  s_waitcnt vmcnt(14) lgkmcnt(4)
  v_mfma_f32_32x32x16_bf16 v[64:79], v[232:235], v[148:151], v[64:79]
  v_mfma_f32_32x32x16_bf16 v[80:95], v[236:239], v[148:151], v[80:95]
  ds_read_b64_tr_b16 v[232:233], v12 offset:6144
  ds_read_b64_tr_b16 v[234:235], v12 offset:7168
  ds_read_b64_tr_b16 v[236:237], v13 offset:6144
  ds_read_b64_tr_b16 v[238:239], v13 offset:7168
  s_waitcnt vmcnt(13) lgkmcnt(4)
  v_mfma_f32_32x32x16_bf16 v[64:79], v[224:227], v[152:155], v[64:79]
  v_mfma_f32_32x32x16_bf16 v[80:95], v[228:231], v[152:155], v[80:95]
  ds_read_b64_tr_b16 v[224:225], v10 offset:0
  ds_read_b64_tr_b16 v[226:227], v10 offset:1024
  ds_read_b64_tr_b16 v[228:229], v11 offset:0
  ds_read_b64_tr_b16 v[230:231], v11 offset:1024
  s_waitcnt vmcnt(12) lgkmcnt(4)
  v_mfma_f32_32x32x16_bf16 v[64:79], v[232:235], v[156:159], v[64:79]
  v_mfma_f32_32x32x16_bf16 v[80:95], v[236:239], v[156:159], v[80:95]
  s_andn2_b32 s33, s36, s34
  s_cbranch_scc1 .fz_kernel_pk26
  s_call_b64 s[68:69], .fz_kernel_pick
.fz_kernel_pk26:
  s_ff1_i32_b32 s33, s33
  s_bitset1_b32 s34, s33
  s_lshl_b32 s27, s33, 13
  s_lshl_b32 s33, s33, 12
  s_add_u32 s30, s33, s35
  buffer_load_dwordx4 v[208:211], v3, s[4:7], s30 offen offset:0
  buffer_load_dwordx4 v[212:215], v3, s[4:7], s30 offen offset:1024
  buffer_load_dwordx4 v[216:219], v3, s[4:7], s30 offen offset:2048
  buffer_load_dwordx4 v[220:223], v3, s[4:7], s30 offen offset:3072
  v_add_u32 v12, s25, v14
  v_add_u32 v13, s25, v15
  ds_read_b64_tr_b16 v[232:233], v10 offset:2048
  ds_read_b64_tr_b16 v[234:235], v10 offset:3072
  ds_read_b64_tr_b16 v[236:237], v11 offset:2048
  ds_read_b64_tr_b16 v[238:239], v11 offset:3072
  s_waitcnt vmcnt(15) lgkmcnt(4)
  v_mfma_f32_32x32x16_bf16 v[64:79], v[224:227], v[160:163], v[64:79]
  v_mfma_f32_32x32x16_bf16 v[80:95], v[228:231], v[160:163], v[80:95]
  ds_read_b64_tr_b16 v[224:225], v10 offset:4096
  ds_read_b64_tr_b16 v[226:227], v10 offset:5120
  ds_read_b64_tr_b16 v[228:229], v11 offset:4096
  ds_read_b64_tr_b16 v[230:231], v11 offset:5120
  s_waitcnt vmcnt(14) lgkmcnt(4)
  v_mfma_f32_32x32x16_bf16 v[64:79], v[232:235], v[164:167], v[64:79]
  v_mfma_f32_32x32x16_bf16 v[80:95], v[236:239], v[164:167], v[80:95]
  ds_read_b64_tr_b16 v[232:233], v10 offset:6144
  ds_read_b64_tr_b16 v[234:235], v10 offset:7168
  ds_read_b64_tr_b16 v[236:237], v11 offset:6144
  ds_read_b64_tr_b16 v[238:239], v11 offset:7168
  s_waitcnt vmcnt(13) lgkmcnt(4)
  v_mfma_f32_32x32x16_bf16 v[64:79], v[224:227], v[168:171], v[64:79]
  v_mfma_f32_32x32x16_bf16 v[80:95], v[228:231], v[168:171], v[80:95]
  ds_read_b64_tr_b16 v[224:225], v12 offset:0
  ds_read_b64_tr_b16 v[226:227], v12 offset:1024
  ds_read_b64_tr_b16 v[228:229], v13 offset:0
  ds_read_b64_tr_b16 v[230:231], v13 offset:1024
  s_waitcnt vmcnt(12) lgkmcnt(4)
  v_mfma_f32_32x32x16_bf16 v[64:79], v[232:235], v[172:175], v[64:79]
  v_mfma_f32_32x32x16_bf16 v[80:95], v[236:239], v[172:175], v[80:95]
  v_add_u32 v10, s26, v14
  v_add_u32 v11, s26, v15
  ds_read_b64_tr_b16 v[232:233], v12 offset:2048
  ds_read_b64_tr_b16 v[234:235], v12 offset:3072
  ds_read_b64_tr_b16 v[236:237], v13 offset:2048
  ds_read_b64_tr_b16 v[238:239], v13 offset:3072
  s_waitcnt vmcnt(11) lgkmcnt(4)
  v_mfma_f32_32x32x16_bf16 v[64:79], v[224:227], v[176:179], v[64:79]
  v_mfma_f32_32x32x16_bf16 v[80:95], v[228:231], v[176:179], v[80:95]
  ds_read_b64_tr_b16 v[224:225], v12 offset:4096
  ds_read_b64_tr_b16 v[226:227], v12 offset:5120
  ds_read_b64_tr_b16 v[228:229], v13 offset:4096
  ds_read_b64_tr_b16 v[230:231], v13 offset:5120
  s_waitcnt vmcnt(10) lgkmcnt(4)
  v_mfma_f32_32x32x16_bf16 v[64:79], v[232:235], v[180:183], v[64:79]
  v_mfma_f32_32x32x16_bf16 v[80:95], v[236:239], v[180:183], v[80:95]
  ds_read_b64_tr_b16 v[232:233], v12 offset:6144
  ds_read_b64_tr_b16 v[234:235], v12 offset:7168
  ds_read_b64_tr_b16 v[236:237], v13 offset:6144
  ds_read_b64_tr_b16 v[238:239], v13 offset:7168
  s_waitcnt vmcnt(9) lgkmcnt(4)
  v_mfma_f32_32x32x16_bf16 v[64:79], v[224:227], v[184:187], v[64:79]
  v_mfma_f32_32x32x16_bf16 v[80:95], v[228:231], v[184:187], v[80:95]
  ds_read_b64_tr_b16 v[224:225], v10 offset:0
  ds_read_b64_tr_b16 v[226:227], v10 offset:1024
  ds_read_b64_tr_b16 v[228:229], v11 offset:0
  ds_read_b64_tr_b16 v[230:231], v11 offset:1024
  s_waitcnt vmcnt(8) lgkmcnt(4)
  v_mfma_f32_32x32x16_bf16 v[64:79], v[232:235], v[188:191], v[64:79]
  v_mfma_f32_32x32x16_bf16 v[80:95], v[236:239], v[188:191], v[80:95]
  v_add_u32 v12, s27, v14
  v_add_u32 v13, s27, v15
  ds_read_b64_tr_b16 v[232:233], v10 offset:2048
  ds_read_b64_tr_b16 v[234:235], v10 offset:3072
  ds_read_b64_tr_b16 v[236:237], v11 offset:2048
  ds_read_b64_tr_b16 v[238:239], v11 offset:3072
  s_waitcnt vmcnt(7) lgkmcnt(4)
  v_mfma_f32_32x32x16_bf16 v[64:79], v[224:227], v[192:195], v[64:79]
  v_mfma_f32_32x32x16_bf16 v[80:95], v[228:231], v[192:195], v[80:95]
  ds_read_b64_tr_b16 v[224:225], v10 offset:4096
  ds_read_b64_tr_b16 v[226:227], v10 offset:5120
  ds_read_b64_tr_b16 v[228:229], v11 offset:4096
  ds_read_b64_tr_b16 v[230:231], v11 offset:5120
  s_waitcnt vmcnt(6) lgkmcnt(4)
  v_mfma_f32_32x32x16_bf16 v[64:79], v[232:235], v[196:199], v[64:79]
  v_mfma_f32_32x32x16_bf16 v[80:95], v[236:239], v[196:199], v[80:95]
  ds_read_b64_tr_b16 v[232:233], v10 offset:6144
  ds_read_b64_tr_b16 v[234:235], v10 offset:7168
  ds_read_b64_tr_b16 v[236:237], v11 offset:6144
  ds_read_b64_tr_b16 v[238:239], v11 offset:7168
  s_waitcnt vmcnt(5) lgkmcnt(4)
  v_mfma_f32_32x32x16_bf16 v[64:79], v[224:227], v[200:203], v[64:79]
  v_mfma_f32_32x32x16_bf16 v[80:95], v[228:231], v[200:203], v[80:95]
  ds_read_b64_tr_b16 v[224:225], v12 offset:0
  ds_read_b64_tr_b16 v[226:227], v12 offset:1024
  ds_read_b64_tr_b16 v[228:229], v13 offset:0
  ds_read_b64_tr_b16 v[230:231], v13 offset:1024
  s_waitcnt vmcnt(4) lgkmcnt(4)
  v_mfma_f32_32x32x16_bf16 v[64:79], v[232:235], v[204:207], v[64:79]
  v_mfma_f32_32x32x16_bf16 v[80:95], v[236:239], v[204:207], v[80:95]
  ds_read_b64_tr_b16 v[232:233], v12 offset:2048
  ds_read_b64_tr_b16 v[234:235], v12 offset:3072
  ds_read_b64_tr_b16 v[236:237], v13 offset:2048
  ds_read_b64_tr_b16 v[238:239], v13 offset:3072
  s_waitcnt vmcnt(3) lgkmcnt(4)
  v_mfma_f32_32x32x16_bf16 v[64:79], v[224:227], v[208:211], v[64:79]
  v_mfma_f32_32x32x16_bf16 v[80:95], v[228:231], v[208:211], v[80:95]
  ds_read_b64_tr_b16 v[224:225], v12 offset:4096
  ds_read_b64_tr_b16 v[226:227], v12 offset:5120
  ds_read_b64_tr_b16 v[228:229], v13 offset:4096
  ds_read_b64_tr_b16 v[230:231], v13 offset:5120
  s_waitcnt vmcnt(2) lgkmcnt(4)
  v_mfma_f32_32x32x16_bf16 v[64:79], v[232:235], v[212:215], v[64:79]
  v_mfma_f32_32x32x16_bf16 v[80:95], v[236:239], v[212:215], v[80:95]
  ds_read_b64_tr_b16 v[232:233], v12 offset:6144
  ds_read_b64_tr_b16 v[234:235], v12 offset:7168
  ds_read_b64_tr_b16 v[236:237], v13 offset:6144
  ds_read_b64_tr_b16 v[238:239], v13 offset:7168
  s_waitcnt vmcnt(1) lgkmcnt(4)
  v_mfma_f32_32x32x16_bf16 v[64:79], v[224:227], v[216:219], v[64:79]
  v_mfma_f32_32x32x16_bf16 v[80:95], v[228:231], v[216:219], v[80:95]
  s_waitcnt vmcnt(0) lgkmcnt(0)
  v_mfma_f32_32x32x16_bf16 v[64:79], v[232:235], v[220:223], v[64:79]
  v_mfma_f32_32x32x16_bf16 v[80:95], v[236:239], v[220:223], v[80:95]
  s_xor_b32 s31, s16, 4
  s_lshl_b32 s31, s31, 12
  v_add_u32 v8, s31, v3
  s_xor_b32 s31, s31, 16384
  v_add_u32 v9, s31, v3
  v_lshlrev_b32 v20, 16, v48
  v_and_b32 v21, 0xffff0000, v48
  v_lshlrev_b32 v22, 16, v49
  v_and_b32 v23, 0xffff0000, v49
  v_lshlrev_b32 v24, 16, v50
  v_and_b32 v25, 0xffff0000, v50
  v_lshlrev_b32 v26, 16, v51
  v_and_b32 v27, 0xffff0000, v51
  v_lshlrev_b32 v28, 16, v52
  v_and_b32 v29, 0xffff0000, v52
  v_lshlrev_b32 v30, 16, v53
  v_and_b32 v31, 0xffff0000, v53
  v_lshlrev_b32 v32, 16, v54
  v_and_b32 v33, 0xffff0000, v54
  v_lshlrev_b32 v34, 16, v55
  v_and_b32 v35, 0xffff0000, v55
  s_barrier
  ds_write_b128 v8, v[80:83] offset:0
  ds_write_b128 v8, v[84:87] offset:1024
  ds_write_b128 v8, v[88:91] offset:2048
  ds_write_b128 v8, v[92:95] offset:3072
  v_pk_fma_f32 v[20:21], v[20:21], v[40:41], v[42:43] op_sel_hi:[1,0,0]
  v_pk_fma_f32 v[22:23], v[22:23], v[40:41], v[42:43] op_sel_hi:[1,0,0]
  v_pk_fma_f32 v[24:25], v[24:25], v[40:41], v[42:43] op_sel_hi:[1,0,0]
  v_pk_fma_f32 v[26:27], v[26:27], v[40:41], v[42:43] op_sel_hi:[1,0,0]
  v_pk_fma_f32 v[28:29], v[28:29], v[40:41], v[42:43] op_sel_hi:[1,0,0]
  v_pk_fma_f32 v[30:31], v[30:31], v[40:41], v[42:43] op_sel_hi:[1,0,0]
  v_pk_fma_f32 v[32:33], v[32:33], v[40:41], v[42:43] op_sel_hi:[1,0,0]
  v_pk_fma_f32 v[34:35], v[34:35], v[40:41], v[42:43] op_sel_hi:[1,0,0]
  v_cmp_eq_u32 vcc, v44, v45
  s_cbranch_vccnz .fz_kernel_w_pt
.fz_kernel_w_pb:
  v_pk_add_f32 v[64:65], v[64:65], v[20:21]
  v_pk_add_f32 v[66:67], v[66:67], v[22:23]
  v_pk_add_f32 v[68:69], v[68:69], v[24:25]
  v_pk_add_f32 v[70:71], v[70:71], v[26:27]
  v_pk_add_f32 v[72:73], v[72:73], v[28:29]
  v_pk_add_f32 v[74:75], v[74:75], v[30:31]
  v_pk_add_f32 v[76:77], v[76:77], v[32:33]
  v_pk_add_f32 v[78:79], v[78:79], v[34:35]
  s_mov_b32 s36, 0x3f803f80
  v_mov_b32 v14, 0
  v_mov_b32 v15, 0
  v_mov_b32 v16, 0
  v_lshlrev_b32 v19, 2, v18
  v_lshl_add_u32 v19, v17, 13, v19
  s_lshl_b32 s34, s32, 7
  s_add_u32 s34, s34, s66
  s_add_u32 s34, s34, 16384
  s_add_u32 s37, s34, 16384
  s_lshl_b32 s35, s32, 6
  s_lshl_b32 s31, s18, 2
  s_add_u32 s35, s35, s31
  s_lshl_b32 s31, s39, 1
  s_add_u32 s35, s35, s31
  s_lshl_b32 s35, s35, 10
  s_add_u32 s35, s35, s65
  s_waitcnt lgkmcnt(0)
  s_barrier
  ds_read_b128 v[96:99], v9 offset:0
  ds_read_b128 v[100:103], v9 offset:1024
  ds_read_b128 v[104:107], v9 offset:2048
  ds_read_b128 v[108:111], v9 offset:3072
  s_waitcnt lgkmcnt(3)
  v_pk_add_f32 v[64:65], v[64:65], v[96:97]
  v_pk_add_f32 v[66:67], v[66:67], v[98:99]
  v_cvt_pk_bf16_f32 v20, v64, v65
  v_cvt_pk_bf16_f32 v21, v66, v67
  s_waitcnt lgkmcnt(2)
  v_pk_add_f32 v[68:69], v[68:69], v[100:101]
  v_pk_add_f32 v[70:71], v[70:71], v[102:103]
  v_cvt_pk_bf16_f32 v22, v68, v69
  v_cvt_pk_bf16_f32 v23, v70, v71
  buffer_store_dwordx4 v[20:23], v3, s[4:7], s35 offen offset:0 sc1
  s_waitcnt lgkmcnt(1)
  v_pk_add_f32 v[72:73], v[72:73], v[104:105]
  v_pk_add_f32 v[74:75], v[74:75], v[106:107]
  v_cvt_pk_bf16_f32 v24, v72, v73
  v_cvt_pk_bf16_f32 v25, v74, v75
  s_waitcnt lgkmcnt(0)
  v_pk_add_f32 v[76:77], v[76:77], v[108:109]
  v_pk_add_f32 v[78:79], v[78:79], v[110:111]
  v_cvt_pk_bf16_f32 v26, v76, v77
  v_cvt_pk_bf16_f32 v27, v78, v79
  buffer_store_dwordx4 v[24:27], v3, s[4:7], s35 offen offset:1024 sc1
  v_dot2c_f32_bf16 v14, s36, v20
  v_dot2c_f32_bf16 v15, v20, v20
  v_dot2c_f32_bf16 v16, v20, v56
  v_dot2c_f32_bf16 v14, s36, v21
  v_dot2c_f32_bf16 v15, v21, v21
  v_dot2c_f32_bf16 v16, v21, v57
  v_dot2c_f32_bf16 v14, s36, v22
  v_dot2c_f32_bf16 v15, v22, v22
  v_dot2c_f32_bf16 v16, v22, v58
  v_dot2c_f32_bf16 v14, s36, v23
  v_dot2c_f32_bf16 v15, v23, v23
  v_dot2c_f32_bf16 v16, v23, v59
  v_dot2c_f32_bf16 v14, s36, v24
  v_dot2c_f32_bf16 v15, v24, v24
  v_dot2c_f32_bf16 v16, v24, v60
  v_dot2c_f32_bf16 v14, s36, v25
  v_dot2c_f32_bf16 v15, v25, v25
  v_dot2c_f32_bf16 v16, v25, v61
  v_dot2c_f32_bf16 v14, s36, v26
  v_dot2c_f32_bf16 v15, v26, v26
  v_dot2c_f32_bf16 v16, v26, v62
  v_dot2c_f32_bf16 v14, s36, v27
  v_dot2c_f32_bf16 v15, v27, v27
  v_dot2c_f32_bf16 v16, v27, v63
  s_nop 2
  v_fma_f32 v16, -v14, v46, v16
  v_fmac_f32 v47, 0x44800000, v15
  v_mov_b32 v36, v16
  s_nop 0
  v_permlane32_swap_b32 v14, v47
  v_permlane32_swap_b32 v16, v36
  v_add_f32 v14, v14, v47
  v_add_f32 v16, v16, v36
  buffer_atomic_add_f32 v14, v19, s[4:7], s34 offen sc1
  s_mov_b32 exec_hi, 0
  buffer_atomic_add_f32 v16, v19, s[4:7], s37 offen sc1
  s_mov_b64 exec, -1
  s_mov_b32 s72, s66
  s_mov_b32 s73, s65
  s_mov_b32 s74, s67
  s_mov_b32 s75, s62
  s_cmp_lg_u32 s62, 0
  s_cbranch_scc1 .fz_kernel_tail
  s_mov_b32 s62, 1
  s_mov_b32 s63, 0x2000000
  s_mov_b32 s64, 0x2800000
  s_mov_b32 s65, 0x1400000
  s_mov_b32 s66, 0x1c42000
  s_mov_b32 s67, 12
  s_mov_b32 s71, 159776
  v_mov_b32 v6, 159832
  s_cmp_lt_u32 s16, 4
  s_cbranch_scc1 .fz_kernel_q_cons2
  s_cmp_eq_u32 s16, 4
  s_cbranch_scc1 .fz_kernel_q_px2
  s_cmp_eq_u32 s16, 5
  s_cbranch_scc1 .fz_kernel_q_pw
  s_branch .fz_kernel_chain
.fz_kernel_tail:
  s_cmp_ge_u32 s16, 6
  s_cbranch_scc1 .fz_kernel_chain
  s_waitcnt vmcnt(0)
  s_barrier
  s_barrier
  s_call_b64 s[68:69], .fz_kernel_outst
  s_branch .fz_kernel_fin
.fz_kernel_chain:
  s_setprio 2
  s_bitcmp1_b32 s18, 0
  s_cselect_b32 s8, s52, s50
  s_cselect_b32 s9, s53, s51
  s_mov_b32 s10, 0x700000
  s_mov_b32 s11, 0x00020000
  s_lshl_b32 s12, s16, 8
  s_and_b32 s12, s12, 511
  s_and_b32 s31, s18, 2
  s_lshl_b32 s31, s31, 8
  s_add_u32 s12, s12, s31
  s_mul_i32 s12, s12, 7168
  s_lshl_b32 s31, s17, 2
  s_lshr_b32 s33, s18, 2
  s_add_u32 s31, s31, s33
  s_lshl_b32 s31, s31, 7
  s_add_u32 s12, s12, s31
  v_lshrrev_b32 v13, 4, v2
  v_mul_u32_u24 v13, 458752, v13
  v_and_b32 v11, 15, v2
  v_lshl_add_u32 v13, v11, 3, v13
  s_cmp_ge_u32 s17, 14
  s_cbranch_scc1 .fz_kernel_c_nl
  buffer_load_dwordx2 v[120:121], v13, s[8:11], s12 offen
  s_add_u32 s12, s12, 7168
  buffer_load_dwordx2 v[122:123], v13, s[8:11], s12 offen
  s_add_u32 s12, s12, 7168
  buffer_load_dwordx2 v[124:125], v13, s[8:11], s12 offen
  s_add_u32 s12, s12, 7168
  buffer_load_dwordx2 v[126:127], v13, s[8:11], s12 offen
  s_add_u32 s12, s12, 7168
  buffer_load_dwordx2 v[128:129], v13, s[8:11], s12 offen
  s_add_u32 s12, s12, 7168
  buffer_load_dwordx2 v[130:131], v13, s[8:11], s12 offen
  s_add_u32 s12, s12, 7168
  buffer_load_dwordx2 v[132:133], v13, s[8:11], s12 offen
  s_add_u32 s12, s12, 7168
  buffer_load_dwordx2 v[134:135], v13, s[8:11], s12 offen
  s_add_u32 s12, s12, 7168
  buffer_load_dwordx2 v[136:137], v13, s[8:11], s12 offen
  s_add_u32 s12, s12, 7168
  buffer_load_dwordx2 v[138:139], v13, s[8:11], s12 offen
  s_add_u32 s12, s12, 7168
  buffer_load_dwordx2 v[140:141], v13, s[8:11], s12 offen
  s_add_u32 s12, s12, 7168
  buffer_load_dwordx2 v[142:143], v13, s[8:11], s12 offen
  s_add_u32 s12, s12, 7168
  buffer_load_dwordx2 v[144:145], v13, s[8:11], s12 offen
  s_add_u32 s12, s12, 7168
  buffer_load_dwordx2 v[146:147], v13, s[8:11], s12 offen
  s_add_u32 s12, s12, 7168
  buffer_load_dwordx2 v[148:149], v13, s[8:11], s12 offen
  s_add_u32 s12, s12, 7168
  buffer_load_dwordx2 v[150:151], v13, s[8:11], s12 offen
  s_add_u32 s12, s12, 7168
  buffer_load_dwordx2 v[152:153], v13, s[8:11], s12 offen
  s_add_u32 s12, s12, 7168
  buffer_load_dwordx2 v[154:155], v13, s[8:11], s12 offen
  s_add_u32 s12, s12, 7168
  buffer_load_dwordx2 v[156:157], v13, s[8:11], s12 offen
  s_add_u32 s12, s12, 7168
  buffer_load_dwordx2 v[158:159], v13, s[8:11], s12 offen
  s_add_u32 s12, s12, 7168
  buffer_load_dwordx2 v[160:161], v13, s[8:11], s12 offen
  s_add_u32 s12, s12, 7168
  buffer_load_dwordx2 v[162:163], v13, s[8:11], s12 offen
  s_add_u32 s12, s12, 7168
  buffer_load_dwordx2 v[164:165], v13, s[8:11], s12 offen
  s_add_u32 s12, s12, 7168
  buffer_load_dwordx2 v[166:167], v13, s[8:11], s12 offen
  s_add_u32 s12, s12, 7168
  buffer_load_dwordx2 v[168:169], v13, s[8:11], s12 offen
  s_add_u32 s12, s12, 7168
  buffer_load_dwordx2 v[170:171], v13, s[8:11], s12 offen
  s_add_u32 s12, s12, 7168
  buffer_load_dwordx2 v[172:173], v13, s[8:11], s12 offen
  s_add_u32 s12, s12, 7168
  buffer_load_dwordx2 v[174:175], v13, s[8:11], s12 offen
  s_add_u32 s12, s12, 7168
  buffer_load_dwordx2 v[176:177], v13, s[8:11], s12 offen
  s_add_u32 s12, s12, 7168
  buffer_load_dwordx2 v[178:179], v13, s[8:11], s12 offen
  s_add_u32 s12, s12, 7168
  buffer_load_dwordx2 v[180:181], v13, s[8:11], s12 offen
  s_add_u32 s12, s12, 7168
  buffer_load_dwordx2 v[182:183], v13, s[8:11], s12 offen
  s_add_u32 s12, s12, 7168
  buffer_load_dwordx2 v[184:185], v13, s[8:11], s12 offen
  s_add_u32 s12, s12, 7168
  buffer_load_dwordx2 v[186:187], v13, s[8:11], s12 offen
  s_add_u32 s12, s12, 7168
  buffer_load_dwordx2 v[188:189], v13, s[8:11], s12 offen
  s_add_u32 s12, s12, 7168
  buffer_load_dwordx2 v[190:191], v13, s[8:11], s12 offen
  s_add_u32 s12, s12, 7168
  buffer_load_dwordx2 v[192:193], v13, s[8:11], s12 offen
  s_add_u32 s12, s12, 7168
  buffer_load_dwordx2 v[194:195], v13, s[8:11], s12 offen
  s_add_u32 s12, s12, 7168
  buffer_load_dwordx2 v[196:197], v13, s[8:11], s12 offen
  s_add_u32 s12, s12, 7168
  buffer_load_dwordx2 v[198:199], v13, s[8:11], s12 offen
  s_add_u32 s12, s12, 7168
  buffer_load_dwordx2 v[200:201], v13, s[8:11], s12 offen
  s_add_u32 s12, s12, 7168
  buffer_load_dwordx2 v[202:203], v13, s[8:11], s12 offen
  s_add_u32 s12, s12, 7168
  buffer_load_dwordx2 v[204:205], v13, s[8:11], s12 offen
  s_add_u32 s12, s12, 7168
  buffer_load_dwordx2 v[206:207], v13, s[8:11], s12 offen
  s_add_u32 s12, s12, 7168
  buffer_load_dwordx2 v[208:209], v13, s[8:11], s12 offen
  s_add_u32 s12, s12, 7168
  buffer_load_dwordx2 v[210:211], v13, s[8:11], s12 offen
  s_add_u32 s12, s12, 7168
  buffer_load_dwordx2 v[212:213], v13, s[8:11], s12 offen
  s_add_u32 s12, s12, 7168
  buffer_load_dwordx2 v[214:215], v13, s[8:11], s12 offen
  s_add_u32 s12, s12, 7168
  buffer_load_dwordx2 v[216:217], v13, s[8:11], s12 offen
  s_add_u32 s12, s12, 7168
  buffer_load_dwordx2 v[218:219], v13, s[8:11], s12 offen
  s_add_u32 s12, s12, 7168
  buffer_load_dwordx2 v[220:221], v13, s[8:11], s12 offen
  s_add_u32 s12, s12, 7168
  buffer_load_dwordx2 v[222:223], v13, s[8:11], s12 offen
  s_add_u32 s12, s12, 7168
  buffer_load_dwordx2 v[224:225], v13, s[8:11], s12 offen
  s_add_u32 s12, s12, 7168
  buffer_load_dwordx2 v[226:227], v13, s[8:11], s12 offen
  s_add_u32 s12, s12, 7168
  buffer_load_dwordx2 v[228:229], v13, s[8:11], s12 offen
  s_add_u32 s12, s12, 7168
  buffer_load_dwordx2 v[230:231], v13, s[8:11], s12 offen
  s_add_u32 s12, s12, 7168
  buffer_load_dwordx2 v[232:233], v13, s[8:11], s12 offen
  s_add_u32 s12, s12, 7168
  buffer_load_dwordx2 v[234:235], v13, s[8:11], s12 offen
  s_add_u32 s12, s12, 7168
  buffer_load_dwordx2 v[236:237], v13, s[8:11], s12 offen
  s_add_u32 s12, s12, 7168
  buffer_load_dwordx2 v[238:239], v13, s[8:11], s12 offen
  s_add_u32 s12, s12, 7168
  s_waitcnt vmcnt(60)
  s_branch .fz_kernel_c_b1
.fz_kernel_c_nl:
  s_waitcnt vmcnt(0)
.fz_kernel_c_b1:
  s_add_u32 s21, s74, 0x1800008
  s_sub_u32 s22, s72, 32768
  v_mov_b32 v9, s21
  v_mov_b32 v10, s22
  v_cmp_gt_u32 vcc, 16, v2
  s_nop 1
  v_cndmask_b32 v9, v10, v9, vcc
  v_lshl_add_u32 v9, v2, 11, v9
  s_lshl_b32 s21, s17, 7
  s_lshl_b32 s22, 1, s18
  v_mov_b32 v10, s22
  s_and_b32 s20, s16, 1
  s_barrier
  s_cbranch_scc0 .fz_kernel_c_nf
  s_mov_b64 exec, 0xffffff
  buffer_atomic_or v10, v9, s[4:7], s21 offen sc1
  s_mov_b64 exec, -1
.fz_kernel_c_nf:
  s_mov_b32 s34, 0x00010001
  s_mov_b32 s35, 0x00010001
  s_mov_b32 s36, 0x05040100
  s_mov_b32 s37, 0x07060302
  v_lshlrev_b32 v19, 3, v11
  v_lshrrev_b32 v8, 4, v2
  v_lshrrev_b32 v12, 3, v2
  v_lshlrev_b32 v14, 12, v8
  v_lshlrev_b32 v15, 9, v12
  v_lshlrev_b32 v16, 3, v2
  v_lshlrev_b32 v10, 7, v2
  v_mov_b32 v28, 0.0009765625
  v_mov_b32 v29, 9.5367431640625e-07
  v_mov_b32 v30, 1e-05
  s_and_b32 s21, s2, 7
  s_lshl_b32 s21, s21, 11
  s_lshl_b32 s22, s20, 10
  s_add_u32 s21, s21, s22
  s_add_u32 s21, s21, s72
  s_lshl_b32 s22, s20, 12
  s_add_u32 s22, s22, s72
  s_add_u32 s22, s22, 16384
  s_add_u32 s23, s22, 8192
  s_add_u32 s24, s22, 16384
  s_cmp_ge_u32 s17, 14
  s_cbranch_scc1 .fz_kernel_c_np
  buffer_load_dwordx2 v[240:241], v13, s[8:11], s12 offen
  s_add_u32 s12, s12, 7168
  buffer_load_dwordx2 v[242:243], v13, s[8:11], s12 offen
  s_add_u32 s12, s12, 7168
  buffer_load_dwordx2 v[244:245], v13, s[8:11], s12 offen
  s_add_u32 s12, s12, 7168
  buffer_load_dwordx2 v[246:247], v13, s[8:11], s12 offen
  s_add_u32 s12, s12, 7168
  v_mov_b32 v88, 0x3f803f80
  v_mov_b32 v89, 0x3f803f80
  v_mov_b32 v90, 0x3f803f80
  v_mov_b32 v91, 0x3f803f80
  v_mov_b32 v92, 0x3f803f80
  v_mov_b32 v93, 0x3f803f80
  v_mov_b32 v94, 0x3f803f80
  v_mov_b32 v95, 0x3f803f80
  v_mov_b32 v96, 0x3f803f80
  v_mov_b32 v97, 0x3f803f80
  v_mov_b32 v98, 0x3f803f80
  v_mov_b32 v99, 0x3f803f80
  v_mov_b32 v100, 0x3f803f80
  v_mov_b32 v101, 0x3f803f80
  v_mov_b32 v102, 0x3f803f80
  v_mov_b32 v103, 0x3f803f80
  s_waitcnt vmcnt(56)
  v_perm_b32 v104, v122, v120, s36
  v_perm_b32 v108, v122, v120, s37
  v_perm_b32 v112, v123, v121, s36
  v_perm_b32 v116, v123, v121, s37
  v_perm_b32 v105, v126, v124, s36
  v_perm_b32 v109, v126, v124, s37
  v_perm_b32 v113, v127, v125, s36
  v_perm_b32 v117, v127, v125, s37
  v_perm_b32 v106, v130, v128, s36
  v_perm_b32 v110, v130, v128, s37
  v_perm_b32 v114, v131, v129, s36
  v_perm_b32 v118, v131, v129, s37
  v_perm_b32 v107, v134, v132, s36
  v_perm_b32 v111, v134, v132, s37
  v_perm_b32 v115, v135, v133, s36
  v_perm_b32 v119, v135, v133, s37
  s_waitcnt vmcnt(48)
  v_perm_b32 v120, v138, v136, s36
  v_perm_b32 v124, v138, v136, s37
  v_perm_b32 v128, v139, v137, s36
  v_perm_b32 v132, v139, v137, s37
  v_perm_b32 v121, v142, v140, s36
  v_perm_b32 v125, v142, v140, s37
  v_perm_b32 v129, v143, v141, s36
  v_perm_b32 v133, v143, v141, s37
  v_perm_b32 v122, v146, v144, s36
  v_perm_b32 v126, v146, v144, s37
  v_perm_b32 v130, v147, v145, s36
  v_perm_b32 v134, v147, v145, s37
  v_perm_b32 v123, v150, v148, s36
  v_perm_b32 v127, v150, v148, s37
  v_perm_b32 v131, v151, v149, s36
  v_perm_b32 v135, v151, v149, s37
  s_waitcnt vmcnt(40)
  v_perm_b32 v136, v154, v152, s36
  v_perm_b32 v140, v154, v152, s37
  v_perm_b32 v144, v155, v153, s36
  v_perm_b32 v148, v155, v153, s37
  v_perm_b32 v137, v158, v156, s36
  v_perm_b32 v141, v158, v156, s37
  v_perm_b32 v145, v159, v157, s36
  v_perm_b32 v149, v159, v157, s37
  v_perm_b32 v138, v162, v160, s36
  v_perm_b32 v142, v162, v160, s37
  v_perm_b32 v146, v163, v161, s36
  v_perm_b32 v150, v163, v161, s37
  v_perm_b32 v139, v166, v164, s36
  v_perm_b32 v143, v166, v164, s37
  v_perm_b32 v147, v167, v165, s36
  v_perm_b32 v151, v167, v165, s37
  s_waitcnt vmcnt(32)
  v_perm_b32 v152, v170, v168, s36
  v_perm_b32 v156, v170, v168, s37
  v_perm_b32 v160, v171, v169, s36
  v_perm_b32 v164, v171, v169, s37
  v_perm_b32 v153, v174, v172, s36
  v_perm_b32 v157, v174, v172, s37
  v_perm_b32 v161, v175, v173, s36
  v_perm_b32 v165, v175, v173, s37
  v_perm_b32 v154, v178, v176, s36
  v_perm_b32 v158, v178, v176, s37
  v_perm_b32 v162, v179, v177, s36
  v_perm_b32 v166, v179, v177, s37
  v_perm_b32 v155, v182, v180, s36
  v_perm_b32 v159, v182, v180, s37
  v_perm_b32 v163, v183, v181, s36
  v_perm_b32 v167, v183, v181, s37
  s_waitcnt vmcnt(24)
  v_perm_b32 v168, v186, v184, s36
  v_perm_b32 v172, v186, v184, s37
  v_perm_b32 v176, v187, v185, s36
  v_perm_b32 v180, v187, v185, s37
  v_perm_b32 v169, v190, v188, s36
  v_perm_b32 v173, v190, v188, s37
  v_perm_b32 v177, v191, v189, s36
  v_perm_b32 v181, v191, v189, s37
  v_perm_b32 v170, v194, v192, s36
  v_perm_b32 v174, v194, v192, s37
  v_perm_b32 v178, v195, v193, s36
  v_perm_b32 v182, v195, v193, s37
  v_perm_b32 v171, v198, v196, s36
  v_perm_b32 v175, v198, v196, s37
  v_perm_b32 v179, v199, v197, s36
  v_perm_b32 v183, v199, v197, s37
  s_waitcnt vmcnt(16)
  v_perm_b32 v184, v202, v200, s36
  v_perm_b32 v188, v202, v200, s37
  v_perm_b32 v192, v203, v201, s36
  v_perm_b32 v196, v203, v201, s37
  v_perm_b32 v185, v206, v204, s36
  v_perm_b32 v189, v206, v204, s37
  v_perm_b32 v193, v207, v205, s36
  v_perm_b32 v197, v207, v205, s37
  v_perm_b32 v186, v210, v208, s36
  v_perm_b32 v190, v210, v208, s37
  v_perm_b32 v194, v211, v209, s36
  v_perm_b32 v198, v211, v209, s37
  v_perm_b32 v187, v214, v212, s36
  v_perm_b32 v191, v214, v212, s37
  v_perm_b32 v195, v215, v213, s36
  v_perm_b32 v199, v215, v213, s37
  s_waitcnt vmcnt(8)
  v_perm_b32 v200, v218, v216, s36
  v_perm_b32 v204, v218, v216, s37
  v_perm_b32 v208, v219, v217, s36
  v_perm_b32 v212, v219, v217, s37
  v_perm_b32 v201, v222, v220, s36
  v_perm_b32 v205, v222, v220, s37
  v_perm_b32 v209, v223, v221, s36
  v_perm_b32 v213, v223, v221, s37
  v_perm_b32 v202, v226, v224, s36
  v_perm_b32 v206, v226, v224, s37
  v_perm_b32 v210, v227, v225, s36
  v_perm_b32 v214, v227, v225, s37
  v_perm_b32 v203, v230, v228, s36
  v_perm_b32 v207, v230, v228, s37
  v_perm_b32 v211, v231, v229, s36
  v_perm_b32 v215, v231, v229, s37
  s_waitcnt vmcnt(0)
  v_perm_b32 v216, v234, v232, s36
  v_perm_b32 v220, v234, v232, s37
  v_perm_b32 v224, v235, v233, s36
  v_perm_b32 v228, v235, v233, s37
  v_perm_b32 v217, v238, v236, s36
  v_perm_b32 v221, v238, v236, s37
  v_perm_b32 v225, v239, v237, s36
  v_perm_b32 v229, v239, v237, s37
  v_perm_b32 v218, v242, v240, s36
  v_perm_b32 v222, v242, v240, s37
  v_perm_b32 v226, v243, v241, s36
  v_perm_b32 v230, v243, v241, s37
  v_perm_b32 v219, v246, v244, s36
  v_perm_b32 v223, v246, v244, s37
  v_perm_b32 v227, v247, v245, s36
  v_perm_b32 v231, v247, v245, s37
  v_mov_b32 v232, v88
  v_mov_b32 v233, v88
  v_mov_b32 v234, v88
  v_mov_b32 v235, v88
  v_mov_b32 v236, v88
  v_mov_b32 v237, v88
  v_mov_b32 v238, v88
  v_mov_b32 v239, v88
  v_mov_b32 v240, v88
  v_mov_b32 v241, v88
  v_mov_b32 v242, v88
  v_mov_b32 v243, v88
  v_mov_b32 v244, v88
  v_mov_b32 v245, v88
  v_mov_b32 v246, v88
  v_mov_b32 v247, v88
.fz_kernel_c_np:
  s_mov_b64 exec, 0xff
  s_mov_b32 s38, 0
.fz_kernel_c_gm:
  buffer_load_dword v9, v10, s[4:7], s21 offen sc1
  s_add_u32 s38, s38, 1
  s_waitcnt vmcnt(0)
  v_cmp_ne_u32 vcc, 0xffff, v9
  s_cbranch_vccz .fz_kernel_c_gmd
  s_cmp_lt_u32 s38, 131072
  s_cbranch_scc1 .fz_kernel_c_gm
.fz_kernel_c_gmd:
  s_mov_b64 exec, -1
  buffer_load_dwordx4 v[32:35], v3, s[4:7], s22 offen offset:0
  buffer_load_dwordx4 v[36:39], v3, s[4:7], s23 offen offset:0
  buffer_load_dwordx4 v[40:43], v3, s[4:7], s24 offen offset:0
  buffer_load_dwordx4 v[44:47], v3, s[4:7], s22 offen offset:1024
  buffer_load_dwordx4 v[48:51], v3, s[4:7], s23 offen offset:1024
  buffer_load_dwordx4 v[52:55], v3, s[4:7], s24 offen offset:1024
  buffer_load_dwordx4 v[56:59], v3, s[4:7], s22 offen offset:2048
  buffer_load_dwordx4 v[60:63], v3, s[4:7], s23 offen offset:2048
  buffer_load_dwordx4 v[64:67], v3, s[4:7], s24 offen offset:2048
  buffer_load_dwordx4 v[68:71], v3, s[4:7], s22 offen offset:3072
  buffer_load_dwordx4 v[72:75], v3, s[4:7], s23 offen offset:3072
  buffer_load_dwordx4 v[76:79], v3, s[4:7], s24 offen offset:3072
  s_lshl_b32 s21, s75, 4
  s_add_u32 s21, s21, 159968
  v_mov_b32 v10, s21
  s_lshl_b32 s22, s20, 3
  v_add_u32 v13, s22, v10
  s_waitcnt vmcnt(10)
  v_fma_f32 v36, -v32, v32, v36
  v_fma_f32 v37, -v33, v33, v37
  v_fma_f32 v38, -v34, v34, v38
  v_fma_f32 v39, -v35, v35, v39
  v_rsq_f32 v36, abs(v36)
  v_rsq_f32 v37, abs(v37)
  v_rsq_f32 v38, abs(v38)
  v_rsq_f32 v39, abs(v39)
  s_waitcnt vmcnt(9)
  v_mul_f32 v40, v40, v36
  v_mul_f32 v41, v41, v37
  v_mul_f32 v42, v42, v38
  v_mul_f32 v43, v43, v39
  v_and_or_b32 v40, v40, -16, 0
  v_and_or_b32 v41, v41, -16, 1
  v_and_or_b32 v42, v42, -16, 2
  v_and_or_b32 v43, v43, -16, 3
  v_max3_f32 v9, v40, v41, v42
  v_max_f32 v9, v9, v43
  s_waitcnt vmcnt(7)
  v_fma_f32 v48, -v44, v44, v48
  v_fma_f32 v49, -v45, v45, v49
  v_fma_f32 v50, -v46, v46, v50
  v_fma_f32 v51, -v47, v47, v51
  v_rsq_f32 v48, abs(v48)
  v_rsq_f32 v49, abs(v49)
  v_rsq_f32 v50, abs(v50)
  v_rsq_f32 v51, abs(v51)
  s_waitcnt vmcnt(6)
  v_mul_f32 v52, v52, v48
  v_mul_f32 v53, v53, v49
  v_mul_f32 v54, v54, v50
  v_mul_f32 v55, v55, v51
  v_and_or_b32 v52, v52, -16, 4
  v_and_or_b32 v53, v53, -16, 5
  v_and_or_b32 v54, v54, -16, 6
  v_and_or_b32 v55, v55, -16, 7
  v_max3_f32 v9, v9, v52, v53
  v_max3_f32 v9, v9, v54, v55
  s_waitcnt vmcnt(4)
  v_fma_f32 v60, -v56, v56, v60
  v_fma_f32 v61, -v57, v57, v61
  v_fma_f32 v62, -v58, v58, v62
  v_fma_f32 v63, -v59, v59, v63
  v_rsq_f32 v60, abs(v60)
  v_rsq_f32 v61, abs(v61)
  v_rsq_f32 v62, abs(v62)
  v_rsq_f32 v63, abs(v63)
  s_waitcnt vmcnt(3)
  v_mul_f32 v64, v64, v60
  v_mul_f32 v65, v65, v61
  v_mul_f32 v66, v66, v62
  v_mul_f32 v67, v67, v63
  v_and_or_b32 v64, v64, -16, 8
  v_and_or_b32 v65, v65, -16, 9
  v_and_or_b32 v66, v66, -16, 10
  v_and_or_b32 v67, v67, -16, 11
  v_max3_f32 v9, v9, v64, v65
  v_max3_f32 v9, v9, v66, v67
  s_waitcnt vmcnt(1)
  v_fma_f32 v72, -v68, v68, v72
  v_fma_f32 v73, -v69, v69, v73
  v_fma_f32 v74, -v70, v70, v74
  v_fma_f32 v75, -v71, v71, v75
  v_rsq_f32 v72, abs(v72)
  v_rsq_f32 v73, abs(v73)
  v_rsq_f32 v74, abs(v74)
  v_rsq_f32 v75, abs(v75)
  s_waitcnt vmcnt(0)
  v_mul_f32 v76, v76, v72
  v_mul_f32 v77, v77, v73
  v_mul_f32 v78, v78, v74
  v_mul_f32 v79, v79, v75
  v_and_or_b32 v76, v76, -16, 12
  v_and_or_b32 v77, v77, -16, 13
  v_and_or_b32 v78, v78, -16, 14
  v_and_or_b32 v79, v79, -16, 15
  v_max3_f32 v9, v9, v76, v77
  v_max3_f32 v9, v9, v78, v79
  s_nop 1
  v_max_f32 v7, v9, v9 row_ror:8 row_mask:0xf bank_mask:0xf
  s_nop 1
  v_max_f32 v7, v7, v7 row_ror:4 row_mask:0xf bank_mask:0xf
  s_nop 1
  v_max_f32 v7, v7, v7 row_ror:2 row_mask:0xf bank_mask:0xf
  s_nop 1
  v_max_f32 v7, v7, v7 row_ror:1 row_mask:0xf bank_mask:0xf
  s_nop 1
  v_max_f32 v7, v7, v7 row_bcast:15 row_mask:0xa bank_mask:0xf
  s_nop 1
  v_max_f32 v7, v7, v7 row_bcast:31 row_mask:0xc bank_mask:0xf
  s_nop 0
  v_readlane_b32 s21, v7, 63
  s_nop 1
  v_cmp_eq_u32 vcc, s21, v9
  s_ff1_i32_b64 s22, vcc
  s_lshl_b32 s22, s22, 2
  s_and_b32 s23, s21, 3
  s_add_u32 s22, s22, s23
  s_and_b32 s23, s21, 12
  s_lshl_b32 s23, s23, 6
  s_add_u32 s22, s22, s23
  s_and_b32 s22, s22, 1023
  s_lshl_b32 s23, s20, 10
  s_add_u32 s22, s22, s23
  s_add_u32 s22, s22, 1
  v_mov_b32 v48, s21
  v_mov_b32 v49, s22
  s_mov_b64 exec, 1
  ds_write_b64 v13, v[48:49]
  s_mov_b32 s38, 0
.fz_kernel_c_am:
  ds_read_b128 v[48:51], v10
  s_add_u32 s38, s38, 1
  s_waitcnt lgkmcnt(0)
  v_min_u32 v9, v49, v51
  v_cmp_eq_u32 vcc, 0, v9
  s_cbranch_vccz .fz_kernel_c_amd
  s_cmp_lt_u32 s38, 524288
  s_cbranch_scc1 .fz_kernel_c_am
.fz_kernel_c_amd:
  v_cmp_gt_f32 vcc, v50, v48
  s_nop 1
  v_cndmask_b32 v49, v49, v51, vcc
  v_cndmask_b32 v48, v48, v50, vcc
  v_readfirstlane_b32 s77, v49
  v_readfirstlane_b32 s27, v48
  s_mov_b64 exec, s[34:35]
  s_sub_u32 s77, s77, 1
  s_and_b32 s77, s77, 2047
  s_lshr_b32 s78, s77, 5
  s_lshl_b32 s78, s78, 16
  s_and_b32 s21, s77, 31
  s_lshl_b32 s21, s21, 4
  s_add_u32 s78, s78, s21
  s_add_u32 s78, s78, s73
  s_and_b32 s25, s18, 2
  s_add_u32 s25, s25, s20
  s_lshl_b32 s21, s25, 14
  s_add_u32 s21, s21, s78
  buffer_load_dwordx4 v[88:91], v14, s[4:7], s21 offen offset:0
  buffer_load_dwordx4 v[92:95], v14, s[4:7], s21 offen offset:512
  buffer_load_dwordx4 v[96:99], v14, s[4:7], s21 offen offset:1024
  buffer_load_dwordx4 v[100:103], v14, s[4:7], s21 offen offset:1536
  buffer_load_dwordx4 v[232:235], v14, s[4:7], s21 offen offset:2048
  buffer_load_dwordx4 v[236:239], v14, s[4:7], s21 offen offset:2560
  buffer_load_dwordx4 v[240:243], v14, s[4:7], s21 offen offset:3072
  buffer_load_dwordx4 v[244:247], v14, s[4:7], s21 offen offset:3584
  s_mov_b64 exec, -1
  s_lshl_b32 s21, s77, 2
  s_add_u32 s21, s21, s72
  s_add_u32 s21, s21, 16384
  s_add_u32 s22, s21, 8192
  buffer_load_dword v68, v4, s[4:7], s21 offen
  buffer_load_dword v70, v4, s[4:7], s22 offen
  s_lshl_b32 s21, s18, 12
  s_add_u32 s21, s21, s78
  buffer_load_dwordx4 v[64:67], v15, s[4:7], s21 offen
  s_lshl_b32 s21, s17, 9
  s_add_u32 s21, s21, s72
  s_add_u32 s21, s21, 16384
  s_add_u32 s22, s21, 8192
  buffer_load_dwordx2 v[72:73], v16, s[4:7], s21 offen
  buffer_load_dwordx2 v[74:75], v16, s[4:7], s22 offen
  s_lshr_b32 s21, s77, 7
  s_and_b32 s79, s77, 127
  s_add_u32 s79, s79, 1
  s_cmp_eq_u32 s21, s17
  s_cselect_b32 s79, s79, 0
  s_and_b32 s21, s18, 1
  s_lshl_b32 s21, s21, 2
  s_add_u32 s21, s21, s25
  s_lshl_b32 s21, s21, 9
  s_lshl_b32 s22, s17, 13
  s_add_u32 s21, s21, s22
  s_and_b32 s22, s18, 8
  s_lshl_b32 s22, s22, 9
  s_add_u32 s21, s21, s22
  s_and_b32 s22, s18, 4
  s_lshl_b32 s22, s22, 6
  s_add_u32 s21, s21, s22
  s_add_u32 s21, s21, s72
  s_add_u32 s21, s21, 40960
  s_lshl_b32 s26, s17, 1
  s_add_u32 s26, s26, s20
  v_mov_b32 v80, -1477.3197218702985
  v_mul_f32 v80, s27, v80
  v_exp_f32 v80, v80
  v_lshl_add_u32 v13, v8, 16, v19
  v_add_f32 v80, 1.0, v80
  v_rcp_f32 v80, v80
  s_cmp_ge_u32 s17, 14
  s_cbranch_scc1 .fz_kernel_c_ng
  s_mov_b32 s8, s54
  s_mov_b32 s9, s55
  s_mov_b32 s10, 0x700000
  s_mov_b32 s11, 0x00020000
  s_lshl_b32 s23, s26, 18
  s_lshl_b32 s22, s18, 7
  s_add_u32 s22, s23, s22
  s_waitcnt vmcnt(12)
  v_mfma_f32_16x16x32_bf16 v[32:35], v[88:91], v[104:107], 0
  v_mfma_f32_16x16x32_bf16 v[36:39], v[88:91], v[108:111], 0
  v_mfma_f32_16x16x32_bf16 v[40:43], v[88:91], v[112:115], 0
  v_mfma_f32_16x16x32_bf16 v[44:47], v[88:91], v[116:119], 0
  s_waitcnt vmcnt(11)
  v_mfma_f32_16x16x32_bf16 v[32:35], v[92:95], v[120:123], v[32:35]
  v_mfma_f32_16x16x32_bf16 v[36:39], v[92:95], v[124:127], v[36:39]
  v_mfma_f32_16x16x32_bf16 v[40:43], v[92:95], v[128:131], v[40:43]
  v_mfma_f32_16x16x32_bf16 v[44:47], v[92:95], v[132:135], v[44:47]
  s_waitcnt vmcnt(10)
  v_mfma_f32_16x16x32_bf16 v[32:35], v[96:99], v[136:139], v[32:35]
  v_mfma_f32_16x16x32_bf16 v[36:39], v[96:99], v[140:143], v[36:39]
  v_mfma_f32_16x16x32_bf16 v[40:43], v[96:99], v[144:147], v[40:43]
  v_mfma_f32_16x16x32_bf16 v[44:47], v[96:99], v[148:151], v[44:47]
  buffer_load_dwordx2 v[120:121], v13, s[8:11], s22 offen offset:0
  buffer_load_dwordx2 v[122:123], v13, s[8:11], s22 offen offset:2048
  s_add_u32 s22, s22, 4096
  buffer_load_dwordx2 v[124:125], v13, s[8:11], s22 offen offset:0
  buffer_load_dwordx2 v[126:127], v13, s[8:11], s22 offen offset:2048
  s_add_u32 s22, s22, 4096
  buffer_load_dwordx2 v[128:129], v13, s[8:11], s22 offen offset:0
  buffer_load_dwordx2 v[130:131], v13, s[8:11], s22 offen offset:2048
  s_add_u32 s22, s22, 4096
  buffer_load_dwordx2 v[132:133], v13, s[8:11], s22 offen offset:0
  buffer_load_dwordx2 v[134:135], v13, s[8:11], s22 offen offset:2048
  s_add_u32 s22, s22, 4096
  s_waitcnt vmcnt(17)
  v_mfma_f32_16x16x32_bf16 v[32:35], v[100:103], v[152:155], v[32:35]
  v_mfma_f32_16x16x32_bf16 v[36:39], v[100:103], v[156:159], v[36:39]
  v_mfma_f32_16x16x32_bf16 v[40:43], v[100:103], v[160:163], v[40:43]
  v_mfma_f32_16x16x32_bf16 v[44:47], v[100:103], v[164:167], v[44:47]
  buffer_load_dwordx2 v[136:137], v13, s[8:11], s22 offen offset:0
  buffer_load_dwordx2 v[138:139], v13, s[8:11], s22 offen offset:2048
  s_add_u32 s22, s22, 4096
  buffer_load_dwordx2 v[140:141], v13, s[8:11], s22 offen offset:0
  buffer_load_dwordx2 v[142:143], v13, s[8:11], s22 offen offset:2048
  s_add_u32 s22, s22, 4096
  buffer_load_dwordx2 v[144:145], v13, s[8:11], s22 offen offset:0
  buffer_load_dwordx2 v[146:147], v13, s[8:11], s22 offen offset:2048
  s_add_u32 s22, s22, 4096
  buffer_load_dwordx2 v[148:149], v13, s[8:11], s22 offen offset:0
  buffer_load_dwordx2 v[150:151], v13, s[8:11], s22 offen offset:2048
  s_add_u32 s22, s22, 4096
  s_waitcnt vmcnt(24)
  v_mfma_f32_16x16x32_bf16 v[32:35], v[232:235], v[168:171], v[32:35]
  v_mfma_f32_16x16x32_bf16 v[36:39], v[232:235], v[172:175], v[36:39]
  v_mfma_f32_16x16x32_bf16 v[40:43], v[232:235], v[176:179], v[40:43]
  v_mfma_f32_16x16x32_bf16 v[44:47], v[232:235], v[180:183], v[44:47]
  buffer_load_dwordx2 v[152:153], v13, s[8:11], s22 offen offset:0
  buffer_load_dwordx2 v[154:155], v13, s[8:11], s22 offen offset:2048
  s_add_u32 s22, s22, 4096
  buffer_load_dwordx2 v[156:157], v13, s[8:11], s22 offen offset:0
  buffer_load_dwordx2 v[158:159], v13, s[8:11], s22 offen offset:2048
  s_add_u32 s22, s22, 4096
  buffer_load_dwordx2 v[160:161], v13, s[8:11], s22 offen offset:0
  buffer_load_dwordx2 v[162:163], v13, s[8:11], s22 offen offset:2048
  s_add_u32 s22, s22, 4096
  buffer_load_dwordx2 v[164:165], v13, s[8:11], s22 offen offset:0
  buffer_load_dwordx2 v[166:167], v13, s[8:11], s22 offen offset:2048
  s_add_u32 s22, s22, 4096
  s_waitcnt vmcnt(31)
  v_mfma_f32_16x16x32_bf16 v[32:35], v[236:239], v[184:187], v[32:35]
  v_mfma_f32_16x16x32_bf16 v[36:39], v[236:239], v[188:191], v[36:39]
  v_mfma_f32_16x16x32_bf16 v[40:43], v[236:239], v[192:195], v[40:43]
  v_mfma_f32_16x16x32_bf16 v[44:47], v[236:239], v[196:199], v[44:47]
  buffer_load_dwordx2 v[168:169], v13, s[8:11], s22 offen offset:0
  buffer_load_dwordx2 v[170:171], v13, s[8:11], s22 offen offset:2048
  s_add_u32 s22, s22, 4096
  buffer_load_dwordx2 v[172:173], v13, s[8:11], s22 offen offset:0
  buffer_load_dwordx2 v[174:175], v13, s[8:11], s22 offen offset:2048
  s_add_u32 s22, s22, 4096
  buffer_load_dwordx2 v[176:177], v13, s[8:11], s22 offen offset:0
  buffer_load_dwordx2 v[178:179], v13, s[8:11], s22 offen offset:2048
  s_add_u32 s22, s22, 4096
  buffer_load_dwordx2 v[180:181], v13, s[8:11], s22 offen offset:0
  buffer_load_dwordx2 v[182:183], v13, s[8:11], s22 offen offset:2048
  s_add_u32 s22, s22, 4096
  s_waitcnt vmcnt(38)
  v_mfma_f32_16x16x32_bf16 v[32:35], v[240:243], v[200:203], v[32:35]
  v_mfma_f32_16x16x32_bf16 v[36:39], v[240:243], v[204:207], v[36:39]
  v_mfma_f32_16x16x32_bf16 v[40:43], v[240:243], v[208:211], v[40:43]
  v_mfma_f32_16x16x32_bf16 v[44:47], v[240:243], v[212:215], v[44:47]
  s_waitcnt vmcnt(37)
  v_mfma_f32_16x16x32_bf16 v[32:35], v[244:247], v[216:219], v[32:35]
  v_mfma_f32_16x16x32_bf16 v[36:39], v[244:247], v[220:223], v[36:39]
  v_mfma_f32_16x16x32_bf16 v[40:43], v[244:247], v[224:227], v[40:43]
  v_mfma_f32_16x16x32_bf16 v[44:47], v[244:247], v[228:231], v[44:47]
  s_waitcnt vmcnt(36)
  v_mul_f32 v69, v28, v68
  s_nop 2
  v_fma_f32 v48, -v69, v33, v32
  v_fma_f32 v49, -v69, v37, v36
  v_or_b32 v48, 1, v48
  v_fma_f32 v50, -v69, v41, v40
  v_fma_f32 v51, -v69, v45, v44
  v_or_b32 v50, 1, v50
  s_mov_b64 exec, 0xffff
  buffer_store_dwordx4 v[48:51], v3, s[4:7], s21 offen offset:0 sc1
  s_mov_b64 exec, -1
  s_waitcnt vmcnt(33)
  s_branch .fz_kernel_c_g1
.fz_kernel_c_ng:
  s_waitcnt vmcnt(0)
  v_mul_f32 v69, v28, v68
.fz_kernel_c_g1:
  s_cmp_lg_u32 s75, 0
  s_cbranch_scc1 .fz_kernel_c_g2
  s_mov_b32 s12, s42
  s_mov_b32 s13, s43
  s_mov_b32 s14, 0x600000
  s_mov_b32 s15, 0x00020000
  v_mul_u32_u24 v10, 98304, v8
  v_add_u32 v10, v10, v19
  s_mul_i32 s21, s18, 393216
  s_lshl_b32 s22, s17, 7
  s_add_u32 s21, s21, s22
  s_lshl_b32 s22, s20, 12
  s_add_u32 s21, s21, s22
  buffer_load_dwordx2 v[184:185], v10, s[12:15], s21 offen
  s_add_u32 s21, s21, 6144
  buffer_load_dwordx2 v[186:187], v10, s[12:15], s21 offen
  s_add_u32 s21, s21, 6144
  buffer_load_dwordx2 v[188:189], v10, s[12:15], s21 offen
  s_add_u32 s21, s21, 6144
  buffer_load_dwordx2 v[190:191], v10, s[12:15], s21 offen
  s_add_u32 s21, s21, 6144
  buffer_load_dwordx2 v[192:193], v10, s[12:15], s21 offen
  s_add_u32 s21, s21, 6144
  buffer_load_dwordx2 v[194:195], v10, s[12:15], s21 offen
  s_add_u32 s21, s21, 6144
  buffer_load_dwordx2 v[196:197], v10, s[12:15], s21 offen
  s_add_u32 s21, s21, 6144
  buffer_load_dwordx2 v[198:199], v10, s[12:15], s21 offen
  s_add_u32 s21, s21, 6144
  buffer_load_dwordx2 v[200:201], v10, s[12:15], s21 offen
  s_add_u32 s21, s21, 6144
  buffer_load_dwordx2 v[202:203], v10, s[12:15], s21 offen
  s_add_u32 s21, s21, 6144
  buffer_load_dwordx2 v[204:205], v10, s[12:15], s21 offen
  s_add_u32 s21, s21, 6144
  buffer_load_dwordx2 v[206:207], v10, s[12:15], s21 offen
  s_add_u32 s21, s21, 6144
  buffer_load_dwordx2 v[208:209], v10, s[12:15], s21 offen
  s_add_u32 s21, s21, 6144
  buffer_load_dwordx2 v[210:211], v10, s[12:15], s21 offen
  s_add_u32 s21, s21, 6144
  buffer_load_dwordx2 v[212:213], v10, s[12:15], s21 offen
  s_add_u32 s21, s21, 6144
  buffer_load_dwordx2 v[214:215], v10, s[12:15], s21 offen
  s_add_u32 s21, s21, 6144
  s_waitcnt vmcnt(17)
  s_cmp_lg_u32 s20, 0
  s_cbranch_scc1 .fz_kernel_c_g2
  s_sub_u32 s21, s21, 98304
  buffer_load_dwordx2 v[216:217], v10, s[12:15], s21 offen offset:2048
  s_add_u32 s21, s21, 6144
  buffer_load_dwordx2 v[218:219], v10, s[12:15], s21 offen offset:2048
  s_add_u32 s21, s21, 6144
  buffer_load_dwordx2 v[220:221], v10, s[12:15], s21 offen offset:2048
  s_add_u32 s21, s21, 6144
  buffer_load_dwordx2 v[222:223], v10, s[12:15], s21 offen offset:2048
  s_add_u32 s21, s21, 6144
  buffer_load_dwordx2 v[224:225], v10, s[12:15], s21 offen offset:2048
  s_add_u32 s21, s21, 6144
  buffer_load_dwordx2 v[226:227], v10, s[12:15], s21 offen offset:2048
  s_add_u32 s21, s21, 6144
  buffer_load_dwordx2 v[228:229], v10, s[12:15], s21 offen offset:2048
  s_add_u32 s21, s21, 6144
  buffer_load_dwordx2 v[230:231], v10, s[12:15], s21 offen offset:2048
  s_add_u32 s21, s21, 6144
  buffer_load_dwordx2 v[232:233], v10, s[12:15], s21 offen offset:2048
  s_add_u32 s21, s21, 6144
  buffer_load_dwordx2 v[234:235], v10, s[12:15], s21 offen offset:2048
  s_add_u32 s21, s21, 6144
  buffer_load_dwordx2 v[236:237], v10, s[12:15], s21 offen offset:2048
  s_add_u32 s21, s21, 6144
  buffer_load_dwordx2 v[238:239], v10, s[12:15], s21 offen offset:2048
  s_add_u32 s21, s21, 6144
  buffer_load_dwordx2 v[240:241], v10, s[12:15], s21 offen offset:2048
  s_add_u32 s21, s21, 6144
  buffer_load_dwordx2 v[242:243], v10, s[12:15], s21 offen offset:2048
  s_add_u32 s21, s21, 6144
  buffer_load_dwordx2 v[244:245], v10, s[12:15], s21 offen offset:2048
  s_add_u32 s21, s21, 6144
  buffer_load_dwordx2 v[246:247], v10, s[12:15], s21 offen offset:2048
  s_add_u32 s21, s21, 6144
.fz_kernel_c_g2:
  v_fma_f32 v70, -v68, v68, v70
  v_rsq_f32 v70, abs(v70)
  v_fma_f32 v74, -v72, v72, v74
  v_fma_f32 v75, -v73, v73, v75
  v_mul_f32 v70, 0x44800000, v70
  v_rsq_f32 v76, abs(v74)
  v_rsq_f32 v77, abs(v75)
  v_add_f32 v82, 1.0, v70
  v_mul_f32 v83, v69, v70
  v_sub_f32 v83, 0, v83
  v_mul_f32 v81, -1.4426950408889634, v70
  v_mul_f32 v70, v70, v70
  v_mul_f32 v80, v80, v70
  v_lshlrev_b32 v88, 16, v64
  v_and_b32 v89, 0xffff0000, v64
  v_lshlrev_b32 v90, 16, v65
  v_and_b32 v91, 0xffff0000, v65
  v_lshlrev_b32 v92, 16, v66
  v_and_b32 v93, 0xffff0000, v66
  v_lshlrev_b32 v94, 16, v67
  v_and_b32 v95, 0xffff0000, v67
  v_fma_f32 v88, v88, v82, v83
  v_fma_f32 v89, v89, v82, v83
  v_fma_f32 v90, v90, v82, v83
  v_fma_f32 v91, v91, v82, v83
  v_fma_f32 v92, v92, v82, v83
  v_fma_f32 v93, v93, v82, v83
  v_fma_f32 v94, v94, v82, v83
  v_fma_f32 v95, v95, v82, v83
  v_mul_f32 v102, v72, v76
  v_sub_f32 v102, 0, v102
  v_mov_b32 v100, 1.0
  v_fmac_f32 v100, 0x44800000, v76
  v_fma_f32 v74, v74, v29, -v30
  v_max_f32 v74, 0, v74
  v_mul_f32 v96, v100, v100
  v_fma_f32 v96, v96, v74, v30
  v_rsq_f32 v96, v96
  v_mul_f32 v72, v28, v72
  v_mul_f32 v96, v96, v100
  v_mul_f32 v98, v96, v72
  v_sub_f32 v98, 0, v98
  v_mul_f32 v103, v73, v77
  v_sub_f32 v103, 0, v103
  v_mov_b32 v101, 1.0
  v_fmac_f32 v101, 0x44800000, v77
  v_fma_f32 v75, v75, v29, -v30
  v_max_f32 v75, 0, v75
  v_mul_f32 v97, v101, v101
  v_fma_f32 v97, v97, v75, v30
  v_rsq_f32 v97, v97
  v_mul_f32 v73, v28, v73
  v_mul_f32 v97, v97, v101
  v_mul_f32 v99, v97, v73
  v_sub_f32 v99, 0, v99
  v_mov_b32 v9, 159952
  v_mov_b32 v7, s79
  v_add_u32 v78, 155648, v16
  s_cmp_eq_u32 s75, 0
  s_cbranch_scc1 .fz_kernel_c_d0
  s_cmp_lg_u32 s20, 0
  s_cbranch_scc1 .fz_kernel_c_t2
  ds_write_b64 v78, v[100:101] offset:6400
  ds_write_b64 v78, v[102:103] offset:6912
  ds_write_b32 v9, v7
  s_waitcnt lgkmcnt(0)
.fz_kernel_c_t2:
  s_barrier
  s_waitcnt vmcnt(1)
.fz_kernel_c_d0:
  s_cmp_ge_u32 s17, 14
  s_cbranch_scc1 .fz_kernel_c_nd0
  s_lshl_b32 s21, s26, 12
  s_add_u32 s21, s21, s72
  s_add_u32 s21, s21, 40960
  s_mul_i32 s27, s18, 28
  s_add_u32 s27, s27, s26
  s_lshl_b32 s27, s27, 8
  s_add_u32 s27, s27, s72
  s_add_u32 s27, s27, 155648
  v_perm_b32 v104, v122, v120, s36
  v_perm_b32 v108, v122, v120, s37
  v_perm_b32 v112, v123, v121, s36
  v_perm_b32 v116, v123, v121, s37
  v_perm_b32 v105, v126, v124, s36
  v_perm_b32 v109, v126, v124, s37
  v_perm_b32 v113, v127, v125, s36
  v_perm_b32 v117, v127, v125, s37
  v_perm_b32 v106, v130, v128, s36
  v_perm_b32 v110, v130, v128, s37
  v_perm_b32 v114, v131, v129, s36
  v_perm_b32 v118, v131, v129, s37
  v_perm_b32 v107, v134, v132, s36
  v_perm_b32 v111, v134, v132, s37
  v_perm_b32 v115, v135, v133, s36
  v_perm_b32 v119, v135, v133, s37
  v_perm_b32 v120, v138, v136, s36
  v_perm_b32 v124, v138, v136, s37
  v_perm_b32 v128, v139, v137, s36
  v_perm_b32 v132, v139, v137, s37
  v_perm_b32 v121, v142, v140, s36
  v_perm_b32 v125, v142, v140, s37
  v_perm_b32 v129, v143, v141, s36
  v_perm_b32 v133, v143, v141, s37
  v_perm_b32 v122, v146, v144, s36
  v_perm_b32 v126, v146, v144, s37
  v_perm_b32 v130, v147, v145, s36
  v_perm_b32 v134, v147, v145, s37
  v_perm_b32 v123, v150, v148, s36
  v_perm_b32 v127, v150, v148, s37
  v_perm_b32 v131, v151, v149, s36
  v_perm_b32 v135, v151, v149, s37
  v_perm_b32 v136, v154, v152, s36
  v_perm_b32 v140, v154, v152, s37
  v_perm_b32 v144, v155, v153, s36
  v_perm_b32 v148, v155, v153, s37
  v_perm_b32 v137, v158, v156, s36
  v_perm_b32 v141, v158, v156, s37
  v_perm_b32 v145, v159, v157, s36
  v_perm_b32 v149, v159, v157, s37
  v_perm_b32 v138, v162, v160, s36
  v_perm_b32 v142, v162, v160, s37
  v_perm_b32 v146, v163, v161, s36
  v_perm_b32 v150, v163, v161, s37
  v_perm_b32 v139, v166, v164, s36
  v_perm_b32 v143, v166, v164, s37
  v_perm_b32 v147, v167, v165, s36
  v_perm_b32 v151, v167, v165, s37
  v_perm_b32 v152, v170, v168, s36
  v_perm_b32 v156, v170, v168, s37
  v_perm_b32 v160, v171, v169, s36
  v_perm_b32 v164, v171, v169, s37
  v_perm_b32 v153, v174, v172, s36
  v_perm_b32 v157, v174, v172, s37
  v_perm_b32 v161, v175, v173, s36
  v_perm_b32 v165, v175, v173, s37
  v_perm_b32 v154, v178, v176, s36
  v_perm_b32 v158, v178, v176, s37
  v_perm_b32 v162, v179, v177, s36
  v_perm_b32 v166, v179, v177, s37
  v_perm_b32 v155, v182, v180, s36
  v_perm_b32 v159, v182, v180, s37
  v_perm_b32 v163, v183, v181, s36
  v_perm_b32 v167, v183, v181, s37
  buffer_load_dwordx2 v[48:49], v16, s[4:7], s21 offen offset:0 sc1
  buffer_load_dwordx2 v[50:51], v16, s[4:7], s21 offen offset:512 sc1
  buffer_load_dwordx2 v[52:53], v16, s[4:7], s21 offen offset:1024 sc1
  buffer_load_dwordx2 v[54:55], v16, s[4:7], s21 offen offset:1536 sc1
  buffer_load_dwordx2 v[56:57], v16, s[4:7], s21 offen offset:2048 sc1
  buffer_load_dwordx2 v[58:59], v16, s[4:7], s21 offen offset:2560 sc1
  buffer_load_dwordx2 v[60:61], v16, s[4:7], s21 offen offset:3072 sc1
  buffer_load_dwordx2 v[62:63], v16, s[4:7], s21 offen offset:3584 sc1
  s_mov_b32 s38, 0
  s_cmp_lg_u32 s75, 0
  s_cbranch_scc1 .fz_kernel_c_gu
  s_waitcnt vmcnt(8)
  s_call_b64 s[68:69], .fz_kernel_c_pperm
.fz_kernel_c_gu:
  s_waitcnt vmcnt(0)
  v_min3_u32 v9, v48, v50, v52
  v_min3_u32 v9, v9, v54, v56
  v_min3_u32 v9, v9, v58, v60
  v_min_u32 v9, v9, v62
  v_cmp_eq_u32 vcc, 0, v9
  v_add_f32 v64, v48, v50
  v_add_f32 v65, v49, v51
  v_add_f32 v66, v52, v54
  v_add_f32 v67, v53, v55
  s_cbranch_vccnz .fz_kernel_c_gur
.fz_kernel_c_gud:
  v_add_f32 v48, v64, v66
  v_add_f32 v49, v65, v67
  v_mul_f32 v50, v48, v81
  v_mul_f32 v51, v49, v81
  v_exp_f32 v50, v50
  v_exp_f32 v51, v51
  v_add_f32 v56, v56, v58
  v_add_f32 v57, v57, v59
  v_add_f32 v60, v60, v62
  v_add_f32 v61, v61, v63
  v_add_f32 v50, 1.0, v50
  v_add_f32 v51, 1.0, v51
  v_rcp_f32 v50, v50
  v_rcp_f32 v51, v51
  v_add_f32 v56, v56, v60
  v_add_f32 v57, v57, v61
  v_mul_f32 v48, v48, v56
  v_mul_f32 v49, v49, v57
  v_mul_f32 v48, v48, v50
  v_mul_f32 v49, v49, v51
  v_cvt_pk_bf16_f32 v48, v48, v49
  s_nop 1
  v_mov_b32 v64, v48 row_newbcast:0 row_mask:0xf bank_mask:0xf
  v_mov_b32 v65, v48 row_newbcast:1 row_mask:0xf bank_mask:0xf
  v_mov_b32 v66, v48 row_newbcast:2 row_mask:0xf bank_mask:0xf
  v_mov_b32 v67, v48 row_newbcast:3 row_mask:0xf bank_mask:0xf
  v_mov_b32 v68, v48 row_newbcast:4 row_mask:0xf bank_mask:0xf
  v_mov_b32 v69, v48 row_newbcast:5 row_mask:0xf bank_mask:0xf
  v_mov_b32 v70, v48 row_newbcast:6 row_mask:0xf bank_mask:0xf
  v_mov_b32 v71, v48 row_newbcast:7 row_mask:0xf bank_mask:0xf
  v_mfma_f32_16x16x32_bf16 v[32:35], v[64:67], v[104:107], 0
  v_mfma_f32_16x16x32_bf16 v[36:39], v[64:67], v[108:111], 0
  v_mfma_f32_16x16x32_bf16 v[40:43], v[64:67], v[112:115], 0
  v_mfma_f32_16x16x32_bf16 v[44:47], v[64:67], v[116:119], 0
  v_mov_b32 v72, v48 row_newbcast:8 row_mask:0xf bank_mask:0xf
  v_mov_b32 v73, v48 row_newbcast:9 row_mask:0xf bank_mask:0xf
  v_mov_b32 v74, v48 row_newbcast:10 row_mask:0xf bank_mask:0xf
  v_mov_b32 v75, v48 row_newbcast:11 row_mask:0xf bank_mask:0xf
  v_mfma_f32_16x16x32_bf16 v[32:35], v[68:71], v[120:123], v[32:35]
  v_mfma_f32_16x16x32_bf16 v[36:39], v[68:71], v[124:127], v[36:39]
  v_mfma_f32_16x16x32_bf16 v[40:43], v[68:71], v[128:131], v[40:43]
  v_mfma_f32_16x16x32_bf16 v[44:47], v[68:71], v[132:135], v[44:47]
  v_mov_b32 v76, v48 row_newbcast:12 row_mask:0xf bank_mask:0xf
  v_mov_b32 v77, v48 row_newbcast:13 row_mask:0xf bank_mask:0xf
  v_mov_b32 v78, v48 row_newbcast:14 row_mask:0xf bank_mask:0xf
  v_mov_b32 v79, v48 row_newbcast:15 row_mask:0xf bank_mask:0xf
  v_mfma_f32_16x16x32_bf16 v[32:35], v[72:75], v[136:139], v[32:35]
  v_mfma_f32_16x16x32_bf16 v[36:39], v[72:75], v[140:143], v[36:39]
  v_mfma_f32_16x16x32_bf16 v[40:43], v[72:75], v[144:147], v[40:43]
  v_mfma_f32_16x16x32_bf16 v[44:47], v[72:75], v[148:151], v[44:47]
  v_mfma_f32_16x16x32_bf16 v[32:35], v[76:79], v[152:155], v[32:35]
  v_mfma_f32_16x16x32_bf16 v[36:39], v[76:79], v[156:159], v[36:39]
  v_mfma_f32_16x16x32_bf16 v[40:43], v[76:79], v[160:163], v[40:43]
  v_mfma_f32_16x16x32_bf16 v[44:47], v[76:79], v[164:167], v[44:47]
  s_nop 4
  v_or_b32 v32, 1, v32
  v_mov_b32 v33, v36
  v_or_b32 v34, 1, v40
  v_mov_b32 v35, v44
  s_mov_b64 exec, 0xffff
  buffer_store_dwordx4 v[32:35], v3, s[4:7], s27 offen offset:0 sc1
  s_mov_b64 exec, -1
.fz_kernel_c_nd:
  s_cmp_eq_u32 s75, 0
  s_cbranch_scc1 .fz_kernel_c_pp
  s_call_b64 s[68:69], .fz_kernel_outst
  s_lshl_b32 s21, s17, 1
  s_add_u32 s21, s21, s20
  s_cmp_lg_u32 s21, 31
  s_cbranch_scc1 .fz_kernel_fin
.fz_kernel_c_pp:
  v_and_b32 v10, 7, v2
  v_lshlrev_b32 v10, 8, v10
  v_lshl_add_u32 v10, v12, 5, v10
  s_mul_i32 s21, s18, 7168
  s_add_u32 s21, s21, s72
  s_add_u32 s21, s21, 155648
  s_add_u32 s22, s21, 4096
  s_mov_b32 s24, 0x0f0f0f0f
  s_mov_b32 s25, 0x0f0f0f0f
  s_lshl_b32 s27, s17, 4
  s_add_u32 s27, s27, s18
  s_lshl_b32 s27, s27, 10
  s_add_u32 s27, s27, 0x1c84000
  v_mov_b32 v72, 1
  v_mov_b32 v73, 1
  v_mov_b32 v74, 1
  v_mov_b32 v75, 1
  v_mov_b32 v76, 1
  v_mov_b32 v77, 1
  v_mov_b32 v78, 1
  v_mov_b32 v79, 1
  s_waitcnt vmcnt(0)
  buffer_load_dwordx4 v[48:51], v10, s[4:7], s21 offen offset:0 sc1
  buffer_load_dwordx4 v[52:55], v10, s[4:7], s21 offen offset:16 sc1
  buffer_load_dwordx4 v[56:59], v10, s[4:7], s21 offen offset:2048 sc1
  buffer_load_dwordx4 v[60:63], v10, s[4:7], s21 offen offset:2064 sc1
  buffer_load_dwordx4 v[64:67], v10, s[4:7], s22 offen offset:0 sc1
  buffer_load_dwordx4 v[68:71], v10, s[4:7], s22 offen offset:16 sc1
  s_mov_b64 exec, s[24:25]
  buffer_load_dwordx4 v[72:75], v10, s[4:7], s22 offen offset:2048 sc1
  buffer_load_dwordx4 v[76:79], v10, s[4:7], s22 offen offset:2064 sc1
  s_mov_b64 exec, -1
  s_mov_b32 s38, 0
.fz_kernel_c_pu:
  s_waitcnt vmcnt(0)
  v_min3_u32 v9, v48, v50, v52
  v_min3_u32 v9, v9, v54, v56
  v_min3_u32 v9, v9, v58, v60
  v_min3_u32 v9, v9, v62, v64
  v_min3_u32 v9, v9, v66, v68
  v_min3_u32 v9, v9, v70, v72
  v_min3_u32 v9, v9, v74, v76
  v_min_u32 v9, v9, v78
  v_cmp_eq_u32 vcc, 0, v9
  v_add_f32 v32, v48, v56
  v_add_f32 v33, v49, v57
  v_add_f32 v34, v50, v58
  v_add_f32 v35, v51, v59
  s_cbranch_vccnz .fz_kernel_c_pur
.fz_kernel_c_pud:
  v_add_f32 v36, v52, v60
  v_add_f32 v37, v53, v61
  v_add_f32 v38, v54, v62
  v_add_f32 v39, v55, v63
  v_add_f32 v64, v64, v72
  v_add_f32 v65, v65, v73
  v_add_f32 v66, v66, v74
  v_add_f32 v67, v67, v75
  v_add_f32 v68, v68, v76
  v_add_f32 v69, v69, v77
  v_add_f32 v70, v70, v78
  v_add_f32 v71, v71, v79
  v_add_f32 v48, v32, v64
  v_add_f32 v49, v33, v65
  v_add_f32 v50, v34, v66
  v_add_f32 v51, v35, v67
  v_add_f32 v52, v36, v68
  v_add_f32 v53, v37, v69
  v_add_f32 v54, v38, v70
  v_add_f32 v55, v39, v71
  v_add_f32 v48, v48, v48 quad_perm:[1,0,3,2] row_mask:0xf bank_mask:0xf
  v_add_f32 v49, v49, v49 quad_perm:[1,0,3,2] row_mask:0xf bank_mask:0xf
  v_add_f32 v50, v50, v50 quad_perm:[1,0,3,2] row_mask:0xf bank_mask:0xf
  v_add_f32 v51, v51, v51 quad_perm:[1,0,3,2] row_mask:0xf bank_mask:0xf
  v_add_f32 v52, v52, v52 quad_perm:[1,0,3,2] row_mask:0xf bank_mask:0xf
  v_add_f32 v53, v53, v53 quad_perm:[1,0,3,2] row_mask:0xf bank_mask:0xf
  v_add_f32 v54, v54, v54 quad_perm:[1,0,3,2] row_mask:0xf bank_mask:0xf
  v_add_f32 v55, v55, v55 quad_perm:[1,0,3,2] row_mask:0xf bank_mask:0xf
  v_add_f32 v48, v48, v48 quad_perm:[2,3,0,1] row_mask:0xf bank_mask:0xf
  v_add_f32 v49, v49, v49 quad_perm:[2,3,0,1] row_mask:0xf bank_mask:0xf
  v_add_f32 v50, v50, v50 quad_perm:[2,3,0,1] row_mask:0xf bank_mask:0xf
  v_add_f32 v51, v51, v51 quad_perm:[2,3,0,1] row_mask:0xf bank_mask:0xf
  v_add_f32 v52, v52, v52 quad_perm:[2,3,0,1] row_mask:0xf bank_mask:0xf
  v_add_f32 v53, v53, v53 quad_perm:[2,3,0,1] row_mask:0xf bank_mask:0xf
  v_add_f32 v54, v54, v54 quad_perm:[2,3,0,1] row_mask:0xf bank_mask:0xf
  v_add_f32 v55, v55, v55 quad_perm:[2,3,0,1] row_mask:0xf bank_mask:0xf
  v_add_f32 v48, v48, v48 row_half_mirror row_mask:0xf bank_mask:0xf
  v_add_f32 v49, v49, v49 row_half_mirror row_mask:0xf bank_mask:0xf
  v_add_f32 v50, v50, v50 row_half_mirror row_mask:0xf bank_mask:0xf
  v_add_f32 v51, v51, v51 row_half_mirror row_mask:0xf bank_mask:0xf
  v_add_f32 v52, v52, v52 row_half_mirror row_mask:0xf bank_mask:0xf
  v_add_f32 v53, v53, v53 row_half_mirror row_mask:0xf bank_mask:0xf
  v_add_f32 v54, v54, v54 row_half_mirror row_mask:0xf bank_mask:0xf
  v_add_f32 v55, v55, v55 row_half_mirror row_mask:0xf bank_mask:0xf
  v_mul_f32 v48, v48, v80
  v_mul_f32 v49, v49, v80
  v_mul_f32 v50, v50, v80
  v_mul_f32 v51, v51, v80
  v_mul_f32 v52, v52, v80
  v_mul_f32 v53, v53, v80
  v_mul_f32 v54, v54, v80
  v_mul_f32 v55, v55, v80
  v_cvt_pk_bf16_f32 v84, v48, v49
  v_cvt_pk_bf16_f32 v85, v50, v51
  v_cvt_pk_bf16_f32 v86, v52, v53
  v_cvt_pk_bf16_f32 v87, v54, v55
  s_cmp_lg_u32 s75, 0
  s_cbranch_scc1 .fz_kernel_c_w7
  v_mfma_f32_16x16x32_bf16 v[32:35], v[84:87], v[168:171], 0
  v_mfma_f32_16x16x32_bf16 v[36:39], v[84:87], v[172:175], 0
  v_mfma_f32_16x16x32_bf16 v[40:43], v[84:87], v[176:179], 0
  v_mfma_f32_16x16x32_bf16 v[44:47], v[84:87], v[180:183], 0
  v_mov_b32 v104, v84 row_ror:8 row_mask:0xf bank_mask:0xf
  v_mov_b32 v105, v85 row_ror:8 row_mask:0xf bank_mask:0xf
  v_mov_b32 v106, v86 row_ror:8 row_mask:0xf bank_mask:0xf
  v_mov_b32 v107, v87 row_ror:8 row_mask:0xf bank_mask:0xf
  s_cmp_lg_u32 s20, 0
  s_cbranch_scc1 .fz_kernel_c_w7m
  v_mfma_f32_16x16x32_bf16 v[48:51], v[84:87], v[200:203], 0
  v_mfma_f32_16x16x32_bf16 v[52:55], v[84:87], v[204:207], 0
  v_mfma_f32_16x16x32_bf16 v[56:59], v[84:87], v[208:211], 0
  v_mfma_f32_16x16x32_bf16 v[60:63], v[84:87], v[212:215], 0
  v_mfma_f32_16x16x32_bf16 v[32:35], v[104:107], v[184:187], v[32:35]
  v_mfma_f32_16x16x32_bf16 v[36:39], v[104:107], v[188:191], v[36:39]
  v_mfma_f32_16x16x32_bf16 v[40:43], v[104:107], v[192:195], v[40:43]
  v_mfma_f32_16x16x32_bf16 v[44:47], v[104:107], v[196:199], v[44:47]
  v_mfma_f32_16x16x32_bf16 v[48:51], v[104:107], v[216:219], v[48:51]
  v_mfma_f32_16x16x32_bf16 v[52:55], v[104:107], v[220:223], v[52:55]
  v_mfma_f32_16x16x32_bf16 v[56:59], v[104:107], v[224:227], v[56:59]
  v_mfma_f32_16x16x32_bf16 v[60:63], v[104:107], v[228:231], v[60:63]
  s_nop 0
  v_or_b32 v32, 1, v32
  v_mov_b32 v33, v36
  v_or_b32 v34, 1, v40
  v_mov_b32 v35, v44
  s_mov_b64 exec, 0xffff
  buffer_store_dwordx4 v[32:35], v3, s[4:7], s27 offen offset:0 sc1
  v_or_b32 v48, 1, v48
  v_mov_b32 v49, v52
  v_or_b32 v50, 1, v56
  v_mov_b32 v51, v60
  s_mov_b64 exec, 0xffff
  buffer_store_dwordx4 v[48:51], v3, s[4:7], s27 offen offset:256 sc1
  s_mov_b64 exec, -1
  v_add_u32 v78, 155648, v16
  v_add_u32 v79, 155648, v3
  s_cmp_eq_u32 s79, 0
  s_cbranch_scc1 .fz_kernel_c_no
  s_lshl_b32 s21, s18, 14
  s_add_u32 s21, s21, 0x1c84000
  s_add_u32 s22, s21, 4096
  s_add_u32 s23, s21, 8192
  s_add_u32 s24, s21, 12288
  v_rcp_f32 v64, v82
  v_lshlrev_b32 v66, 1, v2
  v_sub_u32 v66, s79, v66
  v_cmp_eq_u32 s[28:29], 1, v66
  v_cmp_eq_u32 s[30:31], 2, v66
  s_nop 0
  v_cndmask_b32 v68, 0, v64, s[28:29]
  v_cndmask_b32 v69, 0, v64, s[30:31]
  s_bfm_b64 exec, 49, 0
  s_mov_b32 s38, 0
.fz_kernel_c_pd:
  buffer_load_dwordx4 v[112:115], v3, s[4:7], s21 offen offset:0 sc1
  buffer_load_dwordx4 v[116:119], v3, s[4:7], s21 offen offset:1024 sc1
  buffer_load_dwordx4 v[120:123], v3, s[4:7], s21 offen offset:2048 sc1
  buffer_load_dwordx4 v[124:127], v3, s[4:7], s21 offen offset:3072 sc1
  buffer_load_dwordx4 v[128:131], v3, s[4:7], s22 offen offset:0 sc1
  buffer_load_dwordx4 v[132:135], v3, s[4:7], s22 offen offset:1024 sc1
  buffer_load_dwordx4 v[136:139], v3, s[4:7], s22 offen offset:2048 sc1
  buffer_load_dwordx4 v[140:143], v3, s[4:7], s22 offen offset:3072 sc1
  buffer_load_dwordx4 v[144:147], v3, s[4:7], s23 offen offset:0 sc1
  buffer_load_dwordx4 v[148:151], v3, s[4:7], s23 offen offset:1024 sc1
  buffer_load_dwordx4 v[152:155], v3, s[4:7], s23 offen offset:2048 sc1
  buffer_load_dwordx4 v[156:159], v3, s[4:7], s23 offen offset:3072 sc1
  buffer_load_dwordx4 v[160:163], v3, s[4:7], s24 offen offset:0 sc1
  buffer_load_dwordx4 v[164:167], v3, s[4:7], s24 offen offset:1024 sc1
  buffer_load_dwordx4 v[168:171], v3, s[4:7], s24 offen offset:2048 sc1
  buffer_load_dwordx4 v[172:175], v3, s[4:7], s24 offen offset:3072 sc1
  s_add_u32 s38, s38, 1
  s_waitcnt vmcnt(0)
  v_min3_u32 v9, v112, v114, v116
  v_min3_u32 v9, v9, v118, v120
  v_min3_u32 v9, v9, v122, v124
  v_min3_u32 v9, v9, v126, v128
  v_min3_u32 v9, v9, v130, v132
  v_min3_u32 v9, v9, v134, v136
  v_min3_u32 v9, v9, v138, v140
  v_min3_u32 v9, v9, v142, v144
  v_min3_u32 v9, v9, v146, v148
  v_min3_u32 v9, v9, v150, v152
  v_min3_u32 v9, v9, v154, v156
  v_min3_u32 v9, v9, v158, v160
  v_min3_u32 v9, v9, v162, v164
  v_min3_u32 v9, v9, v166, v168
  v_min3_u32 v9, v9, v170, v172
  v_min_u32 v9, v9, v174
  v_cmp_eq_u32 vcc, 0, v9
  s_cbranch_vccz .fz_kernel_c_pdd
  s_cmp_lt_u32 s38, 131072
  s_cbranch_scc1 .fz_kernel_c_pd
.fz_kernel_c_pdd:
  v_pk_add_f32 v[112:113], v[112:113], v[144:145]
  v_pk_add_f32 v[114:115], v[114:115], v[146:147]
  v_pk_add_f32 v[116:117], v[116:117], v[148:149]
  v_pk_add_f32 v[118:119], v[118:119], v[150:151]
  v_pk_add_f32 v[120:121], v[120:121], v[152:153]
  v_pk_add_f32 v[122:123], v[122:123], v[154:155]
  v_pk_add_f32 v[124:125], v[124:125], v[156:157]
  v_pk_add_f32 v[126:127], v[126:127], v[158:159]
  v_pk_add_f32 v[128:129], v[128:129], v[160:161]
  v_pk_add_f32 v[130:131], v[130:131], v[162:163]
  v_pk_add_f32 v[132:133], v[132:133], v[164:165]
  v_pk_add_f32 v[134:135], v[134:135], v[166:167]
  v_pk_add_f32 v[136:137], v[136:137], v[168:169]
  v_pk_add_f32 v[138:139], v[138:139], v[170:171]
  v_pk_add_f32 v[140:141], v[140:141], v[172:173]
  v_pk_add_f32 v[142:143], v[142:143], v[174:175]
  v_pk_add_f32 v[112:113], v[112:113], v[128:129]
  v_pk_add_f32 v[114:115], v[114:115], v[130:131]
  v_pk_add_f32 v[116:117], v[116:117], v[132:133]
  v_pk_add_f32 v[118:119], v[118:119], v[134:135]
  v_pk_add_f32 v[120:121], v[120:121], v[136:137]
  v_pk_add_f32 v[122:123], v[122:123], v[138:139]
  v_pk_add_f32 v[124:125], v[124:125], v[140:141]
  v_pk_add_f32 v[126:127], v[126:127], v[142:143]
  v_pk_add_f32 v[112:113], v[112:113], v[120:121]
  v_pk_add_f32 v[114:115], v[114:115], v[122:123]
  v_pk_add_f32 v[116:117], v[116:117], v[124:125]
  v_pk_add_f32 v[118:119], v[118:119], v[126:127]
  v_pk_add_f32 v[112:113], v[112:113], v[116:117]
  v_pk_add_f32 v[114:115], v[114:115], v[118:119]
  s_mov_b64 exec, -1
  v_readlane_b32 s21, v112, 48
  v_readlane_b32 s22, v114, 48
  s_nop 0
  v_mul_f32 v64, s21, v28
  v_fma_f32 v65, s22, v28, v30
  v_fma_f32 v65, -v64, v64, v65
  v_rsq_f32 v65, abs(v65)
  v_sub_f32 v64, v83, v64
  v_mul_f32 v66, v65, v82
  v_mul_f32 v67, v65, v64
  v_cndmask_b32 v96, v96, v66, s[28:29]
  v_cndmask_b32 v97, v97, v66, s[30:31]
  v_cndmask_b32 v98, v98, v67, s[28:29]
  v_cndmask_b32 v99, v99, v67, s[30:31]
.fz_kernel_c_no:
  s_call_b64 s[68:69], .fz_kernel_c_land
  v_mov_b32 v9, 159952
  v_mov_b32 v7, s79
  ds_write_b64 v78, v[96:97] offset:4608
  ds_write_b64 v78, v[98:99] offset:5120
  ds_write_b64 v78, v[100:101] offset:6400
  ds_write_b64 v78, v[102:103] offset:6912
  s_cmp_eq_u32 s79, 0
  s_cbranch_scc1 .fz_kernel_c_no2
  ds_write_b32 v9, v7
  ds_write_b64 v78, v[68:69] offset:512
  s_mov_b32 exec_hi, 0xffff
  ds_write_b128 v79, v[112:115] offset:1536
  s_mov_b64 exec, -1
.fz_kernel_c_no2:
  s_waitcnt lgkmcnt(0)
  s_branch .fz_kernel_q_h6e
.fz_kernel_c_w7m:
  v_mfma_f32_16x16x32_bf16 v[32:35], v[104:107], v[184:187], v[32:35]
  v_mfma_f32_16x16x32_bf16 v[36:39], v[104:107], v[188:191], v[36:39]
  v_mfma_f32_16x16x32_bf16 v[40:43], v[104:107], v[192:195], v[40:43]
  v_mfma_f32_16x16x32_bf16 v[44:47], v[104:107], v[196:199], v[44:47]
.fz_kernel_c_w7:
  v_lshlrev_b32 v48, 16, v84
  v_and_b32 v49, 0xffff0000, v84
  v_lshlrev_b32 v50, 16, v85
  v_and_b32 v51, 0xffff0000, v85
  v_lshlrev_b32 v52, 16, v86
  v_and_b32 v53, 0xffff0000, v86
  v_lshlrev_b32 v54, 16, v87
  v_and_b32 v55, 0xffff0000, v87
  v_add_f32 v88, v88, v48
  v_add_f32 v89, v89, v49
  v_add_f32 v90, v90, v50
  v_add_f32 v91, v91, v51
  v_add_f32 v92, v92, v52
  v_add_f32 v93, v93, v53
  v_add_f32 v94, v94, v54
  v_add_f32 v95, v95, v55
  s_cmp_lg_u32 s75, 0
  s_cbranch_scc1 .fz_kernel_c_t3
  v_or_b32 v32, 1, v32
  v_mov_b32 v33, v36
  v_or_b32 v34, 1, v40
  v_mov_b32 v35, v44
  s_mov_b64 exec, 0xffff
  buffer_store_dwordx4 v[32:35], v3, s[4:7], s27 offen offset:512 sc1
  s_mov_b64 exec, -1
  v_mul_f32 v56, v88, v88
  v_add_f32 v58, v88, v89
  v_fmac_f32 v56, v89, v89
  v_fmac_f32 v56, v90, v90
  v_add_f32 v58, v58, v90
  v_fmac_f32 v56, v91, v91
  v_add_f32 v58, v58, v91
  v_fmac_f32 v56, v92, v92
  v_add_f32 v58, v58, v92
  v_fmac_f32 v56, v93, v93
  v_add_f32 v58, v58, v93
  v_fmac_f32 v56, v94, v94
  v_add_f32 v58, v58, v94
  v_fmac_f32 v56, v95, v95
  v_add_f32 v58, v58, v95
  v_lshrrev_b32 v9, 5, v2
  v_lshlrev_b32 v9, 3, v9
  v_permlane32_swap_b32 v58, v56
  v_add_f32 v58, v58, v56
  s_nop 1
  v_add_f32 v58, v58, v58 row_ror:8 row_mask:0xf bank_mask:0xf
  s_nop 1
  v_add_f32 v58, v58, v58 row_bcast:15 row_mask:0xa bank_mask:0xf
  v_or_b32 v58, 1, v58
  s_mov_b32 exec_lo, 0x10000
  s_mov_b32 exec_hi, 0x10000
  buffer_store_dword v58, v9, s[4:7], s27 offen offset:768 sc1
  s_mov_b64 exec, -1
  s_cmp_eq_u32 s79, 0
  s_cbranch_scc1 .fz_kernel_q_h7e
  s_call_b64 s[68:69], .fz_kernel_c_land
  v_lshlrev_b32 v9, 5, v12
  v_add_u32 v9, 155648, v9
  s_mov_b32 exec_lo, 0x01010101
  s_mov_b32 exec_hi, 0x01010101
  ds_write_b128 v9, v[48:51] offset:7424
  ds_write_b128 v9, v[52:55] offset:7440
  s_mov_b64 exec, -1
  s_waitcnt lgkmcnt(0)
  s_branch .fz_kernel_q_h7e
.fz_kernel_c_land:
  v_and_b32 v9, 1, v2
  v_lshlrev_b32 v9, 2, v9
  v_add_u32 v9, s71, v9
  s_mov_b32 s38, 0
.fz_kernel_c_landl:
  ds_read_b32 v7, v9
  s_add_u32 s38, s38, 1
  s_waitcnt lgkmcnt(0)
  v_cmp_gt_u32 vcc, 64, v7
  s_cbranch_vccz .fz_kernel_c_landd
  s_sleep 2
  s_cmp_lt_u32 s38, 524288
  s_cbranch_scc1 .fz_kernel_c_landl
.fz_kernel_c_landd:
  s_setpc_b64 s[68:69]
.fz_kernel_c_t3:
  s_mov_b32 s28, s56
  s_mov_b32 s29, s57
  s_mov_b32 s30, 0x400000
  s_mov_b32 s31, 0x00020000
  v_cvt_pk_bf16_f32 v48, v88, v89
  v_cvt_pk_bf16_f32 v49, v90, v91
  v_cvt_pk_bf16_f32 v50, v92, v93
  v_cvt_pk_bf16_f32 v51, v94, v95
  v_lshlrev_b32 v9, 4, v12
  s_lshl_b32 s21, s77, 11
  s_lshl_b32 s22, s18, 7
  s_add_u32 s21, s21, s22
  s_mov_b32 exec_lo, 0x01010101
  s_mov_b32 exec_hi, 0x01010101
  buffer_store_dwordx4 v[48:51], v9, s[28:31], s21 offen
  s_mov_b64 exec, -1
.fz_kernel_fin:
.fz_kernel_end:
  s_endpgm
.fz_kernel_pick:
  s_mov_b32 s33, 1
  s_cmp_eq_u32 s34, 0xffff
  s_cbranch_scc1 .fz_kernel_pick_ret
  s_mov_b64 exec, 1
  s_mov_b32 s38, 0
.fz_kernel_pick_l:
  ds_read_b32 v7, v6
  s_waitcnt lgkmcnt(0)
  v_readfirstlane_b32 s36, v7
  s_andn2_b32 s33, s36, s34
  s_cbranch_scc1 .fz_kernel_pick_out
  ds_wrxchg_rtn_b32 v7, v6, v5 offset:4
  s_waitcnt lgkmcnt(0)
  v_readfirstlane_b32 s33, v7
  s_cmp_lg_u32 s33, 0
  s_cbranch_scc1 .fz_kernel_pick_sl
  buffer_load_dword v7, v4, s[4:7], s37 offen sc1
  s_waitcnt vmcnt(0)
  ds_or_b32 v6, v7
  ds_write_b32 v6, v4 offset:4
  v_readfirstlane_b32 s36, v7
  s_andn2_b32 s33, s36, s34
  s_cbranch_scc1 .fz_kernel_pick_out
.fz_kernel_pick_sl:
  s_sleep 1
  s_add_u32 s38, s38, 1
  s_cmp_lt_u32 s38, 131072
  s_cbranch_scc1 .fz_kernel_pick_l
  s_mov_b32 s36, 0xffff
  s_andn2_b32 s33, s36, s34
.fz_kernel_pick_out:
  s_waitcnt lgkmcnt(0)
  s_mov_b64 exec, -1
.fz_kernel_pick_ret:
  s_nop 4
  s_setpc_b64 s[68:69]
.fz_kernel_outst:
  s_mov_b32 s28, s56
  s_mov_b32 s29, s57
  s_mov_b32 s30, 0x400000
  s_mov_b32 s31, 0x00020000
  s_and_b32 s32, s16, 3
  s_lshl_b32 s33, s32, 5
  v_add_u32 v34, s33, v18
  v_lshlrev_b32 v33, 2, v34
  v_add_u32 v33, 155648, v33
  v_mov_b32 v32, 159952
  ds_read_b32 v28, v33 offset:6400
  ds_read_b32 v30, v33 offset:6912
  ds_read_b32 v32, v32
  v_add_u32 v34, 1, v34
  v_lshlrev_b32 v33, 11, v18
  v_lshl_add_u32 v33, v17, 4, v33
  s_lshl_b32 s33, s17, 2
  s_add_u32 s32, s32, s33
  s_lshl_b32 s32, s32, 16
  s_lshl_b32 s33, s18, 7
  s_add_u32 s32, s32, s33
  s_lshr_b32 s33, s16, 2
  s_lshl_b32 s33, s33, 6
  s_add_u32 s32, s32, s33
  v_lshlrev_b32 v36, 16, v20
  v_and_b32 v37, 0xffff0000, v20
  v_lshlrev_b32 v38, 16, v21
  v_and_b32 v39, 0xffff0000, v21
  v_lshlrev_b32 v40, 16, v22
  v_and_b32 v41, 0xffff0000, v22
  v_lshlrev_b32 v42, 16, v23
  v_and_b32 v43, 0xffff0000, v23
  v_lshlrev_b32 v44, 16, v24
  v_and_b32 v45, 0xffff0000, v24
  v_lshlrev_b32 v46, 16, v25
  v_and_b32 v47, 0xffff0000, v25
  v_lshlrev_b32 v48, 16, v26
  v_and_b32 v49, 0xffff0000, v26
  v_lshlrev_b32 v50, 16, v27
  v_and_b32 v51, 0xffff0000, v27
  s_waitcnt lgkmcnt(0)
  v_pk_fma_f32 v[36:37], v[36:37], v[28:29], v[30:31] op_sel_hi:[1,0,0]
  v_pk_fma_f32 v[38:39], v[38:39], v[28:29], v[30:31] op_sel_hi:[1,0,0]
  v_pk_fma_f32 v[40:41], v[40:41], v[28:29], v[30:31] op_sel_hi:[1,0,0]
  v_pk_fma_f32 v[42:43], v[42:43], v[28:29], v[30:31] op_sel_hi:[1,0,0]
  v_pk_fma_f32 v[44:45], v[44:45], v[28:29], v[30:31] op_sel_hi:[1,0,0]
  v_pk_fma_f32 v[46:47], v[46:47], v[28:29], v[30:31] op_sel_hi:[1,0,0]
  v_pk_fma_f32 v[48:49], v[48:49], v[28:29], v[30:31] op_sel_hi:[1,0,0]
  v_pk_fma_f32 v[50:51], v[50:51], v[28:29], v[30:31] op_sel_hi:[1,0,0]
  v_cvt_pk_bf16_f32 v52, v36, v37
  v_cvt_pk_bf16_f32 v53, v38, v39
  v_cvt_pk_bf16_f32 v54, v40, v41
  v_cvt_pk_bf16_f32 v55, v42, v43
  v_cvt_pk_bf16_f32 v56, v44, v45
  v_cvt_pk_bf16_f32 v57, v46, v47
  v_cvt_pk_bf16_f32 v58, v48, v49
  v_cvt_pk_bf16_f32 v59, v50, v51
  v_cmp_ne_u32 vcc, v32, v34
  s_mov_b64 exec, vcc
  buffer_store_dwordx4 v[52:55], v33, s[28:31], s32 offen
  buffer_store_dwordx4 v[56:59], v33, s[28:31], s32 offen offset:32
  s_mov_b64 exec, -1
  s_nop 2
  s_setpc_b64 s[68:69]
.fz_kernel_q_cons2:
  v_and_b32 v124, 31, v2
  v_lshrrev_b32 v125, 5, v2
  s_lshl_b32 s28, s16, 12
  v_add_u32 v30, s28, v3
  v_add_u32 v8, 0, v30
  v_xor_b32 v120, 0x1000, v8
  v_add_u32 v9, 1024, v30
  v_xor_b32 v121, 0x1000, v9
  v_add_u32 v10, 2048, v30
  v_xor_b32 v122, 0x1000, v10
  v_add_u32 v11, 3072, v30
  v_xor_b32 v123, 0x1000, v11
  s_branch .fz_kernel_q_cs
.fz_kernel_q_spin:
  s_mov_b32 s38, 0
.fz_kernel_q_spinl:
  ds_read_b32 v127, v126
  s_add_u32 s38, s38, 1
  s_waitcnt lgkmcnt(0)
  v_cmp_le_i32 vcc, v127, v19
  s_cbranch_vccz .fz_kernel_q_spinr
  s_cmp_lt_u32 s38, 524288
  s_cbranch_scc1 .fz_kernel_q_spinl
.fz_kernel_q_spinr:
  s_setpc_b64 s[68:69]
.fz_kernel_q_w0:
  s_call_b64 s[68:69], .fz_kernel_q_spin
  s_branch .fz_kernel_q_back0
.fz_kernel_q_w2:
  s_call_b64 s[68:69], .fz_kernel_q_spin
  s_branch .fz_kernel_q_back2
.fz_kernel_q_w4:
  s_call_b64 s[68:69], .fz_kernel_q_spin
  s_branch .fz_kernel_q_back4
.fz_kernel_q_w6:
  s_call_b64 s[68:69], .fz_kernel_q_spin
  s_branch .fz_kernel_q_back6
.fz_kernel_q_patch:
  ds_read_b32 v224, v25 offset:512
  ds_read_b32 v226, v24 offset:512
  ds_read_b32 v244, v26 offset:2048
  ds_read_b128 v[228:231], v29 offset:1536
  ds_read_b128 v[232:235], v29 offset:1568
  ds_read_b128 v[236:239], v29 offset:1600
  ds_read_b128 v[240:243], v29 offset:1632
  s_waitcnt lgkmcnt(0)
  v_pk_fma_f32 v[128:129], v[228:229], v[224:225], v[128:129] op_sel_hi:[1,0,1]
  v_pk_fma_f32 v[130:131], v[230:231], v[224:225], v[130:131] op_sel_hi:[1,0,1]
  v_pk_fma_f32 v[132:133], v[232:233], v[224:225], v[132:133] op_sel_hi:[1,0,1]
  v_pk_fma_f32 v[134:135], v[234:235], v[224:225], v[134:135] op_sel_hi:[1,0,1]
  v_pk_fma_f32 v[136:137], v[236:237], v[224:225], v[136:137] op_sel_hi:[1,0,1]
  v_pk_fma_f32 v[138:139], v[238:239], v[224:225], v[138:139] op_sel_hi:[1,0,1]
  v_pk_fma_f32 v[140:141], v[240:241], v[224:225], v[140:141] op_sel_hi:[1,0,1]
  v_pk_fma_f32 v[142:143], v[242:243], v[224:225], v[142:143] op_sel_hi:[1,0,1]
  v_pk_fma_f32 v[144:145], v[228:229], v[226:227], v[144:145] op_sel_hi:[1,0,1]
  v_pk_fma_f32 v[146:147], v[230:231], v[226:227], v[146:147] op_sel_hi:[1,0,1]
  v_pk_fma_f32 v[148:149], v[232:233], v[226:227], v[148:149] op_sel_hi:[1,0,1]
  v_pk_fma_f32 v[150:151], v[234:235], v[226:227], v[150:151] op_sel_hi:[1,0,1]
  v_pk_fma_f32 v[152:153], v[236:237], v[226:227], v[152:153] op_sel_hi:[1,0,1]
  v_pk_fma_f32 v[154:155], v[238:239], v[226:227], v[154:155] op_sel_hi:[1,0,1]
  v_pk_fma_f32 v[156:157], v[240:241], v[226:227], v[156:157] op_sel_hi:[1,0,1]
  v_pk_fma_f32 v[158:159], v[242:243], v[226:227], v[158:159] op_sel_hi:[1,0,1]
  ds_read_b128 v[228:231], v29 offset:1792
  ds_read_b128 v[232:235], v29 offset:1824
  ds_read_b128 v[236:239], v29 offset:1856
  ds_read_b128 v[240:243], v29 offset:1888
  s_waitcnt lgkmcnt(0)
  v_pk_fma_f32 v[160:161], v[228:229], v[224:225], v[160:161] op_sel_hi:[1,0,1]
  v_pk_fma_f32 v[162:163], v[230:231], v[224:225], v[162:163] op_sel_hi:[1,0,1]
  v_pk_fma_f32 v[164:165], v[232:233], v[224:225], v[164:165] op_sel_hi:[1,0,1]
  v_pk_fma_f32 v[166:167], v[234:235], v[224:225], v[166:167] op_sel_hi:[1,0,1]
  v_pk_fma_f32 v[168:169], v[236:237], v[224:225], v[168:169] op_sel_hi:[1,0,1]
  v_pk_fma_f32 v[170:171], v[238:239], v[224:225], v[170:171] op_sel_hi:[1,0,1]
  v_pk_fma_f32 v[172:173], v[240:241], v[224:225], v[172:173] op_sel_hi:[1,0,1]
  v_pk_fma_f32 v[174:175], v[242:243], v[224:225], v[174:175] op_sel_hi:[1,0,1]
  v_pk_fma_f32 v[176:177], v[228:229], v[226:227], v[176:177] op_sel_hi:[1,0,1]
  v_pk_fma_f32 v[178:179], v[230:231], v[226:227], v[178:179] op_sel_hi:[1,0,1]
  v_pk_fma_f32 v[180:181], v[232:233], v[226:227], v[180:181] op_sel_hi:[1,0,1]
  v_pk_fma_f32 v[182:183], v[234:235], v[226:227], v[182:183] op_sel_hi:[1,0,1]
  v_pk_fma_f32 v[184:185], v[236:237], v[226:227], v[184:185] op_sel_hi:[1,0,1]
  v_pk_fma_f32 v[186:187], v[238:239], v[226:227], v[186:187] op_sel_hi:[1,0,1]
  v_pk_fma_f32 v[188:189], v[240:241], v[226:227], v[188:189] op_sel_hi:[1,0,1]
  v_pk_fma_f32 v[190:191], v[242:243], v[226:227], v[190:191] op_sel_hi:[1,0,1]
  ds_read_b128 v[228:231], v22 offset:512
  ds_read_b128 v[232:235], v22 offset:544
  ds_read_b128 v[236:239], v22 offset:576
  ds_read_b128 v[240:243], v22 offset:608
  s_waitcnt lgkmcnt(0)
  v_pk_fma_f32 v[192:193], v[228:229], v[244:245], v[192:193] op_sel_hi:[1,0,1]
  v_pk_fma_f32 v[194:195], v[230:231], v[244:245], v[194:195] op_sel_hi:[1,0,1]
  v_pk_fma_f32 v[196:197], v[232:233], v[244:245], v[196:197] op_sel_hi:[1,0,1]
  v_pk_fma_f32 v[198:199], v[234:235], v[244:245], v[198:199] op_sel_hi:[1,0,1]
  v_pk_fma_f32 v[200:201], v[236:237], v[244:245], v[200:201] op_sel_hi:[1,0,1]
  v_pk_fma_f32 v[202:203], v[238:239], v[244:245], v[202:203] op_sel_hi:[1,0,1]
  v_pk_fma_f32 v[204:205], v[240:241], v[244:245], v[204:205] op_sel_hi:[1,0,1]
  v_pk_fma_f32 v[206:207], v[242:243], v[244:245], v[206:207] op_sel_hi:[1,0,1]
  ds_read_b128 v[228:231], v23 offset:512
  ds_read_b128 v[232:235], v23 offset:544
  ds_read_b128 v[236:239], v23 offset:576
  ds_read_b128 v[240:243], v23 offset:608
  s_waitcnt lgkmcnt(0)
  v_pk_fma_f32 v[208:209], v[228:229], v[244:245], v[208:209] op_sel_hi:[1,0,1]
  v_pk_fma_f32 v[210:211], v[230:231], v[244:245], v[210:211] op_sel_hi:[1,0,1]
  v_pk_fma_f32 v[212:213], v[232:233], v[244:245], v[212:213] op_sel_hi:[1,0,1]
  v_pk_fma_f32 v[214:215], v[234:235], v[244:245], v[214:215] op_sel_hi:[1,0,1]
  v_pk_fma_f32 v[216:217], v[236:237], v[244:245], v[216:217] op_sel_hi:[1,0,1]
  v_pk_fma_f32 v[218:219], v[238:239], v[244:245], v[218:219] op_sel_hi:[1,0,1]
  v_pk_fma_f32 v[220:221], v[240:241], v[244:245], v[220:221] op_sel_hi:[1,0,1]
  v_pk_fma_f32 v[222:223], v[242:243], v[244:245], v[222:223] op_sel_hi:[1,0,1]
  s_branch .fz_kernel_q_pback
.fz_kernel_q_pspin:
  s_mov_b32 s38, 0
.fz_kernel_q_pspinl:
  ds_read_b32 v10, v1
  s_add_u32 s38, s38, 1
  s_waitcnt lgkmcnt(0)
  v_cmp_gt_i32 vcc, s34, v10
  s_cbranch_vccz .fz_kernel_q_pspinr
  s_sleep 1
  s_cmp_lt_u32 s38, 524288
  s_cbranch_scc1 .fz_kernel_q_pspinl
.fz_kernel_q_pspinr:
  s_setpc_b64 s[68:69]
.fz_kernel_q_px1_w:
  s_call_b64 s[68:69], .fz_kernel_q_pspin
  s_branch .fz_kernel_q_px1_i
.fz_kernel_q_xw:
  s_mov_b64 exec, 1
  s_mov_b32 s38, 0
.fz_kernel_q_xwl:
  buffer_load_dword v11, v4, s[4:7], s37 offen sc1
  s_add_u32 s38, s38, 1
  s_waitcnt vmcnt(0)
  v_readfirstlane_b32 s36, v11
  s_bitcmp1_b32 s36, s29
  s_cbranch_scc1 .fz_kernel_q_xwd
  s_cmp_lt_u32 s38, 131072
  s_cbranch_scc1 .fz_kernel_q_xwl
  s_mov_b32 s36, -1
.fz_kernel_q_xwd:
  s_mov_b64 exec, -1
  s_branch .fz_kernel_q_xok
.fz_kernel_q_px2_w:
  s_call_b64 s[68:69], .fz_kernel_q_pspin
  s_branch .fz_kernel_q_px2_i
.fz_kernel_q_pw_w:
  s_call_b64 s[68:69], .fz_kernel_q_pspin
  s_branch .fz_kernel_q_pw_i
.fz_kernel_lz4a:
  v_lshlrev_b32 v16, 3, v2
  buffer_atomic_and_x2 v[12:13], v16, s[4:7], s36 offen offset:0 sc1
  buffer_atomic_and_x2 v[12:13], v16, s[4:7], s36 offen offset:512 sc1
  buffer_atomic_and_x2 v[12:13], v16, s[4:7], s36 offen offset:1024 sc1
  buffer_atomic_and_x2 v[12:13], v16, s[4:7], s36 offen offset:1536 sc1
  buffer_atomic_and_x2 v[12:13], v16, s[4:7], s36 offen offset:2048 sc1
  buffer_atomic_and_x2 v[12:13], v16, s[4:7], s36 offen offset:2560 sc1
  buffer_atomic_and_x2 v[12:13], v16, s[4:7], s36 offen offset:3072 sc1
  buffer_atomic_and_x2 v[12:13], v16, s[4:7], s36 offen offset:3584 sc1
  s_branch .fz_kernel_lz4
.fz_kernel_a_cw:
  s_mov_b32 s38, 0
.fz_kernel_a_cwl:
  s_sleep 1
  ds_read_b32 v7, v6 offset:0x100
  s_add_u32 s38, s38, 1
  s_waitcnt lgkmcnt(0)
  v_cmp_gt_u32 vcc, 8, v7
  s_cbranch_vccz .fz_kernel_a_cb
  s_cmp_lt_u32 s38, 524288
  s_cbranch_scc1 .fz_kernel_a_cwl
  s_branch .fz_kernel_a_cb
.fz_kernel_a_slow:
  s_waitcnt vmcnt(0)
  s_lshl_b32 s36, s18, 1
  s_add_u32 s36, s36, s39
  s_lshl_b32 s36, s36, 18
  s_add_u32 s36, s36, s63
  s_mov_b32 s30, s36
  s_mov_b32 s33, 64
  v_mov_b32 v12, 0xff800000
.fz_kernel_a_s1:
  buffer_load_dwordx4 v[184:187], v3, s[4:7], s30 offen offset:0
  buffer_load_dwordx4 v[188:191], v3, s[4:7], s30 offen offset:1024
  s_waitcnt vmcnt(0)
  v_mfma_f32_32x32x16_bf16 v[144:159], v[184:187], v[32:35], 0
  v_mfma_f32_32x32x16_bf16 v[144:159], v[188:191], v[36:39], v[144:159]
  s_nop 11
  v_max3_f32 v12, v12, v144, v145
  v_max3_f32 v12, v12, v146, v147
  v_max3_f32 v12, v12, v148, v149
  v_max3_f32 v12, v12, v150, v151
  v_max3_f32 v12, v12, v152, v153
  v_max3_f32 v12, v12, v154, v155
  v_max3_f32 v12, v12, v156, v157
  v_max3_f32 v12, v12, v158, v159
  s_add_u32 s30, s30, 4096
  s_sub_u32 s33, s33, 1
  s_cmp_lg_u32 s33, 0
  s_cbranch_scc1 .fz_kernel_a_s1
  v_mov_b32 v11, v12
  s_nop 1
  v_permlane32_swap_b32 v11, v12
  v_max_f32 v12, v12, v11
  v_sub_f32 v12, 0, v12
  v_mov_b32 v160, v12
  v_mov_b32 v64, 0
  v_mov_b32 v161, v12
  v_mov_b32 v65, 0
  v_mov_b32 v162, v12
  v_mov_b32 v66, 0
  v_mov_b32 v163, v12
  v_mov_b32 v67, 0
  v_mov_b32 v164, v12
  v_mov_b32 v68, 0
  v_mov_b32 v165, v12
  v_mov_b32 v69, 0
  v_mov_b32 v166, v12
  v_mov_b32 v70, 0
  v_mov_b32 v167, v12
  v_mov_b32 v71, 0
  v_mov_b32 v168, v12
  v_mov_b32 v72, 0
  v_mov_b32 v169, v12
  v_mov_b32 v73, 0
  v_mov_b32 v170, v12
  v_mov_b32 v74, 0
  v_mov_b32 v171, v12
  v_mov_b32 v75, 0
  v_mov_b32 v172, v12
  v_mov_b32 v76, 0
  v_mov_b32 v173, v12
  v_mov_b32 v77, 0
  v_mov_b32 v174, v12
  v_mov_b32 v78, 0
  v_mov_b32 v175, v12
  v_mov_b32 v79, 0
  v_mov_b32 v128, 0
  v_mov_b32 v129, 0
  v_mov_b32 v130, 0
  v_mov_b32 v131, 0
  s_mov_b32 s30, s36
  s_mov_b32 s33, 64
.fz_kernel_a_s2:
  buffer_load_dwordx4 v[184:187], v3, s[4:7], s30 offen offset:0
  buffer_load_dwordx4 v[188:191], v3, s[4:7], s30 offen offset:1024
  buffer_load_dwordx4 v[192:195], v3, s[4:7], s30 offen offset:2048
  buffer_load_dwordx4 v[196:199], v3, s[4:7], s30 offen offset:3072
  s_waitcnt vmcnt(0)
  v_mfma_f32_32x32x16_bf16 v[144:159], v[184:187], v[32:35], v[160:175]
  v_mfma_f32_32x32x16_bf16 v[144:159], v[188:191], v[36:39], v[144:159]
  s_nop 11
  v_exp_f32 v144, v144
  v_exp_f32 v145, v145
  v_exp_f32 v146, v146
  v_exp_f32 v147, v147
  v_exp_f32 v148, v148
  v_exp_f32 v149, v149
  v_exp_f32 v150, v150
  v_exp_f32 v151, v151
  v_exp_f32 v152, v152
  v_exp_f32 v153, v153
  v_exp_f32 v154, v154
  v_exp_f32 v155, v155
  v_exp_f32 v156, v156
  v_exp_f32 v157, v157
  v_exp_f32 v158, v158
  v_exp_f32 v159, v159
  v_cvt_pk_bf16_f32 v176, v144, v145
  v_cvt_pk_bf16_f32 v177, v146, v147
  v_cvt_pk_bf16_f32 v178, v148, v149
  v_cvt_pk_bf16_f32 v179, v150, v151
  v_cvt_pk_bf16_f32 v180, v152, v153
  v_cvt_pk_bf16_f32 v181, v154, v155
  v_cvt_pk_bf16_f32 v182, v156, v157
  v_cvt_pk_bf16_f32 v183, v158, v159
  v_mfma_f32_32x32x16_bf16 v[64:79], v[192:195], v[176:179], v[64:79]
  s_nop 0
  v_mfma_f32_32x32x16_bf16 v[64:79], v[196:199], v[180:183], v[64:79]
  v_smfmac_f32_16x16x64_bf16 v[128:131], v[28:31], v[176:183], v27
  s_add_u32 s30, s30, 4096
  s_sub_u32 s33, s33, 1
  s_cmp_lg_u32 s33, 0
  s_cbranch_scc1 .fz_kernel_a_s2
  s_nop 3
  v_add_f32 v9, v128, v129
  s_branch .fz_kernel_a_fin
.fz_kernel_w_pt:
  s_lshl_b32 s31, s39, 7
  s_add_u32 s31, s31, 155648
  v_lshlrev_b32 v44, 5, v17
  v_add_u32 v44, s31, v44
  s_mov_b64 exec, vcc
  ds_read_b128 v[96:99], v44 offset:7424
  ds_read_b128 v[100:103], v44 offset:7440
  ds_read_b128 v[104:107], v44 offset:7488
  ds_read_b128 v[108:111], v44 offset:7504
  s_waitcnt lgkmcnt(0)
  v_pk_add_f32 v[20:21], v[20:21], v[96:97]
  v_pk_add_f32 v[22:23], v[22:23], v[98:99]
  v_pk_add_f32 v[24:25], v[24:25], v[100:101]
  v_pk_add_f32 v[26:27], v[26:27], v[102:103]
  v_pk_add_f32 v[28:29], v[28:29], v[104:105]
  v_pk_add_f32 v[30:31], v[30:31], v[106:107]
  v_pk_add_f32 v[32:33], v[32:33], v[108:109]
  v_pk_add_f32 v[34:35], v[34:35], v[110:111]
  s_mov_b64 exec, -1
  s_branch .fz_kernel_w_pb
.fz_kernel_c_gur:
  v_cmp_eq_u32 s[8:9], 0, v48
  v_cmp_eq_u32 s[10:11], 0, v50
  v_cmp_eq_u32 s[12:13], 0, v52
  v_cmp_eq_u32 s[14:15], 0, v54
  v_cmp_eq_u32 s[22:23], 0, v56
  v_cmp_eq_u32 s[24:25], 0, v58
  v_cmp_eq_u32 s[28:29], 0, v60
  v_cmp_eq_u32 s[30:31], 0, v62
  s_add_u32 s38, s38, 1
  s_cmp_ge_u32 s38, 131072
  s_cbranch_scc1 .fz_kernel_c_gud
  s_or_b64 exec, s[8:9], 1
  buffer_load_dwordx2 v[48:49], v16, s[4:7], s21 offen offset:0 sc1
  s_or_b64 exec, s[10:11], 1
  buffer_load_dwordx2 v[50:51], v16, s[4:7], s21 offen offset:512 sc1
  s_or_b64 exec, s[12:13], 1
  buffer_load_dwordx2 v[52:53], v16, s[4:7], s21 offen offset:1024 sc1
  s_or_b64 exec, s[14:15], 1
  buffer_load_dwordx2 v[54:55], v16, s[4:7], s21 offen offset:1536 sc1
  s_or_b64 exec, s[22:23], 1
  buffer_load_dwordx2 v[56:57], v16, s[4:7], s21 offen offset:2048 sc1
  s_or_b64 exec, s[24:25], 1
  buffer_load_dwordx2 v[58:59], v16, s[4:7], s21 offen offset:2560 sc1
  s_or_b64 exec, s[28:29], 1
  buffer_load_dwordx2 v[60:61], v16, s[4:7], s21 offen offset:3072 sc1
  s_or_b64 exec, s[30:31], 1
  buffer_load_dwordx2 v[62:63], v16, s[4:7], s21 offen offset:3584 sc1
  s_mov_b64 exec, -1
  s_branch .fz_kernel_c_gu
.fz_kernel_c_nd0:
  s_waitcnt vmcnt(0)
  s_cmp_lg_u32 s75, 0
  s_cbranch_scc1 .fz_kernel_c_nd
  s_call_b64 s[68:69], .fz_kernel_c_pperm
  s_sleep 24
  s_branch .fz_kernel_c_nd
.fz_kernel_c_pperm:
  v_perm_b32 v168, v186, v184, s36
  v_perm_b32 v172, v186, v184, s37
  v_perm_b32 v176, v187, v185, s36
  v_perm_b32 v180, v187, v185, s37
  v_perm_b32 v169, v190, v188, s36
  v_perm_b32 v173, v190, v188, s37
  v_perm_b32 v177, v191, v189, s36
  v_perm_b32 v181, v191, v189, s37
  v_perm_b32 v170, v194, v192, s36
  v_perm_b32 v174, v194, v192, s37
  v_perm_b32 v178, v195, v193, s36
  v_perm_b32 v182, v195, v193, s37
  v_perm_b32 v171, v198, v196, s36
  v_perm_b32 v175, v198, v196, s37
  v_perm_b32 v179, v199, v197, s36
  v_perm_b32 v183, v199, v197, s37
  v_perm_b32 v184, v202, v200, s36
  v_perm_b32 v188, v202, v200, s37
  v_perm_b32 v192, v203, v201, s36
  v_perm_b32 v196, v203, v201, s37
  v_perm_b32 v185, v206, v204, s36
  v_perm_b32 v189, v206, v204, s37
  v_perm_b32 v193, v207, v205, s36
  v_perm_b32 v197, v207, v205, s37
  v_perm_b32 v186, v210, v208, s36
  v_perm_b32 v190, v210, v208, s37
  v_perm_b32 v194, v211, v209, s36
  v_perm_b32 v198, v211, v209, s37
  v_perm_b32 v187, v214, v212, s36
  v_perm_b32 v191, v214, v212, s37
  v_perm_b32 v195, v215, v213, s36
  v_perm_b32 v199, v215, v213, s37
  s_cmp_lg_u32 s20, 0
  s_cbranch_scc1 .fz_kernel_c_ppr
  v_perm_b32 v200, v218, v216, s36
  v_perm_b32 v204, v218, v216, s37
  v_perm_b32 v208, v219, v217, s36
  v_perm_b32 v212, v219, v217, s37
  v_perm_b32 v201, v222, v220, s36
  v_perm_b32 v205, v222, v220, s37
  v_perm_b32 v209, v223, v221, s36
  v_perm_b32 v213, v223, v221, s37
  v_perm_b32 v202, v226, v224, s36
  v_perm_b32 v206, v226, v224, s37
  v_perm_b32 v210, v227, v225, s36
  v_perm_b32 v214, v227, v225, s37
  v_perm_b32 v203, v230, v228, s36
  v_perm_b32 v207, v230, v228, s37
  v_perm_b32 v211, v231, v229, s36
  v_perm_b32 v215, v231, v229, s37
  v_perm_b32 v216, v234, v232, s36
  v_perm_b32 v220, v234, v232, s37
  v_perm_b32 v224, v235, v233, s36
  v_perm_b32 v228, v235, v233, s37
  v_perm_b32 v217, v238, v236, s36
  v_perm_b32 v221, v238, v236, s37
  v_perm_b32 v225, v239, v237, s36
  v_perm_b32 v229, v239, v237, s37
  v_perm_b32 v218, v242, v240, s36
  v_perm_b32 v222, v242, v240, s37
  v_perm_b32 v226, v243, v241, s36
  v_perm_b32 v230, v243, v241, s37
  v_perm_b32 v219, v246, v244, s36
  v_perm_b32 v223, v246, v244, s37
  v_perm_b32 v227, v247, v245, s36
  v_perm_b32 v231, v247, v245, s37
.fz_kernel_c_ppr:
  s_setpc_b64 s[68:69]
.fz_kernel_c_pur:
  v_min3_u32 v9, v48, v50, v52
  v_min_u32 v9, v9, v54
  v_cmp_eq_u32 s[8:9], 0, v9
  v_min3_u32 v9, v56, v58, v60
  v_min_u32 v9, v9, v62
  v_cmp_eq_u32 s[10:11], 0, v9
  v_min3_u32 v9, v64, v66, v68
  v_min_u32 v9, v9, v70
  v_cmp_eq_u32 s[12:13], 0, v9
  v_min3_u32 v9, v72, v74, v76
  v_min_u32 v9, v9, v78
  v_cmp_eq_u32 s[14:15], 0, v9
  s_add_u32 s38, s38, 1
  s_cmp_ge_u32 s38, 131072
  s_cbranch_scc1 .fz_kernel_c_pud
  s_or_b64 exec, s[8:9], 1
  buffer_load_dwordx4 v[48:51], v10, s[4:7], s21 offen offset:0 sc1
  buffer_load_dwordx4 v[52:55], v10, s[4:7], s21 offen offset:16 sc1
  s_or_b64 exec, s[10:11], 1
  buffer_load_dwordx4 v[56:59], v10, s[4:7], s21 offen offset:2048 sc1
  buffer_load_dwordx4 v[60:63], v10, s[4:7], s21 offen offset:2064 sc1
  s_or_b64 exec, s[12:13], 1
  buffer_load_dwordx4 v[64:67], v10, s[4:7], s22 offen offset:0 sc1
  buffer_load_dwordx4 v[68:71], v10, s[4:7], s22 offen offset:16 sc1
  s_or_b64 exec, s[14:15], 1
  buffer_load_dwordx4 v[72:75], v10, s[4:7], s22 offen offset:2048 sc1
  buffer_load_dwordx4 v[76:79], v10, s[4:7], s22 offen offset:2064 sc1
  s_mov_b64 exec, -1
  s_branch .fz_kernel_c_pu
.fz_kernel_cend:
  s_endpgm

.section .rodata,"a"
.p2align 6
.amdhsa_kernel fz_kernel
  .amdhsa_next_free_vgpr 256
  .amdhsa_next_free_sgpr 102
  .amdhsa_accum_offset 256
  .amdhsa_group_segment_fixed_size 0
  .amdhsa_kernarg_size 88
  .amdhsa_user_sgpr_count 2
  .amdhsa_user_sgpr_kernarg_segment_ptr 1
  .amdhsa_system_sgpr_workgroup_id_x 1
.end_amdhsa_kernel
```

```asm
; @launch kernel=g2_kernel grid=(256,1,1) block=(512,1,1) lds=163840
.amdgcn_target "amdgcn-amd-amdhsa--gfx950"
.text
.globl g2_kernel
.p2align 8
.type g2_kernel,@function
g2_kernel:
  s_cmp_ge_u32 s2, 256
  s_cbranch_scc1 .g2_kernel_end
  s_load_dwordx16 s[40:55], s[0:1], 0
  s_load_dwordx4 s[56:59], s[0:1], 64
  s_load_dwordx2 s[60:61], s[0:1], 80
  s_getpc_b64 s[64:65]
.g2_kernel_pc:
  s_mov_b32 s66, .g2_kernel_cend-.g2_kernel_pc
  s_mov_b32 s67, 0x00020000
  s_lshl_b32 s12, s2, 10
  s_and_b32 s12, s12, 0xe000
  v_lshrrev_b32 v3, 3, v0
  v_and_b32 v2, 7, v0
  v_and_b32 v3, 0x38, v3
  v_add_lshl_u32 v3, v3, v2, 7
  s_mov_b64 exec, 0xff
  buffer_load_dword v1, v3, s[64:67], s12 offen
  s_mov_b64 exec, -1
  v_lshrrev_b32 v3, 6, v0
  v_and_b32 v2, 63, v0
  v_readfirstlane_b32 s16, v3
  s_and_b32 s21, s2, 7
  s_lshr_b32 s22, s2, 3
  s_and_b32 s23, s21, 3
  s_lshl_b32 s23, s23, 2
  s_and_b32 s24, s22, 3
  s_add_u32 s18, s23, s24
  s_lshr_b32 s24, s21, 2
  s_lshl_b32 s24, s24, 3
  s_lshr_b32 s25, s22, 2
  s_add_u32 s17, s24, s25
  s_lshl_b32 s19, s17, 4
  s_add_u32 s19, s19, s18
  s_lshl_b32 s19, s19, 7
  s_add_u32 s19, s19, 0x3000000
  s_lshl_b32 s76, s18, 4
  s_add_u32 s76, s76, s17
  s_lshl_b32 s76, s76, 7
  s_add_u32 s76, s76, 0x3008000
  v_lshlrev_b32 v3, 4, v2
  v_mov_b32 v4, 0
  v_mov_b32 v5, 1
  s_mov_b32 s62, 0
  s_mov_b32 s63, 0
  s_mov_b32 s70, 1
  s_mov_b32 s71, 155648
  s_waitcnt lgkmcnt(0)
  s_mov_b32 s4, s60
  s_mov_b32 s5, s61
  s_mov_b32 s6, 0x3200000
  s_mov_b32 s7, 0x00020000
  s_cmp_ge_u32 s16, 4
  s_cbranch_scc1 .g2_kernel_svc
  v_mov_b32 v20, 0
  v_mov_b32 v21, 0
  v_mov_b32 v22, 0
  v_mov_b32 v23, 0
  v_lshlrev_b32 v24, 4, v0
  v_cmp_gt_u32 vcc, 2816, v24
  v_add_u32 v24, 155648, v24
  s_and_saveexec_b64 s[20:21], vcc
  s_cbranch_execz .g2_kernel_q_nz
  ds_write_b128 v24, v[20:23]
.g2_kernel_q_nz:
  s_mov_b64 exec, -1
  v_and_b32 v20, 15, v2
  v_lshrrev_b32 v21, 4, v2
  v_lshrrev_b32 v22, 1, v20
  v_xor_b32 v22, v22, v21
  v_lshlrev_b32 v22, 4, v22
  v_lshl_add_u32 v22, v20, 7, v22
  s_lshr_b32 s26, s16, 1
  s_lshl_b32 s26, s26, 13
  v_add_u32 v8, s26, v22
  v_xor_b32 v9, 64, v8
  s_mov_b32 s29, 0
  s_mov_b32 s31, .g2_kernel_tab-.g2_kernel_pc
  s_mov_b32 s33, -64
  s_mov_b32 m0, 151552
  s_waitcnt lgkmcnt(0)
  s_barrier
.g2_kernel_q_cs:
  s_and_b32 s27, s16, 1
  v_bfe_u32 v20, v2, 2, 2
  v_lshrrev_b32 v21, 4, v2
  v_lshl_add_u32 v22, v21, 3, v20
  v_lshlrev_b32 v22, 7, v22
  v_lshrrev_b32 v23, 1, v20
  v_and_b32 v21, 1, v21
  v_xor_b32 v21, s27, v21
  v_lshl_add_u32 v23, v21, 1, v23
  v_lshl_add_u32 v22, v23, 5, v22
  v_and_b32 v23, 3, v2
  v_lshl_add_u32 v22, v23, 3, v22
  v_add_u32 v12, 65536, v22
  v_xor_b32 v13, 32, v12
  v_mov_b32 v10, v12
  v_mov_b32 v11, v13
  v_mov_b32 v14, 156160
  v_mov_b32 v15, 0
  s_mov_b32 s30, 0
  s_cmp_lt_i32 s29, 0
  s_cbranch_scc0 .g2_kernel_q_init
  .p2align 6
.g2_kernel_q_loop:
  s_waitcnt lgkmcnt(0)
  v_mfma_f32_16x16x32_bf16 v[160:163], v[120:123], v[104:107], v[160:163]
  v_cmp_lt_i32 vcc, s33, v15
  v_mfma_f32_16x16x32_bf16 v[164:167], v[120:123], v[108:111], v[164:167]
  s_cbranch_vccz .g2_kernel_q_w7
.g2_kernel_q_back7:
  v_mfma_f32_16x16x32_bf16 v[168:171], v[120:123], v[112:115], v[168:171]
  ds_read_b64_tr_b16 v[80:81], v10 offset:0
  v_mfma_f32_16x16x32_bf16 v[172:175], v[120:123], v[116:119], v[172:175]
  ds_read_b64_tr_b16 v[82:83], v10 offset:512
  v_mfma_f32_16x16x32_bf16 v[188:191], v[124:127], v[116:119], v[188:191]
  ds_read_b128 v[64:67], v8 offset:0
  v_mfma_f32_16x16x32_bf16 v[184:187], v[124:127], v[112:115], v[184:187]
  ds_read_b128 v[68:71], v8 offset:2048
  v_mfma_f32_16x16x32_bf16 v[180:183], v[124:127], v[108:111], v[180:183]
  ds_read_b128 v[72:75], v8 offset:4096
  v_mfma_f32_16x16x32_bf16 v[176:179], v[124:127], v[104:107], v[176:179]
  ds_read_b128 v[76:79], v8 offset:6144
  v_mfma_f32_16x16x32_bf16 v[192:195], v[128:131], v[104:107], v[192:195]
  ds_read_b64_tr_b16 v[84:85], v11 offset:0
  v_mfma_f32_16x16x32_bf16 v[196:199], v[128:131], v[108:111], v[196:199]
  ds_read_b64_tr_b16 v[86:87], v11 offset:512
  v_mfma_f32_16x16x32_bf16 v[200:203], v[128:131], v[112:115], v[200:203]
  ds_read_b64_tr_b16 v[88:89], v10 offset:4096
  v_mfma_f32_16x16x32_bf16 v[204:207], v[128:131], v[116:119], v[204:207]
  ds_read_b64_tr_b16 v[90:91], v10 offset:4608
  v_mfma_f32_16x16x32_bf16 v[220:223], v[132:135], v[116:119], v[220:223]
  ds_read_b64_tr_b16 v[92:93], v11 offset:4096
  v_mfma_f32_16x16x32_bf16 v[216:219], v[132:135], v[112:115], v[216:219]
  ds_read_b64_tr_b16 v[94:95], v11 offset:4608
  v_mfma_f32_16x16x32_bf16 v[212:215], v[132:135], v[108:111], v[212:215]
  ds_read_b64_tr_b16 v[96:97], v10 offset:8192
  v_mfma_f32_16x16x32_bf16 v[208:211], v[132:135], v[104:107], v[208:211]
  ds_read_b64_tr_b16 v[98:99], v10 offset:8704
  v_mfma_f32_16x16x32_bf16 v[224:227], v[104:107], v[136:139], v[224:227]
  ds_read_b64_tr_b16 v[100:101], v11 offset:8192
  v_mfma_f32_16x16x32_bf16 v[228:231], v[108:111], v[136:139], v[228:231]
  ds_read_b64_tr_b16 v[102:103], v11 offset:8704
  v_mfma_f32_16x16x32_bf16 v[232:235], v[112:115], v[136:139], v[232:235]
  ds_read_b32 v15, v14
  s_add_u32 s30, s30, 12288
  v_mfma_f32_16x16x32_bf16 v[236:239], v[116:119], v[136:139], v[236:239]
  buffer_load_dword off, s[64:67], s31 lds
  s_cmp_eq_u32 s30, 86016
  v_mfma_f32_16x16x32_bf16 v[252:255], v[116:119], v[140:143], v[252:255]
  s_cselect_b32 s30, 0, s30
  s_add_u32 s31, s31, 4
  v_mfma_f32_16x16x32_bf16 v[248:251], v[112:115], v[140:143], v[248:251]
  v_add_u32 v10, s30, v12
  s_add_u32 s33, s33, 1
  v_mfma_f32_16x16x32_bf16 v[244:247], v[108:111], v[140:143], v[244:247]
  v_add_u32 v11, s30, v13
  v_mfma_f32_16x16x32_bf16 v[240:243], v[104:107], v[140:143], v[240:243]
.g2_kernel_q_s0:
  s_waitcnt lgkmcnt(0)
  v_mfma_f32_16x16x32_bf16 v[160:163], v[80:83], v[64:67], v[160:163]
  v_cmp_lt_i32 vcc, s33, v15
  v_mfma_f32_16x16x32_bf16 v[164:167], v[80:83], v[68:71], v[164:167]
  s_cbranch_vccz .g2_kernel_q_w0
.g2_kernel_q_back0:
  v_mfma_f32_16x16x32_bf16 v[168:171], v[80:83], v[72:75], v[168:171]
  ds_read_b64_tr_b16 v[120:121], v10 offset:0
  v_mfma_f32_16x16x32_bf16 v[172:175], v[80:83], v[76:79], v[172:175]
  ds_read_b64_tr_b16 v[122:123], v10 offset:512
  v_mfma_f32_16x16x32_bf16 v[188:191], v[84:87], v[76:79], v[188:191]
  ds_read_b128 v[104:107], v9 offset:0
  v_mfma_f32_16x16x32_bf16 v[184:187], v[84:87], v[72:75], v[184:187]
  ds_read_b128 v[108:111], v9 offset:2048
  v_mfma_f32_16x16x32_bf16 v[180:183], v[84:87], v[68:71], v[180:183]
  ds_read_b128 v[112:115], v9 offset:4096
  v_mfma_f32_16x16x32_bf16 v[176:179], v[84:87], v[64:67], v[176:179]
  ds_read_b128 v[116:119], v9 offset:6144
  v_mfma_f32_16x16x32_bf16 v[192:195], v[88:91], v[64:67], v[192:195]
  ds_read_b64_tr_b16 v[124:125], v11 offset:0
  v_mfma_f32_16x16x32_bf16 v[196:199], v[88:91], v[68:71], v[196:199]
  ds_read_b64_tr_b16 v[126:127], v11 offset:512
  v_mfma_f32_16x16x32_bf16 v[200:203], v[88:91], v[72:75], v[200:203]
  ds_read_b64_tr_b16 v[128:129], v10 offset:4096
  v_mfma_f32_16x16x32_bf16 v[204:207], v[88:91], v[76:79], v[204:207]
  ds_read_b64_tr_b16 v[130:131], v10 offset:4608
  v_mfma_f32_16x16x32_bf16 v[220:223], v[92:95], v[76:79], v[220:223]
  ds_read_b64_tr_b16 v[132:133], v11 offset:4096
  v_mfma_f32_16x16x32_bf16 v[216:219], v[92:95], v[72:75], v[216:219]
  ds_read_b64_tr_b16 v[134:135], v11 offset:4608
  v_mfma_f32_16x16x32_bf16 v[212:215], v[92:95], v[68:71], v[212:215]
  ds_read_b64_tr_b16 v[136:137], v10 offset:8192
  v_mfma_f32_16x16x32_bf16 v[208:211], v[92:95], v[64:67], v[208:211]
  ds_read_b64_tr_b16 v[138:139], v10 offset:8704
  v_mfma_f32_16x16x32_bf16 v[224:227], v[64:67], v[96:99], v[224:227]
  ds_read_b64_tr_b16 v[140:141], v11 offset:8192
  v_mfma_f32_16x16x32_bf16 v[228:231], v[68:71], v[96:99], v[228:231]
  ds_read_b64_tr_b16 v[142:143], v11 offset:8704
  v_mfma_f32_16x16x32_bf16 v[232:235], v[72:75], v[96:99], v[232:235]
  ds_read_b32 v15, v14
  s_add_u32 s30, s30, 12288
  v_mfma_f32_16x16x32_bf16 v[236:239], v[76:79], v[96:99], v[236:239]
  buffer_load_dword off, s[64:67], s31 lds
  s_cmp_eq_u32 s30, 86016
  v_mfma_f32_16x16x32_bf16 v[252:255], v[76:79], v[100:103], v[252:255]
  s_cselect_b32 s30, 0, s30
  s_add_u32 s31, s31, 4
  v_mfma_f32_16x16x32_bf16 v[248:251], v[72:75], v[100:103], v[248:251]
  v_add_u32 v10, s30, v12
  s_add_u32 s33, s33, 1
  v_mfma_f32_16x16x32_bf16 v[244:247], v[68:71], v[100:103], v[244:247]
  v_add_u32 v11, s30, v13
  v_mfma_f32_16x16x32_bf16 v[240:243], v[64:67], v[100:103], v[240:243]
  s_waitcnt lgkmcnt(0)
  v_mfma_f32_16x16x32_bf16 v[160:163], v[120:123], v[104:107], v[160:163]
  v_cmp_lt_i32 vcc, s33, v15
  v_mfma_f32_16x16x32_bf16 v[164:167], v[120:123], v[108:111], v[164:167]
  s_cbranch_vccz .g2_kernel_q_w1
.g2_kernel_q_back1:
  v_mfma_f32_16x16x32_bf16 v[168:171], v[120:123], v[112:115], v[168:171]
  ds_read_b64_tr_b16 v[80:81], v10 offset:0
  v_mfma_f32_16x16x32_bf16 v[172:175], v[120:123], v[116:119], v[172:175]
  ds_read_b64_tr_b16 v[82:83], v10 offset:512
  v_mfma_f32_16x16x32_bf16 v[188:191], v[124:127], v[116:119], v[188:191]
  ds_read_b128 v[64:67], v8 offset:16384
  v_mfma_f32_16x16x32_bf16 v[184:187], v[124:127], v[112:115], v[184:187]
  ds_read_b128 v[68:71], v8 offset:18432
  v_mfma_f32_16x16x32_bf16 v[180:183], v[124:127], v[108:111], v[180:183]
  ds_read_b128 v[72:75], v8 offset:20480
  v_mfma_f32_16x16x32_bf16 v[176:179], v[124:127], v[104:107], v[176:179]
  ds_read_b128 v[76:79], v8 offset:22528
  v_mfma_f32_16x16x32_bf16 v[192:195], v[128:131], v[104:107], v[192:195]
  ds_read_b64_tr_b16 v[84:85], v11 offset:0
  v_mfma_f32_16x16x32_bf16 v[196:199], v[128:131], v[108:111], v[196:199]
  ds_read_b64_tr_b16 v[86:87], v11 offset:512
  v_mfma_f32_16x16x32_bf16 v[200:203], v[128:131], v[112:115], v[200:203]
  ds_read_b64_tr_b16 v[88:89], v10 offset:4096
  v_mfma_f32_16x16x32_bf16 v[204:207], v[128:131], v[116:119], v[204:207]
  ds_read_b64_tr_b16 v[90:91], v10 offset:4608
  v_mfma_f32_16x16x32_bf16 v[220:223], v[132:135], v[116:119], v[220:223]
  ds_read_b64_tr_b16 v[92:93], v11 offset:4096
  v_mfma_f32_16x16x32_bf16 v[216:219], v[132:135], v[112:115], v[216:219]
  ds_read_b64_tr_b16 v[94:95], v11 offset:4608
  v_mfma_f32_16x16x32_bf16 v[212:215], v[132:135], v[108:111], v[212:215]
  ds_read_b64_tr_b16 v[96:97], v10 offset:8192
  v_mfma_f32_16x16x32_bf16 v[208:211], v[132:135], v[104:107], v[208:211]
  ds_read_b64_tr_b16 v[98:99], v10 offset:8704
  v_mfma_f32_16x16x32_bf16 v[224:227], v[104:107], v[136:139], v[224:227]
  ds_read_b64_tr_b16 v[100:101], v11 offset:8192
  v_mfma_f32_16x16x32_bf16 v[228:231], v[108:111], v[136:139], v[228:231]
  ds_read_b64_tr_b16 v[102:103], v11 offset:8704
  v_mfma_f32_16x16x32_bf16 v[232:235], v[112:115], v[136:139], v[232:235]
  ds_read_b32 v15, v14
  s_add_u32 s30, s30, 12288
  v_mfma_f32_16x16x32_bf16 v[236:239], v[116:119], v[136:139], v[236:239]
  buffer_load_dword off, s[64:67], s31 lds
  s_cmp_eq_u32 s30, 86016
  v_mfma_f32_16x16x32_bf16 v[252:255], v[116:119], v[140:143], v[252:255]
  s_cselect_b32 s30, 0, s30
  s_add_u32 s31, s31, 4
  v_mfma_f32_16x16x32_bf16 v[248:251], v[112:115], v[140:143], v[248:251]
  v_add_u32 v10, s30, v12
  s_add_u32 s33, s33, 1
  v_mfma_f32_16x16x32_bf16 v[244:247], v[108:111], v[140:143], v[244:247]
  v_add_u32 v11, s30, v13
  v_mfma_f32_16x16x32_bf16 v[240:243], v[104:107], v[140:143], v[240:243]
  s_waitcnt lgkmcnt(0)
  v_mfma_f32_16x16x32_bf16 v[160:163], v[80:83], v[64:67], v[160:163]
  v_cmp_lt_i32 vcc, s33, v15
  v_mfma_f32_16x16x32_bf16 v[164:167], v[80:83], v[68:71], v[164:167]
  s_cbranch_vccz .g2_kernel_q_w2
.g2_kernel_q_back2:
  v_mfma_f32_16x16x32_bf16 v[168:171], v[80:83], v[72:75], v[168:171]
  ds_read_b64_tr_b16 v[120:121], v10 offset:0
  v_mfma_f32_16x16x32_bf16 v[172:175], v[80:83], v[76:79], v[172:175]
  ds_read_b64_tr_b16 v[122:123], v10 offset:512
  v_mfma_f32_16x16x32_bf16 v[188:191], v[84:87], v[76:79], v[188:191]
  ds_read_b128 v[104:107], v9 offset:16384
  v_mfma_f32_16x16x32_bf16 v[184:187], v[84:87], v[72:75], v[184:187]
  ds_read_b128 v[108:111], v9 offset:18432
  v_mfma_f32_16x16x32_bf16 v[180:183], v[84:87], v[68:71], v[180:183]
  ds_read_b128 v[112:115], v9 offset:20480
  v_mfma_f32_16x16x32_bf16 v[176:179], v[84:87], v[64:67], v[176:179]
  ds_read_b128 v[116:119], v9 offset:22528
  v_mfma_f32_16x16x32_bf16 v[192:195], v[88:91], v[64:67], v[192:195]
  ds_read_b64_tr_b16 v[124:125], v11 offset:0
  v_mfma_f32_16x16x32_bf16 v[196:199], v[88:91], v[68:71], v[196:199]
  ds_read_b64_tr_b16 v[126:127], v11 offset:512
  v_mfma_f32_16x16x32_bf16 v[200:203], v[88:91], v[72:75], v[200:203]
  ds_read_b64_tr_b16 v[128:129], v10 offset:4096
  v_mfma_f32_16x16x32_bf16 v[204:207], v[88:91], v[76:79], v[204:207]
  ds_read_b64_tr_b16 v[130:131], v10 offset:4608
  v_mfma_f32_16x16x32_bf16 v[220:223], v[92:95], v[76:79], v[220:223]
  ds_read_b64_tr_b16 v[132:133], v11 offset:4096
  v_mfma_f32_16x16x32_bf16 v[216:219], v[92:95], v[72:75], v[216:219]
  ds_read_b64_tr_b16 v[134:135], v11 offset:4608
  v_mfma_f32_16x16x32_bf16 v[212:215], v[92:95], v[68:71], v[212:215]
  ds_read_b64_tr_b16 v[136:137], v10 offset:8192
  v_mfma_f32_16x16x32_bf16 v[208:211], v[92:95], v[64:67], v[208:211]
  ds_read_b64_tr_b16 v[138:139], v10 offset:8704
  v_mfma_f32_16x16x32_bf16 v[224:227], v[64:67], v[96:99], v[224:227]
  ds_read_b64_tr_b16 v[140:141], v11 offset:8192
  v_mfma_f32_16x16x32_bf16 v[228:231], v[68:71], v[96:99], v[228:231]
  ds_read_b64_tr_b16 v[142:143], v11 offset:8704
  v_mfma_f32_16x16x32_bf16 v[232:235], v[72:75], v[96:99], v[232:235]
  ds_read_b32 v15, v14
  s_add_u32 s30, s30, 12288
  v_mfma_f32_16x16x32_bf16 v[236:239], v[76:79], v[96:99], v[236:239]
  buffer_load_dword off, s[64:67], s31 lds
  s_cmp_eq_u32 s30, 86016
  v_mfma_f32_16x16x32_bf16 v[252:255], v[76:79], v[100:103], v[252:255]
  s_cselect_b32 s30, 0, s30
  s_add_u32 s31, s31, 4
  v_mfma_f32_16x16x32_bf16 v[248:251], v[72:75], v[100:103], v[248:251]
  v_add_u32 v10, s30, v12
  s_add_u32 s33, s33, 1
  v_mfma_f32_16x16x32_bf16 v[244:247], v[68:71], v[100:103], v[244:247]
  v_add_u32 v11, s30, v13
  v_mfma_f32_16x16x32_bf16 v[240:243], v[64:67], v[100:103], v[240:243]
  s_waitcnt lgkmcnt(0)
  v_mfma_f32_16x16x32_bf16 v[160:163], v[120:123], v[104:107], v[160:163]
  v_cmp_lt_i32 vcc, s33, v15
  v_mfma_f32_16x16x32_bf16 v[164:167], v[120:123], v[108:111], v[164:167]
  s_cbranch_vccz .g2_kernel_q_w3
.g2_kernel_q_back3:
  v_mfma_f32_16x16x32_bf16 v[168:171], v[120:123], v[112:115], v[168:171]
  ds_read_b64_tr_b16 v[80:81], v10 offset:0
  v_mfma_f32_16x16x32_bf16 v[172:175], v[120:123], v[116:119], v[172:175]
  ds_read_b64_tr_b16 v[82:83], v10 offset:512
  v_mfma_f32_16x16x32_bf16 v[188:191], v[124:127], v[116:119], v[188:191]
  ds_read_b128 v[64:67], v8 offset:32768
  v_mfma_f32_16x16x32_bf16 v[184:187], v[124:127], v[112:115], v[184:187]
  ds_read_b128 v[68:71], v8 offset:34816
  v_mfma_f32_16x16x32_bf16 v[180:183], v[124:127], v[108:111], v[180:183]
  ds_read_b128 v[72:75], v8 offset:36864
  v_mfma_f32_16x16x32_bf16 v[176:179], v[124:127], v[104:107], v[176:179]
  ds_read_b128 v[76:79], v8 offset:38912
  v_mfma_f32_16x16x32_bf16 v[192:195], v[128:131], v[104:107], v[192:195]
  ds_read_b64_tr_b16 v[84:85], v11 offset:0
  v_mfma_f32_16x16x32_bf16 v[196:199], v[128:131], v[108:111], v[196:199]
  ds_read_b64_tr_b16 v[86:87], v11 offset:512
  v_mfma_f32_16x16x32_bf16 v[200:203], v[128:131], v[112:115], v[200:203]
  ds_read_b64_tr_b16 v[88:89], v10 offset:4096
  v_mfma_f32_16x16x32_bf16 v[204:207], v[128:131], v[116:119], v[204:207]
  ds_read_b64_tr_b16 v[90:91], v10 offset:4608
  v_mfma_f32_16x16x32_bf16 v[220:223], v[132:135], v[116:119], v[220:223]
  ds_read_b64_tr_b16 v[92:93], v11 offset:4096
  v_mfma_f32_16x16x32_bf16 v[216:219], v[132:135], v[112:115], v[216:219]
  ds_read_b64_tr_b16 v[94:95], v11 offset:4608
  v_mfma_f32_16x16x32_bf16 v[212:215], v[132:135], v[108:111], v[212:215]
  ds_read_b64_tr_b16 v[96:97], v10 offset:8192
  v_mfma_f32_16x16x32_bf16 v[208:211], v[132:135], v[104:107], v[208:211]
  ds_read_b64_tr_b16 v[98:99], v10 offset:8704
  v_mfma_f32_16x16x32_bf16 v[224:227], v[104:107], v[136:139], v[224:227]
  ds_read_b64_tr_b16 v[100:101], v11 offset:8192
  v_mfma_f32_16x16x32_bf16 v[228:231], v[108:111], v[136:139], v[228:231]
  ds_read_b64_tr_b16 v[102:103], v11 offset:8704
  v_mfma_f32_16x16x32_bf16 v[232:235], v[112:115], v[136:139], v[232:235]
  ds_read_b32 v15, v14
  s_add_u32 s30, s30, 12288
  v_mfma_f32_16x16x32_bf16 v[236:239], v[116:119], v[136:139], v[236:239]
  buffer_load_dword off, s[64:67], s31 lds
  s_cmp_eq_u32 s30, 86016
  v_mfma_f32_16x16x32_bf16 v[252:255], v[116:119], v[140:143], v[252:255]
  s_cselect_b32 s30, 0, s30
  s_add_u32 s31, s31, 4
  v_mfma_f32_16x16x32_bf16 v[248:251], v[112:115], v[140:143], v[248:251]
  v_add_u32 v10, s30, v12
  s_add_u32 s33, s33, 1
  v_mfma_f32_16x16x32_bf16 v[244:247], v[108:111], v[140:143], v[244:247]
  v_add_u32 v11, s30, v13
  v_mfma_f32_16x16x32_bf16 v[240:243], v[104:107], v[140:143], v[240:243]
  s_waitcnt lgkmcnt(0)
  v_mfma_f32_16x16x32_bf16 v[160:163], v[80:83], v[64:67], v[160:163]
  v_cmp_lt_i32 vcc, s33, v15
  v_mfma_f32_16x16x32_bf16 v[164:167], v[80:83], v[68:71], v[164:167]
  s_cbranch_vccz .g2_kernel_q_w4
.g2_kernel_q_back4:
  v_mfma_f32_16x16x32_bf16 v[168:171], v[80:83], v[72:75], v[168:171]
  ds_read_b64_tr_b16 v[120:121], v10 offset:0
  v_mfma_f32_16x16x32_bf16 v[172:175], v[80:83], v[76:79], v[172:175]
  ds_read_b64_tr_b16 v[122:123], v10 offset:512
  v_mfma_f32_16x16x32_bf16 v[188:191], v[84:87], v[76:79], v[188:191]
  ds_read_b128 v[104:107], v9 offset:32768
  v_mfma_f32_16x16x32_bf16 v[184:187], v[84:87], v[72:75], v[184:187]
  ds_read_b128 v[108:111], v9 offset:34816
  v_mfma_f32_16x16x32_bf16 v[180:183], v[84:87], v[68:71], v[180:183]
  ds_read_b128 v[112:115], v9 offset:36864
  v_mfma_f32_16x16x32_bf16 v[176:179], v[84:87], v[64:67], v[176:179]
  ds_read_b128 v[116:119], v9 offset:38912
  v_mfma_f32_16x16x32_bf16 v[192:195], v[88:91], v[64:67], v[192:195]
  ds_read_b64_tr_b16 v[124:125], v11 offset:0
  v_mfma_f32_16x16x32_bf16 v[196:199], v[88:91], v[68:71], v[196:199]
  ds_read_b64_tr_b16 v[126:127], v11 offset:512
  v_mfma_f32_16x16x32_bf16 v[200:203], v[88:91], v[72:75], v[200:203]
  ds_read_b64_tr_b16 v[128:129], v10 offset:4096
  v_mfma_f32_16x16x32_bf16 v[204:207], v[88:91], v[76:79], v[204:207]
  ds_read_b64_tr_b16 v[130:131], v10 offset:4608
  v_mfma_f32_16x16x32_bf16 v[220:223], v[92:95], v[76:79], v[220:223]
  ds_read_b64_tr_b16 v[132:133], v11 offset:4096
  v_mfma_f32_16x16x32_bf16 v[216:219], v[92:95], v[72:75], v[216:219]
  ds_read_b64_tr_b16 v[134:135], v11 offset:4608
  v_mfma_f32_16x16x32_bf16 v[212:215], v[92:95], v[68:71], v[212:215]
  ds_read_b64_tr_b16 v[136:137], v10 offset:8192
  v_mfma_f32_16x16x32_bf16 v[208:211], v[92:95], v[64:67], v[208:211]
  ds_read_b64_tr_b16 v[138:139], v10 offset:8704
  v_mfma_f32_16x16x32_bf16 v[224:227], v[64:67], v[96:99], v[224:227]
  ds_read_b64_tr_b16 v[140:141], v11 offset:8192
  v_mfma_f32_16x16x32_bf16 v[228:231], v[68:71], v[96:99], v[228:231]
  ds_read_b64_tr_b16 v[142:143], v11 offset:8704
  v_mfma_f32_16x16x32_bf16 v[232:235], v[72:75], v[96:99], v[232:235]
  ds_read_b32 v15, v14
  s_add_u32 s30, s30, 12288
  v_mfma_f32_16x16x32_bf16 v[236:239], v[76:79], v[96:99], v[236:239]
  buffer_load_dword off, s[64:67], s31 lds
  s_cmp_eq_u32 s30, 86016
  v_mfma_f32_16x16x32_bf16 v[252:255], v[76:79], v[100:103], v[252:255]
  s_cselect_b32 s30, 0, s30
  s_add_u32 s31, s31, 4
  v_mfma_f32_16x16x32_bf16 v[248:251], v[72:75], v[100:103], v[248:251]
  v_add_u32 v10, s30, v12
  s_add_u32 s33, s33, 1
  v_mfma_f32_16x16x32_bf16 v[244:247], v[68:71], v[100:103], v[244:247]
  v_add_u32 v11, s30, v13
  v_mfma_f32_16x16x32_bf16 v[240:243], v[64:67], v[100:103], v[240:243]
  s_waitcnt lgkmcnt(0)
  v_mfma_f32_16x16x32_bf16 v[160:163], v[120:123], v[104:107], v[160:163]
  v_cmp_lt_i32 vcc, s33, v15
  v_mfma_f32_16x16x32_bf16 v[164:167], v[120:123], v[108:111], v[164:167]
  s_cbranch_vccz .g2_kernel_q_w5
.g2_kernel_q_back5:
  v_mfma_f32_16x16x32_bf16 v[168:171], v[120:123], v[112:115], v[168:171]
  ds_read_b64_tr_b16 v[80:81], v10 offset:0
  v_mfma_f32_16x16x32_bf16 v[172:175], v[120:123], v[116:119], v[172:175]
  ds_read_b64_tr_b16 v[82:83], v10 offset:512
  v_mfma_f32_16x16x32_bf16 v[188:191], v[124:127], v[116:119], v[188:191]
  ds_read_b128 v[64:67], v8 offset:49152
  v_mfma_f32_16x16x32_bf16 v[184:187], v[124:127], v[112:115], v[184:187]
  ds_read_b128 v[68:71], v8 offset:51200
  v_mfma_f32_16x16x32_bf16 v[180:183], v[124:127], v[108:111], v[180:183]
  ds_read_b128 v[72:75], v8 offset:53248
  v_mfma_f32_16x16x32_bf16 v[176:179], v[124:127], v[104:107], v[176:179]
  ds_read_b128 v[76:79], v8 offset:55296
  v_mfma_f32_16x16x32_bf16 v[192:195], v[128:131], v[104:107], v[192:195]
  ds_read_b64_tr_b16 v[84:85], v11 offset:0
  v_mfma_f32_16x16x32_bf16 v[196:199], v[128:131], v[108:111], v[196:199]
  ds_read_b64_tr_b16 v[86:87], v11 offset:512
  v_mfma_f32_16x16x32_bf16 v[200:203], v[128:131], v[112:115], v[200:203]
  ds_read_b64_tr_b16 v[88:89], v10 offset:4096
  v_mfma_f32_16x16x32_bf16 v[204:207], v[128:131], v[116:119], v[204:207]
  ds_read_b64_tr_b16 v[90:91], v10 offset:4608
  v_mfma_f32_16x16x32_bf16 v[220:223], v[132:135], v[116:119], v[220:223]
  ds_read_b64_tr_b16 v[92:93], v11 offset:4096
  v_mfma_f32_16x16x32_bf16 v[216:219], v[132:135], v[112:115], v[216:219]
  ds_read_b64_tr_b16 v[94:95], v11 offset:4608
  v_mfma_f32_16x16x32_bf16 v[212:215], v[132:135], v[108:111], v[212:215]
  ds_read_b64_tr_b16 v[96:97], v10 offset:8192
  v_mfma_f32_16x16x32_bf16 v[208:211], v[132:135], v[104:107], v[208:211]
  ds_read_b64_tr_b16 v[98:99], v10 offset:8704
  v_mfma_f32_16x16x32_bf16 v[224:227], v[104:107], v[136:139], v[224:227]
  ds_read_b64_tr_b16 v[100:101], v11 offset:8192
  v_mfma_f32_16x16x32_bf16 v[228:231], v[108:111], v[136:139], v[228:231]
  ds_read_b64_tr_b16 v[102:103], v11 offset:8704
  v_mfma_f32_16x16x32_bf16 v[232:235], v[112:115], v[136:139], v[232:235]
  ds_read_b32 v15, v14
  s_add_u32 s30, s30, 12288
  v_mfma_f32_16x16x32_bf16 v[236:239], v[116:119], v[136:139], v[236:239]
  buffer_load_dword off, s[64:67], s31 lds
  s_cmp_eq_u32 s30, 86016
  v_mfma_f32_16x16x32_bf16 v[252:255], v[116:119], v[140:143], v[252:255]
  s_cselect_b32 s30, 0, s30
  s_add_u32 s31, s31, 4
  v_mfma_f32_16x16x32_bf16 v[248:251], v[112:115], v[140:143], v[248:251]
  v_add_u32 v10, s30, v12
  s_add_u32 s33, s33, 1
  v_mfma_f32_16x16x32_bf16 v[244:247], v[108:111], v[140:143], v[244:247]
  v_add_u32 v11, s30, v13
  v_mfma_f32_16x16x32_bf16 v[240:243], v[104:107], v[140:143], v[240:243]
  s_waitcnt lgkmcnt(0)
  v_mfma_f32_16x16x32_bf16 v[160:163], v[80:83], v[64:67], v[160:163]
  v_cmp_lt_i32 vcc, s33, v15
  v_mfma_f32_16x16x32_bf16 v[164:167], v[80:83], v[68:71], v[164:167]
  s_cbranch_vccz .g2_kernel_q_w6
.g2_kernel_q_back6:
  v_mfma_f32_16x16x32_bf16 v[168:171], v[80:83], v[72:75], v[168:171]
  ds_read_b64_tr_b16 v[120:121], v10 offset:0
  v_mfma_f32_16x16x32_bf16 v[172:175], v[80:83], v[76:79], v[172:175]
  ds_read_b64_tr_b16 v[122:123], v10 offset:512
  v_mfma_f32_16x16x32_bf16 v[188:191], v[84:87], v[76:79], v[188:191]
  ds_read_b128 v[104:107], v9 offset:49152
  v_mfma_f32_16x16x32_bf16 v[184:187], v[84:87], v[72:75], v[184:187]
  ds_read_b128 v[108:111], v9 offset:51200
  v_mfma_f32_16x16x32_bf16 v[180:183], v[84:87], v[68:71], v[180:183]
  ds_read_b128 v[112:115], v9 offset:53248
  v_mfma_f32_16x16x32_bf16 v[176:179], v[84:87], v[64:67], v[176:179]
  ds_read_b128 v[116:119], v9 offset:55296
  v_mfma_f32_16x16x32_bf16 v[192:195], v[88:91], v[64:67], v[192:195]
  ds_read_b64_tr_b16 v[124:125], v11 offset:0
  v_mfma_f32_16x16x32_bf16 v[196:199], v[88:91], v[68:71], v[196:199]
  ds_read_b64_tr_b16 v[126:127], v11 offset:512
  v_mfma_f32_16x16x32_bf16 v[200:203], v[88:91], v[72:75], v[200:203]
  ds_read_b64_tr_b16 v[128:129], v10 offset:4096
  v_mfma_f32_16x16x32_bf16 v[204:207], v[88:91], v[76:79], v[204:207]
  ds_read_b64_tr_b16 v[130:131], v10 offset:4608
  v_mfma_f32_16x16x32_bf16 v[220:223], v[92:95], v[76:79], v[220:223]
  ds_read_b64_tr_b16 v[132:133], v11 offset:4096
  v_mfma_f32_16x16x32_bf16 v[216:219], v[92:95], v[72:75], v[216:219]
  ds_read_b64_tr_b16 v[134:135], v11 offset:4608
  v_mfma_f32_16x16x32_bf16 v[212:215], v[92:95], v[68:71], v[212:215]
  ds_read_b64_tr_b16 v[136:137], v10 offset:8192
  v_mfma_f32_16x16x32_bf16 v[208:211], v[92:95], v[64:67], v[208:211]
  ds_read_b64_tr_b16 v[138:139], v10 offset:8704
  v_mfma_f32_16x16x32_bf16 v[224:227], v[64:67], v[96:99], v[224:227]
  ds_read_b64_tr_b16 v[140:141], v11 offset:8192
  v_mfma_f32_16x16x32_bf16 v[228:231], v[68:71], v[96:99], v[228:231]
  ds_read_b64_tr_b16 v[142:143], v11 offset:8704
  v_mfma_f32_16x16x32_bf16 v[232:235], v[72:75], v[96:99], v[232:235]
  ds_read_b32 v15, v14
  s_add_u32 s30, s30, 12288
  v_mfma_f32_16x16x32_bf16 v[236:239], v[76:79], v[96:99], v[236:239]
  buffer_load_dword off, s[64:67], s31 lds
  s_cmp_eq_u32 s30, 86016
  v_mfma_f32_16x16x32_bf16 v[252:255], v[76:79], v[100:103], v[252:255]
  s_cselect_b32 s30, 0, s30
  s_add_u32 s31, s31, 4
  v_mfma_f32_16x16x32_bf16 v[248:251], v[72:75], v[100:103], v[248:251]
  v_add_u32 v10, s30, v12
  s_add_u32 s33, s33, 1
  v_mfma_f32_16x16x32_bf16 v[244:247], v[68:71], v[100:103], v[244:247]
  v_add_u32 v11, s30, v13
  s_add_u32 s29, s29, 1
  v_mfma_f32_16x16x32_bf16 v[240:243], v[64:67], v[100:103], v[240:243]
  s_and_b32 s28, s29, 3
  s_cbranch_scc1 .g2_kernel_q_loop
  s_cmp_lg_u32 s29, 0
  s_cbranch_scc1 .g2_kernel_q_last
  s_waitcnt lgkmcnt(0)
.g2_kernel_q_init:
  s_lshl_b32 s28, s16, 8
  s_add_u32 m0, s28, 156416
  s_lshl_b32 s33, s62, 5
  s_lshl_b32 s31, s33, 2
  s_add_u32 s31, s31, .g2_kernel_tab-.g2_kernel_pc+4
  v_mov_b32 v10, v12
  v_mov_b32 v11, v13
  s_mov_b32 s29, 0
  s_cmp_lg_u32 s62, 0
  s_cbranch_scc1 .g2_kernel_q_i2
  v_mov_b32 v160, 0
  v_mov_b32 v161, 0
  v_mov_b32 v162, 0
  v_mov_b32 v163, 0
  v_mov_b32 v164, 0
  v_mov_b32 v165, 0
  v_mov_b32 v166, 0
  v_mov_b32 v167, 0
  v_mov_b32 v168, 0
  v_mov_b32 v169, 0
  v_mov_b32 v170, 0
  v_mov_b32 v171, 0
  v_mov_b32 v172, 0
  v_mov_b32 v173, 0
  v_mov_b32 v174, 0
  v_mov_b32 v175, 0
  v_mov_b32 v176, 0
  v_mov_b32 v177, 0
  v_mov_b32 v178, 0
  v_mov_b32 v179, 0
  v_mov_b32 v180, 0
  v_mov_b32 v181, 0
  v_mov_b32 v182, 0
  v_mov_b32 v183, 0
  v_mov_b32 v184, 0
  v_mov_b32 v185, 0
  v_mov_b32 v186, 0
  v_mov_b32 v187, 0
  v_mov_b32 v188, 0
  v_mov_b32 v189, 0
  v_mov_b32 v190, 0
  v_mov_b32 v191, 0
  v_mov_b32 v192, 0
  v_mov_b32 v193, 0
  v_mov_b32 v194, 0
  v_mov_b32 v195, 0
  v_mov_b32 v196, 0
  v_mov_b32 v197, 0
  v_mov_b32 v198, 0
  v_mov_b32 v199, 0
  v_mov_b32 v200, 0
  v_mov_b32 v201, 0
  v_mov_b32 v202, 0
  v_mov_b32 v203, 0
  v_mov_b32 v204, 0
  v_mov_b32 v205, 0
  v_mov_b32 v206, 0
  v_mov_b32 v207, 0
  v_mov_b32 v208, 0
  v_mov_b32 v209, 0
  v_mov_b32 v210, 0
  v_mov_b32 v211, 0
  v_mov_b32 v212, 0
  v_mov_b32 v213, 0
  v_mov_b32 v214, 0
  v_mov_b32 v215, 0
  v_mov_b32 v216, 0
  v_mov_b32 v217, 0
  v_mov_b32 v218, 0
  v_mov_b32 v219, 0
  v_mov_b32 v220, 0
  v_mov_b32 v221, 0
  v_mov_b32 v222, 0
  v_mov_b32 v223, 0
  v_mov_b32 v224, 0
  v_mov_b32 v225, 0
  v_mov_b32 v226, 0
  v_mov_b32 v227, 0
  v_mov_b32 v228, 0
  v_mov_b32 v229, 0
  v_mov_b32 v230, 0
  v_mov_b32 v231, 0
  v_mov_b32 v232, 0
  v_mov_b32 v233, 0
  v_mov_b32 v234, 0
  v_mov_b32 v235, 0
  v_mov_b32 v236, 0
  v_mov_b32 v237, 0
  v_mov_b32 v238, 0
  v_mov_b32 v239, 0
  v_mov_b32 v240, 0
  v_mov_b32 v241, 0
  v_mov_b32 v242, 0
  v_mov_b32 v243, 0
  v_mov_b32 v244, 0
  v_mov_b32 v245, 0
  v_mov_b32 v246, 0
  v_mov_b32 v247, 0
  v_mov_b32 v248, 0
  v_mov_b32 v249, 0
  v_mov_b32 v250, 0
  v_mov_b32 v251, 0
  v_mov_b32 v252, 0
  v_mov_b32 v253, 0
  v_mov_b32 v254, 0
  v_mov_b32 v255, 0
.g2_kernel_q_i2:
  s_call_b64 s[68:69], .g2_kernel_q_spin
  ds_read_b64_tr_b16 v[80:81], v10 offset:0
  ds_read_b64_tr_b16 v[82:83], v10 offset:512
  ds_read_b128 v[64:67], v8 offset:0
  ds_read_b128 v[68:71], v8 offset:2048
  ds_read_b128 v[72:75], v8 offset:4096
  ds_read_b128 v[76:79], v8 offset:6144
  ds_read_b64_tr_b16 v[84:85], v11 offset:0
  ds_read_b64_tr_b16 v[86:87], v11 offset:512
  ds_read_b64_tr_b16 v[88:89], v10 offset:4096
  ds_read_b64_tr_b16 v[90:91], v10 offset:4608
  ds_read_b64_tr_b16 v[92:93], v11 offset:4096
  ds_read_b64_tr_b16 v[94:95], v11 offset:4608
  ds_read_b64_tr_b16 v[96:97], v10 offset:8192
  ds_read_b64_tr_b16 v[98:99], v10 offset:8704
  ds_read_b64_tr_b16 v[100:101], v11 offset:8192
  ds_read_b64_tr_b16 v[102:103], v11 offset:8704
  s_mov_b32 s30, 12288
  s_add_u32 s33, s33, 1
  v_add_u32 v10, s30, v12
  v_add_u32 v11, s30, v13
  s_branch .g2_kernel_q_s0
.g2_kernel_q_last:
  v_and_b32 v48, 15, v2
  v_lshrrev_b32 v49, 4, v2
  s_lshr_b32 s26, s16, 1
  s_lshl_b32 s28, s26, 8
  s_add_u32 s28, s28, 155648
  v_lshl_add_u32 v50, v48, 2, s28
  v_lshl_add_u32 v51, v49, 4, s28
  s_lshl_b32 s28, s27, 7
  s_add_u32 s28, s28, 155648
  v_lshl_add_u32 v52, v49, 4, s28
  v_lshl_add_u32 v53, v48, 2, s28
  v_lshlrev_b32 v54, 9, v49
  v_lshl_add_u32 v55, v48, 4, v54
  v_and_b32 v56, 8, v48
  v_lshl_add_u32 v54, v56, 4, v55
  v_mov_b32 v57, s71
  v_lshlrev_b32 v58, 8, v2
  v_and_b32 v58, 0x300, v58
  v_add_u32 v58, 156416, v58
  s_lshl_b32 s34, s18, 1
  s_add_u32 s34, s34, s27
  s_lshl_b32 s34, s34, 6
  s_lshl_b32 s35, s17, 2
  s_add_u32 s34, s34, s35
  s_lshl_b32 s35, s26, 1
  s_add_u32 s34, s34, s35
  s_lshl_b32 s34, s34, 12
  s_add_u32 s34, s34, s63
  s_add_u32 s35, s34, 4096
  s_lshl_b32 s28, s26, 13
  v_add_u32 v59, s28, v54
  v_add_u32 v60, s28, v55
  s_lshl_b32 s28, s26, 12
  s_mul_i32 s36, s27, -8192
  s_add_u32 s28, s28, s36
  s_add_u32 s28, s28, 139264
  v_add_u32 v61, s28, v55
  s_sub_u32 s36, s27, 1
  s_mov_b32 s37, s36
  s_lshl_b32 s39, s62, 5
  s_add_u32 s39, s39, 28
  s_waitcnt lgkmcnt(0)
  v_mfma_f32_16x16x32_bf16 v[160:163], v[120:123], v[104:107], v[160:163]
  buffer_load_dword off, s[64:67], s31 lds
  v_mfma_f32_16x16x32_bf16 v[164:167], v[120:123], v[108:111], v[164:167]
  v_mfma_f32_16x16x32_bf16 v[168:171], v[120:123], v[112:115], v[168:171]
  v_mfma_f32_16x16x32_bf16 v[172:175], v[120:123], v[116:119], v[172:175]
  v_mfma_f32_16x16x32_bf16 v[188:191], v[124:127], v[116:119], v[188:191]
  v_mfma_f32_16x16x32_bf16 v[184:187], v[124:127], v[112:115], v[184:187]
  v_mfma_f32_16x16x32_bf16 v[180:183], v[124:127], v[108:111], v[180:183]
  v_mfma_f32_16x16x32_bf16 v[176:179], v[124:127], v[104:107], v[176:179]
  v_mfma_f32_16x16x32_bf16 v[192:195], v[128:131], v[104:107], v[192:195]
  v_mfma_f32_16x16x32_bf16 v[196:199], v[128:131], v[108:111], v[196:199]
  v_mfma_f32_16x16x32_bf16 v[200:203], v[128:131], v[112:115], v[200:203]
  v_mfma_f32_16x16x32_bf16 v[204:207], v[128:131], v[116:119], v[204:207]
  v_mfma_f32_16x16x32_bf16 v[220:223], v[132:135], v[116:119], v[220:223]
  v_mfma_f32_16x16x32_bf16 v[216:219], v[132:135], v[112:115], v[216:219]
  v_mfma_f32_16x16x32_bf16 v[212:215], v[132:135], v[108:111], v[212:215]
  v_mfma_f32_16x16x32_bf16 v[208:211], v[132:135], v[104:107], v[208:211]
  v_mfma_f32_16x16x32_bf16 v[224:227], v[104:107], v[136:139], v[224:227]
  v_mfma_f32_16x16x32_bf16 v[228:231], v[108:111], v[136:139], v[228:231]
  v_mfma_f32_16x16x32_bf16 v[232:235], v[112:115], v[136:139], v[232:235]
  v_mfma_f32_16x16x32_bf16 v[236:239], v[116:119], v[136:139], v[236:239]
  v_mfma_f32_16x16x32_bf16 v[252:255], v[116:119], v[140:143], v[252:255]
  v_mfma_f32_16x16x32_bf16 v[248:251], v[112:115], v[140:143], v[248:251]
  v_mfma_f32_16x16x32_bf16 v[244:247], v[108:111], v[140:143], v[244:247]
  v_mfma_f32_16x16x32_bf16 v[240:243], v[104:107], v[140:143], v[240:243]
  ds_read_b32 v62, v57 offset:0
  ds_read_b32 v63, v58
  s_waitcnt lgkmcnt(0)
  v_cmp_gt_u32 vcc, 2, v62
  v_cmp_gt_u32 s[20:21], s39, v63
  s_or_b64 vcc, vcc, s[20:21]
  s_cbranch_scc1 .g2_kernel_q_ew
.g2_kernel_q_eb:
  ds_read_b32 v62, v57 offset:24
  ds_read_b128 v[32:35], v52 offset:5120
  ds_read_b128 v[36:39], v52 offset:5184
  ds_read_b32 v16, v50 offset:2816
  ds_read_b32 v17, v50 offset:3328
  ds_read_b32 v18, v50 offset:2880
  ds_read_b32 v19, v50 offset:3392
  ds_read_b32 v20, v50 offset:2944
  ds_read_b32 v21, v50 offset:3456
  ds_read_b32 v22, v50 offset:3008
  ds_read_b32 v23, v50 offset:3520
  s_waitcnt lgkmcnt(10)
  v_cmp_ne_u32 vcc, 0, v62
  s_cbranch_vccnz .g2_kernel_q_patch
.g2_kernel_q_pback:
  s_waitcnt lgkmcnt(6)
  v_pk_mul_f32 v[144:145], v[32:33], v[16:17] op_sel:[0,1] op_sel_hi:[1,1]
  v_pk_mul_f32 v[146:147], v[34:35], v[16:17] op_sel:[0,1] op_sel_hi:[1,1]
  v_pk_mul_f32 v[148:149], v[36:37], v[16:17] op_sel:[0,1] op_sel_hi:[1,1]
  v_pk_mul_f32 v[150:151], v[38:39], v[16:17] op_sel:[0,1] op_sel_hi:[1,1]
  v_pk_fma_f32 v[192:193], v[192:193], v[16:17], v[144:145] op_sel_hi:[1,0,1]
  v_pk_fma_f32 v[194:195], v[194:195], v[16:17], v[146:147] op_sel_hi:[1,0,1]
  v_pk_fma_f32 v[208:209], v[208:209], v[16:17], v[148:149] op_sel_hi:[1,0,1]
  v_pk_fma_f32 v[210:211], v[210:211], v[16:17], v[150:151] op_sel_hi:[1,0,1]
  v_cvt_pk_bf16_f32 v192, v192, v193
  v_cvt_pk_bf16_f32 v193, v194, v195
  v_cvt_pk_bf16_f32 v194, v208, v209
  v_cvt_pk_bf16_f32 v195, v210, v211
  buffer_store_dwordx4 v[192:195], v54, s[4:7], s34 offen offset:0 sc1
  ds_read_b128 v[64:67], v51 offset:2816
  ds_read_b128 v[80:83], v51 offset:3328
  ds_read_b32 v40, v53 offset:5376
  s_waitcnt lgkmcnt(7)
  v_pk_mul_f32 v[144:145], v[32:33], v[18:19] op_sel:[0,1] op_sel_hi:[1,1]
  v_pk_mul_f32 v[146:147], v[34:35], v[18:19] op_sel:[0,1] op_sel_hi:[1,1]
  v_pk_mul_f32 v[148:149], v[36:37], v[18:19] op_sel:[0,1] op_sel_hi:[1,1]
  v_pk_mul_f32 v[150:151], v[38:39], v[18:19] op_sel:[0,1] op_sel_hi:[1,1]
  v_pk_fma_f32 v[196:197], v[196:197], v[18:19], v[144:145] op_sel_hi:[1,0,1]
  v_pk_fma_f32 v[198:199], v[198:199], v[18:19], v[146:147] op_sel_hi:[1,0,1]
  v_pk_fma_f32 v[212:213], v[212:213], v[18:19], v[148:149] op_sel_hi:[1,0,1]
  v_pk_fma_f32 v[214:215], v[214:215], v[18:19], v[150:151] op_sel_hi:[1,0,1]
  v_cvt_pk_bf16_f32 v196, v196, v197
  v_cvt_pk_bf16_f32 v197, v198, v199
  v_cvt_pk_bf16_f32 v198, v212, v213
  v_cvt_pk_bf16_f32 v199, v214, v215
  buffer_store_dwordx4 v[196:199], v54, s[4:7], s34 offen offset:128 sc1
  ds_read_b128 v[68:71], v51 offset:2880
  ds_read_b128 v[84:87], v51 offset:3392
  ds_read_b32 v42, v53 offset:5440
  s_waitcnt lgkmcnt(8)
  v_pk_mul_f32 v[144:145], v[32:33], v[20:21] op_sel:[0,1] op_sel_hi:[1,1]
  v_pk_mul_f32 v[146:147], v[34:35], v[20:21] op_sel:[0,1] op_sel_hi:[1,1]
  v_pk_mul_f32 v[148:149], v[36:37], v[20:21] op_sel:[0,1] op_sel_hi:[1,1]
  v_pk_mul_f32 v[150:151], v[38:39], v[20:21] op_sel:[0,1] op_sel_hi:[1,1]
  v_pk_fma_f32 v[200:201], v[200:201], v[20:21], v[144:145] op_sel_hi:[1,0,1]
  v_pk_fma_f32 v[202:203], v[202:203], v[20:21], v[146:147] op_sel_hi:[1,0,1]
  v_pk_fma_f32 v[216:217], v[216:217], v[20:21], v[148:149] op_sel_hi:[1,0,1]
  v_pk_fma_f32 v[218:219], v[218:219], v[20:21], v[150:151] op_sel_hi:[1,0,1]
  v_cvt_pk_bf16_f32 v200, v200, v201
  v_cvt_pk_bf16_f32 v201, v202, v203
  v_cvt_pk_bf16_f32 v202, v216, v217
  v_cvt_pk_bf16_f32 v203, v218, v219
  buffer_store_dwordx4 v[200:203], v54, s[4:7], s35 offen offset:0 sc1
  ds_read_b128 v[72:75], v51 offset:2944
  ds_read_b128 v[88:91], v51 offset:3456
  ds_read_b128 v[24:27], v52 offset:4864
  s_waitcnt lgkmcnt(9)
  v_pk_mul_f32 v[144:145], v[32:33], v[22:23] op_sel:[0,1] op_sel_hi:[1,1]
  v_pk_mul_f32 v[146:147], v[34:35], v[22:23] op_sel:[0,1] op_sel_hi:[1,1]
  v_pk_mul_f32 v[148:149], v[36:37], v[22:23] op_sel:[0,1] op_sel_hi:[1,1]
  v_pk_mul_f32 v[150:151], v[38:39], v[22:23] op_sel:[0,1] op_sel_hi:[1,1]
  v_pk_fma_f32 v[204:205], v[204:205], v[22:23], v[144:145] op_sel_hi:[1,0,1]
  v_pk_fma_f32 v[206:207], v[206:207], v[22:23], v[146:147] op_sel_hi:[1,0,1]
  v_pk_fma_f32 v[220:221], v[220:221], v[22:23], v[148:149] op_sel_hi:[1,0,1]
  v_pk_fma_f32 v[222:223], v[222:223], v[22:23], v[150:151] op_sel_hi:[1,0,1]
  v_cvt_pk_bf16_f32 v204, v204, v205
  v_cvt_pk_bf16_f32 v205, v206, v207
  v_cvt_pk_bf16_f32 v206, v220, v221
  v_cvt_pk_bf16_f32 v207, v222, v223
  buffer_store_dwordx4 v[204:207], v54, s[4:7], s35 offen offset:128 sc1
  ds_read_b128 v[76:79], v51 offset:3008
  ds_read_b128 v[92:95], v51 offset:3520
  ds_read_b128 v[28:31], v52 offset:4928
  s_waitcnt lgkmcnt(0)
  v_pk_mul_f32 v[144:145], v[80:81], v[40:41] op_sel_hi:[1,0]
  v_pk_mul_f32 v[146:147], v[82:83], v[40:41] op_sel_hi:[1,0]
  v_pk_mul_f32 v[148:149], v[84:85], v[40:41] op_sel_hi:[1,0]
  v_pk_mul_f32 v[150:151], v[86:87], v[40:41] op_sel_hi:[1,0]
  v_pk_fma_f32 v[224:225], v[224:225], v[64:65], v[144:145]
  v_pk_fma_f32 v[226:227], v[226:227], v[66:67], v[146:147]
  v_pk_fma_f32 v[228:229], v[228:229], v[68:69], v[148:149]
  v_pk_fma_f32 v[230:231], v[230:231], v[70:71], v[150:151]
  v_cvt_pk_bf16_f32 v224, v224, v225
  v_cvt_pk_bf16_f32 v225, v226, v227
  v_cvt_pk_bf16_f32 v226, v228, v229
  v_cvt_pk_bf16_f32 v227, v230, v231
  buffer_store_dwordx4 v[224:227], v55, s[4:7], s34 offen offset:2048 sc1
  v_pk_mul_f32 v[144:145], v[80:81], v[42:43] op_sel_hi:[1,0]
  v_pk_mul_f32 v[146:147], v[82:83], v[42:43] op_sel_hi:[1,0]
  v_pk_mul_f32 v[148:149], v[84:85], v[42:43] op_sel_hi:[1,0]
  v_pk_mul_f32 v[150:151], v[86:87], v[42:43] op_sel_hi:[1,0]
  v_pk_fma_f32 v[240:241], v[240:241], v[64:65], v[144:145]
  v_pk_fma_f32 v[242:243], v[242:243], v[66:67], v[146:147]
  v_pk_fma_f32 v[244:245], v[244:245], v[68:69], v[148:149]
  v_pk_fma_f32 v[246:247], v[246:247], v[70:71], v[150:151]
  v_cvt_pk_bf16_f32 v240, v240, v241
  v_cvt_pk_bf16_f32 v241, v242, v243
  v_cvt_pk_bf16_f32 v242, v244, v245
  v_cvt_pk_bf16_f32 v243, v246, v247
  buffer_store_dwordx4 v[240:243], v55, s[4:7], s34 offen offset:2304 sc1
  v_pk_mul_f32 v[144:145], v[88:89], v[40:41] op_sel_hi:[1,0]
  v_pk_mul_f32 v[146:147], v[90:91], v[40:41] op_sel_hi:[1,0]
  v_pk_mul_f32 v[148:149], v[92:93], v[40:41] op_sel_hi:[1,0]
  v_pk_mul_f32 v[150:151], v[94:95], v[40:41] op_sel_hi:[1,0]
  v_pk_fma_f32 v[232:233], v[232:233], v[72:73], v[144:145]
  v_pk_fma_f32 v[234:235], v[234:235], v[74:75], v[146:147]
  v_pk_fma_f32 v[236:237], v[236:237], v[76:77], v[148:149]
  v_pk_fma_f32 v[238:239], v[238:239], v[78:79], v[150:151]
  v_cvt_pk_bf16_f32 v232, v232, v233
  v_cvt_pk_bf16_f32 v233, v234, v235
  v_cvt_pk_bf16_f32 v234, v236, v237
  v_cvt_pk_bf16_f32 v235, v238, v239
  buffer_store_dwordx4 v[232:235], v55, s[4:7], s35 offen offset:2048 sc1
  v_pk_mul_f32 v[144:145], v[88:89], v[42:43] op_sel_hi:[1,0]
  v_pk_mul_f32 v[146:147], v[90:91], v[42:43] op_sel_hi:[1,0]
  v_pk_mul_f32 v[148:149], v[92:93], v[42:43] op_sel_hi:[1,0]
  v_pk_mul_f32 v[150:151], v[94:95], v[42:43] op_sel_hi:[1,0]
  v_pk_fma_f32 v[248:249], v[248:249], v[72:73], v[144:145]
  v_pk_fma_f32 v[250:251], v[250:251], v[74:75], v[146:147]
  v_pk_fma_f32 v[252:253], v[252:253], v[76:77], v[148:149]
  v_pk_fma_f32 v[254:255], v[254:255], v[78:79], v[150:151]
  v_cvt_pk_bf16_f32 v248, v248, v249
  v_cvt_pk_bf16_f32 v249, v250, v251
  v_cvt_pk_bf16_f32 v250, v252, v253
  v_cvt_pk_bf16_f32 v251, v254, v255
  buffer_store_dwordx4 v[248:251], v55, s[4:7], s35 offen offset:2304 sc1
  s_mov_b64 exec, s[36:37]
  s_cbranch_execz .g2_kernel_q_nk
  ds_write_b128 v59, v[192:195] offset:0
  ds_write_b128 v59, v[196:199] offset:128
  ds_write_b128 v59, v[200:203] offset:4096
  ds_write_b128 v59, v[204:207] offset:4224
  ds_write_b128 v60, v[224:227] offset:2048
  ds_write_b128 v60, v[240:243] offset:2304
  ds_write_b128 v60, v[232:235] offset:6144
  ds_write_b128 v60, v[248:251] offset:6400
.g2_kernel_q_nk:
  s_mov_b64 exec, -1
  v_mov_b32 v48, 0.25503486164919736
  v_pk_mul_f32 v[16:17], v[16:17], v[48:49] op_sel_hi:[1,0]
  v_pk_mul_f32 v[18:19], v[18:19], v[48:49] op_sel_hi:[1,0]
  v_pk_mul_f32 v[20:21], v[20:21], v[48:49] op_sel_hi:[1,0]
  v_pk_mul_f32 v[22:23], v[22:23], v[48:49] op_sel_hi:[1,0]
  v_pk_mul_f32 v[144:145], v[24:25], v[16:17] op_sel:[0,1] op_sel_hi:[1,1]
  v_pk_mul_f32 v[146:147], v[26:27], v[16:17] op_sel:[0,1] op_sel_hi:[1,1]
  v_pk_mul_f32 v[148:149], v[28:29], v[16:17] op_sel:[0,1] op_sel_hi:[1,1]
  v_pk_mul_f32 v[150:151], v[30:31], v[16:17] op_sel:[0,1] op_sel_hi:[1,1]
  v_pk_fma_f32 v[160:161], v[160:161], v[16:17], v[144:145] op_sel_hi:[1,0,1]
  v_pk_fma_f32 v[162:163], v[162:163], v[16:17], v[146:147] op_sel_hi:[1,0,1]
  v_pk_fma_f32 v[176:177], v[176:177], v[16:17], v[148:149] op_sel_hi:[1,0,1]
  v_pk_fma_f32 v[178:179], v[178:179], v[16:17], v[150:151] op_sel_hi:[1,0,1]
  v_cvt_pk_bf16_f32 v160, v160, v161
  v_cvt_pk_bf16_f32 v161, v162, v163
  v_cvt_pk_bf16_f32 v162, v176, v177
  v_cvt_pk_bf16_f32 v163, v178, v179
  ds_write_b128 v61, v[160:163] offset:0
  v_pk_mul_f32 v[144:145], v[24:25], v[18:19] op_sel:[0,1] op_sel_hi:[1,1]
  v_pk_mul_f32 v[146:147], v[26:27], v[18:19] op_sel:[0,1] op_sel_hi:[1,1]
  v_pk_mul_f32 v[148:149], v[28:29], v[18:19] op_sel:[0,1] op_sel_hi:[1,1]
  v_pk_mul_f32 v[150:151], v[30:31], v[18:19] op_sel:[0,1] op_sel_hi:[1,1]
  v_pk_fma_f32 v[164:165], v[164:165], v[18:19], v[144:145] op_sel_hi:[1,0,1]
  v_pk_fma_f32 v[166:167], v[166:167], v[18:19], v[146:147] op_sel_hi:[1,0,1]
  v_pk_fma_f32 v[180:181], v[180:181], v[18:19], v[148:149] op_sel_hi:[1,0,1]
  v_pk_fma_f32 v[182:183], v[182:183], v[18:19], v[150:151] op_sel_hi:[1,0,1]
  v_cvt_pk_bf16_f32 v164, v164, v165
  v_cvt_pk_bf16_f32 v165, v166, v167
  v_cvt_pk_bf16_f32 v166, v180, v181
  v_cvt_pk_bf16_f32 v167, v182, v183
  ds_write_b128 v61, v[164:167] offset:256
  v_pk_mul_f32 v[144:145], v[24:25], v[20:21] op_sel:[0,1] op_sel_hi:[1,1]
  v_pk_mul_f32 v[146:147], v[26:27], v[20:21] op_sel:[0,1] op_sel_hi:[1,1]
  v_pk_mul_f32 v[148:149], v[28:29], v[20:21] op_sel:[0,1] op_sel_hi:[1,1]
  v_pk_mul_f32 v[150:151], v[30:31], v[20:21] op_sel:[0,1] op_sel_hi:[1,1]
  v_pk_fma_f32 v[168:169], v[168:169], v[20:21], v[144:145] op_sel_hi:[1,0,1]
  v_pk_fma_f32 v[170:171], v[170:171], v[20:21], v[146:147] op_sel_hi:[1,0,1]
  v_pk_fma_f32 v[184:185], v[184:185], v[20:21], v[148:149] op_sel_hi:[1,0,1]
  v_pk_fma_f32 v[186:187], v[186:187], v[20:21], v[150:151] op_sel_hi:[1,0,1]
  v_cvt_pk_bf16_f32 v168, v168, v169
  v_cvt_pk_bf16_f32 v169, v170, v171
  v_cvt_pk_bf16_f32 v170, v184, v185
  v_cvt_pk_bf16_f32 v171, v186, v187
  ds_write_b128 v61, v[168:171] offset:2048
  v_pk_mul_f32 v[144:145], v[24:25], v[22:23] op_sel:[0,1] op_sel_hi:[1,1]
  v_pk_mul_f32 v[146:147], v[26:27], v[22:23] op_sel:[0,1] op_sel_hi:[1,1]
  v_pk_mul_f32 v[148:149], v[28:29], v[22:23] op_sel:[0,1] op_sel_hi:[1,1]
  v_pk_mul_f32 v[150:151], v[30:31], v[22:23] op_sel:[0,1] op_sel_hi:[1,1]
  v_pk_fma_f32 v[172:173], v[172:173], v[22:23], v[144:145] op_sel_hi:[1,0,1]
  v_pk_fma_f32 v[174:175], v[174:175], v[22:23], v[146:147] op_sel_hi:[1,0,1]
  v_pk_fma_f32 v[188:189], v[188:189], v[22:23], v[148:149] op_sel_hi:[1,0,1]
  v_pk_fma_f32 v[190:191], v[190:191], v[22:23], v[150:151] op_sel_hi:[1,0,1]
  v_cvt_pk_bf16_f32 v172, v172, v173
  v_cvt_pk_bf16_f32 v173, v174, v175
  v_cvt_pk_bf16_f32 v174, v188, v189
  v_cvt_pk_bf16_f32 v175, v190, v191
  ds_write_b128 v61, v[172:175] offset:2304
  s_mov_b64 exec, 1
  ds_add_u32 v57, v5 offset:4
  s_mov_b64 exec, -1
.g2_kernel_a:
  v_and_b32 v6, 15, v2
  v_xor_b32 v6, s17, v6
  v_and_b32 v7, 16, v2
  v_add_u32 v6, v6, v7
  s_lshr_b32 s28, s16, 1
  s_lshl_b32 s28, s28, 7
  s_add_u32 s28, s28, 157440
  v_lshl_add_u32 v8, v6, 2, s28
  s_lshl_b32 s28, s16, 12
  v_add_u32 v9, s28, v3
  v_and_b32 v6, 31, v2
  s_lshl_b32 s28, s16, 7
  s_add_u32 s28, s28, 161280
  v_lshl_add_u32 v10, v6, 2, s28
  s_lshl_b32 s28, s16, 2
  s_add_u32 s28, s28, 155968
  v_mov_b32 v11, s28
  s_lshl_b32 s28, s62, 1
  s_add_u32 s28, s28, 1
  v_mov_b32 v12, s28
  v_mov_b32 v13, s71
  v_add_u32 v14, 131072, v3
  v_and_b32 v6, 4, v2
  v_cmp_eq_u32 vcc, 0, v6
  v_mov_b32 v7, 0x3f803f80
  v_and_b32 v6, 1, v2
  v_cndmask_b32 v16, 0, v7, vcc
  v_cndmask_b32 v17, 0, v7, vcc
  v_cndmask_b32 v18, v7, 0, vcc
  v_cndmask_b32 v19, v7, 0, vcc
  v_mul_u32_u24 v20, 0xaaaa, v6
  v_add_u32 v20, 0x4444, v20
  s_lshl_b32 s28, s18, 7
  s_add_u32 s28, s28, s16
  s_lshl_b32 s28, s28, 12
  s_add_u32 s28, s28, s63
  s_add_u32 s20, s60, s28
  s_addc_u32 s21, s61, 0
  s_mov_b32 s24, s17
  s_mov_b32 s25, 14
  s_mov_b32 s26, 0
  s_mov_b32 s27, 4
  s_mov_b32 s34, 0xffff0001
  s_mov_b32 s36, 0
  s_mov_b32 s39, 0
  s_lshl_b32 s28, s16, 2
  s_add_u32 s37, s76, s28
  v_mov_b32 v15, s70
  v_mov_b32 v120, 0
  v_mov_b32 v121, 0
  v_mov_b32 v122, 0
  v_mov_b32 v123, 0
  v_mov_b32 v124, 0
  v_mov_b32 v125, 0
  v_mov_b32 v126, 0
  v_mov_b32 v127, 0
  v_mov_b32 v128, 0
  v_mov_b32 v129, 0
  v_mov_b32 v130, 0
  v_mov_b32 v131, 0
  v_mov_b32 v132, 0
  v_mov_b32 v133, 0
  v_mov_b32 v134, 0
  v_mov_b32 v135, 0
  s_mov_b32 s8, s40
  s_mov_b32 s9, s41
  s_mov_b32 s10, 0x400000
  s_mov_b32 s11, 0x00020000
  v_lshrrev_b32 v6, 5, v2
  v_and_b32 v7, 15, v2
  v_lshlrev_b32 v22, 4, v7
  v_lshl_add_u32 v22, v6, 8, v22
  v_and_b32 v7, 16, v2
  v_lshl_add_u32 v22, v7, 7, v22
  v_and_b32 v7, 31, v2
  v_lshlrev_b32 v23, 4, v6
  v_lshl_add_u32 v23, v7, 11, v23
  s_cmp_lg_u32 s62, 0
  s_cbranch_scc1 .g2_kernel_r2
  s_lshl_b32 s28, s17, 2
  s_add_u32 s28, s28, s16
  s_lshl_b32 s28, s28, 16
  s_lshl_b32 s29, s18, 7
  s_add_u32 s28, s28, s29
  buffer_load_dwordx4 v[240:243], v23, s[8:11], s28 offen offset:0
  buffer_load_dwordx4 v[244:247], v23, s[8:11], s28 offen offset:32
  buffer_load_dwordx4 v[248:251], v23, s[8:11], s28 offen offset:64
  buffer_load_dwordx4 v[252:255], v23, s[8:11], s28 offen offset:96
.g2_kernel_r3:
  v_mov_b32 v6, s71
  s_mov_b32 s38, 0
.g2_kernel_wg1:
  ds_read_b32 v7, v6 offset:4
  s_add_u32 s38, s38, 1
  s_waitcnt lgkmcnt(0)
  v_cmp_le_u32 vcc, 4, v7
  s_cbranch_vccnz .g2_kernel_wg1d
  s_cmp_lt_u32 s38, 524288
  s_cbranch_scc1 .g2_kernel_wg1
.g2_kernel_wg1d:
  ds_read_b128 v[176:179], v9 offset:0
  ds_read_b128 v[180:183], v9 offset:1024
  ds_read_b128 v[24:27], v14 offset:8192
  ds_read_b128 v[28:31], v14 offset:9216
  ds_read_b128 v[184:187], v9 offset:2048
  ds_read_b128 v[188:191], v9 offset:3072
  ds_read_b128 v[32:35], v14 offset:10240
  ds_read_b128 v[36:39], v14 offset:11264
  ds_read_b128 v[40:43], v14 offset:12288
  ds_read_b128 v[44:47], v14 offset:13312
  ds_read_b128 v[48:51], v14 offset:14336
  ds_read_b128 v[52:55], v14 offset:15360
  s_waitcnt lgkmcnt(8)
  v_mfma_f32_32x32x16_bf16 v[136:151], v[176:179], v[24:27], 0
  v_mfma_f32_32x32x16_bf16 v[136:151], v[180:183], v[28:31], v[136:151]
  s_waitcnt lgkmcnt(0)
  s_nop 7
  v_mfma_f32_32x32x16_bf16 v[152:167], v[176:179], v[32:35], 0
  s_nop 1
  v_exp_f32 v136, v136
  v_exp_f32 v137, v137
  v_exp_f32 v138, v138
  v_exp_f32 v139, v139
  v_exp_f32 v140, v140
  v_exp_f32 v141, v141
  v_exp_f32 v142, v142
  v_exp_f32 v143, v143
  v_mfma_f32_32x32x16_bf16 v[152:167], v[180:183], v[36:39], v[152:167]
  s_mov_b64 exec, 1
  ds_add_u32 v13, v5 offset:8
  s_mov_b64 exec, -1
  v_cvt_pk_bf16_f32 v168, v136, v137
  v_cvt_pk_bf16_f32 v169, v138, v139
  v_cvt_pk_bf16_f32 v170, v140, v141
  v_cvt_pk_bf16_f32 v171, v142, v143
  v_exp_f32 v144, v144
  v_exp_f32 v145, v145
  v_exp_f32 v146, v146
  v_exp_f32 v147, v147
  v_mfma_f32_32x32x16_bf16 v[56:71], v[184:187], v[168:171], 0
  v_exp_f32 v148, v148
  v_exp_f32 v149, v149
  v_exp_f32 v150, v150
  v_exp_f32 v151, v151
  v_cvt_pk_bf16_f32 v172, v144, v145
  v_cvt_pk_bf16_f32 v173, v146, v147
  v_cvt_pk_bf16_f32 v174, v148, v149
  v_cvt_pk_bf16_f32 v175, v150, v151
  v_mfma_f32_32x32x16_bf16 v[136:151], v[176:179], v[40:43], 0
  s_waitcnt vmcnt(4)
  s_mov_b64 exec, 1
  buffer_store_dword v15, v4, s[4:7], s37 offen sc1
  s_mov_b64 exec, -1
  v_exp_f32 v152, v152
  v_exp_f32 v153, v153
  v_exp_f32 v154, v154
  v_mfma_f32_32x32x16_bf16 v[56:71], v[188:191], v[172:175], v[56:71]
  v_exp_f32 v155, v155
  v_exp_f32 v156, v156
  v_exp_f32 v157, v157
  v_smfmac_f32_16x16x64_bf16 v[120:123], v[16:19], v[168:175], v20
  v_exp_f32 v158, v158
  v_exp_f32 v159, v159
  v_mfma_f32_32x32x16_bf16 v[136:151], v[180:183], v[44:47], v[136:151]
  v_cvt_pk_bf16_f32 v168, v152, v153
  v_cvt_pk_bf16_f32 v169, v154, v155
  v_cvt_pk_bf16_f32 v170, v156, v157
  v_cvt_pk_bf16_f32 v171, v158, v159
  v_exp_f32 v160, v160
  v_exp_f32 v161, v161
  v_exp_f32 v162, v162
  v_exp_f32 v163, v163
  v_mfma_f32_32x32x16_bf16 v[72:87], v[184:187], v[168:171], 0
  v_exp_f32 v164, v164
  v_exp_f32 v165, v165
  v_exp_f32 v166, v166
  v_exp_f32 v167, v167
  v_cvt_pk_bf16_f32 v172, v160, v161
  v_cvt_pk_bf16_f32 v173, v162, v163
  v_cvt_pk_bf16_f32 v174, v164, v165
  v_cvt_pk_bf16_f32 v175, v166, v167
  v_mfma_f32_32x32x16_bf16 v[152:167], v[176:179], v[48:51], 0
  ds_read_b32 v7, v8
  v_exp_f32 v136, v136
  v_exp_f32 v137, v137
  v_exp_f32 v138, v138
  v_mfma_f32_32x32x16_bf16 v[72:87], v[188:191], v[172:175], v[72:87]
  v_exp_f32 v139, v139
  v_exp_f32 v140, v140
  v_exp_f32 v141, v141
  v_smfmac_f32_16x16x64_bf16 v[124:127], v[16:19], v[168:175], v20
  v_exp_f32 v142, v142
  v_exp_f32 v143, v143
  v_mfma_f32_32x32x16_bf16 v[152:167], v[180:183], v[52:55], v[152:167]
  s_waitcnt lgkmcnt(0)
  v_cmp_lt_u32 vcc, s62, v7
  v_cvt_pk_bf16_f32 v168, v136, v137
  v_cvt_pk_bf16_f32 v169, v138, v139
  v_cvt_pk_bf16_f32 v170, v140, v141
  v_cvt_pk_bf16_f32 v171, v142, v143
  v_exp_f32 v144, v144
  v_exp_f32 v145, v145
  v_exp_f32 v146, v146
  v_exp_f32 v147, v147
  v_mfma_f32_32x32x16_bf16 v[88:103], v[184:187], v[168:171], 0
  s_mov_b32 s36, vcc_lo
  s_andn2_b32 s33, s36, s34
  v_exp_f32 v148, v148
  v_exp_f32 v149, v149
  v_exp_f32 v150, v150
  v_exp_f32 v151, v151
  v_cvt_pk_bf16_f32 v172, v144, v145
  v_cvt_pk_bf16_f32 v173, v146, v147
  v_cvt_pk_bf16_f32 v174, v148, v149
  v_cvt_pk_bf16_f32 v175, v150, v151
  v_exp_f32 v152, v152
  v_exp_f32 v153, v153
  v_exp_f32 v154, v154
  v_mfma_f32_32x32x16_bf16 v[88:103], v[188:191], v[172:175], v[88:103]
  s_bcnt1_i32_b32 s39, s33
  s_cmp_lt_u32 s39, 3
  v_exp_f32 v155, v155
  v_exp_f32 v156, v156
  v_exp_f32 v157, v157
  v_smfmac_f32_16x16x64_bf16 v[128:131], v[16:19], v[168:175], v20
  s_cbranch_scc1 .g2_kernel_a_F0n
  s_call_b64 s[72:73], .g2_kernel_a_three
.g2_kernel_a_F0n:
  v_exp_f32 v158, v158
  v_exp_f32 v159, v159
  v_cvt_pk_bf16_f32 v168, v152, v153
  v_cvt_pk_bf16_f32 v169, v154, v155
  v_cvt_pk_bf16_f32 v170, v156, v157
  v_cvt_pk_bf16_f32 v171, v158, v159
  v_exp_f32 v160, v160
  v_exp_f32 v161, v161
  v_exp_f32 v162, v162
  v_exp_f32 v163, v163
  v_mfma_f32_32x32x16_bf16 v[104:119], v[184:187], v[168:171], 0
  v_exp_f32 v164, v164
  v_exp_f32 v165, v165
  v_exp_f32 v166, v166
  v_exp_f32 v167, v167
  v_cvt_pk_bf16_f32 v172, v160, v161
  v_cvt_pk_bf16_f32 v173, v162, v163
  v_cvt_pk_bf16_f32 v174, v164, v165
  v_cvt_pk_bf16_f32 v175, v166, v167
  s_cmp_ge_u32 s39, 3
  s_cbranch_scc1 .g2_kernel_a_p1
  s_call_b64 s[72:73], .g2_kernel_a_three
.g2_kernel_a_p1:
  s_waitcnt vmcnt(10)
  v_mfma_f32_32x32x16_bf16 v[136:151], v[192:195], v[24:27], 0
  v_mfma_f32_32x32x16_bf16 v[136:151], v[196:199], v[28:31], v[136:151]
  s_waitcnt vmcnt(8)
  s_mov_b32 s32, 0
  s_nop 8
  s_branch .g2_kernel_a_n1
  .p2align 6
.g2_kernel_a_loop:
  v_mfma_f32_32x32x16_bf16 v[152:167], v[176:179], v[32:35], 0
  s_andn2_b32 s33, s36, s34
  v_exp_f32 v136, v136
  v_exp_f32 v137, v137
  v_exp_f32 v138, v138
  v_mfma_f32_32x32x16_bf16 v[104:119], v[236:239], v[172:175], v[104:119]
  s_cbranch_scc0 .g2_kernel_a_N0c
.g2_kernel_a_N0b:
  v_exp_f32 v139, v139
  v_exp_f32 v140, v140
  v_exp_f32 v141, v141
  v_smfmac_f32_16x16x64_bf16 v[132:135], v[16:19], v[168:175], v20
  s_ff1_i32_b32 s33, s33
  v_exp_f32 v142, v142
  v_exp_f32 v143, v143
  v_mfma_f32_32x32x16_bf16 v[152:167], v[180:183], v[36:39], v[152:167]
  s_bitset1_b32 s34, s33
  v_cvt_pk_bf16_f32 v168, v136, v137
  v_cvt_pk_bf16_f32 v169, v138, v139
  v_cvt_pk_bf16_f32 v170, v140, v141
  v_cvt_pk_bf16_f32 v171, v142, v143
  v_exp_f32 v144, v144
  v_exp_f32 v145, v145
  v_exp_f32 v146, v146
  v_exp_f32 v147, v147
  v_mfma_f32_32x32x16_bf16 v[56:71], v[184:187], v[168:171], v[56:71]
  s_xor_b32 s33, s33, s24
  v_exp_f32 v148, v148
  v_exp_f32 v149, v149
  v_exp_f32 v150, v150
  v_exp_f32 v151, v151
  v_cvt_pk_bf16_f32 v172, v144, v145
  v_cvt_pk_bf16_f32 v173, v146, v147
  v_cvt_pk_bf16_f32 v174, v148, v149
  v_cvt_pk_bf16_f32 v175, v150, v151
  v_mfma_f32_32x32x16_bf16 v[136:151], v[176:179], v[40:43], 0
  s_lshl_b32 s33, s33, s25
  v_exp_f32 v152, v152
  v_exp_f32 v153, v153
  v_exp_f32 v154, v154
  v_mfma_f32_32x32x16_bf16 v[56:71], v[188:191], v[172:175], v[56:71]
  s_add_u32 s22, s20, s33
  v_exp_f32 v155, v155
  v_exp_f32 v156, v156
  v_exp_f32 v157, v157
  v_smfmac_f32_16x16x64_bf16 v[120:123], v[16:19], v[168:175], v20
  s_addc_u32 s23, s21, 0
  v_exp_f32 v158, v158
  v_exp_f32 v159, v159
  v_mfma_f32_32x32x16_bf16 v[136:151], v[180:183], v[44:47], v[136:151]
  global_load_dwordx4 v[224:227], v3, s[22:23] offset:0
  global_load_dwordx4 v[228:231], v3, s[22:23] offset:1024
  global_load_dwordx4 v[232:235], v3, s[22:23] offset:2048
  global_load_dwordx4 v[236:239], v3, s[22:23] offset:3072
  v_cvt_pk_bf16_f32 v168, v152, v153
  v_cvt_pk_bf16_f32 v169, v154, v155
  v_cvt_pk_bf16_f32 v170, v156, v157
  v_cvt_pk_bf16_f32 v171, v158, v159
  v_exp_f32 v160, v160
  v_exp_f32 v161, v161
  v_exp_f32 v162, v162
  v_exp_f32 v163, v163
  v_mfma_f32_32x32x16_bf16 v[72:87], v[184:187], v[168:171], v[72:87]
  v_exp_f32 v164, v164
  v_exp_f32 v165, v165
  v_exp_f32 v166, v166
  v_exp_f32 v167, v167
  v_cvt_pk_bf16_f32 v172, v160, v161
  v_cvt_pk_bf16_f32 v173, v162, v163
  v_cvt_pk_bf16_f32 v174, v164, v165
  v_cvt_pk_bf16_f32 v175, v166, v167
  v_mfma_f32_32x32x16_bf16 v[152:167], v[176:179], v[48:51], 0
  v_exp_f32 v136, v136
  v_exp_f32 v137, v137
  v_exp_f32 v138, v138
  v_mfma_f32_32x32x16_bf16 v[72:87], v[188:191], v[172:175], v[72:87]
  v_exp_f32 v139, v139
  v_exp_f32 v140, v140
  v_exp_f32 v141, v141
  v_smfmac_f32_16x16x64_bf16 v[124:127], v[16:19], v[168:175], v20
  v_exp_f32 v142, v142
  v_exp_f32 v143, v143
  v_mfma_f32_32x32x16_bf16 v[152:167], v[180:183], v[52:55], v[152:167]
  v_cvt_pk_bf16_f32 v168, v136, v137
  v_cvt_pk_bf16_f32 v169, v138, v139
  v_cvt_pk_bf16_f32 v170, v140, v141
  v_cvt_pk_bf16_f32 v171, v142, v143
  v_exp_f32 v144, v144
  v_exp_f32 v145, v145
  v_exp_f32 v146, v146
  v_exp_f32 v147, v147
  v_mfma_f32_32x32x16_bf16 v[88:103], v[184:187], v[168:171], v[88:103]
  s_waitcnt vmcnt(8)
  v_exp_f32 v148, v148
  v_exp_f32 v149, v149
  v_exp_f32 v150, v150
  v_exp_f32 v151, v151
  v_cvt_pk_bf16_f32 v172, v144, v145
  v_cvt_pk_bf16_f32 v173, v146, v147
  v_cvt_pk_bf16_f32 v174, v148, v149
  v_cvt_pk_bf16_f32 v175, v150, v151
  v_mfma_f32_32x32x16_bf16 v[136:151], v[192:195], v[24:27], 0
  v_exp_f32 v152, v152
  v_exp_f32 v153, v153
  v_exp_f32 v154, v154
  v_mfma_f32_32x32x16_bf16 v[88:103], v[188:191], v[172:175], v[88:103]
  v_exp_f32 v155, v155
  v_exp_f32 v156, v156
  v_exp_f32 v157, v157
  v_smfmac_f32_16x16x64_bf16 v[128:131], v[16:19], v[168:175], v20
  v_exp_f32 v158, v158
  v_exp_f32 v159, v159
  v_mfma_f32_32x32x16_bf16 v[136:151], v[196:199], v[28:31], v[136:151]
  v_cvt_pk_bf16_f32 v168, v152, v153
  v_cvt_pk_bf16_f32 v169, v154, v155
  v_cvt_pk_bf16_f32 v170, v156, v157
  v_cvt_pk_bf16_f32 v171, v158, v159
  v_exp_f32 v160, v160
  v_exp_f32 v161, v161
  v_exp_f32 v162, v162
  v_exp_f32 v163, v163
  v_mfma_f32_32x32x16_bf16 v[104:119], v[184:187], v[168:171], v[104:119]
  v_exp_f32 v164, v164
  v_exp_f32 v165, v165
  v_exp_f32 v166, v166
  v_exp_f32 v167, v167
  v_cvt_pk_bf16_f32 v172, v160, v161
  v_cvt_pk_bf16_f32 v173, v162, v163
  v_cvt_pk_bf16_f32 v174, v164, v165
  v_cvt_pk_bf16_f32 v175, v166, v167
.g2_kernel_a_n1:
  v_mfma_f32_32x32x16_bf16 v[152:167], v[192:195], v[32:35], 0
  s_andn2_b32 s33, s36, s34
  v_exp_f32 v136, v136
  v_exp_f32 v137, v137
  v_exp_f32 v138, v138
  v_mfma_f32_32x32x16_bf16 v[104:119], v[188:191], v[172:175], v[104:119]
  s_cbranch_scc0 .g2_kernel_a_N1c
.g2_kernel_a_N1b:
  v_exp_f32 v139, v139
  v_exp_f32 v140, v140
  v_exp_f32 v141, v141
  v_smfmac_f32_16x16x64_bf16 v[132:135], v[16:19], v[168:175], v20
  s_ff1_i32_b32 s33, s33
  v_exp_f32 v142, v142
  v_exp_f32 v143, v143
  v_mfma_f32_32x32x16_bf16 v[152:167], v[196:199], v[36:39], v[152:167]
  s_bitset1_b32 s34, s33
  v_cvt_pk_bf16_f32 v168, v136, v137
  v_cvt_pk_bf16_f32 v169, v138, v139
  v_cvt_pk_bf16_f32 v170, v140, v141
  v_cvt_pk_bf16_f32 v171, v142, v143
  v_exp_f32 v144, v144
  v_exp_f32 v145, v145
  v_exp_f32 v146, v146
  v_exp_f32 v147, v147
  v_mfma_f32_32x32x16_bf16 v[56:71], v[200:203], v[168:171], v[56:71]
  s_xor_b32 s33, s33, s24
  v_exp_f32 v148, v148
  v_exp_f32 v149, v149
  v_exp_f32 v150, v150
  v_exp_f32 v151, v151
  v_cvt_pk_bf16_f32 v172, v144, v145
  v_cvt_pk_bf16_f32 v173, v146, v147
  v_cvt_pk_bf16_f32 v174, v148, v149
  v_cvt_pk_bf16_f32 v175, v150, v151
  v_mfma_f32_32x32x16_bf16 v[136:151], v[192:195], v[40:43], 0
  s_lshl_b32 s33, s33, s25
  v_exp_f32 v152, v152
  v_exp_f32 v153, v153
  v_exp_f32 v154, v154
  v_mfma_f32_32x32x16_bf16 v[56:71], v[204:207], v[172:175], v[56:71]
  s_add_u32 s22, s20, s33
  v_exp_f32 v155, v155
  v_exp_f32 v156, v156
  v_exp_f32 v157, v157
  v_smfmac_f32_16x16x64_bf16 v[120:123], v[16:19], v[168:175], v20
  s_addc_u32 s23, s21, 0
  v_exp_f32 v158, v158
  v_exp_f32 v159, v159
  v_mfma_f32_32x32x16_bf16 v[136:151], v[196:199], v[44:47], v[136:151]
  global_load_dwordx4 v[176:179], v3, s[22:23] offset:0
  global_load_dwordx4 v[180:183], v3, s[22:23] offset:1024
  global_load_dwordx4 v[184:187], v3, s[22:23] offset:2048
  global_load_dwordx4 v[188:191], v3, s[22:23] offset:3072
  v_cvt_pk_bf16_f32 v168, v152, v153
  v_cvt_pk_bf16_f32 v169, v154, v155
  v_cvt_pk_bf16_f32 v170, v156, v157
  v_cvt_pk_bf16_f32 v171, v158, v159
  v_exp_f32 v160, v160
  v_exp_f32 v161, v161
  v_exp_f32 v162, v162
  v_exp_f32 v163, v163
  v_mfma_f32_32x32x16_bf16 v[72:87], v[200:203], v[168:171], v[72:87]
  v_exp_f32 v164, v164
  v_exp_f32 v165, v165
  v_exp_f32 v166, v166
  v_exp_f32 v167, v167
  v_cvt_pk_bf16_f32 v172, v160, v161
  v_cvt_pk_bf16_f32 v173, v162, v163
  v_cvt_pk_bf16_f32 v174, v164, v165
  v_cvt_pk_bf16_f32 v175, v166, v167
  v_mfma_f32_32x32x16_bf16 v[152:167], v[192:195], v[48:51], 0
  v_exp_f32 v136, v136
  v_exp_f32 v137, v137
  v_exp_f32 v138, v138
  v_mfma_f32_32x32x16_bf16 v[72:87], v[204:207], v[172:175], v[72:87]
  v_exp_f32 v139, v139
  v_exp_f32 v140, v140
  v_exp_f32 v141, v141
  v_smfmac_f32_16x16x64_bf16 v[124:127], v[16:19], v[168:175], v20
  v_exp_f32 v142, v142
  v_exp_f32 v143, v143
  v_mfma_f32_32x32x16_bf16 v[152:167], v[196:199], v[52:55], v[152:167]
  v_cvt_pk_bf16_f32 v168, v136, v137
  v_cvt_pk_bf16_f32 v169, v138, v139
  v_cvt_pk_bf16_f32 v170, v140, v141
  v_cvt_pk_bf16_f32 v171, v142, v143
  v_exp_f32 v144, v144
  v_exp_f32 v145, v145
  v_exp_f32 v146, v146
  v_exp_f32 v147, v147
  v_mfma_f32_32x32x16_bf16 v[88:103], v[200:203], v[168:171], v[88:103]
  s_waitcnt vmcnt(8)
  v_exp_f32 v148, v148
  v_exp_f32 v149, v149
  v_exp_f32 v150, v150
  v_exp_f32 v151, v151
  v_cvt_pk_bf16_f32 v172, v144, v145
  v_cvt_pk_bf16_f32 v173, v146, v147
  v_cvt_pk_bf16_f32 v174, v148, v149
  v_cvt_pk_bf16_f32 v175, v150, v151
  v_mfma_f32_32x32x16_bf16 v[136:151], v[208:211], v[24:27], 0
  v_exp_f32 v152, v152
  v_exp_f32 v153, v153
  v_exp_f32 v154, v154
  v_mfma_f32_32x32x16_bf16 v[88:103], v[204:207], v[172:175], v[88:103]
  v_exp_f32 v155, v155
  v_exp_f32 v156, v156
  v_exp_f32 v157, v157
  v_smfmac_f32_16x16x64_bf16 v[128:131], v[16:19], v[168:175], v20
  v_exp_f32 v158, v158
  v_exp_f32 v159, v159
  v_mfma_f32_32x32x16_bf16 v[136:151], v[212:215], v[28:31], v[136:151]
  v_cvt_pk_bf16_f32 v168, v152, v153
  v_cvt_pk_bf16_f32 v169, v154, v155
  v_cvt_pk_bf16_f32 v170, v156, v157
  v_cvt_pk_bf16_f32 v171, v158, v159
  v_exp_f32 v160, v160
  v_exp_f32 v161, v161
  v_exp_f32 v162, v162
  v_exp_f32 v163, v163
  v_mfma_f32_32x32x16_bf16 v[104:119], v[200:203], v[168:171], v[104:119]
  v_exp_f32 v164, v164
  v_exp_f32 v165, v165
  v_exp_f32 v166, v166
  v_exp_f32 v167, v167
  v_cvt_pk_bf16_f32 v172, v160, v161
  v_cvt_pk_bf16_f32 v173, v162, v163
  v_cvt_pk_bf16_f32 v174, v164, v165
  v_cvt_pk_bf16_f32 v175, v166, v167
  v_mfma_f32_32x32x16_bf16 v[152:167], v[208:211], v[32:35], 0
  s_andn2_b32 s33, s36, s34
  v_exp_f32 v136, v136
  v_exp_f32 v137, v137
  v_exp_f32 v138, v138
  v_mfma_f32_32x32x16_bf16 v[104:119], v[204:207], v[172:175], v[104:119]
  s_cbranch_scc0 .g2_kernel_a_N2c
.g2_kernel_a_N2b:
  v_exp_f32 v139, v139
  v_exp_f32 v140, v140
  v_exp_f32 v141, v141
  v_smfmac_f32_16x16x64_bf16 v[132:135], v[16:19], v[168:175], v20
  s_ff1_i32_b32 s33, s33
  v_exp_f32 v142, v142
  v_exp_f32 v143, v143
  v_mfma_f32_32x32x16_bf16 v[152:167], v[212:215], v[36:39], v[152:167]
  s_bitset1_b32 s34, s33
  v_cvt_pk_bf16_f32 v168, v136, v137
  v_cvt_pk_bf16_f32 v169, v138, v139
  v_cvt_pk_bf16_f32 v170, v140, v141
  v_cvt_pk_bf16_f32 v171, v142, v143
  v_exp_f32 v144, v144
  v_exp_f32 v145, v145
  v_exp_f32 v146, v146
  v_exp_f32 v147, v147
  v_mfma_f32_32x32x16_bf16 v[56:71], v[216:219], v[168:171], v[56:71]
  s_xor_b32 s33, s33, s24
  v_exp_f32 v148, v148
  v_exp_f32 v149, v149
  v_exp_f32 v150, v150
  v_exp_f32 v151, v151
  v_cvt_pk_bf16_f32 v172, v144, v145
  v_cvt_pk_bf16_f32 v173, v146, v147
  v_cvt_pk_bf16_f32 v174, v148, v149
  v_cvt_pk_bf16_f32 v175, v150, v151
  v_mfma_f32_32x32x16_bf16 v[136:151], v[208:211], v[40:43], 0
  s_lshl_b32 s33, s33, s25
  v_exp_f32 v152, v152
  v_exp_f32 v153, v153
  v_exp_f32 v154, v154
  v_mfma_f32_32x32x16_bf16 v[56:71], v[220:223], v[172:175], v[56:71]
  s_add_u32 s22, s20, s33
  v_exp_f32 v155, v155
  v_exp_f32 v156, v156
  v_exp_f32 v157, v157
  v_smfmac_f32_16x16x64_bf16 v[120:123], v[16:19], v[168:175], v20
  s_addc_u32 s23, s21, 0
  v_exp_f32 v158, v158
  v_exp_f32 v159, v159
  v_mfma_f32_32x32x16_bf16 v[136:151], v[212:215], v[44:47], v[136:151]
  global_load_dwordx4 v[192:195], v3, s[22:23] offset:0
  global_load_dwordx4 v[196:199], v3, s[22:23] offset:1024
  global_load_dwordx4 v[200:203], v3, s[22:23] offset:2048
  global_load_dwordx4 v[204:207], v3, s[22:23] offset:3072
  v_cvt_pk_bf16_f32 v168, v152, v153
  v_cvt_pk_bf16_f32 v169, v154, v155
  v_cvt_pk_bf16_f32 v170, v156, v157
  v_cvt_pk_bf16_f32 v171, v158, v159
  v_exp_f32 v160, v160
  v_exp_f32 v161, v161
  v_exp_f32 v162, v162
  v_exp_f32 v163, v163
  v_mfma_f32_32x32x16_bf16 v[72:87], v[216:219], v[168:171], v[72:87]
  v_exp_f32 v164, v164
  v_exp_f32 v165, v165
  v_exp_f32 v166, v166
  v_exp_f32 v167, v167
  v_cvt_pk_bf16_f32 v172, v160, v161
  v_cvt_pk_bf16_f32 v173, v162, v163
  v_cvt_pk_bf16_f32 v174, v164, v165
  v_cvt_pk_bf16_f32 v175, v166, v167
  v_mfma_f32_32x32x16_bf16 v[152:167], v[208:211], v[48:51], 0
  v_exp_f32 v136, v136
  v_exp_f32 v137, v137
  v_exp_f32 v138, v138
  v_mfma_f32_32x32x16_bf16 v[72:87], v[220:223], v[172:175], v[72:87]
  v_exp_f32 v139, v139
  v_exp_f32 v140, v140
  v_exp_f32 v141, v141
  v_smfmac_f32_16x16x64_bf16 v[124:127], v[16:19], v[168:175], v20
  v_exp_f32 v142, v142
  v_exp_f32 v143, v143
  v_mfma_f32_32x32x16_bf16 v[152:167], v[212:215], v[52:55], v[152:167]
  v_cvt_pk_bf16_f32 v168, v136, v137
  v_cvt_pk_bf16_f32 v169, v138, v139
  v_cvt_pk_bf16_f32 v170, v140, v141
  v_cvt_pk_bf16_f32 v171, v142, v143
  v_exp_f32 v144, v144
  v_exp_f32 v145, v145
  v_exp_f32 v146, v146
  v_exp_f32 v147, v147
  v_mfma_f32_32x32x16_bf16 v[88:103], v[216:219], v[168:171], v[88:103]
  s_waitcnt vmcnt(8)
  v_exp_f32 v148, v148
  v_exp_f32 v149, v149
  v_exp_f32 v150, v150
  v_exp_f32 v151, v151
  v_cvt_pk_bf16_f32 v172, v144, v145
  v_cvt_pk_bf16_f32 v173, v146, v147
  v_cvt_pk_bf16_f32 v174, v148, v149
  v_cvt_pk_bf16_f32 v175, v150, v151
  v_mfma_f32_32x32x16_bf16 v[136:151], v[224:227], v[24:27], 0
  v_exp_f32 v152, v152
  v_exp_f32 v153, v153
  v_exp_f32 v154, v154
  v_mfma_f32_32x32x16_bf16 v[88:103], v[220:223], v[172:175], v[88:103]
  v_exp_f32 v155, v155
  v_exp_f32 v156, v156
  v_exp_f32 v157, v157
  v_smfmac_f32_16x16x64_bf16 v[128:131], v[16:19], v[168:175], v20
  v_exp_f32 v158, v158
  v_exp_f32 v159, v159
  v_mfma_f32_32x32x16_bf16 v[136:151], v[228:231], v[28:31], v[136:151]
  s_and_b32 s28, s32, 3
  v_cvt_pk_bf16_f32 v168, v152, v153
  v_cvt_pk_bf16_f32 v169, v154, v155
  v_cvt_pk_bf16_f32 v170, v156, v157
  v_cvt_pk_bf16_f32 v171, v158, v159
  v_exp_f32 v160, v160
  v_exp_f32 v161, v161
  v_exp_f32 v162, v162
  v_exp_f32 v163, v163
  v_mfma_f32_32x32x16_bf16 v[104:119], v[216:219], v[168:171], v[104:119]
  s_cmp_eq_u32 s28, 3
  v_exp_f32 v164, v164
  v_exp_f32 v165, v165
  v_exp_f32 v166, v166
  v_exp_f32 v167, v167
  v_cvt_pk_bf16_f32 v172, v160, v161
  v_cvt_pk_bf16_f32 v173, v162, v163
  v_cvt_pk_bf16_f32 v174, v164, v165
  v_cvt_pk_bf16_f32 v175, v166, v167
  s_cbranch_scc1 .g2_kernel_a_last
  v_mfma_f32_32x32x16_bf16 v[152:167], v[224:227], v[32:35], 0
  s_andn2_b32 s33, s36, s34
  v_exp_f32 v136, v136
  v_exp_f32 v137, v137
  v_exp_f32 v138, v138
  v_mfma_f32_32x32x16_bf16 v[104:119], v[220:223], v[172:175], v[104:119]
  s_cbranch_scc0 .g2_kernel_a_N3c
.g2_kernel_a_N3b:
  v_exp_f32 v139, v139
  v_exp_f32 v140, v140
  v_exp_f32 v141, v141
  v_smfmac_f32_16x16x64_bf16 v[132:135], v[16:19], v[168:175], v20
  s_ff1_i32_b32 s33, s33
  v_exp_f32 v142, v142
  v_exp_f32 v143, v143
  v_mfma_f32_32x32x16_bf16 v[152:167], v[228:231], v[36:39], v[152:167]
  s_bitset1_b32 s34, s33
  v_cvt_pk_bf16_f32 v168, v136, v137
  v_cvt_pk_bf16_f32 v169, v138, v139
  v_cvt_pk_bf16_f32 v170, v140, v141
  v_cvt_pk_bf16_f32 v171, v142, v143
  v_exp_f32 v144, v144
  v_exp_f32 v145, v145
  v_exp_f32 v146, v146
  v_exp_f32 v147, v147
  v_mfma_f32_32x32x16_bf16 v[56:71], v[232:235], v[168:171], v[56:71]
  s_xor_b32 s33, s33, s24
  v_exp_f32 v148, v148
  v_exp_f32 v149, v149
  v_exp_f32 v150, v150
  v_exp_f32 v151, v151
  v_cvt_pk_bf16_f32 v172, v144, v145
  v_cvt_pk_bf16_f32 v173, v146, v147
  v_cvt_pk_bf16_f32 v174, v148, v149
  v_cvt_pk_bf16_f32 v175, v150, v151
  v_mfma_f32_32x32x16_bf16 v[136:151], v[224:227], v[40:43], 0
  s_lshl_b32 s33, s33, s25
  v_exp_f32 v152, v152
  v_exp_f32 v153, v153
  v_exp_f32 v154, v154
  v_mfma_f32_32x32x16_bf16 v[56:71], v[236:239], v[172:175], v[56:71]
  s_add_u32 s22, s20, s33
  v_exp_f32 v155, v155
  v_exp_f32 v156, v156
  v_exp_f32 v157, v157
  v_smfmac_f32_16x16x64_bf16 v[120:123], v[16:19], v[168:175], v20
  s_addc_u32 s23, s21, 0
  v_exp_f32 v158, v158
  v_exp_f32 v159, v159
  v_mfma_f32_32x32x16_bf16 v[136:151], v[228:231], v[44:47], v[136:151]
  global_load_dwordx4 v[208:211], v3, s[22:23] offset:0
  global_load_dwordx4 v[212:215], v3, s[22:23] offset:1024
  global_load_dwordx4 v[216:219], v3, s[22:23] offset:2048
  global_load_dwordx4 v[220:223], v3, s[22:23] offset:3072
  v_cvt_pk_bf16_f32 v168, v152, v153
  v_cvt_pk_bf16_f32 v169, v154, v155
  v_cvt_pk_bf16_f32 v170, v156, v157
  v_cvt_pk_bf16_f32 v171, v158, v159
  v_exp_f32 v160, v160
  v_exp_f32 v161, v161
  v_exp_f32 v162, v162
  v_exp_f32 v163, v163
  v_mfma_f32_32x32x16_bf16 v[72:87], v[232:235], v[168:171], v[72:87]
  v_exp_f32 v164, v164
  v_exp_f32 v165, v165
  v_exp_f32 v166, v166
  v_exp_f32 v167, v167
  v_cvt_pk_bf16_f32 v172, v160, v161
  v_cvt_pk_bf16_f32 v173, v162, v163
  v_cvt_pk_bf16_f32 v174, v164, v165
  v_cvt_pk_bf16_f32 v175, v166, v167
  v_mfma_f32_32x32x16_bf16 v[152:167], v[224:227], v[48:51], 0
  v_exp_f32 v136, v136
  v_exp_f32 v137, v137
  v_exp_f32 v138, v138
  v_mfma_f32_32x32x16_bf16 v[72:87], v[236:239], v[172:175], v[72:87]
  v_exp_f32 v139, v139
  v_exp_f32 v140, v140
  v_exp_f32 v141, v141
  v_smfmac_f32_16x16x64_bf16 v[124:127], v[16:19], v[168:175], v20
  v_exp_f32 v142, v142
  v_exp_f32 v143, v143
  v_mfma_f32_32x32x16_bf16 v[152:167], v[228:231], v[52:55], v[152:167]
  v_cvt_pk_bf16_f32 v168, v136, v137
  v_cvt_pk_bf16_f32 v169, v138, v139
  v_cvt_pk_bf16_f32 v170, v140, v141
  v_cvt_pk_bf16_f32 v171, v142, v143
  v_exp_f32 v144, v144
  v_exp_f32 v145, v145
  v_exp_f32 v146, v146
  v_exp_f32 v147, v147
  v_mfma_f32_32x32x16_bf16 v[88:103], v[232:235], v[168:171], v[88:103]
  s_waitcnt vmcnt(8)
  v_exp_f32 v148, v148
  v_exp_f32 v149, v149
  v_exp_f32 v150, v150
  v_exp_f32 v151, v151
  v_cvt_pk_bf16_f32 v172, v144, v145
  v_cvt_pk_bf16_f32 v173, v146, v147
  v_cvt_pk_bf16_f32 v174, v148, v149
  v_cvt_pk_bf16_f32 v175, v150, v151
  v_mfma_f32_32x32x16_bf16 v[136:151], v[176:179], v[24:27], 0
  v_exp_f32 v152, v152
  v_exp_f32 v153, v153
  v_exp_f32 v154, v154
  v_mfma_f32_32x32x16_bf16 v[88:103], v[236:239], v[172:175], v[88:103]
  v_exp_f32 v155, v155
  v_exp_f32 v156, v156
  v_exp_f32 v157, v157
  v_smfmac_f32_16x16x64_bf16 v[128:131], v[16:19], v[168:175], v20
  v_exp_f32 v158, v158
  v_exp_f32 v159, v159
  v_mfma_f32_32x32x16_bf16 v[136:151], v[180:183], v[28:31], v[136:151]
  v_cvt_pk_bf16_f32 v168, v152, v153
  v_cvt_pk_bf16_f32 v169, v154, v155
  v_cvt_pk_bf16_f32 v170, v156, v157
  v_cvt_pk_bf16_f32 v171, v158, v159
  v_exp_f32 v160, v160
  v_exp_f32 v161, v161
  v_exp_f32 v162, v162
  v_exp_f32 v163, v163
  v_mfma_f32_32x32x16_bf16 v[104:119], v[232:235], v[168:171], v[104:119]
  s_add_u32 s32, s32, 1
  v_exp_f32 v164, v164
  v_exp_f32 v165, v165
  v_exp_f32 v166, v166
  v_exp_f32 v167, v167
  v_cvt_pk_bf16_f32 v172, v160, v161
  v_cvt_pk_bf16_f32 v173, v162, v163
  v_cvt_pk_bf16_f32 v174, v164, v165
  v_cvt_pk_bf16_f32 v175, v166, v167
  s_branch .g2_kernel_a_loop
.g2_kernel_a_last:
  v_mfma_f32_32x32x16_bf16 v[152:167], v[224:227], v[32:35], 0
  ds_read_b32 v21, v13 offset:8
  s_andn2_b32 s33, s36, s34
  v_exp_f32 v136, v136
  v_exp_f32 v137, v137
  v_exp_f32 v138, v138
  v_mfma_f32_32x32x16_bf16 v[104:119], v[220:223], v[172:175], v[104:119]
  s_cbranch_scc0 .g2_kernel_a_L3c
.g2_kernel_a_L3b:
  v_exp_f32 v139, v139
  v_exp_f32 v140, v140
  v_exp_f32 v141, v141
  v_smfmac_f32_16x16x64_bf16 v[132:135], v[16:19], v[168:175], v20
  s_ff1_i32_b32 s33, s33
  v_exp_f32 v142, v142
  v_exp_f32 v143, v143
  v_mfma_f32_32x32x16_bf16 v[152:167], v[228:231], v[36:39], v[152:167]
  s_bitset1_b32 s34, s33
  ds_read_b128 v[24:27], v14 offset:0
  v_cvt_pk_bf16_f32 v168, v136, v137
  v_cvt_pk_bf16_f32 v169, v138, v139
  v_cvt_pk_bf16_f32 v170, v140, v141
  v_cvt_pk_bf16_f32 v171, v142, v143
  v_exp_f32 v144, v144
  v_exp_f32 v145, v145
  v_exp_f32 v146, v146
  v_exp_f32 v147, v147
  v_mfma_f32_32x32x16_bf16 v[56:71], v[232:235], v[168:171], v[56:71]
  s_xor_b32 s33, s33, s24
  ds_read_b128 v[28:31], v14 offset:1024
  v_exp_f32 v148, v148
  v_exp_f32 v149, v149
  v_exp_f32 v150, v150
  v_exp_f32 v151, v151
  v_cvt_pk_bf16_f32 v172, v144, v145
  v_cvt_pk_bf16_f32 v173, v146, v147
  v_cvt_pk_bf16_f32 v174, v148, v149
  v_cvt_pk_bf16_f32 v175, v150, v151
  v_mfma_f32_32x32x16_bf16 v[136:151], v[224:227], v[40:43], 0
  s_waitcnt lgkmcnt(2)
  s_lshl_b32 s33, s33, s25
  v_exp_f32 v152, v152
  v_exp_f32 v153, v153
  v_exp_f32 v154, v154
  v_mfma_f32_32x32x16_bf16 v[56:71], v[236:239], v[172:175], v[56:71]
  v_cmp_gt_u32 vcc, s27, v21
  s_add_u32 s22, s20, s33
  v_exp_f32 v155, v155
  v_exp_f32 v156, v156
  v_exp_f32 v157, v157
  v_smfmac_f32_16x16x64_bf16 v[120:123], v[16:19], v[168:175], v20
  s_addc_u32 s23, s21, 0
  v_exp_f32 v158, v158
  v_exp_f32 v159, v159
  v_mfma_f32_32x32x16_bf16 v[136:151], v[228:231], v[44:47], v[136:151]
  global_load_dwordx4 v[208:211], v3, s[22:23] offset:0
  global_load_dwordx4 v[212:215], v3, s[22:23] offset:1024
  global_load_dwordx4 v[216:219], v3, s[22:23] offset:2048
  global_load_dwordx4 v[220:223], v3, s[22:23] offset:3072
  v_cvt_pk_bf16_f32 v168, v152, v153
  v_cvt_pk_bf16_f32 v169, v154, v155
  v_cvt_pk_bf16_f32 v170, v156, v157
  v_cvt_pk_bf16_f32 v171, v158, v159
  v_exp_f32 v160, v160
  v_exp_f32 v161, v161
  v_exp_f32 v162, v162
  v_exp_f32 v163, v163
  v_mfma_f32_32x32x16_bf16 v[72:87], v[232:235], v[168:171], v[72:87]
  s_cbranch_vccnz .g2_kernel_a_L3g
.g2_kernel_a_L3h:
  ds_read_b128 v[32:35], v14 offset:2048
  ds_read_b128 v[36:39], v14 offset:3072
  v_exp_f32 v164, v164
  v_exp_f32 v165, v165
  v_exp_f32 v166, v166
  v_exp_f32 v167, v167
  v_cvt_pk_bf16_f32 v172, v160, v161
  v_cvt_pk_bf16_f32 v173, v162, v163
  v_cvt_pk_bf16_f32 v174, v164, v165
  v_cvt_pk_bf16_f32 v175, v166, v167
  v_mfma_f32_32x32x16_bf16 v[152:167], v[224:227], v[48:51], 0
  ds_write_b128 v9, v[56:59] offset:0
  v_add_f32 v6, v120, v121
  v_exp_f32 v136, v136
  v_exp_f32 v137, v137
  v_exp_f32 v138, v138
  v_mfma_f32_32x32x16_bf16 v[72:87], v[236:239], v[172:175], v[72:87]
  ds_write_b128 v9, v[60:63] offset:1024
  v_mov_b32 v120, 0
  v_exp_f32 v139, v139
  v_exp_f32 v140, v140
  v_exp_f32 v141, v141
  v_smfmac_f32_16x16x64_bf16 v[124:127], v[16:19], v[168:175], v20
  ds_write_b128 v9, v[64:67] offset:2048
  v_mov_b32 v121, 0
  v_exp_f32 v142, v142
  v_exp_f32 v143, v143
  v_mfma_f32_32x32x16_bf16 v[152:167], v[228:231], v[52:55], v[152:167]
  ds_read_b128 v[40:43], v14 offset:4096
  ds_write_b128 v9, v[68:71] offset:3072
  v_cvt_pk_bf16_f32 v168, v136, v137
  v_cvt_pk_bf16_f32 v169, v138, v139
  v_cvt_pk_bf16_f32 v170, v140, v141
  v_cvt_pk_bf16_f32 v171, v142, v143
  v_exp_f32 v144, v144
  v_exp_f32 v145, v145
  v_exp_f32 v146, v146
  v_exp_f32 v147, v147
  v_mfma_f32_32x32x16_bf16 v[88:103], v[232:235], v[168:171], v[88:103]
  s_waitcnt vmcnt(8)
  ds_read_b128 v[44:47], v14 offset:5120
  ds_write_b32 v10, v6 offset:0
  ds_write_b32 v11, v12 offset:0
  v_exp_f32 v148, v148
  v_exp_f32 v149, v149
  v_exp_f32 v150, v150
  v_exp_f32 v151, v151
  v_cvt_pk_bf16_f32 v172, v144, v145
  v_cvt_pk_bf16_f32 v173, v146, v147
  v_cvt_pk_bf16_f32 v174, v148, v149
  v_cvt_pk_bf16_f32 v175, v150, v151
  s_waitcnt lgkmcnt(10)
  v_mfma_f32_32x32x16_bf16 v[136:151], v[176:179], v[24:27], 0
  ds_write_b128 v9, v[72:75] offset:16384
  v_add_f32 v6, v124, v125
  v_exp_f32 v152, v152
  v_exp_f32 v153, v153
  v_exp_f32 v154, v154
  v_mfma_f32_32x32x16_bf16 v[88:103], v[236:239], v[172:175], v[88:103]
  ds_write_b128 v9, v[76:79] offset:17408
  v_mov_b32 v124, 0
  s_wakeup
  v_exp_f32 v155, v155
  v_exp_f32 v156, v156
  v_exp_f32 v157, v157
  v_smfmac_f32_16x16x64_bf16 v[128:131], v[16:19], v[168:175], v20
  ds_write_b128 v9, v[80:83] offset:18432
  v_mov_b32 v125, 0
  v_exp_f32 v158, v158
  v_exp_f32 v159, v159
  v_mfma_f32_32x32x16_bf16 v[136:151], v[180:183], v[28:31], v[136:151]
  ds_read_b128 v[48:51], v14 offset:6144
  ds_write_b128 v9, v[84:87] offset:19456
  v_cvt_pk_bf16_f32 v168, v152, v153
  v_cvt_pk_bf16_f32 v169, v154, v155
  v_cvt_pk_bf16_f32 v170, v156, v157
  v_cvt_pk_bf16_f32 v171, v158, v159
  v_exp_f32 v160, v160
  v_exp_f32 v161, v161
  v_exp_f32 v162, v162
  v_exp_f32 v163, v163
  v_mfma_f32_32x32x16_bf16 v[104:119], v[232:235], v[168:171], v[104:119]
  ds_read_b128 v[52:55], v14 offset:7168
  ds_write_b32 v10, v6 offset:512
  ds_write_b32 v11, v12 offset:16
  s_add_u32 s32, s32, 1
  v_exp_f32 v164, v164
  v_exp_f32 v165, v165
  v_exp_f32 v166, v166
  v_exp_f32 v167, v167
  v_cvt_pk_bf16_f32 v172, v160, v161
  v_cvt_pk_bf16_f32 v173, v162, v163
  v_cvt_pk_bf16_f32 v174, v164, v165
  v_cvt_pk_bf16_f32 v175, v166, v167
  s_cmp_eq_u32 s32, 8
  s_cbranch_scc1 .g2_kernel_a_end
  s_waitcnt lgkmcnt(15)
  v_mfma_f32_32x32x16_bf16 v[152:167], v[176:179], v[32:35], 0
  s_andn2_b32 s33, s36, s34
  ds_write_b128 v9, v[88:91] offset:32768
  v_add_f32 v6, v128, v129
  v_exp_f32 v136, v136
  v_exp_f32 v137, v137
  v_exp_f32 v138, v138
  v_mfma_f32_32x32x16_bf16 v[104:119], v[236:239], v[172:175], v[104:119]
  s_cbranch_scc0 .g2_kernel_a_G0c
.g2_kernel_a_G0b:
  ds_write_b128 v9, v[92:95] offset:33792
  v_mov_b32 v128, 0
  s_wakeup
  v_exp_f32 v139, v139
  v_exp_f32 v140, v140
  v_exp_f32 v141, v141
  v_smfmac_f32_16x16x64_bf16 v[132:135], v[16:19], v[168:175], v20
  s_ff1_i32_b32 s33, s33
  ds_write_b128 v9, v[96:99] offset:34816
  v_mov_b32 v129, 0
  v_exp_f32 v142, v142
  v_exp_f32 v143, v143
  v_mfma_f32_32x32x16_bf16 v[152:167], v[180:183], v[36:39], v[152:167]
  s_bitset1_b32 s34, s33
  ds_write_b128 v9, v[100:103] offset:35840
  v_cvt_pk_bf16_f32 v168, v136, v137
  v_cvt_pk_bf16_f32 v169, v138, v139
  v_cvt_pk_bf16_f32 v170, v140, v141
  v_cvt_pk_bf16_f32 v171, v142, v143
  v_exp_f32 v144, v144
  v_exp_f32 v145, v145
  v_exp_f32 v146, v146
  v_exp_f32 v147, v147
  s_waitcnt lgkmcnt(15)
  v_mfma_f32_32x32x16_bf16 v[56:71], v[184:187], v[168:171], 0
  s_xor_b32 s33, s33, s24
  ds_write_b32 v10, v6 offset:1024
  ds_write_b32 v11, v12 offset:32
  v_exp_f32 v148, v148
  v_exp_f32 v149, v149
  v_exp_f32 v150, v150
  v_exp_f32 v151, v151
  v_cvt_pk_bf16_f32 v172, v144, v145
  v_cvt_pk_bf16_f32 v173, v146, v147
  v_cvt_pk_bf16_f32 v174, v148, v149
  v_cvt_pk_bf16_f32 v175, v150, v151
  s_waitcnt lgkmcnt(15)
  v_mfma_f32_32x32x16_bf16 v[136:151], v[176:179], v[40:43], 0
  s_lshl_b32 s33, s33, s25
  ds_write_b128 v9, v[104:107] offset:49152
  v_add_f32 v6, v132, v133
  v_exp_f32 v152, v152
  v_exp_f32 v153, v153
  v_exp_f32 v154, v154
  v_mfma_f32_32x32x16_bf16 v[56:71], v[188:191], v[172:175], v[56:71]
  s_add_u32 s22, s20, s33
  ds_write_b128 v9, v[108:111] offset:50176
  v_mov_b32 v132, 0
  s_wakeup
  v_exp_f32 v155, v155
  v_exp_f32 v156, v156
  v_exp_f32 v157, v157
  v_smfmac_f32_16x16x64_bf16 v[120:123], v[16:19], v[168:175], v20
  s_addc_u32 s23, s21, 0
  ds_write_b128 v9, v[112:115] offset:51200
  v_mov_b32 v133, 0
  v_exp_f32 v158, v158
  v_exp_f32 v159, v159
  v_mfma_f32_32x32x16_bf16 v[136:151], v[180:183], v[44:47], v[136:151]
  global_load_dwordx4 v[224:227], v3, s[22:23] offset:0
  global_load_dwordx4 v[228:231], v3, s[22:23] offset:1024
  global_load_dwordx4 v[232:235], v3, s[22:23] offset:2048
  global_load_dwordx4 v[236:239], v3, s[22:23] offset:3072
  ds_write_b128 v9, v[116:119] offset:52224
  v_cvt_pk_bf16_f32 v168, v152, v153
  v_cvt_pk_bf16_f32 v169, v154, v155
  v_cvt_pk_bf16_f32 v170, v156, v157
  v_cvt_pk_bf16_f32 v171, v158, v159
  v_exp_f32 v160, v160
  v_exp_f32 v161, v161
  v_exp_f32 v162, v162
  v_exp_f32 v163, v163
  s_waitcnt lgkmcnt(13)
  v_mfma_f32_32x32x16_bf16 v[72:87], v[184:187], v[168:171], 0
  ds_write_b32 v10, v6 offset:1536
  ds_write_b32 v11, v12 offset:48
  v_exp_f32 v164, v164
  v_exp_f32 v165, v165
  v_exp_f32 v166, v166
  v_exp_f32 v167, v167
  v_cvt_pk_bf16_f32 v172, v160, v161
  v_cvt_pk_bf16_f32 v173, v162, v163
  v_cvt_pk_bf16_f32 v174, v164, v165
  v_cvt_pk_bf16_f32 v175, v166, v167
  s_waitcnt lgkmcnt(14)
  v_mfma_f32_32x32x16_bf16 v[152:167], v[176:179], v[48:51], 0
  v_add_u32 v12, 1, v12
  v_exp_f32 v136, v136
  v_exp_f32 v137, v137
  v_exp_f32 v138, v138
  v_mfma_f32_32x32x16_bf16 v[72:87], v[188:191], v[172:175], v[72:87]
  s_wakeup
  v_exp_f32 v139, v139
  v_exp_f32 v140, v140
  v_exp_f32 v141, v141
  v_smfmac_f32_16x16x64_bf16 v[124:127], v[16:19], v[168:175], v20
  s_mov_b32 s27, 8
  v_exp_f32 v142, v142
  v_exp_f32 v143, v143
  v_mfma_f32_32x32x16_bf16 v[152:167], v[180:183], v[52:55], v[152:167]
  v_cvt_pk_bf16_f32 v168, v136, v137
  v_cvt_pk_bf16_f32 v169, v138, v139
  v_cvt_pk_bf16_f32 v170, v140, v141
  v_cvt_pk_bf16_f32 v171, v142, v143
  v_exp_f32 v144, v144
  v_exp_f32 v145, v145
  v_exp_f32 v146, v146
  v_exp_f32 v147, v147
  s_waitcnt lgkmcnt(8)
  v_mfma_f32_32x32x16_bf16 v[88:103], v[184:187], v[168:171], 0
  s_waitcnt vmcnt(8)
  v_exp_f32 v148, v148
  v_exp_f32 v149, v149
  v_exp_f32 v150, v150
  v_exp_f32 v151, v151
  v_cvt_pk_bf16_f32 v172, v144, v145
  v_cvt_pk_bf16_f32 v173, v146, v147
  v_cvt_pk_bf16_f32 v174, v148, v149
  v_cvt_pk_bf16_f32 v175, v150, v151
  v_mfma_f32_32x32x16_bf16 v[136:151], v[192:195], v[24:27], 0
  v_exp_f32 v152, v152
  v_exp_f32 v153, v153
  v_exp_f32 v154, v154
  v_mfma_f32_32x32x16_bf16 v[88:103], v[188:191], v[172:175], v[88:103]
  v_exp_f32 v155, v155
  v_exp_f32 v156, v156
  v_exp_f32 v157, v157
  v_smfmac_f32_16x16x64_bf16 v[128:131], v[16:19], v[168:175], v20
  v_exp_f32 v158, v158
  v_exp_f32 v159, v159
  v_mfma_f32_32x32x16_bf16 v[136:151], v[196:199], v[28:31], v[136:151]
  v_cvt_pk_bf16_f32 v168, v152, v153
  v_cvt_pk_bf16_f32 v169, v154, v155
  v_cvt_pk_bf16_f32 v170, v156, v157
  v_cvt_pk_bf16_f32 v171, v158, v159
  v_exp_f32 v160, v160
  v_exp_f32 v161, v161
  v_exp_f32 v162, v162
  v_exp_f32 v163, v163
  s_waitcnt lgkmcnt(2)
  v_mfma_f32_32x32x16_bf16 v[104:119], v[184:187], v[168:171], 0
  v_exp_f32 v164, v164
  v_exp_f32 v165, v165
  v_exp_f32 v166, v166
  v_exp_f32 v167, v167
  v_cvt_pk_bf16_f32 v172, v160, v161
  v_cvt_pk_bf16_f32 v173, v162, v163
  v_cvt_pk_bf16_f32 v174, v164, v165
  v_cvt_pk_bf16_f32 v175, v166, v167
  s_branch .g2_kernel_a_n1
.g2_kernel_a_end:
  v_mfma_f32_32x32x16_bf16 v[104:119], v[236:239], v[172:175], v[104:119]
  v_smfmac_f32_16x16x64_bf16 v[132:135], v[16:19], v[168:175], v20
  s_wakeup
  ds_write_b128 v9, v[88:91] offset:32768
  v_add_f32 v6, v128, v129
  ds_write_b128 v9, v[92:95] offset:33792
  v_mov_b32 v128, 0
  ds_write_b128 v9, v[96:99] offset:34816
  v_mov_b32 v129, 0
  ds_write_b128 v9, v[100:103] offset:35840
  ds_write_b32 v10, v6 offset:1024
  ds_write_b32 v11, v12 offset:32
  s_nop 0
  ds_write_b128 v9, v[104:107] offset:49152
  v_add_f32 v6, v132, v133
  ds_write_b128 v9, v[108:111] offset:50176
  v_mov_b32 v132, 0
  ds_write_b128 v9, v[112:115] offset:51200
  v_mov_b32 v133, 0
  ds_write_b128 v9, v[116:119] offset:52224
  ds_write_b32 v10, v6 offset:1536
  ds_write_b32 v11, v12 offset:48
  s_waitcnt lgkmcnt(6)
  s_wakeup
  s_andn2_b32 s33, s36, s34
  s_ff1_i32_b32 s33, s33
  s_bitset1_b32 s34, s33
  s_xor_b32 s33, s33, s24
  s_lshl_b32 s33, s33, 12
  s_add_u32 s22, s20, s33
  s_addc_u32 s23, s21, 0
  global_load_dwordx4 v[224:227], v3, s[22:23] offset:0
  global_load_dwordx4 v[228:231], v3, s[22:23] offset:1024
  global_load_dwordx4 v[232:235], v3, s[22:23] offset:2048
  global_load_dwordx4 v[236:239], v3, s[22:23] offset:3072
  s_andn2_b32 s33, s36, s34
  s_ff1_i32_b32 s33, s33
  s_bitset1_b32 s34, s33
  s_xor_b32 s33, s33, s24
  s_lshl_b32 s33, s33, 12
  s_add_u32 s22, s20, s33
  s_addc_u32 s23, s21, 0
  global_load_dwordx4 v[136:139], v3, s[22:23] offset:0
  global_load_dwordx4 v[140:143], v3, s[22:23] offset:1024
  global_load_dwordx4 v[144:147], v3, s[22:23] offset:2048
  global_load_dwordx4 v[148:151], v3, s[22:23] offset:3072
  s_andn2_b32 s33, s36, s34
  s_ff1_i32_b32 s33, s33
  s_bitset1_b32 s34, s33
  s_xor_b32 s33, s33, s24
  s_lshl_b32 s33, s33, 12
  s_add_u32 s22, s20, s33
  s_addc_u32 s23, s21, 0
  global_load_dwordx4 v[152:155], v3, s[22:23] offset:0
  global_load_dwordx4 v[156:159], v3, s[22:23] offset:1024
  global_load_dwordx4 v[160:163], v3, s[22:23] offset:2048
  global_load_dwordx4 v[164:167], v3, s[22:23] offset:3072
  v_mov_b32 v20, s71
  v_lshrrev_b32 v17, 5, v2
  v_and_b32 v18, 31, v2
  s_lshl_b32 s28, s16, 5
  v_add_u32 v19, s28, v18
  v_lshlrev_b32 v7, 2, v19
  v_add_u32 v7, 155648, v7
  ds_read_b32 v8, v7 offset:3840
  ds_read_b32 v9, v7 offset:4352
  ds_read_b32 v16, v20 offset:24
  ds_read_b32 v6, v20 offset:52
  v_add_u32 v19, 1, v19
  v_bfe_u32 v7, v2, 2, 2
  v_lshl_add_u32 v14, v17, 2, v7
  v_lshlrev_b32 v14, 7, v14
  v_lshrrev_b32 v7, 1, v7
  v_lshl_add_u32 v14, v7, 6, v14
  v_bfe_u32 v7, v2, 4, 1
  v_lshl_add_u32 v14, v7, 5, v14
  v_and_b32 v7, 1, v2
  v_lshl_add_u32 v14, v7, 4, v14
  v_bfe_u32 v7, v2, 1, 1
  v_lshl_add_u32 v14, v7, 3, v14
  v_xor_b32 v15, 64, v14
  v_and_b32 v7, 7, v2
  v_xor_b32 v7, s24, v7
  s_lshl_b32 s28, s16, 6
  s_add_u32 s28, s28, 157952
  v_lshl_add_u32 v21, v7, 3, s28
  v_lshlrev_b32 v24, 16, v240
  v_and_b32 v25, 0xffff0000, v240
  v_lshlrev_b32 v26, 16, v241
  v_and_b32 v27, 0xffff0000, v241
  v_lshlrev_b32 v28, 16, v242
  v_and_b32 v29, 0xffff0000, v242
  v_lshlrev_b32 v30, 16, v243
  v_and_b32 v31, 0xffff0000, v243
  v_lshlrev_b32 v32, 16, v244
  v_and_b32 v33, 0xffff0000, v244
  v_lshlrev_b32 v34, 16, v245
  v_and_b32 v35, 0xffff0000, v245
  v_lshlrev_b32 v36, 16, v246
  v_and_b32 v37, 0xffff0000, v246
  v_lshlrev_b32 v38, 16, v247
  v_and_b32 v39, 0xffff0000, v247
  v_lshlrev_b32 v40, 16, v248
  v_and_b32 v41, 0xffff0000, v248
  v_lshlrev_b32 v42, 16, v249
  v_and_b32 v43, 0xffff0000, v249
  v_lshlrev_b32 v44, 16, v250
  v_and_b32 v45, 0xffff0000, v250
  v_lshlrev_b32 v46, 16, v251
  v_and_b32 v47, 0xffff0000, v251
  v_lshlrev_b32 v48, 16, v252
  v_and_b32 v49, 0xffff0000, v252
  v_lshlrev_b32 v50, 16, v253
  v_and_b32 v51, 0xffff0000, v253
  v_lshlrev_b32 v52, 16, v254
  v_and_b32 v53, 0xffff0000, v254
  v_lshlrev_b32 v54, 16, v255
  v_and_b32 v55, 0xffff0000, v255
  s_waitcnt lgkmcnt(0)
  s_wakeup
  v_cmp_gt_u32 vcc, 4, v6
  s_cbranch_vccnz .g2_kernel_w_aw
.g2_kernel_w_ab:
  s_xor_b32 s28, s24, 0
  s_lshl_b32 s28, s28, 13
  s_add_u32 s28, s28, 65536
  v_add_u32 v10, s28, v14
  v_add_u32 v11, s28, v15
  ds_read_b64_tr_b16 v[120:121], v10 offset:0
  ds_read_b64_tr_b16 v[122:123], v10 offset:1024
  ds_read_b64_tr_b16 v[124:125], v11 offset:0
  ds_read_b64_tr_b16 v[126:127], v11 offset:1024
  s_andn2_b32 s33, s36, s34
  s_ff1_i32_b32 s33, s33
  s_bitset1_b32 s34, s33
  s_xor_b32 s33, s33, s24
  s_lshl_b32 s33, s33, 12
  s_add_u32 s22, s20, s33
  s_addc_u32 s23, s21, 0
  global_load_dwordx4 v[56:59], v3, s[22:23] offset:0
  global_load_dwordx4 v[60:63], v3, s[22:23] offset:1024
  global_load_dwordx4 v[64:67], v3, s[22:23] offset:2048
  global_load_dwordx4 v[68:71], v3, s[22:23] offset:3072
  s_andn2_b32 s33, s36, s34
  s_ff1_i32_b32 s33, s33
  s_bitset1_b32 s34, s33
  s_xor_b32 s33, s33, s24
  s_lshl_b32 s33, s33, 12
  s_add_u32 s22, s20, s33
  s_addc_u32 s23, s21, 0
  global_load_dwordx4 v[72:75], v3, s[22:23] offset:0
  global_load_dwordx4 v[76:79], v3, s[22:23] offset:1024
  global_load_dwordx4 v[80:83], v3, s[22:23] offset:2048
  global_load_dwordx4 v[84:87], v3, s[22:23] offset:3072
  v_pk_fma_f32 v[24:25], v[24:25], v[8:9], v[8:9] op_sel:[0,0,1] op_sel_hi:[1,0,1]
  v_pk_fma_f32 v[26:27], v[26:27], v[8:9], v[8:9] op_sel:[0,0,1] op_sel_hi:[1,0,1]
  v_pk_fma_f32 v[28:29], v[28:29], v[8:9], v[8:9] op_sel:[0,0,1] op_sel_hi:[1,0,1]
  v_pk_fma_f32 v[30:31], v[30:31], v[8:9], v[8:9] op_sel:[0,0,1] op_sel_hi:[1,0,1]
  v_pk_fma_f32 v[32:33], v[32:33], v[8:9], v[8:9] op_sel:[0,0,1] op_sel_hi:[1,0,1]
  v_pk_fma_f32 v[34:35], v[34:35], v[8:9], v[8:9] op_sel:[0,0,1] op_sel_hi:[1,0,1]
  v_pk_fma_f32 v[36:37], v[36:37], v[8:9], v[8:9] op_sel:[0,0,1] op_sel_hi:[1,0,1]
  v_pk_fma_f32 v[38:39], v[38:39], v[8:9], v[8:9] op_sel:[0,0,1] op_sel_hi:[1,0,1]
  v_pk_fma_f32 v[40:41], v[40:41], v[8:9], v[8:9] op_sel:[0,0,1] op_sel_hi:[1,0,1]
  v_pk_fma_f32 v[42:43], v[42:43], v[8:9], v[8:9] op_sel:[0,0,1] op_sel_hi:[1,0,1]
  v_pk_fma_f32 v[44:45], v[44:45], v[8:9], v[8:9] op_sel:[0,0,1] op_sel_hi:[1,0,1]
  v_pk_fma_f32 v[46:47], v[46:47], v[8:9], v[8:9] op_sel:[0,0,1] op_sel_hi:[1,0,1]
  v_pk_fma_f32 v[48:49], v[48:49], v[8:9], v[8:9] op_sel:[0,0,1] op_sel_hi:[1,0,1]
  v_pk_fma_f32 v[50:51], v[50:51], v[8:9], v[8:9] op_sel:[0,0,1] op_sel_hi:[1,0,1]
  v_pk_fma_f32 v[52:53], v[52:53], v[8:9], v[8:9] op_sel:[0,0,1] op_sel_hi:[1,0,1]
  v_pk_fma_f32 v[54:55], v[54:55], v[8:9], v[8:9] op_sel:[0,0,1] op_sel_hi:[1,0,1]
  v_cmp_eq_u32 vcc, v16, v19
  s_cbranch_vccnz .g2_kernel_w_pt
.g2_kernel_w_pb:
  s_mov_b32 s72, s48
  s_mov_b32 s73, s49
  s_mov_b32 s74, 0x800
  s_mov_b32 s75, 0x00020000
  s_xor_b32 s28, s24, 1
  s_lshl_b32 s28, s28, 13
  s_add_u32 s28, s28, 65536
  v_add_u32 v12, s28, v14
  v_add_u32 v13, s28, v15
  ds_read_b64_tr_b16 v[128:129], v10 offset:2048
  ds_read_b64_tr_b16 v[130:131], v10 offset:3072
  ds_read_b64_tr_b16 v[132:133], v11 offset:2048
  ds_read_b64_tr_b16 v[134:135], v11 offset:3072
  s_waitcnt vmcnt(31) lgkmcnt(4)
  v_mfma_f32_32x32x16_bf16 v[24:39], v[120:123], v[176:179], v[24:39]
  v_mfma_f32_32x32x16_bf16 v[40:55], v[124:127], v[176:179], v[40:55]
  ds_read_b64_tr_b16 v[120:121], v10 offset:4096
  ds_read_b64_tr_b16 v[122:123], v10 offset:5120
  ds_read_b64_tr_b16 v[124:125], v11 offset:4096
  ds_read_b64_tr_b16 v[126:127], v11 offset:5120
  s_waitcnt vmcnt(30) lgkmcnt(4)
  v_mfma_f32_32x32x16_bf16 v[24:39], v[128:131], v[180:183], v[24:39]
  v_mfma_f32_32x32x16_bf16 v[40:55], v[132:135], v[180:183], v[40:55]
  ds_read_b64_tr_b16 v[128:129], v10 offset:6144
  ds_read_b64_tr_b16 v[130:131], v10 offset:7168
  ds_read_b64_tr_b16 v[132:133], v11 offset:6144
  ds_read_b64_tr_b16 v[134:135], v11 offset:7168
  s_waitcnt vmcnt(29) lgkmcnt(4)
  v_mfma_f32_32x32x16_bf16 v[24:39], v[120:123], v[184:187], v[24:39]
  v_mfma_f32_32x32x16_bf16 v[40:55], v[124:127], v[184:187], v[40:55]
  ds_read_b64_tr_b16 v[120:121], v12 offset:0
  ds_read_b64_tr_b16 v[122:123], v12 offset:1024
  ds_read_b64_tr_b16 v[124:125], v13 offset:0
  ds_read_b64_tr_b16 v[126:127], v13 offset:1024
  s_waitcnt vmcnt(28) lgkmcnt(4)
  v_mfma_f32_32x32x16_bf16 v[24:39], v[128:131], v[188:191], v[24:39]
  v_mfma_f32_32x32x16_bf16 v[40:55], v[132:135], v[188:191], v[40:55]
  s_xor_b32 s28, s24, 2
  s_lshl_b32 s28, s28, 13
  s_add_u32 s28, s28, 65536
  v_add_u32 v10, s28, v14
  v_add_u32 v11, s28, v15
  ds_read_b64_tr_b16 v[128:129], v12 offset:2048
  ds_read_b64_tr_b16 v[130:131], v12 offset:3072
  ds_read_b64_tr_b16 v[132:133], v13 offset:2048
  ds_read_b64_tr_b16 v[134:135], v13 offset:3072
  s_waitcnt vmcnt(27) lgkmcnt(4)
  v_mfma_f32_32x32x16_bf16 v[24:39], v[120:123], v[192:195], v[24:39]
  v_mfma_f32_32x32x16_bf16 v[40:55], v[124:127], v[192:195], v[40:55]
  ds_read_b64_tr_b16 v[120:121], v12 offset:4096
  ds_read_b64_tr_b16 v[122:123], v12 offset:5120
  ds_read_b64_tr_b16 v[124:125], v13 offset:4096
  ds_read_b64_tr_b16 v[126:127], v13 offset:5120
  s_waitcnt vmcnt(26) lgkmcnt(4)
  v_mfma_f32_32x32x16_bf16 v[24:39], v[128:131], v[196:199], v[24:39]
  v_mfma_f32_32x32x16_bf16 v[40:55], v[132:135], v[196:199], v[40:55]
  ds_read_b64_tr_b16 v[128:129], v12 offset:6144
  ds_read_b64_tr_b16 v[130:131], v12 offset:7168
  ds_read_b64_tr_b16 v[132:133], v13 offset:6144
  ds_read_b64_tr_b16 v[134:135], v13 offset:7168
  s_waitcnt vmcnt(25) lgkmcnt(4)
  v_mfma_f32_32x32x16_bf16 v[24:39], v[120:123], v[200:203], v[24:39]
  v_mfma_f32_32x32x16_bf16 v[40:55], v[124:127], v[200:203], v[40:55]
  ds_read_b64_tr_b16 v[120:121], v10 offset:0
  ds_read_b64_tr_b16 v[122:123], v10 offset:1024
  ds_read_b64_tr_b16 v[124:125], v11 offset:0
  ds_read_b64_tr_b16 v[126:127], v11 offset:1024
  s_waitcnt vmcnt(24) lgkmcnt(4)
  v_mfma_f32_32x32x16_bf16 v[24:39], v[128:131], v[204:207], v[24:39]
  v_mfma_f32_32x32x16_bf16 v[40:55], v[132:135], v[204:207], v[40:55]
  s_xor_b32 s28, s24, 3
  s_lshl_b32 s28, s28, 13
  s_add_u32 s28, s28, 65536
  v_add_u32 v12, s28, v14
  v_add_u32 v13, s28, v15
  ds_read_b64_tr_b16 v[128:129], v10 offset:2048
  ds_read_b64_tr_b16 v[130:131], v10 offset:3072
  ds_read_b64_tr_b16 v[132:133], v11 offset:2048
  ds_read_b64_tr_b16 v[134:135], v11 offset:3072
  s_waitcnt vmcnt(23) lgkmcnt(4)
  v_mfma_f32_32x32x16_bf16 v[24:39], v[120:123], v[208:211], v[24:39]
  v_mfma_f32_32x32x16_bf16 v[40:55], v[124:127], v[208:211], v[40:55]
  ds_read_b64_tr_b16 v[120:121], v10 offset:4096
  ds_read_b64_tr_b16 v[122:123], v10 offset:5120
  ds_read_b64_tr_b16 v[124:125], v11 offset:4096
  ds_read_b64_tr_b16 v[126:127], v11 offset:5120
  s_waitcnt vmcnt(22) lgkmcnt(4)
  v_mfma_f32_32x32x16_bf16 v[24:39], v[128:131], v[212:215], v[24:39]
  v_mfma_f32_32x32x16_bf16 v[40:55], v[132:135], v[212:215], v[40:55]
  ds_read_b64_tr_b16 v[128:129], v10 offset:6144
  ds_read_b64_tr_b16 v[130:131], v10 offset:7168
  ds_read_b64_tr_b16 v[132:133], v11 offset:6144
  ds_read_b64_tr_b16 v[134:135], v11 offset:7168
  s_waitcnt vmcnt(21) lgkmcnt(4)
  v_mfma_f32_32x32x16_bf16 v[24:39], v[120:123], v[216:219], v[24:39]
  v_mfma_f32_32x32x16_bf16 v[40:55], v[124:127], v[216:219], v[40:55]
  ds_read_b64_tr_b16 v[120:121], v12 offset:0
  ds_read_b64_tr_b16 v[122:123], v12 offset:1024
  ds_read_b64_tr_b16 v[124:125], v13 offset:0
  ds_read_b64_tr_b16 v[126:127], v13 offset:1024
  s_waitcnt vmcnt(20) lgkmcnt(4)
  v_mfma_f32_32x32x16_bf16 v[24:39], v[128:131], v[220:223], v[24:39]
  v_mfma_f32_32x32x16_bf16 v[40:55], v[132:135], v[220:223], v[40:55]
  s_xor_b32 s28, s24, 4
  s_lshl_b32 s28, s28, 13
  s_add_u32 s28, s28, 65536
  v_add_u32 v10, s28, v14
  v_add_u32 v11, s28, v15
  ds_read_b64_tr_b16 v[128:129], v12 offset:2048
  ds_read_b64_tr_b16 v[130:131], v12 offset:3072
  ds_read_b64_tr_b16 v[132:133], v13 offset:2048
  ds_read_b64_tr_b16 v[134:135], v13 offset:3072
  s_waitcnt vmcnt(19) lgkmcnt(4)
  v_mfma_f32_32x32x16_bf16 v[24:39], v[120:123], v[224:227], v[24:39]
  v_mfma_f32_32x32x16_bf16 v[40:55], v[124:127], v[224:227], v[40:55]
  ds_read_b64_tr_b16 v[120:121], v12 offset:4096
  ds_read_b64_tr_b16 v[122:123], v12 offset:5120
  ds_read_b64_tr_b16 v[124:125], v13 offset:4096
  ds_read_b64_tr_b16 v[126:127], v13 offset:5120
  s_waitcnt vmcnt(18) lgkmcnt(4)
  v_mfma_f32_32x32x16_bf16 v[24:39], v[128:131], v[228:231], v[24:39]
  v_mfma_f32_32x32x16_bf16 v[40:55], v[132:135], v[228:231], v[40:55]
  ds_read_b64_tr_b16 v[128:129], v12 offset:6144
  ds_read_b64_tr_b16 v[130:131], v12 offset:7168
  ds_read_b64_tr_b16 v[132:133], v13 offset:6144
  ds_read_b64_tr_b16 v[134:135], v13 offset:7168
  s_waitcnt vmcnt(17) lgkmcnt(4)
  v_mfma_f32_32x32x16_bf16 v[24:39], v[120:123], v[232:235], v[24:39]
  v_mfma_f32_32x32x16_bf16 v[40:55], v[124:127], v[232:235], v[40:55]
  ds_read_b64_tr_b16 v[120:121], v10 offset:0
  ds_read_b64_tr_b16 v[122:123], v10 offset:1024
  ds_read_b64_tr_b16 v[124:125], v11 offset:0
  ds_read_b64_tr_b16 v[126:127], v11 offset:1024
  s_waitcnt vmcnt(16) lgkmcnt(4)
  v_mfma_f32_32x32x16_bf16 v[24:39], v[128:131], v[236:239], v[24:39]
  v_mfma_f32_32x32x16_bf16 v[40:55], v[132:135], v[236:239], v[40:55]
  s_andn2_b32 s33, s36, s34
  s_cbranch_scc0 .g2_kernel_w_i8c
.g2_kernel_w_i8b:
  s_ff1_i32_b32 s33, s33
  s_bitset1_b32 s34, s33
  s_xor_b32 s33, s33, s24
  s_and_b32 s8, s33, 7
  s_cmp_lt_u32 s8, 2
  s_cselect_b32 s28, 139264, 0
  s_lshl_b32 s8, s8, 13
  s_add_u32 s8, s8, s28
  s_lshl_b32 s33, s33, 12
  s_add_u32 s22, s20, s33
  s_addc_u32 s23, s21, 0
  global_load_dwordx4 v[88:91], v3, s[22:23] offset:0
  global_load_dwordx4 v[92:95], v3, s[22:23] offset:1024
  global_load_dwordx4 v[96:99], v3, s[22:23] offset:2048
  global_load_dwordx4 v[100:103], v3, s[22:23] offset:3072
  s_xor_b32 s28, s24, 5
  s_lshl_b32 s28, s28, 13
  s_add_u32 s28, s28, 65536
  v_add_u32 v12, s28, v14
  v_add_u32 v13, s28, v15
  ds_read_b64_tr_b16 v[128:129], v10 offset:2048
  ds_read_b64_tr_b16 v[130:131], v10 offset:3072
  ds_read_b64_tr_b16 v[132:133], v11 offset:2048
  ds_read_b64_tr_b16 v[134:135], v11 offset:3072
  s_waitcnt vmcnt(19) lgkmcnt(4)
  v_mfma_f32_32x32x16_bf16 v[24:39], v[120:123], v[136:139], v[24:39]
  v_mfma_f32_32x32x16_bf16 v[40:55], v[124:127], v[136:139], v[40:55]
  ds_read_b64_tr_b16 v[120:121], v10 offset:4096
  ds_read_b64_tr_b16 v[122:123], v10 offset:5120
  ds_read_b64_tr_b16 v[124:125], v11 offset:4096
  ds_read_b64_tr_b16 v[126:127], v11 offset:5120
  s_waitcnt vmcnt(18) lgkmcnt(4)
  v_mfma_f32_32x32x16_bf16 v[24:39], v[128:131], v[140:143], v[24:39]
  v_mfma_f32_32x32x16_bf16 v[40:55], v[132:135], v[140:143], v[40:55]
  ds_read_b64_tr_b16 v[128:129], v10 offset:6144
  ds_read_b64_tr_b16 v[130:131], v10 offset:7168
  ds_read_b64_tr_b16 v[132:133], v11 offset:6144
  ds_read_b64_tr_b16 v[134:135], v11 offset:7168
  s_waitcnt vmcnt(17) lgkmcnt(4)
  v_mfma_f32_32x32x16_bf16 v[24:39], v[120:123], v[144:147], v[24:39]
  v_mfma_f32_32x32x16_bf16 v[40:55], v[124:127], v[144:147], v[40:55]
  ds_read_b64_tr_b16 v[120:121], v12 offset:0
  ds_read_b64_tr_b16 v[122:123], v12 offset:1024
  ds_read_b64_tr_b16 v[124:125], v13 offset:0
  ds_read_b64_tr_b16 v[126:127], v13 offset:1024
  s_waitcnt vmcnt(16) lgkmcnt(4)
  v_mfma_f32_32x32x16_bf16 v[24:39], v[128:131], v[148:151], v[24:39]
  v_mfma_f32_32x32x16_bf16 v[40:55], v[132:135], v[148:151], v[40:55]
  s_andn2_b32 s33, s36, s34
  s_cbranch_scc0 .g2_kernel_w_i9c
.g2_kernel_w_i9b:
  s_ff1_i32_b32 s33, s33
  s_bitset1_b32 s34, s33
  s_xor_b32 s33, s33, s24
  s_and_b32 s9, s33, 7
  s_cmp_lt_u32 s9, 2
  s_cselect_b32 s28, 139264, 0
  s_lshl_b32 s9, s9, 13
  s_add_u32 s9, s9, s28
  s_lshl_b32 s33, s33, 12
  s_add_u32 s22, s20, s33
  s_addc_u32 s23, s21, 0
  global_load_dwordx4 v[104:107], v3, s[22:23] offset:0
  global_load_dwordx4 v[108:111], v3, s[22:23] offset:1024
  global_load_dwordx4 v[112:115], v3, s[22:23] offset:2048
  global_load_dwordx4 v[116:119], v3, s[22:23] offset:3072
  s_xor_b32 s28, s24, 6
  s_lshl_b32 s28, s28, 13
  s_add_u32 s28, s28, 65536
  v_add_u32 v10, s28, v14
  v_add_u32 v11, s28, v15
  ds_read_b64_tr_b16 v[128:129], v12 offset:2048
  ds_read_b64_tr_b16 v[130:131], v12 offset:3072
  ds_read_b64_tr_b16 v[132:133], v13 offset:2048
  ds_read_b64_tr_b16 v[134:135], v13 offset:3072
  s_waitcnt vmcnt(19) lgkmcnt(4)
  v_mfma_f32_32x32x16_bf16 v[24:39], v[120:123], v[152:155], v[24:39]
  v_mfma_f32_32x32x16_bf16 v[40:55], v[124:127], v[152:155], v[40:55]
  ds_read_b64_tr_b16 v[120:121], v12 offset:4096
  ds_read_b64_tr_b16 v[122:123], v12 offset:5120
  ds_read_b64_tr_b16 v[124:125], v13 offset:4096
  ds_read_b64_tr_b16 v[126:127], v13 offset:5120
  s_waitcnt vmcnt(18) lgkmcnt(4)
  v_mfma_f32_32x32x16_bf16 v[24:39], v[128:131], v[156:159], v[24:39]
  v_mfma_f32_32x32x16_bf16 v[40:55], v[132:135], v[156:159], v[40:55]
  ds_read_b64_tr_b16 v[128:129], v12 offset:6144
  ds_read_b64_tr_b16 v[130:131], v12 offset:7168
  ds_read_b64_tr_b16 v[132:133], v13 offset:6144
  ds_read_b64_tr_b16 v[134:135], v13 offset:7168
  s_waitcnt vmcnt(17) lgkmcnt(4)
  v_mfma_f32_32x32x16_bf16 v[24:39], v[120:123], v[160:163], v[24:39]
  v_mfma_f32_32x32x16_bf16 v[40:55], v[124:127], v[160:163], v[40:55]
  ds_read_b64_tr_b16 v[120:121], v10 offset:0
  ds_read_b64_tr_b16 v[122:123], v10 offset:1024
  ds_read_b64_tr_b16 v[124:125], v11 offset:0
  ds_read_b64_tr_b16 v[126:127], v11 offset:1024
  s_waitcnt vmcnt(16) lgkmcnt(4)
  v_mfma_f32_32x32x16_bf16 v[24:39], v[128:131], v[164:167], v[24:39]
  v_mfma_f32_32x32x16_bf16 v[40:55], v[132:135], v[164:167], v[40:55]
  s_andn2_b32 s33, s36, s34
  s_cbranch_scc0 .g2_kernel_w_i10c
.g2_kernel_w_i10b:
  s_ff1_i32_b32 s33, s33
  s_bitset1_b32 s34, s33
  s_xor_b32 s33, s33, s24
  s_and_b32 s10, s33, 7
  s_cmp_lt_u32 s10, 2
  s_cselect_b32 s28, 139264, 0
  s_lshl_b32 s10, s10, 13
  s_add_u32 s10, s10, s28
  s_lshl_b32 s33, s33, 12
  s_add_u32 s22, s20, s33
  s_addc_u32 s23, s21, 0
  global_load_dwordx4 v[136:139], v3, s[22:23] offset:0
  global_load_dwordx4 v[140:143], v3, s[22:23] offset:1024
  global_load_dwordx4 v[144:147], v3, s[22:23] offset:2048
  global_load_dwordx4 v[148:151], v3, s[22:23] offset:3072
  s_xor_b32 s28, s24, 7
  s_lshl_b32 s28, s28, 13
  s_add_u32 s28, s28, 65536
  v_add_u32 v12, s28, v14
  v_add_u32 v13, s28, v15
  ds_read_b64_tr_b16 v[128:129], v10 offset:2048
  ds_read_b64_tr_b16 v[130:131], v10 offset:3072
  ds_read_b64_tr_b16 v[132:133], v11 offset:2048
  ds_read_b64_tr_b16 v[134:135], v11 offset:3072
  s_waitcnt vmcnt(19) lgkmcnt(4)
  v_mfma_f32_32x32x16_bf16 v[24:39], v[120:123], v[56:59], v[24:39]
  v_mfma_f32_32x32x16_bf16 v[40:55], v[124:127], v[56:59], v[40:55]
  ds_read_b64_tr_b16 v[120:121], v10 offset:4096
  ds_read_b64_tr_b16 v[122:123], v10 offset:5120
  ds_read_b64_tr_b16 v[124:125], v11 offset:4096
  ds_read_b64_tr_b16 v[126:127], v11 offset:5120
  s_waitcnt vmcnt(18) lgkmcnt(4)
  v_mfma_f32_32x32x16_bf16 v[24:39], v[128:131], v[60:63], v[24:39]
  v_mfma_f32_32x32x16_bf16 v[40:55], v[132:135], v[60:63], v[40:55]
  ds_read_b64_tr_b16 v[128:129], v10 offset:6144
  ds_read_b64_tr_b16 v[130:131], v10 offset:7168
  ds_read_b64_tr_b16 v[132:133], v11 offset:6144
  ds_read_b64_tr_b16 v[134:135], v11 offset:7168
  s_waitcnt vmcnt(17) lgkmcnt(4)
  v_mfma_f32_32x32x16_bf16 v[24:39], v[120:123], v[64:67], v[24:39]
  v_mfma_f32_32x32x16_bf16 v[40:55], v[124:127], v[64:67], v[40:55]
  ds_read_b64_tr_b16 v[120:121], v12 offset:0
  ds_read_b64_tr_b16 v[122:123], v12 offset:1024
  ds_read_b64_tr_b16 v[124:125], v13 offset:0
  ds_read_b64_tr_b16 v[126:127], v13 offset:1024
  s_waitcnt vmcnt(16) lgkmcnt(4)
  v_mfma_f32_32x32x16_bf16 v[24:39], v[128:131], v[68:71], v[24:39]
  v_mfma_f32_32x32x16_bf16 v[40:55], v[132:135], v[68:71], v[40:55]
  s_andn2_b32 s33, s36, s34
  s_cbranch_scc0 .g2_kernel_w_i11c
.g2_kernel_w_i11b:
  s_ff1_i32_b32 s33, s33
  s_bitset1_b32 s34, s33
  s_xor_b32 s33, s33, s24
  s_and_b32 s11, s33, 7
  s_cmp_lt_u32 s11, 2
  s_cselect_b32 s28, 139264, 0
  s_lshl_b32 s11, s11, 13
  s_add_u32 s11, s11, s28
  s_lshl_b32 s33, s33, 12
  s_add_u32 s22, s20, s33
  s_addc_u32 s23, s21, 0
  global_load_dwordx4 v[152:155], v3, s[22:23] offset:0
  global_load_dwordx4 v[156:159], v3, s[22:23] offset:1024
  global_load_dwordx4 v[160:163], v3, s[22:23] offset:2048
  global_load_dwordx4 v[164:167], v3, s[22:23] offset:3072
  v_add_u32 v10, s8, v14
  v_add_u32 v11, s8, v15
  ds_read_b32 v16, v20 offset:12
  ds_read_b64_tr_b16 v[128:129], v12 offset:2048
  ds_read_b64_tr_b16 v[130:131], v12 offset:3072
  ds_read_b64_tr_b16 v[132:133], v13 offset:2048
  ds_read_b64_tr_b16 v[134:135], v13 offset:3072
  s_waitcnt vmcnt(19) lgkmcnt(4)
  v_mfma_f32_32x32x16_bf16 v[24:39], v[120:123], v[72:75], v[24:39]
  v_mfma_f32_32x32x16_bf16 v[40:55], v[124:127], v[72:75], v[40:55]
  ds_read_b64_tr_b16 v[120:121], v12 offset:4096
  ds_read_b64_tr_b16 v[122:123], v12 offset:5120
  ds_read_b64_tr_b16 v[124:125], v13 offset:4096
  ds_read_b64_tr_b16 v[126:127], v13 offset:5120
  s_waitcnt vmcnt(18) lgkmcnt(4)
  v_mfma_f32_32x32x16_bf16 v[24:39], v[128:131], v[76:79], v[24:39]
  v_mfma_f32_32x32x16_bf16 v[40:55], v[132:135], v[76:79], v[40:55]
  ds_read_b64_tr_b16 v[128:129], v12 offset:6144
  ds_read_b64_tr_b16 v[130:131], v12 offset:7168
  ds_read_b64_tr_b16 v[132:133], v13 offset:6144
  ds_read_b64_tr_b16 v[134:135], v13 offset:7168
  s_waitcnt vmcnt(17) lgkmcnt(4)
  v_mfma_f32_32x32x16_bf16 v[24:39], v[120:123], v[80:83], v[24:39]
  v_mfma_f32_32x32x16_bf16 v[40:55], v[124:127], v[80:83], v[40:55]
  v_cmp_gt_u32 vcc, 4, v16
  s_cbranch_vccnz .g2_kernel_w_bw
.g2_kernel_w_bb:
  ds_read_b64_tr_b16 v[120:121], v10 offset:0
  ds_read_b64_tr_b16 v[122:123], v10 offset:1024
  ds_read_b64_tr_b16 v[124:125], v11 offset:0
  ds_read_b64_tr_b16 v[126:127], v11 offset:1024
  s_waitcnt vmcnt(16) lgkmcnt(4)
  v_mfma_f32_32x32x16_bf16 v[24:39], v[128:131], v[84:87], v[24:39]
  v_mfma_f32_32x32x16_bf16 v[40:55], v[132:135], v[84:87], v[40:55]
  s_mov_b64 exec, 1
  ds_add_u32 v20, v5 offset:16
  s_mov_b64 exec, -1
  s_andn2_b32 s33, s36, s34
  s_cbranch_scc0 .g2_kernel_w_i12c
.g2_kernel_w_i12b:
  s_ff1_i32_b32 s33, s33
  s_bitset1_b32 s34, s33
  s_xor_b32 s33, s33, s24
  s_and_b32 s12, s33, 7
  s_cmp_lt_u32 s12, 2
  s_cselect_b32 s28, 139264, 0
  s_lshl_b32 s12, s12, 13
  s_add_u32 s12, s12, s28
  s_lshl_b32 s33, s33, 12
  s_add_u32 s22, s20, s33
  s_addc_u32 s23, s21, 0
  global_load_dwordx4 v[56:59], v3, s[22:23] offset:0
  global_load_dwordx4 v[60:63], v3, s[22:23] offset:1024
  global_load_dwordx4 v[64:67], v3, s[22:23] offset:2048
  global_load_dwordx4 v[68:71], v3, s[22:23] offset:3072
  v_add_u32 v12, s9, v14
  v_add_u32 v13, s9, v15
  ds_read_b64_tr_b16 v[128:129], v10 offset:2048
  ds_read_b64_tr_b16 v[130:131], v10 offset:3072
  ds_read_b64_tr_b16 v[132:133], v11 offset:2048
  ds_read_b64_tr_b16 v[134:135], v11 offset:3072
  s_waitcnt vmcnt(19) lgkmcnt(4)
  v_mfma_f32_32x32x16_bf16 v[24:39], v[120:123], v[88:91], v[24:39]
  v_mov_b32 v168, 0
  v_mov_b32 v169, 0
  v_mov_b32 v170, 0
  v_mfma_f32_32x32x16_bf16 v[40:55], v[124:127], v[88:91], v[40:55]
  v_mov_b32 v171, 0
  v_mov_b32 v172, 0
  v_mov_b32 v173, 0
  ds_read_b64_tr_b16 v[120:121], v10 offset:4096
  ds_read_b64_tr_b16 v[122:123], v10 offset:5120
  ds_read_b64_tr_b16 v[124:125], v11 offset:4096
  ds_read_b64_tr_b16 v[126:127], v11 offset:5120
  s_waitcnt vmcnt(18) lgkmcnt(4)
  v_mfma_f32_32x32x16_bf16 v[24:39], v[128:131], v[92:95], v[24:39]
  v_mov_b32 v174, 0
  v_mov_b32 v175, 0
  v_mov_b32 v176, 0
  v_mfma_f32_32x32x16_bf16 v[40:55], v[132:135], v[92:95], v[40:55]
  v_mov_b32 v177, 0
  v_mov_b32 v178, 0
  v_mov_b32 v179, 0
  ds_read_b64_tr_b16 v[128:129], v10 offset:6144
  ds_read_b64_tr_b16 v[130:131], v10 offset:7168
  ds_read_b64_tr_b16 v[132:133], v11 offset:6144
  ds_read_b64_tr_b16 v[134:135], v11 offset:7168
  s_waitcnt vmcnt(17) lgkmcnt(4)
  v_mfma_f32_32x32x16_bf16 v[24:39], v[120:123], v[96:99], v[24:39]
  v_mov_b32 v180, 0
  v_mov_b32 v181, 0
  v_mov_b32 v182, 0
  v_mfma_f32_32x32x16_bf16 v[40:55], v[124:127], v[96:99], v[40:55]
  v_mov_b32 v183, 0
  v_mov_b32 v184, 0
  v_mov_b32 v185, 0
  ds_read_b64_tr_b16 v[120:121], v12 offset:0
  ds_read_b64_tr_b16 v[122:123], v12 offset:1024
  ds_read_b64_tr_b16 v[124:125], v13 offset:0
  ds_read_b64_tr_b16 v[126:127], v13 offset:1024
  s_waitcnt vmcnt(16) lgkmcnt(4)
  v_mfma_f32_32x32x16_bf16 v[24:39], v[128:131], v[100:103], v[24:39]
  v_mov_b32 v186, 0
  v_mov_b32 v187, 0
  v_mov_b32 v188, 0
  v_mfma_f32_32x32x16_bf16 v[40:55], v[132:135], v[100:103], v[40:55]
  v_mov_b32 v189, 0
  v_mov_b32 v190, 0
  v_mov_b32 v191, 0
  s_andn2_b32 s33, s36, s34
  s_cbranch_scc0 .g2_kernel_w_i13c
.g2_kernel_w_i13b:
  s_ff1_i32_b32 s33, s33
  s_bitset1_b32 s34, s33
  s_xor_b32 s33, s33, s24
  s_and_b32 s13, s33, 7
  s_cmp_lt_u32 s13, 2
  s_cselect_b32 s28, 139264, 0
  s_lshl_b32 s13, s13, 13
  s_add_u32 s13, s13, s28
  s_lshl_b32 s33, s33, 12
  s_add_u32 s22, s20, s33
  s_addc_u32 s23, s21, 0
  global_load_dwordx4 v[72:75], v3, s[22:23] offset:0
  global_load_dwordx4 v[76:79], v3, s[22:23] offset:1024
  global_load_dwordx4 v[80:83], v3, s[22:23] offset:2048
  global_load_dwordx4 v[84:87], v3, s[22:23] offset:3072
  v_add_u32 v10, s10, v14
  v_add_u32 v11, s10, v15
  ds_read_b64_tr_b16 v[128:129], v12 offset:2048
  ds_read_b64_tr_b16 v[130:131], v12 offset:3072
  ds_read_b64_tr_b16 v[132:133], v13 offset:2048
  ds_read_b64_tr_b16 v[134:135], v13 offset:3072
  s_waitcnt vmcnt(19) lgkmcnt(4)
  v_mfma_f32_32x32x16_bf16 v[24:39], v[120:123], v[104:107], v[24:39]
  v_mov_b32 v192, 0
  v_mov_b32 v193, 0
  v_mov_b32 v194, 0
  v_mfma_f32_32x32x16_bf16 v[40:55], v[124:127], v[104:107], v[40:55]
  v_mov_b32 v195, 0
  v_mov_b32 v196, 0
  v_mov_b32 v197, 0
  ds_read_b64_tr_b16 v[120:121], v12 offset:4096
  ds_read_b64_tr_b16 v[122:123], v12 offset:5120
  ds_read_b64_tr_b16 v[124:125], v13 offset:4096
  ds_read_b64_tr_b16 v[126:127], v13 offset:5120
  s_waitcnt vmcnt(18) lgkmcnt(4)
  v_mfma_f32_32x32x16_bf16 v[24:39], v[128:131], v[108:111], v[24:39]
  v_mov_b32 v198, 0
  v_mov_b32 v199, 0
  v_mov_b32 v200, 0
  v_mfma_f32_32x32x16_bf16 v[40:55], v[132:135], v[108:111], v[40:55]
  v_mov_b32 v201, 0
  v_mov_b32 v202, 0
  v_mov_b32 v203, 0
  ds_read_b64_tr_b16 v[128:129], v12 offset:6144
  ds_read_b64_tr_b16 v[130:131], v12 offset:7168
  ds_read_b64_tr_b16 v[132:133], v13 offset:6144
  ds_read_b64_tr_b16 v[134:135], v13 offset:7168
  s_waitcnt vmcnt(17) lgkmcnt(4)
  v_mfma_f32_32x32x16_bf16 v[24:39], v[120:123], v[112:115], v[24:39]
  v_mov_b32 v204, 0
  v_mov_b32 v205, 0
  v_mov_b32 v206, 0
  v_mfma_f32_32x32x16_bf16 v[40:55], v[124:127], v[112:115], v[40:55]
  v_mov_b32 v207, 0
  v_mov_b32 v208, 0
  v_mov_b32 v209, 0
  ds_read_b64_tr_b16 v[120:121], v10 offset:0
  ds_read_b64_tr_b16 v[122:123], v10 offset:1024
  ds_read_b64_tr_b16 v[124:125], v11 offset:0
  ds_read_b64_tr_b16 v[126:127], v11 offset:1024
  s_waitcnt vmcnt(16) lgkmcnt(4)
  v_mfma_f32_32x32x16_bf16 v[24:39], v[128:131], v[116:119], v[24:39]
  v_mov_b32 v210, 0
  v_mov_b32 v211, 0
  v_mov_b32 v212, 0
  v_mfma_f32_32x32x16_bf16 v[40:55], v[132:135], v[116:119], v[40:55]
  v_mov_b32 v213, 0
  v_mov_b32 v214, 0
  v_mov_b32 v215, 0
  s_andn2_b32 s33, s36, s34
  s_cbranch_scc0 .g2_kernel_w_i14c
.g2_kernel_w_i14b:
  s_ff1_i32_b32 s33, s33
  s_bitset1_b32 s34, s33
  s_xor_b32 s33, s33, s24
  s_and_b32 s14, s33, 7
  s_cmp_lt_u32 s14, 2
  s_cselect_b32 s28, 139264, 0
  s_lshl_b32 s14, s14, 13
  s_add_u32 s14, s14, s28
  s_lshl_b32 s33, s33, 12
  s_add_u32 s22, s20, s33
  s_addc_u32 s23, s21, 0
  global_load_dwordx4 v[88:91], v3, s[22:23] offset:0
  global_load_dwordx4 v[92:95], v3, s[22:23] offset:1024
  global_load_dwordx4 v[96:99], v3, s[22:23] offset:2048
  global_load_dwordx4 v[100:103], v3, s[22:23] offset:3072
  v_add_u32 v12, s11, v14
  v_add_u32 v13, s11, v15
  ds_read_b64_tr_b16 v[128:129], v10 offset:2048
  ds_read_b64_tr_b16 v[130:131], v10 offset:3072
  ds_read_b64_tr_b16 v[132:133], v11 offset:2048
  ds_read_b64_tr_b16 v[134:135], v11 offset:3072
  s_waitcnt vmcnt(19) lgkmcnt(4)
  v_mfma_f32_32x32x16_bf16 v[24:39], v[120:123], v[136:139], v[24:39]
  v_mov_b32 v216, 0
  v_mov_b32 v217, 0
  v_mov_b32 v218, 0
  v_mfma_f32_32x32x16_bf16 v[40:55], v[124:127], v[136:139], v[40:55]
  v_mov_b32 v219, 0
  v_mov_b32 v220, 0
  v_mov_b32 v221, 0
  ds_read_b64_tr_b16 v[120:121], v10 offset:4096
  ds_read_b64_tr_b16 v[122:123], v10 offset:5120
  ds_read_b64_tr_b16 v[124:125], v11 offset:4096
  ds_read_b64_tr_b16 v[126:127], v11 offset:5120
  s_waitcnt vmcnt(18) lgkmcnt(4)
  v_mfma_f32_32x32x16_bf16 v[24:39], v[128:131], v[140:143], v[24:39]
  v_mov_b32 v222, 0
  v_mov_b32 v223, 0
  v_mov_b32 v224, 0
  v_mfma_f32_32x32x16_bf16 v[40:55], v[132:135], v[140:143], v[40:55]
  v_mov_b32 v225, 0
  v_mov_b32 v226, 0
  v_mov_b32 v227, 0
  ds_read_b64_tr_b16 v[128:129], v10 offset:6144
  ds_read_b64_tr_b16 v[130:131], v10 offset:7168
  ds_read_b64_tr_b16 v[132:133], v11 offset:6144
  ds_read_b64_tr_b16 v[134:135], v11 offset:7168
  s_waitcnt vmcnt(17) lgkmcnt(4)
  v_mfma_f32_32x32x16_bf16 v[24:39], v[120:123], v[144:147], v[24:39]
  v_mov_b32 v228, 0
  v_mov_b32 v229, 0
  v_mov_b32 v230, 0
  v_mfma_f32_32x32x16_bf16 v[40:55], v[124:127], v[144:147], v[40:55]
  v_mov_b32 v231, 0
  v_mov_b32 v232, 0
  v_mov_b32 v233, 0
  ds_read_b64_tr_b16 v[120:121], v12 offset:0
  ds_read_b64_tr_b16 v[122:123], v12 offset:1024
  ds_read_b64_tr_b16 v[124:125], v13 offset:0
  ds_read_b64_tr_b16 v[126:127], v13 offset:1024
  s_waitcnt vmcnt(16) lgkmcnt(4)
  v_mfma_f32_32x32x16_bf16 v[24:39], v[128:131], v[148:151], v[24:39]
  v_mov_b32 v234, 0
  v_mov_b32 v235, 0
  v_mov_b32 v236, 0
  v_mfma_f32_32x32x16_bf16 v[40:55], v[132:135], v[148:151], v[40:55]
  v_mov_b32 v237, 0
  v_mov_b32 v238, 0
  v_mov_b32 v239, 0
  v_lshlrev_b32 v7, 4, v17
  s_lshl_b32 s28, s18, 7
  buffer_load_dwordx4 v[136:139], v7, s[72:75], s28 offen offset:0
  buffer_load_dwordx4 v[140:143], v7, s[72:75], s28 offen offset:32
  buffer_load_dwordx4 v[144:147], v7, s[72:75], s28 offen offset:64
  buffer_load_dwordx4 v[148:151], v7, s[72:75], s28 offen offset:96
  s_andn2_b32 s33, s36, s34
  s_cbranch_scc0 .g2_kernel_w_i15c
.g2_kernel_w_i15b:
  s_ff1_i32_b32 s33, s33
  s_bitset1_b32 s34, s33
  s_xor_b32 s33, s33, s24
  s_and_b32 s15, s33, 7
  s_cmp_lt_u32 s15, 2
  s_cselect_b32 s28, 139264, 0
  s_lshl_b32 s15, s15, 13
  s_add_u32 s15, s15, s28
  s_lshl_b32 s33, s33, 12
  s_add_u32 s22, s20, s33
  s_addc_u32 s23, s21, 0
  global_load_dwordx4 v[104:107], v3, s[22:23] offset:0
  global_load_dwordx4 v[108:111], v3, s[22:23] offset:1024
  global_load_dwordx4 v[112:115], v3, s[22:23] offset:2048
  global_load_dwordx4 v[116:119], v3, s[22:23] offset:3072
  v_add_u32 v10, s12, v14
  v_add_u32 v11, s12, v15
  ds_read_b64_tr_b16 v[128:129], v12 offset:2048
  ds_read_b64_tr_b16 v[130:131], v12 offset:3072
  ds_read_b64_tr_b16 v[132:133], v13 offset:2048
  ds_read_b64_tr_b16 v[134:135], v13 offset:3072
  s_waitcnt vmcnt(23) lgkmcnt(4)
  v_mfma_f32_32x32x16_bf16 v[24:39], v[120:123], v[152:155], v[24:39]
  v_mov_b32 v240, 0
  v_mov_b32 v241, 0
  v_mov_b32 v242, 0
  v_mfma_f32_32x32x16_bf16 v[40:55], v[124:127], v[152:155], v[40:55]
  v_mov_b32 v243, 0
  v_mov_b32 v244, 0
  v_mov_b32 v245, 0
  ds_read_b64_tr_b16 v[120:121], v12 offset:4096
  ds_read_b64_tr_b16 v[122:123], v12 offset:5120
  ds_read_b64_tr_b16 v[124:125], v13 offset:4096
  ds_read_b64_tr_b16 v[126:127], v13 offset:5120
  s_waitcnt vmcnt(22) lgkmcnt(4)
  v_mfma_f32_32x32x16_bf16 v[24:39], v[128:131], v[156:159], v[24:39]
  v_mov_b32 v246, 0
  v_mov_b32 v247, 0
  v_mov_b32 v248, 0
  v_mfma_f32_32x32x16_bf16 v[40:55], v[132:135], v[156:159], v[40:55]
  v_mov_b32 v249, 0
  v_mov_b32 v250, 0
  v_mov_b32 v251, 0
  ds_read_b64_tr_b16 v[128:129], v12 offset:6144
  ds_read_b64_tr_b16 v[130:131], v12 offset:7168
  ds_read_b64_tr_b16 v[132:133], v13 offset:6144
  ds_read_b64_tr_b16 v[134:135], v13 offset:7168
  s_waitcnt vmcnt(21) lgkmcnt(4)
  v_mfma_f32_32x32x16_bf16 v[24:39], v[120:123], v[160:163], v[24:39]
  v_mov_b32 v252, 0
  v_mov_b32 v253, 0
  v_mov_b32 v254, 0
  v_mfma_f32_32x32x16_bf16 v[40:55], v[124:127], v[160:163], v[40:55]
  v_mov_b32 v255, 0
  ds_read_b64_tr_b16 v[120:121], v10 offset:0
  ds_read_b64_tr_b16 v[122:123], v10 offset:1024
  ds_read_b64_tr_b16 v[124:125], v11 offset:0
  ds_read_b64_tr_b16 v[126:127], v11 offset:1024
  s_waitcnt vmcnt(20) lgkmcnt(4)
  v_mfma_f32_32x32x16_bf16 v[24:39], v[128:131], v[164:167], v[24:39]
  v_mfma_f32_32x32x16_bf16 v[40:55], v[132:135], v[164:167], v[40:55]
  v_add_u32 v12, s13, v14
  v_add_u32 v13, s13, v15
  ds_read_b64_tr_b16 v[128:129], v10 offset:2048
  ds_read_b64_tr_b16 v[130:131], v10 offset:3072
  ds_read_b64_tr_b16 v[132:133], v11 offset:2048
  ds_read_b64_tr_b16 v[134:135], v11 offset:3072
  s_waitcnt vmcnt(19) lgkmcnt(4)
  v_mfma_f32_32x32x16_bf16 v[24:39], v[120:123], v[56:59], v[24:39]
  v_mov_b32 v160, 0
  v_mov_b32 v161, 0
  v_mov_b32 v162, 0
  v_mfma_f32_32x32x16_bf16 v[40:55], v[124:127], v[56:59], v[40:55]
  v_mov_b32 v163, 0
  v_mov_b32 v164, 0
  v_mov_b32 v165, 0
  ds_read_b64_tr_b16 v[120:121], v10 offset:4096
  ds_read_b64_tr_b16 v[122:123], v10 offset:5120
  ds_read_b64_tr_b16 v[124:125], v11 offset:4096
  ds_read_b64_tr_b16 v[126:127], v11 offset:5120
  s_waitcnt vmcnt(18) lgkmcnt(4)
  v_mfma_f32_32x32x16_bf16 v[24:39], v[128:131], v[60:63], v[24:39]
  v_mov_b32 v166, 0
  v_mov_b32 v167, 0
  v_mfma_f32_32x32x16_bf16 v[40:55], v[132:135], v[60:63], v[40:55]
  ds_read_b64_tr_b16 v[128:129], v10 offset:6144
  ds_read_b64_tr_b16 v[130:131], v10 offset:7168
  ds_read_b64_tr_b16 v[132:133], v11 offset:6144
  ds_read_b64_tr_b16 v[134:135], v11 offset:7168
  s_waitcnt vmcnt(17) lgkmcnt(4)
  v_mfma_f32_32x32x16_bf16 v[24:39], v[120:123], v[64:67], v[24:39]
  v_mfma_f32_32x32x16_bf16 v[40:55], v[124:127], v[64:67], v[40:55]
  ds_read_b64_tr_b16 v[120:121], v12 offset:0
  ds_read_b64_tr_b16 v[122:123], v12 offset:1024
  ds_read_b64_tr_b16 v[124:125], v13 offset:0
  ds_read_b64_tr_b16 v[126:127], v13 offset:1024
  s_waitcnt vmcnt(16) lgkmcnt(4)
  v_mfma_f32_32x32x16_bf16 v[24:39], v[128:131], v[68:71], v[24:39]
  v_mfma_f32_32x32x16_bf16 v[40:55], v[132:135], v[68:71], v[40:55]
  v_add_u32 v10, s14, v14
  v_add_u32 v11, s14, v15
  ds_read_b64_tr_b16 v[128:129], v12 offset:2048
  ds_read_b64_tr_b16 v[130:131], v12 offset:3072
  ds_read_b64_tr_b16 v[132:133], v13 offset:2048
  ds_read_b64_tr_b16 v[134:135], v13 offset:3072
  s_waitcnt vmcnt(15) lgkmcnt(4)
  v_mfma_f32_32x32x16_bf16 v[24:39], v[120:123], v[72:75], v[24:39]
  v_mfma_f32_32x32x16_bf16 v[40:55], v[124:127], v[72:75], v[40:55]
  ds_read_b64_tr_b16 v[120:121], v12 offset:4096
  ds_read_b64_tr_b16 v[122:123], v12 offset:5120
  ds_read_b64_tr_b16 v[124:125], v13 offset:4096
  ds_read_b64_tr_b16 v[126:127], v13 offset:5120
  s_waitcnt vmcnt(14) lgkmcnt(4)
  v_mfma_f32_32x32x16_bf16 v[24:39], v[128:131], v[76:79], v[24:39]
  v_mfma_f32_32x32x16_bf16 v[40:55], v[132:135], v[76:79], v[40:55]
  ds_read_b64_tr_b16 v[128:129], v12 offset:6144
  ds_read_b64_tr_b16 v[130:131], v12 offset:7168
  ds_read_b64_tr_b16 v[132:133], v13 offset:6144
  ds_read_b64_tr_b16 v[134:135], v13 offset:7168
  s_waitcnt vmcnt(13) lgkmcnt(4)
  v_mfma_f32_32x32x16_bf16 v[24:39], v[120:123], v[80:83], v[24:39]
  v_mfma_f32_32x32x16_bf16 v[40:55], v[124:127], v[80:83], v[40:55]
  ds_read_b64_tr_b16 v[120:121], v10 offset:0
  ds_read_b64_tr_b16 v[122:123], v10 offset:1024
  ds_read_b64_tr_b16 v[124:125], v11 offset:0
  ds_read_b64_tr_b16 v[126:127], v11 offset:1024
  s_waitcnt vmcnt(12) lgkmcnt(4)
  v_mfma_f32_32x32x16_bf16 v[24:39], v[128:131], v[84:87], v[24:39]
  v_mfma_f32_32x32x16_bf16 v[40:55], v[132:135], v[84:87], v[40:55]
  v_add_u32 v12, s15, v14
  v_add_u32 v13, s15, v15
  ds_read_b64_tr_b16 v[128:129], v10 offset:2048
  ds_read_b64_tr_b16 v[130:131], v10 offset:3072
  ds_read_b64_tr_b16 v[132:133], v11 offset:2048
  ds_read_b64_tr_b16 v[134:135], v11 offset:3072
  s_waitcnt vmcnt(11) lgkmcnt(4)
  v_mfma_f32_32x32x16_bf16 v[24:39], v[120:123], v[88:91], v[24:39]
  v_mfma_f32_32x32x16_bf16 v[40:55], v[124:127], v[88:91], v[40:55]
  ds_read_b64_tr_b16 v[120:121], v10 offset:4096
  ds_read_b64_tr_b16 v[122:123], v10 offset:5120
  ds_read_b64_tr_b16 v[124:125], v11 offset:4096
  ds_read_b64_tr_b16 v[126:127], v11 offset:5120
  s_waitcnt vmcnt(10) lgkmcnt(4)
  v_mfma_f32_32x32x16_bf16 v[24:39], v[128:131], v[92:95], v[24:39]
  v_mfma_f32_32x32x16_bf16 v[40:55], v[132:135], v[92:95], v[40:55]
  ds_read_b64_tr_b16 v[128:129], v10 offset:6144
  ds_read_b64_tr_b16 v[130:131], v10 offset:7168
  ds_read_b64_tr_b16 v[132:133], v11 offset:6144
  ds_read_b64_tr_b16 v[134:135], v11 offset:7168
  s_waitcnt vmcnt(9) lgkmcnt(4)
  v_mfma_f32_32x32x16_bf16 v[24:39], v[120:123], v[96:99], v[24:39]
  v_mfma_f32_32x32x16_bf16 v[40:55], v[124:127], v[96:99], v[40:55]
  ds_read_b64_tr_b16 v[120:121], v12 offset:0
  ds_read_b64_tr_b16 v[122:123], v12 offset:1024
  ds_read_b64_tr_b16 v[124:125], v13 offset:0
  ds_read_b64_tr_b16 v[126:127], v13 offset:1024
  s_waitcnt vmcnt(8) lgkmcnt(4)
  v_mfma_f32_32x32x16_bf16 v[24:39], v[128:131], v[100:103], v[24:39]
  v_mfma_f32_32x32x16_bf16 v[40:55], v[132:135], v[100:103], v[40:55]
  ds_read_b64_tr_b16 v[128:129], v12 offset:2048
  ds_read_b64_tr_b16 v[130:131], v12 offset:3072
  ds_read_b64_tr_b16 v[132:133], v13 offset:2048
  ds_read_b64_tr_b16 v[134:135], v13 offset:3072
  s_waitcnt vmcnt(3) lgkmcnt(4)
  v_mfma_f32_32x32x16_bf16 v[24:39], v[120:123], v[104:107], v[24:39]
  v_mfma_f32_32x32x16_bf16 v[40:55], v[124:127], v[104:107], v[40:55]
  ds_read_b64_tr_b16 v[120:121], v12 offset:4096
  ds_read_b64_tr_b16 v[122:123], v12 offset:5120
  ds_read_b64_tr_b16 v[124:125], v13 offset:4096
  ds_read_b64_tr_b16 v[126:127], v13 offset:5120
  s_waitcnt vmcnt(2) lgkmcnt(4)
  v_mfma_f32_32x32x16_bf16 v[24:39], v[128:131], v[108:111], v[24:39]
  v_mfma_f32_32x32x16_bf16 v[40:55], v[132:135], v[108:111], v[40:55]
  ds_read_b64_tr_b16 v[128:129], v12 offset:6144
  ds_read_b64_tr_b16 v[130:131], v12 offset:7168
  ds_read_b64_tr_b16 v[132:133], v13 offset:6144
  ds_read_b64_tr_b16 v[134:135], v13 offset:7168
  s_waitcnt vmcnt(1) lgkmcnt(4)
  v_mfma_f32_32x32x16_bf16 v[24:39], v[120:123], v[112:115], v[24:39]
  v_mfma_f32_32x32x16_bf16 v[40:55], v[124:127], v[112:115], v[40:55]
  s_waitcnt vmcnt(0) lgkmcnt(0)
  v_mfma_f32_32x32x16_bf16 v[24:39], v[128:131], v[116:119], v[24:39]
  v_mfma_f32_32x32x16_bf16 v[40:55], v[132:135], v[116:119], v[40:55]
  s_lshl_b32 s28, s17, 4
  s_add_u32 s28, s28, s18
  s_lshl_b32 s28, s28, 2
  s_add_u32 s28, s28, s16
  s_lshl_b32 s28, s28, 12
  s_add_u32 s28, s28, s63
  s_add_u32 s28, s28, 0xc00000
  s_lshl_b32 s29, s16, 12
  v_add_u32 v6, s29, v22
  s_mov_b32 s36, 0x3f803f80
  v_mov_b32 v8, 0
  v_mov_b32 v9, 0
  v_mov_b32 v10, 0
  v_lshlrev_b32 v7, 8, v18
  v_cvt_pk_bf16_f32 v56, v24, v25
  v_cvt_pk_bf16_f32 v57, v26, v27
  v_cvt_pk_bf16_f32 v58, v28, v29
  v_cvt_pk_bf16_f32 v59, v30, v31
  buffer_store_dwordx4 v[56:59], v22, s[4:7], s28 offen offset:0 sc1
  v_cvt_pk_bf16_f32 v60, v32, v33
  v_cvt_pk_bf16_f32 v61, v34, v35
  v_cvt_pk_bf16_f32 v62, v36, v37
  v_cvt_pk_bf16_f32 v63, v38, v39
  buffer_store_dwordx4 v[60:63], v22, s[4:7], s28 offen offset:512 sc1
  v_cvt_pk_bf16_f32 v64, v40, v41
  v_cvt_pk_bf16_f32 v65, v42, v43
  v_cvt_pk_bf16_f32 v66, v44, v45
  v_cvt_pk_bf16_f32 v67, v46, v47
  buffer_store_dwordx4 v[64:67], v22, s[4:7], s28 offen offset:1024 sc1
  v_cvt_pk_bf16_f32 v68, v48, v49
  v_cvt_pk_bf16_f32 v69, v50, v51
  v_cvt_pk_bf16_f32 v70, v52, v53
  v_cvt_pk_bf16_f32 v71, v54, v55
  buffer_store_dwordx4 v[68:71], v22, s[4:7], s28 offen offset:1536 sc1
  ds_write_b128 v6, v[56:59] offset:0
  ds_write_b128 v6, v[60:63] offset:512
  ds_write_b128 v6, v[64:67] offset:1024
  ds_write_b128 v6, v[68:71] offset:1536
  s_mov_b64 exec, 1
  ds_add_u32 v20, v5 offset:20
  s_mov_b64 exec, -1
  s_lshl_b32 s28, s17, 2
  s_add_u32 s28, s28, s16
  s_lshl_b32 s28, s28, 13
  s_lshl_b32 s29, s18, 4
  s_add_u32 s28, s28, s29
  s_add_u32 s28, s28, s63
  s_add_u32 s28, s28, 0x1000000
  v_dot2c_f32_bf16 v8, s36, v56
  v_dot2c_f32_bf16 v9, v56, v56
  v_dot2c_f32_bf16 v10, v56, v136
  v_dot2c_f32_bf16 v8, s36, v57
  v_dot2c_f32_bf16 v9, v57, v57
  v_dot2c_f32_bf16 v10, v57, v137
  v_dot2c_f32_bf16 v8, s36, v58
  v_dot2c_f32_bf16 v9, v58, v58
  v_dot2c_f32_bf16 v10, v58, v138
  v_dot2c_f32_bf16 v8, s36, v59
  v_dot2c_f32_bf16 v9, v59, v59
  v_dot2c_f32_bf16 v10, v59, v139
  v_dot2c_f32_bf16 v8, s36, v60
  v_dot2c_f32_bf16 v9, v60, v60
  v_dot2c_f32_bf16 v10, v60, v140
  v_dot2c_f32_bf16 v8, s36, v61
  v_dot2c_f32_bf16 v9, v61, v61
  v_dot2c_f32_bf16 v10, v61, v141
  v_dot2c_f32_bf16 v8, s36, v62
  v_dot2c_f32_bf16 v9, v62, v62
  v_dot2c_f32_bf16 v10, v62, v142
  v_dot2c_f32_bf16 v8, s36, v63
  v_dot2c_f32_bf16 v9, v63, v63
  v_dot2c_f32_bf16 v10, v63, v143
  v_dot2c_f32_bf16 v8, s36, v64
  v_dot2c_f32_bf16 v9, v64, v64
  v_dot2c_f32_bf16 v10, v64, v144
  v_dot2c_f32_bf16 v8, s36, v65
  v_dot2c_f32_bf16 v9, v65, v65
  v_dot2c_f32_bf16 v10, v65, v145
  v_dot2c_f32_bf16 v8, s36, v66
  v_dot2c_f32_bf16 v9, v66, v66
  v_dot2c_f32_bf16 v10, v66, v146
  v_dot2c_f32_bf16 v8, s36, v67
  v_dot2c_f32_bf16 v9, v67, v67
  v_dot2c_f32_bf16 v10, v67, v147
  v_dot2c_f32_bf16 v8, s36, v68
  v_dot2c_f32_bf16 v9, v68, v68
  v_dot2c_f32_bf16 v10, v68, v148
  v_dot2c_f32_bf16 v8, s36, v69
  v_dot2c_f32_bf16 v9, v69, v69
  v_dot2c_f32_bf16 v10, v69, v149
  v_dot2c_f32_bf16 v8, s36, v70
  v_dot2c_f32_bf16 v9, v70, v70
  v_dot2c_f32_bf16 v10, v70, v150
  v_dot2c_f32_bf16 v8, s36, v71
  v_dot2c_f32_bf16 v9, v71, v71
  v_dot2c_f32_bf16 v10, v71, v151
  s_lshl_b32 s29, s16, 2
  s_add_u32 s37, s19, s29
  v_mov_b32 v24, v8
  v_mov_b32 v25, v9
  v_mov_b32 v26, v10
  v_mov_b32 v11, 1
  v_permlane32_swap_b32 v8, v24
  v_permlane32_swap_b32 v9, v25
  v_permlane32_swap_b32 v10, v26
  v_add_f32 v8, v8, v24
  v_add_f32 v9, v9, v25
  v_add_f32 v10, v10, v26
  v_or_b32 v8, 1, v8
  v_mov_b32 v16, s70
  s_mov_b32 exec_hi, 0
  s_waitcnt vmcnt(0)
  buffer_store_dwordx4 v[8:11], v7, s[4:7], s28 offen sc1
  s_mov_b64 exec, 1
  buffer_store_dword v16, v4, s[4:7], s37 offen offset:32 sc1
  s_mov_b64 exec, -1
  s_cmp_lg_u32 s62, 0
  s_cbranch_scc1 .g2_kernel_tail
  v_mov_b32 v6, s71
  s_mov_b32 s38, 0
.g2_kernel_wg3:
  ds_read_b32 v7, v6 offset:20
  s_add_u32 s38, s38, 1
  s_waitcnt lgkmcnt(0)
  v_cmp_le_u32 vcc, 4, v7
  s_cbranch_vccnz .g2_kernel_wg3d
  s_cmp_lt_u32 s38, 524288
  s_cbranch_scc1 .g2_kernel_wg3
.g2_kernel_wg3d:
  s_mov_b32 s62, 1
  s_mov_b32 s63, 0x1800000
  s_mov_b32 s70, 2
  s_mov_b32 s71, 155776
  s_branch .g2_kernel_q_cons2
.g2_kernel_tail:
  s_mov_b32 s28, s56
  s_mov_b32 s29, s57
  s_mov_b32 s30, 0x400000
  s_mov_b32 s31, 0x00020000
  v_lshlrev_b32 v24, 16, v56
  v_and_b32 v25, 0xffff0000, v56
  v_lshlrev_b32 v26, 16, v57
  v_and_b32 v27, 0xffff0000, v57
  v_lshlrev_b32 v28, 16, v58
  v_and_b32 v29, 0xffff0000, v58
  v_lshlrev_b32 v30, 16, v59
  v_and_b32 v31, 0xffff0000, v59
  v_lshlrev_b32 v32, 16, v60
  v_and_b32 v33, 0xffff0000, v60
  v_lshlrev_b32 v34, 16, v61
  v_and_b32 v35, 0xffff0000, v61
  v_lshlrev_b32 v36, 16, v62
  v_and_b32 v37, 0xffff0000, v62
  v_lshlrev_b32 v38, 16, v63
  v_and_b32 v39, 0xffff0000, v63
  v_lshlrev_b32 v40, 16, v64
  v_and_b32 v41, 0xffff0000, v64
  v_lshlrev_b32 v42, 16, v65
  v_and_b32 v43, 0xffff0000, v65
  v_lshlrev_b32 v44, 16, v66
  v_and_b32 v45, 0xffff0000, v66
  v_lshlrev_b32 v46, 16, v67
  v_and_b32 v47, 0xffff0000, v67
  v_lshlrev_b32 v48, 16, v68
  v_and_b32 v49, 0xffff0000, v68
  v_lshlrev_b32 v50, 16, v69
  v_and_b32 v51, 0xffff0000, v69
  v_lshlrev_b32 v52, 16, v70
  v_and_b32 v53, 0xffff0000, v70
  v_lshlrev_b32 v54, 16, v71
  v_and_b32 v55, 0xffff0000, v71
  v_lshlrev_b32 v10, 2, v19
  v_add_u32 v10, 155644, v10
  s_lshl_b32 s32, s17, 2
  s_add_u32 s32, s32, s16
  s_lshl_b32 s32, s32, 16
  s_lshl_b32 s33, s18, 7
  s_add_u32 s32, s32, s33
  v_mov_b32 v6, s71
  s_mov_b32 s38, 0
.g2_kernel_wg4:
  ds_read_b32 v7, v6 offset:28
  s_add_u32 s38, s38, 1
  s_waitcnt lgkmcnt(0)
  v_cmp_le_u32 vcc, 1, v7
  s_cbranch_vccnz .g2_kernel_wg4d
  s_sleep 2
  s_cmp_lt_u32 s38, 524288
  s_cbranch_scc1 .g2_kernel_wg4
.g2_kernel_wg4d:
  ds_read_b32 v8, v10 offset:3840
  ds_read_b32 v9, v10 offset:4352
  ds_read_b32 v16, v20 offset:32
  s_waitcnt lgkmcnt(0)
  v_cmp_ne_u32 vcc, v16, v19
  v_pk_fma_f32 v[24:25], v[24:25], v[8:9], v[8:9] op_sel:[0,0,1] op_sel_hi:[1,0,1]
  v_pk_fma_f32 v[26:27], v[26:27], v[8:9], v[8:9] op_sel:[0,0,1] op_sel_hi:[1,0,1]
  v_pk_fma_f32 v[28:29], v[28:29], v[8:9], v[8:9] op_sel:[0,0,1] op_sel_hi:[1,0,1]
  v_pk_fma_f32 v[30:31], v[30:31], v[8:9], v[8:9] op_sel:[0,0,1] op_sel_hi:[1,0,1]
  v_pk_fma_f32 v[32:33], v[32:33], v[8:9], v[8:9] op_sel:[0,0,1] op_sel_hi:[1,0,1]
  v_pk_fma_f32 v[34:35], v[34:35], v[8:9], v[8:9] op_sel:[0,0,1] op_sel_hi:[1,0,1]
  v_pk_fma_f32 v[36:37], v[36:37], v[8:9], v[8:9] op_sel:[0,0,1] op_sel_hi:[1,0,1]
  v_pk_fma_f32 v[38:39], v[38:39], v[8:9], v[8:9] op_sel:[0,0,1] op_sel_hi:[1,0,1]
  v_pk_fma_f32 v[40:41], v[40:41], v[8:9], v[8:9] op_sel:[0,0,1] op_sel_hi:[1,0,1]
  v_pk_fma_f32 v[42:43], v[42:43], v[8:9], v[8:9] op_sel:[0,0,1] op_sel_hi:[1,0,1]
  v_pk_fma_f32 v[44:45], v[44:45], v[8:9], v[8:9] op_sel:[0,0,1] op_sel_hi:[1,0,1]
  v_pk_fma_f32 v[46:47], v[46:47], v[8:9], v[8:9] op_sel:[0,0,1] op_sel_hi:[1,0,1]
  v_pk_fma_f32 v[48:49], v[48:49], v[8:9], v[8:9] op_sel:[0,0,1] op_sel_hi:[1,0,1]
  v_pk_fma_f32 v[50:51], v[50:51], v[8:9], v[8:9] op_sel:[0,0,1] op_sel_hi:[1,0,1]
  v_pk_fma_f32 v[52:53], v[52:53], v[8:9], v[8:9] op_sel:[0,0,1] op_sel_hi:[1,0,1]
  v_pk_fma_f32 v[54:55], v[54:55], v[8:9], v[8:9] op_sel:[0,0,1] op_sel_hi:[1,0,1]
  v_cvt_pk_bf16_f32 v56, v24, v25
  v_cvt_pk_bf16_f32 v57, v26, v27
  v_cvt_pk_bf16_f32 v58, v28, v29
  v_cvt_pk_bf16_f32 v59, v30, v31
  v_cvt_pk_bf16_f32 v60, v32, v33
  v_cvt_pk_bf16_f32 v61, v34, v35
  v_cvt_pk_bf16_f32 v62, v36, v37
  v_cvt_pk_bf16_f32 v63, v38, v39
  v_cvt_pk_bf16_f32 v64, v40, v41
  v_cvt_pk_bf16_f32 v65, v42, v43
  v_cvt_pk_bf16_f32 v66, v44, v45
  v_cvt_pk_bf16_f32 v67, v46, v47
  v_cvt_pk_bf16_f32 v68, v48, v49
  v_cvt_pk_bf16_f32 v69, v50, v51
  v_cvt_pk_bf16_f32 v70, v52, v53
  v_cvt_pk_bf16_f32 v71, v54, v55
  s_mov_b64 exec, vcc
  buffer_store_dwordx4 v[56:59], v23, s[28:31], s32 offen offset:0
  buffer_store_dwordx4 v[60:63], v23, s[28:31], s32 offen offset:32
  buffer_store_dwordx4 v[64:67], v23, s[28:31], s32 offen offset:64
  buffer_store_dwordx4 v[68:71], v23, s[28:31], s32 offen offset:96
  s_mov_b64 exec, -1
  s_branch .g2_kernel_fin
.g2_kernel_svc:
  s_cmp_eq_u32 s16, 5
  s_cbranch_scc1 .g2_kernel_s1
  s_cmp_eq_u32 s16, 6
  s_cbranch_scc1 .g2_kernel_s2
  s_cmp_eq_u32 s16, 7
  s_cbranch_scc1 .g2_kernel_s3
  s_mov_b32 s8, s40
  s_mov_b32 s9, s41
  s_mov_b32 s10, 0x400000
  s_mov_b32 s11, 0x00020000
  s_setprio 3
  v_lshrrev_b32 v20, 3, v2
  v_and_b32 v21, 7, v2
  v_lshrrev_b32 v22, 4, v2
  v_xor_b32 v23, v21, v22
  v_lshlrev_b32 v23, 4, v23
  v_lshl_add_u32 v24, v20, 11, v23
  v_xor_b32 v25, 64, v24
  s_lshl_b32 s32, s17, 18
  v_add_u32 v32, 0, v24
  v_add_u32 v33, 15360, v25
  v_add_u32 v34, 30720, v24
  v_add_u32 v35, 46080, v25
  v_add_u32 v36, 65536, v24
  v_add_u32 v37, 80896, v25
  v_add_u32 v38, 96256, v24
  v_add_u32 v39, 111616, v25
  v_add_u32 v40, 131072, v24
  v_add_u32 v41, 146432, v25
  v_add_u32 v42, 161792, v24
  v_add_u32 v43, 177152, v25
  v_add_u32 v44, 196608, v24
  v_add_u32 v45, 211968, v25
  v_add_u32 v46, 227328, v24
  v_add_u32 v47, 242688, v25
  s_mov_b32 s29, 0
  s_add_u32 m0, s29, 0
  s_nop 0
  buffer_load_dwordx4 v32, s[8:11], s32 offen offset:0 lds
  buffer_load_dwordx4 v33, s[8:11], s32 offen offset:1024 lds
  buffer_load_dwordx4 v34, s[8:11], s32 offen offset:2048 lds
  buffer_load_dwordx4 v35, s[8:11], s32 offen offset:3072 lds
  s_add_u32 m0, s29, 4096
  s_nop 0
  buffer_load_dwordx4 v36, s[8:11], s32 offen offset:0 lds
  buffer_load_dwordx4 v37, s[8:11], s32 offen offset:1024 lds
  buffer_load_dwordx4 v38, s[8:11], s32 offen offset:2048 lds
  buffer_load_dwordx4 v39, s[8:11], s32 offen offset:3072 lds
  s_add_u32 m0, s29, 8192
  s_nop 0
  buffer_load_dwordx4 v40, s[8:11], s32 offen offset:0 lds
  buffer_load_dwordx4 v41, s[8:11], s32 offen offset:1024 lds
  buffer_load_dwordx4 v42, s[8:11], s32 offen offset:2048 lds
  buffer_load_dwordx4 v43, s[8:11], s32 offen offset:3072 lds
  s_add_u32 m0, s29, 12288
  s_nop 0
  buffer_load_dwordx4 v44, s[8:11], s32 offen offset:0 lds
  buffer_load_dwordx4 v45, s[8:11], s32 offen offset:1024 lds
  buffer_load_dwordx4 v46, s[8:11], s32 offen offset:2048 lds
  buffer_load_dwordx4 v47, s[8:11], s32 offen offset:3072 lds
  s_add_u32 s32, s32, 128
  s_mov_b32 s12, s42
  s_mov_b32 s13, s43
  s_mov_b32 s14, 0x600000
  s_mov_b32 s15, 0x00020000
  v_lshrrev_b32 v28, 3, v2
  v_and_b32 v29, 7, v2
  v_bfe_u32 v30, v2, 4, 1
  v_lshlrev_b32 v30, 1, v30
  v_xor_b32 v31, v29, v30
  v_lshlrev_b32 v31, 4, v31
  v_mul_u32_u24 v28, 6144, v28
  v_add_u32 v28, v28, v31
  v_xor_b32 v29, 64, v28
  v_lshlrev_b32 v9, 8, v2
  v_and_b32 v9, 0x300, v9
  v_add_u32 v9, 156416, v9
  v_add_u32 v48, 0, v28
  v_add_u32 v49, 48128, v29
  v_add_u32 v50, 96256, v28
  v_add_u32 v51, 144384, v29
  v_add_u32 v52, 2048, v28
  v_add_u32 v53, 50176, v29
  v_add_u32 v54, 98304, v28
  v_add_u32 v55, 146432, v29
  v_add_u32 v56, 4096, v28
  v_add_u32 v57, 52224, v29
  v_add_u32 v58, 100352, v28
  v_add_u32 v59, 148480, v29
  s_lshl_b32 s36, s18, 7
  s_mov_b32 s30, 0
  s_add_u32 m0, s30, 65536
  s_nop 0
  buffer_load_dwordx4 v48, s[12:15], s36 offen offset:0 lds
  buffer_load_dwordx4 v49, s[12:15], s36 offen offset:1024 lds
  buffer_load_dwordx4 v50, s[12:15], s36 offen offset:2048 lds
  buffer_load_dwordx4 v51, s[12:15], s36 offen offset:3072 lds
  s_add_u32 m0, s30, 69632
  s_nop 0
  buffer_load_dwordx4 v52, s[12:15], s36 offen offset:0 lds
  buffer_load_dwordx4 v53, s[12:15], s36 offen offset:1024 lds
  buffer_load_dwordx4 v54, s[12:15], s36 offen offset:2048 lds
  buffer_load_dwordx4 v55, s[12:15], s36 offen offset:3072 lds
  s_add_u32 m0, s30, 73728
  s_nop 0
  buffer_load_dwordx4 v56, s[12:15], s36 offen offset:0 lds
  buffer_load_dwordx4 v57, s[12:15], s36 offen offset:1024 lds
  buffer_load_dwordx4 v58, s[12:15], s36 offen offset:2048 lds
  buffer_load_dwordx4 v59, s[12:15], s36 offen offset:3072 lds
  s_add_u32 s30, s30, 12288
  s_cmp_eq_u32 s30, 86016
  s_cselect_b32 s30, 0, s30
  s_barrier
  s_mov_b32 s35, .g2_kernel_tab-.g2_kernel_pc+4
  s_mov_b32 s34, -5
  v_mov_b32 v10, 0
  s_mov_b32 m0, 156160
  s_add_u32 s36, s36, 196608
  buffer_load_dword off, s[64:67], s35 lds
  s_add_u32 s35, s35, 4
  s_branch .g2_kernel_p1_o
  .p2align 6
.g2_kernel_p1_l:
  s_waitcnt lgkmcnt(0)
  v_cmp_gt_i32 vcc, s34, v10
  s_cbranch_vccnz .g2_kernel_p1_aw
.g2_kernel_p1_ai:
  s_add_u32 s29, s29, 16384
  s_and_b32 s29, s29, 0xffff
  s_add_u32 m0, s29, 0
  s_nop 0
  buffer_load_dwordx4 v32, s[8:11], s32 offen offset:0 lds
  buffer_load_dwordx4 v33, s[8:11], s32 offen offset:1024 lds
  buffer_load_dwordx4 v34, s[8:11], s32 offen offset:2048 lds
  buffer_load_dwordx4 v35, s[8:11], s32 offen offset:3072 lds
  s_add_u32 m0, s29, 4096
  s_nop 0
  buffer_load_dwordx4 v36, s[8:11], s32 offen offset:0 lds
  buffer_load_dwordx4 v37, s[8:11], s32 offen offset:1024 lds
  buffer_load_dwordx4 v38, s[8:11], s32 offen offset:2048 lds
  buffer_load_dwordx4 v39, s[8:11], s32 offen offset:3072 lds
  s_add_u32 m0, s29, 8192
  s_nop 0
  buffer_load_dwordx4 v40, s[8:11], s32 offen offset:0 lds
  buffer_load_dwordx4 v41, s[8:11], s32 offen offset:1024 lds
  buffer_load_dwordx4 v42, s[8:11], s32 offen offset:2048 lds
  buffer_load_dwordx4 v43, s[8:11], s32 offen offset:3072 lds
  s_add_u32 m0, s29, 12288
  s_nop 0
  buffer_load_dwordx4 v44, s[8:11], s32 offen offset:0 lds
  buffer_load_dwordx4 v45, s[8:11], s32 offen offset:1024 lds
  buffer_load_dwordx4 v46, s[8:11], s32 offen offset:2048 lds
  buffer_load_dwordx4 v47, s[8:11], s32 offen offset:3072 lds
  s_add_u32 s32, s32, 128
  s_add_u32 m0, s30, 65536
  s_nop 0
  buffer_load_dwordx4 v48, s[12:15], s36 offen offset:0 lds
  buffer_load_dwordx4 v49, s[12:15], s36 offen offset:1024 lds
  buffer_load_dwordx4 v50, s[12:15], s36 offen offset:2048 lds
  buffer_load_dwordx4 v51, s[12:15], s36 offen offset:3072 lds
  s_add_u32 m0, s30, 69632
  s_nop 0
  buffer_load_dwordx4 v52, s[12:15], s36 offen offset:0 lds
  buffer_load_dwordx4 v53, s[12:15], s36 offen offset:1024 lds
  buffer_load_dwordx4 v54, s[12:15], s36 offen offset:2048 lds
  buffer_load_dwordx4 v55, s[12:15], s36 offen offset:3072 lds
  s_add_u32 m0, s30, 73728
  s_nop 0
  buffer_load_dwordx4 v56, s[12:15], s36 offen offset:0 lds
  buffer_load_dwordx4 v57, s[12:15], s36 offen offset:1024 lds
  buffer_load_dwordx4 v58, s[12:15], s36 offen offset:2048 lds
  buffer_load_dwordx4 v59, s[12:15], s36 offen offset:3072 lds
  s_add_u32 s30, s30, 12288
  s_cmp_eq_u32 s30, 86016
  s_cselect_b32 s30, 0, s30
  ds_read_b32 v10, v9
  s_mov_b32 m0, 156160
  s_add_u32 s34, s34, 1
  buffer_load_dword off, s[64:67], s35 lds
  s_add_u32 s35, s35, 4
  s_add_u32 s36, s36, 196608
.g2_kernel_p1_o:
  s_waitcnt lgkmcnt(0)
  v_cmp_gt_i32 vcc, s34, v10
  s_cbranch_vccnz .g2_kernel_p1_bw
.g2_kernel_p1_bi:
  s_add_u32 m0, s30, 65536
  s_nop 0
  buffer_load_dwordx4 v48, s[12:15], s36 offen offset:0 lds
  buffer_load_dwordx4 v49, s[12:15], s36 offen offset:1024 lds
  buffer_load_dwordx4 v50, s[12:15], s36 offen offset:2048 lds
  buffer_load_dwordx4 v51, s[12:15], s36 offen offset:3072 lds
  s_add_u32 m0, s30, 69632
  s_nop 0
  buffer_load_dwordx4 v52, s[12:15], s36 offen offset:0 lds
  buffer_load_dwordx4 v53, s[12:15], s36 offen offset:1024 lds
  buffer_load_dwordx4 v54, s[12:15], s36 offen offset:2048 lds
  buffer_load_dwordx4 v55, s[12:15], s36 offen offset:3072 lds
  s_add_u32 m0, s30, 73728
  s_nop 0
  buffer_load_dwordx4 v56, s[12:15], s36 offen offset:0 lds
  buffer_load_dwordx4 v57, s[12:15], s36 offen offset:1024 lds
  buffer_load_dwordx4 v58, s[12:15], s36 offen offset:2048 lds
  buffer_load_dwordx4 v59, s[12:15], s36 offen offset:3072 lds
  s_add_u32 s30, s30, 12288
  s_cmp_eq_u32 s30, 86016
  s_cselect_b32 s30, 0, s30
  ds_read_b32 v10, v9
  s_mov_b32 m0, 156160
  s_add_u32 s34, s34, 1
  buffer_load_dword off, s[64:67], s35 lds
  s_add_u32 s35, s35, 4
  s_add_u32 s36, s36, 196608
  s_cmp_lt_i32 s34, 26
  s_cbranch_scc1 .g2_kernel_p1_l
  s_branch .g2_kernel_v
.g2_kernel_s1:
  s_mov_b32 s8, s40
  s_mov_b32 s9, s41
  s_mov_b32 s10, 0x400000
  s_mov_b32 s11, 0x00020000
  v_lshrrev_b32 v20, 3, v2
  v_and_b32 v21, 7, v2
  v_lshlrev_b32 v21, 4, v21
  v_lshl_add_u32 v21, v20, 11, v21
  s_lshl_b32 s30, s17, 4
  s_add_u32 s30, s30, s18
  s_lshl_b32 s33, s30, 5
  s_lshl_b32 s30, s30, 14
  s_barrier
  s_sleep 0
  buffer_load_dwordx4 v[64:67], v21, s[8:11], s30 offen offset:0
  buffer_load_dwordx4 v[68:71], v21, s[8:11], s30 offen offset:128
  buffer_load_dwordx4 v[72:75], v21, s[8:11], s30 offen offset:256
  buffer_load_dwordx4 v[76:79], v21, s[8:11], s30 offen offset:384
  buffer_load_dwordx4 v[80:83], v21, s[8:11], s30 offen offset:512
  buffer_load_dwordx4 v[84:87], v21, s[8:11], s30 offen offset:640
  buffer_load_dwordx4 v[88:91], v21, s[8:11], s30 offen offset:768
  buffer_load_dwordx4 v[92:95], v21, s[8:11], s30 offen offset:896
  buffer_load_dwordx4 v[96:99], v21, s[8:11], s30 offen offset:1024
  buffer_load_dwordx4 v[100:103], v21, s[8:11], s30 offen offset:1152
  buffer_load_dwordx4 v[104:107], v21, s[8:11], s30 offen offset:1280
  buffer_load_dwordx4 v[108:111], v21, s[8:11], s30 offen offset:1408
  buffer_load_dwordx4 v[112:115], v21, s[8:11], s30 offen offset:1536
  buffer_load_dwordx4 v[116:119], v21, s[8:11], s30 offen offset:1664
  buffer_load_dwordx4 v[120:123], v21, s[8:11], s30 offen offset:1792
  buffer_load_dwordx4 v[124:127], v21, s[8:11], s30 offen offset:1920
  v_mov_b32 v24, 0
  v_mov_b32 v25, 0
  v_mov_b32 v26, 0
  v_mov_b32 v27, 0
  s_waitcnt vmcnt(15)
  v_lshlrev_b32 v22, 16, v64
  v_and_b32 v64, 0xffff0000, v64
  v_add_f32 v24, v24, v22
  v_fmac_f32 v25, v22, v22
  v_add_f32 v26, v26, v64
  v_fmac_f32 v27, v64, v64
  v_lshlrev_b32 v22, 16, v65
  v_and_b32 v65, 0xffff0000, v65
  v_add_f32 v24, v24, v22
  v_fmac_f32 v25, v22, v22
  v_add_f32 v26, v26, v65
  v_fmac_f32 v27, v65, v65
  v_lshlrev_b32 v22, 16, v66
  v_and_b32 v66, 0xffff0000, v66
  v_add_f32 v24, v24, v22
  v_fmac_f32 v25, v22, v22
  v_add_f32 v26, v26, v66
  v_fmac_f32 v27, v66, v66
  v_lshlrev_b32 v22, 16, v67
  v_and_b32 v67, 0xffff0000, v67
  v_add_f32 v24, v24, v22
  v_fmac_f32 v25, v22, v22
  v_add_f32 v26, v26, v67
  v_fmac_f32 v27, v67, v67
  s_waitcnt vmcnt(14)
  v_lshlrev_b32 v22, 16, v68
  v_and_b32 v68, 0xffff0000, v68
  v_add_f32 v24, v24, v22
  v_fmac_f32 v25, v22, v22
  v_add_f32 v26, v26, v68
  v_fmac_f32 v27, v68, v68
  v_lshlrev_b32 v22, 16, v69
  v_and_b32 v69, 0xffff0000, v69
  v_add_f32 v24, v24, v22
  v_fmac_f32 v25, v22, v22
  v_add_f32 v26, v26, v69
  v_fmac_f32 v27, v69, v69
  v_lshlrev_b32 v22, 16, v70
  v_and_b32 v70, 0xffff0000, v70
  v_add_f32 v24, v24, v22
  v_fmac_f32 v25, v22, v22
  v_add_f32 v26, v26, v70
  v_fmac_f32 v27, v70, v70
  v_lshlrev_b32 v22, 16, v71
  v_and_b32 v71, 0xffff0000, v71
  v_add_f32 v24, v24, v22
  v_fmac_f32 v25, v22, v22
  v_add_f32 v26, v26, v71
  v_fmac_f32 v27, v71, v71
  s_waitcnt vmcnt(13)
  v_lshlrev_b32 v22, 16, v72
  v_and_b32 v72, 0xffff0000, v72
  v_add_f32 v24, v24, v22
  v_fmac_f32 v25, v22, v22
  v_add_f32 v26, v26, v72
  v_fmac_f32 v27, v72, v72
  v_lshlrev_b32 v22, 16, v73
  v_and_b32 v73, 0xffff0000, v73
  v_add_f32 v24, v24, v22
  v_fmac_f32 v25, v22, v22
  v_add_f32 v26, v26, v73
  v_fmac_f32 v27, v73, v73
  v_lshlrev_b32 v22, 16, v74
  v_and_b32 v74, 0xffff0000, v74
  v_add_f32 v24, v24, v22
  v_fmac_f32 v25, v22, v22
  v_add_f32 v26, v26, v74
  v_fmac_f32 v27, v74, v74
  v_lshlrev_b32 v22, 16, v75
  v_and_b32 v75, 0xffff0000, v75
  v_add_f32 v24, v24, v22
  v_fmac_f32 v25, v22, v22
  v_add_f32 v26, v26, v75
  v_fmac_f32 v27, v75, v75
  s_waitcnt vmcnt(12)
  v_lshlrev_b32 v22, 16, v76
  v_and_b32 v76, 0xffff0000, v76
  v_add_f32 v24, v24, v22
  v_fmac_f32 v25, v22, v22
  v_add_f32 v26, v26, v76
  v_fmac_f32 v27, v76, v76
  v_lshlrev_b32 v22, 16, v77
  v_and_b32 v77, 0xffff0000, v77
  v_add_f32 v24, v24, v22
  v_fmac_f32 v25, v22, v22
  v_add_f32 v26, v26, v77
  v_fmac_f32 v27, v77, v77
  v_lshlrev_b32 v22, 16, v78
  v_and_b32 v78, 0xffff0000, v78
  v_add_f32 v24, v24, v22
  v_fmac_f32 v25, v22, v22
  v_add_f32 v26, v26, v78
  v_fmac_f32 v27, v78, v78
  v_lshlrev_b32 v22, 16, v79
  v_and_b32 v79, 0xffff0000, v79
  v_add_f32 v24, v24, v22
  v_fmac_f32 v25, v22, v22
  v_add_f32 v26, v26, v79
  v_fmac_f32 v27, v79, v79
  s_waitcnt vmcnt(11)
  v_lshlrev_b32 v22, 16, v80
  v_and_b32 v80, 0xffff0000, v80
  v_add_f32 v24, v24, v22
  v_fmac_f32 v25, v22, v22
  v_add_f32 v26, v26, v80
  v_fmac_f32 v27, v80, v80
  v_lshlrev_b32 v22, 16, v81
  v_and_b32 v81, 0xffff0000, v81
  v_add_f32 v24, v24, v22
  v_fmac_f32 v25, v22, v22
  v_add_f32 v26, v26, v81
  v_fmac_f32 v27, v81, v81
  v_lshlrev_b32 v22, 16, v82
  v_and_b32 v82, 0xffff0000, v82
  v_add_f32 v24, v24, v22
  v_fmac_f32 v25, v22, v22
  v_add_f32 v26, v26, v82
  v_fmac_f32 v27, v82, v82
  v_lshlrev_b32 v22, 16, v83
  v_and_b32 v83, 0xffff0000, v83
  v_add_f32 v24, v24, v22
  v_fmac_f32 v25, v22, v22
  v_add_f32 v26, v26, v83
  v_fmac_f32 v27, v83, v83
  s_waitcnt vmcnt(10)
  v_lshlrev_b32 v22, 16, v84
  v_and_b32 v84, 0xffff0000, v84
  v_add_f32 v24, v24, v22
  v_fmac_f32 v25, v22, v22
  v_add_f32 v26, v26, v84
  v_fmac_f32 v27, v84, v84
  v_lshlrev_b32 v22, 16, v85
  v_and_b32 v85, 0xffff0000, v85
  v_add_f32 v24, v24, v22
  v_fmac_f32 v25, v22, v22
  v_add_f32 v26, v26, v85
  v_fmac_f32 v27, v85, v85
  v_lshlrev_b32 v22, 16, v86
  v_and_b32 v86, 0xffff0000, v86
  v_add_f32 v24, v24, v22
  v_fmac_f32 v25, v22, v22
  v_add_f32 v26, v26, v86
  v_fmac_f32 v27, v86, v86
  v_lshlrev_b32 v22, 16, v87
  v_and_b32 v87, 0xffff0000, v87
  v_add_f32 v24, v24, v22
  v_fmac_f32 v25, v22, v22
  v_add_f32 v26, v26, v87
  v_fmac_f32 v27, v87, v87
  s_waitcnt vmcnt(9)
  v_lshlrev_b32 v22, 16, v88
  v_and_b32 v88, 0xffff0000, v88
  v_add_f32 v24, v24, v22
  v_fmac_f32 v25, v22, v22
  v_add_f32 v26, v26, v88
  v_fmac_f32 v27, v88, v88
  v_lshlrev_b32 v22, 16, v89
  v_and_b32 v89, 0xffff0000, v89
  v_add_f32 v24, v24, v22
  v_fmac_f32 v25, v22, v22
  v_add_f32 v26, v26, v89
  v_fmac_f32 v27, v89, v89
  v_lshlrev_b32 v22, 16, v90
  v_and_b32 v90, 0xffff0000, v90
  v_add_f32 v24, v24, v22
  v_fmac_f32 v25, v22, v22
  v_add_f32 v26, v26, v90
  v_fmac_f32 v27, v90, v90
  v_lshlrev_b32 v22, 16, v91
  v_and_b32 v91, 0xffff0000, v91
  v_add_f32 v24, v24, v22
  v_fmac_f32 v25, v22, v22
  v_add_f32 v26, v26, v91
  v_fmac_f32 v27, v91, v91
  s_waitcnt vmcnt(8)
  v_lshlrev_b32 v22, 16, v92
  v_and_b32 v92, 0xffff0000, v92
  v_add_f32 v24, v24, v22
  v_fmac_f32 v25, v22, v22
  v_add_f32 v26, v26, v92
  v_fmac_f32 v27, v92, v92
  v_lshlrev_b32 v22, 16, v93
  v_and_b32 v93, 0xffff0000, v93
  v_add_f32 v24, v24, v22
  v_fmac_f32 v25, v22, v22
  v_add_f32 v26, v26, v93
  v_fmac_f32 v27, v93, v93
  v_lshlrev_b32 v22, 16, v94
  v_and_b32 v94, 0xffff0000, v94
  v_add_f32 v24, v24, v22
  v_fmac_f32 v25, v22, v22
  v_add_f32 v26, v26, v94
  v_fmac_f32 v27, v94, v94
  v_lshlrev_b32 v22, 16, v95
  v_and_b32 v95, 0xffff0000, v95
  v_add_f32 v24, v24, v22
  v_fmac_f32 v25, v22, v22
  v_add_f32 v26, v26, v95
  v_fmac_f32 v27, v95, v95
  s_waitcnt vmcnt(7)
  v_lshlrev_b32 v22, 16, v96
  v_and_b32 v96, 0xffff0000, v96
  v_add_f32 v24, v24, v22
  v_fmac_f32 v25, v22, v22
  v_add_f32 v26, v26, v96
  v_fmac_f32 v27, v96, v96
  v_lshlrev_b32 v22, 16, v97
  v_and_b32 v97, 0xffff0000, v97
  v_add_f32 v24, v24, v22
  v_fmac_f32 v25, v22, v22
  v_add_f32 v26, v26, v97
  v_fmac_f32 v27, v97, v97
  v_lshlrev_b32 v22, 16, v98
  v_and_b32 v98, 0xffff0000, v98
  v_add_f32 v24, v24, v22
  v_fmac_f32 v25, v22, v22
  v_add_f32 v26, v26, v98
  v_fmac_f32 v27, v98, v98
  v_lshlrev_b32 v22, 16, v99
  v_and_b32 v99, 0xffff0000, v99
  v_add_f32 v24, v24, v22
  v_fmac_f32 v25, v22, v22
  v_add_f32 v26, v26, v99
  v_fmac_f32 v27, v99, v99
  s_waitcnt vmcnt(6)
  v_lshlrev_b32 v22, 16, v100
  v_and_b32 v100, 0xffff0000, v100
  v_add_f32 v24, v24, v22
  v_fmac_f32 v25, v22, v22
  v_add_f32 v26, v26, v100
  v_fmac_f32 v27, v100, v100
  v_lshlrev_b32 v22, 16, v101
  v_and_b32 v101, 0xffff0000, v101
  v_add_f32 v24, v24, v22
  v_fmac_f32 v25, v22, v22
  v_add_f32 v26, v26, v101
  v_fmac_f32 v27, v101, v101
  v_lshlrev_b32 v22, 16, v102
  v_and_b32 v102, 0xffff0000, v102
  v_add_f32 v24, v24, v22
  v_fmac_f32 v25, v22, v22
  v_add_f32 v26, v26, v102
  v_fmac_f32 v27, v102, v102
  v_lshlrev_b32 v22, 16, v103
  v_and_b32 v103, 0xffff0000, v103
  v_add_f32 v24, v24, v22
  v_fmac_f32 v25, v22, v22
  v_add_f32 v26, v26, v103
  v_fmac_f32 v27, v103, v103
  s_waitcnt vmcnt(5)
  v_lshlrev_b32 v22, 16, v104
  v_and_b32 v104, 0xffff0000, v104
  v_add_f32 v24, v24, v22
  v_fmac_f32 v25, v22, v22
  v_add_f32 v26, v26, v104
  v_fmac_f32 v27, v104, v104
  v_lshlrev_b32 v22, 16, v105
  v_and_b32 v105, 0xffff0000, v105
  v_add_f32 v24, v24, v22
  v_fmac_f32 v25, v22, v22
  v_add_f32 v26, v26, v105
  v_fmac_f32 v27, v105, v105
  v_lshlrev_b32 v22, 16, v106
  v_and_b32 v106, 0xffff0000, v106
  v_add_f32 v24, v24, v22
  v_fmac_f32 v25, v22, v22
  v_add_f32 v26, v26, v106
  v_fmac_f32 v27, v106, v106
  v_lshlrev_b32 v22, 16, v107
  v_and_b32 v107, 0xffff0000, v107
  v_add_f32 v24, v24, v22
  v_fmac_f32 v25, v22, v22
  v_add_f32 v26, v26, v107
  v_fmac_f32 v27, v107, v107
  s_waitcnt vmcnt(4)
  v_lshlrev_b32 v22, 16, v108
  v_and_b32 v108, 0xffff0000, v108
  v_add_f32 v24, v24, v22
  v_fmac_f32 v25, v22, v22
  v_add_f32 v26, v26, v108
  v_fmac_f32 v27, v108, v108
  v_lshlrev_b32 v22, 16, v109
  v_and_b32 v109, 0xffff0000, v109
  v_add_f32 v24, v24, v22
  v_fmac_f32 v25, v22, v22
  v_add_f32 v26, v26, v109
  v_fmac_f32 v27, v109, v109
  v_lshlrev_b32 v22, 16, v110
  v_and_b32 v110, 0xffff0000, v110
  v_add_f32 v24, v24, v22
  v_fmac_f32 v25, v22, v22
  v_add_f32 v26, v26, v110
  v_fmac_f32 v27, v110, v110
  v_lshlrev_b32 v22, 16, v111
  v_and_b32 v111, 0xffff0000, v111
  v_add_f32 v24, v24, v22
  v_fmac_f32 v25, v22, v22
  v_add_f32 v26, v26, v111
  v_fmac_f32 v27, v111, v111
  s_waitcnt vmcnt(3)
  v_lshlrev_b32 v22, 16, v112
  v_and_b32 v112, 0xffff0000, v112
  v_add_f32 v24, v24, v22
  v_fmac_f32 v25, v22, v22
  v_add_f32 v26, v26, v112
  v_fmac_f32 v27, v112, v112
  v_lshlrev_b32 v22, 16, v113
  v_and_b32 v113, 0xffff0000, v113
  v_add_f32 v24, v24, v22
  v_fmac_f32 v25, v22, v22
  v_add_f32 v26, v26, v113
  v_fmac_f32 v27, v113, v113
  v_lshlrev_b32 v22, 16, v114
  v_and_b32 v114, 0xffff0000, v114
  v_add_f32 v24, v24, v22
  v_fmac_f32 v25, v22, v22
  v_add_f32 v26, v26, v114
  v_fmac_f32 v27, v114, v114
  v_lshlrev_b32 v22, 16, v115
  v_and_b32 v115, 0xffff0000, v115
  v_add_f32 v24, v24, v22
  v_fmac_f32 v25, v22, v22
  v_add_f32 v26, v26, v115
  v_fmac_f32 v27, v115, v115
  s_waitcnt vmcnt(2)
  v_lshlrev_b32 v22, 16, v116
  v_and_b32 v116, 0xffff0000, v116
  v_add_f32 v24, v24, v22
  v_fmac_f32 v25, v22, v22
  v_add_f32 v26, v26, v116
  v_fmac_f32 v27, v116, v116
  v_lshlrev_b32 v22, 16, v117
  v_and_b32 v117, 0xffff0000, v117
  v_add_f32 v24, v24, v22
  v_fmac_f32 v25, v22, v22
  v_add_f32 v26, v26, v117
  v_fmac_f32 v27, v117, v117
  v_lshlrev_b32 v22, 16, v118
  v_and_b32 v118, 0xffff0000, v118
  v_add_f32 v24, v24, v22
  v_fmac_f32 v25, v22, v22
  v_add_f32 v26, v26, v118
  v_fmac_f32 v27, v118, v118
  v_lshlrev_b32 v22, 16, v119
  v_and_b32 v119, 0xffff0000, v119
  v_add_f32 v24, v24, v22
  v_fmac_f32 v25, v22, v22
  v_add_f32 v26, v26, v119
  v_fmac_f32 v27, v119, v119
  s_waitcnt vmcnt(1)
  v_lshlrev_b32 v22, 16, v120
  v_and_b32 v120, 0xffff0000, v120
  v_add_f32 v24, v24, v22
  v_fmac_f32 v25, v22, v22
  v_add_f32 v26, v26, v120
  v_fmac_f32 v27, v120, v120
  v_lshlrev_b32 v22, 16, v121
  v_and_b32 v121, 0xffff0000, v121
  v_add_f32 v24, v24, v22
  v_fmac_f32 v25, v22, v22
  v_add_f32 v26, v26, v121
  v_fmac_f32 v27, v121, v121
  v_lshlrev_b32 v22, 16, v122
  v_and_b32 v122, 0xffff0000, v122
  v_add_f32 v24, v24, v22
  v_fmac_f32 v25, v22, v22
  v_add_f32 v26, v26, v122
  v_fmac_f32 v27, v122, v122
  v_lshlrev_b32 v22, 16, v123
  v_and_b32 v123, 0xffff0000, v123
  v_add_f32 v24, v24, v22
  v_fmac_f32 v25, v22, v22
  v_add_f32 v26, v26, v123
  v_fmac_f32 v27, v123, v123
  s_waitcnt vmcnt(0)
  v_lshlrev_b32 v22, 16, v124
  v_and_b32 v124, 0xffff0000, v124
  v_add_f32 v24, v24, v22
  v_fmac_f32 v25, v22, v22
  v_add_f32 v26, v26, v124
  v_fmac_f32 v27, v124, v124
  v_lshlrev_b32 v22, 16, v125
  v_and_b32 v125, 0xffff0000, v125
  v_add_f32 v24, v24, v22
  v_fmac_f32 v25, v22, v22
  v_add_f32 v26, v26, v125
  v_fmac_f32 v27, v125, v125
  v_lshlrev_b32 v22, 16, v126
  v_and_b32 v126, 0xffff0000, v126
  v_add_f32 v24, v24, v22
  v_fmac_f32 v25, v22, v22
  v_add_f32 v26, v26, v126
  v_fmac_f32 v27, v126, v126
  v_lshlrev_b32 v22, 16, v127
  v_and_b32 v127, 0xffff0000, v127
  v_add_f32 v24, v24, v22
  v_fmac_f32 v25, v22, v22
  v_add_f32 v26, v26, v127
  v_fmac_f32 v27, v127, v127
  v_add_f32 v24, v24, v26
  v_add_f32 v25, v25, v27
  s_nop 0
  v_add_f32 v24, v24, v24 quad_perm:[1,0,3,2] row_mask:0xf bank_mask:0xf
  v_add_f32 v25, v25, v25 quad_perm:[1,0,3,2] row_mask:0xf bank_mask:0xf
  s_nop 0
  v_add_f32 v24, v24, v24 quad_perm:[2,3,0,1] row_mask:0xf bank_mask:0xf
  v_add_f32 v25, v25, v25 quad_perm:[2,3,0,1] row_mask:0xf bank_mask:0xf
  s_nop 0
  v_add_f32 v24, v24, v24 row_half_mirror row_mask:0xf bank_mask:0xf
  v_add_f32 v25, v25, v25 row_half_mirror row_mask:0xf bank_mask:0xf
  v_mov_b32 v26, 0.0009765625
  v_mul_f32 v24, v26, v24
  v_mul_f32 v27, v24, v24
  v_fma_f32 v25, v25, v26, -v27
  v_max_f32 v25, 0, v25
  v_add_f32 v25, 1e-05, v25
  v_rsq_f32 v25, v25
  v_lshlrev_b32 v20, 2, v20
  v_mul_f32 v24, v24, v25
  v_sub_f32 v24, 0, v24
  s_add_u32 s33, s33, 0x3018000
  s_add_u32 s34, s33, 0x2000
  s_mov_b32 exec_lo, 0x01010101
  s_mov_b32 exec_hi, 0x01010101
  buffer_store_dword v25, v20, s[4:7], s33 offen sc1
  buffer_store_dword v24, v20, s[4:7], s34 offen sc1
  s_mov_b64 exec, -1
  s_mov_b32 s12, s58
  s_mov_b32 s13, s59
  s_mov_b32 s14, 0x100
  s_mov_b32 s15, 0x00020000
  s_mov_b32 s38, 0
  s_mov_b64 exec, 1
.g2_kernel_gt5:
  buffer_load_dword v6, v4, s[12:15], 0 offen sc1
  s_add_u32 s38, s38, 1
  s_waitcnt vmcnt(0)
  v_cmp_eq_u32 vcc, 0x60, v6
  s_cbranch_vccnz .g2_kernel_gt5d
  s_sleep 8
  s_cmp_lt_u32 s38, 131072
  s_cbranch_scc1 .g2_kernel_gt5
.g2_kernel_gt5d:
  s_mov_b64 exec, -1
  v_mov_b32 v6, s70
  s_mov_b64 exec, 1
  buffer_store_dword v6, v4, s[4:7], s19 offen offset:48 sc1
  s_mov_b64 exec, -1
  v_mov_b32 v6, 155648
  s_mov_b32 s38, 0
.g2_kernel_wg6:
  ds_read_b32 v7, v6 offset:512
  s_add_u32 s38, s38, 1
  s_waitcnt lgkmcnt(0)
  v_cmp_le_u32 vcc, 27, v7
  s_cbranch_vccnz .g2_kernel_wg6d
  s_sleep 4
  s_cmp_lt_u32 s38, 524288
  s_cbranch_scc1 .g2_kernel_wg6
.g2_kernel_wg6d:
  s_and_b32 s31, s19, 0xfffff800
  s_add_u32 s31, s31, 48
  v_and_b32 v6, 15, v2
  v_lshlrev_b32 v6, 7, v6
  v_lshrrev_b32 v7, 4, v2
  v_lshl_add_u32 v6, v7, 2, v6
  v_lshlrev_b32 v7, 2, v2
  v_add_u32 v7, 157952, v7
  s_mov_b32 m0, 157952
  s_mov_b32 s38, 0
  s_bfm_b64 exec, 16, 0
.g2_kernel_pa7:
  buffer_load_dword v6, s[4:7], s31 offen sc1 lds
  s_add_u32 s38, s38, 1
  s_waitcnt vmcnt(0)
  ds_read_b32 v8, v7
  s_waitcnt lgkmcnt(0)
  v_cmp_ge_u32 vcc, s62, v8
  s_cbranch_vccz .g2_kernel_pa7d
  s_mov_b64 exec, vcc
  s_sleep 16
  s_cmp_lt_u32 s38, 131072
  s_cbranch_scc1 .g2_kernel_pa7
.g2_kernel_pa7d:
  s_mov_b64 exec, -1
  s_lshl_b32 s33, s17, 9
  s_add_u32 s33, s33, 0x3018000
  s_add_u32 s34, s33, 0x2000
  s_mov_b32 exec_hi, 0
  s_mov_b32 m0, 158464
  s_nop 0
  buffer_load_dwordx4 v3, s[4:7], s33 offen sc1 lds
  s_mov_b32 m0, 158976
  s_nop 0
  buffer_load_dwordx4 v3, s[4:7], s34 offen sc1 lds
  s_mov_b64 exec, -1
  v_mov_b32 v20, 1.0
  v_mov_b32 v21, 1.0
  v_mov_b32 v22, 0
  v_mov_b32 v23, 0
  v_lshlrev_b32 v24, 3, v2
  v_add_u32 v24, 155648, v24
  v_mov_b32 v6, 155648
  s_mov_b32 s38, 0
.g2_kernel_wg8:
  ds_read_b32 v7, v6 offset:512
  s_add_u32 s38, s38, 1
  s_waitcnt lgkmcnt(0)
  v_cmp_le_u32 vcc, 32, v7
  s_cbranch_vccnz .g2_kernel_wg8d
  s_sleep 2
  s_cmp_lt_u32 s38, 524288
  s_cbranch_scc1 .g2_kernel_wg8
.g2_kernel_wg8d:
  ds_write_b64 v24, v[20:21] offset:3840
  ds_write_b64 v24, v[22:23] offset:4352
  v_lshlrev_b32 v24, 2, v2
  v_add_u32 v24, 155648, v24
  ds_write_b32 v24, v4 offset:2304
  s_waitcnt vmcnt(0)
  v_mov_b32 v6, s71
  s_mov_b64 exec, 1
  ds_add_u32 v6, v5 offset:0
  s_mov_b64 exec, -1
  s_branch .g2_kernel_v
.g2_kernel_s2:
  s_mov_b32 s8, s42
  s_mov_b32 s9, s43
  s_mov_b32 s10, 0x600000
  s_mov_b32 s11, 0x00020000
  v_lshrrev_b32 v20, 3, v2
  v_and_b32 v21, 7, v2
  v_mul_u32_u24 v20, 6144, v20
  v_lshl_add_u32 v20, v21, 4, v20
  s_mul_i32 s30, s17, 393216
  s_lshl_b32 s31, s18, 7
  s_add_u32 s30, s30, s31
  s_add_u32 s31, s30, 4096
  s_barrier
  s_sleep 0
  buffer_load_dwordx4 v[64:67], v20, s[8:11], s30 offen
  buffer_load_dwordx4 v[68:71], v20, s[8:11], s30 offen offset:2048
  buffer_load_dwordx4 v[72:75], v20, s[8:11], s31 offen
  s_add_u32 s30, s30, 49152
  s_add_u32 s31, s31, 49152
  buffer_load_dwordx4 v[76:79], v20, s[8:11], s30 offen
  buffer_load_dwordx4 v[80:83], v20, s[8:11], s30 offen offset:2048
  buffer_load_dwordx4 v[84:87], v20, s[8:11], s31 offen
  s_add_u32 s30, s30, 49152
  s_add_u32 s31, s31, 49152
  buffer_load_dwordx4 v[88:91], v20, s[8:11], s30 offen
  buffer_load_dwordx4 v[92:95], v20, s[8:11], s30 offen offset:2048
  buffer_load_dwordx4 v[96:99], v20, s[8:11], s31 offen
  s_add_u32 s30, s30, 49152
  s_add_u32 s31, s31, 49152
  buffer_load_dwordx4 v[100:103], v20, s[8:11], s30 offen
  buffer_load_dwordx4 v[104:107], v20, s[8:11], s30 offen offset:2048
  buffer_load_dwordx4 v[108:111], v20, s[8:11], s31 offen
  s_add_u32 s30, s30, 49152
  s_add_u32 s31, s31, 49152
  buffer_load_dwordx4 v[112:115], v20, s[8:11], s30 offen
  buffer_load_dwordx4 v[116:119], v20, s[8:11], s30 offen offset:2048
  buffer_load_dwordx4 v[120:123], v20, s[8:11], s31 offen
  s_add_u32 s30, s30, 49152
  s_add_u32 s31, s31, 49152
  buffer_load_dwordx4 v[124:127], v20, s[8:11], s30 offen
  buffer_load_dwordx4 v[128:131], v20, s[8:11], s30 offen offset:2048
  buffer_load_dwordx4 v[132:135], v20, s[8:11], s31 offen
  s_add_u32 s30, s30, 49152
  s_add_u32 s31, s31, 49152
  buffer_load_dwordx4 v[136:139], v20, s[8:11], s30 offen
  buffer_load_dwordx4 v[140:143], v20, s[8:11], s30 offen offset:2048
  buffer_load_dwordx4 v[144:147], v20, s[8:11], s31 offen
  s_add_u32 s30, s30, 49152
  s_add_u32 s31, s31, 49152
  buffer_load_dwordx4 v[148:151], v20, s[8:11], s30 offen
  buffer_load_dwordx4 v[152:155], v20, s[8:11], s30 offen offset:2048
  buffer_load_dwordx4 v[156:159], v20, s[8:11], s31 offen
  s_add_u32 s30, s30, 49152
  s_add_u32 s31, s31, 49152
  v_lshlrev_b32 v21, 5, v21
  v_lshrrev_b32 v22, 5, v2
  v_lshl_add_u32 v21, v22, 4, v21
  v_bfe_u32 v22, v2, 4, 1
  v_lshl_add_u32 v21, v22, 3, v21
  s_lshl_b32 s30, s18, 4
  s_add_u32 s30, s30, s17
  s_mul_i32 s30, s30, 768
  s_add_u32 s30, s30, 0x3020000
  s_waitcnt vmcnt(23)
  v_lshlrev_b32 v160, 16, v64
  v_and_b32 v161, 0xffff0000, v64
  v_lshlrev_b32 v162, 16, v65
  v_and_b32 v163, 0xffff0000, v65
  v_lshlrev_b32 v164, 16, v66
  v_and_b32 v165, 0xffff0000, v66
  v_lshlrev_b32 v166, 16, v67
  v_and_b32 v167, 0xffff0000, v67
  s_waitcnt vmcnt(22)
  v_lshlrev_b32 v168, 16, v68
  v_and_b32 v169, 0xffff0000, v68
  v_lshlrev_b32 v170, 16, v69
  v_and_b32 v171, 0xffff0000, v69
  v_lshlrev_b32 v172, 16, v70
  v_and_b32 v173, 0xffff0000, v70
  v_lshlrev_b32 v174, 16, v71
  v_and_b32 v175, 0xffff0000, v71
  s_waitcnt vmcnt(21)
  v_lshlrev_b32 v176, 16, v72
  v_and_b32 v177, 0xffff0000, v72
  v_lshlrev_b32 v178, 16, v73
  v_and_b32 v179, 0xffff0000, v73
  v_lshlrev_b32 v180, 16, v74
  v_and_b32 v181, 0xffff0000, v74
  v_lshlrev_b32 v182, 16, v75
  v_and_b32 v183, 0xffff0000, v75
  s_waitcnt vmcnt(20)
  v_lshlrev_b32 v184, 16, v76
  v_and_b32 v185, 0xffff0000, v76
  v_lshlrev_b32 v186, 16, v77
  v_and_b32 v187, 0xffff0000, v77
  v_lshlrev_b32 v188, 16, v78
  v_and_b32 v189, 0xffff0000, v78
  v_lshlrev_b32 v190, 16, v79
  v_and_b32 v191, 0xffff0000, v79
  v_add_f32 v160, v160, v184
  v_add_f32 v161, v161, v185
  v_add_f32 v162, v162, v186
  v_add_f32 v163, v163, v187
  v_add_f32 v164, v164, v188
  v_add_f32 v165, v165, v189
  v_add_f32 v166, v166, v190
  v_add_f32 v167, v167, v191
  s_waitcnt vmcnt(19)
  v_lshlrev_b32 v184, 16, v80
  v_and_b32 v185, 0xffff0000, v80
  v_lshlrev_b32 v186, 16, v81
  v_and_b32 v187, 0xffff0000, v81
  v_lshlrev_b32 v188, 16, v82
  v_and_b32 v189, 0xffff0000, v82
  v_lshlrev_b32 v190, 16, v83
  v_and_b32 v191, 0xffff0000, v83
  v_add_f32 v168, v168, v184
  v_add_f32 v169, v169, v185
  v_add_f32 v170, v170, v186
  v_add_f32 v171, v171, v187
  v_add_f32 v172, v172, v188
  v_add_f32 v173, v173, v189
  v_add_f32 v174, v174, v190
  v_add_f32 v175, v175, v191
  s_waitcnt vmcnt(18)
  v_lshlrev_b32 v184, 16, v84
  v_and_b32 v185, 0xffff0000, v84
  v_lshlrev_b32 v186, 16, v85
  v_and_b32 v187, 0xffff0000, v85
  v_lshlrev_b32 v188, 16, v86
  v_and_b32 v189, 0xffff0000, v86
  v_lshlrev_b32 v190, 16, v87
  v_and_b32 v191, 0xffff0000, v87
  v_add_f32 v176, v176, v184
  v_add_f32 v177, v177, v185
  v_add_f32 v178, v178, v186
  v_add_f32 v179, v179, v187
  v_add_f32 v180, v180, v188
  v_add_f32 v181, v181, v189
  v_add_f32 v182, v182, v190
  v_add_f32 v183, v183, v191
  s_waitcnt vmcnt(17)
  v_lshlrev_b32 v184, 16, v88
  v_and_b32 v185, 0xffff0000, v88
  v_lshlrev_b32 v186, 16, v89
  v_and_b32 v187, 0xffff0000, v89
  v_lshlrev_b32 v188, 16, v90
  v_and_b32 v189, 0xffff0000, v90
  v_lshlrev_b32 v190, 16, v91
  v_and_b32 v191, 0xffff0000, v91
  v_add_f32 v160, v160, v184
  v_add_f32 v161, v161, v185
  v_add_f32 v162, v162, v186
  v_add_f32 v163, v163, v187
  v_add_f32 v164, v164, v188
  v_add_f32 v165, v165, v189
  v_add_f32 v166, v166, v190
  v_add_f32 v167, v167, v191
  s_waitcnt vmcnt(16)
  v_lshlrev_b32 v184, 16, v92
  v_and_b32 v185, 0xffff0000, v92
  v_lshlrev_b32 v186, 16, v93
  v_and_b32 v187, 0xffff0000, v93
  v_lshlrev_b32 v188, 16, v94
  v_and_b32 v189, 0xffff0000, v94
  v_lshlrev_b32 v190, 16, v95
  v_and_b32 v191, 0xffff0000, v95
  v_add_f32 v168, v168, v184
  v_add_f32 v169, v169, v185
  v_add_f32 v170, v170, v186
  v_add_f32 v171, v171, v187
  v_add_f32 v172, v172, v188
  v_add_f32 v173, v173, v189
  v_add_f32 v174, v174, v190
  v_add_f32 v175, v175, v191
  s_waitcnt vmcnt(15)
  v_lshlrev_b32 v184, 16, v96
  v_and_b32 v185, 0xffff0000, v96
  v_lshlrev_b32 v186, 16, v97
  v_and_b32 v187, 0xffff0000, v97
  v_lshlrev_b32 v188, 16, v98
  v_and_b32 v189, 0xffff0000, v98
  v_lshlrev_b32 v190, 16, v99
  v_and_b32 v191, 0xffff0000, v99
  v_add_f32 v176, v176, v184
  v_add_f32 v177, v177, v185
  v_add_f32 v178, v178, v186
  v_add_f32 v179, v179, v187
  v_add_f32 v180, v180, v188
  v_add_f32 v181, v181, v189
  v_add_f32 v182, v182, v190
  v_add_f32 v183, v183, v191
  s_waitcnt vmcnt(14)
  v_lshlrev_b32 v184, 16, v100
  v_and_b32 v185, 0xffff0000, v100
  v_lshlrev_b32 v186, 16, v101
  v_and_b32 v187, 0xffff0000, v101
  v_lshlrev_b32 v188, 16, v102
  v_and_b32 v189, 0xffff0000, v102
  v_lshlrev_b32 v190, 16, v103
  v_and_b32 v191, 0xffff0000, v103
  v_add_f32 v160, v160, v184
  v_add_f32 v161, v161, v185
  v_add_f32 v162, v162, v186
  v_add_f32 v163, v163, v187
  v_add_f32 v164, v164, v188
  v_add_f32 v165, v165, v189
  v_add_f32 v166, v166, v190
  v_add_f32 v167, v167, v191
  s_waitcnt vmcnt(13)
  v_lshlrev_b32 v184, 16, v104
  v_and_b32 v185, 0xffff0000, v104
  v_lshlrev_b32 v186, 16, v105
  v_and_b32 v187, 0xffff0000, v105
  v_lshlrev_b32 v188, 16, v106
  v_and_b32 v189, 0xffff0000, v106
  v_lshlrev_b32 v190, 16, v107
  v_and_b32 v191, 0xffff0000, v107
  v_add_f32 v168, v168, v184
  v_add_f32 v169, v169, v185
  v_add_f32 v170, v170, v186
  v_add_f32 v171, v171, v187
  v_add_f32 v172, v172, v188
  v_add_f32 v173, v173, v189
  v_add_f32 v174, v174, v190
  v_add_f32 v175, v175, v191
  s_waitcnt vmcnt(12)
  v_lshlrev_b32 v184, 16, v108
  v_and_b32 v185, 0xffff0000, v108
  v_lshlrev_b32 v186, 16, v109
  v_and_b32 v187, 0xffff0000, v109
  v_lshlrev_b32 v188, 16, v110
  v_and_b32 v189, 0xffff0000, v110
  v_lshlrev_b32 v190, 16, v111
  v_and_b32 v191, 0xffff0000, v111
  v_add_f32 v176, v176, v184
  v_add_f32 v177, v177, v185
  v_add_f32 v178, v178, v186
  v_add_f32 v179, v179, v187
  v_add_f32 v180, v180, v188
  v_add_f32 v181, v181, v189
  v_add_f32 v182, v182, v190
  v_add_f32 v183, v183, v191
  s_waitcnt vmcnt(11)
  v_lshlrev_b32 v184, 16, v112
  v_and_b32 v185, 0xffff0000, v112
  v_lshlrev_b32 v186, 16, v113
  v_and_b32 v187, 0xffff0000, v113
  v_lshlrev_b32 v188, 16, v114
  v_and_b32 v189, 0xffff0000, v114
  v_lshlrev_b32 v190, 16, v115
  v_and_b32 v191, 0xffff0000, v115
  v_add_f32 v160, v160, v184
  v_add_f32 v161, v161, v185
  v_add_f32 v162, v162, v186
  v_add_f32 v163, v163, v187
  v_add_f32 v164, v164, v188
  v_add_f32 v165, v165, v189
  v_add_f32 v166, v166, v190
  v_add_f32 v167, v167, v191
  s_waitcnt vmcnt(10)
  v_lshlrev_b32 v184, 16, v116
  v_and_b32 v185, 0xffff0000, v116
  v_lshlrev_b32 v186, 16, v117
  v_and_b32 v187, 0xffff0000, v117
  v_lshlrev_b32 v188, 16, v118
  v_and_b32 v189, 0xffff0000, v118
  v_lshlrev_b32 v190, 16, v119
  v_and_b32 v191, 0xffff0000, v119
  v_add_f32 v168, v168, v184
  v_add_f32 v169, v169, v185
  v_add_f32 v170, v170, v186
  v_add_f32 v171, v171, v187
  v_add_f32 v172, v172, v188
  v_add_f32 v173, v173, v189
  v_add_f32 v174, v174, v190
  v_add_f32 v175, v175, v191
  s_waitcnt vmcnt(9)
  v_lshlrev_b32 v184, 16, v120
  v_and_b32 v185, 0xffff0000, v120
  v_lshlrev_b32 v186, 16, v121
  v_and_b32 v187, 0xffff0000, v121
  v_lshlrev_b32 v188, 16, v122
  v_and_b32 v189, 0xffff0000, v122
  v_lshlrev_b32 v190, 16, v123
  v_and_b32 v191, 0xffff0000, v123
  v_add_f32 v176, v176, v184
  v_add_f32 v177, v177, v185
  v_add_f32 v178, v178, v186
  v_add_f32 v179, v179, v187
  v_add_f32 v180, v180, v188
  v_add_f32 v181, v181, v189
  v_add_f32 v182, v182, v190
  v_add_f32 v183, v183, v191
  s_waitcnt vmcnt(8)
  v_lshlrev_b32 v184, 16, v124
  v_and_b32 v185, 0xffff0000, v124
  v_lshlrev_b32 v186, 16, v125
  v_and_b32 v187, 0xffff0000, v125
  v_lshlrev_b32 v188, 16, v126
  v_and_b32 v189, 0xffff0000, v126
  v_lshlrev_b32 v190, 16, v127
  v_and_b32 v191, 0xffff0000, v127
  v_add_f32 v160, v160, v184
  v_add_f32 v161, v161, v185
  v_add_f32 v162, v162, v186
  v_add_f32 v163, v163, v187
  v_add_f32 v164, v164, v188
  v_add_f32 v165, v165, v189
  v_add_f32 v166, v166, v190
  v_add_f32 v167, v167, v191
  s_waitcnt vmcnt(7)
  v_lshlrev_b32 v184, 16, v128
  v_and_b32 v185, 0xffff0000, v128
  v_lshlrev_b32 v186, 16, v129
  v_and_b32 v187, 0xffff0000, v129
  v_lshlrev_b32 v188, 16, v130
  v_and_b32 v189, 0xffff0000, v130
  v_lshlrev_b32 v190, 16, v131
  v_and_b32 v191, 0xffff0000, v131
  v_add_f32 v168, v168, v184
  v_add_f32 v169, v169, v185
  v_add_f32 v170, v170, v186
  v_add_f32 v171, v171, v187
  v_add_f32 v172, v172, v188
  v_add_f32 v173, v173, v189
  v_add_f32 v174, v174, v190
  v_add_f32 v175, v175, v191
  s_waitcnt vmcnt(6)
  v_lshlrev_b32 v184, 16, v132
  v_and_b32 v185, 0xffff0000, v132
  v_lshlrev_b32 v186, 16, v133
  v_and_b32 v187, 0xffff0000, v133
  v_lshlrev_b32 v188, 16, v134
  v_and_b32 v189, 0xffff0000, v134
  v_lshlrev_b32 v190, 16, v135
  v_and_b32 v191, 0xffff0000, v135
  v_add_f32 v176, v176, v184
  v_add_f32 v177, v177, v185
  v_add_f32 v178, v178, v186
  v_add_f32 v179, v179, v187
  v_add_f32 v180, v180, v188
  v_add_f32 v181, v181, v189
  v_add_f32 v182, v182, v190
  v_add_f32 v183, v183, v191
  s_waitcnt vmcnt(5)
  v_lshlrev_b32 v184, 16, v136
  v_and_b32 v185, 0xffff0000, v136
  v_lshlrev_b32 v186, 16, v137
  v_and_b32 v187, 0xffff0000, v137
  v_lshlrev_b32 v188, 16, v138
  v_and_b32 v189, 0xffff0000, v138
  v_lshlrev_b32 v190, 16, v139
  v_and_b32 v191, 0xffff0000, v139
  v_add_f32 v160, v160, v184
  v_add_f32 v161, v161, v185
  v_add_f32 v162, v162, v186
  v_add_f32 v163, v163, v187
  v_add_f32 v164, v164, v188
  v_add_f32 v165, v165, v189
  v_add_f32 v166, v166, v190
  v_add_f32 v167, v167, v191
  s_waitcnt vmcnt(4)
  v_lshlrev_b32 v184, 16, v140
  v_and_b32 v185, 0xffff0000, v140
  v_lshlrev_b32 v186, 16, v141
  v_and_b32 v187, 0xffff0000, v141
  v_lshlrev_b32 v188, 16, v142
  v_and_b32 v189, 0xffff0000, v142
  v_lshlrev_b32 v190, 16, v143
  v_and_b32 v191, 0xffff0000, v143
  v_add_f32 v168, v168, v184
  v_add_f32 v169, v169, v185
  v_add_f32 v170, v170, v186
  v_add_f32 v171, v171, v187
  v_add_f32 v172, v172, v188
  v_add_f32 v173, v173, v189
  v_add_f32 v174, v174, v190
  v_add_f32 v175, v175, v191
  s_waitcnt vmcnt(3)
  v_lshlrev_b32 v184, 16, v144
  v_and_b32 v185, 0xffff0000, v144
  v_lshlrev_b32 v186, 16, v145
  v_and_b32 v187, 0xffff0000, v145
  v_lshlrev_b32 v188, 16, v146
  v_and_b32 v189, 0xffff0000, v146
  v_lshlrev_b32 v190, 16, v147
  v_and_b32 v191, 0xffff0000, v147
  v_add_f32 v176, v176, v184
  v_add_f32 v177, v177, v185
  v_add_f32 v178, v178, v186
  v_add_f32 v179, v179, v187
  v_add_f32 v180, v180, v188
  v_add_f32 v181, v181, v189
  v_add_f32 v182, v182, v190
  v_add_f32 v183, v183, v191
  s_waitcnt vmcnt(2)
  v_lshlrev_b32 v184, 16, v148
  v_and_b32 v185, 0xffff0000, v148
  v_lshlrev_b32 v186, 16, v149
  v_and_b32 v187, 0xffff0000, v149
  v_lshlrev_b32 v188, 16, v150
  v_and_b32 v189, 0xffff0000, v150
  v_lshlrev_b32 v190, 16, v151
  v_and_b32 v191, 0xffff0000, v151
  v_add_f32 v160, v160, v184
  v_add_f32 v161, v161, v185
  v_add_f32 v162, v162, v186
  v_add_f32 v163, v163, v187
  v_add_f32 v164, v164, v188
  v_add_f32 v165, v165, v189
  v_add_f32 v166, v166, v190
  v_add_f32 v167, v167, v191
  s_waitcnt vmcnt(1)
  v_lshlrev_b32 v184, 16, v152
  v_and_b32 v185, 0xffff0000, v152
  v_lshlrev_b32 v186, 16, v153
  v_and_b32 v187, 0xffff0000, v153
  v_lshlrev_b32 v188, 16, v154
  v_and_b32 v189, 0xffff0000, v154
  v_lshlrev_b32 v190, 16, v155
  v_and_b32 v191, 0xffff0000, v155
  v_add_f32 v168, v168, v184
  v_add_f32 v169, v169, v185
  v_add_f32 v170, v170, v186
  v_add_f32 v171, v171, v187
  v_add_f32 v172, v172, v188
  v_add_f32 v173, v173, v189
  v_add_f32 v174, v174, v190
  v_add_f32 v175, v175, v191
  s_waitcnt vmcnt(0)
  v_lshlrev_b32 v184, 16, v156
  v_and_b32 v185, 0xffff0000, v156
  v_lshlrev_b32 v186, 16, v157
  v_and_b32 v187, 0xffff0000, v157
  v_lshlrev_b32 v188, 16, v158
  v_and_b32 v189, 0xffff0000, v158
  v_lshlrev_b32 v190, 16, v159
  v_and_b32 v191, 0xffff0000, v159
  v_add_f32 v176, v176, v184
  v_add_f32 v177, v177, v185
  v_add_f32 v178, v178, v186
  v_add_f32 v179, v179, v187
  v_add_f32 v180, v180, v188
  v_add_f32 v181, v181, v189
  v_add_f32 v182, v182, v190
  v_add_f32 v183, v183, v191
  v_permlane32_swap_b32 v160, v164
  v_permlane32_swap_b32 v161, v165
  v_permlane32_swap_b32 v162, v166
  v_permlane32_swap_b32 v163, v167
  v_add_f32 v160, v160, v164
  v_add_f32 v161, v161, v165
  v_add_f32 v162, v162, v166
  v_add_f32 v163, v163, v167
  s_nop 0
  v_permlane16_swap_b32 v160, v162
  v_permlane16_swap_b32 v161, v163
  v_add_f32 v160, v160, v162
  v_add_f32 v161, v161, v163
  s_nop 0
  v_add_f32 v160, v160, v160 row_ror:8 row_mask:0xf bank_mask:0xf
  v_add_f32 v161, v161, v161 row_ror:8 row_mask:0xf bank_mask:0xf
  v_permlane32_swap_b32 v168, v172
  v_permlane32_swap_b32 v169, v173
  v_permlane32_swap_b32 v170, v174
  v_permlane32_swap_b32 v171, v175
  v_add_f32 v168, v168, v172
  v_add_f32 v169, v169, v173
  v_add_f32 v170, v170, v174
  v_add_f32 v171, v171, v175
  s_nop 0
  v_permlane16_swap_b32 v168, v170
  v_permlane16_swap_b32 v169, v171
  v_add_f32 v168, v168, v170
  v_add_f32 v169, v169, v171
  s_nop 0
  v_add_f32 v168, v168, v168 row_ror:8 row_mask:0xf bank_mask:0xf
  v_add_f32 v169, v169, v169 row_ror:8 row_mask:0xf bank_mask:0xf
  v_permlane32_swap_b32 v176, v180
  v_permlane32_swap_b32 v177, v181
  v_permlane32_swap_b32 v178, v182
  v_permlane32_swap_b32 v179, v183
  v_add_f32 v176, v176, v180
  v_add_f32 v177, v177, v181
  v_add_f32 v178, v178, v182
  v_add_f32 v179, v179, v183
  s_nop 0
  v_permlane16_swap_b32 v176, v178
  v_permlane16_swap_b32 v177, v179
  v_add_f32 v176, v176, v178
  v_add_f32 v177, v177, v179
  s_nop 0
  v_add_f32 v176, v176, v176 row_ror:8 row_mask:0xf bank_mask:0xf
  v_add_f32 v177, v177, v177 row_ror:8 row_mask:0xf bank_mask:0xf
  s_mov_b32 exec_lo, 0x00ff00ff
  s_mov_b32 exec_hi, 0x00ff00ff
  buffer_store_dwordx2 v[160:161], v21, s[4:7], s30 offen offset:0 sc1
  buffer_store_dwordx2 v[168:169], v21, s[4:7], s30 offen offset:256 sc1
  buffer_store_dwordx2 v[176:177], v21, s[4:7], s30 offen offset:512 sc1
  s_mov_b64 exec, -1
  s_mov_b32 s12, s58
  s_mov_b32 s13, s59
  s_mov_b32 s14, 0x100
  s_mov_b32 s15, 0x00020000
  s_mov_b32 s38, 0
  s_mov_b64 exec, 1
.g2_kernel_gt9:
  buffer_load_dword v6, v4, s[12:15], 0 offen sc1
  s_add_u32 s38, s38, 1
  s_waitcnt vmcnt(0)
  v_cmp_eq_u32 vcc, 0x60, v6
  s_cbranch_vccnz .g2_kernel_gt9d
  s_sleep 8
  s_cmp_lt_u32 s38, 131072
  s_cbranch_scc1 .g2_kernel_gt9
.g2_kernel_gt9d:
  s_mov_b64 exec, -1
  v_mov_b32 v6, s70
  s_mov_b64 exec, 1
  buffer_store_dword v6, v4, s[4:7], s76 offen offset:16 sc1
  s_mov_b64 exec, -1
  v_mov_b32 v6, 155648
  s_mov_b32 s38, 0
.g2_kernel_wg10:
  ds_read_b32 v7, v6 offset:512
  s_add_u32 s38, s38, 1
  s_waitcnt lgkmcnt(0)
  v_cmp_le_u32 vcc, 27, v7
  s_cbranch_vccnz .g2_kernel_wg10d
  s_sleep 4
  s_cmp_lt_u32 s38, 524288
  s_cbranch_scc1 .g2_kernel_wg10
.g2_kernel_wg10d:
  s_and_b32 s31, s76, 0xfffff800
  s_add_u32 s31, s31, 16
  v_and_b32 v6, 15, v2
  v_lshlrev_b32 v6, 7, v6
  v_lshrrev_b32 v7, 4, v2
  v_lshl_add_u32 v6, v7, 2, v6
  v_lshlrev_b32 v7, 2, v2
  v_add_u32 v7, 157696, v7
  s_mov_b32 m0, 157696
  s_mov_b32 s38, 0
  s_bfm_b64 exec, 16, 0
.g2_kernel_pa11:
  buffer_load_dword v6, s[4:7], s31 offen sc1 lds
  s_add_u32 s38, s38, 1
  s_waitcnt vmcnt(0)
  ds_read_b32 v8, v7
  s_waitcnt lgkmcnt(0)
  v_cmp_ge_u32 vcc, s62, v8
  s_cbranch_vccz .g2_kernel_pa11d
  s_mov_b64 exec, vcc
  s_sleep 16
  s_cmp_lt_u32 s38, 131072
  s_cbranch_scc1 .g2_kernel_pa11
.g2_kernel_pa11d:
  s_mov_b64 exec, -1
  s_mul_i32 s30, s18, 12288
  s_add_u32 s30, s30, 0x3020000
  s_mov_b32 exec_hi, 0xffff
  buffer_load_dwordx4 v[64:67], v3, s[4:7], s30 offen offset:0 sc1
  buffer_load_dwordx4 v[68:71], v3, s[4:7], s30 offen offset:768 sc1
  buffer_load_dwordx4 v[72:75], v3, s[4:7], s30 offen offset:1536 sc1
  buffer_load_dwordx4 v[76:79], v3, s[4:7], s30 offen offset:2304 sc1
  s_add_u32 s30, s30, 3072
  buffer_load_dwordx4 v[80:83], v3, s[4:7], s30 offen offset:0 sc1
  buffer_load_dwordx4 v[84:87], v3, s[4:7], s30 offen offset:768 sc1
  buffer_load_dwordx4 v[88:91], v3, s[4:7], s30 offen offset:1536 sc1
  buffer_load_dwordx4 v[92:95], v3, s[4:7], s30 offen offset:2304 sc1
  s_add_u32 s30, s30, 3072
  buffer_load_dwordx4 v[96:99], v3, s[4:7], s30 offen offset:0 sc1
  buffer_load_dwordx4 v[100:103], v3, s[4:7], s30 offen offset:768 sc1
  buffer_load_dwordx4 v[104:107], v3, s[4:7], s30 offen offset:1536 sc1
  buffer_load_dwordx4 v[108:111], v3, s[4:7], s30 offen offset:2304 sc1
  s_add_u32 s30, s30, 3072
  buffer_load_dwordx4 v[112:115], v3, s[4:7], s30 offen offset:0 sc1
  buffer_load_dwordx4 v[116:119], v3, s[4:7], s30 offen offset:768 sc1
  buffer_load_dwordx4 v[120:123], v3, s[4:7], s30 offen offset:1536 sc1
  buffer_load_dwordx4 v[124:127], v3, s[4:7], s30 offen offset:2304 sc1
  s_add_u32 s30, s30, 3072
  s_waitcnt vmcnt(14)
  v_add_f32 v64, v64, v68
  v_add_f32 v65, v65, v69
  v_add_f32 v66, v66, v70
  v_add_f32 v67, v67, v71
  s_waitcnt vmcnt(13)
  v_add_f32 v64, v64, v72
  v_add_f32 v65, v65, v73
  v_add_f32 v66, v66, v74
  v_add_f32 v67, v67, v75
  s_waitcnt vmcnt(12)
  v_add_f32 v64, v64, v76
  v_add_f32 v65, v65, v77
  v_add_f32 v66, v66, v78
  v_add_f32 v67, v67, v79
  s_waitcnt vmcnt(11)
  v_add_f32 v64, v64, v80
  v_add_f32 v65, v65, v81
  v_add_f32 v66, v66, v82
  v_add_f32 v67, v67, v83
  s_waitcnt vmcnt(10)
  v_add_f32 v64, v64, v84
  v_add_f32 v65, v65, v85
  v_add_f32 v66, v66, v86
  v_add_f32 v67, v67, v87
  s_waitcnt vmcnt(9)
  v_add_f32 v64, v64, v88
  v_add_f32 v65, v65, v89
  v_add_f32 v66, v66, v90
  v_add_f32 v67, v67, v91
  s_waitcnt vmcnt(8)
  v_add_f32 v64, v64, v92
  v_add_f32 v65, v65, v93
  v_add_f32 v66, v66, v94
  v_add_f32 v67, v67, v95
  s_waitcnt vmcnt(7)
  v_add_f32 v64, v64, v96
  v_add_f32 v65, v65, v97
  v_add_f32 v66, v66, v98
  v_add_f32 v67, v67, v99
  s_waitcnt vmcnt(6)
  v_add_f32 v64, v64, v100
  v_add_f32 v65, v65, v101
  v_add_f32 v66, v66, v102
  v_add_f32 v67, v67, v103
  s_waitcnt vmcnt(5)
  v_add_f32 v64, v64, v104
  v_add_f32 v65, v65, v105
  v_add_f32 v66, v66, v106
  v_add_f32 v67, v67, v107
  s_waitcnt vmcnt(4)
  v_add_f32 v64, v64, v108
  v_add_f32 v65, v65, v109
  v_add_f32 v66, v66, v110
  v_add_f32 v67, v67, v111
  s_waitcnt vmcnt(3)
  v_add_f32 v64, v64, v112
  v_add_f32 v65, v65, v113
  v_add_f32 v66, v66, v114
  v_add_f32 v67, v67, v115
  s_waitcnt vmcnt(2)
  v_add_f32 v64, v64, v116
  v_add_f32 v65, v65, v117
  v_add_f32 v66, v66, v118
  v_add_f32 v67, v67, v119
  s_waitcnt vmcnt(1)
  v_add_f32 v64, v64, v120
  v_add_f32 v65, v65, v121
  v_add_f32 v66, v66, v122
  v_add_f32 v67, v67, v123
  s_waitcnt vmcnt(0)
  v_add_f32 v64, v64, v124
  v_add_f32 v65, v65, v125
  v_add_f32 v66, v66, v126
  v_add_f32 v67, v67, v127
  s_mov_b64 exec, -1
  v_mov_b32 v6, 155648
  s_mov_b32 s38, 0
.g2_kernel_wg12:
  ds_read_b32 v7, v6 offset:512
  s_add_u32 s38, s38, 1
  s_waitcnt lgkmcnt(0)
  v_cmp_le_u32 vcc, 32, v7
  s_cbranch_vccnz .g2_kernel_wg12d
  s_sleep 2
  s_cmp_lt_u32 s38, 524288
  s_cbranch_scc1 .g2_kernel_wg12
.g2_kernel_wg12d:
  v_lshlrev_b32 v24, 2, v2
  v_add_u32 v24, 155648, v24
  ds_write_b32 v24, v4 offset:2048
  v_add_u32 v24, 155648, v3
  s_mov_b32 exec_hi, 0xffff
  ds_write_b128 v24, v[64:67] offset:4864
  s_mov_b64 exec, -1
  v_mov_b32 v6, s71
  s_mov_b64 exec, 1
  ds_add_u32 v6, v5 offset:0
  s_mov_b64 exec, -1
  s_branch .g2_kernel_v
.g2_kernel_s3:
  s_mov_b32 s12, s58
  s_mov_b32 s13, s59
  s_mov_b32 s14, 0x100
  s_mov_b32 s15, 0x00020000
  s_mov_b32 s20, s48
  s_mov_b32 s21, s49
  s_mov_b32 s22, 0x800
  s_mov_b32 s23, 0x00020000
  v_mov_b32 v12, 0
  v_mov_b32 v13, 0
  v_mov_b32 v14, 0
  v_mov_b32 v15, 0
  s_cmp_ge_u32 s2, 96
  s_cbranch_scc1 .g2_kernel_zm13
  s_lshl_b32 s36, s2, 10
  s_add_u32 s36, s36, 0x3000000
  buffer_store_dwordx4 v[12:15], v3, s[4:7], s36 offen sc1
.g2_kernel_zm13:
  s_barrier
  s_cbranch_scc1 .g2_kernel_zm13b
  s_mov_b64 exec, 1
  s_waitcnt vmcnt(0)
  buffer_atomic_add v5, v4, s[12:15], 0 offen sc1
  s_mov_b64 exec, -1
.g2_kernel_zm13b:
  v_lshlrev_b32 v20, 5, v2
  buffer_load_dwordx4 v[24:27], v20, s[20:23], 0 offen
  buffer_load_dwordx4 v[28:31], v20, s[20:23], 0 offen offset:16
  v_mov_b32 v20, 0
  s_waitcnt vmcnt(0)
  v_lshlrev_b32 v21, 16, v24
  v_and_b32 v22, 0xffff0000, v24
  v_add_f32 v20, v20, v21
  v_add_f32 v20, v20, v22
  v_lshlrev_b32 v21, 16, v25
  v_and_b32 v22, 0xffff0000, v25
  v_add_f32 v20, v20, v21
  v_add_f32 v20, v20, v22
  v_lshlrev_b32 v21, 16, v26
  v_and_b32 v22, 0xffff0000, v26
  v_add_f32 v20, v20, v21
  v_add_f32 v20, v20, v22
  v_lshlrev_b32 v21, 16, v27
  v_and_b32 v22, 0xffff0000, v27
  v_add_f32 v20, v20, v21
  v_add_f32 v20, v20, v22
  v_lshlrev_b32 v21, 16, v28
  v_and_b32 v22, 0xffff0000, v28
  v_add_f32 v20, v20, v21
  v_add_f32 v20, v20, v22
  v_lshlrev_b32 v21, 16, v29
  v_and_b32 v22, 0xffff0000, v29
  v_add_f32 v20, v20, v21
  v_add_f32 v20, v20, v22
  v_lshlrev_b32 v21, 16, v30
  v_and_b32 v22, 0xffff0000, v30
  v_add_f32 v20, v20, v21
  v_add_f32 v20, v20, v22
  v_lshlrev_b32 v21, 16, v31
  v_and_b32 v22, 0xffff0000, v31
  v_add_f32 v20, v20, v21
  v_add_f32 v20, v20, v22
  s_nop 1
  v_add_f32 v20, v20, v20 quad_perm:[1,0,3,2] row_mask:0xf bank_mask:0xf
  s_nop 1
  v_add_f32 v20, v20, v20 quad_perm:[2,3,0,1] row_mask:0xf bank_mask:0xf
  s_nop 1
  v_add_f32 v20, v20, v20 row_half_mirror row_mask:0xf bank_mask:0xf
  s_nop 1
  v_add_f32 v20, v20, v20 row_mirror row_mask:0xf bank_mask:0xf
  s_nop 0
  v_readlane_b32 s20, v20, 16
  v_readlane_b32 s21, v20, 32
  v_readlane_b32 s22, v20, 48
  v_add_f32 v20, s20, v20
  v_add_f32 v20, s21, v20
  v_add_f32 v20, s22, v20
  v_mul_f32 v20, 0x3a800000, v20
  v_mov_b32 v6, 155648
  s_mov_b32 s38, 0
.g2_kernel_wg14:
  ds_read_b32 v7, v6 offset:512
  s_add_u32 s38, s38, 1
  s_waitcnt lgkmcnt(0)
  v_cmp_le_u32 vcc, 32, v7
  s_cbranch_vccnz .g2_kernel_wg14d
  s_sleep 2
  s_cmp_lt_u32 s38, 524288
  s_cbranch_scc1 .g2_kernel_wg14
.g2_kernel_wg14d:
  v_mov_b32 v21, 155648
  s_mov_b64 exec, 1
  ds_write_b32 v21, v20 offset:256
  s_mov_b64 exec, -1
.g2_kernel_v:
  s_setprio 3
  s_cmp_lg_u32 s16, 4
  s_cbranch_scc1 .g2_kernel_v_1
  v_mov_b32 v6, s71
  s_mov_b32 s38, 0
.g2_kernel_wg15:
  ds_read_b32 v7, v6 offset:8
  s_add_u32 s38, s38, 1
  s_waitcnt lgkmcnt(0)
  v_cmp_le_u32 vcc, 4, v7
  s_cbranch_vccnz .g2_kernel_wg15d
  s_sleep 1
  s_cmp_lt_u32 s38, 524288
  s_cbranch_scc1 .g2_kernel_wg15
.g2_kernel_wg15d:
  s_sleep 8
  s_and_b32 s31, s76, 0xfffff800
  s_add_u32 s31, s31, 0
  v_and_b32 v6, 15, v2
  v_lshlrev_b32 v6, 7, v6
  v_lshrrev_b32 v7, 4, v2
  v_lshl_add_u32 v6, v7, 2, v6
  v_lshlrev_b32 v7, 2, v2
  v_add_u32 v7, 157440, v7
  s_mov_b32 m0, 157440
  s_mov_b32 s38, 0
.g2_kernel_pa16:
  buffer_load_dword v6, s[4:7], s31 offen sc1 lds
  s_add_u32 s38, s38, 1
  s_waitcnt vmcnt(0)
  ds_read_b32 v8, v7
  s_waitcnt lgkmcnt(0)
  v_cmp_ge_u32 vcc, s62, v8
  s_cbranch_vccz .g2_kernel_pa16d
  s_mov_b64 exec, vcc
  s_sleep 2
  s_cmp_lt_u32 s38, 131072
  s_cbranch_scc1 .g2_kernel_pa16
.g2_kernel_pa16d:
  s_mov_b64 exec, -1
  s_branch .g2_kernel_v_2
.g2_kernel_v_1:
  v_mov_b32 v6, s71
  s_mov_b32 s38, 0
.g2_kernel_wg17:
  ds_read_b32 v7, v6 offset:4
  s_add_u32 s38, s38, 1
  s_waitcnt lgkmcnt(0)
  v_cmp_le_u32 vcc, 4, v7
  s_cbranch_vccnz .g2_kernel_wg17d
  s_sleep 8
  s_cmp_lt_u32 s38, 524288
  s_cbranch_scc1 .g2_kernel_wg17
.g2_kernel_wg17d:
  s_sleep 70
.g2_kernel_v_2:
  s_mov_b32 s39, 0
  v_mov_b32 v12, 0
  v_mov_b32 v13, 0
  v_mov_b32 v14, 0
  v_mov_b32 v15, 0
  s_lshl_b32 s30, s17, 2
  s_and_b32 s31, s16, 3
  s_add_u32 s30, s30, s31
  s_lshl_b32 s30, s30, 4
  s_add_u32 s30, s30, s18
  s_lshl_b32 s30, s30, 9
  s_add_u32 s30, s30, s63
  s_add_u32 s30, s30, 0x1000000
  s_mov_b32 exec_hi, 0
  buffer_store_dwordx4 v[12:15], v3, s[4:7], s30 offen sc1
  s_mov_b64 exec, -1
  s_lshl_b32 s30, s17, 4
  s_add_u32 s30, s30, s18
  s_cmp_lt_u32 s16, 5
  s_cbranch_scc1 .g2_kernel_zs18
  s_cmp_eq_u32 s16, 5
  s_cbranch_scc1 .g2_kernel_zs18a
  s_lshl_b32 s30, s30, 1
  s_and_b32 s31, s16, 1
  s_add_u32 s30, s30, s31
  s_lshl_b32 s30, s30, 11
  s_add_u32 s30, s30, s63
  s_add_u32 s30, s30, 0x1090000
  buffer_store_dwordx4 v[12:15], v3, s[4:7], s30 offen sc1
  buffer_store_dwordx4 v[12:15], v3, s[4:7], s30 offen offset:1024 sc1
  s_branch .g2_kernel_zs18
.g2_kernel_zs18a:
  s_lshl_b32 s30, s30, 6
  s_add_u32 s30, s30, s63
  s_add_u32 s30, s30, 0x1080000
  s_mov_b64 exec, 15
  buffer_store_dwordx4 v[12:15], v3, s[4:7], s30 offen sc1
  s_mov_b64 exec, -1
  s_and_b32 s30, s18, 14
  s_lshl_b32 s30, s30, 4
  s_add_u32 s30, s30, s17
  s_lshl_b32 s30, s30, 1
  s_and_b32 s31, s18, 1
  s_add_u32 s30, s30, s31
  s_lshl_b32 s30, s30, 10
  s_add_u32 s30, s30, s63
  s_add_u32 s30, s30, 0x1190000
  s_add_u32 s31, s30, 32768
  buffer_store_dwordx4 v[12:15], v3, s[4:7], s30 offen sc1
  buffer_store_dwordx4 v[12:15], v3, s[4:7], s31 offen sc1
.g2_kernel_zs18:
  s_cmp_eq_u32 s16, 4
  s_cbranch_scc1 .g2_kernel_v_3
  s_cmp_lg_u32 s62, 0
  s_cbranch_scc1 .g2_kernel_g_e
  s_and_b32 s22, s16, 3
  s_lshl_b32 s22, s22, 14
  s_add_u32 s22, s22, 65536
  v_bfe_u32 v8, v2, 2, 2
  v_lshrrev_b32 v9, 4, v2
  v_and_b32 v10, 3, v2
  v_lshlrev_b32 v10, 3, v10
  v_add_u32 v10, s22, v10
  s_cmp_eq_u32 s16, 5
  s_cbranch_scc1 .g2_kernel_g_p
  s_cmp_ge_u32 s17, 14
  s_cbranch_scc1 .g2_kernel_g_e
  v_lshrrev_b32 v6, 1, v2
  v_mul_u32_u24 v6, 7168, v6
  v_and_b32 v7, 1, v2
  v_lshl_add_u32 v250, v7, 4, v6
  v_lshl_add_u32 v11, v9, 3, v8
  v_lshl_add_u32 v251, v11, 5, v10
  v_and_b32 v11, 1, v9
  v_lshl_add_u32 v11, v11, 3, v8
  v_lshl_add_u32 v11, v11, 10, v10
  v_lshrrev_b32 v7, 1, v9
  v_lshl_add_u32 v252, v7, 7, v11
  s_lshl_b32 s24, s17, 4
  s_add_u32 s24, s24, s18
  s_and_b32 s25, s16, 1
  s_mov_b32 s12, s50
  s_mov_b32 s13, s51
  s_mov_b32 s14, 0x700000
  s_mov_b32 s15, 0x00020000
  s_mul_i32 s20, s25, 3670016
  s_lshl_b32 s31, s24, 5
  s_add_u32 s20, s20, s31
  s_lshl_b32 s31, s18, 2
  s_mov_b32 s23, s31
  s_mov_b32 s21, 16
.g2_kernel_gl19:
  s_call_b64 s[26:27], .g2_kernel_v_may
  s_and_b32 s23, s23, 15
  s_lshl_b32 s30, s23, 10
  s_add_u32 s30, s30, 0
  s_add_u32 m0, s30, s22
  s_mul_i32 s30, s23, 229376
  s_add_u32 s30, s30, s20
  buffer_load_dwordx4 v250, s[12:15], s30 offen lds
  s_add_u32 s23, s23, 1
  s_sub_u32 s21, s21, 1
  s_sleep 2
  s_waitcnt vmcnt(4)
  s_cmp_lg_u32 s21, 0
  s_cbranch_scc1 .g2_kernel_gl19
  s_waitcnt vmcnt(0)
  ds_read_b64_tr_b16 v[64:65], v251 offset:0
  ds_read_b64_tr_b16 v[66:67], v251 offset:128
  ds_read_b64_tr_b16 v[68:69], v251 offset:1024
  ds_read_b64_tr_b16 v[70:71], v251 offset:1152
  ds_read_b64_tr_b16 v[72:73], v251 offset:2048
  ds_read_b64_tr_b16 v[74:75], v251 offset:2176
  ds_read_b64_tr_b16 v[76:77], v251 offset:3072
  ds_read_b64_tr_b16 v[78:79], v251 offset:3200
  ds_read_b64_tr_b16 v[80:81], v251 offset:4096
  ds_read_b64_tr_b16 v[82:83], v251 offset:4224
  ds_read_b64_tr_b16 v[84:85], v251 offset:5120
  ds_read_b64_tr_b16 v[86:87], v251 offset:5248
  ds_read_b64_tr_b16 v[88:89], v251 offset:6144
  ds_read_b64_tr_b16 v[90:91], v251 offset:6272
  ds_read_b64_tr_b16 v[92:93], v251 offset:7168
  ds_read_b64_tr_b16 v[94:95], v251 offset:7296
  ds_read_b64_tr_b16 v[96:97], v251 offset:8192
  ds_read_b64_tr_b16 v[98:99], v251 offset:8320
  ds_read_b64_tr_b16 v[100:101], v251 offset:9216
  ds_read_b64_tr_b16 v[102:103], v251 offset:9344
  ds_read_b64_tr_b16 v[104:105], v251 offset:10240
  ds_read_b64_tr_b16 v[106:107], v251 offset:10368
  ds_read_b64_tr_b16 v[108:109], v251 offset:11264
  ds_read_b64_tr_b16 v[110:111], v251 offset:11392
  ds_read_b64_tr_b16 v[112:113], v251 offset:12288
  ds_read_b64_tr_b16 v[114:115], v251 offset:12416
  ds_read_b64_tr_b16 v[116:117], v251 offset:13312
  ds_read_b64_tr_b16 v[118:119], v251 offset:13440
  ds_read_b64_tr_b16 v[120:121], v251 offset:14336
  ds_read_b64_tr_b16 v[122:123], v251 offset:14464
  ds_read_b64_tr_b16 v[124:125], v251 offset:15360
  ds_read_b64_tr_b16 v[126:127], v251 offset:15488
  s_waitcnt lgkmcnt(0)
  s_mov_b32 s12, s52
  s_mov_b32 s13, s53
  s_mov_b32 s14, 0x700000
  s_mov_b32 s15, 0x00020000
  s_mul_i32 s20, s25, 3670016
  s_lshl_b32 s31, s24, 5
  s_add_u32 s20, s20, s31
  s_lshl_b32 s31, s18, 2
  s_mov_b32 s23, s31
  s_mov_b32 s21, 16
.g2_kernel_gl20:
  s_call_b64 s[26:27], .g2_kernel_v_may
  s_and_b32 s23, s23, 15
  s_lshl_b32 s30, s23, 10
  s_add_u32 s30, s30, 0
  s_add_u32 m0, s30, s22
  s_mul_i32 s30, s23, 229376
  s_add_u32 s30, s30, s20
  buffer_load_dwordx4 v250, s[12:15], s30 offen lds
  s_add_u32 s23, s23, 1
  s_sub_u32 s21, s21, 1
  s_sleep 2
  s_waitcnt vmcnt(4)
  s_cmp_lg_u32 s21, 0
  s_cbranch_scc1 .g2_kernel_gl20
  s_waitcnt vmcnt(0)
  ds_read_b64_tr_b16 v[128:129], v251 offset:0
  ds_read_b64_tr_b16 v[130:131], v251 offset:128
  ds_read_b64_tr_b16 v[132:133], v251 offset:1024
  ds_read_b64_tr_b16 v[134:135], v251 offset:1152
  ds_read_b64_tr_b16 v[136:137], v251 offset:2048
  ds_read_b64_tr_b16 v[138:139], v251 offset:2176
  ds_read_b64_tr_b16 v[140:141], v251 offset:3072
  ds_read_b64_tr_b16 v[142:143], v251 offset:3200
  ds_read_b64_tr_b16 v[144:145], v251 offset:4096
  ds_read_b64_tr_b16 v[146:147], v251 offset:4224
  ds_read_b64_tr_b16 v[148:149], v251 offset:5120
  ds_read_b64_tr_b16 v[150:151], v251 offset:5248
  ds_read_b64_tr_b16 v[152:153], v251 offset:6144
  ds_read_b64_tr_b16 v[154:155], v251 offset:6272
  ds_read_b64_tr_b16 v[156:157], v251 offset:7168
  ds_read_b64_tr_b16 v[158:159], v251 offset:7296
  ds_read_b64_tr_b16 v[160:161], v251 offset:8192
  ds_read_b64_tr_b16 v[162:163], v251 offset:8320
  ds_read_b64_tr_b16 v[164:165], v251 offset:9216
  ds_read_b64_tr_b16 v[166:167], v251 offset:9344
  ds_read_b64_tr_b16 v[168:169], v251 offset:10240
  ds_read_b64_tr_b16 v[170:171], v251 offset:10368
  ds_read_b64_tr_b16 v[172:173], v251 offset:11264
  ds_read_b64_tr_b16 v[174:175], v251 offset:11392
  ds_read_b64_tr_b16 v[176:177], v251 offset:12288
  ds_read_b64_tr_b16 v[178:179], v251 offset:12416
  ds_read_b64_tr_b16 v[180:181], v251 offset:13312
  ds_read_b64_tr_b16 v[182:183], v251 offset:13440
  ds_read_b64_tr_b16 v[184:185], v251 offset:14336
  ds_read_b64_tr_b16 v[186:187], v251 offset:14464
  ds_read_b64_tr_b16 v[188:189], v251 offset:15360
  ds_read_b64_tr_b16 v[190:191], v251 offset:15488
  s_waitcnt lgkmcnt(0)
  s_mov_b32 s12, s54
  s_mov_b32 s13, s55
  s_mov_b32 s14, 0x700000
  s_mov_b32 s15, 0x00020000
  s_lshl_b32 s20, s24, 15
  s_lshl_b32 s31, s25, 10
  s_add_u32 s20, s20, s31
  s_mov_b32 s23, 0
  s_mov_b32 s21, 16
.g2_kernel_gl21:
  s_call_b64 s[26:27], .g2_kernel_v_may
  s_and_b32 s23, s23, 15
  s_lshl_b32 s30, s23, 10
  s_add_u32 s30, s30, 0
  s_add_u32 m0, s30, s22
  s_mul_i32 s30, s23, 2048
  s_add_u32 s30, s30, s20
  buffer_load_dwordx4 v3, s[12:15], s30 offen lds
  s_add_u32 s23, s23, 1
  s_sub_u32 s21, s21, 1
  s_sleep 1
  s_waitcnt vmcnt(4)
  s_cmp_lg_u32 s21, 0
  s_cbranch_scc1 .g2_kernel_gl21
  v_mov_b32 v11, v252
  s_waitcnt vmcnt(0)
  ds_read_b64_tr_b16 v[192:193], v11 offset:0
  ds_read_b64_tr_b16 v[194:195], v11 offset:4096
  ds_read_b64_tr_b16 v[196:197], v11 offset:32
  ds_read_b64_tr_b16 v[198:199], v11 offset:4128
  ds_read_b64_tr_b16 v[200:201], v11 offset:64
  ds_read_b64_tr_b16 v[202:203], v11 offset:4160
  ds_read_b64_tr_b16 v[204:205], v11 offset:96
  ds_read_b64_tr_b16 v[206:207], v11 offset:4192
  ds_read_b64_tr_b16 v[208:209], v11 offset:256
  ds_read_b64_tr_b16 v[210:211], v11 offset:4352
  ds_read_b64_tr_b16 v[212:213], v11 offset:288
  ds_read_b64_tr_b16 v[214:215], v11 offset:4384
  ds_read_b64_tr_b16 v[216:217], v11 offset:320
  ds_read_b64_tr_b16 v[218:219], v11 offset:4416
  ds_read_b64_tr_b16 v[220:221], v11 offset:352
  ds_read_b64_tr_b16 v[222:223], v11 offset:4448
  ds_read_b64_tr_b16 v[224:225], v11 offset:512
  ds_read_b64_tr_b16 v[226:227], v11 offset:4608
  ds_read_b64_tr_b16 v[228:229], v11 offset:544
  ds_read_b64_tr_b16 v[230:231], v11 offset:4640
  ds_read_b64_tr_b16 v[232:233], v11 offset:576
  ds_read_b64_tr_b16 v[234:235], v11 offset:4672
  ds_read_b64_tr_b16 v[236:237], v11 offset:608
  ds_read_b64_tr_b16 v[238:239], v11 offset:4704
  ds_read_b64_tr_b16 v[240:241], v11 offset:768
  ds_read_b64_tr_b16 v[242:243], v11 offset:4864
  ds_read_b64_tr_b16 v[244:245], v11 offset:800
  ds_read_b64_tr_b16 v[246:247], v11 offset:4896
  ds_read_b64_tr_b16 v[248:249], v11 offset:832
  ds_read_b64_tr_b16 v[250:251], v11 offset:4928
  ds_read_b64_tr_b16 v[252:253], v11 offset:864
  ds_read_b64_tr_b16 v[254:255], v11 offset:4960
  s_waitcnt lgkmcnt(0)
  s_branch .g2_kernel_g_e
.g2_kernel_g_p:
  s_mov_b32 s12, s42
  s_mov_b32 s13, s43
  s_mov_b32 s14, 0x600000
  s_mov_b32 s15, 0x00020000
  v_mul_u32_u24 v6, 6144, v9
  v_and_b32 v7, 15, v2
  v_lshl_add_u32 v250, v7, 4, v6
  v_lshl_add_u32 v11, v8, 2, v9
  v_lshl_add_u32 v251, v11, 9, v10
  s_lshl_b32 s20, s17, 3
  s_and_b32 s31, s18, 1
  s_add_u32 s20, s20, s31
  s_mul_i32 s20, s20, 49152
  s_and_b32 s31, s18, 14
  s_lshl_b32 s31, s31, 7
  s_add_u32 s20, s20, s31
  s_mov_b32 s23, 0
  s_mov_b32 s21, 8
.g2_kernel_gl22:
  s_call_b64 s[26:27], .g2_kernel_v_may
  s_and_b32 s23, s23, 7
  s_lshl_b32 s30, s23, 10
  s_add_u32 s30, s30, 0
  s_add_u32 m0, s30, s22
  s_mul_i32 s30, s23, 49152
  s_add_u32 s30, s30, s20
  s_and_b32 s31, s23, 1
  s_mul_i32 s31, s31, -24576
  s_add_u32 s30, s30, s31
  buffer_load_dwordx4 v250, s[12:15], s30 offen lds
  s_add_u32 s23, s23, 1
  s_sub_u32 s21, s21, 1
  s_sleep 2
  s_waitcnt vmcnt(4)
  s_cmp_lg_u32 s21, 0
  s_cbranch_scc1 .g2_kernel_gl22
  s_add_u32 s20, s20, 2048
  s_mov_b32 s23, 0
  s_mov_b32 s21, 8
.g2_kernel_gl23:
  s_call_b64 s[26:27], .g2_kernel_v_may
  s_and_b32 s23, s23, 7
  s_lshl_b32 s30, s23, 10
  s_add_u32 s30, s30, 8192
  s_add_u32 m0, s30, s22
  s_mul_i32 s30, s23, 49152
  s_add_u32 s30, s30, s20
  s_and_b32 s31, s23, 1
  s_mul_i32 s31, s31, -24576
  s_add_u32 s30, s30, s31
  buffer_load_dwordx4 v250, s[12:15], s30 offen lds
  s_add_u32 s23, s23, 1
  s_sub_u32 s21, s21, 1
  s_sleep 2
  s_waitcnt vmcnt(4)
  s_cmp_lg_u32 s21, 0
  s_cbranch_scc1 .g2_kernel_gl23
  s_add_u32 s20, s20, 2048
  s_waitcnt vmcnt(0)
  ds_read_b64_tr_b16 v[64:65], v251 offset:0
  ds_read_b64_tr_b16 v[66:67], v251 offset:256
  ds_read_b64_tr_b16 v[68:69], v251 offset:32
  ds_read_b64_tr_b16 v[70:71], v251 offset:288
  ds_read_b64_tr_b16 v[72:73], v251 offset:64
  ds_read_b64_tr_b16 v[74:75], v251 offset:320
  ds_read_b64_tr_b16 v[76:77], v251 offset:96
  ds_read_b64_tr_b16 v[78:79], v251 offset:352
  ds_read_b64_tr_b16 v[80:81], v251 offset:128
  ds_read_b64_tr_b16 v[82:83], v251 offset:384
  ds_read_b64_tr_b16 v[84:85], v251 offset:160
  ds_read_b64_tr_b16 v[86:87], v251 offset:416
  ds_read_b64_tr_b16 v[88:89], v251 offset:192
  ds_read_b64_tr_b16 v[90:91], v251 offset:448
  ds_read_b64_tr_b16 v[92:93], v251 offset:224
  ds_read_b64_tr_b16 v[94:95], v251 offset:480
  ds_read_b64_tr_b16 v[96:97], v251 offset:8192
  ds_read_b64_tr_b16 v[98:99], v251 offset:8448
  ds_read_b64_tr_b16 v[100:101], v251 offset:8224
  ds_read_b64_tr_b16 v[102:103], v251 offset:8480
  ds_read_b64_tr_b16 v[104:105], v251 offset:8256
  ds_read_b64_tr_b16 v[106:107], v251 offset:8512
  ds_read_b64_tr_b16 v[108:109], v251 offset:8288
  ds_read_b64_tr_b16 v[110:111], v251 offset:8544
  ds_read_b64_tr_b16 v[112:113], v251 offset:8320
  ds_read_b64_tr_b16 v[114:115], v251 offset:8576
  ds_read_b64_tr_b16 v[116:117], v251 offset:8352
  ds_read_b64_tr_b16 v[118:119], v251 offset:8608
  ds_read_b64_tr_b16 v[120:121], v251 offset:8384
  ds_read_b64_tr_b16 v[122:123], v251 offset:8640
  ds_read_b64_tr_b16 v[124:125], v251 offset:8416
  ds_read_b64_tr_b16 v[126:127], v251 offset:8672
  s_waitcnt lgkmcnt(0)
  s_mov_b32 s23, 0
  s_mov_b32 s21, 8
.g2_kernel_gl24:
  s_call_b64 s[26:27], .g2_kernel_v_may
  s_and_b32 s23, s23, 7
  s_lshl_b32 s30, s23, 10
  s_add_u32 s30, s30, 0
  s_add_u32 m0, s30, s22
  s_mul_i32 s30, s23, 49152
  s_add_u32 s30, s30, s20
  s_and_b32 s31, s23, 1
  s_mul_i32 s31, s31, -24576
  s_add_u32 s30, s30, s31
  buffer_load_dwordx4 v250, s[12:15], s30 offen lds
  s_add_u32 s23, s23, 1
  s_sub_u32 s21, s21, 1
  s_sleep 2
  s_waitcnt vmcnt(4)
  s_cmp_lg_u32 s21, 0
  s_cbranch_scc1 .g2_kernel_gl24
  s_add_u32 s20, s20, 2048
  s_waitcnt vmcnt(0)
  ds_read_b64_tr_b16 v[128:129], v251 offset:0
  ds_read_b64_tr_b16 v[130:131], v251 offset:256
  ds_read_b64_tr_b16 v[132:133], v251 offset:32
  ds_read_b64_tr_b16 v[134:135], v251 offset:288
  ds_read_b64_tr_b16 v[136:137], v251 offset:64
  ds_read_b64_tr_b16 v[138:139], v251 offset:320
  ds_read_b64_tr_b16 v[140:141], v251 offset:96
  ds_read_b64_tr_b16 v[142:143], v251 offset:352
  ds_read_b64_tr_b16 v[144:145], v251 offset:128
  ds_read_b64_tr_b16 v[146:147], v251 offset:384
  ds_read_b64_tr_b16 v[148:149], v251 offset:160
  ds_read_b64_tr_b16 v[150:151], v251 offset:416
  ds_read_b64_tr_b16 v[152:153], v251 offset:192
  ds_read_b64_tr_b16 v[154:155], v251 offset:448
  ds_read_b64_tr_b16 v[156:157], v251 offset:224
  ds_read_b64_tr_b16 v[158:159], v251 offset:480
  s_waitcnt lgkmcnt(0)
.g2_kernel_g_e:
.g2_kernel_v_3:
  s_mov_b32 s29, 0
  s_and_b32 s30, s16, 3
  s_lshl_b32 s30, s30, 14
  s_add_u32 s30, s30, 65536
  s_call_b64 s[68:69], .g2_kernel_v_wo
  s_waitcnt vmcnt(0)
  v_mov_b32 v6, s71
  s_mov_b64 exec, 1
  ds_add_u32 v6, v5 offset:52
  s_mov_b64 exec, -1
  s_cmp_lg_u32 s39, 0
  s_cbranch_scc1 .g2_kernel_v_3b
  s_call_b64 s[26:27], .g2_kernel_v_do
.g2_kernel_v_3b:
  s_cmp_lg_u32 s16, 4
  s_cbranch_scc1 .g2_kernel_v_4
  v_mov_b32 v6, s71
  s_mov_b32 s38, 0
.g2_kernel_wg25:
  ds_read_b32 v7, v6 offset:8
  s_add_u32 s38, s38, 1
  s_waitcnt lgkmcnt(0)
  v_cmp_le_u32 vcc, 8, v7
  s_cbranch_vccnz .g2_kernel_wg25d
  s_sleep 8
  s_cmp_lt_u32 s38, 524288
  s_cbranch_scc1 .g2_kernel_wg25
.g2_kernel_wg25d:
  s_mov_b32 s29, 1
  s_mov_b32 s30, 139264
  s_call_b64 s[68:69], .g2_kernel_v_wo
.g2_kernel_v_4:
  s_cmp_lg_u32 s16, 5
  s_cbranch_scc1 .g2_kernel_v_5
  s_sleep 64
  s_and_b32 s31, s19, 0xfffff800
  s_add_u32 s31, s31, 0
  v_and_b32 v6, 15, v2
  v_lshlrev_b32 v6, 7, v6
  v_lshrrev_b32 v7, 4, v2
  v_lshl_add_u32 v6, v7, 2, v6
  v_lshlrev_b32 v7, 2, v2
  v_add_u32 v7, 157696, v7
  s_mov_b32 m0, 157696
  s_mov_b32 s38, 0
.g2_kernel_pa26:
  buffer_load_dword v6, s[4:7], s31 offen sc1 lds
  s_add_u32 s38, s38, 1
  s_waitcnt vmcnt(0)
  ds_read_b32 v8, v7
  s_waitcnt lgkmcnt(0)
  v_cmp_ge_u32 vcc, s62, v8
  s_cbranch_vccz .g2_kernel_pa26d
  s_mov_b64 exec, vcc
  s_sleep 32
  s_cmp_lt_u32 s38, 131072
  s_cbranch_scc1 .g2_kernel_pa26
.g2_kernel_pa26d:
  s_mov_b64 exec, -1
.g2_kernel_v_5:
  s_waitcnt vmcnt(0)
  s_mov_b32 s29, 1
  s_call_b64 s[68:69], .g2_kernel_v_cmb
  s_cmp_eq_u32 s16, 4
  s_cbranch_scc1 .g2_kernel_v_6
  s_and_b32 s30, s16, 3
  s_lshl_b32 s30, s30, 14
  s_call_b64 s[68:69], .g2_kernel_v_wo
  s_waitcnt vmcnt(16)
  s_branch .g2_kernel_v_7
.g2_kernel_v_6:
  s_waitcnt vmcnt(0)
.g2_kernel_v_7:
  s_and_b32 s33, s16, 3
  s_lshl_b32 s33, s33, 2
  s_lshl_b32 s28, s29, 4
  s_add_u32 s33, s33, s28
  s_add_u32 s31, s19, s33
  v_mov_b32 v6, s70
  s_mov_b64 exec, 1
  buffer_store_dword v6, v4, s[4:7], s31 offen offset:0 sc1
  s_mov_b64 exec, -1
  s_waitcnt vmcnt(1)
  v_mov_b32 v6, s71
  s_mov_b64 exec, 1
  ds_add_u32 v6, v5 offset:12
  s_mov_b64 exec, -1
  s_cmp_eq_u32 s16, 5
  s_cbranch_scc1 .g2_kernel_c1
  s_cmp_lg_u32 s16, 4
  s_cbranch_scc1 .g2_kernel_c2
  s_cmp_lg_u32 s62, 0
  s_cbranch_scc1 .g2_kernel_fin1
  s_setprio 3
  s_mov_b32 s12, s42
  s_mov_b32 s13, s43
  s_mov_b32 s14, 0x600000
  s_mov_b32 s15, 0x00020000
  v_lshrrev_b32 v28, 3, v2
  v_and_b32 v29, 7, v2
  v_bfe_u32 v30, v2, 4, 1
  v_lshlrev_b32 v30, 1, v30
  v_xor_b32 v31, v29, v30
  v_lshlrev_b32 v31, 4, v31
  v_mul_u32_u24 v28, 6144, v28
  v_add_u32 v28, v28, v31
  v_xor_b32 v29, 64, v28
  v_lshlrev_b32 v9, 8, v2
  v_and_b32 v9, 0x300, v9
  v_add_u32 v9, 156416, v9
  v_add_u32 v48, 0, v28
  v_add_u32 v49, 48128, v29
  v_add_u32 v50, 96256, v28
  v_add_u32 v51, 144384, v29
  v_add_u32 v52, 2048, v28
  v_add_u32 v53, 50176, v29
  v_add_u32 v54, 98304, v28
  v_add_u32 v55, 146432, v29
  v_add_u32 v56, 4096, v28
  v_add_u32 v57, 52224, v29
  v_add_u32 v58, 100352, v28
  v_add_u32 v59, 148480, v29
  v_and_b32 v11, 15, v2
  v_xor_b32 v11, s18, v11
  v_and_b32 v12, 48, v2
  v_add_u32 v11, v11, v12
  v_lshlrev_b32 v11, 2, v11
  v_add_u32 v11, 158208, v11
  s_lshl_b32 s39, s18, 7
  s_lshl_b32 s32, s17, 18
  s_add_u32 s32, s32, 0xc00000
  s_mov_b32 s30, 0
  s_mov_b32 s29, 0
  s_mov_b32 s37, 0
  v_mov_b32 v6, s71
  s_mov_b32 s38, 0
.g2_kernel_wg27:
  ds_read_b32 v7, v6 offset:16
  s_add_u32 s38, s38, 1
  s_waitcnt lgkmcnt(0)
  v_cmp_le_u32 vcc, 4, v7
  s_cbranch_vccnz .g2_kernel_wg27d
  s_sleep 2
  s_cmp_lt_u32 s38, 524288
  s_cbranch_scc1 .g2_kernel_wg27
.g2_kernel_wg27d:
  s_xor_b32 s36, s18, 0
  s_mul_i32 s36, s36, 393216
  s_add_u32 s36, s36, s39
  s_add_u32 m0, s30, 65536
  s_nop 0
  buffer_load_dwordx4 v48, s[12:15], s36 offen offset:0 lds
  buffer_load_dwordx4 v49, s[12:15], s36 offen offset:1024 lds
  buffer_load_dwordx4 v50, s[12:15], s36 offen offset:2048 lds
  buffer_load_dwordx4 v51, s[12:15], s36 offen offset:3072 lds
  s_add_u32 m0, s30, 69632
  s_nop 0
  buffer_load_dwordx4 v52, s[12:15], s36 offen offset:0 lds
  buffer_load_dwordx4 v53, s[12:15], s36 offen offset:1024 lds
  buffer_load_dwordx4 v54, s[12:15], s36 offen offset:2048 lds
  buffer_load_dwordx4 v55, s[12:15], s36 offen offset:3072 lds
  s_add_u32 m0, s30, 73728
  s_nop 0
  buffer_load_dwordx4 v56, s[12:15], s36 offen offset:0 lds
  buffer_load_dwordx4 v57, s[12:15], s36 offen offset:1024 lds
  buffer_load_dwordx4 v58, s[12:15], s36 offen offset:2048 lds
  buffer_load_dwordx4 v59, s[12:15], s36 offen offset:3072 lds
  s_add_u32 s30, s30, 12288
  s_cmp_eq_u32 s30, 86016
  s_cselect_b32 s30, 0, s30
  s_xor_b32 s36, s18, 0
  s_mul_i32 s36, s36, 393216
  s_add_u32 s36, s36, s39
  s_add_u32 s36, s36, 196608
  s_add_u32 m0, s30, 65536
  s_nop 0
  buffer_load_dwordx4 v48, s[12:15], s36 offen offset:0 lds
  buffer_load_dwordx4 v49, s[12:15], s36 offen offset:1024 lds
  buffer_load_dwordx4 v50, s[12:15], s36 offen offset:2048 lds
  buffer_load_dwordx4 v51, s[12:15], s36 offen offset:3072 lds
  s_add_u32 m0, s30, 69632
  s_nop 0
  buffer_load_dwordx4 v52, s[12:15], s36 offen offset:0 lds
  buffer_load_dwordx4 v53, s[12:15], s36 offen offset:1024 lds
  buffer_load_dwordx4 v54, s[12:15], s36 offen offset:2048 lds
  buffer_load_dwordx4 v55, s[12:15], s36 offen offset:3072 lds
  s_add_u32 m0, s30, 73728
  s_nop 0
  buffer_load_dwordx4 v56, s[12:15], s36 offen offset:0 lds
  buffer_load_dwordx4 v57, s[12:15], s36 offen offset:1024 lds
  buffer_load_dwordx4 v58, s[12:15], s36 offen offset:2048 lds
  buffer_load_dwordx4 v59, s[12:15], s36 offen offset:3072 lds
  s_add_u32 s30, s30, 12288
  s_cmp_eq_u32 s30, 86016
  s_cselect_b32 s30, 0, s30
  s_mov_b32 m0, 156160
  s_mov_b32 s35, .g2_kernel_tab-.g2_kernel_pc+136
  buffer_load_dword off, s[64:67], s35 lds
  s_xor_b32 s36, s18, 1
  s_mul_i32 s36, s36, 393216
  s_add_u32 s36, s36, s39
  s_add_u32 m0, s30, 65536
  s_nop 0
  buffer_load_dwordx4 v48, s[12:15], s36 offen offset:0 lds
  buffer_load_dwordx4 v49, s[12:15], s36 offen offset:1024 lds
  buffer_load_dwordx4 v50, s[12:15], s36 offen offset:2048 lds
  buffer_load_dwordx4 v51, s[12:15], s36 offen offset:3072 lds
  s_add_u32 m0, s30, 69632
  s_nop 0
  buffer_load_dwordx4 v52, s[12:15], s36 offen offset:0 lds
  buffer_load_dwordx4 v53, s[12:15], s36 offen offset:1024 lds
  buffer_load_dwordx4 v54, s[12:15], s36 offen offset:2048 lds
  buffer_load_dwordx4 v55, s[12:15], s36 offen offset:3072 lds
  s_add_u32 m0, s30, 73728
  s_nop 0
  buffer_load_dwordx4 v56, s[12:15], s36 offen offset:0 lds
  buffer_load_dwordx4 v57, s[12:15], s36 offen offset:1024 lds
  buffer_load_dwordx4 v58, s[12:15], s36 offen offset:2048 lds
  buffer_load_dwordx4 v59, s[12:15], s36 offen offset:3072 lds
  s_add_u32 s30, s30, 12288
  s_cmp_eq_u32 s30, 86016
  s_cselect_b32 s30, 0, s30
  s_xor_b32 s36, s18, 1
  s_mul_i32 s36, s36, 393216
  s_add_u32 s36, s36, s39
  s_add_u32 s36, s36, 196608
  s_add_u32 m0, s30, 65536
  s_nop 0
  buffer_load_dwordx4 v48, s[12:15], s36 offen offset:0 lds
  buffer_load_dwordx4 v49, s[12:15], s36 offen offset:1024 lds
  buffer_load_dwordx4 v50, s[12:15], s36 offen offset:2048 lds
  buffer_load_dwordx4 v51, s[12:15], s36 offen offset:3072 lds
  s_add_u32 m0, s30, 69632
  s_nop 0
  buffer_load_dwordx4 v52, s[12:15], s36 offen offset:0 lds
  buffer_load_dwordx4 v53, s[12:15], s36 offen offset:1024 lds
  buffer_load_dwordx4 v54, s[12:15], s36 offen offset:2048 lds
  buffer_load_dwordx4 v55, s[12:15], s36 offen offset:3072 lds
  s_add_u32 m0, s30, 73728
  s_nop 0
  buffer_load_dwordx4 v56, s[12:15], s36 offen offset:0 lds
  buffer_load_dwordx4 v57, s[12:15], s36 offen offset:1024 lds
  buffer_load_dwordx4 v58, s[12:15], s36 offen offset:2048 lds
  buffer_load_dwordx4 v59, s[12:15], s36 offen offset:3072 lds
  s_add_u32 s30, s30, 12288
  s_cmp_eq_u32 s30, 86016
  s_cselect_b32 s30, 0, s30
  s_xor_b32 s36, s18, 2
  s_mul_i32 s36, s36, 393216
  s_add_u32 s36, s36, s39
  s_add_u32 m0, s30, 65536
  s_nop 0
  buffer_load_dwordx4 v48, s[12:15], s36 offen offset:0 lds
  buffer_load_dwordx4 v49, s[12:15], s36 offen offset:1024 lds
  buffer_load_dwordx4 v50, s[12:15], s36 offen offset:2048 lds
  buffer_load_dwordx4 v51, s[12:15], s36 offen offset:3072 lds
  s_add_u32 m0, s30, 69632
  s_nop 0
  buffer_load_dwordx4 v52, s[12:15], s36 offen offset:0 lds
  buffer_load_dwordx4 v53, s[12:15], s36 offen offset:1024 lds
  buffer_load_dwordx4 v54, s[12:15], s36 offen offset:2048 lds
  buffer_load_dwordx4 v55, s[12:15], s36 offen offset:3072 lds
  s_add_u32 m0, s30, 73728
  s_nop 0
  buffer_load_dwordx4 v56, s[12:15], s36 offen offset:0 lds
  buffer_load_dwordx4 v57, s[12:15], s36 offen offset:1024 lds
  buffer_load_dwordx4 v58, s[12:15], s36 offen offset:2048 lds
  buffer_load_dwordx4 v59, s[12:15], s36 offen offset:3072 lds
  s_add_u32 s30, s30, 12288
  s_cmp_eq_u32 s30, 86016
  s_cselect_b32 s30, 0, s30
  v_mov_b32 v6, s71
  s_mov_b32 s38, 0
.g2_kernel_wg28:
  ds_read_b32 v7, v6 offset:20
  s_add_u32 s38, s38, 1
  s_waitcnt lgkmcnt(0)
  v_cmp_le_u32 vcc, 4, v7
  s_cbranch_vccnz .g2_kernel_wg28d
  s_sleep 1
  s_cmp_lt_u32 s38, 524288
  s_cbranch_scc1 .g2_kernel_wg28
.g2_kernel_wg28d:
  s_mov_b32 s62, 1
  s_mov_b32 s63, 0x1800000
  s_mov_b32 s70, 2
  s_mov_b32 s71, 155776
  s_xor_b32 s36, s18, 2
  s_mul_i32 s36, s36, 393216
  s_add_u32 s36, s36, s39
  s_add_u32 s36, s36, 196608
  s_add_u32 m0, s30, 65536
  s_nop 0
  buffer_load_dwordx4 v48, s[12:15], s36 offen offset:0 lds
  buffer_load_dwordx4 v49, s[12:15], s36 offen offset:1024 lds
  buffer_load_dwordx4 v50, s[12:15], s36 offen offset:2048 lds
  buffer_load_dwordx4 v51, s[12:15], s36 offen offset:3072 lds
  s_add_u32 m0, s30, 69632
  s_nop 0
  buffer_load_dwordx4 v52, s[12:15], s36 offen offset:0 lds
  buffer_load_dwordx4 v53, s[12:15], s36 offen offset:1024 lds
  buffer_load_dwordx4 v54, s[12:15], s36 offen offset:2048 lds
  buffer_load_dwordx4 v55, s[12:15], s36 offen offset:3072 lds
  s_add_u32 m0, s30, 73728
  s_nop 0
  buffer_load_dwordx4 v56, s[12:15], s36 offen offset:0 lds
  buffer_load_dwordx4 v57, s[12:15], s36 offen offset:1024 lds
  buffer_load_dwordx4 v58, s[12:15], s36 offen offset:2048 lds
  buffer_load_dwordx4 v59, s[12:15], s36 offen offset:3072 lds
  s_add_u32 s30, s30, 12288
  s_cmp_eq_u32 s30, 86016
  s_cselect_b32 s30, 0, s30
  s_xor_b32 s36, s18, 3
  s_mul_i32 s36, s36, 393216
  s_add_u32 s36, s36, s39
  s_add_u32 m0, s30, 65536
  s_nop 0
  buffer_load_dwordx4 v48, s[12:15], s36 offen offset:0 lds
  buffer_load_dwordx4 v49, s[12:15], s36 offen offset:1024 lds
  buffer_load_dwordx4 v50, s[12:15], s36 offen offset:2048 lds
  buffer_load_dwordx4 v51, s[12:15], s36 offen offset:3072 lds
  s_add_u32 m0, s30, 69632
  s_nop 0
  buffer_load_dwordx4 v52, s[12:15], s36 offen offset:0 lds
  buffer_load_dwordx4 v53, s[12:15], s36 offen offset:1024 lds
  buffer_load_dwordx4 v54, s[12:15], s36 offen offset:2048 lds
  buffer_load_dwordx4 v55, s[12:15], s36 offen offset:3072 lds
  s_add_u32 m0, s30, 73728
  s_nop 0
  buffer_load_dwordx4 v56, s[12:15], s36 offen offset:0 lds
  buffer_load_dwordx4 v57, s[12:15], s36 offen offset:1024 lds
  buffer_load_dwordx4 v58, s[12:15], s36 offen offset:2048 lds
  buffer_load_dwordx4 v59, s[12:15], s36 offen offset:3072 lds
  s_add_u32 s30, s30, 12288
  s_cmp_eq_u32 s30, 86016
  s_cselect_b32 s30, 0, s30
  s_mov_b32 s28, 1
  s_mov_b32 s29, 16384
  s_bitcmp1_b32 s37, s28
  s_cbranch_scc0 .g2_kernel_p2_x0w
.g2_kernel_p2_x0b:
  s_xor_b32 s33, s28, s18
  s_lshl_b32 s33, s33, 14
  s_add_u32 s33, s33, s32
  s_add_u32 m0, s29, 0
  s_nop 0
  buffer_load_dwordx4 v3, s[4:7], s33 offen offset:0 lds
  buffer_load_dwordx4 v3, s[4:7], s33 offen offset:1024 lds
  buffer_load_dwordx4 v3, s[4:7], s33 offen offset:2048 lds
  buffer_load_dwordx4 v3, s[4:7], s33 offen offset:3072 lds
  s_add_u32 m0, s29, 4096
  s_add_u32 s33, s33, 4096
  buffer_load_dwordx4 v3, s[4:7], s33 offen offset:0 lds
  buffer_load_dwordx4 v3, s[4:7], s33 offen offset:1024 lds
  buffer_load_dwordx4 v3, s[4:7], s33 offen offset:2048 lds
  buffer_load_dwordx4 v3, s[4:7], s33 offen offset:3072 lds
  s_add_u32 m0, s29, 8192
  s_add_u32 s33, s33, 4096
  buffer_load_dwordx4 v3, s[4:7], s33 offen offset:0 lds
  buffer_load_dwordx4 v3, s[4:7], s33 offen offset:1024 lds
  buffer_load_dwordx4 v3, s[4:7], s33 offen offset:2048 lds
  buffer_load_dwordx4 v3, s[4:7], s33 offen offset:3072 lds
  s_add_u32 m0, s29, 12288
  s_add_u32 s33, s33, 4096
  buffer_load_dwordx4 v3, s[4:7], s33 offen offset:0 lds
  buffer_load_dwordx4 v3, s[4:7], s33 offen offset:1024 lds
  buffer_load_dwordx4 v3, s[4:7], s33 offen offset:2048 lds
  buffer_load_dwordx4 v3, s[4:7], s33 offen offset:3072 lds
  s_mov_b32 m0, 156160
  s_mov_b32 s35, .g2_kernel_tab-.g2_kernel_pc+144
  buffer_load_dword off, s[64:67], s35 lds
  s_mov_b32 s28, 2
  s_mov_b32 s29, 32768
  s_bitcmp1_b32 s37, s28
  s_cbranch_scc0 .g2_kernel_p2_x1w
.g2_kernel_p2_x1b:
  s_xor_b32 s33, s28, s18
  s_lshl_b32 s33, s33, 14
  s_add_u32 s33, s33, s32
  s_add_u32 m0, s29, 0
  s_nop 0
  buffer_load_dwordx4 v3, s[4:7], s33 offen offset:0 lds
  buffer_load_dwordx4 v3, s[4:7], s33 offen offset:1024 lds
  buffer_load_dwordx4 v3, s[4:7], s33 offen offset:2048 lds
  buffer_load_dwordx4 v3, s[4:7], s33 offen offset:3072 lds
  s_add_u32 m0, s29, 4096
  s_add_u32 s33, s33, 4096
  buffer_load_dwordx4 v3, s[4:7], s33 offen offset:0 lds
  buffer_load_dwordx4 v3, s[4:7], s33 offen offset:1024 lds
  buffer_load_dwordx4 v3, s[4:7], s33 offen offset:2048 lds
  buffer_load_dwordx4 v3, s[4:7], s33 offen offset:3072 lds
  s_add_u32 m0, s29, 8192
  s_add_u32 s33, s33, 4096
  buffer_load_dwordx4 v3, s[4:7], s33 offen offset:0 lds
  buffer_load_dwordx4 v3, s[4:7], s33 offen offset:1024 lds
  buffer_load_dwordx4 v3, s[4:7], s33 offen offset:2048 lds
  buffer_load_dwordx4 v3, s[4:7], s33 offen offset:3072 lds
  s_add_u32 m0, s29, 12288
  s_add_u32 s33, s33, 4096
  buffer_load_dwordx4 v3, s[4:7], s33 offen offset:0 lds
  buffer_load_dwordx4 v3, s[4:7], s33 offen offset:1024 lds
  buffer_load_dwordx4 v3, s[4:7], s33 offen offset:2048 lds
  buffer_load_dwordx4 v3, s[4:7], s33 offen offset:3072 lds
  s_mov_b32 m0, 156160
  s_mov_b32 s35, .g2_kernel_tab-.g2_kernel_pc+152
  buffer_load_dword off, s[64:67], s35 lds
  s_mov_b32 s28, 3
  s_mov_b32 s29, 49152
  s_bitcmp1_b32 s37, s28
  s_cbranch_scc0 .g2_kernel_p2_x2w
.g2_kernel_p2_x2b:
  s_xor_b32 s33, s28, s18
  s_lshl_b32 s33, s33, 14
  s_add_u32 s33, s33, s32
  s_add_u32 m0, s29, 0
  s_nop 0
  buffer_load_dwordx4 v3, s[4:7], s33 offen offset:0 lds
  buffer_load_dwordx4 v3, s[4:7], s33 offen offset:1024 lds
  buffer_load_dwordx4 v3, s[4:7], s33 offen offset:2048 lds
  buffer_load_dwordx4 v3, s[4:7], s33 offen offset:3072 lds
  s_add_u32 m0, s29, 4096
  s_add_u32 s33, s33, 4096
  buffer_load_dwordx4 v3, s[4:7], s33 offen offset:0 lds
  buffer_load_dwordx4 v3, s[4:7], s33 offen offset:1024 lds
  buffer_load_dwordx4 v3, s[4:7], s33 offen offset:2048 lds
  buffer_load_dwordx4 v3, s[4:7], s33 offen offset:3072 lds
  s_add_u32 m0, s29, 8192
  s_add_u32 s33, s33, 4096
  buffer_load_dwordx4 v3, s[4:7], s33 offen offset:0 lds
  buffer_load_dwordx4 v3, s[4:7], s33 offen offset:1024 lds
  buffer_load_dwordx4 v3, s[4:7], s33 offen offset:2048 lds
  buffer_load_dwordx4 v3, s[4:7], s33 offen offset:3072 lds
  s_add_u32 m0, s29, 12288
  s_add_u32 s33, s33, 4096
  buffer_load_dwordx4 v3, s[4:7], s33 offen offset:0 lds
  buffer_load_dwordx4 v3, s[4:7], s33 offen offset:1024 lds
  buffer_load_dwordx4 v3, s[4:7], s33 offen offset:2048 lds
  buffer_load_dwordx4 v3, s[4:7], s33 offen offset:3072 lds
  s_mov_b32 m0, 156160
  s_mov_b32 s35, .g2_kernel_tab-.g2_kernel_pc+156
  buffer_load_dword off, s[64:67], s35 lds
  s_xor_b32 s36, s18, 3
  s_mul_i32 s36, s36, 393216
  s_add_u32 s36, s36, s39
  s_add_u32 s36, s36, 196608
  ds_read_b32 v10, v9
  s_mov_b32 s34, 33
  s_mov_b32 s35, .g2_kernel_tab-.g2_kernel_pc+160
  s_branch .g2_kernel_p2_o
  .p2align 6
.g2_kernel_p2_l:
  s_waitcnt lgkmcnt(0)
  v_cmp_gt_i32 vcc, s34, v10
  s_cbranch_vccnz .g2_kernel_p2_aw
.g2_kernel_p2_ai:
  s_add_u32 s29, s29, 16384
  s_and_b32 s29, s29, 0xffff
  s_bitcmp1_b32 s37, s28
  s_cbranch_scc0 .g2_kernel_p2_x3w
.g2_kernel_p2_x3b:
  s_xor_b32 s33, s28, s18
  s_lshl_b32 s33, s33, 14
  s_add_u32 s33, s33, s32
  s_add_u32 m0, s29, 0
  s_nop 0
  buffer_load_dwordx4 v3, s[4:7], s33 offen offset:0 lds
  buffer_load_dwordx4 v3, s[4:7], s33 offen offset:1024 lds
  buffer_load_dwordx4 v3, s[4:7], s33 offen offset:2048 lds
  buffer_load_dwordx4 v3, s[4:7], s33 offen offset:3072 lds
  s_add_u32 m0, s29, 4096
  s_add_u32 s33, s33, 4096
  buffer_load_dwordx4 v3, s[4:7], s33 offen offset:0 lds
  buffer_load_dwordx4 v3, s[4:7], s33 offen offset:1024 lds
  buffer_load_dwordx4 v3, s[4:7], s33 offen offset:2048 lds
  buffer_load_dwordx4 v3, s[4:7], s33 offen offset:3072 lds
  s_add_u32 m0, s29, 8192
  s_add_u32 s33, s33, 4096
  buffer_load_dwordx4 v3, s[4:7], s33 offen offset:0 lds
  buffer_load_dwordx4 v3, s[4:7], s33 offen offset:1024 lds
  buffer_load_dwordx4 v3, s[4:7], s33 offen offset:2048 lds
  buffer_load_dwordx4 v3, s[4:7], s33 offen offset:3072 lds
  s_add_u32 m0, s29, 12288
  s_add_u32 s33, s33, 4096
  buffer_load_dwordx4 v3, s[4:7], s33 offen offset:0 lds
  buffer_load_dwordx4 v3, s[4:7], s33 offen offset:1024 lds
  buffer_load_dwordx4 v3, s[4:7], s33 offen offset:2048 lds
  buffer_load_dwordx4 v3, s[4:7], s33 offen offset:3072 lds
  s_add_u32 m0, s30, 65536
  s_nop 0
  buffer_load_dwordx4 v48, s[12:15], s36 offen offset:0 lds
  buffer_load_dwordx4 v49, s[12:15], s36 offen offset:1024 lds
  buffer_load_dwordx4 v50, s[12:15], s36 offen offset:2048 lds
  buffer_load_dwordx4 v51, s[12:15], s36 offen offset:3072 lds
  s_add_u32 m0, s30, 69632
  s_nop 0
  buffer_load_dwordx4 v52, s[12:15], s36 offen offset:0 lds
  buffer_load_dwordx4 v53, s[12:15], s36 offen offset:1024 lds
  buffer_load_dwordx4 v54, s[12:15], s36 offen offset:2048 lds
  buffer_load_dwordx4 v55, s[12:15], s36 offen offset:3072 lds
  s_add_u32 m0, s30, 73728
  s_nop 0
  buffer_load_dwordx4 v56, s[12:15], s36 offen offset:0 lds
  buffer_load_dwordx4 v57, s[12:15], s36 offen offset:1024 lds
  buffer_load_dwordx4 v58, s[12:15], s36 offen offset:2048 lds
  buffer_load_dwordx4 v59, s[12:15], s36 offen offset:3072 lds
  s_add_u32 s30, s30, 12288
  s_cmp_eq_u32 s30, 86016
  s_cselect_b32 s30, 0, s30
  ds_read_b32 v10, v9
  s_mov_b32 m0, 156160
  s_add_u32 s34, s34, 1
  buffer_load_dword off, s[64:67], s35 lds
  s_add_u32 s35, s35, 4
  s_add_u32 s36, s36, 196608
.g2_kernel_p2_o:
  s_waitcnt lgkmcnt(0)
  v_cmp_gt_i32 vcc, s34, v10
  s_cbranch_vccnz .g2_kernel_p2_bw
.g2_kernel_p2_bi:
  s_add_u32 m0, s30, 65536
  s_nop 0
  buffer_load_dwordx4 v48, s[12:15], s36 offen offset:0 lds
  buffer_load_dwordx4 v49, s[12:15], s36 offen offset:1024 lds
  buffer_load_dwordx4 v50, s[12:15], s36 offen offset:2048 lds
  buffer_load_dwordx4 v51, s[12:15], s36 offen offset:3072 lds
  s_add_u32 m0, s30, 69632
  s_nop 0
  buffer_load_dwordx4 v52, s[12:15], s36 offen offset:0 lds
  buffer_load_dwordx4 v53, s[12:15], s36 offen offset:1024 lds
  buffer_load_dwordx4 v54, s[12:15], s36 offen offset:2048 lds
  buffer_load_dwordx4 v55, s[12:15], s36 offen offset:3072 lds
  s_add_u32 m0, s30, 73728
  s_nop 0
  buffer_load_dwordx4 v56, s[12:15], s36 offen offset:0 lds
  buffer_load_dwordx4 v57, s[12:15], s36 offen offset:1024 lds
  buffer_load_dwordx4 v58, s[12:15], s36 offen offset:2048 lds
  buffer_load_dwordx4 v59, s[12:15], s36 offen offset:3072 lds
  s_add_u32 s30, s30, 12288
  s_cmp_eq_u32 s30, 86016
  s_cselect_b32 s30, 0, s30
  ds_read_b32 v10, v9
  s_mov_b32 m0, 156160
  s_add_u32 s34, s34, 1
  buffer_load_dword off, s[64:67], s35 lds
  s_add_u32 s35, s35, 4
  s_add_u32 s28, s28, 1
  s_xor_b32 s36, s18, s28
  s_mul_i32 s36, s36, 393216
  s_add_u32 s36, s36, s39
  s_cmp_lt_i32 s34, 58
  s_cbranch_scc1 .g2_kernel_p2_l
  s_branch .g2_kernel_v
.g2_kernel_c1:
  s_and_b32 s31, s19, 0xfffff800
  s_add_u32 s31, s31, 16
  v_and_b32 v6, 15, v2
  v_lshlrev_b32 v6, 7, v6
  v_lshrrev_b32 v7, 4, v2
  v_lshl_add_u32 v6, v7, 2, v6
  v_lshlrev_b32 v7, 2, v2
  v_add_u32 v7, 157952, v7
  s_mov_b32 m0, 157952
  s_mov_b32 s38, 0
.g2_kernel_pa29:
  buffer_load_dword v6, s[4:7], s31 offen sc1 lds
  s_add_u32 s38, s38, 1
  s_waitcnt vmcnt(0)
  ds_read_b32 v8, v7
  s_waitcnt lgkmcnt(0)
  v_cmp_ge_u32 vcc, s62, v8
  s_cbranch_vccz .g2_kernel_pa29d
  s_mov_b64 exec, vcc
  s_sleep 2
  s_cmp_lt_u32 s38, 131072
  s_cbranch_scc1 .g2_kernel_pa29
.g2_kernel_pa29d:
  s_mov_b64 exec, -1
  s_setprio 2
  s_lshl_b32 s30, s17, 4
  s_add_u32 s30, s30, s18
  s_lshl_b32 s20, s30, 11
  s_add_u32 s20, s20, s63
  s_add_u32 s20, s20, 0x1000000
  s_lshl_b32 s21, s30, 6
  s_add_u32 s21, s21, s63
  s_add_u32 s21, s21, 0x1080000
  s_lshl_b32 s23, s62, 14
  s_add_u32 s23, s23, 0x3010000
  s_lshl_b32 s22, s30, 3
  s_add_u32 s22, s22, s23
  s_and_b32 s28, s2, 7
  s_lshl_b32 s28, s28, 11
  s_add_u32 s23, s23, s28
  v_mov_b32 v9, 155648
  ds_read_b32 v26, v9 offset:256
  v_lshrrev_b32 v24, 4, v2
  v_lshlrev_b32 v25, 3, v24
  v_lshlrev_b32 v27, 11, v2
  v_mov_b32 v28, 0.0009765625
  v_mov_b32 v30, 1e-05
  v_mov_b32 v6, s71
  s_mov_b32 s38, 0
.g2_kernel_wg31:
  ds_read_b32 v7, v6 offset:20
  s_add_u32 s38, s38, 1
  s_waitcnt lgkmcnt(0)
  v_cmp_le_u32 vcc, 4, v7
  s_cbranch_vccnz .g2_kernel_wg31d
  s_sleep 1
  s_cmp_lt_u32 s38, 524288
  s_cbranch_scc1 .g2_kernel_wg31
.g2_kernel_wg31d:
  s_sleep 12
  s_mov_b32 s38, 0
.g2_kernel_gx32:
  buffer_load_dwordx4 v[16:19], v3, s[4:7], s20 offen offset:0 sc1
  buffer_load_dwordx4 v[20:23], v3, s[4:7], s20 offen offset:1024 sc1
  s_add_u32 s38, s38, 1
  s_waitcnt vmcnt(0)
  v_min3_u32 v6, v16, v19, v20
  v_min_u32 v6, v6, v23
  v_cmp_eq_u32 vcc, 0, v6
  s_cbranch_vccz .g2_kernel_gx32d
  s_mov_b64 exec, vcc
  s_sleep 1
  s_cmp_lt_u32 s38, 131072
  s_cbranch_scc1 .g2_kernel_gx32
.g2_kernel_gx32d:
  s_mov_b64 exec, -1
  v_add_f32 v16, v16, v16 row_ror:8 row_mask:0xf bank_mask:0xf
  v_add_f32 v17, v17, v17 row_ror:8 row_mask:0xf bank_mask:0xf
  v_add_f32 v18, v18, v18 row_ror:8 row_mask:0xf bank_mask:0xf
  v_add_f32 v20, v20, v20 row_ror:8 row_mask:0xf bank_mask:0xf
  v_add_f32 v21, v21, v21 row_ror:8 row_mask:0xf bank_mask:0xf
  v_add_f32 v22, v22, v22 row_ror:8 row_mask:0xf bank_mask:0xf
  v_add_f32 v16, v16, v16 row_ror:4 row_mask:0xf bank_mask:0xf
  v_add_f32 v17, v17, v17 row_ror:4 row_mask:0xf bank_mask:0xf
  v_add_f32 v18, v18, v18 row_ror:4 row_mask:0xf bank_mask:0xf
  v_add_f32 v20, v20, v20 row_ror:4 row_mask:0xf bank_mask:0xf
  v_add_f32 v21, v21, v21 row_ror:4 row_mask:0xf bank_mask:0xf
  v_add_f32 v22, v22, v22 row_ror:4 row_mask:0xf bank_mask:0xf
  v_add_f32 v16, v16, v16 row_ror:2 row_mask:0xf bank_mask:0xf
  v_add_f32 v17, v17, v17 row_ror:2 row_mask:0xf bank_mask:0xf
  v_add_f32 v18, v18, v18 row_ror:2 row_mask:0xf bank_mask:0xf
  v_add_f32 v20, v20, v20 row_ror:2 row_mask:0xf bank_mask:0xf
  v_add_f32 v21, v21, v21 row_ror:2 row_mask:0xf bank_mask:0xf
  v_add_f32 v22, v22, v22 row_ror:2 row_mask:0xf bank_mask:0xf
  v_add_f32 v16, v16, v16 row_ror:1 row_mask:0xf bank_mask:0xf
  v_add_f32 v17, v17, v17 row_ror:1 row_mask:0xf bank_mask:0xf
  v_add_f32 v18, v18, v18 row_ror:1 row_mask:0xf bank_mask:0xf
  v_add_f32 v20, v20, v20 row_ror:1 row_mask:0xf bank_mask:0xf
  v_add_f32 v21, v21, v21 row_ror:1 row_mask:0xf bank_mask:0xf
  v_add_f32 v22, v22, v22 row_ror:1 row_mask:0xf bank_mask:0xf
  v_fma_f32 v18, -v16, v26, v18
  v_mul_f32 v16, v28, v16
  v_mul_f32 v19, v16, v16
  v_fma_f32 v17, v17, v28, -v19
  v_max_f32 v17, 0, v17
  v_add_f32 v17, v30, v17
  v_rsq_f32 v19, v17
  v_fma_f32 v22, -v20, v26, v22
  v_mul_f32 v20, v28, v20
  v_mul_f32 v23, v20, v20
  v_fma_f32 v21, v21, v28, -v23
  v_max_f32 v21, 0, v21
  v_add_f32 v21, v30, v21
  v_rsq_f32 v23, v21
  v_mul_f32 v18, v18, v19
  v_mul_f32 v22, v22, v23
  v_and_or_b32 v18, v18, -8, v24
  v_or_b32 v29, 4, v24
  v_and_or_b32 v22, v22, -8, v29
  v_max_f32 v10, v18, v22
  v_mov_b32 v11, 1
  s_nop 0
  v_max_f32 v10, v10, v10 row_bcast:15 row_mask:0xa bank_mask:0xf
  s_nop 1
  v_max_f32 v10, v10, v10 row_bcast:31 row_mask:0xc bank_mask:0xf
  s_nop 0
  v_readlane_b32 s28, v10, 63
  s_nop 1
  v_mov_b32 v10, s28
  s_mov_b64 exec, 0xff
  buffer_store_dwordx2 v[10:11], v27, s[4:7], s22 offen sc1
  s_mov_b32 exec_lo, 0x00010001
  s_mov_b32 exec_hi, 0x00010001
  buffer_store_dwordx2 v[16:17], v25, s[4:7], s21 offen sc1
  buffer_store_dwordx2 v[20:21], v25, s[4:7], s21 offen offset:32 sc1
  s_mov_b64 exec, -1
  s_sleep 8
  s_mov_b32 s38, 0
.g2_kernel_gx33:
  buffer_load_dwordx4 v[16:19], v3, s[4:7], s23 offen offset:0 sc1
  buffer_load_dwordx4 v[20:23], v3, s[4:7], s23 offen offset:1024 sc1
  s_add_u32 s38, s38, 1
  s_waitcnt vmcnt(0)
  v_min3_u32 v6, v17, v19, v21
  v_min_u32 v6, v6, v23
  v_cmp_eq_u32 vcc, 0, v6
  s_cbranch_vccz .g2_kernel_gx33d
  s_mov_b64 exec, vcc
  s_sleep 1
  s_cmp_lt_u32 s38, 131072
  s_cbranch_scc1 .g2_kernel_gx33
.g2_kernel_gx33d:
  s_mov_b64 exec, -1
  s_mov_b32 s28, 0xffffffe7
  v_and_or_b32 v16, v16, s28, 0
  v_and_or_b32 v18, v18, s28, 8
  v_and_or_b32 v20, v20, s28, 16
  v_and_or_b32 v22, v22, s28, 24
  v_max3_f32 v10, v16, v18, v20
  v_max_f32 v10, v10, v22
  s_nop 1
  v_max_f32 v11, v10, v10 row_ror:8 row_mask:0xf bank_mask:0xf
  s_nop 1
  v_max_f32 v11, v11, v11 row_ror:4 row_mask:0xf bank_mask:0xf
  s_nop 1
  v_max_f32 v11, v11, v11 row_ror:2 row_mask:0xf bank_mask:0xf
  s_nop 1
  v_max_f32 v11, v11, v11 row_ror:1 row_mask:0xf bank_mask:0xf
  s_nop 1
  v_max_f32 v11, v11, v11 row_bcast:15 row_mask:0xa bank_mask:0xf
  s_nop 1
  v_max_f32 v11, v11, v11 row_bcast:31 row_mask:0xc bank_mask:0xf
  s_nop 0
  v_readlane_b32 s27, v11, 63
  s_nop 1
  v_cmp_eq_u32 vcc, s27, v10
  s_ff1_i32_b64 s77, vcc
  s_lshl_b32 s77, s77, 4
  s_and_b32 s28, s27, 15
  s_add_u32 s77, s77, s28
  s_and_b32 s28, s27, 16
  s_lshl_b32 s28, s28, 6
  s_add_u32 s77, s77, s28
  s_and_b32 s77, s77, 2047
  s_add_u32 s28, s77, 1
  v_mov_b32 v10, s28
  v_mov_b32 v9, s71
  ds_write_b32 v9, v10 offset:36
  s_lshr_b32 s24, s77, 7
  s_lshl_b32 s24, s24, 18
  s_bfe_u32 s28, s77, 0x30004
  s_lshl_b32 s28, s28, 11
  s_add_u32 s24, s24, s28
  s_and_b32 s28, s77, 15
  s_lshl_b32 s28, s28, 4
  s_add_u32 s24, s24, s28
  s_add_u32 s24, s24, s63
  s_add_u32 s24, s24, 0xc00000
  s_lshl_b32 s28, s17, 14
  s_add_u32 s24, s24, s28
  s_and_b32 s28, s18, 1
  s_lshl_b32 s28, s28, 8
  s_add_u32 s24, s24, s28
  v_lshrrev_b32 v12, 3, v2
  v_lshlrev_b32 v13, 1, v12
  s_waitcnt lgkmcnt(0)
  s_wakeup
  buffer_load_ushort v56, v13, s[4:7], s24 offen offset:0
  buffer_load_ushort v57, v13, s[4:7], s24 offen offset:512
  buffer_load_ushort v58, v13, s[4:7], s24 offen offset:1024
  buffer_load_ushort v59, v13, s[4:7], s24 offen offset:1536
  s_lshl_b32 s25, s77, 3
  s_add_u32 s25, s25, s63
  s_add_u32 s25, s25, 0x1080000
  s_lshl_b32 s21, s17, 10
  s_add_u32 s21, s21, s63
  s_add_u32 s21, s21, 0x1080000
  s_mov_b32 s38, 0
.g2_kernel_gx34:
  buffer_load_dwordx4 v[16:19], v3, s[4:7], s21 offen sc1
  buffer_load_dwordx2 v[20:21], v4, s[4:7], s25 offen sc1
  s_add_u32 s38, s38, 1
  s_waitcnt vmcnt(0)
  v_min3_u32 v6, v17, v19, v21
  v_cmp_eq_u32 vcc, 0, v6
  s_cbranch_vccz .g2_kernel_gx34d
  s_mov_b64 exec, vcc
  s_sleep 1
  s_cmp_lt_u32 s38, 131072
  s_cbranch_scc1 .g2_kernel_gx34
.g2_kernel_gx34d:
  s_mov_b64 exec, -1
  s_lshr_b32 s28, s77, 7
  s_and_b32 s79, s77, 127
  s_add_u32 s79, s79, 1
  s_cmp_eq_u32 s28, s17
  s_cselect_b32 s79, s79, 0
  v_rsq_f32 v22, v17
  v_rsq_f32 v23, v19
  v_rsq_f32 v21, v21
  v_mov_b32 v62, -1.4426950408889634
  v_mul_f32 v62, s27, v62
  v_exp_f32 v62, v62
  v_lshlrev_b32 v14, 3, v2
  v_add_u32 v14, 155648, v14
  v_mov_b32 v15, s79
  v_add_f32 v52, 1.0, v22
  v_mul_f32 v54, v16, v22
  v_sub_f32 v54, 0, v54
  v_add_f32 v53, 1.0, v23
  v_mul_f32 v55, v18, v23
  v_sub_f32 v55, 0, v55
  s_cmp_eq_u32 s62, 0
  s_cbranch_scc1 .g2_kernel_c_m1
  ds_write_b64 v14, v[52:53] offset:3840
  ds_write_b64 v14, v[54:55] offset:4352
  ds_write_b32 v9, v15 offset:32
  ds_write_b32 v9, v5 offset:28
  s_cmp_ge_u32 s18, 2
  s_cbranch_scc1 .g2_kernel_fin
.g2_kernel_c_m1:
  v_add_f32 v62, 1.0, v62
  v_rcp_f32 v62, v62
  v_add_f32 v60, 1.0, v21
  v_mul_f32 v61, v20, v21
  v_sub_f32 v61, 0, v61
  v_sub_f32 v17, v17, v30
  v_mul_f32 v48, v52, v52
  v_fma_f32 v48, v48, v17, v30
  v_rsq_f32 v48, v48
  s_nop 0
  v_mul_f32 v48, v48, v52
  v_mul_f32 v50, v48, v16
  v_sub_f32 v50, 0, v50
  v_sub_f32 v19, v19, v30
  v_mul_f32 v49, v53, v53
  v_fma_f32 v49, v49, v19, v30
  v_rsq_f32 v49, v49
  s_nop 0
  v_mul_f32 v49, v49, v53
  v_mul_f32 v51, v49, v18
  v_sub_f32 v51, 0, v51
  v_lshlrev_b32 v56, 16, v56
  v_fma_f32 v56, v56, v60, v61
  v_lshlrev_b32 v57, 16, v57
  v_fma_f32 v57, v57, v60, v61
  v_lshlrev_b32 v58, 16, v58
  v_fma_f32 v58, v58, v60, v61
  v_lshlrev_b32 v59, 16, v59
  v_fma_f32 v59, v59, v60, v61
  v_and_b32 v10, 7, v2
  v_lshlrev_b32 v10, 12, v10
  v_lshl_add_u32 v10, v12, 4, v10
  s_lshl_b32 s20, s17, 1
  s_and_b32 s28, s18, 1
  s_add_u32 s20, s20, s28
  s_lshl_b32 s20, s20, 7
  s_add_u32 s20, s20, s63
  s_add_u32 s20, s20, 0x1090000
  s_and_b32 s26, s18, 14
  s_lshl_b32 s26, s26, 4
  s_add_u32 s26, s26, s17
  s_lshl_b32 s26, s26, 1
  s_and_b32 s28, s18, 1
  s_add_u32 s26, s26, s28
  s_lshl_b32 s26, s26, 10
  s_add_u32 s26, s26, s63
  s_add_u32 s26, s26, 0x1190000
  s_add_u32 s25, s26, 32768
  v_mov_b32 v6, s71
  s_mov_b32 s38, 0
.g2_kernel_wg35:
  ds_read_b32 v7, v6 offset:48
  s_add_u32 s38, s38, 1
  s_waitcnt lgkmcnt(0)
  v_cmp_le_u32 vcc, 2, v7
  s_cbranch_vccnz .g2_kernel_wg35d
  s_sleep 1
  s_cmp_lt_u32 s38, 524288
  s_cbranch_scc1 .g2_kernel_wg35
.g2_kernel_wg35d:
  s_sleep 8
  s_mov_b32 s38, 0
.g2_kernel_gx36:
  s_mov_b32 s21, s20
  buffer_load_dwordx4 v[160:163], v10, s[4:7], s21 offen sc1
  s_add_u32 s21, s21, 32768
  buffer_load_dwordx4 v[164:167], v10, s[4:7], s21 offen sc1
  s_add_u32 s21, s21, 32768
  buffer_load_dwordx4 v[168:171], v10, s[4:7], s21 offen sc1
  s_add_u32 s21, s21, 32768
  buffer_load_dwordx4 v[172:175], v10, s[4:7], s21 offen sc1
  s_add_u32 s21, s21, 32768
  buffer_load_dwordx4 v[176:179], v10, s[4:7], s21 offen sc1
  s_add_u32 s21, s21, 32768
  buffer_load_dwordx4 v[180:183], v10, s[4:7], s21 offen sc1
  s_add_u32 s21, s21, 32768
  buffer_load_dwordx4 v[184:187], v10, s[4:7], s21 offen sc1
  s_add_u32 s21, s21, 32768
  buffer_load_dwordx4 v[188:191], v10, s[4:7], s21 offen sc1
  s_add_u32 s21, s21, 32768
  buffer_load_dwordx4 v[192:195], v10, s[4:7], s21 offen sc1
  s_add_u32 s21, s21, 32768
  buffer_load_dwordx4 v[196:199], v10, s[4:7], s21 offen sc1
  s_add_u32 s21, s21, 32768
  buffer_load_dwordx4 v[200:203], v10, s[4:7], s21 offen sc1
  s_add_u32 s21, s21, 32768
  buffer_load_dwordx4 v[204:207], v10, s[4:7], s21 offen sc1
  s_add_u32 s21, s21, 32768
  buffer_load_dwordx4 v[208:211], v10, s[4:7], s21 offen sc1
  s_add_u32 s21, s21, 32768
  buffer_load_dwordx4 v[212:215], v10, s[4:7], s21 offen sc1
  s_add_u32 s21, s21, 32768
  buffer_load_dwordx4 v[216:219], v10, s[4:7], s21 offen sc1
  s_add_u32 s21, s21, 32768
  buffer_load_dwordx4 v[220:223], v10, s[4:7], s21 offen sc1
  s_add_u32 s21, s21, 32768
  buffer_load_dwordx4 v[224:227], v10, s[4:7], s21 offen sc1
  s_add_u32 s21, s21, 32768
  buffer_load_dwordx4 v[228:231], v10, s[4:7], s21 offen sc1
  s_add_u32 s21, s21, 32768
  buffer_load_dwordx4 v[232:235], v10, s[4:7], s21 offen sc1
  s_add_u32 s21, s21, 32768
  buffer_load_dwordx4 v[236:239], v10, s[4:7], s21 offen sc1
  s_add_u32 s21, s21, 32768
  buffer_load_dwordx4 v[240:243], v10, s[4:7], s21 offen sc1
  s_add_u32 s21, s21, 32768
  buffer_load_dwordx4 v[244:247], v10, s[4:7], s21 offen sc1
  s_add_u32 s21, s21, 32768
  buffer_load_dwordx4 v[248:251], v10, s[4:7], s21 offen sc1
  s_add_u32 s21, s21, 32768
  buffer_load_dwordx4 v[252:255], v10, s[4:7], s21 offen sc1
  s_add_u32 s21, s21, 32768
  buffer_load_dwordx4 v[16:19], v10, s[4:7], s21 offen sc1
  s_add_u32 s21, s21, 32768
  buffer_load_dwordx4 v[20:23], v10, s[4:7], s21 offen sc1
  s_add_u32 s21, s21, 32768
  buffer_load_dwordx4 v[24:27], v10, s[4:7], s21 offen sc1
  s_add_u32 s21, s21, 32768
  buffer_load_dwordx4 v[28:31], v10, s[4:7], s21 offen sc1
  s_add_u32 s21, s21, 32768
  s_add_u32 s38, s38, 1
  s_waitcnt vmcnt(0)
  v_min3_u32 v6, v160, v162, v164
  v_min3_u32 v6, v6, v166, v168
  v_min3_u32 v6, v6, v170, v172
  v_min3_u32 v6, v6, v174, v176
  v_min3_u32 v6, v6, v178, v180
  v_min3_u32 v6, v6, v182, v184
  v_min3_u32 v6, v6, v186, v188
  v_min3_u32 v6, v6, v190, v192
  v_min3_u32 v6, v6, v194, v196
  v_min3_u32 v6, v6, v198, v200
  v_min3_u32 v6, v6, v202, v204
  v_min3_u32 v6, v6, v206, v208
  v_min3_u32 v6, v6, v210, v212
  v_min3_u32 v6, v6, v214, v216
  v_min3_u32 v6, v6, v218, v220
  v_min3_u32 v6, v6, v222, v224
  v_min3_u32 v6, v6, v226, v228
  v_min3_u32 v6, v6, v230, v232
  v_min3_u32 v6, v6, v234, v236
  v_min3_u32 v6, v6, v238, v240
  v_min3_u32 v6, v6, v242, v244
  v_min3_u32 v6, v6, v246, v248
  v_min3_u32 v6, v6, v250, v252
  v_min3_u32 v6, v6, v254, v16
  v_min3_u32 v6, v6, v18, v20
  v_min3_u32 v6, v6, v22, v24
  v_min3_u32 v6, v6, v26, v28
  v_min_u32 v6, v6, v30
  v_cmp_eq_u32 vcc, 0, v6
  s_cbranch_vccz .g2_kernel_gx36d
  s_mov_b64 exec, vcc
  s_sleep 1
  s_cmp_lt_u32 s38, 131072
  s_cbranch_scc1 .g2_kernel_gx36
.g2_kernel_gx36d:
  s_mov_b64 exec, -1
  v_add_f32 v164, v164, v160
  v_add_f32 v165, v165, v161
  v_add_f32 v166, v166, v162
  v_add_f32 v167, v167, v163
  v_add_f32 v172, v172, v168
  v_add_f32 v173, v173, v169
  v_add_f32 v174, v174, v170
  v_add_f32 v175, v175, v171
  v_add_f32 v180, v180, v176
  v_add_f32 v181, v181, v177
  v_add_f32 v182, v182, v178
  v_add_f32 v183, v183, v179
  v_add_f32 v188, v188, v184
  v_add_f32 v189, v189, v185
  v_add_f32 v190, v190, v186
  v_add_f32 v191, v191, v187
  v_add_f32 v196, v196, v192
  v_add_f32 v197, v197, v193
  v_add_f32 v198, v198, v194
  v_add_f32 v199, v199, v195
  v_add_f32 v204, v204, v200
  v_add_f32 v205, v205, v201
  v_add_f32 v206, v206, v202
  v_add_f32 v207, v207, v203
  v_add_f32 v212, v212, v208
  v_add_f32 v213, v213, v209
  v_add_f32 v214, v214, v210
  v_add_f32 v215, v215, v211
  v_add_f32 v220, v220, v216
  v_add_f32 v221, v221, v217
  v_add_f32 v222, v222, v218
  v_add_f32 v223, v223, v219
  v_add_f32 v228, v228, v224
  v_add_f32 v229, v229, v225
  v_add_f32 v230, v230, v226
  v_add_f32 v231, v231, v227
  v_add_f32 v236, v236, v232
  v_add_f32 v237, v237, v233
  v_add_f32 v238, v238, v234
  v_add_f32 v239, v239, v235
  v_add_f32 v244, v244, v240
  v_add_f32 v245, v245, v241
  v_add_f32 v246, v246, v242
  v_add_f32 v247, v247, v243
  v_add_f32 v252, v252, v248
  v_add_f32 v253, v253, v249
  v_add_f32 v254, v254, v250
  v_add_f32 v255, v255, v251
  v_add_f32 v20, v20, v16
  v_add_f32 v21, v21, v17
  v_add_f32 v22, v22, v18
  v_add_f32 v23, v23, v19
  v_add_f32 v28, v28, v24
  v_add_f32 v29, v29, v25
  v_add_f32 v30, v30, v26
  v_add_f32 v31, v31, v27
  v_add_f32 v172, v172, v164
  v_add_f32 v173, v173, v165
  v_add_f32 v174, v174, v166
  v_add_f32 v175, v175, v167
  v_add_f32 v188, v188, v180
  v_add_f32 v189, v189, v181
  v_add_f32 v190, v190, v182
  v_add_f32 v191, v191, v183
  v_add_f32 v204, v204, v196
  v_add_f32 v205, v205, v197
  v_add_f32 v206, v206, v198
  v_add_f32 v207, v207, v199
  v_add_f32 v220, v220, v212
  v_add_f32 v221, v221, v213
  v_add_f32 v222, v222, v214
  v_add_f32 v223, v223, v215
  v_add_f32 v236, v236, v228
  v_add_f32 v237, v237, v229
  v_add_f32 v238, v238, v230
  v_add_f32 v239, v239, v231
  v_add_f32 v252, v252, v244
  v_add_f32 v253, v253, v245
  v_add_f32 v254, v254, v246
  v_add_f32 v255, v255, v247
  v_add_f32 v28, v28, v20
  v_add_f32 v29, v29, v21
  v_add_f32 v30, v30, v22
  v_add_f32 v31, v31, v23
  v_add_f32 v188, v188, v172
  v_add_f32 v189, v189, v173
  v_add_f32 v190, v190, v174
  v_add_f32 v191, v191, v175
  v_add_f32 v220, v220, v204
  v_add_f32 v221, v221, v205
  v_add_f32 v222, v222, v206
  v_add_f32 v223, v223, v207
  v_add_f32 v252, v252, v236
  v_add_f32 v253, v253, v237
  v_add_f32 v254, v254, v238
  v_add_f32 v255, v255, v239
  v_add_f32 v220, v220, v188
  v_add_f32 v221, v221, v189
  v_add_f32 v222, v222, v190
  v_add_f32 v223, v223, v191
  v_add_f32 v28, v28, v252
  v_add_f32 v29, v29, v253
  v_add_f32 v30, v30, v254
  v_add_f32 v31, v31, v255
  v_add_f32 v28, v28, v220
  v_add_f32 v29, v29, v221
  v_add_f32 v30, v30, v222
  v_add_f32 v31, v31, v223
  v_add_f32 v28, v28, v28 quad_perm:[1,0,3,2] row_mask:0xf bank_mask:0xf
  v_add_f32 v29, v29, v29 quad_perm:[1,0,3,2] row_mask:0xf bank_mask:0xf
  v_add_f32 v30, v30, v30 quad_perm:[1,0,3,2] row_mask:0xf bank_mask:0xf
  v_add_f32 v31, v31, v31 quad_perm:[1,0,3,2] row_mask:0xf bank_mask:0xf
  v_add_f32 v28, v28, v28 quad_perm:[2,3,0,1] row_mask:0xf bank_mask:0xf
  v_add_f32 v29, v29, v29 quad_perm:[2,3,0,1] row_mask:0xf bank_mask:0xf
  v_add_f32 v30, v30, v30 quad_perm:[2,3,0,1] row_mask:0xf bank_mask:0xf
  v_add_f32 v31, v31, v31 quad_perm:[2,3,0,1] row_mask:0xf bank_mask:0xf
  v_add_f32 v28, v28, v28 row_half_mirror row_mask:0xf bank_mask:0xf
  v_add_f32 v29, v29, v29 row_half_mirror row_mask:0xf bank_mask:0xf
  v_add_f32 v30, v30, v30 row_half_mirror row_mask:0xf bank_mask:0xf
  v_add_f32 v31, v31, v31 row_half_mirror row_mask:0xf bank_mask:0xf
  v_mul_f32 v28, v28, v62
  v_mul_f32 v29, v29, v62
  v_mul_f32 v30, v30, v62
  v_mul_f32 v31, v31, v62
  v_cvt_pk_bf16_f32 v16, v28, v29
  v_cvt_pk_bf16_f32 v17, v30, v31
  s_mov_b32 s28, 0x00010001
  s_mov_b32 s29, 0x00010001
  v_mov_b32 v18, v16 row_ror:8 row_mask:0xf bank_mask:0xf
  v_mov_b32 v19, v17 row_ror:8 row_mask:0xf bank_mask:0xf
  v_lshlrev_b32 v28, 16, v16
  v_and_b32 v29, 0xffff0000, v16
  v_lshlrev_b32 v30, 16, v17
  v_and_b32 v31, 0xffff0000, v17
  s_cmp_lg_u32 s62, 0
  s_cbranch_scc1 .g2_kernel_c_t3
  v_cndmask_b32 v32, 0, v16, s[28:29]
  v_cndmask_b32 v33, 0, v17, s[28:29]
  v_cndmask_b32 v34, 0, v18, s[28:29]
  v_cndmask_b32 v35, 0, v19, s[28:29]
  s_lshl_b64 s[28:29], s[28:29], 1
  s_nop 0
  v_mfma_f32_16x16x32_bf16 v[160:163], v[32:35], v[64:67], 0
  v_mfma_f32_16x16x32_bf16 v[164:167], v[32:35], v[80:83], 0
  v_mfma_f32_16x16x32_bf16 v[168:171], v[32:35], v[96:99], 0
  v_mfma_f32_16x16x32_bf16 v[172:175], v[32:35], v[112:115], 0
  v_mfma_f32_16x16x32_bf16 v[176:179], v[32:35], v[128:131], 0
  v_mfma_f32_16x16x32_bf16 v[180:183], v[32:35], v[144:147], 0
  v_cndmask_b32 v36, 0, v16, s[28:29]
  v_cndmask_b32 v37, 0, v17, s[28:29]
  v_cndmask_b32 v38, 0, v18, s[28:29]
  v_cndmask_b32 v39, 0, v19, s[28:29]
  s_lshl_b64 s[28:29], s[28:29], 1
  s_nop 0
  v_mfma_f32_16x16x32_bf16 v[160:163], v[36:39], v[68:71], v[160:163]
  v_mfma_f32_16x16x32_bf16 v[164:167], v[36:39], v[84:87], v[164:167]
  v_mfma_f32_16x16x32_bf16 v[168:171], v[36:39], v[100:103], v[168:171]
  v_mfma_f32_16x16x32_bf16 v[172:175], v[36:39], v[116:119], v[172:175]
  v_mfma_f32_16x16x32_bf16 v[176:179], v[36:39], v[132:135], v[176:179]
  v_mfma_f32_16x16x32_bf16 v[180:183], v[36:39], v[148:151], v[180:183]
  v_cndmask_b32 v40, 0, v16, s[28:29]
  v_cndmask_b32 v41, 0, v17, s[28:29]
  v_cndmask_b32 v42, 0, v18, s[28:29]
  v_cndmask_b32 v43, 0, v19, s[28:29]
  s_lshl_b64 s[28:29], s[28:29], 1
  s_nop 0
  v_mfma_f32_16x16x32_bf16 v[160:163], v[40:43], v[72:75], v[160:163]
  v_mfma_f32_16x16x32_bf16 v[164:167], v[40:43], v[88:91], v[164:167]
  v_mfma_f32_16x16x32_bf16 v[168:171], v[40:43], v[104:107], v[168:171]
  v_mfma_f32_16x16x32_bf16 v[172:175], v[40:43], v[120:123], v[172:175]
  v_mfma_f32_16x16x32_bf16 v[176:179], v[40:43], v[136:139], v[176:179]
  v_mfma_f32_16x16x32_bf16 v[180:183], v[40:43], v[152:155], v[180:183]
  v_cndmask_b32 v44, 0, v16, s[28:29]
  v_cndmask_b32 v45, 0, v17, s[28:29]
  v_cndmask_b32 v46, 0, v18, s[28:29]
  v_cndmask_b32 v47, 0, v19, s[28:29]
  s_lshl_b64 s[28:29], s[28:29], 1
  s_nop 0
  v_mfma_f32_16x16x32_bf16 v[160:163], v[44:47], v[76:79], v[160:163]
  v_mfma_f32_16x16x32_bf16 v[164:167], v[44:47], v[92:95], v[164:167]
  v_mfma_f32_16x16x32_bf16 v[168:171], v[44:47], v[108:111], v[168:171]
  v_mfma_f32_16x16x32_bf16 v[172:175], v[44:47], v[124:127], v[172:175]
  v_mfma_f32_16x16x32_bf16 v[176:179], v[44:47], v[140:143], v[176:179]
  v_mfma_f32_16x16x32_bf16 v[180:183], v[44:47], v[156:159], v[180:183]
  v_add_f32 v56, v56, v28
  v_add_f32 v57, v57, v29
  v_add_f32 v58, v58, v30
  v_add_f32 v59, v59, v31
  v_add_f32 v20, v56, v57
  v_mul_f32 v22, v56, v56
  v_add_f32 v21, v58, v59
  v_fmac_f32 v22, v57, v57
  v_add_f32 v20, v20, v21
  v_fmac_f32 v22, v58, v58
  v_fmac_f32 v22, v59, v59
  v_or_b32 v28, 1, v28
  v_or_b32 v30, 1, v30
  v_add_f32 v20, v20, v20 row_ror:8 row_mask:0xf bank_mask:0xf
  v_add_f32 v22, v22, v22 row_ror:8 row_mask:0xf bank_mask:0xf
  v_lshlrev_b32 v11, 4, v12
  v_add_f32 v20, v20, v20 row_bcast:15 row_mask:0xa bank_mask:0xf
  v_add_f32 v22, v22, v22 row_bcast:15 row_mask:0xa bank_mask:0xf
  s_mov_b32 exec_lo, 0x01010101
  s_mov_b32 exec_hi, 0x01010101
  buffer_store_dwordx4 v[28:31], v11, s[4:7], s26 offen offset:768 sc1
  buffer_store_dwordx4 v[28:31], v11, s[4:7], s25 offen offset:768 sc1
  s_mov_b64 exec, -1
  v_add_f32 v20, v20, v20 row_bcast:31 row_mask:0xc bank_mask:0xf
  v_add_f32 v22, v22, v22 row_bcast:31 row_mask:0xc bank_mask:0xf
  v_or_b32 v20, 1, v20
  v_or_b32 v22, 1, v22
  s_mov_b32 exec_lo, 0
  s_mov_b32 exec_hi, 0x80000000
  buffer_store_dwordx4 v[20:23], v4, s[4:7], s26 offen offset:896 sc1
  buffer_store_dwordx4 v[20:23], v4, s[4:7], s25 offen offset:896 sc1
  s_mov_b64 exec, 0xffff
  v_or_b32 v160, 1, v160
  v_or_b32 v162, 1, v162
  buffer_store_dwordx4 v[160:163], v3, s[4:7], s26 offen offset:0 sc1
  v_or_b32 v164, 1, v164
  v_or_b32 v166, 1, v166
  buffer_store_dwordx4 v[164:167], v3, s[4:7], s25 offen offset:0 sc1
  v_or_b32 v168, 1, v168
  v_or_b32 v170, 1, v170
  buffer_store_dwordx4 v[168:171], v3, s[4:7], s26 offen offset:256 sc1
  v_or_b32 v172, 1, v172
  v_or_b32 v174, 1, v174
  buffer_store_dwordx4 v[172:175], v3, s[4:7], s25 offen offset:256 sc1
  v_or_b32 v176, 1, v176
  v_or_b32 v178, 1, v178
  buffer_store_dwordx4 v[176:179], v3, s[4:7], s26 offen offset:512 sc1
  v_or_b32 v180, 1, v180
  v_or_b32 v182, 1, v182
  buffer_store_dwordx4 v[180:183], v3, s[4:7], s25 offen offset:512 sc1
  s_mov_b64 exec, -1
  s_cmp_eq_u32 s79, 0
  s_cbranch_scc1 .g2_kernel_c_no
  s_lshl_b32 s20, s18, 15
  s_add_u32 s20, s20, 0x1190000
  s_lshl_b32 s22, s18, 11
  s_add_u32 s22, s22, s20
  v_rcp_f32 v16, v60
  v_lshlrev_b32 v17, 1, v2
  v_sub_u32 v17, s79, v17
  v_cmp_eq_u32 s[34:35], 1, v17
  v_cmp_eq_u32 s[36:37], 2, v17
  s_nop 0
  v_cndmask_b32 v18, 0, v16, s[34:35]
  v_cndmask_b32 v19, 0, v16, s[36:37]
  s_sleep 8
  s_mov_b32 s38, 0
  s_bfm_b64 exec, 57, 0
.g2_kernel_gx37:
  s_mov_b32 s21, s20
  buffer_load_dwordx4 v[64:67], v3, s[4:7], s21 offen offset:0 sc1
  buffer_load_dwordx4 v[68:71], v3, s[4:7], s21 offen offset:1024 sc1
  buffer_load_dwordx4 v[72:75], v3, s[4:7], s21 offen offset:2048 sc1
  buffer_load_dwordx4 v[76:79], v3, s[4:7], s21 offen offset:3072 sc1
  s_add_u32 s21, s21, 4096
  buffer_load_dwordx4 v[80:83], v3, s[4:7], s21 offen offset:0 sc1
  buffer_load_dwordx4 v[84:87], v3, s[4:7], s21 offen offset:1024 sc1
  buffer_load_dwordx4 v[88:91], v3, s[4:7], s21 offen offset:2048 sc1
  buffer_load_dwordx4 v[92:95], v3, s[4:7], s21 offen offset:3072 sc1
  s_add_u32 s21, s21, 4096
  buffer_load_dwordx4 v[96:99], v3, s[4:7], s21 offen offset:0 sc1
  buffer_load_dwordx4 v[100:103], v3, s[4:7], s21 offen offset:1024 sc1
  buffer_load_dwordx4 v[104:107], v3, s[4:7], s21 offen offset:2048 sc1
  buffer_load_dwordx4 v[108:111], v3, s[4:7], s21 offen offset:3072 sc1
  s_add_u32 s21, s21, 4096
  buffer_load_dwordx4 v[112:115], v3, s[4:7], s21 offen offset:0 sc1
  buffer_load_dwordx4 v[116:119], v3, s[4:7], s21 offen offset:1024 sc1
  buffer_load_dwordx4 v[120:123], v3, s[4:7], s21 offen offset:2048 sc1
  buffer_load_dwordx4 v[124:127], v3, s[4:7], s21 offen offset:3072 sc1
  s_add_u32 s21, s21, 4096
  buffer_load_dwordx4 v[128:131], v3, s[4:7], s21 offen offset:0 sc1
  buffer_load_dwordx4 v[132:135], v3, s[4:7], s21 offen offset:1024 sc1
  buffer_load_dwordx4 v[136:139], v3, s[4:7], s21 offen offset:2048 sc1
  buffer_load_dwordx4 v[140:143], v3, s[4:7], s21 offen offset:3072 sc1
  s_add_u32 s21, s21, 4096
  buffer_load_dwordx4 v[144:147], v3, s[4:7], s21 offen offset:0 sc1
  buffer_load_dwordx4 v[148:151], v3, s[4:7], s21 offen offset:1024 sc1
  buffer_load_dwordx4 v[152:155], v3, s[4:7], s21 offen offset:2048 sc1
  buffer_load_dwordx4 v[156:159], v3, s[4:7], s21 offen offset:3072 sc1
  s_add_u32 s21, s21, 4096
  buffer_load_dwordx4 v[160:163], v3, s[4:7], s21 offen offset:0 sc1
  buffer_load_dwordx4 v[164:167], v3, s[4:7], s21 offen offset:1024 sc1
  buffer_load_dwordx4 v[168:171], v3, s[4:7], s21 offen offset:2048 sc1
  buffer_load_dwordx4 v[172:175], v3, s[4:7], s21 offen offset:3072 sc1
  s_add_u32 s21, s21, 4096
  buffer_load_dwordx4 v[176:179], v3, s[4:7], s21 offen offset:0 sc1
  buffer_load_dwordx4 v[180:183], v3, s[4:7], s21 offen offset:1024 sc1
  buffer_load_dwordx4 v[184:187], v3, s[4:7], s21 offen offset:2048 sc1
  buffer_load_dwordx4 v[188:191], v3, s[4:7], s21 offen offset:3072 sc1
  s_add_u32 s21, s21, 4096
  buffer_load_dwordx4 v[192:195], v3, s[4:7], s22 offen offset:0 sc1
  buffer_load_dwordx4 v[196:199], v3, s[4:7], s22 offen offset:1024 sc1
  s_add_u32 s38, s38, 1
  s_waitcnt vmcnt(0)
  v_min3_u32 v6, v64, v66, v68
  v_min3_u32 v6, v6, v70, v72
  v_min3_u32 v6, v6, v74, v76
  v_min3_u32 v6, v6, v78, v80
  v_min3_u32 v6, v6, v82, v84
  v_min3_u32 v6, v6, v86, v88
  v_min3_u32 v6, v6, v90, v92
  v_min3_u32 v6, v6, v94, v96
  v_min3_u32 v6, v6, v98, v100
  v_min3_u32 v6, v6, v102, v104
  v_min3_u32 v6, v6, v106, v108
  v_min3_u32 v6, v6, v110, v112
  v_min3_u32 v6, v6, v114, v116
  v_min3_u32 v6, v6, v118, v120
  v_min3_u32 v6, v6, v122, v124
  v_min3_u32 v6, v6, v126, v128
  v_min3_u32 v6, v6, v130, v132
  v_min3_u32 v6, v6, v134, v136
  v_min3_u32 v6, v6, v138, v140
  v_min3_u32 v6, v6, v142, v144
  v_min3_u32 v6, v6, v146, v148
  v_min3_u32 v6, v6, v150, v152
  v_min3_u32 v6, v6, v154, v156
  v_min3_u32 v6, v6, v158, v160
  v_min3_u32 v6, v6, v162, v164
  v_min3_u32 v6, v6, v166, v168
  v_min3_u32 v6, v6, v170, v172
  v_min3_u32 v6, v6, v174, v176
  v_min3_u32 v6, v6, v178, v180
  v_min3_u32 v6, v6, v182, v184
  v_min3_u32 v6, v6, v186, v188
  v_min3_u32 v6, v6, v190, v192
  v_min3_u32 v6, v6, v194, v196
  v_min_u32 v6, v6, v198
  v_cmp_eq_u32 vcc, 0, v6
  s_cbranch_vccz .g2_kernel_gx37d
  s_mov_b64 exec, vcc
  s_sleep 1
  s_cmp_lt_u32 s38, 131072
  s_cbranch_scc1 .g2_kernel_gx37
.g2_kernel_gx37d:
  s_mov_b64 exec, -1
  v_add_f32 v64, v64, v128
  v_add_f32 v65, v65, v129
  v_add_f32 v66, v66, v130
  v_add_f32 v67, v67, v131
  v_add_f32 v68, v68, v132
  v_add_f32 v69, v69, v133
  v_add_f32 v70, v70, v134
  v_add_f32 v71, v71, v135
  v_add_f32 v72, v72, v136
  v_add_f32 v73, v73, v137
  v_add_f32 v74, v74, v138
  v_add_f32 v75, v75, v139
  v_add_f32 v76, v76, v140
  v_add_f32 v77, v77, v141
  v_add_f32 v78, v78, v142
  v_add_f32 v79, v79, v143
  v_add_f32 v80, v80, v144
  v_add_f32 v81, v81, v145
  v_add_f32 v82, v82, v146
  v_add_f32 v83, v83, v147
  v_add_f32 v84, v84, v148
  v_add_f32 v85, v85, v149
  v_add_f32 v86, v86, v150
  v_add_f32 v87, v87, v151
  v_add_f32 v88, v88, v152
  v_add_f32 v89, v89, v153
  v_add_f32 v90, v90, v154
  v_add_f32 v91, v91, v155
  v_add_f32 v92, v92, v156
  v_add_f32 v93, v93, v157
  v_add_f32 v94, v94, v158
  v_add_f32 v95, v95, v159
  v_add_f32 v96, v96, v160
  v_add_f32 v97, v97, v161
  v_add_f32 v98, v98, v162
  v_add_f32 v99, v99, v163
  v_add_f32 v100, v100, v164
  v_add_f32 v101, v101, v165
  v_add_f32 v102, v102, v166
  v_add_f32 v103, v103, v167
  v_add_f32 v104, v104, v168
  v_add_f32 v105, v105, v169
  v_add_f32 v106, v106, v170
  v_add_f32 v107, v107, v171
  v_add_f32 v108, v108, v172
  v_add_f32 v109, v109, v173
  v_add_f32 v110, v110, v174
  v_add_f32 v111, v111, v175
  v_add_f32 v112, v112, v176
  v_add_f32 v113, v113, v177
  v_add_f32 v114, v114, v178
  v_add_f32 v115, v115, v179
  v_add_f32 v116, v116, v180
  v_add_f32 v117, v117, v181
  v_add_f32 v118, v118, v182
  v_add_f32 v119, v119, v183
  v_add_f32 v120, v120, v184
  v_add_f32 v121, v121, v185
  v_add_f32 v122, v122, v186
  v_add_f32 v123, v123, v187
  v_add_f32 v124, v124, v188
  v_add_f32 v125, v125, v189
  v_add_f32 v126, v126, v190
  v_add_f32 v127, v127, v191
  v_add_f32 v64, v64, v96
  v_add_f32 v65, v65, v97
  v_add_f32 v66, v66, v98
  v_add_f32 v67, v67, v99
  v_add_f32 v68, v68, v100
  v_add_f32 v69, v69, v101
  v_add_f32 v70, v70, v102
  v_add_f32 v71, v71, v103
  v_add_f32 v72, v72, v104
  v_add_f32 v73, v73, v105
  v_add_f32 v74, v74, v106
  v_add_f32 v75, v75, v107
  v_add_f32 v76, v76, v108
  v_add_f32 v77, v77, v109
  v_add_f32 v78, v78, v110
  v_add_f32 v79, v79, v111
  v_add_f32 v80, v80, v112
  v_add_f32 v81, v81, v113
  v_add_f32 v82, v82, v114
  v_add_f32 v83, v83, v115
  v_add_f32 v84, v84, v116
  v_add_f32 v85, v85, v117
  v_add_f32 v86, v86, v118
  v_add_f32 v87, v87, v119
  v_add_f32 v88, v88, v120
  v_add_f32 v89, v89, v121
  v_add_f32 v90, v90, v122
  v_add_f32 v91, v91, v123
  v_add_f32 v92, v92, v124
  v_add_f32 v93, v93, v125
  v_add_f32 v94, v94, v126
  v_add_f32 v95, v95, v127
  v_add_f32 v64, v64, v80
  v_add_f32 v65, v65, v81
  v_add_f32 v66, v66, v82
  v_add_f32 v67, v67, v83
  v_add_f32 v68, v68, v84
  v_add_f32 v69, v69, v85
  v_add_f32 v70, v70, v86
  v_add_f32 v71, v71, v87
  v_add_f32 v72, v72, v88
  v_add_f32 v73, v73, v89
  v_add_f32 v74, v74, v90
  v_add_f32 v75, v75, v91
  v_add_f32 v76, v76, v92
  v_add_f32 v77, v77, v93
  v_add_f32 v78, v78, v94
  v_add_f32 v79, v79, v95
  v_add_f32 v64, v64, v72
  v_add_f32 v65, v65, v73
  v_add_f32 v66, v66, v74
  v_add_f32 v67, v67, v75
  v_add_f32 v68, v68, v76
  v_add_f32 v69, v69, v77
  v_add_f32 v70, v70, v78
  v_add_f32 v71, v71, v79
  v_add_f32 v64, v64, v68
  v_add_f32 v65, v65, v69
  v_add_f32 v66, v66, v70
  v_add_f32 v67, v67, v71
  v_mov_b32 v28, 0.0009765625
  v_mov_b32 v30, 1e-05
  v_readlane_b32 s21, v64, 56
  v_readlane_b32 s22, v66, 56
  s_nop 0
  v_mul_f32 v20, s21, v28
  v_fma_f32 v21, s22, v28, v30
  v_fma_f32 v21, -v20, v20, v21
  v_rsq_f32 v21, abs(v21)
  v_sub_f32 v20, v61, v20
  v_mul_f32 v22, v21, v60
  v_mul_f32 v23, v21, v20
  v_cndmask_b32 v48, v48, v22, s[34:35]
  v_cndmask_b32 v49, v49, v22, s[36:37]
  v_cndmask_b32 v50, v50, v23, s[34:35]
  v_cndmask_b32 v51, v51, v23, s[36:37]
.g2_kernel_c_no:
  s_mov_b32 s62, 1
  s_mov_b32 s63, 0x1800000
  s_mov_b32 s70, 2
  s_mov_b32 s71, 155776
  v_mov_b32 v6, 155648
  s_mov_b32 s38, 0
.g2_kernel_wg38:
  ds_read_b32 v7, v6 offset:512
  s_add_u32 s38, s38, 1
  s_waitcnt lgkmcnt(0)
  v_cmp_le_u32 vcc, 64, v7
  s_cbranch_vccnz .g2_kernel_wg38d
  s_sleep 2
  s_cmp_lt_u32 s38, 524288
  s_cbranch_scc1 .g2_kernel_wg38
.g2_kernel_wg38d:
  v_mov_b32 v9, s71
  ds_write_b64 v14, v[48:49] offset:2816
  ds_write_b64 v14, v[50:51] offset:3328
  ds_write_b64 v14, v[52:53] offset:3840
  ds_write_b64 v14, v[54:55] offset:4352
  s_cmp_eq_u32 s79, 0
  s_cbranch_scc1 .g2_kernel_c_no2
  ds_write_b32 v9, v15 offset:24
  ds_write_b64 v14, v[18:19] offset:5632
  v_and_b32 v10, 15, v2
  v_lshrrev_b32 v11, 4, v2
  v_lshlrev_b32 v10, 2, v10
  v_lshl_add_u32 v10, v11, 8, v10
  v_add_u32 v10, 155648, v10
  s_mov_b32 exec_hi, 0xffff
  ds_write_b32 v10, v64 offset:6144
  ds_write_b32 v10, v65 offset:6208
  ds_write_b32 v10, v66 offset:6272
  ds_write_b32 v10, v67 offset:6336
  s_mov_b32 exec_lo, 0
  s_mov_b32 exec_hi, 0xff0000
  ds_write_b32 v10, v192 offset:6912
  ds_write_b32 v10, v193 offset:6976
  ds_write_b32 v10, v194 offset:7040
  ds_write_b32 v10, v195 offset:7104
  ds_write_b32 v10, v196 offset:6944
  ds_write_b32 v10, v197 offset:7008
  ds_write_b32 v10, v198 offset:7072
  ds_write_b32 v10, v199 offset:7136
  s_mov_b64 exec, -1
.g2_kernel_c_no2:
  v_mov_b32 v8, 2
  ds_write_b32 v9, v8 offset:0
  s_branch .g2_kernel_v
.g2_kernel_c_t3:
  s_mov_b32 s28, s56
  s_mov_b32 s29, s57
  s_mov_b32 s30, 0x400000
  s_mov_b32 s31, 0x00020000
  v_add_f32 v56, v56, v28
  v_add_f32 v57, v57, v29
  v_add_f32 v58, v58, v30
  v_add_f32 v59, v59, v31
  v_cvt_pk_bf16_f32 v56, v56, v57
  v_cvt_pk_bf16_f32 v58, v58, v59
  s_lshl_b32 s21, s77, 11
  s_lshl_b32 s22, s17, 7
  s_add_u32 s21, s21, s22
  s_lshl_b32 s22, s18, 4
  s_add_u32 s21, s21, s22
  s_mov_b32 exec_lo, 0x01010101
  s_mov_b32 exec_hi, 0x01010101
  buffer_store_short v56, v13, s[28:31], s21 offen
  buffer_store_short_d16_hi v56, v13, s[28:31], s21 offen offset:32
  buffer_store_short v58, v13, s[28:31], s21 offen offset:64
  buffer_store_short_d16_hi v58, v13, s[28:31], s21 offen offset:96
  s_mov_b64 exec, -1
  s_branch .g2_kernel_fin
.g2_kernel_c2:
  s_cmp_lg_u32 s62, 0
  s_cbranch_scc1 .g2_kernel_d_a
  s_cmp_lg_u32 s16, 7
  s_cbranch_scc1 .g2_kernel_d_a
  v_mov_b32 v6, s71
  s_mov_b32 s38, 0
.g2_kernel_wg40:
  ds_read_b32 v7, v6 offset:20
  s_add_u32 s38, s38, 1
  s_waitcnt lgkmcnt(0)
  v_cmp_le_u32 vcc, 4, v7
  s_cbranch_vccnz .g2_kernel_wg40d
  s_sleep 2
  s_cmp_lt_u32 s38, 524288
  s_cbranch_scc1 .g2_kernel_wg40
.g2_kernel_wg40d:
  s_sleep 12
  s_and_b32 s31, s19, 0xfffff800
  s_add_u32 s31, s31, 32
  v_and_b32 v6, 15, v2
  v_lshlrev_b32 v6, 7, v6
  v_lshrrev_b32 v7, 4, v2
  v_lshl_add_u32 v6, v7, 2, v6
  v_lshlrev_b32 v7, 2, v2
  v_add_u32 v7, 158208, v7
  s_mov_b32 m0, 158208
  s_mov_b32 s38, 0
.g2_kernel_pa41:
  buffer_load_dword v6, s[4:7], s31 offen sc1 lds
  s_add_u32 s38, s38, 1
  s_waitcnt vmcnt(0)
  ds_read_b32 v8, v7
  s_waitcnt lgkmcnt(0)
  v_cmp_ge_u32 vcc, s62, v8
  s_cbranch_vccz .g2_kernel_pa41d
  s_mov_b64 exec, vcc
  s_sleep 2
  s_cmp_lt_u32 s38, 131072
  s_cbranch_scc1 .g2_kernel_pa41
.g2_kernel_pa41d:
  s_mov_b64 exec, -1
.g2_kernel_d_a:
  s_setprio 2
  s_and_b32 s20, s16, 1
  v_bfe_u32 v8, v2, 1, 3
  v_lshlrev_b32 v8, 14, v8
  v_and_b32 v9, 1, v2
  v_lshl_add_u32 v8, v9, 10, v8
  v_lshrrev_b32 v9, 4, v2
  v_lshl_add_u32 v8, v9, 8, v8
  v_and_b32 v9, 15, v2
  v_lshlrev_b32 v9, 3, v9
  s_lshl_b32 s28, s20, 7
  s_add_u32 s28, s28, 162560
  v_add_u32 v10, s28, v9
  v_xor_b32 v11, 128, v10
  s_lshl_b32 s28, s20, 2
  s_add_u32 s28, s28, s71
  v_mov_b32 v12, s28
  v_xor_b32 v13, 4, v12
  s_lshl_b32 s26, s17, 4
  s_add_u32 s26, s26, s18
  s_lshl_b32 s26, s26, 1
  s_add_u32 s26, s26, s20
  s_lshl_b32 s26, s26, 11
  s_add_u32 s26, s26, s63
  s_add_u32 s26, s26, 0x1090000
  v_mov_b32 v6, s71
  s_mov_b32 s38, 0
.g2_kernel_wg42:
  ds_read_b32 v7, v6 offset:36
  s_add_u32 s38, s38, 1
  s_waitcnt lgkmcnt(0)
  v_cmp_le_u32 vcc, 1, v7
  s_cbranch_vccnz .g2_kernel_wg42d
  s_sleep 4
  s_cmp_lt_u32 s38, 524288
  s_cbranch_scc1 .g2_kernel_wg42
.g2_kernel_wg42d:
  s_cmp_ge_u32 s17, 14
  s_cbranch_scc1 .g2_kernel_d_none
  v_readfirstlane_b32 s77, v7
  s_sub_u32 s77, s77, 1
  s_and_b32 s77, s77, 2047
  s_lshr_b32 s24, s77, 7
  s_lshl_b32 s24, s24, 18
  s_bfe_u32 s28, s77, 0x30004
  s_lshl_b32 s28, s28, 11
  s_add_u32 s24, s24, s28
  s_and_b32 s28, s77, 15
  s_lshl_b32 s28, s28, 4
  s_add_u32 s24, s24, s28
  s_add_u32 s24, s24, s63
  s_add_u32 s24, s24, 0xc00000
  s_lshl_b32 s28, s20, 17
  s_add_u32 s24, s24, s28
  buffer_load_dwordx4 v[16:19], v8, s[4:7], s24 offen
  s_lshl_b32 s25, s77, 3
  s_add_u32 s25, s25, s63
  s_add_u32 s25, s25, 0x1080000
  s_mov_b32 s38, 0
.g2_kernel_gx43:
  buffer_load_dwordx2 v[20:21], v4, s[4:7], s25 offen sc1
  s_add_u32 s38, s38, 1
  s_waitcnt vmcnt(0)
  v_min_u32 v6, v21, v21
  v_cmp_eq_u32 vcc, 0, v6
  s_cbranch_vccz .g2_kernel_gx43d
  s_mov_b64 exec, vcc
  s_sleep 1
  s_cmp_lt_u32 s38, 131072
  s_cbranch_scc1 .g2_kernel_gx43
.g2_kernel_gx43d:
  s_mov_b64 exec, -1
  v_rsq_f32 v21, v21
  v_lshlrev_b32 v24, 16, v16
  v_and_b32 v25, 0xffff0000, v16
  v_lshlrev_b32 v26, 16, v17
  v_and_b32 v27, 0xffff0000, v17
  v_lshlrev_b32 v28, 16, v18
  v_and_b32 v29, 0xffff0000, v18
  v_lshlrev_b32 v30, 16, v19
  v_and_b32 v31, 0xffff0000, v19
  v_mul_f32 v20, v20, v21
  v_fma_f32 v24, v24, v21, -v20
  v_fma_f32 v25, v25, v21, -v20
  v_fma_f32 v26, v26, v21, -v20
  v_fma_f32 v27, v27, v21, -v20
  v_fma_f32 v28, v28, v21, -v20
  v_fma_f32 v29, v29, v21, -v20
  v_fma_f32 v30, v30, v21, -v20
  v_fma_f32 v31, v31, v21, -v20
  v_cvt_pk_bf16_f32 v16, v24, v25
  v_cvt_pk_bf16_f32 v17, v26, v27
  v_cvt_pk_bf16_f32 v18, v28, v29
  v_cvt_pk_bf16_f32 v19, v30, v31
  v_mov_b32 v24, v16 row_newbcast:0 row_mask:0xf bank_mask:0xf
  v_mov_b32 v25, v17 row_newbcast:0 row_mask:0xf bank_mask:0xf
  v_mov_b32 v26, v18 row_newbcast:0 row_mask:0xf bank_mask:0xf
  v_mov_b32 v27, v19 row_newbcast:0 row_mask:0xf bank_mask:0xf
  v_mov_b32 v28, v16 row_newbcast:1 row_mask:0xf bank_mask:0xf
  v_mov_b32 v29, v17 row_newbcast:1 row_mask:0xf bank_mask:0xf
  v_mov_b32 v30, v18 row_newbcast:1 row_mask:0xf bank_mask:0xf
  v_mov_b32 v31, v19 row_newbcast:1 row_mask:0xf bank_mask:0xf
  v_mfma_f32_16x16x32_bf16 v[32:35], v[24:27], v[64:67], 0
  v_mfma_f32_16x16x32_bf16 v[36:39], v[24:27], v[128:131], 0
  v_mov_b32 v24, v16 row_newbcast:2 row_mask:0xf bank_mask:0xf
  v_mov_b32 v25, v17 row_newbcast:2 row_mask:0xf bank_mask:0xf
  v_mov_b32 v26, v18 row_newbcast:2 row_mask:0xf bank_mask:0xf
  v_mov_b32 v27, v19 row_newbcast:2 row_mask:0xf bank_mask:0xf
  v_mfma_f32_16x16x32_bf16 v[32:35], v[28:31], v[68:71], v[32:35]
  v_mfma_f32_16x16x32_bf16 v[36:39], v[28:31], v[132:135], v[36:39]
  v_mov_b32 v28, v16 row_newbcast:3 row_mask:0xf bank_mask:0xf
  v_mov_b32 v29, v17 row_newbcast:3 row_mask:0xf bank_mask:0xf
  v_mov_b32 v30, v18 row_newbcast:3 row_mask:0xf bank_mask:0xf
  v_mov_b32 v31, v19 row_newbcast:3 row_mask:0xf bank_mask:0xf
  v_mfma_f32_16x16x32_bf16 v[32:35], v[24:27], v[72:75], v[32:35]
  v_mfma_f32_16x16x32_bf16 v[36:39], v[24:27], v[136:139], v[36:39]
  v_mov_b32 v24, v16 row_newbcast:4 row_mask:0xf bank_mask:0xf
  v_mov_b32 v25, v17 row_newbcast:4 row_mask:0xf bank_mask:0xf
  v_mov_b32 v26, v18 row_newbcast:4 row_mask:0xf bank_mask:0xf
  v_mov_b32 v27, v19 row_newbcast:4 row_mask:0xf bank_mask:0xf
  v_mfma_f32_16x16x32_bf16 v[32:35], v[28:31], v[76:79], v[32:35]
  v_mfma_f32_16x16x32_bf16 v[36:39], v[28:31], v[140:143], v[36:39]
  v_mov_b32 v28, v16 row_newbcast:5 row_mask:0xf bank_mask:0xf
  v_mov_b32 v29, v17 row_newbcast:5 row_mask:0xf bank_mask:0xf
  v_mov_b32 v30, v18 row_newbcast:5 row_mask:0xf bank_mask:0xf
  v_mov_b32 v31, v19 row_newbcast:5 row_mask:0xf bank_mask:0xf
  v_mfma_f32_16x16x32_bf16 v[32:35], v[24:27], v[80:83], v[32:35]
  v_mfma_f32_16x16x32_bf16 v[36:39], v[24:27], v[144:147], v[36:39]
  v_mov_b32 v24, v16 row_newbcast:6 row_mask:0xf bank_mask:0xf
  v_mov_b32 v25, v17 row_newbcast:6 row_mask:0xf bank_mask:0xf
  v_mov_b32 v26, v18 row_newbcast:6 row_mask:0xf bank_mask:0xf
  v_mov_b32 v27, v19 row_newbcast:6 row_mask:0xf bank_mask:0xf
  v_mfma_f32_16x16x32_bf16 v[32:35], v[28:31], v[84:87], v[32:35]
  v_mfma_f32_16x16x32_bf16 v[36:39], v[28:31], v[148:151], v[36:39]
  v_mov_b32 v28, v16 row_newbcast:7 row_mask:0xf bank_mask:0xf
  v_mov_b32 v29, v17 row_newbcast:7 row_mask:0xf bank_mask:0xf
  v_mov_b32 v30, v18 row_newbcast:7 row_mask:0xf bank_mask:0xf
  v_mov_b32 v31, v19 row_newbcast:7 row_mask:0xf bank_mask:0xf
  v_mfma_f32_16x16x32_bf16 v[32:35], v[24:27], v[88:91], v[32:35]
  v_mfma_f32_16x16x32_bf16 v[36:39], v[24:27], v[152:155], v[36:39]
  v_mov_b32 v24, v16 row_newbcast:8 row_mask:0xf bank_mask:0xf
  v_mov_b32 v25, v17 row_newbcast:8 row_mask:0xf bank_mask:0xf
  v_mov_b32 v26, v18 row_newbcast:8 row_mask:0xf bank_mask:0xf
  v_mov_b32 v27, v19 row_newbcast:8 row_mask:0xf bank_mask:0xf
  v_mfma_f32_16x16x32_bf16 v[32:35], v[28:31], v[92:95], v[32:35]
  v_mfma_f32_16x16x32_bf16 v[36:39], v[28:31], v[156:159], v[36:39]
  v_mov_b32 v28, v16 row_newbcast:9 row_mask:0xf bank_mask:0xf
  v_mov_b32 v29, v17 row_newbcast:9 row_mask:0xf bank_mask:0xf
  v_mov_b32 v30, v18 row_newbcast:9 row_mask:0xf bank_mask:0xf
  v_mov_b32 v31, v19 row_newbcast:9 row_mask:0xf bank_mask:0xf
  v_mfma_f32_16x16x32_bf16 v[32:35], v[24:27], v[96:99], v[32:35]
  v_mfma_f32_16x16x32_bf16 v[36:39], v[24:27], v[160:163], v[36:39]
  v_mov_b32 v24, v16 row_newbcast:10 row_mask:0xf bank_mask:0xf
  v_mov_b32 v25, v17 row_newbcast:10 row_mask:0xf bank_mask:0xf
  v_mov_b32 v26, v18 row_newbcast:10 row_mask:0xf bank_mask:0xf
  v_mov_b32 v27, v19 row_newbcast:10 row_mask:0xf bank_mask:0xf
  v_mfma_f32_16x16x32_bf16 v[32:35], v[28:31], v[100:103], v[32:35]
  v_mfma_f32_16x16x32_bf16 v[36:39], v[28:31], v[164:167], v[36:39]
  v_mov_b32 v28, v16 row_newbcast:11 row_mask:0xf bank_mask:0xf
  v_mov_b32 v29, v17 row_newbcast:11 row_mask:0xf bank_mask:0xf
  v_mov_b32 v30, v18 row_newbcast:11 row_mask:0xf bank_mask:0xf
  v_mov_b32 v31, v19 row_newbcast:11 row_mask:0xf bank_mask:0xf
  v_mfma_f32_16x16x32_bf16 v[32:35], v[24:27], v[104:107], v[32:35]
  v_mfma_f32_16x16x32_bf16 v[36:39], v[24:27], v[168:171], v[36:39]
  v_mov_b32 v24, v16 row_newbcast:12 row_mask:0xf bank_mask:0xf
  v_mov_b32 v25, v17 row_newbcast:12 row_mask:0xf bank_mask:0xf
  v_mov_b32 v26, v18 row_newbcast:12 row_mask:0xf bank_mask:0xf
  v_mov_b32 v27, v19 row_newbcast:12 row_mask:0xf bank_mask:0xf
  v_mfma_f32_16x16x32_bf16 v[32:35], v[28:31], v[108:111], v[32:35]
  v_mfma_f32_16x16x32_bf16 v[36:39], v[28:31], v[172:175], v[36:39]
  v_mov_b32 v28, v16 row_newbcast:13 row_mask:0xf bank_mask:0xf
  v_mov_b32 v29, v17 row_newbcast:13 row_mask:0xf bank_mask:0xf
  v_mov_b32 v30, v18 row_newbcast:13 row_mask:0xf bank_mask:0xf
  v_mov_b32 v31, v19 row_newbcast:13 row_mask:0xf bank_mask:0xf
  v_mfma_f32_16x16x32_bf16 v[32:35], v[24:27], v[112:115], v[32:35]
  v_mfma_f32_16x16x32_bf16 v[36:39], v[24:27], v[176:179], v[36:39]
  v_mov_b32 v24, v16 row_newbcast:14 row_mask:0xf bank_mask:0xf
  v_mov_b32 v25, v17 row_newbcast:14 row_mask:0xf bank_mask:0xf
  v_mov_b32 v26, v18 row_newbcast:14 row_mask:0xf bank_mask:0xf
  v_mov_b32 v27, v19 row_newbcast:14 row_mask:0xf bank_mask:0xf
  v_mfma_f32_16x16x32_bf16 v[32:35], v[28:31], v[116:119], v[32:35]
  v_mfma_f32_16x16x32_bf16 v[36:39], v[28:31], v[180:183], v[36:39]
  v_mov_b32 v28, v16 row_newbcast:15 row_mask:0xf bank_mask:0xf
  v_mov_b32 v29, v17 row_newbcast:15 row_mask:0xf bank_mask:0xf
  v_mov_b32 v30, v18 row_newbcast:15 row_mask:0xf bank_mask:0xf
  v_mov_b32 v31, v19 row_newbcast:15 row_mask:0xf bank_mask:0xf
  v_mfma_f32_16x16x32_bf16 v[32:35], v[24:27], v[120:123], v[32:35]
  v_mfma_f32_16x16x32_bf16 v[36:39], v[24:27], v[184:187], v[36:39]
  v_mfma_f32_16x16x32_bf16 v[32:35], v[28:31], v[124:127], v[32:35]
  v_mfma_f32_16x16x32_bf16 v[36:39], v[28:31], v[188:191], v[36:39]
  s_mov_b32 s38, 0
  s_mov_b32 s28, 0x00010001
  s_mov_b32 s29, 0x00100010
  s_nop 4
  v_mov_b32 v35, v36
  ds_write_b64 v10, v[34:35]
  ds_write_b32 v12, v5 offset:40
.g2_kernel_d_x:
  ds_read_b32 v6, v13 offset:40
  ds_read_b64 v[16:17], v11
  s_add_u32 s38, s38, 1
  s_waitcnt lgkmcnt(0)
  v_cmp_ne_u32 vcc, 0, v6
  s_cbranch_vccnz .g2_kernel_d_xd
  s_cmp_lt_u32 s38, 524288
  s_cbranch_scc1 .g2_kernel_d_x
.g2_kernel_d_xd:
  v_add_f32 v16, v16, v32
  v_add_f32 v17, v17, v36
  v_mul_f32 v18, -1.4426950408889634, v16
  v_exp_f32 v18, v18
  v_mul_f32 v16, v16, v17
  v_add_f32 v18, 1.0, v18
  v_rcp_f32 v18, v18
  s_nop 0
  v_mul_f32 v16, v16, v18
  s_nop 1
  v_mov_b32 v17, v16 quad_perm:[1,0,3,2] row_mask:0xf bank_mask:0xf
  v_cvt_pk_bf16_f32 v16, v16, v17
  s_nop 1
  v_mov_b32 v20, v16 row_newbcast:0 row_mask:0x5 bank_mask:0xf
  v_mov_b32 v21, v16 row_newbcast:2 row_mask:0x5 bank_mask:0xf
  v_mov_b32 v22, v16 row_newbcast:4 row_mask:0x5 bank_mask:0xf
  v_mov_b32 v23, v16 row_newbcast:6 row_mask:0x5 bank_mask:0xf
  v_mov_b32 v20, v16 row_newbcast:8 row_mask:0xa bank_mask:0xf
  v_mov_b32 v21, v16 row_newbcast:10 row_mask:0xa bank_mask:0xf
  v_mov_b32 v22, v16 row_newbcast:12 row_mask:0xa bank_mask:0xf
  v_mov_b32 v23, v16 row_newbcast:14 row_mask:0xa bank_mask:0xf
  v_cndmask_b32 v24, 0, v20, s[28:29]
  v_cndmask_b32 v25, 0, v21, s[28:29]
  v_cndmask_b32 v26, 0, v22, s[28:29]
  v_cndmask_b32 v27, 0, v23, s[28:29]
  s_lshl_b64 s[28:29], s[28:29], 1
  s_nop 0
  v_mfma_f32_16x16x32_bf16 v[40:43], v[24:27], v[192:195], 0
  v_mfma_f32_16x16x32_bf16 v[44:47], v[24:27], v[208:211], 0
  v_mfma_f32_16x16x32_bf16 v[48:51], v[24:27], v[224:227], 0
  v_mfma_f32_16x16x32_bf16 v[52:55], v[24:27], v[240:243], 0
  v_cndmask_b32 v28, 0, v20, s[28:29]
  v_cndmask_b32 v29, 0, v21, s[28:29]
  v_cndmask_b32 v30, 0, v22, s[28:29]
  v_cndmask_b32 v31, 0, v23, s[28:29]
  s_lshl_b64 s[28:29], s[28:29], 1
  s_nop 0
  v_mfma_f32_16x16x32_bf16 v[40:43], v[28:31], v[196:199], v[40:43]
  v_mfma_f32_16x16x32_bf16 v[44:47], v[28:31], v[212:215], v[44:47]
  v_mfma_f32_16x16x32_bf16 v[48:51], v[28:31], v[228:231], v[48:51]
  v_mfma_f32_16x16x32_bf16 v[52:55], v[28:31], v[244:247], v[52:55]
  v_cndmask_b32 v32, 0, v20, s[28:29]
  v_cndmask_b32 v33, 0, v21, s[28:29]
  v_cndmask_b32 v34, 0, v22, s[28:29]
  v_cndmask_b32 v35, 0, v23, s[28:29]
  s_lshl_b64 s[28:29], s[28:29], 1
  s_nop 0
  v_mfma_f32_16x16x32_bf16 v[40:43], v[32:35], v[200:203], v[40:43]
  v_mfma_f32_16x16x32_bf16 v[44:47], v[32:35], v[216:219], v[44:47]
  v_mfma_f32_16x16x32_bf16 v[48:51], v[32:35], v[232:235], v[48:51]
  v_mfma_f32_16x16x32_bf16 v[52:55], v[32:35], v[248:251], v[52:55]
  v_cndmask_b32 v36, 0, v20, s[28:29]
  v_cndmask_b32 v37, 0, v21, s[28:29]
  v_cndmask_b32 v38, 0, v22, s[28:29]
  v_cndmask_b32 v39, 0, v23, s[28:29]
  s_lshl_b64 s[28:29], s[28:29], 1
  s_nop 0
  v_mfma_f32_16x16x32_bf16 v[40:43], v[36:39], v[204:207], v[40:43]
  v_mfma_f32_16x16x32_bf16 v[44:47], v[36:39], v[220:223], v[44:47]
  v_mfma_f32_16x16x32_bf16 v[48:51], v[36:39], v[236:239], v[48:51]
  v_mfma_f32_16x16x32_bf16 v[52:55], v[36:39], v[252:255], v[52:55]
  s_mov_b32 exec_hi, 0
  s_nop 3
  v_or_b32 v40, 1, v40
  v_or_b32 v42, 1, v42
  buffer_store_dwordx4 v[40:43], v3, s[4:7], s26 offen offset:0 sc1
  v_or_b32 v44, 1, v44
  v_or_b32 v46, 1, v46
  buffer_store_dwordx4 v[44:47], v3, s[4:7], s26 offen offset:512 sc1
  v_or_b32 v48, 1, v48
  v_or_b32 v50, 1, v50
  buffer_store_dwordx4 v[48:51], v3, s[4:7], s26 offen offset:1024 sc1
  v_or_b32 v52, 1, v52
  v_or_b32 v54, 1, v54
  buffer_store_dwordx4 v[52:55], v3, s[4:7], s26 offen offset:1536 sc1
  s_mov_b64 exec, -1
  s_branch .g2_kernel_d_e
.g2_kernel_d_none:
  s_sleep 40
.g2_kernel_d_e:
  v_mov_b32 v6, s71
  s_mov_b64 exec, 1
  ds_add_u32 v6, v5 offset:48
  s_mov_b64 exec, -1
  s_cmp_lg_u32 s62, 0
  s_cbranch_scc1 .g2_kernel_fin
  s_mov_b32 s62, 1
  s_mov_b32 s63, 0x1800000
  s_mov_b32 s70, 2
  s_mov_b32 s71, 155776
  s_branch .g2_kernel_v
.g2_kernel_fin1:
.g2_kernel_fin:
.g2_kernel_end:
  s_endpgm
.g2_kernel_q_spin:
  s_mov_b32 s38, 0
.g2_kernel_q_spinl:
  ds_read_b32 v15, v14
  s_add_u32 s38, s38, 1
  s_waitcnt lgkmcnt(0)
  v_cmp_lt_i32 vcc, s33, v15
  s_cbranch_vccnz .g2_kernel_q_spinr
  s_cmp_lt_u32 s38, 524288
  s_cbranch_scc1 .g2_kernel_q_spinl
.g2_kernel_q_spinr:
  s_setpc_b64 s[68:69]
.g2_kernel_q_w7:
  s_call_b64 s[68:69], .g2_kernel_q_spin
  s_branch .g2_kernel_q_back7
.g2_kernel_q_w0:
  s_call_b64 s[68:69], .g2_kernel_q_spin
  s_branch .g2_kernel_q_back0
.g2_kernel_q_w1:
  s_call_b64 s[68:69], .g2_kernel_q_spin
  s_branch .g2_kernel_q_back1
.g2_kernel_q_w2:
  s_call_b64 s[68:69], .g2_kernel_q_spin
  s_branch .g2_kernel_q_back2
.g2_kernel_q_w3:
  s_call_b64 s[68:69], .g2_kernel_q_spin
  s_branch .g2_kernel_q_back3
.g2_kernel_q_w4:
  s_call_b64 s[68:69], .g2_kernel_q_spin
  s_branch .g2_kernel_q_back4
.g2_kernel_q_w5:
  s_call_b64 s[68:69], .g2_kernel_q_spin
  s_branch .g2_kernel_q_back5
.g2_kernel_q_w6:
  s_call_b64 s[68:69], .g2_kernel_q_spin
  s_branch .g2_kernel_q_back6
.g2_kernel_q_cons2:
  s_lshr_b32 s26, s16, 1
  s_lshl_b32 s26, s26, 13
  v_add_u32 v8, s26, v3
  v_add_u32 v9, 1024, v8
  s_mov_b32 s29, 0
  s_branch .g2_kernel_q_cs
.g2_kernel_q_ew:
  s_mov_b32 s38, 0
.g2_kernel_q_ewl:
  ds_read_b32 v62, v57 offset:0
  ds_read_b32 v63, v58
  s_add_u32 s38, s38, 1
  s_waitcnt lgkmcnt(0)
  v_cmp_gt_u32 vcc, 2, v62
  v_cmp_gt_u32 s[20:21], s39, v63
  s_or_b64 vcc, vcc, s[20:21]
  s_cbranch_scc0 .g2_kernel_q_eb
  s_cmp_lt_u32 s38, 524288
  s_cbranch_scc1 .g2_kernel_q_ewl
  s_branch .g2_kernel_q_eb
.g2_kernel_q_patch:
  ds_read_b32 v64, v50 offset:5632
  ds_read_b128 v[72:75], v51 offset:5632
  ds_read_b32 v66, v50 offset:5696
  ds_read_b128 v[76:79], v51 offset:5696
  ds_read_b32 v68, v50 offset:5760
  ds_read_b128 v[80:83], v51 offset:5760
  ds_read_b32 v70, v50 offset:5824
  ds_read_b128 v[84:87], v51 offset:5824
  s_waitcnt lgkmcnt(0)
  ds_read_b128 v[88:91], v52 offset:6144
  ds_read_b128 v[92:95], v52 offset:6208
  ds_read_b128 v[96:99], v52 offset:6400
  ds_read_b128 v[100:103], v52 offset:6464
  ds_read_b32 v104, v53 offset:6656
  ds_read_b32 v106, v53 offset:6720
  s_waitcnt lgkmcnt(0)
  v_pk_fma_f32 v[160:161], v[88:89], v[64:65], v[160:161] op_sel_hi:[1,0,1]
  v_pk_fma_f32 v[162:163], v[90:91], v[64:65], v[162:163] op_sel_hi:[1,0,1]
  v_pk_fma_f32 v[164:165], v[88:89], v[66:67], v[164:165] op_sel_hi:[1,0,1]
  v_pk_fma_f32 v[166:167], v[90:91], v[66:67], v[166:167] op_sel_hi:[1,0,1]
  v_pk_fma_f32 v[168:169], v[88:89], v[68:69], v[168:169] op_sel_hi:[1,0,1]
  v_pk_fma_f32 v[170:171], v[90:91], v[68:69], v[170:171] op_sel_hi:[1,0,1]
  v_pk_fma_f32 v[172:173], v[88:89], v[70:71], v[172:173] op_sel_hi:[1,0,1]
  v_pk_fma_f32 v[174:175], v[90:91], v[70:71], v[174:175] op_sel_hi:[1,0,1]
  v_pk_fma_f32 v[176:177], v[92:93], v[64:65], v[176:177] op_sel_hi:[1,0,1]
  v_pk_fma_f32 v[178:179], v[94:95], v[64:65], v[178:179] op_sel_hi:[1,0,1]
  v_pk_fma_f32 v[180:181], v[92:93], v[66:67], v[180:181] op_sel_hi:[1,0,1]
  v_pk_fma_f32 v[182:183], v[94:95], v[66:67], v[182:183] op_sel_hi:[1,0,1]
  v_pk_fma_f32 v[184:185], v[92:93], v[68:69], v[184:185] op_sel_hi:[1,0,1]
  v_pk_fma_f32 v[186:187], v[94:95], v[68:69], v[186:187] op_sel_hi:[1,0,1]
  v_pk_fma_f32 v[188:189], v[92:93], v[70:71], v[188:189] op_sel_hi:[1,0,1]
  v_pk_fma_f32 v[190:191], v[94:95], v[70:71], v[190:191] op_sel_hi:[1,0,1]
  v_pk_fma_f32 v[192:193], v[96:97], v[64:65], v[192:193] op_sel_hi:[1,0,1]
  v_pk_fma_f32 v[194:195], v[98:99], v[64:65], v[194:195] op_sel_hi:[1,0,1]
  v_pk_fma_f32 v[196:197], v[96:97], v[66:67], v[196:197] op_sel_hi:[1,0,1]
  v_pk_fma_f32 v[198:199], v[98:99], v[66:67], v[198:199] op_sel_hi:[1,0,1]
  v_pk_fma_f32 v[200:201], v[96:97], v[68:69], v[200:201] op_sel_hi:[1,0,1]
  v_pk_fma_f32 v[202:203], v[98:99], v[68:69], v[202:203] op_sel_hi:[1,0,1]
  v_pk_fma_f32 v[204:205], v[96:97], v[70:71], v[204:205] op_sel_hi:[1,0,1]
  v_pk_fma_f32 v[206:207], v[98:99], v[70:71], v[206:207] op_sel_hi:[1,0,1]
  v_pk_fma_f32 v[208:209], v[100:101], v[64:65], v[208:209] op_sel_hi:[1,0,1]
  v_pk_fma_f32 v[210:211], v[102:103], v[64:65], v[210:211] op_sel_hi:[1,0,1]
  v_pk_fma_f32 v[212:213], v[100:101], v[66:67], v[212:213] op_sel_hi:[1,0,1]
  v_pk_fma_f32 v[214:215], v[102:103], v[66:67], v[214:215] op_sel_hi:[1,0,1]
  v_pk_fma_f32 v[216:217], v[100:101], v[68:69], v[216:217] op_sel_hi:[1,0,1]
  v_pk_fma_f32 v[218:219], v[102:103], v[68:69], v[218:219] op_sel_hi:[1,0,1]
  v_pk_fma_f32 v[220:221], v[100:101], v[70:71], v[220:221] op_sel_hi:[1,0,1]
  v_pk_fma_f32 v[222:223], v[102:103], v[70:71], v[222:223] op_sel_hi:[1,0,1]
  v_pk_fma_f32 v[224:225], v[72:73], v[104:105], v[224:225] op_sel_hi:[1,0,1]
  v_pk_fma_f32 v[226:227], v[74:75], v[104:105], v[226:227] op_sel_hi:[1,0,1]
  v_pk_fma_f32 v[228:229], v[76:77], v[104:105], v[228:229] op_sel_hi:[1,0,1]
  v_pk_fma_f32 v[230:231], v[78:79], v[104:105], v[230:231] op_sel_hi:[1,0,1]
  v_pk_fma_f32 v[232:233], v[80:81], v[104:105], v[232:233] op_sel_hi:[1,0,1]
  v_pk_fma_f32 v[234:235], v[82:83], v[104:105], v[234:235] op_sel_hi:[1,0,1]
  v_pk_fma_f32 v[236:237], v[84:85], v[104:105], v[236:237] op_sel_hi:[1,0,1]
  v_pk_fma_f32 v[238:239], v[86:87], v[104:105], v[238:239] op_sel_hi:[1,0,1]
  v_pk_fma_f32 v[240:241], v[72:73], v[106:107], v[240:241] op_sel_hi:[1,0,1]
  v_pk_fma_f32 v[242:243], v[74:75], v[106:107], v[242:243] op_sel_hi:[1,0,1]
  v_pk_fma_f32 v[244:245], v[76:77], v[106:107], v[244:245] op_sel_hi:[1,0,1]
  v_pk_fma_f32 v[246:247], v[78:79], v[106:107], v[246:247] op_sel_hi:[1,0,1]
  v_pk_fma_f32 v[248:249], v[80:81], v[106:107], v[248:249] op_sel_hi:[1,0,1]
  v_pk_fma_f32 v[250:251], v[82:83], v[106:107], v[250:251] op_sel_hi:[1,0,1]
  v_pk_fma_f32 v[252:253], v[84:85], v[106:107], v[252:253] op_sel_hi:[1,0,1]
  v_pk_fma_f32 v[254:255], v[86:87], v[106:107], v[254:255] op_sel_hi:[1,0,1]
  s_branch .g2_kernel_q_pback
.g2_kernel_r2:
  s_lshl_b32 s28, s17, 4
  s_add_u32 s28, s28, s18
  s_lshl_b32 s28, s28, 2
  s_add_u32 s28, s28, s16
  s_lshl_b32 s28, s28, 12
  s_add_u32 s28, s28, 0xc00000
  buffer_load_dwordx4 v[240:243], v22, s[4:7], s28 offen offset:0
  buffer_load_dwordx4 v[244:247], v22, s[4:7], s28 offen offset:512
  buffer_load_dwordx4 v[248:251], v22, s[4:7], s28 offen offset:1024
  buffer_load_dwordx4 v[252:255], v22, s[4:7], s28 offen offset:1536
  s_branch .g2_kernel_r3
.g2_kernel_a_t1c:
  s_call_b64 s[68:69], .g2_kernel_a_pick
  s_branch .g2_kernel_a_t1b
.g2_kernel_a_t2c:
  s_call_b64 s[68:69], .g2_kernel_a_pick
  s_branch .g2_kernel_a_t2b
.g2_kernel_a_t3c:
  s_call_b64 s[68:69], .g2_kernel_a_pick
  s_branch .g2_kernel_a_t3b
.g2_kernel_a_three:
  s_andn2_b32 s33, s36, s34
  s_cbranch_scc0 .g2_kernel_a_t1c
.g2_kernel_a_t1b:
  s_ff1_i32_b32 s33, s33
  s_bitset1_b32 s34, s33
  s_xor_b32 s33, s33, s24
  s_lshl_b32 s33, s33, s25
  s_add_u32 s22, s20, s33
  s_addc_u32 s23, s21, 0
  global_load_dwordx4 v[192:195], v3, s[22:23] offset:0
  global_load_dwordx4 v[196:199], v3, s[22:23] offset:1024
  global_load_dwordx4 v[200:203], v3, s[22:23] offset:2048
  global_load_dwordx4 v[204:207], v3, s[22:23] offset:3072
  s_andn2_b32 s33, s36, s34
  s_cbranch_scc0 .g2_kernel_a_t2c
.g2_kernel_a_t2b:
  s_ff1_i32_b32 s33, s33
  s_bitset1_b32 s34, s33
  s_xor_b32 s33, s33, s24
  s_lshl_b32 s33, s33, s25
  s_add_u32 s22, s20, s33
  s_addc_u32 s23, s21, 0
  global_load_dwordx4 v[208:211], v3, s[22:23] offset:0
  global_load_dwordx4 v[212:215], v3, s[22:23] offset:1024
  global_load_dwordx4 v[216:219], v3, s[22:23] offset:2048
  global_load_dwordx4 v[220:223], v3, s[22:23] offset:3072
  s_andn2_b32 s33, s36, s34
  s_cbranch_scc0 .g2_kernel_a_t3c
.g2_kernel_a_t3b:
  s_ff1_i32_b32 s33, s33
  s_bitset1_b32 s34, s33
  s_xor_b32 s33, s33, s24
  s_lshl_b32 s33, s33, s25
  s_add_u32 s22, s20, s33
  s_addc_u32 s23, s21, 0
  global_load_dwordx4 v[224:227], v3, s[22:23] offset:0
  global_load_dwordx4 v[228:231], v3, s[22:23] offset:1024
  global_load_dwordx4 v[232:235], v3, s[22:23] offset:2048
  global_load_dwordx4 v[236:239], v3, s[22:23] offset:3072
  s_setpc_b64 s[72:73]
.g2_kernel_a_N0c:
  s_call_b64 s[68:69], .g2_kernel_a_pick
  s_branch .g2_kernel_a_N0b
.g2_kernel_a_N1c:
  s_call_b64 s[68:69], .g2_kernel_a_pick
  s_branch .g2_kernel_a_N1b
.g2_kernel_a_N2c:
  s_call_b64 s[68:69], .g2_kernel_a_pick
  s_branch .g2_kernel_a_N2b
.g2_kernel_a_N3c:
  s_call_b64 s[68:69], .g2_kernel_a_pick
  s_branch .g2_kernel_a_N3b
.g2_kernel_a_L3c:
  s_call_b64 s[68:69], .g2_kernel_a_pick
  s_branch .g2_kernel_a_L3b
.g2_kernel_a_G0c:
  s_call_b64 s[68:69], .g2_kernel_a_pick
  s_branch .g2_kernel_a_G0b
.g2_kernel_a_L3g:
  s_mov_b32 s38, 0
.g2_kernel_a_L3gl:
  ds_read_b32 v7, v13 offset:8
  s_add_u32 s38, s38, 1
  s_waitcnt lgkmcnt(0)
  v_cmp_gt_u32 vcc, s27, v7
  s_cbranch_vccz .g2_kernel_a_L3h
  s_cmp_lt_u32 s38, 524288
  s_cbranch_scc1 .g2_kernel_a_L3gl
  s_branch .g2_kernel_a_L3h
.g2_kernel_a_pick:
  s_cmp_lg_u32 s34, -1
  s_cbranch_scc1 .g2_kernel_a_pk1
  s_add_u32 s26, s26, 1
  s_mov_b32 s34, 0xffff
  s_cmp_eq_u32 s26, 1
  s_cbranch_scc1 .g2_kernel_a_pk1
  v_and_b32 v8, 15, v2
  s_lshl_b32 s28, s16, 6
  s_add_u32 s28, s28, 157696
  v_lshl_add_u32 v8, v8, 2, s28
  s_lshl_b32 s28, s17, 2
  s_add_u32 s28, s28, s16
  s_lshl_b32 s28, s28, 16
  s_add_u32 s28, s28, s63
  s_add_u32 s28, s28, 0x800000
  s_add_u32 s20, s60, s28
  s_addc_u32 s21, s61, 0
  s_lshr_b32 s24, s18, 1
  s_mov_b32 s25, 12
  s_mov_b32 s34, 0
  s_mov_b32 s36, 0xff
  s_mov_b32 s33, 0xff
  s_mov_b32 s38, 0
.g2_kernel_a_pk2:
  ds_read_b32 v7, v8
  s_add_u32 s38, s38, 1
  s_waitcnt lgkmcnt(0)
  v_cmp_ge_u32 vcc, s62, v7
  s_cbranch_vccz .g2_kernel_a_pkr
  s_cmp_lt_u32 s38, 524288
  s_cbranch_scc1 .g2_kernel_a_pk2
  s_branch .g2_kernel_a_pkr
.g2_kernel_a_pk1:
  s_mov_b32 s38, 0
.g2_kernel_a_pkl:
  ds_read_b32 v7, v8
  s_add_u32 s38, s38, 1
  s_waitcnt lgkmcnt(0)
  v_cmp_lt_u32 vcc, s62, v7
  s_mov_b32 s36, vcc_lo
  s_andn2_b32 s33, s36, s34
  s_cbranch_scc1 .g2_kernel_a_pkr
  s_cmp_lt_u32 s38, 524288
  s_cbranch_scc1 .g2_kernel_a_pkl
  s_not_b32 s33, s34
.g2_kernel_a_pkr:
  s_setpc_b64 s[68:69]
.g2_kernel_w_aw:
  v_mov_b32 v6, s71
  s_mov_b32 s38, 0
.g2_kernel_wg2:
  ds_read_b32 v7, v6 offset:52
  s_add_u32 s38, s38, 1
  s_waitcnt lgkmcnt(0)
  v_cmp_le_u32 vcc, 4, v7
  s_cbranch_vccnz .g2_kernel_wg2d
  s_sleep 1
  s_cmp_lt_u32 s38, 524288
  s_cbranch_scc1 .g2_kernel_wg2
.g2_kernel_wg2d:
  s_branch .g2_kernel_w_ab
.g2_kernel_w_pt:
  v_lshlrev_b32 v7, 5, v17
  v_add_u32 v7, 155648, v7
  s_mov_b64 exec, vcc
  ds_read_b128 v[240:243], v7 offset:7680
  ds_read_b128 v[244:247], v7 offset:7696
  ds_read_b128 v[248:251], v7 offset:7744
  ds_read_b128 v[252:255], v7 offset:7760
  s_waitcnt lgkmcnt(0)
  v_pk_add_f32 v[24:25], v[24:25], v[240:241]
  v_pk_add_f32 v[26:27], v[26:27], v[242:243]
  v_pk_add_f32 v[28:29], v[28:29], v[244:245]
  v_pk_add_f32 v[30:31], v[30:31], v[246:247]
  v_pk_add_f32 v[32:33], v[32:33], v[248:249]
  v_pk_add_f32 v[34:35], v[34:35], v[250:251]
  v_pk_add_f32 v[36:37], v[36:37], v[252:253]
  v_pk_add_f32 v[38:39], v[38:39], v[254:255]
  ds_read_b128 v[240:243], v7 offset:7808
  ds_read_b128 v[244:247], v7 offset:7824
  ds_read_b128 v[248:251], v7 offset:7872
  ds_read_b128 v[252:255], v7 offset:7888
  s_waitcnt lgkmcnt(0)
  v_pk_add_f32 v[40:41], v[40:41], v[240:241]
  v_pk_add_f32 v[42:43], v[42:43], v[242:243]
  v_pk_add_f32 v[44:45], v[44:45], v[244:245]
  v_pk_add_f32 v[46:47], v[46:47], v[246:247]
  v_pk_add_f32 v[48:49], v[48:49], v[248:249]
  v_pk_add_f32 v[50:51], v[50:51], v[250:251]
  v_pk_add_f32 v[52:53], v[52:53], v[252:253]
  v_pk_add_f32 v[54:55], v[54:55], v[254:255]
  s_mov_b64 exec, -1
  s_branch .g2_kernel_w_pb
.g2_kernel_w_i8c:
  s_call_b64 s[68:69], .g2_kernel_w_pick
  s_branch .g2_kernel_w_i8b
.g2_kernel_w_i9c:
  s_call_b64 s[68:69], .g2_kernel_w_pick
  s_branch .g2_kernel_w_i9b
.g2_kernel_w_i10c:
  s_call_b64 s[68:69], .g2_kernel_w_pick
  s_branch .g2_kernel_w_i10b
.g2_kernel_w_i11c:
  s_call_b64 s[68:69], .g2_kernel_w_pick
  s_branch .g2_kernel_w_i11b
.g2_kernel_w_i12c:
  s_call_b64 s[68:69], .g2_kernel_w_pick
  s_branch .g2_kernel_w_i12b
.g2_kernel_w_i13c:
  s_call_b64 s[68:69], .g2_kernel_w_pick
  s_branch .g2_kernel_w_i13b
.g2_kernel_w_i14c:
  s_call_b64 s[68:69], .g2_kernel_w_pick
  s_branch .g2_kernel_w_i14b
.g2_kernel_w_i15c:
  s_call_b64 s[68:69], .g2_kernel_w_pick
  s_branch .g2_kernel_w_i15b
.g2_kernel_w_bw:
  s_mov_b32 s38, 0
.g2_kernel_w_bwl:
  ds_read_b32 v16, v20 offset:12
  s_add_u32 s38, s38, 1
  s_waitcnt lgkmcnt(0)
  v_cmp_gt_u32 vcc, 4, v16
  s_cbranch_vccz .g2_kernel_w_bb
  s_cmp_lt_u32 s38, 524288
  s_cbranch_scc1 .g2_kernel_w_bwl
  s_branch .g2_kernel_w_bb
.g2_kernel_w_pick:
  s_mov_b32 s38, 0
.g2_kernel_w_pkl:
  ds_read_b64 v[6:7], v21
  s_add_u32 s38, s38, 1
  s_waitcnt lgkmcnt(0)
  v_min_u32 v6, v6, v7
  v_cmp_lt_u32 vcc, s62, v6
  s_and_b32 s36, vcc_lo, 0xff00
  s_andn2_b32 s33, s36, s34
  s_cbranch_scc1 .g2_kernel_w_pkr
  s_cmp_lt_u32 s38, 524288
  s_cbranch_scc1 .g2_kernel_w_pkl
  s_andn2_b32 s33, 0xff00, s34
.g2_kernel_w_pkr:
  s_setpc_b64 s[68:69]
.g2_kernel_p_spin:
  s_mov_b32 s38, 0
.g2_kernel_p_spinl:
  ds_read_b32 v10, v9
  s_add_u32 s38, s38, 1
  s_waitcnt lgkmcnt(0)
  v_cmp_gt_i32 vcc, s34, v10
  s_cbranch_vccz .g2_kernel_p_spinr
  s_sleep 1
  s_cmp_lt_u32 s38, 524288
  s_cbranch_scc1 .g2_kernel_p_spinl
.g2_kernel_p_spinr:
  s_setpc_b64 s[68:69]
.g2_kernel_p1_aw:
  s_call_b64 s[68:69], .g2_kernel_p_spin
  s_branch .g2_kernel_p1_ai
.g2_kernel_p1_bw:
  s_call_b64 s[68:69], .g2_kernel_p_spin
  s_branch .g2_kernel_p1_bi
.g2_kernel_v_may:
  s_cmp_lg_u32 s39, 0
  s_cbranch_scc1 .g2_kernel_v_mr
  s_and_b32 s28, s16, 3
  s_lshl_b32 s28, s28, 4
  s_add_u32 s28, s28, 155968
  v_mov_b32 v6, s28
  ds_read_b32 v7, v6
  s_waitcnt lgkmcnt(0)
  v_cmp_ne_u32 vcc, 0, v7
  s_cbranch_vccz .g2_kernel_v_mr
.g2_kernel_v_do:
  s_mov_b32 s39, 1
  s_mov_b32 s29, 0
  s_call_b64 s[68:69], .g2_kernel_v_cmb
  s_waitcnt vmcnt(0)
  v_mov_b32 v6, s71
  s_mov_b64 exec, 1
  ds_add_u32 v6, v5 offset:8
  s_mov_b64 exec, -1
  s_and_b32 s33, s16, 3
  s_lshl_b32 s33, s33, 2
  s_lshl_b32 s28, s29, 4
  s_add_u32 s33, s33, s28
  s_add_u32 s31, s19, s33
  v_mov_b32 v6, s70
  s_mov_b64 exec, 1
  buffer_store_dword v6, v4, s[4:7], s31 offen offset:0 sc1
  s_mov_b64 exec, -1
.g2_kernel_v_mr:
  s_setpc_b64 s[26:27]
.g2_kernel_v_wo:
  s_mov_b32 s8, s44
  s_mov_b32 s9, s45
  s_mov_b32 s10, 0x200000
  s_mov_b32 s11, 0x00020000
  v_lshrrev_b32 v6, 3, v2
  v_and_b32 v7, 7, v2
  v_bfe_u32 v8, v2, 4, 1
  v_lshlrev_b32 v8, 2, v8
  v_xor_b32 v7, v7, v8
  v_lshlrev_b32 v7, 4, v7
  v_lshl_add_u32 v6, v6, 11, v7
  s_and_b32 s31, s16, 3
  s_lshl_b32 s31, s31, 3
  s_add_u32 s31, s31, s29
  s_lshl_b32 s31, s31, 16
  s_lshl_b32 s33, s18, 7
  s_add_u32 s31, s31, s33
  s_mov_b32 m0, s30
  s_nop 0
  buffer_load_dwordx4 v6, s[8:11], s31 offen lds
  s_add_u32 m0, m0, 1024
  s_add_u32 s31, s31, 16384
  buffer_load_dwordx4 v6, s[8:11], s31 offen lds
  s_add_u32 m0, m0, 1024
  s_add_u32 s31, s31, 16384
  buffer_load_dwordx4 v6, s[8:11], s31 offen lds
  s_add_u32 m0, m0, 1024
  s_add_u32 s31, s31, 16384
  buffer_load_dwordx4 v6, s[8:11], s31 offen lds
  s_add_u32 m0, m0, 1024
  s_add_u32 s31, s31, 81920
  buffer_load_dwordx4 v6, s[8:11], s31 offen lds
  s_add_u32 m0, m0, 1024
  s_add_u32 s31, s31, 16384
  buffer_load_dwordx4 v6, s[8:11], s31 offen lds
  s_add_u32 m0, m0, 1024
  s_add_u32 s31, s31, 16384
  buffer_load_dwordx4 v6, s[8:11], s31 offen lds
  s_add_u32 m0, m0, 1024
  s_add_u32 s31, s31, 16384
  buffer_load_dwordx4 v6, s[8:11], s31 offen lds
  s_add_u32 m0, m0, 1024
  s_add_u32 s31, s31, 81920
  buffer_load_dwordx4 v6, s[8:11], s31 offen lds
  s_add_u32 m0, m0, 1024
  s_add_u32 s31, s31, 16384
  buffer_load_dwordx4 v6, s[8:11], s31 offen lds
  s_add_u32 m0, m0, 1024
  s_add_u32 s31, s31, 16384
  buffer_load_dwordx4 v6, s[8:11], s31 offen lds
  s_add_u32 m0, m0, 1024
  s_add_u32 s31, s31, 16384
  buffer_load_dwordx4 v6, s[8:11], s31 offen lds
  s_add_u32 m0, m0, 1024
  s_add_u32 s31, s31, 81920
  buffer_load_dwordx4 v6, s[8:11], s31 offen lds
  s_add_u32 m0, m0, 1024
  s_add_u32 s31, s31, 16384
  buffer_load_dwordx4 v6, s[8:11], s31 offen lds
  s_add_u32 m0, m0, 1024
  s_add_u32 s31, s31, 16384
  buffer_load_dwordx4 v6, s[8:11], s31 offen lds
  s_add_u32 m0, m0, 1024
  s_add_u32 s31, s31, 16384
  buffer_load_dwordx4 v6, s[8:11], s31 offen lds
  s_setpc_b64 s[68:69]
.g2_kernel_v_cmb:
  s_and_b32 s28, s16, 3
  s_lshl_b32 s30, s28, 4
  s_add_u32 s30, s30, 155968
  v_and_b32 v6, 3, v2
  v_lshl_add_u32 v6, v6, 2, s30
  s_lshl_b32 s30, s28, 14
  v_add_u32 v12, s30, v3
  v_and_b32 v13, 31, v2
  s_lshl_b32 s31, s28, 9
  s_add_u32 s31, s31, 161280
  v_lshl_add_u32 v13, v13, 2, s31
  s_lshl_b32 s33, s62, 1
  s_add_u32 s33, s33, s29
  s_lshl_b32 s31, s17, 2
  s_add_u32 s31, s31, s28
  s_lshl_b32 s31, s31, 1
  s_add_u32 s31, s31, s29
  s_lshl_b32 s31, s31, 4
  s_add_u32 s31, s31, s18
  s_lshl_b32 s31, s31, 11
  s_add_u32 s31, s31, s63
  s_add_u32 s35, s31, 0x800000
  v_mov_b32 v14, 8.673617379884035e-19
  v_mov_b32 v15, 1.152921504606847e+18
  s_mov_b32 s38, 0
.g2_kernel_v_cmbw:
  ds_read_b32 v7, v6
  s_add_u32 s38, s38, 1
  s_waitcnt lgkmcnt(0)
  v_cmp_ge_u32 vcc, s33, v7
  s_cbranch_vccz .g2_kernel_v_cmbd
  v_cmp_lt_u32 vcc, s33, v7
  s_cbranch_vccnz .g2_kernel_v_cmbq
  s_sleep 12
.g2_kernel_v_cmbq:
  s_cmp_lt_u32 s38, 524288
  s_cbranch_scc1 .g2_kernel_v_cmbw
.g2_kernel_v_cmbd:
  s_setprio 3
  ds_read_b128 v[16:19], v12 offset:0
  ds_read_b128 v[20:23], v12 offset:1024
  ds_read_b128 v[24:27], v12 offset:2048
  ds_read_b128 v[28:31], v12 offset:3072
  ds_read_b128 v[32:35], v12 offset:4096
  ds_read_b128 v[36:39], v12 offset:5120
  ds_read_b128 v[40:43], v12 offset:6144
  ds_read_b128 v[44:47], v12 offset:7168
  ds_read_b128 v[48:51], v12 offset:8192
  ds_read_b128 v[52:55], v12 offset:9216
  ds_read_b128 v[56:59], v12 offset:10240
  ds_read_b128 v[60:63], v12 offset:11264
  s_waitcnt lgkmcnt(4)
  ds_read_b32 v8, v13 offset:0
  ds_read_b32 v9, v13 offset:128
  ds_read_b32 v10, v13 offset:256
  ds_read_b32 v11, v13 offset:384
  v_pk_add_f32 v[16:17], v[16:17], v[32:33]
  v_pk_add_f32 v[18:19], v[18:19], v[34:35]
  v_pk_add_f32 v[20:21], v[20:21], v[36:37]
  v_pk_add_f32 v[22:23], v[22:23], v[38:39]
  v_pk_add_f32 v[24:25], v[24:25], v[40:41]
  v_pk_add_f32 v[26:27], v[26:27], v[42:43]
  v_pk_add_f32 v[28:29], v[28:29], v[44:45]
  v_pk_add_f32 v[30:31], v[30:31], v[46:47]
  ds_read_b128 v[32:35], v12 offset:12288
  ds_read_b128 v[36:39], v12 offset:13312
  ds_read_b128 v[40:43], v12 offset:14336
  ds_read_b128 v[44:47], v12 offset:15360
  s_waitcnt lgkmcnt(4)
  v_pk_add_f32 v[16:17], v[16:17], v[48:49]
  v_pk_add_f32 v[18:19], v[18:19], v[50:51]
  v_pk_add_f32 v[20:21], v[20:21], v[52:53]
  v_pk_add_f32 v[22:23], v[22:23], v[54:55]
  v_pk_add_f32 v[24:25], v[24:25], v[56:57]
  v_pk_add_f32 v[26:27], v[26:27], v[58:59]
  v_pk_add_f32 v[28:29], v[28:29], v[60:61]
  v_pk_add_f32 v[30:31], v[30:31], v[62:63]
  v_pk_add_f32 v[8:9], v[8:9], v[10:11]
  v_add_f32 v9, v8, v9
  v_cmp_ge_f32 vcc, v9, v14
  v_cmp_le_f32 s[36:37], v9, v15
  v_rcp_f32 v10, v9
  v_mul_f32 v15, v15, v15
  s_waitcnt lgkmcnt(0)
  v_pk_add_f32 v[16:17], v[16:17], v[32:33]
  v_pk_add_f32 v[18:19], v[18:19], v[34:35]
  v_pk_add_f32 v[20:21], v[20:21], v[36:37]
  v_pk_add_f32 v[22:23], v[22:23], v[38:39]
  v_pk_add_f32 v[24:25], v[24:25], v[40:41]
  v_pk_add_f32 v[26:27], v[26:27], v[42:43]
  v_pk_add_f32 v[28:29], v[28:29], v[44:45]
  v_pk_add_f32 v[30:31], v[30:31], v[46:47]
  s_and_b64 s[36:37], s[36:37], vcc
  v_maximum3_f32 v48, abs(v16), abs(v17), abs(v18)
  v_maximum3_f32 v49, abs(v19), abs(v20), abs(v21)
  v_maximum3_f32 v50, abs(v22), abs(v23), abs(v24)
  v_maximum3_f32 v51, abs(v25), abs(v26), abs(v27)
  v_maximum3_f32 v52, abs(v28), abs(v29), abs(v30)
  v_maximum3_f32 v48, v48, v49, abs(v31)
  v_maximum3_f32 v50, v50, v51, v52
  v_maximum3_f32 v48, v48, v50, v50
  v_cmp_le_f32 vcc, v48, v15
  s_and_b64 vcc, vcc, s[36:37]
  s_cmp_eq_u64 vcc, -1
  s_cbranch_scc0 .g2_kernel_v_cmbslow
.g2_kernel_v_cmbfin:
  v_pk_mul_f32 v[16:17], v[16:17], v[10:11] op_sel_hi:[1,0]
  v_pk_mul_f32 v[18:19], v[18:19], v[10:11] op_sel_hi:[1,0]
  v_pk_mul_f32 v[20:21], v[20:21], v[10:11] op_sel_hi:[1,0]
  v_pk_mul_f32 v[22:23], v[22:23], v[10:11] op_sel_hi:[1,0]
  v_pk_mul_f32 v[24:25], v[24:25], v[10:11] op_sel_hi:[1,0]
  v_pk_mul_f32 v[26:27], v[26:27], v[10:11] op_sel_hi:[1,0]
  v_pk_mul_f32 v[28:29], v[28:29], v[10:11] op_sel_hi:[1,0]
  v_pk_mul_f32 v[30:31], v[30:31], v[10:11] op_sel_hi:[1,0]
  v_cvt_pk_bf16_f32 v32, v16, v17
  v_cvt_pk_bf16_f32 v33, v18, v19
  v_cvt_pk_bf16_f32 v34, v20, v21
  v_cvt_pk_bf16_f32 v35, v22, v23
  buffer_store_dwordx4 v[32:35], v3, s[4:7], s35 offen offset:0 sc1
  v_cvt_pk_bf16_f32 v36, v24, v25
  v_cvt_pk_bf16_f32 v37, v26, v27
  v_cvt_pk_bf16_f32 v38, v28, v29
  v_cvt_pk_bf16_f32 v39, v30, v31
  buffer_store_dwordx4 v[36:39], v3, s[4:7], s35 offen offset:1024 sc1
  s_setprio 3
  s_setpc_b64 s[68:69]
.g2_kernel_v_cmbslow:
  s_setprio 0
  s_lshl_b32 s30, s28, 11
  s_mul_i32 s31, s29, -8192
  s_add_u32 s30, s30, s31
  s_add_u32 s30, s30, 139264
  v_add_u32 v6, s30, v3
  ds_read_b128 v[48:51], v6
  ds_read_b128 v[52:55], v6 offset:1024
  s_lshl_b32 s36, s18, 1
  s_add_u32 s36, s36, s29
  s_lshl_b32 s36, s36, 18
  s_add_u32 s36, s36, s63
  s_mov_b32 s30, s36
  s_mov_b32 s33, 64
  v_mov_b32 v10, 0xff800000
  s_waitcnt lgkmcnt(0)
.g2_kernel_v_cmbs1:
  buffer_load_dwordx4 v[56:59], v3, s[4:7], s30 offen offset:0
  buffer_load_dwordx4 v[60:63], v3, s[4:7], s30 offen offset:1024
  s_waitcnt vmcnt(0)
  v_mfma_f32_32x32x16_bf16 v[32:47], v[56:59], v[48:51], 0
  v_mfma_f32_32x32x16_bf16 v[32:47], v[60:63], v[52:55], v[32:47]
  s_nop 11
  v_max3_f32 v10, v10, v32, v33
  v_max3_f32 v10, v10, v34, v35
  v_max3_f32 v10, v10, v36, v37
  v_max3_f32 v10, v10, v38, v39
  v_max3_f32 v10, v10, v40, v41
  v_max3_f32 v10, v10, v42, v43
  v_max3_f32 v10, v10, v44, v45
  v_max3_f32 v10, v10, v46, v47
  s_add_u32 s30, s30, 4096
  s_sub_u32 s33, s33, 1
  s_cmp_lg_u32 s33, 0
  s_cbranch_scc1 .g2_kernel_v_cmbs1
  v_mov_b32 v11, v10
  s_nop 1
  v_permlane32_swap_b32 v11, v10
  v_max_f32 v10, v10, v11
  v_mov_b32 v9, 0
  v_mov_b32 v16, 0
  v_mov_b32 v17, 0
  v_mov_b32 v18, 0
  v_mov_b32 v19, 0
  v_mov_b32 v20, 0
  v_mov_b32 v21, 0
  v_mov_b32 v22, 0
  v_mov_b32 v23, 0
  v_mov_b32 v24, 0
  v_mov_b32 v25, 0
  v_mov_b32 v26, 0
  v_mov_b32 v27, 0
  v_mov_b32 v28, 0
  v_mov_b32 v29, 0
  v_mov_b32 v30, 0
  v_mov_b32 v31, 0
  s_mov_b32 s30, s36
  s_mov_b32 s33, 64
.g2_kernel_v_cmbs2:
  buffer_load_dwordx4 v[56:59], v3, s[4:7], s30 offen offset:0
  buffer_load_dwordx4 v[60:63], v3, s[4:7], s30 offen offset:1024
  s_waitcnt vmcnt(0)
  v_mfma_f32_32x32x16_bf16 v[32:47], v[56:59], v[48:51], 0
  v_mfma_f32_32x32x16_bf16 v[32:47], v[60:63], v[52:55], v[32:47]
  s_nop 11
  v_sub_f32 v32, v32, v10
  v_sub_f32 v33, v33, v10
  v_sub_f32 v34, v34, v10
  v_sub_f32 v35, v35, v10
  v_sub_f32 v36, v36, v10
  v_sub_f32 v37, v37, v10
  v_sub_f32 v38, v38, v10
  v_sub_f32 v39, v39, v10
  v_sub_f32 v40, v40, v10
  v_sub_f32 v41, v41, v10
  v_sub_f32 v42, v42, v10
  v_sub_f32 v43, v43, v10
  v_sub_f32 v44, v44, v10
  v_sub_f32 v45, v45, v10
  v_sub_f32 v46, v46, v10
  v_sub_f32 v47, v47, v10
  buffer_load_dwordx4 v[56:59], v3, s[4:7], s30 offen offset:2048
  buffer_load_dwordx4 v[60:63], v3, s[4:7], s30 offen offset:3072
  v_exp_f32 v32, v32
  v_exp_f32 v33, v33
  v_exp_f32 v34, v34
  v_exp_f32 v35, v35
  v_exp_f32 v36, v36
  v_exp_f32 v37, v37
  v_exp_f32 v38, v38
  v_exp_f32 v39, v39
  v_exp_f32 v40, v40
  v_exp_f32 v41, v41
  v_exp_f32 v42, v42
  v_exp_f32 v43, v43
  v_exp_f32 v44, v44
  v_exp_f32 v45, v45
  v_exp_f32 v46, v46
  v_exp_f32 v47, v47
  v_add_f32 v9, v9, v32
  v_add_f32 v9, v9, v33
  v_add_f32 v9, v9, v34
  v_add_f32 v9, v9, v35
  v_add_f32 v9, v9, v36
  v_add_f32 v9, v9, v37
  v_add_f32 v9, v9, v38
  v_add_f32 v9, v9, v39
  v_add_f32 v9, v9, v40
  v_add_f32 v9, v9, v41
  v_add_f32 v9, v9, v42
  v_add_f32 v9, v9, v43
  v_add_f32 v9, v9, v44
  v_add_f32 v9, v9, v45
  v_add_f32 v9, v9, v46
  v_add_f32 v9, v9, v47
  v_cvt_pk_bf16_f32 v32, v32, v33
  v_cvt_pk_bf16_f32 v33, v34, v35
  v_cvt_pk_bf16_f32 v34, v36, v37
  v_cvt_pk_bf16_f32 v35, v38, v39
  v_cvt_pk_bf16_f32 v36, v40, v41
  v_cvt_pk_bf16_f32 v37, v42, v43
  v_cvt_pk_bf16_f32 v38, v44, v45
  v_cvt_pk_bf16_f32 v39, v46, v47
  s_waitcnt vmcnt(0)
  v_mfma_f32_32x32x16_bf16 v[16:31], v[56:59], v[32:35], v[16:31]
  v_mfma_f32_32x32x16_bf16 v[16:31], v[60:63], v[36:39], v[16:31]
  s_nop 15
  s_add_u32 s30, s30, 4096
  s_sub_u32 s33, s33, 1
  s_cmp_lg_u32 s33, 0
  s_cbranch_scc1 .g2_kernel_v_cmbs2
  v_mov_b32 v11, v9
  s_nop 1
  v_permlane32_swap_b32 v11, v9
  v_add_f32 v9, v9, v11
  v_rcp_f32 v10, v9
  s_branch .g2_kernel_v_cmbfin
.g2_kernel_p2_xw:
  s_mov_b32 s38, 0
.g2_kernel_p2_xwl:
  ds_read_b32 v12, v11
  s_add_u32 s38, s38, 1
  s_waitcnt lgkmcnt(0)
  v_cmp_ne_u32 vcc, 0, v12
  s_and_b32 s37, vcc_lo, vcc_hi
  s_lshr_b32 s33, s37, 16
  s_and_b32 s37, s37, s33
  s_bitcmp1_b32 s37, s28
  s_cbranch_scc1 .g2_kernel_p2_xwr
  s_sleep 1
  s_cmp_lt_u32 s38, 524288
  s_cbranch_scc1 .g2_kernel_p2_xwl
.g2_kernel_p2_xwr:
  s_setpc_b64 s[68:69]
.g2_kernel_p2_x0w:
  s_call_b64 s[68:69], .g2_kernel_p2_xw
  s_branch .g2_kernel_p2_x0b
.g2_kernel_p2_x1w:
  s_call_b64 s[68:69], .g2_kernel_p2_xw
  s_branch .g2_kernel_p2_x1b
.g2_kernel_p2_x2w:
  s_call_b64 s[68:69], .g2_kernel_p2_xw
  s_branch .g2_kernel_p2_x2b
.g2_kernel_p2_aw:
  s_call_b64 s[68:69], .g2_kernel_p_spin
  s_branch .g2_kernel_p2_ai
.g2_kernel_p2_x3w:
  s_call_b64 s[68:69], .g2_kernel_p2_xw
  s_branch .g2_kernel_p2_x3b
.g2_kernel_p2_bw:
  s_call_b64 s[68:69], .g2_kernel_p_spin
  s_branch .g2_kernel_p2_bi
  .p2align 8
.g2_kernel_tab:
  .long 0, 1, 2, 3, 4, 5, 6, 7
  .long 8, 9, 10, 11, 12, 13, 14, 15
  .long 16, 17, 18, 19, 20, 21, 22, 23
  .long 24, 25, 26, 27, 28, 29, 30, 31
  .long 32, 33, 34, 35, 36, 37, 38, 39
  .long 40, 41, 42, 43, 44, 45, 46, 47
  .long 48, 49, 50, 51, 52, 53, 54, 55
  .long 56, 57, 58, 59, 60, 61, 62, 63
  .long 64, 65, 66, 67, 68, 69, 70, 71
.g2_kernel_cend:

.section .rodata,"a"
.p2align 6
.amdhsa_kernel g2_kernel
  .amdhsa_next_free_vgpr 256
  .amdhsa_next_free_sgpr 102
  .amdhsa_accum_offset 256
  .amdhsa_group_segment_fixed_size 0
  .amdhsa_kernarg_size 88
  .amdhsa_user_sgpr_count 2
  .amdhsa_user_sgpr_kernarg_segment_ptr 1
  .amdhsa_system_sgpr_workgroup_id_x 1
.end_amdhsa_kernel
```

```asm
; @launch kernel=g2_kernel grid=(256,1,1) block=(512,1,1) lds=163840
.amdgcn_target "amdgcn-amd-amdhsa--gfx950"
.text
.globl g2_kernel
.p2align 8
.type g2_kernel,@function
g2_kernel:
  s_cmp_ge_u32 s2, 256
  s_cbranch_scc1 .g2_kernel_end
  s_load_dwordx16 s[40:55], s[0:1], 0
  s_load_dwordx4 s[56:59], s[0:1], 64
  s_load_dwordx2 s[60:61], s[0:1], 80
  s_getpc_b64 s[64:65]
.g2_kernel_pc:
  s_mov_b32 s66, .g2_kernel_cend-.g2_kernel_pc
  s_mov_b32 s67, 0x00020000
  s_lshl_b32 s12, s2, 10
  s_and_b32 s12, s12, 0xe000
  v_lshrrev_b32 v3, 3, v0
  v_and_b32 v2, 7, v0
  v_and_b32 v3, 0x38, v3
  v_add_lshl_u32 v3, v3, v2, 7
  s_mov_b64 exec, 0xff
  buffer_load_dword v1, v3, s[64:67], s12 offen
  s_mov_b64 exec, -1
  v_lshrrev_b32 v3, 6, v0
  v_and_b32 v2, 63, v0
  v_readfirstlane_b32 s16, v3
  s_and_b32 s21, s2, 7
  s_lshr_b32 s22, s2, 3
  s_and_b32 s23, s21, 3
  s_lshl_b32 s23, s23, 2
  s_and_b32 s24, s22, 3
  s_add_u32 s18, s23, s24
  s_lshr_b32 s24, s21, 2
  s_lshl_b32 s24, s24, 3
  s_lshr_b32 s25, s22, 2
  s_add_u32 s17, s24, s25
  s_lshl_b32 s19, s17, 4
  s_add_u32 s19, s19, s18
  s_lshl_b32 s19, s19, 9
  s_add_u32 s19, s19, 0x3000000
  s_lshl_b32 s76, s18, 4
  s_add_u32 s76, s76, s17
  s_lshl_b32 s76, s76, 9
  s_add_u32 s76, s76, 0x3020000
  v_lshlrev_b32 v3, 4, v2
  v_mov_b32 v4, 0
  v_mov_b32 v5, 1
  s_mov_b32 s62, 0
  s_mov_b32 s63, 0
  s_mov_b32 s70, 1
  s_mov_b32 s71, 155648
  s_waitcnt lgkmcnt(0)
  s_mov_b32 s4, s60
  s_mov_b32 s5, s61
  s_mov_b32 s6, 0x3200000
  s_mov_b32 s7, 0x00020000
  s_cmp_ge_u32 s16, 4
  s_cbranch_scc1 .g2_kernel_svc
  v_mov_b32 v20, 0
  v_mov_b32 v21, 0
  v_mov_b32 v22, 0
  v_mov_b32 v23, 0
  v_lshlrev_b32 v24, 4, v0
  v_cmp_gt_u32 vcc, 2816, v24
  v_add_u32 v24, 155648, v24
  s_and_saveexec_b64 s[20:21], vcc
  s_cbranch_execz .g2_kernel_q_nz
  ds_write_b128 v24, v[20:23]
.g2_kernel_q_nz:
  s_mov_b64 exec, -1
  v_and_b32 v20, 15, v2
  v_lshrrev_b32 v21, 4, v2
  v_lshrrev_b32 v22, 1, v20
  v_xor_b32 v22, v22, v21
  v_lshlrev_b32 v22, 4, v22
  v_lshl_add_u32 v22, v20, 7, v22
  s_lshr_b32 s26, s16, 1
  s_lshl_b32 s26, s26, 13
  v_add_u32 v8, s26, v22
  v_xor_b32 v9, 64, v8
  s_mov_b32 s29, 0
  s_mov_b32 s31, .g2_kernel_tab-.g2_kernel_pc
  s_mov_b32 s33, -64
  s_mov_b32 m0, 151552
  s_waitcnt lgkmcnt(0)
  s_barrier
.g2_kernel_q_cs:
  s_and_b32 s27, s16, 1
  v_bfe_u32 v20, v2, 2, 2
  v_lshrrev_b32 v21, 4, v2
  v_lshl_add_u32 v22, v21, 3, v20
  v_lshlrev_b32 v22, 7, v22
  v_lshrrev_b32 v23, 1, v20
  v_and_b32 v21, 1, v21
  v_xor_b32 v21, s27, v21
  v_lshl_add_u32 v23, v21, 1, v23
  v_lshl_add_u32 v22, v23, 5, v22
  v_and_b32 v23, 3, v2
  v_lshl_add_u32 v22, v23, 3, v22
  v_add_u32 v12, 65536, v22
  v_xor_b32 v13, 32, v12
  v_mov_b32 v10, v12
  v_mov_b32 v11, v13
  v_mov_b32 v14, 156160
  v_mov_b32 v15, 0
  s_mov_b32 s30, 0
  s_cmp_lt_i32 s29, 0
  s_cbranch_scc0 .g2_kernel_q_init
  .p2align 6
.g2_kernel_q_loop:
  s_waitcnt lgkmcnt(0)
  v_mfma_f32_16x16x32_bf16 v[160:163], v[120:123], v[104:107], v[160:163]
  v_cmp_lt_i32 vcc, s33, v15
  v_mfma_f32_16x16x32_bf16 v[164:167], v[120:123], v[108:111], v[164:167]
  s_cbranch_vccz .g2_kernel_q_w7
.g2_kernel_q_back7:
  v_mfma_f32_16x16x32_bf16 v[168:171], v[120:123], v[112:115], v[168:171]
  ds_read_b64_tr_b16 v[80:81], v10 offset:0
  v_mfma_f32_16x16x32_bf16 v[172:175], v[120:123], v[116:119], v[172:175]
  ds_read_b64_tr_b16 v[82:83], v10 offset:512
  v_mfma_f32_16x16x32_bf16 v[188:191], v[124:127], v[116:119], v[188:191]
  ds_read_b128 v[64:67], v8 offset:0
  v_mfma_f32_16x16x32_bf16 v[184:187], v[124:127], v[112:115], v[184:187]
  ds_read_b128 v[68:71], v8 offset:2048
  v_mfma_f32_16x16x32_bf16 v[180:183], v[124:127], v[108:111], v[180:183]
  ds_read_b128 v[72:75], v8 offset:4096
  v_mfma_f32_16x16x32_bf16 v[176:179], v[124:127], v[104:107], v[176:179]
  ds_read_b128 v[76:79], v8 offset:6144
  v_mfma_f32_16x16x32_bf16 v[192:195], v[128:131], v[104:107], v[192:195]
  ds_read_b64_tr_b16 v[84:85], v11 offset:0
  v_mfma_f32_16x16x32_bf16 v[196:199], v[128:131], v[108:111], v[196:199]
  ds_read_b64_tr_b16 v[86:87], v11 offset:512
  v_mfma_f32_16x16x32_bf16 v[200:203], v[128:131], v[112:115], v[200:203]
  ds_read_b64_tr_b16 v[88:89], v10 offset:4096
  v_mfma_f32_16x16x32_bf16 v[204:207], v[128:131], v[116:119], v[204:207]
  ds_read_b64_tr_b16 v[90:91], v10 offset:4608
  v_mfma_f32_16x16x32_bf16 v[220:223], v[132:135], v[116:119], v[220:223]
  ds_read_b64_tr_b16 v[92:93], v11 offset:4096
  v_mfma_f32_16x16x32_bf16 v[216:219], v[132:135], v[112:115], v[216:219]
  ds_read_b64_tr_b16 v[94:95], v11 offset:4608
  v_mfma_f32_16x16x32_bf16 v[212:215], v[132:135], v[108:111], v[212:215]
  ds_read_b64_tr_b16 v[96:97], v10 offset:8192
  v_mfma_f32_16x16x32_bf16 v[208:211], v[132:135], v[104:107], v[208:211]
  ds_read_b64_tr_b16 v[98:99], v10 offset:8704
  v_mfma_f32_16x16x32_bf16 v[224:227], v[104:107], v[136:139], v[224:227]
  ds_read_b64_tr_b16 v[100:101], v11 offset:8192
  v_mfma_f32_16x16x32_bf16 v[228:231], v[108:111], v[136:139], v[228:231]
  ds_read_b64_tr_b16 v[102:103], v11 offset:8704
  v_mfma_f32_16x16x32_bf16 v[232:235], v[112:115], v[136:139], v[232:235]
  ds_read_b32 v15, v14
  s_add_u32 s30, s30, 12288
  v_mfma_f32_16x16x32_bf16 v[236:239], v[116:119], v[136:139], v[236:239]
  buffer_load_dword off, s[64:67], s31 lds
  s_cmp_eq_u32 s30, 86016
  v_mfma_f32_16x16x32_bf16 v[252:255], v[116:119], v[140:143], v[252:255]
  s_cselect_b32 s30, 0, s30
  s_add_u32 s31, s31, 4
  v_mfma_f32_16x16x32_bf16 v[248:251], v[112:115], v[140:143], v[248:251]
  v_add_u32 v10, s30, v12
  s_add_u32 s33, s33, 1
  v_mfma_f32_16x16x32_bf16 v[244:247], v[108:111], v[140:143], v[244:247]
  v_add_u32 v11, s30, v13
  v_mfma_f32_16x16x32_bf16 v[240:243], v[104:107], v[140:143], v[240:243]
  s_waitcnt lgkmcnt(0)
  v_mfma_f32_16x16x32_bf16 v[160:163], v[80:83], v[64:67], v[160:163]
  v_cmp_lt_i32 vcc, s33, v15
  v_mfma_f32_16x16x32_bf16 v[164:167], v[80:83], v[68:71], v[164:167]
  s_cbranch_vccz .g2_kernel_q_w0
.g2_kernel_q_back0:
  v_mfma_f32_16x16x32_bf16 v[168:171], v[80:83], v[72:75], v[168:171]
  ds_read_b64_tr_b16 v[120:121], v10 offset:0
  v_mfma_f32_16x16x32_bf16 v[172:175], v[80:83], v[76:79], v[172:175]
  ds_read_b64_tr_b16 v[122:123], v10 offset:512
  v_mfma_f32_16x16x32_bf16 v[188:191], v[84:87], v[76:79], v[188:191]
  ds_read_b128 v[104:107], v9 offset:0
  v_mfma_f32_16x16x32_bf16 v[184:187], v[84:87], v[72:75], v[184:187]
  ds_read_b128 v[108:111], v9 offset:2048
  v_mfma_f32_16x16x32_bf16 v[180:183], v[84:87], v[68:71], v[180:183]
  ds_read_b128 v[112:115], v9 offset:4096
  v_mfma_f32_16x16x32_bf16 v[176:179], v[84:87], v[64:67], v[176:179]
  ds_read_b128 v[116:119], v9 offset:6144
  v_mfma_f32_16x16x32_bf16 v[192:195], v[88:91], v[64:67], v[192:195]
  ds_read_b64_tr_b16 v[124:125], v11 offset:0
  v_mfma_f32_16x16x32_bf16 v[196:199], v[88:91], v[68:71], v[196:199]
  ds_read_b64_tr_b16 v[126:127], v11 offset:512
  v_mfma_f32_16x16x32_bf16 v[200:203], v[88:91], v[72:75], v[200:203]
  ds_read_b64_tr_b16 v[128:129], v10 offset:4096
  v_mfma_f32_16x16x32_bf16 v[204:207], v[88:91], v[76:79], v[204:207]
  ds_read_b64_tr_b16 v[130:131], v10 offset:4608
  v_mfma_f32_16x16x32_bf16 v[220:223], v[92:95], v[76:79], v[220:223]
  ds_read_b64_tr_b16 v[132:133], v11 offset:4096
  v_mfma_f32_16x16x32_bf16 v[216:219], v[92:95], v[72:75], v[216:219]
  ds_read_b64_tr_b16 v[134:135], v11 offset:4608
  v_mfma_f32_16x16x32_bf16 v[212:215], v[92:95], v[68:71], v[212:215]
  ds_read_b64_tr_b16 v[136:137], v10 offset:8192
  v_mfma_f32_16x16x32_bf16 v[208:211], v[92:95], v[64:67], v[208:211]
  ds_read_b64_tr_b16 v[138:139], v10 offset:8704
  v_mfma_f32_16x16x32_bf16 v[224:227], v[64:67], v[96:99], v[224:227]
  ds_read_b64_tr_b16 v[140:141], v11 offset:8192
  v_mfma_f32_16x16x32_bf16 v[228:231], v[68:71], v[96:99], v[228:231]
  ds_read_b64_tr_b16 v[142:143], v11 offset:8704
  v_mfma_f32_16x16x32_bf16 v[232:235], v[72:75], v[96:99], v[232:235]
  ds_read_b32 v15, v14
  s_add_u32 s30, s30, 12288
  v_mfma_f32_16x16x32_bf16 v[236:239], v[76:79], v[96:99], v[236:239]
  buffer_load_dword off, s[64:67], s31 lds
  s_cmp_eq_u32 s30, 86016
  v_mfma_f32_16x16x32_bf16 v[252:255], v[76:79], v[100:103], v[252:255]
  s_cselect_b32 s30, 0, s30
  s_add_u32 s31, s31, 4
  v_mfma_f32_16x16x32_bf16 v[248:251], v[72:75], v[100:103], v[248:251]
  v_add_u32 v10, s30, v12
  s_add_u32 s33, s33, 1
  v_mfma_f32_16x16x32_bf16 v[244:247], v[68:71], v[100:103], v[244:247]
  v_add_u32 v11, s30, v13
  v_mfma_f32_16x16x32_bf16 v[240:243], v[64:67], v[100:103], v[240:243]
.g2_kernel_q_s1:
  s_waitcnt lgkmcnt(0)
  v_mfma_f32_16x16x32_bf16 v[160:163], v[120:123], v[104:107], v[160:163]
  v_cmp_lt_i32 vcc, s33, v15
  v_mfma_f32_16x16x32_bf16 v[164:167], v[120:123], v[108:111], v[164:167]
  s_cbranch_vccz .g2_kernel_q_w1
.g2_kernel_q_back1:
  v_mfma_f32_16x16x32_bf16 v[168:171], v[120:123], v[112:115], v[168:171]
  ds_read_b64_tr_b16 v[80:81], v10 offset:0
  v_mfma_f32_16x16x32_bf16 v[172:175], v[120:123], v[116:119], v[172:175]
  ds_read_b64_tr_b16 v[82:83], v10 offset:512
  v_mfma_f32_16x16x32_bf16 v[188:191], v[124:127], v[116:119], v[188:191]
  ds_read_b128 v[64:67], v8 offset:16384
  v_mfma_f32_16x16x32_bf16 v[184:187], v[124:127], v[112:115], v[184:187]
  ds_read_b128 v[68:71], v8 offset:18432
  v_mfma_f32_16x16x32_bf16 v[180:183], v[124:127], v[108:111], v[180:183]
  ds_read_b128 v[72:75], v8 offset:20480
  v_mfma_f32_16x16x32_bf16 v[176:179], v[124:127], v[104:107], v[176:179]
  ds_read_b128 v[76:79], v8 offset:22528
  v_mfma_f32_16x16x32_bf16 v[192:195], v[128:131], v[104:107], v[192:195]
  ds_read_b64_tr_b16 v[84:85], v11 offset:0
  v_mfma_f32_16x16x32_bf16 v[196:199], v[128:131], v[108:111], v[196:199]
  ds_read_b64_tr_b16 v[86:87], v11 offset:512
  v_mfma_f32_16x16x32_bf16 v[200:203], v[128:131], v[112:115], v[200:203]
  ds_read_b64_tr_b16 v[88:89], v10 offset:4096
  v_mfma_f32_16x16x32_bf16 v[204:207], v[128:131], v[116:119], v[204:207]
  ds_read_b64_tr_b16 v[90:91], v10 offset:4608
  v_mfma_f32_16x16x32_bf16 v[220:223], v[132:135], v[116:119], v[220:223]
  ds_read_b64_tr_b16 v[92:93], v11 offset:4096
  v_mfma_f32_16x16x32_bf16 v[216:219], v[132:135], v[112:115], v[216:219]
  ds_read_b64_tr_b16 v[94:95], v11 offset:4608
  v_mfma_f32_16x16x32_bf16 v[212:215], v[132:135], v[108:111], v[212:215]
  ds_read_b64_tr_b16 v[96:97], v10 offset:8192
  v_mfma_f32_16x16x32_bf16 v[208:211], v[132:135], v[104:107], v[208:211]
  ds_read_b64_tr_b16 v[98:99], v10 offset:8704
  v_mfma_f32_16x16x32_bf16 v[224:227], v[104:107], v[136:139], v[224:227]
  ds_read_b64_tr_b16 v[100:101], v11 offset:8192
  v_mfma_f32_16x16x32_bf16 v[228:231], v[108:111], v[136:139], v[228:231]
  ds_read_b64_tr_b16 v[102:103], v11 offset:8704
  v_mfma_f32_16x16x32_bf16 v[232:235], v[112:115], v[136:139], v[232:235]
  ds_read_b32 v15, v14
  s_add_u32 s30, s30, 12288
  v_mfma_f32_16x16x32_bf16 v[236:239], v[116:119], v[136:139], v[236:239]
  buffer_load_dword off, s[64:67], s31 lds
  s_cmp_eq_u32 s30, 86016
  v_mfma_f32_16x16x32_bf16 v[252:255], v[116:119], v[140:143], v[252:255]
  s_cselect_b32 s30, 0, s30
  s_add_u32 s31, s31, 4
  v_mfma_f32_16x16x32_bf16 v[248:251], v[112:115], v[140:143], v[248:251]
  v_add_u32 v10, s30, v12
  s_add_u32 s33, s33, 1
  v_mfma_f32_16x16x32_bf16 v[244:247], v[108:111], v[140:143], v[244:247]
  v_add_u32 v11, s30, v13
  v_mfma_f32_16x16x32_bf16 v[240:243], v[104:107], v[140:143], v[240:243]
  s_waitcnt lgkmcnt(0)
  v_mfma_f32_16x16x32_bf16 v[160:163], v[80:83], v[64:67], v[160:163]
  v_cmp_lt_i32 vcc, s33, v15
  v_mfma_f32_16x16x32_bf16 v[164:167], v[80:83], v[68:71], v[164:167]
  s_cbranch_vccz .g2_kernel_q_w2
.g2_kernel_q_back2:
  v_mfma_f32_16x16x32_bf16 v[168:171], v[80:83], v[72:75], v[168:171]
  ds_read_b64_tr_b16 v[120:121], v10 offset:0
  v_mfma_f32_16x16x32_bf16 v[172:175], v[80:83], v[76:79], v[172:175]
  ds_read_b64_tr_b16 v[122:123], v10 offset:512
  v_mfma_f32_16x16x32_bf16 v[188:191], v[84:87], v[76:79], v[188:191]
  ds_read_b128 v[104:107], v9 offset:16384
  v_mfma_f32_16x16x32_bf16 v[184:187], v[84:87], v[72:75], v[184:187]
  ds_read_b128 v[108:111], v9 offset:18432
  v_mfma_f32_16x16x32_bf16 v[180:183], v[84:87], v[68:71], v[180:183]
  ds_read_b128 v[112:115], v9 offset:20480
  v_mfma_f32_16x16x32_bf16 v[176:179], v[84:87], v[64:67], v[176:179]
  ds_read_b128 v[116:119], v9 offset:22528
  v_mfma_f32_16x16x32_bf16 v[192:195], v[88:91], v[64:67], v[192:195]
  ds_read_b64_tr_b16 v[124:125], v11 offset:0
  v_mfma_f32_16x16x32_bf16 v[196:199], v[88:91], v[68:71], v[196:199]
  ds_read_b64_tr_b16 v[126:127], v11 offset:512
  v_mfma_f32_16x16x32_bf16 v[200:203], v[88:91], v[72:75], v[200:203]
  ds_read_b64_tr_b16 v[128:129], v10 offset:4096
  v_mfma_f32_16x16x32_bf16 v[204:207], v[88:91], v[76:79], v[204:207]
  ds_read_b64_tr_b16 v[130:131], v10 offset:4608
  v_mfma_f32_16x16x32_bf16 v[220:223], v[92:95], v[76:79], v[220:223]
  ds_read_b64_tr_b16 v[132:133], v11 offset:4096
  v_mfma_f32_16x16x32_bf16 v[216:219], v[92:95], v[72:75], v[216:219]
  ds_read_b64_tr_b16 v[134:135], v11 offset:4608
  v_mfma_f32_16x16x32_bf16 v[212:215], v[92:95], v[68:71], v[212:215]
  ds_read_b64_tr_b16 v[136:137], v10 offset:8192
  v_mfma_f32_16x16x32_bf16 v[208:211], v[92:95], v[64:67], v[208:211]
  ds_read_b64_tr_b16 v[138:139], v10 offset:8704
  v_mfma_f32_16x16x32_bf16 v[224:227], v[64:67], v[96:99], v[224:227]
  ds_read_b64_tr_b16 v[140:141], v11 offset:8192
  v_mfma_f32_16x16x32_bf16 v[228:231], v[68:71], v[96:99], v[228:231]
  ds_read_b64_tr_b16 v[142:143], v11 offset:8704
  v_mfma_f32_16x16x32_bf16 v[232:235], v[72:75], v[96:99], v[232:235]
  ds_read_b32 v15, v14
  s_add_u32 s30, s30, 12288
  v_mfma_f32_16x16x32_bf16 v[236:239], v[76:79], v[96:99], v[236:239]
  buffer_load_dword off, s[64:67], s31 lds
  s_cmp_eq_u32 s30, 86016
  v_mfma_f32_16x16x32_bf16 v[252:255], v[76:79], v[100:103], v[252:255]
  s_cselect_b32 s30, 0, s30
  s_add_u32 s31, s31, 4
  v_mfma_f32_16x16x32_bf16 v[248:251], v[72:75], v[100:103], v[248:251]
  v_add_u32 v10, s30, v12
  s_add_u32 s33, s33, 1
  v_mfma_f32_16x16x32_bf16 v[244:247], v[68:71], v[100:103], v[244:247]
  v_add_u32 v11, s30, v13
  v_mfma_f32_16x16x32_bf16 v[240:243], v[64:67], v[100:103], v[240:243]
  s_waitcnt lgkmcnt(0)
  v_mfma_f32_16x16x32_bf16 v[160:163], v[120:123], v[104:107], v[160:163]
  v_cmp_lt_i32 vcc, s33, v15
  v_mfma_f32_16x16x32_bf16 v[164:167], v[120:123], v[108:111], v[164:167]
  s_cbranch_vccz .g2_kernel_q_w3
.g2_kernel_q_back3:
  v_mfma_f32_16x16x32_bf16 v[168:171], v[120:123], v[112:115], v[168:171]
  ds_read_b64_tr_b16 v[80:81], v10 offset:0
  v_mfma_f32_16x16x32_bf16 v[172:175], v[120:123], v[116:119], v[172:175]
  ds_read_b64_tr_b16 v[82:83], v10 offset:512
  v_mfma_f32_16x16x32_bf16 v[188:191], v[124:127], v[116:119], v[188:191]
  ds_read_b128 v[64:67], v8 offset:32768
  v_mfma_f32_16x16x32_bf16 v[184:187], v[124:127], v[112:115], v[184:187]
  ds_read_b128 v[68:71], v8 offset:34816
  v_mfma_f32_16x16x32_bf16 v[180:183], v[124:127], v[108:111], v[180:183]
  ds_read_b128 v[72:75], v8 offset:36864
  v_mfma_f32_16x16x32_bf16 v[176:179], v[124:127], v[104:107], v[176:179]
  ds_read_b128 v[76:79], v8 offset:38912
  v_mfma_f32_16x16x32_bf16 v[192:195], v[128:131], v[104:107], v[192:195]
  ds_read_b64_tr_b16 v[84:85], v11 offset:0
  v_mfma_f32_16x16x32_bf16 v[196:199], v[128:131], v[108:111], v[196:199]
  ds_read_b64_tr_b16 v[86:87], v11 offset:512
  v_mfma_f32_16x16x32_bf16 v[200:203], v[128:131], v[112:115], v[200:203]
  ds_read_b64_tr_b16 v[88:89], v10 offset:4096
  v_mfma_f32_16x16x32_bf16 v[204:207], v[128:131], v[116:119], v[204:207]
  ds_read_b64_tr_b16 v[90:91], v10 offset:4608
  v_mfma_f32_16x16x32_bf16 v[220:223], v[132:135], v[116:119], v[220:223]
  ds_read_b64_tr_b16 v[92:93], v11 offset:4096
  v_mfma_f32_16x16x32_bf16 v[216:219], v[132:135], v[112:115], v[216:219]
  ds_read_b64_tr_b16 v[94:95], v11 offset:4608
  v_mfma_f32_16x16x32_bf16 v[212:215], v[132:135], v[108:111], v[212:215]
  ds_read_b64_tr_b16 v[96:97], v10 offset:8192
  v_mfma_f32_16x16x32_bf16 v[208:211], v[132:135], v[104:107], v[208:211]
  ds_read_b64_tr_b16 v[98:99], v10 offset:8704
  v_mfma_f32_16x16x32_bf16 v[224:227], v[104:107], v[136:139], v[224:227]
  ds_read_b64_tr_b16 v[100:101], v11 offset:8192
  v_mfma_f32_16x16x32_bf16 v[228:231], v[108:111], v[136:139], v[228:231]
  ds_read_b64_tr_b16 v[102:103], v11 offset:8704
  v_mfma_f32_16x16x32_bf16 v[232:235], v[112:115], v[136:139], v[232:235]
  ds_read_b32 v15, v14
  s_add_u32 s30, s30, 12288
  v_mfma_f32_16x16x32_bf16 v[236:239], v[116:119], v[136:139], v[236:239]
  buffer_load_dword off, s[64:67], s31 lds
  s_cmp_eq_u32 s30, 86016
  v_mfma_f32_16x16x32_bf16 v[252:255], v[116:119], v[140:143], v[252:255]
  s_cselect_b32 s30, 0, s30
  s_add_u32 s31, s31, 4
  v_mfma_f32_16x16x32_bf16 v[248:251], v[112:115], v[140:143], v[248:251]
  v_add_u32 v10, s30, v12
  s_add_u32 s33, s33, 1
  v_mfma_f32_16x16x32_bf16 v[244:247], v[108:111], v[140:143], v[244:247]
  v_add_u32 v11, s30, v13
  v_mfma_f32_16x16x32_bf16 v[240:243], v[104:107], v[140:143], v[240:243]
  s_waitcnt lgkmcnt(0)
  v_mfma_f32_16x16x32_bf16 v[160:163], v[80:83], v[64:67], v[160:163]
  v_cmp_lt_i32 vcc, s33, v15
  v_mfma_f32_16x16x32_bf16 v[164:167], v[80:83], v[68:71], v[164:167]
  s_cbranch_vccz .g2_kernel_q_w4
.g2_kernel_q_back4:
  v_mfma_f32_16x16x32_bf16 v[168:171], v[80:83], v[72:75], v[168:171]
  ds_read_b64_tr_b16 v[120:121], v10 offset:0
  v_mfma_f32_16x16x32_bf16 v[172:175], v[80:83], v[76:79], v[172:175]
  ds_read_b64_tr_b16 v[122:123], v10 offset:512
  v_mfma_f32_16x16x32_bf16 v[188:191], v[84:87], v[76:79], v[188:191]
  ds_read_b128 v[104:107], v9 offset:32768
  v_mfma_f32_16x16x32_bf16 v[184:187], v[84:87], v[72:75], v[184:187]
  ds_read_b128 v[108:111], v9 offset:34816
  v_mfma_f32_16x16x32_bf16 v[180:183], v[84:87], v[68:71], v[180:183]
  ds_read_b128 v[112:115], v9 offset:36864
  v_mfma_f32_16x16x32_bf16 v[176:179], v[84:87], v[64:67], v[176:179]
  ds_read_b128 v[116:119], v9 offset:38912
  v_mfma_f32_16x16x32_bf16 v[192:195], v[88:91], v[64:67], v[192:195]
  ds_read_b64_tr_b16 v[124:125], v11 offset:0
  v_mfma_f32_16x16x32_bf16 v[196:199], v[88:91], v[68:71], v[196:199]
  ds_read_b64_tr_b16 v[126:127], v11 offset:512
  v_mfma_f32_16x16x32_bf16 v[200:203], v[88:91], v[72:75], v[200:203]
  ds_read_b64_tr_b16 v[128:129], v10 offset:4096
  v_mfma_f32_16x16x32_bf16 v[204:207], v[88:91], v[76:79], v[204:207]
  ds_read_b64_tr_b16 v[130:131], v10 offset:4608
  v_mfma_f32_16x16x32_bf16 v[220:223], v[92:95], v[76:79], v[220:223]
  ds_read_b64_tr_b16 v[132:133], v11 offset:4096
  v_mfma_f32_16x16x32_bf16 v[216:219], v[92:95], v[72:75], v[216:219]
  ds_read_b64_tr_b16 v[134:135], v11 offset:4608
  v_mfma_f32_16x16x32_bf16 v[212:215], v[92:95], v[68:71], v[212:215]
  ds_read_b64_tr_b16 v[136:137], v10 offset:8192
  v_mfma_f32_16x16x32_bf16 v[208:211], v[92:95], v[64:67], v[208:211]
  ds_read_b64_tr_b16 v[138:139], v10 offset:8704
  v_mfma_f32_16x16x32_bf16 v[224:227], v[64:67], v[96:99], v[224:227]
  ds_read_b64_tr_b16 v[140:141], v11 offset:8192
  v_mfma_f32_16x16x32_bf16 v[228:231], v[68:71], v[96:99], v[228:231]
  ds_read_b64_tr_b16 v[142:143], v11 offset:8704
  v_mfma_f32_16x16x32_bf16 v[232:235], v[72:75], v[96:99], v[232:235]
  ds_read_b32 v15, v14
  s_add_u32 s30, s30, 12288
  v_mfma_f32_16x16x32_bf16 v[236:239], v[76:79], v[96:99], v[236:239]
  buffer_load_dword off, s[64:67], s31 lds
  s_cmp_eq_u32 s30, 86016
  v_mfma_f32_16x16x32_bf16 v[252:255], v[76:79], v[100:103], v[252:255]
  s_cselect_b32 s30, 0, s30
  s_add_u32 s31, s31, 4
  v_mfma_f32_16x16x32_bf16 v[248:251], v[72:75], v[100:103], v[248:251]
  v_add_u32 v10, s30, v12
  s_add_u32 s33, s33, 1
  v_mfma_f32_16x16x32_bf16 v[244:247], v[68:71], v[100:103], v[244:247]
  v_add_u32 v11, s30, v13
  v_mfma_f32_16x16x32_bf16 v[240:243], v[64:67], v[100:103], v[240:243]
  s_waitcnt lgkmcnt(0)
  v_mfma_f32_16x16x32_bf16 v[160:163], v[120:123], v[104:107], v[160:163]
  v_cmp_lt_i32 vcc, s33, v15
  v_mfma_f32_16x16x32_bf16 v[164:167], v[120:123], v[108:111], v[164:167]
  s_cbranch_vccz .g2_kernel_q_w5
.g2_kernel_q_back5:
  v_mfma_f32_16x16x32_bf16 v[168:171], v[120:123], v[112:115], v[168:171]
  ds_read_b64_tr_b16 v[80:81], v10 offset:0
  v_mfma_f32_16x16x32_bf16 v[172:175], v[120:123], v[116:119], v[172:175]
  ds_read_b64_tr_b16 v[82:83], v10 offset:512
  v_mfma_f32_16x16x32_bf16 v[188:191], v[124:127], v[116:119], v[188:191]
  ds_read_b128 v[64:67], v8 offset:49152
  v_mfma_f32_16x16x32_bf16 v[184:187], v[124:127], v[112:115], v[184:187]
  ds_read_b128 v[68:71], v8 offset:51200
  v_mfma_f32_16x16x32_bf16 v[180:183], v[124:127], v[108:111], v[180:183]
  ds_read_b128 v[72:75], v8 offset:53248
  v_mfma_f32_16x16x32_bf16 v[176:179], v[124:127], v[104:107], v[176:179]
  ds_read_b128 v[76:79], v8 offset:55296
  v_mfma_f32_16x16x32_bf16 v[192:195], v[128:131], v[104:107], v[192:195]
  ds_read_b64_tr_b16 v[84:85], v11 offset:0
  v_mfma_f32_16x16x32_bf16 v[196:199], v[128:131], v[108:111], v[196:199]
  ds_read_b64_tr_b16 v[86:87], v11 offset:512
  v_mfma_f32_16x16x32_bf16 v[200:203], v[128:131], v[112:115], v[200:203]
  ds_read_b64_tr_b16 v[88:89], v10 offset:4096
  v_mfma_f32_16x16x32_bf16 v[204:207], v[128:131], v[116:119], v[204:207]
  ds_read_b64_tr_b16 v[90:91], v10 offset:4608
  v_mfma_f32_16x16x32_bf16 v[220:223], v[132:135], v[116:119], v[220:223]
  ds_read_b64_tr_b16 v[92:93], v11 offset:4096
  v_mfma_f32_16x16x32_bf16 v[216:219], v[132:135], v[112:115], v[216:219]
  ds_read_b64_tr_b16 v[94:95], v11 offset:4608
  v_mfma_f32_16x16x32_bf16 v[212:215], v[132:135], v[108:111], v[212:215]
  ds_read_b64_tr_b16 v[96:97], v10 offset:8192
  v_mfma_f32_16x16x32_bf16 v[208:211], v[132:135], v[104:107], v[208:211]
  ds_read_b64_tr_b16 v[98:99], v10 offset:8704
  v_mfma_f32_16x16x32_bf16 v[224:227], v[104:107], v[136:139], v[224:227]
  ds_read_b64_tr_b16 v[100:101], v11 offset:8192
  v_mfma_f32_16x16x32_bf16 v[228:231], v[108:111], v[136:139], v[228:231]
  ds_read_b64_tr_b16 v[102:103], v11 offset:8704
  v_mfma_f32_16x16x32_bf16 v[232:235], v[112:115], v[136:139], v[232:235]
  ds_read_b32 v15, v14
  s_add_u32 s30, s30, 12288
  v_mfma_f32_16x16x32_bf16 v[236:239], v[116:119], v[136:139], v[236:239]
  buffer_load_dword off, s[64:67], s31 lds
  s_cmp_eq_u32 s30, 86016
  v_mfma_f32_16x16x32_bf16 v[252:255], v[116:119], v[140:143], v[252:255]
  s_cselect_b32 s30, 0, s30
  s_add_u32 s31, s31, 4
  v_mfma_f32_16x16x32_bf16 v[248:251], v[112:115], v[140:143], v[248:251]
  v_add_u32 v10, s30, v12
  s_add_u32 s33, s33, 1
  v_mfma_f32_16x16x32_bf16 v[244:247], v[108:111], v[140:143], v[244:247]
  v_add_u32 v11, s30, v13
  v_mfma_f32_16x16x32_bf16 v[240:243], v[104:107], v[140:143], v[240:243]
  s_waitcnt lgkmcnt(0)
  v_mfma_f32_16x16x32_bf16 v[160:163], v[80:83], v[64:67], v[160:163]
  v_cmp_lt_i32 vcc, s33, v15
  v_mfma_f32_16x16x32_bf16 v[164:167], v[80:83], v[68:71], v[164:167]
  s_cbranch_vccz .g2_kernel_q_w6
.g2_kernel_q_back6:
  v_mfma_f32_16x16x32_bf16 v[168:171], v[80:83], v[72:75], v[168:171]
  ds_read_b64_tr_b16 v[120:121], v10 offset:0
  v_mfma_f32_16x16x32_bf16 v[172:175], v[80:83], v[76:79], v[172:175]
  ds_read_b64_tr_b16 v[122:123], v10 offset:512
  v_mfma_f32_16x16x32_bf16 v[188:191], v[84:87], v[76:79], v[188:191]
  ds_read_b128 v[104:107], v9 offset:49152
  v_mfma_f32_16x16x32_bf16 v[184:187], v[84:87], v[72:75], v[184:187]
  ds_read_b128 v[108:111], v9 offset:51200
  v_mfma_f32_16x16x32_bf16 v[180:183], v[84:87], v[68:71], v[180:183]
  ds_read_b128 v[112:115], v9 offset:53248
  v_mfma_f32_16x16x32_bf16 v[176:179], v[84:87], v[64:67], v[176:179]
  ds_read_b128 v[116:119], v9 offset:55296
  v_mfma_f32_16x16x32_bf16 v[192:195], v[88:91], v[64:67], v[192:195]
  ds_read_b64_tr_b16 v[124:125], v11 offset:0
  v_mfma_f32_16x16x32_bf16 v[196:199], v[88:91], v[68:71], v[196:199]
  ds_read_b64_tr_b16 v[126:127], v11 offset:512
  v_mfma_f32_16x16x32_bf16 v[200:203], v[88:91], v[72:75], v[200:203]
  ds_read_b64_tr_b16 v[128:129], v10 offset:4096
  v_mfma_f32_16x16x32_bf16 v[204:207], v[88:91], v[76:79], v[204:207]
  ds_read_b64_tr_b16 v[130:131], v10 offset:4608
  v_mfma_f32_16x16x32_bf16 v[220:223], v[92:95], v[76:79], v[220:223]
  ds_read_b64_tr_b16 v[132:133], v11 offset:4096
  v_mfma_f32_16x16x32_bf16 v[216:219], v[92:95], v[72:75], v[216:219]
  ds_read_b64_tr_b16 v[134:135], v11 offset:4608
  v_mfma_f32_16x16x32_bf16 v[212:215], v[92:95], v[68:71], v[212:215]
  ds_read_b64_tr_b16 v[136:137], v10 offset:8192
  v_mfma_f32_16x16x32_bf16 v[208:211], v[92:95], v[64:67], v[208:211]
  ds_read_b64_tr_b16 v[138:139], v10 offset:8704
  v_mfma_f32_16x16x32_bf16 v[224:227], v[64:67], v[96:99], v[224:227]
  ds_read_b64_tr_b16 v[140:141], v11 offset:8192
  v_mfma_f32_16x16x32_bf16 v[228:231], v[68:71], v[96:99], v[228:231]
  ds_read_b64_tr_b16 v[142:143], v11 offset:8704
  v_mfma_f32_16x16x32_bf16 v[232:235], v[72:75], v[96:99], v[232:235]
  ds_read_b32 v15, v14
  s_add_u32 s30, s30, 12288
  v_mfma_f32_16x16x32_bf16 v[236:239], v[76:79], v[96:99], v[236:239]
  buffer_load_dword off, s[64:67], s31 lds
  s_cmp_eq_u32 s30, 86016
  v_mfma_f32_16x16x32_bf16 v[252:255], v[76:79], v[100:103], v[252:255]
  s_cselect_b32 s30, 0, s30
  s_add_u32 s31, s31, 4
  v_mfma_f32_16x16x32_bf16 v[248:251], v[72:75], v[100:103], v[248:251]
  v_add_u32 v10, s30, v12
  s_add_u32 s33, s33, 1
  v_mfma_f32_16x16x32_bf16 v[244:247], v[68:71], v[100:103], v[244:247]
  v_add_u32 v11, s30, v13
  s_add_u32 s29, s29, 1
  v_mfma_f32_16x16x32_bf16 v[240:243], v[64:67], v[100:103], v[240:243]
  s_and_b32 s28, s29, 3
  s_cbranch_scc1 .g2_kernel_q_loop
  s_cmp_lg_u32 s29, 0
  s_cbranch_scc1 .g2_kernel_q_last
  s_waitcnt lgkmcnt(0)
.g2_kernel_q_init:
  s_lshl_b32 s28, s16, 8
  s_add_u32 m0, s28, 156416
  s_lshl_b32 s33, s62, 5
  s_lshl_b32 s31, s33, 2
  s_add_u32 s31, s31, .g2_kernel_tab-.g2_kernel_pc+4
  v_mov_b32 v10, v12
  v_mov_b32 v11, v13
  s_mov_b32 s29, 0
  s_call_b64 s[68:69], .g2_kernel_q_spin
  ds_read_b64_tr_b16 v[80:81], v10 offset:0
  ds_read_b64_tr_b16 v[82:83], v10 offset:512
  ds_read_b128 v[64:67], v8 offset:0
  ds_read_b128 v[68:71], v8 offset:2048
  ds_read_b128 v[72:75], v8 offset:4096
  ds_read_b128 v[76:79], v8 offset:6144
  ds_read_b64_tr_b16 v[84:85], v11 offset:0
  ds_read_b64_tr_b16 v[86:87], v11 offset:512
  ds_read_b64_tr_b16 v[88:89], v10 offset:4096
  ds_read_b64_tr_b16 v[90:91], v10 offset:4608
  ds_read_b64_tr_b16 v[92:93], v11 offset:4096
  ds_read_b64_tr_b16 v[94:95], v11 offset:4608
  ds_read_b64_tr_b16 v[96:97], v10 offset:8192
  ds_read_b64_tr_b16 v[98:99], v10 offset:8704
  ds_read_b64_tr_b16 v[100:101], v11 offset:8192
  ds_read_b64_tr_b16 v[102:103], v11 offset:8704
  s_mov_b32 s30, 12288
  s_add_u32 s33, s33, 1
  v_add_u32 v10, s30, v12
  v_add_u32 v11, s30, v13
  s_waitcnt lgkmcnt(0)
  v_mfma_f32_16x16x32_bf16 v[160:163], v[80:83], v[64:67], 0
  v_cmp_lt_i32 vcc, s33, v15
  v_mfma_f32_16x16x32_bf16 v[164:167], v[80:83], v[68:71], 0
  s_cbranch_vccz .g2_kernel_q_wf
.g2_kernel_q_backf:
  v_mfma_f32_16x16x32_bf16 v[168:171], v[80:83], v[72:75], 0
  ds_read_b64_tr_b16 v[120:121], v10 offset:0
  v_mfma_f32_16x16x32_bf16 v[172:175], v[80:83], v[76:79], 0
  ds_read_b64_tr_b16 v[122:123], v10 offset:512
  v_mfma_f32_16x16x32_bf16 v[188:191], v[84:87], v[76:79], 0
  ds_read_b128 v[104:107], v9 offset:0
  v_mfma_f32_16x16x32_bf16 v[184:187], v[84:87], v[72:75], 0
  ds_read_b128 v[108:111], v9 offset:2048
  v_mfma_f32_16x16x32_bf16 v[180:183], v[84:87], v[68:71], 0
  ds_read_b128 v[112:115], v9 offset:4096
  v_mfma_f32_16x16x32_bf16 v[176:179], v[84:87], v[64:67], 0
  ds_read_b128 v[116:119], v9 offset:6144
  v_mfma_f32_16x16x32_bf16 v[192:195], v[88:91], v[64:67], 0
  ds_read_b64_tr_b16 v[124:125], v11 offset:0
  v_mfma_f32_16x16x32_bf16 v[196:199], v[88:91], v[68:71], 0
  ds_read_b64_tr_b16 v[126:127], v11 offset:512
  v_mfma_f32_16x16x32_bf16 v[200:203], v[88:91], v[72:75], 0
  ds_read_b64_tr_b16 v[128:129], v10 offset:4096
  v_mfma_f32_16x16x32_bf16 v[204:207], v[88:91], v[76:79], 0
  ds_read_b64_tr_b16 v[130:131], v10 offset:4608
  v_mfma_f32_16x16x32_bf16 v[220:223], v[92:95], v[76:79], 0
  ds_read_b64_tr_b16 v[132:133], v11 offset:4096
  v_mfma_f32_16x16x32_bf16 v[216:219], v[92:95], v[72:75], 0
  ds_read_b64_tr_b16 v[134:135], v11 offset:4608
  v_mfma_f32_16x16x32_bf16 v[212:215], v[92:95], v[68:71], 0
  ds_read_b64_tr_b16 v[136:137], v10 offset:8192
  v_mfma_f32_16x16x32_bf16 v[208:211], v[92:95], v[64:67], 0
  ds_read_b64_tr_b16 v[138:139], v10 offset:8704
  v_mfma_f32_16x16x32_bf16 v[224:227], v[64:67], v[96:99], 0
  ds_read_b64_tr_b16 v[140:141], v11 offset:8192
  v_mfma_f32_16x16x32_bf16 v[228:231], v[68:71], v[96:99], 0
  ds_read_b64_tr_b16 v[142:143], v11 offset:8704
  v_mfma_f32_16x16x32_bf16 v[232:235], v[72:75], v[96:99], 0
  ds_read_b32 v15, v14
  s_add_u32 s30, s30, 12288
  v_mfma_f32_16x16x32_bf16 v[236:239], v[76:79], v[96:99], 0
  buffer_load_dword off, s[64:67], s31 lds
  s_cmp_eq_u32 s30, 86016
  v_mfma_f32_16x16x32_bf16 v[252:255], v[76:79], v[100:103], 0
  s_cselect_b32 s30, 0, s30
  s_add_u32 s31, s31, 4
  v_mfma_f32_16x16x32_bf16 v[248:251], v[72:75], v[100:103], 0
  v_add_u32 v10, s30, v12
  s_add_u32 s33, s33, 1
  v_mfma_f32_16x16x32_bf16 v[244:247], v[68:71], v[100:103], 0
  v_add_u32 v11, s30, v13
  v_mfma_f32_16x16x32_bf16 v[240:243], v[64:67], v[100:103], 0
  s_branch .g2_kernel_q_s1
.g2_kernel_q_last:
  v_and_b32 v48, 15, v2
  v_lshrrev_b32 v49, 4, v2
  s_lshr_b32 s26, s16, 1
  s_lshl_b32 s28, s26, 8
  s_add_u32 s28, s28, 155648
  v_lshl_add_u32 v50, v48, 2, s28
  v_lshl_add_u32 v51, v49, 4, s28
  s_lshl_b32 s28, s27, 7
  s_add_u32 s28, s28, 155648
  v_lshl_add_u32 v52, v49, 4, s28
  v_lshl_add_u32 v53, v48, 2, s28
  v_lshlrev_b32 v54, 9, v49
  v_lshl_add_u32 v55, v48, 4, v54
  v_and_b32 v56, 8, v48
  v_lshl_add_u32 v54, v56, 4, v55
  v_mov_b32 v57, s71
  v_lshlrev_b32 v58, 8, v2
  v_and_b32 v58, 0x300, v58
  v_add_u32 v58, 156416, v58
  s_lshl_b32 s34, s18, 1
  s_add_u32 s34, s34, s27
  s_lshl_b32 s34, s34, 6
  s_lshl_b32 s35, s17, 2
  s_add_u32 s34, s34, s35
  s_lshl_b32 s35, s26, 1
  s_add_u32 s34, s34, s35
  s_lshl_b32 s34, s34, 12
  s_add_u32 s34, s34, s63
  s_add_u32 s35, s34, 4096
  s_lshl_b32 s28, s26, 13
  v_add_u32 v59, s28, v54
  v_add_u32 v60, s28, v55
  s_lshl_b32 s28, s26, 12
  s_mul_i32 s36, s27, -8192
  s_add_u32 s28, s28, s36
  s_add_u32 s28, s28, 139264
  v_add_u32 v61, s28, v55
  s_sub_u32 s36, s27, 1
  s_mov_b32 s37, s36
  s_lshl_b32 s39, s62, 5
  s_add_u32 s39, s39, 28
  s_waitcnt lgkmcnt(0)
  v_mfma_f32_16x16x32_bf16 v[160:163], v[120:123], v[104:107], v[160:163]
  buffer_load_dword off, s[64:67], s31 lds
  v_mfma_f32_16x16x32_bf16 v[164:167], v[120:123], v[108:111], v[164:167]
  v_mfma_f32_16x16x32_bf16 v[168:171], v[120:123], v[112:115], v[168:171]
  v_mfma_f32_16x16x32_bf16 v[172:175], v[120:123], v[116:119], v[172:175]
  v_mfma_f32_16x16x32_bf16 v[188:191], v[124:127], v[116:119], v[188:191]
  v_mfma_f32_16x16x32_bf16 v[184:187], v[124:127], v[112:115], v[184:187]
  v_mfma_f32_16x16x32_bf16 v[180:183], v[124:127], v[108:111], v[180:183]
  v_mfma_f32_16x16x32_bf16 v[176:179], v[124:127], v[104:107], v[176:179]
  v_mfma_f32_16x16x32_bf16 v[192:195], v[128:131], v[104:107], v[192:195]
  v_mfma_f32_16x16x32_bf16 v[196:199], v[128:131], v[108:111], v[196:199]
  v_mfma_f32_16x16x32_bf16 v[200:203], v[128:131], v[112:115], v[200:203]
  v_mfma_f32_16x16x32_bf16 v[204:207], v[128:131], v[116:119], v[204:207]
  v_mfma_f32_16x16x32_bf16 v[220:223], v[132:135], v[116:119], v[220:223]
  v_mfma_f32_16x16x32_bf16 v[216:219], v[132:135], v[112:115], v[216:219]
  v_mfma_f32_16x16x32_bf16 v[212:215], v[132:135], v[108:111], v[212:215]
  v_mfma_f32_16x16x32_bf16 v[208:211], v[132:135], v[104:107], v[208:211]
  v_mfma_f32_16x16x32_bf16 v[224:227], v[104:107], v[136:139], v[224:227]
  v_mfma_f32_16x16x32_bf16 v[228:231], v[108:111], v[136:139], v[228:231]
  v_mfma_f32_16x16x32_bf16 v[232:235], v[112:115], v[136:139], v[232:235]
  v_mfma_f32_16x16x32_bf16 v[236:239], v[116:119], v[136:139], v[236:239]
  v_mfma_f32_16x16x32_bf16 v[252:255], v[116:119], v[140:143], v[252:255]
  v_mfma_f32_16x16x32_bf16 v[248:251], v[112:115], v[140:143], v[248:251]
  v_mfma_f32_16x16x32_bf16 v[244:247], v[108:111], v[140:143], v[244:247]
  v_mfma_f32_16x16x32_bf16 v[240:243], v[104:107], v[140:143], v[240:243]
  ds_read_b32 v62, v57 offset:0
  ds_read_b32 v63, v58
  s_waitcnt lgkmcnt(0)
  v_cmp_gt_u32 vcc, 2, v62
  v_cmp_gt_u32 s[20:21], s39, v63
  s_or_b64 vcc, vcc, s[20:21]
  s_cbranch_scc1 .g2_kernel_q_ew
.g2_kernel_q_eb:
  ds_read_b32 v62, v57 offset:24
  ds_read_b128 v[32:35], v52 offset:5120
  ds_read_b128 v[36:39], v52 offset:5184
  ds_read_b32 v16, v50 offset:2816
  ds_read_b32 v17, v50 offset:3328
  ds_read_b32 v18, v50 offset:2880
  ds_read_b32 v19, v50 offset:3392
  ds_read_b32 v20, v50 offset:2944
  ds_read_b32 v21, v50 offset:3456
  ds_read_b32 v22, v50 offset:3008
  ds_read_b32 v23, v50 offset:3520
  s_waitcnt lgkmcnt(10)
  v_cmp_ne_u32 vcc, 0, v62
  s_cbranch_vccnz .g2_kernel_q_patch
.g2_kernel_q_pback:
  s_waitcnt lgkmcnt(6)
  v_pk_mul_f32 v[144:145], v[32:33], v[16:17] op_sel:[0,1] op_sel_hi:[1,1]
  v_pk_mul_f32 v[146:147], v[34:35], v[16:17] op_sel:[0,1] op_sel_hi:[1,1]
  v_pk_mul_f32 v[148:149], v[36:37], v[16:17] op_sel:[0,1] op_sel_hi:[1,1]
  v_pk_mul_f32 v[150:151], v[38:39], v[16:17] op_sel:[0,1] op_sel_hi:[1,1]
  v_pk_fma_f32 v[192:193], v[192:193], v[16:17], v[144:145] op_sel_hi:[1,0,1]
  v_pk_fma_f32 v[194:195], v[194:195], v[16:17], v[146:147] op_sel_hi:[1,0,1]
  v_pk_fma_f32 v[208:209], v[208:209], v[16:17], v[148:149] op_sel_hi:[1,0,1]
  v_pk_fma_f32 v[210:211], v[210:211], v[16:17], v[150:151] op_sel_hi:[1,0,1]
  v_cvt_pk_bf16_f32 v192, v192, v193
  v_cvt_pk_bf16_f32 v193, v194, v195
  v_cvt_pk_bf16_f32 v194, v208, v209
  v_cvt_pk_bf16_f32 v195, v210, v211
  buffer_store_dwordx4 v[192:195], v54, s[4:7], s34 offen offset:0 sc1
  ds_read_b128 v[64:67], v51 offset:2816
  ds_read_b128 v[80:83], v51 offset:3328
  ds_read_b32 v40, v53 offset:5376
  s_waitcnt lgkmcnt(7)
  v_pk_mul_f32 v[144:145], v[32:33], v[18:19] op_sel:[0,1] op_sel_hi:[1,1]
  v_pk_mul_f32 v[146:147], v[34:35], v[18:19] op_sel:[0,1] op_sel_hi:[1,1]
  v_pk_mul_f32 v[148:149], v[36:37], v[18:19] op_sel:[0,1] op_sel_hi:[1,1]
  v_pk_mul_f32 v[150:151], v[38:39], v[18:19] op_sel:[0,1] op_sel_hi:[1,1]
  v_pk_fma_f32 v[196:197], v[196:197], v[18:19], v[144:145] op_sel_hi:[1,0,1]
  v_pk_fma_f32 v[198:199], v[198:199], v[18:19], v[146:147] op_sel_hi:[1,0,1]
  v_pk_fma_f32 v[212:213], v[212:213], v[18:19], v[148:149] op_sel_hi:[1,0,1]
  v_pk_fma_f32 v[214:215], v[214:215], v[18:19], v[150:151] op_sel_hi:[1,0,1]
  v_cvt_pk_bf16_f32 v196, v196, v197
  v_cvt_pk_bf16_f32 v197, v198, v199
  v_cvt_pk_bf16_f32 v198, v212, v213
  v_cvt_pk_bf16_f32 v199, v214, v215
  buffer_store_dwordx4 v[196:199], v54, s[4:7], s34 offen offset:128 sc1
  ds_read_b128 v[68:71], v51 offset:2880
  ds_read_b128 v[84:87], v51 offset:3392
  ds_read_b32 v42, v53 offset:5440
  s_waitcnt lgkmcnt(8)
  v_pk_mul_f32 v[144:145], v[32:33], v[20:21] op_sel:[0,1] op_sel_hi:[1,1]
  v_pk_mul_f32 v[146:147], v[34:35], v[20:21] op_sel:[0,1] op_sel_hi:[1,1]
  v_pk_mul_f32 v[148:149], v[36:37], v[20:21] op_sel:[0,1] op_sel_hi:[1,1]
  v_pk_mul_f32 v[150:151], v[38:39], v[20:21] op_sel:[0,1] op_sel_hi:[1,1]
  v_pk_fma_f32 v[200:201], v[200:201], v[20:21], v[144:145] op_sel_hi:[1,0,1]
  v_pk_fma_f32 v[202:203], v[202:203], v[20:21], v[146:147] op_sel_hi:[1,0,1]
  v_pk_fma_f32 v[216:217], v[216:217], v[20:21], v[148:149] op_sel_hi:[1,0,1]
  v_pk_fma_f32 v[218:219], v[218:219], v[20:21], v[150:151] op_sel_hi:[1,0,1]
  v_cvt_pk_bf16_f32 v200, v200, v201
  v_cvt_pk_bf16_f32 v201, v202, v203
  v_cvt_pk_bf16_f32 v202, v216, v217
  v_cvt_pk_bf16_f32 v203, v218, v219
  buffer_store_dwordx4 v[200:203], v54, s[4:7], s35 offen offset:0 sc1
  ds_read_b128 v[72:75], v51 offset:2944
  ds_read_b128 v[88:91], v51 offset:3456
  ds_read_b128 v[24:27], v52 offset:4864
  s_waitcnt lgkmcnt(9)
  v_pk_mul_f32 v[144:145], v[32:33], v[22:23] op_sel:[0,1] op_sel_hi:[1,1]
  v_pk_mul_f32 v[146:147], v[34:35], v[22:23] op_sel:[0,1] op_sel_hi:[1,1]
  v_pk_mul_f32 v[148:149], v[36:37], v[22:23] op_sel:[0,1] op_sel_hi:[1,1]
  v_pk_mul_f32 v[150:151], v[38:39], v[22:23] op_sel:[0,1] op_sel_hi:[1,1]
  v_pk_fma_f32 v[204:205], v[204:205], v[22:23], v[144:145] op_sel_hi:[1,0,1]
  v_pk_fma_f32 v[206:207], v[206:207], v[22:23], v[146:147] op_sel_hi:[1,0,1]
  v_pk_fma_f32 v[220:221], v[220:221], v[22:23], v[148:149] op_sel_hi:[1,0,1]
  v_pk_fma_f32 v[222:223], v[222:223], v[22:23], v[150:151] op_sel_hi:[1,0,1]
  v_cvt_pk_bf16_f32 v204, v204, v205
  v_cvt_pk_bf16_f32 v205, v206, v207
  v_cvt_pk_bf16_f32 v206, v220, v221
  v_cvt_pk_bf16_f32 v207, v222, v223
  buffer_store_dwordx4 v[204:207], v54, s[4:7], s35 offen offset:128 sc1
  ds_read_b128 v[76:79], v51 offset:3008
  ds_read_b128 v[92:95], v51 offset:3520
  ds_read_b128 v[28:31], v52 offset:4928
  s_waitcnt lgkmcnt(0)
  v_pk_mul_f32 v[144:145], v[80:81], v[40:41] op_sel_hi:[1,0]
  v_pk_mul_f32 v[146:147], v[82:83], v[40:41] op_sel_hi:[1,0]
  v_pk_mul_f32 v[148:149], v[84:85], v[40:41] op_sel_hi:[1,0]
  v_pk_mul_f32 v[150:151], v[86:87], v[40:41] op_sel_hi:[1,0]
  v_pk_fma_f32 v[224:225], v[224:225], v[64:65], v[144:145]
  v_pk_fma_f32 v[226:227], v[226:227], v[66:67], v[146:147]
  v_pk_fma_f32 v[228:229], v[228:229], v[68:69], v[148:149]
  v_pk_fma_f32 v[230:231], v[230:231], v[70:71], v[150:151]
  v_cvt_pk_bf16_f32 v224, v224, v225
  v_cvt_pk_bf16_f32 v225, v226, v227
  v_cvt_pk_bf16_f32 v226, v228, v229
  v_cvt_pk_bf16_f32 v227, v230, v231
  buffer_store_dwordx4 v[224:227], v55, s[4:7], s34 offen offset:2048 sc1
  v_pk_mul_f32 v[144:145], v[80:81], v[42:43] op_sel_hi:[1,0]
  v_pk_mul_f32 v[146:147], v[82:83], v[42:43] op_sel_hi:[1,0]
  v_pk_mul_f32 v[148:149], v[84:85], v[42:43] op_sel_hi:[1,0]
  v_pk_mul_f32 v[150:151], v[86:87], v[42:43] op_sel_hi:[1,0]
  v_pk_fma_f32 v[240:241], v[240:241], v[64:65], v[144:145]
  v_pk_fma_f32 v[242:243], v[242:243], v[66:67], v[146:147]
  v_pk_fma_f32 v[244:245], v[244:245], v[68:69], v[148:149]
  v_pk_fma_f32 v[246:247], v[246:247], v[70:71], v[150:151]
  v_cvt_pk_bf16_f32 v240, v240, v241
  v_cvt_pk_bf16_f32 v241, v242, v243
  v_cvt_pk_bf16_f32 v242, v244, v245
  v_cvt_pk_bf16_f32 v243, v246, v247
  buffer_store_dwordx4 v[240:243], v55, s[4:7], s34 offen offset:2304 sc1
  v_pk_mul_f32 v[144:145], v[88:89], v[40:41] op_sel_hi:[1,0]
  v_pk_mul_f32 v[146:147], v[90:91], v[40:41] op_sel_hi:[1,0]
  v_pk_mul_f32 v[148:149], v[92:93], v[40:41] op_sel_hi:[1,0]
  v_pk_mul_f32 v[150:151], v[94:95], v[40:41] op_sel_hi:[1,0]
  v_pk_fma_f32 v[232:233], v[232:233], v[72:73], v[144:145]
  v_pk_fma_f32 v[234:235], v[234:235], v[74:75], v[146:147]
  v_pk_fma_f32 v[236:237], v[236:237], v[76:77], v[148:149]
  v_pk_fma_f32 v[238:239], v[238:239], v[78:79], v[150:151]
  v_cvt_pk_bf16_f32 v232, v232, v233
  v_cvt_pk_bf16_f32 v233, v234, v235
  v_cvt_pk_bf16_f32 v234, v236, v237
  v_cvt_pk_bf16_f32 v235, v238, v239
  buffer_store_dwordx4 v[232:235], v55, s[4:7], s35 offen offset:2048 sc1
  v_pk_mul_f32 v[144:145], v[88:89], v[42:43] op_sel_hi:[1,0]
  v_pk_mul_f32 v[146:147], v[90:91], v[42:43] op_sel_hi:[1,0]
  v_pk_mul_f32 v[148:149], v[92:93], v[42:43] op_sel_hi:[1,0]
  v_pk_mul_f32 v[150:151], v[94:95], v[42:43] op_sel_hi:[1,0]
  v_pk_fma_f32 v[248:249], v[248:249], v[72:73], v[144:145]
  v_pk_fma_f32 v[250:251], v[250:251], v[74:75], v[146:147]
  v_pk_fma_f32 v[252:253], v[252:253], v[76:77], v[148:149]
  v_pk_fma_f32 v[254:255], v[254:255], v[78:79], v[150:151]
  v_cvt_pk_bf16_f32 v248, v248, v249
  v_cvt_pk_bf16_f32 v249, v250, v251
  v_cvt_pk_bf16_f32 v250, v252, v253
  v_cvt_pk_bf16_f32 v251, v254, v255
  buffer_store_dwordx4 v[248:251], v55, s[4:7], s35 offen offset:2304 sc1
  s_mov_b64 exec, s[36:37]
  s_cbranch_execz .g2_kernel_q_nk
  ds_write_b128 v59, v[192:195] offset:0
  ds_write_b128 v59, v[196:199] offset:128
  ds_write_b128 v59, v[200:203] offset:4096
  ds_write_b128 v59, v[204:207] offset:4224
  ds_write_b128 v60, v[224:227] offset:2048
  ds_write_b128 v60, v[240:243] offset:2304
  ds_write_b128 v60, v[232:235] offset:6144
  ds_write_b128 v60, v[248:251] offset:6400
.g2_kernel_q_nk:
  s_mov_b64 exec, -1
  v_mov_b32 v48, 0.25503486164919736
  v_pk_mul_f32 v[16:17], v[16:17], v[48:49] op_sel_hi:[1,0]
  v_pk_mul_f32 v[18:19], v[18:19], v[48:49] op_sel_hi:[1,0]
  v_pk_mul_f32 v[20:21], v[20:21], v[48:49] op_sel_hi:[1,0]
  v_pk_mul_f32 v[22:23], v[22:23], v[48:49] op_sel_hi:[1,0]
  v_pk_mul_f32 v[144:145], v[24:25], v[16:17] op_sel:[0,1] op_sel_hi:[1,1]
  v_pk_mul_f32 v[146:147], v[26:27], v[16:17] op_sel:[0,1] op_sel_hi:[1,1]
  v_pk_mul_f32 v[148:149], v[28:29], v[16:17] op_sel:[0,1] op_sel_hi:[1,1]
  v_pk_mul_f32 v[150:151], v[30:31], v[16:17] op_sel:[0,1] op_sel_hi:[1,1]
  v_pk_fma_f32 v[160:161], v[160:161], v[16:17], v[144:145] op_sel_hi:[1,0,1]
  v_pk_fma_f32 v[162:163], v[162:163], v[16:17], v[146:147] op_sel_hi:[1,0,1]
  v_pk_fma_f32 v[176:177], v[176:177], v[16:17], v[148:149] op_sel_hi:[1,0,1]
  v_pk_fma_f32 v[178:179], v[178:179], v[16:17], v[150:151] op_sel_hi:[1,0,1]
  v_cvt_pk_bf16_f32 v160, v160, v161
  v_cvt_pk_bf16_f32 v161, v162, v163
  v_cvt_pk_bf16_f32 v162, v176, v177
  v_cvt_pk_bf16_f32 v163, v178, v179
  ds_write_b128 v61, v[160:163] offset:0
  v_pk_mul_f32 v[144:145], v[24:25], v[18:19] op_sel:[0,1] op_sel_hi:[1,1]
  v_pk_mul_f32 v[146:147], v[26:27], v[18:19] op_sel:[0,1] op_sel_hi:[1,1]
  v_pk_mul_f32 v[148:149], v[28:29], v[18:19] op_sel:[0,1] op_sel_hi:[1,1]
  v_pk_mul_f32 v[150:151], v[30:31], v[18:19] op_sel:[0,1] op_sel_hi:[1,1]
  v_pk_fma_f32 v[164:165], v[164:165], v[18:19], v[144:145] op_sel_hi:[1,0,1]
  v_pk_fma_f32 v[166:167], v[166:167], v[18:19], v[146:147] op_sel_hi:[1,0,1]
  v_pk_fma_f32 v[180:181], v[180:181], v[18:19], v[148:149] op_sel_hi:[1,0,1]
  v_pk_fma_f32 v[182:183], v[182:183], v[18:19], v[150:151] op_sel_hi:[1,0,1]
  v_cvt_pk_bf16_f32 v164, v164, v165
  v_cvt_pk_bf16_f32 v165, v166, v167
  v_cvt_pk_bf16_f32 v166, v180, v181
  v_cvt_pk_bf16_f32 v167, v182, v183
  ds_write_b128 v61, v[164:167] offset:256
  v_pk_mul_f32 v[144:145], v[24:25], v[20:21] op_sel:[0,1] op_sel_hi:[1,1]
  v_pk_mul_f32 v[146:147], v[26:27], v[20:21] op_sel:[0,1] op_sel_hi:[1,1]
  v_pk_mul_f32 v[148:149], v[28:29], v[20:21] op_sel:[0,1] op_sel_hi:[1,1]
  v_pk_mul_f32 v[150:151], v[30:31], v[20:21] op_sel:[0,1] op_sel_hi:[1,1]
  v_pk_fma_f32 v[168:169], v[168:169], v[20:21], v[144:145] op_sel_hi:[1,0,1]
  v_pk_fma_f32 v[170:171], v[170:171], v[20:21], v[146:147] op_sel_hi:[1,0,1]
  v_pk_fma_f32 v[184:185], v[184:185], v[20:21], v[148:149] op_sel_hi:[1,0,1]
  v_pk_fma_f32 v[186:187], v[186:187], v[20:21], v[150:151] op_sel_hi:[1,0,1]
  v_cvt_pk_bf16_f32 v168, v168, v169
  v_cvt_pk_bf16_f32 v169, v170, v171
  v_cvt_pk_bf16_f32 v170, v184, v185
  v_cvt_pk_bf16_f32 v171, v186, v187
  ds_write_b128 v61, v[168:171] offset:2048
  v_pk_mul_f32 v[144:145], v[24:25], v[22:23] op_sel:[0,1] op_sel_hi:[1,1]
  v_pk_mul_f32 v[146:147], v[26:27], v[22:23] op_sel:[0,1] op_sel_hi:[1,1]
  v_pk_mul_f32 v[148:149], v[28:29], v[22:23] op_sel:[0,1] op_sel_hi:[1,1]
  v_pk_mul_f32 v[150:151], v[30:31], v[22:23] op_sel:[0,1] op_sel_hi:[1,1]
  v_pk_fma_f32 v[172:173], v[172:173], v[22:23], v[144:145] op_sel_hi:[1,0,1]
  v_pk_fma_f32 v[174:175], v[174:175], v[22:23], v[146:147] op_sel_hi:[1,0,1]
  v_pk_fma_f32 v[188:189], v[188:189], v[22:23], v[148:149] op_sel_hi:[1,0,1]
  v_pk_fma_f32 v[190:191], v[190:191], v[22:23], v[150:151] op_sel_hi:[1,0,1]
  v_cvt_pk_bf16_f32 v172, v172, v173
  v_cvt_pk_bf16_f32 v173, v174, v175
  v_cvt_pk_bf16_f32 v174, v188, v189
  v_cvt_pk_bf16_f32 v175, v190, v191
  ds_write_b128 v61, v[172:175] offset:2304
  s_mov_b64 exec, 1
  ds_add_u32 v57, v5 offset:4
  s_mov_b64 exec, -1
.g2_kernel_a:
  v_and_b32 v6, 15, v2
  v_xor_b32 v6, s17, v6
  v_and_b32 v7, 16, v2
  v_add_u32 v6, v6, v7
  s_lshr_b32 s28, s16, 1
  s_lshl_b32 s28, s28, 7
  s_add_u32 s28, s28, 157440
  v_lshl_add_u32 v8, v6, 2, s28
  s_lshl_b32 s28, s16, 12
  v_add_u32 v9, s28, v3
  v_and_b32 v6, 31, v2
  s_lshl_b32 s28, s16, 7
  s_add_u32 s28, s28, 161280
  v_lshl_add_u32 v10, v6, 2, s28
  s_lshl_b32 s28, s16, 2
  s_add_u32 s28, s28, 155968
  v_mov_b32 v11, s28
  s_lshl_b32 s28, s62, 1
  s_add_u32 s28, s28, 1
  v_mov_b32 v12, s28
  v_mov_b32 v13, s71
  v_add_u32 v14, 131072, v3
  v_and_b32 v6, 4, v2
  v_cmp_eq_u32 vcc, 0, v6
  v_mov_b32 v7, 0x3f803f80
  v_and_b32 v6, 1, v2
  v_cndmask_b32 v16, 0, v7, vcc
  v_cndmask_b32 v17, 0, v7, vcc
  v_cndmask_b32 v18, v7, 0, vcc
  v_cndmask_b32 v19, v7, 0, vcc
  v_mul_u32_u24 v20, 0xaaaa, v6
  v_add_u32 v20, 0x4444, v20
  s_lshl_b32 s28, s18, 7
  s_add_u32 s28, s28, s16
  s_lshl_b32 s28, s28, 12
  s_add_u32 s28, s28, s63
  s_add_u32 s20, s60, s28
  s_addc_u32 s21, s61, 0
  s_mov_b32 s24, s17
  s_mov_b32 s25, 14
  s_mov_b32 s26, 0
  s_mov_b32 s27, 4
  s_mov_b32 s34, 0xffff0001
  s_mov_b32 s36, 0
  s_mov_b32 s39, 0
  s_lshl_b32 s28, s16, 7
  s_add_u32 s37, s76, s28
  v_mov_b32 v15, s70
  v_mov_b32 v120, 0
  v_mov_b32 v121, 0
  v_mov_b32 v122, 0
  v_mov_b32 v123, 0
  v_mov_b32 v124, 0
  v_mov_b32 v125, 0
  v_mov_b32 v126, 0
  v_mov_b32 v127, 0
  v_mov_b32 v128, 0
  v_mov_b32 v129, 0
  v_mov_b32 v130, 0
  v_mov_b32 v131, 0
  v_mov_b32 v132, 0
  v_mov_b32 v133, 0
  v_mov_b32 v134, 0
  v_mov_b32 v135, 0
  s_mov_b32 s8, s40
  s_mov_b32 s9, s41
  s_mov_b32 s10, 0x400000
  s_mov_b32 s11, 0x00020000
  v_lshrrev_b32 v6, 5, v2
  v_and_b32 v7, 15, v2
  v_lshlrev_b32 v22, 4, v7
  v_lshl_add_u32 v22, v6, 8, v22
  v_and_b32 v7, 16, v2
  v_lshl_add_u32 v22, v7, 7, v22
  v_and_b32 v7, 31, v2
  v_lshlrev_b32 v23, 4, v6
  v_lshl_add_u32 v23, v7, 11, v23
  s_cmp_lg_u32 s62, 0
  s_cbranch_scc1 .g2_kernel_r2
  s_lshl_b32 s28, s17, 2
  s_add_u32 s28, s28, s16
  s_lshl_b32 s28, s28, 16
  s_lshl_b32 s29, s18, 7
  s_add_u32 s28, s28, s29
  buffer_load_dwordx4 v[240:243], v23, s[8:11], s28 offen offset:0
  buffer_load_dwordx4 v[244:247], v23, s[8:11], s28 offen offset:32
  buffer_load_dwordx4 v[248:251], v23, s[8:11], s28 offen offset:64
  buffer_load_dwordx4 v[252:255], v23, s[8:11], s28 offen offset:96
.g2_kernel_r3:
  v_mov_b32 v6, s71
  s_mov_b32 s38, 0
.g2_kernel_wg1:
  ds_read_b32 v7, v6 offset:4
  s_add_u32 s38, s38, 1
  s_waitcnt lgkmcnt(0)
  v_cmp_le_u32 vcc, 4, v7
  s_cbranch_vccnz .g2_kernel_wg1d
  s_cmp_lt_u32 s38, 524288
  s_cbranch_scc1 .g2_kernel_wg1
.g2_kernel_wg1d:
  ds_read_b128 v[176:179], v9 offset:0
  ds_read_b128 v[180:183], v9 offset:1024
  ds_read_b128 v[24:27], v14 offset:8192
  ds_read_b128 v[28:31], v14 offset:9216
  ds_read_b128 v[184:187], v9 offset:2048
  ds_read_b128 v[188:191], v9 offset:3072
  ds_read_b128 v[32:35], v14 offset:10240
  ds_read_b128 v[36:39], v14 offset:11264
  ds_read_b128 v[40:43], v14 offset:12288
  ds_read_b128 v[44:47], v14 offset:13312
  ds_read_b128 v[48:51], v14 offset:14336
  ds_read_b128 v[52:55], v14 offset:15360
  s_waitcnt lgkmcnt(8)
  v_mfma_f32_32x32x16_bf16 v[136:151], v[176:179], v[24:27], 0
  v_mfma_f32_32x32x16_bf16 v[136:151], v[180:183], v[28:31], v[136:151]
  s_waitcnt lgkmcnt(0)
  s_nop 7
  v_mfma_f32_32x32x16_bf16 v[152:167], v[176:179], v[32:35], 0
  s_nop 1
  v_exp_f32 v136, v136
  v_exp_f32 v137, v137
  v_exp_f32 v138, v138
  v_exp_f32 v139, v139
  v_exp_f32 v140, v140
  v_exp_f32 v141, v141
  v_exp_f32 v142, v142
  v_exp_f32 v143, v143
  v_mfma_f32_32x32x16_bf16 v[152:167], v[180:183], v[36:39], v[152:167]
  s_mov_b64 exec, 1
  ds_add_u32 v13, v5 offset:8
  s_mov_b64 exec, -1
  v_cvt_pk_bf16_f32 v168, v136, v137
  v_cvt_pk_bf16_f32 v169, v138, v139
  v_cvt_pk_bf16_f32 v170, v140, v141
  v_cvt_pk_bf16_f32 v171, v142, v143
  v_exp_f32 v144, v144
  v_exp_f32 v145, v145
  v_exp_f32 v146, v146
  v_exp_f32 v147, v147
  v_mfma_f32_32x32x16_bf16 v[56:71], v[184:187], v[168:171], 0
  v_exp_f32 v148, v148
  v_exp_f32 v149, v149
  v_exp_f32 v150, v150
  v_exp_f32 v151, v151
  v_cvt_pk_bf16_f32 v172, v144, v145
  v_cvt_pk_bf16_f32 v173, v146, v147
  v_cvt_pk_bf16_f32 v174, v148, v149
  v_cvt_pk_bf16_f32 v175, v150, v151
  v_mfma_f32_32x32x16_bf16 v[136:151], v[176:179], v[40:43], 0
  s_waitcnt vmcnt(4)
  s_mov_b64 exec, 1
  buffer_store_dword v15, v4, s[4:7], s37 offen sc1
  s_mov_b64 exec, -1
  v_exp_f32 v152, v152
  v_exp_f32 v153, v153
  v_exp_f32 v154, v154
  v_mfma_f32_32x32x16_bf16 v[56:71], v[188:191], v[172:175], v[56:71]
  v_exp_f32 v155, v155
  v_exp_f32 v156, v156
  v_exp_f32 v157, v157
  v_smfmac_f32_16x16x64_bf16 v[120:123], v[16:19], v[168:175], v20
  v_exp_f32 v158, v158
  v_exp_f32 v159, v159
  v_mfma_f32_32x32x16_bf16 v[136:151], v[180:183], v[44:47], v[136:151]
  v_cvt_pk_bf16_f32 v168, v152, v153
  v_cvt_pk_bf16_f32 v169, v154, v155
  v_cvt_pk_bf16_f32 v170, v156, v157
  v_cvt_pk_bf16_f32 v171, v158, v159
  v_exp_f32 v160, v160
  v_exp_f32 v161, v161
  v_exp_f32 v162, v162
  v_exp_f32 v163, v163
  v_mfma_f32_32x32x16_bf16 v[72:87], v[184:187], v[168:171], 0
  v_exp_f32 v164, v164
  v_exp_f32 v165, v165
  v_exp_f32 v166, v166
  v_exp_f32 v167, v167
  v_cvt_pk_bf16_f32 v172, v160, v161
  v_cvt_pk_bf16_f32 v173, v162, v163
  v_cvt_pk_bf16_f32 v174, v164, v165
  v_cvt_pk_bf16_f32 v175, v166, v167
  v_mfma_f32_32x32x16_bf16 v[152:167], v[176:179], v[48:51], 0
  ds_read_b32 v7, v8
  v_exp_f32 v136, v136
  v_exp_f32 v137, v137
  v_exp_f32 v138, v138
  v_mfma_f32_32x32x16_bf16 v[72:87], v[188:191], v[172:175], v[72:87]
  v_exp_f32 v139, v139
  v_exp_f32 v140, v140
  v_exp_f32 v141, v141
  v_smfmac_f32_16x16x64_bf16 v[124:127], v[16:19], v[168:175], v20
  v_exp_f32 v142, v142
  v_exp_f32 v143, v143
  v_mfma_f32_32x32x16_bf16 v[152:167], v[180:183], v[52:55], v[152:167]
  s_waitcnt lgkmcnt(0)
  v_cmp_lt_u32 vcc, s62, v7
  v_cvt_pk_bf16_f32 v168, v136, v137
  v_cvt_pk_bf16_f32 v169, v138, v139
  v_cvt_pk_bf16_f32 v170, v140, v141
  v_cvt_pk_bf16_f32 v171, v142, v143
  v_exp_f32 v144, v144
  v_exp_f32 v145, v145
  v_exp_f32 v146, v146
  v_exp_f32 v147, v147
  v_mfma_f32_32x32x16_bf16 v[88:103], v[184:187], v[168:171], 0
  s_mov_b32 s36, vcc_lo
  s_andn2_b32 s33, s36, s34
  v_exp_f32 v148, v148
  v_exp_f32 v149, v149
  v_exp_f32 v150, v150
  v_exp_f32 v151, v151
  v_cvt_pk_bf16_f32 v172, v144, v145
  v_cvt_pk_bf16_f32 v173, v146, v147
  v_cvt_pk_bf16_f32 v174, v148, v149
  v_cvt_pk_bf16_f32 v175, v150, v151
  v_exp_f32 v152, v152
  v_exp_f32 v153, v153
  v_exp_f32 v154, v154
  v_mfma_f32_32x32x16_bf16 v[88:103], v[188:191], v[172:175], v[88:103]
  s_bcnt1_i32_b32 s39, s33
  s_cmp_lt_u32 s39, 3
  v_exp_f32 v155, v155
  v_exp_f32 v156, v156
  v_exp_f32 v157, v157
  v_smfmac_f32_16x16x64_bf16 v[128:131], v[16:19], v[168:175], v20
  s_cbranch_scc1 .g2_kernel_a_F0n
  s_call_b64 s[72:73], .g2_kernel_a_three
.g2_kernel_a_F0n:
  v_exp_f32 v158, v158
  v_exp_f32 v159, v159
  v_cvt_pk_bf16_f32 v168, v152, v153
  v_cvt_pk_bf16_f32 v169, v154, v155
  v_cvt_pk_bf16_f32 v170, v156, v157
  v_cvt_pk_bf16_f32 v171, v158, v159
  v_exp_f32 v160, v160
  v_exp_f32 v161, v161
  v_exp_f32 v162, v162
  v_exp_f32 v163, v163
  v_mfma_f32_32x32x16_bf16 v[104:119], v[184:187], v[168:171], 0
  v_exp_f32 v164, v164
  v_exp_f32 v165, v165
  v_exp_f32 v166, v166
  v_exp_f32 v167, v167
  v_cvt_pk_bf16_f32 v172, v160, v161
  v_cvt_pk_bf16_f32 v173, v162, v163
  v_cvt_pk_bf16_f32 v174, v164, v165
  v_cvt_pk_bf16_f32 v175, v166, v167
  s_cmp_ge_u32 s39, 3
  s_cbranch_scc1 .g2_kernel_a_p1
  s_call_b64 s[72:73], .g2_kernel_a_three
.g2_kernel_a_p1:
  s_waitcnt vmcnt(10)
  v_mfma_f32_32x32x16_bf16 v[136:151], v[192:195], v[24:27], 0
  v_mfma_f32_32x32x16_bf16 v[136:151], v[196:199], v[28:31], v[136:151]
  s_waitcnt vmcnt(8)
  s_mov_b32 s32, 0
  s_nop 8
  s_branch .g2_kernel_a_n1
  .p2align 6
.g2_kernel_a_loop:
  v_mfma_f32_32x32x16_bf16 v[152:167], v[176:179], v[32:35], 0
  s_andn2_b32 s33, s36, s34
  v_exp_f32 v136, v136
  v_exp_f32 v137, v137
  v_exp_f32 v138, v138
  v_mfma_f32_32x32x16_bf16 v[104:119], v[236:239], v[172:175], v[104:119]
  s_cbranch_scc0 .g2_kernel_a_N0c
.g2_kernel_a_N0b:
  v_exp_f32 v139, v139
  v_exp_f32 v140, v140
  v_exp_f32 v141, v141
  v_smfmac_f32_16x16x64_bf16 v[132:135], v[16:19], v[168:175], v20
  s_ff1_i32_b32 s33, s33
  v_exp_f32 v142, v142
  v_exp_f32 v143, v143
  v_mfma_f32_32x32x16_bf16 v[152:167], v[180:183], v[36:39], v[152:167]
  s_bitset1_b32 s34, s33
  v_cvt_pk_bf16_f32 v168, v136, v137
  v_cvt_pk_bf16_f32 v169, v138, v139
  v_cvt_pk_bf16_f32 v170, v140, v141
  v_cvt_pk_bf16_f32 v171, v142, v143
  v_exp_f32 v144, v144
  v_exp_f32 v145, v145
  v_exp_f32 v146, v146
  v_exp_f32 v147, v147
  v_mfma_f32_32x32x16_bf16 v[56:71], v[184:187], v[168:171], v[56:71]
  s_xor_b32 s33, s33, s24
  v_exp_f32 v148, v148
  v_exp_f32 v149, v149
  v_exp_f32 v150, v150
  v_exp_f32 v151, v151
  v_cvt_pk_bf16_f32 v172, v144, v145
  v_cvt_pk_bf16_f32 v173, v146, v147
  v_cvt_pk_bf16_f32 v174, v148, v149
  v_cvt_pk_bf16_f32 v175, v150, v151
  v_mfma_f32_32x32x16_bf16 v[136:151], v[176:179], v[40:43], 0
  s_lshl_b32 s33, s33, s25
  v_exp_f32 v152, v152
  v_exp_f32 v153, v153
  v_exp_f32 v154, v154
  v_mfma_f32_32x32x16_bf16 v[56:71], v[188:191], v[172:175], v[56:71]
  s_add_u32 s22, s20, s33
  v_exp_f32 v155, v155
  v_exp_f32 v156, v156
  v_exp_f32 v157, v157
  v_smfmac_f32_16x16x64_bf16 v[120:123], v[16:19], v[168:175], v20
  s_addc_u32 s23, s21, 0
  v_exp_f32 v158, v158
  v_exp_f32 v159, v159
  v_mfma_f32_32x32x16_bf16 v[136:151], v[180:183], v[44:47], v[136:151]
  global_load_dwordx4 v[224:227], v3, s[22:23] offset:0
  global_load_dwordx4 v[228:231], v3, s[22:23] offset:1024
  global_load_dwordx4 v[232:235], v3, s[22:23] offset:2048
  global_load_dwordx4 v[236:239], v3, s[22:23] offset:3072
  v_cvt_pk_bf16_f32 v168, v152, v153
  v_cvt_pk_bf16_f32 v169, v154, v155
  v_cvt_pk_bf16_f32 v170, v156, v157
  v_cvt_pk_bf16_f32 v171, v158, v159
  v_exp_f32 v160, v160
  v_exp_f32 v161, v161
  v_exp_f32 v162, v162
  v_exp_f32 v163, v163
  v_mfma_f32_32x32x16_bf16 v[72:87], v[184:187], v[168:171], v[72:87]
  v_exp_f32 v164, v164
  v_exp_f32 v165, v165
  v_exp_f32 v166, v166
  v_exp_f32 v167, v167
  v_cvt_pk_bf16_f32 v172, v160, v161
  v_cvt_pk_bf16_f32 v173, v162, v163
  v_cvt_pk_bf16_f32 v174, v164, v165
  v_cvt_pk_bf16_f32 v175, v166, v167
  v_mfma_f32_32x32x16_bf16 v[152:167], v[176:179], v[48:51], 0
  v_exp_f32 v136, v136
  v_exp_f32 v137, v137
  v_exp_f32 v138, v138
  v_mfma_f32_32x32x16_bf16 v[72:87], v[188:191], v[172:175], v[72:87]
  v_exp_f32 v139, v139
  v_exp_f32 v140, v140
  v_exp_f32 v141, v141
  v_smfmac_f32_16x16x64_bf16 v[124:127], v[16:19], v[168:175], v20
  v_exp_f32 v142, v142
  v_exp_f32 v143, v143
  v_mfma_f32_32x32x16_bf16 v[152:167], v[180:183], v[52:55], v[152:167]
  v_cvt_pk_bf16_f32 v168, v136, v137
  v_cvt_pk_bf16_f32 v169, v138, v139
  v_cvt_pk_bf16_f32 v170, v140, v141
  v_cvt_pk_bf16_f32 v171, v142, v143
  v_exp_f32 v144, v144
  v_exp_f32 v145, v145
  v_exp_f32 v146, v146
  v_exp_f32 v147, v147
  v_mfma_f32_32x32x16_bf16 v[88:103], v[184:187], v[168:171], v[88:103]
  s_waitcnt vmcnt(8)
  v_exp_f32 v148, v148
  v_exp_f32 v149, v149
  v_exp_f32 v150, v150
  v_exp_f32 v151, v151
  v_cvt_pk_bf16_f32 v172, v144, v145
  v_cvt_pk_bf16_f32 v173, v146, v147
  v_cvt_pk_bf16_f32 v174, v148, v149
  v_cvt_pk_bf16_f32 v175, v150, v151
  v_mfma_f32_32x32x16_bf16 v[136:151], v[192:195], v[24:27], 0
  v_exp_f32 v152, v152
  v_exp_f32 v153, v153
  v_exp_f32 v154, v154
  v_mfma_f32_32x32x16_bf16 v[88:103], v[188:191], v[172:175], v[88:103]
  v_exp_f32 v155, v155
  v_exp_f32 v156, v156
  v_exp_f32 v157, v157
  v_smfmac_f32_16x16x64_bf16 v[128:131], v[16:19], v[168:175], v20
  v_exp_f32 v158, v158
  v_exp_f32 v159, v159
  v_mfma_f32_32x32x16_bf16 v[136:151], v[196:199], v[28:31], v[136:151]
  v_cvt_pk_bf16_f32 v168, v152, v153
  v_cvt_pk_bf16_f32 v169, v154, v155
  v_cvt_pk_bf16_f32 v170, v156, v157
  v_cvt_pk_bf16_f32 v171, v158, v159
  v_exp_f32 v160, v160
  v_exp_f32 v161, v161
  v_exp_f32 v162, v162
  v_exp_f32 v163, v163
  v_mfma_f32_32x32x16_bf16 v[104:119], v[184:187], v[168:171], v[104:119]
  v_exp_f32 v164, v164
  v_exp_f32 v165, v165
  v_exp_f32 v166, v166
  v_exp_f32 v167, v167
  v_cvt_pk_bf16_f32 v172, v160, v161
  v_cvt_pk_bf16_f32 v173, v162, v163
  v_cvt_pk_bf16_f32 v174, v164, v165
  v_cvt_pk_bf16_f32 v175, v166, v167
.g2_kernel_a_n1:
  v_mfma_f32_32x32x16_bf16 v[152:167], v[192:195], v[32:35], 0
  s_andn2_b32 s33, s36, s34
  v_exp_f32 v136, v136
  v_exp_f32 v137, v137
  v_exp_f32 v138, v138
  v_mfma_f32_32x32x16_bf16 v[104:119], v[188:191], v[172:175], v[104:119]
  s_cbranch_scc0 .g2_kernel_a_N1c
.g2_kernel_a_N1b:
  v_exp_f32 v139, v139
  v_exp_f32 v140, v140
  v_exp_f32 v141, v141
  v_smfmac_f32_16x16x64_bf16 v[132:135], v[16:19], v[168:175], v20
  s_ff1_i32_b32 s33, s33
  v_exp_f32 v142, v142
  v_exp_f32 v143, v143
  v_mfma_f32_32x32x16_bf16 v[152:167], v[196:199], v[36:39], v[152:167]
  s_bitset1_b32 s34, s33
  v_cvt_pk_bf16_f32 v168, v136, v137
  v_cvt_pk_bf16_f32 v169, v138, v139
  v_cvt_pk_bf16_f32 v170, v140, v141
  v_cvt_pk_bf16_f32 v171, v142, v143
  v_exp_f32 v144, v144
  v_exp_f32 v145, v145
  v_exp_f32 v146, v146
  v_exp_f32 v147, v147
  v_mfma_f32_32x32x16_bf16 v[56:71], v[200:203], v[168:171], v[56:71]
  s_xor_b32 s33, s33, s24
  v_exp_f32 v148, v148
  v_exp_f32 v149, v149
  v_exp_f32 v150, v150
  v_exp_f32 v151, v151
  v_cvt_pk_bf16_f32 v172, v144, v145
  v_cvt_pk_bf16_f32 v173, v146, v147
  v_cvt_pk_bf16_f32 v174, v148, v149
  v_cvt_pk_bf16_f32 v175, v150, v151
  v_mfma_f32_32x32x16_bf16 v[136:151], v[192:195], v[40:43], 0
  s_lshl_b32 s33, s33, s25
  v_exp_f32 v152, v152
  v_exp_f32 v153, v153
  v_exp_f32 v154, v154
  v_mfma_f32_32x32x16_bf16 v[56:71], v[204:207], v[172:175], v[56:71]
  s_add_u32 s22, s20, s33
  v_exp_f32 v155, v155
  v_exp_f32 v156, v156
  v_exp_f32 v157, v157
  v_smfmac_f32_16x16x64_bf16 v[120:123], v[16:19], v[168:175], v20
  s_addc_u32 s23, s21, 0
  v_exp_f32 v158, v158
  v_exp_f32 v159, v159
  v_mfma_f32_32x32x16_bf16 v[136:151], v[196:199], v[44:47], v[136:151]
  global_load_dwordx4 v[176:179], v3, s[22:23] offset:0
  global_load_dwordx4 v[180:183], v3, s[22:23] offset:1024
  global_load_dwordx4 v[184:187], v3, s[22:23] offset:2048
  global_load_dwordx4 v[188:191], v3, s[22:23] offset:3072
  v_cvt_pk_bf16_f32 v168, v152, v153
  v_cvt_pk_bf16_f32 v169, v154, v155
  v_cvt_pk_bf16_f32 v170, v156, v157
  v_cvt_pk_bf16_f32 v171, v158, v159
  v_exp_f32 v160, v160
  v_exp_f32 v161, v161
  v_exp_f32 v162, v162
  v_exp_f32 v163, v163
  v_mfma_f32_32x32x16_bf16 v[72:87], v[200:203], v[168:171], v[72:87]
  v_exp_f32 v164, v164
  v_exp_f32 v165, v165
  v_exp_f32 v166, v166
  v_exp_f32 v167, v167
  v_cvt_pk_bf16_f32 v172, v160, v161
  v_cvt_pk_bf16_f32 v173, v162, v163
  v_cvt_pk_bf16_f32 v174, v164, v165
  v_cvt_pk_bf16_f32 v175, v166, v167
  v_mfma_f32_32x32x16_bf16 v[152:167], v[192:195], v[48:51], 0
  v_exp_f32 v136, v136
  v_exp_f32 v137, v137
  v_exp_f32 v138, v138
  v_mfma_f32_32x32x16_bf16 v[72:87], v[204:207], v[172:175], v[72:87]
  v_exp_f32 v139, v139
  v_exp_f32 v140, v140
  v_exp_f32 v141, v141
  v_smfmac_f32_16x16x64_bf16 v[124:127], v[16:19], v[168:175], v20
  v_exp_f32 v142, v142
  v_exp_f32 v143, v143
  v_mfma_f32_32x32x16_bf16 v[152:167], v[196:199], v[52:55], v[152:167]
  v_cvt_pk_bf16_f32 v168, v136, v137
  v_cvt_pk_bf16_f32 v169, v138, v139
  v_cvt_pk_bf16_f32 v170, v140, v141
  v_cvt_pk_bf16_f32 v171, v142, v143
  v_exp_f32 v144, v144
  v_exp_f32 v145, v145
  v_exp_f32 v146, v146
  v_exp_f32 v147, v147
  v_mfma_f32_32x32x16_bf16 v[88:103], v[200:203], v[168:171], v[88:103]
  s_waitcnt vmcnt(8)
  v_exp_f32 v148, v148
  v_exp_f32 v149, v149
  v_exp_f32 v150, v150
  v_exp_f32 v151, v151
  v_cvt_pk_bf16_f32 v172, v144, v145
  v_cvt_pk_bf16_f32 v173, v146, v147
  v_cvt_pk_bf16_f32 v174, v148, v149
  v_cvt_pk_bf16_f32 v175, v150, v151
  v_mfma_f32_32x32x16_bf16 v[136:151], v[208:211], v[24:27], 0
  v_exp_f32 v152, v152
  v_exp_f32 v153, v153
  v_exp_f32 v154, v154
  v_mfma_f32_32x32x16_bf16 v[88:103], v[204:207], v[172:175], v[88:103]
  v_exp_f32 v155, v155
  v_exp_f32 v156, v156
  v_exp_f32 v157, v157
  v_smfmac_f32_16x16x64_bf16 v[128:131], v[16:19], v[168:175], v20
  v_exp_f32 v158, v158
  v_exp_f32 v159, v159
  v_mfma_f32_32x32x16_bf16 v[136:151], v[212:215], v[28:31], v[136:151]
  v_cvt_pk_bf16_f32 v168, v152, v153
  v_cvt_pk_bf16_f32 v169, v154, v155
  v_cvt_pk_bf16_f32 v170, v156, v157
  v_cvt_pk_bf16_f32 v171, v158, v159
  v_exp_f32 v160, v160
  v_exp_f32 v161, v161
  v_exp_f32 v162, v162
  v_exp_f32 v163, v163
  v_mfma_f32_32x32x16_bf16 v[104:119], v[200:203], v[168:171], v[104:119]
  v_exp_f32 v164, v164
  v_exp_f32 v165, v165
  v_exp_f32 v166, v166
  v_exp_f32 v167, v167
  v_cvt_pk_bf16_f32 v172, v160, v161
  v_cvt_pk_bf16_f32 v173, v162, v163
  v_cvt_pk_bf16_f32 v174, v164, v165
  v_cvt_pk_bf16_f32 v175, v166, v167
  v_mfma_f32_32x32x16_bf16 v[152:167], v[208:211], v[32:35], 0
  s_andn2_b32 s33, s36, s34
  v_exp_f32 v136, v136
  v_exp_f32 v137, v137
  v_exp_f32 v138, v138
  v_mfma_f32_32x32x16_bf16 v[104:119], v[204:207], v[172:175], v[104:119]
  s_cbranch_scc0 .g2_kernel_a_N2c
.g2_kernel_a_N2b:
  v_exp_f32 v139, v139
  v_exp_f32 v140, v140
  v_exp_f32 v141, v141
  v_smfmac_f32_16x16x64_bf16 v[132:135], v[16:19], v[168:175], v20
  s_ff1_i32_b32 s33, s33
  v_exp_f32 v142, v142
  v_exp_f32 v143, v143
  v_mfma_f32_32x32x16_bf16 v[152:167], v[212:215], v[36:39], v[152:167]
  s_bitset1_b32 s34, s33
  v_cvt_pk_bf16_f32 v168, v136, v137
  v_cvt_pk_bf16_f32 v169, v138, v139
  v_cvt_pk_bf16_f32 v170, v140, v141
  v_cvt_pk_bf16_f32 v171, v142, v143
  v_exp_f32 v144, v144
  v_exp_f32 v145, v145
  v_exp_f32 v146, v146
  v_exp_f32 v147, v147
  v_mfma_f32_32x32x16_bf16 v[56:71], v[216:219], v[168:171], v[56:71]
  s_xor_b32 s33, s33, s24
  v_exp_f32 v148, v148
  v_exp_f32 v149, v149
  v_exp_f32 v150, v150
  v_exp_f32 v151, v151
  v_cvt_pk_bf16_f32 v172, v144, v145
  v_cvt_pk_bf16_f32 v173, v146, v147
  v_cvt_pk_bf16_f32 v174, v148, v149
  v_cvt_pk_bf16_f32 v175, v150, v151
  v_mfma_f32_32x32x16_bf16 v[136:151], v[208:211], v[40:43], 0
  s_lshl_b32 s33, s33, s25
  v_exp_f32 v152, v152
  v_exp_f32 v153, v153
  v_exp_f32 v154, v154
  v_mfma_f32_32x32x16_bf16 v[56:71], v[220:223], v[172:175], v[56:71]
  s_add_u32 s22, s20, s33
  v_exp_f32 v155, v155
  v_exp_f32 v156, v156
  v_exp_f32 v157, v157
  v_smfmac_f32_16x16x64_bf16 v[120:123], v[16:19], v[168:175], v20
  s_addc_u32 s23, s21, 0
  v_exp_f32 v158, v158
  v_exp_f32 v159, v159
  v_mfma_f32_32x32x16_bf16 v[136:151], v[212:215], v[44:47], v[136:151]
  global_load_dwordx4 v[192:195], v3, s[22:23] offset:0
  global_load_dwordx4 v[196:199], v3, s[22:23] offset:1024
  global_load_dwordx4 v[200:203], v3, s[22:23] offset:2048
  global_load_dwordx4 v[204:207], v3, s[22:23] offset:3072
  v_cvt_pk_bf16_f32 v168, v152, v153
  v_cvt_pk_bf16_f32 v169, v154, v155
  v_cvt_pk_bf16_f32 v170, v156, v157
  v_cvt_pk_bf16_f32 v171, v158, v159
  v_exp_f32 v160, v160
  v_exp_f32 v161, v161
  v_exp_f32 v162, v162
  v_exp_f32 v163, v163
  v_mfma_f32_32x32x16_bf16 v[72:87], v[216:219], v[168:171], v[72:87]
  v_exp_f32 v164, v164
  v_exp_f32 v165, v165
  v_exp_f32 v166, v166
  v_exp_f32 v167, v167
  v_cvt_pk_bf16_f32 v172, v160, v161
  v_cvt_pk_bf16_f32 v173, v162, v163
  v_cvt_pk_bf16_f32 v174, v164, v165
  v_cvt_pk_bf16_f32 v175, v166, v167
  v_mfma_f32_32x32x16_bf16 v[152:167], v[208:211], v[48:51], 0
  v_exp_f32 v136, v136
  v_exp_f32 v137, v137
  v_exp_f32 v138, v138
  v_mfma_f32_32x32x16_bf16 v[72:87], v[220:223], v[172:175], v[72:87]
  v_exp_f32 v139, v139
  v_exp_f32 v140, v140
  v_exp_f32 v141, v141
  v_smfmac_f32_16x16x64_bf16 v[124:127], v[16:19], v[168:175], v20
  v_exp_f32 v142, v142
  v_exp_f32 v143, v143
  v_mfma_f32_32x32x16_bf16 v[152:167], v[212:215], v[52:55], v[152:167]
  v_cvt_pk_bf16_f32 v168, v136, v137
  v_cvt_pk_bf16_f32 v169, v138, v139
  v_cvt_pk_bf16_f32 v170, v140, v141
  v_cvt_pk_bf16_f32 v171, v142, v143
  v_exp_f32 v144, v144
  v_exp_f32 v145, v145
  v_exp_f32 v146, v146
  v_exp_f32 v147, v147
  v_mfma_f32_32x32x16_bf16 v[88:103], v[216:219], v[168:171], v[88:103]
  s_waitcnt vmcnt(8)
  v_exp_f32 v148, v148
  v_exp_f32 v149, v149
  v_exp_f32 v150, v150
  v_exp_f32 v151, v151
  v_cvt_pk_bf16_f32 v172, v144, v145
  v_cvt_pk_bf16_f32 v173, v146, v147
  v_cvt_pk_bf16_f32 v174, v148, v149
  v_cvt_pk_bf16_f32 v175, v150, v151
  v_mfma_f32_32x32x16_bf16 v[136:151], v[224:227], v[24:27], 0
  v_exp_f32 v152, v152
  v_exp_f32 v153, v153
  v_exp_f32 v154, v154
  v_mfma_f32_32x32x16_bf16 v[88:103], v[220:223], v[172:175], v[88:103]
  v_exp_f32 v155, v155
  v_exp_f32 v156, v156
  v_exp_f32 v157, v157
  v_smfmac_f32_16x16x64_bf16 v[128:131], v[16:19], v[168:175], v20
  v_exp_f32 v158, v158
  v_exp_f32 v159, v159
  v_mfma_f32_32x32x16_bf16 v[136:151], v[228:231], v[28:31], v[136:151]
  s_and_b32 s28, s32, 3
  v_cvt_pk_bf16_f32 v168, v152, v153
  v_cvt_pk_bf16_f32 v169, v154, v155
  v_cvt_pk_bf16_f32 v170, v156, v157
  v_cvt_pk_bf16_f32 v171, v158, v159
  v_exp_f32 v160, v160
  v_exp_f32 v161, v161
  v_exp_f32 v162, v162
  v_exp_f32 v163, v163
  v_mfma_f32_32x32x16_bf16 v[104:119], v[216:219], v[168:171], v[104:119]
  s_cmp_eq_u32 s28, 3
  v_exp_f32 v164, v164
  v_exp_f32 v165, v165
  v_exp_f32 v166, v166
  v_exp_f32 v167, v167
  v_cvt_pk_bf16_f32 v172, v160, v161
  v_cvt_pk_bf16_f32 v173, v162, v163
  v_cvt_pk_bf16_f32 v174, v164, v165
  v_cvt_pk_bf16_f32 v175, v166, v167
  s_cbranch_scc1 .g2_kernel_a_last
  v_mfma_f32_32x32x16_bf16 v[152:167], v[224:227], v[32:35], 0
  s_andn2_b32 s33, s36, s34
  v_exp_f32 v136, v136
  v_exp_f32 v137, v137
  v_exp_f32 v138, v138
  v_mfma_f32_32x32x16_bf16 v[104:119], v[220:223], v[172:175], v[104:119]
  s_cbranch_scc0 .g2_kernel_a_N3c
.g2_kernel_a_N3b:
  v_exp_f32 v139, v139
  v_exp_f32 v140, v140
  v_exp_f32 v141, v141
  v_smfmac_f32_16x16x64_bf16 v[132:135], v[16:19], v[168:175], v20
  s_ff1_i32_b32 s33, s33
  v_exp_f32 v142, v142
  v_exp_f32 v143, v143
  v_mfma_f32_32x32x16_bf16 v[152:167], v[228:231], v[36:39], v[152:167]
  s_bitset1_b32 s34, s33
  v_cvt_pk_bf16_f32 v168, v136, v137
  v_cvt_pk_bf16_f32 v169, v138, v139
  v_cvt_pk_bf16_f32 v170, v140, v141
  v_cvt_pk_bf16_f32 v171, v142, v143
  v_exp_f32 v144, v144
  v_exp_f32 v145, v145
  v_exp_f32 v146, v146
  v_exp_f32 v147, v147
  v_mfma_f32_32x32x16_bf16 v[56:71], v[232:235], v[168:171], v[56:71]
  s_xor_b32 s33, s33, s24
  v_exp_f32 v148, v148
  v_exp_f32 v149, v149
  v_exp_f32 v150, v150
  v_exp_f32 v151, v151
  v_cvt_pk_bf16_f32 v172, v144, v145
  v_cvt_pk_bf16_f32 v173, v146, v147
  v_cvt_pk_bf16_f32 v174, v148, v149
  v_cvt_pk_bf16_f32 v175, v150, v151
  v_mfma_f32_32x32x16_bf16 v[136:151], v[224:227], v[40:43], 0
  s_lshl_b32 s33, s33, s25
  v_exp_f32 v152, v152
  v_exp_f32 v153, v153
  v_exp_f32 v154, v154
  v_mfma_f32_32x32x16_bf16 v[56:71], v[236:239], v[172:175], v[56:71]
  s_add_u32 s22, s20, s33
  v_exp_f32 v155, v155
  v_exp_f32 v156, v156
  v_exp_f32 v157, v157
  v_smfmac_f32_16x16x64_bf16 v[120:123], v[16:19], v[168:175], v20
  s_addc_u32 s23, s21, 0
  v_exp_f32 v158, v158
  v_exp_f32 v159, v159
  v_mfma_f32_32x32x16_bf16 v[136:151], v[228:231], v[44:47], v[136:151]
  global_load_dwordx4 v[208:211], v3, s[22:23] offset:0
  global_load_dwordx4 v[212:215], v3, s[22:23] offset:1024
  global_load_dwordx4 v[216:219], v3, s[22:23] offset:2048
  global_load_dwordx4 v[220:223], v3, s[22:23] offset:3072
  v_cvt_pk_bf16_f32 v168, v152, v153
  v_cvt_pk_bf16_f32 v169, v154, v155
  v_cvt_pk_bf16_f32 v170, v156, v157
  v_cvt_pk_bf16_f32 v171, v158, v159
  v_exp_f32 v160, v160
  v_exp_f32 v161, v161
  v_exp_f32 v162, v162
  v_exp_f32 v163, v163
  v_mfma_f32_32x32x16_bf16 v[72:87], v[232:235], v[168:171], v[72:87]
  v_exp_f32 v164, v164
  v_exp_f32 v165, v165
  v_exp_f32 v166, v166
  v_exp_f32 v167, v167
  v_cvt_pk_bf16_f32 v172, v160, v161
  v_cvt_pk_bf16_f32 v173, v162, v163
  v_cvt_pk_bf16_f32 v174, v164, v165
  v_cvt_pk_bf16_f32 v175, v166, v167
  v_mfma_f32_32x32x16_bf16 v[152:167], v[224:227], v[48:51], 0
  v_exp_f32 v136, v136
  v_exp_f32 v137, v137
  v_exp_f32 v138, v138
  v_mfma_f32_32x32x16_bf16 v[72:87], v[236:239], v[172:175], v[72:87]
  v_exp_f32 v139, v139
  v_exp_f32 v140, v140
  v_exp_f32 v141, v141
  v_smfmac_f32_16x16x64_bf16 v[124:127], v[16:19], v[168:175], v20
  v_exp_f32 v142, v142
  v_exp_f32 v143, v143
  v_mfma_f32_32x32x16_bf16 v[152:167], v[228:231], v[52:55], v[152:167]
  v_cvt_pk_bf16_f32 v168, v136, v137
  v_cvt_pk_bf16_f32 v169, v138, v139
  v_cvt_pk_bf16_f32 v170, v140, v141
  v_cvt_pk_bf16_f32 v171, v142, v143
  v_exp_f32 v144, v144
  v_exp_f32 v145, v145
  v_exp_f32 v146, v146
  v_exp_f32 v147, v147
  v_mfma_f32_32x32x16_bf16 v[88:103], v[232:235], v[168:171], v[88:103]
  s_waitcnt vmcnt(8)
  v_exp_f32 v148, v148
  v_exp_f32 v149, v149
  v_exp_f32 v150, v150
  v_exp_f32 v151, v151
  v_cvt_pk_bf16_f32 v172, v144, v145
  v_cvt_pk_bf16_f32 v173, v146, v147
  v_cvt_pk_bf16_f32 v174, v148, v149
  v_cvt_pk_bf16_f32 v175, v150, v151
  v_mfma_f32_32x32x16_bf16 v[136:151], v[176:179], v[24:27], 0
  v_exp_f32 v152, v152
  v_exp_f32 v153, v153
  v_exp_f32 v154, v154
  v_mfma_f32_32x32x16_bf16 v[88:103], v[236:239], v[172:175], v[88:103]
  v_exp_f32 v155, v155
  v_exp_f32 v156, v156
  v_exp_f32 v157, v157
  v_smfmac_f32_16x16x64_bf16 v[128:131], v[16:19], v[168:175], v20
  v_exp_f32 v158, v158
  v_exp_f32 v159, v159
  v_mfma_f32_32x32x16_bf16 v[136:151], v[180:183], v[28:31], v[136:151]
  v_cvt_pk_bf16_f32 v168, v152, v153
  v_cvt_pk_bf16_f32 v169, v154, v155
  v_cvt_pk_bf16_f32 v170, v156, v157
  v_cvt_pk_bf16_f32 v171, v158, v159
  v_exp_f32 v160, v160
  v_exp_f32 v161, v161
  v_exp_f32 v162, v162
  v_exp_f32 v163, v163
  v_mfma_f32_32x32x16_bf16 v[104:119], v[232:235], v[168:171], v[104:119]
  s_add_u32 s32, s32, 1
  v_exp_f32 v164, v164
  v_exp_f32 v165, v165
  v_exp_f32 v166, v166
  v_exp_f32 v167, v167
  v_cvt_pk_bf16_f32 v172, v160, v161
  v_cvt_pk_bf16_f32 v173, v162, v163
  v_cvt_pk_bf16_f32 v174, v164, v165
  v_cvt_pk_bf16_f32 v175, v166, v167
  s_branch .g2_kernel_a_loop
.g2_kernel_a_last:
  v_mfma_f32_32x32x16_bf16 v[152:167], v[224:227], v[32:35], 0
  ds_read_b32 v21, v13 offset:8
  s_andn2_b32 s33, s36, s34
  v_exp_f32 v136, v136
  v_exp_f32 v137, v137
  v_exp_f32 v138, v138
  v_mfma_f32_32x32x16_bf16 v[104:119], v[220:223], v[172:175], v[104:119]
  s_cbranch_scc0 .g2_kernel_a_L3c
.g2_kernel_a_L3b:
  v_exp_f32 v139, v139
  v_exp_f32 v140, v140
  v_exp_f32 v141, v141
  v_smfmac_f32_16x16x64_bf16 v[132:135], v[16:19], v[168:175], v20
  s_ff1_i32_b32 s33, s33
  v_exp_f32 v142, v142
  v_exp_f32 v143, v143
  v_mfma_f32_32x32x16_bf16 v[152:167], v[228:231], v[36:39], v[152:167]
  s_bitset1_b32 s34, s33
  ds_read_b128 v[24:27], v14 offset:0
  v_cvt_pk_bf16_f32 v168, v136, v137
  v_cvt_pk_bf16_f32 v169, v138, v139
  v_cvt_pk_bf16_f32 v170, v140, v141
  v_cvt_pk_bf16_f32 v171, v142, v143
  v_exp_f32 v144, v144
  v_exp_f32 v145, v145
  v_exp_f32 v146, v146
  v_exp_f32 v147, v147
  v_mfma_f32_32x32x16_bf16 v[56:71], v[232:235], v[168:171], v[56:71]
  s_xor_b32 s33, s33, s24
  ds_read_b128 v[28:31], v14 offset:1024
  v_exp_f32 v148, v148
  v_exp_f32 v149, v149
  v_exp_f32 v150, v150
  v_exp_f32 v151, v151
  v_cvt_pk_bf16_f32 v172, v144, v145
  v_cvt_pk_bf16_f32 v173, v146, v147
  v_cvt_pk_bf16_f32 v174, v148, v149
  v_cvt_pk_bf16_f32 v175, v150, v151
  v_mfma_f32_32x32x16_bf16 v[136:151], v[224:227], v[40:43], 0
  s_waitcnt lgkmcnt(2)
  s_lshl_b32 s33, s33, s25
  v_exp_f32 v152, v152
  v_exp_f32 v153, v153
  v_exp_f32 v154, v154
  v_mfma_f32_32x32x16_bf16 v[56:71], v[236:239], v[172:175], v[56:71]
  v_cmp_gt_u32 vcc, s27, v21
  s_add_u32 s22, s20, s33
  v_exp_f32 v155, v155
  v_exp_f32 v156, v156
  v_exp_f32 v157, v157
  v_smfmac_f32_16x16x64_bf16 v[120:123], v[16:19], v[168:175], v20
  s_addc_u32 s23, s21, 0
  v_exp_f32 v158, v158
  v_exp_f32 v159, v159
  v_mfma_f32_32x32x16_bf16 v[136:151], v[228:231], v[44:47], v[136:151]
  global_load_dwordx4 v[208:211], v3, s[22:23] offset:0
  global_load_dwordx4 v[212:215], v3, s[22:23] offset:1024
  global_load_dwordx4 v[216:219], v3, s[22:23] offset:2048
  global_load_dwordx4 v[220:223], v3, s[22:23] offset:3072
  v_cvt_pk_bf16_f32 v168, v152, v153
  v_cvt_pk_bf16_f32 v169, v154, v155
  v_cvt_pk_bf16_f32 v170, v156, v157
  v_cvt_pk_bf16_f32 v171, v158, v159
  v_exp_f32 v160, v160
  v_exp_f32 v161, v161
  v_exp_f32 v162, v162
  v_exp_f32 v163, v163
  v_mfma_f32_32x32x16_bf16 v[72:87], v[232:235], v[168:171], v[72:87]
  s_cbranch_vccnz .g2_kernel_a_L3g
.g2_kernel_a_L3h:
  ds_read_b128 v[32:35], v14 offset:2048
  ds_read_b128 v[36:39], v14 offset:3072
  v_exp_f32 v164, v164
  v_exp_f32 v165, v165
  v_exp_f32 v166, v166
  v_exp_f32 v167, v167
  v_cvt_pk_bf16_f32 v172, v160, v161
  v_cvt_pk_bf16_f32 v173, v162, v163
  v_cvt_pk_bf16_f32 v174, v164, v165
  v_cvt_pk_bf16_f32 v175, v166, v167
  v_mfma_f32_32x32x16_bf16 v[152:167], v[224:227], v[48:51], 0
  ds_write_b128 v9, v[56:59] offset:0
  v_add_f32 v6, v120, v121
  v_exp_f32 v136, v136
  v_exp_f32 v137, v137
  v_exp_f32 v138, v138
  v_mfma_f32_32x32x16_bf16 v[72:87], v[236:239], v[172:175], v[72:87]
  ds_write_b128 v9, v[60:63] offset:1024
  v_mov_b32 v120, 0
  v_exp_f32 v139, v139
  v_exp_f32 v140, v140
  v_exp_f32 v141, v141
  v_smfmac_f32_16x16x64_bf16 v[124:127], v[16:19], v[168:175], v20
  ds_write_b128 v9, v[64:67] offset:2048
  v_mov_b32 v121, 0
  v_exp_f32 v142, v142
  v_exp_f32 v143, v143
  v_mfma_f32_32x32x16_bf16 v[152:167], v[228:231], v[52:55], v[152:167]
  ds_read_b128 v[40:43], v14 offset:4096
  ds_write_b128 v9, v[68:71] offset:3072
  v_cvt_pk_bf16_f32 v168, v136, v137
  v_cvt_pk_bf16_f32 v169, v138, v139
  v_cvt_pk_bf16_f32 v170, v140, v141
  v_cvt_pk_bf16_f32 v171, v142, v143
  v_exp_f32 v144, v144
  v_exp_f32 v145, v145
  v_exp_f32 v146, v146
  v_exp_f32 v147, v147
  v_mfma_f32_32x32x16_bf16 v[88:103], v[232:235], v[168:171], v[88:103]
  s_waitcnt vmcnt(8)
  ds_read_b128 v[44:47], v14 offset:5120
  ds_write_b32 v10, v6 offset:0
  ds_write_b32 v11, v12 offset:0
  v_exp_f32 v148, v148
  v_exp_f32 v149, v149
  v_exp_f32 v150, v150
  v_exp_f32 v151, v151
  v_cvt_pk_bf16_f32 v172, v144, v145
  v_cvt_pk_bf16_f32 v173, v146, v147
  v_cvt_pk_bf16_f32 v174, v148, v149
  v_cvt_pk_bf16_f32 v175, v150, v151
  s_waitcnt lgkmcnt(10)
  v_mfma_f32_32x32x16_bf16 v[136:151], v[176:179], v[24:27], 0
  ds_write_b128 v9, v[72:75] offset:16384
  v_add_f32 v6, v124, v125
  v_exp_f32 v152, v152
  v_exp_f32 v153, v153
  v_exp_f32 v154, v154
  v_mfma_f32_32x32x16_bf16 v[88:103], v[236:239], v[172:175], v[88:103]
  ds_write_b128 v9, v[76:79] offset:17408
  v_mov_b32 v124, 0
  s_wakeup
  v_exp_f32 v155, v155
  v_exp_f32 v156, v156
  v_exp_f32 v157, v157
  v_smfmac_f32_16x16x64_bf16 v[128:131], v[16:19], v[168:175], v20
  ds_write_b128 v9, v[80:83] offset:18432
  v_mov_b32 v125, 0
  v_exp_f32 v158, v158
  v_exp_f32 v159, v159
  v_mfma_f32_32x32x16_bf16 v[136:151], v[180:183], v[28:31], v[136:151]
  ds_read_b128 v[48:51], v14 offset:6144
  ds_write_b128 v9, v[84:87] offset:19456
  v_cvt_pk_bf16_f32 v168, v152, v153
  v_cvt_pk_bf16_f32 v169, v154, v155
  v_cvt_pk_bf16_f32 v170, v156, v157
  v_cvt_pk_bf16_f32 v171, v158, v159
  v_exp_f32 v160, v160
  v_exp_f32 v161, v161
  v_exp_f32 v162, v162
  v_exp_f32 v163, v163
  v_mfma_f32_32x32x16_bf16 v[104:119], v[232:235], v[168:171], v[104:119]
  ds_read_b128 v[52:55], v14 offset:7168
  ds_write_b32 v10, v6 offset:512
  ds_write_b32 v11, v12 offset:16
  s_add_u32 s32, s32, 1
  v_exp_f32 v164, v164
  v_exp_f32 v165, v165
  v_exp_f32 v166, v166
  v_exp_f32 v167, v167
  v_cvt_pk_bf16_f32 v172, v160, v161
  v_cvt_pk_bf16_f32 v173, v162, v163
  v_cvt_pk_bf16_f32 v174, v164, v165
  v_cvt_pk_bf16_f32 v175, v166, v167
  s_cmp_eq_u32 s32, 8
  s_cbranch_scc1 .g2_kernel_a_end
  s_waitcnt lgkmcnt(15)
  v_mfma_f32_32x32x16_bf16 v[152:167], v[176:179], v[32:35], 0
  s_andn2_b32 s33, s36, s34
  ds_write_b128 v9, v[88:91] offset:32768
  v_add_f32 v6, v128, v129
  v_exp_f32 v136, v136
  v_exp_f32 v137, v137
  v_exp_f32 v138, v138
  v_mfma_f32_32x32x16_bf16 v[104:119], v[236:239], v[172:175], v[104:119]
  s_cbranch_scc0 .g2_kernel_a_G0c
.g2_kernel_a_G0b:
  ds_write_b128 v9, v[92:95] offset:33792
  v_mov_b32 v128, 0
  s_wakeup
  v_exp_f32 v139, v139
  v_exp_f32 v140, v140
  v_exp_f32 v141, v141
  v_smfmac_f32_16x16x64_bf16 v[132:135], v[16:19], v[168:175], v20
  s_ff1_i32_b32 s33, s33
  ds_write_b128 v9, v[96:99] offset:34816
  v_mov_b32 v129, 0
  v_exp_f32 v142, v142
  v_exp_f32 v143, v143
  v_mfma_f32_32x32x16_bf16 v[152:167], v[180:183], v[36:39], v[152:167]
  s_bitset1_b32 s34, s33
  ds_write_b128 v9, v[100:103] offset:35840
  v_cvt_pk_bf16_f32 v168, v136, v137
  v_cvt_pk_bf16_f32 v169, v138, v139
  v_cvt_pk_bf16_f32 v170, v140, v141
  v_cvt_pk_bf16_f32 v171, v142, v143
  v_exp_f32 v144, v144
  v_exp_f32 v145, v145
  v_exp_f32 v146, v146
  v_exp_f32 v147, v147
  s_waitcnt lgkmcnt(15)
  v_mfma_f32_32x32x16_bf16 v[56:71], v[184:187], v[168:171], 0
  s_xor_b32 s33, s33, s24
  ds_write_b32 v10, v6 offset:1024
  ds_write_b32 v11, v12 offset:32
  v_exp_f32 v148, v148
  v_exp_f32 v149, v149
  v_exp_f32 v150, v150
  v_exp_f32 v151, v151
  v_cvt_pk_bf16_f32 v172, v144, v145
  v_cvt_pk_bf16_f32 v173, v146, v147
  v_cvt_pk_bf16_f32 v174, v148, v149
  v_cvt_pk_bf16_f32 v175, v150, v151
  s_waitcnt lgkmcnt(15)
  v_mfma_f32_32x32x16_bf16 v[136:151], v[176:179], v[40:43], 0
  s_lshl_b32 s33, s33, s25
  ds_write_b128 v9, v[104:107] offset:49152
  v_add_f32 v6, v132, v133
  v_exp_f32 v152, v152
  v_exp_f32 v153, v153
  v_exp_f32 v154, v154
  v_mfma_f32_32x32x16_bf16 v[56:71], v[188:191], v[172:175], v[56:71]
  s_add_u32 s22, s20, s33
  ds_write_b128 v9, v[108:111] offset:50176
  v_mov_b32 v132, 0
  s_wakeup
  v_exp_f32 v155, v155
  v_exp_f32 v156, v156
  v_exp_f32 v157, v157
  v_smfmac_f32_16x16x64_bf16 v[120:123], v[16:19], v[168:175], v20
  s_addc_u32 s23, s21, 0
  ds_write_b128 v9, v[112:115] offset:51200
  v_mov_b32 v133, 0
  v_exp_f32 v158, v158
  v_exp_f32 v159, v159
  v_mfma_f32_32x32x16_bf16 v[136:151], v[180:183], v[44:47], v[136:151]
  global_load_dwordx4 v[224:227], v3, s[22:23] offset:0
  global_load_dwordx4 v[228:231], v3, s[22:23] offset:1024
  global_load_dwordx4 v[232:235], v3, s[22:23] offset:2048
  global_load_dwordx4 v[236:239], v3, s[22:23] offset:3072
  ds_write_b128 v9, v[116:119] offset:52224
  v_cvt_pk_bf16_f32 v168, v152, v153
  v_cvt_pk_bf16_f32 v169, v154, v155
  v_cvt_pk_bf16_f32 v170, v156, v157
  v_cvt_pk_bf16_f32 v171, v158, v159
  v_exp_f32 v160, v160
  v_exp_f32 v161, v161
  v_exp_f32 v162, v162
  v_exp_f32 v163, v163
  s_waitcnt lgkmcnt(13)
  v_mfma_f32_32x32x16_bf16 v[72:87], v[184:187], v[168:171], 0
  ds_write_b32 v10, v6 offset:1536
  ds_write_b32 v11, v12 offset:48
  v_exp_f32 v164, v164
  v_exp_f32 v165, v165
  v_exp_f32 v166, v166
  v_exp_f32 v167, v167
  v_cvt_pk_bf16_f32 v172, v160, v161
  v_cvt_pk_bf16_f32 v173, v162, v163
  v_cvt_pk_bf16_f32 v174, v164, v165
  v_cvt_pk_bf16_f32 v175, v166, v167
  s_waitcnt lgkmcnt(14)
  v_mfma_f32_32x32x16_bf16 v[152:167], v[176:179], v[48:51], 0
  v_add_u32 v12, 1, v12
  v_exp_f32 v136, v136
  v_exp_f32 v137, v137
  v_exp_f32 v138, v138
  v_mfma_f32_32x32x16_bf16 v[72:87], v[188:191], v[172:175], v[72:87]
  s_wakeup
  v_exp_f32 v139, v139
  v_exp_f32 v140, v140
  v_exp_f32 v141, v141
  v_smfmac_f32_16x16x64_bf16 v[124:127], v[16:19], v[168:175], v20
  s_mov_b32 s27, 8
  v_exp_f32 v142, v142
  v_exp_f32 v143, v143
  v_mfma_f32_32x32x16_bf16 v[152:167], v[180:183], v[52:55], v[152:167]
  v_cvt_pk_bf16_f32 v168, v136, v137
  v_cvt_pk_bf16_f32 v169, v138, v139
  v_cvt_pk_bf16_f32 v170, v140, v141
  v_cvt_pk_bf16_f32 v171, v142, v143
  v_exp_f32 v144, v144
  v_exp_f32 v145, v145
  v_exp_f32 v146, v146
  v_exp_f32 v147, v147
  s_waitcnt lgkmcnt(8)
  v_mfma_f32_32x32x16_bf16 v[88:103], v[184:187], v[168:171], 0
  s_waitcnt vmcnt(8)
  v_exp_f32 v148, v148
  v_exp_f32 v149, v149
  v_exp_f32 v150, v150
  v_exp_f32 v151, v151
  v_cvt_pk_bf16_f32 v172, v144, v145
  v_cvt_pk_bf16_f32 v173, v146, v147
  v_cvt_pk_bf16_f32 v174, v148, v149
  v_cvt_pk_bf16_f32 v175, v150, v151
  v_mfma_f32_32x32x16_bf16 v[136:151], v[192:195], v[24:27], 0
  v_exp_f32 v152, v152
  v_exp_f32 v153, v153
  v_exp_f32 v154, v154
  v_mfma_f32_32x32x16_bf16 v[88:103], v[188:191], v[172:175], v[88:103]
  v_exp_f32 v155, v155
  v_exp_f32 v156, v156
  v_exp_f32 v157, v157
  v_smfmac_f32_16x16x64_bf16 v[128:131], v[16:19], v[168:175], v20
  v_exp_f32 v158, v158
  v_exp_f32 v159, v159
  v_mfma_f32_32x32x16_bf16 v[136:151], v[196:199], v[28:31], v[136:151]
  v_cvt_pk_bf16_f32 v168, v152, v153
  v_cvt_pk_bf16_f32 v169, v154, v155
  v_cvt_pk_bf16_f32 v170, v156, v157
  v_cvt_pk_bf16_f32 v171, v158, v159
  v_exp_f32 v160, v160
  v_exp_f32 v161, v161
  v_exp_f32 v162, v162
  v_exp_f32 v163, v163
  s_waitcnt lgkmcnt(2)
  v_mfma_f32_32x32x16_bf16 v[104:119], v[184:187], v[168:171], 0
  v_exp_f32 v164, v164
  v_exp_f32 v165, v165
  v_exp_f32 v166, v166
  v_exp_f32 v167, v167
  v_cvt_pk_bf16_f32 v172, v160, v161
  v_cvt_pk_bf16_f32 v173, v162, v163
  v_cvt_pk_bf16_f32 v174, v164, v165
  v_cvt_pk_bf16_f32 v175, v166, v167
  s_branch .g2_kernel_a_n1
.g2_kernel_a_end:
  v_mfma_f32_32x32x16_bf16 v[104:119], v[236:239], v[172:175], v[104:119]
  v_smfmac_f32_16x16x64_bf16 v[132:135], v[16:19], v[168:175], v20
  s_wakeup
  ds_write_b128 v9, v[88:91] offset:32768
  v_add_f32 v6, v128, v129
  ds_write_b128 v9, v[92:95] offset:33792
  v_mov_b32 v128, 0
  ds_write_b128 v9, v[96:99] offset:34816
  v_mov_b32 v129, 0
  ds_write_b128 v9, v[100:103] offset:35840
  ds_write_b32 v10, v6 offset:1024
  ds_write_b32 v11, v12 offset:32
  s_nop 0
  ds_write_b128 v9, v[104:107] offset:49152
  v_add_f32 v6, v132, v133
  ds_write_b128 v9, v[108:111] offset:50176
  v_mov_b32 v132, 0
  ds_write_b128 v9, v[112:115] offset:51200
  v_mov_b32 v133, 0
  ds_write_b128 v9, v[116:119] offset:52224
  ds_write_b32 v10, v6 offset:1536
  ds_write_b32 v11, v12 offset:48
  s_waitcnt lgkmcnt(6)
  s_wakeup
  v_mov_b32 v20, s71
  v_lshrrev_b32 v17, 5, v2
  v_and_b32 v18, 31, v2
  s_lshl_b32 s28, s16, 5
  v_add_u32 v19, s28, v18
  v_lshlrev_b32 v7, 2, v19
  v_add_u32 v7, 155648, v7
  ds_read_b32 v8, v7 offset:3840
  ds_read_b32 v9, v7 offset:4352
  ds_read_b32 v16, v20 offset:24
  ds_read_b32 v6, v20 offset:52
  v_add_u32 v19, 1, v19
  v_bfe_u32 v7, v2, 2, 2
  v_lshl_add_u32 v14, v17, 2, v7
  v_lshlrev_b32 v14, 7, v14
  v_lshrrev_b32 v7, 1, v7
  v_lshl_add_u32 v14, v7, 6, v14
  v_bfe_u32 v7, v2, 4, 1
  v_lshl_add_u32 v14, v7, 5, v14
  v_and_b32 v7, 1, v2
  v_lshl_add_u32 v14, v7, 4, v14
  v_bfe_u32 v7, v2, 1, 1
  v_lshl_add_u32 v14, v7, 3, v14
  v_xor_b32 v15, 64, v14
  v_and_b32 v7, 7, v2
  v_xor_b32 v7, s24, v7
  s_lshl_b32 s28, s16, 6
  s_add_u32 s28, s28, 157952
  v_lshl_add_u32 v21, v7, 3, s28
  v_lshlrev_b32 v24, 16, v240
  v_and_b32 v25, 0xffff0000, v240
  v_lshlrev_b32 v26, 16, v241
  v_and_b32 v27, 0xffff0000, v241
  v_lshlrev_b32 v28, 16, v242
  v_and_b32 v29, 0xffff0000, v242
  v_lshlrev_b32 v30, 16, v243
  v_and_b32 v31, 0xffff0000, v243
  v_lshlrev_b32 v32, 16, v244
  v_and_b32 v33, 0xffff0000, v244
  v_lshlrev_b32 v34, 16, v245
  v_and_b32 v35, 0xffff0000, v245
  v_lshlrev_b32 v36, 16, v246
  v_and_b32 v37, 0xffff0000, v246
  v_lshlrev_b32 v38, 16, v247
  v_and_b32 v39, 0xffff0000, v247
  v_lshlrev_b32 v40, 16, v248
  v_and_b32 v41, 0xffff0000, v248
  v_lshlrev_b32 v42, 16, v249
  v_and_b32 v43, 0xffff0000, v249
  v_lshlrev_b32 v44, 16, v250
  v_and_b32 v45, 0xffff0000, v250
  v_lshlrev_b32 v46, 16, v251
  v_and_b32 v47, 0xffff0000, v251
  v_lshlrev_b32 v48, 16, v252
  v_and_b32 v49, 0xffff0000, v252
  v_lshlrev_b32 v50, 16, v253
  v_and_b32 v51, 0xffff0000, v253
  v_lshlrev_b32 v52, 16, v254
  v_and_b32 v53, 0xffff0000, v254
  v_lshlrev_b32 v54, 16, v255
  v_and_b32 v55, 0xffff0000, v255
  s_waitcnt lgkmcnt(0)
  s_wakeup
  v_cmp_gt_u32 vcc, 4, v6
  s_cbranch_vccnz .g2_kernel_w_aw
.g2_kernel_w_ab:
  s_xor_b32 s28, s24, 0
  s_lshl_b32 s28, s28, 13
  s_add_u32 s28, s28, 65536
  v_add_u32 v10, s28, v14
  v_add_u32 v11, s28, v15
  ds_read_b64_tr_b16 v[104:105], v10 offset:0
  ds_read_b64_tr_b16 v[106:107], v10 offset:1024
  ds_read_b64_tr_b16 v[108:109], v11 offset:0
  ds_read_b64_tr_b16 v[110:111], v11 offset:1024
  ds_read_b64_tr_b16 v[112:113], v10 offset:2048
  ds_read_b64_tr_b16 v[114:115], v10 offset:3072
  ds_read_b64_tr_b16 v[116:117], v11 offset:2048
  ds_read_b64_tr_b16 v[118:119], v11 offset:3072
  ds_read_b64_tr_b16 v[120:121], v10 offset:4096
  ds_read_b64_tr_b16 v[122:123], v10 offset:5120
  ds_read_b64_tr_b16 v[124:125], v11 offset:4096
  ds_read_b64_tr_b16 v[126:127], v11 offset:5120
  v_pk_fma_f32 v[24:25], v[24:25], v[8:9], v[8:9] op_sel:[0,0,1] op_sel_hi:[1,0,1]
  v_pk_fma_f32 v[26:27], v[26:27], v[8:9], v[8:9] op_sel:[0,0,1] op_sel_hi:[1,0,1]
  v_pk_fma_f32 v[28:29], v[28:29], v[8:9], v[8:9] op_sel:[0,0,1] op_sel_hi:[1,0,1]
  v_pk_fma_f32 v[30:31], v[30:31], v[8:9], v[8:9] op_sel:[0,0,1] op_sel_hi:[1,0,1]
  v_pk_fma_f32 v[32:33], v[32:33], v[8:9], v[8:9] op_sel:[0,0,1] op_sel_hi:[1,0,1]
  v_pk_fma_f32 v[34:35], v[34:35], v[8:9], v[8:9] op_sel:[0,0,1] op_sel_hi:[1,0,1]
  v_pk_fma_f32 v[36:37], v[36:37], v[8:9], v[8:9] op_sel:[0,0,1] op_sel_hi:[1,0,1]
  v_pk_fma_f32 v[38:39], v[38:39], v[8:9], v[8:9] op_sel:[0,0,1] op_sel_hi:[1,0,1]
  v_pk_fma_f32 v[40:41], v[40:41], v[8:9], v[8:9] op_sel:[0,0,1] op_sel_hi:[1,0,1]
  v_pk_fma_f32 v[42:43], v[42:43], v[8:9], v[8:9] op_sel:[0,0,1] op_sel_hi:[1,0,1]
  v_pk_fma_f32 v[44:45], v[44:45], v[8:9], v[8:9] op_sel:[0,0,1] op_sel_hi:[1,0,1]
  v_pk_fma_f32 v[46:47], v[46:47], v[8:9], v[8:9] op_sel:[0,0,1] op_sel_hi:[1,0,1]
  v_pk_fma_f32 v[48:49], v[48:49], v[8:9], v[8:9] op_sel:[0,0,1] op_sel_hi:[1,0,1]
  v_pk_fma_f32 v[50:51], v[50:51], v[8:9], v[8:9] op_sel:[0,0,1] op_sel_hi:[1,0,1]
  v_pk_fma_f32 v[52:53], v[52:53], v[8:9], v[8:9] op_sel:[0,0,1] op_sel_hi:[1,0,1]
  v_pk_fma_f32 v[54:55], v[54:55], v[8:9], v[8:9] op_sel:[0,0,1] op_sel_hi:[1,0,1]
  v_cmp_eq_u32 vcc, v16, v19
  s_cbranch_vccnz .g2_kernel_w_pt
.g2_kernel_w_pb:
  s_mov_b32 s72, s48
  s_mov_b32 s73, s49
  s_mov_b32 s74, 0x800
  s_mov_b32 s75, 0x00020000
  s_andn2_b32 s33, s36, s34
  s_ff1_i32_b32 s33, s33
  s_bitset1_b32 s34, s33
  s_xor_b32 s33, s33, s24
  s_lshl_b32 s33, s33, 12
  s_add_u32 s22, s20, s33
  s_addc_u32 s23, s21, 0
  global_load_dwordx4 v[224:227], v3, s[22:23] offset:0
  global_load_dwordx4 v[228:231], v3, s[22:23] offset:1024
  global_load_dwordx4 v[232:235], v3, s[22:23] offset:2048
  global_load_dwordx4 v[236:239], v3, s[22:23] offset:3072
  s_xor_b32 s28, s24, 1
  s_lshl_b32 s28, s28, 13
  s_add_u32 s28, s28, 65536
  v_add_u32 v12, s28, v14
  v_add_u32 v13, s28, v15
  s_waitcnt vmcnt(15) lgkmcnt(8)
  v_mfma_f32_32x32x16_bf16 v[24:39], v[104:107], v[176:179], v[24:39]
  ds_read_b64_tr_b16 v[128:129], v10 offset:6144
  ds_read_b64_tr_b16 v[130:131], v10 offset:7168
  v_mfma_f32_32x32x16_bf16 v[40:55], v[108:111], v[176:179], v[40:55]
  ds_read_b64_tr_b16 v[132:133], v11 offset:6144
  ds_read_b64_tr_b16 v[134:135], v11 offset:7168
  s_waitcnt vmcnt(14) lgkmcnt(8)
  v_mfma_f32_32x32x16_bf16 v[24:39], v[112:115], v[180:183], v[24:39]
  ds_read_b64_tr_b16 v[104:105], v12 offset:0
  ds_read_b64_tr_b16 v[106:107], v12 offset:1024
  v_mfma_f32_32x32x16_bf16 v[40:55], v[116:119], v[180:183], v[40:55]
  ds_read_b64_tr_b16 v[108:109], v13 offset:0
  ds_read_b64_tr_b16 v[110:111], v13 offset:1024
  s_waitcnt vmcnt(13) lgkmcnt(8)
  v_mfma_f32_32x32x16_bf16 v[24:39], v[120:123], v[184:187], v[24:39]
  ds_read_b64_tr_b16 v[112:113], v12 offset:2048
  ds_read_b64_tr_b16 v[114:115], v12 offset:3072
  v_mfma_f32_32x32x16_bf16 v[40:55], v[124:127], v[184:187], v[40:55]
  ds_read_b64_tr_b16 v[116:117], v13 offset:2048
  ds_read_b64_tr_b16 v[118:119], v13 offset:3072
  s_waitcnt vmcnt(12) lgkmcnt(8)
  v_mfma_f32_32x32x16_bf16 v[24:39], v[128:131], v[188:191], v[24:39]
  ds_read_b64_tr_b16 v[120:121], v12 offset:4096
  ds_read_b64_tr_b16 v[122:123], v12 offset:5120
  v_mfma_f32_32x32x16_bf16 v[40:55], v[132:135], v[188:191], v[40:55]
  ds_read_b64_tr_b16 v[124:125], v13 offset:4096
  ds_read_b64_tr_b16 v[126:127], v13 offset:5120
  s_andn2_b32 s33, s36, s34
  s_ff1_i32_b32 s33, s33
  s_bitset1_b32 s34, s33
  s_xor_b32 s33, s33, s24
  s_lshl_b32 s33, s33, 12
  s_add_u32 s22, s20, s33
  s_addc_u32 s23, s21, 0
  global_load_dwordx4 v[136:139], v3, s[22:23] offset:0
  global_load_dwordx4 v[140:143], v3, s[22:23] offset:1024
  global_load_dwordx4 v[144:147], v3, s[22:23] offset:2048
  global_load_dwordx4 v[148:151], v3, s[22:23] offset:3072
  s_xor_b32 s28, s24, 2
  s_lshl_b32 s28, s28, 13
  s_add_u32 s28, s28, 65536
  v_add_u32 v10, s28, v14
  v_add_u32 v11, s28, v15
  s_waitcnt vmcnt(15) lgkmcnt(8)
  v_mfma_f32_32x32x16_bf16 v[24:39], v[104:107], v[192:195], v[24:39]
  ds_read_b64_tr_b16 v[128:129], v12 offset:6144
  ds_read_b64_tr_b16 v[130:131], v12 offset:7168
  v_mfma_f32_32x32x16_bf16 v[40:55], v[108:111], v[192:195], v[40:55]
  ds_read_b64_tr_b16 v[132:133], v13 offset:6144
  ds_read_b64_tr_b16 v[134:135], v13 offset:7168
  s_waitcnt vmcnt(14) lgkmcnt(8)
  v_mfma_f32_32x32x16_bf16 v[24:39], v[112:115], v[196:199], v[24:39]
  ds_read_b64_tr_b16 v[104:105], v10 offset:0
  ds_read_b64_tr_b16 v[106:107], v10 offset:1024
  v_mfma_f32_32x32x16_bf16 v[40:55], v[116:119], v[196:199], v[40:55]
  ds_read_b64_tr_b16 v[108:109], v11 offset:0
  ds_read_b64_tr_b16 v[110:111], v11 offset:1024
  s_waitcnt vmcnt(13) lgkmcnt(8)
  v_mfma_f32_32x32x16_bf16 v[24:39], v[120:123], v[200:203], v[24:39]
  ds_read_b64_tr_b16 v[112:113], v10 offset:2048
  ds_read_b64_tr_b16 v[114:115], v10 offset:3072
  v_mfma_f32_32x32x16_bf16 v[40:55], v[124:127], v[200:203], v[40:55]
  ds_read_b64_tr_b16 v[116:117], v11 offset:2048
  ds_read_b64_tr_b16 v[118:119], v11 offset:3072
  s_waitcnt vmcnt(12) lgkmcnt(8)
  v_mfma_f32_32x32x16_bf16 v[24:39], v[128:131], v[204:207], v[24:39]
  ds_read_b64_tr_b16 v[120:121], v10 offset:4096
  ds_read_b64_tr_b16 v[122:123], v10 offset:5120
  v_mfma_f32_32x32x16_bf16 v[40:55], v[132:135], v[204:207], v[40:55]
  ds_read_b64_tr_b16 v[124:125], v11 offset:4096
  ds_read_b64_tr_b16 v[126:127], v11 offset:5120
  s_andn2_b32 s33, s36, s34
  s_ff1_i32_b32 s33, s33
  s_bitset1_b32 s34, s33
  s_xor_b32 s33, s33, s24
  s_lshl_b32 s33, s33, 12
  s_add_u32 s22, s20, s33
  s_addc_u32 s23, s21, 0
  global_load_dwordx4 v[152:155], v3, s[22:23] offset:0
  global_load_dwordx4 v[156:159], v3, s[22:23] offset:1024
  global_load_dwordx4 v[160:163], v3, s[22:23] offset:2048
  global_load_dwordx4 v[164:167], v3, s[22:23] offset:3072
  s_xor_b32 s28, s24, 3
  s_lshl_b32 s28, s28, 13
  s_add_u32 s28, s28, 65536
  v_add_u32 v12, s28, v14
  v_add_u32 v13, s28, v15
  s_waitcnt vmcnt(15) lgkmcnt(8)
  v_mfma_f32_32x32x16_bf16 v[24:39], v[104:107], v[208:211], v[24:39]
  ds_read_b64_tr_b16 v[128:129], v10 offset:6144
  ds_read_b64_tr_b16 v[130:131], v10 offset:7168
  v_mfma_f32_32x32x16_bf16 v[40:55], v[108:111], v[208:211], v[40:55]
  ds_read_b64_tr_b16 v[132:133], v11 offset:6144
  ds_read_b64_tr_b16 v[134:135], v11 offset:7168
  s_waitcnt vmcnt(14) lgkmcnt(8)
  v_mfma_f32_32x32x16_bf16 v[24:39], v[112:115], v[212:215], v[24:39]
  ds_read_b64_tr_b16 v[104:105], v12 offset:0
  ds_read_b64_tr_b16 v[106:107], v12 offset:1024
  v_mfma_f32_32x32x16_bf16 v[40:55], v[116:119], v[212:215], v[40:55]
  ds_read_b64_tr_b16 v[108:109], v13 offset:0
  ds_read_b64_tr_b16 v[110:111], v13 offset:1024
  s_waitcnt vmcnt(13) lgkmcnt(8)
  v_mfma_f32_32x32x16_bf16 v[24:39], v[120:123], v[216:219], v[24:39]
  ds_read_b64_tr_b16 v[112:113], v12 offset:2048
  ds_read_b64_tr_b16 v[114:115], v12 offset:3072
  v_mfma_f32_32x32x16_bf16 v[40:55], v[124:127], v[216:219], v[40:55]
  ds_read_b64_tr_b16 v[116:117], v13 offset:2048
  ds_read_b64_tr_b16 v[118:119], v13 offset:3072
  s_waitcnt vmcnt(12) lgkmcnt(8)
  v_mfma_f32_32x32x16_bf16 v[24:39], v[128:131], v[220:223], v[24:39]
  ds_read_b64_tr_b16 v[120:121], v12 offset:4096
  ds_read_b64_tr_b16 v[122:123], v12 offset:5120
  v_mfma_f32_32x32x16_bf16 v[40:55], v[132:135], v[220:223], v[40:55]
  ds_read_b64_tr_b16 v[124:125], v13 offset:4096
  ds_read_b64_tr_b16 v[126:127], v13 offset:5120
  s_andn2_b32 s33, s36, s34
  s_ff1_i32_b32 s33, s33
  s_bitset1_b32 s34, s33
  s_xor_b32 s33, s33, s24
  s_lshl_b32 s33, s33, 12
  s_add_u32 s22, s20, s33
  s_addc_u32 s23, s21, 0
  global_load_dwordx4 v[56:59], v3, s[22:23] offset:0
  global_load_dwordx4 v[60:63], v3, s[22:23] offset:1024
  global_load_dwordx4 v[64:67], v3, s[22:23] offset:2048
  global_load_dwordx4 v[68:71], v3, s[22:23] offset:3072
  s_xor_b32 s28, s24, 4
  s_lshl_b32 s28, s28, 13
  s_add_u32 s28, s28, 65536
  v_add_u32 v10, s28, v14
  v_add_u32 v11, s28, v15
  s_waitcnt vmcnt(15) lgkmcnt(8)
  v_mfma_f32_32x32x16_bf16 v[24:39], v[104:107], v[224:227], v[24:39]
  ds_read_b64_tr_b16 v[128:129], v12 offset:6144
  ds_read_b64_tr_b16 v[130:131], v12 offset:7168
  v_mfma_f32_32x32x16_bf16 v[40:55], v[108:111], v[224:227], v[40:55]
  ds_read_b64_tr_b16 v[132:133], v13 offset:6144
  ds_read_b64_tr_b16 v[134:135], v13 offset:7168
  s_waitcnt vmcnt(14) lgkmcnt(8)
  v_mfma_f32_32x32x16_bf16 v[24:39], v[112:115], v[228:231], v[24:39]
  ds_read_b64_tr_b16 v[104:105], v10 offset:0
  ds_read_b64_tr_b16 v[106:107], v10 offset:1024
  v_mfma_f32_32x32x16_bf16 v[40:55], v[116:119], v[228:231], v[40:55]
  ds_read_b64_tr_b16 v[108:109], v11 offset:0
  ds_read_b64_tr_b16 v[110:111], v11 offset:1024
  s_waitcnt vmcnt(13) lgkmcnt(8)
  v_mfma_f32_32x32x16_bf16 v[24:39], v[120:123], v[232:235], v[24:39]
  ds_read_b64_tr_b16 v[112:113], v10 offset:2048
  ds_read_b64_tr_b16 v[114:115], v10 offset:3072
  v_mfma_f32_32x32x16_bf16 v[40:55], v[124:127], v[232:235], v[40:55]
  ds_read_b64_tr_b16 v[116:117], v11 offset:2048
  ds_read_b64_tr_b16 v[118:119], v11 offset:3072
  s_waitcnt vmcnt(12) lgkmcnt(8)
  v_mfma_f32_32x32x16_bf16 v[24:39], v[128:131], v[236:239], v[24:39]
  ds_read_b64_tr_b16 v[120:121], v10 offset:4096
  ds_read_b64_tr_b16 v[122:123], v10 offset:5120
  v_mfma_f32_32x32x16_bf16 v[40:55], v[132:135], v[236:239], v[40:55]
  ds_read_b64_tr_b16 v[124:125], v11 offset:4096
  ds_read_b64_tr_b16 v[126:127], v11 offset:5120
  s_andn2_b32 s33, s36, s34
  s_ff1_i32_b32 s33, s33
  s_bitset1_b32 s34, s33
  s_xor_b32 s33, s33, s24
  s_lshl_b32 s33, s33, 12
  s_add_u32 s22, s20, s33
  s_addc_u32 s23, s21, 0
  global_load_dwordx4 v[72:75], v3, s[22:23] offset:0
  global_load_dwordx4 v[76:79], v3, s[22:23] offset:1024
  global_load_dwordx4 v[80:83], v3, s[22:23] offset:2048
  global_load_dwordx4 v[84:87], v3, s[22:23] offset:3072
  s_xor_b32 s28, s24, 5
  s_lshl_b32 s28, s28, 13
  s_add_u32 s28, s28, 65536
  v_add_u32 v12, s28, v14
  v_add_u32 v13, s28, v15
  s_waitcnt vmcnt(15) lgkmcnt(8)
  v_mfma_f32_32x32x16_bf16 v[24:39], v[104:107], v[136:139], v[24:39]
  ds_read_b64_tr_b16 v[128:129], v10 offset:6144
  ds_read_b64_tr_b16 v[130:131], v10 offset:7168
  v_mfma_f32_32x32x16_bf16 v[40:55], v[108:111], v[136:139], v[40:55]
  ds_read_b64_tr_b16 v[132:133], v11 offset:6144
  ds_read_b64_tr_b16 v[134:135], v11 offset:7168
  s_waitcnt vmcnt(14) lgkmcnt(8)
  v_mfma_f32_32x32x16_bf16 v[24:39], v[112:115], v[140:143], v[24:39]
  ds_read_b64_tr_b16 v[104:105], v12 offset:0
  ds_read_b64_tr_b16 v[106:107], v12 offset:1024
  v_mfma_f32_32x32x16_bf16 v[40:55], v[116:119], v[140:143], v[40:55]
  ds_read_b64_tr_b16 v[108:109], v13 offset:0
  ds_read_b64_tr_b16 v[110:111], v13 offset:1024
  s_waitcnt vmcnt(13) lgkmcnt(8)
  v_mfma_f32_32x32x16_bf16 v[24:39], v[120:123], v[144:147], v[24:39]
  ds_read_b64_tr_b16 v[112:113], v12 offset:2048
  ds_read_b64_tr_b16 v[114:115], v12 offset:3072
  v_mfma_f32_32x32x16_bf16 v[40:55], v[124:127], v[144:147], v[40:55]
  ds_read_b64_tr_b16 v[116:117], v13 offset:2048
  ds_read_b64_tr_b16 v[118:119], v13 offset:3072
  s_waitcnt vmcnt(12) lgkmcnt(8)
  v_mfma_f32_32x32x16_bf16 v[24:39], v[128:131], v[148:151], v[24:39]
  ds_read_b64_tr_b16 v[120:121], v12 offset:4096
  ds_read_b64_tr_b16 v[122:123], v12 offset:5120
  v_mfma_f32_32x32x16_bf16 v[40:55], v[132:135], v[148:151], v[40:55]
  ds_read_b64_tr_b16 v[124:125], v13 offset:4096
  ds_read_b64_tr_b16 v[126:127], v13 offset:5120
  v_lshlrev_b32 v7, 4, v17
  s_lshl_b32 s28, s18, 7
  buffer_load_dwordx4 v[240:243], v7, s[72:75], s28 offen offset:0
  buffer_load_dwordx4 v[244:247], v7, s[72:75], s28 offen offset:32
  buffer_load_dwordx4 v[248:251], v7, s[72:75], s28 offen offset:64
  buffer_load_dwordx4 v[252:255], v7, s[72:75], s28 offen offset:96
  s_xor_b32 s28, s24, 6
  s_lshl_b32 s28, s28, 13
  s_add_u32 s28, s28, 65536
  v_add_u32 v10, s28, v14
  v_add_u32 v11, s28, v15
  s_waitcnt vmcnt(15) lgkmcnt(8)
  v_mfma_f32_32x32x16_bf16 v[24:39], v[104:107], v[152:155], v[24:39]
  ds_read_b64_tr_b16 v[128:129], v12 offset:6144
  ds_read_b64_tr_b16 v[130:131], v12 offset:7168
  v_mfma_f32_32x32x16_bf16 v[40:55], v[108:111], v[152:155], v[40:55]
  ds_read_b64_tr_b16 v[132:133], v13 offset:6144
  ds_read_b64_tr_b16 v[134:135], v13 offset:7168
  s_waitcnt vmcnt(14) lgkmcnt(8)
  v_mfma_f32_32x32x16_bf16 v[24:39], v[112:115], v[156:159], v[24:39]
  ds_read_b64_tr_b16 v[104:105], v10 offset:0
  ds_read_b64_tr_b16 v[106:107], v10 offset:1024
  v_mfma_f32_32x32x16_bf16 v[40:55], v[116:119], v[156:159], v[40:55]
  ds_read_b64_tr_b16 v[108:109], v11 offset:0
  ds_read_b64_tr_b16 v[110:111], v11 offset:1024
  s_waitcnt vmcnt(13) lgkmcnt(8)
  v_mfma_f32_32x32x16_bf16 v[24:39], v[120:123], v[160:163], v[24:39]
  ds_read_b64_tr_b16 v[112:113], v10 offset:2048
  ds_read_b64_tr_b16 v[114:115], v10 offset:3072
  v_mfma_f32_32x32x16_bf16 v[40:55], v[124:127], v[160:163], v[40:55]
  ds_read_b64_tr_b16 v[116:117], v11 offset:2048
  ds_read_b64_tr_b16 v[118:119], v11 offset:3072
  s_waitcnt vmcnt(12) lgkmcnt(8)
  v_mfma_f32_32x32x16_bf16 v[24:39], v[128:131], v[164:167], v[24:39]
  ds_read_b64_tr_b16 v[120:121], v10 offset:4096
  ds_read_b64_tr_b16 v[122:123], v10 offset:5120
  v_mfma_f32_32x32x16_bf16 v[40:55], v[132:135], v[164:167], v[40:55]
  ds_read_b64_tr_b16 v[124:125], v11 offset:4096
  ds_read_b64_tr_b16 v[126:127], v11 offset:5120
  s_xor_b32 s28, s24, 7
  s_lshl_b32 s28, s28, 13
  s_add_u32 s28, s28, 65536
  v_add_u32 v12, s28, v14
  v_add_u32 v13, s28, v15
  s_waitcnt vmcnt(11) lgkmcnt(8)
  v_mfma_f32_32x32x16_bf16 v[24:39], v[104:107], v[56:59], v[24:39]
  ds_read_b64_tr_b16 v[128:129], v10 offset:6144
  ds_read_b64_tr_b16 v[130:131], v10 offset:7168
  v_mfma_f32_32x32x16_bf16 v[40:55], v[108:111], v[56:59], v[40:55]
  ds_read_b64_tr_b16 v[132:133], v11 offset:6144
  ds_read_b64_tr_b16 v[134:135], v11 offset:7168
  s_waitcnt vmcnt(10) lgkmcnt(8)
  v_mfma_f32_32x32x16_bf16 v[24:39], v[112:115], v[60:63], v[24:39]
  ds_read_b64_tr_b16 v[104:105], v12 offset:0
  ds_read_b64_tr_b16 v[106:107], v12 offset:1024
  v_mfma_f32_32x32x16_bf16 v[40:55], v[116:119], v[60:63], v[40:55]
  ds_read_b64_tr_b16 v[108:109], v13 offset:0
  ds_read_b64_tr_b16 v[110:111], v13 offset:1024
  s_waitcnt vmcnt(9) lgkmcnt(8)
  v_mfma_f32_32x32x16_bf16 v[24:39], v[120:123], v[64:67], v[24:39]
  ds_read_b64_tr_b16 v[112:113], v12 offset:2048
  ds_read_b64_tr_b16 v[114:115], v12 offset:3072
  v_mfma_f32_32x32x16_bf16 v[40:55], v[124:127], v[64:67], v[40:55]
  ds_read_b64_tr_b16 v[116:117], v13 offset:2048
  ds_read_b64_tr_b16 v[118:119], v13 offset:3072
  s_waitcnt vmcnt(8) lgkmcnt(8)
  v_mfma_f32_32x32x16_bf16 v[24:39], v[128:131], v[68:71], v[24:39]
  ds_read_b64_tr_b16 v[120:121], v12 offset:4096
  ds_read_b64_tr_b16 v[122:123], v12 offset:5120
  v_mfma_f32_32x32x16_bf16 v[40:55], v[132:135], v[68:71], v[40:55]
  ds_read_b64_tr_b16 v[124:125], v13 offset:4096
  ds_read_b64_tr_b16 v[126:127], v13 offset:5120
  s_waitcnt vmcnt(7) lgkmcnt(8)
  v_mfma_f32_32x32x16_bf16 v[24:39], v[104:107], v[72:75], v[24:39]
  ds_read_b64_tr_b16 v[128:129], v12 offset:6144
  ds_read_b64_tr_b16 v[130:131], v12 offset:7168
  v_mfma_f32_32x32x16_bf16 v[40:55], v[108:111], v[72:75], v[40:55]
  ds_read_b64_tr_b16 v[132:133], v13 offset:6144
  ds_read_b64_tr_b16 v[134:135], v13 offset:7168
  s_waitcnt vmcnt(6) lgkmcnt(8)
  v_mfma_f32_32x32x16_bf16 v[24:39], v[112:115], v[76:79], v[24:39]
  v_mfma_f32_32x32x16_bf16 v[40:55], v[116:119], v[76:79], v[40:55]
  s_waitcnt vmcnt(5) lgkmcnt(4)
  v_mfma_f32_32x32x16_bf16 v[24:39], v[120:123], v[80:83], v[24:39]
  v_mfma_f32_32x32x16_bf16 v[40:55], v[124:127], v[80:83], v[40:55]
  s_waitcnt vmcnt(4) lgkmcnt(0)
  v_mfma_f32_32x32x16_bf16 v[24:39], v[128:131], v[84:87], v[24:39]
  v_mfma_f32_32x32x16_bf16 v[40:55], v[132:135], v[84:87], v[40:55]
  s_andn2_b32 s33, s36, s34
  s_cbranch_scc0 .g2_kernel_w_i8c
.g2_kernel_w_i8b:
  s_ff1_i32_b32 s33, s33
  s_bitset1_b32 s34, s33
  s_xor_b32 s33, s33, s24
  s_and_b32 s8, s33, 7
  s_cmp_lt_u32 s8, 2
  s_cselect_b32 s28, 139264, 0
  s_lshl_b32 s8, s8, 13
  s_add_u32 s8, s8, s28
  s_lshl_b32 s33, s33, 12
  s_add_u32 s22, s20, s33
  s_addc_u32 s23, s21, 0
  global_load_dwordx4 v[88:91], v3, s[22:23] offset:0
  global_load_dwordx4 v[92:95], v3, s[22:23] offset:1024
  global_load_dwordx4 v[96:99], v3, s[22:23] offset:2048
  global_load_dwordx4 v[100:103], v3, s[22:23] offset:3072
  s_andn2_b32 s33, s36, s34
  s_cbranch_scc0 .g2_kernel_w_i9c
.g2_kernel_w_i9b:
  s_ff1_i32_b32 s33, s33
  s_bitset1_b32 s34, s33
  s_xor_b32 s33, s33, s24
  s_and_b32 s9, s33, 7
  s_cmp_lt_u32 s9, 2
  s_cselect_b32 s28, 139264, 0
  s_lshl_b32 s9, s9, 13
  s_add_u32 s9, s9, s28
  s_lshl_b32 s33, s33, 12
  s_add_u32 s22, s20, s33
  s_addc_u32 s23, s21, 0
  global_load_dwordx4 v[176:179], v3, s[22:23] offset:0
  global_load_dwordx4 v[180:183], v3, s[22:23] offset:1024
  global_load_dwordx4 v[184:187], v3, s[22:23] offset:2048
  global_load_dwordx4 v[188:191], v3, s[22:23] offset:3072
  s_andn2_b32 s33, s36, s34
  s_cbranch_scc0 .g2_kernel_w_i10c
.g2_kernel_w_i10b:
  s_ff1_i32_b32 s33, s33
  s_bitset1_b32 s34, s33
  s_xor_b32 s33, s33, s24
  s_and_b32 s10, s33, 7
  s_cmp_lt_u32 s10, 2
  s_cselect_b32 s28, 139264, 0
  s_lshl_b32 s10, s10, 13
  s_add_u32 s10, s10, s28
  s_lshl_b32 s33, s33, 12
  s_add_u32 s22, s20, s33
  s_addc_u32 s23, s21, 0
  global_load_dwordx4 v[192:195], v3, s[22:23] offset:0
  global_load_dwordx4 v[196:199], v3, s[22:23] offset:1024
  global_load_dwordx4 v[200:203], v3, s[22:23] offset:2048
  global_load_dwordx4 v[204:207], v3, s[22:23] offset:3072
  s_andn2_b32 s33, s36, s34
  s_cbranch_scc0 .g2_kernel_w_i11c
.g2_kernel_w_i11b:
  s_ff1_i32_b32 s33, s33
  s_bitset1_b32 s34, s33
  s_xor_b32 s33, s33, s24
  s_and_b32 s11, s33, 7
  s_cmp_lt_u32 s11, 2
  s_cselect_b32 s28, 139264, 0
  s_lshl_b32 s11, s11, 13
  s_add_u32 s11, s11, s28
  s_lshl_b32 s33, s33, 12
  s_add_u32 s22, s20, s33
  s_addc_u32 s23, s21, 0
  global_load_dwordx4 v[208:211], v3, s[22:23] offset:0
  global_load_dwordx4 v[212:215], v3, s[22:23] offset:1024
  global_load_dwordx4 v[216:219], v3, s[22:23] offset:2048
  global_load_dwordx4 v[220:223], v3, s[22:23] offset:3072
  s_andn2_b32 s33, s36, s34
  s_cbranch_scc0 .g2_kernel_w_i12c
.g2_kernel_w_i12b:
  s_ff1_i32_b32 s33, s33
  s_bitset1_b32 s34, s33
  s_xor_b32 s33, s33, s24
  s_and_b32 s12, s33, 7
  s_cmp_lt_u32 s12, 2
  s_cselect_b32 s28, 139264, 0
  s_lshl_b32 s12, s12, 13
  s_add_u32 s12, s12, s28
  s_lshl_b32 s33, s33, 12
  s_add_u32 s22, s20, s33
  s_addc_u32 s23, s21, 0
  global_load_dwordx4 v[224:227], v3, s[22:23] offset:0
  global_load_dwordx4 v[228:231], v3, s[22:23] offset:1024
  global_load_dwordx4 v[232:235], v3, s[22:23] offset:2048
  global_load_dwordx4 v[236:239], v3, s[22:23] offset:3072
  s_andn2_b32 s33, s36, s34
  s_cbranch_scc0 .g2_kernel_w_i13c
.g2_kernel_w_i13b:
  s_ff1_i32_b32 s33, s33
  s_bitset1_b32 s34, s33
  s_xor_b32 s33, s33, s24
  s_and_b32 s13, s33, 7
  s_cmp_lt_u32 s13, 2
  s_cselect_b32 s28, 139264, 0
  s_lshl_b32 s13, s13, 13
  s_add_u32 s13, s13, s28
  s_lshl_b32 s33, s33, 12
  s_add_u32 s22, s20, s33
  s_addc_u32 s23, s21, 0
  global_load_dwordx4 v[136:139], v3, s[22:23] offset:0
  global_load_dwordx4 v[140:143], v3, s[22:23] offset:1024
  global_load_dwordx4 v[144:147], v3, s[22:23] offset:2048
  global_load_dwordx4 v[148:151], v3, s[22:23] offset:3072
  ds_read_b32 v16, v20 offset:12
  v_add_u32 v10, s8, v14
  v_add_u32 v11, s8, v15
  s_waitcnt lgkmcnt(0)
  v_cmp_gt_u32 vcc, 4, v16
  s_cbranch_vccnz .g2_kernel_w_bw
.g2_kernel_w_bb:
  ds_read_b64_tr_b16 v[104:105], v10 offset:0
  ds_read_b64_tr_b16 v[106:107], v10 offset:1024
  ds_read_b64_tr_b16 v[108:109], v11 offset:0
  ds_read_b64_tr_b16 v[110:111], v11 offset:1024
  ds_read_b64_tr_b16 v[112:113], v10 offset:2048
  ds_read_b64_tr_b16 v[114:115], v10 offset:3072
  ds_read_b64_tr_b16 v[116:117], v11 offset:2048
  ds_read_b64_tr_b16 v[118:119], v11 offset:3072
  ds_read_b64_tr_b16 v[120:121], v10 offset:4096
  ds_read_b64_tr_b16 v[122:123], v10 offset:5120
  ds_read_b64_tr_b16 v[124:125], v11 offset:4096
  ds_read_b64_tr_b16 v[126:127], v11 offset:5120
  v_add_u32 v12, s9, v14
  v_add_u32 v13, s9, v15
  s_waitcnt vmcnt(23) lgkmcnt(8)
  v_mfma_f32_32x32x16_bf16 v[24:39], v[104:107], v[88:91], v[24:39]
  ds_read_b64_tr_b16 v[128:129], v10 offset:6144
  ds_read_b64_tr_b16 v[130:131], v10 offset:7168
  v_mfma_f32_32x32x16_bf16 v[40:55], v[108:111], v[88:91], v[40:55]
  ds_read_b64_tr_b16 v[132:133], v11 offset:6144
  ds_read_b64_tr_b16 v[134:135], v11 offset:7168
  s_waitcnt vmcnt(22) lgkmcnt(8)
  v_mfma_f32_32x32x16_bf16 v[24:39], v[112:115], v[92:95], v[24:39]
  ds_read_b64_tr_b16 v[104:105], v12 offset:0
  ds_read_b64_tr_b16 v[106:107], v12 offset:1024
  v_mfma_f32_32x32x16_bf16 v[40:55], v[116:119], v[92:95], v[40:55]
  ds_read_b64_tr_b16 v[108:109], v13 offset:0
  ds_read_b64_tr_b16 v[110:111], v13 offset:1024
  s_waitcnt vmcnt(21) lgkmcnt(8)
  v_mfma_f32_32x32x16_bf16 v[24:39], v[120:123], v[96:99], v[24:39]
  ds_read_b64_tr_b16 v[112:113], v12 offset:2048
  ds_read_b64_tr_b16 v[114:115], v12 offset:3072
  v_mfma_f32_32x32x16_bf16 v[40:55], v[124:127], v[96:99], v[40:55]
  ds_read_b64_tr_b16 v[116:117], v13 offset:2048
  ds_read_b64_tr_b16 v[118:119], v13 offset:3072
  s_waitcnt vmcnt(20) lgkmcnt(8)
  v_mfma_f32_32x32x16_bf16 v[24:39], v[128:131], v[100:103], v[24:39]
  ds_read_b64_tr_b16 v[120:121], v12 offset:4096
  ds_read_b64_tr_b16 v[122:123], v12 offset:5120
  v_mfma_f32_32x32x16_bf16 v[40:55], v[132:135], v[100:103], v[40:55]
  ds_read_b64_tr_b16 v[124:125], v13 offset:4096
  ds_read_b64_tr_b16 v[126:127], v13 offset:5120
  s_andn2_b32 s33, s36, s34
  s_cbranch_scc0 .g2_kernel_w_i14c
.g2_kernel_w_i14b:
  s_ff1_i32_b32 s33, s33
  s_bitset1_b32 s34, s33
  s_xor_b32 s33, s33, s24
  s_and_b32 s14, s33, 7
  s_cmp_lt_u32 s14, 2
  s_cselect_b32 s28, 139264, 0
  s_lshl_b32 s14, s14, 13
  s_add_u32 s14, s14, s28
  s_lshl_b32 s33, s33, 12
  s_add_u32 s22, s20, s33
  s_addc_u32 s23, s21, 0
  global_load_dwordx4 v[152:155], v3, s[22:23] offset:0
  global_load_dwordx4 v[156:159], v3, s[22:23] offset:1024
  global_load_dwordx4 v[160:163], v3, s[22:23] offset:2048
  global_load_dwordx4 v[164:167], v3, s[22:23] offset:3072
  v_add_u32 v10, s10, v14
  v_add_u32 v11, s10, v15
  s_waitcnt vmcnt(23) lgkmcnt(8)
  v_mfma_f32_32x32x16_bf16 v[24:39], v[104:107], v[176:179], v[24:39]
  ds_read_b64_tr_b16 v[128:129], v12 offset:6144
  ds_read_b64_tr_b16 v[130:131], v12 offset:7168
  v_mfma_f32_32x32x16_bf16 v[40:55], v[108:111], v[176:179], v[40:55]
  ds_read_b64_tr_b16 v[132:133], v13 offset:6144
  ds_read_b64_tr_b16 v[134:135], v13 offset:7168
  s_waitcnt vmcnt(22) lgkmcnt(8)
  v_mfma_f32_32x32x16_bf16 v[24:39], v[112:115], v[180:183], v[24:39]
  ds_read_b64_tr_b16 v[104:105], v10 offset:0
  ds_read_b64_tr_b16 v[106:107], v10 offset:1024
  v_mfma_f32_32x32x16_bf16 v[40:55], v[116:119], v[180:183], v[40:55]
  ds_read_b64_tr_b16 v[108:109], v11 offset:0
  ds_read_b64_tr_b16 v[110:111], v11 offset:1024
  s_waitcnt vmcnt(21) lgkmcnt(8)
  v_mfma_f32_32x32x16_bf16 v[24:39], v[120:123], v[184:187], v[24:39]
  ds_read_b64_tr_b16 v[112:113], v10 offset:2048
  ds_read_b64_tr_b16 v[114:115], v10 offset:3072
  v_mfma_f32_32x32x16_bf16 v[40:55], v[124:127], v[184:187], v[40:55]
  ds_read_b64_tr_b16 v[116:117], v11 offset:2048
  ds_read_b64_tr_b16 v[118:119], v11 offset:3072
  s_waitcnt vmcnt(20) lgkmcnt(8)
  v_mfma_f32_32x32x16_bf16 v[24:39], v[128:131], v[188:191], v[24:39]
  ds_read_b64_tr_b16 v[120:121], v10 offset:4096
  ds_read_b64_tr_b16 v[122:123], v10 offset:5120
  v_mfma_f32_32x32x16_bf16 v[40:55], v[132:135], v[188:191], v[40:55]
  ds_read_b64_tr_b16 v[124:125], v11 offset:4096
  ds_read_b64_tr_b16 v[126:127], v11 offset:5120
  s_andn2_b32 s33, s36, s34
  s_cbranch_scc0 .g2_kernel_w_i15c
.g2_kernel_w_i15b:
  s_ff1_i32_b32 s33, s33
  s_bitset1_b32 s34, s33
  s_xor_b32 s33, s33, s24
  s_and_b32 s15, s33, 7
  s_cmp_lt_u32 s15, 2
  s_cselect_b32 s28, 139264, 0
  s_lshl_b32 s15, s15, 13
  s_add_u32 s15, s15, s28
  s_lshl_b32 s33, s33, 12
  s_add_u32 s22, s20, s33
  s_addc_u32 s23, s21, 0
  global_load_dwordx4 v[56:59], v3, s[22:23] offset:0
  global_load_dwordx4 v[60:63], v3, s[22:23] offset:1024
  global_load_dwordx4 v[64:67], v3, s[22:23] offset:2048
  global_load_dwordx4 v[68:71], v3, s[22:23] offset:3072
  v_add_u32 v12, s11, v14
  v_add_u32 v13, s11, v15
  s_waitcnt vmcnt(23) lgkmcnt(8)
  v_mfma_f32_32x32x16_bf16 v[24:39], v[104:107], v[192:195], v[24:39]
  ds_read_b64_tr_b16 v[128:129], v10 offset:6144
  ds_read_b64_tr_b16 v[130:131], v10 offset:7168
  v_mfma_f32_32x32x16_bf16 v[40:55], v[108:111], v[192:195], v[40:55]
  ds_read_b64_tr_b16 v[132:133], v11 offset:6144
  ds_read_b64_tr_b16 v[134:135], v11 offset:7168
  s_waitcnt vmcnt(22) lgkmcnt(8)
  v_mfma_f32_32x32x16_bf16 v[24:39], v[112:115], v[196:199], v[24:39]
  ds_read_b64_tr_b16 v[104:105], v12 offset:0
  ds_read_b64_tr_b16 v[106:107], v12 offset:1024
  v_mfma_f32_32x32x16_bf16 v[40:55], v[116:119], v[196:199], v[40:55]
  ds_read_b64_tr_b16 v[108:109], v13 offset:0
  ds_read_b64_tr_b16 v[110:111], v13 offset:1024
  s_waitcnt vmcnt(21) lgkmcnt(8)
  v_mfma_f32_32x32x16_bf16 v[24:39], v[120:123], v[200:203], v[24:39]
  ds_read_b64_tr_b16 v[112:113], v12 offset:2048
  ds_read_b64_tr_b16 v[114:115], v12 offset:3072
  v_mfma_f32_32x32x16_bf16 v[40:55], v[124:127], v[200:203], v[40:55]
  ds_read_b64_tr_b16 v[116:117], v13 offset:2048
  ds_read_b64_tr_b16 v[118:119], v13 offset:3072
  s_waitcnt vmcnt(20) lgkmcnt(8)
  v_mfma_f32_32x32x16_bf16 v[24:39], v[128:131], v[204:207], v[24:39]
  ds_read_b64_tr_b16 v[120:121], v12 offset:4096
  ds_read_b64_tr_b16 v[122:123], v12 offset:5120
  v_mfma_f32_32x32x16_bf16 v[40:55], v[132:135], v[204:207], v[40:55]
  ds_read_b64_tr_b16 v[124:125], v13 offset:4096
  ds_read_b64_tr_b16 v[126:127], v13 offset:5120
  s_mov_b64 exec, 1
  ds_add_u32 v20, v5 offset:16
  s_mov_b64 exec, -1
  v_add_u32 v10, s12, v14
  v_add_u32 v11, s12, v15
  s_waitcnt vmcnt(19) lgkmcnt(8)
  v_mfma_f32_32x32x16_bf16 v[24:39], v[104:107], v[208:211], v[24:39]
  ds_read_b64_tr_b16 v[128:129], v12 offset:6144
  ds_read_b64_tr_b16 v[130:131], v12 offset:7168
  v_mfma_f32_32x32x16_bf16 v[40:55], v[108:111], v[208:211], v[40:55]
  ds_read_b64_tr_b16 v[132:133], v13 offset:6144
  ds_read_b64_tr_b16 v[134:135], v13 offset:7168
  s_waitcnt vmcnt(18) lgkmcnt(8)
  v_mfma_f32_32x32x16_bf16 v[24:39], v[112:115], v[212:215], v[24:39]
  ds_read_b64_tr_b16 v[104:105], v10 offset:0
  ds_read_b64_tr_b16 v[106:107], v10 offset:1024
  v_mfma_f32_32x32x16_bf16 v[40:55], v[116:119], v[212:215], v[40:55]
  ds_read_b64_tr_b16 v[108:109], v11 offset:0
  ds_read_b64_tr_b16 v[110:111], v11 offset:1024
  s_waitcnt vmcnt(17) lgkmcnt(8)
  v_mfma_f32_32x32x16_bf16 v[24:39], v[120:123], v[216:219], v[24:39]
  ds_read_b64_tr_b16 v[112:113], v10 offset:2048
  ds_read_b64_tr_b16 v[114:115], v10 offset:3072
  v_mfma_f32_32x32x16_bf16 v[40:55], v[124:127], v[216:219], v[40:55]
  ds_read_b64_tr_b16 v[116:117], v11 offset:2048
  ds_read_b64_tr_b16 v[118:119], v11 offset:3072
  s_waitcnt vmcnt(16) lgkmcnt(8)
  v_mfma_f32_32x32x16_bf16 v[24:39], v[128:131], v[220:223], v[24:39]
  ds_read_b64_tr_b16 v[120:121], v10 offset:4096
  ds_read_b64_tr_b16 v[122:123], v10 offset:5120
  v_mfma_f32_32x32x16_bf16 v[40:55], v[132:135], v[220:223], v[40:55]
  ds_read_b64_tr_b16 v[124:125], v11 offset:4096
  ds_read_b64_tr_b16 v[126:127], v11 offset:5120
  v_add_u32 v12, s13, v14
  v_add_u32 v13, s13, v15
  s_waitcnt vmcnt(15) lgkmcnt(8)
  v_mfma_f32_32x32x16_bf16 v[24:39], v[104:107], v[224:227], v[24:39]
  ds_read_b64_tr_b16 v[128:129], v10 offset:6144
  ds_read_b64_tr_b16 v[130:131], v10 offset:7168
  v_mfma_f32_32x32x16_bf16 v[40:55], v[108:111], v[224:227], v[40:55]
  ds_read_b64_tr_b16 v[132:133], v11 offset:6144
  ds_read_b64_tr_b16 v[134:135], v11 offset:7168
  s_waitcnt vmcnt(14) lgkmcnt(8)
  v_mfma_f32_32x32x16_bf16 v[24:39], v[112:115], v[228:231], v[24:39]
  ds_read_b64_tr_b16 v[104:105], v12 offset:0
  ds_read_b64_tr_b16 v[106:107], v12 offset:1024
  v_mfma_f32_32x32x16_bf16 v[40:55], v[116:119], v[228:231], v[40:55]
  ds_read_b64_tr_b16 v[108:109], v13 offset:0
  ds_read_b64_tr_b16 v[110:111], v13 offset:1024
  s_waitcnt vmcnt(13) lgkmcnt(8)
  v_mfma_f32_32x32x16_bf16 v[24:39], v[120:123], v[232:235], v[24:39]
  ds_read_b64_tr_b16 v[112:113], v12 offset:2048
  ds_read_b64_tr_b16 v[114:115], v12 offset:3072
  v_mfma_f32_32x32x16_bf16 v[40:55], v[124:127], v[232:235], v[40:55]
  ds_read_b64_tr_b16 v[116:117], v13 offset:2048
  ds_read_b64_tr_b16 v[118:119], v13 offset:3072
  s_waitcnt vmcnt(12) lgkmcnt(8)
  v_mfma_f32_32x32x16_bf16 v[24:39], v[128:131], v[236:239], v[24:39]
  ds_read_b64_tr_b16 v[120:121], v12 offset:4096
  ds_read_b64_tr_b16 v[122:123], v12 offset:5120
  v_mfma_f32_32x32x16_bf16 v[40:55], v[132:135], v[236:239], v[40:55]
  ds_read_b64_tr_b16 v[124:125], v13 offset:4096
  ds_read_b64_tr_b16 v[126:127], v13 offset:5120
  v_add_u32 v10, s14, v14
  v_add_u32 v11, s14, v15
  s_waitcnt vmcnt(11) lgkmcnt(8)
  v_mfma_f32_32x32x16_bf16 v[24:39], v[104:107], v[136:139], v[24:39]
  ds_read_b64_tr_b16 v[128:129], v12 offset:6144
  ds_read_b64_tr_b16 v[130:131], v12 offset:7168
  v_mfma_f32_32x32x16_bf16 v[40:55], v[108:111], v[136:139], v[40:55]
  ds_read_b64_tr_b16 v[132:133], v13 offset:6144
  ds_read_b64_tr_b16 v[134:135], v13 offset:7168
  s_waitcnt vmcnt(10) lgkmcnt(8)
  v_mfma_f32_32x32x16_bf16 v[24:39], v[112:115], v[140:143], v[24:39]
  ds_read_b64_tr_b16 v[104:105], v10 offset:0
  ds_read_b64_tr_b16 v[106:107], v10 offset:1024
  v_mfma_f32_32x32x16_bf16 v[40:55], v[116:119], v[140:143], v[40:55]
  ds_read_b64_tr_b16 v[108:109], v11 offset:0
  ds_read_b64_tr_b16 v[110:111], v11 offset:1024
  s_waitcnt vmcnt(9) lgkmcnt(8)
  v_mfma_f32_32x32x16_bf16 v[24:39], v[120:123], v[144:147], v[24:39]
  ds_read_b64_tr_b16 v[112:113], v10 offset:2048
  ds_read_b64_tr_b16 v[114:115], v10 offset:3072
  v_mfma_f32_32x32x16_bf16 v[40:55], v[124:127], v[144:147], v[40:55]
  ds_read_b64_tr_b16 v[116:117], v11 offset:2048
  ds_read_b64_tr_b16 v[118:119], v11 offset:3072
  s_waitcnt vmcnt(8) lgkmcnt(8)
  v_mfma_f32_32x32x16_bf16 v[24:39], v[128:131], v[148:151], v[24:39]
  ds_read_b64_tr_b16 v[120:121], v10 offset:4096
  ds_read_b64_tr_b16 v[122:123], v10 offset:5120
  v_mfma_f32_32x32x16_bf16 v[40:55], v[132:135], v[148:151], v[40:55]
  ds_read_b64_tr_b16 v[124:125], v11 offset:4096
  ds_read_b64_tr_b16 v[126:127], v11 offset:5120
  v_add_u32 v12, s15, v14
  v_add_u32 v13, s15, v15
  s_waitcnt vmcnt(7) lgkmcnt(8)
  v_mfma_f32_32x32x16_bf16 v[24:39], v[104:107], v[152:155], v[24:39]
  ds_read_b64_tr_b16 v[128:129], v10 offset:6144
  ds_read_b64_tr_b16 v[130:131], v10 offset:7168
  v_mfma_f32_32x32x16_bf16 v[40:55], v[108:111], v[152:155], v[40:55]
  ds_read_b64_tr_b16 v[132:133], v11 offset:6144
  ds_read_b64_tr_b16 v[134:135], v11 offset:7168
  s_waitcnt vmcnt(6) lgkmcnt(8)
  v_mfma_f32_32x32x16_bf16 v[24:39], v[112:115], v[156:159], v[24:39]
  ds_read_b64_tr_b16 v[104:105], v12 offset:0
  ds_read_b64_tr_b16 v[106:107], v12 offset:1024
  v_mfma_f32_32x32x16_bf16 v[40:55], v[116:119], v[156:159], v[40:55]
  ds_read_b64_tr_b16 v[108:109], v13 offset:0
  ds_read_b64_tr_b16 v[110:111], v13 offset:1024
  s_waitcnt vmcnt(5) lgkmcnt(8)
  v_mfma_f32_32x32x16_bf16 v[24:39], v[120:123], v[160:163], v[24:39]
  ds_read_b64_tr_b16 v[112:113], v12 offset:2048
  ds_read_b64_tr_b16 v[114:115], v12 offset:3072
  v_mfma_f32_32x32x16_bf16 v[40:55], v[124:127], v[160:163], v[40:55]
  ds_read_b64_tr_b16 v[116:117], v13 offset:2048
  ds_read_b64_tr_b16 v[118:119], v13 offset:3072
  s_waitcnt vmcnt(4) lgkmcnt(8)
  v_mfma_f32_32x32x16_bf16 v[24:39], v[128:131], v[164:167], v[24:39]
  ds_read_b64_tr_b16 v[120:121], v12 offset:4096
  ds_read_b64_tr_b16 v[122:123], v12 offset:5120
  v_mfma_f32_32x32x16_bf16 v[40:55], v[132:135], v[164:167], v[40:55]
  ds_read_b64_tr_b16 v[124:125], v13 offset:4096
  ds_read_b64_tr_b16 v[126:127], v13 offset:5120
  s_waitcnt vmcnt(3) lgkmcnt(8)
  v_mfma_f32_32x32x16_bf16 v[24:39], v[104:107], v[56:59], v[24:39]
  ds_read_b64_tr_b16 v[128:129], v12 offset:6144
  ds_read_b64_tr_b16 v[130:131], v12 offset:7168
  v_mfma_f32_32x32x16_bf16 v[40:55], v[108:111], v[56:59], v[40:55]
  ds_read_b64_tr_b16 v[132:133], v13 offset:6144
  ds_read_b64_tr_b16 v[134:135], v13 offset:7168
  s_waitcnt vmcnt(2) lgkmcnt(8)
  v_mfma_f32_32x32x16_bf16 v[24:39], v[112:115], v[60:63], v[24:39]
  v_mfma_f32_32x32x16_bf16 v[40:55], v[116:119], v[60:63], v[40:55]
  s_waitcnt vmcnt(1) lgkmcnt(4)
  v_mfma_f32_32x32x16_bf16 v[24:39], v[120:123], v[64:67], v[24:39]
  v_mfma_f32_32x32x16_bf16 v[40:55], v[124:127], v[64:67], v[40:55]
  s_waitcnt vmcnt(0) lgkmcnt(0)
  v_mfma_f32_32x32x16_bf16 v[24:39], v[128:131], v[68:71], v[24:39]
  v_mfma_f32_32x32x16_bf16 v[40:55], v[132:135], v[68:71], v[40:55]
  s_lshl_b32 s28, s17, 4
  s_add_u32 s28, s28, s18
  s_lshl_b32 s28, s28, 2
  s_add_u32 s28, s28, s16
  s_lshl_b32 s28, s28, 12
  s_add_u32 s28, s28, s63
  s_add_u32 s28, s28, 0xc00000
  s_lshl_b32 s29, s16, 12
  v_add_u32 v6, s29, v22
  s_mov_b32 s36, 0x3f803f80
  v_mov_b32 v8, 0
  v_mov_b32 v9, 0
  v_mov_b32 v10, 0
  v_lshlrev_b32 v7, 8, v18
  v_cvt_pk_bf16_f32 v56, v24, v25
  v_cvt_pk_bf16_f32 v57, v26, v27
  v_cvt_pk_bf16_f32 v58, v28, v29
  v_cvt_pk_bf16_f32 v59, v30, v31
  buffer_store_dwordx4 v[56:59], v22, s[4:7], s28 offen offset:0 sc1
  v_cvt_pk_bf16_f32 v60, v32, v33
  v_cvt_pk_bf16_f32 v61, v34, v35
  v_cvt_pk_bf16_f32 v62, v36, v37
  v_cvt_pk_bf16_f32 v63, v38, v39
  buffer_store_dwordx4 v[60:63], v22, s[4:7], s28 offen offset:512 sc1
  v_cvt_pk_bf16_f32 v64, v40, v41
  v_cvt_pk_bf16_f32 v65, v42, v43
  v_cvt_pk_bf16_f32 v66, v44, v45
  v_cvt_pk_bf16_f32 v67, v46, v47
  buffer_store_dwordx4 v[64:67], v22, s[4:7], s28 offen offset:1024 sc1
  v_cvt_pk_bf16_f32 v68, v48, v49
  v_cvt_pk_bf16_f32 v69, v50, v51
  v_cvt_pk_bf16_f32 v70, v52, v53
  v_cvt_pk_bf16_f32 v71, v54, v55
  buffer_store_dwordx4 v[68:71], v22, s[4:7], s28 offen offset:1536 sc1
  ds_write_b128 v6, v[56:59] offset:0
  ds_write_b128 v6, v[60:63] offset:512
  ds_write_b128 v6, v[64:67] offset:1024
  ds_write_b128 v6, v[68:71] offset:1536
  s_mov_b64 exec, 1
  ds_add_u32 v20, v5 offset:20
  s_mov_b64 exec, -1
  s_lshl_b32 s28, s17, 2
  s_add_u32 s28, s28, s16
  s_lshl_b32 s28, s28, 13
  s_lshl_b32 s29, s18, 4
  s_add_u32 s28, s28, s29
  s_add_u32 s28, s28, s63
  s_add_u32 s28, s28, 0x1000000
  v_dot2c_f32_bf16 v8, s36, v56
  v_dot2c_f32_bf16 v9, v56, v56
  v_dot2c_f32_bf16 v10, v56, v240
  v_dot2c_f32_bf16 v8, s36, v57
  v_dot2c_f32_bf16 v9, v57, v57
  v_dot2c_f32_bf16 v10, v57, v241
  v_dot2c_f32_bf16 v8, s36, v58
  v_dot2c_f32_bf16 v9, v58, v58
  v_dot2c_f32_bf16 v10, v58, v242
  v_dot2c_f32_bf16 v8, s36, v59
  v_dot2c_f32_bf16 v9, v59, v59
  v_dot2c_f32_bf16 v10, v59, v243
  v_dot2c_f32_bf16 v8, s36, v60
  v_dot2c_f32_bf16 v9, v60, v60
  v_dot2c_f32_bf16 v10, v60, v244
  v_dot2c_f32_bf16 v8, s36, v61
  v_dot2c_f32_bf16 v9, v61, v61
  v_dot2c_f32_bf16 v10, v61, v245
  v_dot2c_f32_bf16 v8, s36, v62
  v_dot2c_f32_bf16 v9, v62, v62
  v_dot2c_f32_bf16 v10, v62, v246
  v_dot2c_f32_bf16 v8, s36, v63
  v_dot2c_f32_bf16 v9, v63, v63
  v_dot2c_f32_bf16 v10, v63, v247
  v_dot2c_f32_bf16 v8, s36, v64
  v_dot2c_f32_bf16 v9, v64, v64
  v_dot2c_f32_bf16 v10, v64, v248
  v_dot2c_f32_bf16 v8, s36, v65
  v_dot2c_f32_bf16 v9, v65, v65
  v_dot2c_f32_bf16 v10, v65, v249
  v_dot2c_f32_bf16 v8, s36, v66
  v_dot2c_f32_bf16 v9, v66, v66
  v_dot2c_f32_bf16 v10, v66, v250
  v_dot2c_f32_bf16 v8, s36, v67
  v_dot2c_f32_bf16 v9, v67, v67
  v_dot2c_f32_bf16 v10, v67, v251
  v_dot2c_f32_bf16 v8, s36, v68
  v_dot2c_f32_bf16 v9, v68, v68
  v_dot2c_f32_bf16 v10, v68, v252
  v_dot2c_f32_bf16 v8, s36, v69
  v_dot2c_f32_bf16 v9, v69, v69
  v_dot2c_f32_bf16 v10, v69, v253
  v_dot2c_f32_bf16 v8, s36, v70
  v_dot2c_f32_bf16 v9, v70, v70
  v_dot2c_f32_bf16 v10, v70, v254
  v_dot2c_f32_bf16 v8, s36, v71
  v_dot2c_f32_bf16 v9, v71, v71
  v_dot2c_f32_bf16 v10, v71, v255
  s_lshl_b32 s29, s16, 7
  s_add_u32 s37, s19, s29
  v_mov_b32 v24, v8
  v_mov_b32 v25, v9
  v_mov_b32 v26, v10
  v_mov_b32 v11, 1
  v_permlane32_swap_b32 v8, v24
  v_permlane32_swap_b32 v9, v25
  v_permlane32_swap_b32 v10, v26
  v_add_f32 v8, v8, v24
  v_add_f32 v9, v9, v25
  v_add_f32 v10, v10, v26
  v_or_b32 v8, 1, v8
  v_mov_b32 v16, s70
  s_mov_b32 exec_hi, 0
  s_waitcnt vmcnt(0)
  buffer_store_dwordx4 v[8:11], v7, s[4:7], s28 offen sc1
  s_mov_b64 exec, 1
  buffer_store_dword v16, v4, s[4:7], s37 offen offset:8 sc1
  s_mov_b64 exec, -1
  s_cmp_lg_u32 s62, 0
  s_cbranch_scc1 .g2_kernel_tail
  v_mov_b32 v6, s71
  s_mov_b32 s38, 0
.g2_kernel_wg3:
  ds_read_b32 v7, v6 offset:20
  s_add_u32 s38, s38, 1
  s_waitcnt lgkmcnt(0)
  v_cmp_le_u32 vcc, 4, v7
  s_cbranch_vccnz .g2_kernel_wg3d
  s_cmp_lt_u32 s38, 524288
  s_cbranch_scc1 .g2_kernel_wg3
.g2_kernel_wg3d:
  s_mov_b32 s62, 1
  s_mov_b32 s63, 0x1800000
  s_mov_b32 s70, 2
  s_mov_b32 s71, 155776
  s_branch .g2_kernel_q_cons2
.g2_kernel_tail:
  s_mov_b32 s28, s56
  s_mov_b32 s29, s57
  s_mov_b32 s30, 0x400000
  s_mov_b32 s31, 0x00020000
  v_lshlrev_b32 v24, 16, v56
  v_and_b32 v25, 0xffff0000, v56
  v_lshlrev_b32 v26, 16, v57
  v_and_b32 v27, 0xffff0000, v57
  v_lshlrev_b32 v28, 16, v58
  v_and_b32 v29, 0xffff0000, v58
  v_lshlrev_b32 v30, 16, v59
  v_and_b32 v31, 0xffff0000, v59
  v_lshlrev_b32 v32, 16, v60
  v_and_b32 v33, 0xffff0000, v60
  v_lshlrev_b32 v34, 16, v61
  v_and_b32 v35, 0xffff0000, v61
  v_lshlrev_b32 v36, 16, v62
  v_and_b32 v37, 0xffff0000, v62
  v_lshlrev_b32 v38, 16, v63
  v_and_b32 v39, 0xffff0000, v63
  v_lshlrev_b32 v40, 16, v64
  v_and_b32 v41, 0xffff0000, v64
  v_lshlrev_b32 v42, 16, v65
  v_and_b32 v43, 0xffff0000, v65
  v_lshlrev_b32 v44, 16, v66
  v_and_b32 v45, 0xffff0000, v66
  v_lshlrev_b32 v46, 16, v67
  v_and_b32 v47, 0xffff0000, v67
  v_lshlrev_b32 v48, 16, v68
  v_and_b32 v49, 0xffff0000, v68
  v_lshlrev_b32 v50, 16, v69
  v_and_b32 v51, 0xffff0000, v69
  v_lshlrev_b32 v52, 16, v70
  v_and_b32 v53, 0xffff0000, v70
  v_lshlrev_b32 v54, 16, v71
  v_and_b32 v55, 0xffff0000, v71
  v_lshlrev_b32 v10, 2, v19
  v_add_u32 v10, 155644, v10
  s_lshl_b32 s32, s17, 2
  s_add_u32 s32, s32, s16
  s_lshl_b32 s32, s32, 16
  s_lshl_b32 s33, s18, 7
  s_add_u32 s32, s32, s33
  v_mov_b32 v6, s71
  s_mov_b32 s38, 0
.g2_kernel_wg4:
  ds_read_b32 v7, v6 offset:28
  s_add_u32 s38, s38, 1
  s_waitcnt lgkmcnt(0)
  v_cmp_le_u32 vcc, 1, v7
  s_cbranch_vccnz .g2_kernel_wg4d
  s_sleep 2
  s_cmp_lt_u32 s38, 524288
  s_cbranch_scc1 .g2_kernel_wg4
.g2_kernel_wg4d:
  ds_read_b32 v8, v10 offset:3840
  ds_read_b32 v9, v10 offset:4352
  ds_read_b32 v16, v20 offset:32
  s_waitcnt lgkmcnt(0)
  v_cmp_ne_u32 vcc, v16, v19
  v_pk_fma_f32 v[24:25], v[24:25], v[8:9], v[8:9] op_sel:[0,0,1] op_sel_hi:[1,0,1]
  v_pk_fma_f32 v[26:27], v[26:27], v[8:9], v[8:9] op_sel:[0,0,1] op_sel_hi:[1,0,1]
  v_pk_fma_f32 v[28:29], v[28:29], v[8:9], v[8:9] op_sel:[0,0,1] op_sel_hi:[1,0,1]
  v_pk_fma_f32 v[30:31], v[30:31], v[8:9], v[8:9] op_sel:[0,0,1] op_sel_hi:[1,0,1]
  v_pk_fma_f32 v[32:33], v[32:33], v[8:9], v[8:9] op_sel:[0,0,1] op_sel_hi:[1,0,1]
  v_pk_fma_f32 v[34:35], v[34:35], v[8:9], v[8:9] op_sel:[0,0,1] op_sel_hi:[1,0,1]
  v_pk_fma_f32 v[36:37], v[36:37], v[8:9], v[8:9] op_sel:[0,0,1] op_sel_hi:[1,0,1]
  v_pk_fma_f32 v[38:39], v[38:39], v[8:9], v[8:9] op_sel:[0,0,1] op_sel_hi:[1,0,1]
  v_pk_fma_f32 v[40:41], v[40:41], v[8:9], v[8:9] op_sel:[0,0,1] op_sel_hi:[1,0,1]
  v_pk_fma_f32 v[42:43], v[42:43], v[8:9], v[8:9] op_sel:[0,0,1] op_sel_hi:[1,0,1]
  v_pk_fma_f32 v[44:45], v[44:45], v[8:9], v[8:9] op_sel:[0,0,1] op_sel_hi:[1,0,1]
  v_pk_fma_f32 v[46:47], v[46:47], v[8:9], v[8:9] op_sel:[0,0,1] op_sel_hi:[1,0,1]
  v_pk_fma_f32 v[48:49], v[48:49], v[8:9], v[8:9] op_sel:[0,0,1] op_sel_hi:[1,0,1]
  v_pk_fma_f32 v[50:51], v[50:51], v[8:9], v[8:9] op_sel:[0,0,1] op_sel_hi:[1,0,1]
  v_pk_fma_f32 v[52:53], v[52:53], v[8:9], v[8:9] op_sel:[0,0,1] op_sel_hi:[1,0,1]
  v_pk_fma_f32 v[54:55], v[54:55], v[8:9], v[8:9] op_sel:[0,0,1] op_sel_hi:[1,0,1]
  v_cvt_pk_bf16_f32 v56, v24, v25
  v_cvt_pk_bf16_f32 v57, v26, v27
  v_cvt_pk_bf16_f32 v58, v28, v29
  v_cvt_pk_bf16_f32 v59, v30, v31
  v_cvt_pk_bf16_f32 v60, v32, v33
  v_cvt_pk_bf16_f32 v61, v34, v35
  v_cvt_pk_bf16_f32 v62, v36, v37
  v_cvt_pk_bf16_f32 v63, v38, v39
  v_cvt_pk_bf16_f32 v64, v40, v41
  v_cvt_pk_bf16_f32 v65, v42, v43
  v_cvt_pk_bf16_f32 v66, v44, v45
  v_cvt_pk_bf16_f32 v67, v46, v47
  v_cvt_pk_bf16_f32 v68, v48, v49
  v_cvt_pk_bf16_f32 v69, v50, v51
  v_cvt_pk_bf16_f32 v70, v52, v53
  v_cvt_pk_bf16_f32 v71, v54, v55
  s_mov_b64 exec, vcc
  buffer_store_dwordx4 v[56:59], v23, s[28:31], s32 offen offset:0
  buffer_store_dwordx4 v[60:63], v23, s[28:31], s32 offen offset:32
  buffer_store_dwordx4 v[64:67], v23, s[28:31], s32 offen offset:64
  buffer_store_dwordx4 v[68:71], v23, s[28:31], s32 offen offset:96
  s_mov_b64 exec, -1
  s_branch .g2_kernel_fin
.g2_kernel_svc:
  s_cmp_eq_u32 s16, 5
  s_cbranch_scc1 .g2_kernel_s1
  s_cmp_eq_u32 s16, 6
  s_cbranch_scc1 .g2_kernel_s2
  s_cmp_eq_u32 s16, 7
  s_cbranch_scc1 .g2_kernel_s3
  s_mov_b32 s8, s40
  s_mov_b32 s9, s41
  s_mov_b32 s10, 0x400000
  s_mov_b32 s11, 0x00020000
  s_setprio 3
  v_lshrrev_b32 v20, 3, v2
  v_and_b32 v21, 7, v2
  v_lshrrev_b32 v22, 4, v2
  v_xor_b32 v23, v21, v22
  v_lshlrev_b32 v23, 4, v23
  v_lshl_add_u32 v24, v20, 11, v23
  v_xor_b32 v25, 64, v24
  s_lshl_b32 s32, s17, 18
  v_add_u32 v32, 0, v24
  v_add_u32 v33, 15360, v25
  v_add_u32 v34, 30720, v24
  v_add_u32 v35, 46080, v25
  v_add_u32 v36, 65536, v24
  v_add_u32 v37, 80896, v25
  v_add_u32 v38, 96256, v24
  v_add_u32 v39, 111616, v25
  v_add_u32 v40, 131072, v24
  v_add_u32 v41, 146432, v25
  v_add_u32 v42, 161792, v24
  v_add_u32 v43, 177152, v25
  v_add_u32 v44, 196608, v24
  v_add_u32 v45, 211968, v25
  v_add_u32 v46, 227328, v24
  v_add_u32 v47, 242688, v25
  s_mov_b32 s29, 0
  s_add_u32 m0, s29, 0
  s_nop 0
  buffer_load_dwordx4 v32, s[8:11], s32 offen offset:0 lds
  buffer_load_dwordx4 v33, s[8:11], s32 offen offset:1024 lds
  buffer_load_dwordx4 v34, s[8:11], s32 offen offset:2048 lds
  buffer_load_dwordx4 v35, s[8:11], s32 offen offset:3072 lds
  s_add_u32 m0, s29, 4096
  s_nop 0
  buffer_load_dwordx4 v36, s[8:11], s32 offen offset:0 lds
  buffer_load_dwordx4 v37, s[8:11], s32 offen offset:1024 lds
  buffer_load_dwordx4 v38, s[8:11], s32 offen offset:2048 lds
  buffer_load_dwordx4 v39, s[8:11], s32 offen offset:3072 lds
  s_add_u32 m0, s29, 8192
  s_nop 0
  buffer_load_dwordx4 v40, s[8:11], s32 offen offset:0 lds
  buffer_load_dwordx4 v41, s[8:11], s32 offen offset:1024 lds
  buffer_load_dwordx4 v42, s[8:11], s32 offen offset:2048 lds
  buffer_load_dwordx4 v43, s[8:11], s32 offen offset:3072 lds
  s_add_u32 m0, s29, 12288
  s_nop 0
  buffer_load_dwordx4 v44, s[8:11], s32 offen offset:0 lds
  buffer_load_dwordx4 v45, s[8:11], s32 offen offset:1024 lds
  buffer_load_dwordx4 v46, s[8:11], s32 offen offset:2048 lds
  buffer_load_dwordx4 v47, s[8:11], s32 offen offset:3072 lds
  s_add_u32 s32, s32, 128
  s_mov_b32 s12, s42
  s_mov_b32 s13, s43
  s_mov_b32 s14, 0x600000
  s_mov_b32 s15, 0x00020000
  v_lshrrev_b32 v28, 3, v2
  v_and_b32 v29, 7, v2
  v_bfe_u32 v30, v2, 4, 1
  v_lshlrev_b32 v30, 1, v30
  v_xor_b32 v31, v29, v30
  v_lshlrev_b32 v31, 4, v31
  v_mul_u32_u24 v28, 6144, v28
  v_add_u32 v28, v28, v31
  v_xor_b32 v29, 64, v28
  v_lshlrev_b32 v9, 8, v2
  v_and_b32 v9, 0x300, v9
  v_add_u32 v9, 156416, v9
  v_add_u32 v48, 0, v28
  v_add_u32 v49, 48128, v29
  v_add_u32 v50, 96256, v28
  v_add_u32 v51, 144384, v29
  v_add_u32 v52, 2048, v28
  v_add_u32 v53, 50176, v29
  v_add_u32 v54, 98304, v28
  v_add_u32 v55, 146432, v29
  v_add_u32 v56, 4096, v28
  v_add_u32 v57, 52224, v29
  v_add_u32 v58, 100352, v28
  v_add_u32 v59, 148480, v29
  s_lshl_b32 s36, s18, 7
  s_mov_b32 s30, 0
  s_add_u32 m0, s30, 65536
  s_nop 0
  buffer_load_dwordx4 v48, s[12:15], s36 offen offset:0 lds
  buffer_load_dwordx4 v49, s[12:15], s36 offen offset:1024 lds
  buffer_load_dwordx4 v50, s[12:15], s36 offen offset:2048 lds
  buffer_load_dwordx4 v51, s[12:15], s36 offen offset:3072 lds
  s_add_u32 m0, s30, 69632
  s_nop 0
  buffer_load_dwordx4 v52, s[12:15], s36 offen offset:0 lds
  buffer_load_dwordx4 v53, s[12:15], s36 offen offset:1024 lds
  buffer_load_dwordx4 v54, s[12:15], s36 offen offset:2048 lds
  buffer_load_dwordx4 v55, s[12:15], s36 offen offset:3072 lds
  s_add_u32 m0, s30, 73728
  s_nop 0
  buffer_load_dwordx4 v56, s[12:15], s36 offen offset:0 lds
  buffer_load_dwordx4 v57, s[12:15], s36 offen offset:1024 lds
  buffer_load_dwordx4 v58, s[12:15], s36 offen offset:2048 lds
  buffer_load_dwordx4 v59, s[12:15], s36 offen offset:3072 lds
  s_add_u32 s30, s30, 12288
  s_cmp_eq_u32 s30, 86016
  s_cselect_b32 s30, 0, s30
  s_barrier
  s_mov_b32 s35, .g2_kernel_tab-.g2_kernel_pc+4
  s_mov_b32 s34, -5
  v_mov_b32 v10, 0
  s_mov_b32 m0, 156160
  s_add_u32 s36, s36, 196608
  buffer_load_dword off, s[64:67], s35 lds
  s_add_u32 s35, s35, 4
  s_branch .g2_kernel_p1_o
  .p2align 6
.g2_kernel_p1_l:
  s_waitcnt lgkmcnt(0)
  v_cmp_gt_i32 vcc, s34, v10
  s_cbranch_vccnz .g2_kernel_p1_aw
.g2_kernel_p1_ai:
  s_add_u32 s29, s29, 16384
  s_and_b32 s29, s29, 0xffff
  s_add_u32 m0, s29, 0
  s_nop 0
  buffer_load_dwordx4 v32, s[8:11], s32 offen offset:0 lds
  buffer_load_dwordx4 v33, s[8:11], s32 offen offset:1024 lds
  buffer_load_dwordx4 v34, s[8:11], s32 offen offset:2048 lds
  buffer_load_dwordx4 v35, s[8:11], s32 offen offset:3072 lds
  s_add_u32 m0, s29, 4096
  s_nop 0
  buffer_load_dwordx4 v36, s[8:11], s32 offen offset:0 lds
  buffer_load_dwordx4 v37, s[8:11], s32 offen offset:1024 lds
  buffer_load_dwordx4 v38, s[8:11], s32 offen offset:2048 lds
  buffer_load_dwordx4 v39, s[8:11], s32 offen offset:3072 lds
  s_add_u32 m0, s29, 8192
  s_nop 0
  buffer_load_dwordx4 v40, s[8:11], s32 offen offset:0 lds
  buffer_load_dwordx4 v41, s[8:11], s32 offen offset:1024 lds
  buffer_load_dwordx4 v42, s[8:11], s32 offen offset:2048 lds
  buffer_load_dwordx4 v43, s[8:11], s32 offen offset:3072 lds
  s_add_u32 m0, s29, 12288
  s_nop 0
  buffer_load_dwordx4 v44, s[8:11], s32 offen offset:0 lds
  buffer_load_dwordx4 v45, s[8:11], s32 offen offset:1024 lds
  buffer_load_dwordx4 v46, s[8:11], s32 offen offset:2048 lds
  buffer_load_dwordx4 v47, s[8:11], s32 offen offset:3072 lds
  s_add_u32 s32, s32, 128
  s_add_u32 m0, s30, 65536
  s_nop 0
  buffer_load_dwordx4 v48, s[12:15], s36 offen offset:0 lds
  buffer_load_dwordx4 v49, s[12:15], s36 offen offset:1024 lds
  buffer_load_dwordx4 v50, s[12:15], s36 offen offset:2048 lds
  buffer_load_dwordx4 v51, s[12:15], s36 offen offset:3072 lds
  s_add_u32 m0, s30, 69632
  s_nop 0
  buffer_load_dwordx4 v52, s[12:15], s36 offen offset:0 lds
  buffer_load_dwordx4 v53, s[12:15], s36 offen offset:1024 lds
  buffer_load_dwordx4 v54, s[12:15], s36 offen offset:2048 lds
  buffer_load_dwordx4 v55, s[12:15], s36 offen offset:3072 lds
  s_add_u32 m0, s30, 73728
  s_nop 0
  buffer_load_dwordx4 v56, s[12:15], s36 offen offset:0 lds
  buffer_load_dwordx4 v57, s[12:15], s36 offen offset:1024 lds
  buffer_load_dwordx4 v58, s[12:15], s36 offen offset:2048 lds
  buffer_load_dwordx4 v59, s[12:15], s36 offen offset:3072 lds
  s_add_u32 s30, s30, 12288
  s_cmp_eq_u32 s30, 86016
  s_cselect_b32 s30, 0, s30
  ds_read_b32 v10, v9
  s_mov_b32 m0, 156160
  s_add_u32 s34, s34, 1
  buffer_load_dword off, s[64:67], s35 lds
  s_add_u32 s35, s35, 4
  s_add_u32 s36, s36, 196608
.g2_kernel_p1_o:
  s_waitcnt lgkmcnt(0)
  v_cmp_gt_i32 vcc, s34, v10
  s_cbranch_vccnz .g2_kernel_p1_bw
.g2_kernel_p1_bi:
  s_add_u32 m0, s30, 65536
  s_nop 0
  buffer_load_dwordx4 v48, s[12:15], s36 offen offset:0 lds
  buffer_load_dwordx4 v49, s[12:15], s36 offen offset:1024 lds
  buffer_load_dwordx4 v50, s[12:15], s36 offen offset:2048 lds
  buffer_load_dwordx4 v51, s[12:15], s36 offen offset:3072 lds
  s_add_u32 m0, s30, 69632
  s_nop 0
  buffer_load_dwordx4 v52, s[12:15], s36 offen offset:0 lds
  buffer_load_dwordx4 v53, s[12:15], s36 offen offset:1024 lds
  buffer_load_dwordx4 v54, s[12:15], s36 offen offset:2048 lds
  buffer_load_dwordx4 v55, s[12:15], s36 offen offset:3072 lds
  s_add_u32 m0, s30, 73728
  s_nop 0
  buffer_load_dwordx4 v56, s[12:15], s36 offen offset:0 lds
  buffer_load_dwordx4 v57, s[12:15], s36 offen offset:1024 lds
  buffer_load_dwordx4 v58, s[12:15], s36 offen offset:2048 lds
  buffer_load_dwordx4 v59, s[12:15], s36 offen offset:3072 lds
  s_add_u32 s30, s30, 12288
  s_cmp_eq_u32 s30, 86016
  s_cselect_b32 s30, 0, s30
  ds_read_b32 v10, v9
  s_mov_b32 m0, 156160
  s_add_u32 s34, s34, 1
  buffer_load_dword off, s[64:67], s35 lds
  s_add_u32 s35, s35, 4
  s_add_u32 s36, s36, 196608
  s_cmp_lt_i32 s34, 26
  s_cbranch_scc1 .g2_kernel_p1_l
  s_branch .g2_kernel_v
.g2_kernel_s1:
  s_mov_b32 s8, s40
  s_mov_b32 s9, s41
  s_mov_b32 s10, 0x400000
  s_mov_b32 s11, 0x00020000
  v_lshrrev_b32 v20, 3, v2
  v_and_b32 v21, 7, v2
  v_lshlrev_b32 v21, 4, v21
  v_lshl_add_u32 v21, v20, 11, v21
  s_lshl_b32 s30, s17, 4
  s_add_u32 s30, s30, s18
  s_lshl_b32 s33, s30, 5
  s_lshl_b32 s30, s30, 14
  s_barrier
  s_sleep 0
  buffer_load_dwordx4 v[64:67], v21, s[8:11], s30 offen offset:0
  buffer_load_dwordx4 v[68:71], v21, s[8:11], s30 offen offset:128
  buffer_load_dwordx4 v[72:75], v21, s[8:11], s30 offen offset:256
  buffer_load_dwordx4 v[76:79], v21, s[8:11], s30 offen offset:384
  buffer_load_dwordx4 v[80:83], v21, s[8:11], s30 offen offset:512
  buffer_load_dwordx4 v[84:87], v21, s[8:11], s30 offen offset:640
  buffer_load_dwordx4 v[88:91], v21, s[8:11], s30 offen offset:768
  buffer_load_dwordx4 v[92:95], v21, s[8:11], s30 offen offset:896
  buffer_load_dwordx4 v[96:99], v21, s[8:11], s30 offen offset:1024
  buffer_load_dwordx4 v[100:103], v21, s[8:11], s30 offen offset:1152
  buffer_load_dwordx4 v[104:107], v21, s[8:11], s30 offen offset:1280
  buffer_load_dwordx4 v[108:111], v21, s[8:11], s30 offen offset:1408
  buffer_load_dwordx4 v[112:115], v21, s[8:11], s30 offen offset:1536
  buffer_load_dwordx4 v[116:119], v21, s[8:11], s30 offen offset:1664
  buffer_load_dwordx4 v[120:123], v21, s[8:11], s30 offen offset:1792
  buffer_load_dwordx4 v[124:127], v21, s[8:11], s30 offen offset:1920
  v_mov_b32 v24, 0
  v_mov_b32 v25, 0
  v_mov_b32 v26, 0
  v_mov_b32 v27, 0
  s_waitcnt vmcnt(15)
  v_lshlrev_b32 v22, 16, v64
  v_and_b32 v64, 0xffff0000, v64
  v_add_f32 v24, v24, v22
  v_fmac_f32 v25, v22, v22
  v_add_f32 v26, v26, v64
  v_fmac_f32 v27, v64, v64
  v_lshlrev_b32 v22, 16, v65
  v_and_b32 v65, 0xffff0000, v65
  v_add_f32 v24, v24, v22
  v_fmac_f32 v25, v22, v22
  v_add_f32 v26, v26, v65
  v_fmac_f32 v27, v65, v65
  v_lshlrev_b32 v22, 16, v66
  v_and_b32 v66, 0xffff0000, v66
  v_add_f32 v24, v24, v22
  v_fmac_f32 v25, v22, v22
  v_add_f32 v26, v26, v66
  v_fmac_f32 v27, v66, v66
  v_lshlrev_b32 v22, 16, v67
  v_and_b32 v67, 0xffff0000, v67
  v_add_f32 v24, v24, v22
  v_fmac_f32 v25, v22, v22
  v_add_f32 v26, v26, v67
  v_fmac_f32 v27, v67, v67
  s_waitcnt vmcnt(14)
  v_lshlrev_b32 v22, 16, v68
  v_and_b32 v68, 0xffff0000, v68
  v_add_f32 v24, v24, v22
  v_fmac_f32 v25, v22, v22
  v_add_f32 v26, v26, v68
  v_fmac_f32 v27, v68, v68
  v_lshlrev_b32 v22, 16, v69
  v_and_b32 v69, 0xffff0000, v69
  v_add_f32 v24, v24, v22
  v_fmac_f32 v25, v22, v22
  v_add_f32 v26, v26, v69
  v_fmac_f32 v27, v69, v69
  v_lshlrev_b32 v22, 16, v70
  v_and_b32 v70, 0xffff0000, v70
  v_add_f32 v24, v24, v22
  v_fmac_f32 v25, v22, v22
  v_add_f32 v26, v26, v70
  v_fmac_f32 v27, v70, v70
  v_lshlrev_b32 v22, 16, v71
  v_and_b32 v71, 0xffff0000, v71
  v_add_f32 v24, v24, v22
  v_fmac_f32 v25, v22, v22
  v_add_f32 v26, v26, v71
  v_fmac_f32 v27, v71, v71
  s_waitcnt vmcnt(13)
  v_lshlrev_b32 v22, 16, v72
  v_and_b32 v72, 0xffff0000, v72
  v_add_f32 v24, v24, v22
  v_fmac_f32 v25, v22, v22
  v_add_f32 v26, v26, v72
  v_fmac_f32 v27, v72, v72
  v_lshlrev_b32 v22, 16, v73
  v_and_b32 v73, 0xffff0000, v73
  v_add_f32 v24, v24, v22
  v_fmac_f32 v25, v22, v22
  v_add_f32 v26, v26, v73
  v_fmac_f32 v27, v73, v73
  v_lshlrev_b32 v22, 16, v74
  v_and_b32 v74, 0xffff0000, v74
  v_add_f32 v24, v24, v22
  v_fmac_f32 v25, v22, v22
  v_add_f32 v26, v26, v74
  v_fmac_f32 v27, v74, v74
  v_lshlrev_b32 v22, 16, v75
  v_and_b32 v75, 0xffff0000, v75
  v_add_f32 v24, v24, v22
  v_fmac_f32 v25, v22, v22
  v_add_f32 v26, v26, v75
  v_fmac_f32 v27, v75, v75
  s_waitcnt vmcnt(12)
  v_lshlrev_b32 v22, 16, v76
  v_and_b32 v76, 0xffff0000, v76
  v_add_f32 v24, v24, v22
  v_fmac_f32 v25, v22, v22
  v_add_f32 v26, v26, v76
  v_fmac_f32 v27, v76, v76
  v_lshlrev_b32 v22, 16, v77
  v_and_b32 v77, 0xffff0000, v77
  v_add_f32 v24, v24, v22
  v_fmac_f32 v25, v22, v22
  v_add_f32 v26, v26, v77
  v_fmac_f32 v27, v77, v77
  v_lshlrev_b32 v22, 16, v78
  v_and_b32 v78, 0xffff0000, v78
  v_add_f32 v24, v24, v22
  v_fmac_f32 v25, v22, v22
  v_add_f32 v26, v26, v78
  v_fmac_f32 v27, v78, v78
  v_lshlrev_b32 v22, 16, v79
  v_and_b32 v79, 0xffff0000, v79
  v_add_f32 v24, v24, v22
  v_fmac_f32 v25, v22, v22
  v_add_f32 v26, v26, v79
  v_fmac_f32 v27, v79, v79
  s_waitcnt vmcnt(11)
  v_lshlrev_b32 v22, 16, v80
  v_and_b32 v80, 0xffff0000, v80
  v_add_f32 v24, v24, v22
  v_fmac_f32 v25, v22, v22
  v_add_f32 v26, v26, v80
  v_fmac_f32 v27, v80, v80
  v_lshlrev_b32 v22, 16, v81
  v_and_b32 v81, 0xffff0000, v81
  v_add_f32 v24, v24, v22
  v_fmac_f32 v25, v22, v22
  v_add_f32 v26, v26, v81
  v_fmac_f32 v27, v81, v81
  v_lshlrev_b32 v22, 16, v82
  v_and_b32 v82, 0xffff0000, v82
  v_add_f32 v24, v24, v22
  v_fmac_f32 v25, v22, v22
  v_add_f32 v26, v26, v82
  v_fmac_f32 v27, v82, v82
  v_lshlrev_b32 v22, 16, v83
  v_and_b32 v83, 0xffff0000, v83
  v_add_f32 v24, v24, v22
  v_fmac_f32 v25, v22, v22
  v_add_f32 v26, v26, v83
  v_fmac_f32 v27, v83, v83
  s_waitcnt vmcnt(10)
  v_lshlrev_b32 v22, 16, v84
  v_and_b32 v84, 0xffff0000, v84
  v_add_f32 v24, v24, v22
  v_fmac_f32 v25, v22, v22
  v_add_f32 v26, v26, v84
  v_fmac_f32 v27, v84, v84
  v_lshlrev_b32 v22, 16, v85
  v_and_b32 v85, 0xffff0000, v85
  v_add_f32 v24, v24, v22
  v_fmac_f32 v25, v22, v22
  v_add_f32 v26, v26, v85
  v_fmac_f32 v27, v85, v85
  v_lshlrev_b32 v22, 16, v86
  v_and_b32 v86, 0xffff0000, v86
  v_add_f32 v24, v24, v22
  v_fmac_f32 v25, v22, v22
  v_add_f32 v26, v26, v86
  v_fmac_f32 v27, v86, v86
  v_lshlrev_b32 v22, 16, v87
  v_and_b32 v87, 0xffff0000, v87
  v_add_f32 v24, v24, v22
  v_fmac_f32 v25, v22, v22
  v_add_f32 v26, v26, v87
  v_fmac_f32 v27, v87, v87
  s_waitcnt vmcnt(9)
  v_lshlrev_b32 v22, 16, v88
  v_and_b32 v88, 0xffff0000, v88
  v_add_f32 v24, v24, v22
  v_fmac_f32 v25, v22, v22
  v_add_f32 v26, v26, v88
  v_fmac_f32 v27, v88, v88
  v_lshlrev_b32 v22, 16, v89
  v_and_b32 v89, 0xffff0000, v89
  v_add_f32 v24, v24, v22
  v_fmac_f32 v25, v22, v22
  v_add_f32 v26, v26, v89
  v_fmac_f32 v27, v89, v89
  v_lshlrev_b32 v22, 16, v90
  v_and_b32 v90, 0xffff0000, v90
  v_add_f32 v24, v24, v22
  v_fmac_f32 v25, v22, v22
  v_add_f32 v26, v26, v90
  v_fmac_f32 v27, v90, v90
  v_lshlrev_b32 v22, 16, v91
  v_and_b32 v91, 0xffff0000, v91
  v_add_f32 v24, v24, v22
  v_fmac_f32 v25, v22, v22
  v_add_f32 v26, v26, v91
  v_fmac_f32 v27, v91, v91
  s_waitcnt vmcnt(8)
  v_lshlrev_b32 v22, 16, v92
  v_and_b32 v92, 0xffff0000, v92
  v_add_f32 v24, v24, v22
  v_fmac_f32 v25, v22, v22
  v_add_f32 v26, v26, v92
  v_fmac_f32 v27, v92, v92
  v_lshlrev_b32 v22, 16, v93
  v_and_b32 v93, 0xffff0000, v93
  v_add_f32 v24, v24, v22
  v_fmac_f32 v25, v22, v22
  v_add_f32 v26, v26, v93
  v_fmac_f32 v27, v93, v93
  v_lshlrev_b32 v22, 16, v94
  v_and_b32 v94, 0xffff0000, v94
  v_add_f32 v24, v24, v22
  v_fmac_f32 v25, v22, v22
  v_add_f32 v26, v26, v94
  v_fmac_f32 v27, v94, v94
  v_lshlrev_b32 v22, 16, v95
  v_and_b32 v95, 0xffff0000, v95
  v_add_f32 v24, v24, v22
  v_fmac_f32 v25, v22, v22
  v_add_f32 v26, v26, v95
  v_fmac_f32 v27, v95, v95
  s_waitcnt vmcnt(7)
  v_lshlrev_b32 v22, 16, v96
  v_and_b32 v96, 0xffff0000, v96
  v_add_f32 v24, v24, v22
  v_fmac_f32 v25, v22, v22
  v_add_f32 v26, v26, v96
  v_fmac_f32 v27, v96, v96
  v_lshlrev_b32 v22, 16, v97
  v_and_b32 v97, 0xffff0000, v97
  v_add_f32 v24, v24, v22
  v_fmac_f32 v25, v22, v22
  v_add_f32 v26, v26, v97
  v_fmac_f32 v27, v97, v97
  v_lshlrev_b32 v22, 16, v98
  v_and_b32 v98, 0xffff0000, v98
  v_add_f32 v24, v24, v22
  v_fmac_f32 v25, v22, v22
  v_add_f32 v26, v26, v98
  v_fmac_f32 v27, v98, v98
  v_lshlrev_b32 v22, 16, v99
  v_and_b32 v99, 0xffff0000, v99
  v_add_f32 v24, v24, v22
  v_fmac_f32 v25, v22, v22
  v_add_f32 v26, v26, v99
  v_fmac_f32 v27, v99, v99
  s_waitcnt vmcnt(6)
  v_lshlrev_b32 v22, 16, v100
  v_and_b32 v100, 0xffff0000, v100
  v_add_f32 v24, v24, v22
  v_fmac_f32 v25, v22, v22
  v_add_f32 v26, v26, v100
  v_fmac_f32 v27, v100, v100
  v_lshlrev_b32 v22, 16, v101
  v_and_b32 v101, 0xffff0000, v101
  v_add_f32 v24, v24, v22
  v_fmac_f32 v25, v22, v22
  v_add_f32 v26, v26, v101
  v_fmac_f32 v27, v101, v101
  v_lshlrev_b32 v22, 16, v102
  v_and_b32 v102, 0xffff0000, v102
  v_add_f32 v24, v24, v22
  v_fmac_f32 v25, v22, v22
  v_add_f32 v26, v26, v102
  v_fmac_f32 v27, v102, v102
  v_lshlrev_b32 v22, 16, v103
  v_and_b32 v103, 0xffff0000, v103
  v_add_f32 v24, v24, v22
  v_fmac_f32 v25, v22, v22
  v_add_f32 v26, v26, v103
  v_fmac_f32 v27, v103, v103
  s_waitcnt vmcnt(5)
  v_lshlrev_b32 v22, 16, v104
  v_and_b32 v104, 0xffff0000, v104
  v_add_f32 v24, v24, v22
  v_fmac_f32 v25, v22, v22
  v_add_f32 v26, v26, v104
  v_fmac_f32 v27, v104, v104
  v_lshlrev_b32 v22, 16, v105
  v_and_b32 v105, 0xffff0000, v105
  v_add_f32 v24, v24, v22
  v_fmac_f32 v25, v22, v22
  v_add_f32 v26, v26, v105
  v_fmac_f32 v27, v105, v105
  v_lshlrev_b32 v22, 16, v106
  v_and_b32 v106, 0xffff0000, v106
  v_add_f32 v24, v24, v22
  v_fmac_f32 v25, v22, v22
  v_add_f32 v26, v26, v106
  v_fmac_f32 v27, v106, v106
  v_lshlrev_b32 v22, 16, v107
  v_and_b32 v107, 0xffff0000, v107
  v_add_f32 v24, v24, v22
  v_fmac_f32 v25, v22, v22
  v_add_f32 v26, v26, v107
  v_fmac_f32 v27, v107, v107
  s_waitcnt vmcnt(4)
  v_lshlrev_b32 v22, 16, v108
  v_and_b32 v108, 0xffff0000, v108
  v_add_f32 v24, v24, v22
  v_fmac_f32 v25, v22, v22
  v_add_f32 v26, v26, v108
  v_fmac_f32 v27, v108, v108
  v_lshlrev_b32 v22, 16, v109
  v_and_b32 v109, 0xffff0000, v109
  v_add_f32 v24, v24, v22
  v_fmac_f32 v25, v22, v22
  v_add_f32 v26, v26, v109
  v_fmac_f32 v27, v109, v109
  v_lshlrev_b32 v22, 16, v110
  v_and_b32 v110, 0xffff0000, v110
  v_add_f32 v24, v24, v22
  v_fmac_f32 v25, v22, v22
  v_add_f32 v26, v26, v110
  v_fmac_f32 v27, v110, v110
  v_lshlrev_b32 v22, 16, v111
  v_and_b32 v111, 0xffff0000, v111
  v_add_f32 v24, v24, v22
  v_fmac_f32 v25, v22, v22
  v_add_f32 v26, v26, v111
  v_fmac_f32 v27, v111, v111
  s_waitcnt vmcnt(3)
  v_lshlrev_b32 v22, 16, v112
  v_and_b32 v112, 0xffff0000, v112
  v_add_f32 v24, v24, v22
  v_fmac_f32 v25, v22, v22
  v_add_f32 v26, v26, v112
  v_fmac_f32 v27, v112, v112
  v_lshlrev_b32 v22, 16, v113
  v_and_b32 v113, 0xffff0000, v113
  v_add_f32 v24, v24, v22
  v_fmac_f32 v25, v22, v22
  v_add_f32 v26, v26, v113
  v_fmac_f32 v27, v113, v113
  v_lshlrev_b32 v22, 16, v114
  v_and_b32 v114, 0xffff0000, v114
  v_add_f32 v24, v24, v22
  v_fmac_f32 v25, v22, v22
  v_add_f32 v26, v26, v114
  v_fmac_f32 v27, v114, v114
  v_lshlrev_b32 v22, 16, v115
  v_and_b32 v115, 0xffff0000, v115
  v_add_f32 v24, v24, v22
  v_fmac_f32 v25, v22, v22
  v_add_f32 v26, v26, v115
  v_fmac_f32 v27, v115, v115
  s_waitcnt vmcnt(2)
  v_lshlrev_b32 v22, 16, v116
  v_and_b32 v116, 0xffff0000, v116
  v_add_f32 v24, v24, v22
  v_fmac_f32 v25, v22, v22
  v_add_f32 v26, v26, v116
  v_fmac_f32 v27, v116, v116
  v_lshlrev_b32 v22, 16, v117
  v_and_b32 v117, 0xffff0000, v117
  v_add_f32 v24, v24, v22
  v_fmac_f32 v25, v22, v22
  v_add_f32 v26, v26, v117
  v_fmac_f32 v27, v117, v117
  v_lshlrev_b32 v22, 16, v118
  v_and_b32 v118, 0xffff0000, v118
  v_add_f32 v24, v24, v22
  v_fmac_f32 v25, v22, v22
  v_add_f32 v26, v26, v118
  v_fmac_f32 v27, v118, v118
  v_lshlrev_b32 v22, 16, v119
  v_and_b32 v119, 0xffff0000, v119
  v_add_f32 v24, v24, v22
  v_fmac_f32 v25, v22, v22
  v_add_f32 v26, v26, v119
  v_fmac_f32 v27, v119, v119
  s_waitcnt vmcnt(1)
  v_lshlrev_b32 v22, 16, v120
  v_and_b32 v120, 0xffff0000, v120
  v_add_f32 v24, v24, v22
  v_fmac_f32 v25, v22, v22
  v_add_f32 v26, v26, v120
  v_fmac_f32 v27, v120, v120
  v_lshlrev_b32 v22, 16, v121
  v_and_b32 v121, 0xffff0000, v121
  v_add_f32 v24, v24, v22
  v_fmac_f32 v25, v22, v22
  v_add_f32 v26, v26, v121
  v_fmac_f32 v27, v121, v121
  v_lshlrev_b32 v22, 16, v122
  v_and_b32 v122, 0xffff0000, v122
  v_add_f32 v24, v24, v22
  v_fmac_f32 v25, v22, v22
  v_add_f32 v26, v26, v122
  v_fmac_f32 v27, v122, v122
  v_lshlrev_b32 v22, 16, v123
  v_and_b32 v123, 0xffff0000, v123
  v_add_f32 v24, v24, v22
  v_fmac_f32 v25, v22, v22
  v_add_f32 v26, v26, v123
  v_fmac_f32 v27, v123, v123
  s_waitcnt vmcnt(0)
  v_lshlrev_b32 v22, 16, v124
  v_and_b32 v124, 0xffff0000, v124
  v_add_f32 v24, v24, v22
  v_fmac_f32 v25, v22, v22
  v_add_f32 v26, v26, v124
  v_fmac_f32 v27, v124, v124
  v_lshlrev_b32 v22, 16, v125
  v_and_b32 v125, 0xffff0000, v125
  v_add_f32 v24, v24, v22
  v_fmac_f32 v25, v22, v22
  v_add_f32 v26, v26, v125
  v_fmac_f32 v27, v125, v125
  v_lshlrev_b32 v22, 16, v126
  v_and_b32 v126, 0xffff0000, v126
  v_add_f32 v24, v24, v22
  v_fmac_f32 v25, v22, v22
  v_add_f32 v26, v26, v126
  v_fmac_f32 v27, v126, v126
  v_lshlrev_b32 v22, 16, v127
  v_and_b32 v127, 0xffff0000, v127
  v_add_f32 v24, v24, v22
  v_fmac_f32 v25, v22, v22
  v_add_f32 v26, v26, v127
  v_fmac_f32 v27, v127, v127
  v_add_f32 v24, v24, v26
  v_add_f32 v25, v25, v27
  s_nop 0
  v_add_f32 v24, v24, v24 quad_perm:[1,0,3,2] row_mask:0xf bank_mask:0xf
  v_add_f32 v25, v25, v25 quad_perm:[1,0,3,2] row_mask:0xf bank_mask:0xf
  s_nop 0
  v_add_f32 v24, v24, v24 quad_perm:[2,3,0,1] row_mask:0xf bank_mask:0xf
  v_add_f32 v25, v25, v25 quad_perm:[2,3,0,1] row_mask:0xf bank_mask:0xf
  s_nop 0
  v_add_f32 v24, v24, v24 row_half_mirror row_mask:0xf bank_mask:0xf
  v_add_f32 v25, v25, v25 row_half_mirror row_mask:0xf bank_mask:0xf
  v_mov_b32 v26, 0.0009765625
  v_mul_f32 v24, v26, v24
  v_mul_f32 v27, v24, v24
  v_fma_f32 v25, v25, v26, -v27
  v_max_f32 v25, 0, v25
  v_add_f32 v25, 1e-05, v25
  v_rsq_f32 v25, v25
  v_lshlrev_b32 v20, 2, v20
  v_mul_f32 v24, v24, v25
  v_sub_f32 v24, 0, v24
  s_add_u32 s33, s33, 0x3050000
  s_add_u32 s34, s33, 0x2000
  s_mov_b32 exec_lo, 0x01010101
  s_mov_b32 exec_hi, 0x01010101
  buffer_store_dword v25, v20, s[4:7], s33 offen sc1
  buffer_store_dword v24, v20, s[4:7], s34 offen sc1
  s_mov_b64 exec, -1
  s_mov_b32 s12, s58
  s_mov_b32 s13, s59
  s_mov_b32 s14, 0x100
  s_mov_b32 s15, 0x00020000
  s_mov_b32 s38, 0
  s_mov_b64 exec, 1
.g2_kernel_gt5:
  buffer_load_dword v6, v4, s[12:15], 0 offen sc1
  s_add_u32 s38, s38, 1
  s_waitcnt vmcnt(0)
  v_cmp_eq_u32 vcc, 0x48, v6
  s_cbranch_vccnz .g2_kernel_gt5d
  s_sleep 8
  s_cmp_lt_u32 s38, 131072
  s_cbranch_scc1 .g2_kernel_gt5
.g2_kernel_gt5d:
  s_mov_b64 exec, -1
  v_mov_b32 v6, s70
  s_mov_b64 exec, 1
  buffer_store_dword v6, v4, s[4:7], s19 offen offset:12 sc1
  s_mov_b64 exec, -1
  v_mov_b32 v6, 155648
  s_mov_b32 s38, 0
.g2_kernel_wg6:
  ds_read_b32 v7, v6 offset:512
  s_add_u32 s38, s38, 1
  s_waitcnt lgkmcnt(0)
  v_cmp_le_u32 vcc, 27, v7
  s_cbranch_vccnz .g2_kernel_wg6d
  s_sleep 4
  s_cmp_lt_u32 s38, 524288
  s_cbranch_scc1 .g2_kernel_wg6
.g2_kernel_wg6d:
  s_and_b32 s31, s19, 0xffffe000
  s_add_u32 s31, s31, 12
  v_and_b32 v6, 15, v2
  v_lshlrev_b32 v6, 9, v6
  v_lshrrev_b32 v7, 4, v2
  v_lshl_add_u32 v6, v7, 7, v6
  v_lshlrev_b32 v7, 2, v2
  v_add_u32 v7, 157952, v7
  s_mov_b32 m0, 157952
  s_mov_b32 s38, 0
  s_bfm_b64 exec, 16, 0
.g2_kernel_pa7:
  buffer_load_dword v6, s[4:7], s31 offen sc1 lds
  s_add_u32 s38, s38, 1
  s_waitcnt vmcnt(0)
  ds_read_b32 v8, v7
  s_waitcnt lgkmcnt(0)
  v_cmp_ge_u32 vcc, s62, v8
  s_cbranch_vccz .g2_kernel_pa7d
  s_mov_b64 exec, vcc
  s_sleep 16
  s_cmp_lt_u32 s38, 131072
  s_cbranch_scc1 .g2_kernel_pa7
.g2_kernel_pa7d:
  s_mov_b64 exec, -1
  s_lshl_b32 s33, s17, 9
  s_add_u32 s33, s33, 0x3050000
  s_add_u32 s34, s33, 0x2000
  s_mov_b32 exec_hi, 0
  s_mov_b32 m0, 158464
  s_nop 0
  buffer_load_dwordx4 v3, s[4:7], s33 offen sc1 lds
  s_mov_b32 m0, 158976
  s_nop 0
  buffer_load_dwordx4 v3, s[4:7], s34 offen sc1 lds
  s_mov_b64 exec, -1
  v_mov_b32 v20, 1.0
  v_mov_b32 v21, 1.0
  v_mov_b32 v22, 0
  v_mov_b32 v23, 0
  v_lshlrev_b32 v24, 3, v2
  v_add_u32 v24, 155648, v24
  v_mov_b32 v6, 155648
  s_mov_b32 s38, 0
.g2_kernel_wg8:
  ds_read_b32 v7, v6 offset:512
  s_add_u32 s38, s38, 1
  s_waitcnt lgkmcnt(0)
  v_cmp_le_u32 vcc, 32, v7
  s_cbranch_vccnz .g2_kernel_wg8d
  s_sleep 2
  s_cmp_lt_u32 s38, 524288
  s_cbranch_scc1 .g2_kernel_wg8
.g2_kernel_wg8d:
  ds_write_b64 v24, v[20:21] offset:3840
  ds_write_b64 v24, v[22:23] offset:4352
  v_lshlrev_b32 v24, 2, v2
  v_add_u32 v24, 155648, v24
  ds_write_b32 v24, v4 offset:2304
  s_waitcnt vmcnt(0)
  v_mov_b32 v6, s71
  s_mov_b64 exec, 1
  ds_add_u32 v6, v5 offset:0
  s_mov_b64 exec, -1
  s_branch .g2_kernel_v
.g2_kernel_s2:
  s_mov_b32 s8, s42
  s_mov_b32 s9, s43
  s_mov_b32 s10, 0x600000
  s_mov_b32 s11, 0x00020000
  v_lshrrev_b32 v20, 3, v2
  v_and_b32 v21, 7, v2
  v_mul_u32_u24 v20, 6144, v20
  v_lshl_add_u32 v20, v21, 4, v20
  s_mul_i32 s30, s17, 393216
  s_lshl_b32 s31, s18, 7
  s_add_u32 s30, s30, s31
  s_add_u32 s31, s30, 4096
  s_barrier
  s_sleep 0
  buffer_load_dwordx4 v[64:67], v20, s[8:11], s30 offen
  buffer_load_dwordx4 v[68:71], v20, s[8:11], s30 offen offset:2048
  buffer_load_dwordx4 v[72:75], v20, s[8:11], s31 offen
  s_add_u32 s30, s30, 49152
  s_add_u32 s31, s31, 49152
  buffer_load_dwordx4 v[76:79], v20, s[8:11], s30 offen
  buffer_load_dwordx4 v[80:83], v20, s[8:11], s30 offen offset:2048
  buffer_load_dwordx4 v[84:87], v20, s[8:11], s31 offen
  s_add_u32 s30, s30, 49152
  s_add_u32 s31, s31, 49152
  buffer_load_dwordx4 v[88:91], v20, s[8:11], s30 offen
  buffer_load_dwordx4 v[92:95], v20, s[8:11], s30 offen offset:2048
  buffer_load_dwordx4 v[96:99], v20, s[8:11], s31 offen
  s_add_u32 s30, s30, 49152
  s_add_u32 s31, s31, 49152
  buffer_load_dwordx4 v[100:103], v20, s[8:11], s30 offen
  buffer_load_dwordx4 v[104:107], v20, s[8:11], s30 offen offset:2048
  buffer_load_dwordx4 v[108:111], v20, s[8:11], s31 offen
  s_add_u32 s30, s30, 49152
  s_add_u32 s31, s31, 49152
  buffer_load_dwordx4 v[112:115], v20, s[8:11], s30 offen
  buffer_load_dwordx4 v[116:119], v20, s[8:11], s30 offen offset:2048
  buffer_load_dwordx4 v[120:123], v20, s[8:11], s31 offen
  s_add_u32 s30, s30, 49152
  s_add_u32 s31, s31, 49152
  buffer_load_dwordx4 v[124:127], v20, s[8:11], s30 offen
  buffer_load_dwordx4 v[128:131], v20, s[8:11], s30 offen offset:2048
  buffer_load_dwordx4 v[132:135], v20, s[8:11], s31 offen
  s_add_u32 s30, s30, 49152
  s_add_u32 s31, s31, 49152
  buffer_load_dwordx4 v[136:139], v20, s[8:11], s30 offen
  buffer_load_dwordx4 v[140:143], v20, s[8:11], s30 offen offset:2048
  buffer_load_dwordx4 v[144:147], v20, s[8:11], s31 offen
  s_add_u32 s30, s30, 49152
  s_add_u32 s31, s31, 49152
  buffer_load_dwordx4 v[148:151], v20, s[8:11], s30 offen
  buffer_load_dwordx4 v[152:155], v20, s[8:11], s30 offen offset:2048
  buffer_load_dwordx4 v[156:159], v20, s[8:11], s31 offen
  s_add_u32 s30, s30, 49152
  s_add_u32 s31, s31, 49152
  v_lshlrev_b32 v21, 5, v21
  v_lshrrev_b32 v22, 5, v2
  v_lshl_add_u32 v21, v22, 4, v21
  v_bfe_u32 v22, v2, 4, 1
  v_lshl_add_u32 v21, v22, 3, v21
  s_lshl_b32 s30, s18, 4
  s_add_u32 s30, s30, s17
  s_mul_i32 s30, s30, 768
  s_add_u32 s30, s30, 0x3060000
  s_waitcnt vmcnt(23)
  v_lshlrev_b32 v160, 16, v64
  v_and_b32 v161, 0xffff0000, v64
  v_lshlrev_b32 v162, 16, v65
  v_and_b32 v163, 0xffff0000, v65
  v_lshlrev_b32 v164, 16, v66
  v_and_b32 v165, 0xffff0000, v66
  v_lshlrev_b32 v166, 16, v67
  v_and_b32 v167, 0xffff0000, v67
  s_waitcnt vmcnt(22)
  v_lshlrev_b32 v168, 16, v68
  v_and_b32 v169, 0xffff0000, v68
  v_lshlrev_b32 v170, 16, v69
  v_and_b32 v171, 0xffff0000, v69
  v_lshlrev_b32 v172, 16, v70
  v_and_b32 v173, 0xffff0000, v70
  v_lshlrev_b32 v174, 16, v71
  v_and_b32 v175, 0xffff0000, v71
  s_waitcnt vmcnt(21)
  v_lshlrev_b32 v176, 16, v72
  v_and_b32 v177, 0xffff0000, v72
  v_lshlrev_b32 v178, 16, v73
  v_and_b32 v179, 0xffff0000, v73
  v_lshlrev_b32 v180, 16, v74
  v_and_b32 v181, 0xffff0000, v74
  v_lshlrev_b32 v182, 16, v75
  v_and_b32 v183, 0xffff0000, v75
  s_waitcnt vmcnt(20)
  v_lshlrev_b32 v184, 16, v76
  v_and_b32 v185, 0xffff0000, v76
  v_lshlrev_b32 v186, 16, v77
  v_and_b32 v187, 0xffff0000, v77
  v_lshlrev_b32 v188, 16, v78
  v_and_b32 v189, 0xffff0000, v78
  v_lshlrev_b32 v190, 16, v79
  v_and_b32 v191, 0xffff0000, v79
  v_add_f32 v160, v160, v184
  v_add_f32 v161, v161, v185
  v_add_f32 v162, v162, v186
  v_add_f32 v163, v163, v187
  v_add_f32 v164, v164, v188
  v_add_f32 v165, v165, v189
  v_add_f32 v166, v166, v190
  v_add_f32 v167, v167, v191
  s_waitcnt vmcnt(19)
  v_lshlrev_b32 v184, 16, v80
  v_and_b32 v185, 0xffff0000, v80
  v_lshlrev_b32 v186, 16, v81
  v_and_b32 v187, 0xffff0000, v81
  v_lshlrev_b32 v188, 16, v82
  v_and_b32 v189, 0xffff0000, v82
  v_lshlrev_b32 v190, 16, v83
  v_and_b32 v191, 0xffff0000, v83
  v_add_f32 v168, v168, v184
  v_add_f32 v169, v169, v185
  v_add_f32 v170, v170, v186
  v_add_f32 v171, v171, v187
  v_add_f32 v172, v172, v188
  v_add_f32 v173, v173, v189
  v_add_f32 v174, v174, v190
  v_add_f32 v175, v175, v191
  s_waitcnt vmcnt(18)
  v_lshlrev_b32 v184, 16, v84
  v_and_b32 v185, 0xffff0000, v84
  v_lshlrev_b32 v186, 16, v85
  v_and_b32 v187, 0xffff0000, v85
  v_lshlrev_b32 v188, 16, v86
  v_and_b32 v189, 0xffff0000, v86
  v_lshlrev_b32 v190, 16, v87
  v_and_b32 v191, 0xffff0000, v87
  v_add_f32 v176, v176, v184
  v_add_f32 v177, v177, v185
  v_add_f32 v178, v178, v186
  v_add_f32 v179, v179, v187
  v_add_f32 v180, v180, v188
  v_add_f32 v181, v181, v189
  v_add_f32 v182, v182, v190
  v_add_f32 v183, v183, v191
  s_waitcnt vmcnt(17)
  v_lshlrev_b32 v184, 16, v88
  v_and_b32 v185, 0xffff0000, v88
  v_lshlrev_b32 v186, 16, v89
  v_and_b32 v187, 0xffff0000, v89
  v_lshlrev_b32 v188, 16, v90
  v_and_b32 v189, 0xffff0000, v90
  v_lshlrev_b32 v190, 16, v91
  v_and_b32 v191, 0xffff0000, v91
  v_add_f32 v160, v160, v184
  v_add_f32 v161, v161, v185
  v_add_f32 v162, v162, v186
  v_add_f32 v163, v163, v187
  v_add_f32 v164, v164, v188
  v_add_f32 v165, v165, v189
  v_add_f32 v166, v166, v190
  v_add_f32 v167, v167, v191
  s_waitcnt vmcnt(16)
  v_lshlrev_b32 v184, 16, v92
  v_and_b32 v185, 0xffff0000, v92
  v_lshlrev_b32 v186, 16, v93
  v_and_b32 v187, 0xffff0000, v93
  v_lshlrev_b32 v188, 16, v94
  v_and_b32 v189, 0xffff0000, v94
  v_lshlrev_b32 v190, 16, v95
  v_and_b32 v191, 0xffff0000, v95
  v_add_f32 v168, v168, v184
  v_add_f32 v169, v169, v185
  v_add_f32 v170, v170, v186
  v_add_f32 v171, v171, v187
  v_add_f32 v172, v172, v188
  v_add_f32 v173, v173, v189
  v_add_f32 v174, v174, v190
  v_add_f32 v175, v175, v191
  s_waitcnt vmcnt(15)
  v_lshlrev_b32 v184, 16, v96
  v_and_b32 v185, 0xffff0000, v96
  v_lshlrev_b32 v186, 16, v97
  v_and_b32 v187, 0xffff0000, v97
  v_lshlrev_b32 v188, 16, v98
  v_and_b32 v189, 0xffff0000, v98
  v_lshlrev_b32 v190, 16, v99
  v_and_b32 v191, 0xffff0000, v99
  v_add_f32 v176, v176, v184
  v_add_f32 v177, v177, v185
  v_add_f32 v178, v178, v186
  v_add_f32 v179, v179, v187
  v_add_f32 v180, v180, v188
  v_add_f32 v181, v181, v189
  v_add_f32 v182, v182, v190
  v_add_f32 v183, v183, v191
  s_waitcnt vmcnt(14)
  v_lshlrev_b32 v184, 16, v100
  v_and_b32 v185, 0xffff0000, v100
  v_lshlrev_b32 v186, 16, v101
  v_and_b32 v187, 0xffff0000, v101
  v_lshlrev_b32 v188, 16, v102
  v_and_b32 v189, 0xffff0000, v102
  v_lshlrev_b32 v190, 16, v103
  v_and_b32 v191, 0xffff0000, v103
  v_add_f32 v160, v160, v184
  v_add_f32 v161, v161, v185
  v_add_f32 v162, v162, v186
  v_add_f32 v163, v163, v187
  v_add_f32 v164, v164, v188
  v_add_f32 v165, v165, v189
  v_add_f32 v166, v166, v190
  v_add_f32 v167, v167, v191
  s_waitcnt vmcnt(13)
  v_lshlrev_b32 v184, 16, v104
  v_and_b32 v185, 0xffff0000, v104
  v_lshlrev_b32 v186, 16, v105
  v_and_b32 v187, 0xffff0000, v105
  v_lshlrev_b32 v188, 16, v106
  v_and_b32 v189, 0xffff0000, v106
  v_lshlrev_b32 v190, 16, v107
  v_and_b32 v191, 0xffff0000, v107
  v_add_f32 v168, v168, v184
  v_add_f32 v169, v169, v185
  v_add_f32 v170, v170, v186
  v_add_f32 v171, v171, v187
  v_add_f32 v172, v172, v188
  v_add_f32 v173, v173, v189
  v_add_f32 v174, v174, v190
  v_add_f32 v175, v175, v191
  s_waitcnt vmcnt(12)
  v_lshlrev_b32 v184, 16, v108
  v_and_b32 v185, 0xffff0000, v108
  v_lshlrev_b32 v186, 16, v109
  v_and_b32 v187, 0xffff0000, v109
  v_lshlrev_b32 v188, 16, v110
  v_and_b32 v189, 0xffff0000, v110
  v_lshlrev_b32 v190, 16, v111
  v_and_b32 v191, 0xffff0000, v111
  v_add_f32 v176, v176, v184
  v_add_f32 v177, v177, v185
  v_add_f32 v178, v178, v186
  v_add_f32 v179, v179, v187
  v_add_f32 v180, v180, v188
  v_add_f32 v181, v181, v189
  v_add_f32 v182, v182, v190
  v_add_f32 v183, v183, v191
  s_waitcnt vmcnt(11)
  v_lshlrev_b32 v184, 16, v112
  v_and_b32 v185, 0xffff0000, v112
  v_lshlrev_b32 v186, 16, v113
  v_and_b32 v187, 0xffff0000, v113
  v_lshlrev_b32 v188, 16, v114
  v_and_b32 v189, 0xffff0000, v114
  v_lshlrev_b32 v190, 16, v115
  v_and_b32 v191, 0xffff0000, v115
  v_add_f32 v160, v160, v184
  v_add_f32 v161, v161, v185
  v_add_f32 v162, v162, v186
  v_add_f32 v163, v163, v187
  v_add_f32 v164, v164, v188
  v_add_f32 v165, v165, v189
  v_add_f32 v166, v166, v190
  v_add_f32 v167, v167, v191
  s_waitcnt vmcnt(10)
  v_lshlrev_b32 v184, 16, v116
  v_and_b32 v185, 0xffff0000, v116
  v_lshlrev_b32 v186, 16, v117
  v_and_b32 v187, 0xffff0000, v117
  v_lshlrev_b32 v188, 16, v118
  v_and_b32 v189, 0xffff0000, v118
  v_lshlrev_b32 v190, 16, v119
  v_and_b32 v191, 0xffff0000, v119
  v_add_f32 v168, v168, v184
  v_add_f32 v169, v169, v185
  v_add_f32 v170, v170, v186
  v_add_f32 v171, v171, v187
  v_add_f32 v172, v172, v188
  v_add_f32 v173, v173, v189
  v_add_f32 v174, v174, v190
  v_add_f32 v175, v175, v191
  s_waitcnt vmcnt(9)
  v_lshlrev_b32 v184, 16, v120
  v_and_b32 v185, 0xffff0000, v120
  v_lshlrev_b32 v186, 16, v121
  v_and_b32 v187, 0xffff0000, v121
  v_lshlrev_b32 v188, 16, v122
  v_and_b32 v189, 0xffff0000, v122
  v_lshlrev_b32 v190, 16, v123
  v_and_b32 v191, 0xffff0000, v123
  v_add_f32 v176, v176, v184
  v_add_f32 v177, v177, v185
  v_add_f32 v178, v178, v186
  v_add_f32 v179, v179, v187
  v_add_f32 v180, v180, v188
  v_add_f32 v181, v181, v189
  v_add_f32 v182, v182, v190
  v_add_f32 v183, v183, v191
  s_waitcnt vmcnt(8)
  v_lshlrev_b32 v184, 16, v124
  v_and_b32 v185, 0xffff0000, v124
  v_lshlrev_b32 v186, 16, v125
  v_and_b32 v187, 0xffff0000, v125
  v_lshlrev_b32 v188, 16, v126
  v_and_b32 v189, 0xffff0000, v126
  v_lshlrev_b32 v190, 16, v127
  v_and_b32 v191, 0xffff0000, v127
  v_add_f32 v160, v160, v184
  v_add_f32 v161, v161, v185
  v_add_f32 v162, v162, v186
  v_add_f32 v163, v163, v187
  v_add_f32 v164, v164, v188
  v_add_f32 v165, v165, v189
  v_add_f32 v166, v166, v190
  v_add_f32 v167, v167, v191
  s_waitcnt vmcnt(7)
  v_lshlrev_b32 v184, 16, v128
  v_and_b32 v185, 0xffff0000, v128
  v_lshlrev_b32 v186, 16, v129
  v_and_b32 v187, 0xffff0000, v129
  v_lshlrev_b32 v188, 16, v130
  v_and_b32 v189, 0xffff0000, v130
  v_lshlrev_b32 v190, 16, v131
  v_and_b32 v191, 0xffff0000, v131
  v_add_f32 v168, v168, v184
  v_add_f32 v169, v169, v185
  v_add_f32 v170, v170, v186
  v_add_f32 v171, v171, v187
  v_add_f32 v172, v172, v188
  v_add_f32 v173, v173, v189
  v_add_f32 v174, v174, v190
  v_add_f32 v175, v175, v191
  s_waitcnt vmcnt(6)
  v_lshlrev_b32 v184, 16, v132
  v_and_b32 v185, 0xffff0000, v132
  v_lshlrev_b32 v186, 16, v133
  v_and_b32 v187, 0xffff0000, v133
  v_lshlrev_b32 v188, 16, v134
  v_and_b32 v189, 0xffff0000, v134
  v_lshlrev_b32 v190, 16, v135
  v_and_b32 v191, 0xffff0000, v135
  v_add_f32 v176, v176, v184
  v_add_f32 v177, v177, v185
  v_add_f32 v178, v178, v186
  v_add_f32 v179, v179, v187
  v_add_f32 v180, v180, v188
  v_add_f32 v181, v181, v189
  v_add_f32 v182, v182, v190
  v_add_f32 v183, v183, v191
  s_waitcnt vmcnt(5)
  v_lshlrev_b32 v184, 16, v136
  v_and_b32 v185, 0xffff0000, v136
  v_lshlrev_b32 v186, 16, v137
  v_and_b32 v187, 0xffff0000, v137
  v_lshlrev_b32 v188, 16, v138
  v_and_b32 v189, 0xffff0000, v138
  v_lshlrev_b32 v190, 16, v139
  v_and_b32 v191, 0xffff0000, v139
  v_add_f32 v160, v160, v184
  v_add_f32 v161, v161, v185
  v_add_f32 v162, v162, v186
  v_add_f32 v163, v163, v187
  v_add_f32 v164, v164, v188
  v_add_f32 v165, v165, v189
  v_add_f32 v166, v166, v190
  v_add_f32 v167, v167, v191
  s_waitcnt vmcnt(4)
  v_lshlrev_b32 v184, 16, v140
  v_and_b32 v185, 0xffff0000, v140
  v_lshlrev_b32 v186, 16, v141
  v_and_b32 v187, 0xffff0000, v141
  v_lshlrev_b32 v188, 16, v142
  v_and_b32 v189, 0xffff0000, v142
  v_lshlrev_b32 v190, 16, v143
  v_and_b32 v191, 0xffff0000, v143
  v_add_f32 v168, v168, v184
  v_add_f32 v169, v169, v185
  v_add_f32 v170, v170, v186
  v_add_f32 v171, v171, v187
  v_add_f32 v172, v172, v188
  v_add_f32 v173, v173, v189
  v_add_f32 v174, v174, v190
  v_add_f32 v175, v175, v191
  s_waitcnt vmcnt(3)
  v_lshlrev_b32 v184, 16, v144
  v_and_b32 v185, 0xffff0000, v144
  v_lshlrev_b32 v186, 16, v145
  v_and_b32 v187, 0xffff0000, v145
  v_lshlrev_b32 v188, 16, v146
  v_and_b32 v189, 0xffff0000, v146
  v_lshlrev_b32 v190, 16, v147
  v_and_b32 v191, 0xffff0000, v147
  v_add_f32 v176, v176, v184
  v_add_f32 v177, v177, v185
  v_add_f32 v178, v178, v186
  v_add_f32 v179, v179, v187
  v_add_f32 v180, v180, v188
  v_add_f32 v181, v181, v189
  v_add_f32 v182, v182, v190
  v_add_f32 v183, v183, v191
  s_waitcnt vmcnt(2)
  v_lshlrev_b32 v184, 16, v148
  v_and_b32 v185, 0xffff0000, v148
  v_lshlrev_b32 v186, 16, v149
  v_and_b32 v187, 0xffff0000, v149
  v_lshlrev_b32 v188, 16, v150
  v_and_b32 v189, 0xffff0000, v150
  v_lshlrev_b32 v190, 16, v151
  v_and_b32 v191, 0xffff0000, v151
  v_add_f32 v160, v160, v184
  v_add_f32 v161, v161, v185
  v_add_f32 v162, v162, v186
  v_add_f32 v163, v163, v187
  v_add_f32 v164, v164, v188
  v_add_f32 v165, v165, v189
  v_add_f32 v166, v166, v190
  v_add_f32 v167, v167, v191
  s_waitcnt vmcnt(1)
  v_lshlrev_b32 v184, 16, v152
  v_and_b32 v185, 0xffff0000, v152
  v_lshlrev_b32 v186, 16, v153
  v_and_b32 v187, 0xffff0000, v153
  v_lshlrev_b32 v188, 16, v154
  v_and_b32 v189, 0xffff0000, v154
  v_lshlrev_b32 v190, 16, v155
  v_and_b32 v191, 0xffff0000, v155
  v_add_f32 v168, v168, v184
  v_add_f32 v169, v169, v185
  v_add_f32 v170, v170, v186
  v_add_f32 v171, v171, v187
  v_add_f32 v172, v172, v188
  v_add_f32 v173, v173, v189
  v_add_f32 v174, v174, v190
  v_add_f32 v175, v175, v191
  s_waitcnt vmcnt(0)
  v_lshlrev_b32 v184, 16, v156
  v_and_b32 v185, 0xffff0000, v156
  v_lshlrev_b32 v186, 16, v157
  v_and_b32 v187, 0xffff0000, v157
  v_lshlrev_b32 v188, 16, v158
  v_and_b32 v189, 0xffff0000, v158
  v_lshlrev_b32 v190, 16, v159
  v_and_b32 v191, 0xffff0000, v159
  v_add_f32 v176, v176, v184
  v_add_f32 v177, v177, v185
  v_add_f32 v178, v178, v186
  v_add_f32 v179, v179, v187
  v_add_f32 v180, v180, v188
  v_add_f32 v181, v181, v189
  v_add_f32 v182, v182, v190
  v_add_f32 v183, v183, v191
  v_permlane32_swap_b32 v160, v164
  v_permlane32_swap_b32 v161, v165
  v_permlane32_swap_b32 v162, v166
  v_permlane32_swap_b32 v163, v167
  v_add_f32 v160, v160, v164
  v_add_f32 v161, v161, v165
  v_add_f32 v162, v162, v166
  v_add_f32 v163, v163, v167
  s_nop 0
  v_permlane16_swap_b32 v160, v162
  v_permlane16_swap_b32 v161, v163
  v_add_f32 v160, v160, v162
  v_add_f32 v161, v161, v163
  s_nop 0
  v_add_f32 v160, v160, v160 row_ror:8 row_mask:0xf bank_mask:0xf
  v_add_f32 v161, v161, v161 row_ror:8 row_mask:0xf bank_mask:0xf
  v_permlane32_swap_b32 v168, v172
  v_permlane32_swap_b32 v169, v173
  v_permlane32_swap_b32 v170, v174
  v_permlane32_swap_b32 v171, v175
  v_add_f32 v168, v168, v172
  v_add_f32 v169, v169, v173
  v_add_f32 v170, v170, v174
  v_add_f32 v171, v171, v175
  s_nop 0
  v_permlane16_swap_b32 v168, v170
  v_permlane16_swap_b32 v169, v171
  v_add_f32 v168, v168, v170
  v_add_f32 v169, v169, v171
  s_nop 0
  v_add_f32 v168, v168, v168 row_ror:8 row_mask:0xf bank_mask:0xf
  v_add_f32 v169, v169, v169 row_ror:8 row_mask:0xf bank_mask:0xf
  v_permlane32_swap_b32 v176, v180
  v_permlane32_swap_b32 v177, v181
  v_permlane32_swap_b32 v178, v182
  v_permlane32_swap_b32 v179, v183
  v_add_f32 v176, v176, v180
  v_add_f32 v177, v177, v181
  v_add_f32 v178, v178, v182
  v_add_f32 v179, v179, v183
  s_nop 0
  v_permlane16_swap_b32 v176, v178
  v_permlane16_swap_b32 v177, v179
  v_add_f32 v176, v176, v178
  v_add_f32 v177, v177, v179
  s_nop 0
  v_add_f32 v176, v176, v176 row_ror:8 row_mask:0xf bank_mask:0xf
  v_add_f32 v177, v177, v177 row_ror:8 row_mask:0xf bank_mask:0xf
  s_mov_b32 exec_lo, 0x00ff00ff
  s_mov_b32 exec_hi, 0x00ff00ff
  buffer_store_dwordx2 v[160:161], v21, s[4:7], s30 offen offset:0 sc1
  buffer_store_dwordx2 v[168:169], v21, s[4:7], s30 offen offset:256 sc1
  buffer_store_dwordx2 v[176:177], v21, s[4:7], s30 offen offset:512 sc1
  s_mov_b64 exec, -1
  s_mov_b32 s12, s58
  s_mov_b32 s13, s59
  s_mov_b32 s14, 0x100
  s_mov_b32 s15, 0x00020000
  s_mov_b32 s38, 0
  s_mov_b64 exec, 1
.g2_kernel_gt9:
  buffer_load_dword v6, v4, s[12:15], 0 offen sc1
  s_add_u32 s38, s38, 1
  s_waitcnt vmcnt(0)
  v_cmp_eq_u32 vcc, 0x48, v6
  s_cbranch_vccnz .g2_kernel_gt9d
  s_sleep 8
  s_cmp_lt_u32 s38, 131072
  s_cbranch_scc1 .g2_kernel_gt9
.g2_kernel_gt9d:
  s_mov_b64 exec, -1
  v_mov_b32 v6, s70
  s_mov_b64 exec, 1
  buffer_store_dword v6, v4, s[4:7], s76 offen offset:4 sc1
  s_mov_b64 exec, -1
  v_mov_b32 v6, 155648
  s_mov_b32 s38, 0
.g2_kernel_wg10:
  ds_read_b32 v7, v6 offset:512
  s_add_u32 s38, s38, 1
  s_waitcnt lgkmcnt(0)
  v_cmp_le_u32 vcc, 27, v7
  s_cbranch_vccnz .g2_kernel_wg10d
  s_sleep 4
  s_cmp_lt_u32 s38, 524288
  s_cbranch_scc1 .g2_kernel_wg10
.g2_kernel_wg10d:
  s_and_b32 s31, s76, 0xffffe000
  s_add_u32 s31, s31, 4
  v_and_b32 v6, 15, v2
  v_lshlrev_b32 v6, 9, v6
  v_lshrrev_b32 v7, 4, v2
  v_lshl_add_u32 v6, v7, 7, v6
  v_lshlrev_b32 v7, 2, v2
  v_add_u32 v7, 157696, v7
  s_mov_b32 m0, 157696
  s_mov_b32 s38, 0
  s_bfm_b64 exec, 16, 0
.g2_kernel_pa11:
  buffer_load_dword v6, s[4:7], s31 offen sc1 lds
  s_add_u32 s38, s38, 1
  s_waitcnt vmcnt(0)
  ds_read_b32 v8, v7
  s_waitcnt lgkmcnt(0)
  v_cmp_ge_u32 vcc, s62, v8
  s_cbranch_vccz .g2_kernel_pa11d
  s_mov_b64 exec, vcc
  s_sleep 16
  s_cmp_lt_u32 s38, 131072
  s_cbranch_scc1 .g2_kernel_pa11
.g2_kernel_pa11d:
  s_mov_b64 exec, -1
  s_mul_i32 s30, s18, 12288
  s_add_u32 s30, s30, 0x3060000
  s_mov_b32 exec_hi, 0xffff
  buffer_load_dwordx4 v[64:67], v3, s[4:7], s30 offen offset:0 sc1
  buffer_load_dwordx4 v[68:71], v3, s[4:7], s30 offen offset:768 sc1
  buffer_load_dwordx4 v[72:75], v3, s[4:7], s30 offen offset:1536 sc1
  buffer_load_dwordx4 v[76:79], v3, s[4:7], s30 offen offset:2304 sc1
  s_add_u32 s30, s30, 3072
  buffer_load_dwordx4 v[80:83], v3, s[4:7], s30 offen offset:0 sc1
  buffer_load_dwordx4 v[84:87], v3, s[4:7], s30 offen offset:768 sc1
  buffer_load_dwordx4 v[88:91], v3, s[4:7], s30 offen offset:1536 sc1
  buffer_load_dwordx4 v[92:95], v3, s[4:7], s30 offen offset:2304 sc1
  s_add_u32 s30, s30, 3072
  buffer_load_dwordx4 v[96:99], v3, s[4:7], s30 offen offset:0 sc1
  buffer_load_dwordx4 v[100:103], v3, s[4:7], s30 offen offset:768 sc1
  buffer_load_dwordx4 v[104:107], v3, s[4:7], s30 offen offset:1536 sc1
  buffer_load_dwordx4 v[108:111], v3, s[4:7], s30 offen offset:2304 sc1
  s_add_u32 s30, s30, 3072
  buffer_load_dwordx4 v[112:115], v3, s[4:7], s30 offen offset:0 sc1
  buffer_load_dwordx4 v[116:119], v3, s[4:7], s30 offen offset:768 sc1
  buffer_load_dwordx4 v[120:123], v3, s[4:7], s30 offen offset:1536 sc1
  buffer_load_dwordx4 v[124:127], v3, s[4:7], s30 offen offset:2304 sc1
  s_add_u32 s30, s30, 3072
  s_waitcnt vmcnt(14)
  v_add_f32 v64, v64, v68
  v_add_f32 v65, v65, v69
  v_add_f32 v66, v66, v70
  v_add_f32 v67, v67, v71
  s_waitcnt vmcnt(13)
  v_add_f32 v64, v64, v72
  v_add_f32 v65, v65, v73
  v_add_f32 v66, v66, v74
  v_add_f32 v67, v67, v75
  s_waitcnt vmcnt(12)
  v_add_f32 v64, v64, v76
  v_add_f32 v65, v65, v77
  v_add_f32 v66, v66, v78
  v_add_f32 v67, v67, v79
  s_waitcnt vmcnt(11)
  v_add_f32 v64, v64, v80
  v_add_f32 v65, v65, v81
  v_add_f32 v66, v66, v82
  v_add_f32 v67, v67, v83
  s_waitcnt vmcnt(10)
  v_add_f32 v64, v64, v84
  v_add_f32 v65, v65, v85
  v_add_f32 v66, v66, v86
  v_add_f32 v67, v67, v87
  s_waitcnt vmcnt(9)
  v_add_f32 v64, v64, v88
  v_add_f32 v65, v65, v89
  v_add_f32 v66, v66, v90
  v_add_f32 v67, v67, v91
  s_waitcnt vmcnt(8)
  v_add_f32 v64, v64, v92
  v_add_f32 v65, v65, v93
  v_add_f32 v66, v66, v94
  v_add_f32 v67, v67, v95
  s_waitcnt vmcnt(7)
  v_add_f32 v64, v64, v96
  v_add_f32 v65, v65, v97
  v_add_f32 v66, v66, v98
  v_add_f32 v67, v67, v99
  s_waitcnt vmcnt(6)
  v_add_f32 v64, v64, v100
  v_add_f32 v65, v65, v101
  v_add_f32 v66, v66, v102
  v_add_f32 v67, v67, v103
  s_waitcnt vmcnt(5)
  v_add_f32 v64, v64, v104
  v_add_f32 v65, v65, v105
  v_add_f32 v66, v66, v106
  v_add_f32 v67, v67, v107
  s_waitcnt vmcnt(4)
  v_add_f32 v64, v64, v108
  v_add_f32 v65, v65, v109
  v_add_f32 v66, v66, v110
  v_add_f32 v67, v67, v111
  s_waitcnt vmcnt(3)
  v_add_f32 v64, v64, v112
  v_add_f32 v65, v65, v113
  v_add_f32 v66, v66, v114
  v_add_f32 v67, v67, v115
  s_waitcnt vmcnt(2)
  v_add_f32 v64, v64, v116
  v_add_f32 v65, v65, v117
  v_add_f32 v66, v66, v118
  v_add_f32 v67, v67, v119
  s_waitcnt vmcnt(1)
  v_add_f32 v64, v64, v120
  v_add_f32 v65, v65, v121
  v_add_f32 v66, v66, v122
  v_add_f32 v67, v67, v123
  s_waitcnt vmcnt(0)
  v_add_f32 v64, v64, v124
  v_add_f32 v65, v65, v125
  v_add_f32 v66, v66, v126
  v_add_f32 v67, v67, v127
  s_mov_b64 exec, -1
  v_mov_b32 v6, 155648
  s_mov_b32 s38, 0
.g2_kernel_wg12:
  ds_read_b32 v7, v6 offset:512
  s_add_u32 s38, s38, 1
  s_waitcnt lgkmcnt(0)
  v_cmp_le_u32 vcc, 32, v7
  s_cbranch_vccnz .g2_kernel_wg12d
  s_sleep 2
  s_cmp_lt_u32 s38, 524288
  s_cbranch_scc1 .g2_kernel_wg12
.g2_kernel_wg12d:
  v_lshlrev_b32 v24, 2, v2
  v_add_u32 v24, 155648, v24
  ds_write_b32 v24, v4 offset:2048
  v_add_u32 v24, 155648, v3
  s_mov_b32 exec_hi, 0xffff
  ds_write_b128 v24, v[64:67] offset:4864
  s_mov_b64 exec, -1
  v_mov_b32 v6, s71
  s_mov_b64 exec, 1
  ds_add_u32 v6, v5 offset:0
  s_mov_b64 exec, -1
  s_branch .g2_kernel_v
.g2_kernel_s3:
  s_mov_b32 s12, s58
  s_mov_b32 s13, s59
  s_mov_b32 s14, 0x100
  s_mov_b32 s15, 0x00020000
  s_mov_b32 s20, s48
  s_mov_b32 s21, s49
  s_mov_b32 s22, 0x800
  s_mov_b32 s23, 0x00020000
  v_mov_b32 v12, 0
  v_mov_b32 v13, 0
  v_mov_b32 v14, 0
  v_mov_b32 v15, 0
  s_cmp_ge_u32 s2, 72
  s_cbranch_scc1 .g2_kernel_zm13
  s_lshl_b32 s36, s2, 12
  s_add_u32 s36, s36, 0x3000000
  buffer_store_dwordx4 v[12:15], v3, s[4:7], s36 offen sc1
  buffer_store_dwordx4 v[12:15], v3, s[4:7], s36 offen offset:1024 sc1
  buffer_store_dwordx4 v[12:15], v3, s[4:7], s36 offen offset:2048 sc1
  buffer_store_dwordx4 v[12:15], v3, s[4:7], s36 offen offset:3072 sc1
.g2_kernel_zm13:
  s_barrier
  s_cbranch_scc1 .g2_kernel_zm13b
  s_mov_b64 exec, 1
  s_waitcnt vmcnt(0)
  buffer_atomic_add v5, v4, s[12:15], 0 offen sc1
  s_mov_b64 exec, -1
.g2_kernel_zm13b:
  v_lshlrev_b32 v20, 5, v2
  buffer_load_dwordx4 v[24:27], v20, s[20:23], 0 offen
  buffer_load_dwordx4 v[28:31], v20, s[20:23], 0 offen offset:16
  v_mov_b32 v20, 0
  s_waitcnt vmcnt(0)
  v_lshlrev_b32 v21, 16, v24
  v_and_b32 v22, 0xffff0000, v24
  v_add_f32 v20, v20, v21
  v_add_f32 v20, v20, v22
  v_lshlrev_b32 v21, 16, v25
  v_and_b32 v22, 0xffff0000, v25
  v_add_f32 v20, v20, v21
  v_add_f32 v20, v20, v22
  v_lshlrev_b32 v21, 16, v26
  v_and_b32 v22, 0xffff0000, v26
  v_add_f32 v20, v20, v21
  v_add_f32 v20, v20, v22
  v_lshlrev_b32 v21, 16, v27
  v_and_b32 v22, 0xffff0000, v27
  v_add_f32 v20, v20, v21
  v_add_f32 v20, v20, v22
  v_lshlrev_b32 v21, 16, v28
  v_and_b32 v22, 0xffff0000, v28
  v_add_f32 v20, v20, v21
  v_add_f32 v20, v20, v22
  v_lshlrev_b32 v21, 16, v29
  v_and_b32 v22, 0xffff0000, v29
  v_add_f32 v20, v20, v21
  v_add_f32 v20, v20, v22
  v_lshlrev_b32 v21, 16, v30
  v_and_b32 v22, 0xffff0000, v30
  v_add_f32 v20, v20, v21
  v_add_f32 v20, v20, v22
  v_lshlrev_b32 v21, 16, v31
  v_and_b32 v22, 0xffff0000, v31
  v_add_f32 v20, v20, v21
  v_add_f32 v20, v20, v22
  s_nop 1
  v_add_f32 v20, v20, v20 quad_perm:[1,0,3,2] row_mask:0xf bank_mask:0xf
  s_nop 1
  v_add_f32 v20, v20, v20 quad_perm:[2,3,0,1] row_mask:0xf bank_mask:0xf
  s_nop 1
  v_add_f32 v20, v20, v20 row_half_mirror row_mask:0xf bank_mask:0xf
  s_nop 1
  v_add_f32 v20, v20, v20 row_mirror row_mask:0xf bank_mask:0xf
  s_nop 0
  v_readlane_b32 s20, v20, 16
  v_readlane_b32 s21, v20, 32
  v_readlane_b32 s22, v20, 48
  v_add_f32 v20, s20, v20
  v_add_f32 v20, s21, v20
  v_add_f32 v20, s22, v20
  v_mul_f32 v20, 0x3a800000, v20
  v_mov_b32 v6, 155648
  s_mov_b32 s38, 0
.g2_kernel_wg14:
  ds_read_b32 v7, v6 offset:512
  s_add_u32 s38, s38, 1
  s_waitcnt lgkmcnt(0)
  v_cmp_le_u32 vcc, 32, v7
  s_cbranch_vccnz .g2_kernel_wg14d
  s_sleep 2
  s_cmp_lt_u32 s38, 524288
  s_cbranch_scc1 .g2_kernel_wg14
.g2_kernel_wg14d:
  v_mov_b32 v21, 155648
  s_mov_b64 exec, 1
  ds_write_b32 v21, v20 offset:256
  s_mov_b64 exec, -1
.g2_kernel_v:
  s_setprio 3
  s_cmp_lg_u32 s16, 4
  s_cbranch_scc1 .g2_kernel_v_1
  v_mov_b32 v6, s71
  s_mov_b32 s38, 0
.g2_kernel_wg15:
  ds_read_b32 v7, v6 offset:8
  s_add_u32 s38, s38, 1
  s_waitcnt lgkmcnt(0)
  v_cmp_le_u32 vcc, 4, v7
  s_cbranch_vccnz .g2_kernel_wg15d
  s_sleep 1
  s_cmp_lt_u32 s38, 524288
  s_cbranch_scc1 .g2_kernel_wg15
.g2_kernel_wg15d:
  s_sleep 8
  s_and_b32 s31, s76, 0xffffe000
  s_add_u32 s31, s31, 0
  v_and_b32 v6, 15, v2
  v_lshlrev_b32 v6, 9, v6
  v_lshrrev_b32 v7, 4, v2
  v_lshl_add_u32 v6, v7, 7, v6
  v_lshlrev_b32 v7, 2, v2
  v_add_u32 v7, 157440, v7
  s_mov_b32 m0, 157440
  s_mov_b32 s38, 0
.g2_kernel_pa16:
  buffer_load_dword v6, s[4:7], s31 offen sc1 lds
  s_add_u32 s38, s38, 1
  s_waitcnt vmcnt(0)
  ds_read_b32 v8, v7
  s_waitcnt lgkmcnt(0)
  v_cmp_ge_u32 vcc, s62, v8
  s_cbranch_vccz .g2_kernel_pa16d
  s_mov_b64 exec, vcc
  s_sleep 2
  s_cmp_lt_u32 s38, 131072
  s_cbranch_scc1 .g2_kernel_pa16
.g2_kernel_pa16d:
  s_mov_b64 exec, -1
  s_branch .g2_kernel_v_2
.g2_kernel_v_1:
  v_mov_b32 v6, s71
  s_mov_b32 s38, 0
.g2_kernel_wg17:
  ds_read_b32 v7, v6 offset:4
  s_add_u32 s38, s38, 1
  s_waitcnt lgkmcnt(0)
  v_cmp_le_u32 vcc, 4, v7
  s_cbranch_vccnz .g2_kernel_wg17d
  s_sleep 8
  s_cmp_lt_u32 s38, 524288
  s_cbranch_scc1 .g2_kernel_wg17
.g2_kernel_wg17d:
  s_sleep 70
.g2_kernel_v_2:
  s_mov_b32 s39, 0
  v_mov_b32 v12, 0
  v_mov_b32 v13, 0
  v_mov_b32 v14, 0
  v_mov_b32 v15, 0
  s_lshl_b32 s30, s17, 2
  s_and_b32 s31, s16, 3
  s_add_u32 s30, s30, s31
  s_lshl_b32 s30, s30, 4
  s_add_u32 s30, s30, s18
  s_lshl_b32 s30, s30, 9
  s_add_u32 s30, s30, s63
  s_add_u32 s30, s30, 0x1000000
  s_mov_b32 exec_hi, 0
  buffer_store_dwordx4 v[12:15], v3, s[4:7], s30 offen sc1
  s_mov_b64 exec, -1
  s_lshl_b32 s30, s17, 4
  s_add_u32 s30, s30, s18
  s_cmp_lt_u32 s16, 5
  s_cbranch_scc1 .g2_kernel_zs18
  s_cmp_eq_u32 s16, 5
  s_cbranch_scc1 .g2_kernel_zs18a
  s_lshl_b32 s30, s30, 1
  s_and_b32 s31, s16, 1
  s_add_u32 s30, s30, s31
  s_lshl_b32 s30, s30, 11
  s_add_u32 s30, s30, s63
  s_add_u32 s30, s30, 0x1090000
  buffer_store_dwordx4 v[12:15], v3, s[4:7], s30 offen sc1
  buffer_store_dwordx4 v[12:15], v3, s[4:7], s30 offen offset:1024 sc1
  s_branch .g2_kernel_zs18
.g2_kernel_zs18a:
  s_lshl_b32 s30, s30, 6
  s_add_u32 s30, s30, s63
  s_add_u32 s30, s30, 0x1080000
  s_mov_b64 exec, 15
  buffer_store_dwordx4 v[12:15], v3, s[4:7], s30 offen sc1
  s_mov_b64 exec, -1
  s_and_b32 s30, s18, 14
  s_lshl_b32 s30, s30, 4
  s_add_u32 s30, s30, s17
  s_lshl_b32 s30, s30, 1
  s_and_b32 s31, s18, 1
  s_add_u32 s30, s30, s31
  s_lshl_b32 s30, s30, 10
  s_add_u32 s30, s30, s63
  s_add_u32 s30, s30, 0x1190000
  s_add_u32 s31, s30, 32768
  buffer_store_dwordx4 v[12:15], v3, s[4:7], s30 offen sc1
  buffer_store_dwordx4 v[12:15], v3, s[4:7], s31 offen sc1
.g2_kernel_zs18:
  s_cmp_eq_u32 s16, 4
  s_cbranch_scc1 .g2_kernel_v_3
  s_cmp_lg_u32 s62, 0
  s_cbranch_scc1 .g2_kernel_g_e
  s_and_b32 s22, s16, 3
  s_lshl_b32 s22, s22, 14
  s_add_u32 s22, s22, 65536
  v_bfe_u32 v8, v2, 2, 2
  v_lshrrev_b32 v9, 4, v2
  v_and_b32 v10, 3, v2
  v_lshlrev_b32 v10, 3, v10
  v_add_u32 v10, s22, v10
  s_cmp_eq_u32 s16, 5
  s_cbranch_scc1 .g2_kernel_g_p
  s_cmp_ge_u32 s17, 14
  s_cbranch_scc1 .g2_kernel_g_e
  v_lshrrev_b32 v6, 1, v2
  v_mul_u32_u24 v6, 7168, v6
  v_and_b32 v7, 1, v2
  v_lshl_add_u32 v250, v7, 4, v6
  v_lshl_add_u32 v11, v9, 3, v8
  v_lshl_add_u32 v251, v11, 5, v10
  v_and_b32 v11, 1, v9
  v_lshl_add_u32 v11, v11, 3, v8
  v_lshl_add_u32 v11, v11, 10, v10
  v_lshrrev_b32 v7, 1, v9
  v_lshl_add_u32 v252, v7, 7, v11
  s_lshl_b32 s24, s17, 4
  s_add_u32 s24, s24, s18
  s_and_b32 s25, s16, 1
  s_mov_b32 s12, s50
  s_mov_b32 s13, s51
  s_mov_b32 s14, 0x700000
  s_mov_b32 s15, 0x00020000
  s_mul_i32 s20, s25, 3670016
  s_lshl_b32 s31, s24, 5
  s_add_u32 s20, s20, s31
  s_lshl_b32 s31, s18, 2
  s_mov_b32 s23, s31
  s_mov_b32 s21, 16
.g2_kernel_gl19:
  s_call_b64 s[26:27], .g2_kernel_v_may
  s_and_b32 s23, s23, 15
  s_lshl_b32 s30, s23, 10
  s_add_u32 s30, s30, 0
  s_add_u32 m0, s30, s22
  s_mul_i32 s30, s23, 229376
  s_add_u32 s30, s30, s20
  buffer_load_dwordx4 v250, s[12:15], s30 offen lds
  s_add_u32 s23, s23, 1
  s_sub_u32 s21, s21, 1
  s_sleep 2
  s_waitcnt vmcnt(4)
  s_cmp_lg_u32 s21, 0
  s_cbranch_scc1 .g2_kernel_gl19
  s_waitcnt vmcnt(0)
  ds_read_b64_tr_b16 v[64:65], v251 offset:0
  ds_read_b64_tr_b16 v[66:67], v251 offset:128
  ds_read_b64_tr_b16 v[68:69], v251 offset:1024
  ds_read_b64_tr_b16 v[70:71], v251 offset:1152
  ds_read_b64_tr_b16 v[72:73], v251 offset:2048
  ds_read_b64_tr_b16 v[74:75], v251 offset:2176
  ds_read_b64_tr_b16 v[76:77], v251 offset:3072
  ds_read_b64_tr_b16 v[78:79], v251 offset:3200
  ds_read_b64_tr_b16 v[80:81], v251 offset:4096
  ds_read_b64_tr_b16 v[82:83], v251 offset:4224
  ds_read_b64_tr_b16 v[84:85], v251 offset:5120
  ds_read_b64_tr_b16 v[86:87], v251 offset:5248
  ds_read_b64_tr_b16 v[88:89], v251 offset:6144
  ds_read_b64_tr_b16 v[90:91], v251 offset:6272
  ds_read_b64_tr_b16 v[92:93], v251 offset:7168
  ds_read_b64_tr_b16 v[94:95], v251 offset:7296
  ds_read_b64_tr_b16 v[96:97], v251 offset:8192
  ds_read_b64_tr_b16 v[98:99], v251 offset:8320
  ds_read_b64_tr_b16 v[100:101], v251 offset:9216
  ds_read_b64_tr_b16 v[102:103], v251 offset:9344
  ds_read_b64_tr_b16 v[104:105], v251 offset:10240
  ds_read_b64_tr_b16 v[106:107], v251 offset:10368
  ds_read_b64_tr_b16 v[108:109], v251 offset:11264
  ds_read_b64_tr_b16 v[110:111], v251 offset:11392
  ds_read_b64_tr_b16 v[112:113], v251 offset:12288
  ds_read_b64_tr_b16 v[114:115], v251 offset:12416
  ds_read_b64_tr_b16 v[116:117], v251 offset:13312
  ds_read_b64_tr_b16 v[118:119], v251 offset:13440
  ds_read_b64_tr_b16 v[120:121], v251 offset:14336
  ds_read_b64_tr_b16 v[122:123], v251 offset:14464
  ds_read_b64_tr_b16 v[124:125], v251 offset:15360
  ds_read_b64_tr_b16 v[126:127], v251 offset:15488
  s_waitcnt lgkmcnt(0)
  s_mov_b32 s12, s52
  s_mov_b32 s13, s53
  s_mov_b32 s14, 0x700000
  s_mov_b32 s15, 0x00020000
  s_mul_i32 s20, s25, 3670016
  s_lshl_b32 s31, s24, 5
  s_add_u32 s20, s20, s31
  s_lshl_b32 s31, s18, 2
  s_mov_b32 s23, s31
  s_mov_b32 s21, 16
.g2_kernel_gl20:
  s_call_b64 s[26:27], .g2_kernel_v_may
  s_and_b32 s23, s23, 15
  s_lshl_b32 s30, s23, 10
  s_add_u32 s30, s30, 0
  s_add_u32 m0, s30, s22
  s_mul_i32 s30, s23, 229376
  s_add_u32 s30, s30, s20
  buffer_load_dwordx4 v250, s[12:15], s30 offen lds
  s_add_u32 s23, s23, 1
  s_sub_u32 s21, s21, 1
  s_sleep 2
  s_waitcnt vmcnt(4)
  s_cmp_lg_u32 s21, 0
  s_cbranch_scc1 .g2_kernel_gl20
  s_waitcnt vmcnt(0)
  ds_read_b64_tr_b16 v[128:129], v251 offset:0
  ds_read_b64_tr_b16 v[130:131], v251 offset:128
  ds_read_b64_tr_b16 v[132:133], v251 offset:1024
  ds_read_b64_tr_b16 v[134:135], v251 offset:1152
  ds_read_b64_tr_b16 v[136:137], v251 offset:2048
  ds_read_b64_tr_b16 v[138:139], v251 offset:2176
  ds_read_b64_tr_b16 v[140:141], v251 offset:3072
  ds_read_b64_tr_b16 v[142:143], v251 offset:3200
  ds_read_b64_tr_b16 v[144:145], v251 offset:4096
  ds_read_b64_tr_b16 v[146:147], v251 offset:4224
  ds_read_b64_tr_b16 v[148:149], v251 offset:5120
  ds_read_b64_tr_b16 v[150:151], v251 offset:5248
  ds_read_b64_tr_b16 v[152:153], v251 offset:6144
  ds_read_b64_tr_b16 v[154:155], v251 offset:6272
  ds_read_b64_tr_b16 v[156:157], v251 offset:7168
  ds_read_b64_tr_b16 v[158:159], v251 offset:7296
  ds_read_b64_tr_b16 v[160:161], v251 offset:8192
  ds_read_b64_tr_b16 v[162:163], v251 offset:8320
  ds_read_b64_tr_b16 v[164:165], v251 offset:9216
  ds_read_b64_tr_b16 v[166:167], v251 offset:9344
  ds_read_b64_tr_b16 v[168:169], v251 offset:10240
  ds_read_b64_tr_b16 v[170:171], v251 offset:10368
  ds_read_b64_tr_b16 v[172:173], v251 offset:11264
  ds_read_b64_tr_b16 v[174:175], v251 offset:11392
  ds_read_b64_tr_b16 v[176:177], v251 offset:12288
  ds_read_b64_tr_b16 v[178:179], v251 offset:12416
  ds_read_b64_tr_b16 v[180:181], v251 offset:13312
  ds_read_b64_tr_b16 v[182:183], v251 offset:13440
  ds_read_b64_tr_b16 v[184:185], v251 offset:14336
  ds_read_b64_tr_b16 v[186:187], v251 offset:14464
  ds_read_b64_tr_b16 v[188:189], v251 offset:15360
  ds_read_b64_tr_b16 v[190:191], v251 offset:15488
  s_waitcnt lgkmcnt(0)
  s_mov_b32 s12, s54
  s_mov_b32 s13, s55
  s_mov_b32 s14, 0x700000
  s_mov_b32 s15, 0x00020000
  s_lshl_b32 s20, s24, 15
  s_lshl_b32 s31, s25, 10
  s_add_u32 s20, s20, s31
  s_mov_b32 s23, 0
  s_mov_b32 s21, 16
.g2_kernel_gl21:
  s_call_b64 s[26:27], .g2_kernel_v_may
  s_and_b32 s23, s23, 15
  s_lshl_b32 s30, s23, 10
  s_add_u32 s30, s30, 0
  s_add_u32 m0, s30, s22
  s_mul_i32 s30, s23, 2048
  s_add_u32 s30, s30, s20
  buffer_load_dwordx4 v3, s[12:15], s30 offen lds
  s_add_u32 s23, s23, 1
  s_sub_u32 s21, s21, 1
  s_sleep 1
  s_waitcnt vmcnt(4)
  s_cmp_lg_u32 s21, 0
  s_cbranch_scc1 .g2_kernel_gl21
  v_mov_b32 v11, v252
  s_waitcnt vmcnt(0)
  ds_read_b64_tr_b16 v[192:193], v11 offset:0
  ds_read_b64_tr_b16 v[194:195], v11 offset:4096
  ds_read_b64_tr_b16 v[196:197], v11 offset:32
  ds_read_b64_tr_b16 v[198:199], v11 offset:4128
  ds_read_b64_tr_b16 v[200:201], v11 offset:64
  ds_read_b64_tr_b16 v[202:203], v11 offset:4160
  ds_read_b64_tr_b16 v[204:205], v11 offset:96
  ds_read_b64_tr_b16 v[206:207], v11 offset:4192
  ds_read_b64_tr_b16 v[208:209], v11 offset:256
  ds_read_b64_tr_b16 v[210:211], v11 offset:4352
  ds_read_b64_tr_b16 v[212:213], v11 offset:288
  ds_read_b64_tr_b16 v[214:215], v11 offset:4384
  ds_read_b64_tr_b16 v[216:217], v11 offset:320
  ds_read_b64_tr_b16 v[218:219], v11 offset:4416
  ds_read_b64_tr_b16 v[220:221], v11 offset:352
  ds_read_b64_tr_b16 v[222:223], v11 offset:4448
  ds_read_b64_tr_b16 v[224:225], v11 offset:512
  ds_read_b64_tr_b16 v[226:227], v11 offset:4608
  ds_read_b64_tr_b16 v[228:229], v11 offset:544
  ds_read_b64_tr_b16 v[230:231], v11 offset:4640
  ds_read_b64_tr_b16 v[232:233], v11 offset:576
  ds_read_b64_tr_b16 v[234:235], v11 offset:4672
  ds_read_b64_tr_b16 v[236:237], v11 offset:608
  ds_read_b64_tr_b16 v[238:239], v11 offset:4704
  ds_read_b64_tr_b16 v[240:241], v11 offset:768
  ds_read_b64_tr_b16 v[242:243], v11 offset:4864
  ds_read_b64_tr_b16 v[244:245], v11 offset:800
  ds_read_b64_tr_b16 v[246:247], v11 offset:4896
  ds_read_b64_tr_b16 v[248:249], v11 offset:832
  ds_read_b64_tr_b16 v[250:251], v11 offset:4928
  ds_read_b64_tr_b16 v[252:253], v11 offset:864
  ds_read_b64_tr_b16 v[254:255], v11 offset:4960
  s_waitcnt lgkmcnt(0)
  s_branch .g2_kernel_g_e
.g2_kernel_g_p:
  s_mov_b32 s12, s42
  s_mov_b32 s13, s43
  s_mov_b32 s14, 0x600000
  s_mov_b32 s15, 0x00020000
  v_mul_u32_u24 v6, 6144, v9
  v_and_b32 v7, 15, v2
  v_lshl_add_u32 v250, v7, 4, v6
  v_lshl_add_u32 v11, v8, 2, v9
  v_lshl_add_u32 v251, v11, 9, v10
  s_lshl_b32 s20, s17, 3
  s_and_b32 s31, s18, 1
  s_add_u32 s20, s20, s31
  s_mul_i32 s20, s20, 49152
  s_and_b32 s31, s18, 14
  s_lshl_b32 s31, s31, 7
  s_add_u32 s20, s20, s31
  s_mov_b32 s23, 0
  s_mov_b32 s21, 8
.g2_kernel_gl22:
  s_call_b64 s[26:27], .g2_kernel_v_may
  s_and_b32 s23, s23, 7
  s_lshl_b32 s30, s23, 10
  s_add_u32 s30, s30, 0
  s_add_u32 m0, s30, s22
  s_mul_i32 s30, s23, 49152
  s_add_u32 s30, s30, s20
  s_and_b32 s31, s23, 1
  s_mul_i32 s31, s31, -24576
  s_add_u32 s30, s30, s31
  buffer_load_dwordx4 v250, s[12:15], s30 offen lds
  s_add_u32 s23, s23, 1
  s_sub_u32 s21, s21, 1
  s_sleep 2
  s_waitcnt vmcnt(4)
  s_cmp_lg_u32 s21, 0
  s_cbranch_scc1 .g2_kernel_gl22
  s_add_u32 s20, s20, 2048
  s_mov_b32 s23, 0
  s_mov_b32 s21, 8
.g2_kernel_gl23:
  s_call_b64 s[26:27], .g2_kernel_v_may
  s_and_b32 s23, s23, 7
  s_lshl_b32 s30, s23, 10
  s_add_u32 s30, s30, 8192
  s_add_u32 m0, s30, s22
  s_mul_i32 s30, s23, 49152
  s_add_u32 s30, s30, s20
  s_and_b32 s31, s23, 1
  s_mul_i32 s31, s31, -24576
  s_add_u32 s30, s30, s31
  buffer_load_dwordx4 v250, s[12:15], s30 offen lds
  s_add_u32 s23, s23, 1
  s_sub_u32 s21, s21, 1
  s_sleep 2
  s_waitcnt vmcnt(4)
  s_cmp_lg_u32 s21, 0
  s_cbranch_scc1 .g2_kernel_gl23
  s_add_u32 s20, s20, 2048
  s_waitcnt vmcnt(0)
  ds_read_b64_tr_b16 v[64:65], v251 offset:0
  ds_read_b64_tr_b16 v[66:67], v251 offset:256
  ds_read_b64_tr_b16 v[68:69], v251 offset:32
  ds_read_b64_tr_b16 v[70:71], v251 offset:288
  ds_read_b64_tr_b16 v[72:73], v251 offset:64
  ds_read_b64_tr_b16 v[74:75], v251 offset:320
  ds_read_b64_tr_b16 v[76:77], v251 offset:96
  ds_read_b64_tr_b16 v[78:79], v251 offset:352
  ds_read_b64_tr_b16 v[80:81], v251 offset:128
  ds_read_b64_tr_b16 v[82:83], v251 offset:384
  ds_read_b64_tr_b16 v[84:85], v251 offset:160
  ds_read_b64_tr_b16 v[86:87], v251 offset:416
  ds_read_b64_tr_b16 v[88:89], v251 offset:192
  ds_read_b64_tr_b16 v[90:91], v251 offset:448
  ds_read_b64_tr_b16 v[92:93], v251 offset:224
  ds_read_b64_tr_b16 v[94:95], v251 offset:480
  ds_read_b64_tr_b16 v[96:97], v251 offset:8192
  ds_read_b64_tr_b16 v[98:99], v251 offset:8448
  ds_read_b64_tr_b16 v[100:101], v251 offset:8224
  ds_read_b64_tr_b16 v[102:103], v251 offset:8480
  ds_read_b64_tr_b16 v[104:105], v251 offset:8256
  ds_read_b64_tr_b16 v[106:107], v251 offset:8512
  ds_read_b64_tr_b16 v[108:109], v251 offset:8288
  ds_read_b64_tr_b16 v[110:111], v251 offset:8544
  ds_read_b64_tr_b16 v[112:113], v251 offset:8320
  ds_read_b64_tr_b16 v[114:115], v251 offset:8576
  ds_read_b64_tr_b16 v[116:117], v251 offset:8352
  ds_read_b64_tr_b16 v[118:119], v251 offset:8608
  ds_read_b64_tr_b16 v[120:121], v251 offset:8384
  ds_read_b64_tr_b16 v[122:123], v251 offset:8640
  ds_read_b64_tr_b16 v[124:125], v251 offset:8416
  ds_read_b64_tr_b16 v[126:127], v251 offset:8672
  s_waitcnt lgkmcnt(0)
  s_mov_b32 s23, 0
  s_mov_b32 s21, 8
.g2_kernel_gl24:
  s_call_b64 s[26:27], .g2_kernel_v_may
  s_and_b32 s23, s23, 7
  s_lshl_b32 s30, s23, 10
  s_add_u32 s30, s30, 0
  s_add_u32 m0, s30, s22
  s_mul_i32 s30, s23, 49152
  s_add_u32 s30, s30, s20
  s_and_b32 s31, s23, 1
  s_mul_i32 s31, s31, -24576
  s_add_u32 s30, s30, s31
  buffer_load_dwordx4 v250, s[12:15], s30 offen lds
  s_add_u32 s23, s23, 1
  s_sub_u32 s21, s21, 1
  s_sleep 2
  s_waitcnt vmcnt(4)
  s_cmp_lg_u32 s21, 0
  s_cbranch_scc1 .g2_kernel_gl24
  s_add_u32 s20, s20, 2048
  s_waitcnt vmcnt(0)
  ds_read_b64_tr_b16 v[128:129], v251 offset:0
  ds_read_b64_tr_b16 v[130:131], v251 offset:256
  ds_read_b64_tr_b16 v[132:133], v251 offset:32
  ds_read_b64_tr_b16 v[134:135], v251 offset:288
  ds_read_b64_tr_b16 v[136:137], v251 offset:64
  ds_read_b64_tr_b16 v[138:139], v251 offset:320
  ds_read_b64_tr_b16 v[140:141], v251 offset:96
  ds_read_b64_tr_b16 v[142:143], v251 offset:352
  ds_read_b64_tr_b16 v[144:145], v251 offset:128
  ds_read_b64_tr_b16 v[146:147], v251 offset:384
  ds_read_b64_tr_b16 v[148:149], v251 offset:160
  ds_read_b64_tr_b16 v[150:151], v251 offset:416
  ds_read_b64_tr_b16 v[152:153], v251 offset:192
  ds_read_b64_tr_b16 v[154:155], v251 offset:448
  ds_read_b64_tr_b16 v[156:157], v251 offset:224
  ds_read_b64_tr_b16 v[158:159], v251 offset:480
  s_waitcnt lgkmcnt(0)
.g2_kernel_g_e:
.g2_kernel_v_3:
  s_mov_b32 s29, 0
  s_and_b32 s30, s16, 3
  s_lshl_b32 s30, s30, 14
  s_add_u32 s30, s30, 65536
  s_call_b64 s[68:69], .g2_kernel_v_wo
  s_waitcnt vmcnt(0)
  v_mov_b32 v6, s71
  s_mov_b64 exec, 1
  ds_add_u32 v6, v5 offset:52
  s_mov_b64 exec, -1
  s_cmp_lg_u32 s39, 0
  s_cbranch_scc1 .g2_kernel_v_3b
  s_call_b64 s[26:27], .g2_kernel_v_do
.g2_kernel_v_3b:
  s_cmp_lg_u32 s16, 4
  s_cbranch_scc1 .g2_kernel_v_4
  v_mov_b32 v6, s71
  s_mov_b32 s38, 0
.g2_kernel_wg25:
  ds_read_b32 v7, v6 offset:8
  s_add_u32 s38, s38, 1
  s_waitcnt lgkmcnt(0)
  v_cmp_le_u32 vcc, 8, v7
  s_cbranch_vccnz .g2_kernel_wg25d
  s_sleep 8
  s_cmp_lt_u32 s38, 524288
  s_cbranch_scc1 .g2_kernel_wg25
.g2_kernel_wg25d:
  s_mov_b32 s29, 1
  s_mov_b32 s30, 139264
  s_call_b64 s[68:69], .g2_kernel_v_wo
  s_add_u32 s31, s31, 81920
  s_sleep 6
  s_waitcnt vmcnt(4)
  buffer_load_dwordx4 v[64:67], v6, s[8:11], s31 offen
  s_add_u32 s31, s31, 16384
  buffer_load_dwordx4 v[68:71], v6, s[8:11], s31 offen
  s_add_u32 s31, s31, 16384
  buffer_load_dwordx4 v[72:75], v6, s[8:11], s31 offen
  s_add_u32 s31, s31, 16384
  buffer_load_dwordx4 v[76:79], v6, s[8:11], s31 offen
  s_add_u32 s31, s31, 81920
  s_sleep 6
  s_waitcnt vmcnt(4)
  buffer_load_dwordx4 v[80:83], v6, s[8:11], s31 offen
  s_add_u32 s31, s31, 16384
  buffer_load_dwordx4 v[84:87], v6, s[8:11], s31 offen
  s_add_u32 s31, s31, 16384
  buffer_load_dwordx4 v[88:91], v6, s[8:11], s31 offen
  s_add_u32 s31, s31, 16384
  buffer_load_dwordx4 v[92:95], v6, s[8:11], s31 offen
  s_add_u32 s31, s31, 81920
  s_sleep 6
  s_waitcnt vmcnt(4)
  buffer_load_dwordx4 v[96:99], v6, s[8:11], s31 offen
  s_add_u32 s31, s31, 16384
  buffer_load_dwordx4 v[100:103], v6, s[8:11], s31 offen
  s_add_u32 s31, s31, 16384
  buffer_load_dwordx4 v[104:107], v6, s[8:11], s31 offen
  s_add_u32 s31, s31, 16384
  buffer_load_dwordx4 v[108:111], v6, s[8:11], s31 offen
  s_add_u32 s31, s31, 81920
  s_sleep 6
  s_waitcnt vmcnt(4)
  buffer_load_dwordx4 v[112:115], v6, s[8:11], s31 offen
  s_add_u32 s31, s31, 16384
  buffer_load_dwordx4 v[116:119], v6, s[8:11], s31 offen
  s_add_u32 s31, s31, 16384
  buffer_load_dwordx4 v[120:123], v6, s[8:11], s31 offen
  s_add_u32 s31, s31, 16384
  buffer_load_dwordx4 v[124:127], v6, s[8:11], s31 offen
  s_add_u32 s31, s31, 81920
  s_sleep 6
  s_waitcnt vmcnt(4)
  buffer_load_dwordx4 v[128:131], v6, s[8:11], s31 offen
  s_add_u32 s31, s31, 16384
  buffer_load_dwordx4 v[132:135], v6, s[8:11], s31 offen
  s_add_u32 s31, s31, 16384
  buffer_load_dwordx4 v[136:139], v6, s[8:11], s31 offen
  s_add_u32 s31, s31, 16384
  buffer_load_dwordx4 v[140:143], v6, s[8:11], s31 offen
  s_add_u32 s31, s31, 81920
  s_sleep 6
  s_waitcnt vmcnt(4)
  buffer_load_dwordx4 v[144:147], v6, s[8:11], s31 offen
  s_add_u32 s31, s31, 16384
  buffer_load_dwordx4 v[148:151], v6, s[8:11], s31 offen
  s_add_u32 s31, s31, 16384
  buffer_load_dwordx4 v[152:155], v6, s[8:11], s31 offen
  s_add_u32 s31, s31, 16384
  buffer_load_dwordx4 v[156:159], v6, s[8:11], s31 offen
  s_add_u32 s31, s31, 81920
  s_sleep 6
  s_waitcnt vmcnt(4)
  buffer_load_dwordx4 v[160:163], v6, s[8:11], s31 offen
  s_add_u32 s31, s31, 16384
  buffer_load_dwordx4 v[164:167], v6, s[8:11], s31 offen
  s_add_u32 s31, s31, 16384
  buffer_load_dwordx4 v[168:171], v6, s[8:11], s31 offen
  s_add_u32 s31, s31, 16384
  buffer_load_dwordx4 v[172:175], v6, s[8:11], s31 offen
  s_add_u32 s31, s31, 81920
  s_sleep 6
  s_waitcnt vmcnt(4)
  buffer_load_dwordx4 v[176:179], v6, s[8:11], s31 offen
  s_add_u32 s31, s31, 16384
  buffer_load_dwordx4 v[180:183], v6, s[8:11], s31 offen
  s_add_u32 s31, s31, 16384
  buffer_load_dwordx4 v[184:187], v6, s[8:11], s31 offen
  s_add_u32 s31, s31, 16384
  buffer_load_dwordx4 v[188:191], v6, s[8:11], s31 offen
  s_add_u32 s31, s31, 81920
  s_sleep 6
  s_waitcnt vmcnt(4)
  buffer_load_dwordx4 v[192:195], v6, s[8:11], s31 offen
  s_add_u32 s31, s31, 16384
  buffer_load_dwordx4 v[196:199], v6, s[8:11], s31 offen
  s_add_u32 s31, s31, 16384
  buffer_load_dwordx4 v[200:203], v6, s[8:11], s31 offen
  s_add_u32 s31, s31, 16384
  buffer_load_dwordx4 v[204:207], v6, s[8:11], s31 offen
  s_add_u32 s31, s31, 81920
  s_sleep 6
  s_waitcnt vmcnt(4)
  buffer_load_dwordx4 v[208:211], v6, s[8:11], s31 offen
  s_add_u32 s31, s31, 16384
  buffer_load_dwordx4 v[212:215], v6, s[8:11], s31 offen
  s_add_u32 s31, s31, 16384
  buffer_load_dwordx4 v[216:219], v6, s[8:11], s31 offen
  s_add_u32 s31, s31, 16384
  buffer_load_dwordx4 v[220:223], v6, s[8:11], s31 offen
  s_add_u32 s31, s31, 81920
  s_sleep 6
  s_waitcnt vmcnt(4)
  buffer_load_dwordx4 v[224:227], v6, s[8:11], s31 offen
  s_add_u32 s31, s31, 16384
  buffer_load_dwordx4 v[228:231], v6, s[8:11], s31 offen
  s_add_u32 s31, s31, 16384
  buffer_load_dwordx4 v[232:235], v6, s[8:11], s31 offen
  s_add_u32 s31, s31, 16384
  buffer_load_dwordx4 v[236:239], v6, s[8:11], s31 offen
  s_add_u32 s31, s31, 81920
  s_sleep 6
  s_waitcnt vmcnt(4)
  buffer_load_dwordx4 v[240:243], v6, s[8:11], s31 offen
  s_add_u32 s31, s31, 16384
  buffer_load_dwordx4 v[244:247], v6, s[8:11], s31 offen
  s_add_u32 s31, s31, 16384
  buffer_load_dwordx4 v[248:251], v6, s[8:11], s31 offen
  s_add_u32 s31, s31, 16384
  buffer_load_dwordx4 v[252:255], v6, s[8:11], s31 offen
.g2_kernel_v_4:
  s_cmp_lg_u32 s16, 5
  s_cbranch_scc1 .g2_kernel_v_5
  s_sleep 64
  s_and_b32 s31, s19, 0xffffe000
  s_add_u32 s31, s31, 0
  v_and_b32 v6, 15, v2
  v_lshlrev_b32 v6, 9, v6
  v_lshrrev_b32 v7, 4, v2
  v_lshl_add_u32 v6, v7, 7, v6
  v_lshlrev_b32 v7, 2, v2
  v_add_u32 v7, 157696, v7
  s_mov_b32 m0, 157696
  s_mov_b32 s38, 0
.g2_kernel_pa26:
  buffer_load_dword v6, s[4:7], s31 offen sc1 lds
  s_add_u32 s38, s38, 1
  s_waitcnt vmcnt(0)
  ds_read_b32 v8, v7
  s_waitcnt lgkmcnt(0)
  v_cmp_ge_u32 vcc, s62, v8
  s_cbranch_vccz .g2_kernel_pa26d
  s_mov_b64 exec, vcc
  s_sleep 32
  s_cmp_lt_u32 s38, 131072
  s_cbranch_scc1 .g2_kernel_pa26
.g2_kernel_pa26d:
  s_mov_b64 exec, -1
  v_lshlrev_b32 v6, 7, v2
  s_lshl_b32 s30, s17, 2
  s_and_b32 s31, s18, 3
  s_add_u32 s30, s30, s31
  s_lshl_b32 s30, s30, 16
  s_add_u32 s30, s30, s63
  s_add_u32 s30, s30, 0x800000
  s_sleep 8
  buffer_load_dword v8, v6, s[4:7], s30 offen
  s_add_u32 s30, s30, 8192
  s_sleep 8
  buffer_load_dword v8, v6, s[4:7], s30 offen
  s_add_u32 s30, s30, 8192
  s_sleep 8
  buffer_load_dword v8, v6, s[4:7], s30 offen
  s_add_u32 s30, s30, 8192
  s_sleep 8
  buffer_load_dword v8, v6, s[4:7], s30 offen
  s_add_u32 s30, s30, 8192
.g2_kernel_v_5:
  s_waitcnt vmcnt(0)
  s_mov_b32 s29, 1
  s_call_b64 s[68:69], .g2_kernel_v_cmb
  s_waitcnt vmcnt(0)
  s_and_b32 s33, s16, 3
  s_lshl_b32 s33, s33, 7
  s_lshl_b32 s28, s29, 2
  s_add_u32 s33, s33, s28
  s_add_u32 s31, s19, s33
  v_mov_b32 v6, s70
  s_mov_b64 exec, 1
  buffer_store_dword v6, v4, s[4:7], s31 offen offset:0 sc1
  s_mov_b64 exec, -1
  s_cmp_lg_u32 s16, 4
  s_cbranch_scc1 .g2_kernel_v_8
  v_mov_b32 v6, s71
  s_mov_b32 s38, 0
.g2_kernel_wg27:
  ds_read_b32 v7, v6 offset:68
  s_add_u32 s38, s38, 1
  s_waitcnt lgkmcnt(0)
  v_cmp_le_u32 vcc, 1, v7
  s_cbranch_vccnz .g2_kernel_wg27d
  s_cmp_lt_u32 s38, 524288
  s_cbranch_scc1 .g2_kernel_wg27
.g2_kernel_wg27d:
  ds_write_b128 v3, v[64:67] offset:16384
  ds_write_b128 v3, v[68:71] offset:17408
  ds_write_b128 v3, v[72:75] offset:18432
  ds_write_b128 v3, v[76:79] offset:19456
  ds_write_b128 v3, v[80:83] offset:20480
  ds_write_b128 v3, v[84:87] offset:21504
  ds_write_b128 v3, v[88:91] offset:22528
  ds_write_b128 v3, v[92:95] offset:23552
  ds_write_b128 v3, v[96:99] offset:24576
  ds_write_b128 v3, v[100:103] offset:25600
  ds_write_b128 v3, v[104:107] offset:26624
  ds_write_b128 v3, v[108:111] offset:27648
  ds_write_b128 v3, v[112:115] offset:28672
  ds_write_b128 v3, v[116:119] offset:29696
  ds_write_b128 v3, v[120:123] offset:30720
  ds_write_b128 v3, v[124:127] offset:31744
  v_mov_b32 v6, s71
  s_mov_b32 s38, 0
.g2_kernel_wg28:
  ds_read_b32 v7, v6 offset:72
  s_add_u32 s38, s38, 1
  s_waitcnt lgkmcnt(0)
  v_cmp_le_u32 vcc, 1, v7
  s_cbranch_vccnz .g2_kernel_wg28d
  s_cmp_lt_u32 s38, 524288
  s_cbranch_scc1 .g2_kernel_wg28
.g2_kernel_wg28d:
  ds_write_b128 v3, v[128:131] offset:32768
  ds_write_b128 v3, v[132:135] offset:33792
  ds_write_b128 v3, v[136:139] offset:34816
  ds_write_b128 v3, v[140:143] offset:35840
  ds_write_b128 v3, v[144:147] offset:36864
  ds_write_b128 v3, v[148:151] offset:37888
  ds_write_b128 v3, v[152:155] offset:38912
  ds_write_b128 v3, v[156:159] offset:39936
  ds_write_b128 v3, v[160:163] offset:40960
  ds_write_b128 v3, v[164:167] offset:41984
  ds_write_b128 v3, v[168:171] offset:43008
  ds_write_b128 v3, v[172:175] offset:44032
  ds_write_b128 v3, v[176:179] offset:45056
  ds_write_b128 v3, v[180:183] offset:46080
  ds_write_b128 v3, v[184:187] offset:47104
  ds_write_b128 v3, v[188:191] offset:48128
  v_mov_b32 v6, s71
  s_mov_b32 s38, 0
.g2_kernel_wg29:
  ds_read_b32 v7, v6 offset:76
  s_add_u32 s38, s38, 1
  s_waitcnt lgkmcnt(0)
  v_cmp_le_u32 vcc, 1, v7
  s_cbranch_vccnz .g2_kernel_wg29d
  s_cmp_lt_u32 s38, 524288
  s_cbranch_scc1 .g2_kernel_wg29
.g2_kernel_wg29d:
  ds_write_b128 v3, v[192:195] offset:49152
  ds_write_b128 v3, v[196:199] offset:50176
  ds_write_b128 v3, v[200:203] offset:51200
  ds_write_b128 v3, v[204:207] offset:52224
  ds_write_b128 v3, v[208:211] offset:53248
  ds_write_b128 v3, v[212:215] offset:54272
  ds_write_b128 v3, v[216:219] offset:55296
  ds_write_b128 v3, v[220:223] offset:56320
  ds_write_b128 v3, v[224:227] offset:57344
  ds_write_b128 v3, v[228:231] offset:58368
  ds_write_b128 v3, v[232:235] offset:59392
  ds_write_b128 v3, v[236:239] offset:60416
  ds_write_b128 v3, v[240:243] offset:61440
  ds_write_b128 v3, v[244:247] offset:62464
  ds_write_b128 v3, v[248:251] offset:63488
  ds_write_b128 v3, v[252:255] offset:64512
  v_mov_b32 v8, 4
  ds_write_b32 v6, v8 offset:12
.g2_kernel_v_8:
  s_cmp_eq_u32 s16, 5
  s_cbranch_scc1 .g2_kernel_c1
  s_cmp_lg_u32 s16, 4
  s_cbranch_scc1 .g2_kernel_c2
  s_cmp_lg_u32 s62, 0
  s_cbranch_scc1 .g2_kernel_fin1
  s_setprio 3
  s_mov_b32 s12, s42
  s_mov_b32 s13, s43
  s_mov_b32 s14, 0x600000
  s_mov_b32 s15, 0x00020000
  v_lshrrev_b32 v28, 3, v2
  v_and_b32 v29, 7, v2
  v_bfe_u32 v30, v2, 4, 1
  v_lshlrev_b32 v30, 1, v30
  v_xor_b32 v31, v29, v30
  v_lshlrev_b32 v31, 4, v31
  v_mul_u32_u24 v28, 6144, v28
  v_add_u32 v28, v28, v31
  v_xor_b32 v29, 64, v28
  v_lshlrev_b32 v9, 8, v2
  v_and_b32 v9, 0x300, v9
  v_add_u32 v9, 156416, v9
  v_add_u32 v48, 0, v28
  v_add_u32 v49, 48128, v29
  v_add_u32 v50, 96256, v28
  v_add_u32 v51, 144384, v29
  v_add_u32 v52, 2048, v28
  v_add_u32 v53, 50176, v29
  v_add_u32 v54, 98304, v28
  v_add_u32 v55, 146432, v29
  v_add_u32 v56, 4096, v28
  v_add_u32 v57, 52224, v29
  v_add_u32 v58, 100352, v28
  v_add_u32 v59, 148480, v29
  v_and_b32 v11, 15, v2
  v_xor_b32 v11, s18, v11
  v_and_b32 v12, 48, v2
  v_add_u32 v11, v11, v12
  v_lshlrev_b32 v11, 2, v11
  v_add_u32 v11, 158208, v11
  s_lshl_b32 s39, s18, 7
  s_lshl_b32 s32, s17, 18
  s_add_u32 s32, s32, 0xc00000
  s_mov_b32 s30, 0
  s_mov_b32 s29, 0
  s_mov_b32 s37, 0
  v_mov_b32 v6, s71
  s_mov_b32 s38, 0
.g2_kernel_wg30:
  ds_read_b32 v7, v6 offset:16
  s_add_u32 s38, s38, 1
  s_waitcnt lgkmcnt(0)
  v_cmp_le_u32 vcc, 4, v7
  s_cbranch_vccnz .g2_kernel_wg30d
  s_sleep 2
  s_cmp_lt_u32 s38, 524288
  s_cbranch_scc1 .g2_kernel_wg30
.g2_kernel_wg30d:
  s_xor_b32 s36, s18, 0
  s_mul_i32 s36, s36, 393216
  s_add_u32 s36, s36, s39
  s_add_u32 m0, s30, 65536
  s_nop 0
  buffer_load_dwordx4 v48, s[12:15], s36 offen offset:0 lds
  buffer_load_dwordx4 v49, s[12:15], s36 offen offset:1024 lds
  buffer_load_dwordx4 v50, s[12:15], s36 offen offset:2048 lds
  buffer_load_dwordx4 v51, s[12:15], s36 offen offset:3072 lds
  s_add_u32 m0, s30, 69632
  s_nop 0
  buffer_load_dwordx4 v52, s[12:15], s36 offen offset:0 lds
  buffer_load_dwordx4 v53, s[12:15], s36 offen offset:1024 lds
  buffer_load_dwordx4 v54, s[12:15], s36 offen offset:2048 lds
  buffer_load_dwordx4 v55, s[12:15], s36 offen offset:3072 lds
  s_add_u32 m0, s30, 73728
  s_nop 0
  buffer_load_dwordx4 v56, s[12:15], s36 offen offset:0 lds
  buffer_load_dwordx4 v57, s[12:15], s36 offen offset:1024 lds
  buffer_load_dwordx4 v58, s[12:15], s36 offen offset:2048 lds
  buffer_load_dwordx4 v59, s[12:15], s36 offen offset:3072 lds
  s_add_u32 s30, s30, 12288
  s_cmp_eq_u32 s30, 86016
  s_cselect_b32 s30, 0, s30
  s_xor_b32 s36, s18, 0
  s_mul_i32 s36, s36, 393216
  s_add_u32 s36, s36, s39
  s_add_u32 s36, s36, 196608
  s_add_u32 m0, s30, 65536
  s_nop 0
  buffer_load_dwordx4 v48, s[12:15], s36 offen offset:0 lds
  buffer_load_dwordx4 v49, s[12:15], s36 offen offset:1024 lds
  buffer_load_dwordx4 v50, s[12:15], s36 offen offset:2048 lds
  buffer_load_dwordx4 v51, s[12:15], s36 offen offset:3072 lds
  s_add_u32 m0, s30, 69632
  s_nop 0
  buffer_load_dwordx4 v52, s[12:15], s36 offen offset:0 lds
  buffer_load_dwordx4 v53, s[12:15], s36 offen offset:1024 lds
  buffer_load_dwordx4 v54, s[12:15], s36 offen offset:2048 lds
  buffer_load_dwordx4 v55, s[12:15], s36 offen offset:3072 lds
  s_add_u32 m0, s30, 73728
  s_nop 0
  buffer_load_dwordx4 v56, s[12:15], s36 offen offset:0 lds
  buffer_load_dwordx4 v57, s[12:15], s36 offen offset:1024 lds
  buffer_load_dwordx4 v58, s[12:15], s36 offen offset:2048 lds
  buffer_load_dwordx4 v59, s[12:15], s36 offen offset:3072 lds
  s_add_u32 s30, s30, 12288
  s_cmp_eq_u32 s30, 86016
  s_cselect_b32 s30, 0, s30
  s_mov_b32 m0, 156160
  s_mov_b32 s35, .g2_kernel_tab-.g2_kernel_pc+136
  buffer_load_dword off, s[64:67], s35 lds
  s_xor_b32 s36, s18, 1
  s_mul_i32 s36, s36, 393216
  s_add_u32 s36, s36, s39
  s_add_u32 m0, s30, 65536
  s_nop 0
  buffer_load_dwordx4 v48, s[12:15], s36 offen offset:0 lds
  buffer_load_dwordx4 v49, s[12:15], s36 offen offset:1024 lds
  buffer_load_dwordx4 v50, s[12:15], s36 offen offset:2048 lds
  buffer_load_dwordx4 v51, s[12:15], s36 offen offset:3072 lds
  s_add_u32 m0, s30, 69632
  s_nop 0
  buffer_load_dwordx4 v52, s[12:15], s36 offen offset:0 lds
  buffer_load_dwordx4 v53, s[12:15], s36 offen offset:1024 lds
  buffer_load_dwordx4 v54, s[12:15], s36 offen offset:2048 lds
  buffer_load_dwordx4 v55, s[12:15], s36 offen offset:3072 lds
  s_add_u32 m0, s30, 73728
  s_nop 0
  buffer_load_dwordx4 v56, s[12:15], s36 offen offset:0 lds
  buffer_load_dwordx4 v57, s[12:15], s36 offen offset:1024 lds
  buffer_load_dwordx4 v58, s[12:15], s36 offen offset:2048 lds
  buffer_load_dwordx4 v59, s[12:15], s36 offen offset:3072 lds
  s_add_u32 s30, s30, 12288
  s_cmp_eq_u32 s30, 86016
  s_cselect_b32 s30, 0, s30
  s_xor_b32 s36, s18, 1
  s_mul_i32 s36, s36, 393216
  s_add_u32 s36, s36, s39
  s_add_u32 s36, s36, 196608
  s_add_u32 m0, s30, 65536
  s_nop 0
  buffer_load_dwordx4 v48, s[12:15], s36 offen offset:0 lds
  buffer_load_dwordx4 v49, s[12:15], s36 offen offset:1024 lds
  buffer_load_dwordx4 v50, s[12:15], s36 offen offset:2048 lds
  buffer_load_dwordx4 v51, s[12:15], s36 offen offset:3072 lds
  s_add_u32 m0, s30, 69632
  s_nop 0
  buffer_load_dwordx4 v52, s[12:15], s36 offen offset:0 lds
  buffer_load_dwordx4 v53, s[12:15], s36 offen offset:1024 lds
  buffer_load_dwordx4 v54, s[12:15], s36 offen offset:2048 lds
  buffer_load_dwordx4 v55, s[12:15], s36 offen offset:3072 lds
  s_add_u32 m0, s30, 73728
  s_nop 0
  buffer_load_dwordx4 v56, s[12:15], s36 offen offset:0 lds
  buffer_load_dwordx4 v57, s[12:15], s36 offen offset:1024 lds
  buffer_load_dwordx4 v58, s[12:15], s36 offen offset:2048 lds
  buffer_load_dwordx4 v59, s[12:15], s36 offen offset:3072 lds
  s_add_u32 s30, s30, 12288
  s_cmp_eq_u32 s30, 86016
  s_cselect_b32 s30, 0, s30
  s_xor_b32 s36, s18, 2
  s_mul_i32 s36, s36, 393216
  s_add_u32 s36, s36, s39
  s_add_u32 m0, s30, 65536
  s_nop 0
  buffer_load_dwordx4 v48, s[12:15], s36 offen offset:0 lds
  buffer_load_dwordx4 v49, s[12:15], s36 offen offset:1024 lds
  buffer_load_dwordx4 v50, s[12:15], s36 offen offset:2048 lds
  buffer_load_dwordx4 v51, s[12:15], s36 offen offset:3072 lds
  s_add_u32 m0, s30, 69632
  s_nop 0
  buffer_load_dwordx4 v52, s[12:15], s36 offen offset:0 lds
  buffer_load_dwordx4 v53, s[12:15], s36 offen offset:1024 lds
  buffer_load_dwordx4 v54, s[12:15], s36 offen offset:2048 lds
  buffer_load_dwordx4 v55, s[12:15], s36 offen offset:3072 lds
  s_add_u32 m0, s30, 73728
  s_nop 0
  buffer_load_dwordx4 v56, s[12:15], s36 offen offset:0 lds
  buffer_load_dwordx4 v57, s[12:15], s36 offen offset:1024 lds
  buffer_load_dwordx4 v58, s[12:15], s36 offen offset:2048 lds
  buffer_load_dwordx4 v59, s[12:15], s36 offen offset:3072 lds
  s_add_u32 s30, s30, 12288
  s_cmp_eq_u32 s30, 86016
  s_cselect_b32 s30, 0, s30
  v_mov_b32 v6, s71
  s_mov_b32 s38, 0
.g2_kernel_wg31:
  ds_read_b32 v7, v6 offset:20
  s_add_u32 s38, s38, 1
  s_waitcnt lgkmcnt(0)
  v_cmp_le_u32 vcc, 4, v7
  s_cbranch_vccnz .g2_kernel_wg31d
  s_sleep 1
  s_cmp_lt_u32 s38, 524288
  s_cbranch_scc1 .g2_kernel_wg31
.g2_kernel_wg31d:
  s_mov_b32 s62, 1
  s_mov_b32 s63, 0x1800000
  s_mov_b32 s70, 2
  s_mov_b32 s71, 155776
  s_xor_b32 s36, s18, 2
  s_mul_i32 s36, s36, 393216
  s_add_u32 s36, s36, s39
  s_add_u32 s36, s36, 196608
  s_add_u32 m0, s30, 65536
  s_nop 0
  buffer_load_dwordx4 v48, s[12:15], s36 offen offset:0 lds
  buffer_load_dwordx4 v49, s[12:15], s36 offen offset:1024 lds
  buffer_load_dwordx4 v50, s[12:15], s36 offen offset:2048 lds
  buffer_load_dwordx4 v51, s[12:15], s36 offen offset:3072 lds
  s_add_u32 m0, s30, 69632
  s_nop 0
  buffer_load_dwordx4 v52, s[12:15], s36 offen offset:0 lds
  buffer_load_dwordx4 v53, s[12:15], s36 offen offset:1024 lds
  buffer_load_dwordx4 v54, s[12:15], s36 offen offset:2048 lds
  buffer_load_dwordx4 v55, s[12:15], s36 offen offset:3072 lds
  s_add_u32 m0, s30, 73728
  s_nop 0
  buffer_load_dwordx4 v56, s[12:15], s36 offen offset:0 lds
  buffer_load_dwordx4 v57, s[12:15], s36 offen offset:1024 lds
  buffer_load_dwordx4 v58, s[12:15], s36 offen offset:2048 lds
  buffer_load_dwordx4 v59, s[12:15], s36 offen offset:3072 lds
  s_add_u32 s30, s30, 12288
  s_cmp_eq_u32 s30, 86016
  s_cselect_b32 s30, 0, s30
  s_xor_b32 s36, s18, 3
  s_mul_i32 s36, s36, 393216
  s_add_u32 s36, s36, s39
  s_add_u32 m0, s30, 65536
  s_nop 0
  buffer_load_dwordx4 v48, s[12:15], s36 offen offset:0 lds
  buffer_load_dwordx4 v49, s[12:15], s36 offen offset:1024 lds
  buffer_load_dwordx4 v50, s[12:15], s36 offen offset:2048 lds
  buffer_load_dwordx4 v51, s[12:15], s36 offen offset:3072 lds
  s_add_u32 m0, s30, 69632
  s_nop 0
  buffer_load_dwordx4 v52, s[12:15], s36 offen offset:0 lds
  buffer_load_dwordx4 v53, s[12:15], s36 offen offset:1024 lds
  buffer_load_dwordx4 v54, s[12:15], s36 offen offset:2048 lds
  buffer_load_dwordx4 v55, s[12:15], s36 offen offset:3072 lds
  s_add_u32 m0, s30, 73728
  s_nop 0
  buffer_load_dwordx4 v56, s[12:15], s36 offen offset:0 lds
  buffer_load_dwordx4 v57, s[12:15], s36 offen offset:1024 lds
  buffer_load_dwordx4 v58, s[12:15], s36 offen offset:2048 lds
  buffer_load_dwordx4 v59, s[12:15], s36 offen offset:3072 lds
  s_add_u32 s30, s30, 12288
  s_cmp_eq_u32 s30, 86016
  s_cselect_b32 s30, 0, s30
  s_mov_b32 s28, 1
  s_mov_b32 s29, 16384
  s_bitcmp1_b32 s37, s28
  s_cbranch_scc0 .g2_kernel_p2_x0w
.g2_kernel_p2_x0b:
  s_xor_b32 s33, s28, s18
  s_lshl_b32 s33, s33, 14
  s_add_u32 s33, s33, s32
  s_add_u32 m0, s29, 0
  s_nop 0
  buffer_load_dwordx4 v3, s[4:7], s33 offen offset:0 lds
  buffer_load_dwordx4 v3, s[4:7], s33 offen offset:1024 lds
  buffer_load_dwordx4 v3, s[4:7], s33 offen offset:2048 lds
  buffer_load_dwordx4 v3, s[4:7], s33 offen offset:3072 lds
  s_add_u32 m0, s29, 4096
  s_add_u32 s33, s33, 4096
  buffer_load_dwordx4 v3, s[4:7], s33 offen offset:0 lds
  buffer_load_dwordx4 v3, s[4:7], s33 offen offset:1024 lds
  buffer_load_dwordx4 v3, s[4:7], s33 offen offset:2048 lds
  buffer_load_dwordx4 v3, s[4:7], s33 offen offset:3072 lds
  s_add_u32 m0, s29, 8192
  s_add_u32 s33, s33, 4096
  buffer_load_dwordx4 v3, s[4:7], s33 offen offset:0 lds
  buffer_load_dwordx4 v3, s[4:7], s33 offen offset:1024 lds
  buffer_load_dwordx4 v3, s[4:7], s33 offen offset:2048 lds
  buffer_load_dwordx4 v3, s[4:7], s33 offen offset:3072 lds
  s_add_u32 m0, s29, 12288
  s_add_u32 s33, s33, 4096
  buffer_load_dwordx4 v3, s[4:7], s33 offen offset:0 lds
  buffer_load_dwordx4 v3, s[4:7], s33 offen offset:1024 lds
  buffer_load_dwordx4 v3, s[4:7], s33 offen offset:2048 lds
  buffer_load_dwordx4 v3, s[4:7], s33 offen offset:3072 lds
  s_mov_b32 m0, 156160
  s_mov_b32 s35, .g2_kernel_tab-.g2_kernel_pc+144
  buffer_load_dword off, s[64:67], s35 lds
  s_mov_b32 s28, 2
  s_mov_b32 s29, 32768
  s_bitcmp1_b32 s37, s28
  s_cbranch_scc0 .g2_kernel_p2_x1w
.g2_kernel_p2_x1b:
  s_xor_b32 s33, s28, s18
  s_lshl_b32 s33, s33, 14
  s_add_u32 s33, s33, s32
  s_add_u32 m0, s29, 0
  s_nop 0
  buffer_load_dwordx4 v3, s[4:7], s33 offen offset:0 lds
  buffer_load_dwordx4 v3, s[4:7], s33 offen offset:1024 lds
  buffer_load_dwordx4 v3, s[4:7], s33 offen offset:2048 lds
  buffer_load_dwordx4 v3, s[4:7], s33 offen offset:3072 lds
  s_add_u32 m0, s29, 4096
  s_add_u32 s33, s33, 4096
  buffer_load_dwordx4 v3, s[4:7], s33 offen offset:0 lds
  buffer_load_dwordx4 v3, s[4:7], s33 offen offset:1024 lds
  buffer_load_dwordx4 v3, s[4:7], s33 offen offset:2048 lds
  buffer_load_dwordx4 v3, s[4:7], s33 offen offset:3072 lds
  s_add_u32 m0, s29, 8192
  s_add_u32 s33, s33, 4096
  buffer_load_dwordx4 v3, s[4:7], s33 offen offset:0 lds
  buffer_load_dwordx4 v3, s[4:7], s33 offen offset:1024 lds
  buffer_load_dwordx4 v3, s[4:7], s33 offen offset:2048 lds
  buffer_load_dwordx4 v3, s[4:7], s33 offen offset:3072 lds
  s_add_u32 m0, s29, 12288
  s_add_u32 s33, s33, 4096
  buffer_load_dwordx4 v3, s[4:7], s33 offen offset:0 lds
  buffer_load_dwordx4 v3, s[4:7], s33 offen offset:1024 lds
  buffer_load_dwordx4 v3, s[4:7], s33 offen offset:2048 lds
  buffer_load_dwordx4 v3, s[4:7], s33 offen offset:3072 lds
  s_mov_b32 m0, 156160
  s_mov_b32 s35, .g2_kernel_tab-.g2_kernel_pc+152
  buffer_load_dword off, s[64:67], s35 lds
  s_mov_b32 s28, 3
  s_mov_b32 s29, 49152
  s_bitcmp1_b32 s37, s28
  s_cbranch_scc0 .g2_kernel_p2_x2w
.g2_kernel_p2_x2b:
  s_xor_b32 s33, s28, s18
  s_lshl_b32 s33, s33, 14
  s_add_u32 s33, s33, s32
  s_add_u32 m0, s29, 0
  s_nop 0
  buffer_load_dwordx4 v3, s[4:7], s33 offen offset:0 lds
  buffer_load_dwordx4 v3, s[4:7], s33 offen offset:1024 lds
  buffer_load_dwordx4 v3, s[4:7], s33 offen offset:2048 lds
  buffer_load_dwordx4 v3, s[4:7], s33 offen offset:3072 lds
  s_add_u32 m0, s29, 4096
  s_add_u32 s33, s33, 4096
  buffer_load_dwordx4 v3, s[4:7], s33 offen offset:0 lds
  buffer_load_dwordx4 v3, s[4:7], s33 offen offset:1024 lds
  buffer_load_dwordx4 v3, s[4:7], s33 offen offset:2048 lds
  buffer_load_dwordx4 v3, s[4:7], s33 offen offset:3072 lds
  s_add_u32 m0, s29, 8192
  s_add_u32 s33, s33, 4096
  buffer_load_dwordx4 v3, s[4:7], s33 offen offset:0 lds
  buffer_load_dwordx4 v3, s[4:7], s33 offen offset:1024 lds
  buffer_load_dwordx4 v3, s[4:7], s33 offen offset:2048 lds
  buffer_load_dwordx4 v3, s[4:7], s33 offen offset:3072 lds
  s_add_u32 m0, s29, 12288
  s_add_u32 s33, s33, 4096
  buffer_load_dwordx4 v3, s[4:7], s33 offen offset:0 lds
  buffer_load_dwordx4 v3, s[4:7], s33 offen offset:1024 lds
  buffer_load_dwordx4 v3, s[4:7], s33 offen offset:2048 lds
  buffer_load_dwordx4 v3, s[4:7], s33 offen offset:3072 lds
  s_mov_b32 m0, 156160
  s_mov_b32 s35, .g2_kernel_tab-.g2_kernel_pc+156
  buffer_load_dword off, s[64:67], s35 lds
  s_xor_b32 s36, s18, 3
  s_mul_i32 s36, s36, 393216
  s_add_u32 s36, s36, s39
  s_add_u32 s36, s36, 196608
  ds_read_b32 v10, v9
  s_mov_b32 s34, 33
  s_mov_b32 s35, .g2_kernel_tab-.g2_kernel_pc+160
  s_branch .g2_kernel_p2_o
  .p2align 6
.g2_kernel_p2_l:
  s_waitcnt lgkmcnt(0)
  v_cmp_gt_i32 vcc, s34, v10
  s_cbranch_vccnz .g2_kernel_p2_aw
.g2_kernel_p2_ai:
  s_add_u32 s29, s29, 16384
  s_and_b32 s29, s29, 0xffff
  s_bitcmp1_b32 s37, s28
  s_cbranch_scc0 .g2_kernel_p2_x3w
.g2_kernel_p2_x3b:
  s_xor_b32 s33, s28, s18
  s_lshl_b32 s33, s33, 14
  s_add_u32 s33, s33, s32
  s_add_u32 m0, s29, 0
  s_nop 0
  buffer_load_dwordx4 v3, s[4:7], s33 offen offset:0 lds
  buffer_load_dwordx4 v3, s[4:7], s33 offen offset:1024 lds
  buffer_load_dwordx4 v3, s[4:7], s33 offen offset:2048 lds
  buffer_load_dwordx4 v3, s[4:7], s33 offen offset:3072 lds
  s_add_u32 m0, s29, 4096
  s_add_u32 s33, s33, 4096
  buffer_load_dwordx4 v3, s[4:7], s33 offen offset:0 lds
  buffer_load_dwordx4 v3, s[4:7], s33 offen offset:1024 lds
  buffer_load_dwordx4 v3, s[4:7], s33 offen offset:2048 lds
  buffer_load_dwordx4 v3, s[4:7], s33 offen offset:3072 lds
  s_add_u32 m0, s29, 8192
  s_add_u32 s33, s33, 4096
  buffer_load_dwordx4 v3, s[4:7], s33 offen offset:0 lds
  buffer_load_dwordx4 v3, s[4:7], s33 offen offset:1024 lds
  buffer_load_dwordx4 v3, s[4:7], s33 offen offset:2048 lds
  buffer_load_dwordx4 v3, s[4:7], s33 offen offset:3072 lds
  s_add_u32 m0, s29, 12288
  s_add_u32 s33, s33, 4096
  buffer_load_dwordx4 v3, s[4:7], s33 offen offset:0 lds
  buffer_load_dwordx4 v3, s[4:7], s33 offen offset:1024 lds
  buffer_load_dwordx4 v3, s[4:7], s33 offen offset:2048 lds
  buffer_load_dwordx4 v3, s[4:7], s33 offen offset:3072 lds
  s_add_u32 m0, s30, 65536
  s_nop 0
  buffer_load_dwordx4 v48, s[12:15], s36 offen offset:0 lds
  buffer_load_dwordx4 v49, s[12:15], s36 offen offset:1024 lds
  buffer_load_dwordx4 v50, s[12:15], s36 offen offset:2048 lds
  buffer_load_dwordx4 v51, s[12:15], s36 offen offset:3072 lds
  s_add_u32 m0, s30, 69632
  s_nop 0
  buffer_load_dwordx4 v52, s[12:15], s36 offen offset:0 lds
  buffer_load_dwordx4 v53, s[12:15], s36 offen offset:1024 lds
  buffer_load_dwordx4 v54, s[12:15], s36 offen offset:2048 lds
  buffer_load_dwordx4 v55, s[12:15], s36 offen offset:3072 lds
  s_add_u32 m0, s30, 73728
  s_nop 0
  buffer_load_dwordx4 v56, s[12:15], s36 offen offset:0 lds
  buffer_load_dwordx4 v57, s[12:15], s36 offen offset:1024 lds
  buffer_load_dwordx4 v58, s[12:15], s36 offen offset:2048 lds
  buffer_load_dwordx4 v59, s[12:15], s36 offen offset:3072 lds
  s_add_u32 s30, s30, 12288
  s_cmp_eq_u32 s30, 86016
  s_cselect_b32 s30, 0, s30
  ds_read_b32 v10, v9
  s_mov_b32 m0, 156160
  s_add_u32 s34, s34, 1
  buffer_load_dword off, s[64:67], s35 lds
  s_add_u32 s35, s35, 4
  s_add_u32 s36, s36, 196608
.g2_kernel_p2_o:
  s_waitcnt lgkmcnt(0)
  v_cmp_gt_i32 vcc, s34, v10
  s_cbranch_vccnz .g2_kernel_p2_bw
.g2_kernel_p2_bi:
  s_add_u32 m0, s30, 65536
  s_nop 0
  buffer_load_dwordx4 v48, s[12:15], s36 offen offset:0 lds
  buffer_load_dwordx4 v49, s[12:15], s36 offen offset:1024 lds
  buffer_load_dwordx4 v50, s[12:15], s36 offen offset:2048 lds
  buffer_load_dwordx4 v51, s[12:15], s36 offen offset:3072 lds
  s_add_u32 m0, s30, 69632
  s_nop 0
  buffer_load_dwordx4 v52, s[12:15], s36 offen offset:0 lds
  buffer_load_dwordx4 v53, s[12:15], s36 offen offset:1024 lds
  buffer_load_dwordx4 v54, s[12:15], s36 offen offset:2048 lds
  buffer_load_dwordx4 v55, s[12:15], s36 offen offset:3072 lds
  s_add_u32 m0, s30, 73728
  s_nop 0
  buffer_load_dwordx4 v56, s[12:15], s36 offen offset:0 lds
  buffer_load_dwordx4 v57, s[12:15], s36 offen offset:1024 lds
  buffer_load_dwordx4 v58, s[12:15], s36 offen offset:2048 lds
  buffer_load_dwordx4 v59, s[12:15], s36 offen offset:3072 lds
  s_add_u32 s30, s30, 12288
  s_cmp_eq_u32 s30, 86016
  s_cselect_b32 s30, 0, s30
  ds_read_b32 v10, v9
  s_mov_b32 m0, 156160
  s_add_u32 s34, s34, 1
  buffer_load_dword off, s[64:67], s35 lds
  s_add_u32 s35, s35, 4
  s_add_u32 s28, s28, 1
  s_xor_b32 s36, s18, s28
  s_mul_i32 s36, s36, 393216
  s_add_u32 s36, s36, s39
  s_cmp_lt_i32 s34, 58
  s_cbranch_scc1 .g2_kernel_p2_l
  s_branch .g2_kernel_v
.g2_kernel_c1:
  v_mov_b32 v6, s71
  s_mov_b32 s38, 0
.g2_kernel_wg32:
  ds_read_b32 v7, v6 offset:76
  s_add_u32 s38, s38, 1
  s_waitcnt lgkmcnt(0)
  v_cmp_le_u32 vcc, 1, v7
  s_cbranch_vccnz .g2_kernel_wg32d
  s_sleep 1
  s_cmp_lt_u32 s38, 524288
  s_cbranch_scc1 .g2_kernel_wg32
.g2_kernel_wg32d:
  s_sleep 10
  s_and_b32 s31, s19, 0xffffe000
  s_add_u32 s31, s31, 4
  v_and_b32 v6, 15, v2
  v_lshlrev_b32 v6, 9, v6
  v_lshrrev_b32 v7, 4, v2
  v_lshl_add_u32 v6, v7, 7, v6
  v_lshlrev_b32 v7, 2, v2
  v_add_u32 v7, 157952, v7
  s_mov_b32 m0, 157952
  s_mov_b32 s38, 0
.g2_kernel_pa33:
  buffer_load_dword v6, s[4:7], s31 offen sc1 lds
  s_add_u32 s38, s38, 1
  s_waitcnt vmcnt(0)
  ds_read_b32 v8, v7
  s_waitcnt lgkmcnt(0)
  v_cmp_ge_u32 vcc, s62, v8
  s_cbranch_vccz .g2_kernel_pa33d
  s_mov_b64 exec, vcc
  s_sleep 4
  s_cmp_lt_u32 s38, 131072
  s_cbranch_scc1 .g2_kernel_pa33
.g2_kernel_pa33d:
  s_mov_b64 exec, -1
  s_setprio 2
  s_lshl_b32 s30, s17, 4
  s_add_u32 s30, s30, s18
  s_lshl_b32 s20, s30, 11
  s_add_u32 s20, s20, s63
  s_add_u32 s20, s20, 0x1000000
  s_lshl_b32 s21, s30, 6
  s_add_u32 s21, s21, s63
  s_add_u32 s21, s21, 0x1080000
  s_lshl_b32 s23, s62, 14
  s_add_u32 s23, s23, 0x3040000
  s_lshl_b32 s22, s30, 3
  s_add_u32 s22, s22, s23
  s_and_b32 s28, s2, 7
  s_lshl_b32 s28, s28, 11
  s_add_u32 s23, s23, s28
  v_mov_b32 v9, 155648
  ds_read_b32 v26, v9 offset:256
  v_lshrrev_b32 v24, 4, v2
  v_lshlrev_b32 v25, 3, v24
  v_lshlrev_b32 v27, 11, v2
  v_mov_b32 v28, 0.0009765625
  v_mov_b32 v30, 1e-05
  v_mov_b32 v6, s71
  s_mov_b32 s38, 0
.g2_kernel_wg35:
  ds_read_b32 v7, v6 offset:20
  s_add_u32 s38, s38, 1
  s_waitcnt lgkmcnt(0)
  v_cmp_le_u32 vcc, 4, v7
  s_cbranch_vccnz .g2_kernel_wg35d
  s_sleep 1
  s_cmp_lt_u32 s38, 524288
  s_cbranch_scc1 .g2_kernel_wg35
.g2_kernel_wg35d:
  s_sleep 12
  s_cmp_lg_u32 s62, 0
  s_cbranch_scc1 .g2_kernel_nap36
  s_sleep 8
.g2_kernel_nap36:
  s_mov_b32 s38, 0
.g2_kernel_gx37:
  buffer_load_dwordx4 v[16:19], v3, s[4:7], s20 offen offset:0 sc1
  buffer_load_dwordx4 v[20:23], v3, s[4:7], s20 offen offset:1024 sc1
  s_add_u32 s38, s38, 1
  s_waitcnt vmcnt(0)
  v_min3_u32 v6, v16, v19, v20
  v_min_u32 v6, v6, v23
  v_cmp_eq_u32 vcc, 0, v6
  s_cbranch_vccz .g2_kernel_gx37d
  s_mov_b64 exec, vcc
  s_sleep 1
  s_cmp_lg_u32 s62, 0
  s_cbranch_scc1 .g2_kernel_nap38
  s_sleep 11
.g2_kernel_nap38:
  s_cmp_lt_u32 s38, 131072
  s_cbranch_scc1 .g2_kernel_gx37
.g2_kernel_gx37d:
  s_mov_b64 exec, -1
  v_add_f32 v16, v16, v16 row_ror:8 row_mask:0xf bank_mask:0xf
  v_add_f32 v17, v17, v17 row_ror:8 row_mask:0xf bank_mask:0xf
  v_add_f32 v18, v18, v18 row_ror:8 row_mask:0xf bank_mask:0xf
  v_add_f32 v20, v20, v20 row_ror:8 row_mask:0xf bank_mask:0xf
  v_add_f32 v21, v21, v21 row_ror:8 row_mask:0xf bank_mask:0xf
  v_add_f32 v22, v22, v22 row_ror:8 row_mask:0xf bank_mask:0xf
  v_add_f32 v16, v16, v16 row_ror:4 row_mask:0xf bank_mask:0xf
  v_add_f32 v17, v17, v17 row_ror:4 row_mask:0xf bank_mask:0xf
  v_add_f32 v18, v18, v18 row_ror:4 row_mask:0xf bank_mask:0xf
  v_add_f32 v20, v20, v20 row_ror:4 row_mask:0xf bank_mask:0xf
  v_add_f32 v21, v21, v21 row_ror:4 row_mask:0xf bank_mask:0xf
  v_add_f32 v22, v22, v22 row_ror:4 row_mask:0xf bank_mask:0xf
  v_add_f32 v16, v16, v16 row_ror:2 row_mask:0xf bank_mask:0xf
  v_add_f32 v17, v17, v17 row_ror:2 row_mask:0xf bank_mask:0xf
  v_add_f32 v18, v18, v18 row_ror:2 row_mask:0xf bank_mask:0xf
  v_add_f32 v20, v20, v20 row_ror:2 row_mask:0xf bank_mask:0xf
  v_add_f32 v21, v21, v21 row_ror:2 row_mask:0xf bank_mask:0xf
  v_add_f32 v22, v22, v22 row_ror:2 row_mask:0xf bank_mask:0xf
  v_add_f32 v16, v16, v16 row_ror:1 row_mask:0xf bank_mask:0xf
  v_add_f32 v17, v17, v17 row_ror:1 row_mask:0xf bank_mask:0xf
  v_add_f32 v18, v18, v18 row_ror:1 row_mask:0xf bank_mask:0xf
  v_add_f32 v20, v20, v20 row_ror:1 row_mask:0xf bank_mask:0xf
  v_add_f32 v21, v21, v21 row_ror:1 row_mask:0xf bank_mask:0xf
  v_add_f32 v22, v22, v22 row_ror:1 row_mask:0xf bank_mask:0xf
  v_fma_f32 v18, -v16, v26, v18
  v_mul_f32 v16, v28, v16
  v_mul_f32 v19, v16, v16
  v_fma_f32 v17, v17, v28, -v19
  v_max_f32 v17, 0, v17
  v_add_f32 v17, v30, v17
  v_rsq_f32 v19, v17
  v_fma_f32 v22, -v20, v26, v22
  v_mul_f32 v20, v28, v20
  v_mul_f32 v23, v20, v20
  v_fma_f32 v21, v21, v28, -v23
  v_max_f32 v21, 0, v21
  v_add_f32 v21, v30, v21
  v_rsq_f32 v23, v21
  v_mul_f32 v18, v18, v19
  v_mul_f32 v22, v22, v23
  v_and_or_b32 v18, v18, -8, v24
  v_or_b32 v29, 4, v24
  v_and_or_b32 v22, v22, -8, v29
  v_max_f32 v10, v18, v22
  v_mov_b32 v11, 1
  s_nop 0
  v_max_f32 v10, v10, v10 row_bcast:15 row_mask:0xa bank_mask:0xf
  s_nop 1
  v_max_f32 v10, v10, v10 row_bcast:31 row_mask:0xc bank_mask:0xf
  s_nop 0
  v_readlane_b32 s28, v10, 63
  s_nop 1
  v_mov_b32 v10, s28
  s_mov_b64 exec, 0xff
  buffer_store_dwordx2 v[10:11], v27, s[4:7], s22 offen sc1
  s_mov_b32 exec_lo, 0x00010001
  s_mov_b32 exec_hi, 0x00010001
  buffer_store_dwordx2 v[16:17], v25, s[4:7], s21 offen sc1
  buffer_store_dwordx2 v[20:21], v25, s[4:7], s21 offen offset:32 sc1
  s_mov_b64 exec, -1
  s_sleep 8
  s_cmp_lg_u32 s62, 0
  s_cbranch_scc1 .g2_kernel_nap39
  s_sleep 12
.g2_kernel_nap39:
  s_mov_b32 s38, 0
.g2_kernel_gx40:
  buffer_load_dwordx4 v[16:19], v3, s[4:7], s23 offen offset:0 sc1
  buffer_load_dwordx4 v[20:23], v3, s[4:7], s23 offen offset:1024 sc1
  s_add_u32 s38, s38, 1
  s_waitcnt vmcnt(0)
  v_min3_u32 v6, v17, v19, v21
  v_min_u32 v6, v6, v23
  v_cmp_eq_u32 vcc, 0, v6
  s_cbranch_vccz .g2_kernel_gx40d
  s_mov_b64 exec, vcc
  s_sleep 1
  s_cmp_lg_u32 s62, 0
  s_cbranch_scc1 .g2_kernel_nap41
  s_sleep 11
.g2_kernel_nap41:
  s_cmp_lt_u32 s38, 131072
  s_cbranch_scc1 .g2_kernel_gx40
.g2_kernel_gx40d:
  s_mov_b64 exec, -1
  s_mov_b32 s28, 0xffffffe7
  v_and_or_b32 v16, v16, s28, 0
  v_and_or_b32 v18, v18, s28, 8
  v_and_or_b32 v20, v20, s28, 16
  v_and_or_b32 v22, v22, s28, 24
  v_max3_f32 v10, v16, v18, v20
  v_max_f32 v10, v10, v22
  s_nop 1
  v_max_f32 v11, v10, v10 row_ror:8 row_mask:0xf bank_mask:0xf
  s_nop 1
  v_max_f32 v11, v11, v11 row_ror:4 row_mask:0xf bank_mask:0xf
  s_nop 1
  v_max_f32 v11, v11, v11 row_ror:2 row_mask:0xf bank_mask:0xf
  s_nop 1
  v_max_f32 v11, v11, v11 row_ror:1 row_mask:0xf bank_mask:0xf
  s_nop 1
  v_max_f32 v11, v11, v11 row_bcast:15 row_mask:0xa bank_mask:0xf
  s_nop 1
  v_max_f32 v11, v11, v11 row_bcast:31 row_mask:0xc bank_mask:0xf
  s_nop 0
  v_readlane_b32 s27, v11, 63
  s_nop 1
  v_cmp_eq_u32 vcc, s27, v10
  s_ff1_i32_b64 s77, vcc
  s_lshl_b32 s77, s77, 4
  s_and_b32 s28, s27, 15
  s_add_u32 s77, s77, s28
  s_and_b32 s28, s27, 16
  s_lshl_b32 s28, s28, 6
  s_add_u32 s77, s77, s28
  s_and_b32 s77, s77, 2047
  s_add_u32 s28, s77, 1
  v_mov_b32 v10, s28
  v_mov_b32 v9, s71
  ds_write_b32 v9, v10 offset:36
  s_lshr_b32 s24, s77, 7
  s_lshl_b32 s24, s24, 18
  s_bfe_u32 s28, s77, 0x30004
  s_lshl_b32 s28, s28, 11
  s_add_u32 s24, s24, s28
  s_and_b32 s28, s77, 15
  s_lshl_b32 s28, s28, 4
  s_add_u32 s24, s24, s28
  s_add_u32 s24, s24, s63
  s_add_u32 s24, s24, 0xc00000
  s_lshl_b32 s28, s17, 14
  s_add_u32 s24, s24, s28
  s_and_b32 s28, s18, 1
  s_lshl_b32 s28, s28, 8
  s_add_u32 s24, s24, s28
  v_lshrrev_b32 v12, 3, v2
  v_lshlrev_b32 v13, 1, v12
  s_waitcnt lgkmcnt(0)
  s_wakeup
  buffer_load_ushort v56, v13, s[4:7], s24 offen offset:0
  buffer_load_ushort v57, v13, s[4:7], s24 offen offset:512
  buffer_load_ushort v58, v13, s[4:7], s24 offen offset:1024
  buffer_load_ushort v59, v13, s[4:7], s24 offen offset:1536
  s_lshl_b32 s25, s77, 3
  s_add_u32 s25, s25, s63
  s_add_u32 s25, s25, 0x1080000
  s_lshl_b32 s21, s17, 10
  s_add_u32 s21, s21, s63
  s_add_u32 s21, s21, 0x1080000
  s_mov_b32 s38, 0
.g2_kernel_gx42:
  buffer_load_dwordx4 v[16:19], v3, s[4:7], s21 offen sc1
  buffer_load_dwordx2 v[20:21], v4, s[4:7], s25 offen sc1
  s_add_u32 s38, s38, 1
  s_waitcnt vmcnt(0)
  v_min3_u32 v6, v17, v19, v21
  v_cmp_eq_u32 vcc, 0, v6
  s_cbranch_vccz .g2_kernel_gx42d
  s_mov_b64 exec, vcc
  s_sleep 1
  s_cmp_lt_u32 s38, 131072
  s_cbranch_scc1 .g2_kernel_gx42
.g2_kernel_gx42d:
  s_mov_b64 exec, -1
  s_lshr_b32 s28, s77, 7
  s_and_b32 s79, s77, 127
  s_add_u32 s79, s79, 1
  s_cmp_eq_u32 s28, s17
  s_cselect_b32 s79, s79, 0
  v_rsq_f32 v22, v17
  v_rsq_f32 v23, v19
  v_rsq_f32 v21, v21
  v_mov_b32 v62, -1.4426950408889634
  v_mul_f32 v62, s27, v62
  v_exp_f32 v62, v62
  v_lshlrev_b32 v14, 3, v2
  v_add_u32 v14, 155648, v14
  v_mov_b32 v15, s79
  v_add_f32 v52, 1.0, v22
  v_mul_f32 v54, v16, v22
  v_sub_f32 v54, 0, v54
  v_add_f32 v53, 1.0, v23
  v_mul_f32 v55, v18, v23
  v_sub_f32 v55, 0, v55
  s_cmp_eq_u32 s62, 0
  s_cbranch_scc1 .g2_kernel_c_m1
  ds_write_b64 v14, v[52:53] offset:3840
  ds_write_b64 v14, v[54:55] offset:4352
  ds_write_b32 v9, v15 offset:32
  ds_write_b32 v9, v5 offset:28
  s_cmp_ge_u32 s18, 2
  s_cbranch_scc1 .g2_kernel_fin
.g2_kernel_c_m1:
  v_add_f32 v62, 1.0, v62
  v_rcp_f32 v62, v62
  v_add_f32 v60, 1.0, v21
  v_mul_f32 v61, v20, v21
  v_sub_f32 v61, 0, v61
  v_sub_f32 v17, v17, v30
  v_mul_f32 v48, v52, v52
  v_fma_f32 v48, v48, v17, v30
  v_rsq_f32 v48, v48
  s_nop 0
  v_mul_f32 v48, v48, v52
  v_mul_f32 v50, v48, v16
  v_sub_f32 v50, 0, v50
  v_sub_f32 v19, v19, v30
  v_mul_f32 v49, v53, v53
  v_fma_f32 v49, v49, v19, v30
  v_rsq_f32 v49, v49
  s_nop 0
  v_mul_f32 v49, v49, v53
  v_mul_f32 v51, v49, v18
  v_sub_f32 v51, 0, v51
  v_lshlrev_b32 v56, 16, v56
  v_fma_f32 v56, v56, v60, v61
  v_lshlrev_b32 v57, 16, v57
  v_fma_f32 v57, v57, v60, v61
  v_lshlrev_b32 v58, 16, v58
  v_fma_f32 v58, v58, v60, v61
  v_lshlrev_b32 v59, 16, v59
  v_fma_f32 v59, v59, v60, v61
  v_and_b32 v10, 7, v2
  v_lshlrev_b32 v10, 12, v10
  v_lshl_add_u32 v10, v12, 4, v10
  s_lshl_b32 s20, s17, 1
  s_and_b32 s28, s18, 1
  s_add_u32 s20, s20, s28
  s_lshl_b32 s20, s20, 7
  s_add_u32 s20, s20, s63
  s_add_u32 s20, s20, 0x1090000
  s_and_b32 s26, s18, 14
  s_lshl_b32 s26, s26, 4
  s_add_u32 s26, s26, s17
  s_lshl_b32 s26, s26, 1
  s_and_b32 s28, s18, 1
  s_add_u32 s26, s26, s28
  s_lshl_b32 s26, s26, 10
  s_add_u32 s26, s26, s63
  s_add_u32 s26, s26, 0x1190000
  s_add_u32 s25, s26, 32768
  v_mov_b32 v6, s71
  s_mov_b32 s38, 0
.g2_kernel_wg43:
  ds_read_b32 v7, v6 offset:48
  s_add_u32 s38, s38, 1
  s_waitcnt lgkmcnt(0)
  v_cmp_le_u32 vcc, 2, v7
  s_cbranch_vccnz .g2_kernel_wg43d
  s_sleep 1
  s_cmp_lt_u32 s38, 524288
  s_cbranch_scc1 .g2_kernel_wg43
.g2_kernel_wg43d:
  s_sleep 8
  s_cmp_lg_u32 s62, 0
  s_cbranch_scc1 .g2_kernel_nap44
  s_sleep 12
.g2_kernel_nap44:
  s_mov_b32 s38, 0
.g2_kernel_gx45:
  s_mov_b32 s21, s20
  buffer_load_dwordx4 v[160:163], v10, s[4:7], s21 offen sc1
  s_add_u32 s21, s21, 32768
  buffer_load_dwordx4 v[164:167], v10, s[4:7], s21 offen sc1
  s_add_u32 s21, s21, 32768
  buffer_load_dwordx4 v[168:171], v10, s[4:7], s21 offen sc1
  s_add_u32 s21, s21, 32768
  buffer_load_dwordx4 v[172:175], v10, s[4:7], s21 offen sc1
  s_add_u32 s21, s21, 32768
  buffer_load_dwordx4 v[176:179], v10, s[4:7], s21 offen sc1
  s_add_u32 s21, s21, 32768
  buffer_load_dwordx4 v[180:183], v10, s[4:7], s21 offen sc1
  s_add_u32 s21, s21, 32768
  buffer_load_dwordx4 v[184:187], v10, s[4:7], s21 offen sc1
  s_add_u32 s21, s21, 32768
  buffer_load_dwordx4 v[188:191], v10, s[4:7], s21 offen sc1
  s_add_u32 s21, s21, 32768
  buffer_load_dwordx4 v[192:195], v10, s[4:7], s21 offen sc1
  s_add_u32 s21, s21, 32768
  buffer_load_dwordx4 v[196:199], v10, s[4:7], s21 offen sc1
  s_add_u32 s21, s21, 32768
  buffer_load_dwordx4 v[200:203], v10, s[4:7], s21 offen sc1
  s_add_u32 s21, s21, 32768
  buffer_load_dwordx4 v[204:207], v10, s[4:7], s21 offen sc1
  s_add_u32 s21, s21, 32768
  buffer_load_dwordx4 v[208:211], v10, s[4:7], s21 offen sc1
  s_add_u32 s21, s21, 32768
  buffer_load_dwordx4 v[212:215], v10, s[4:7], s21 offen sc1
  s_add_u32 s21, s21, 32768
  buffer_load_dwordx4 v[216:219], v10, s[4:7], s21 offen sc1
  s_add_u32 s21, s21, 32768
  buffer_load_dwordx4 v[220:223], v10, s[4:7], s21 offen sc1
  s_add_u32 s21, s21, 32768
  buffer_load_dwordx4 v[224:227], v10, s[4:7], s21 offen sc1
  s_add_u32 s21, s21, 32768
  buffer_load_dwordx4 v[228:231], v10, s[4:7], s21 offen sc1
  s_add_u32 s21, s21, 32768
  buffer_load_dwordx4 v[232:235], v10, s[4:7], s21 offen sc1
  s_add_u32 s21, s21, 32768
  buffer_load_dwordx4 v[236:239], v10, s[4:7], s21 offen sc1
  s_add_u32 s21, s21, 32768
  buffer_load_dwordx4 v[240:243], v10, s[4:7], s21 offen sc1
  s_add_u32 s21, s21, 32768
  buffer_load_dwordx4 v[244:247], v10, s[4:7], s21 offen sc1
  s_add_u32 s21, s21, 32768
  buffer_load_dwordx4 v[248:251], v10, s[4:7], s21 offen sc1
  s_add_u32 s21, s21, 32768
  buffer_load_dwordx4 v[252:255], v10, s[4:7], s21 offen sc1
  s_add_u32 s21, s21, 32768
  buffer_load_dwordx4 v[16:19], v10, s[4:7], s21 offen sc1
  s_add_u32 s21, s21, 32768
  buffer_load_dwordx4 v[20:23], v10, s[4:7], s21 offen sc1
  s_add_u32 s21, s21, 32768
  buffer_load_dwordx4 v[24:27], v10, s[4:7], s21 offen sc1
  s_add_u32 s21, s21, 32768
  buffer_load_dwordx4 v[28:31], v10, s[4:7], s21 offen sc1
  s_add_u32 s21, s21, 32768
  s_add_u32 s38, s38, 1
  s_waitcnt vmcnt(0)
  v_min3_u32 v6, v160, v162, v164
  v_min3_u32 v6, v6, v166, v168
  v_min3_u32 v6, v6, v170, v172
  v_min3_u32 v6, v6, v174, v176
  v_min3_u32 v6, v6, v178, v180
  v_min3_u32 v6, v6, v182, v184
  v_min3_u32 v6, v6, v186, v188
  v_min3_u32 v6, v6, v190, v192
  v_min3_u32 v6, v6, v194, v196
  v_min3_u32 v6, v6, v198, v200
  v_min3_u32 v6, v6, v202, v204
  v_min3_u32 v6, v6, v206, v208
  v_min3_u32 v6, v6, v210, v212
  v_min3_u32 v6, v6, v214, v216
  v_min3_u32 v6, v6, v218, v220
  v_min3_u32 v6, v6, v222, v224
  v_min3_u32 v6, v6, v226, v228
  v_min3_u32 v6, v6, v230, v232
  v_min3_u32 v6, v6, v234, v236
  v_min3_u32 v6, v6, v238, v240
  v_min3_u32 v6, v6, v242, v244
  v_min3_u32 v6, v6, v246, v248
  v_min3_u32 v6, v6, v250, v252
  v_min3_u32 v6, v6, v254, v16
  v_min3_u32 v6, v6, v18, v20
  v_min3_u32 v6, v6, v22, v24
  v_min3_u32 v6, v6, v26, v28
  v_min_u32 v6, v6, v30
  v_cmp_eq_u32 vcc, 0, v6
  s_cbranch_vccz .g2_kernel_gx45d
  s_mov_b64 exec, vcc
  s_sleep 1
  s_cmp_lg_u32 s62, 0
  s_cbranch_scc1 .g2_kernel_nap46
  s_sleep 11
.g2_kernel_nap46:
  s_cmp_lt_u32 s38, 131072
  s_cbranch_scc1 .g2_kernel_gx45
.g2_kernel_gx45d:
  s_mov_b64 exec, -1
  v_add_f32 v164, v164, v160
  v_add_f32 v165, v165, v161
  v_add_f32 v166, v166, v162
  v_add_f32 v167, v167, v163
  v_add_f32 v172, v172, v168
  v_add_f32 v173, v173, v169
  v_add_f32 v174, v174, v170
  v_add_f32 v175, v175, v171
  v_add_f32 v180, v180, v176
  v_add_f32 v181, v181, v177
  v_add_f32 v182, v182, v178
  v_add_f32 v183, v183, v179
  v_add_f32 v188, v188, v184
  v_add_f32 v189, v189, v185
  v_add_f32 v190, v190, v186
  v_add_f32 v191, v191, v187
  v_add_f32 v196, v196, v192
  v_add_f32 v197, v197, v193
  v_add_f32 v198, v198, v194
  v_add_f32 v199, v199, v195
  v_add_f32 v204, v204, v200
  v_add_f32 v205, v205, v201
  v_add_f32 v206, v206, v202
  v_add_f32 v207, v207, v203
  v_add_f32 v212, v212, v208
  v_add_f32 v213, v213, v209
  v_add_f32 v214, v214, v210
  v_add_f32 v215, v215, v211
  v_add_f32 v220, v220, v216
  v_add_f32 v221, v221, v217
  v_add_f32 v222, v222, v218
  v_add_f32 v223, v223, v219
  v_add_f32 v228, v228, v224
  v_add_f32 v229, v229, v225
  v_add_f32 v230, v230, v226
  v_add_f32 v231, v231, v227
  v_add_f32 v236, v236, v232
  v_add_f32 v237, v237, v233
  v_add_f32 v238, v238, v234
  v_add_f32 v239, v239, v235
  v_add_f32 v244, v244, v240
  v_add_f32 v245, v245, v241
  v_add_f32 v246, v246, v242
  v_add_f32 v247, v247, v243
  v_add_f32 v252, v252, v248
  v_add_f32 v253, v253, v249
  v_add_f32 v254, v254, v250
  v_add_f32 v255, v255, v251
  v_add_f32 v20, v20, v16
  v_add_f32 v21, v21, v17
  v_add_f32 v22, v22, v18
  v_add_f32 v23, v23, v19
  v_add_f32 v28, v28, v24
  v_add_f32 v29, v29, v25
  v_add_f32 v30, v30, v26
  v_add_f32 v31, v31, v27
  v_add_f32 v172, v172, v164
  v_add_f32 v173, v173, v165
  v_add_f32 v174, v174, v166
  v_add_f32 v175, v175, v167
  v_add_f32 v188, v188, v180
  v_add_f32 v189, v189, v181
  v_add_f32 v190, v190, v182
  v_add_f32 v191, v191, v183
  v_add_f32 v204, v204, v196
  v_add_f32 v205, v205, v197
  v_add_f32 v206, v206, v198
  v_add_f32 v207, v207, v199
  v_add_f32 v220, v220, v212
  v_add_f32 v221, v221, v213
  v_add_f32 v222, v222, v214
  v_add_f32 v223, v223, v215
  v_add_f32 v236, v236, v228
  v_add_f32 v237, v237, v229
  v_add_f32 v238, v238, v230
  v_add_f32 v239, v239, v231
  v_add_f32 v252, v252, v244
  v_add_f32 v253, v253, v245
  v_add_f32 v254, v254, v246
  v_add_f32 v255, v255, v247
  v_add_f32 v28, v28, v20
  v_add_f32 v29, v29, v21
  v_add_f32 v30, v30, v22
  v_add_f32 v31, v31, v23
  v_add_f32 v188, v188, v172
  v_add_f32 v189, v189, v173
  v_add_f32 v190, v190, v174
  v_add_f32 v191, v191, v175
  v_add_f32 v220, v220, v204
  v_add_f32 v221, v221, v205
  v_add_f32 v222, v222, v206
  v_add_f32 v223, v223, v207
  v_add_f32 v252, v252, v236
  v_add_f32 v253, v253, v237
  v_add_f32 v254, v254, v238
  v_add_f32 v255, v255, v239
  v_add_f32 v220, v220, v188
  v_add_f32 v221, v221, v189
  v_add_f32 v222, v222, v190
  v_add_f32 v223, v223, v191
  v_add_f32 v28, v28, v252
  v_add_f32 v29, v29, v253
  v_add_f32 v30, v30, v254
  v_add_f32 v31, v31, v255
  v_add_f32 v28, v28, v220
  v_add_f32 v29, v29, v221
  v_add_f32 v30, v30, v222
  v_add_f32 v31, v31, v223
  v_add_f32 v28, v28, v28 quad_perm:[1,0,3,2] row_mask:0xf bank_mask:0xf
  v_add_f32 v29, v29, v29 quad_perm:[1,0,3,2] row_mask:0xf bank_mask:0xf
  v_add_f32 v30, v30, v30 quad_perm:[1,0,3,2] row_mask:0xf bank_mask:0xf
  v_add_f32 v31, v31, v31 quad_perm:[1,0,3,2] row_mask:0xf bank_mask:0xf
  v_add_f32 v28, v28, v28 quad_perm:[2,3,0,1] row_mask:0xf bank_mask:0xf
  v_add_f32 v29, v29, v29 quad_perm:[2,3,0,1] row_mask:0xf bank_mask:0xf
  v_add_f32 v30, v30, v30 quad_perm:[2,3,0,1] row_mask:0xf bank_mask:0xf
  v_add_f32 v31, v31, v31 quad_perm:[2,3,0,1] row_mask:0xf bank_mask:0xf
  v_add_f32 v28, v28, v28 row_half_mirror row_mask:0xf bank_mask:0xf
  v_add_f32 v29, v29, v29 row_half_mirror row_mask:0xf bank_mask:0xf
  v_add_f32 v30, v30, v30 row_half_mirror row_mask:0xf bank_mask:0xf
  v_add_f32 v31, v31, v31 row_half_mirror row_mask:0xf bank_mask:0xf
  v_mul_f32 v28, v28, v62
  v_mul_f32 v29, v29, v62
  v_mul_f32 v30, v30, v62
  v_mul_f32 v31, v31, v62
  v_cvt_pk_bf16_f32 v16, v28, v29
  v_cvt_pk_bf16_f32 v17, v30, v31
  s_mov_b32 s28, 0x00010001
  s_mov_b32 s29, 0x00010001
  v_mov_b32 v18, v16 row_ror:8 row_mask:0xf bank_mask:0xf
  v_mov_b32 v19, v17 row_ror:8 row_mask:0xf bank_mask:0xf
  v_lshlrev_b32 v28, 16, v16
  v_and_b32 v29, 0xffff0000, v16
  v_lshlrev_b32 v30, 16, v17
  v_and_b32 v31, 0xffff0000, v17
  s_cmp_lg_u32 s62, 0
  s_cbranch_scc1 .g2_kernel_c_t3
  v_cndmask_b32 v32, 0, v16, s[28:29]
  v_cndmask_b32 v33, 0, v17, s[28:29]
  v_cndmask_b32 v34, 0, v18, s[28:29]
  v_cndmask_b32 v35, 0, v19, s[28:29]
  s_lshl_b64 s[28:29], s[28:29], 1
  s_nop 0
  v_mfma_f32_16x16x32_bf16 v[160:163], v[32:35], v[64:67], 0
  v_mfma_f32_16x16x32_bf16 v[164:167], v[32:35], v[80:83], 0
  v_mfma_f32_16x16x32_bf16 v[168:171], v[32:35], v[96:99], 0
  v_mfma_f32_16x16x32_bf16 v[172:175], v[32:35], v[112:115], 0
  v_mfma_f32_16x16x32_bf16 v[176:179], v[32:35], v[128:131], 0
  v_mfma_f32_16x16x32_bf16 v[180:183], v[32:35], v[144:147], 0
  v_cndmask_b32 v36, 0, v16, s[28:29]
  v_cndmask_b32 v37, 0, v17, s[28:29]
  v_cndmask_b32 v38, 0, v18, s[28:29]
  v_cndmask_b32 v39, 0, v19, s[28:29]
  s_lshl_b64 s[28:29], s[28:29], 1
  s_nop 0
  v_mfma_f32_16x16x32_bf16 v[160:163], v[36:39], v[68:71], v[160:163]
  v_mfma_f32_16x16x32_bf16 v[164:167], v[36:39], v[84:87], v[164:167]
  v_mfma_f32_16x16x32_bf16 v[168:171], v[36:39], v[100:103], v[168:171]
  v_mfma_f32_16x16x32_bf16 v[172:175], v[36:39], v[116:119], v[172:175]
  v_mfma_f32_16x16x32_bf16 v[176:179], v[36:39], v[132:135], v[176:179]
  v_mfma_f32_16x16x32_bf16 v[180:183], v[36:39], v[148:151], v[180:183]
  v_cndmask_b32 v40, 0, v16, s[28:29]
  v_cndmask_b32 v41, 0, v17, s[28:29]
  v_cndmask_b32 v42, 0, v18, s[28:29]
  v_cndmask_b32 v43, 0, v19, s[28:29]
  s_lshl_b64 s[28:29], s[28:29], 1
  s_nop 0
  v_mfma_f32_16x16x32_bf16 v[160:163], v[40:43], v[72:75], v[160:163]
  v_mfma_f32_16x16x32_bf16 v[164:167], v[40:43], v[88:91], v[164:167]
  v_mfma_f32_16x16x32_bf16 v[168:171], v[40:43], v[104:107], v[168:171]
  v_mfma_f32_16x16x32_bf16 v[172:175], v[40:43], v[120:123], v[172:175]
  v_mfma_f32_16x16x32_bf16 v[176:179], v[40:43], v[136:139], v[176:179]
  v_mfma_f32_16x16x32_bf16 v[180:183], v[40:43], v[152:155], v[180:183]
  v_cndmask_b32 v44, 0, v16, s[28:29]
  v_cndmask_b32 v45, 0, v17, s[28:29]
  v_cndmask_b32 v46, 0, v18, s[28:29]
  v_cndmask_b32 v47, 0, v19, s[28:29]
  s_lshl_b64 s[28:29], s[28:29], 1
  s_nop 0
  v_mfma_f32_16x16x32_bf16 v[160:163], v[44:47], v[76:79], v[160:163]
  v_mfma_f32_16x16x32_bf16 v[164:167], v[44:47], v[92:95], v[164:167]
  v_mfma_f32_16x16x32_bf16 v[168:171], v[44:47], v[108:111], v[168:171]
  v_mfma_f32_16x16x32_bf16 v[172:175], v[44:47], v[124:127], v[172:175]
  v_mfma_f32_16x16x32_bf16 v[176:179], v[44:47], v[140:143], v[176:179]
  v_mfma_f32_16x16x32_bf16 v[180:183], v[44:47], v[156:159], v[180:183]
  v_add_f32 v56, v56, v28
  v_add_f32 v57, v57, v29
  v_add_f32 v58, v58, v30
  v_add_f32 v59, v59, v31
  v_add_f32 v20, v56, v57
  v_mul_f32 v22, v56, v56
  v_add_f32 v21, v58, v59
  v_fmac_f32 v22, v57, v57
  v_add_f32 v20, v20, v21
  v_fmac_f32 v22, v58, v58
  v_fmac_f32 v22, v59, v59
  v_or_b32 v28, 1, v28
  v_or_b32 v30, 1, v30
  v_add_f32 v20, v20, v20 row_ror:8 row_mask:0xf bank_mask:0xf
  v_add_f32 v22, v22, v22 row_ror:8 row_mask:0xf bank_mask:0xf
  v_lshlrev_b32 v11, 4, v12
  v_add_f32 v20, v20, v20 row_bcast:15 row_mask:0xa bank_mask:0xf
  v_add_f32 v22, v22, v22 row_bcast:15 row_mask:0xa bank_mask:0xf
  s_mov_b32 exec_lo, 0x01010101
  s_mov_b32 exec_hi, 0x01010101
  buffer_store_dwordx4 v[28:31], v11, s[4:7], s26 offen offset:768 sc1
  buffer_store_dwordx4 v[28:31], v11, s[4:7], s25 offen offset:768 sc1
  s_mov_b64 exec, -1
  v_add_f32 v20, v20, v20 row_bcast:31 row_mask:0xc bank_mask:0xf
  v_add_f32 v22, v22, v22 row_bcast:31 row_mask:0xc bank_mask:0xf
  v_or_b32 v20, 1, v20
  v_or_b32 v22, 1, v22
  s_mov_b32 exec_lo, 0
  s_mov_b32 exec_hi, 0x80000000
  buffer_store_dwordx4 v[20:23], v4, s[4:7], s26 offen offset:896 sc1
  buffer_store_dwordx4 v[20:23], v4, s[4:7], s25 offen offset:896 sc1
  s_mov_b64 exec, 0xffff
  v_or_b32 v160, 1, v160
  v_or_b32 v162, 1, v162
  buffer_store_dwordx4 v[160:163], v3, s[4:7], s26 offen offset:0 sc1
  v_or_b32 v164, 1, v164
  v_or_b32 v166, 1, v166
  buffer_store_dwordx4 v[164:167], v3, s[4:7], s25 offen offset:0 sc1
  v_or_b32 v168, 1, v168
  v_or_b32 v170, 1, v170
  buffer_store_dwordx4 v[168:171], v3, s[4:7], s26 offen offset:256 sc1
  v_or_b32 v172, 1, v172
  v_or_b32 v174, 1, v174
  buffer_store_dwordx4 v[172:175], v3, s[4:7], s25 offen offset:256 sc1
  v_or_b32 v176, 1, v176
  v_or_b32 v178, 1, v178
  buffer_store_dwordx4 v[176:179], v3, s[4:7], s26 offen offset:512 sc1
  v_or_b32 v180, 1, v180
  v_or_b32 v182, 1, v182
  buffer_store_dwordx4 v[180:183], v3, s[4:7], s25 offen offset:512 sc1
  s_mov_b64 exec, -1
  s_cmp_eq_u32 s79, 0
  s_cbranch_scc1 .g2_kernel_c_no
  s_lshl_b32 s20, s18, 15
  s_add_u32 s20, s20, 0x1190000
  s_lshl_b32 s22, s18, 11
  s_add_u32 s22, s22, s20
  v_rcp_f32 v16, v60
  v_lshlrev_b32 v17, 1, v2
  v_sub_u32 v17, s79, v17
  v_cmp_eq_u32 s[34:35], 1, v17
  v_cmp_eq_u32 s[36:37], 2, v17
  s_nop 0
  v_cndmask_b32 v18, 0, v16, s[34:35]
  v_cndmask_b32 v19, 0, v16, s[36:37]
  s_sleep 8
  s_mov_b32 s38, 0
  s_bfm_b64 exec, 57, 0
.g2_kernel_gx47:
  s_mov_b32 s21, s20
  buffer_load_dwordx4 v[64:67], v3, s[4:7], s21 offen offset:0 sc1
  buffer_load_dwordx4 v[68:71], v3, s[4:7], s21 offen offset:1024 sc1
  buffer_load_dwordx4 v[72:75], v3, s[4:7], s21 offen offset:2048 sc1
  buffer_load_dwordx4 v[76:79], v3, s[4:7], s21 offen offset:3072 sc1
  s_add_u32 s21, s21, 4096
  buffer_load_dwordx4 v[80:83], v3, s[4:7], s21 offen offset:0 sc1
  buffer_load_dwordx4 v[84:87], v3, s[4:7], s21 offen offset:1024 sc1
  buffer_load_dwordx4 v[88:91], v3, s[4:7], s21 offen offset:2048 sc1
  buffer_load_dwordx4 v[92:95], v3, s[4:7], s21 offen offset:3072 sc1
  s_add_u32 s21, s21, 4096
  buffer_load_dwordx4 v[96:99], v3, s[4:7], s21 offen offset:0 sc1
  buffer_load_dwordx4 v[100:103], v3, s[4:7], s21 offen offset:1024 sc1
  buffer_load_dwordx4 v[104:107], v3, s[4:7], s21 offen offset:2048 sc1
  buffer_load_dwordx4 v[108:111], v3, s[4:7], s21 offen offset:3072 sc1
  s_add_u32 s21, s21, 4096
  buffer_load_dwordx4 v[112:115], v3, s[4:7], s21 offen offset:0 sc1
  buffer_load_dwordx4 v[116:119], v3, s[4:7], s21 offen offset:1024 sc1
  buffer_load_dwordx4 v[120:123], v3, s[4:7], s21 offen offset:2048 sc1
  buffer_load_dwordx4 v[124:127], v3, s[4:7], s21 offen offset:3072 sc1
  s_add_u32 s21, s21, 4096
  buffer_load_dwordx4 v[128:131], v3, s[4:7], s21 offen offset:0 sc1
  buffer_load_dwordx4 v[132:135], v3, s[4:7], s21 offen offset:1024 sc1
  buffer_load_dwordx4 v[136:139], v3, s[4:7], s21 offen offset:2048 sc1
  buffer_load_dwordx4 v[140:143], v3, s[4:7], s21 offen offset:3072 sc1
  s_add_u32 s21, s21, 4096
  buffer_load_dwordx4 v[144:147], v3, s[4:7], s21 offen offset:0 sc1
  buffer_load_dwordx4 v[148:151], v3, s[4:7], s21 offen offset:1024 sc1
  buffer_load_dwordx4 v[152:155], v3, s[4:7], s21 offen offset:2048 sc1
  buffer_load_dwordx4 v[156:159], v3, s[4:7], s21 offen offset:3072 sc1
  s_add_u32 s21, s21, 4096
  buffer_load_dwordx4 v[160:163], v3, s[4:7], s21 offen offset:0 sc1
  buffer_load_dwordx4 v[164:167], v3, s[4:7], s21 offen offset:1024 sc1
  buffer_load_dwordx4 v[168:171], v3, s[4:7], s21 offen offset:2048 sc1
  buffer_load_dwordx4 v[172:175], v3, s[4:7], s21 offen offset:3072 sc1
  s_add_u32 s21, s21, 4096
  buffer_load_dwordx4 v[176:179], v3, s[4:7], s21 offen offset:0 sc1
  buffer_load_dwordx4 v[180:183], v3, s[4:7], s21 offen offset:1024 sc1
  buffer_load_dwordx4 v[184:187], v3, s[4:7], s21 offen offset:2048 sc1
  buffer_load_dwordx4 v[188:191], v3, s[4:7], s21 offen offset:3072 sc1
  s_add_u32 s21, s21, 4096
  buffer_load_dwordx4 v[192:195], v3, s[4:7], s22 offen offset:0 sc1
  buffer_load_dwordx4 v[196:199], v3, s[4:7], s22 offen offset:1024 sc1
  s_add_u32 s38, s38, 1
  s_waitcnt vmcnt(0)
  v_min3_u32 v6, v64, v66, v68
  v_min3_u32 v6, v6, v70, v72
  v_min3_u32 v6, v6, v74, v76
  v_min3_u32 v6, v6, v78, v80
  v_min3_u32 v6, v6, v82, v84
  v_min3_u32 v6, v6, v86, v88
  v_min3_u32 v6, v6, v90, v92
  v_min3_u32 v6, v6, v94, v96
  v_min3_u32 v6, v6, v98, v100
  v_min3_u32 v6, v6, v102, v104
  v_min3_u32 v6, v6, v106, v108
  v_min3_u32 v6, v6, v110, v112
  v_min3_u32 v6, v6, v114, v116
  v_min3_u32 v6, v6, v118, v120
  v_min3_u32 v6, v6, v122, v124
  v_min3_u32 v6, v6, v126, v128
  v_min3_u32 v6, v6, v130, v132
  v_min3_u32 v6, v6, v134, v136
  v_min3_u32 v6, v6, v138, v140
  v_min3_u32 v6, v6, v142, v144
  v_min3_u32 v6, v6, v146, v148
  v_min3_u32 v6, v6, v150, v152
  v_min3_u32 v6, v6, v154, v156
  v_min3_u32 v6, v6, v158, v160
  v_min3_u32 v6, v6, v162, v164
  v_min3_u32 v6, v6, v166, v168
  v_min3_u32 v6, v6, v170, v172
  v_min3_u32 v6, v6, v174, v176
  v_min3_u32 v6, v6, v178, v180
  v_min3_u32 v6, v6, v182, v184
  v_min3_u32 v6, v6, v186, v188
  v_min3_u32 v6, v6, v190, v192
  v_min3_u32 v6, v6, v194, v196
  v_min_u32 v6, v6, v198
  v_cmp_eq_u32 vcc, 0, v6
  s_cbranch_vccz .g2_kernel_gx47d
  s_mov_b64 exec, vcc
  s_sleep 12
  s_cmp_lt_u32 s38, 131072
  s_cbranch_scc1 .g2_kernel_gx47
.g2_kernel_gx47d:
  s_mov_b64 exec, -1
  v_add_f32 v64, v64, v128
  v_add_f32 v65, v65, v129
  v_add_f32 v66, v66, v130
  v_add_f32 v67, v67, v131
  v_add_f32 v68, v68, v132
  v_add_f32 v69, v69, v133
  v_add_f32 v70, v70, v134
  v_add_f32 v71, v71, v135
  v_add_f32 v72, v72, v136
  v_add_f32 v73, v73, v137
  v_add_f32 v74, v74, v138
  v_add_f32 v75, v75, v139
  v_add_f32 v76, v76, v140
  v_add_f32 v77, v77, v141
  v_add_f32 v78, v78, v142
  v_add_f32 v79, v79, v143
  v_add_f32 v80, v80, v144
  v_add_f32 v81, v81, v145
  v_add_f32 v82, v82, v146
  v_add_f32 v83, v83, v147
  v_add_f32 v84, v84, v148
  v_add_f32 v85, v85, v149
  v_add_f32 v86, v86, v150
  v_add_f32 v87, v87, v151
  v_add_f32 v88, v88, v152
  v_add_f32 v89, v89, v153
  v_add_f32 v90, v90, v154
  v_add_f32 v91, v91, v155
  v_add_f32 v92, v92, v156
  v_add_f32 v93, v93, v157
  v_add_f32 v94, v94, v158
  v_add_f32 v95, v95, v159
  v_add_f32 v96, v96, v160
  v_add_f32 v97, v97, v161
  v_add_f32 v98, v98, v162
  v_add_f32 v99, v99, v163
  v_add_f32 v100, v100, v164
  v_add_f32 v101, v101, v165
  v_add_f32 v102, v102, v166
  v_add_f32 v103, v103, v167
  v_add_f32 v104, v104, v168
  v_add_f32 v105, v105, v169
  v_add_f32 v106, v106, v170
  v_add_f32 v107, v107, v171
  v_add_f32 v108, v108, v172
  v_add_f32 v109, v109, v173
  v_add_f32 v110, v110, v174
  v_add_f32 v111, v111, v175
  v_add_f32 v112, v112, v176
  v_add_f32 v113, v113, v177
  v_add_f32 v114, v114, v178
  v_add_f32 v115, v115, v179
  v_add_f32 v116, v116, v180
  v_add_f32 v117, v117, v181
  v_add_f32 v118, v118, v182
  v_add_f32 v119, v119, v183
  v_add_f32 v120, v120, v184
  v_add_f32 v121, v121, v185
  v_add_f32 v122, v122, v186
  v_add_f32 v123, v123, v187
  v_add_f32 v124, v124, v188
  v_add_f32 v125, v125, v189
  v_add_f32 v126, v126, v190
  v_add_f32 v127, v127, v191
  v_add_f32 v64, v64, v96
  v_add_f32 v65, v65, v97
  v_add_f32 v66, v66, v98
  v_add_f32 v67, v67, v99
  v_add_f32 v68, v68, v100
  v_add_f32 v69, v69, v101
  v_add_f32 v70, v70, v102
  v_add_f32 v71, v71, v103
  v_add_f32 v72, v72, v104
  v_add_f32 v73, v73, v105
  v_add_f32 v74, v74, v106
  v_add_f32 v75, v75, v107
  v_add_f32 v76, v76, v108
  v_add_f32 v77, v77, v109
  v_add_f32 v78, v78, v110
  v_add_f32 v79, v79, v111
  v_add_f32 v80, v80, v112
  v_add_f32 v81, v81, v113
  v_add_f32 v82, v82, v114
  v_add_f32 v83, v83, v115
  v_add_f32 v84, v84, v116
  v_add_f32 v85, v85, v117
  v_add_f32 v86, v86, v118
  v_add_f32 v87, v87, v119
  v_add_f32 v88, v88, v120
  v_add_f32 v89, v89, v121
  v_add_f32 v90, v90, v122
  v_add_f32 v91, v91, v123
  v_add_f32 v92, v92, v124
  v_add_f32 v93, v93, v125
  v_add_f32 v94, v94, v126
  v_add_f32 v95, v95, v127
  v_add_f32 v64, v64, v80
  v_add_f32 v65, v65, v81
  v_add_f32 v66, v66, v82
  v_add_f32 v67, v67, v83
  v_add_f32 v68, v68, v84
  v_add_f32 v69, v69, v85
  v_add_f32 v70, v70, v86
  v_add_f32 v71, v71, v87
  v_add_f32 v72, v72, v88
  v_add_f32 v73, v73, v89
  v_add_f32 v74, v74, v90
  v_add_f32 v75, v75, v91
  v_add_f32 v76, v76, v92
  v_add_f32 v77, v77, v93
  v_add_f32 v78, v78, v94
  v_add_f32 v79, v79, v95
  v_add_f32 v64, v64, v72
  v_add_f32 v65, v65, v73
  v_add_f32 v66, v66, v74
  v_add_f32 v67, v67, v75
  v_add_f32 v68, v68, v76
  v_add_f32 v69, v69, v77
  v_add_f32 v70, v70, v78
  v_add_f32 v71, v71, v79
  v_add_f32 v64, v64, v68
  v_add_f32 v65, v65, v69
  v_add_f32 v66, v66, v70
  v_add_f32 v67, v67, v71
  v_mov_b32 v28, 0.0009765625
  v_mov_b32 v30, 1e-05
  v_readlane_b32 s21, v64, 56
  v_readlane_b32 s22, v66, 56
  s_nop 0
  v_mul_f32 v20, s21, v28
  v_fma_f32 v21, s22, v28, v30
  v_fma_f32 v21, -v20, v20, v21
  v_rsq_f32 v21, abs(v21)
  v_sub_f32 v20, v61, v20
  v_mul_f32 v22, v21, v60
  v_mul_f32 v23, v21, v20
  v_cndmask_b32 v48, v48, v22, s[34:35]
  v_cndmask_b32 v49, v49, v22, s[36:37]
  v_cndmask_b32 v50, v50, v23, s[34:35]
  v_cndmask_b32 v51, v51, v23, s[36:37]
.g2_kernel_c_no:
  s_mov_b32 s62, 1
  s_mov_b32 s63, 0x1800000
  s_mov_b32 s70, 2
  s_mov_b32 s71, 155776
  v_mov_b32 v6, 155648
  s_mov_b32 s38, 0
.g2_kernel_wg48:
  ds_read_b32 v7, v6 offset:512
  s_add_u32 s38, s38, 1
  s_waitcnt lgkmcnt(0)
  v_cmp_le_u32 vcc, 64, v7
  s_cbranch_vccnz .g2_kernel_wg48d
  s_sleep 2
  s_cmp_lt_u32 s38, 524288
  s_cbranch_scc1 .g2_kernel_wg48
.g2_kernel_wg48d:
  v_mov_b32 v9, s71
  ds_write_b64 v14, v[48:49] offset:2816
  ds_write_b64 v14, v[50:51] offset:3328
  ds_write_b64 v14, v[52:53] offset:3840
  ds_write_b64 v14, v[54:55] offset:4352
  s_cmp_eq_u32 s79, 0
  s_cbranch_scc1 .g2_kernel_c_no2
  ds_write_b32 v9, v15 offset:24
  ds_write_b64 v14, v[18:19] offset:5632
  v_and_b32 v10, 15, v2
  v_lshrrev_b32 v11, 4, v2
  v_lshlrev_b32 v10, 2, v10
  v_lshl_add_u32 v10, v11, 8, v10
  v_add_u32 v10, 155648, v10
  s_mov_b32 exec_hi, 0xffff
  ds_write_b32 v10, v64 offset:6144
  ds_write_b32 v10, v65 offset:6208
  ds_write_b32 v10, v66 offset:6272
  ds_write_b32 v10, v67 offset:6336
  s_mov_b32 exec_lo, 0
  s_mov_b32 exec_hi, 0xff0000
  ds_write_b32 v10, v192 offset:6912
  ds_write_b32 v10, v193 offset:6976
  ds_write_b32 v10, v194 offset:7040
  ds_write_b32 v10, v195 offset:7104
  ds_write_b32 v10, v196 offset:6944
  ds_write_b32 v10, v197 offset:7008
  ds_write_b32 v10, v198 offset:7072
  ds_write_b32 v10, v199 offset:7136
  s_mov_b64 exec, -1
.g2_kernel_c_no2:
  v_mov_b32 v8, 2
  ds_write_b32 v9, v8 offset:0
  s_branch .g2_kernel_v
.g2_kernel_c_t3:
  s_mov_b32 s28, s56
  s_mov_b32 s29, s57
  s_mov_b32 s30, 0x400000
  s_mov_b32 s31, 0x00020000
  v_add_f32 v56, v56, v28
  v_add_f32 v57, v57, v29
  v_add_f32 v58, v58, v30
  v_add_f32 v59, v59, v31
  v_cvt_pk_bf16_f32 v56, v56, v57
  v_cvt_pk_bf16_f32 v58, v58, v59
  s_lshl_b32 s21, s77, 11
  s_lshl_b32 s22, s17, 7
  s_add_u32 s21, s21, s22
  s_lshl_b32 s22, s18, 4
  s_add_u32 s21, s21, s22
  s_mov_b32 exec_lo, 0x01010101
  s_mov_b32 exec_hi, 0x01010101
  buffer_store_short v56, v13, s[28:31], s21 offen
  buffer_store_short_d16_hi v56, v13, s[28:31], s21 offen offset:32
  buffer_store_short v58, v13, s[28:31], s21 offen offset:64
  buffer_store_short_d16_hi v58, v13, s[28:31], s21 offen offset:96
  s_mov_b64 exec, -1
  s_branch .g2_kernel_fin
.g2_kernel_c2:
  s_cmp_lg_u32 s62, 0
  s_cbranch_scc1 .g2_kernel_d_a
  s_cmp_lg_u32 s16, 7
  s_cbranch_scc1 .g2_kernel_d_a
  v_mov_b32 v6, s71
  s_mov_b32 s38, 0
.g2_kernel_wg50:
  ds_read_b32 v7, v6 offset:20
  s_add_u32 s38, s38, 1
  s_waitcnt lgkmcnt(0)
  v_cmp_le_u32 vcc, 4, v7
  s_cbranch_vccnz .g2_kernel_wg50d
  s_sleep 2
  s_cmp_lt_u32 s38, 524288
  s_cbranch_scc1 .g2_kernel_wg50
.g2_kernel_wg50d:
  s_sleep 12
  s_and_b32 s31, s19, 0xffffe000
  s_add_u32 s31, s31, 8
  v_and_b32 v6, 15, v2
  v_lshlrev_b32 v6, 9, v6
  v_lshrrev_b32 v7, 4, v2
  v_lshl_add_u32 v6, v7, 7, v6
  v_lshlrev_b32 v7, 2, v2
  v_add_u32 v7, 158208, v7
  s_mov_b32 m0, 158208
  s_mov_b32 s38, 0
.g2_kernel_pa51:
  buffer_load_dword v6, s[4:7], s31 offen sc1 lds
  s_add_u32 s38, s38, 1
  s_waitcnt vmcnt(0)
  ds_read_b32 v8, v7
  s_waitcnt lgkmcnt(0)
  v_cmp_ge_u32 vcc, s62, v8
  s_cbranch_vccz .g2_kernel_pa51d
  s_mov_b64 exec, vcc
  s_sleep 6
  s_cmp_lt_u32 s38, 131072
  s_cbranch_scc1 .g2_kernel_pa51
.g2_kernel_pa51d:
  s_mov_b64 exec, -1
.g2_kernel_d_a:
  s_setprio 2
  s_and_b32 s20, s16, 1
  v_bfe_u32 v8, v2, 1, 3
  v_lshlrev_b32 v8, 14, v8
  v_and_b32 v9, 1, v2
  v_lshl_add_u32 v8, v9, 10, v8
  v_lshrrev_b32 v9, 4, v2
  v_lshl_add_u32 v8, v9, 8, v8
  v_and_b32 v9, 15, v2
  v_lshlrev_b32 v9, 3, v9
  s_lshl_b32 s28, s20, 7
  s_add_u32 s28, s28, 162560
  v_add_u32 v10, s28, v9
  v_xor_b32 v11, 128, v10
  s_lshl_b32 s28, s20, 2
  s_add_u32 s28, s28, s71
  v_mov_b32 v12, s28
  v_xor_b32 v13, 4, v12
  s_lshl_b32 s26, s17, 4
  s_add_u32 s26, s26, s18
  s_lshl_b32 s26, s26, 1
  s_add_u32 s26, s26, s20
  s_lshl_b32 s26, s26, 11
  s_add_u32 s26, s26, s63
  s_add_u32 s26, s26, 0x1090000
  v_mov_b32 v6, s71
  s_mov_b32 s38, 0
.g2_kernel_wg52:
  ds_read_b32 v7, v6 offset:36
  s_add_u32 s38, s38, 1
  s_waitcnt lgkmcnt(0)
  v_cmp_le_u32 vcc, 1, v7
  s_cbranch_vccnz .g2_kernel_wg52d
  s_sleep 4
  s_cmp_lt_u32 s38, 524288
  s_cbranch_scc1 .g2_kernel_wg52
.g2_kernel_wg52d:
  s_cmp_ge_u32 s17, 14
  s_cbranch_scc1 .g2_kernel_d_none
  v_readfirstlane_b32 s77, v7
  s_sub_u32 s77, s77, 1
  s_and_b32 s77, s77, 2047
  s_lshr_b32 s24, s77, 7
  s_lshl_b32 s24, s24, 18
  s_bfe_u32 s28, s77, 0x30004
  s_lshl_b32 s28, s28, 11
  s_add_u32 s24, s24, s28
  s_and_b32 s28, s77, 15
  s_lshl_b32 s28, s28, 4
  s_add_u32 s24, s24, s28
  s_add_u32 s24, s24, s63
  s_add_u32 s24, s24, 0xc00000
  s_lshl_b32 s28, s20, 17
  s_add_u32 s24, s24, s28
  buffer_load_dwordx4 v[16:19], v8, s[4:7], s24 offen
  s_lshl_b32 s25, s77, 3
  s_add_u32 s25, s25, s63
  s_add_u32 s25, s25, 0x1080000
  s_mov_b32 s38, 0
.g2_kernel_gx53:
  buffer_load_dwordx2 v[20:21], v4, s[4:7], s25 offen sc1
  s_add_u32 s38, s38, 1
  s_waitcnt vmcnt(0)
  v_min_u32 v6, v21, v21
  v_cmp_eq_u32 vcc, 0, v6
  s_cbranch_vccz .g2_kernel_gx53d
  s_mov_b64 exec, vcc
  s_sleep 1
  s_cmp_lt_u32 s38, 131072
  s_cbranch_scc1 .g2_kernel_gx53
.g2_kernel_gx53d:
  s_mov_b64 exec, -1
  v_rsq_f32 v21, v21
  v_lshlrev_b32 v24, 16, v16
  v_and_b32 v25, 0xffff0000, v16
  v_lshlrev_b32 v26, 16, v17
  v_and_b32 v27, 0xffff0000, v17
  v_lshlrev_b32 v28, 16, v18
  v_and_b32 v29, 0xffff0000, v18
  v_lshlrev_b32 v30, 16, v19
  v_and_b32 v31, 0xffff0000, v19
  v_mul_f32 v20, v20, v21
  v_fma_f32 v24, v24, v21, -v20
  v_fma_f32 v25, v25, v21, -v20
  v_fma_f32 v26, v26, v21, -v20
  v_fma_f32 v27, v27, v21, -v20
  v_fma_f32 v28, v28, v21, -v20
  v_fma_f32 v29, v29, v21, -v20
  v_fma_f32 v30, v30, v21, -v20
  v_fma_f32 v31, v31, v21, -v20
  v_cvt_pk_bf16_f32 v16, v24, v25
  v_cvt_pk_bf16_f32 v17, v26, v27
  v_cvt_pk_bf16_f32 v18, v28, v29
  v_cvt_pk_bf16_f32 v19, v30, v31
  v_mov_b32 v24, v16 row_newbcast:0 row_mask:0xf bank_mask:0xf
  v_mov_b32 v25, v17 row_newbcast:0 row_mask:0xf bank_mask:0xf
  v_mov_b32 v26, v18 row_newbcast:0 row_mask:0xf bank_mask:0xf
  v_mov_b32 v27, v19 row_newbcast:0 row_mask:0xf bank_mask:0xf
  v_mov_b32 v28, v16 row_newbcast:1 row_mask:0xf bank_mask:0xf
  v_mov_b32 v29, v17 row_newbcast:1 row_mask:0xf bank_mask:0xf
  v_mov_b32 v30, v18 row_newbcast:1 row_mask:0xf bank_mask:0xf
  v_mov_b32 v31, v19 row_newbcast:1 row_mask:0xf bank_mask:0xf
  v_mfma_f32_16x16x32_bf16 v[32:35], v[24:27], v[64:67], 0
  v_mfma_f32_16x16x32_bf16 v[36:39], v[24:27], v[128:131], 0
  v_mov_b32 v24, v16 row_newbcast:2 row_mask:0xf bank_mask:0xf
  v_mov_b32 v25, v17 row_newbcast:2 row_mask:0xf bank_mask:0xf
  v_mov_b32 v26, v18 row_newbcast:2 row_mask:0xf bank_mask:0xf
  v_mov_b32 v27, v19 row_newbcast:2 row_mask:0xf bank_mask:0xf
  v_mfma_f32_16x16x32_bf16 v[32:35], v[28:31], v[68:71], v[32:35]
  v_mfma_f32_16x16x32_bf16 v[36:39], v[28:31], v[132:135], v[36:39]
  v_mov_b32 v28, v16 row_newbcast:3 row_mask:0xf bank_mask:0xf
  v_mov_b32 v29, v17 row_newbcast:3 row_mask:0xf bank_mask:0xf
  v_mov_b32 v30, v18 row_newbcast:3 row_mask:0xf bank_mask:0xf
  v_mov_b32 v31, v19 row_newbcast:3 row_mask:0xf bank_mask:0xf
  v_mfma_f32_16x16x32_bf16 v[32:35], v[24:27], v[72:75], v[32:35]
  v_mfma_f32_16x16x32_bf16 v[36:39], v[24:27], v[136:139], v[36:39]
  v_mov_b32 v24, v16 row_newbcast:4 row_mask:0xf bank_mask:0xf
  v_mov_b32 v25, v17 row_newbcast:4 row_mask:0xf bank_mask:0xf
  v_mov_b32 v26, v18 row_newbcast:4 row_mask:0xf bank_mask:0xf
  v_mov_b32 v27, v19 row_newbcast:4 row_mask:0xf bank_mask:0xf
  v_mfma_f32_16x16x32_bf16 v[32:35], v[28:31], v[76:79], v[32:35]
  v_mfma_f32_16x16x32_bf16 v[36:39], v[28:31], v[140:143], v[36:39]
  v_mov_b32 v28, v16 row_newbcast:5 row_mask:0xf bank_mask:0xf
  v_mov_b32 v29, v17 row_newbcast:5 row_mask:0xf bank_mask:0xf
  v_mov_b32 v30, v18 row_newbcast:5 row_mask:0xf bank_mask:0xf
  v_mov_b32 v31, v19 row_newbcast:5 row_mask:0xf bank_mask:0xf
  v_mfma_f32_16x16x32_bf16 v[32:35], v[24:27], v[80:83], v[32:35]
  v_mfma_f32_16x16x32_bf16 v[36:39], v[24:27], v[144:147], v[36:39]
  v_mov_b32 v24, v16 row_newbcast:6 row_mask:0xf bank_mask:0xf
  v_mov_b32 v25, v17 row_newbcast:6 row_mask:0xf bank_mask:0xf
  v_mov_b32 v26, v18 row_newbcast:6 row_mask:0xf bank_mask:0xf
  v_mov_b32 v27, v19 row_newbcast:6 row_mask:0xf bank_mask:0xf
  v_mfma_f32_16x16x32_bf16 v[32:35], v[28:31], v[84:87], v[32:35]
  v_mfma_f32_16x16x32_bf16 v[36:39], v[28:31], v[148:151], v[36:39]
  v_mov_b32 v28, v16 row_newbcast:7 row_mask:0xf bank_mask:0xf
  v_mov_b32 v29, v17 row_newbcast:7 row_mask:0xf bank_mask:0xf
  v_mov_b32 v30, v18 row_newbcast:7 row_mask:0xf bank_mask:0xf
  v_mov_b32 v31, v19 row_newbcast:7 row_mask:0xf bank_mask:0xf
  v_mfma_f32_16x16x32_bf16 v[32:35], v[24:27], v[88:91], v[32:35]
  v_mfma_f32_16x16x32_bf16 v[36:39], v[24:27], v[152:155], v[36:39]
  v_mov_b32 v24, v16 row_newbcast:8 row_mask:0xf bank_mask:0xf
  v_mov_b32 v25, v17 row_newbcast:8 row_mask:0xf bank_mask:0xf
  v_mov_b32 v26, v18 row_newbcast:8 row_mask:0xf bank_mask:0xf
  v_mov_b32 v27, v19 row_newbcast:8 row_mask:0xf bank_mask:0xf
  v_mfma_f32_16x16x32_bf16 v[32:35], v[28:31], v[92:95], v[32:35]
  v_mfma_f32_16x16x32_bf16 v[36:39], v[28:31], v[156:159], v[36:39]
  v_mov_b32 v28, v16 row_newbcast:9 row_mask:0xf bank_mask:0xf
  v_mov_b32 v29, v17 row_newbcast:9 row_mask:0xf bank_mask:0xf
  v_mov_b32 v30, v18 row_newbcast:9 row_mask:0xf bank_mask:0xf
  v_mov_b32 v31, v19 row_newbcast:9 row_mask:0xf bank_mask:0xf
  v_mfma_f32_16x16x32_bf16 v[32:35], v[24:27], v[96:99], v[32:35]
  v_mfma_f32_16x16x32_bf16 v[36:39], v[24:27], v[160:163], v[36:39]
  v_mov_b32 v24, v16 row_newbcast:10 row_mask:0xf bank_mask:0xf
  v_mov_b32 v25, v17 row_newbcast:10 row_mask:0xf bank_mask:0xf
  v_mov_b32 v26, v18 row_newbcast:10 row_mask:0xf bank_mask:0xf
  v_mov_b32 v27, v19 row_newbcast:10 row_mask:0xf bank_mask:0xf
  v_mfma_f32_16x16x32_bf16 v[32:35], v[28:31], v[100:103], v[32:35]
  v_mfma_f32_16x16x32_bf16 v[36:39], v[28:31], v[164:167], v[36:39]
  v_mov_b32 v28, v16 row_newbcast:11 row_mask:0xf bank_mask:0xf
  v_mov_b32 v29, v17 row_newbcast:11 row_mask:0xf bank_mask:0xf
  v_mov_b32 v30, v18 row_newbcast:11 row_mask:0xf bank_mask:0xf
  v_mov_b32 v31, v19 row_newbcast:11 row_mask:0xf bank_mask:0xf
  v_mfma_f32_16x16x32_bf16 v[32:35], v[24:27], v[104:107], v[32:35]
  v_mfma_f32_16x16x32_bf16 v[36:39], v[24:27], v[168:171], v[36:39]
  v_mov_b32 v24, v16 row_newbcast:12 row_mask:0xf bank_mask:0xf
  v_mov_b32 v25, v17 row_newbcast:12 row_mask:0xf bank_mask:0xf
  v_mov_b32 v26, v18 row_newbcast:12 row_mask:0xf bank_mask:0xf
  v_mov_b32 v27, v19 row_newbcast:12 row_mask:0xf bank_mask:0xf
  v_mfma_f32_16x16x32_bf16 v[32:35], v[28:31], v[108:111], v[32:35]
  v_mfma_f32_16x16x32_bf16 v[36:39], v[28:31], v[172:175], v[36:39]
  v_mov_b32 v28, v16 row_newbcast:13 row_mask:0xf bank_mask:0xf
  v_mov_b32 v29, v17 row_newbcast:13 row_mask:0xf bank_mask:0xf
  v_mov_b32 v30, v18 row_newbcast:13 row_mask:0xf bank_mask:0xf
  v_mov_b32 v31, v19 row_newbcast:13 row_mask:0xf bank_mask:0xf
  v_mfma_f32_16x16x32_bf16 v[32:35], v[24:27], v[112:115], v[32:35]
  v_mfma_f32_16x16x32_bf16 v[36:39], v[24:27], v[176:179], v[36:39]
  v_mov_b32 v24, v16 row_newbcast:14 row_mask:0xf bank_mask:0xf
  v_mov_b32 v25, v17 row_newbcast:14 row_mask:0xf bank_mask:0xf
  v_mov_b32 v26, v18 row_newbcast:14 row_mask:0xf bank_mask:0xf
  v_mov_b32 v27, v19 row_newbcast:14 row_mask:0xf bank_mask:0xf
  v_mfma_f32_16x16x32_bf16 v[32:35], v[28:31], v[116:119], v[32:35]
  v_mfma_f32_16x16x32_bf16 v[36:39], v[28:31], v[180:183], v[36:39]
  v_mov_b32 v28, v16 row_newbcast:15 row_mask:0xf bank_mask:0xf
  v_mov_b32 v29, v17 row_newbcast:15 row_mask:0xf bank_mask:0xf
  v_mov_b32 v30, v18 row_newbcast:15 row_mask:0xf bank_mask:0xf
  v_mov_b32 v31, v19 row_newbcast:15 row_mask:0xf bank_mask:0xf
  v_mfma_f32_16x16x32_bf16 v[32:35], v[24:27], v[120:123], v[32:35]
  v_mfma_f32_16x16x32_bf16 v[36:39], v[24:27], v[184:187], v[36:39]
  v_mfma_f32_16x16x32_bf16 v[32:35], v[28:31], v[124:127], v[32:35]
  v_mfma_f32_16x16x32_bf16 v[36:39], v[28:31], v[188:191], v[36:39]
  s_mov_b32 s38, 0
  s_mov_b32 s28, 0x00010001
  s_mov_b32 s29, 0x00100010
  s_nop 4
  v_mov_b32 v35, v36
  ds_write_b64 v10, v[34:35]
  ds_write_b32 v12, v5 offset:40
.g2_kernel_d_x:
  ds_read_b32 v6, v13 offset:40
  ds_read_b64 v[16:17], v11
  s_add_u32 s38, s38, 1
  s_waitcnt lgkmcnt(0)
  v_cmp_ne_u32 vcc, 0, v6
  s_cbranch_vccnz .g2_kernel_d_xd
  s_cmp_lt_u32 s38, 524288
  s_cbranch_scc1 .g2_kernel_d_x
.g2_kernel_d_xd:
  v_add_f32 v16, v16, v32
  v_add_f32 v17, v17, v36
  v_mul_f32 v18, -1.4426950408889634, v16
  v_exp_f32 v18, v18
  v_mul_f32 v16, v16, v17
  v_add_f32 v18, 1.0, v18
  v_rcp_f32 v18, v18
  s_nop 0
  v_mul_f32 v16, v16, v18
  s_nop 1
  v_mov_b32 v17, v16 quad_perm:[1,0,3,2] row_mask:0xf bank_mask:0xf
  v_cvt_pk_bf16_f32 v16, v16, v17
  s_nop 1
  v_mov_b32 v20, v16 row_newbcast:0 row_mask:0x5 bank_mask:0xf
  v_mov_b32 v21, v16 row_newbcast:2 row_mask:0x5 bank_mask:0xf
  v_mov_b32 v22, v16 row_newbcast:4 row_mask:0x5 bank_mask:0xf
  v_mov_b32 v23, v16 row_newbcast:6 row_mask:0x5 bank_mask:0xf
  v_mov_b32 v20, v16 row_newbcast:8 row_mask:0xa bank_mask:0xf
  v_mov_b32 v21, v16 row_newbcast:10 row_mask:0xa bank_mask:0xf
  v_mov_b32 v22, v16 row_newbcast:12 row_mask:0xa bank_mask:0xf
  v_mov_b32 v23, v16 row_newbcast:14 row_mask:0xa bank_mask:0xf
  v_cndmask_b32 v24, 0, v20, s[28:29]
  v_cndmask_b32 v25, 0, v21, s[28:29]
  v_cndmask_b32 v26, 0, v22, s[28:29]
  v_cndmask_b32 v27, 0, v23, s[28:29]
  s_lshl_b64 s[28:29], s[28:29], 1
  s_nop 0
  v_mfma_f32_16x16x32_bf16 v[40:43], v[24:27], v[192:195], 0
  v_mfma_f32_16x16x32_bf16 v[44:47], v[24:27], v[208:211], 0
  v_mfma_f32_16x16x32_bf16 v[48:51], v[24:27], v[224:227], 0
  v_mfma_f32_16x16x32_bf16 v[52:55], v[24:27], v[240:243], 0
  v_cndmask_b32 v28, 0, v20, s[28:29]
  v_cndmask_b32 v29, 0, v21, s[28:29]
  v_cndmask_b32 v30, 0, v22, s[28:29]
  v_cndmask_b32 v31, 0, v23, s[28:29]
  s_lshl_b64 s[28:29], s[28:29], 1
  s_nop 0
  v_mfma_f32_16x16x32_bf16 v[40:43], v[28:31], v[196:199], v[40:43]
  v_mfma_f32_16x16x32_bf16 v[44:47], v[28:31], v[212:215], v[44:47]
  v_mfma_f32_16x16x32_bf16 v[48:51], v[28:31], v[228:231], v[48:51]
  v_mfma_f32_16x16x32_bf16 v[52:55], v[28:31], v[244:247], v[52:55]
  v_cndmask_b32 v32, 0, v20, s[28:29]
  v_cndmask_b32 v33, 0, v21, s[28:29]
  v_cndmask_b32 v34, 0, v22, s[28:29]
  v_cndmask_b32 v35, 0, v23, s[28:29]
  s_lshl_b64 s[28:29], s[28:29], 1
  s_nop 0
  v_mfma_f32_16x16x32_bf16 v[40:43], v[32:35], v[200:203], v[40:43]
  v_mfma_f32_16x16x32_bf16 v[44:47], v[32:35], v[216:219], v[44:47]
  v_mfma_f32_16x16x32_bf16 v[48:51], v[32:35], v[232:235], v[48:51]
  v_mfma_f32_16x16x32_bf16 v[52:55], v[32:35], v[248:251], v[52:55]
  v_cndmask_b32 v36, 0, v20, s[28:29]
  v_cndmask_b32 v37, 0, v21, s[28:29]
  v_cndmask_b32 v38, 0, v22, s[28:29]
  v_cndmask_b32 v39, 0, v23, s[28:29]
  s_lshl_b64 s[28:29], s[28:29], 1
  s_nop 0
  v_mfma_f32_16x16x32_bf16 v[40:43], v[36:39], v[204:207], v[40:43]
  v_mfma_f32_16x16x32_bf16 v[44:47], v[36:39], v[220:223], v[44:47]
  v_mfma_f32_16x16x32_bf16 v[48:51], v[36:39], v[236:239], v[48:51]
  v_mfma_f32_16x16x32_bf16 v[52:55], v[36:39], v[252:255], v[52:55]
  s_mov_b32 exec_hi, 0
  s_nop 3
  v_or_b32 v40, 1, v40
  v_or_b32 v42, 1, v42
  buffer_store_dwordx4 v[40:43], v3, s[4:7], s26 offen offset:0 sc1
  v_or_b32 v44, 1, v44
  v_or_b32 v46, 1, v46
  buffer_store_dwordx4 v[44:47], v3, s[4:7], s26 offen offset:512 sc1
  v_or_b32 v48, 1, v48
  v_or_b32 v50, 1, v50
  buffer_store_dwordx4 v[48:51], v3, s[4:7], s26 offen offset:1024 sc1
  v_or_b32 v52, 1, v52
  v_or_b32 v54, 1, v54
  buffer_store_dwordx4 v[52:55], v3, s[4:7], s26 offen offset:1536 sc1
  s_mov_b64 exec, -1
  s_branch .g2_kernel_d_e
.g2_kernel_d_none:
  s_sleep 40
.g2_kernel_d_e:
  v_mov_b32 v6, s71
  s_mov_b64 exec, 1
  ds_add_u32 v6, v5 offset:48
  s_mov_b64 exec, -1
  s_cmp_lg_u32 s62, 0
  s_cbranch_scc1 .g2_kernel_fin
  s_mov_b32 s62, 1
  s_mov_b32 s63, 0x1800000
  s_mov_b32 s70, 2
  s_mov_b32 s71, 155776
  s_branch .g2_kernel_v
.g2_kernel_fin1:
.g2_kernel_fin:
.g2_kernel_end:
  s_endpgm
.g2_kernel_q_spin:
  s_mov_b32 s38, 0
.g2_kernel_q_spinl:
  ds_read_b32 v15, v14
  s_add_u32 s38, s38, 1
  s_waitcnt lgkmcnt(0)
  v_cmp_lt_i32 vcc, s33, v15
  s_cbranch_vccnz .g2_kernel_q_spinr
  s_cmp_lt_u32 s38, 524288
  s_cbranch_scc1 .g2_kernel_q_spinl
.g2_kernel_q_spinr:
  s_setpc_b64 s[68:69]
.g2_kernel_q_w7:
  s_call_b64 s[68:69], .g2_kernel_q_spin
  s_branch .g2_kernel_q_back7
.g2_kernel_q_w0:
  s_call_b64 s[68:69], .g2_kernel_q_spin
  s_branch .g2_kernel_q_back0
.g2_kernel_q_w1:
  s_call_b64 s[68:69], .g2_kernel_q_spin
  s_branch .g2_kernel_q_back1
.g2_kernel_q_w2:
  s_call_b64 s[68:69], .g2_kernel_q_spin
  s_branch .g2_kernel_q_back2
.g2_kernel_q_w3:
  s_call_b64 s[68:69], .g2_kernel_q_spin
  s_branch .g2_kernel_q_back3
.g2_kernel_q_w4:
  s_call_b64 s[68:69], .g2_kernel_q_spin
  s_branch .g2_kernel_q_back4
.g2_kernel_q_w5:
  s_call_b64 s[68:69], .g2_kernel_q_spin
  s_branch .g2_kernel_q_back5
.g2_kernel_q_w6:
  s_call_b64 s[68:69], .g2_kernel_q_spin
  s_branch .g2_kernel_q_back6
.g2_kernel_q_wf:
  s_call_b64 s[68:69], .g2_kernel_q_spin
  s_branch .g2_kernel_q_backf
.g2_kernel_q_cons2:
  s_lshr_b32 s26, s16, 1
  s_lshl_b32 s26, s26, 13
  v_add_u32 v8, s26, v3
  v_add_u32 v9, 1024, v8
  s_mov_b32 s29, 0
  s_branch .g2_kernel_q_cs
.g2_kernel_q_ew:
  s_mov_b32 s38, 0
.g2_kernel_q_ewl:
  ds_read_b32 v62, v57 offset:0
  ds_read_b32 v63, v58
  s_add_u32 s38, s38, 1
  s_waitcnt lgkmcnt(0)
  v_cmp_gt_u32 vcc, 2, v62
  v_cmp_gt_u32 s[20:21], s39, v63
  s_or_b64 vcc, vcc, s[20:21]
  s_cbranch_scc0 .g2_kernel_q_eb
  s_cmp_lt_u32 s38, 524288
  s_cbranch_scc1 .g2_kernel_q_ewl
  s_branch .g2_kernel_q_eb
.g2_kernel_q_patch:
  ds_read_b32 v64, v50 offset:5632
  ds_read_b128 v[72:75], v51 offset:5632
  ds_read_b32 v66, v50 offset:5696
  ds_read_b128 v[76:79], v51 offset:5696
  ds_read_b32 v68, v50 offset:5760
  ds_read_b128 v[80:83], v51 offset:5760
  ds_read_b32 v70, v50 offset:5824
  ds_read_b128 v[84:87], v51 offset:5824
  s_waitcnt lgkmcnt(0)
  ds_read_b128 v[88:91], v52 offset:6144
  ds_read_b128 v[92:95], v52 offset:6208
  ds_read_b128 v[96:99], v52 offset:6400
  ds_read_b128 v[100:103], v52 offset:6464
  ds_read_b32 v104, v53 offset:6656
  ds_read_b32 v106, v53 offset:6720
  s_waitcnt lgkmcnt(0)
  v_pk_fma_f32 v[160:161], v[88:89], v[64:65], v[160:161] op_sel_hi:[1,0,1]
  v_pk_fma_f32 v[162:163], v[90:91], v[64:65], v[162:163] op_sel_hi:[1,0,1]
  v_pk_fma_f32 v[164:165], v[88:89], v[66:67], v[164:165] op_sel_hi:[1,0,1]
  v_pk_fma_f32 v[166:167], v[90:91], v[66:67], v[166:167] op_sel_hi:[1,0,1]
  v_pk_fma_f32 v[168:169], v[88:89], v[68:69], v[168:169] op_sel_hi:[1,0,1]
  v_pk_fma_f32 v[170:171], v[90:91], v[68:69], v[170:171] op_sel_hi:[1,0,1]
  v_pk_fma_f32 v[172:173], v[88:89], v[70:71], v[172:173] op_sel_hi:[1,0,1]
  v_pk_fma_f32 v[174:175], v[90:91], v[70:71], v[174:175] op_sel_hi:[1,0,1]
  v_pk_fma_f32 v[176:177], v[92:93], v[64:65], v[176:177] op_sel_hi:[1,0,1]
  v_pk_fma_f32 v[178:179], v[94:95], v[64:65], v[178:179] op_sel_hi:[1,0,1]
  v_pk_fma_f32 v[180:181], v[92:93], v[66:67], v[180:181] op_sel_hi:[1,0,1]
  v_pk_fma_f32 v[182:183], v[94:95], v[66:67], v[182:183] op_sel_hi:[1,0,1]
  v_pk_fma_f32 v[184:185], v[92:93], v[68:69], v[184:185] op_sel_hi:[1,0,1]
  v_pk_fma_f32 v[186:187], v[94:95], v[68:69], v[186:187] op_sel_hi:[1,0,1]
  v_pk_fma_f32 v[188:189], v[92:93], v[70:71], v[188:189] op_sel_hi:[1,0,1]
  v_pk_fma_f32 v[190:191], v[94:95], v[70:71], v[190:191] op_sel_hi:[1,0,1]
  v_pk_fma_f32 v[192:193], v[96:97], v[64:65], v[192:193] op_sel_hi:[1,0,1]
  v_pk_fma_f32 v[194:195], v[98:99], v[64:65], v[194:195] op_sel_hi:[1,0,1]
  v_pk_fma_f32 v[196:197], v[96:97], v[66:67], v[196:197] op_sel_hi:[1,0,1]
  v_pk_fma_f32 v[198:199], v[98:99], v[66:67], v[198:199] op_sel_hi:[1,0,1]
  v_pk_fma_f32 v[200:201], v[96:97], v[68:69], v[200:201] op_sel_hi:[1,0,1]
  v_pk_fma_f32 v[202:203], v[98:99], v[68:69], v[202:203] op_sel_hi:[1,0,1]
  v_pk_fma_f32 v[204:205], v[96:97], v[70:71], v[204:205] op_sel_hi:[1,0,1]
  v_pk_fma_f32 v[206:207], v[98:99], v[70:71], v[206:207] op_sel_hi:[1,0,1]
  v_pk_fma_f32 v[208:209], v[100:101], v[64:65], v[208:209] op_sel_hi:[1,0,1]
  v_pk_fma_f32 v[210:211], v[102:103], v[64:65], v[210:211] op_sel_hi:[1,0,1]
  v_pk_fma_f32 v[212:213], v[100:101], v[66:67], v[212:213] op_sel_hi:[1,0,1]
  v_pk_fma_f32 v[214:215], v[102:103], v[66:67], v[214:215] op_sel_hi:[1,0,1]
  v_pk_fma_f32 v[216:217], v[100:101], v[68:69], v[216:217] op_sel_hi:[1,0,1]
  v_pk_fma_f32 v[218:219], v[102:103], v[68:69], v[218:219] op_sel_hi:[1,0,1]
  v_pk_fma_f32 v[220:221], v[100:101], v[70:71], v[220:221] op_sel_hi:[1,0,1]
  v_pk_fma_f32 v[222:223], v[102:103], v[70:71], v[222:223] op_sel_hi:[1,0,1]
  v_pk_fma_f32 v[224:225], v[72:73], v[104:105], v[224:225] op_sel_hi:[1,0,1]
  v_pk_fma_f32 v[226:227], v[74:75], v[104:105], v[226:227] op_sel_hi:[1,0,1]
  v_pk_fma_f32 v[228:229], v[76:77], v[104:105], v[228:229] op_sel_hi:[1,0,1]
  v_pk_fma_f32 v[230:231], v[78:79], v[104:105], v[230:231] op_sel_hi:[1,0,1]
  v_pk_fma_f32 v[232:233], v[80:81], v[104:105], v[232:233] op_sel_hi:[1,0,1]
  v_pk_fma_f32 v[234:235], v[82:83], v[104:105], v[234:235] op_sel_hi:[1,0,1]
  v_pk_fma_f32 v[236:237], v[84:85], v[104:105], v[236:237] op_sel_hi:[1,0,1]
  v_pk_fma_f32 v[238:239], v[86:87], v[104:105], v[238:239] op_sel_hi:[1,0,1]
  v_pk_fma_f32 v[240:241], v[72:73], v[106:107], v[240:241] op_sel_hi:[1,0,1]
  v_pk_fma_f32 v[242:243], v[74:75], v[106:107], v[242:243] op_sel_hi:[1,0,1]
  v_pk_fma_f32 v[244:245], v[76:77], v[106:107], v[244:245] op_sel_hi:[1,0,1]
  v_pk_fma_f32 v[246:247], v[78:79], v[106:107], v[246:247] op_sel_hi:[1,0,1]
  v_pk_fma_f32 v[248:249], v[80:81], v[106:107], v[248:249] op_sel_hi:[1,0,1]
  v_pk_fma_f32 v[250:251], v[82:83], v[106:107], v[250:251] op_sel_hi:[1,0,1]
  v_pk_fma_f32 v[252:253], v[84:85], v[106:107], v[252:253] op_sel_hi:[1,0,1]
  v_pk_fma_f32 v[254:255], v[86:87], v[106:107], v[254:255] op_sel_hi:[1,0,1]
  s_branch .g2_kernel_q_pback
.g2_kernel_r2:
  s_lshl_b32 s28, s17, 4
  s_add_u32 s28, s28, s18
  s_lshl_b32 s28, s28, 2
  s_add_u32 s28, s28, s16
  s_lshl_b32 s28, s28, 12
  s_add_u32 s28, s28, 0xc00000
  buffer_load_dwordx4 v[240:243], v22, s[4:7], s28 offen offset:0
  buffer_load_dwordx4 v[244:247], v22, s[4:7], s28 offen offset:512
  buffer_load_dwordx4 v[248:251], v22, s[4:7], s28 offen offset:1024
  buffer_load_dwordx4 v[252:255], v22, s[4:7], s28 offen offset:1536
  s_branch .g2_kernel_r3
.g2_kernel_a_t1c:
  s_call_b64 s[68:69], .g2_kernel_a_pick
  s_branch .g2_kernel_a_t1b
.g2_kernel_a_t2c:
  s_call_b64 s[68:69], .g2_kernel_a_pick
  s_branch .g2_kernel_a_t2b
.g2_kernel_a_t3c:
  s_call_b64 s[68:69], .g2_kernel_a_pick
  s_branch .g2_kernel_a_t3b
.g2_kernel_a_three:
  s_andn2_b32 s33, s36, s34
  s_cbranch_scc0 .g2_kernel_a_t1c
.g2_kernel_a_t1b:
  s_ff1_i32_b32 s33, s33
  s_bitset1_b32 s34, s33
  s_xor_b32 s33, s33, s24
  s_lshl_b32 s33, s33, s25
  s_add_u32 s22, s20, s33
  s_addc_u32 s23, s21, 0
  global_load_dwordx4 v[192:195], v3, s[22:23] offset:0
  global_load_dwordx4 v[196:199], v3, s[22:23] offset:1024
  global_load_dwordx4 v[200:203], v3, s[22:23] offset:2048
  global_load_dwordx4 v[204:207], v3, s[22:23] offset:3072
  s_andn2_b32 s33, s36, s34
  s_cbranch_scc0 .g2_kernel_a_t2c
.g2_kernel_a_t2b:
  s_ff1_i32_b32 s33, s33
  s_bitset1_b32 s34, s33
  s_xor_b32 s33, s33, s24
  s_lshl_b32 s33, s33, s25
  s_add_u32 s22, s20, s33
  s_addc_u32 s23, s21, 0
  global_load_dwordx4 v[208:211], v3, s[22:23] offset:0
  global_load_dwordx4 v[212:215], v3, s[22:23] offset:1024
  global_load_dwordx4 v[216:219], v3, s[22:23] offset:2048
  global_load_dwordx4 v[220:223], v3, s[22:23] offset:3072
  s_andn2_b32 s33, s36, s34
  s_cbranch_scc0 .g2_kernel_a_t3c
.g2_kernel_a_t3b:
  s_ff1_i32_b32 s33, s33
  s_bitset1_b32 s34, s33
  s_xor_b32 s33, s33, s24
  s_lshl_b32 s33, s33, s25
  s_add_u32 s22, s20, s33
  s_addc_u32 s23, s21, 0
  global_load_dwordx4 v[224:227], v3, s[22:23] offset:0
  global_load_dwordx4 v[228:231], v3, s[22:23] offset:1024
  global_load_dwordx4 v[232:235], v3, s[22:23] offset:2048
  global_load_dwordx4 v[236:239], v3, s[22:23] offset:3072
  s_setpc_b64 s[72:73]
.g2_kernel_a_N0c:
  s_call_b64 s[68:69], .g2_kernel_a_pick
  s_branch .g2_kernel_a_N0b
.g2_kernel_a_N1c:
  s_call_b64 s[68:69], .g2_kernel_a_pick
  s_branch .g2_kernel_a_N1b
.g2_kernel_a_N2c:
  s_call_b64 s[68:69], .g2_kernel_a_pick
  s_branch .g2_kernel_a_N2b
.g2_kernel_a_N3c:
  s_call_b64 s[68:69], .g2_kernel_a_pick
  s_branch .g2_kernel_a_N3b
.g2_kernel_a_L3c:
  s_call_b64 s[68:69], .g2_kernel_a_pick
  s_branch .g2_kernel_a_L3b
.g2_kernel_a_G0c:
  s_call_b64 s[68:69], .g2_kernel_a_pick
  s_branch .g2_kernel_a_G0b
.g2_kernel_a_L3g:
  s_mov_b32 s38, 0
.g2_kernel_a_L3gl:
  ds_read_b32 v7, v13 offset:8
  s_add_u32 s38, s38, 1
  s_waitcnt lgkmcnt(0)
  v_cmp_gt_u32 vcc, s27, v7
  s_cbranch_vccz .g2_kernel_a_L3h
  s_cmp_lt_u32 s38, 524288
  s_cbranch_scc1 .g2_kernel_a_L3gl
  s_branch .g2_kernel_a_L3h
.g2_kernel_a_pick:
  s_cmp_lg_u32 s34, -1
  s_cbranch_scc1 .g2_kernel_a_pk1
  s_add_u32 s26, s26, 1
  s_mov_b32 s34, 0xffff
  s_cmp_eq_u32 s26, 1
  s_cbranch_scc1 .g2_kernel_a_pk1
  v_and_b32 v8, 15, v2
  s_lshl_b32 s28, s16, 6
  s_add_u32 s28, s28, 157696
  v_lshl_add_u32 v8, v8, 2, s28
  s_lshl_b32 s28, s17, 2
  s_add_u32 s28, s28, s16
  s_lshl_b32 s28, s28, 16
  s_add_u32 s28, s28, s63
  s_add_u32 s28, s28, 0x800000
  s_add_u32 s20, s60, s28
  s_addc_u32 s21, s61, 0
  s_lshl_b32 s24, s18, 1
  s_and_b32 s24, s24, 6
  s_mov_b32 s25, 12
  s_mov_b32 s34, 0
  s_mov_b32 s36, 0xff
  s_mov_b32 s33, 0xff
  s_mov_b32 s38, 0
.g2_kernel_a_pk2:
  ds_read_b32 v7, v8
  s_add_u32 s38, s38, 1
  s_waitcnt lgkmcnt(0)
  v_cmp_ge_u32 vcc, s62, v7
  s_cbranch_vccz .g2_kernel_a_pkr
  s_cmp_lt_u32 s38, 524288
  s_cbranch_scc1 .g2_kernel_a_pk2
  s_branch .g2_kernel_a_pkr
.g2_kernel_a_pk1:
  s_mov_b32 s38, 0
.g2_kernel_a_pkl:
  ds_read_b32 v7, v8
  s_add_u32 s38, s38, 1
  s_waitcnt lgkmcnt(0)
  v_cmp_lt_u32 vcc, s62, v7
  s_mov_b32 s36, vcc_lo
  s_andn2_b32 s33, s36, s34
  s_cbranch_scc1 .g2_kernel_a_pkr
  s_cmp_lt_u32 s38, 524288
  s_cbranch_scc1 .g2_kernel_a_pkl
  s_not_b32 s33, s34
.g2_kernel_a_pkr:
  s_setpc_b64 s[68:69]
.g2_kernel_w_aw:
  v_mov_b32 v6, s71
  s_mov_b32 s38, 0
.g2_kernel_wg2:
  ds_read_b32 v7, v6 offset:52
  s_add_u32 s38, s38, 1
  s_waitcnt lgkmcnt(0)
  v_cmp_le_u32 vcc, 4, v7
  s_cbranch_vccnz .g2_kernel_wg2d
  s_sleep 1
  s_cmp_lt_u32 s38, 524288
  s_cbranch_scc1 .g2_kernel_wg2
.g2_kernel_wg2d:
  s_branch .g2_kernel_w_ab
.g2_kernel_w_pt:
  v_lshlrev_b32 v7, 5, v17
  v_add_u32 v7, 155648, v7
  s_mov_b64 exec, vcc
  ds_read_b128 v[240:243], v7 offset:7680
  ds_read_b128 v[244:247], v7 offset:7696
  ds_read_b128 v[248:251], v7 offset:7744
  ds_read_b128 v[252:255], v7 offset:7760
  s_waitcnt lgkmcnt(0)
  v_pk_add_f32 v[24:25], v[24:25], v[240:241]
  v_pk_add_f32 v[26:27], v[26:27], v[242:243]
  v_pk_add_f32 v[28:29], v[28:29], v[244:245]
  v_pk_add_f32 v[30:31], v[30:31], v[246:247]
  v_pk_add_f32 v[32:33], v[32:33], v[248:249]
  v_pk_add_f32 v[34:35], v[34:35], v[250:251]
  v_pk_add_f32 v[36:37], v[36:37], v[252:253]
  v_pk_add_f32 v[38:39], v[38:39], v[254:255]
  ds_read_b128 v[240:243], v7 offset:7808
  ds_read_b128 v[244:247], v7 offset:7824
  ds_read_b128 v[248:251], v7 offset:7872
  ds_read_b128 v[252:255], v7 offset:7888
  s_waitcnt lgkmcnt(0)
  v_pk_add_f32 v[40:41], v[40:41], v[240:241]
  v_pk_add_f32 v[42:43], v[42:43], v[242:243]
  v_pk_add_f32 v[44:45], v[44:45], v[244:245]
  v_pk_add_f32 v[46:47], v[46:47], v[246:247]
  v_pk_add_f32 v[48:49], v[48:49], v[248:249]
  v_pk_add_f32 v[50:51], v[50:51], v[250:251]
  v_pk_add_f32 v[52:53], v[52:53], v[252:253]
  v_pk_add_f32 v[54:55], v[54:55], v[254:255]
  s_mov_b64 exec, -1
  s_branch .g2_kernel_w_pb
.g2_kernel_w_i8c:
  s_call_b64 s[68:69], .g2_kernel_w_pick
  s_branch .g2_kernel_w_i8b
.g2_kernel_w_i9c:
  s_call_b64 s[68:69], .g2_kernel_w_pick
  s_branch .g2_kernel_w_i9b
.g2_kernel_w_i10c:
  s_call_b64 s[68:69], .g2_kernel_w_pick
  s_branch .g2_kernel_w_i10b
.g2_kernel_w_i11c:
  s_call_b64 s[68:69], .g2_kernel_w_pick
  s_branch .g2_kernel_w_i11b
.g2_kernel_w_i12c:
  s_call_b64 s[68:69], .g2_kernel_w_pick
  s_branch .g2_kernel_w_i12b
.g2_kernel_w_i13c:
  s_call_b64 s[68:69], .g2_kernel_w_pick
  s_branch .g2_kernel_w_i13b
.g2_kernel_w_i14c:
  s_call_b64 s[68:69], .g2_kernel_w_pick
  s_branch .g2_kernel_w_i14b
.g2_kernel_w_i15c:
  s_call_b64 s[68:69], .g2_kernel_w_pick
  s_branch .g2_kernel_w_i15b
.g2_kernel_w_bw:
  s_mov_b32 s38, 0
.g2_kernel_w_bwl:
  ds_read_b32 v16, v20 offset:12
  s_add_u32 s38, s38, 1
  s_waitcnt lgkmcnt(0)
  v_cmp_gt_u32 vcc, 4, v16
  s_cbranch_vccz .g2_kernel_w_bb
  s_cmp_lt_u32 s38, 524288
  s_cbranch_scc1 .g2_kernel_w_bwl
  s_branch .g2_kernel_w_bb
.g2_kernel_w_pick:
  s_mov_b32 s38, 0
.g2_kernel_w_pkl:
  ds_read_b64 v[6:7], v21
  s_add_u32 s38, s38, 1
  s_waitcnt lgkmcnt(0)
  v_min_u32 v6, v6, v7
  v_cmp_lt_u32 vcc, s62, v6
  s_and_b32 s36, vcc_lo, 0xff00
  s_andn2_b32 s33, s36, s34
  s_cbranch_scc1 .g2_kernel_w_pkr
  s_cmp_lt_u32 s38, 524288
  s_cbranch_scc1 .g2_kernel_w_pkl
  s_andn2_b32 s33, 0xff00, s34
.g2_kernel_w_pkr:
  s_setpc_b64 s[68:69]
.g2_kernel_p_spin:
  s_mov_b32 s38, 0
.g2_kernel_p_spinl:
  ds_read_b32 v10, v9
  s_add_u32 s38, s38, 1
  s_waitcnt lgkmcnt(0)
  v_cmp_gt_i32 vcc, s34, v10
  s_cbranch_vccz .g2_kernel_p_spinr
  s_sleep 1
  s_cmp_lt_u32 s38, 524288
  s_cbranch_scc1 .g2_kernel_p_spinl
.g2_kernel_p_spinr:
  s_setpc_b64 s[68:69]
.g2_kernel_p1_aw:
  s_call_b64 s[68:69], .g2_kernel_p_spin
  s_branch .g2_kernel_p1_ai
.g2_kernel_p1_bw:
  s_call_b64 s[68:69], .g2_kernel_p_spin
  s_branch .g2_kernel_p1_bi
.g2_kernel_v_may:
  s_cmp_lg_u32 s39, 0
  s_cbranch_scc1 .g2_kernel_v_mr
  s_and_b32 s28, s16, 3
  s_lshl_b32 s28, s28, 4
  s_add_u32 s28, s28, 155968
  v_mov_b32 v6, s28
  ds_read_b32 v7, v6
  s_waitcnt lgkmcnt(0)
  v_cmp_ne_u32 vcc, 0, v7
  s_cbranch_vccz .g2_kernel_v_mr
.g2_kernel_v_do:
  s_mov_b32 s39, 1
  s_mov_b32 s29, 0
  s_call_b64 s[68:69], .g2_kernel_v_cmb
  s_waitcnt vmcnt(0)
  v_mov_b32 v6, s71
  s_mov_b64 exec, 1
  ds_add_u32 v6, v5 offset:8
  s_mov_b64 exec, -1
  s_and_b32 s33, s16, 3
  s_lshl_b32 s33, s33, 7
  s_lshl_b32 s28, s29, 2
  s_add_u32 s33, s33, s28
  s_add_u32 s31, s19, s33
  v_mov_b32 v6, s70
  s_mov_b64 exec, 1
  buffer_store_dword v6, v4, s[4:7], s31 offen offset:0 sc1
  s_mov_b64 exec, -1
.g2_kernel_v_mr:
  s_setpc_b64 s[26:27]
.g2_kernel_v_wo:
  s_mov_b32 s8, s44
  s_mov_b32 s9, s45
  s_mov_b32 s10, 0x200000
  s_mov_b32 s11, 0x00020000
  v_lshrrev_b32 v6, 3, v2
  v_and_b32 v7, 7, v2
  v_bfe_u32 v8, v2, 4, 1
  v_lshlrev_b32 v8, 2, v8
  v_xor_b32 v7, v7, v8
  v_lshlrev_b32 v7, 4, v7
  v_lshl_add_u32 v6, v6, 11, v7
  s_and_b32 s31, s16, 3
  s_lshl_b32 s31, s31, 3
  s_add_u32 s31, s31, s29
  s_lshl_b32 s31, s31, 16
  s_lshl_b32 s33, s18, 7
  s_add_u32 s31, s31, s33
  s_mov_b32 m0, s30
  s_nop 0
  buffer_load_dwordx4 v6, s[8:11], s31 offen lds
  s_add_u32 m0, m0, 1024
  s_add_u32 s31, s31, 16384
  buffer_load_dwordx4 v6, s[8:11], s31 offen lds
  s_add_u32 m0, m0, 1024
  s_add_u32 s31, s31, 16384
  buffer_load_dwordx4 v6, s[8:11], s31 offen lds
  s_add_u32 m0, m0, 1024
  s_add_u32 s31, s31, 16384
  buffer_load_dwordx4 v6, s[8:11], s31 offen lds
  s_add_u32 m0, m0, 1024
  s_add_u32 s31, s31, 81920
  buffer_load_dwordx4 v6, s[8:11], s31 offen lds
  s_add_u32 m0, m0, 1024
  s_add_u32 s31, s31, 16384
  buffer_load_dwordx4 v6, s[8:11], s31 offen lds
  s_add_u32 m0, m0, 1024
  s_add_u32 s31, s31, 16384
  buffer_load_dwordx4 v6, s[8:11], s31 offen lds
  s_add_u32 m0, m0, 1024
  s_add_u32 s31, s31, 16384
  buffer_load_dwordx4 v6, s[8:11], s31 offen lds
  s_add_u32 m0, m0, 1024
  s_add_u32 s31, s31, 81920
  buffer_load_dwordx4 v6, s[8:11], s31 offen lds
  s_add_u32 m0, m0, 1024
  s_add_u32 s31, s31, 16384
  buffer_load_dwordx4 v6, s[8:11], s31 offen lds
  s_add_u32 m0, m0, 1024
  s_add_u32 s31, s31, 16384
  buffer_load_dwordx4 v6, s[8:11], s31 offen lds
  s_add_u32 m0, m0, 1024
  s_add_u32 s31, s31, 16384
  buffer_load_dwordx4 v6, s[8:11], s31 offen lds
  s_add_u32 m0, m0, 1024
  s_add_u32 s31, s31, 81920
  buffer_load_dwordx4 v6, s[8:11], s31 offen lds
  s_add_u32 m0, m0, 1024
  s_add_u32 s31, s31, 16384
  buffer_load_dwordx4 v6, s[8:11], s31 offen lds
  s_add_u32 m0, m0, 1024
  s_add_u32 s31, s31, 16384
  buffer_load_dwordx4 v6, s[8:11], s31 offen lds
  s_add_u32 m0, m0, 1024
  s_add_u32 s31, s31, 16384
  buffer_load_dwordx4 v6, s[8:11], s31 offen lds
  s_setpc_b64 s[68:69]
.g2_kernel_v_cmb:
  s_and_b32 s28, s16, 3
  s_lshl_b32 s30, s28, 4
  s_add_u32 s30, s30, 155968
  v_and_b32 v6, 3, v2
  v_lshl_add_u32 v6, v6, 2, s30
  s_lshl_b32 s30, s28, 14
  v_add_u32 v12, s30, v3
  v_and_b32 v13, 31, v2
  s_lshl_b32 s31, s28, 9
  s_add_u32 s31, s31, 161280
  v_lshl_add_u32 v13, v13, 2, s31
  s_lshl_b32 s33, s62, 1
  s_add_u32 s33, s33, s29
  s_lshl_b32 s31, s17, 2
  s_add_u32 s31, s31, s28
  s_lshl_b32 s31, s31, 1
  s_add_u32 s31, s31, s29
  s_lshl_b32 s31, s31, 4
  s_add_u32 s31, s31, s18
  s_lshl_b32 s31, s31, 11
  s_add_u32 s31, s31, s63
  s_add_u32 s35, s31, 0x800000
  v_mov_b32 v14, 8.673617379884035e-19
  v_mov_b32 v15, 1.152921504606847e+18
  s_mov_b32 s38, 0
.g2_kernel_v_cmbw:
  ds_read_b32 v7, v6
  s_add_u32 s38, s38, 1
  s_waitcnt lgkmcnt(0)
  v_cmp_ge_u32 vcc, s33, v7
  s_cbranch_vccz .g2_kernel_v_cmbd
  v_cmp_lt_u32 vcc, s33, v7
  s_cbranch_vccnz .g2_kernel_v_cmbq
  s_sleep 12
.g2_kernel_v_cmbq:
  s_cmp_lt_u32 s38, 524288
  s_cbranch_scc1 .g2_kernel_v_cmbw
.g2_kernel_v_cmbd:
  s_setprio 3
  s_lshl_b32 s30, s28, 2
  s_add_u32 s30, s30, s71
  v_mov_b32 v7, s30
  ds_read_b128 v[16:19], v12 offset:0
  ds_read_b128 v[20:23], v12 offset:1024
  ds_read_b128 v[24:27], v12 offset:2048
  ds_read_b128 v[28:31], v12 offset:3072
  ds_read_b128 v[32:35], v12 offset:4096
  ds_read_b128 v[36:39], v12 offset:5120
  ds_read_b128 v[40:43], v12 offset:6144
  ds_read_b128 v[44:47], v12 offset:7168
  ds_read_b128 v[48:51], v12 offset:8192
  ds_read_b128 v[52:55], v12 offset:9216
  ds_read_b128 v[56:59], v12 offset:10240
  ds_read_b128 v[60:63], v12 offset:11264
  s_waitcnt lgkmcnt(4)
  ds_read_b32 v8, v13 offset:0
  ds_read_b32 v9, v13 offset:128
  ds_read_b32 v10, v13 offset:256
  ds_read_b32 v11, v13 offset:384
  v_pk_add_f32 v[16:17], v[16:17], v[32:33]
  v_pk_add_f32 v[18:19], v[18:19], v[34:35]
  v_pk_add_f32 v[20:21], v[20:21], v[36:37]
  v_pk_add_f32 v[22:23], v[22:23], v[38:39]
  v_pk_add_f32 v[24:25], v[24:25], v[40:41]
  v_pk_add_f32 v[26:27], v[26:27], v[42:43]
  v_pk_add_f32 v[28:29], v[28:29], v[44:45]
  v_pk_add_f32 v[30:31], v[30:31], v[46:47]
  ds_read_b128 v[32:35], v12 offset:12288
  ds_read_b128 v[36:39], v12 offset:13312
  ds_read_b128 v[40:43], v12 offset:14336
  ds_read_b128 v[44:47], v12 offset:15360
  s_waitcnt lgkmcnt(4)
  v_pk_add_f32 v[16:17], v[16:17], v[48:49]
  v_pk_add_f32 v[18:19], v[18:19], v[50:51]
  v_pk_add_f32 v[20:21], v[20:21], v[52:53]
  v_pk_add_f32 v[22:23], v[22:23], v[54:55]
  v_pk_add_f32 v[24:25], v[24:25], v[56:57]
  v_pk_add_f32 v[26:27], v[26:27], v[58:59]
  v_pk_add_f32 v[28:29], v[28:29], v[60:61]
  v_pk_add_f32 v[30:31], v[30:31], v[62:63]
  v_pk_add_f32 v[8:9], v[8:9], v[10:11]
  v_add_f32 v9, v8, v9
  v_cmp_ge_f32 vcc, v9, v14
  v_cmp_le_f32 s[36:37], v9, v15
  v_rcp_f32 v10, v9
  v_mul_f32 v15, v15, v15
  v_mov_b32 v11, s29
  s_waitcnt lgkmcnt(0)
  ds_write_b32 v7, v11 offset:64
  v_pk_add_f32 v[16:17], v[16:17], v[32:33]
  v_pk_add_f32 v[18:19], v[18:19], v[34:35]
  v_pk_add_f32 v[20:21], v[20:21], v[36:37]
  v_pk_add_f32 v[22:23], v[22:23], v[38:39]
  v_pk_add_f32 v[24:25], v[24:25], v[40:41]
  v_pk_add_f32 v[26:27], v[26:27], v[42:43]
  v_pk_add_f32 v[28:29], v[28:29], v[44:45]
  v_pk_add_f32 v[30:31], v[30:31], v[46:47]
  s_and_b64 s[36:37], s[36:37], vcc
  v_maximum3_f32 v48, abs(v16), abs(v17), abs(v18)
  v_maximum3_f32 v49, abs(v19), abs(v20), abs(v21)
  v_maximum3_f32 v50, abs(v22), abs(v23), abs(v24)
  v_maximum3_f32 v51, abs(v25), abs(v26), abs(v27)
  v_maximum3_f32 v52, abs(v28), abs(v29), abs(v30)
  v_maximum3_f32 v48, v48, v49, abs(v31)
  v_maximum3_f32 v50, v50, v51, v52
  v_maximum3_f32 v48, v48, v50, v50
  v_cmp_le_f32 vcc, v48, v15
  s_and_b64 vcc, vcc, s[36:37]
  s_cmp_eq_u64 vcc, -1
  s_cbranch_scc0 .g2_kernel_v_cmbslow
.g2_kernel_v_cmbfin:
  v_pk_mul_f32 v[16:17], v[16:17], v[10:11] op_sel_hi:[1,0]
  v_pk_mul_f32 v[18:19], v[18:19], v[10:11] op_sel_hi:[1,0]
  v_pk_mul_f32 v[20:21], v[20:21], v[10:11] op_sel_hi:[1,0]
  v_pk_mul_f32 v[22:23], v[22:23], v[10:11] op_sel_hi:[1,0]
  v_pk_mul_f32 v[24:25], v[24:25], v[10:11] op_sel_hi:[1,0]
  v_pk_mul_f32 v[26:27], v[26:27], v[10:11] op_sel_hi:[1,0]
  v_pk_mul_f32 v[28:29], v[28:29], v[10:11] op_sel_hi:[1,0]
  v_pk_mul_f32 v[30:31], v[30:31], v[10:11] op_sel_hi:[1,0]
  v_cvt_pk_bf16_f32 v32, v16, v17
  v_cvt_pk_bf16_f32 v33, v18, v19
  v_cvt_pk_bf16_f32 v34, v20, v21
  v_cvt_pk_bf16_f32 v35, v22, v23
  buffer_store_dwordx4 v[32:35], v3, s[4:7], s35 offen offset:0 sc1
  v_cvt_pk_bf16_f32 v36, v24, v25
  v_cvt_pk_bf16_f32 v37, v26, v27
  v_cvt_pk_bf16_f32 v38, v28, v29
  v_cvt_pk_bf16_f32 v39, v30, v31
  buffer_store_dwordx4 v[36:39], v3, s[4:7], s35 offen offset:1024 sc1
  s_setprio 3
  s_setpc_b64 s[68:69]
.g2_kernel_v_cmbslow:
  s_setprio 0
  s_lshl_b32 s30, s28, 11
  s_mul_i32 s31, s29, -8192
  s_add_u32 s30, s30, s31
  s_add_u32 s30, s30, 139264
  v_add_u32 v6, s30, v3
  ds_read_b128 v[48:51], v6
  ds_read_b128 v[52:55], v6 offset:1024
  s_lshl_b32 s36, s18, 1
  s_add_u32 s36, s36, s29
  s_lshl_b32 s36, s36, 18
  s_add_u32 s36, s36, s63
  s_mov_b32 s30, s36
  s_mov_b32 s33, 64
  v_mov_b32 v10, 0xff800000
  s_waitcnt lgkmcnt(0)
.g2_kernel_v_cmbs1:
  buffer_load_dwordx4 v[56:59], v3, s[4:7], s30 offen offset:0
  buffer_load_dwordx4 v[60:63], v3, s[4:7], s30 offen offset:1024
  s_waitcnt vmcnt(0)
  v_mfma_f32_32x32x16_bf16 v[32:47], v[56:59], v[48:51], 0
  v_mfma_f32_32x32x16_bf16 v[32:47], v[60:63], v[52:55], v[32:47]
  s_nop 11
  v_max3_f32 v10, v10, v32, v33
  v_max3_f32 v10, v10, v34, v35
  v_max3_f32 v10, v10, v36, v37
  v_max3_f32 v10, v10, v38, v39
  v_max3_f32 v10, v10, v40, v41
  v_max3_f32 v10, v10, v42, v43
  v_max3_f32 v10, v10, v44, v45
  v_max3_f32 v10, v10, v46, v47
  s_add_u32 s30, s30, 4096
  s_sub_u32 s33, s33, 1
  s_cmp_lg_u32 s33, 0
  s_cbranch_scc1 .g2_kernel_v_cmbs1
  v_mov_b32 v11, v10
  s_nop 1
  v_permlane32_swap_b32 v11, v10
  v_max_f32 v10, v10, v11
  v_mov_b32 v9, 0
  v_mov_b32 v16, 0
  v_mov_b32 v17, 0
  v_mov_b32 v18, 0
  v_mov_b32 v19, 0
  v_mov_b32 v20, 0
  v_mov_b32 v21, 0
  v_mov_b32 v22, 0
  v_mov_b32 v23, 0
  v_mov_b32 v24, 0
  v_mov_b32 v25, 0
  v_mov_b32 v26, 0
  v_mov_b32 v27, 0
  v_mov_b32 v28, 0
  v_mov_b32 v29, 0
  v_mov_b32 v30, 0
  v_mov_b32 v31, 0
  s_mov_b32 s30, s36
  s_mov_b32 s33, 64
.g2_kernel_v_cmbs2:
  buffer_load_dwordx4 v[56:59], v3, s[4:7], s30 offen offset:0
  buffer_load_dwordx4 v[60:63], v3, s[4:7], s30 offen offset:1024
  s_waitcnt vmcnt(0)
  v_mfma_f32_32x32x16_bf16 v[32:47], v[56:59], v[48:51], 0
  v_mfma_f32_32x32x16_bf16 v[32:47], v[60:63], v[52:55], v[32:47]
  s_nop 11
  v_sub_f32 v32, v32, v10
  v_sub_f32 v33, v33, v10
  v_sub_f32 v34, v34, v10
  v_sub_f32 v35, v35, v10
  v_sub_f32 v36, v36, v10
  v_sub_f32 v37, v37, v10
  v_sub_f32 v38, v38, v10
  v_sub_f32 v39, v39, v10
  v_sub_f32 v40, v40, v10
  v_sub_f32 v41, v41, v10
  v_sub_f32 v42, v42, v10
  v_sub_f32 v43, v43, v10
  v_sub_f32 v44, v44, v10
  v_sub_f32 v45, v45, v10
  v_sub_f32 v46, v46, v10
  v_sub_f32 v47, v47, v10
  buffer_load_dwordx4 v[56:59], v3, s[4:7], s30 offen offset:2048
  buffer_load_dwordx4 v[60:63], v3, s[4:7], s30 offen offset:3072
  v_exp_f32 v32, v32
  v_exp_f32 v33, v33
  v_exp_f32 v34, v34
  v_exp_f32 v35, v35
  v_exp_f32 v36, v36
  v_exp_f32 v37, v37
  v_exp_f32 v38, v38
  v_exp_f32 v39, v39
  v_exp_f32 v40, v40
  v_exp_f32 v41, v41
  v_exp_f32 v42, v42
  v_exp_f32 v43, v43
  v_exp_f32 v44, v44
  v_exp_f32 v45, v45
  v_exp_f32 v46, v46
  v_exp_f32 v47, v47
  v_add_f32 v9, v9, v32
  v_add_f32 v9, v9, v33
  v_add_f32 v9, v9, v34
  v_add_f32 v9, v9, v35
  v_add_f32 v9, v9, v36
  v_add_f32 v9, v9, v37
  v_add_f32 v9, v9, v38
  v_add_f32 v9, v9, v39
  v_add_f32 v9, v9, v40
  v_add_f32 v9, v9, v41
  v_add_f32 v9, v9, v42
  v_add_f32 v9, v9, v43
  v_add_f32 v9, v9, v44
  v_add_f32 v9, v9, v45
  v_add_f32 v9, v9, v46
  v_add_f32 v9, v9, v47
  v_cvt_pk_bf16_f32 v32, v32, v33
  v_cvt_pk_bf16_f32 v33, v34, v35
  v_cvt_pk_bf16_f32 v34, v36, v37
  v_cvt_pk_bf16_f32 v35, v38, v39
  v_cvt_pk_bf16_f32 v36, v40, v41
  v_cvt_pk_bf16_f32 v37, v42, v43
  v_cvt_pk_bf16_f32 v38, v44, v45
  v_cvt_pk_bf16_f32 v39, v46, v47
  s_waitcnt vmcnt(0)
  v_mfma_f32_32x32x16_bf16 v[16:31], v[56:59], v[32:35], v[16:31]
  v_mfma_f32_32x32x16_bf16 v[16:31], v[60:63], v[36:39], v[16:31]
  s_nop 15
  s_add_u32 s30, s30, 4096
  s_sub_u32 s33, s33, 1
  s_cmp_lg_u32 s33, 0
  s_cbranch_scc1 .g2_kernel_v_cmbs2
  v_mov_b32 v11, v9
  s_nop 1
  v_permlane32_swap_b32 v11, v9
  v_add_f32 v9, v9, v11
  v_rcp_f32 v10, v9
  s_branch .g2_kernel_v_cmbfin
.g2_kernel_p2_xw:
  s_mov_b32 s38, 0
.g2_kernel_p2_xwl:
  ds_read_b32 v12, v11
  s_add_u32 s38, s38, 1
  s_waitcnt lgkmcnt(0)
  v_cmp_ne_u32 vcc, 0, v12
  s_and_b32 s37, vcc_lo, vcc_hi
  s_lshr_b32 s33, s37, 16
  s_and_b32 s37, s37, s33
  s_bitcmp1_b32 s37, s28
  s_cbranch_scc1 .g2_kernel_p2_xwr
  s_sleep 1
  s_cmp_lt_u32 s38, 524288
  s_cbranch_scc1 .g2_kernel_p2_xwl
.g2_kernel_p2_xwr:
  s_setpc_b64 s[68:69]
.g2_kernel_p2_x0w:
  s_call_b64 s[68:69], .g2_kernel_p2_xw
  s_branch .g2_kernel_p2_x0b
.g2_kernel_p2_x1w:
  s_call_b64 s[68:69], .g2_kernel_p2_xw
  s_branch .g2_kernel_p2_x1b
.g2_kernel_p2_x2w:
  s_call_b64 s[68:69], .g2_kernel_p2_xw
  s_branch .g2_kernel_p2_x2b
.g2_kernel_p2_aw:
  s_call_b64 s[68:69], .g2_kernel_p_spin
  s_branch .g2_kernel_p2_ai
.g2_kernel_p2_x3w:
  s_call_b64 s[68:69], .g2_kernel_p2_xw
  s_branch .g2_kernel_p2_x3b
.g2_kernel_p2_bw:
  s_call_b64 s[68:69], .g2_kernel_p_spin
  s_branch .g2_kernel_p2_bi
  .p2align 8
.g2_kernel_tab:
  .long 0, 1, 2, 3, 4, 5, 6, 7
  .long 8, 9, 10, 11, 12, 13, 14, 15
  .long 16, 17, 18, 19, 20, 21, 22, 23
  .long 24, 25, 26, 27, 28, 29, 30, 31
  .long 32, 33, 34, 35, 36, 37, 38, 39
  .long 40, 41, 42, 43, 44, 45, 46, 47
  .long 48, 49, 50, 51, 52, 53, 54, 55
  .long 56, 57, 58, 59, 60, 61, 62, 63
  .long 64, 65, 66, 67, 68, 69, 70, 71
.g2_kernel_cend:

.section .rodata,"a"
.p2align 6
.amdhsa_kernel g2_kernel
  .amdhsa_next_free_vgpr 256
  .amdhsa_next_free_sgpr 102
  .amdhsa_accum_offset 256
  .amdhsa_group_segment_fixed_size 0
  .amdhsa_kernarg_size 88
  .amdhsa_user_sgpr_count 2
  .amdhsa_user_sgpr_kernarg_segment_ptr 1
  .amdhsa_system_sgpr_workgroup_id_x 1
.end_amdhsa_kernel
```

```asm
; @launch kernel=g2_kernel grid=(256,1,1) block=(512,1,1) lds=163840
.amdgcn_target "amdgcn-amd-amdhsa--gfx950"
.text
.globl g2_kernel
.p2align 8
.type g2_kernel,@function
g2_kernel:
  s_cmp_ge_u32 s2, 256
  s_cbranch_scc1 .g2_kernel_end
  s_load_dwordx16 s[40:55], s[0:1], 0
  s_load_dwordx4 s[56:59], s[0:1], 64
  s_load_dwordx2 s[60:61], s[0:1], 80
  s_getpc_b64 s[64:65]
.g2_kernel_pc:
  s_mov_b32 s66, .g2_kernel_cend-.g2_kernel_pc
  s_mov_b32 s67, 0x00020000
  s_lshl_b32 s12, s2, 10
  s_and_b32 s12, s12, 0xe000
  v_lshrrev_b32 v3, 3, v0
  v_and_b32 v2, 7, v0
  v_and_b32 v3, 0x38, v3
  v_add_lshl_u32 v3, v3, v2, 7
  s_mov_b64 exec, 0xff
  buffer_load_dword v1, v3, s[64:67], s12 offen
  s_mov_b64 exec, -1
  v_lshrrev_b32 v3, 6, v0
  v_and_b32 v2, 63, v0
  v_readfirstlane_b32 s16, v3
  s_and_b32 s21, s2, 7
  s_lshr_b32 s22, s2, 3
  s_and_b32 s23, s21, 3
  s_lshl_b32 s23, s23, 2
  s_and_b32 s24, s22, 3
  s_add_u32 s18, s23, s24
  s_lshr_b32 s24, s21, 2
  s_lshl_b32 s24, s24, 3
  s_lshr_b32 s25, s22, 2
  s_add_u32 s17, s24, s25
  s_lshl_b32 s19, s17, 4
  s_add_u32 s19, s19, s18
  s_lshl_b32 s19, s19, 9
  s_add_u32 s19, s19, 0x3000000
  s_lshl_b32 s76, s18, 4
  s_add_u32 s76, s76, s17
  s_lshl_b32 s76, s76, 9
  s_add_u32 s76, s76, 0x3020000
  v_lshlrev_b32 v3, 4, v2
  v_mov_b32 v4, 0
  v_mov_b32 v5, 1
  s_mov_b32 s62, 0
  s_mov_b32 s63, 0
  s_mov_b32 s70, 1
  s_mov_b32 s71, 155648
  s_waitcnt lgkmcnt(0)
  s_mov_b32 s4, s60
  s_mov_b32 s5, s61
  s_mov_b32 s6, 0x3200000
  s_mov_b32 s7, 0x00020000
  s_cmp_ge_u32 s16, 4
  s_cbranch_scc1 .g2_kernel_svc
  v_mov_b32 v20, 0
  v_mov_b32 v21, 0
  v_mov_b32 v22, 0
  v_mov_b32 v23, 0
  v_lshlrev_b32 v24, 4, v0
  v_cmp_gt_u32 vcc, 2816, v24
  v_add_u32 v24, 155648, v24
  s_and_saveexec_b64 s[20:21], vcc
  s_cbranch_execz .g2_kernel_q_nz
  ds_write_b128 v24, v[20:23]
.g2_kernel_q_nz:
  s_mov_b64 exec, -1
  v_and_b32 v20, 15, v2
  v_lshrrev_b32 v21, 4, v2
  v_lshrrev_b32 v22, 1, v20
  v_xor_b32 v22, v22, v21
  v_lshlrev_b32 v22, 4, v22
  v_lshl_add_u32 v22, v20, 7, v22
  s_lshr_b32 s26, s16, 1
  s_lshl_b32 s26, s26, 13
  v_add_u32 v144, s26, v22
  v_xor_b32 v145, 64, v144
.g2_kernel_q_cs:
  s_and_b32 s27, s16, 1
  s_lshr_b32 s26, s16, 1
  v_bfe_u32 v20, v2, 2, 2
  v_lshrrev_b32 v49, 4, v2
  v_lshl_add_u32 v22, v49, 3, v20
  v_lshlrev_b32 v22, 7, v22
  v_lshrrev_b32 v23, 1, v20
  v_and_b32 v21, 1, v49
  v_xor_b32 v21, s27, v21
  v_lshl_add_u32 v23, v21, 1, v23
  v_lshl_add_u32 v22, v23, 5, v22
  v_and_b32 v23, 3, v2
  v_lshl_add_u32 v22, v23, 3, v22
  v_add_u32 v148, 65536, v22
  v_xor_b32 v149, 32, v148
  v_mov_b32 v146, v148
  v_mov_b32 v147, v149
  v_mov_b32 v150, 156160
  v_and_b32 v48, 15, v2
  s_lshl_b32 s28, s26, 8
  s_add_u32 s28, s28, 155648
  v_lshl_add_u32 v50, v48, 2, s28
  v_lshl_add_u32 v51, v49, 4, s28
  s_lshl_b32 s28, s27, 7
  s_add_u32 s28, s28, 155648
  v_lshl_add_u32 v52, v49, 4, s28
  v_lshl_add_u32 v53, v48, 2, s28
  v_lshlrev_b32 v54, 9, v49
  v_lshl_add_u32 v55, v48, 4, v54
  v_and_b32 v56, 8, v48
  v_lshl_add_u32 v54, v56, 4, v55
  v_mov_b32 v56, 0.25503486164919736
  v_lshlrev_b32 v58, 8, v2
  v_and_b32 v58, 0x300, v58
  v_add_u32 v58, 156416, v58
  s_lshl_b32 s8, s18, 1
  s_add_u32 s8, s8, s27
  s_lshl_b32 s8, s8, 6
  s_lshl_b32 s9, s17, 2
  s_add_u32 s8, s8, s9
  s_lshl_b32 s9, s26, 1
  s_add_u32 s8, s8, s9
  s_lshl_b32 s8, s8, 12
  s_add_u32 s8, s8, s63
  s_add_u32 s9, s8, 4096
  s_lshl_b32 s28, s26, 13
  v_add_u32 v59, s28, v54
  v_add_u32 v60, s28, v55
  s_lshl_b32 s28, s26, 12
  s_mul_i32 s10, s27, -8192
  s_add_u32 s28, s28, s10
  s_add_u32 s28, s28, 139264
  v_add_u32 v61, s28, v55
  s_mov_b32 s10, s27
  s_lshl_b32 s12, s62, 5
  s_add_u32 s12, s12, 28
  v_and_b32 v6, 15, v2
  v_xor_b32 v6, s17, v6
  v_and_b32 v7, 16, v2
  v_add_u32 v6, v6, v7
  s_lshr_b32 s28, s16, 1
  s_lshl_b32 s28, s28, 7
  s_add_u32 s28, s28, 157440
  v_lshl_add_u32 v8, v6, 2, s28
  s_lshl_b32 s28, s16, 12
  v_add_u32 v9, s28, v3
  v_and_b32 v6, 31, v2
  s_lshl_b32 s28, s16, 7
  s_add_u32 s28, s28, 161280
  v_lshl_add_u32 v10, v6, 2, s28
  s_lshl_b32 s28, s16, 2
  s_add_u32 s28, s28, 155968
  v_mov_b32 v11, s28
  s_lshl_b32 s28, s62, 1
  s_add_u32 s28, s28, 1
  v_mov_b32 v12, s28
  v_mov_b32 v13, s71
  v_add_u32 v14, 131072, v3
  v_and_b32 v6, 4, v2
  v_cmp_eq_u32 vcc, 0, v6
  v_mov_b32 v7, 0x3f803f80
  v_and_b32 v6, 1, v2
  v_cndmask_b32 v16, 0, v7, vcc
  v_cndmask_b32 v17, 0, v7, vcc
  v_cndmask_b32 v18, v7, 0, vcc
  v_cndmask_b32 v19, v7, 0, vcc
  v_mul_u32_u24 v20, 0xaaaa, v6
  v_add_u32 v20, 0x4444, v20
  s_lshl_b32 s28, s18, 7
  s_add_u32 s28, s28, s16
  s_lshl_b32 s28, s28, 12
  s_add_u32 s28, s28, s63
  s_add_u32 s20, s60, s28
  s_addc_u32 s21, s61, 0
  s_mov_b32 s24, s17
  s_mov_b32 s25, 14
  s_mov_b32 s26, 0
  s_mov_b32 s27, 4
  s_mov_b32 s34, 0xffff0001
  s_mov_b32 s35, 0
  s_mov_b32 s36, 0
  s_mov_b32 s39, 0
  s_lshl_b32 s28, s16, 7
  s_add_u32 s37, s76, s28
  v_mov_b32 v15, s70
  v_lshrrev_b32 v6, 5, v2
  v_and_b32 v7, 15, v2
  v_lshlrev_b32 v22, 4, v7
  v_lshl_add_u32 v22, v6, 8, v22
  v_and_b32 v7, 16, v2
  v_lshl_add_u32 v22, v7, 7, v22
  v_and_b32 v7, 31, v2
  v_lshlrev_b32 v23, 4, v6
  v_lshl_add_u32 v23, v7, 11, v23
  s_lshl_b32 s28, s17, 2
  s_add_u32 s28, s28, s16
  s_lshl_b32 s28, s28, 16
  s_lshl_b32 s29, s18, 7
  s_add_u32 s28, s28, s29
  s_add_u32 s74, s40, s28
  s_addc_u32 s75, s41, 0
  s_lshl_b32 s13, s17, 4
  s_add_u32 s13, s13, s18
  s_lshl_b32 s13, s13, 2
  s_add_u32 s13, s13, s16
  s_lshl_b32 s13, s13, 12
  s_add_u32 s13, s13, 0xc00000
  s_lshl_b32 s28, s16, 8
  s_add_u32 m0, s28, 156416
  s_lshl_b32 s33, s62, 5
  s_lshl_b32 s31, s33, 2
  s_add_u32 s31, s31, .g2_kernel_tab-.g2_kernel_pc+4
  s_mov_b32 s29, 0
  s_cmp_lg_u32 s62, 0
  s_cbranch_scc1 .g2_kernel_q_i2
  s_waitcnt lgkmcnt(0)
  s_barrier
.g2_kernel_q_i3:
  s_call_b64 s[68:69], .g2_kernel_q_spin
  ds_read_b64_tr_b16 v[80:81], v146 offset:0
  ds_read_b64_tr_b16 v[82:83], v146 offset:512
  ds_read_b128 v[64:67], v144 offset:0
  ds_read_b128 v[68:71], v144 offset:2048
  ds_read_b128 v[72:75], v144 offset:4096
  ds_read_b128 v[76:79], v144 offset:6144
  ds_read_b64_tr_b16 v[84:85], v147 offset:0
  ds_read_b64_tr_b16 v[86:87], v147 offset:512
  ds_read_b64_tr_b16 v[88:89], v146 offset:4096
  ds_read_b64_tr_b16 v[90:91], v146 offset:4608
  ds_read_b64_tr_b16 v[92:93], v147 offset:4096
  ds_read_b64_tr_b16 v[94:95], v147 offset:4608
  ds_read_b64_tr_b16 v[96:97], v146 offset:8192
  ds_read_b64_tr_b16 v[98:99], v146 offset:8704
  ds_read_b64_tr_b16 v[100:101], v147 offset:8192
  ds_read_b64_tr_b16 v[102:103], v147 offset:8704
  s_mov_b32 s30, 12288
  s_add_u32 s33, s33, 1
  v_add_u32 v146, s30, v148
  v_add_u32 v147, s30, v149
  s_waitcnt lgkmcnt(0)
  v_mfma_f32_16x16x32_bf16 v[160:163], v[80:83], v[64:67], 0
  v_cmp_lt_i32 vcc, s33, v151
  v_mfma_f32_16x16x32_bf16 v[164:167], v[80:83], v[68:71], 0
  s_cbranch_vccz .g2_kernel_q_wf
.g2_kernel_q_backf:
  v_mfma_f32_16x16x32_bf16 v[168:171], v[80:83], v[72:75], 0
  ds_read_b64_tr_b16 v[120:121], v146 offset:0
  v_mfma_f32_16x16x32_bf16 v[172:175], v[80:83], v[76:79], 0
  ds_read_b64_tr_b16 v[122:123], v146 offset:512
  v_mfma_f32_16x16x32_bf16 v[188:191], v[84:87], v[76:79], 0
  ds_read_b128 v[104:107], v145 offset:0
  v_mfma_f32_16x16x32_bf16 v[184:187], v[84:87], v[72:75], 0
  ds_read_b128 v[108:111], v145 offset:2048
  v_mfma_f32_16x16x32_bf16 v[180:183], v[84:87], v[68:71], 0
  ds_read_b128 v[112:115], v145 offset:4096
  v_mfma_f32_16x16x32_bf16 v[176:179], v[84:87], v[64:67], 0
  ds_read_b128 v[116:119], v145 offset:6144
  v_mfma_f32_16x16x32_bf16 v[192:195], v[88:91], v[64:67], 0
  ds_read_b64_tr_b16 v[124:125], v147 offset:0
  v_mfma_f32_16x16x32_bf16 v[196:199], v[88:91], v[68:71], 0
  ds_read_b64_tr_b16 v[126:127], v147 offset:512
  v_mfma_f32_16x16x32_bf16 v[200:203], v[88:91], v[72:75], 0
  ds_read_b64_tr_b16 v[128:129], v146 offset:4096
  v_mfma_f32_16x16x32_bf16 v[204:207], v[88:91], v[76:79], 0
  ds_read_b64_tr_b16 v[130:131], v146 offset:4608
  v_mfma_f32_16x16x32_bf16 v[220:223], v[92:95], v[76:79], 0
  ds_read_b64_tr_b16 v[132:133], v147 offset:4096
  v_mfma_f32_16x16x32_bf16 v[216:219], v[92:95], v[72:75], 0
  ds_read_b64_tr_b16 v[134:135], v147 offset:4608
  v_mfma_f32_16x16x32_bf16 v[212:215], v[92:95], v[68:71], 0
  ds_read_b64_tr_b16 v[136:137], v146 offset:8192
  v_mfma_f32_16x16x32_bf16 v[208:211], v[92:95], v[64:67], 0
  ds_read_b64_tr_b16 v[138:139], v146 offset:8704
  v_mfma_f32_16x16x32_bf16 v[224:227], v[64:67], v[96:99], 0
  ds_read_b64_tr_b16 v[140:141], v147 offset:8192
  v_mfma_f32_16x16x32_bf16 v[228:231], v[68:71], v[96:99], 0
  ds_read_b64_tr_b16 v[142:143], v147 offset:8704
  v_mfma_f32_16x16x32_bf16 v[232:235], v[72:75], v[96:99], 0
  ds_read_b32 v151, v150
  s_add_u32 s30, s30, 12288
  v_mfma_f32_16x16x32_bf16 v[236:239], v[76:79], v[96:99], 0
  buffer_load_dword off, s[64:67], s31 lds
  s_cmp_eq_u32 s30, 86016
  v_mfma_f32_16x16x32_bf16 v[252:255], v[76:79], v[100:103], 0
  s_cselect_b32 s30, 0, s30
  s_add_u32 s31, s31, 4
  v_mfma_f32_16x16x32_bf16 v[248:251], v[72:75], v[100:103], 0
  v_add_u32 v146, s30, v148
  s_add_u32 s33, s33, 1
  v_mfma_f32_16x16x32_bf16 v[244:247], v[68:71], v[100:103], 0
  v_add_u32 v147, s30, v149
  v_mfma_f32_16x16x32_bf16 v[240:243], v[64:67], v[100:103], 0
  s_branch .g2_kernel_q_s1
  .p2align 6
.g2_kernel_q_loop:
  s_waitcnt lgkmcnt(0)
  v_mfma_f32_16x16x32_bf16 v[160:163], v[120:123], v[104:107], v[160:163]
  v_cmp_lt_i32 vcc, s33, v151
  v_mfma_f32_16x16x32_bf16 v[164:167], v[120:123], v[108:111], v[164:167]
  s_cbranch_vccz .g2_kernel_q_w7
.g2_kernel_q_back7:
  v_mfma_f32_16x16x32_bf16 v[168:171], v[120:123], v[112:115], v[168:171]
  ds_read_b64_tr_b16 v[80:81], v146 offset:0
  v_mfma_f32_16x16x32_bf16 v[172:175], v[120:123], v[116:119], v[172:175]
  ds_read_b64_tr_b16 v[82:83], v146 offset:512
  v_mfma_f32_16x16x32_bf16 v[188:191], v[124:127], v[116:119], v[188:191]
  ds_read_b128 v[64:67], v144 offset:0
  v_mfma_f32_16x16x32_bf16 v[184:187], v[124:127], v[112:115], v[184:187]
  ds_read_b128 v[68:71], v144 offset:2048
  v_mfma_f32_16x16x32_bf16 v[180:183], v[124:127], v[108:111], v[180:183]
  ds_read_b128 v[72:75], v144 offset:4096
  v_mfma_f32_16x16x32_bf16 v[176:179], v[124:127], v[104:107], v[176:179]
  ds_read_b128 v[76:79], v144 offset:6144
  v_mfma_f32_16x16x32_bf16 v[192:195], v[128:131], v[104:107], v[192:195]
  ds_read_b64_tr_b16 v[84:85], v147 offset:0
  v_mfma_f32_16x16x32_bf16 v[196:199], v[128:131], v[108:111], v[196:199]
  ds_read_b64_tr_b16 v[86:87], v147 offset:512
  v_mfma_f32_16x16x32_bf16 v[200:203], v[128:131], v[112:115], v[200:203]
  ds_read_b64_tr_b16 v[88:89], v146 offset:4096
  v_mfma_f32_16x16x32_bf16 v[204:207], v[128:131], v[116:119], v[204:207]
  ds_read_b64_tr_b16 v[90:91], v146 offset:4608
  v_mfma_f32_16x16x32_bf16 v[220:223], v[132:135], v[116:119], v[220:223]
  ds_read_b64_tr_b16 v[92:93], v147 offset:4096
  v_mfma_f32_16x16x32_bf16 v[216:219], v[132:135], v[112:115], v[216:219]
  ds_read_b64_tr_b16 v[94:95], v147 offset:4608
  v_mfma_f32_16x16x32_bf16 v[212:215], v[132:135], v[108:111], v[212:215]
  ds_read_b64_tr_b16 v[96:97], v146 offset:8192
  v_mfma_f32_16x16x32_bf16 v[208:211], v[132:135], v[104:107], v[208:211]
  ds_read_b64_tr_b16 v[98:99], v146 offset:8704
  v_mfma_f32_16x16x32_bf16 v[224:227], v[104:107], v[136:139], v[224:227]
  ds_read_b64_tr_b16 v[100:101], v147 offset:8192
  v_mfma_f32_16x16x32_bf16 v[228:231], v[108:111], v[136:139], v[228:231]
  ds_read_b64_tr_b16 v[102:103], v147 offset:8704
  v_mfma_f32_16x16x32_bf16 v[232:235], v[112:115], v[136:139], v[232:235]
  ds_read_b32 v151, v150
  s_add_u32 s30, s30, 12288
  v_mfma_f32_16x16x32_bf16 v[236:239], v[116:119], v[136:139], v[236:239]
  buffer_load_dword off, s[64:67], s31 lds
  s_cmp_eq_u32 s30, 86016
  v_mfma_f32_16x16x32_bf16 v[252:255], v[116:119], v[140:143], v[252:255]
  s_cselect_b32 s30, 0, s30
  s_add_u32 s31, s31, 4
  v_mfma_f32_16x16x32_bf16 v[248:251], v[112:115], v[140:143], v[248:251]
  v_add_u32 v146, s30, v148
  s_add_u32 s33, s33, 1
  v_mfma_f32_16x16x32_bf16 v[244:247], v[108:111], v[140:143], v[244:247]
  v_add_u32 v147, s30, v149
  v_mfma_f32_16x16x32_bf16 v[240:243], v[104:107], v[140:143], v[240:243]
  s_waitcnt lgkmcnt(0)
  v_mfma_f32_16x16x32_bf16 v[160:163], v[80:83], v[64:67], v[160:163]
  v_cmp_lt_i32 vcc, s33, v151
  v_mfma_f32_16x16x32_bf16 v[164:167], v[80:83], v[68:71], v[164:167]
  s_cbranch_vccz .g2_kernel_q_w0
.g2_kernel_q_back0:
  v_mfma_f32_16x16x32_bf16 v[168:171], v[80:83], v[72:75], v[168:171]
  ds_read_b64_tr_b16 v[120:121], v146 offset:0
  v_mfma_f32_16x16x32_bf16 v[172:175], v[80:83], v[76:79], v[172:175]
  ds_read_b64_tr_b16 v[122:123], v146 offset:512
  v_mfma_f32_16x16x32_bf16 v[188:191], v[84:87], v[76:79], v[188:191]
  ds_read_b128 v[104:107], v145 offset:0
  v_mfma_f32_16x16x32_bf16 v[184:187], v[84:87], v[72:75], v[184:187]
  ds_read_b128 v[108:111], v145 offset:2048
  v_mfma_f32_16x16x32_bf16 v[180:183], v[84:87], v[68:71], v[180:183]
  ds_read_b128 v[112:115], v145 offset:4096
  v_mfma_f32_16x16x32_bf16 v[176:179], v[84:87], v[64:67], v[176:179]
  ds_read_b128 v[116:119], v145 offset:6144
  v_mfma_f32_16x16x32_bf16 v[192:195], v[88:91], v[64:67], v[192:195]
  ds_read_b64_tr_b16 v[124:125], v147 offset:0
  v_mfma_f32_16x16x32_bf16 v[196:199], v[88:91], v[68:71], v[196:199]
  ds_read_b64_tr_b16 v[126:127], v147 offset:512
  v_mfma_f32_16x16x32_bf16 v[200:203], v[88:91], v[72:75], v[200:203]
  ds_read_b64_tr_b16 v[128:129], v146 offset:4096
  v_mfma_f32_16x16x32_bf16 v[204:207], v[88:91], v[76:79], v[204:207]
  ds_read_b64_tr_b16 v[130:131], v146 offset:4608
  v_mfma_f32_16x16x32_bf16 v[220:223], v[92:95], v[76:79], v[220:223]
  ds_read_b64_tr_b16 v[132:133], v147 offset:4096
  v_mfma_f32_16x16x32_bf16 v[216:219], v[92:95], v[72:75], v[216:219]
  ds_read_b64_tr_b16 v[134:135], v147 offset:4608
  v_mfma_f32_16x16x32_bf16 v[212:215], v[92:95], v[68:71], v[212:215]
  ds_read_b64_tr_b16 v[136:137], v146 offset:8192
  v_mfma_f32_16x16x32_bf16 v[208:211], v[92:95], v[64:67], v[208:211]
  ds_read_b64_tr_b16 v[138:139], v146 offset:8704
  v_mfma_f32_16x16x32_bf16 v[224:227], v[64:67], v[96:99], v[224:227]
  ds_read_b64_tr_b16 v[140:141], v147 offset:8192
  v_mfma_f32_16x16x32_bf16 v[228:231], v[68:71], v[96:99], v[228:231]
  ds_read_b64_tr_b16 v[142:143], v147 offset:8704
  v_mfma_f32_16x16x32_bf16 v[232:235], v[72:75], v[96:99], v[232:235]
  ds_read_b32 v151, v150
  s_add_u32 s30, s30, 12288
  v_mfma_f32_16x16x32_bf16 v[236:239], v[76:79], v[96:99], v[236:239]
  buffer_load_dword off, s[64:67], s31 lds
  s_cmp_eq_u32 s30, 86016
  v_mfma_f32_16x16x32_bf16 v[252:255], v[76:79], v[100:103], v[252:255]
  s_cselect_b32 s30, 0, s30
  s_add_u32 s31, s31, 4
  v_mfma_f32_16x16x32_bf16 v[248:251], v[72:75], v[100:103], v[248:251]
  v_add_u32 v146, s30, v148
  s_add_u32 s33, s33, 1
  v_mfma_f32_16x16x32_bf16 v[244:247], v[68:71], v[100:103], v[244:247]
  v_add_u32 v147, s30, v149
  v_mfma_f32_16x16x32_bf16 v[240:243], v[64:67], v[100:103], v[240:243]
.g2_kernel_q_s1:
  s_waitcnt lgkmcnt(0)
  v_mfma_f32_16x16x32_bf16 v[160:163], v[120:123], v[104:107], v[160:163]
  v_cmp_lt_i32 vcc, s33, v151
  v_mfma_f32_16x16x32_bf16 v[164:167], v[120:123], v[108:111], v[164:167]
  s_cbranch_vccz .g2_kernel_q_w1
.g2_kernel_q_back1:
  v_mfma_f32_16x16x32_bf16 v[168:171], v[120:123], v[112:115], v[168:171]
  ds_read_b64_tr_b16 v[80:81], v146 offset:0
  v_mfma_f32_16x16x32_bf16 v[172:175], v[120:123], v[116:119], v[172:175]
  ds_read_b64_tr_b16 v[82:83], v146 offset:512
  v_mfma_f32_16x16x32_bf16 v[188:191], v[124:127], v[116:119], v[188:191]
  ds_read_b128 v[64:67], v144 offset:16384
  v_mfma_f32_16x16x32_bf16 v[184:187], v[124:127], v[112:115], v[184:187]
  ds_read_b128 v[68:71], v144 offset:18432
  v_mfma_f32_16x16x32_bf16 v[180:183], v[124:127], v[108:111], v[180:183]
  ds_read_b128 v[72:75], v144 offset:20480
  v_mfma_f32_16x16x32_bf16 v[176:179], v[124:127], v[104:107], v[176:179]
  ds_read_b128 v[76:79], v144 offset:22528
  v_mfma_f32_16x16x32_bf16 v[192:195], v[128:131], v[104:107], v[192:195]
  ds_read_b64_tr_b16 v[84:85], v147 offset:0
  v_mfma_f32_16x16x32_bf16 v[196:199], v[128:131], v[108:111], v[196:199]
  ds_read_b64_tr_b16 v[86:87], v147 offset:512
  v_mfma_f32_16x16x32_bf16 v[200:203], v[128:131], v[112:115], v[200:203]
  ds_read_b64_tr_b16 v[88:89], v146 offset:4096
  v_mfma_f32_16x16x32_bf16 v[204:207], v[128:131], v[116:119], v[204:207]
  ds_read_b64_tr_b16 v[90:91], v146 offset:4608
  v_mfma_f32_16x16x32_bf16 v[220:223], v[132:135], v[116:119], v[220:223]
  ds_read_b64_tr_b16 v[92:93], v147 offset:4096
  v_mfma_f32_16x16x32_bf16 v[216:219], v[132:135], v[112:115], v[216:219]
  ds_read_b64_tr_b16 v[94:95], v147 offset:4608
  v_mfma_f32_16x16x32_bf16 v[212:215], v[132:135], v[108:111], v[212:215]
  ds_read_b64_tr_b16 v[96:97], v146 offset:8192
  v_mfma_f32_16x16x32_bf16 v[208:211], v[132:135], v[104:107], v[208:211]
  ds_read_b64_tr_b16 v[98:99], v146 offset:8704
  v_mfma_f32_16x16x32_bf16 v[224:227], v[104:107], v[136:139], v[224:227]
  ds_read_b64_tr_b16 v[100:101], v147 offset:8192
  v_mfma_f32_16x16x32_bf16 v[228:231], v[108:111], v[136:139], v[228:231]
  ds_read_b64_tr_b16 v[102:103], v147 offset:8704
  v_mfma_f32_16x16x32_bf16 v[232:235], v[112:115], v[136:139], v[232:235]
  ds_read_b32 v151, v150
  s_add_u32 s30, s30, 12288
  v_mfma_f32_16x16x32_bf16 v[236:239], v[116:119], v[136:139], v[236:239]
  buffer_load_dword off, s[64:67], s31 lds
  s_cmp_eq_u32 s30, 86016
  v_mfma_f32_16x16x32_bf16 v[252:255], v[116:119], v[140:143], v[252:255]
  s_cselect_b32 s30, 0, s30
  s_add_u32 s31, s31, 4
  v_mfma_f32_16x16x32_bf16 v[248:251], v[112:115], v[140:143], v[248:251]
  v_add_u32 v146, s30, v148
  s_add_u32 s33, s33, 1
  v_mfma_f32_16x16x32_bf16 v[244:247], v[108:111], v[140:143], v[244:247]
  v_add_u32 v147, s30, v149
  v_mfma_f32_16x16x32_bf16 v[240:243], v[104:107], v[140:143], v[240:243]
  s_waitcnt lgkmcnt(0)
  v_mfma_f32_16x16x32_bf16 v[160:163], v[80:83], v[64:67], v[160:163]
  v_cmp_lt_i32 vcc, s33, v151
  v_mfma_f32_16x16x32_bf16 v[164:167], v[80:83], v[68:71], v[164:167]
  s_cbranch_vccz .g2_kernel_q_w2
.g2_kernel_q_back2:
  v_mfma_f32_16x16x32_bf16 v[168:171], v[80:83], v[72:75], v[168:171]
  ds_read_b64_tr_b16 v[120:121], v146 offset:0
  v_mfma_f32_16x16x32_bf16 v[172:175], v[80:83], v[76:79], v[172:175]
  ds_read_b64_tr_b16 v[122:123], v146 offset:512
  v_mfma_f32_16x16x32_bf16 v[188:191], v[84:87], v[76:79], v[188:191]
  ds_read_b128 v[104:107], v145 offset:16384
  v_mfma_f32_16x16x32_bf16 v[184:187], v[84:87], v[72:75], v[184:187]
  ds_read_b128 v[108:111], v145 offset:18432
  v_mfma_f32_16x16x32_bf16 v[180:183], v[84:87], v[68:71], v[180:183]
  ds_read_b128 v[112:115], v145 offset:20480
  v_mfma_f32_16x16x32_bf16 v[176:179], v[84:87], v[64:67], v[176:179]
  ds_read_b128 v[116:119], v145 offset:22528
  v_mfma_f32_16x16x32_bf16 v[192:195], v[88:91], v[64:67], v[192:195]
  ds_read_b64_tr_b16 v[124:125], v147 offset:0
  v_mfma_f32_16x16x32_bf16 v[196:199], v[88:91], v[68:71], v[196:199]
  ds_read_b64_tr_b16 v[126:127], v147 offset:512
  v_mfma_f32_16x16x32_bf16 v[200:203], v[88:91], v[72:75], v[200:203]
  ds_read_b64_tr_b16 v[128:129], v146 offset:4096
  v_mfma_f32_16x16x32_bf16 v[204:207], v[88:91], v[76:79], v[204:207]
  ds_read_b64_tr_b16 v[130:131], v146 offset:4608
  v_mfma_f32_16x16x32_bf16 v[220:223], v[92:95], v[76:79], v[220:223]
  ds_read_b64_tr_b16 v[132:133], v147 offset:4096
  v_mfma_f32_16x16x32_bf16 v[216:219], v[92:95], v[72:75], v[216:219]
  ds_read_b64_tr_b16 v[134:135], v147 offset:4608
  v_mfma_f32_16x16x32_bf16 v[212:215], v[92:95], v[68:71], v[212:215]
  ds_read_b64_tr_b16 v[136:137], v146 offset:8192
  v_mfma_f32_16x16x32_bf16 v[208:211], v[92:95], v[64:67], v[208:211]
  ds_read_b64_tr_b16 v[138:139], v146 offset:8704
  v_mfma_f32_16x16x32_bf16 v[224:227], v[64:67], v[96:99], v[224:227]
  ds_read_b64_tr_b16 v[140:141], v147 offset:8192
  v_mfma_f32_16x16x32_bf16 v[228:231], v[68:71], v[96:99], v[228:231]
  ds_read_b64_tr_b16 v[142:143], v147 offset:8704
  v_mfma_f32_16x16x32_bf16 v[232:235], v[72:75], v[96:99], v[232:235]
  ds_read_b32 v151, v150
  s_add_u32 s30, s30, 12288
  v_mfma_f32_16x16x32_bf16 v[236:239], v[76:79], v[96:99], v[236:239]
  buffer_load_dword off, s[64:67], s31 lds
  s_cmp_eq_u32 s30, 86016
  v_mfma_f32_16x16x32_bf16 v[252:255], v[76:79], v[100:103], v[252:255]
  s_cselect_b32 s30, 0, s30
  s_add_u32 s31, s31, 4
  v_mfma_f32_16x16x32_bf16 v[248:251], v[72:75], v[100:103], v[248:251]
  v_add_u32 v146, s30, v148
  s_add_u32 s33, s33, 1
  v_mfma_f32_16x16x32_bf16 v[244:247], v[68:71], v[100:103], v[244:247]
  v_add_u32 v147, s30, v149
  v_mfma_f32_16x16x32_bf16 v[240:243], v[64:67], v[100:103], v[240:243]
  s_waitcnt lgkmcnt(0)
  v_mfma_f32_16x16x32_bf16 v[160:163], v[120:123], v[104:107], v[160:163]
  v_cmp_lt_i32 vcc, s33, v151
  v_mfma_f32_16x16x32_bf16 v[164:167], v[120:123], v[108:111], v[164:167]
  s_cbranch_vccz .g2_kernel_q_w3
.g2_kernel_q_back3:
  v_mfma_f32_16x16x32_bf16 v[168:171], v[120:123], v[112:115], v[168:171]
  ds_read_b64_tr_b16 v[80:81], v146 offset:0
  v_mfma_f32_16x16x32_bf16 v[172:175], v[120:123], v[116:119], v[172:175]
  ds_read_b64_tr_b16 v[82:83], v146 offset:512
  v_mfma_f32_16x16x32_bf16 v[188:191], v[124:127], v[116:119], v[188:191]
  ds_read_b128 v[64:67], v144 offset:32768
  v_mfma_f32_16x16x32_bf16 v[184:187], v[124:127], v[112:115], v[184:187]
  ds_read_b128 v[68:71], v144 offset:34816
  v_mfma_f32_16x16x32_bf16 v[180:183], v[124:127], v[108:111], v[180:183]
  ds_read_b128 v[72:75], v144 offset:36864
  v_mfma_f32_16x16x32_bf16 v[176:179], v[124:127], v[104:107], v[176:179]
  ds_read_b128 v[76:79], v144 offset:38912
  v_mfma_f32_16x16x32_bf16 v[192:195], v[128:131], v[104:107], v[192:195]
  ds_read_b64_tr_b16 v[84:85], v147 offset:0
  v_mfma_f32_16x16x32_bf16 v[196:199], v[128:131], v[108:111], v[196:199]
  ds_read_b64_tr_b16 v[86:87], v147 offset:512
  v_mfma_f32_16x16x32_bf16 v[200:203], v[128:131], v[112:115], v[200:203]
  ds_read_b64_tr_b16 v[88:89], v146 offset:4096
  v_mfma_f32_16x16x32_bf16 v[204:207], v[128:131], v[116:119], v[204:207]
  ds_read_b64_tr_b16 v[90:91], v146 offset:4608
  v_mfma_f32_16x16x32_bf16 v[220:223], v[132:135], v[116:119], v[220:223]
  ds_read_b64_tr_b16 v[92:93], v147 offset:4096
  v_mfma_f32_16x16x32_bf16 v[216:219], v[132:135], v[112:115], v[216:219]
  ds_read_b64_tr_b16 v[94:95], v147 offset:4608
  v_mfma_f32_16x16x32_bf16 v[212:215], v[132:135], v[108:111], v[212:215]
  ds_read_b64_tr_b16 v[96:97], v146 offset:8192
  v_mfma_f32_16x16x32_bf16 v[208:211], v[132:135], v[104:107], v[208:211]
  ds_read_b64_tr_b16 v[98:99], v146 offset:8704
  v_mfma_f32_16x16x32_bf16 v[224:227], v[104:107], v[136:139], v[224:227]
  ds_read_b64_tr_b16 v[100:101], v147 offset:8192
  v_mfma_f32_16x16x32_bf16 v[228:231], v[108:111], v[136:139], v[228:231]
  ds_read_b64_tr_b16 v[102:103], v147 offset:8704
  v_mfma_f32_16x16x32_bf16 v[232:235], v[112:115], v[136:139], v[232:235]
  ds_read_b32 v151, v150
  s_add_u32 s30, s30, 12288
  v_mfma_f32_16x16x32_bf16 v[236:239], v[116:119], v[136:139], v[236:239]
  buffer_load_dword off, s[64:67], s31 lds
  s_cmp_eq_u32 s30, 86016
  v_mfma_f32_16x16x32_bf16 v[252:255], v[116:119], v[140:143], v[252:255]
  s_cselect_b32 s30, 0, s30
  s_add_u32 s31, s31, 4
  v_mfma_f32_16x16x32_bf16 v[248:251], v[112:115], v[140:143], v[248:251]
  v_add_u32 v146, s30, v148
  s_add_u32 s33, s33, 1
  v_mfma_f32_16x16x32_bf16 v[244:247], v[108:111], v[140:143], v[244:247]
  v_add_u32 v147, s30, v149
  v_mfma_f32_16x16x32_bf16 v[240:243], v[104:107], v[140:143], v[240:243]
  s_waitcnt lgkmcnt(0)
  v_mfma_f32_16x16x32_bf16 v[160:163], v[80:83], v[64:67], v[160:163]
  v_cmp_lt_i32 vcc, s33, v151
  v_mfma_f32_16x16x32_bf16 v[164:167], v[80:83], v[68:71], v[164:167]
  s_cbranch_vccz .g2_kernel_q_w4
.g2_kernel_q_back4:
  v_mfma_f32_16x16x32_bf16 v[168:171], v[80:83], v[72:75], v[168:171]
  ds_read_b64_tr_b16 v[120:121], v146 offset:0
  v_mfma_f32_16x16x32_bf16 v[172:175], v[80:83], v[76:79], v[172:175]
  ds_read_b64_tr_b16 v[122:123], v146 offset:512
  v_mfma_f32_16x16x32_bf16 v[188:191], v[84:87], v[76:79], v[188:191]
  ds_read_b128 v[104:107], v145 offset:32768
  v_mfma_f32_16x16x32_bf16 v[184:187], v[84:87], v[72:75], v[184:187]
  ds_read_b128 v[108:111], v145 offset:34816
  v_mfma_f32_16x16x32_bf16 v[180:183], v[84:87], v[68:71], v[180:183]
  ds_read_b128 v[112:115], v145 offset:36864
  v_mfma_f32_16x16x32_bf16 v[176:179], v[84:87], v[64:67], v[176:179]
  ds_read_b128 v[116:119], v145 offset:38912
  v_mfma_f32_16x16x32_bf16 v[192:195], v[88:91], v[64:67], v[192:195]
  ds_read_b64_tr_b16 v[124:125], v147 offset:0
  v_mfma_f32_16x16x32_bf16 v[196:199], v[88:91], v[68:71], v[196:199]
  ds_read_b64_tr_b16 v[126:127], v147 offset:512
  v_mfma_f32_16x16x32_bf16 v[200:203], v[88:91], v[72:75], v[200:203]
  ds_read_b64_tr_b16 v[128:129], v146 offset:4096
  v_mfma_f32_16x16x32_bf16 v[204:207], v[88:91], v[76:79], v[204:207]
  ds_read_b64_tr_b16 v[130:131], v146 offset:4608
  v_mfma_f32_16x16x32_bf16 v[220:223], v[92:95], v[76:79], v[220:223]
  ds_read_b64_tr_b16 v[132:133], v147 offset:4096
  v_mfma_f32_16x16x32_bf16 v[216:219], v[92:95], v[72:75], v[216:219]
  ds_read_b64_tr_b16 v[134:135], v147 offset:4608
  v_mfma_f32_16x16x32_bf16 v[212:215], v[92:95], v[68:71], v[212:215]
  ds_read_b64_tr_b16 v[136:137], v146 offset:8192
  v_mfma_f32_16x16x32_bf16 v[208:211], v[92:95], v[64:67], v[208:211]
  ds_read_b64_tr_b16 v[138:139], v146 offset:8704
  v_mfma_f32_16x16x32_bf16 v[224:227], v[64:67], v[96:99], v[224:227]
  ds_read_b64_tr_b16 v[140:141], v147 offset:8192
  v_mfma_f32_16x16x32_bf16 v[228:231], v[68:71], v[96:99], v[228:231]
  ds_read_b64_tr_b16 v[142:143], v147 offset:8704
  v_mfma_f32_16x16x32_bf16 v[232:235], v[72:75], v[96:99], v[232:235]
  ds_read_b32 v151, v150
  s_add_u32 s30, s30, 12288
  v_mfma_f32_16x16x32_bf16 v[236:239], v[76:79], v[96:99], v[236:239]
  buffer_load_dword off, s[64:67], s31 lds
  s_cmp_eq_u32 s30, 86016
  v_mfma_f32_16x16x32_bf16 v[252:255], v[76:79], v[100:103], v[252:255]
  s_cselect_b32 s30, 0, s30
  s_add_u32 s31, s31, 4
  v_mfma_f32_16x16x32_bf16 v[248:251], v[72:75], v[100:103], v[248:251]
  v_add_u32 v146, s30, v148
  s_add_u32 s33, s33, 1
  v_mfma_f32_16x16x32_bf16 v[244:247], v[68:71], v[100:103], v[244:247]
  v_add_u32 v147, s30, v149
  v_mfma_f32_16x16x32_bf16 v[240:243], v[64:67], v[100:103], v[240:243]
  s_waitcnt lgkmcnt(0)
  v_mfma_f32_16x16x32_bf16 v[160:163], v[120:123], v[104:107], v[160:163]
  v_cmp_lt_i32 vcc, s33, v151
  v_mfma_f32_16x16x32_bf16 v[164:167], v[120:123], v[108:111], v[164:167]
  s_cbranch_vccz .g2_kernel_q_w5
.g2_kernel_q_back5:
  v_mfma_f32_16x16x32_bf16 v[168:171], v[120:123], v[112:115], v[168:171]
  ds_read_b64_tr_b16 v[80:81], v146 offset:0
  v_mfma_f32_16x16x32_bf16 v[172:175], v[120:123], v[116:119], v[172:175]
  ds_read_b64_tr_b16 v[82:83], v146 offset:512
  v_mfma_f32_16x16x32_bf16 v[188:191], v[124:127], v[116:119], v[188:191]
  ds_read_b128 v[64:67], v144 offset:49152
  v_mfma_f32_16x16x32_bf16 v[184:187], v[124:127], v[112:115], v[184:187]
  ds_read_b128 v[68:71], v144 offset:51200
  v_mfma_f32_16x16x32_bf16 v[180:183], v[124:127], v[108:111], v[180:183]
  ds_read_b128 v[72:75], v144 offset:53248
  v_mfma_f32_16x16x32_bf16 v[176:179], v[124:127], v[104:107], v[176:179]
  ds_read_b128 v[76:79], v144 offset:55296
  v_mfma_f32_16x16x32_bf16 v[192:195], v[128:131], v[104:107], v[192:195]
  ds_read_b64_tr_b16 v[84:85], v147 offset:0
  v_mfma_f32_16x16x32_bf16 v[196:199], v[128:131], v[108:111], v[196:199]
  ds_read_b64_tr_b16 v[86:87], v147 offset:512
  v_mfma_f32_16x16x32_bf16 v[200:203], v[128:131], v[112:115], v[200:203]
  ds_read_b64_tr_b16 v[88:89], v146 offset:4096
  v_mfma_f32_16x16x32_bf16 v[204:207], v[128:131], v[116:119], v[204:207]
  ds_read_b64_tr_b16 v[90:91], v146 offset:4608
  v_mfma_f32_16x16x32_bf16 v[220:223], v[132:135], v[116:119], v[220:223]
  ds_read_b64_tr_b16 v[92:93], v147 offset:4096
  v_mfma_f32_16x16x32_bf16 v[216:219], v[132:135], v[112:115], v[216:219]
  ds_read_b64_tr_b16 v[94:95], v147 offset:4608
  v_mfma_f32_16x16x32_bf16 v[212:215], v[132:135], v[108:111], v[212:215]
  ds_read_b64_tr_b16 v[96:97], v146 offset:8192
  v_mfma_f32_16x16x32_bf16 v[208:211], v[132:135], v[104:107], v[208:211]
  ds_read_b64_tr_b16 v[98:99], v146 offset:8704
  v_mfma_f32_16x16x32_bf16 v[224:227], v[104:107], v[136:139], v[224:227]
  ds_read_b64_tr_b16 v[100:101], v147 offset:8192
  v_mfma_f32_16x16x32_bf16 v[228:231], v[108:111], v[136:139], v[228:231]
  ds_read_b64_tr_b16 v[102:103], v147 offset:8704
  v_mfma_f32_16x16x32_bf16 v[232:235], v[112:115], v[136:139], v[232:235]
  ds_read_b32 v151, v150
  s_add_u32 s30, s30, 12288
  v_mfma_f32_16x16x32_bf16 v[236:239], v[116:119], v[136:139], v[236:239]
  buffer_load_dword off, s[64:67], s31 lds
  s_cmp_eq_u32 s30, 86016
  v_mfma_f32_16x16x32_bf16 v[252:255], v[116:119], v[140:143], v[252:255]
  s_cselect_b32 s30, 0, s30
  s_add_u32 s31, s31, 4
  v_mfma_f32_16x16x32_bf16 v[248:251], v[112:115], v[140:143], v[248:251]
  v_add_u32 v146, s30, v148
  s_add_u32 s33, s33, 1
  v_mfma_f32_16x16x32_bf16 v[244:247], v[108:111], v[140:143], v[244:247]
  v_add_u32 v147, s30, v149
  v_mfma_f32_16x16x32_bf16 v[240:243], v[104:107], v[140:143], v[240:243]
  s_waitcnt lgkmcnt(0)
  v_mfma_f32_16x16x32_bf16 v[160:163], v[80:83], v[64:67], v[160:163]
  v_cmp_lt_i32 vcc, s33, v151
  v_mfma_f32_16x16x32_bf16 v[164:167], v[80:83], v[68:71], v[164:167]
  s_cbranch_vccz .g2_kernel_q_w6
.g2_kernel_q_back6:
  v_mfma_f32_16x16x32_bf16 v[168:171], v[80:83], v[72:75], v[168:171]
  ds_read_b64_tr_b16 v[120:121], v146 offset:0
  v_mfma_f32_16x16x32_bf16 v[172:175], v[80:83], v[76:79], v[172:175]
  ds_read_b64_tr_b16 v[122:123], v146 offset:512
  v_mfma_f32_16x16x32_bf16 v[188:191], v[84:87], v[76:79], v[188:191]
  ds_read_b128 v[104:107], v145 offset:49152
  v_mfma_f32_16x16x32_bf16 v[184:187], v[84:87], v[72:75], v[184:187]
  ds_read_b128 v[108:111], v145 offset:51200
  v_mfma_f32_16x16x32_bf16 v[180:183], v[84:87], v[68:71], v[180:183]
  ds_read_b128 v[112:115], v145 offset:53248
  v_mfma_f32_16x16x32_bf16 v[176:179], v[84:87], v[64:67], v[176:179]
  ds_read_b128 v[116:119], v145 offset:55296
  v_mfma_f32_16x16x32_bf16 v[192:195], v[88:91], v[64:67], v[192:195]
  ds_read_b64_tr_b16 v[124:125], v147 offset:0
  v_mfma_f32_16x16x32_bf16 v[196:199], v[88:91], v[68:71], v[196:199]
  ds_read_b64_tr_b16 v[126:127], v147 offset:512
  v_mfma_f32_16x16x32_bf16 v[200:203], v[88:91], v[72:75], v[200:203]
  ds_read_b64_tr_b16 v[128:129], v146 offset:4096
  v_mfma_f32_16x16x32_bf16 v[204:207], v[88:91], v[76:79], v[204:207]
  ds_read_b64_tr_b16 v[130:131], v146 offset:4608
  v_mfma_f32_16x16x32_bf16 v[220:223], v[92:95], v[76:79], v[220:223]
  ds_read_b64_tr_b16 v[132:133], v147 offset:4096
  v_mfma_f32_16x16x32_bf16 v[216:219], v[92:95], v[72:75], v[216:219]
  ds_read_b64_tr_b16 v[134:135], v147 offset:4608
  v_mfma_f32_16x16x32_bf16 v[212:215], v[92:95], v[68:71], v[212:215]
  ds_read_b64_tr_b16 v[136:137], v146 offset:8192
  v_mfma_f32_16x16x32_bf16 v[208:211], v[92:95], v[64:67], v[208:211]
  ds_read_b64_tr_b16 v[138:139], v146 offset:8704
  v_mfma_f32_16x16x32_bf16 v[224:227], v[64:67], v[96:99], v[224:227]
  ds_read_b64_tr_b16 v[140:141], v147 offset:8192
  v_mfma_f32_16x16x32_bf16 v[228:231], v[68:71], v[96:99], v[228:231]
  ds_read_b64_tr_b16 v[142:143], v147 offset:8704
  v_mfma_f32_16x16x32_bf16 v[232:235], v[72:75], v[96:99], v[232:235]
  ds_read_b32 v151, v150
  s_add_u32 s30, s30, 12288
  v_mfma_f32_16x16x32_bf16 v[236:239], v[76:79], v[96:99], v[236:239]
  buffer_load_dword off, s[64:67], s31 lds
  s_cmp_eq_u32 s30, 86016
  v_mfma_f32_16x16x32_bf16 v[252:255], v[76:79], v[100:103], v[252:255]
  s_cselect_b32 s30, 0, s30
  s_add_u32 s31, s31, 4
  v_mfma_f32_16x16x32_bf16 v[248:251], v[72:75], v[100:103], v[248:251]
  v_add_u32 v146, s30, v148
  s_add_u32 s33, s33, 1
  v_mfma_f32_16x16x32_bf16 v[244:247], v[68:71], v[100:103], v[244:247]
  v_add_u32 v147, s30, v149
  s_add_u32 s29, s29, 1
  v_mfma_f32_16x16x32_bf16 v[240:243], v[64:67], v[100:103], v[240:243]
  s_cmp_lg_u32 s29, 4
  s_cbranch_scc1 .g2_kernel_q_loop
  s_waitcnt lgkmcnt(0)
  v_mfma_f32_16x16x32_bf16 v[192:195], v[128:131], v[104:107], v[192:195]
  ds_read_b32 v62, v13 offset:0
  ds_read_b32 v63, v58
  v_mfma_f32_16x16x32_bf16 v[196:199], v[128:131], v[108:111], v[196:199]
  ds_read_b32 v57, v13 offset:24
  ds_read_b128 v[40:43], v52 offset:5120
  v_mfma_f32_16x16x32_bf16 v[200:203], v[128:131], v[112:115], v[200:203]
  ds_read_b128 v[44:47], v52 offset:5184
  ds_read_b32 v24, v50 offset:2816
  v_mfma_f32_16x16x32_bf16 v[204:207], v[128:131], v[116:119], v[204:207]
  ds_read_b32 v25, v50 offset:3328
  ds_read_b32 v26, v50 offset:2880
  v_mfma_f32_16x16x32_bf16 v[220:223], v[132:135], v[116:119], v[220:223]
  ds_read_b32 v27, v50 offset:3392
  ds_read_b32 v28, v50 offset:2944
  v_mfma_f32_16x16x32_bf16 v[216:219], v[132:135], v[112:115], v[216:219]
  ds_read_b32 v29, v50 offset:3456
  ds_read_b32 v30, v50 offset:3008
  v_mfma_f32_16x16x32_bf16 v[212:215], v[132:135], v[108:111], v[212:215]
  ds_read_b32 v31, v50 offset:3520
  ds_read_b128 v[64:67], v51 offset:2816
  v_mfma_f32_16x16x32_bf16 v[208:211], v[132:135], v[104:107], v[208:211]
  ds_read_b128 v[80:83], v51 offset:3328
  ds_read_b128 v[68:71], v51 offset:2880
  v_mfma_f32_16x16x32_bf16 v[224:227], v[104:107], v[136:139], v[224:227]
  ds_read_b128 v[84:87], v51 offset:3392
  v_mfma_f32_16x16x32_bf16 v[228:231], v[108:111], v[136:139], v[228:231]
  ds_read_b128 v[72:75], v51 offset:2944
  v_mfma_f32_16x16x32_bf16 v[232:235], v[112:115], v[136:139], v[232:235]
  ds_read_b128 v[88:91], v51 offset:3456
  v_mfma_f32_16x16x32_bf16 v[236:239], v[116:119], v[136:139], v[236:239]
  ds_read_b128 v[76:79], v51 offset:3008
  v_mfma_f32_16x16x32_bf16 v[252:255], v[116:119], v[140:143], v[252:255]
  ds_read_b128 v[92:95], v51 offset:3520
  v_mfma_f32_16x16x32_bf16 v[248:251], v[112:115], v[140:143], v[248:251]
  ds_read_b32 v48, v53 offset:5376
  v_mfma_f32_16x16x32_bf16 v[244:247], v[108:111], v[140:143], v[244:247]
  ds_read_b32 v49, v53 offset:5440
  v_mfma_f32_16x16x32_bf16 v[240:243], v[104:107], v[140:143], v[240:243]
  ds_read_b128 v[32:35], v52 offset:4864
  v_mfma_f32_16x16x32_bf16 v[160:163], v[120:123], v[104:107], v[160:163]
  ds_read_b128 v[36:39], v52 offset:4928
  v_mfma_f32_16x16x32_bf16 v[164:167], v[120:123], v[108:111], v[164:167]
  v_mfma_f32_16x16x32_bf16 v[168:171], v[120:123], v[112:115], v[168:171]
  v_mfma_f32_16x16x32_bf16 v[172:175], v[120:123], v[116:119], v[172:175]
  v_mfma_f32_16x16x32_bf16 v[188:191], v[124:127], v[116:119], v[188:191]
  buffer_load_dword off, s[64:67], s31 lds
  v_mfma_f32_16x16x32_bf16 v[184:187], v[124:127], v[112:115], v[184:187]
  v_mfma_f32_16x16x32_bf16 v[180:183], v[124:127], v[108:111], v[180:183]
  v_mfma_f32_16x16x32_bf16 v[176:179], v[124:127], v[104:107], v[176:179]
  s_waitcnt lgkmcnt(0)
  v_cmp_gt_u32 vcc, 2, v62
  v_cmp_gt_u32 s[14:15], s12, v63
  s_or_b64 vcc, vcc, s[14:15]
  s_cbranch_scc1 .g2_kernel_q_ew
.g2_kernel_q_eb:
  v_cmp_ne_u32 vcc, 0, v57
  s_cbranch_vccnz .g2_kernel_q_patch
.g2_kernel_q_pback:
  v_pk_mul_f32 v[152:153], v[40:41], v[24:25] op_sel:[0,1] op_sel_hi:[1,1]
  v_pk_mul_f32 v[154:155], v[42:43], v[24:25] op_sel:[0,1] op_sel_hi:[1,1]
  v_pk_mul_f32 v[156:157], v[44:45], v[24:25] op_sel:[0,1] op_sel_hi:[1,1]
  v_pk_mul_f32 v[158:159], v[46:47], v[24:25] op_sel:[0,1] op_sel_hi:[1,1]
  v_pk_fma_f32 v[192:193], v[192:193], v[24:25], v[152:153] op_sel_hi:[1,0,1]
  v_pk_fma_f32 v[194:195], v[194:195], v[24:25], v[154:155] op_sel_hi:[1,0,1]
  v_pk_fma_f32 v[208:209], v[208:209], v[24:25], v[156:157] op_sel_hi:[1,0,1]
  v_pk_fma_f32 v[210:211], v[210:211], v[24:25], v[158:159] op_sel_hi:[1,0,1]
  v_cvt_pk_bf16_f32 v192, v192, v193
  v_cvt_pk_bf16_f32 v193, v194, v195
  v_cvt_pk_bf16_f32 v194, v208, v209
  v_cvt_pk_bf16_f32 v195, v210, v211
  buffer_store_dwordx4 v[192:195], v54, s[4:7], s8 offen offset:0 sc1
  v_pk_mul_f32 v[152:153], v[40:41], v[26:27] op_sel:[0,1] op_sel_hi:[1,1]
  v_pk_mul_f32 v[154:155], v[42:43], v[26:27] op_sel:[0,1] op_sel_hi:[1,1]
  v_pk_mul_f32 v[156:157], v[44:45], v[26:27] op_sel:[0,1] op_sel_hi:[1,1]
  v_pk_mul_f32 v[158:159], v[46:47], v[26:27] op_sel:[0,1] op_sel_hi:[1,1]
  v_pk_fma_f32 v[196:197], v[196:197], v[26:27], v[152:153] op_sel_hi:[1,0,1]
  v_pk_fma_f32 v[198:199], v[198:199], v[26:27], v[154:155] op_sel_hi:[1,0,1]
  v_pk_fma_f32 v[212:213], v[212:213], v[26:27], v[156:157] op_sel_hi:[1,0,1]
  v_pk_fma_f32 v[214:215], v[214:215], v[26:27], v[158:159] op_sel_hi:[1,0,1]
  v_cvt_pk_bf16_f32 v196, v196, v197
  v_cvt_pk_bf16_f32 v197, v198, v199
  v_cvt_pk_bf16_f32 v198, v212, v213
  v_cvt_pk_bf16_f32 v199, v214, v215
  buffer_store_dwordx4 v[196:199], v54, s[4:7], s8 offen offset:128 sc1
  v_pk_mul_f32 v[152:153], v[40:41], v[28:29] op_sel:[0,1] op_sel_hi:[1,1]
  v_pk_mul_f32 v[154:155], v[42:43], v[28:29] op_sel:[0,1] op_sel_hi:[1,1]
  v_pk_mul_f32 v[156:157], v[44:45], v[28:29] op_sel:[0,1] op_sel_hi:[1,1]
  v_pk_mul_f32 v[158:159], v[46:47], v[28:29] op_sel:[0,1] op_sel_hi:[1,1]
  v_pk_fma_f32 v[200:201], v[200:201], v[28:29], v[152:153] op_sel_hi:[1,0,1]
  v_pk_fma_f32 v[202:203], v[202:203], v[28:29], v[154:155] op_sel_hi:[1,0,1]
  v_pk_fma_f32 v[216:217], v[216:217], v[28:29], v[156:157] op_sel_hi:[1,0,1]
  v_pk_fma_f32 v[218:219], v[218:219], v[28:29], v[158:159] op_sel_hi:[1,0,1]
  v_cvt_pk_bf16_f32 v200, v200, v201
  v_cvt_pk_bf16_f32 v201, v202, v203
  v_cvt_pk_bf16_f32 v202, v216, v217
  v_cvt_pk_bf16_f32 v203, v218, v219
  buffer_store_dwordx4 v[200:203], v54, s[4:7], s9 offen offset:0 sc1
  v_pk_mul_f32 v[152:153], v[40:41], v[30:31] op_sel:[0,1] op_sel_hi:[1,1]
  v_pk_mul_f32 v[154:155], v[42:43], v[30:31] op_sel:[0,1] op_sel_hi:[1,1]
  v_pk_mul_f32 v[156:157], v[44:45], v[30:31] op_sel:[0,1] op_sel_hi:[1,1]
  v_pk_mul_f32 v[158:159], v[46:47], v[30:31] op_sel:[0,1] op_sel_hi:[1,1]
  v_pk_fma_f32 v[204:205], v[204:205], v[30:31], v[152:153] op_sel_hi:[1,0,1]
  v_pk_fma_f32 v[206:207], v[206:207], v[30:31], v[154:155] op_sel_hi:[1,0,1]
  v_pk_fma_f32 v[220:221], v[220:221], v[30:31], v[156:157] op_sel_hi:[1,0,1]
  v_pk_fma_f32 v[222:223], v[222:223], v[30:31], v[158:159] op_sel_hi:[1,0,1]
  v_cvt_pk_bf16_f32 v204, v204, v205
  v_cvt_pk_bf16_f32 v205, v206, v207
  v_cvt_pk_bf16_f32 v206, v220, v221
  v_cvt_pk_bf16_f32 v207, v222, v223
  buffer_store_dwordx4 v[204:207], v54, s[4:7], s9 offen offset:128 sc1
  v_pk_mul_f32 v[152:153], v[80:81], v[48:49] op_sel:[0,0] op_sel_hi:[1,0]
  v_pk_mul_f32 v[154:155], v[82:83], v[48:49] op_sel:[0,0] op_sel_hi:[1,0]
  v_pk_mul_f32 v[156:157], v[84:85], v[48:49] op_sel:[0,0] op_sel_hi:[1,0]
  v_pk_mul_f32 v[158:159], v[86:87], v[48:49] op_sel:[0,0] op_sel_hi:[1,0]
  v_pk_fma_f32 v[224:225], v[224:225], v[64:65], v[152:153]
  v_pk_fma_f32 v[226:227], v[226:227], v[66:67], v[154:155]
  v_pk_fma_f32 v[228:229], v[228:229], v[68:69], v[156:157]
  v_pk_fma_f32 v[230:231], v[230:231], v[70:71], v[158:159]
  v_cvt_pk_bf16_f32 v224, v224, v225
  v_cvt_pk_bf16_f32 v225, v226, v227
  v_cvt_pk_bf16_f32 v226, v228, v229
  v_cvt_pk_bf16_f32 v227, v230, v231
  buffer_store_dwordx4 v[224:227], v55, s[4:7], s8 offen offset:2048 sc1
  v_pk_mul_f32 v[152:153], v[80:81], v[48:49] op_sel:[0,1] op_sel_hi:[1,1]
  v_pk_mul_f32 v[154:155], v[82:83], v[48:49] op_sel:[0,1] op_sel_hi:[1,1]
  v_pk_mul_f32 v[156:157], v[84:85], v[48:49] op_sel:[0,1] op_sel_hi:[1,1]
  v_pk_mul_f32 v[158:159], v[86:87], v[48:49] op_sel:[0,1] op_sel_hi:[1,1]
  v_pk_fma_f32 v[240:241], v[240:241], v[64:65], v[152:153]
  v_pk_fma_f32 v[242:243], v[242:243], v[66:67], v[154:155]
  v_pk_fma_f32 v[244:245], v[244:245], v[68:69], v[156:157]
  v_pk_fma_f32 v[246:247], v[246:247], v[70:71], v[158:159]
  v_cvt_pk_bf16_f32 v240, v240, v241
  v_cvt_pk_bf16_f32 v241, v242, v243
  v_cvt_pk_bf16_f32 v242, v244, v245
  v_cvt_pk_bf16_f32 v243, v246, v247
  buffer_store_dwordx4 v[240:243], v55, s[4:7], s8 offen offset:2304 sc1
  v_pk_mul_f32 v[152:153], v[88:89], v[48:49] op_sel:[0,0] op_sel_hi:[1,0]
  v_pk_mul_f32 v[154:155], v[90:91], v[48:49] op_sel:[0,0] op_sel_hi:[1,0]
  v_pk_mul_f32 v[156:157], v[92:93], v[48:49] op_sel:[0,0] op_sel_hi:[1,0]
  v_pk_mul_f32 v[158:159], v[94:95], v[48:49] op_sel:[0,0] op_sel_hi:[1,0]
  v_pk_fma_f32 v[232:233], v[232:233], v[72:73], v[152:153]
  v_pk_fma_f32 v[234:235], v[234:235], v[74:75], v[154:155]
  v_pk_fma_f32 v[236:237], v[236:237], v[76:77], v[156:157]
  v_pk_fma_f32 v[238:239], v[238:239], v[78:79], v[158:159]
  v_cvt_pk_bf16_f32 v232, v232, v233
  v_cvt_pk_bf16_f32 v233, v234, v235
  v_cvt_pk_bf16_f32 v234, v236, v237
  v_cvt_pk_bf16_f32 v235, v238, v239
  buffer_store_dwordx4 v[232:235], v55, s[4:7], s9 offen offset:2048 sc1
  v_pk_mul_f32 v[152:153], v[88:89], v[48:49] op_sel:[0,1] op_sel_hi:[1,1]
  v_pk_mul_f32 v[154:155], v[90:91], v[48:49] op_sel:[0,1] op_sel_hi:[1,1]
  v_pk_mul_f32 v[156:157], v[92:93], v[48:49] op_sel:[0,1] op_sel_hi:[1,1]
  v_pk_mul_f32 v[158:159], v[94:95], v[48:49] op_sel:[0,1] op_sel_hi:[1,1]
  v_pk_fma_f32 v[248:249], v[248:249], v[72:73], v[152:153]
  v_pk_fma_f32 v[250:251], v[250:251], v[74:75], v[154:155]
  v_pk_fma_f32 v[252:253], v[252:253], v[76:77], v[156:157]
  v_pk_fma_f32 v[254:255], v[254:255], v[78:79], v[158:159]
  v_cvt_pk_bf16_f32 v248, v248, v249
  v_cvt_pk_bf16_f32 v249, v250, v251
  v_cvt_pk_bf16_f32 v250, v252, v253
  v_cvt_pk_bf16_f32 v251, v254, v255
  buffer_store_dwordx4 v[248:251], v55, s[4:7], s9 offen offset:2304 sc1
  v_pk_mul_f32 v[24:25], v[24:25], v[56:57] op_sel_hi:[1,0]
  v_pk_mul_f32 v[26:27], v[26:27], v[56:57] op_sel_hi:[1,0]
  v_pk_mul_f32 v[28:29], v[28:29], v[56:57] op_sel_hi:[1,0]
  v_pk_mul_f32 v[30:31], v[30:31], v[56:57] op_sel_hi:[1,0]
  s_cmp_lg_u32 s10, 0
  s_cbranch_scc1 .g2_kernel_q_nk
  ds_write_b128 v59, v[192:195] offset:0
  ds_write_b128 v59, v[196:199] offset:128
  v_pk_mul_f32 v[152:153], v[32:33], v[24:25] op_sel:[0,1] op_sel_hi:[1,1]
  v_pk_mul_f32 v[154:155], v[34:35], v[24:25] op_sel:[0,1] op_sel_hi:[1,1]
  v_pk_mul_f32 v[156:157], v[36:37], v[24:25] op_sel:[0,1] op_sel_hi:[1,1]
  v_pk_mul_f32 v[158:159], v[38:39], v[24:25] op_sel:[0,1] op_sel_hi:[1,1]
  v_pk_fma_f32 v[160:161], v[160:161], v[24:25], v[152:153] op_sel_hi:[1,0,1]
  v_pk_fma_f32 v[162:163], v[162:163], v[24:25], v[154:155] op_sel_hi:[1,0,1]
  v_pk_fma_f32 v[176:177], v[176:177], v[24:25], v[156:157] op_sel_hi:[1,0,1]
  v_pk_fma_f32 v[178:179], v[178:179], v[24:25], v[158:159] op_sel_hi:[1,0,1]
  v_cvt_pk_bf16_f32 v160, v160, v161
  v_cvt_pk_bf16_f32 v161, v162, v163
  v_cvt_pk_bf16_f32 v162, v176, v177
  v_cvt_pk_bf16_f32 v163, v178, v179
  ds_write_b128 v61, v[160:163] offset:0
  ds_write_b128 v59, v[200:203] offset:4096
  ds_write_b128 v59, v[204:207] offset:4224
  v_pk_mul_f32 v[152:153], v[32:33], v[26:27] op_sel:[0,1] op_sel_hi:[1,1]
  v_pk_mul_f32 v[154:155], v[34:35], v[26:27] op_sel:[0,1] op_sel_hi:[1,1]
  v_pk_mul_f32 v[156:157], v[36:37], v[26:27] op_sel:[0,1] op_sel_hi:[1,1]
  v_pk_mul_f32 v[158:159], v[38:39], v[26:27] op_sel:[0,1] op_sel_hi:[1,1]
  v_pk_fma_f32 v[164:165], v[164:165], v[26:27], v[152:153] op_sel_hi:[1,0,1]
  v_pk_fma_f32 v[166:167], v[166:167], v[26:27], v[154:155] op_sel_hi:[1,0,1]
  v_pk_fma_f32 v[180:181], v[180:181], v[26:27], v[156:157] op_sel_hi:[1,0,1]
  v_pk_fma_f32 v[182:183], v[182:183], v[26:27], v[158:159] op_sel_hi:[1,0,1]
  v_cvt_pk_bf16_f32 v164, v164, v165
  v_cvt_pk_bf16_f32 v165, v166, v167
  v_cvt_pk_bf16_f32 v166, v180, v181
  v_cvt_pk_bf16_f32 v167, v182, v183
  ds_write_b128 v61, v[164:167] offset:256
  ds_write_b128 v60, v[224:227] offset:2048
  ds_write_b128 v60, v[240:243] offset:2304
  v_pk_mul_f32 v[152:153], v[32:33], v[28:29] op_sel:[0,1] op_sel_hi:[1,1]
  v_pk_mul_f32 v[154:155], v[34:35], v[28:29] op_sel:[0,1] op_sel_hi:[1,1]
  v_pk_mul_f32 v[156:157], v[36:37], v[28:29] op_sel:[0,1] op_sel_hi:[1,1]
  v_pk_mul_f32 v[158:159], v[38:39], v[28:29] op_sel:[0,1] op_sel_hi:[1,1]
  v_pk_fma_f32 v[168:169], v[168:169], v[28:29], v[152:153] op_sel_hi:[1,0,1]
  v_pk_fma_f32 v[170:171], v[170:171], v[28:29], v[154:155] op_sel_hi:[1,0,1]
  v_pk_fma_f32 v[184:185], v[184:185], v[28:29], v[156:157] op_sel_hi:[1,0,1]
  v_pk_fma_f32 v[186:187], v[186:187], v[28:29], v[158:159] op_sel_hi:[1,0,1]
  v_cvt_pk_bf16_f32 v168, v168, v169
  v_cvt_pk_bf16_f32 v169, v170, v171
  v_cvt_pk_bf16_f32 v170, v184, v185
  v_cvt_pk_bf16_f32 v171, v186, v187
  ds_write_b128 v61, v[168:171] offset:2048
  ds_write_b128 v60, v[232:235] offset:6144
  ds_write_b128 v60, v[248:251] offset:6400
  v_pk_mul_f32 v[152:153], v[32:33], v[30:31] op_sel:[0,1] op_sel_hi:[1,1]
  v_pk_mul_f32 v[154:155], v[34:35], v[30:31] op_sel:[0,1] op_sel_hi:[1,1]
  v_pk_mul_f32 v[156:157], v[36:37], v[30:31] op_sel:[0,1] op_sel_hi:[1,1]
  v_pk_mul_f32 v[158:159], v[38:39], v[30:31] op_sel:[0,1] op_sel_hi:[1,1]
  v_pk_fma_f32 v[172:173], v[172:173], v[30:31], v[152:153] op_sel_hi:[1,0,1]
  v_pk_fma_f32 v[174:175], v[174:175], v[30:31], v[154:155] op_sel_hi:[1,0,1]
  v_pk_fma_f32 v[188:189], v[188:189], v[30:31], v[156:157] op_sel_hi:[1,0,1]
  v_pk_fma_f32 v[190:191], v[190:191], v[30:31], v[158:159] op_sel_hi:[1,0,1]
  v_cvt_pk_bf16_f32 v172, v172, v173
  v_cvt_pk_bf16_f32 v173, v174, v175
  v_cvt_pk_bf16_f32 v174, v188, v189
  v_cvt_pk_bf16_f32 v175, v190, v191
  ds_write_b128 v61, v[172:175] offset:2304
.g2_kernel_q_kd:
  s_mov_b64 exec, 1
  ds_add_u32 v13, v5 offset:4
  s_mov_b64 exec, -1
  v_mov_b32 v120, 0
  v_mov_b32 v121, 0
  v_mov_b32 v124, 0
  v_mov_b32 v125, 0
  v_mov_b32 v128, 0
  v_mov_b32 v129, 0
  v_mov_b32 v132, 0
  v_mov_b32 v133, 0
  s_cmp_lg_u32 s62, 0
  s_cbranch_scc1 .g2_kernel_r2
  global_load_dwordx4 v[240:243], v23, s[74:75] offset:0
  global_load_dwordx4 v[244:247], v23, s[74:75] offset:32
  global_load_dwordx4 v[248:251], v23, s[74:75] offset:64
  global_load_dwordx4 v[252:255], v23, s[74:75] offset:96
.g2_kernel_r3:
  v_mov_b32 v6, s71
  s_mov_b32 s38, 0
.g2_kernel_wg2:
  ds_read_b32 v7, v6 offset:4
  s_add_u32 s38, s38, 1
  s_waitcnt lgkmcnt(0)
  v_cmp_le_u32 vcc, 4, v7
  s_cbranch_vccnz .g2_kernel_wg2d
  s_cmp_lt_u32 s38, 524288
  s_cbranch_scc1 .g2_kernel_wg2
.g2_kernel_wg2d:
  ds_read_b128 v[176:179], v9 offset:0
  ds_read_b128 v[180:183], v9 offset:1024
  ds_read_b128 v[24:27], v14 offset:8192
  ds_read_b128 v[28:31], v14 offset:9216
  ds_read_b128 v[184:187], v9 offset:2048
  ds_read_b128 v[188:191], v9 offset:3072
  ds_read_b128 v[32:35], v14 offset:10240
  ds_read_b128 v[36:39], v14 offset:11264
  ds_read_b128 v[40:43], v14 offset:12288
  ds_read_b128 v[44:47], v14 offset:13312
  ds_read_b128 v[48:51], v14 offset:14336
  ds_read_b128 v[52:55], v14 offset:15360
  s_cmp_lg_u32 s35, 0
  s_cbranch_scc1 .g2_kernel_a_own
  s_waitcnt lgkmcnt(8)
.g2_kernel_a_ob:
  v_mfma_f32_32x32x16_bf16 v[136:151], v[176:179], v[24:27], 0
  v_mfma_f32_32x32x16_bf16 v[136:151], v[180:183], v[28:31], v[136:151]
  s_waitcnt lgkmcnt(0)
  s_nop 7
  v_mfma_f32_32x32x16_bf16 v[152:167], v[176:179], v[32:35], 0
  s_nop 1
  v_exp_f32 v136, v136
  v_exp_f32 v137, v137
  v_exp_f32 v138, v138
  v_exp_f32 v139, v139
  v_exp_f32 v140, v140
  v_exp_f32 v141, v141
  v_exp_f32 v142, v142
  v_exp_f32 v143, v143
  v_mfma_f32_32x32x16_bf16 v[152:167], v[180:183], v[36:39], v[152:167]
  s_mov_b64 exec, 1
  ds_add_u32 v13, v5 offset:8
  s_mov_b64 exec, -1
  v_cvt_pk_bf16_f32 v168, v136, v137
  v_cvt_pk_bf16_f32 v169, v138, v139
  v_cvt_pk_bf16_f32 v170, v140, v141
  v_cvt_pk_bf16_f32 v171, v142, v143
  v_exp_f32 v144, v144
  v_exp_f32 v145, v145
  v_exp_f32 v146, v146
  v_exp_f32 v147, v147
  v_mfma_f32_32x32x16_bf16 v[56:71], v[184:187], v[168:171], 0
  v_exp_f32 v148, v148
  v_exp_f32 v149, v149
  v_exp_f32 v150, v150
  v_exp_f32 v151, v151
  v_cvt_pk_bf16_f32 v172, v144, v145
  v_cvt_pk_bf16_f32 v173, v146, v147
  v_cvt_pk_bf16_f32 v174, v148, v149
  v_cvt_pk_bf16_f32 v175, v150, v151
  v_mfma_f32_32x32x16_bf16 v[136:151], v[176:179], v[40:43], 0
  s_waitcnt vmcnt(4)
  s_mov_b64 exec, 1
  buffer_store_dword v15, v4, s[4:7], s37 offen sc1
  s_mov_b64 exec, -1
  v_exp_f32 v152, v152
  v_exp_f32 v153, v153
  v_exp_f32 v154, v154
  v_mfma_f32_32x32x16_bf16 v[56:71], v[188:191], v[172:175], v[56:71]
  v_exp_f32 v155, v155
  v_exp_f32 v156, v156
  v_exp_f32 v157, v157
  v_smfmac_f32_16x16x64_bf16 v[120:123], v[16:19], v[168:175], v20
  v_exp_f32 v158, v158
  v_exp_f32 v159, v159
  v_mfma_f32_32x32x16_bf16 v[136:151], v[180:183], v[44:47], v[136:151]
  v_cvt_pk_bf16_f32 v168, v152, v153
  v_cvt_pk_bf16_f32 v169, v154, v155
  v_cvt_pk_bf16_f32 v170, v156, v157
  v_cvt_pk_bf16_f32 v171, v158, v159
  v_exp_f32 v160, v160
  v_exp_f32 v161, v161
  v_exp_f32 v162, v162
  v_exp_f32 v163, v163
  v_mfma_f32_32x32x16_bf16 v[72:87], v[184:187], v[168:171], 0
  v_exp_f32 v164, v164
  v_exp_f32 v165, v165
  v_exp_f32 v166, v166
  v_exp_f32 v167, v167
  v_cvt_pk_bf16_f32 v172, v160, v161
  v_cvt_pk_bf16_f32 v173, v162, v163
  v_cvt_pk_bf16_f32 v174, v164, v165
  v_cvt_pk_bf16_f32 v175, v166, v167
  v_mfma_f32_32x32x16_bf16 v[152:167], v[176:179], v[48:51], 0
  ds_read_b32 v7, v8
  v_exp_f32 v136, v136
  v_exp_f32 v137, v137
  v_exp_f32 v138, v138
  v_mfma_f32_32x32x16_bf16 v[72:87], v[188:191], v[172:175], v[72:87]
  v_exp_f32 v139, v139
  v_exp_f32 v140, v140
  v_exp_f32 v141, v141
  v_smfmac_f32_16x16x64_bf16 v[124:127], v[16:19], v[168:175], v20
  v_exp_f32 v142, v142
  v_exp_f32 v143, v143
  v_mfma_f32_32x32x16_bf16 v[152:167], v[180:183], v[52:55], v[152:167]
  s_waitcnt lgkmcnt(0)
  v_cmp_lt_u32 vcc, s62, v7
  v_cvt_pk_bf16_f32 v168, v136, v137
  v_cvt_pk_bf16_f32 v169, v138, v139
  v_cvt_pk_bf16_f32 v170, v140, v141
  v_cvt_pk_bf16_f32 v171, v142, v143
  v_exp_f32 v144, v144
  v_exp_f32 v145, v145
  v_exp_f32 v146, v146
  v_exp_f32 v147, v147
  v_mfma_f32_32x32x16_bf16 v[88:103], v[184:187], v[168:171], 0
  s_mov_b32 s36, vcc_lo
  s_andn2_b32 s33, s36, s34
  v_exp_f32 v148, v148
  v_exp_f32 v149, v149
  v_exp_f32 v150, v150
  v_exp_f32 v151, v151
  v_cvt_pk_bf16_f32 v172, v144, v145
  v_cvt_pk_bf16_f32 v173, v146, v147
  v_cvt_pk_bf16_f32 v174, v148, v149
  v_cvt_pk_bf16_f32 v175, v150, v151
  v_exp_f32 v152, v152
  v_exp_f32 v153, v153
  v_exp_f32 v154, v154
  v_mfma_f32_32x32x16_bf16 v[88:103], v[188:191], v[172:175], v[88:103]
  s_bcnt1_i32_b32 s39, s33
  s_cmp_lt_u32 s39, 3
  v_exp_f32 v155, v155
  v_exp_f32 v156, v156
  v_exp_f32 v157, v157
  v_smfmac_f32_16x16x64_bf16 v[128:131], v[16:19], v[168:175], v20
  s_cbranch_scc1 .g2_kernel_a_F0n
  s_call_b64 s[72:73], .g2_kernel_a_three
.g2_kernel_a_F0n:
  v_exp_f32 v158, v158
  v_exp_f32 v159, v159
  v_cvt_pk_bf16_f32 v168, v152, v153
  v_cvt_pk_bf16_f32 v169, v154, v155
  v_cvt_pk_bf16_f32 v170, v156, v157
  v_cvt_pk_bf16_f32 v171, v158, v159
  v_exp_f32 v160, v160
  v_exp_f32 v161, v161
  v_exp_f32 v162, v162
  v_exp_f32 v163, v163
  v_mfma_f32_32x32x16_bf16 v[104:119], v[184:187], v[168:171], 0
  v_exp_f32 v164, v164
  v_exp_f32 v165, v165
  v_exp_f32 v166, v166
  v_exp_f32 v167, v167
  v_cvt_pk_bf16_f32 v172, v160, v161
  v_cvt_pk_bf16_f32 v173, v162, v163
  v_cvt_pk_bf16_f32 v174, v164, v165
  v_cvt_pk_bf16_f32 v175, v166, v167
  s_add_u32 s39, s39, s35
  s_cmp_ge_u32 s39, 3
  s_cbranch_scc1 .g2_kernel_a_p1
  s_call_b64 s[72:73], .g2_kernel_a_three
.g2_kernel_a_p1:
  s_waitcnt vmcnt(10)
  v_mfma_f32_32x32x16_bf16 v[136:151], v[192:195], v[24:27], 0
  v_mfma_f32_32x32x16_bf16 v[136:151], v[196:199], v[28:31], v[136:151]
  s_waitcnt vmcnt(8)
  s_mov_b32 s32, 0
  s_nop 8
  s_branch .g2_kernel_a_n1
  .p2align 6
.g2_kernel_a_loop:
  v_mfma_f32_32x32x16_bf16 v[152:167], v[176:179], v[32:35], 0
  s_andn2_b32 s33, s36, s34
  v_exp_f32 v136, v136
  v_exp_f32 v137, v137
  v_exp_f32 v138, v138
  v_mfma_f32_32x32x16_bf16 v[104:119], v[236:239], v[172:175], v[104:119]
  s_cbranch_scc0 .g2_kernel_a_N0c
.g2_kernel_a_N0b:
  v_exp_f32 v139, v139
  v_exp_f32 v140, v140
  v_exp_f32 v141, v141
  v_smfmac_f32_16x16x64_bf16 v[132:135], v[16:19], v[168:175], v20
  s_ff1_i32_b32 s33, s33
  v_exp_f32 v142, v142
  v_exp_f32 v143, v143
  v_mfma_f32_32x32x16_bf16 v[152:167], v[180:183], v[36:39], v[152:167]
  s_bitset1_b32 s34, s33
  v_cvt_pk_bf16_f32 v168, v136, v137
  v_cvt_pk_bf16_f32 v169, v138, v139
  v_cvt_pk_bf16_f32 v170, v140, v141
  v_cvt_pk_bf16_f32 v171, v142, v143
  v_exp_f32 v144, v144
  v_exp_f32 v145, v145
  v_exp_f32 v146, v146
  v_exp_f32 v147, v147
  v_mfma_f32_32x32x16_bf16 v[56:71], v[184:187], v[168:171], v[56:71]
  s_xor_b32 s33, s33, s24
  v_exp_f32 v148, v148
  v_exp_f32 v149, v149
  v_exp_f32 v150, v150
  v_exp_f32 v151, v151
  v_cvt_pk_bf16_f32 v172, v144, v145
  v_cvt_pk_bf16_f32 v173, v146, v147
  v_cvt_pk_bf16_f32 v174, v148, v149
  v_cvt_pk_bf16_f32 v175, v150, v151
  v_mfma_f32_32x32x16_bf16 v[136:151], v[176:179], v[40:43], 0
  s_lshl_b32 s33, s33, s25
  v_exp_f32 v152, v152
  v_exp_f32 v153, v153
  v_exp_f32 v154, v154
  v_mfma_f32_32x32x16_bf16 v[56:71], v[188:191], v[172:175], v[56:71]
  s_add_u32 s22, s20, s33
  v_exp_f32 v155, v155
  v_exp_f32 v156, v156
  v_exp_f32 v157, v157
  v_smfmac_f32_16x16x64_bf16 v[120:123], v[16:19], v[168:175], v20
  s_addc_u32 s23, s21, 0
  v_exp_f32 v158, v158
  v_exp_f32 v159, v159
  v_mfma_f32_32x32x16_bf16 v[136:151], v[180:183], v[44:47], v[136:151]
  global_load_dwordx4 v[224:227], v3, s[22:23] offset:0
  global_load_dwordx4 v[228:231], v3, s[22:23] offset:1024
  global_load_dwordx4 v[232:235], v3, s[22:23] offset:2048
  global_load_dwordx4 v[236:239], v3, s[22:23] offset:3072
  v_cvt_pk_bf16_f32 v168, v152, v153
  v_cvt_pk_bf16_f32 v169, v154, v155
  v_cvt_pk_bf16_f32 v170, v156, v157
  v_cvt_pk_bf16_f32 v171, v158, v159
  v_exp_f32 v160, v160
  v_exp_f32 v161, v161
  v_exp_f32 v162, v162
  v_exp_f32 v163, v163
  v_mfma_f32_32x32x16_bf16 v[72:87], v[184:187], v[168:171], v[72:87]
  v_exp_f32 v164, v164
  v_exp_f32 v165, v165
  v_exp_f32 v166, v166
  v_exp_f32 v167, v167
  v_cvt_pk_bf16_f32 v172, v160, v161
  v_cvt_pk_bf16_f32 v173, v162, v163
  v_cvt_pk_bf16_f32 v174, v164, v165
  v_cvt_pk_bf16_f32 v175, v166, v167
  v_mfma_f32_32x32x16_bf16 v[152:167], v[176:179], v[48:51], 0
  v_exp_f32 v136, v136
  v_exp_f32 v137, v137
  v_exp_f32 v138, v138
  v_mfma_f32_32x32x16_bf16 v[72:87], v[188:191], v[172:175], v[72:87]
  v_exp_f32 v139, v139
  v_exp_f32 v140, v140
  v_exp_f32 v141, v141
  v_smfmac_f32_16x16x64_bf16 v[124:127], v[16:19], v[168:175], v20
  v_exp_f32 v142, v142
  v_exp_f32 v143, v143
  v_mfma_f32_32x32x16_bf16 v[152:167], v[180:183], v[52:55], v[152:167]
  v_cvt_pk_bf16_f32 v168, v136, v137
  v_cvt_pk_bf16_f32 v169, v138, v139
  v_cvt_pk_bf16_f32 v170, v140, v141
  v_cvt_pk_bf16_f32 v171, v142, v143
  v_exp_f32 v144, v144
  v_exp_f32 v145, v145
  v_exp_f32 v146, v146
  v_exp_f32 v147, v147
  v_mfma_f32_32x32x16_bf16 v[88:103], v[184:187], v[168:171], v[88:103]
  s_waitcnt vmcnt(8)
  v_exp_f32 v148, v148
  v_exp_f32 v149, v149
  v_exp_f32 v150, v150
  v_exp_f32 v151, v151
  v_cvt_pk_bf16_f32 v172, v144, v145
  v_cvt_pk_bf16_f32 v173, v146, v147
  v_cvt_pk_bf16_f32 v174, v148, v149
  v_cvt_pk_bf16_f32 v175, v150, v151
  v_mfma_f32_32x32x16_bf16 v[136:151], v[192:195], v[24:27], 0
  v_exp_f32 v152, v152
  v_exp_f32 v153, v153
  v_exp_f32 v154, v154
  v_mfma_f32_32x32x16_bf16 v[88:103], v[188:191], v[172:175], v[88:103]
  v_exp_f32 v155, v155
  v_exp_f32 v156, v156
  v_exp_f32 v157, v157
  v_smfmac_f32_16x16x64_bf16 v[128:131], v[16:19], v[168:175], v20
  v_exp_f32 v158, v158
  v_exp_f32 v159, v159
  v_mfma_f32_32x32x16_bf16 v[136:151], v[196:199], v[28:31], v[136:151]
  v_cvt_pk_bf16_f32 v168, v152, v153
  v_cvt_pk_bf16_f32 v169, v154, v155
  v_cvt_pk_bf16_f32 v170, v156, v157
  v_cvt_pk_bf16_f32 v171, v158, v159
  v_exp_f32 v160, v160
  v_exp_f32 v161, v161
  v_exp_f32 v162, v162
  v_exp_f32 v163, v163
  v_mfma_f32_32x32x16_bf16 v[104:119], v[184:187], v[168:171], v[104:119]
  v_exp_f32 v164, v164
  v_exp_f32 v165, v165
  v_exp_f32 v166, v166
  v_exp_f32 v167, v167
  v_cvt_pk_bf16_f32 v172, v160, v161
  v_cvt_pk_bf16_f32 v173, v162, v163
  v_cvt_pk_bf16_f32 v174, v164, v165
  v_cvt_pk_bf16_f32 v175, v166, v167
.g2_kernel_a_n1:
  v_mfma_f32_32x32x16_bf16 v[152:167], v[192:195], v[32:35], 0
  s_andn2_b32 s33, s36, s34
  v_exp_f32 v136, v136
  v_exp_f32 v137, v137
  v_exp_f32 v138, v138
  v_mfma_f32_32x32x16_bf16 v[104:119], v[188:191], v[172:175], v[104:119]
  s_cbranch_scc0 .g2_kernel_a_N1c
.g2_kernel_a_N1b:
  v_exp_f32 v139, v139
  v_exp_f32 v140, v140
  v_exp_f32 v141, v141
  v_smfmac_f32_16x16x64_bf16 v[132:135], v[16:19], v[168:175], v20
  s_ff1_i32_b32 s33, s33
  v_exp_f32 v142, v142
  v_exp_f32 v143, v143
  v_mfma_f32_32x32x16_bf16 v[152:167], v[196:199], v[36:39], v[152:167]
  s_bitset1_b32 s34, s33
  v_cvt_pk_bf16_f32 v168, v136, v137
  v_cvt_pk_bf16_f32 v169, v138, v139
  v_cvt_pk_bf16_f32 v170, v140, v141
  v_cvt_pk_bf16_f32 v171, v142, v143
  v_exp_f32 v144, v144
  v_exp_f32 v145, v145
  v_exp_f32 v146, v146
  v_exp_f32 v147, v147
  v_mfma_f32_32x32x16_bf16 v[56:71], v[200:203], v[168:171], v[56:71]
  s_xor_b32 s33, s33, s24
  v_exp_f32 v148, v148
  v_exp_f32 v149, v149
  v_exp_f32 v150, v150
  v_exp_f32 v151, v151
  v_cvt_pk_bf16_f32 v172, v144, v145
  v_cvt_pk_bf16_f32 v173, v146, v147
  v_cvt_pk_bf16_f32 v174, v148, v149
  v_cvt_pk_bf16_f32 v175, v150, v151
  v_mfma_f32_32x32x16_bf16 v[136:151], v[192:195], v[40:43], 0
  s_lshl_b32 s33, s33, s25
  v_exp_f32 v152, v152
  v_exp_f32 v153, v153
  v_exp_f32 v154, v154
  v_mfma_f32_32x32x16_bf16 v[56:71], v[204:207], v[172:175], v[56:71]
  s_add_u32 s22, s20, s33
  v_exp_f32 v155, v155
  v_exp_f32 v156, v156
  v_exp_f32 v157, v157
  v_smfmac_f32_16x16x64_bf16 v[120:123], v[16:19], v[168:175], v20
  s_addc_u32 s23, s21, 0
  v_exp_f32 v158, v158
  v_exp_f32 v159, v159
  v_mfma_f32_32x32x16_bf16 v[136:151], v[196:199], v[44:47], v[136:151]
  global_load_dwordx4 v[176:179], v3, s[22:23] offset:0
  global_load_dwordx4 v[180:183], v3, s[22:23] offset:1024
  global_load_dwordx4 v[184:187], v3, s[22:23] offset:2048
  global_load_dwordx4 v[188:191], v3, s[22:23] offset:3072
  v_cvt_pk_bf16_f32 v168, v152, v153
  v_cvt_pk_bf16_f32 v169, v154, v155
  v_cvt_pk_bf16_f32 v170, v156, v157
  v_cvt_pk_bf16_f32 v171, v158, v159
  v_exp_f32 v160, v160
  v_exp_f32 v161, v161
  v_exp_f32 v162, v162
  v_exp_f32 v163, v163
  v_mfma_f32_32x32x16_bf16 v[72:87], v[200:203], v[168:171], v[72:87]
  v_exp_f32 v164, v164
  v_exp_f32 v165, v165
  v_exp_f32 v166, v166
  v_exp_f32 v167, v167
  v_cvt_pk_bf16_f32 v172, v160, v161
  v_cvt_pk_bf16_f32 v173, v162, v163
  v_cvt_pk_bf16_f32 v174, v164, v165
  v_cvt_pk_bf16_f32 v175, v166, v167
  v_mfma_f32_32x32x16_bf16 v[152:167], v[192:195], v[48:51], 0
  v_exp_f32 v136, v136
  v_exp_f32 v137, v137
  v_exp_f32 v138, v138
  v_mfma_f32_32x32x16_bf16 v[72:87], v[204:207], v[172:175], v[72:87]
  v_exp_f32 v139, v139
  v_exp_f32 v140, v140
  v_exp_f32 v141, v141
  v_smfmac_f32_16x16x64_bf16 v[124:127], v[16:19], v[168:175], v20
  v_exp_f32 v142, v142
  v_exp_f32 v143, v143
  v_mfma_f32_32x32x16_bf16 v[152:167], v[196:199], v[52:55], v[152:167]
  v_cvt_pk_bf16_f32 v168, v136, v137
  v_cvt_pk_bf16_f32 v169, v138, v139
  v_cvt_pk_bf16_f32 v170, v140, v141
  v_cvt_pk_bf16_f32 v171, v142, v143
  v_exp_f32 v144, v144
  v_exp_f32 v145, v145
  v_exp_f32 v146, v146
  v_exp_f32 v147, v147
  v_mfma_f32_32x32x16_bf16 v[88:103], v[200:203], v[168:171], v[88:103]
  s_waitcnt vmcnt(8)
  v_exp_f32 v148, v148
  v_exp_f32 v149, v149
  v_exp_f32 v150, v150
  v_exp_f32 v151, v151
  v_cvt_pk_bf16_f32 v172, v144, v145
  v_cvt_pk_bf16_f32 v173, v146, v147
  v_cvt_pk_bf16_f32 v174, v148, v149
  v_cvt_pk_bf16_f32 v175, v150, v151
  v_mfma_f32_32x32x16_bf16 v[136:151], v[208:211], v[24:27], 0
  v_exp_f32 v152, v152
  v_exp_f32 v153, v153
  v_exp_f32 v154, v154
  v_mfma_f32_32x32x16_bf16 v[88:103], v[204:207], v[172:175], v[88:103]
  v_exp_f32 v155, v155
  v_exp_f32 v156, v156
  v_exp_f32 v157, v157
  v_smfmac_f32_16x16x64_bf16 v[128:131], v[16:19], v[168:175], v20
  v_exp_f32 v158, v158
  v_exp_f32 v159, v159
  v_mfma_f32_32x32x16_bf16 v[136:151], v[212:215], v[28:31], v[136:151]
  v_cvt_pk_bf16_f32 v168, v152, v153
  v_cvt_pk_bf16_f32 v169, v154, v155
  v_cvt_pk_bf16_f32 v170, v156, v157
  v_cvt_pk_bf16_f32 v171, v158, v159
  v_exp_f32 v160, v160
  v_exp_f32 v161, v161
  v_exp_f32 v162, v162
  v_exp_f32 v163, v163
  v_mfma_f32_32x32x16_bf16 v[104:119], v[200:203], v[168:171], v[104:119]
  v_exp_f32 v164, v164
  v_exp_f32 v165, v165
  v_exp_f32 v166, v166
  v_exp_f32 v167, v167
  v_cvt_pk_bf16_f32 v172, v160, v161
  v_cvt_pk_bf16_f32 v173, v162, v163
  v_cvt_pk_bf16_f32 v174, v164, v165
  v_cvt_pk_bf16_f32 v175, v166, v167
  v_mfma_f32_32x32x16_bf16 v[152:167], v[208:211], v[32:35], 0
  s_andn2_b32 s33, s36, s34
  v_exp_f32 v136, v136
  v_exp_f32 v137, v137
  v_exp_f32 v138, v138
  v_mfma_f32_32x32x16_bf16 v[104:119], v[204:207], v[172:175], v[104:119]
  s_cbranch_scc0 .g2_kernel_a_N2c
.g2_kernel_a_N2b:
  v_exp_f32 v139, v139
  v_exp_f32 v140, v140
  v_exp_f32 v141, v141
  v_smfmac_f32_16x16x64_bf16 v[132:135], v[16:19], v[168:175], v20
  s_ff1_i32_b32 s33, s33
  v_exp_f32 v142, v142
  v_exp_f32 v143, v143
  v_mfma_f32_32x32x16_bf16 v[152:167], v[212:215], v[36:39], v[152:167]
  s_bitset1_b32 s34, s33
  v_cvt_pk_bf16_f32 v168, v136, v137
  v_cvt_pk_bf16_f32 v169, v138, v139
  v_cvt_pk_bf16_f32 v170, v140, v141
  v_cvt_pk_bf16_f32 v171, v142, v143
  v_exp_f32 v144, v144
  v_exp_f32 v145, v145
  v_exp_f32 v146, v146
  v_exp_f32 v147, v147
  v_mfma_f32_32x32x16_bf16 v[56:71], v[216:219], v[168:171], v[56:71]
  s_xor_b32 s33, s33, s24
  v_exp_f32 v148, v148
  v_exp_f32 v149, v149
  v_exp_f32 v150, v150
  v_exp_f32 v151, v151
  v_cvt_pk_bf16_f32 v172, v144, v145
  v_cvt_pk_bf16_f32 v173, v146, v147
  v_cvt_pk_bf16_f32 v174, v148, v149
  v_cvt_pk_bf16_f32 v175, v150, v151
  v_mfma_f32_32x32x16_bf16 v[136:151], v[208:211], v[40:43], 0
  s_lshl_b32 s33, s33, s25
  v_exp_f32 v152, v152
  v_exp_f32 v153, v153
  v_exp_f32 v154, v154
  v_mfma_f32_32x32x16_bf16 v[56:71], v[220:223], v[172:175], v[56:71]
  s_add_u32 s22, s20, s33
  v_exp_f32 v155, v155
  v_exp_f32 v156, v156
  v_exp_f32 v157, v157
  v_smfmac_f32_16x16x64_bf16 v[120:123], v[16:19], v[168:175], v20
  s_addc_u32 s23, s21, 0
  v_exp_f32 v158, v158
  v_exp_f32 v159, v159
  v_mfma_f32_32x32x16_bf16 v[136:151], v[212:215], v[44:47], v[136:151]
  global_load_dwordx4 v[192:195], v3, s[22:23] offset:0
  global_load_dwordx4 v[196:199], v3, s[22:23] offset:1024
  global_load_dwordx4 v[200:203], v3, s[22:23] offset:2048
  global_load_dwordx4 v[204:207], v3, s[22:23] offset:3072
  v_cvt_pk_bf16_f32 v168, v152, v153
  v_cvt_pk_bf16_f32 v169, v154, v155
  v_cvt_pk_bf16_f32 v170, v156, v157
  v_cvt_pk_bf16_f32 v171, v158, v159
  v_exp_f32 v160, v160
  v_exp_f32 v161, v161
  v_exp_f32 v162, v162
  v_exp_f32 v163, v163
  v_mfma_f32_32x32x16_bf16 v[72:87], v[216:219], v[168:171], v[72:87]
  v_exp_f32 v164, v164
  v_exp_f32 v165, v165
  v_exp_f32 v166, v166
  v_exp_f32 v167, v167
  v_cvt_pk_bf16_f32 v172, v160, v161
  v_cvt_pk_bf16_f32 v173, v162, v163
  v_cvt_pk_bf16_f32 v174, v164, v165
  v_cvt_pk_bf16_f32 v175, v166, v167
  v_mfma_f32_32x32x16_bf16 v[152:167], v[208:211], v[48:51], 0
  v_exp_f32 v136, v136
  v_exp_f32 v137, v137
  v_exp_f32 v138, v138
  v_mfma_f32_32x32x16_bf16 v[72:87], v[220:223], v[172:175], v[72:87]
  v_exp_f32 v139, v139
  v_exp_f32 v140, v140
  v_exp_f32 v141, v141
  v_smfmac_f32_16x16x64_bf16 v[124:127], v[16:19], v[168:175], v20
  v_exp_f32 v142, v142
  v_exp_f32 v143, v143
  v_mfma_f32_32x32x16_bf16 v[152:167], v[212:215], v[52:55], v[152:167]
  v_cvt_pk_bf16_f32 v168, v136, v137
  v_cvt_pk_bf16_f32 v169, v138, v139
  v_cvt_pk_bf16_f32 v170, v140, v141
  v_cvt_pk_bf16_f32 v171, v142, v143
  v_exp_f32 v144, v144
  v_exp_f32 v145, v145
  v_exp_f32 v146, v146
  v_exp_f32 v147, v147
  v_mfma_f32_32x32x16_bf16 v[88:103], v[216:219], v[168:171], v[88:103]
  s_waitcnt vmcnt(8)
  v_exp_f32 v148, v148
  v_exp_f32 v149, v149
  v_exp_f32 v150, v150
  v_exp_f32 v151, v151
  v_cvt_pk_bf16_f32 v172, v144, v145
  v_cvt_pk_bf16_f32 v173, v146, v147
  v_cvt_pk_bf16_f32 v174, v148, v149
  v_cvt_pk_bf16_f32 v175, v150, v151
  v_mfma_f32_32x32x16_bf16 v[136:151], v[224:227], v[24:27], 0
  v_exp_f32 v152, v152
  v_exp_f32 v153, v153
  v_exp_f32 v154, v154
  v_mfma_f32_32x32x16_bf16 v[88:103], v[220:223], v[172:175], v[88:103]
  v_exp_f32 v155, v155
  v_exp_f32 v156, v156
  v_exp_f32 v157, v157
  v_smfmac_f32_16x16x64_bf16 v[128:131], v[16:19], v[168:175], v20
  v_exp_f32 v158, v158
  v_exp_f32 v159, v159
  v_mfma_f32_32x32x16_bf16 v[136:151], v[228:231], v[28:31], v[136:151]
  s_and_b32 s28, s32, 3
  v_cvt_pk_bf16_f32 v168, v152, v153
  v_cvt_pk_bf16_f32 v169, v154, v155
  v_cvt_pk_bf16_f32 v170, v156, v157
  v_cvt_pk_bf16_f32 v171, v158, v159
  v_exp_f32 v160, v160
  v_exp_f32 v161, v161
  v_exp_f32 v162, v162
  v_exp_f32 v163, v163
  v_mfma_f32_32x32x16_bf16 v[104:119], v[216:219], v[168:171], v[104:119]
  s_cmp_eq_u32 s28, 3
  v_exp_f32 v164, v164
  v_exp_f32 v165, v165
  v_exp_f32 v166, v166
  v_exp_f32 v167, v167
  v_cvt_pk_bf16_f32 v172, v160, v161
  v_cvt_pk_bf16_f32 v173, v162, v163
  v_cvt_pk_bf16_f32 v174, v164, v165
  v_cvt_pk_bf16_f32 v175, v166, v167
  s_cbranch_scc1 .g2_kernel_a_last
  v_mfma_f32_32x32x16_bf16 v[152:167], v[224:227], v[32:35], 0
  s_andn2_b32 s33, s36, s34
  v_exp_f32 v136, v136
  v_exp_f32 v137, v137
  v_exp_f32 v138, v138
  v_mfma_f32_32x32x16_bf16 v[104:119], v[220:223], v[172:175], v[104:119]
  s_cbranch_scc0 .g2_kernel_a_N3c
.g2_kernel_a_N3b:
  v_exp_f32 v139, v139
  v_exp_f32 v140, v140
  v_exp_f32 v141, v141
  v_smfmac_f32_16x16x64_bf16 v[132:135], v[16:19], v[168:175], v20
  s_ff1_i32_b32 s33, s33
  v_exp_f32 v142, v142
  v_exp_f32 v143, v143
  v_mfma_f32_32x32x16_bf16 v[152:167], v[228:231], v[36:39], v[152:167]
  s_bitset1_b32 s34, s33
  v_cvt_pk_bf16_f32 v168, v136, v137
  v_cvt_pk_bf16_f32 v169, v138, v139
  v_cvt_pk_bf16_f32 v170, v140, v141
  v_cvt_pk_bf16_f32 v171, v142, v143
  v_exp_f32 v144, v144
  v_exp_f32 v145, v145
  v_exp_f32 v146, v146
  v_exp_f32 v147, v147
  v_mfma_f32_32x32x16_bf16 v[56:71], v[232:235], v[168:171], v[56:71]
  s_xor_b32 s33, s33, s24
  v_exp_f32 v148, v148
  v_exp_f32 v149, v149
  v_exp_f32 v150, v150
  v_exp_f32 v151, v151
  v_cvt_pk_bf16_f32 v172, v144, v145
  v_cvt_pk_bf16_f32 v173, v146, v147
  v_cvt_pk_bf16_f32 v174, v148, v149
  v_cvt_pk_bf16_f32 v175, v150, v151
  v_mfma_f32_32x32x16_bf16 v[136:151], v[224:227], v[40:43], 0
  s_lshl_b32 s33, s33, s25
  v_exp_f32 v152, v152
  v_exp_f32 v153, v153
  v_exp_f32 v154, v154
  v_mfma_f32_32x32x16_bf16 v[56:71], v[236:239], v[172:175], v[56:71]
  s_add_u32 s22, s20, s33
  v_exp_f32 v155, v155
  v_exp_f32 v156, v156
  v_exp_f32 v157, v157
  v_smfmac_f32_16x16x64_bf16 v[120:123], v[16:19], v[168:175], v20
  s_addc_u32 s23, s21, 0
  v_exp_f32 v158, v158
  v_exp_f32 v159, v159
  v_mfma_f32_32x32x16_bf16 v[136:151], v[228:231], v[44:47], v[136:151]
  global_load_dwordx4 v[208:211], v3, s[22:23] offset:0
  global_load_dwordx4 v[212:215], v3, s[22:23] offset:1024
  global_load_dwordx4 v[216:219], v3, s[22:23] offset:2048
  global_load_dwordx4 v[220:223], v3, s[22:23] offset:3072
  v_cvt_pk_bf16_f32 v168, v152, v153
  v_cvt_pk_bf16_f32 v169, v154, v155
  v_cvt_pk_bf16_f32 v170, v156, v157
  v_cvt_pk_bf16_f32 v171, v158, v159
  v_exp_f32 v160, v160
  v_exp_f32 v161, v161
  v_exp_f32 v162, v162
  v_exp_f32 v163, v163
  v_mfma_f32_32x32x16_bf16 v[72:87], v[232:235], v[168:171], v[72:87]
  v_exp_f32 v164, v164
  v_exp_f32 v165, v165
  v_exp_f32 v166, v166
  v_exp_f32 v167, v167
  v_cvt_pk_bf16_f32 v172, v160, v161
  v_cvt_pk_bf16_f32 v173, v162, v163
  v_cvt_pk_bf16_f32 v174, v164, v165
  v_cvt_pk_bf16_f32 v175, v166, v167
  v_mfma_f32_32x32x16_bf16 v[152:167], v[224:227], v[48:51], 0
  v_exp_f32 v136, v136
  v_exp_f32 v137, v137
  v_exp_f32 v138, v138
  v_mfma_f32_32x32x16_bf16 v[72:87], v[236:239], v[172:175], v[72:87]
  v_exp_f32 v139, v139
  v_exp_f32 v140, v140
  v_exp_f32 v141, v141
  v_smfmac_f32_16x16x64_bf16 v[124:127], v[16:19], v[168:175], v20
  v_exp_f32 v142, v142
  v_exp_f32 v143, v143
  v_mfma_f32_32x32x16_bf16 v[152:167], v[228:231], v[52:55], v[152:167]
  v_cvt_pk_bf16_f32 v168, v136, v137
  v_cvt_pk_bf16_f32 v169, v138, v139
  v_cvt_pk_bf16_f32 v170, v140, v141
  v_cvt_pk_bf16_f32 v171, v142, v143
  v_exp_f32 v144, v144
  v_exp_f32 v145, v145
  v_exp_f32 v146, v146
  v_exp_f32 v147, v147
  v_mfma_f32_32x32x16_bf16 v[88:103], v[232:235], v[168:171], v[88:103]
  s_waitcnt vmcnt(8)
  v_exp_f32 v148, v148
  v_exp_f32 v149, v149
  v_exp_f32 v150, v150
  v_exp_f32 v151, v151
  v_cvt_pk_bf16_f32 v172, v144, v145
  v_cvt_pk_bf16_f32 v173, v146, v147
  v_cvt_pk_bf16_f32 v174, v148, v149
  v_cvt_pk_bf16_f32 v175, v150, v151
  v_mfma_f32_32x32x16_bf16 v[136:151], v[176:179], v[24:27], 0
  v_exp_f32 v152, v152
  v_exp_f32 v153, v153
  v_exp_f32 v154, v154
  v_mfma_f32_32x32x16_bf16 v[88:103], v[236:239], v[172:175], v[88:103]
  v_exp_f32 v155, v155
  v_exp_f32 v156, v156
  v_exp_f32 v157, v157
  v_smfmac_f32_16x16x64_bf16 v[128:131], v[16:19], v[168:175], v20
  v_exp_f32 v158, v158
  v_exp_f32 v159, v159
  v_mfma_f32_32x32x16_bf16 v[136:151], v[180:183], v[28:31], v[136:151]
  s_add_u32 s32, s32, 1
  v_cvt_pk_bf16_f32 v168, v152, v153
  v_cvt_pk_bf16_f32 v169, v154, v155
  v_cvt_pk_bf16_f32 v170, v156, v157
  v_cvt_pk_bf16_f32 v171, v158, v159
  v_exp_f32 v160, v160
  v_exp_f32 v161, v161
  v_exp_f32 v162, v162
  v_exp_f32 v163, v163
  v_mfma_f32_32x32x16_bf16 v[104:119], v[232:235], v[168:171], v[104:119]
  s_cmp_eq_u32 s35, 0
  v_exp_f32 v164, v164
  v_exp_f32 v165, v165
  v_exp_f32 v166, v166
  v_exp_f32 v167, v167
  v_cvt_pk_bf16_f32 v172, v160, v161
  v_cvt_pk_bf16_f32 v173, v162, v163
  v_cvt_pk_bf16_f32 v174, v164, v165
  v_cvt_pk_bf16_f32 v175, v166, v167
  s_cbranch_scc1 .g2_kernel_a_loop
  s_branch .g2_kernel_a_redo
.g2_kernel_a_last:
  v_mfma_f32_32x32x16_bf16 v[152:167], v[224:227], v[32:35], 0
  ds_read_b32 v21, v13 offset:8
  s_andn2_b32 s33, s36, s34
  v_exp_f32 v136, v136
  v_exp_f32 v137, v137
  v_exp_f32 v138, v138
  v_mfma_f32_32x32x16_bf16 v[104:119], v[220:223], v[172:175], v[104:119]
  s_cbranch_scc0 .g2_kernel_a_L3c
.g2_kernel_a_L3b:
  v_exp_f32 v139, v139
  v_exp_f32 v140, v140
  v_exp_f32 v141, v141
  v_smfmac_f32_16x16x64_bf16 v[132:135], v[16:19], v[168:175], v20
  s_ff1_i32_b32 s33, s33
  v_exp_f32 v142, v142
  v_exp_f32 v143, v143
  v_mfma_f32_32x32x16_bf16 v[152:167], v[228:231], v[36:39], v[152:167]
  s_bitset1_b32 s34, s33
  ds_read_b128 v[24:27], v14 offset:0
  v_cvt_pk_bf16_f32 v168, v136, v137
  v_cvt_pk_bf16_f32 v169, v138, v139
  v_cvt_pk_bf16_f32 v170, v140, v141
  v_cvt_pk_bf16_f32 v171, v142, v143
  v_exp_f32 v144, v144
  v_exp_f32 v145, v145
  v_exp_f32 v146, v146
  v_exp_f32 v147, v147
  v_mfma_f32_32x32x16_bf16 v[56:71], v[232:235], v[168:171], v[56:71]
  s_xor_b32 s33, s33, s24
  ds_read_b128 v[28:31], v14 offset:1024
  v_exp_f32 v148, v148
  v_exp_f32 v149, v149
  v_exp_f32 v150, v150
  v_exp_f32 v151, v151
  v_cvt_pk_bf16_f32 v172, v144, v145
  v_cvt_pk_bf16_f32 v173, v146, v147
  v_cvt_pk_bf16_f32 v174, v148, v149
  v_cvt_pk_bf16_f32 v175, v150, v151
  v_mfma_f32_32x32x16_bf16 v[136:151], v[224:227], v[40:43], 0
  s_waitcnt lgkmcnt(2)
  s_lshl_b32 s33, s33, s25
  v_exp_f32 v152, v152
  v_exp_f32 v153, v153
  v_exp_f32 v154, v154
  v_mfma_f32_32x32x16_bf16 v[56:71], v[236:239], v[172:175], v[56:71]
  v_cmp_gt_u32 vcc, s27, v21
  s_add_u32 s22, s20, s33
  v_exp_f32 v155, v155
  v_exp_f32 v156, v156
  v_exp_f32 v157, v157
  v_smfmac_f32_16x16x64_bf16 v[120:123], v[16:19], v[168:175], v20
  s_addc_u32 s23, s21, 0
  v_exp_f32 v158, v158
  v_exp_f32 v159, v159
  v_mfma_f32_32x32x16_bf16 v[136:151], v[228:231], v[44:47], v[136:151]
  global_load_dwordx4 v[208:211], v3, s[22:23] offset:0
  global_load_dwordx4 v[212:215], v3, s[22:23] offset:1024
  global_load_dwordx4 v[216:219], v3, s[22:23] offset:2048
  global_load_dwordx4 v[220:223], v3, s[22:23] offset:3072
  v_cvt_pk_bf16_f32 v168, v152, v153
  v_cvt_pk_bf16_f32 v169, v154, v155
  v_cvt_pk_bf16_f32 v170, v156, v157
  v_cvt_pk_bf16_f32 v171, v158, v159
  v_exp_f32 v160, v160
  v_exp_f32 v161, v161
  v_exp_f32 v162, v162
  v_exp_f32 v163, v163
  v_mfma_f32_32x32x16_bf16 v[72:87], v[232:235], v[168:171], v[72:87]
  s_cbranch_vccnz .g2_kernel_a_L3g
.g2_kernel_a_L3h:
  ds_read_b128 v[32:35], v14 offset:2048
  ds_read_b128 v[36:39], v14 offset:3072
  ds_write_b128 v9, v[56:59] offset:0
  v_add_f32 v6, v120, v121
  ds_write_b128 v9, v[60:63] offset:1024
  v_mov_b32 v120, 0
  v_exp_f32 v164, v164
  v_exp_f32 v165, v165
  v_exp_f32 v166, v166
  v_exp_f32 v167, v167
  v_cvt_pk_bf16_f32 v172, v160, v161
  v_cvt_pk_bf16_f32 v173, v162, v163
  v_cvt_pk_bf16_f32 v174, v164, v165
  v_cvt_pk_bf16_f32 v175, v166, v167
  v_mfma_f32_32x32x16_bf16 v[152:167], v[224:227], v[48:51], 0
  ds_write_b128 v9, v[64:67] offset:2048
  v_mov_b32 v121, 0
  v_exp_f32 v136, v136
  v_exp_f32 v137, v137
  v_exp_f32 v138, v138
  v_mfma_f32_32x32x16_bf16 v[72:87], v[236:239], v[172:175], v[72:87]
  ds_write_b128 v9, v[68:71] offset:3072
  ds_write_b32 v10, v6 offset:0
  ds_write_b32 v11, v12 offset:0
  v_exp_f32 v139, v139
  v_exp_f32 v140, v140
  v_exp_f32 v141, v141
  v_smfmac_f32_16x16x64_bf16 v[124:127], v[16:19], v[168:175], v20
  v_exp_f32 v142, v142
  v_exp_f32 v143, v143
  v_mfma_f32_32x32x16_bf16 v[152:167], v[228:231], v[52:55], v[152:167]
  ds_read_b128 v[40:43], v14 offset:4096
  s_wakeup
  v_cvt_pk_bf16_f32 v168, v136, v137
  v_cvt_pk_bf16_f32 v169, v138, v139
  v_cvt_pk_bf16_f32 v170, v140, v141
  v_cvt_pk_bf16_f32 v171, v142, v143
  v_exp_f32 v144, v144
  v_exp_f32 v145, v145
  v_exp_f32 v146, v146
  v_exp_f32 v147, v147
  v_mfma_f32_32x32x16_bf16 v[88:103], v[232:235], v[168:171], v[88:103]
  s_waitcnt vmcnt(8)
  ds_read_b128 v[44:47], v14 offset:5120
  ds_write_b128 v9, v[72:75] offset:16384
  v_add_f32 v6, v124, v125
  ds_write_b128 v9, v[76:79] offset:17408
  v_mov_b32 v124, 0
  v_exp_f32 v148, v148
  v_exp_f32 v149, v149
  v_exp_f32 v150, v150
  v_exp_f32 v151, v151
  v_cvt_pk_bf16_f32 v172, v144, v145
  v_cvt_pk_bf16_f32 v173, v146, v147
  v_cvt_pk_bf16_f32 v174, v148, v149
  v_cvt_pk_bf16_f32 v175, v150, v151
  s_waitcnt lgkmcnt(12)
  v_mfma_f32_32x32x16_bf16 v[136:151], v[176:179], v[24:27], 0
  ds_write_b128 v9, v[80:83] offset:18432
  v_mov_b32 v125, 0
  v_exp_f32 v152, v152
  v_exp_f32 v153, v153
  v_exp_f32 v154, v154
  v_mfma_f32_32x32x16_bf16 v[88:103], v[236:239], v[172:175], v[88:103]
  ds_write_b128 v9, v[84:87] offset:19456
  ds_write_b32 v10, v6 offset:512
  ds_write_b32 v11, v12 offset:16
  v_exp_f32 v155, v155
  v_exp_f32 v156, v156
  v_exp_f32 v157, v157
  v_smfmac_f32_16x16x64_bf16 v[128:131], v[16:19], v[168:175], v20
  v_exp_f32 v158, v158
  v_exp_f32 v159, v159
  v_mfma_f32_32x32x16_bf16 v[136:151], v[180:183], v[28:31], v[136:151]
  ds_read_b128 v[48:51], v14 offset:6144
  v_cvt_pk_bf16_f32 v168, v152, v153
  v_cvt_pk_bf16_f32 v169, v154, v155
  v_cvt_pk_bf16_f32 v170, v156, v157
  v_cvt_pk_bf16_f32 v171, v158, v159
  v_exp_f32 v160, v160
  v_exp_f32 v161, v161
  v_exp_f32 v162, v162
  v_exp_f32 v163, v163
  v_mfma_f32_32x32x16_bf16 v[104:119], v[232:235], v[168:171], v[104:119]
  ds_read_b128 v[52:55], v14 offset:7168
  ds_write_b128 v9, v[88:91] offset:32768
  v_add_f32 v6, v128, v129
  ds_write_b128 v9, v[92:95] offset:33792
  v_mov_b32 v128, 0
  ds_write_b128 v9, v[96:99] offset:34816
  v_mov_b32 v129, 0
  ds_write_b128 v9, v[100:103] offset:35840
  ds_write_b32 v10, v6 offset:1024
  ds_write_b32 v11, v12 offset:32
  s_add_u32 s32, s32, 1
  v_exp_f32 v164, v164
  v_exp_f32 v165, v165
  v_exp_f32 v166, v166
  v_exp_f32 v167, v167
  v_cvt_pk_bf16_f32 v172, v160, v161
  v_cvt_pk_bf16_f32 v173, v162, v163
  v_cvt_pk_bf16_f32 v174, v164, v165
  v_cvt_pk_bf16_f32 v175, v166, v167
  s_cmp_eq_u32 s32, 8
  s_cbranch_scc1 .g2_kernel_a_end
  s_waitcnt lgkmcnt(15)
  v_mfma_f32_32x32x16_bf16 v[152:167], v[176:179], v[32:35], 0
  s_andn2_b32 s33, s36, s34
  v_exp_f32 v136, v136
  v_exp_f32 v137, v137
  v_exp_f32 v138, v138
  v_mfma_f32_32x32x16_bf16 v[104:119], v[236:239], v[172:175], v[104:119]
  s_cbranch_scc0 .g2_kernel_a_G0c
.g2_kernel_a_G0b:
  v_exp_f32 v139, v139
  v_exp_f32 v140, v140
  v_exp_f32 v141, v141
  v_smfmac_f32_16x16x64_bf16 v[132:135], v[16:19], v[168:175], v20
  s_ff1_i32_b32 s33, s33
  v_exp_f32 v142, v142
  v_exp_f32 v143, v143
  v_mfma_f32_32x32x16_bf16 v[152:167], v[180:183], v[36:39], v[152:167]
  s_bitset1_b32 s34, s33
  v_cvt_pk_bf16_f32 v168, v136, v137
  v_cvt_pk_bf16_f32 v169, v138, v139
  v_cvt_pk_bf16_f32 v170, v140, v141
  v_cvt_pk_bf16_f32 v171, v142, v143
  v_exp_f32 v144, v144
  v_exp_f32 v145, v145
  v_exp_f32 v146, v146
  v_exp_f32 v147, v147
  s_waitcnt lgkmcnt(15)
  v_mfma_f32_32x32x16_bf16 v[56:71], v[184:187], v[168:171], 0
  s_xor_b32 s33, s33, s24
  ds_write_b128 v9, v[104:107] offset:49152
  v_add_f32 v6, v132, v133
  v_exp_f32 v148, v148
  v_exp_f32 v149, v149
  v_exp_f32 v150, v150
  v_exp_f32 v151, v151
  v_cvt_pk_bf16_f32 v172, v144, v145
  v_cvt_pk_bf16_f32 v173, v146, v147
  v_cvt_pk_bf16_f32 v174, v148, v149
  v_cvt_pk_bf16_f32 v175, v150, v151
  s_waitcnt lgkmcnt(15)
  v_mfma_f32_32x32x16_bf16 v[136:151], v[176:179], v[40:43], 0
  s_lshl_b32 s33, s33, s25
  ds_write_b128 v9, v[108:111] offset:50176
  v_mov_b32 v132, 0
  v_exp_f32 v152, v152
  v_exp_f32 v153, v153
  v_exp_f32 v154, v154
  v_mfma_f32_32x32x16_bf16 v[56:71], v[188:191], v[172:175], v[56:71]
  s_add_u32 s22, s20, s33
  ds_write_b128 v9, v[112:115] offset:51200
  v_mov_b32 v133, 0
  v_exp_f32 v155, v155
  v_exp_f32 v156, v156
  v_exp_f32 v157, v157
  v_smfmac_f32_16x16x64_bf16 v[120:123], v[16:19], v[168:175], v20
  s_addc_u32 s23, s21, 0
  ds_write_b128 v9, v[116:119] offset:52224
  v_exp_f32 v158, v158
  v_exp_f32 v159, v159
  v_mfma_f32_32x32x16_bf16 v[136:151], v[180:183], v[44:47], v[136:151]
  global_load_dwordx4 v[224:227], v3, s[22:23] offset:0
  global_load_dwordx4 v[228:231], v3, s[22:23] offset:1024
  global_load_dwordx4 v[232:235], v3, s[22:23] offset:2048
  global_load_dwordx4 v[236:239], v3, s[22:23] offset:3072
  v_cvt_pk_bf16_f32 v168, v152, v153
  v_cvt_pk_bf16_f32 v169, v154, v155
  v_cvt_pk_bf16_f32 v170, v156, v157
  v_cvt_pk_bf16_f32 v171, v158, v159
  v_exp_f32 v160, v160
  v_exp_f32 v161, v161
  v_exp_f32 v162, v162
  v_exp_f32 v163, v163
  s_waitcnt lgkmcnt(14)
  v_mfma_f32_32x32x16_bf16 v[72:87], v[184:187], v[168:171], 0
  ds_write_b32 v10, v6 offset:1536
  ds_write_b32 v11, v12 offset:48
  v_exp_f32 v164, v164
  v_exp_f32 v165, v165
  v_exp_f32 v166, v166
  v_exp_f32 v167, v167
  v_cvt_pk_bf16_f32 v172, v160, v161
  v_cvt_pk_bf16_f32 v173, v162, v163
  v_cvt_pk_bf16_f32 v174, v164, v165
  v_cvt_pk_bf16_f32 v175, v166, v167
  s_waitcnt lgkmcnt(12)
  v_mfma_f32_32x32x16_bf16 v[152:167], v[176:179], v[48:51], 0
  v_add_u32 v12, 1, v12
  v_exp_f32 v136, v136
  v_exp_f32 v137, v137
  v_exp_f32 v138, v138
  v_mfma_f32_32x32x16_bf16 v[72:87], v[188:191], v[172:175], v[72:87]
  v_exp_f32 v139, v139
  v_exp_f32 v140, v140
  v_exp_f32 v141, v141
  v_smfmac_f32_16x16x64_bf16 v[124:127], v[16:19], v[168:175], v20
  s_mov_b32 s27, 8
  v_exp_f32 v142, v142
  v_exp_f32 v143, v143
  v_mfma_f32_32x32x16_bf16 v[152:167], v[180:183], v[52:55], v[152:167]
  v_cvt_pk_bf16_f32 v168, v136, v137
  v_cvt_pk_bf16_f32 v169, v138, v139
  v_cvt_pk_bf16_f32 v170, v140, v141
  v_cvt_pk_bf16_f32 v171, v142, v143
  v_exp_f32 v144, v144
  v_exp_f32 v145, v145
  v_exp_f32 v146, v146
  v_exp_f32 v147, v147
  s_waitcnt lgkmcnt(8)
  v_mfma_f32_32x32x16_bf16 v[88:103], v[184:187], v[168:171], 0
  s_waitcnt vmcnt(8)
  v_exp_f32 v148, v148
  v_exp_f32 v149, v149
  v_exp_f32 v150, v150
  v_exp_f32 v151, v151
  v_cvt_pk_bf16_f32 v172, v144, v145
  v_cvt_pk_bf16_f32 v173, v146, v147
  v_cvt_pk_bf16_f32 v174, v148, v149
  v_cvt_pk_bf16_f32 v175, v150, v151
  v_mfma_f32_32x32x16_bf16 v[136:151], v[192:195], v[24:27], 0
  v_exp_f32 v152, v152
  v_exp_f32 v153, v153
  v_exp_f32 v154, v154
  v_mfma_f32_32x32x16_bf16 v[88:103], v[188:191], v[172:175], v[88:103]
  v_exp_f32 v155, v155
  v_exp_f32 v156, v156
  v_exp_f32 v157, v157
  v_smfmac_f32_16x16x64_bf16 v[128:131], v[16:19], v[168:175], v20
  v_exp_f32 v158, v158
  v_exp_f32 v159, v159
  v_mfma_f32_32x32x16_bf16 v[136:151], v[196:199], v[28:31], v[136:151]
  v_cvt_pk_bf16_f32 v168, v152, v153
  v_cvt_pk_bf16_f32 v169, v154, v155
  v_cvt_pk_bf16_f32 v170, v156, v157
  v_cvt_pk_bf16_f32 v171, v158, v159
  v_exp_f32 v160, v160
  v_exp_f32 v161, v161
  v_exp_f32 v162, v162
  v_exp_f32 v163, v163
  s_waitcnt lgkmcnt(2)
  v_mfma_f32_32x32x16_bf16 v[104:119], v[184:187], v[168:171], 0
  v_exp_f32 v164, v164
  v_exp_f32 v165, v165
  v_exp_f32 v166, v166
  v_exp_f32 v167, v167
  v_cvt_pk_bf16_f32 v172, v160, v161
  v_cvt_pk_bf16_f32 v173, v162, v163
  v_cvt_pk_bf16_f32 v174, v164, v165
  v_cvt_pk_bf16_f32 v175, v166, v167
  s_branch .g2_kernel_a_n1
.g2_kernel_a_end:
  v_mfma_f32_32x32x16_bf16 v[104:119], v[236:239], v[172:175], v[104:119]
  v_smfmac_f32_16x16x64_bf16 v[132:135], v[16:19], v[168:175], v20
  s_nop 10
  ds_write_b128 v9, v[104:107] offset:49152
  v_add_f32 v6, v132, v133
  ds_write_b128 v9, v[108:111] offset:50176
  v_mov_b32 v132, 0
  ds_write_b128 v9, v[112:115] offset:51200
  v_mov_b32 v133, 0
  ds_write_b128 v9, v[116:119] offset:52224
  ds_write_b32 v10, v6 offset:1536
  ds_write_b32 v11, v12 offset:48
  s_waitcnt lgkmcnt(6)
  v_mov_b32 v20, s71
  v_lshrrev_b32 v17, 5, v2
  v_and_b32 v18, 31, v2
  s_lshl_b32 s28, s16, 5
  v_add_u32 v19, s28, v18
  v_lshlrev_b32 v7, 2, v19
  v_add_u32 v7, 155648, v7
  ds_read_b32 v8, v7 offset:3840
  ds_read_b32 v9, v7 offset:4352
  ds_read_b32 v16, v20 offset:24
  ds_read_b32 v6, v20 offset:52
  v_add_u32 v19, 1, v19
  v_bfe_u32 v7, v2, 2, 2
  v_lshl_add_u32 v14, v17, 2, v7
  v_lshlrev_b32 v14, 7, v14
  v_lshrrev_b32 v7, 1, v7
  v_lshl_add_u32 v14, v7, 6, v14
  v_bfe_u32 v7, v2, 4, 1
  v_lshl_add_u32 v14, v7, 5, v14
  v_and_b32 v7, 1, v2
  v_lshl_add_u32 v14, v7, 4, v14
  v_bfe_u32 v7, v2, 1, 1
  v_lshl_add_u32 v14, v7, 3, v14
  v_xor_b32 v15, 64, v14
  v_and_b32 v7, 7, v2
  v_xor_b32 v7, s24, v7
  s_lshl_b32 s28, s16, 6
  s_add_u32 s28, s28, 157952
  v_lshl_add_u32 v21, v7, 3, s28
  v_lshlrev_b32 v24, 16, v240
  v_and_b32 v25, 0xffff0000, v240
  v_lshlrev_b32 v26, 16, v241
  v_and_b32 v27, 0xffff0000, v241
  v_lshlrev_b32 v28, 16, v242
  v_and_b32 v29, 0xffff0000, v242
  v_lshlrev_b32 v30, 16, v243
  v_and_b32 v31, 0xffff0000, v243
  v_lshlrev_b32 v32, 16, v244
  v_and_b32 v33, 0xffff0000, v244
  v_lshlrev_b32 v34, 16, v245
  v_and_b32 v35, 0xffff0000, v245
  v_lshlrev_b32 v36, 16, v246
  v_and_b32 v37, 0xffff0000, v246
  v_lshlrev_b32 v38, 16, v247
  v_and_b32 v39, 0xffff0000, v247
  v_lshlrev_b32 v40, 16, v248
  v_and_b32 v41, 0xffff0000, v248
  v_lshlrev_b32 v42, 16, v249
  v_and_b32 v43, 0xffff0000, v249
  v_lshlrev_b32 v44, 16, v250
  v_and_b32 v45, 0xffff0000, v250
  v_lshlrev_b32 v46, 16, v251
  v_and_b32 v47, 0xffff0000, v251
  v_lshlrev_b32 v48, 16, v252
  v_and_b32 v49, 0xffff0000, v252
  v_lshlrev_b32 v50, 16, v253
  v_and_b32 v51, 0xffff0000, v253
  v_lshlrev_b32 v52, 16, v254
  v_and_b32 v53, 0xffff0000, v254
  v_lshlrev_b32 v54, 16, v255
  v_and_b32 v55, 0xffff0000, v255
  s_waitcnt lgkmcnt(0)
  v_cmp_gt_u32 vcc, 4, v6
  s_cbranch_vccnz .g2_kernel_w_aw
.g2_kernel_w_ab:
  s_xor_b32 s28, s24, 0
  s_lshl_b32 s28, s28, 13
  s_add_u32 s28, s28, 65536
  v_add_u32 v10, s28, v14
  v_add_u32 v11, s28, v15
  ds_read_b64_tr_b16 v[104:105], v10 offset:0
  ds_read_b64_tr_b16 v[106:107], v10 offset:1024
  ds_read_b64_tr_b16 v[108:109], v11 offset:0
  ds_read_b64_tr_b16 v[110:111], v11 offset:1024
  ds_read_b64_tr_b16 v[112:113], v10 offset:2048
  ds_read_b64_tr_b16 v[114:115], v10 offset:3072
  ds_read_b64_tr_b16 v[116:117], v11 offset:2048
  ds_read_b64_tr_b16 v[118:119], v11 offset:3072
  ds_read_b64_tr_b16 v[120:121], v10 offset:4096
  ds_read_b64_tr_b16 v[122:123], v10 offset:5120
  ds_read_b64_tr_b16 v[124:125], v11 offset:4096
  ds_read_b64_tr_b16 v[126:127], v11 offset:5120
  s_andn2_b32 s33, s36, s34
  s_ff1_i32_b32 s33, s33
  s_bitset1_b32 s34, s33
  s_xor_b32 s33, s33, s24
  s_lshl_b32 s33, s33, 12
  s_add_u32 s22, s20, s33
  s_addc_u32 s23, s21, 0
  global_load_dwordx4 v[224:227], v3, s[22:23] offset:0
  global_load_dwordx4 v[228:231], v3, s[22:23] offset:1024
  global_load_dwordx4 v[232:235], v3, s[22:23] offset:2048
  global_load_dwordx4 v[236:239], v3, s[22:23] offset:3072
  v_pk_fma_f32 v[24:25], v[24:25], v[8:9], v[8:9] op_sel:[0,0,1] op_sel_hi:[1,0,1]
  v_pk_fma_f32 v[26:27], v[26:27], v[8:9], v[8:9] op_sel:[0,0,1] op_sel_hi:[1,0,1]
  v_pk_fma_f32 v[28:29], v[28:29], v[8:9], v[8:9] op_sel:[0,0,1] op_sel_hi:[1,0,1]
  v_pk_fma_f32 v[30:31], v[30:31], v[8:9], v[8:9] op_sel:[0,0,1] op_sel_hi:[1,0,1]
  v_pk_fma_f32 v[32:33], v[32:33], v[8:9], v[8:9] op_sel:[0,0,1] op_sel_hi:[1,0,1]
  v_pk_fma_f32 v[34:35], v[34:35], v[8:9], v[8:9] op_sel:[0,0,1] op_sel_hi:[1,0,1]
  v_pk_fma_f32 v[36:37], v[36:37], v[8:9], v[8:9] op_sel:[0,0,1] op_sel_hi:[1,0,1]
  v_pk_fma_f32 v[38:39], v[38:39], v[8:9], v[8:9] op_sel:[0,0,1] op_sel_hi:[1,0,1]
  v_pk_fma_f32 v[40:41], v[40:41], v[8:9], v[8:9] op_sel:[0,0,1] op_sel_hi:[1,0,1]
  v_pk_fma_f32 v[42:43], v[42:43], v[8:9], v[8:9] op_sel:[0,0,1] op_sel_hi:[1,0,1]
  v_pk_fma_f32 v[44:45], v[44:45], v[8:9], v[8:9] op_sel:[0,0,1] op_sel_hi:[1,0,1]
  v_pk_fma_f32 v[46:47], v[46:47], v[8:9], v[8:9] op_sel:[0,0,1] op_sel_hi:[1,0,1]
  v_pk_fma_f32 v[48:49], v[48:49], v[8:9], v[8:9] op_sel:[0,0,1] op_sel_hi:[1,0,1]
  v_pk_fma_f32 v[50:51], v[50:51], v[8:9], v[8:9] op_sel:[0,0,1] op_sel_hi:[1,0,1]
  v_pk_fma_f32 v[52:53], v[52:53], v[8:9], v[8:9] op_sel:[0,0,1] op_sel_hi:[1,0,1]
  v_pk_fma_f32 v[54:55], v[54:55], v[8:9], v[8:9] op_sel:[0,0,1] op_sel_hi:[1,0,1]
  v_cmp_eq_u32 vcc, v16, v19
  s_cbranch_vccnz .g2_kernel_w_pt
.g2_kernel_w_pb:
  s_mov_b32 s72, s48
  s_mov_b32 s73, s49
  s_mov_b32 s74, 0x800
  s_mov_b32 s75, 0x00020000
  s_waitcnt vmcnt(15) lgkmcnt(8)
  v_mfma_f32_32x32x16_bf16 v[24:39], v[104:107], v[176:179], v[24:39]
  s_xor_b32 s28, s24, 1
  s_lshl_b32 s28, s28, 13
  s_add_u32 s28, s28, 65536
  ds_read_b64_tr_b16 v[128:129], v10 offset:6144
  ds_read_b64_tr_b16 v[130:131], v10 offset:7168
  v_mfma_f32_32x32x16_bf16 v[40:55], v[108:111], v[176:179], v[40:55]
  v_add_u32 v12, s28, v14
  v_add_u32 v13, s28, v15
  s_andn2_b32 s33, s36, s34
  ds_read_b64_tr_b16 v[132:133], v11 offset:6144
  ds_read_b64_tr_b16 v[134:135], v11 offset:7168
  s_waitcnt vmcnt(14) lgkmcnt(8)
  v_mfma_f32_32x32x16_bf16 v[24:39], v[112:115], v[180:183], v[24:39]
  s_ff1_i32_b32 s33, s33
  s_bitset1_b32 s34, s33
  s_xor_b32 s33, s33, s24
  ds_read_b64_tr_b16 v[104:105], v12 offset:0
  ds_read_b64_tr_b16 v[106:107], v12 offset:1024
  v_mfma_f32_32x32x16_bf16 v[40:55], v[116:119], v[180:183], v[40:55]
  s_lshl_b32 s33, s33, 12
  s_add_u32 s22, s20, s33
  s_addc_u32 s23, s21, 0
  ds_read_b64_tr_b16 v[108:109], v13 offset:0
  ds_read_b64_tr_b16 v[110:111], v13 offset:1024
  s_waitcnt vmcnt(13) lgkmcnt(8)
  v_mfma_f32_32x32x16_bf16 v[24:39], v[120:123], v[184:187], v[24:39]
  global_load_dwordx4 v[136:139], v3, s[22:23] offset:0
  global_load_dwordx4 v[140:143], v3, s[22:23] offset:1024
  global_load_dwordx4 v[144:147], v3, s[22:23] offset:2048
  ds_read_b64_tr_b16 v[112:113], v12 offset:2048
  ds_read_b64_tr_b16 v[114:115], v12 offset:3072
  v_mfma_f32_32x32x16_bf16 v[40:55], v[124:127], v[184:187], v[40:55]
  global_load_dwordx4 v[148:151], v3, s[22:23] offset:3072
  ds_read_b64_tr_b16 v[116:117], v13 offset:2048
  ds_read_b64_tr_b16 v[118:119], v13 offset:3072
  s_waitcnt vmcnt(16) lgkmcnt(8)
  v_mfma_f32_32x32x16_bf16 v[24:39], v[128:131], v[188:191], v[24:39]
  ds_read_b64_tr_b16 v[120:121], v12 offset:4096
  ds_read_b64_tr_b16 v[122:123], v12 offset:5120
  v_mfma_f32_32x32x16_bf16 v[40:55], v[132:135], v[188:191], v[40:55]
  ds_read_b64_tr_b16 v[124:125], v13 offset:4096
  ds_read_b64_tr_b16 v[126:127], v13 offset:5120
  s_waitcnt vmcnt(15) lgkmcnt(8)
  v_mfma_f32_32x32x16_bf16 v[24:39], v[104:107], v[192:195], v[24:39]
  s_xor_b32 s28, s24, 2
  s_lshl_b32 s28, s28, 13
  s_add_u32 s28, s28, 65536
  ds_read_b64_tr_b16 v[128:129], v12 offset:6144
  ds_read_b64_tr_b16 v[130:131], v12 offset:7168
  v_mfma_f32_32x32x16_bf16 v[40:55], v[108:111], v[192:195], v[40:55]
  v_add_u32 v10, s28, v14
  v_add_u32 v11, s28, v15
  s_andn2_b32 s33, s36, s34
  ds_read_b64_tr_b16 v[132:133], v13 offset:6144
  ds_read_b64_tr_b16 v[134:135], v13 offset:7168
  s_waitcnt vmcnt(14) lgkmcnt(8)
  v_mfma_f32_32x32x16_bf16 v[24:39], v[112:115], v[196:199], v[24:39]
  s_ff1_i32_b32 s33, s33
  s_bitset1_b32 s34, s33
  s_xor_b32 s33, s33, s24
  ds_read_b64_tr_b16 v[104:105], v10 offset:0
  ds_read_b64_tr_b16 v[106:107], v10 offset:1024
  v_mfma_f32_32x32x16_bf16 v[40:55], v[116:119], v[196:199], v[40:55]
  s_lshl_b32 s33, s33, 12
  s_add_u32 s22, s20, s33
  s_addc_u32 s23, s21, 0
  ds_read_b64_tr_b16 v[108:109], v11 offset:0
  ds_read_b64_tr_b16 v[110:111], v11 offset:1024
  s_waitcnt vmcnt(13) lgkmcnt(8)
  v_mfma_f32_32x32x16_bf16 v[24:39], v[120:123], v[200:203], v[24:39]
  global_load_dwordx4 v[152:155], v3, s[22:23] offset:0
  global_load_dwordx4 v[156:159], v3, s[22:23] offset:1024
  global_load_dwordx4 v[160:163], v3, s[22:23] offset:2048
  ds_read_b64_tr_b16 v[112:113], v10 offset:2048
  ds_read_b64_tr_b16 v[114:115], v10 offset:3072
  v_mfma_f32_32x32x16_bf16 v[40:55], v[124:127], v[200:203], v[40:55]
  global_load_dwordx4 v[164:167], v3, s[22:23] offset:3072
  ds_read_b64_tr_b16 v[116:117], v11 offset:2048
  ds_read_b64_tr_b16 v[118:119], v11 offset:3072
  s_waitcnt vmcnt(16) lgkmcnt(8)
  v_mfma_f32_32x32x16_bf16 v[24:39], v[128:131], v[204:207], v[24:39]
  ds_read_b64_tr_b16 v[120:121], v10 offset:4096
  ds_read_b64_tr_b16 v[122:123], v10 offset:5120
  v_mfma_f32_32x32x16_bf16 v[40:55], v[132:135], v[204:207], v[40:55]
  ds_read_b64_tr_b16 v[124:125], v11 offset:4096
  ds_read_b64_tr_b16 v[126:127], v11 offset:5120
  s_waitcnt vmcnt(15) lgkmcnt(8)
  v_mfma_f32_32x32x16_bf16 v[24:39], v[104:107], v[208:211], v[24:39]
  s_xor_b32 s28, s24, 3
  s_lshl_b32 s28, s28, 13
  s_add_u32 s28, s28, 65536
  ds_read_b64_tr_b16 v[128:129], v10 offset:6144
  ds_read_b64_tr_b16 v[130:131], v10 offset:7168
  v_mfma_f32_32x32x16_bf16 v[40:55], v[108:111], v[208:211], v[40:55]
  v_add_u32 v12, s28, v14
  v_add_u32 v13, s28, v15
  s_andn2_b32 s33, s36, s34
  ds_read_b64_tr_b16 v[132:133], v11 offset:6144
  ds_read_b64_tr_b16 v[134:135], v11 offset:7168
  s_waitcnt vmcnt(14) lgkmcnt(8)
  v_mfma_f32_32x32x16_bf16 v[24:39], v[112:115], v[212:215], v[24:39]
  s_ff1_i32_b32 s33, s33
  s_bitset1_b32 s34, s33
  s_xor_b32 s33, s33, s24
  ds_read_b64_tr_b16 v[104:105], v12 offset:0
  ds_read_b64_tr_b16 v[106:107], v12 offset:1024
  v_mfma_f32_32x32x16_bf16 v[40:55], v[116:119], v[212:215], v[40:55]
  s_lshl_b32 s33, s33, 12
  s_add_u32 s22, s20, s33
  s_addc_u32 s23, s21, 0
  ds_read_b64_tr_b16 v[108:109], v13 offset:0
  ds_read_b64_tr_b16 v[110:111], v13 offset:1024
  s_waitcnt vmcnt(13) lgkmcnt(8)
  v_mfma_f32_32x32x16_bf16 v[24:39], v[120:123], v[216:219], v[24:39]
  global_load_dwordx4 v[56:59], v3, s[22:23] offset:0
  global_load_dwordx4 v[60:63], v3, s[22:23] offset:1024
  global_load_dwordx4 v[64:67], v3, s[22:23] offset:2048
  ds_read_b64_tr_b16 v[112:113], v12 offset:2048
  ds_read_b64_tr_b16 v[114:115], v12 offset:3072
  v_mfma_f32_32x32x16_bf16 v[40:55], v[124:127], v[216:219], v[40:55]
  global_load_dwordx4 v[68:71], v3, s[22:23] offset:3072
  ds_read_b64_tr_b16 v[116:117], v13 offset:2048
  ds_read_b64_tr_b16 v[118:119], v13 offset:3072
  s_waitcnt vmcnt(16) lgkmcnt(8)
  v_mfma_f32_32x32x16_bf16 v[24:39], v[128:131], v[220:223], v[24:39]
  ds_read_b64_tr_b16 v[120:121], v12 offset:4096
  ds_read_b64_tr_b16 v[122:123], v12 offset:5120
  v_mfma_f32_32x32x16_bf16 v[40:55], v[132:135], v[220:223], v[40:55]
  ds_read_b64_tr_b16 v[124:125], v13 offset:4096
  ds_read_b64_tr_b16 v[126:127], v13 offset:5120
  s_waitcnt vmcnt(15) lgkmcnt(8)
  v_mfma_f32_32x32x16_bf16 v[24:39], v[104:107], v[224:227], v[24:39]
  s_xor_b32 s28, s24, 4
  s_lshl_b32 s28, s28, 13
  s_add_u32 s28, s28, 65536
  ds_read_b64_tr_b16 v[128:129], v12 offset:6144
  ds_read_b64_tr_b16 v[130:131], v12 offset:7168
  v_mfma_f32_32x32x16_bf16 v[40:55], v[108:111], v[224:227], v[40:55]
  v_add_u32 v10, s28, v14
  v_add_u32 v11, s28, v15
  s_andn2_b32 s33, s36, s34
  ds_read_b64_tr_b16 v[132:133], v13 offset:6144
  ds_read_b64_tr_b16 v[134:135], v13 offset:7168
  s_waitcnt vmcnt(14) lgkmcnt(8)
  v_mfma_f32_32x32x16_bf16 v[24:39], v[112:115], v[228:231], v[24:39]
  s_ff1_i32_b32 s33, s33
  s_bitset1_b32 s34, s33
  s_xor_b32 s33, s33, s24
  ds_read_b64_tr_b16 v[104:105], v10 offset:0
  ds_read_b64_tr_b16 v[106:107], v10 offset:1024
  v_mfma_f32_32x32x16_bf16 v[40:55], v[116:119], v[228:231], v[40:55]
  s_lshl_b32 s33, s33, 12
  s_add_u32 s22, s20, s33
  s_addc_u32 s23, s21, 0
  ds_read_b64_tr_b16 v[108:109], v11 offset:0
  ds_read_b64_tr_b16 v[110:111], v11 offset:1024
  s_waitcnt vmcnt(13) lgkmcnt(8)
  v_mfma_f32_32x32x16_bf16 v[24:39], v[120:123], v[232:235], v[24:39]
  global_load_dwordx4 v[72:75], v3, s[22:23] offset:0
  global_load_dwordx4 v[76:79], v3, s[22:23] offset:1024
  global_load_dwordx4 v[80:83], v3, s[22:23] offset:2048
  ds_read_b64_tr_b16 v[112:113], v10 offset:2048
  ds_read_b64_tr_b16 v[114:115], v10 offset:3072
  v_mfma_f32_32x32x16_bf16 v[40:55], v[124:127], v[232:235], v[40:55]
  global_load_dwordx4 v[84:87], v3, s[22:23] offset:3072
  ds_read_b64_tr_b16 v[116:117], v11 offset:2048
  ds_read_b64_tr_b16 v[118:119], v11 offset:3072
  s_waitcnt vmcnt(16) lgkmcnt(8)
  v_mfma_f32_32x32x16_bf16 v[24:39], v[128:131], v[236:239], v[24:39]
  ds_read_b64_tr_b16 v[120:121], v10 offset:4096
  ds_read_b64_tr_b16 v[122:123], v10 offset:5120
  v_mfma_f32_32x32x16_bf16 v[40:55], v[132:135], v[236:239], v[40:55]
  ds_read_b64_tr_b16 v[124:125], v11 offset:4096
  ds_read_b64_tr_b16 v[126:127], v11 offset:5120
  s_waitcnt vmcnt(15) lgkmcnt(8)
  v_mfma_f32_32x32x16_bf16 v[24:39], v[104:107], v[136:139], v[24:39]
  s_xor_b32 s28, s24, 5
  s_lshl_b32 s28, s28, 13
  s_add_u32 s28, s28, 65536
  v_add_u32 v12, s28, v14
  ds_read_b64_tr_b16 v[128:129], v10 offset:6144
  ds_read_b64_tr_b16 v[130:131], v10 offset:7168
  v_mfma_f32_32x32x16_bf16 v[40:55], v[108:111], v[136:139], v[40:55]
  v_add_u32 v13, s28, v15
  s_andn2_b32 s33, s36, s34
  s_cbranch_scc0 .g2_kernel_w_i8c
.g2_kernel_w_i8b:
  s_ff1_i32_b32 s33, s33
  ds_read_b64_tr_b16 v[132:133], v11 offset:6144
  ds_read_b64_tr_b16 v[134:135], v11 offset:7168
  s_waitcnt vmcnt(14) lgkmcnt(8)
  v_mfma_f32_32x32x16_bf16 v[24:39], v[112:115], v[140:143], v[24:39]
  s_bitset1_b32 s34, s33
  s_xor_b32 s33, s33, s24
  s_and_b32 s8, s33, 7
  s_cmp_lt_u32 s8, 2
  ds_read_b64_tr_b16 v[104:105], v12 offset:0
  ds_read_b64_tr_b16 v[106:107], v12 offset:1024
  v_mfma_f32_32x32x16_bf16 v[40:55], v[116:119], v[140:143], v[40:55]
  s_cselect_b32 s28, 139264, 0
  s_lshl_b32 s8, s8, 13
  s_add_u32 s8, s8, s28
  s_lshl_b32 s33, s33, 12
  ds_read_b64_tr_b16 v[108:109], v13 offset:0
  ds_read_b64_tr_b16 v[110:111], v13 offset:1024
  s_waitcnt vmcnt(13) lgkmcnt(8)
  v_mfma_f32_32x32x16_bf16 v[24:39], v[120:123], v[144:147], v[24:39]
  s_add_u32 s22, s20, s33
  s_addc_u32 s23, s21, 0
  global_load_dwordx4 v[88:91], v3, s[22:23] offset:0
  global_load_dwordx4 v[92:95], v3, s[22:23] offset:1024
  ds_read_b64_tr_b16 v[112:113], v12 offset:2048
  ds_read_b64_tr_b16 v[114:115], v12 offset:3072
  v_mfma_f32_32x32x16_bf16 v[40:55], v[124:127], v[144:147], v[40:55]
  global_load_dwordx4 v[96:99], v3, s[22:23] offset:2048
  global_load_dwordx4 v[100:103], v3, s[22:23] offset:3072
  ds_read_b64_tr_b16 v[116:117], v13 offset:2048
  ds_read_b64_tr_b16 v[118:119], v13 offset:3072
  s_waitcnt vmcnt(16) lgkmcnt(8)
  v_mfma_f32_32x32x16_bf16 v[24:39], v[128:131], v[148:151], v[24:39]
  ds_read_b64_tr_b16 v[120:121], v12 offset:4096
  ds_read_b64_tr_b16 v[122:123], v12 offset:5120
  v_mfma_f32_32x32x16_bf16 v[40:55], v[132:135], v[148:151], v[40:55]
  ds_read_b64_tr_b16 v[124:125], v13 offset:4096
  ds_read_b64_tr_b16 v[126:127], v13 offset:5120
  s_waitcnt vmcnt(15) lgkmcnt(8)
  v_mfma_f32_32x32x16_bf16 v[24:39], v[104:107], v[152:155], v[24:39]
  s_xor_b32 s28, s24, 6
  s_lshl_b32 s28, s28, 13
  s_add_u32 s28, s28, 65536
  v_add_u32 v10, s28, v14
  v_add_u32 v11, s28, v15
  ds_read_b64_tr_b16 v[128:129], v12 offset:6144
  ds_read_b64_tr_b16 v[130:131], v12 offset:7168
  v_mfma_f32_32x32x16_bf16 v[40:55], v[108:111], v[152:155], v[40:55]
  s_andn2_b32 s33, s36, s34
  s_cbranch_scc0 .g2_kernel_w_i9c
.g2_kernel_w_i9b:
  s_ff1_i32_b32 s33, s33
  s_bitset1_b32 s34, s33
  s_xor_b32 s33, s33, s24
  ds_read_b64_tr_b16 v[132:133], v13 offset:6144
  ds_read_b64_tr_b16 v[134:135], v13 offset:7168
  s_waitcnt vmcnt(14) lgkmcnt(8)
  v_mfma_f32_32x32x16_bf16 v[24:39], v[112:115], v[156:159], v[24:39]
  s_and_b32 s9, s33, 7
  s_cmp_lt_u32 s9, 2
  s_cselect_b32 s28, 139264, 0
  s_lshl_b32 s9, s9, 13
  s_add_u32 s9, s9, s28
  ds_read_b64_tr_b16 v[104:105], v10 offset:0
  ds_read_b64_tr_b16 v[106:107], v10 offset:1024
  v_mfma_f32_32x32x16_bf16 v[40:55], v[116:119], v[156:159], v[40:55]
  s_lshl_b32 s33, s33, 12
  s_add_u32 s22, s20, s33
  s_addc_u32 s23, s21, 0
  global_load_dwordx4 v[176:179], v3, s[22:23] offset:0
  global_load_dwordx4 v[180:183], v3, s[22:23] offset:1024
  ds_read_b64_tr_b16 v[108:109], v11 offset:0
  ds_read_b64_tr_b16 v[110:111], v11 offset:1024
  s_waitcnt vmcnt(15) lgkmcnt(8)
  v_mfma_f32_32x32x16_bf16 v[24:39], v[120:123], v[160:163], v[24:39]
  global_load_dwordx4 v[184:187], v3, s[22:23] offset:2048
  global_load_dwordx4 v[188:191], v3, s[22:23] offset:3072
  v_lshlrev_b32 v16, 4, v17
  s_lshl_b32 s29, s18, 7
  buffer_load_dwordx4 v[240:243], v16, s[72:75], s29 offen offset:0
  ds_read_b64_tr_b16 v[112:113], v10 offset:2048
  ds_read_b64_tr_b16 v[114:115], v10 offset:3072
  v_mfma_f32_32x32x16_bf16 v[40:55], v[124:127], v[160:163], v[40:55]
  buffer_load_dwordx4 v[244:247], v16, s[72:75], s29 offen offset:32
  buffer_load_dwordx4 v[248:251], v16, s[72:75], s29 offen offset:64
  buffer_load_dwordx4 v[252:255], v16, s[72:75], s29 offen offset:96
  ds_read_b64_tr_b16 v[116:117], v11 offset:2048
  ds_read_b64_tr_b16 v[118:119], v11 offset:3072
  s_waitcnt vmcnt(20) lgkmcnt(8)
  v_mfma_f32_32x32x16_bf16 v[24:39], v[128:131], v[164:167], v[24:39]
  ds_read_b64_tr_b16 v[120:121], v10 offset:4096
  ds_read_b64_tr_b16 v[122:123], v10 offset:5120
  v_mfma_f32_32x32x16_bf16 v[40:55], v[132:135], v[164:167], v[40:55]
  ds_read_b64_tr_b16 v[124:125], v11 offset:4096
  ds_read_b64_tr_b16 v[126:127], v11 offset:5120
  s_waitcnt vmcnt(19) lgkmcnt(8)
  v_mfma_f32_32x32x16_bf16 v[24:39], v[104:107], v[56:59], v[24:39]
  s_xor_b32 s28, s24, 7
  s_lshl_b32 s28, s28, 13
  s_add_u32 s28, s28, 65536
  v_add_u32 v12, s28, v14
  ds_read_b64_tr_b16 v[128:129], v10 offset:6144
  ds_read_b64_tr_b16 v[130:131], v10 offset:7168
  v_mfma_f32_32x32x16_bf16 v[40:55], v[108:111], v[56:59], v[40:55]
  v_add_u32 v13, s28, v15
  s_andn2_b32 s33, s36, s34
  s_cbranch_scc0 .g2_kernel_w_i10c
.g2_kernel_w_i10b:
  s_ff1_i32_b32 s33, s33
  ds_read_b64_tr_b16 v[132:133], v11 offset:6144
  ds_read_b64_tr_b16 v[134:135], v11 offset:7168
  s_waitcnt vmcnt(18) lgkmcnt(8)
  v_mfma_f32_32x32x16_bf16 v[24:39], v[112:115], v[60:63], v[24:39]
  s_bitset1_b32 s34, s33
  s_xor_b32 s33, s33, s24
  s_and_b32 s10, s33, 7
  s_cmp_lt_u32 s10, 2
  ds_read_b64_tr_b16 v[104:105], v12 offset:0
  ds_read_b64_tr_b16 v[106:107], v12 offset:1024
  v_mfma_f32_32x32x16_bf16 v[40:55], v[116:119], v[60:63], v[40:55]
  s_cselect_b32 s28, 139264, 0
  s_lshl_b32 s10, s10, 13
  s_add_u32 s10, s10, s28
  s_lshl_b32 s33, s33, 12
  ds_read_b64_tr_b16 v[108:109], v13 offset:0
  ds_read_b64_tr_b16 v[110:111], v13 offset:1024
  s_waitcnt vmcnt(17) lgkmcnt(8)
  v_mfma_f32_32x32x16_bf16 v[24:39], v[120:123], v[64:67], v[24:39]
  s_add_u32 s22, s20, s33
  s_addc_u32 s23, s21, 0
  global_load_dwordx4 v[192:195], v3, s[22:23] offset:0
  global_load_dwordx4 v[196:199], v3, s[22:23] offset:1024
  ds_read_b64_tr_b16 v[112:113], v12 offset:2048
  ds_read_b64_tr_b16 v[114:115], v12 offset:3072
  v_mfma_f32_32x32x16_bf16 v[40:55], v[124:127], v[64:67], v[40:55]
  global_load_dwordx4 v[200:203], v3, s[22:23] offset:2048
  global_load_dwordx4 v[204:207], v3, s[22:23] offset:3072
  ds_read_b64_tr_b16 v[116:117], v13 offset:2048
  ds_read_b64_tr_b16 v[118:119], v13 offset:3072
  s_waitcnt vmcnt(20) lgkmcnt(8)
  v_mfma_f32_32x32x16_bf16 v[24:39], v[128:131], v[68:71], v[24:39]
  ds_read_b64_tr_b16 v[120:121], v12 offset:4096
  ds_read_b64_tr_b16 v[122:123], v12 offset:5120
  v_mfma_f32_32x32x16_bf16 v[40:55], v[132:135], v[68:71], v[40:55]
  ds_read_b64_tr_b16 v[124:125], v13 offset:4096
  ds_read_b64_tr_b16 v[126:127], v13 offset:5120
  s_waitcnt vmcnt(19) lgkmcnt(8)
  v_mfma_f32_32x32x16_bf16 v[24:39], v[104:107], v[72:75], v[24:39]
  s_andn2_b32 s33, s36, s34
  s_cbranch_scc0 .g2_kernel_w_i11c
.g2_kernel_w_i11b:
  s_ff1_i32_b32 s33, s33
  ds_read_b64_tr_b16 v[128:129], v12 offset:6144
  ds_read_b64_tr_b16 v[130:131], v12 offset:7168
  v_mfma_f32_32x32x16_bf16 v[40:55], v[108:111], v[72:75], v[40:55]
  s_bitset1_b32 s34, s33
  s_xor_b32 s33, s33, s24
  s_and_b32 s11, s33, 7
  ds_read_b64_tr_b16 v[132:133], v13 offset:6144
  ds_read_b64_tr_b16 v[134:135], v13 offset:7168
  s_waitcnt vmcnt(18) lgkmcnt(8)
  v_mfma_f32_32x32x16_bf16 v[24:39], v[112:115], v[76:79], v[24:39]
  s_cmp_lt_u32 s11, 2
  s_cselect_b32 s28, 139264, 0
  s_lshl_b32 s11, s11, 13
  v_mfma_f32_32x32x16_bf16 v[40:55], v[116:119], v[76:79], v[40:55]
  s_add_u32 s11, s11, s28
  s_lshl_b32 s33, s33, 12
  s_add_u32 s22, s20, s33
  s_waitcnt vmcnt(17) lgkmcnt(4)
  v_mfma_f32_32x32x16_bf16 v[24:39], v[120:123], v[80:83], v[24:39]
  s_addc_u32 s23, s21, 0
  global_load_dwordx4 v[208:211], v3, s[22:23] offset:0
  global_load_dwordx4 v[212:215], v3, s[22:23] offset:1024
  v_mfma_f32_32x32x16_bf16 v[40:55], v[124:127], v[80:83], v[40:55]
  global_load_dwordx4 v[216:219], v3, s[22:23] offset:2048
  global_load_dwordx4 v[220:223], v3, s[22:23] offset:3072
  s_waitcnt vmcnt(20) lgkmcnt(0)
  v_mfma_f32_32x32x16_bf16 v[24:39], v[128:131], v[84:87], v[24:39]
  v_mfma_f32_32x32x16_bf16 v[40:55], v[132:135], v[84:87], v[40:55]
  ds_read_b32 v16, v20 offset:12
  v_add_u32 v10, s8, v14
  v_add_u32 v11, s8, v15
  s_waitcnt lgkmcnt(0)
  v_cmp_gt_u32 vcc, 4, v16
  s_cbranch_vccnz .g2_kernel_w_bw
.g2_kernel_w_bb:
  ds_read_b64_tr_b16 v[104:105], v10 offset:0
  ds_read_b64_tr_b16 v[106:107], v10 offset:1024
  ds_read_b64_tr_b16 v[108:109], v11 offset:0
  ds_read_b64_tr_b16 v[110:111], v11 offset:1024
  ds_read_b64_tr_b16 v[112:113], v10 offset:2048
  ds_read_b64_tr_b16 v[114:115], v10 offset:3072
  ds_read_b64_tr_b16 v[116:117], v11 offset:2048
  ds_read_b64_tr_b16 v[118:119], v11 offset:3072
  ds_read_b64_tr_b16 v[120:121], v10 offset:4096
  ds_read_b64_tr_b16 v[122:123], v10 offset:5120
  ds_read_b64_tr_b16 v[124:125], v11 offset:4096
  ds_read_b64_tr_b16 v[126:127], v11 offset:5120
  s_waitcnt vmcnt(16)
  v_min3_u32 v6, v88, v90, v92
  v_min3_u32 v7, v94, v96, v98
  v_min3_u32 v6, v6, v100, v102
  v_min_u32 v6, v6, v7
  v_cmp_eq_u32 vcc, 0, v6
  s_cbranch_vccnz .g2_kernel_w_v8
.g2_kernel_w_vb8:
  s_waitcnt lgkmcnt(8)
  v_mfma_f32_32x32x16_bf16 v[24:39], v[104:107], v[88:91], v[24:39]
  v_add_u32 v12, s9, v14
  v_add_u32 v13, s9, v15
  s_andn2_b32 s33, s36, s34
  s_cbranch_scc0 .g2_kernel_w_i12c
.g2_kernel_w_i12b:
  ds_read_b64_tr_b16 v[128:129], v10 offset:6144
  ds_read_b64_tr_b16 v[130:131], v10 offset:7168
  v_mfma_f32_32x32x16_bf16 v[40:55], v[108:111], v[88:91], v[40:55]
  s_ff1_i32_b32 s33, s33
  s_bitset1_b32 s34, s33
  s_xor_b32 s33, s33, s24
  s_and_b32 s12, s33, 7
  ds_read_b64_tr_b16 v[132:133], v11 offset:6144
  ds_read_b64_tr_b16 v[134:135], v11 offset:7168
  s_waitcnt lgkmcnt(8)
  v_mfma_f32_32x32x16_bf16 v[24:39], v[112:115], v[92:95], v[24:39]
  s_cmp_lt_u32 s12, 2
  s_cselect_b32 s28, 139264, 0
  s_lshl_b32 s12, s12, 13
  s_add_u32 s12, s12, s28
  ds_read_b64_tr_b16 v[104:105], v12 offset:0
  ds_read_b64_tr_b16 v[106:107], v12 offset:1024
  v_mfma_f32_32x32x16_bf16 v[40:55], v[116:119], v[92:95], v[40:55]
  s_lshl_b32 s33, s33, 12
  s_add_u32 s22, s20, s33
  s_addc_u32 s23, s21, 0
  global_load_dwordx4 v[224:227], v3, s[22:23] offset:0
  ds_read_b64_tr_b16 v[108:109], v13 offset:0
  ds_read_b64_tr_b16 v[110:111], v13 offset:1024
  s_waitcnt lgkmcnt(8)
  v_mfma_f32_32x32x16_bf16 v[24:39], v[120:123], v[96:99], v[24:39]
  global_load_dwordx4 v[228:231], v3, s[22:23] offset:1024
  global_load_dwordx4 v[232:235], v3, s[22:23] offset:2048
  global_load_dwordx4 v[236:239], v3, s[22:23] offset:3072
  ds_read_b64_tr_b16 v[112:113], v12 offset:2048
  ds_read_b64_tr_b16 v[114:115], v12 offset:3072
  v_mfma_f32_32x32x16_bf16 v[40:55], v[124:127], v[96:99], v[40:55]
  ds_read_b64_tr_b16 v[116:117], v13 offset:2048
  ds_read_b64_tr_b16 v[118:119], v13 offset:3072
  s_waitcnt lgkmcnt(8)
  v_mfma_f32_32x32x16_bf16 v[24:39], v[128:131], v[100:103], v[24:39]
  ds_read_b64_tr_b16 v[120:121], v12 offset:4096
  ds_read_b64_tr_b16 v[122:123], v12 offset:5120
  s_waitcnt vmcnt(16)
  v_min3_u32 v6, v176, v178, v180
  v_min3_u32 v7, v182, v184, v186
  v_min3_u32 v6, v6, v188, v190
  v_min_u32 v6, v6, v7
  v_cmp_eq_u32 vcc, 0, v6
  v_mfma_f32_32x32x16_bf16 v[40:55], v[132:135], v[100:103], v[40:55]
  ds_read_b64_tr_b16 v[124:125], v13 offset:4096
  ds_read_b64_tr_b16 v[126:127], v13 offset:5120
  s_cbranch_vccnz .g2_kernel_w_v9
.g2_kernel_w_vb9:
  s_waitcnt lgkmcnt(8)
  v_mfma_f32_32x32x16_bf16 v[24:39], v[104:107], v[176:179], v[24:39]
  v_add_u32 v10, s10, v14
  v_add_u32 v11, s10, v15
  s_andn2_b32 s33, s36, s34
  s_cbranch_scc0 .g2_kernel_w_i13c
.g2_kernel_w_i13b:
  ds_read_b64_tr_b16 v[128:129], v12 offset:6144
  ds_read_b64_tr_b16 v[130:131], v12 offset:7168
  v_mfma_f32_32x32x16_bf16 v[40:55], v[108:111], v[176:179], v[40:55]
  s_ff1_i32_b32 s33, s33
  s_bitset1_b32 s34, s33
  s_xor_b32 s33, s33, s24
  s_and_b32 s13, s33, 7
  ds_read_b64_tr_b16 v[132:133], v13 offset:6144
  ds_read_b64_tr_b16 v[134:135], v13 offset:7168
  s_waitcnt lgkmcnt(8)
  v_mfma_f32_32x32x16_bf16 v[24:39], v[112:115], v[180:183], v[24:39]
  s_cmp_lt_u32 s13, 2
  s_cselect_b32 s28, 139264, 0
  s_lshl_b32 s13, s13, 13
  s_add_u32 s13, s13, s28
  ds_read_b64_tr_b16 v[104:105], v10 offset:0
  ds_read_b64_tr_b16 v[106:107], v10 offset:1024
  v_mfma_f32_32x32x16_bf16 v[40:55], v[116:119], v[180:183], v[40:55]
  s_lshl_b32 s33, s33, 12
  s_add_u32 s22, s20, s33
  s_addc_u32 s23, s21, 0
  global_load_dwordx4 v[136:139], v3, s[22:23] offset:0
  ds_read_b64_tr_b16 v[108:109], v11 offset:0
  ds_read_b64_tr_b16 v[110:111], v11 offset:1024
  s_waitcnt lgkmcnt(8)
  v_mfma_f32_32x32x16_bf16 v[24:39], v[120:123], v[184:187], v[24:39]
  global_load_dwordx4 v[140:143], v3, s[22:23] offset:1024
  global_load_dwordx4 v[144:147], v3, s[22:23] offset:2048
  global_load_dwordx4 v[148:151], v3, s[22:23] offset:3072
  ds_read_b64_tr_b16 v[112:113], v10 offset:2048
  ds_read_b64_tr_b16 v[114:115], v10 offset:3072
  v_mfma_f32_32x32x16_bf16 v[40:55], v[124:127], v[184:187], v[40:55]
  ds_read_b64_tr_b16 v[116:117], v11 offset:2048
  ds_read_b64_tr_b16 v[118:119], v11 offset:3072
  s_waitcnt lgkmcnt(8)
  v_mfma_f32_32x32x16_bf16 v[24:39], v[128:131], v[188:191], v[24:39]
  ds_read_b64_tr_b16 v[120:121], v10 offset:4096
  ds_read_b64_tr_b16 v[122:123], v10 offset:5120
  s_waitcnt vmcnt(12)
  v_min3_u32 v6, v192, v194, v196
  v_min3_u32 v7, v198, v200, v202
  v_min3_u32 v6, v6, v204, v206
  v_min_u32 v6, v6, v7
  v_cmp_eq_u32 vcc, 0, v6
  v_mfma_f32_32x32x16_bf16 v[40:55], v[132:135], v[188:191], v[40:55]
  ds_read_b64_tr_b16 v[124:125], v11 offset:4096
  ds_read_b64_tr_b16 v[126:127], v11 offset:5120
  s_cbranch_vccnz .g2_kernel_w_v10
.g2_kernel_w_vb10:
  s_waitcnt lgkmcnt(8)
  v_mfma_f32_32x32x16_bf16 v[24:39], v[104:107], v[192:195], v[24:39]
  v_add_u32 v12, s11, v14
  v_add_u32 v13, s11, v15
  s_andn2_b32 s33, s36, s34
  s_cbranch_scc0 .g2_kernel_w_i14c
.g2_kernel_w_i14b:
  ds_read_b64_tr_b16 v[128:129], v10 offset:6144
  ds_read_b64_tr_b16 v[130:131], v10 offset:7168
  v_mfma_f32_32x32x16_bf16 v[40:55], v[108:111], v[192:195], v[40:55]
  s_ff1_i32_b32 s33, s33
  s_bitset1_b32 s34, s33
  s_xor_b32 s33, s33, s24
  s_and_b32 s14, s33, 7
  ds_read_b64_tr_b16 v[132:133], v11 offset:6144
  ds_read_b64_tr_b16 v[134:135], v11 offset:7168
  s_waitcnt lgkmcnt(8)
  v_mfma_f32_32x32x16_bf16 v[24:39], v[112:115], v[196:199], v[24:39]
  s_cmp_lt_u32 s14, 2
  s_cselect_b32 s28, 139264, 0
  s_lshl_b32 s14, s14, 13
  s_add_u32 s14, s14, s28
  ds_read_b64_tr_b16 v[104:105], v12 offset:0
  ds_read_b64_tr_b16 v[106:107], v12 offset:1024
  v_mfma_f32_32x32x16_bf16 v[40:55], v[116:119], v[196:199], v[40:55]
  s_lshl_b32 s33, s33, 12
  s_add_u32 s22, s20, s33
  s_addc_u32 s23, s21, 0
  global_load_dwordx4 v[152:155], v3, s[22:23] offset:0 sc1
  ds_read_b64_tr_b16 v[108:109], v13 offset:0
  ds_read_b64_tr_b16 v[110:111], v13 offset:1024
  s_waitcnt lgkmcnt(8)
  v_mfma_f32_32x32x16_bf16 v[24:39], v[120:123], v[200:203], v[24:39]
  global_load_dwordx4 v[156:159], v3, s[22:23] offset:1024 sc1
  global_load_dwordx4 v[160:163], v3, s[22:23] offset:2048 sc1
  global_load_dwordx4 v[164:167], v3, s[22:23] offset:3072 sc1
  ds_read_b64_tr_b16 v[112:113], v12 offset:2048
  ds_read_b64_tr_b16 v[114:115], v12 offset:3072
  v_mfma_f32_32x32x16_bf16 v[40:55], v[124:127], v[200:203], v[40:55]
  ds_read_b64_tr_b16 v[116:117], v13 offset:2048
  ds_read_b64_tr_b16 v[118:119], v13 offset:3072
  s_waitcnt lgkmcnt(8)
  v_mfma_f32_32x32x16_bf16 v[24:39], v[128:131], v[204:207], v[24:39]
  ds_read_b64_tr_b16 v[120:121], v12 offset:4096
  ds_read_b64_tr_b16 v[122:123], v12 offset:5120
  s_waitcnt vmcnt(12)
  v_min3_u32 v6, v208, v210, v212
  v_min3_u32 v7, v214, v216, v218
  v_min3_u32 v6, v6, v220, v222
  v_min_u32 v6, v6, v7
  v_cmp_eq_u32 vcc, 0, v6
  v_mfma_f32_32x32x16_bf16 v[40:55], v[132:135], v[204:207], v[40:55]
  ds_read_b64_tr_b16 v[124:125], v13 offset:4096
  ds_read_b64_tr_b16 v[126:127], v13 offset:5120
  s_cbranch_vccnz .g2_kernel_w_v11
.g2_kernel_w_vb11:
  s_mov_b64 exec, 1
  ds_add_u32 v20, v5 offset:16
  s_mov_b64 exec, -1
  s_waitcnt lgkmcnt(8)
  v_mfma_f32_32x32x16_bf16 v[24:39], v[104:107], v[208:211], v[24:39]
  v_add_u32 v10, s12, v14
  v_add_u32 v11, s12, v15
  s_andn2_b32 s33, s36, s34
  s_cbranch_scc0 .g2_kernel_w_i15c
.g2_kernel_w_i15b:
  ds_read_b64_tr_b16 v[128:129], v12 offset:6144
  ds_read_b64_tr_b16 v[130:131], v12 offset:7168
  v_mfma_f32_32x32x16_bf16 v[40:55], v[108:111], v[208:211], v[40:55]
  s_ff1_i32_b32 s33, s33
  s_bitset1_b32 s34, s33
  s_xor_b32 s33, s33, s24
  s_and_b32 s15, s33, 7
  ds_read_b64_tr_b16 v[132:133], v13 offset:6144
  ds_read_b64_tr_b16 v[134:135], v13 offset:7168
  s_waitcnt lgkmcnt(8)
  v_mfma_f32_32x32x16_bf16 v[24:39], v[112:115], v[212:215], v[24:39]
  s_cmp_lt_u32 s15, 2
  s_cselect_b32 s28, 139264, 0
  s_lshl_b32 s15, s15, 13
  s_add_u32 s15, s15, s28
  ds_read_b64_tr_b16 v[104:105], v10 offset:0
  ds_read_b64_tr_b16 v[106:107], v10 offset:1024
  v_mfma_f32_32x32x16_bf16 v[40:55], v[116:119], v[212:215], v[40:55]
  s_lshl_b32 s33, s33, 12
  s_add_u32 s22, s20, s33
  s_addc_u32 s23, s21, 0
  global_load_dwordx4 v[56:59], v3, s[22:23] offset:0 sc1
  ds_read_b64_tr_b16 v[108:109], v11 offset:0
  ds_read_b64_tr_b16 v[110:111], v11 offset:1024
  s_waitcnt lgkmcnt(8)
  v_mfma_f32_32x32x16_bf16 v[24:39], v[120:123], v[216:219], v[24:39]
  global_load_dwordx4 v[60:63], v3, s[22:23] offset:1024 sc1
  global_load_dwordx4 v[64:67], v3, s[22:23] offset:2048 sc1
  global_load_dwordx4 v[68:71], v3, s[22:23] offset:3072 sc1
  ds_read_b64_tr_b16 v[112:113], v10 offset:2048
  ds_read_b64_tr_b16 v[114:115], v10 offset:3072
  v_mfma_f32_32x32x16_bf16 v[40:55], v[124:127], v[216:219], v[40:55]
  ds_read_b64_tr_b16 v[116:117], v11 offset:2048
  ds_read_b64_tr_b16 v[118:119], v11 offset:3072
  s_waitcnt lgkmcnt(8)
  v_mfma_f32_32x32x16_bf16 v[24:39], v[128:131], v[220:223], v[24:39]
  ds_read_b64_tr_b16 v[120:121], v10 offset:4096
  ds_read_b64_tr_b16 v[122:123], v10 offset:5120
  s_waitcnt vmcnt(12)
  v_min3_u32 v6, v224, v226, v228
  v_min3_u32 v7, v230, v232, v234
  v_min3_u32 v6, v6, v236, v238
  v_min_u32 v6, v6, v7
  v_cmp_eq_u32 vcc, 0, v6
  v_mfma_f32_32x32x16_bf16 v[40:55], v[132:135], v[220:223], v[40:55]
  ds_read_b64_tr_b16 v[124:125], v11 offset:4096
  ds_read_b64_tr_b16 v[126:127], v11 offset:5120
  s_cbranch_vccnz .g2_kernel_w_v12
.g2_kernel_w_vb12:
  s_waitcnt lgkmcnt(8)
  v_mfma_f32_32x32x16_bf16 v[24:39], v[104:107], v[224:227], v[24:39]
  v_add_u32 v12, s13, v14
  v_add_u32 v13, s13, v15
  ds_read_b64_tr_b16 v[128:129], v10 offset:6144
  ds_read_b64_tr_b16 v[130:131], v10 offset:7168
  v_mfma_f32_32x32x16_bf16 v[40:55], v[108:111], v[224:227], v[40:55]
  ds_read_b64_tr_b16 v[132:133], v11 offset:6144
  ds_read_b64_tr_b16 v[134:135], v11 offset:7168
  s_waitcnt lgkmcnt(8)
  v_mfma_f32_32x32x16_bf16 v[24:39], v[112:115], v[228:231], v[24:39]
  ds_read_b64_tr_b16 v[104:105], v12 offset:0
  ds_read_b64_tr_b16 v[106:107], v12 offset:1024
  v_mfma_f32_32x32x16_bf16 v[40:55], v[116:119], v[228:231], v[40:55]
  ds_read_b64_tr_b16 v[108:109], v13 offset:0
  ds_read_b64_tr_b16 v[110:111], v13 offset:1024
  s_waitcnt lgkmcnt(8)
  v_mfma_f32_32x32x16_bf16 v[24:39], v[120:123], v[232:235], v[24:39]
  ds_read_b64_tr_b16 v[112:113], v12 offset:2048
  ds_read_b64_tr_b16 v[114:115], v12 offset:3072
  v_mfma_f32_32x32x16_bf16 v[40:55], v[124:127], v[232:235], v[40:55]
  ds_read_b64_tr_b16 v[116:117], v13 offset:2048
  ds_read_b64_tr_b16 v[118:119], v13 offset:3072
  s_waitcnt lgkmcnt(8)
  v_mfma_f32_32x32x16_bf16 v[24:39], v[128:131], v[236:239], v[24:39]
  ds_read_b64_tr_b16 v[120:121], v12 offset:4096
  ds_read_b64_tr_b16 v[122:123], v12 offset:5120
  s_waitcnt vmcnt(8)
  v_min3_u32 v6, v136, v138, v140
  v_min3_u32 v7, v142, v144, v146
  v_min3_u32 v6, v6, v148, v150
  v_min_u32 v6, v6, v7
  v_cmp_eq_u32 vcc, 0, v6
  v_mfma_f32_32x32x16_bf16 v[40:55], v[132:135], v[236:239], v[40:55]
  ds_read_b64_tr_b16 v[124:125], v13 offset:4096
  ds_read_b64_tr_b16 v[126:127], v13 offset:5120
  s_cbranch_vccnz .g2_kernel_w_v13
.g2_kernel_w_vb13:
  s_waitcnt lgkmcnt(8)
  v_mfma_f32_32x32x16_bf16 v[24:39], v[104:107], v[136:139], v[24:39]
  v_add_u32 v10, s14, v14
  v_add_u32 v11, s14, v15
  ds_read_b64_tr_b16 v[128:129], v12 offset:6144
  ds_read_b64_tr_b16 v[130:131], v12 offset:7168
  v_mfma_f32_32x32x16_bf16 v[40:55], v[108:111], v[136:139], v[40:55]
  ds_read_b64_tr_b16 v[132:133], v13 offset:6144
  ds_read_b64_tr_b16 v[134:135], v13 offset:7168
  s_waitcnt lgkmcnt(8)
  v_mfma_f32_32x32x16_bf16 v[24:39], v[112:115], v[140:143], v[24:39]
  ds_read_b64_tr_b16 v[104:105], v10 offset:0
  ds_read_b64_tr_b16 v[106:107], v10 offset:1024
  v_mfma_f32_32x32x16_bf16 v[40:55], v[116:119], v[140:143], v[40:55]
  ds_read_b64_tr_b16 v[108:109], v11 offset:0
  ds_read_b64_tr_b16 v[110:111], v11 offset:1024
  s_waitcnt lgkmcnt(8)
  v_mfma_f32_32x32x16_bf16 v[24:39], v[120:123], v[144:147], v[24:39]
  ds_read_b64_tr_b16 v[112:113], v10 offset:2048
  ds_read_b64_tr_b16 v[114:115], v10 offset:3072
  v_mfma_f32_32x32x16_bf16 v[40:55], v[124:127], v[144:147], v[40:55]
  ds_read_b64_tr_b16 v[116:117], v11 offset:2048
  ds_read_b64_tr_b16 v[118:119], v11 offset:3072
  s_waitcnt lgkmcnt(8)
  v_mfma_f32_32x32x16_bf16 v[24:39], v[128:131], v[148:151], v[24:39]
  ds_read_b64_tr_b16 v[120:121], v10 offset:4096
  ds_read_b64_tr_b16 v[122:123], v10 offset:5120
  s_waitcnt vmcnt(4)
  v_min3_u32 v6, v152, v154, v156
  v_min3_u32 v7, v158, v160, v162
  v_min3_u32 v6, v6, v164, v166
  v_min_u32 v6, v6, v7
  v_cmp_eq_u32 vcc, 0, v6
  v_mfma_f32_32x32x16_bf16 v[40:55], v[132:135], v[148:151], v[40:55]
  ds_read_b64_tr_b16 v[124:125], v11 offset:4096
  ds_read_b64_tr_b16 v[126:127], v11 offset:5120
  s_cbranch_vccnz .g2_kernel_w_v14
.g2_kernel_w_vb14:
  s_waitcnt lgkmcnt(8)
  v_mfma_f32_32x32x16_bf16 v[24:39], v[104:107], v[152:155], v[24:39]
  v_add_u32 v12, s15, v14
  v_add_u32 v13, s15, v15
  ds_read_b64_tr_b16 v[128:129], v10 offset:6144
  ds_read_b64_tr_b16 v[130:131], v10 offset:7168
  v_mfma_f32_32x32x16_bf16 v[40:55], v[108:111], v[152:155], v[40:55]
  ds_read_b64_tr_b16 v[132:133], v11 offset:6144
  ds_read_b64_tr_b16 v[134:135], v11 offset:7168
  s_waitcnt lgkmcnt(8)
  v_mfma_f32_32x32x16_bf16 v[24:39], v[112:115], v[156:159], v[24:39]
  ds_read_b64_tr_b16 v[104:105], v12 offset:0
  ds_read_b64_tr_b16 v[106:107], v12 offset:1024
  v_mfma_f32_32x32x16_bf16 v[40:55], v[116:119], v[156:159], v[40:55]
  ds_read_b64_tr_b16 v[108:109], v13 offset:0
  ds_read_b64_tr_b16 v[110:111], v13 offset:1024
  s_waitcnt lgkmcnt(8)
  v_mfma_f32_32x32x16_bf16 v[24:39], v[120:123], v[160:163], v[24:39]
  ds_read_b64_tr_b16 v[112:113], v12 offset:2048
  ds_read_b64_tr_b16 v[114:115], v12 offset:3072
  v_mfma_f32_32x32x16_bf16 v[40:55], v[124:127], v[160:163], v[40:55]
  ds_read_b64_tr_b16 v[116:117], v13 offset:2048
  ds_read_b64_tr_b16 v[118:119], v13 offset:3072
  s_waitcnt lgkmcnt(8)
  v_mfma_f32_32x32x16_bf16 v[24:39], v[128:131], v[164:167], v[24:39]
  ds_read_b64_tr_b16 v[120:121], v12 offset:4096
  ds_read_b64_tr_b16 v[122:123], v12 offset:5120
  s_waitcnt vmcnt(0)
  v_min3_u32 v6, v56, v58, v60
  v_min3_u32 v7, v62, v64, v66
  v_min3_u32 v6, v6, v68, v70
  v_min_u32 v6, v6, v7
  v_cmp_eq_u32 vcc, 0, v6
  v_mfma_f32_32x32x16_bf16 v[40:55], v[132:135], v[164:167], v[40:55]
  ds_read_b64_tr_b16 v[124:125], v13 offset:4096
  ds_read_b64_tr_b16 v[126:127], v13 offset:5120
  s_cbranch_vccnz .g2_kernel_w_v15
.g2_kernel_w_vb15:
  s_waitcnt lgkmcnt(8)
  v_mfma_f32_32x32x16_bf16 v[24:39], v[104:107], v[56:59], v[24:39]
  ds_read_b64_tr_b16 v[128:129], v12 offset:6144
  ds_read_b64_tr_b16 v[130:131], v12 offset:7168
  v_mfma_f32_32x32x16_bf16 v[40:55], v[108:111], v[56:59], v[40:55]
  ds_read_b64_tr_b16 v[132:133], v13 offset:6144
  ds_read_b64_tr_b16 v[134:135], v13 offset:7168
  s_waitcnt lgkmcnt(8)
  v_mfma_f32_32x32x16_bf16 v[24:39], v[112:115], v[60:63], v[24:39]
  v_mfma_f32_32x32x16_bf16 v[40:55], v[116:119], v[60:63], v[40:55]
  s_waitcnt lgkmcnt(4)
  v_mfma_f32_32x32x16_bf16 v[24:39], v[120:123], v[64:67], v[24:39]
  v_mfma_f32_32x32x16_bf16 v[40:55], v[124:127], v[64:67], v[40:55]
  s_waitcnt lgkmcnt(0)
  v_mfma_f32_32x32x16_bf16 v[24:39], v[128:131], v[68:71], v[24:39]
  v_mfma_f32_32x32x16_bf16 v[40:55], v[132:135], v[68:71], v[40:55]
  s_lshl_b32 s28, s17, 4
  s_add_u32 s28, s28, s18
  s_lshl_b32 s28, s28, 2
  s_add_u32 s28, s28, s16
  s_lshl_b32 s28, s28, 12
  s_add_u32 s28, s28, s63
  s_add_u32 s28, s28, 0xc00000
  s_lshl_b32 s29, s16, 12
  v_add_u32 v6, s29, v22
  s_mov_b32 s36, 0x3f803f80
  v_mov_b32 v8, 0
  v_mov_b32 v9, 0
  v_mov_b32 v10, 0
  v_lshlrev_b32 v7, 8, v18
  v_cvt_pk_bf16_f32 v56, v24, v25
  v_cvt_pk_bf16_f32 v57, v26, v27
  v_cvt_pk_bf16_f32 v58, v28, v29
  v_cvt_pk_bf16_f32 v59, v30, v31
  buffer_store_dwordx4 v[56:59], v22, s[4:7], s28 offen offset:0 sc1
  v_cvt_pk_bf16_f32 v60, v32, v33
  v_cvt_pk_bf16_f32 v61, v34, v35
  v_cvt_pk_bf16_f32 v62, v36, v37
  v_cvt_pk_bf16_f32 v63, v38, v39
  buffer_store_dwordx4 v[60:63], v22, s[4:7], s28 offen offset:512 sc1
  v_cvt_pk_bf16_f32 v64, v40, v41
  v_cvt_pk_bf16_f32 v65, v42, v43
  v_cvt_pk_bf16_f32 v66, v44, v45
  v_cvt_pk_bf16_f32 v67, v46, v47
  buffer_store_dwordx4 v[64:67], v22, s[4:7], s28 offen offset:1024 sc1
  v_cvt_pk_bf16_f32 v68, v48, v49
  v_cvt_pk_bf16_f32 v69, v50, v51
  v_cvt_pk_bf16_f32 v70, v52, v53
  v_cvt_pk_bf16_f32 v71, v54, v55
  buffer_store_dwordx4 v[68:71], v22, s[4:7], s28 offen offset:1536 sc1
  ds_write_b128 v6, v[56:59] offset:0
  ds_write_b128 v6, v[60:63] offset:512
  ds_write_b128 v6, v[64:67] offset:1024
  ds_write_b128 v6, v[68:71] offset:1536
  s_mov_b64 exec, 1
  ds_add_u32 v20, v5 offset:20
  s_mov_b64 exec, -1
  s_lshl_b32 s28, s17, 2
  s_add_u32 s28, s28, s16
  s_lshl_b32 s28, s28, 13
  s_lshl_b32 s29, s18, 4
  s_add_u32 s28, s28, s29
  s_add_u32 s28, s28, s63
  s_add_u32 s28, s28, 0x1000000
  v_dot2c_f32_bf16 v8, s36, v56
  v_dot2c_f32_bf16 v9, v56, v56
  v_dot2c_f32_bf16 v10, v56, v240
  v_dot2c_f32_bf16 v8, s36, v57
  v_dot2c_f32_bf16 v9, v57, v57
  v_dot2c_f32_bf16 v10, v57, v241
  v_dot2c_f32_bf16 v8, s36, v58
  v_dot2c_f32_bf16 v9, v58, v58
  v_dot2c_f32_bf16 v10, v58, v242
  v_dot2c_f32_bf16 v8, s36, v59
  v_dot2c_f32_bf16 v9, v59, v59
  v_dot2c_f32_bf16 v10, v59, v243
  v_dot2c_f32_bf16 v8, s36, v60
  v_dot2c_f32_bf16 v9, v60, v60
  v_dot2c_f32_bf16 v10, v60, v244
  v_dot2c_f32_bf16 v8, s36, v61
  v_dot2c_f32_bf16 v9, v61, v61
  v_dot2c_f32_bf16 v10, v61, v245
  v_dot2c_f32_bf16 v8, s36, v62
  v_dot2c_f32_bf16 v9, v62, v62
  v_dot2c_f32_bf16 v10, v62, v246
  v_dot2c_f32_bf16 v8, s36, v63
  v_dot2c_f32_bf16 v9, v63, v63
  v_dot2c_f32_bf16 v10, v63, v247
  v_dot2c_f32_bf16 v8, s36, v64
  v_dot2c_f32_bf16 v9, v64, v64
  v_dot2c_f32_bf16 v10, v64, v248
  v_dot2c_f32_bf16 v8, s36, v65
  v_dot2c_f32_bf16 v9, v65, v65
  v_dot2c_f32_bf16 v10, v65, v249
  v_dot2c_f32_bf16 v8, s36, v66
  v_dot2c_f32_bf16 v9, v66, v66
  v_dot2c_f32_bf16 v10, v66, v250
  v_dot2c_f32_bf16 v8, s36, v67
  v_dot2c_f32_bf16 v9, v67, v67
  v_dot2c_f32_bf16 v10, v67, v251
  v_dot2c_f32_bf16 v8, s36, v68
  v_dot2c_f32_bf16 v9, v68, v68
  v_dot2c_f32_bf16 v10, v68, v252
  v_dot2c_f32_bf16 v8, s36, v69
  v_dot2c_f32_bf16 v9, v69, v69
  v_dot2c_f32_bf16 v10, v69, v253
  v_dot2c_f32_bf16 v8, s36, v70
  v_dot2c_f32_bf16 v9, v70, v70
  v_dot2c_f32_bf16 v10, v70, v254
  v_dot2c_f32_bf16 v8, s36, v71
  v_dot2c_f32_bf16 v9, v71, v71
  v_dot2c_f32_bf16 v10, v71, v255
  s_lshl_b32 s29, s16, 7
  s_add_u32 s37, s19, s29
  v_mov_b32 v24, v8
  v_mov_b32 v25, v9
  v_mov_b32 v26, v10
  v_mov_b32 v11, 1
  v_permlane32_swap_b32 v8, v24
  v_permlane32_swap_b32 v9, v25
  v_permlane32_swap_b32 v10, v26
  v_add_f32 v8, v8, v24
  v_add_f32 v9, v9, v25
  v_add_f32 v10, v10, v26
  v_or_b32 v8, 1, v8
  v_mov_b32 v16, s70
  s_mov_b32 exec_hi, 0
  s_waitcnt vmcnt(0)
  buffer_store_dwordx4 v[8:11], v7, s[4:7], s28 offen sc1
  s_mov_b64 exec, 1
  buffer_store_dword v16, v4, s[4:7], s37 offen offset:8 sc1
  s_mov_b64 exec, -1
  s_cmp_lg_u32 s62, 0
  s_cbranch_scc1 .g2_kernel_tail
  s_mov_b32 s62, 1
  s_mov_b32 s63, 0x1800000
  s_mov_b32 s70, 2
  s_mov_b32 s71, 155776
  s_branch .g2_kernel_q_cons2
.g2_kernel_tail:
  s_mov_b32 s28, s56
  s_mov_b32 s29, s57
  s_mov_b32 s30, 0x400000
  s_mov_b32 s31, 0x00020000
  v_lshlrev_b32 v24, 16, v56
  v_and_b32 v25, 0xffff0000, v56
  v_lshlrev_b32 v26, 16, v57
  v_and_b32 v27, 0xffff0000, v57
  v_lshlrev_b32 v28, 16, v58
  v_and_b32 v29, 0xffff0000, v58
  v_lshlrev_b32 v30, 16, v59
  v_and_b32 v31, 0xffff0000, v59
  v_lshlrev_b32 v32, 16, v60
  v_and_b32 v33, 0xffff0000, v60
  v_lshlrev_b32 v34, 16, v61
  v_and_b32 v35, 0xffff0000, v61
  v_lshlrev_b32 v36, 16, v62
  v_and_b32 v37, 0xffff0000, v62
  v_lshlrev_b32 v38, 16, v63
  v_and_b32 v39, 0xffff0000, v63
  v_lshlrev_b32 v40, 16, v64
  v_and_b32 v41, 0xffff0000, v64
  v_lshlrev_b32 v42, 16, v65
  v_and_b32 v43, 0xffff0000, v65
  v_lshlrev_b32 v44, 16, v66
  v_and_b32 v45, 0xffff0000, v66
  v_lshlrev_b32 v46, 16, v67
  v_and_b32 v47, 0xffff0000, v67
  v_lshlrev_b32 v48, 16, v68
  v_and_b32 v49, 0xffff0000, v68
  v_lshlrev_b32 v50, 16, v69
  v_and_b32 v51, 0xffff0000, v69
  v_lshlrev_b32 v52, 16, v70
  v_and_b32 v53, 0xffff0000, v70
  v_lshlrev_b32 v54, 16, v71
  v_and_b32 v55, 0xffff0000, v71
  v_lshlrev_b32 v10, 2, v19
  v_add_u32 v10, 155644, v10
  s_lshl_b32 s32, s17, 2
  s_add_u32 s32, s32, s16
  s_lshl_b32 s32, s32, 16
  s_lshl_b32 s33, s18, 7
  s_add_u32 s32, s32, s33
  v_mov_b32 v6, s71
  s_mov_b32 s38, 0
.g2_kernel_wg5:
  ds_read_b32 v7, v6 offset:28
  s_add_u32 s38, s38, 1
  s_waitcnt lgkmcnt(0)
  v_cmp_le_u32 vcc, 1, v7
  s_cbranch_vccnz .g2_kernel_wg5d
  s_sleep 2
  s_cmp_lt_u32 s38, 524288
  s_cbranch_scc1 .g2_kernel_wg5
.g2_kernel_wg5d:
  ds_read_b32 v8, v10 offset:3840
  ds_read_b32 v9, v10 offset:4352
  ds_read_b32 v16, v20 offset:32
  s_waitcnt lgkmcnt(0)
  v_cmp_ne_u32 vcc, v16, v19
  v_pk_fma_f32 v[24:25], v[24:25], v[8:9], v[8:9] op_sel:[0,0,1] op_sel_hi:[1,0,1]
  v_pk_fma_f32 v[26:27], v[26:27], v[8:9], v[8:9] op_sel:[0,0,1] op_sel_hi:[1,0,1]
  v_pk_fma_f32 v[28:29], v[28:29], v[8:9], v[8:9] op_sel:[0,0,1] op_sel_hi:[1,0,1]
  v_pk_fma_f32 v[30:31], v[30:31], v[8:9], v[8:9] op_sel:[0,0,1] op_sel_hi:[1,0,1]
  v_pk_fma_f32 v[32:33], v[32:33], v[8:9], v[8:9] op_sel:[0,0,1] op_sel_hi:[1,0,1]
  v_pk_fma_f32 v[34:35], v[34:35], v[8:9], v[8:9] op_sel:[0,0,1] op_sel_hi:[1,0,1]
  v_pk_fma_f32 v[36:37], v[36:37], v[8:9], v[8:9] op_sel:[0,0,1] op_sel_hi:[1,0,1]
  v_pk_fma_f32 v[38:39], v[38:39], v[8:9], v[8:9] op_sel:[0,0,1] op_sel_hi:[1,0,1]
  v_pk_fma_f32 v[40:41], v[40:41], v[8:9], v[8:9] op_sel:[0,0,1] op_sel_hi:[1,0,1]
  v_pk_fma_f32 v[42:43], v[42:43], v[8:9], v[8:9] op_sel:[0,0,1] op_sel_hi:[1,0,1]
  v_pk_fma_f32 v[44:45], v[44:45], v[8:9], v[8:9] op_sel:[0,0,1] op_sel_hi:[1,0,1]
  v_pk_fma_f32 v[46:47], v[46:47], v[8:9], v[8:9] op_sel:[0,0,1] op_sel_hi:[1,0,1]
  v_pk_fma_f32 v[48:49], v[48:49], v[8:9], v[8:9] op_sel:[0,0,1] op_sel_hi:[1,0,1]
  v_pk_fma_f32 v[50:51], v[50:51], v[8:9], v[8:9] op_sel:[0,0,1] op_sel_hi:[1,0,1]
  v_pk_fma_f32 v[52:53], v[52:53], v[8:9], v[8:9] op_sel:[0,0,1] op_sel_hi:[1,0,1]
  v_pk_fma_f32 v[54:55], v[54:55], v[8:9], v[8:9] op_sel:[0,0,1] op_sel_hi:[1,0,1]
  v_cvt_pk_bf16_f32 v56, v24, v25
  v_cvt_pk_bf16_f32 v57, v26, v27
  v_cvt_pk_bf16_f32 v58, v28, v29
  v_cvt_pk_bf16_f32 v59, v30, v31
  v_cvt_pk_bf16_f32 v60, v32, v33
  v_cvt_pk_bf16_f32 v61, v34, v35
  v_cvt_pk_bf16_f32 v62, v36, v37
  v_cvt_pk_bf16_f32 v63, v38, v39
  v_cvt_pk_bf16_f32 v64, v40, v41
  v_cvt_pk_bf16_f32 v65, v42, v43
  v_cvt_pk_bf16_f32 v66, v44, v45
  v_cvt_pk_bf16_f32 v67, v46, v47
  v_cvt_pk_bf16_f32 v68, v48, v49
  v_cvt_pk_bf16_f32 v69, v50, v51
  v_cvt_pk_bf16_f32 v70, v52, v53
  v_cvt_pk_bf16_f32 v71, v54, v55
  s_mov_b64 exec, vcc
  buffer_store_dwordx4 v[56:59], v23, s[28:31], s32 offen offset:0
  buffer_store_dwordx4 v[60:63], v23, s[28:31], s32 offen offset:32
  buffer_store_dwordx4 v[64:67], v23, s[28:31], s32 offen offset:64
  buffer_store_dwordx4 v[68:71], v23, s[28:31], s32 offen offset:96
  s_mov_b64 exec, -1
  s_branch .g2_kernel_fin
.g2_kernel_svc:
  s_cmp_eq_u32 s16, 5
  s_cbranch_scc1 .g2_kernel_s1
  s_cmp_eq_u32 s16, 6
  s_cbranch_scc1 .g2_kernel_s2
  s_cmp_eq_u32 s16, 7
  s_cbranch_scc1 .g2_kernel_s3
  s_mov_b32 s8, s40
  s_mov_b32 s9, s41
  s_mov_b32 s10, 0x400000
  s_mov_b32 s11, 0x00020000
  s_setprio 3
  v_lshrrev_b32 v20, 3, v2
  v_and_b32 v21, 7, v2
  v_lshrrev_b32 v22, 4, v2
  v_xor_b32 v23, v21, v22
  v_lshlrev_b32 v23, 4, v23
  v_lshl_add_u32 v24, v20, 11, v23
  v_xor_b32 v25, 64, v24
  s_lshl_b32 s32, s17, 18
  v_add_u32 v32, 0, v24
  v_add_u32 v33, 15360, v25
  v_add_u32 v34, 30720, v24
  v_add_u32 v35, 46080, v25
  v_add_u32 v36, 65536, v24
  v_add_u32 v37, 80896, v25
  v_add_u32 v38, 96256, v24
  v_add_u32 v39, 111616, v25
  v_add_u32 v40, 131072, v24
  v_add_u32 v41, 146432, v25
  v_add_u32 v42, 161792, v24
  v_add_u32 v43, 177152, v25
  v_add_u32 v44, 196608, v24
  v_add_u32 v45, 211968, v25
  v_add_u32 v46, 227328, v24
  v_add_u32 v47, 242688, v25
  s_mov_b32 s29, 0
  s_add_u32 m0, s29, 0
  s_nop 0
  buffer_load_dwordx4 v32, s[8:11], s32 offen offset:0 lds
  buffer_load_dwordx4 v33, s[8:11], s32 offen offset:1024 lds
  buffer_load_dwordx4 v34, s[8:11], s32 offen offset:2048 lds
  buffer_load_dwordx4 v35, s[8:11], s32 offen offset:3072 lds
  s_add_u32 m0, s29, 4096
  s_nop 0
  buffer_load_dwordx4 v36, s[8:11], s32 offen offset:0 lds
  buffer_load_dwordx4 v37, s[8:11], s32 offen offset:1024 lds
  buffer_load_dwordx4 v38, s[8:11], s32 offen offset:2048 lds
  buffer_load_dwordx4 v39, s[8:11], s32 offen offset:3072 lds
  s_add_u32 m0, s29, 8192
  s_nop 0
  buffer_load_dwordx4 v40, s[8:11], s32 offen offset:0 lds
  buffer_load_dwordx4 v41, s[8:11], s32 offen offset:1024 lds
  buffer_load_dwordx4 v42, s[8:11], s32 offen offset:2048 lds
  buffer_load_dwordx4 v43, s[8:11], s32 offen offset:3072 lds
  s_add_u32 m0, s29, 12288
  s_nop 0
  buffer_load_dwordx4 v44, s[8:11], s32 offen offset:0 lds
  buffer_load_dwordx4 v45, s[8:11], s32 offen offset:1024 lds
  buffer_load_dwordx4 v46, s[8:11], s32 offen offset:2048 lds
  buffer_load_dwordx4 v47, s[8:11], s32 offen offset:3072 lds
  s_add_u32 s32, s32, 128
  s_mov_b32 s12, s42
  s_mov_b32 s13, s43
  s_mov_b32 s14, 0x600000
  s_mov_b32 s15, 0x00020000
  v_lshrrev_b32 v28, 3, v2
  v_and_b32 v29, 7, v2
  v_bfe_u32 v30, v2, 4, 1
  v_lshlrev_b32 v30, 1, v30
  v_xor_b32 v31, v29, v30
  v_lshlrev_b32 v31, 4, v31
  v_mul_u32_u24 v28, 6144, v28
  v_add_u32 v28, v28, v31
  v_xor_b32 v29, 64, v28
  v_lshlrev_b32 v9, 8, v2
  v_and_b32 v9, 0x300, v9
  v_add_u32 v9, 156416, v9
  v_add_u32 v48, 0, v28
  v_add_u32 v49, 48128, v29
  v_add_u32 v50, 96256, v28
  v_add_u32 v51, 144384, v29
  v_add_u32 v52, 2048, v28
  v_add_u32 v53, 50176, v29
  v_add_u32 v54, 98304, v28
  v_add_u32 v55, 146432, v29
  v_add_u32 v56, 4096, v28
  v_add_u32 v57, 52224, v29
  v_add_u32 v58, 100352, v28
  v_add_u32 v59, 148480, v29
  s_lshl_b32 s36, s18, 7
  s_mov_b32 s30, 0
  s_add_u32 m0, s30, 65536
  s_nop 0
  buffer_load_dwordx4 v48, s[12:15], s36 offen offset:0 lds
  buffer_load_dwordx4 v49, s[12:15], s36 offen offset:1024 lds
  buffer_load_dwordx4 v50, s[12:15], s36 offen offset:2048 lds
  buffer_load_dwordx4 v51, s[12:15], s36 offen offset:3072 lds
  s_add_u32 m0, s30, 69632
  s_nop 0
  buffer_load_dwordx4 v52, s[12:15], s36 offen offset:0 lds
  buffer_load_dwordx4 v53, s[12:15], s36 offen offset:1024 lds
  buffer_load_dwordx4 v54, s[12:15], s36 offen offset:2048 lds
  buffer_load_dwordx4 v55, s[12:15], s36 offen offset:3072 lds
  s_add_u32 m0, s30, 73728
  s_nop 0
  buffer_load_dwordx4 v56, s[12:15], s36 offen offset:0 lds
  buffer_load_dwordx4 v57, s[12:15], s36 offen offset:1024 lds
  buffer_load_dwordx4 v58, s[12:15], s36 offen offset:2048 lds
  buffer_load_dwordx4 v59, s[12:15], s36 offen offset:3072 lds
  s_add_u32 s30, s30, 12288
  s_cmp_eq_u32 s30, 86016
  s_cselect_b32 s30, 0, s30
  s_barrier
  s_mov_b32 s35, .g2_kernel_tab-.g2_kernel_pc+4
  s_mov_b32 s34, -5
  v_mov_b32 v10, 0
  s_mov_b32 m0, 156160
  s_add_u32 s36, s36, 196608
  buffer_load_dword off, s[64:67], s35 lds
  s_add_u32 s35, s35, 4
  s_branch .g2_kernel_p1_o
  .p2align 6
.g2_kernel_p1_l:
  s_waitcnt lgkmcnt(0)
  v_cmp_gt_i32 vcc, s34, v10
  s_cbranch_vccnz .g2_kernel_p1_aw
.g2_kernel_p1_ai:
  s_add_u32 s29, s29, 16384
  s_and_b32 s29, s29, 0xffff
  s_add_u32 m0, s29, 0
  s_nop 0
  buffer_load_dwordx4 v32, s[8:11], s32 offen offset:0 lds
  buffer_load_dwordx4 v33, s[8:11], s32 offen offset:1024 lds
  buffer_load_dwordx4 v34, s[8:11], s32 offen offset:2048 lds
  buffer_load_dwordx4 v35, s[8:11], s32 offen offset:3072 lds
  s_add_u32 m0, s29, 4096
  s_nop 0
  buffer_load_dwordx4 v36, s[8:11], s32 offen offset:0 lds
  buffer_load_dwordx4 v37, s[8:11], s32 offen offset:1024 lds
  buffer_load_dwordx4 v38, s[8:11], s32 offen offset:2048 lds
  buffer_load_dwordx4 v39, s[8:11], s32 offen offset:3072 lds
  s_add_u32 m0, s29, 8192
  s_nop 0
  buffer_load_dwordx4 v40, s[8:11], s32 offen offset:0 lds
  buffer_load_dwordx4 v41, s[8:11], s32 offen offset:1024 lds
  buffer_load_dwordx4 v42, s[8:11], s32 offen offset:2048 lds
  buffer_load_dwordx4 v43, s[8:11], s32 offen offset:3072 lds
  s_add_u32 m0, s29, 12288
  s_nop 0
  buffer_load_dwordx4 v44, s[8:11], s32 offen offset:0 lds
  buffer_load_dwordx4 v45, s[8:11], s32 offen offset:1024 lds
  buffer_load_dwordx4 v46, s[8:11], s32 offen offset:2048 lds
  buffer_load_dwordx4 v47, s[8:11], s32 offen offset:3072 lds
  s_add_u32 s32, s32, 128
  s_add_u32 m0, s30, 65536
  s_nop 0
  buffer_load_dwordx4 v48, s[12:15], s36 offen offset:0 lds
  buffer_load_dwordx4 v49, s[12:15], s36 offen offset:1024 lds
  buffer_load_dwordx4 v50, s[12:15], s36 offen offset:2048 lds
  buffer_load_dwordx4 v51, s[12:15], s36 offen offset:3072 lds
  s_add_u32 m0, s30, 69632
  s_nop 0
  buffer_load_dwordx4 v52, s[12:15], s36 offen offset:0 lds
  buffer_load_dwordx4 v53, s[12:15], s36 offen offset:1024 lds
  buffer_load_dwordx4 v54, s[12:15], s36 offen offset:2048 lds
  buffer_load_dwordx4 v55, s[12:15], s36 offen offset:3072 lds
  s_add_u32 m0, s30, 73728
  s_nop 0
  buffer_load_dwordx4 v56, s[12:15], s36 offen offset:0 lds
  buffer_load_dwordx4 v57, s[12:15], s36 offen offset:1024 lds
  buffer_load_dwordx4 v58, s[12:15], s36 offen offset:2048 lds
  buffer_load_dwordx4 v59, s[12:15], s36 offen offset:3072 lds
  s_add_u32 s30, s30, 12288
  s_cmp_eq_u32 s30, 86016
  s_cselect_b32 s30, 0, s30
  ds_read_b32 v10, v9
  s_mov_b32 m0, 156160
  s_add_u32 s34, s34, 1
  buffer_load_dword off, s[64:67], s35 lds
  s_add_u32 s35, s35, 4
  s_add_u32 s36, s36, 196608
.g2_kernel_p1_o:
  s_waitcnt lgkmcnt(0)
  v_cmp_gt_i32 vcc, s34, v10
  s_cbranch_vccnz .g2_kernel_p1_bw
.g2_kernel_p1_bi:
  s_add_u32 m0, s30, 65536
  s_nop 0
  buffer_load_dwordx4 v48, s[12:15], s36 offen offset:0 lds
  buffer_load_dwordx4 v49, s[12:15], s36 offen offset:1024 lds
  buffer_load_dwordx4 v50, s[12:15], s36 offen offset:2048 lds
  buffer_load_dwordx4 v51, s[12:15], s36 offen offset:3072 lds
  s_add_u32 m0, s30, 69632
  s_nop 0
  buffer_load_dwordx4 v52, s[12:15], s36 offen offset:0 lds
  buffer_load_dwordx4 v53, s[12:15], s36 offen offset:1024 lds
  buffer_load_dwordx4 v54, s[12:15], s36 offen offset:2048 lds
  buffer_load_dwordx4 v55, s[12:15], s36 offen offset:3072 lds
  s_add_u32 m0, s30, 73728
  s_nop 0
  buffer_load_dwordx4 v56, s[12:15], s36 offen offset:0 lds
  buffer_load_dwordx4 v57, s[12:15], s36 offen offset:1024 lds
  buffer_load_dwordx4 v58, s[12:15], s36 offen offset:2048 lds
  buffer_load_dwordx4 v59, s[12:15], s36 offen offset:3072 lds
  s_add_u32 s30, s30, 12288
  s_cmp_eq_u32 s30, 86016
  s_cselect_b32 s30, 0, s30
  ds_read_b32 v10, v9
  s_mov_b32 m0, 156160
  s_add_u32 s34, s34, 1
  buffer_load_dword off, s[64:67], s35 lds
  s_add_u32 s35, s35, 4
  s_add_u32 s36, s36, 196608
  s_cmp_lt_i32 s34, 26
  s_cbranch_scc1 .g2_kernel_p1_l
  s_branch .g2_kernel_v
.g2_kernel_s1:
  s_mov_b32 s8, s40
  s_mov_b32 s9, s41
  s_mov_b32 s10, 0x400000
  s_mov_b32 s11, 0x00020000
  v_lshrrev_b32 v20, 3, v2
  v_and_b32 v21, 7, v2
  v_lshlrev_b32 v21, 4, v21
  v_lshl_add_u32 v21, v20, 11, v21
  s_lshl_b32 s30, s17, 4
  s_add_u32 s30, s30, s18
  s_lshl_b32 s33, s30, 5
  s_lshl_b32 s30, s30, 14
  s_barrier
  s_sleep 30
  buffer_load_dwordx4 v[64:67], v21, s[8:11], s30 offen offset:0
  buffer_load_dwordx4 v[68:71], v21, s[8:11], s30 offen offset:128
  buffer_load_dwordx4 v[72:75], v21, s[8:11], s30 offen offset:256
  buffer_load_dwordx4 v[76:79], v21, s[8:11], s30 offen offset:384
  buffer_load_dwordx4 v[80:83], v21, s[8:11], s30 offen offset:512
  buffer_load_dwordx4 v[84:87], v21, s[8:11], s30 offen offset:640
  buffer_load_dwordx4 v[88:91], v21, s[8:11], s30 offen offset:768
  buffer_load_dwordx4 v[92:95], v21, s[8:11], s30 offen offset:896
  buffer_load_dwordx4 v[96:99], v21, s[8:11], s30 offen offset:1024
  buffer_load_dwordx4 v[100:103], v21, s[8:11], s30 offen offset:1152
  buffer_load_dwordx4 v[104:107], v21, s[8:11], s30 offen offset:1280
  buffer_load_dwordx4 v[108:111], v21, s[8:11], s30 offen offset:1408
  buffer_load_dwordx4 v[112:115], v21, s[8:11], s30 offen offset:1536
  buffer_load_dwordx4 v[116:119], v21, s[8:11], s30 offen offset:1664
  buffer_load_dwordx4 v[120:123], v21, s[8:11], s30 offen offset:1792
  buffer_load_dwordx4 v[124:127], v21, s[8:11], s30 offen offset:1920
  v_mov_b32 v24, 0
  v_mov_b32 v25, 0
  v_mov_b32 v26, 0
  v_mov_b32 v27, 0
  s_waitcnt vmcnt(15)
  v_lshlrev_b32 v22, 16, v64
  v_and_b32 v64, 0xffff0000, v64
  v_add_f32 v24, v24, v22
  v_fmac_f32 v25, v22, v22
  v_add_f32 v26, v26, v64
  v_fmac_f32 v27, v64, v64
  v_lshlrev_b32 v22, 16, v65
  v_and_b32 v65, 0xffff0000, v65
  v_add_f32 v24, v24, v22
  v_fmac_f32 v25, v22, v22
  v_add_f32 v26, v26, v65
  v_fmac_f32 v27, v65, v65
  v_lshlrev_b32 v22, 16, v66
  v_and_b32 v66, 0xffff0000, v66
  v_add_f32 v24, v24, v22
  v_fmac_f32 v25, v22, v22
  v_add_f32 v26, v26, v66
  v_fmac_f32 v27, v66, v66
  v_lshlrev_b32 v22, 16, v67
  v_and_b32 v67, 0xffff0000, v67
  v_add_f32 v24, v24, v22
  v_fmac_f32 v25, v22, v22
  v_add_f32 v26, v26, v67
  v_fmac_f32 v27, v67, v67
  s_waitcnt vmcnt(14)
  v_lshlrev_b32 v22, 16, v68
  v_and_b32 v68, 0xffff0000, v68
  v_add_f32 v24, v24, v22
  v_fmac_f32 v25, v22, v22
  v_add_f32 v26, v26, v68
  v_fmac_f32 v27, v68, v68
  v_lshlrev_b32 v22, 16, v69
  v_and_b32 v69, 0xffff0000, v69
  v_add_f32 v24, v24, v22
  v_fmac_f32 v25, v22, v22
  v_add_f32 v26, v26, v69
  v_fmac_f32 v27, v69, v69
  v_lshlrev_b32 v22, 16, v70
  v_and_b32 v70, 0xffff0000, v70
  v_add_f32 v24, v24, v22
  v_fmac_f32 v25, v22, v22
  v_add_f32 v26, v26, v70
  v_fmac_f32 v27, v70, v70
  v_lshlrev_b32 v22, 16, v71
  v_and_b32 v71, 0xffff0000, v71
  v_add_f32 v24, v24, v22
  v_fmac_f32 v25, v22, v22
  v_add_f32 v26, v26, v71
  v_fmac_f32 v27, v71, v71
  s_waitcnt vmcnt(13)
  v_lshlrev_b32 v22, 16, v72
  v_and_b32 v72, 0xffff0000, v72
  v_add_f32 v24, v24, v22
  v_fmac_f32 v25, v22, v22
  v_add_f32 v26, v26, v72
  v_fmac_f32 v27, v72, v72
  v_lshlrev_b32 v22, 16, v73
  v_and_b32 v73, 0xffff0000, v73
  v_add_f32 v24, v24, v22
  v_fmac_f32 v25, v22, v22
  v_add_f32 v26, v26, v73
  v_fmac_f32 v27, v73, v73
  v_lshlrev_b32 v22, 16, v74
  v_and_b32 v74, 0xffff0000, v74
  v_add_f32 v24, v24, v22
  v_fmac_f32 v25, v22, v22
  v_add_f32 v26, v26, v74
  v_fmac_f32 v27, v74, v74
  v_lshlrev_b32 v22, 16, v75
  v_and_b32 v75, 0xffff0000, v75
  v_add_f32 v24, v24, v22
  v_fmac_f32 v25, v22, v22
  v_add_f32 v26, v26, v75
  v_fmac_f32 v27, v75, v75
  s_waitcnt vmcnt(12)
  v_lshlrev_b32 v22, 16, v76
  v_and_b32 v76, 0xffff0000, v76
  v_add_f32 v24, v24, v22
  v_fmac_f32 v25, v22, v22
  v_add_f32 v26, v26, v76
  v_fmac_f32 v27, v76, v76
  v_lshlrev_b32 v22, 16, v77
  v_and_b32 v77, 0xffff0000, v77
  v_add_f32 v24, v24, v22
  v_fmac_f32 v25, v22, v22
  v_add_f32 v26, v26, v77
  v_fmac_f32 v27, v77, v77
  v_lshlrev_b32 v22, 16, v78
  v_and_b32 v78, 0xffff0000, v78
  v_add_f32 v24, v24, v22
  v_fmac_f32 v25, v22, v22
  v_add_f32 v26, v26, v78
  v_fmac_f32 v27, v78, v78
  v_lshlrev_b32 v22, 16, v79
  v_and_b32 v79, 0xffff0000, v79
  v_add_f32 v24, v24, v22
  v_fmac_f32 v25, v22, v22
  v_add_f32 v26, v26, v79
  v_fmac_f32 v27, v79, v79
  s_waitcnt vmcnt(11)
  v_lshlrev_b32 v22, 16, v80
  v_and_b32 v80, 0xffff0000, v80
  v_add_f32 v24, v24, v22
  v_fmac_f32 v25, v22, v22
  v_add_f32 v26, v26, v80
  v_fmac_f32 v27, v80, v80
  v_lshlrev_b32 v22, 16, v81
  v_and_b32 v81, 0xffff0000, v81
  v_add_f32 v24, v24, v22
  v_fmac_f32 v25, v22, v22
  v_add_f32 v26, v26, v81
  v_fmac_f32 v27, v81, v81
  v_lshlrev_b32 v22, 16, v82
  v_and_b32 v82, 0xffff0000, v82
  v_add_f32 v24, v24, v22
  v_fmac_f32 v25, v22, v22
  v_add_f32 v26, v26, v82
  v_fmac_f32 v27, v82, v82
  v_lshlrev_b32 v22, 16, v83
  v_and_b32 v83, 0xffff0000, v83
  v_add_f32 v24, v24, v22
  v_fmac_f32 v25, v22, v22
  v_add_f32 v26, v26, v83
  v_fmac_f32 v27, v83, v83
  s_waitcnt vmcnt(10)
  v_lshlrev_b32 v22, 16, v84
  v_and_b32 v84, 0xffff0000, v84
  v_add_f32 v24, v24, v22
  v_fmac_f32 v25, v22, v22
  v_add_f32 v26, v26, v84
  v_fmac_f32 v27, v84, v84
  v_lshlrev_b32 v22, 16, v85
  v_and_b32 v85, 0xffff0000, v85
  v_add_f32 v24, v24, v22
  v_fmac_f32 v25, v22, v22
  v_add_f32 v26, v26, v85
  v_fmac_f32 v27, v85, v85
  v_lshlrev_b32 v22, 16, v86
  v_and_b32 v86, 0xffff0000, v86
  v_add_f32 v24, v24, v22
  v_fmac_f32 v25, v22, v22
  v_add_f32 v26, v26, v86
  v_fmac_f32 v27, v86, v86
  v_lshlrev_b32 v22, 16, v87
  v_and_b32 v87, 0xffff0000, v87
  v_add_f32 v24, v24, v22
  v_fmac_f32 v25, v22, v22
  v_add_f32 v26, v26, v87
  v_fmac_f32 v27, v87, v87
  s_waitcnt vmcnt(9)
  v_lshlrev_b32 v22, 16, v88
  v_and_b32 v88, 0xffff0000, v88
  v_add_f32 v24, v24, v22
  v_fmac_f32 v25, v22, v22
  v_add_f32 v26, v26, v88
  v_fmac_f32 v27, v88, v88
  v_lshlrev_b32 v22, 16, v89
  v_and_b32 v89, 0xffff0000, v89
  v_add_f32 v24, v24, v22
  v_fmac_f32 v25, v22, v22
  v_add_f32 v26, v26, v89
  v_fmac_f32 v27, v89, v89
  v_lshlrev_b32 v22, 16, v90
  v_and_b32 v90, 0xffff0000, v90
  v_add_f32 v24, v24, v22
  v_fmac_f32 v25, v22, v22
  v_add_f32 v26, v26, v90
  v_fmac_f32 v27, v90, v90
  v_lshlrev_b32 v22, 16, v91
  v_and_b32 v91, 0xffff0000, v91
  v_add_f32 v24, v24, v22
  v_fmac_f32 v25, v22, v22
  v_add_f32 v26, v26, v91
  v_fmac_f32 v27, v91, v91
  s_waitcnt vmcnt(8)
  v_lshlrev_b32 v22, 16, v92
  v_and_b32 v92, 0xffff0000, v92
  v_add_f32 v24, v24, v22
  v_fmac_f32 v25, v22, v22
  v_add_f32 v26, v26, v92
  v_fmac_f32 v27, v92, v92
  v_lshlrev_b32 v22, 16, v93
  v_and_b32 v93, 0xffff0000, v93
  v_add_f32 v24, v24, v22
  v_fmac_f32 v25, v22, v22
  v_add_f32 v26, v26, v93
  v_fmac_f32 v27, v93, v93
  v_lshlrev_b32 v22, 16, v94
  v_and_b32 v94, 0xffff0000, v94
  v_add_f32 v24, v24, v22
  v_fmac_f32 v25, v22, v22
  v_add_f32 v26, v26, v94
  v_fmac_f32 v27, v94, v94
  v_lshlrev_b32 v22, 16, v95
  v_and_b32 v95, 0xffff0000, v95
  v_add_f32 v24, v24, v22
  v_fmac_f32 v25, v22, v22
  v_add_f32 v26, v26, v95
  v_fmac_f32 v27, v95, v95
  s_waitcnt vmcnt(7)
  v_lshlrev_b32 v22, 16, v96
  v_and_b32 v96, 0xffff0000, v96
  v_add_f32 v24, v24, v22
  v_fmac_f32 v25, v22, v22
  v_add_f32 v26, v26, v96
  v_fmac_f32 v27, v96, v96
  v_lshlrev_b32 v22, 16, v97
  v_and_b32 v97, 0xffff0000, v97
  v_add_f32 v24, v24, v22
  v_fmac_f32 v25, v22, v22
  v_add_f32 v26, v26, v97
  v_fmac_f32 v27, v97, v97
  v_lshlrev_b32 v22, 16, v98
  v_and_b32 v98, 0xffff0000, v98
  v_add_f32 v24, v24, v22
  v_fmac_f32 v25, v22, v22
  v_add_f32 v26, v26, v98
  v_fmac_f32 v27, v98, v98
  v_lshlrev_b32 v22, 16, v99
  v_and_b32 v99, 0xffff0000, v99
  v_add_f32 v24, v24, v22
  v_fmac_f32 v25, v22, v22
  v_add_f32 v26, v26, v99
  v_fmac_f32 v27, v99, v99
  s_waitcnt vmcnt(6)
  v_lshlrev_b32 v22, 16, v100
  v_and_b32 v100, 0xffff0000, v100
  v_add_f32 v24, v24, v22
  v_fmac_f32 v25, v22, v22
  v_add_f32 v26, v26, v100
  v_fmac_f32 v27, v100, v100
  v_lshlrev_b32 v22, 16, v101
  v_and_b32 v101, 0xffff0000, v101
  v_add_f32 v24, v24, v22
  v_fmac_f32 v25, v22, v22
  v_add_f32 v26, v26, v101
  v_fmac_f32 v27, v101, v101
  v_lshlrev_b32 v22, 16, v102
  v_and_b32 v102, 0xffff0000, v102
  v_add_f32 v24, v24, v22
  v_fmac_f32 v25, v22, v22
  v_add_f32 v26, v26, v102
  v_fmac_f32 v27, v102, v102
  v_lshlrev_b32 v22, 16, v103
  v_and_b32 v103, 0xffff0000, v103
  v_add_f32 v24, v24, v22
  v_fmac_f32 v25, v22, v22
  v_add_f32 v26, v26, v103
  v_fmac_f32 v27, v103, v103
  s_waitcnt vmcnt(5)
  v_lshlrev_b32 v22, 16, v104
  v_and_b32 v104, 0xffff0000, v104
  v_add_f32 v24, v24, v22
  v_fmac_f32 v25, v22, v22
  v_add_f32 v26, v26, v104
  v_fmac_f32 v27, v104, v104
  v_lshlrev_b32 v22, 16, v105
  v_and_b32 v105, 0xffff0000, v105
  v_add_f32 v24, v24, v22
  v_fmac_f32 v25, v22, v22
  v_add_f32 v26, v26, v105
  v_fmac_f32 v27, v105, v105
  v_lshlrev_b32 v22, 16, v106
  v_and_b32 v106, 0xffff0000, v106
  v_add_f32 v24, v24, v22
  v_fmac_f32 v25, v22, v22
  v_add_f32 v26, v26, v106
  v_fmac_f32 v27, v106, v106
  v_lshlrev_b32 v22, 16, v107
  v_and_b32 v107, 0xffff0000, v107
  v_add_f32 v24, v24, v22
  v_fmac_f32 v25, v22, v22
  v_add_f32 v26, v26, v107
  v_fmac_f32 v27, v107, v107
  s_waitcnt vmcnt(4)
  v_lshlrev_b32 v22, 16, v108
  v_and_b32 v108, 0xffff0000, v108
  v_add_f32 v24, v24, v22
  v_fmac_f32 v25, v22, v22
  v_add_f32 v26, v26, v108
  v_fmac_f32 v27, v108, v108
  v_lshlrev_b32 v22, 16, v109
  v_and_b32 v109, 0xffff0000, v109
  v_add_f32 v24, v24, v22
  v_fmac_f32 v25, v22, v22
  v_add_f32 v26, v26, v109
  v_fmac_f32 v27, v109, v109
  v_lshlrev_b32 v22, 16, v110
  v_and_b32 v110, 0xffff0000, v110
  v_add_f32 v24, v24, v22
  v_fmac_f32 v25, v22, v22
  v_add_f32 v26, v26, v110
  v_fmac_f32 v27, v110, v110
  v_lshlrev_b32 v22, 16, v111
  v_and_b32 v111, 0xffff0000, v111
  v_add_f32 v24, v24, v22
  v_fmac_f32 v25, v22, v22
  v_add_f32 v26, v26, v111
  v_fmac_f32 v27, v111, v111
  s_waitcnt vmcnt(3)
  v_lshlrev_b32 v22, 16, v112
  v_and_b32 v112, 0xffff0000, v112
  v_add_f32 v24, v24, v22
  v_fmac_f32 v25, v22, v22
  v_add_f32 v26, v26, v112
  v_fmac_f32 v27, v112, v112
  v_lshlrev_b32 v22, 16, v113
  v_and_b32 v113, 0xffff0000, v113
  v_add_f32 v24, v24, v22
  v_fmac_f32 v25, v22, v22
  v_add_f32 v26, v26, v113
  v_fmac_f32 v27, v113, v113
  v_lshlrev_b32 v22, 16, v114
  v_and_b32 v114, 0xffff0000, v114
  v_add_f32 v24, v24, v22
  v_fmac_f32 v25, v22, v22
  v_add_f32 v26, v26, v114
  v_fmac_f32 v27, v114, v114
  v_lshlrev_b32 v22, 16, v115
  v_and_b32 v115, 0xffff0000, v115
  v_add_f32 v24, v24, v22
  v_fmac_f32 v25, v22, v22
  v_add_f32 v26, v26, v115
  v_fmac_f32 v27, v115, v115
  s_waitcnt vmcnt(2)
  v_lshlrev_b32 v22, 16, v116
  v_and_b32 v116, 0xffff0000, v116
  v_add_f32 v24, v24, v22
  v_fmac_f32 v25, v22, v22
  v_add_f32 v26, v26, v116
  v_fmac_f32 v27, v116, v116
  v_lshlrev_b32 v22, 16, v117
  v_and_b32 v117, 0xffff0000, v117
  v_add_f32 v24, v24, v22
  v_fmac_f32 v25, v22, v22
  v_add_f32 v26, v26, v117
  v_fmac_f32 v27, v117, v117
  v_lshlrev_b32 v22, 16, v118
  v_and_b32 v118, 0xffff0000, v118
  v_add_f32 v24, v24, v22
  v_fmac_f32 v25, v22, v22
  v_add_f32 v26, v26, v118
  v_fmac_f32 v27, v118, v118
  v_lshlrev_b32 v22, 16, v119
  v_and_b32 v119, 0xffff0000, v119
  v_add_f32 v24, v24, v22
  v_fmac_f32 v25, v22, v22
  v_add_f32 v26, v26, v119
  v_fmac_f32 v27, v119, v119
  s_waitcnt vmcnt(1)
  v_lshlrev_b32 v22, 16, v120
  v_and_b32 v120, 0xffff0000, v120
  v_add_f32 v24, v24, v22
  v_fmac_f32 v25, v22, v22
  v_add_f32 v26, v26, v120
  v_fmac_f32 v27, v120, v120
  v_lshlrev_b32 v22, 16, v121
  v_and_b32 v121, 0xffff0000, v121
  v_add_f32 v24, v24, v22
  v_fmac_f32 v25, v22, v22
  v_add_f32 v26, v26, v121
  v_fmac_f32 v27, v121, v121
  v_lshlrev_b32 v22, 16, v122
  v_and_b32 v122, 0xffff0000, v122
  v_add_f32 v24, v24, v22
  v_fmac_f32 v25, v22, v22
  v_add_f32 v26, v26, v122
  v_fmac_f32 v27, v122, v122
  v_lshlrev_b32 v22, 16, v123
  v_and_b32 v123, 0xffff0000, v123
  v_add_f32 v24, v24, v22
  v_fmac_f32 v25, v22, v22
  v_add_f32 v26, v26, v123
  v_fmac_f32 v27, v123, v123
  s_waitcnt vmcnt(0)
  v_lshlrev_b32 v22, 16, v124
  v_and_b32 v124, 0xffff0000, v124
  v_add_f32 v24, v24, v22
  v_fmac_f32 v25, v22, v22
  v_add_f32 v26, v26, v124
  v_fmac_f32 v27, v124, v124
  v_lshlrev_b32 v22, 16, v125
  v_and_b32 v125, 0xffff0000, v125
  v_add_f32 v24, v24, v22
  v_fmac_f32 v25, v22, v22
  v_add_f32 v26, v26, v125
  v_fmac_f32 v27, v125, v125
  v_lshlrev_b32 v22, 16, v126
  v_and_b32 v126, 0xffff0000, v126
  v_add_f32 v24, v24, v22
  v_fmac_f32 v25, v22, v22
  v_add_f32 v26, v26, v126
  v_fmac_f32 v27, v126, v126
  v_lshlrev_b32 v22, 16, v127
  v_and_b32 v127, 0xffff0000, v127
  v_add_f32 v24, v24, v22
  v_fmac_f32 v25, v22, v22
  v_add_f32 v26, v26, v127
  v_fmac_f32 v27, v127, v127
  v_add_f32 v24, v24, v26
  v_add_f32 v25, v25, v27
  s_nop 0
  v_add_f32 v24, v24, v24 quad_perm:[1,0,3,2] row_mask:0xf bank_mask:0xf
  v_add_f32 v25, v25, v25 quad_perm:[1,0,3,2] row_mask:0xf bank_mask:0xf
  s_nop 0
  v_add_f32 v24, v24, v24 quad_perm:[2,3,0,1] row_mask:0xf bank_mask:0xf
  v_add_f32 v25, v25, v25 quad_perm:[2,3,0,1] row_mask:0xf bank_mask:0xf
  s_nop 0
  v_add_f32 v24, v24, v24 row_half_mirror row_mask:0xf bank_mask:0xf
  v_add_f32 v25, v25, v25 row_half_mirror row_mask:0xf bank_mask:0xf
  v_mov_b32 v26, 0.0009765625
  v_mul_f32 v24, v26, v24
  v_mul_f32 v27, v24, v24
  v_fma_f32 v25, v25, v26, -v27
  v_max_f32 v25, 0, v25
  v_add_f32 v25, 1e-05, v25
  v_rsq_f32 v25, v25
  v_lshlrev_b32 v20, 2, v20
  v_mul_f32 v24, v24, v25
  v_sub_f32 v24, 0, v24
  s_add_u32 s33, s33, 0x3050000
  s_add_u32 s34, s33, 0x2000
  s_mov_b32 exec_lo, 0x01010101
  s_mov_b32 exec_hi, 0x01010101
  buffer_store_dword v25, v20, s[4:7], s33 offen sc1
  buffer_store_dword v24, v20, s[4:7], s34 offen sc1
  s_mov_b64 exec, -1
  s_mov_b32 s12, s58
  s_mov_b32 s13, s59
  s_mov_b32 s14, 0x100
  s_mov_b32 s15, 0x00020000
  s_mov_b32 s38, 0
  s_mov_b64 exec, 1
.g2_kernel_gt6:
  buffer_load_dword v6, v4, s[12:15], 0 offen sc1
  s_add_u32 s38, s38, 1
  s_waitcnt vmcnt(0)
  v_cmp_eq_u32 vcc, 0x48, v6
  s_cbranch_vccnz .g2_kernel_gt6d
  s_sleep 8
  s_cmp_lt_u32 s38, 131072
  s_cbranch_scc1 .g2_kernel_gt6
.g2_kernel_gt6d:
  s_mov_b64 exec, -1
  v_mov_b32 v6, s70
  s_mov_b64 exec, 1
  buffer_store_dword v6, v4, s[4:7], s19 offen offset:12 sc1
  s_mov_b64 exec, -1
  v_mov_b32 v6, 155648
  s_mov_b32 s38, 0
.g2_kernel_wg7:
  ds_read_b32 v7, v6 offset:512
  s_add_u32 s38, s38, 1
  s_waitcnt lgkmcnt(0)
  v_cmp_le_u32 vcc, 27, v7
  s_cbranch_vccnz .g2_kernel_wg7d
  s_sleep 4
  s_cmp_lt_u32 s38, 524288
  s_cbranch_scc1 .g2_kernel_wg7
.g2_kernel_wg7d:
  s_and_b32 s31, s19, 0xffffe000
  s_add_u32 s31, s31, 12
  v_and_b32 v6, 15, v2
  v_lshlrev_b32 v6, 9, v6
  v_lshrrev_b32 v7, 4, v2
  v_lshl_add_u32 v6, v7, 7, v6
  v_lshlrev_b32 v7, 2, v2
  v_add_u32 v7, 157952, v7
  s_mov_b32 m0, 157952
  s_mov_b32 s38, 0
  s_bfm_b64 exec, 16, 0
.g2_kernel_pa8:
  buffer_load_dword v6, s[4:7], s31 offen sc1 lds
  s_add_u32 s38, s38, 1
  s_waitcnt vmcnt(0)
  ds_read_b32 v8, v7
  s_waitcnt lgkmcnt(0)
  v_cmp_ge_u32 vcc, s62, v8
  s_cbranch_vccz .g2_kernel_pa8d
  s_mov_b64 exec, vcc
  s_sleep 16
  s_cmp_lt_u32 s38, 131072
  s_cbranch_scc1 .g2_kernel_pa8
.g2_kernel_pa8d:
  s_mov_b64 exec, -1
  s_lshl_b32 s33, s17, 9
  s_add_u32 s33, s33, 0x3050000
  s_add_u32 s34, s33, 0x2000
  s_mov_b32 exec_hi, 0
  s_mov_b32 m0, 158464
  s_nop 0
  buffer_load_dwordx4 v3, s[4:7], s33 offen sc1 lds
  s_mov_b32 m0, 158976
  s_nop 0
  buffer_load_dwordx4 v3, s[4:7], s34 offen sc1 lds
  s_mov_b64 exec, -1
  v_mov_b32 v20, 1.0
  v_mov_b32 v21, 1.0
  v_mov_b32 v22, 0
  v_mov_b32 v23, 0
  v_lshlrev_b32 v24, 3, v2
  v_add_u32 v24, 155648, v24
  v_mov_b32 v6, 155648
  s_mov_b32 s38, 0
.g2_kernel_wg9:
  ds_read_b32 v7, v6 offset:512
  s_add_u32 s38, s38, 1
  s_waitcnt lgkmcnt(0)
  v_cmp_le_u32 vcc, 32, v7
  s_cbranch_vccnz .g2_kernel_wg9d
  s_sleep 2
  s_cmp_lt_u32 s38, 524288
  s_cbranch_scc1 .g2_kernel_wg9
.g2_kernel_wg9d:
  ds_write_b64 v24, v[20:21] offset:3840
  ds_write_b64 v24, v[22:23] offset:4352
  v_lshlrev_b32 v24, 2, v2
  v_add_u32 v24, 155648, v24
  ds_write_b32 v24, v4 offset:2304
  s_waitcnt vmcnt(0)
  v_mov_b32 v6, s71
  s_mov_b64 exec, 1
  ds_add_u32 v6, v5 offset:0
  s_mov_b64 exec, -1
  s_branch .g2_kernel_v
.g2_kernel_s2:
  s_mov_b32 s8, s42
  s_mov_b32 s9, s43
  s_mov_b32 s10, 0x600000
  s_mov_b32 s11, 0x00020000
  v_lshrrev_b32 v20, 3, v2
  v_and_b32 v21, 7, v2
  v_mul_u32_u24 v20, 6144, v20
  v_lshl_add_u32 v20, v21, 4, v20
  s_mul_i32 s30, s17, 393216
  s_lshl_b32 s31, s18, 7
  s_add_u32 s30, s30, s31
  s_add_u32 s31, s30, 4096
  s_barrier
  s_sleep 30
  buffer_load_dwordx4 v[64:67], v20, s[8:11], s30 offen
  buffer_load_dwordx4 v[68:71], v20, s[8:11], s30 offen offset:2048
  buffer_load_dwordx4 v[72:75], v20, s[8:11], s31 offen
  s_add_u32 s30, s30, 49152
  s_add_u32 s31, s31, 49152
  buffer_load_dwordx4 v[76:79], v20, s[8:11], s30 offen
  buffer_load_dwordx4 v[80:83], v20, s[8:11], s30 offen offset:2048
  buffer_load_dwordx4 v[84:87], v20, s[8:11], s31 offen
  s_add_u32 s30, s30, 49152
  s_add_u32 s31, s31, 49152
  buffer_load_dwordx4 v[88:91], v20, s[8:11], s30 offen
  buffer_load_dwordx4 v[92:95], v20, s[8:11], s30 offen offset:2048
  buffer_load_dwordx4 v[96:99], v20, s[8:11], s31 offen
  s_add_u32 s30, s30, 49152
  s_add_u32 s31, s31, 49152
  buffer_load_dwordx4 v[100:103], v20, s[8:11], s30 offen
  buffer_load_dwordx4 v[104:107], v20, s[8:11], s30 offen offset:2048
  buffer_load_dwordx4 v[108:111], v20, s[8:11], s31 offen
  s_add_u32 s30, s30, 49152
  s_add_u32 s31, s31, 49152
  buffer_load_dwordx4 v[112:115], v20, s[8:11], s30 offen
  buffer_load_dwordx4 v[116:119], v20, s[8:11], s30 offen offset:2048
  buffer_load_dwordx4 v[120:123], v20, s[8:11], s31 offen
  s_add_u32 s30, s30, 49152
  s_add_u32 s31, s31, 49152
  buffer_load_dwordx4 v[124:127], v20, s[8:11], s30 offen
  buffer_load_dwordx4 v[128:131], v20, s[8:11], s30 offen offset:2048
  buffer_load_dwordx4 v[132:135], v20, s[8:11], s31 offen
  s_add_u32 s30, s30, 49152
  s_add_u32 s31, s31, 49152
  buffer_load_dwordx4 v[136:139], v20, s[8:11], s30 offen
  buffer_load_dwordx4 v[140:143], v20, s[8:11], s30 offen offset:2048
  buffer_load_dwordx4 v[144:147], v20, s[8:11], s31 offen
  s_add_u32 s30, s30, 49152
  s_add_u32 s31, s31, 49152
  buffer_load_dwordx4 v[148:151], v20, s[8:11], s30 offen
  buffer_load_dwordx4 v[152:155], v20, s[8:11], s30 offen offset:2048
  buffer_load_dwordx4 v[156:159], v20, s[8:11], s31 offen
  s_add_u32 s30, s30, 49152
  s_add_u32 s31, s31, 49152
  v_lshlrev_b32 v21, 5, v21
  v_lshrrev_b32 v22, 5, v2
  v_lshl_add_u32 v21, v22, 4, v21
  v_bfe_u32 v22, v2, 4, 1
  v_lshl_add_u32 v21, v22, 3, v21
  s_lshl_b32 s30, s18, 4
  s_add_u32 s30, s30, s17
  s_mul_i32 s30, s30, 768
  s_add_u32 s30, s30, 0x3060000
  s_waitcnt vmcnt(23)
  v_lshlrev_b32 v160, 16, v64
  v_and_b32 v161, 0xffff0000, v64
  v_lshlrev_b32 v162, 16, v65
  v_and_b32 v163, 0xffff0000, v65
  v_lshlrev_b32 v164, 16, v66
  v_and_b32 v165, 0xffff0000, v66
  v_lshlrev_b32 v166, 16, v67
  v_and_b32 v167, 0xffff0000, v67
  s_waitcnt vmcnt(22)
  v_lshlrev_b32 v168, 16, v68
  v_and_b32 v169, 0xffff0000, v68
  v_lshlrev_b32 v170, 16, v69
  v_and_b32 v171, 0xffff0000, v69
  v_lshlrev_b32 v172, 16, v70
  v_and_b32 v173, 0xffff0000, v70
  v_lshlrev_b32 v174, 16, v71
  v_and_b32 v175, 0xffff0000, v71
  s_waitcnt vmcnt(21)
  v_lshlrev_b32 v176, 16, v72
  v_and_b32 v177, 0xffff0000, v72
  v_lshlrev_b32 v178, 16, v73
  v_and_b32 v179, 0xffff0000, v73
  v_lshlrev_b32 v180, 16, v74
  v_and_b32 v181, 0xffff0000, v74
  v_lshlrev_b32 v182, 16, v75
  v_and_b32 v183, 0xffff0000, v75
  s_waitcnt vmcnt(20)
  v_lshlrev_b32 v184, 16, v76
  v_and_b32 v185, 0xffff0000, v76
  v_lshlrev_b32 v186, 16, v77
  v_and_b32 v187, 0xffff0000, v77
  v_lshlrev_b32 v188, 16, v78
  v_and_b32 v189, 0xffff0000, v78
  v_lshlrev_b32 v190, 16, v79
  v_and_b32 v191, 0xffff0000, v79
  v_add_f32 v160, v160, v184
  v_add_f32 v161, v161, v185
  v_add_f32 v162, v162, v186
  v_add_f32 v163, v163, v187
  v_add_f32 v164, v164, v188
  v_add_f32 v165, v165, v189
  v_add_f32 v166, v166, v190
  v_add_f32 v167, v167, v191
  s_waitcnt vmcnt(19)
  v_lshlrev_b32 v184, 16, v80
  v_and_b32 v185, 0xffff0000, v80
  v_lshlrev_b32 v186, 16, v81
  v_and_b32 v187, 0xffff0000, v81
  v_lshlrev_b32 v188, 16, v82
  v_and_b32 v189, 0xffff0000, v82
  v_lshlrev_b32 v190, 16, v83
  v_and_b32 v191, 0xffff0000, v83
  v_add_f32 v168, v168, v184
  v_add_f32 v169, v169, v185
  v_add_f32 v170, v170, v186
  v_add_f32 v171, v171, v187
  v_add_f32 v172, v172, v188
  v_add_f32 v173, v173, v189
  v_add_f32 v174, v174, v190
  v_add_f32 v175, v175, v191
  s_waitcnt vmcnt(18)
  v_lshlrev_b32 v184, 16, v84
  v_and_b32 v185, 0xffff0000, v84
  v_lshlrev_b32 v186, 16, v85
  v_and_b32 v187, 0xffff0000, v85
  v_lshlrev_b32 v188, 16, v86
  v_and_b32 v189, 0xffff0000, v86
  v_lshlrev_b32 v190, 16, v87
  v_and_b32 v191, 0xffff0000, v87
  v_add_f32 v176, v176, v184
  v_add_f32 v177, v177, v185
  v_add_f32 v178, v178, v186
  v_add_f32 v179, v179, v187
  v_add_f32 v180, v180, v188
  v_add_f32 v181, v181, v189
  v_add_f32 v182, v182, v190
  v_add_f32 v183, v183, v191
  s_waitcnt vmcnt(17)
  v_lshlrev_b32 v184, 16, v88
  v_and_b32 v185, 0xffff0000, v88
  v_lshlrev_b32 v186, 16, v89
  v_and_b32 v187, 0xffff0000, v89
  v_lshlrev_b32 v188, 16, v90
  v_and_b32 v189, 0xffff0000, v90
  v_lshlrev_b32 v190, 16, v91
  v_and_b32 v191, 0xffff0000, v91
  v_add_f32 v160, v160, v184
  v_add_f32 v161, v161, v185
  v_add_f32 v162, v162, v186
  v_add_f32 v163, v163, v187
  v_add_f32 v164, v164, v188
  v_add_f32 v165, v165, v189
  v_add_f32 v166, v166, v190
  v_add_f32 v167, v167, v191
  s_waitcnt vmcnt(16)
  v_lshlrev_b32 v184, 16, v92
  v_and_b32 v185, 0xffff0000, v92
  v_lshlrev_b32 v186, 16, v93
  v_and_b32 v187, 0xffff0000, v93
  v_lshlrev_b32 v188, 16, v94
  v_and_b32 v189, 0xffff0000, v94
  v_lshlrev_b32 v190, 16, v95
  v_and_b32 v191, 0xffff0000, v95
  v_add_f32 v168, v168, v184
  v_add_f32 v169, v169, v185
  v_add_f32 v170, v170, v186
  v_add_f32 v171, v171, v187
  v_add_f32 v172, v172, v188
  v_add_f32 v173, v173, v189
  v_add_f32 v174, v174, v190
  v_add_f32 v175, v175, v191
  s_waitcnt vmcnt(15)
  v_lshlrev_b32 v184, 16, v96
  v_and_b32 v185, 0xffff0000, v96
  v_lshlrev_b32 v186, 16, v97
  v_and_b32 v187, 0xffff0000, v97
  v_lshlrev_b32 v188, 16, v98
  v_and_b32 v189, 0xffff0000, v98
  v_lshlrev_b32 v190, 16, v99
  v_and_b32 v191, 0xffff0000, v99
  v_add_f32 v176, v176, v184
  v_add_f32 v177, v177, v185
  v_add_f32 v178, v178, v186
  v_add_f32 v179, v179, v187
  v_add_f32 v180, v180, v188
  v_add_f32 v181, v181, v189
  v_add_f32 v182, v182, v190
  v_add_f32 v183, v183, v191
  s_waitcnt vmcnt(14)
  v_lshlrev_b32 v184, 16, v100
  v_and_b32 v185, 0xffff0000, v100
  v_lshlrev_b32 v186, 16, v101
  v_and_b32 v187, 0xffff0000, v101
  v_lshlrev_b32 v188, 16, v102
  v_and_b32 v189, 0xffff0000, v102
  v_lshlrev_b32 v190, 16, v103
  v_and_b32 v191, 0xffff0000, v103
  v_add_f32 v160, v160, v184
  v_add_f32 v161, v161, v185
  v_add_f32 v162, v162, v186
  v_add_f32 v163, v163, v187
  v_add_f32 v164, v164, v188
  v_add_f32 v165, v165, v189
  v_add_f32 v166, v166, v190
  v_add_f32 v167, v167, v191
  s_waitcnt vmcnt(13)
  v_lshlrev_b32 v184, 16, v104
  v_and_b32 v185, 0xffff0000, v104
  v_lshlrev_b32 v186, 16, v105
  v_and_b32 v187, 0xffff0000, v105
  v_lshlrev_b32 v188, 16, v106
  v_and_b32 v189, 0xffff0000, v106
  v_lshlrev_b32 v190, 16, v107
  v_and_b32 v191, 0xffff0000, v107
  v_add_f32 v168, v168, v184
  v_add_f32 v169, v169, v185
  v_add_f32 v170, v170, v186
  v_add_f32 v171, v171, v187
  v_add_f32 v172, v172, v188
  v_add_f32 v173, v173, v189
  v_add_f32 v174, v174, v190
  v_add_f32 v175, v175, v191
  s_waitcnt vmcnt(12)
  v_lshlrev_b32 v184, 16, v108
  v_and_b32 v185, 0xffff0000, v108
  v_lshlrev_b32 v186, 16, v109
  v_and_b32 v187, 0xffff0000, v109
  v_lshlrev_b32 v188, 16, v110
  v_and_b32 v189, 0xffff0000, v110
  v_lshlrev_b32 v190, 16, v111
  v_and_b32 v191, 0xffff0000, v111
  v_add_f32 v176, v176, v184
  v_add_f32 v177, v177, v185
  v_add_f32 v178, v178, v186
  v_add_f32 v179, v179, v187
  v_add_f32 v180, v180, v188
  v_add_f32 v181, v181, v189
  v_add_f32 v182, v182, v190
  v_add_f32 v183, v183, v191
  s_waitcnt vmcnt(11)
  v_lshlrev_b32 v184, 16, v112
  v_and_b32 v185, 0xffff0000, v112
  v_lshlrev_b32 v186, 16, v113
  v_and_b32 v187, 0xffff0000, v113
  v_lshlrev_b32 v188, 16, v114
  v_and_b32 v189, 0xffff0000, v114
  v_lshlrev_b32 v190, 16, v115
  v_and_b32 v191, 0xffff0000, v115
  v_add_f32 v160, v160, v184
  v_add_f32 v161, v161, v185
  v_add_f32 v162, v162, v186
  v_add_f32 v163, v163, v187
  v_add_f32 v164, v164, v188
  v_add_f32 v165, v165, v189
  v_add_f32 v166, v166, v190
  v_add_f32 v167, v167, v191
  s_waitcnt vmcnt(10)
  v_lshlrev_b32 v184, 16, v116
  v_and_b32 v185, 0xffff0000, v116
  v_lshlrev_b32 v186, 16, v117
  v_and_b32 v187, 0xffff0000, v117
  v_lshlrev_b32 v188, 16, v118
  v_and_b32 v189, 0xffff0000, v118
  v_lshlrev_b32 v190, 16, v119
  v_and_b32 v191, 0xffff0000, v119
  v_add_f32 v168, v168, v184
  v_add_f32 v169, v169, v185
  v_add_f32 v170, v170, v186
  v_add_f32 v171, v171, v187
  v_add_f32 v172, v172, v188
  v_add_f32 v173, v173, v189
  v_add_f32 v174, v174, v190
  v_add_f32 v175, v175, v191
  s_waitcnt vmcnt(9)
  v_lshlrev_b32 v184, 16, v120
  v_and_b32 v185, 0xffff0000, v120
  v_lshlrev_b32 v186, 16, v121
  v_and_b32 v187, 0xffff0000, v121
  v_lshlrev_b32 v188, 16, v122
  v_and_b32 v189, 0xffff0000, v122
  v_lshlrev_b32 v190, 16, v123
  v_and_b32 v191, 0xffff0000, v123
  v_add_f32 v176, v176, v184
  v_add_f32 v177, v177, v185
  v_add_f32 v178, v178, v186
  v_add_f32 v179, v179, v187
  v_add_f32 v180, v180, v188
  v_add_f32 v181, v181, v189
  v_add_f32 v182, v182, v190
  v_add_f32 v183, v183, v191
  s_waitcnt vmcnt(8)
  v_lshlrev_b32 v184, 16, v124
  v_and_b32 v185, 0xffff0000, v124
  v_lshlrev_b32 v186, 16, v125
  v_and_b32 v187, 0xffff0000, v125
  v_lshlrev_b32 v188, 16, v126
  v_and_b32 v189, 0xffff0000, v126
  v_lshlrev_b32 v190, 16, v127
  v_and_b32 v191, 0xffff0000, v127
  v_add_f32 v160, v160, v184
  v_add_f32 v161, v161, v185
  v_add_f32 v162, v162, v186
  v_add_f32 v163, v163, v187
  v_add_f32 v164, v164, v188
  v_add_f32 v165, v165, v189
  v_add_f32 v166, v166, v190
  v_add_f32 v167, v167, v191
  s_waitcnt vmcnt(7)
  v_lshlrev_b32 v184, 16, v128
  v_and_b32 v185, 0xffff0000, v128
  v_lshlrev_b32 v186, 16, v129
  v_and_b32 v187, 0xffff0000, v129
  v_lshlrev_b32 v188, 16, v130
  v_and_b32 v189, 0xffff0000, v130
  v_lshlrev_b32 v190, 16, v131
  v_and_b32 v191, 0xffff0000, v131
  v_add_f32 v168, v168, v184
  v_add_f32 v169, v169, v185
  v_add_f32 v170, v170, v186
  v_add_f32 v171, v171, v187
  v_add_f32 v172, v172, v188
  v_add_f32 v173, v173, v189
  v_add_f32 v174, v174, v190
  v_add_f32 v175, v175, v191
  s_waitcnt vmcnt(6)
  v_lshlrev_b32 v184, 16, v132
  v_and_b32 v185, 0xffff0000, v132
  v_lshlrev_b32 v186, 16, v133
  v_and_b32 v187, 0xffff0000, v133
  v_lshlrev_b32 v188, 16, v134
  v_and_b32 v189, 0xffff0000, v134
  v_lshlrev_b32 v190, 16, v135
  v_and_b32 v191, 0xffff0000, v135
  v_add_f32 v176, v176, v184
  v_add_f32 v177, v177, v185
  v_add_f32 v178, v178, v186
  v_add_f32 v179, v179, v187
  v_add_f32 v180, v180, v188
  v_add_f32 v181, v181, v189
  v_add_f32 v182, v182, v190
  v_add_f32 v183, v183, v191
  s_waitcnt vmcnt(5)
  v_lshlrev_b32 v184, 16, v136
  v_and_b32 v185, 0xffff0000, v136
  v_lshlrev_b32 v186, 16, v137
  v_and_b32 v187, 0xffff0000, v137
  v_lshlrev_b32 v188, 16, v138
  v_and_b32 v189, 0xffff0000, v138
  v_lshlrev_b32 v190, 16, v139
  v_and_b32 v191, 0xffff0000, v139
  v_add_f32 v160, v160, v184
  v_add_f32 v161, v161, v185
  v_add_f32 v162, v162, v186
  v_add_f32 v163, v163, v187
  v_add_f32 v164, v164, v188
  v_add_f32 v165, v165, v189
  v_add_f32 v166, v166, v190
  v_add_f32 v167, v167, v191
  s_waitcnt vmcnt(4)
  v_lshlrev_b32 v184, 16, v140
  v_and_b32 v185, 0xffff0000, v140
  v_lshlrev_b32 v186, 16, v141
  v_and_b32 v187, 0xffff0000, v141
  v_lshlrev_b32 v188, 16, v142
  v_and_b32 v189, 0xffff0000, v142
  v_lshlrev_b32 v190, 16, v143
  v_and_b32 v191, 0xffff0000, v143
  v_add_f32 v168, v168, v184
  v_add_f32 v169, v169, v185
  v_add_f32 v170, v170, v186
  v_add_f32 v171, v171, v187
  v_add_f32 v172, v172, v188
  v_add_f32 v173, v173, v189
  v_add_f32 v174, v174, v190
  v_add_f32 v175, v175, v191
  s_waitcnt vmcnt(3)
  v_lshlrev_b32 v184, 16, v144
  v_and_b32 v185, 0xffff0000, v144
  v_lshlrev_b32 v186, 16, v145
  v_and_b32 v187, 0xffff0000, v145
  v_lshlrev_b32 v188, 16, v146
  v_and_b32 v189, 0xffff0000, v146
  v_lshlrev_b32 v190, 16, v147
  v_and_b32 v191, 0xffff0000, v147
  v_add_f32 v176, v176, v184
  v_add_f32 v177, v177, v185
  v_add_f32 v178, v178, v186
  v_add_f32 v179, v179, v187
  v_add_f32 v180, v180, v188
  v_add_f32 v181, v181, v189
  v_add_f32 v182, v182, v190
  v_add_f32 v183, v183, v191
  s_waitcnt vmcnt(2)
  v_lshlrev_b32 v184, 16, v148
  v_and_b32 v185, 0xffff0000, v148
  v_lshlrev_b32 v186, 16, v149
  v_and_b32 v187, 0xffff0000, v149
  v_lshlrev_b32 v188, 16, v150
  v_and_b32 v189, 0xffff0000, v150
  v_lshlrev_b32 v190, 16, v151
  v_and_b32 v191, 0xffff0000, v151
  v_add_f32 v160, v160, v184
  v_add_f32 v161, v161, v185
  v_add_f32 v162, v162, v186
  v_add_f32 v163, v163, v187
  v_add_f32 v164, v164, v188
  v_add_f32 v165, v165, v189
  v_add_f32 v166, v166, v190
  v_add_f32 v167, v167, v191
  s_waitcnt vmcnt(1)
  v_lshlrev_b32 v184, 16, v152
  v_and_b32 v185, 0xffff0000, v152
  v_lshlrev_b32 v186, 16, v153
  v_and_b32 v187, 0xffff0000, v153
  v_lshlrev_b32 v188, 16, v154
  v_and_b32 v189, 0xffff0000, v154
  v_lshlrev_b32 v190, 16, v155
  v_and_b32 v191, 0xffff0000, v155
  v_add_f32 v168, v168, v184
  v_add_f32 v169, v169, v185
  v_add_f32 v170, v170, v186
  v_add_f32 v171, v171, v187
  v_add_f32 v172, v172, v188
  v_add_f32 v173, v173, v189
  v_add_f32 v174, v174, v190
  v_add_f32 v175, v175, v191
  s_waitcnt vmcnt(0)
  v_lshlrev_b32 v184, 16, v156
  v_and_b32 v185, 0xffff0000, v156
  v_lshlrev_b32 v186, 16, v157
  v_and_b32 v187, 0xffff0000, v157
  v_lshlrev_b32 v188, 16, v158
  v_and_b32 v189, 0xffff0000, v158
  v_lshlrev_b32 v190, 16, v159
  v_and_b32 v191, 0xffff0000, v159
  v_add_f32 v176, v176, v184
  v_add_f32 v177, v177, v185
  v_add_f32 v178, v178, v186
  v_add_f32 v179, v179, v187
  v_add_f32 v180, v180, v188
  v_add_f32 v181, v181, v189
  v_add_f32 v182, v182, v190
  v_add_f32 v183, v183, v191
  v_permlane32_swap_b32 v160, v164
  v_permlane32_swap_b32 v161, v165
  v_permlane32_swap_b32 v162, v166
  v_permlane32_swap_b32 v163, v167
  v_add_f32 v160, v160, v164
  v_add_f32 v161, v161, v165
  v_add_f32 v162, v162, v166
  v_add_f32 v163, v163, v167
  s_nop 0
  v_permlane16_swap_b32 v160, v162
  v_permlane16_swap_b32 v161, v163
  v_add_f32 v160, v160, v162
  v_add_f32 v161, v161, v163
  s_nop 0
  v_add_f32 v160, v160, v160 row_ror:8 row_mask:0xf bank_mask:0xf
  v_add_f32 v161, v161, v161 row_ror:8 row_mask:0xf bank_mask:0xf
  v_permlane32_swap_b32 v168, v172
  v_permlane32_swap_b32 v169, v173
  v_permlane32_swap_b32 v170, v174
  v_permlane32_swap_b32 v171, v175
  v_add_f32 v168, v168, v172
  v_add_f32 v169, v169, v173
  v_add_f32 v170, v170, v174
  v_add_f32 v171, v171, v175
  s_nop 0
  v_permlane16_swap_b32 v168, v170
  v_permlane16_swap_b32 v169, v171
  v_add_f32 v168, v168, v170
  v_add_f32 v169, v169, v171
  s_nop 0
  v_add_f32 v168, v168, v168 row_ror:8 row_mask:0xf bank_mask:0xf
  v_add_f32 v169, v169, v169 row_ror:8 row_mask:0xf bank_mask:0xf
  v_permlane32_swap_b32 v176, v180
  v_permlane32_swap_b32 v177, v181
  v_permlane32_swap_b32 v178, v182
  v_permlane32_swap_b32 v179, v183
  v_add_f32 v176, v176, v180
  v_add_f32 v177, v177, v181
  v_add_f32 v178, v178, v182
  v_add_f32 v179, v179, v183
  s_nop 0
  v_permlane16_swap_b32 v176, v178
  v_permlane16_swap_b32 v177, v179
  v_add_f32 v176, v176, v178
  v_add_f32 v177, v177, v179
  s_nop 0
  v_add_f32 v176, v176, v176 row_ror:8 row_mask:0xf bank_mask:0xf
  v_add_f32 v177, v177, v177 row_ror:8 row_mask:0xf bank_mask:0xf
  s_mov_b32 exec_lo, 0x00ff00ff
  s_mov_b32 exec_hi, 0x00ff00ff
  buffer_store_dwordx2 v[160:161], v21, s[4:7], s30 offen offset:0 sc1
  buffer_store_dwordx2 v[168:169], v21, s[4:7], s30 offen offset:256 sc1
  buffer_store_dwordx2 v[176:177], v21, s[4:7], s30 offen offset:512 sc1
  s_mov_b64 exec, -1
  s_mov_b32 s12, s58
  s_mov_b32 s13, s59
  s_mov_b32 s14, 0x100
  s_mov_b32 s15, 0x00020000
  s_mov_b32 s38, 0
  s_mov_b64 exec, 1
.g2_kernel_gt10:
  buffer_load_dword v6, v4, s[12:15], 0 offen sc1
  s_add_u32 s38, s38, 1
  s_waitcnt vmcnt(0)
  v_cmp_eq_u32 vcc, 0x48, v6
  s_cbranch_vccnz .g2_kernel_gt10d
  s_sleep 8
  s_cmp_lt_u32 s38, 131072
  s_cbranch_scc1 .g2_kernel_gt10
.g2_kernel_gt10d:
  s_mov_b64 exec, -1
  v_mov_b32 v6, s70
  s_mov_b64 exec, 1
  buffer_store_dword v6, v4, s[4:7], s76 offen offset:4 sc1
  s_mov_b64 exec, -1
  v_mov_b32 v6, 155648
  s_mov_b32 s38, 0
.g2_kernel_wg11:
  ds_read_b32 v7, v6 offset:512
  s_add_u32 s38, s38, 1
  s_waitcnt lgkmcnt(0)
  v_cmp_le_u32 vcc, 27, v7
  s_cbranch_vccnz .g2_kernel_wg11d
  s_sleep 4
  s_cmp_lt_u32 s38, 524288
  s_cbranch_scc1 .g2_kernel_wg11
.g2_kernel_wg11d:
  s_and_b32 s31, s76, 0xffffe000
  s_add_u32 s31, s31, 4
  v_and_b32 v6, 15, v2
  v_lshlrev_b32 v6, 9, v6
  v_lshrrev_b32 v7, 4, v2
  v_lshl_add_u32 v6, v7, 7, v6
  v_lshlrev_b32 v7, 2, v2
  v_add_u32 v7, 157696, v7
  s_mov_b32 m0, 157696
  s_mov_b32 s38, 0
  s_bfm_b64 exec, 16, 0
.g2_kernel_pa12:
  buffer_load_dword v6, s[4:7], s31 offen sc1 lds
  s_add_u32 s38, s38, 1
  s_waitcnt vmcnt(0)
  ds_read_b32 v8, v7
  s_waitcnt lgkmcnt(0)
  v_cmp_ge_u32 vcc, s62, v8
  s_cbranch_vccz .g2_kernel_pa12d
  s_mov_b64 exec, vcc
  s_sleep 16
  s_cmp_lt_u32 s38, 131072
  s_cbranch_scc1 .g2_kernel_pa12
.g2_kernel_pa12d:
  s_mov_b64 exec, -1
  s_mul_i32 s30, s18, 12288
  s_add_u32 s30, s30, 0x3060000
  s_mov_b32 exec_hi, 0xffff
  buffer_load_dwordx4 v[64:67], v3, s[4:7], s30 offen offset:0 sc1
  buffer_load_dwordx4 v[68:71], v3, s[4:7], s30 offen offset:768 sc1
  buffer_load_dwordx4 v[72:75], v3, s[4:7], s30 offen offset:1536 sc1
  buffer_load_dwordx4 v[76:79], v3, s[4:7], s30 offen offset:2304 sc1
  s_add_u32 s30, s30, 3072
  buffer_load_dwordx4 v[80:83], v3, s[4:7], s30 offen offset:0 sc1
  buffer_load_dwordx4 v[84:87], v3, s[4:7], s30 offen offset:768 sc1
  buffer_load_dwordx4 v[88:91], v3, s[4:7], s30 offen offset:1536 sc1
  buffer_load_dwordx4 v[92:95], v3, s[4:7], s30 offen offset:2304 sc1
  s_add_u32 s30, s30, 3072
  buffer_load_dwordx4 v[96:99], v3, s[4:7], s30 offen offset:0 sc1
  buffer_load_dwordx4 v[100:103], v3, s[4:7], s30 offen offset:768 sc1
  buffer_load_dwordx4 v[104:107], v3, s[4:7], s30 offen offset:1536 sc1
  buffer_load_dwordx4 v[108:111], v3, s[4:7], s30 offen offset:2304 sc1
  s_add_u32 s30, s30, 3072
  buffer_load_dwordx4 v[112:115], v3, s[4:7], s30 offen offset:0 sc1
  buffer_load_dwordx4 v[116:119], v3, s[4:7], s30 offen offset:768 sc1
  buffer_load_dwordx4 v[120:123], v3, s[4:7], s30 offen offset:1536 sc1
  buffer_load_dwordx4 v[124:127], v3, s[4:7], s30 offen offset:2304 sc1
  s_add_u32 s30, s30, 3072
  s_waitcnt vmcnt(14)
  v_add_f32 v64, v64, v68
  v_add_f32 v65, v65, v69
  v_add_f32 v66, v66, v70
  v_add_f32 v67, v67, v71
  s_waitcnt vmcnt(13)
  v_add_f32 v64, v64, v72
  v_add_f32 v65, v65, v73
  v_add_f32 v66, v66, v74
  v_add_f32 v67, v67, v75
  s_waitcnt vmcnt(12)
  v_add_f32 v64, v64, v76
  v_add_f32 v65, v65, v77
  v_add_f32 v66, v66, v78
  v_add_f32 v67, v67, v79
  s_waitcnt vmcnt(11)
  v_add_f32 v64, v64, v80
  v_add_f32 v65, v65, v81
  v_add_f32 v66, v66, v82
  v_add_f32 v67, v67, v83
  s_waitcnt vmcnt(10)
  v_add_f32 v64, v64, v84
  v_add_f32 v65, v65, v85
  v_add_f32 v66, v66, v86
  v_add_f32 v67, v67, v87
  s_waitcnt vmcnt(9)
  v_add_f32 v64, v64, v88
  v_add_f32 v65, v65, v89
  v_add_f32 v66, v66, v90
  v_add_f32 v67, v67, v91
  s_waitcnt vmcnt(8)
  v_add_f32 v64, v64, v92
  v_add_f32 v65, v65, v93
  v_add_f32 v66, v66, v94
  v_add_f32 v67, v67, v95
  s_waitcnt vmcnt(7)
  v_add_f32 v64, v64, v96
  v_add_f32 v65, v65, v97
  v_add_f32 v66, v66, v98
  v_add_f32 v67, v67, v99
  s_waitcnt vmcnt(6)
  v_add_f32 v64, v64, v100
  v_add_f32 v65, v65, v101
  v_add_f32 v66, v66, v102
  v_add_f32 v67, v67, v103
  s_waitcnt vmcnt(5)
  v_add_f32 v64, v64, v104
  v_add_f32 v65, v65, v105
  v_add_f32 v66, v66, v106
  v_add_f32 v67, v67, v107
  s_waitcnt vmcnt(4)
  v_add_f32 v64, v64, v108
  v_add_f32 v65, v65, v109
  v_add_f32 v66, v66, v110
  v_add_f32 v67, v67, v111
  s_waitcnt vmcnt(3)
  v_add_f32 v64, v64, v112
  v_add_f32 v65, v65, v113
  v_add_f32 v66, v66, v114
  v_add_f32 v67, v67, v115
  s_waitcnt vmcnt(2)
  v_add_f32 v64, v64, v116
  v_add_f32 v65, v65, v117
  v_add_f32 v66, v66, v118
  v_add_f32 v67, v67, v119
  s_waitcnt vmcnt(1)
  v_add_f32 v64, v64, v120
  v_add_f32 v65, v65, v121
  v_add_f32 v66, v66, v122
  v_add_f32 v67, v67, v123
  s_waitcnt vmcnt(0)
  v_add_f32 v64, v64, v124
  v_add_f32 v65, v65, v125
  v_add_f32 v66, v66, v126
  v_add_f32 v67, v67, v127
  s_mov_b64 exec, -1
  v_mov_b32 v6, 155648
  s_mov_b32 s38, 0
.g2_kernel_wg13:
  ds_read_b32 v7, v6 offset:512
  s_add_u32 s38, s38, 1
  s_waitcnt lgkmcnt(0)
  v_cmp_le_u32 vcc, 32, v7
  s_cbranch_vccnz .g2_kernel_wg13d
  s_sleep 2
  s_cmp_lt_u32 s38, 524288
  s_cbranch_scc1 .g2_kernel_wg13
.g2_kernel_wg13d:
  v_lshlrev_b32 v24, 2, v2
  v_add_u32 v24, 155648, v24
  ds_write_b32 v24, v4 offset:2048
  v_add_u32 v24, 155648, v3
  s_mov_b32 exec_hi, 0xffff
  ds_write_b128 v24, v[64:67] offset:4864
  s_mov_b64 exec, -1
  v_mov_b32 v6, s71
  s_mov_b64 exec, 1
  ds_add_u32 v6, v5 offset:0
  s_mov_b64 exec, -1
  s_branch .g2_kernel_v
.g2_kernel_s3:
  s_mov_b32 s12, s58
  s_mov_b32 s13, s59
  s_mov_b32 s14, 0x100
  s_mov_b32 s15, 0x00020000
  s_mov_b32 s20, s48
  s_mov_b32 s21, s49
  s_mov_b32 s22, 0x800
  s_mov_b32 s23, 0x00020000
  v_mov_b32 v12, 0
  v_mov_b32 v13, 0
  v_mov_b32 v14, 0
  v_mov_b32 v15, 0
  s_cmp_ge_u32 s2, 72
  s_cbranch_scc1 .g2_kernel_zm14
  s_lshl_b32 s36, s2, 12
  s_add_u32 s36, s36, 0x3000000
  buffer_store_dwordx4 v[12:15], v3, s[4:7], s36 offen sc1
  buffer_store_dwordx4 v[12:15], v3, s[4:7], s36 offen offset:1024 sc1
  buffer_store_dwordx4 v[12:15], v3, s[4:7], s36 offen offset:2048 sc1
  buffer_store_dwordx4 v[12:15], v3, s[4:7], s36 offen offset:3072 sc1
.g2_kernel_zm14:
  s_barrier
  s_cbranch_scc1 .g2_kernel_zm14b
  s_mov_b64 exec, 1
  s_waitcnt vmcnt(0)
  buffer_atomic_add v5, v4, s[12:15], 0 offen sc1
  s_mov_b64 exec, -1
.g2_kernel_zm14b:
  v_lshlrev_b32 v20, 5, v2
  buffer_load_dwordx4 v[24:27], v20, s[20:23], 0 offen
  buffer_load_dwordx4 v[28:31], v20, s[20:23], 0 offen offset:16
  v_mov_b32 v20, 0
  s_waitcnt vmcnt(0)
  v_lshlrev_b32 v21, 16, v24
  v_and_b32 v22, 0xffff0000, v24
  v_add_f32 v20, v20, v21
  v_add_f32 v20, v20, v22
  v_lshlrev_b32 v21, 16, v25
  v_and_b32 v22, 0xffff0000, v25
  v_add_f32 v20, v20, v21
  v_add_f32 v20, v20, v22
  v_lshlrev_b32 v21, 16, v26
  v_and_b32 v22, 0xffff0000, v26
  v_add_f32 v20, v20, v21
  v_add_f32 v20, v20, v22
  v_lshlrev_b32 v21, 16, v27
  v_and_b32 v22, 0xffff0000, v27
  v_add_f32 v20, v20, v21
  v_add_f32 v20, v20, v22
  v_lshlrev_b32 v21, 16, v28
  v_and_b32 v22, 0xffff0000, v28
  v_add_f32 v20, v20, v21
  v_add_f32 v20, v20, v22
  v_lshlrev_b32 v21, 16, v29
  v_and_b32 v22, 0xffff0000, v29
  v_add_f32 v20, v20, v21
  v_add_f32 v20, v20, v22
  v_lshlrev_b32 v21, 16, v30
  v_and_b32 v22, 0xffff0000, v30
  v_add_f32 v20, v20, v21
  v_add_f32 v20, v20, v22
  v_lshlrev_b32 v21, 16, v31
  v_and_b32 v22, 0xffff0000, v31
  v_add_f32 v20, v20, v21
  v_add_f32 v20, v20, v22
  s_nop 1
  v_add_f32 v20, v20, v20 quad_perm:[1,0,3,2] row_mask:0xf bank_mask:0xf
  s_nop 1
  v_add_f32 v20, v20, v20 quad_perm:[2,3,0,1] row_mask:0xf bank_mask:0xf
  s_nop 1
  v_add_f32 v20, v20, v20 row_half_mirror row_mask:0xf bank_mask:0xf
  s_nop 1
  v_add_f32 v20, v20, v20 row_mirror row_mask:0xf bank_mask:0xf
  s_nop 0
  v_readlane_b32 s20, v20, 16
  v_readlane_b32 s21, v20, 32
  v_readlane_b32 s22, v20, 48
  v_add_f32 v20, s20, v20
  v_add_f32 v20, s21, v20
  v_add_f32 v20, s22, v20
  v_mul_f32 v20, 0x3a800000, v20
  v_mov_b32 v6, 155648
  s_mov_b32 s38, 0
.g2_kernel_wg15:
  ds_read_b32 v7, v6 offset:512
  s_add_u32 s38, s38, 1
  s_waitcnt lgkmcnt(0)
  v_cmp_le_u32 vcc, 32, v7
  s_cbranch_vccnz .g2_kernel_wg15d
  s_sleep 2
  s_cmp_lt_u32 s38, 524288
  s_cbranch_scc1 .g2_kernel_wg15
.g2_kernel_wg15d:
  v_mov_b32 v21, 155648
  s_mov_b64 exec, 1
  ds_write_b32 v21, v20 offset:256
  s_mov_b64 exec, -1
.g2_kernel_v:
  s_setprio 3
  s_cmp_lg_u32 s16, 4
  s_cbranch_scc1 .g2_kernel_v_1
  v_mov_b32 v6, s71
  s_mov_b32 s38, 0
.g2_kernel_wg16:
  ds_read_b32 v7, v6 offset:4
  s_add_u32 s38, s38, 1
  s_waitcnt lgkmcnt(0)
  v_cmp_le_u32 vcc, 4, v7
  s_cbranch_vccnz .g2_kernel_wg16d
  s_sleep 1
  s_cmp_lt_u32 s38, 524288
  s_cbranch_scc1 .g2_kernel_wg16
.g2_kernel_wg16d:
  s_sleep 12
  s_and_b32 s31, s76, 0xffffe000
  s_add_u32 s31, s31, 0
  v_and_b32 v6, 15, v2
  v_lshlrev_b32 v6, 9, v6
  v_lshrrev_b32 v7, 4, v2
  v_lshl_add_u32 v6, v7, 7, v6
  v_lshlrev_b32 v7, 2, v2
  v_add_u32 v7, 157440, v7
  s_mov_b32 m0, 157440
  s_mov_b32 s38, 0
.g2_kernel_pa17:
  buffer_load_dword v6, s[4:7], s31 offen sc1 lds
  s_add_u32 s38, s38, 1
  s_waitcnt vmcnt(0)
  ds_read_b32 v8, v7
  s_waitcnt lgkmcnt(0)
  v_cmp_ge_u32 vcc, s62, v8
  s_cbranch_vccz .g2_kernel_pa17d
  s_mov_b64 exec, vcc
  s_sleep 4
  s_cmp_lt_u32 s38, 131072
  s_cbranch_scc1 .g2_kernel_pa17
.g2_kernel_pa17d:
  s_mov_b64 exec, -1
  v_mov_b32 v6, s71
  s_mov_b64 exec, 1
  ds_add_u32 v6, v5 offset:80
  s_mov_b64 exec, -1
.g2_kernel_v_1:
  v_mov_b32 v6, s71
  s_mov_b32 s38, 0
.g2_kernel_wg18:
  ds_read_b32 v7, v6 offset:80
  s_add_u32 s38, s38, 1
  s_waitcnt lgkmcnt(0)
  v_cmp_le_u32 vcc, 1, v7
  s_cbranch_vccnz .g2_kernel_wg18d
  s_sleep 8
  s_cmp_lt_u32 s38, 524288
  s_cbranch_scc1 .g2_kernel_wg18
.g2_kernel_wg18d:
  s_sleep 20
  s_mov_b32 s39, 0
  v_mov_b32 v12, 0
  v_mov_b32 v13, 0
  v_mov_b32 v14, 0
  v_mov_b32 v15, 0
  s_lshl_b32 s30, s17, 2
  s_and_b32 s31, s16, 3
  s_add_u32 s30, s30, s31
  s_lshl_b32 s30, s30, 4
  s_add_u32 s30, s30, s18
  s_lshl_b32 s30, s30, 9
  s_add_u32 s30, s30, s63
  s_add_u32 s30, s30, 0x1000000
  s_mov_b32 exec_hi, 0
  buffer_store_dwordx4 v[12:15], v3, s[4:7], s30 offen sc1
  s_mov_b64 exec, -1
  s_lshl_b32 s30, s17, 2
  s_add_u32 s30, s30, s31
  s_lshl_b32 s30, s30, 5
  s_add_u32 s30, s30, s18
  s_lshl_b32 s30, s30, 11
  s_add_u32 s30, s30, s63
  s_add_u32 s30, s30, 0x808000
  buffer_store_dwordx4 v[12:15], v3, s[4:7], s30 offen sc1
  buffer_store_dwordx4 v[12:15], v3, s[4:7], s30 offen offset:1024 sc1
  s_lshl_b32 s30, s17, 4
  s_add_u32 s30, s30, s18
  s_cmp_lt_u32 s16, 5
  s_cbranch_scc1 .g2_kernel_zs19
  s_cmp_eq_u32 s16, 5
  s_cbranch_scc1 .g2_kernel_zs19a
  s_lshl_b32 s30, s30, 1
  s_and_b32 s31, s16, 1
  s_add_u32 s30, s30, s31
  s_lshl_b32 s30, s30, 11
  s_add_u32 s30, s30, s63
  s_add_u32 s30, s30, 0x1090000
  buffer_store_dwordx4 v[12:15], v3, s[4:7], s30 offen sc1
  buffer_store_dwordx4 v[12:15], v3, s[4:7], s30 offen offset:1024 sc1
  s_branch .g2_kernel_zs19
.g2_kernel_zs19a:
  s_lshl_b32 s30, s30, 6
  s_add_u32 s30, s30, s63
  s_add_u32 s30, s30, 0x1080000
  s_mov_b64 exec, 15
  buffer_store_dwordx4 v[12:15], v3, s[4:7], s30 offen sc1
  s_mov_b64 exec, -1
  s_and_b32 s30, s18, 14
  s_lshl_b32 s30, s30, 4
  s_add_u32 s30, s30, s17
  s_lshl_b32 s30, s30, 1
  s_and_b32 s31, s18, 1
  s_add_u32 s30, s30, s31
  s_lshl_b32 s30, s30, 10
  s_add_u32 s30, s30, s63
  s_add_u32 s30, s30, 0x1190000
  s_add_u32 s31, s30, 32768
  buffer_store_dwordx4 v[12:15], v3, s[4:7], s30 offen sc1
  buffer_store_dwordx4 v[12:15], v3, s[4:7], s31 offen sc1
.g2_kernel_zs19:
  s_cmp_eq_u32 s16, 4
  s_cbranch_scc1 .g2_kernel_v_3
  s_cmp_lg_u32 s62, 0
  s_cbranch_scc1 .g2_kernel_g_e
  s_and_b32 s22, s16, 3
  s_lshl_b32 s22, s22, 14
  s_add_u32 s22, s22, 65536
  v_bfe_u32 v8, v2, 2, 2
  v_lshrrev_b32 v9, 4, v2
  v_and_b32 v10, 3, v2
  v_lshlrev_b32 v10, 3, v10
  v_add_u32 v10, s22, v10
  s_cmp_eq_u32 s16, 5
  s_cbranch_scc1 .g2_kernel_g_p
  s_cmp_ge_u32 s17, 14
  s_cbranch_scc1 .g2_kernel_g_e
  v_lshrrev_b32 v6, 1, v2
  v_mul_u32_u24 v6, 7168, v6
  v_and_b32 v7, 1, v2
  v_lshl_add_u32 v250, v7, 4, v6
  v_lshl_add_u32 v11, v9, 3, v8
  v_lshl_add_u32 v251, v11, 5, v10
  v_and_b32 v11, 1, v9
  v_lshl_add_u32 v11, v11, 3, v8
  v_lshl_add_u32 v11, v11, 10, v10
  v_lshrrev_b32 v7, 1, v9
  v_lshl_add_u32 v252, v7, 7, v11
  s_lshl_b32 s24, s17, 4
  s_add_u32 s24, s24, s18
  s_and_b32 s25, s16, 1
  s_mov_b32 s12, s50
  s_mov_b32 s13, s51
  s_mov_b32 s14, 0x700000
  s_mov_b32 s15, 0x00020000
  s_mul_i32 s20, s25, 3670016
  s_lshl_b32 s31, s24, 5
  s_add_u32 s20, s20, s31
  s_lshl_b32 s31, s18, 2
  s_mov_b32 s23, s31
  s_mov_b32 s21, 16
.g2_kernel_gl20:
  s_call_b64 s[26:27], .g2_kernel_v_may
  s_and_b32 s23, s23, 15
  s_lshl_b32 s30, s23, 10
  s_add_u32 s30, s30, 0
  s_add_u32 m0, s30, s22
  s_mul_i32 s30, s23, 229376
  s_add_u32 s30, s30, s20
  buffer_load_dwordx4 v250, s[12:15], s30 offen lds
  s_add_u32 s23, s23, 1
  s_sub_u32 s21, s21, 1
  s_sleep 2
  s_waitcnt vmcnt(4)
  s_cmp_lg_u32 s21, 0
  s_cbranch_scc1 .g2_kernel_gl20
  s_waitcnt vmcnt(0)
  ds_read_b64_tr_b16 v[64:65], v251 offset:0
  ds_read_b64_tr_b16 v[66:67], v251 offset:128
  ds_read_b64_tr_b16 v[68:69], v251 offset:1024
  ds_read_b64_tr_b16 v[70:71], v251 offset:1152
  ds_read_b64_tr_b16 v[72:73], v251 offset:2048
  ds_read_b64_tr_b16 v[74:75], v251 offset:2176
  ds_read_b64_tr_b16 v[76:77], v251 offset:3072
  ds_read_b64_tr_b16 v[78:79], v251 offset:3200
  ds_read_b64_tr_b16 v[80:81], v251 offset:4096
  ds_read_b64_tr_b16 v[82:83], v251 offset:4224
  ds_read_b64_tr_b16 v[84:85], v251 offset:5120
  ds_read_b64_tr_b16 v[86:87], v251 offset:5248
  ds_read_b64_tr_b16 v[88:89], v251 offset:6144
  ds_read_b64_tr_b16 v[90:91], v251 offset:6272
  ds_read_b64_tr_b16 v[92:93], v251 offset:7168
  ds_read_b64_tr_b16 v[94:95], v251 offset:7296
  ds_read_b64_tr_b16 v[96:97], v251 offset:8192
  ds_read_b64_tr_b16 v[98:99], v251 offset:8320
  ds_read_b64_tr_b16 v[100:101], v251 offset:9216
  ds_read_b64_tr_b16 v[102:103], v251 offset:9344
  ds_read_b64_tr_b16 v[104:105], v251 offset:10240
  ds_read_b64_tr_b16 v[106:107], v251 offset:10368
  ds_read_b64_tr_b16 v[108:109], v251 offset:11264
  ds_read_b64_tr_b16 v[110:111], v251 offset:11392
  ds_read_b64_tr_b16 v[112:113], v251 offset:12288
  ds_read_b64_tr_b16 v[114:115], v251 offset:12416
  ds_read_b64_tr_b16 v[116:117], v251 offset:13312
  ds_read_b64_tr_b16 v[118:119], v251 offset:13440
  ds_read_b64_tr_b16 v[120:121], v251 offset:14336
  ds_read_b64_tr_b16 v[122:123], v251 offset:14464
  ds_read_b64_tr_b16 v[124:125], v251 offset:15360
  ds_read_b64_tr_b16 v[126:127], v251 offset:15488
  s_waitcnt lgkmcnt(0)
  s_mov_b32 s12, s52
  s_mov_b32 s13, s53
  s_mov_b32 s14, 0x700000
  s_mov_b32 s15, 0x00020000
  s_mul_i32 s20, s25, 3670016
  s_lshl_b32 s31, s24, 5
  s_add_u32 s20, s20, s31
  s_lshl_b32 s31, s18, 2
  s_mov_b32 s23, s31
  s_mov_b32 s21, 16
.g2_kernel_gl21:
  s_call_b64 s[26:27], .g2_kernel_v_may
  s_and_b32 s23, s23, 15
  s_lshl_b32 s30, s23, 10
  s_add_u32 s30, s30, 0
  s_add_u32 m0, s30, s22
  s_mul_i32 s30, s23, 229376
  s_add_u32 s30, s30, s20
  buffer_load_dwordx4 v250, s[12:15], s30 offen lds
  s_add_u32 s23, s23, 1
  s_sub_u32 s21, s21, 1
  s_sleep 2
  s_waitcnt vmcnt(4)
  s_cmp_lg_u32 s21, 0
  s_cbranch_scc1 .g2_kernel_gl21
  s_waitcnt vmcnt(0)
  ds_read_b64_tr_b16 v[128:129], v251 offset:0
  ds_read_b64_tr_b16 v[130:131], v251 offset:128
  ds_read_b64_tr_b16 v[132:133], v251 offset:1024
  ds_read_b64_tr_b16 v[134:135], v251 offset:1152
  ds_read_b64_tr_b16 v[136:137], v251 offset:2048
  ds_read_b64_tr_b16 v[138:139], v251 offset:2176
  ds_read_b64_tr_b16 v[140:141], v251 offset:3072
  ds_read_b64_tr_b16 v[142:143], v251 offset:3200
  ds_read_b64_tr_b16 v[144:145], v251 offset:4096
  ds_read_b64_tr_b16 v[146:147], v251 offset:4224
  ds_read_b64_tr_b16 v[148:149], v251 offset:5120
  ds_read_b64_tr_b16 v[150:151], v251 offset:5248
  ds_read_b64_tr_b16 v[152:153], v251 offset:6144
  ds_read_b64_tr_b16 v[154:155], v251 offset:6272
  ds_read_b64_tr_b16 v[156:157], v251 offset:7168
  ds_read_b64_tr_b16 v[158:159], v251 offset:7296
  ds_read_b64_tr_b16 v[160:161], v251 offset:8192
  ds_read_b64_tr_b16 v[162:163], v251 offset:8320
  ds_read_b64_tr_b16 v[164:165], v251 offset:9216
  ds_read_b64_tr_b16 v[166:167], v251 offset:9344
  ds_read_b64_tr_b16 v[168:169], v251 offset:10240
  ds_read_b64_tr_b16 v[170:171], v251 offset:10368
  ds_read_b64_tr_b16 v[172:173], v251 offset:11264
  ds_read_b64_tr_b16 v[174:175], v251 offset:11392
  ds_read_b64_tr_b16 v[176:177], v251 offset:12288
  ds_read_b64_tr_b16 v[178:179], v251 offset:12416
  ds_read_b64_tr_b16 v[180:181], v251 offset:13312
  ds_read_b64_tr_b16 v[182:183], v251 offset:13440
  ds_read_b64_tr_b16 v[184:185], v251 offset:14336
  ds_read_b64_tr_b16 v[186:187], v251 offset:14464
  ds_read_b64_tr_b16 v[188:189], v251 offset:15360
  ds_read_b64_tr_b16 v[190:191], v251 offset:15488
  s_waitcnt lgkmcnt(0)
  s_mov_b32 s12, s54
  s_mov_b32 s13, s55
  s_mov_b32 s14, 0x700000
  s_mov_b32 s15, 0x00020000
  s_lshl_b32 s20, s24, 15
  s_lshl_b32 s31, s25, 10
  s_add_u32 s20, s20, s31
  s_mov_b32 s23, 0
  s_mov_b32 s21, 16
.g2_kernel_gl22:
  s_call_b64 s[26:27], .g2_kernel_v_may
  s_and_b32 s23, s23, 15
  s_lshl_b32 s30, s23, 10
  s_add_u32 s30, s30, 0
  s_add_u32 m0, s30, s22
  s_mul_i32 s30, s23, 2048
  s_add_u32 s30, s30, s20
  buffer_load_dwordx4 v3, s[12:15], s30 offen lds
  s_add_u32 s23, s23, 1
  s_sub_u32 s21, s21, 1
  s_sleep 1
  s_waitcnt vmcnt(4)
  s_cmp_lg_u32 s21, 0
  s_cbranch_scc1 .g2_kernel_gl22
  v_mov_b32 v11, v252
  s_waitcnt vmcnt(0)
  ds_read_b64_tr_b16 v[192:193], v11 offset:0
  ds_read_b64_tr_b16 v[194:195], v11 offset:4096
  ds_read_b64_tr_b16 v[196:197], v11 offset:32
  ds_read_b64_tr_b16 v[198:199], v11 offset:4128
  ds_read_b64_tr_b16 v[200:201], v11 offset:64
  ds_read_b64_tr_b16 v[202:203], v11 offset:4160
  ds_read_b64_tr_b16 v[204:205], v11 offset:96
  ds_read_b64_tr_b16 v[206:207], v11 offset:4192
  ds_read_b64_tr_b16 v[208:209], v11 offset:256
  ds_read_b64_tr_b16 v[210:211], v11 offset:4352
  ds_read_b64_tr_b16 v[212:213], v11 offset:288
  ds_read_b64_tr_b16 v[214:215], v11 offset:4384
  ds_read_b64_tr_b16 v[216:217], v11 offset:320
  ds_read_b64_tr_b16 v[218:219], v11 offset:4416
  ds_read_b64_tr_b16 v[220:221], v11 offset:352
  ds_read_b64_tr_b16 v[222:223], v11 offset:4448
  ds_read_b64_tr_b16 v[224:225], v11 offset:512
  ds_read_b64_tr_b16 v[226:227], v11 offset:4608
  ds_read_b64_tr_b16 v[228:229], v11 offset:544
  ds_read_b64_tr_b16 v[230:231], v11 offset:4640
  ds_read_b64_tr_b16 v[232:233], v11 offset:576
  ds_read_b64_tr_b16 v[234:235], v11 offset:4672
  ds_read_b64_tr_b16 v[236:237], v11 offset:608
  ds_read_b64_tr_b16 v[238:239], v11 offset:4704
  ds_read_b64_tr_b16 v[240:241], v11 offset:768
  ds_read_b64_tr_b16 v[242:243], v11 offset:4864
  ds_read_b64_tr_b16 v[244:245], v11 offset:800
  ds_read_b64_tr_b16 v[246:247], v11 offset:4896
  ds_read_b64_tr_b16 v[248:249], v11 offset:832
  ds_read_b64_tr_b16 v[250:251], v11 offset:4928
  ds_read_b64_tr_b16 v[252:253], v11 offset:864
  ds_read_b64_tr_b16 v[254:255], v11 offset:4960
  s_waitcnt lgkmcnt(0)
  s_branch .g2_kernel_g_e
.g2_kernel_g_p:
  s_mov_b32 s12, s42
  s_mov_b32 s13, s43
  s_mov_b32 s14, 0x600000
  s_mov_b32 s15, 0x00020000
  v_mul_u32_u24 v6, 6144, v9
  v_and_b32 v7, 15, v2
  v_lshl_add_u32 v250, v7, 4, v6
  v_lshl_add_u32 v11, v8, 2, v9
  v_lshl_add_u32 v251, v11, 9, v10
  s_lshl_b32 s20, s17, 3
  s_and_b32 s31, s18, 1
  s_add_u32 s20, s20, s31
  s_mul_i32 s20, s20, 49152
  s_and_b32 s31, s18, 14
  s_lshl_b32 s31, s31, 7
  s_add_u32 s20, s20, s31
  s_mov_b32 s23, 0
  s_mov_b32 s21, 8
.g2_kernel_gl23:
  s_call_b64 s[26:27], .g2_kernel_v_may
  s_and_b32 s23, s23, 7
  s_lshl_b32 s30, s23, 10
  s_add_u32 s30, s30, 0
  s_add_u32 m0, s30, s22
  s_mul_i32 s30, s23, 49152
  s_add_u32 s30, s30, s20
  s_and_b32 s31, s23, 1
  s_mul_i32 s31, s31, -24576
  s_add_u32 s30, s30, s31
  buffer_load_dwordx4 v250, s[12:15], s30 offen lds
  s_add_u32 s23, s23, 1
  s_sub_u32 s21, s21, 1
  s_sleep 2
  s_waitcnt vmcnt(4)
  s_cmp_lg_u32 s21, 0
  s_cbranch_scc1 .g2_kernel_gl23
  s_add_u32 s20, s20, 2048
  s_mov_b32 s23, 0
  s_mov_b32 s21, 8
.g2_kernel_gl24:
  s_call_b64 s[26:27], .g2_kernel_v_may
  s_and_b32 s23, s23, 7
  s_lshl_b32 s30, s23, 10
  s_add_u32 s30, s30, 8192
  s_add_u32 m0, s30, s22
  s_mul_i32 s30, s23, 49152
  s_add_u32 s30, s30, s20
  s_and_b32 s31, s23, 1
  s_mul_i32 s31, s31, -24576
  s_add_u32 s30, s30, s31
  buffer_load_dwordx4 v250, s[12:15], s30 offen lds
  s_add_u32 s23, s23, 1
  s_sub_u32 s21, s21, 1
  s_sleep 2
  s_waitcnt vmcnt(4)
  s_cmp_lg_u32 s21, 0
  s_cbranch_scc1 .g2_kernel_gl24
  s_add_u32 s20, s20, 2048
  s_waitcnt vmcnt(0)
  ds_read_b64_tr_b16 v[64:65], v251 offset:0
  ds_read_b64_tr_b16 v[66:67], v251 offset:256
  ds_read_b64_tr_b16 v[68:69], v251 offset:32
  ds_read_b64_tr_b16 v[70:71], v251 offset:288
  ds_read_b64_tr_b16 v[72:73], v251 offset:64
  ds_read_b64_tr_b16 v[74:75], v251 offset:320
  ds_read_b64_tr_b16 v[76:77], v251 offset:96
  ds_read_b64_tr_b16 v[78:79], v251 offset:352
  ds_read_b64_tr_b16 v[80:81], v251 offset:128
  ds_read_b64_tr_b16 v[82:83], v251 offset:384
  ds_read_b64_tr_b16 v[84:85], v251 offset:160
  ds_read_b64_tr_b16 v[86:87], v251 offset:416
  ds_read_b64_tr_b16 v[88:89], v251 offset:192
  ds_read_b64_tr_b16 v[90:91], v251 offset:448
  ds_read_b64_tr_b16 v[92:93], v251 offset:224
  ds_read_b64_tr_b16 v[94:95], v251 offset:480
  ds_read_b64_tr_b16 v[96:97], v251 offset:8192
  ds_read_b64_tr_b16 v[98:99], v251 offset:8448
  ds_read_b64_tr_b16 v[100:101], v251 offset:8224
  ds_read_b64_tr_b16 v[102:103], v251 offset:8480
  ds_read_b64_tr_b16 v[104:105], v251 offset:8256
  ds_read_b64_tr_b16 v[106:107], v251 offset:8512
  ds_read_b64_tr_b16 v[108:109], v251 offset:8288
  ds_read_b64_tr_b16 v[110:111], v251 offset:8544
  ds_read_b64_tr_b16 v[112:113], v251 offset:8320
  ds_read_b64_tr_b16 v[114:115], v251 offset:8576
  ds_read_b64_tr_b16 v[116:117], v251 offset:8352
  ds_read_b64_tr_b16 v[118:119], v251 offset:8608
  ds_read_b64_tr_b16 v[120:121], v251 offset:8384
  ds_read_b64_tr_b16 v[122:123], v251 offset:8640
  ds_read_b64_tr_b16 v[124:125], v251 offset:8416
  ds_read_b64_tr_b16 v[126:127], v251 offset:8672
  s_waitcnt lgkmcnt(0)
  s_mov_b32 s23, 0
  s_mov_b32 s21, 8
.g2_kernel_gl25:
  s_call_b64 s[26:27], .g2_kernel_v_may
  s_and_b32 s23, s23, 7
  s_lshl_b32 s30, s23, 10
  s_add_u32 s30, s30, 0
  s_add_u32 m0, s30, s22
  s_mul_i32 s30, s23, 49152
  s_add_u32 s30, s30, s20
  s_and_b32 s31, s23, 1
  s_mul_i32 s31, s31, -24576
  s_add_u32 s30, s30, s31
  buffer_load_dwordx4 v250, s[12:15], s30 offen lds
  s_add_u32 s23, s23, 1
  s_sub_u32 s21, s21, 1
  s_sleep 2
  s_waitcnt vmcnt(4)
  s_cmp_lg_u32 s21, 0
  s_cbranch_scc1 .g2_kernel_gl25
  s_add_u32 s20, s20, 2048
  s_waitcnt vmcnt(0)
  ds_read_b64_tr_b16 v[128:129], v251 offset:0
  ds_read_b64_tr_b16 v[130:131], v251 offset:256
  ds_read_b64_tr_b16 v[132:133], v251 offset:32
  ds_read_b64_tr_b16 v[134:135], v251 offset:288
  ds_read_b64_tr_b16 v[136:137], v251 offset:64
  ds_read_b64_tr_b16 v[138:139], v251 offset:320
  ds_read_b64_tr_b16 v[140:141], v251 offset:96
  ds_read_b64_tr_b16 v[142:143], v251 offset:352
  ds_read_b64_tr_b16 v[144:145], v251 offset:128
  ds_read_b64_tr_b16 v[146:147], v251 offset:384
  ds_read_b64_tr_b16 v[148:149], v251 offset:160
  ds_read_b64_tr_b16 v[150:151], v251 offset:416
  ds_read_b64_tr_b16 v[152:153], v251 offset:192
  ds_read_b64_tr_b16 v[154:155], v251 offset:448
  ds_read_b64_tr_b16 v[156:157], v251 offset:224
  ds_read_b64_tr_b16 v[158:159], v251 offset:480
  s_waitcnt lgkmcnt(0)
.g2_kernel_g_e:
.g2_kernel_v_3:
  s_mov_b32 s29, 0
  s_and_b32 s30, s16, 3
  s_lshl_b32 s30, s30, 14
  s_add_u32 s30, s30, 65536
  s_call_b64 s[68:69], .g2_kernel_v_wo
  s_waitcnt vmcnt(0)
  v_mov_b32 v6, s71
  s_mov_b64 exec, 1
  ds_add_u32 v6, v5 offset:52
  s_mov_b64 exec, -1
  s_cmp_lg_u32 s39, 0
  s_cbranch_scc1 .g2_kernel_v_3b
  s_call_b64 s[26:27], .g2_kernel_v_do
.g2_kernel_v_3b:
  s_cmp_lg_u32 s16, 4
  s_cbranch_scc1 .g2_kernel_v_4
  v_mov_b32 v6, s71
  s_mov_b32 s38, 0
.g2_kernel_wg26:
  ds_read_b32 v7, v6 offset:8
  s_add_u32 s38, s38, 1
  s_waitcnt lgkmcnt(0)
  v_cmp_le_u32 vcc, 8, v7
  s_cbranch_vccnz .g2_kernel_wg26d
  s_sleep 8
  s_cmp_lt_u32 s38, 524288
  s_cbranch_scc1 .g2_kernel_wg26
.g2_kernel_wg26d:
  s_mov_b32 s29, 1
  s_mov_b32 s30, 139264
  s_call_b64 s[68:69], .g2_kernel_v_wo
  s_add_u32 s31, s31, 81920
  s_sleep 6
  s_waitcnt vmcnt(4)
  buffer_load_dwordx4 v[64:67], v6, s[8:11], s31 offen
  s_add_u32 s31, s31, 16384
  buffer_load_dwordx4 v[68:71], v6, s[8:11], s31 offen
  s_add_u32 s31, s31, 16384
  buffer_load_dwordx4 v[72:75], v6, s[8:11], s31 offen
  s_add_u32 s31, s31, 16384
  buffer_load_dwordx4 v[76:79], v6, s[8:11], s31 offen
  s_add_u32 s31, s31, 81920
  s_sleep 6
  s_waitcnt vmcnt(4)
  buffer_load_dwordx4 v[80:83], v6, s[8:11], s31 offen
  s_add_u32 s31, s31, 16384
  buffer_load_dwordx4 v[84:87], v6, s[8:11], s31 offen
  s_add_u32 s31, s31, 16384
  buffer_load_dwordx4 v[88:91], v6, s[8:11], s31 offen
  s_add_u32 s31, s31, 16384
  buffer_load_dwordx4 v[92:95], v6, s[8:11], s31 offen
  s_add_u32 s31, s31, 81920
  s_sleep 6
  s_waitcnt vmcnt(4)
  buffer_load_dwordx4 v[96:99], v6, s[8:11], s31 offen
  s_add_u32 s31, s31, 16384
  buffer_load_dwordx4 v[100:103], v6, s[8:11], s31 offen
  s_add_u32 s31, s31, 16384
  buffer_load_dwordx4 v[104:107], v6, s[8:11], s31 offen
  s_add_u32 s31, s31, 16384
  buffer_load_dwordx4 v[108:111], v6, s[8:11], s31 offen
  s_add_u32 s31, s31, 81920
  s_sleep 6
  s_waitcnt vmcnt(4)
  buffer_load_dwordx4 v[112:115], v6, s[8:11], s31 offen
  s_add_u32 s31, s31, 16384
  buffer_load_dwordx4 v[116:119], v6, s[8:11], s31 offen
  s_add_u32 s31, s31, 16384
  buffer_load_dwordx4 v[120:123], v6, s[8:11], s31 offen
  s_add_u32 s31, s31, 16384
  buffer_load_dwordx4 v[124:127], v6, s[8:11], s31 offen
  s_add_u32 s31, s31, 81920
  s_sleep 6
  s_waitcnt vmcnt(4)
  buffer_load_dwordx4 v[128:131], v6, s[8:11], s31 offen
  s_add_u32 s31, s31, 16384
  buffer_load_dwordx4 v[132:135], v6, s[8:11], s31 offen
  s_add_u32 s31, s31, 16384
  buffer_load_dwordx4 v[136:139], v6, s[8:11], s31 offen
  s_add_u32 s31, s31, 16384
  buffer_load_dwordx4 v[140:143], v6, s[8:11], s31 offen
  s_add_u32 s31, s31, 81920
  s_sleep 6
  s_waitcnt vmcnt(4)
  buffer_load_dwordx4 v[144:147], v6, s[8:11], s31 offen
  s_add_u32 s31, s31, 16384
  buffer_load_dwordx4 v[148:151], v6, s[8:11], s31 offen
  s_add_u32 s31, s31, 16384
  buffer_load_dwordx4 v[152:155], v6, s[8:11], s31 offen
  s_add_u32 s31, s31, 16384
  buffer_load_dwordx4 v[156:159], v6, s[8:11], s31 offen
  s_add_u32 s31, s31, 81920
  s_sleep 6
  s_waitcnt vmcnt(4)
  buffer_load_dwordx4 v[160:163], v6, s[8:11], s31 offen
  s_add_u32 s31, s31, 16384
  buffer_load_dwordx4 v[164:167], v6, s[8:11], s31 offen
  s_add_u32 s31, s31, 16384
  buffer_load_dwordx4 v[168:171], v6, s[8:11], s31 offen
  s_add_u32 s31, s31, 16384
  buffer_load_dwordx4 v[172:175], v6, s[8:11], s31 offen
  s_add_u32 s31, s31, 81920
  s_sleep 6
  s_waitcnt vmcnt(4)
  buffer_load_dwordx4 v[176:179], v6, s[8:11], s31 offen
  s_add_u32 s31, s31, 16384
  buffer_load_dwordx4 v[180:183], v6, s[8:11], s31 offen
  s_add_u32 s31, s31, 16384
  buffer_load_dwordx4 v[184:187], v6, s[8:11], s31 offen
  s_add_u32 s31, s31, 16384
  buffer_load_dwordx4 v[188:191], v6, s[8:11], s31 offen
  s_add_u32 s31, s31, 81920
  s_sleep 6
  s_waitcnt vmcnt(4)
  buffer_load_dwordx4 v[192:195], v6, s[8:11], s31 offen
  s_add_u32 s31, s31, 16384
  buffer_load_dwordx4 v[196:199], v6, s[8:11], s31 offen
  s_add_u32 s31, s31, 16384
  buffer_load_dwordx4 v[200:203], v6, s[8:11], s31 offen
  s_add_u32 s31, s31, 16384
  buffer_load_dwordx4 v[204:207], v6, s[8:11], s31 offen
  s_add_u32 s31, s31, 81920
  s_sleep 6
  s_waitcnt vmcnt(4)
  buffer_load_dwordx4 v[208:211], v6, s[8:11], s31 offen
  s_add_u32 s31, s31, 16384
  buffer_load_dwordx4 v[212:215], v6, s[8:11], s31 offen
  s_add_u32 s31, s31, 16384
  buffer_load_dwordx4 v[216:219], v6, s[8:11], s31 offen
  s_add_u32 s31, s31, 16384
  buffer_load_dwordx4 v[220:223], v6, s[8:11], s31 offen
  s_add_u32 s31, s31, 81920
  s_sleep 6
  s_waitcnt vmcnt(4)
  buffer_load_dwordx4 v[224:227], v6, s[8:11], s31 offen
  s_add_u32 s31, s31, 16384
  buffer_load_dwordx4 v[228:231], v6, s[8:11], s31 offen
  s_add_u32 s31, s31, 16384
  buffer_load_dwordx4 v[232:235], v6, s[8:11], s31 offen
  s_add_u32 s31, s31, 16384
  buffer_load_dwordx4 v[236:239], v6, s[8:11], s31 offen
  s_add_u32 s31, s31, 81920
  s_sleep 6
  s_waitcnt vmcnt(4)
  buffer_load_dwordx4 v[240:243], v6, s[8:11], s31 offen
  s_add_u32 s31, s31, 16384
  buffer_load_dwordx4 v[244:247], v6, s[8:11], s31 offen
  s_add_u32 s31, s31, 16384
  buffer_load_dwordx4 v[248:251], v6, s[8:11], s31 offen
  s_add_u32 s31, s31, 16384
  buffer_load_dwordx4 v[252:255], v6, s[8:11], s31 offen
.g2_kernel_v_4:
  s_cmp_lg_u32 s16, 5
  s_cbranch_scc1 .g2_kernel_v_5
  s_sleep 64
  s_and_b32 s31, s19, 0xffffe000
  s_add_u32 s31, s31, 0
  v_and_b32 v6, 15, v2
  v_lshlrev_b32 v6, 9, v6
  v_lshrrev_b32 v7, 4, v2
  v_lshl_add_u32 v6, v7, 7, v6
  v_lshlrev_b32 v7, 2, v2
  v_add_u32 v7, 157696, v7
  s_mov_b32 m0, 157696
  s_mov_b32 s38, 0
.g2_kernel_pa27:
  buffer_load_dword v6, s[4:7], s31 offen sc1 lds
  s_add_u32 s38, s38, 1
  s_waitcnt vmcnt(0)
  ds_read_b32 v8, v7
  s_waitcnt lgkmcnt(0)
  v_cmp_ge_u32 vcc, s62, v8
  s_cbranch_vccz .g2_kernel_pa27d
  s_mov_b64 exec, vcc
  s_sleep 32
  s_cmp_lt_u32 s38, 131072
  s_cbranch_scc1 .g2_kernel_pa27
.g2_kernel_pa27d:
  s_mov_b64 exec, -1
  v_lshlrev_b32 v6, 7, v2
  s_lshl_b32 s30, s17, 2
  s_and_b32 s31, s18, 3
  s_add_u32 s30, s30, s31
  s_lshl_b32 s30, s30, 16
  s_add_u32 s30, s30, s63
  s_add_u32 s30, s30, 0x800000
  s_sleep 8
  buffer_load_dword v1, v6, s[4:7], s30 offen
  s_add_u32 s30, s30, 8192
  s_sleep 8
  buffer_load_dword v1, v6, s[4:7], s30 offen
  s_add_u32 s30, s30, 8192
  s_sleep 8
  buffer_load_dword v1, v6, s[4:7], s30 offen
  s_add_u32 s30, s30, 8192
  s_sleep 8
  buffer_load_dword v1, v6, s[4:7], s30 offen
  s_add_u32 s30, s30, 8192
  s_and_b32 s31, s19, 0xffffe000
  s_add_u32 s31, s31, 4
  v_and_b32 v7, 15, v2
  v_lshlrev_b32 v7, 9, v7
  v_lshrrev_b32 v9, 4, v2
  v_lshl_add_u32 v7, v9, 7, v7
  s_and_b32 s33, s18, 3
  s_lshl_b32 s33, s33, 6
  s_add_u32 s33, s33, 157952
  v_lshl_add_u32 v9, v9, 2, s33
  v_lshlrev_b32 v10, 2, v2
  v_add_u32 v10, 157952, v10
  v_mov_b32 v11, 155968
  s_lshl_b32 s33, s62, 1
  s_add_u32 s33, s33, 1
  s_mov_b32 m0, 157952
  s_mov_b64 s[8:9], -1
  s_mov_b64 s[10:11], -1
  s_mov_b64 s[12:13], -1
  s_mov_b64 s[14:15], -1
  s_mov_b64 s[20:21], -1
  s_add_u32 s34, s30, 8192
  s_add_u32 s35, s30, 16384
  s_add_u32 s36, s30, 24576
  s_mov_b32 s38, 0
  s_sleep 8
.g2_kernel_bp28:
  s_mov_b64 exec, s[20:21]
  buffer_load_dword v7, s[4:7], s31 offen sc1 lds
  s_mov_b64 exec, -1
  s_add_u32 s38, s38, 1
  s_waitcnt vmcnt(0)
  ds_read_b32 v12, v10
  ds_read_b32 v13, v9
  ds_read_b32 v14, v9 offset:16
  ds_read_b32 v15, v9 offset:32
  ds_read_b32 v16, v9 offset:48
  s_waitcnt lgkmcnt(0)
  v_cmp_ge_u32 s[20:21], s62, v12
  v_cmp_lt_u32 vcc, s62, v13
  s_and_b64 exec, vcc, s[8:9]
  s_cbranch_scc0 .g2_kernel_bp28n0
  s_andn2_b64 s[8:9], s[8:9], vcc
  buffer_load_dword v1, v6, s[4:7], s30 offen
.g2_kernel_bp28n0:
  s_mov_b64 exec, -1
  v_cmp_lt_u32 vcc, s62, v14
  s_and_b64 exec, vcc, s[10:11]
  s_cbranch_scc0 .g2_kernel_bp28n1
  s_andn2_b64 s[10:11], s[10:11], vcc
  buffer_load_dword v1, v6, s[4:7], s34 offen
.g2_kernel_bp28n1:
  s_mov_b64 exec, -1
  v_cmp_lt_u32 vcc, s62, v15
  s_and_b64 exec, vcc, s[12:13]
  s_cbranch_scc0 .g2_kernel_bp28n2
  s_andn2_b64 s[12:13], s[12:13], vcc
  buffer_load_dword v1, v6, s[4:7], s35 offen
.g2_kernel_bp28n2:
  s_mov_b64 exec, -1
  v_cmp_lt_u32 vcc, s62, v16
  s_and_b64 exec, vcc, s[14:15]
  s_cbranch_scc0 .g2_kernel_bp28n3
  s_andn2_b64 s[14:15], s[14:15], vcc
  buffer_load_dword v1, v6, s[4:7], s36 offen
.g2_kernel_bp28n3:
  s_mov_b64 exec, -1
  s_sleep 10
  ds_read_b32 v12, v11
  s_waitcnt lgkmcnt(0)
  v_cmp_lt_u32 vcc, s33, v12
  s_cbranch_vccnz .g2_kernel_bp28d
  s_cmp_lt_u32 s38, 131072
  s_cbranch_scc1 .g2_kernel_bp28
.g2_kernel_bp28d:
.g2_kernel_v_5:
  s_mov_b32 s29, 1
  s_call_b64 s[68:69], .g2_kernel_v_cmb
  s_and_b32 s33, s16, 3
  s_lshl_b32 s33, s33, 7
  s_lshl_b32 s28, s29, 2
  s_add_u32 s33, s33, s28
  s_add_u32 s31, s19, s33
  v_mov_b32 v6, s70
  s_mov_b64 exec, 1
  buffer_store_dword v6, v4, s[4:7], s31 offen offset:0 sc1
  s_mov_b64 exec, -1
  s_cmp_lg_u32 s16, 4
  s_cbranch_scc1 .g2_kernel_v_8
  s_waitcnt vmcnt(3)
  v_mov_b32 v6, s71
  s_mov_b32 s38, 0
.g2_kernel_wg29:
  ds_read_b32 v7, v6 offset:76
  s_add_u32 s38, s38, 1
  s_waitcnt lgkmcnt(0)
  v_cmp_le_u32 vcc, 1, v7
  s_cbranch_vccnz .g2_kernel_wg29d
  s_sleep 1
  s_cmp_lt_u32 s38, 524288
  s_cbranch_scc1 .g2_kernel_wg29
.g2_kernel_wg29d:
  ds_write_b128 v3, v[192:195] offset:49152
  ds_write_b128 v3, v[196:199] offset:50176
  ds_write_b128 v3, v[200:203] offset:51200
  ds_write_b128 v3, v[204:207] offset:52224
  ds_write_b128 v3, v[208:211] offset:53248
  ds_write_b128 v3, v[212:215] offset:54272
  ds_write_b128 v3, v[216:219] offset:55296
  ds_write_b128 v3, v[220:223] offset:56320
  ds_write_b128 v3, v[224:227] offset:57344
  ds_write_b128 v3, v[228:231] offset:58368
  ds_write_b128 v3, v[232:235] offset:59392
  ds_write_b128 v3, v[236:239] offset:60416
  ds_write_b128 v3, v[240:243] offset:61440
  ds_write_b128 v3, v[244:247] offset:62464
  ds_write_b128 v3, v[248:251] offset:63488
  ds_write_b128 v3, v[252:255] offset:64512
  v_mov_b32 v6, s71
  s_mov_b32 s38, 0
.g2_kernel_wg30:
  ds_read_b32 v7, v6 offset:68
  s_add_u32 s38, s38, 1
  s_waitcnt lgkmcnt(0)
  v_cmp_le_u32 vcc, 1, v7
  s_cbranch_vccnz .g2_kernel_wg30d
  s_sleep 1
  s_cmp_lt_u32 s38, 524288
  s_cbranch_scc1 .g2_kernel_wg30
.g2_kernel_wg30d:
  ds_write_b128 v3, v[64:67] offset:16384
  ds_write_b128 v3, v[68:71] offset:17408
  ds_write_b128 v3, v[72:75] offset:18432
  ds_write_b128 v3, v[76:79] offset:19456
  ds_write_b128 v3, v[80:83] offset:20480
  ds_write_b128 v3, v[84:87] offset:21504
  ds_write_b128 v3, v[88:91] offset:22528
  ds_write_b128 v3, v[92:95] offset:23552
  ds_write_b128 v3, v[96:99] offset:24576
  ds_write_b128 v3, v[100:103] offset:25600
  ds_write_b128 v3, v[104:107] offset:26624
  ds_write_b128 v3, v[108:111] offset:27648
  ds_write_b128 v3, v[112:115] offset:28672
  ds_write_b128 v3, v[116:119] offset:29696
  ds_write_b128 v3, v[120:123] offset:30720
  ds_write_b128 v3, v[124:127] offset:31744
  v_mov_b32 v6, s71
  s_mov_b32 s38, 0
.g2_kernel_wg31:
  ds_read_b32 v7, v6 offset:72
  s_add_u32 s38, s38, 1
  s_waitcnt lgkmcnt(0)
  v_cmp_le_u32 vcc, 1, v7
  s_cbranch_vccnz .g2_kernel_wg31d
  s_sleep 1
  s_cmp_lt_u32 s38, 524288
  s_cbranch_scc1 .g2_kernel_wg31
.g2_kernel_wg31d:
  ds_write_b128 v3, v[128:131] offset:32768
  ds_write_b128 v3, v[132:135] offset:33792
  ds_write_b128 v3, v[136:139] offset:34816
  ds_write_b128 v3, v[140:143] offset:35840
  ds_write_b128 v3, v[144:147] offset:36864
  ds_write_b128 v3, v[148:151] offset:37888
  ds_write_b128 v3, v[152:155] offset:38912
  ds_write_b128 v3, v[156:159] offset:39936
  ds_write_b128 v3, v[160:163] offset:40960
  ds_write_b128 v3, v[164:167] offset:41984
  ds_write_b128 v3, v[168:171] offset:43008
  ds_write_b128 v3, v[172:175] offset:44032
  ds_write_b128 v3, v[176:179] offset:45056
  ds_write_b128 v3, v[180:183] offset:46080
  ds_write_b128 v3, v[184:187] offset:47104
  ds_write_b128 v3, v[188:191] offset:48128
  v_mov_b32 v8, 4
  ds_write_b32 v6, v8 offset:12
.g2_kernel_v_8:
  s_cmp_eq_u32 s16, 5
  s_cbranch_scc1 .g2_kernel_c1
  s_cmp_lg_u32 s16, 4
  s_cbranch_scc1 .g2_kernel_c2
  s_cmp_lg_u32 s62, 0
  s_cbranch_scc1 .g2_kernel_fin1
  s_setprio 3
  s_mov_b32 s12, s42
  s_mov_b32 s13, s43
  s_mov_b32 s14, 0x600000
  s_mov_b32 s15, 0x00020000
  v_lshrrev_b32 v28, 3, v2
  v_and_b32 v29, 7, v2
  v_bfe_u32 v30, v2, 4, 1
  v_lshlrev_b32 v30, 1, v30
  v_xor_b32 v31, v29, v30
  v_lshlrev_b32 v31, 4, v31
  v_mul_u32_u24 v28, 6144, v28
  v_add_u32 v28, v28, v31
  v_xor_b32 v29, 64, v28
  v_lshlrev_b32 v9, 8, v2
  v_and_b32 v9, 0x300, v9
  v_add_u32 v9, 156416, v9
  v_add_u32 v48, 0, v28
  v_add_u32 v49, 48128, v29
  v_add_u32 v50, 96256, v28
  v_add_u32 v51, 144384, v29
  v_add_u32 v52, 2048, v28
  v_add_u32 v53, 50176, v29
  v_add_u32 v54, 98304, v28
  v_add_u32 v55, 146432, v29
  v_add_u32 v56, 4096, v28
  v_add_u32 v57, 52224, v29
  v_add_u32 v58, 100352, v28
  v_add_u32 v59, 148480, v29
  v_and_b32 v11, 15, v2
  v_xor_b32 v11, s18, v11
  v_and_b32 v12, 48, v2
  v_add_u32 v11, v11, v12
  v_lshlrev_b32 v11, 2, v11
  v_add_u32 v11, 158208, v11
  s_lshl_b32 s39, s18, 7
  s_lshl_b32 s32, s17, 18
  s_add_u32 s32, s32, 0xc00000
  s_mov_b32 s30, 0
  s_mov_b32 s29, 0
  s_mov_b32 s37, 0
  v_mov_b32 v6, s71
  s_mov_b32 s38, 0
.g2_kernel_wg32:
  ds_read_b32 v7, v6 offset:16
  s_add_u32 s38, s38, 1
  s_waitcnt lgkmcnt(0)
  v_cmp_le_u32 vcc, 4, v7
  s_cbranch_vccnz .g2_kernel_wg32d
  s_sleep 2
  s_cmp_lt_u32 s38, 524288
  s_cbranch_scc1 .g2_kernel_wg32
.g2_kernel_wg32d:
  s_xor_b32 s36, s18, 0
  s_mul_i32 s36, s36, 393216
  s_add_u32 s36, s36, s39
  s_add_u32 m0, s30, 65536
  s_nop 0
  buffer_load_dwordx4 v48, s[12:15], s36 offen offset:0 lds
  buffer_load_dwordx4 v49, s[12:15], s36 offen offset:1024 lds
  buffer_load_dwordx4 v50, s[12:15], s36 offen offset:2048 lds
  buffer_load_dwordx4 v51, s[12:15], s36 offen offset:3072 lds
  s_add_u32 m0, s30, 69632
  s_nop 0
  buffer_load_dwordx4 v52, s[12:15], s36 offen offset:0 lds
  buffer_load_dwordx4 v53, s[12:15], s36 offen offset:1024 lds
  buffer_load_dwordx4 v54, s[12:15], s36 offen offset:2048 lds
  buffer_load_dwordx4 v55, s[12:15], s36 offen offset:3072 lds
  s_add_u32 m0, s30, 73728
  s_nop 0
  buffer_load_dwordx4 v56, s[12:15], s36 offen offset:0 lds
  buffer_load_dwordx4 v57, s[12:15], s36 offen offset:1024 lds
  buffer_load_dwordx4 v58, s[12:15], s36 offen offset:2048 lds
  buffer_load_dwordx4 v59, s[12:15], s36 offen offset:3072 lds
  s_add_u32 s30, s30, 12288
  s_cmp_eq_u32 s30, 86016
  s_cselect_b32 s30, 0, s30
  s_xor_b32 s36, s18, 0
  s_mul_i32 s36, s36, 393216
  s_add_u32 s36, s36, s39
  s_add_u32 s36, s36, 196608
  s_add_u32 m0, s30, 65536
  s_nop 0
  buffer_load_dwordx4 v48, s[12:15], s36 offen offset:0 lds
  buffer_load_dwordx4 v49, s[12:15], s36 offen offset:1024 lds
  buffer_load_dwordx4 v50, s[12:15], s36 offen offset:2048 lds
  buffer_load_dwordx4 v51, s[12:15], s36 offen offset:3072 lds
  s_add_u32 m0, s30, 69632
  s_nop 0
  buffer_load_dwordx4 v52, s[12:15], s36 offen offset:0 lds
  buffer_load_dwordx4 v53, s[12:15], s36 offen offset:1024 lds
  buffer_load_dwordx4 v54, s[12:15], s36 offen offset:2048 lds
  buffer_load_dwordx4 v55, s[12:15], s36 offen offset:3072 lds
  s_add_u32 m0, s30, 73728
  s_nop 0
  buffer_load_dwordx4 v56, s[12:15], s36 offen offset:0 lds
  buffer_load_dwordx4 v57, s[12:15], s36 offen offset:1024 lds
  buffer_load_dwordx4 v58, s[12:15], s36 offen offset:2048 lds
  buffer_load_dwordx4 v59, s[12:15], s36 offen offset:3072 lds
  s_add_u32 s30, s30, 12288
  s_cmp_eq_u32 s30, 86016
  s_cselect_b32 s30, 0, s30
  s_mov_b32 m0, 156160
  s_mov_b32 s35, .g2_kernel_tab-.g2_kernel_pc+136
  buffer_load_dword off, s[64:67], s35 lds
  s_xor_b32 s36, s18, 1
  s_mul_i32 s36, s36, 393216
  s_add_u32 s36, s36, s39
  s_add_u32 m0, s30, 65536
  s_nop 0
  buffer_load_dwordx4 v48, s[12:15], s36 offen offset:0 lds
  buffer_load_dwordx4 v49, s[12:15], s36 offen offset:1024 lds
  buffer_load_dwordx4 v50, s[12:15], s36 offen offset:2048 lds
  buffer_load_dwordx4 v51, s[12:15], s36 offen offset:3072 lds
  s_add_u32 m0, s30, 69632
  s_nop 0
  buffer_load_dwordx4 v52, s[12:15], s36 offen offset:0 lds
  buffer_load_dwordx4 v53, s[12:15], s36 offen offset:1024 lds
  buffer_load_dwordx4 v54, s[12:15], s36 offen offset:2048 lds
  buffer_load_dwordx4 v55, s[12:15], s36 offen offset:3072 lds
  s_add_u32 m0, s30, 73728
  s_nop 0
  buffer_load_dwordx4 v56, s[12:15], s36 offen offset:0 lds
  buffer_load_dwordx4 v57, s[12:15], s36 offen offset:1024 lds
  buffer_load_dwordx4 v58, s[12:15], s36 offen offset:2048 lds
  buffer_load_dwordx4 v59, s[12:15], s36 offen offset:3072 lds
  s_add_u32 s30, s30, 12288
  s_cmp_eq_u32 s30, 86016
  s_cselect_b32 s30, 0, s30
  s_xor_b32 s36, s18, 1
  s_mul_i32 s36, s36, 393216
  s_add_u32 s36, s36, s39
  s_add_u32 s36, s36, 196608
  s_add_u32 m0, s30, 65536
  s_nop 0
  buffer_load_dwordx4 v48, s[12:15], s36 offen offset:0 lds
  buffer_load_dwordx4 v49, s[12:15], s36 offen offset:1024 lds
  buffer_load_dwordx4 v50, s[12:15], s36 offen offset:2048 lds
  buffer_load_dwordx4 v51, s[12:15], s36 offen offset:3072 lds
  s_add_u32 m0, s30, 69632
  s_nop 0
  buffer_load_dwordx4 v52, s[12:15], s36 offen offset:0 lds
  buffer_load_dwordx4 v53, s[12:15], s36 offen offset:1024 lds
  buffer_load_dwordx4 v54, s[12:15], s36 offen offset:2048 lds
  buffer_load_dwordx4 v55, s[12:15], s36 offen offset:3072 lds
  s_add_u32 m0, s30, 73728
  s_nop 0
  buffer_load_dwordx4 v56, s[12:15], s36 offen offset:0 lds
  buffer_load_dwordx4 v57, s[12:15], s36 offen offset:1024 lds
  buffer_load_dwordx4 v58, s[12:15], s36 offen offset:2048 lds
  buffer_load_dwordx4 v59, s[12:15], s36 offen offset:3072 lds
  s_add_u32 s30, s30, 12288
  s_cmp_eq_u32 s30, 86016
  s_cselect_b32 s30, 0, s30
  s_xor_b32 s36, s18, 2
  s_mul_i32 s36, s36, 393216
  s_add_u32 s36, s36, s39
  s_add_u32 m0, s30, 65536
  s_nop 0
  buffer_load_dwordx4 v48, s[12:15], s36 offen offset:0 lds
  buffer_load_dwordx4 v49, s[12:15], s36 offen offset:1024 lds
  buffer_load_dwordx4 v50, s[12:15], s36 offen offset:2048 lds
  buffer_load_dwordx4 v51, s[12:15], s36 offen offset:3072 lds
  s_add_u32 m0, s30, 69632
  s_nop 0
  buffer_load_dwordx4 v52, s[12:15], s36 offen offset:0 lds
  buffer_load_dwordx4 v53, s[12:15], s36 offen offset:1024 lds
  buffer_load_dwordx4 v54, s[12:15], s36 offen offset:2048 lds
  buffer_load_dwordx4 v55, s[12:15], s36 offen offset:3072 lds
  s_add_u32 m0, s30, 73728
  s_nop 0
  buffer_load_dwordx4 v56, s[12:15], s36 offen offset:0 lds
  buffer_load_dwordx4 v57, s[12:15], s36 offen offset:1024 lds
  buffer_load_dwordx4 v58, s[12:15], s36 offen offset:2048 lds
  buffer_load_dwordx4 v59, s[12:15], s36 offen offset:3072 lds
  s_add_u32 s30, s30, 12288
  s_cmp_eq_u32 s30, 86016
  s_cselect_b32 s30, 0, s30
  v_mov_b32 v6, s71
  s_mov_b32 s38, 0
.g2_kernel_wg33:
  ds_read_b32 v7, v6 offset:20
  s_add_u32 s38, s38, 1
  s_waitcnt lgkmcnt(0)
  v_cmp_le_u32 vcc, 4, v7
  s_cbranch_vccnz .g2_kernel_wg33d
  s_sleep 1
  s_cmp_lt_u32 s38, 524288
  s_cbranch_scc1 .g2_kernel_wg33
.g2_kernel_wg33d:
  s_mov_b32 s62, 1
  s_mov_b32 s63, 0x1800000
  s_mov_b32 s70, 2
  s_mov_b32 s71, 155776
  s_xor_b32 s36, s18, 2
  s_mul_i32 s36, s36, 393216
  s_add_u32 s36, s36, s39
  s_add_u32 s36, s36, 196608
  s_add_u32 m0, s30, 65536
  s_nop 0
  buffer_load_dwordx4 v48, s[12:15], s36 offen offset:0 lds
  buffer_load_dwordx4 v49, s[12:15], s36 offen offset:1024 lds
  buffer_load_dwordx4 v50, s[12:15], s36 offen offset:2048 lds
  buffer_load_dwordx4 v51, s[12:15], s36 offen offset:3072 lds
  s_add_u32 m0, s30, 69632
  s_nop 0
  buffer_load_dwordx4 v52, s[12:15], s36 offen offset:0 lds
  buffer_load_dwordx4 v53, s[12:15], s36 offen offset:1024 lds
  buffer_load_dwordx4 v54, s[12:15], s36 offen offset:2048 lds
  buffer_load_dwordx4 v55, s[12:15], s36 offen offset:3072 lds
  s_add_u32 m0, s30, 73728
  s_nop 0
  buffer_load_dwordx4 v56, s[12:15], s36 offen offset:0 lds
  buffer_load_dwordx4 v57, s[12:15], s36 offen offset:1024 lds
  buffer_load_dwordx4 v58, s[12:15], s36 offen offset:2048 lds
  buffer_load_dwordx4 v59, s[12:15], s36 offen offset:3072 lds
  s_add_u32 s30, s30, 12288
  s_cmp_eq_u32 s30, 86016
  s_cselect_b32 s30, 0, s30
  s_xor_b32 s36, s18, 3
  s_mul_i32 s36, s36, 393216
  s_add_u32 s36, s36, s39
  s_add_u32 m0, s30, 65536
  s_nop 0
  buffer_load_dwordx4 v48, s[12:15], s36 offen offset:0 lds
  buffer_load_dwordx4 v49, s[12:15], s36 offen offset:1024 lds
  buffer_load_dwordx4 v50, s[12:15], s36 offen offset:2048 lds
  buffer_load_dwordx4 v51, s[12:15], s36 offen offset:3072 lds
  s_add_u32 m0, s30, 69632
  s_nop 0
  buffer_load_dwordx4 v52, s[12:15], s36 offen offset:0 lds
  buffer_load_dwordx4 v53, s[12:15], s36 offen offset:1024 lds
  buffer_load_dwordx4 v54, s[12:15], s36 offen offset:2048 lds
  buffer_load_dwordx4 v55, s[12:15], s36 offen offset:3072 lds
  s_add_u32 m0, s30, 73728
  s_nop 0
  buffer_load_dwordx4 v56, s[12:15], s36 offen offset:0 lds
  buffer_load_dwordx4 v57, s[12:15], s36 offen offset:1024 lds
  buffer_load_dwordx4 v58, s[12:15], s36 offen offset:2048 lds
  buffer_load_dwordx4 v59, s[12:15], s36 offen offset:3072 lds
  s_add_u32 s30, s30, 12288
  s_cmp_eq_u32 s30, 86016
  s_cselect_b32 s30, 0, s30
  s_mov_b32 s28, 1
  s_mov_b32 s29, 16384
  s_bitcmp1_b32 s37, s28
  s_cbranch_scc0 .g2_kernel_p2_x0w
.g2_kernel_p2_x0b:
  s_xor_b32 s33, s28, s18
  s_lshl_b32 s33, s33, 14
  s_add_u32 s33, s33, s32
  s_add_u32 m0, s29, 0
  s_nop 0
  buffer_load_dwordx4 v3, s[4:7], s33 offen offset:0 lds
  buffer_load_dwordx4 v3, s[4:7], s33 offen offset:1024 lds
  buffer_load_dwordx4 v3, s[4:7], s33 offen offset:2048 lds
  buffer_load_dwordx4 v3, s[4:7], s33 offen offset:3072 lds
  s_add_u32 m0, s29, 4096
  s_add_u32 s33, s33, 4096
  buffer_load_dwordx4 v3, s[4:7], s33 offen offset:0 lds
  buffer_load_dwordx4 v3, s[4:7], s33 offen offset:1024 lds
  buffer_load_dwordx4 v3, s[4:7], s33 offen offset:2048 lds
  buffer_load_dwordx4 v3, s[4:7], s33 offen offset:3072 lds
  s_add_u32 m0, s29, 8192
  s_add_u32 s33, s33, 4096
  buffer_load_dwordx4 v3, s[4:7], s33 offen offset:0 lds
  buffer_load_dwordx4 v3, s[4:7], s33 offen offset:1024 lds
  buffer_load_dwordx4 v3, s[4:7], s33 offen offset:2048 lds
  buffer_load_dwordx4 v3, s[4:7], s33 offen offset:3072 lds
  s_add_u32 m0, s29, 12288
  s_add_u32 s33, s33, 4096
  buffer_load_dwordx4 v3, s[4:7], s33 offen offset:0 lds
  buffer_load_dwordx4 v3, s[4:7], s33 offen offset:1024 lds
  buffer_load_dwordx4 v3, s[4:7], s33 offen offset:2048 lds
  buffer_load_dwordx4 v3, s[4:7], s33 offen offset:3072 lds
  s_mov_b32 m0, 156160
  s_mov_b32 s35, .g2_kernel_tab-.g2_kernel_pc+144
  buffer_load_dword off, s[64:67], s35 lds
  s_mov_b32 s28, 2
  s_mov_b32 s29, 32768
  s_bitcmp1_b32 s37, s28
  s_cbranch_scc0 .g2_kernel_p2_x1w
.g2_kernel_p2_x1b:
  s_xor_b32 s33, s28, s18
  s_lshl_b32 s33, s33, 14
  s_add_u32 s33, s33, s32
  s_add_u32 m0, s29, 0
  s_nop 0
  buffer_load_dwordx4 v3, s[4:7], s33 offen offset:0 lds
  buffer_load_dwordx4 v3, s[4:7], s33 offen offset:1024 lds
  buffer_load_dwordx4 v3, s[4:7], s33 offen offset:2048 lds
  buffer_load_dwordx4 v3, s[4:7], s33 offen offset:3072 lds
  s_add_u32 m0, s29, 4096
  s_add_u32 s33, s33, 4096
  buffer_load_dwordx4 v3, s[4:7], s33 offen offset:0 lds
  buffer_load_dwordx4 v3, s[4:7], s33 offen offset:1024 lds
  buffer_load_dwordx4 v3, s[4:7], s33 offen offset:2048 lds
  buffer_load_dwordx4 v3, s[4:7], s33 offen offset:3072 lds
  s_add_u32 m0, s29, 8192
  s_add_u32 s33, s33, 4096
  buffer_load_dwordx4 v3, s[4:7], s33 offen offset:0 lds
  buffer_load_dwordx4 v3, s[4:7], s33 offen offset:1024 lds
  buffer_load_dwordx4 v3, s[4:7], s33 offen offset:2048 lds
  buffer_load_dwordx4 v3, s[4:7], s33 offen offset:3072 lds
  s_add_u32 m0, s29, 12288
  s_add_u32 s33, s33, 4096
  buffer_load_dwordx4 v3, s[4:7], s33 offen offset:0 lds
  buffer_load_dwordx4 v3, s[4:7], s33 offen offset:1024 lds
  buffer_load_dwordx4 v3, s[4:7], s33 offen offset:2048 lds
  buffer_load_dwordx4 v3, s[4:7], s33 offen offset:3072 lds
  s_mov_b32 m0, 156160
  s_mov_b32 s35, .g2_kernel_tab-.g2_kernel_pc+152
  buffer_load_dword off, s[64:67], s35 lds
  s_mov_b32 s28, 3
  s_mov_b32 s29, 49152
  s_bitcmp1_b32 s37, s28
  s_cbranch_scc0 .g2_kernel_p2_x2w
.g2_kernel_p2_x2b:
  s_xor_b32 s33, s28, s18
  s_lshl_b32 s33, s33, 14
  s_add_u32 s33, s33, s32
  s_add_u32 m0, s29, 0
  s_nop 0
  buffer_load_dwordx4 v3, s[4:7], s33 offen offset:0 lds
  buffer_load_dwordx4 v3, s[4:7], s33 offen offset:1024 lds
  buffer_load_dwordx4 v3, s[4:7], s33 offen offset:2048 lds
  buffer_load_dwordx4 v3, s[4:7], s33 offen offset:3072 lds
  s_add_u32 m0, s29, 4096
  s_add_u32 s33, s33, 4096
  buffer_load_dwordx4 v3, s[4:7], s33 offen offset:0 lds
  buffer_load_dwordx4 v3, s[4:7], s33 offen offset:1024 lds
  buffer_load_dwordx4 v3, s[4:7], s33 offen offset:2048 lds
  buffer_load_dwordx4 v3, s[4:7], s33 offen offset:3072 lds
  s_add_u32 m0, s29, 8192
  s_add_u32 s33, s33, 4096
  buffer_load_dwordx4 v3, s[4:7], s33 offen offset:0 lds
  buffer_load_dwordx4 v3, s[4:7], s33 offen offset:1024 lds
  buffer_load_dwordx4 v3, s[4:7], s33 offen offset:2048 lds
  buffer_load_dwordx4 v3, s[4:7], s33 offen offset:3072 lds
  s_add_u32 m0, s29, 12288
  s_add_u32 s33, s33, 4096
  buffer_load_dwordx4 v3, s[4:7], s33 offen offset:0 lds
  buffer_load_dwordx4 v3, s[4:7], s33 offen offset:1024 lds
  buffer_load_dwordx4 v3, s[4:7], s33 offen offset:2048 lds
  buffer_load_dwordx4 v3, s[4:7], s33 offen offset:3072 lds
  s_mov_b32 m0, 156160
  s_mov_b32 s35, .g2_kernel_tab-.g2_kernel_pc+156
  buffer_load_dword off, s[64:67], s35 lds
  s_xor_b32 s36, s18, 3
  s_mul_i32 s36, s36, 393216
  s_add_u32 s36, s36, s39
  s_add_u32 s36, s36, 196608
  ds_read_b32 v10, v9
  s_mov_b32 s34, 33
  s_mov_b32 s35, .g2_kernel_tab-.g2_kernel_pc+160
  s_branch .g2_kernel_p2_o
  .p2align 6
.g2_kernel_p2_l:
  s_waitcnt lgkmcnt(0)
  v_cmp_gt_i32 vcc, s34, v10
  s_cbranch_vccnz .g2_kernel_p2_aw
.g2_kernel_p2_ai:
  s_add_u32 s29, s29, 16384
  s_and_b32 s29, s29, 0xffff
  s_bitcmp1_b32 s37, s28
  s_cbranch_scc0 .g2_kernel_p2_x3w
.g2_kernel_p2_x3b:
  s_xor_b32 s33, s28, s18
  s_lshl_b32 s33, s33, 14
  s_add_u32 s33, s33, s32
  s_add_u32 m0, s29, 0
  s_nop 0
  buffer_load_dwordx4 v3, s[4:7], s33 offen offset:0 lds
  buffer_load_dwordx4 v3, s[4:7], s33 offen offset:1024 lds
  buffer_load_dwordx4 v3, s[4:7], s33 offen offset:2048 lds
  buffer_load_dwordx4 v3, s[4:7], s33 offen offset:3072 lds
  s_add_u32 m0, s29, 4096
  s_add_u32 s33, s33, 4096
  buffer_load_dwordx4 v3, s[4:7], s33 offen offset:0 lds
  buffer_load_dwordx4 v3, s[4:7], s33 offen offset:1024 lds
  buffer_load_dwordx4 v3, s[4:7], s33 offen offset:2048 lds
  buffer_load_dwordx4 v3, s[4:7], s33 offen offset:3072 lds
  s_add_u32 m0, s29, 8192
  s_add_u32 s33, s33, 4096
  buffer_load_dwordx4 v3, s[4:7], s33 offen offset:0 lds
  buffer_load_dwordx4 v3, s[4:7], s33 offen offset:1024 lds
  buffer_load_dwordx4 v3, s[4:7], s33 offen offset:2048 lds
  buffer_load_dwordx4 v3, s[4:7], s33 offen offset:3072 lds
  s_add_u32 m0, s29, 12288
  s_add_u32 s33, s33, 4096
  buffer_load_dwordx4 v3, s[4:7], s33 offen offset:0 lds
  buffer_load_dwordx4 v3, s[4:7], s33 offen offset:1024 lds
  buffer_load_dwordx4 v3, s[4:7], s33 offen offset:2048 lds
  buffer_load_dwordx4 v3, s[4:7], s33 offen offset:3072 lds
  s_add_u32 m0, s30, 65536
  s_nop 0
  buffer_load_dwordx4 v48, s[12:15], s36 offen offset:0 lds
  buffer_load_dwordx4 v49, s[12:15], s36 offen offset:1024 lds
  buffer_load_dwordx4 v50, s[12:15], s36 offen offset:2048 lds
  buffer_load_dwordx4 v51, s[12:15], s36 offen offset:3072 lds
  s_add_u32 m0, s30, 69632
  s_nop 0
  buffer_load_dwordx4 v52, s[12:15], s36 offen offset:0 lds
  buffer_load_dwordx4 v53, s[12:15], s36 offen offset:1024 lds
  buffer_load_dwordx4 v54, s[12:15], s36 offen offset:2048 lds
  buffer_load_dwordx4 v55, s[12:15], s36 offen offset:3072 lds
  s_add_u32 m0, s30, 73728
  s_nop 0
  buffer_load_dwordx4 v56, s[12:15], s36 offen offset:0 lds
  buffer_load_dwordx4 v57, s[12:15], s36 offen offset:1024 lds
  buffer_load_dwordx4 v58, s[12:15], s36 offen offset:2048 lds
  buffer_load_dwordx4 v59, s[12:15], s36 offen offset:3072 lds
  s_add_u32 s30, s30, 12288
  s_cmp_eq_u32 s30, 86016
  s_cselect_b32 s30, 0, s30
  ds_read_b32 v10, v9
  s_mov_b32 m0, 156160
  s_add_u32 s34, s34, 1
  buffer_load_dword off, s[64:67], s35 lds
  s_add_u32 s35, s35, 4
  s_add_u32 s36, s36, 196608
.g2_kernel_p2_o:
  s_waitcnt lgkmcnt(0)
  v_cmp_gt_i32 vcc, s34, v10
  s_cbranch_vccnz .g2_kernel_p2_bw
.g2_kernel_p2_bi:
  s_add_u32 m0, s30, 65536
  s_nop 0
  buffer_load_dwordx4 v48, s[12:15], s36 offen offset:0 lds
  buffer_load_dwordx4 v49, s[12:15], s36 offen offset:1024 lds
  buffer_load_dwordx4 v50, s[12:15], s36 offen offset:2048 lds
  buffer_load_dwordx4 v51, s[12:15], s36 offen offset:3072 lds
  s_add_u32 m0, s30, 69632
  s_nop 0
  buffer_load_dwordx4 v52, s[12:15], s36 offen offset:0 lds
  buffer_load_dwordx4 v53, s[12:15], s36 offen offset:1024 lds
  buffer_load_dwordx4 v54, s[12:15], s36 offen offset:2048 lds
  buffer_load_dwordx4 v55, s[12:15], s36 offen offset:3072 lds
  s_add_u32 m0, s30, 73728
  s_nop 0
  buffer_load_dwordx4 v56, s[12:15], s36 offen offset:0 lds
  buffer_load_dwordx4 v57, s[12:15], s36 offen offset:1024 lds
  buffer_load_dwordx4 v58, s[12:15], s36 offen offset:2048 lds
  buffer_load_dwordx4 v59, s[12:15], s36 offen offset:3072 lds
  s_add_u32 s30, s30, 12288
  s_cmp_eq_u32 s30, 86016
  s_cselect_b32 s30, 0, s30
  ds_read_b32 v10, v9
  s_mov_b32 m0, 156160
  s_add_u32 s34, s34, 1
  buffer_load_dword off, s[64:67], s35 lds
  s_add_u32 s35, s35, 4
  s_add_u32 s28, s28, 1
  s_xor_b32 s36, s18, s28
  s_mul_i32 s36, s36, 393216
  s_add_u32 s36, s36, s39
  s_cmp_lt_i32 s34, 58
  s_cbranch_scc1 .g2_kernel_p2_l
  s_branch .g2_kernel_v
.g2_kernel_c1:
  v_mov_b32 v6, s71
  s_mov_b32 s38, 0
.g2_kernel_wg34:
  ds_read_b32 v7, v6 offset:76
  s_add_u32 s38, s38, 1
  s_waitcnt lgkmcnt(0)
  v_cmp_le_u32 vcc, 1, v7
  s_cbranch_vccnz .g2_kernel_wg34d
  s_sleep 1
  s_cmp_lt_u32 s38, 524288
  s_cbranch_scc1 .g2_kernel_wg34
.g2_kernel_wg34d:
  s_sleep 4
  s_and_b32 s31, s19, 0xffffe000
  s_add_u32 s31, s31, 4
  v_and_b32 v6, 15, v2
  v_lshlrev_b32 v6, 9, v6
  v_lshrrev_b32 v7, 4, v2
  v_lshl_add_u32 v6, v7, 7, v6
  v_lshlrev_b32 v7, 2, v2
  v_add_u32 v7, 157952, v7
  s_mov_b32 m0, 157952
  s_mov_b32 s38, 0
.g2_kernel_pa35:
  buffer_load_dword v6, s[4:7], s31 offen sc1 lds
  s_add_u32 s38, s38, 1
  s_waitcnt vmcnt(0)
  ds_read_b32 v8, v7
  s_waitcnt lgkmcnt(0)
  v_cmp_ge_u32 vcc, s62, v8
  s_cbranch_vccz .g2_kernel_pa35d
  s_mov_b64 exec, vcc
  s_sleep 4
  s_cmp_lt_u32 s38, 131072
  s_cbranch_scc1 .g2_kernel_pa35
.g2_kernel_pa35d:
  s_mov_b64 exec, -1
  s_setprio 2
  s_lshl_b32 s30, s17, 4
  s_add_u32 s30, s30, s18
  s_lshl_b32 s20, s30, 11
  s_add_u32 s20, s20, s63
  s_add_u32 s20, s20, 0x1000000
  s_lshl_b32 s21, s30, 6
  s_add_u32 s21, s21, s63
  s_add_u32 s21, s21, 0x1080000
  s_lshl_b32 s23, s62, 14
  s_add_u32 s23, s23, 0x3040000
  s_lshl_b32 s22, s30, 3
  s_add_u32 s22, s22, s23
  s_and_b32 s28, s2, 7
  s_lshl_b32 s28, s28, 11
  s_add_u32 s23, s23, s28
  v_mov_b32 v9, 155648
  ds_read_b32 v26, v9 offset:256
  v_lshrrev_b32 v24, 4, v2
  v_lshlrev_b32 v25, 3, v24
  v_lshlrev_b32 v27, 11, v2
  v_mov_b32 v28, 0.0009765625
  v_mov_b32 v30, 1e-05
  v_mov_b32 v6, s71
  s_mov_b32 s38, 0
.g2_kernel_wg37:
  ds_read_b32 v7, v6 offset:20
  s_add_u32 s38, s38, 1
  s_waitcnt lgkmcnt(0)
  v_cmp_le_u32 vcc, 4, v7
  s_cbranch_vccnz .g2_kernel_wg37d
  s_sleep 1
  s_cmp_lt_u32 s38, 524288
  s_cbranch_scc1 .g2_kernel_wg37
.g2_kernel_wg37d:
  s_sleep 12
  s_cmp_lg_u32 s62, 0
  s_cbranch_scc1 .g2_kernel_nap38
  s_sleep 24
.g2_kernel_nap38:
  s_mov_b32 s38, 0
.g2_kernel_gx39:
  buffer_load_dwordx4 v[16:19], v3, s[4:7], s20 offen offset:0 sc1
  buffer_load_dwordx4 v[20:23], v3, s[4:7], s20 offen offset:1024 sc1
  s_add_u32 s38, s38, 1
  s_waitcnt vmcnt(0)
  v_min3_u32 v6, v16, v19, v20
  v_min_u32 v6, v6, v23
  v_cmp_eq_u32 vcc, 0, v6
  s_cbranch_vccz .g2_kernel_gx39d
  s_mov_b64 exec, vcc
  s_sleep 1
  s_cmp_lg_u32 s62, 0
  s_cbranch_scc1 .g2_kernel_nap40
  s_sleep 23
.g2_kernel_nap40:
  s_cmp_lt_u32 s38, 131072
  s_cbranch_scc1 .g2_kernel_gx39
.g2_kernel_gx39d:
  s_mov_b64 exec, -1
  v_add_f32 v16, v16, v16 row_ror:8 row_mask:0xf bank_mask:0xf
  v_add_f32 v17, v17, v17 row_ror:8 row_mask:0xf bank_mask:0xf
  v_add_f32 v18, v18, v18 row_ror:8 row_mask:0xf bank_mask:0xf
  v_add_f32 v20, v20, v20 row_ror:8 row_mask:0xf bank_mask:0xf
  v_add_f32 v21, v21, v21 row_ror:8 row_mask:0xf bank_mask:0xf
  v_add_f32 v22, v22, v22 row_ror:8 row_mask:0xf bank_mask:0xf
  v_add_f32 v16, v16, v16 row_ror:4 row_mask:0xf bank_mask:0xf
  v_add_f32 v17, v17, v17 row_ror:4 row_mask:0xf bank_mask:0xf
  v_add_f32 v18, v18, v18 row_ror:4 row_mask:0xf bank_mask:0xf
  v_add_f32 v20, v20, v20 row_ror:4 row_mask:0xf bank_mask:0xf
  v_add_f32 v21, v21, v21 row_ror:4 row_mask:0xf bank_mask:0xf
  v_add_f32 v22, v22, v22 row_ror:4 row_mask:0xf bank_mask:0xf
  v_add_f32 v16, v16, v16 row_ror:2 row_mask:0xf bank_mask:0xf
  v_add_f32 v17, v17, v17 row_ror:2 row_mask:0xf bank_mask:0xf
  v_add_f32 v18, v18, v18 row_ror:2 row_mask:0xf bank_mask:0xf
  v_add_f32 v20, v20, v20 row_ror:2 row_mask:0xf bank_mask:0xf
  v_add_f32 v21, v21, v21 row_ror:2 row_mask:0xf bank_mask:0xf
  v_add_f32 v22, v22, v22 row_ror:2 row_mask:0xf bank_mask:0xf
  v_add_f32 v16, v16, v16 row_ror:1 row_mask:0xf bank_mask:0xf
  v_add_f32 v17, v17, v17 row_ror:1 row_mask:0xf bank_mask:0xf
  v_add_f32 v18, v18, v18 row_ror:1 row_mask:0xf bank_mask:0xf
  v_add_f32 v20, v20, v20 row_ror:1 row_mask:0xf bank_mask:0xf
  v_add_f32 v21, v21, v21 row_ror:1 row_mask:0xf bank_mask:0xf
  v_add_f32 v22, v22, v22 row_ror:1 row_mask:0xf bank_mask:0xf
  v_fma_f32 v18, -v16, v26, v18
  v_mul_f32 v16, v28, v16
  v_mul_f32 v19, v16, v16
  v_fma_f32 v17, v17, v28, -v19
  v_max_f32 v17, 0, v17
  v_add_f32 v17, v30, v17
  v_rsq_f32 v19, v17
  v_fma_f32 v22, -v20, v26, v22
  v_mul_f32 v20, v28, v20
  v_mul_f32 v23, v20, v20
  v_fma_f32 v21, v21, v28, -v23
  v_max_f32 v21, 0, v21
  v_add_f32 v21, v30, v21
  v_rsq_f32 v23, v21
  v_mul_f32 v18, v18, v19
  v_mul_f32 v22, v22, v23
  v_and_or_b32 v18, v18, -8, v24
  v_or_b32 v29, 4, v24
  v_and_or_b32 v22, v22, -8, v29
  v_max_f32 v10, v18, v22
  v_mov_b32 v11, 1
  s_nop 0
  v_max_f32 v10, v10, v10 row_bcast:15 row_mask:0xa bank_mask:0xf
  s_nop 1
  v_max_f32 v10, v10, v10 row_bcast:31 row_mask:0xc bank_mask:0xf
  s_nop 0
  v_readlane_b32 s28, v10, 63
  s_nop 1
  v_mov_b32 v10, s28
  s_mov_b64 exec, 0xff
  buffer_store_dwordx2 v[10:11], v27, s[4:7], s22 offen sc1
  s_mov_b32 exec_lo, 0x00010001
  s_mov_b32 exec_hi, 0x00010001
  buffer_store_dwordx2 v[16:17], v25, s[4:7], s21 offen sc1
  buffer_store_dwordx2 v[20:21], v25, s[4:7], s21 offen offset:32 sc1
  s_mov_b64 exec, -1
  s_sleep 8
  s_cmp_lg_u32 s62, 0
  s_cbranch_scc1 .g2_kernel_nap41
  s_sleep 22
.g2_kernel_nap41:
  s_mov_b32 s38, 0
.g2_kernel_gx42:
  buffer_load_dwordx4 v[16:19], v3, s[4:7], s23 offen offset:0 sc1
  buffer_load_dwordx4 v[20:23], v3, s[4:7], s23 offen offset:1024 sc1
  s_add_u32 s38, s38, 1
  s_waitcnt vmcnt(0)
  v_min3_u32 v6, v17, v19, v21
  v_min_u32 v6, v6, v23
  v_cmp_eq_u32 vcc, 0, v6
  s_cbranch_vccz .g2_kernel_gx42d
  s_mov_b64 exec, vcc
  s_sleep 1
  s_cmp_lg_u32 s62, 0
  s_cbranch_scc1 .g2_kernel_nap43
  s_sleep 23
.g2_kernel_nap43:
  s_cmp_lt_u32 s38, 131072
  s_cbranch_scc1 .g2_kernel_gx42
.g2_kernel_gx42d:
  s_mov_b64 exec, -1
  s_mov_b32 s28, 0xffffffe7
  v_and_or_b32 v16, v16, s28, 0
  v_and_or_b32 v18, v18, s28, 8
  v_and_or_b32 v20, v20, s28, 16
  v_and_or_b32 v22, v22, s28, 24
  v_max3_f32 v10, v16, v18, v20
  v_max_f32 v10, v10, v22
  s_nop 1
  v_max_f32 v11, v10, v10 row_ror:8 row_mask:0xf bank_mask:0xf
  s_nop 1
  v_max_f32 v11, v11, v11 row_ror:4 row_mask:0xf bank_mask:0xf
  s_nop 1
  v_max_f32 v11, v11, v11 row_ror:2 row_mask:0xf bank_mask:0xf
  s_nop 1
  v_max_f32 v11, v11, v11 row_ror:1 row_mask:0xf bank_mask:0xf
  s_nop 1
  v_max_f32 v11, v11, v11 row_bcast:15 row_mask:0xa bank_mask:0xf
  s_nop 1
  v_max_f32 v11, v11, v11 row_bcast:31 row_mask:0xc bank_mask:0xf
  s_nop 0
  v_readlane_b32 s27, v11, 63
  s_nop 1
  v_cmp_eq_u32 vcc, s27, v10
  s_ff1_i32_b64 s77, vcc
  s_lshl_b32 s77, s77, 4
  s_and_b32 s28, s27, 15
  s_add_u32 s77, s77, s28
  s_and_b32 s28, s27, 16
  s_lshl_b32 s28, s28, 6
  s_add_u32 s77, s77, s28
  s_and_b32 s77, s77, 2047
  s_add_u32 s28, s77, 1
  v_mov_b32 v10, s28
  v_mov_b32 v9, s71
  ds_write_b32 v9, v10 offset:36
  s_lshr_b32 s24, s77, 7
  s_lshl_b32 s24, s24, 18
  s_bfe_u32 s28, s77, 0x30004
  s_lshl_b32 s28, s28, 11
  s_add_u32 s24, s24, s28
  s_and_b32 s28, s77, 15
  s_lshl_b32 s28, s28, 4
  s_add_u32 s24, s24, s28
  s_add_u32 s24, s24, s63
  s_add_u32 s24, s24, 0xc00000
  s_lshl_b32 s28, s17, 14
  s_add_u32 s24, s24, s28
  s_and_b32 s28, s18, 1
  s_lshl_b32 s28, s28, 8
  s_add_u32 s24, s24, s28
  v_lshrrev_b32 v12, 3, v2
  v_lshlrev_b32 v13, 1, v12
  s_waitcnt lgkmcnt(0)
  s_wakeup
  buffer_load_ushort v56, v13, s[4:7], s24 offen offset:0
  buffer_load_ushort v57, v13, s[4:7], s24 offen offset:512
  buffer_load_ushort v58, v13, s[4:7], s24 offen offset:1024
  buffer_load_ushort v59, v13, s[4:7], s24 offen offset:1536
  s_lshl_b32 s25, s77, 3
  s_add_u32 s25, s25, s63
  s_add_u32 s25, s25, 0x1080000
  s_lshl_b32 s21, s17, 10
  s_add_u32 s21, s21, s63
  s_add_u32 s21, s21, 0x1080000
  s_mov_b32 s38, 0
.g2_kernel_gx44:
  buffer_load_dwordx4 v[16:19], v3, s[4:7], s21 offen sc1
  buffer_load_dwordx2 v[20:21], v4, s[4:7], s25 offen sc1
  s_add_u32 s38, s38, 1
  s_waitcnt vmcnt(0)
  v_min3_u32 v6, v17, v19, v21
  v_cmp_eq_u32 vcc, 0, v6
  s_cbranch_vccz .g2_kernel_gx44d
  s_mov_b64 exec, vcc
  s_sleep 1
  s_cmp_lt_u32 s38, 131072
  s_cbranch_scc1 .g2_kernel_gx44
.g2_kernel_gx44d:
  s_mov_b64 exec, -1
  s_lshr_b32 s28, s77, 7
  s_and_b32 s79, s77, 127
  s_add_u32 s79, s79, 1
  s_cmp_eq_u32 s28, s17
  s_cselect_b32 s79, s79, 0
  v_rsq_f32 v22, v17
  v_rsq_f32 v23, v19
  v_rsq_f32 v21, v21
  v_mov_b32 v62, -1.4426950408889634
  v_mul_f32 v62, s27, v62
  v_exp_f32 v62, v62
  v_lshlrev_b32 v14, 3, v2
  v_add_u32 v14, 155648, v14
  v_mov_b32 v15, s79
  v_add_f32 v52, 1.0, v22
  v_mul_f32 v54, v16, v22
  v_sub_f32 v54, 0, v54
  v_add_f32 v53, 1.0, v23
  v_mul_f32 v55, v18, v23
  v_sub_f32 v55, 0, v55
  s_cmp_eq_u32 s62, 0
  s_cbranch_scc1 .g2_kernel_c_m1
  ds_write_b64 v14, v[52:53] offset:3840
  ds_write_b64 v14, v[54:55] offset:4352
  ds_write_b32 v9, v15 offset:32
  ds_write_b32 v9, v5 offset:28
  s_cmp_ge_u32 s18, 2
  s_cbranch_scc1 .g2_kernel_fin
.g2_kernel_c_m1:
  v_add_f32 v62, 1.0, v62
  v_rcp_f32 v62, v62
  v_add_f32 v60, 1.0, v21
  v_mul_f32 v61, v20, v21
  v_sub_f32 v61, 0, v61
  v_sub_f32 v17, v17, v30
  v_mul_f32 v48, v52, v52
  v_fma_f32 v48, v48, v17, v30
  v_rsq_f32 v48, v48
  s_nop 0
  v_mul_f32 v48, v48, v52
  v_mul_f32 v50, v48, v16
  v_sub_f32 v50, 0, v50
  v_sub_f32 v19, v19, v30
  v_mul_f32 v49, v53, v53
  v_fma_f32 v49, v49, v19, v30
  v_rsq_f32 v49, v49
  s_nop 0
  v_mul_f32 v49, v49, v53
  v_mul_f32 v51, v49, v18
  v_sub_f32 v51, 0, v51
  v_lshlrev_b32 v56, 16, v56
  v_fma_f32 v56, v56, v60, v61
  v_lshlrev_b32 v57, 16, v57
  v_fma_f32 v57, v57, v60, v61
  v_lshlrev_b32 v58, 16, v58
  v_fma_f32 v58, v58, v60, v61
  v_lshlrev_b32 v59, 16, v59
  v_fma_f32 v59, v59, v60, v61
  v_and_b32 v10, 7, v2
  v_lshlrev_b32 v10, 12, v10
  v_lshl_add_u32 v10, v12, 4, v10
  s_lshl_b32 s20, s17, 1
  s_and_b32 s28, s18, 1
  s_add_u32 s20, s20, s28
  s_lshl_b32 s20, s20, 7
  s_add_u32 s20, s20, s63
  s_add_u32 s20, s20, 0x1090000
  s_and_b32 s26, s18, 14
  s_lshl_b32 s26, s26, 4
  s_add_u32 s26, s26, s17
  s_lshl_b32 s26, s26, 1
  s_and_b32 s28, s18, 1
  s_add_u32 s26, s26, s28
  s_lshl_b32 s26, s26, 10
  s_add_u32 s26, s26, s63
  s_add_u32 s26, s26, 0x1190000
  s_add_u32 s25, s26, 32768
  s_cmp_lg_u32 s62, 0
  s_cbranch_scc1 .g2_kernel_c_np
  ds_write_b64 v14, v[48:49] offset:2816
  ds_write_b64 v14, v[50:51] offset:3328
  ds_write_b64 v14, v[52:53] offset:3840
  ds_write_b64 v14, v[54:55] offset:4352
  v_mov_b32 v8, 2
  ds_write_b32 v9, v15 offset:152
  ds_write_b32 v9, v8 offset:128
.g2_kernel_c_np:
  v_mov_b32 v6, s71
  s_mov_b32 s38, 0
.g2_kernel_wg45:
  ds_read_b32 v7, v6 offset:48
  s_add_u32 s38, s38, 1
  s_waitcnt lgkmcnt(0)
  v_cmp_le_u32 vcc, 2, v7
  s_cbranch_vccnz .g2_kernel_wg45d
  s_sleep 1
  s_cmp_lt_u32 s38, 524288
  s_cbranch_scc1 .g2_kernel_wg45
.g2_kernel_wg45d:
  s_sleep 8
  s_cmp_lg_u32 s62, 0
  s_cbranch_scc1 .g2_kernel_nap46
  s_sleep 22
.g2_kernel_nap46:
  s_mov_b32 s38, 0
.g2_kernel_gx47:
  s_mov_b32 s21, s20
  buffer_load_dwordx4 v[160:163], v10, s[4:7], s21 offen sc1
  s_add_u32 s21, s21, 32768
  buffer_load_dwordx4 v[164:167], v10, s[4:7], s21 offen sc1
  s_add_u32 s21, s21, 32768
  buffer_load_dwordx4 v[168:171], v10, s[4:7], s21 offen sc1
  s_add_u32 s21, s21, 32768
  buffer_load_dwordx4 v[172:175], v10, s[4:7], s21 offen sc1
  s_add_u32 s21, s21, 32768
  buffer_load_dwordx4 v[176:179], v10, s[4:7], s21 offen sc1
  s_add_u32 s21, s21, 32768
  buffer_load_dwordx4 v[180:183], v10, s[4:7], s21 offen sc1
  s_add_u32 s21, s21, 32768
  buffer_load_dwordx4 v[184:187], v10, s[4:7], s21 offen sc1
  s_add_u32 s21, s21, 32768
  buffer_load_dwordx4 v[188:191], v10, s[4:7], s21 offen sc1
  s_add_u32 s21, s21, 32768
  buffer_load_dwordx4 v[192:195], v10, s[4:7], s21 offen sc1
  s_add_u32 s21, s21, 32768
  buffer_load_dwordx4 v[196:199], v10, s[4:7], s21 offen sc1
  s_add_u32 s21, s21, 32768
  buffer_load_dwordx4 v[200:203], v10, s[4:7], s21 offen sc1
  s_add_u32 s21, s21, 32768
  buffer_load_dwordx4 v[204:207], v10, s[4:7], s21 offen sc1
  s_add_u32 s21, s21, 32768
  buffer_load_dwordx4 v[208:211], v10, s[4:7], s21 offen sc1
  s_add_u32 s21, s21, 32768
  buffer_load_dwordx4 v[212:215], v10, s[4:7], s21 offen sc1
  s_add_u32 s21, s21, 32768
  buffer_load_dwordx4 v[216:219], v10, s[4:7], s21 offen sc1
  s_add_u32 s21, s21, 32768
  buffer_load_dwordx4 v[220:223], v10, s[4:7], s21 offen sc1
  s_add_u32 s21, s21, 32768
  buffer_load_dwordx4 v[224:227], v10, s[4:7], s21 offen sc1
  s_add_u32 s21, s21, 32768
  buffer_load_dwordx4 v[228:231], v10, s[4:7], s21 offen sc1
  s_add_u32 s21, s21, 32768
  buffer_load_dwordx4 v[232:235], v10, s[4:7], s21 offen sc1
  s_add_u32 s21, s21, 32768
  buffer_load_dwordx4 v[236:239], v10, s[4:7], s21 offen sc1
  s_add_u32 s21, s21, 32768
  buffer_load_dwordx4 v[240:243], v10, s[4:7], s21 offen sc1
  s_add_u32 s21, s21, 32768
  buffer_load_dwordx4 v[244:247], v10, s[4:7], s21 offen sc1
  s_add_u32 s21, s21, 32768
  buffer_load_dwordx4 v[248:251], v10, s[4:7], s21 offen sc1
  s_add_u32 s21, s21, 32768
  buffer_load_dwordx4 v[252:255], v10, s[4:7], s21 offen sc1
  s_add_u32 s21, s21, 32768
  buffer_load_dwordx4 v[16:19], v10, s[4:7], s21 offen sc1
  s_add_u32 s21, s21, 32768
  buffer_load_dwordx4 v[20:23], v10, s[4:7], s21 offen sc1
  s_add_u32 s21, s21, 32768
  buffer_load_dwordx4 v[24:27], v10, s[4:7], s21 offen sc1
  s_add_u32 s21, s21, 32768
  buffer_load_dwordx4 v[28:31], v10, s[4:7], s21 offen sc1
  s_add_u32 s21, s21, 32768
  s_add_u32 s38, s38, 1
  s_waitcnt vmcnt(0)
  v_min3_u32 v6, v160, v162, v164
  v_min3_u32 v6, v6, v166, v168
  v_min3_u32 v6, v6, v170, v172
  v_min3_u32 v6, v6, v174, v176
  v_min3_u32 v6, v6, v178, v180
  v_min3_u32 v6, v6, v182, v184
  v_min3_u32 v6, v6, v186, v188
  v_min3_u32 v6, v6, v190, v192
  v_min3_u32 v6, v6, v194, v196
  v_min3_u32 v6, v6, v198, v200
  v_min3_u32 v6, v6, v202, v204
  v_min3_u32 v6, v6, v206, v208
  v_min3_u32 v6, v6, v210, v212
  v_min3_u32 v6, v6, v214, v216
  v_min3_u32 v6, v6, v218, v220
  v_min3_u32 v6, v6, v222, v224
  v_min3_u32 v6, v6, v226, v228
  v_min3_u32 v6, v6, v230, v232
  v_min3_u32 v6, v6, v234, v236
  v_min3_u32 v6, v6, v238, v240
  v_min3_u32 v6, v6, v242, v244
  v_min3_u32 v6, v6, v246, v248
  v_min3_u32 v6, v6, v250, v252
  v_min3_u32 v6, v6, v254, v16
  v_min3_u32 v6, v6, v18, v20
  v_min3_u32 v6, v6, v22, v24
  v_min3_u32 v6, v6, v26, v28
  v_min_u32 v6, v6, v30
  v_cmp_eq_u32 vcc, 0, v6
  s_cbranch_vccz .g2_kernel_gx47d
  s_mov_b64 exec, vcc
  s_sleep 1
  s_cmp_lg_u32 s62, 0
  s_cbranch_scc1 .g2_kernel_nap48
  s_sleep 11
.g2_kernel_nap48:
  s_cmp_lt_u32 s38, 131072
  s_cbranch_scc1 .g2_kernel_gx47
.g2_kernel_gx47d:
  s_mov_b64 exec, -1
  v_add_f32 v164, v164, v160
  v_add_f32 v165, v165, v161
  v_add_f32 v166, v166, v162
  v_add_f32 v167, v167, v163
  v_add_f32 v172, v172, v168
  v_add_f32 v173, v173, v169
  v_add_f32 v174, v174, v170
  v_add_f32 v175, v175, v171
  v_add_f32 v180, v180, v176
  v_add_f32 v181, v181, v177
  v_add_f32 v182, v182, v178
  v_add_f32 v183, v183, v179
  v_add_f32 v188, v188, v184
  v_add_f32 v189, v189, v185
  v_add_f32 v190, v190, v186
  v_add_f32 v191, v191, v187
  v_add_f32 v196, v196, v192
  v_add_f32 v197, v197, v193
  v_add_f32 v198, v198, v194
  v_add_f32 v199, v199, v195
  v_add_f32 v204, v204, v200
  v_add_f32 v205, v205, v201
  v_add_f32 v206, v206, v202
  v_add_f32 v207, v207, v203
  v_add_f32 v212, v212, v208
  v_add_f32 v213, v213, v209
  v_add_f32 v214, v214, v210
  v_add_f32 v215, v215, v211
  v_add_f32 v220, v220, v216
  v_add_f32 v221, v221, v217
  v_add_f32 v222, v222, v218
  v_add_f32 v223, v223, v219
  v_add_f32 v228, v228, v224
  v_add_f32 v229, v229, v225
  v_add_f32 v230, v230, v226
  v_add_f32 v231, v231, v227
  v_add_f32 v236, v236, v232
  v_add_f32 v237, v237, v233
  v_add_f32 v238, v238, v234
  v_add_f32 v239, v239, v235
  v_add_f32 v244, v244, v240
  v_add_f32 v245, v245, v241
  v_add_f32 v246, v246, v242
  v_add_f32 v247, v247, v243
  v_add_f32 v252, v252, v248
  v_add_f32 v253, v253, v249
  v_add_f32 v254, v254, v250
  v_add_f32 v255, v255, v251
  v_add_f32 v20, v20, v16
  v_add_f32 v21, v21, v17
  v_add_f32 v22, v22, v18
  v_add_f32 v23, v23, v19
  v_add_f32 v28, v28, v24
  v_add_f32 v29, v29, v25
  v_add_f32 v30, v30, v26
  v_add_f32 v31, v31, v27
  v_add_f32 v172, v172, v164
  v_add_f32 v173, v173, v165
  v_add_f32 v174, v174, v166
  v_add_f32 v175, v175, v167
  v_add_f32 v188, v188, v180
  v_add_f32 v189, v189, v181
  v_add_f32 v190, v190, v182
  v_add_f32 v191, v191, v183
  v_add_f32 v204, v204, v196
  v_add_f32 v205, v205, v197
  v_add_f32 v206, v206, v198
  v_add_f32 v207, v207, v199
  v_add_f32 v220, v220, v212
  v_add_f32 v221, v221, v213
  v_add_f32 v222, v222, v214
  v_add_f32 v223, v223, v215
  v_add_f32 v236, v236, v228
  v_add_f32 v237, v237, v229
  v_add_f32 v238, v238, v230
  v_add_f32 v239, v239, v231
  v_add_f32 v252, v252, v244
  v_add_f32 v253, v253, v245
  v_add_f32 v254, v254, v246
  v_add_f32 v255, v255, v247
  v_add_f32 v28, v28, v20
  v_add_f32 v29, v29, v21
  v_add_f32 v30, v30, v22
  v_add_f32 v31, v31, v23
  v_add_f32 v188, v188, v172
  v_add_f32 v189, v189, v173
  v_add_f32 v190, v190, v174
  v_add_f32 v191, v191, v175
  v_add_f32 v220, v220, v204
  v_add_f32 v221, v221, v205
  v_add_f32 v222, v222, v206
  v_add_f32 v223, v223, v207
  v_add_f32 v252, v252, v236
  v_add_f32 v253, v253, v237
  v_add_f32 v254, v254, v238
  v_add_f32 v255, v255, v239
  v_add_f32 v220, v220, v188
  v_add_f32 v221, v221, v189
  v_add_f32 v222, v222, v190
  v_add_f32 v223, v223, v191
  v_add_f32 v28, v28, v252
  v_add_f32 v29, v29, v253
  v_add_f32 v30, v30, v254
  v_add_f32 v31, v31, v255
  v_add_f32 v28, v28, v220
  v_add_f32 v29, v29, v221
  v_add_f32 v30, v30, v222
  v_add_f32 v31, v31, v223
  v_add_f32 v28, v28, v28 quad_perm:[1,0,3,2] row_mask:0xf bank_mask:0xf
  v_add_f32 v29, v29, v29 quad_perm:[1,0,3,2] row_mask:0xf bank_mask:0xf
  v_add_f32 v30, v30, v30 quad_perm:[1,0,3,2] row_mask:0xf bank_mask:0xf
  v_add_f32 v31, v31, v31 quad_perm:[1,0,3,2] row_mask:0xf bank_mask:0xf
  v_add_f32 v28, v28, v28 quad_perm:[2,3,0,1] row_mask:0xf bank_mask:0xf
  v_add_f32 v29, v29, v29 quad_perm:[2,3,0,1] row_mask:0xf bank_mask:0xf
  v_add_f32 v30, v30, v30 quad_perm:[2,3,0,1] row_mask:0xf bank_mask:0xf
  v_add_f32 v31, v31, v31 quad_perm:[2,3,0,1] row_mask:0xf bank_mask:0xf
  v_add_f32 v28, v28, v28 row_half_mirror row_mask:0xf bank_mask:0xf
  v_add_f32 v29, v29, v29 row_half_mirror row_mask:0xf bank_mask:0xf
  v_add_f32 v30, v30, v30 row_half_mirror row_mask:0xf bank_mask:0xf
  v_add_f32 v31, v31, v31 row_half_mirror row_mask:0xf bank_mask:0xf
  v_mul_f32 v28, v28, v62
  v_mul_f32 v29, v29, v62
  v_mul_f32 v30, v30, v62
  v_mul_f32 v31, v31, v62
  v_cvt_pk_bf16_f32 v16, v28, v29
  v_cvt_pk_bf16_f32 v17, v30, v31
  s_mov_b32 s28, 0x00010001
  s_mov_b32 s29, 0x00010001
  v_mov_b32 v18, v16 row_ror:8 row_mask:0xf bank_mask:0xf
  v_mov_b32 v19, v17 row_ror:8 row_mask:0xf bank_mask:0xf
  v_lshlrev_b32 v28, 16, v16
  v_and_b32 v29, 0xffff0000, v16
  v_lshlrev_b32 v30, 16, v17
  v_and_b32 v31, 0xffff0000, v17
  s_cmp_lg_u32 s62, 0
  s_cbranch_scc1 .g2_kernel_c_t3
  v_cndmask_b32 v32, 0, v16, s[28:29]
  v_cndmask_b32 v33, 0, v17, s[28:29]
  v_cndmask_b32 v34, 0, v18, s[28:29]
  v_cndmask_b32 v35, 0, v19, s[28:29]
  s_lshl_b64 s[28:29], s[28:29], 1
  s_nop 0
  v_mfma_f32_16x16x32_bf16 v[160:163], v[32:35], v[64:67], 0
  v_mfma_f32_16x16x32_bf16 v[164:167], v[32:35], v[80:83], 0
  v_mfma_f32_16x16x32_bf16 v[168:171], v[32:35], v[96:99], 0
  v_mfma_f32_16x16x32_bf16 v[172:175], v[32:35], v[112:115], 0
  v_mfma_f32_16x16x32_bf16 v[176:179], v[32:35], v[128:131], 0
  v_mfma_f32_16x16x32_bf16 v[180:183], v[32:35], v[144:147], 0
  v_cndmask_b32 v36, 0, v16, s[28:29]
  v_cndmask_b32 v37, 0, v17, s[28:29]
  v_cndmask_b32 v38, 0, v18, s[28:29]
  v_cndmask_b32 v39, 0, v19, s[28:29]
  s_lshl_b64 s[28:29], s[28:29], 1
  s_nop 0
  v_mfma_f32_16x16x32_bf16 v[160:163], v[36:39], v[68:71], v[160:163]
  v_mfma_f32_16x16x32_bf16 v[164:167], v[36:39], v[84:87], v[164:167]
  v_mfma_f32_16x16x32_bf16 v[168:171], v[36:39], v[100:103], v[168:171]
  v_mfma_f32_16x16x32_bf16 v[172:175], v[36:39], v[116:119], v[172:175]
  v_mfma_f32_16x16x32_bf16 v[176:179], v[36:39], v[132:135], v[176:179]
  v_mfma_f32_16x16x32_bf16 v[180:183], v[36:39], v[148:151], v[180:183]
  v_cndmask_b32 v40, 0, v16, s[28:29]
  v_cndmask_b32 v41, 0, v17, s[28:29]
  v_cndmask_b32 v42, 0, v18, s[28:29]
  v_cndmask_b32 v43, 0, v19, s[28:29]
  s_lshl_b64 s[28:29], s[28:29], 1
  s_nop 0
  v_mfma_f32_16x16x32_bf16 v[160:163], v[40:43], v[72:75], v[160:163]
  v_mfma_f32_16x16x32_bf16 v[164:167], v[40:43], v[88:91], v[164:167]
  v_mfma_f32_16x16x32_bf16 v[168:171], v[40:43], v[104:107], v[168:171]
  v_mfma_f32_16x16x32_bf16 v[172:175], v[40:43], v[120:123], v[172:175]
  v_mfma_f32_16x16x32_bf16 v[176:179], v[40:43], v[136:139], v[176:179]
  v_mfma_f32_16x16x32_bf16 v[180:183], v[40:43], v[152:155], v[180:183]
  v_cndmask_b32 v44, 0, v16, s[28:29]
  v_cndmask_b32 v45, 0, v17, s[28:29]
  v_cndmask_b32 v46, 0, v18, s[28:29]
  v_cndmask_b32 v47, 0, v19, s[28:29]
  s_lshl_b64 s[28:29], s[28:29], 1
  s_nop 0
  v_mfma_f32_16x16x32_bf16 v[160:163], v[44:47], v[76:79], v[160:163]
  v_mfma_f32_16x16x32_bf16 v[164:167], v[44:47], v[92:95], v[164:167]
  v_mfma_f32_16x16x32_bf16 v[168:171], v[44:47], v[108:111], v[168:171]
  v_mfma_f32_16x16x32_bf16 v[172:175], v[44:47], v[124:127], v[172:175]
  v_mfma_f32_16x16x32_bf16 v[176:179], v[44:47], v[140:143], v[176:179]
  v_mfma_f32_16x16x32_bf16 v[180:183], v[44:47], v[156:159], v[180:183]
  v_add_f32 v56, v56, v28
  v_add_f32 v57, v57, v29
  v_add_f32 v58, v58, v30
  v_add_f32 v59, v59, v31
  v_add_f32 v20, v56, v57
  v_mul_f32 v22, v56, v56
  v_add_f32 v21, v58, v59
  v_fmac_f32 v22, v57, v57
  v_add_f32 v20, v20, v21
  v_fmac_f32 v22, v58, v58
  v_fmac_f32 v22, v59, v59
  v_or_b32 v28, 1, v28
  v_or_b32 v30, 1, v30
  v_add_f32 v20, v20, v20 row_ror:8 row_mask:0xf bank_mask:0xf
  v_add_f32 v22, v22, v22 row_ror:8 row_mask:0xf bank_mask:0xf
  v_lshlrev_b32 v11, 4, v12
  v_add_f32 v20, v20, v20 row_bcast:15 row_mask:0xa bank_mask:0xf
  v_add_f32 v22, v22, v22 row_bcast:15 row_mask:0xa bank_mask:0xf
  s_mov_b32 exec_lo, 0x01010101
  s_mov_b32 exec_hi, 0x01010101
  buffer_store_dwordx4 v[28:31], v11, s[4:7], s26 offen offset:768 sc1
  buffer_store_dwordx4 v[28:31], v11, s[4:7], s25 offen offset:768 sc1
  s_mov_b64 exec, -1
  v_add_f32 v20, v20, v20 row_bcast:31 row_mask:0xc bank_mask:0xf
  v_add_f32 v22, v22, v22 row_bcast:31 row_mask:0xc bank_mask:0xf
  v_or_b32 v20, 1, v20
  v_or_b32 v22, 1, v22
  s_mov_b32 exec_lo, 0
  s_mov_b32 exec_hi, 0x80000000
  buffer_store_dwordx4 v[20:23], v4, s[4:7], s26 offen offset:896 sc1
  buffer_store_dwordx4 v[20:23], v4, s[4:7], s25 offen offset:896 sc1
  s_mov_b64 exec, 0xffff
  v_or_b32 v160, 1, v160
  v_or_b32 v162, 1, v162
  buffer_store_dwordx4 v[160:163], v3, s[4:7], s26 offen offset:0 sc1
  v_or_b32 v164, 1, v164
  v_or_b32 v166, 1, v166
  buffer_store_dwordx4 v[164:167], v3, s[4:7], s25 offen offset:0 sc1
  v_or_b32 v168, 1, v168
  v_or_b32 v170, 1, v170
  buffer_store_dwordx4 v[168:171], v3, s[4:7], s26 offen offset:256 sc1
  v_or_b32 v172, 1, v172
  v_or_b32 v174, 1, v174
  buffer_store_dwordx4 v[172:175], v3, s[4:7], s25 offen offset:256 sc1
  v_or_b32 v176, 1, v176
  v_or_b32 v178, 1, v178
  buffer_store_dwordx4 v[176:179], v3, s[4:7], s26 offen offset:512 sc1
  v_or_b32 v180, 1, v180
  v_or_b32 v182, 1, v182
  buffer_store_dwordx4 v[180:183], v3, s[4:7], s25 offen offset:512 sc1
  s_mov_b64 exec, -1
  s_cmp_eq_u32 s79, 0
  s_cbranch_scc1 .g2_kernel_c_no
  s_lshl_b32 s20, s18, 15
  s_add_u32 s20, s20, 0x1190000
  s_lshl_b32 s22, s18, 11
  s_add_u32 s22, s22, s20
  v_lshlrev_b32 v16, 10, v2
  s_sleep 16
  s_mov_b32 s38, 0
  s_mov_b32 exec_hi, 0
.g2_kernel_gx49:
  buffer_load_dword v17, v16, s[4:7], s20 offen offset:752 sc1
  s_add_u32 s38, s38, 1
  s_waitcnt vmcnt(0)
  v_min_u32 v6, v17, v17
  v_cmp_eq_u32 vcc, 0, v6
  s_cbranch_vccz .g2_kernel_gx49d
  s_mov_b64 exec, vcc
  s_sleep 6
  s_cmp_lt_u32 s38, 131072
  s_cbranch_scc1 .g2_kernel_gx49
.g2_kernel_gx49d:
  s_mov_b64 exec, -1
  s_mov_b32 s38, 0
  s_bfm_b64 exec, 57, 0
.g2_kernel_gx50:
  s_mov_b32 s21, s20
  buffer_load_dwordx4 v[64:67], v3, s[4:7], s21 offen offset:0 sc1
  buffer_load_dwordx4 v[68:71], v3, s[4:7], s21 offen offset:1024 sc1
  buffer_load_dwordx4 v[72:75], v3, s[4:7], s21 offen offset:2048 sc1
  buffer_load_dwordx4 v[76:79], v3, s[4:7], s21 offen offset:3072 sc1
  s_add_u32 s21, s21, 4096
  buffer_load_dwordx4 v[80:83], v3, s[4:7], s21 offen offset:0 sc1
  buffer_load_dwordx4 v[84:87], v3, s[4:7], s21 offen offset:1024 sc1
  buffer_load_dwordx4 v[88:91], v3, s[4:7], s21 offen offset:2048 sc1
  buffer_load_dwordx4 v[92:95], v3, s[4:7], s21 offen offset:3072 sc1
  s_add_u32 s21, s21, 4096
  buffer_load_dwordx4 v[96:99], v3, s[4:7], s21 offen offset:0 sc1
  buffer_load_dwordx4 v[100:103], v3, s[4:7], s21 offen offset:1024 sc1
  buffer_load_dwordx4 v[104:107], v3, s[4:7], s21 offen offset:2048 sc1
  buffer_load_dwordx4 v[108:111], v3, s[4:7], s21 offen offset:3072 sc1
  s_add_u32 s21, s21, 4096
  buffer_load_dwordx4 v[112:115], v3, s[4:7], s21 offen offset:0 sc1
  buffer_load_dwordx4 v[116:119], v3, s[4:7], s21 offen offset:1024 sc1
  buffer_load_dwordx4 v[120:123], v3, s[4:7], s21 offen offset:2048 sc1
  buffer_load_dwordx4 v[124:127], v3, s[4:7], s21 offen offset:3072 sc1
  s_add_u32 s21, s21, 4096
  buffer_load_dwordx4 v[128:131], v3, s[4:7], s21 offen offset:0 sc1
  buffer_load_dwordx4 v[132:135], v3, s[4:7], s21 offen offset:1024 sc1
  buffer_load_dwordx4 v[136:139], v3, s[4:7], s21 offen offset:2048 sc1
  buffer_load_dwordx4 v[140:143], v3, s[4:7], s21 offen offset:3072 sc1
  s_add_u32 s21, s21, 4096
  buffer_load_dwordx4 v[144:147], v3, s[4:7], s21 offen offset:0 sc1
  buffer_load_dwordx4 v[148:151], v3, s[4:7], s21 offen offset:1024 sc1
  buffer_load_dwordx4 v[152:155], v3, s[4:7], s21 offen offset:2048 sc1
  buffer_load_dwordx4 v[156:159], v3, s[4:7], s21 offen offset:3072 sc1
  s_add_u32 s21, s21, 4096
  buffer_load_dwordx4 v[160:163], v3, s[4:7], s21 offen offset:0 sc1
  buffer_load_dwordx4 v[164:167], v3, s[4:7], s21 offen offset:1024 sc1
  buffer_load_dwordx4 v[168:171], v3, s[4:7], s21 offen offset:2048 sc1
  buffer_load_dwordx4 v[172:175], v3, s[4:7], s21 offen offset:3072 sc1
  s_add_u32 s21, s21, 4096
  buffer_load_dwordx4 v[176:179], v3, s[4:7], s21 offen offset:0 sc1
  buffer_load_dwordx4 v[180:183], v3, s[4:7], s21 offen offset:1024 sc1
  buffer_load_dwordx4 v[184:187], v3, s[4:7], s21 offen offset:2048 sc1
  buffer_load_dwordx4 v[188:191], v3, s[4:7], s21 offen offset:3072 sc1
  s_add_u32 s21, s21, 4096
  buffer_load_dwordx4 v[192:195], v3, s[4:7], s22 offen offset:0 sc1
  buffer_load_dwordx4 v[196:199], v3, s[4:7], s22 offen offset:1024 sc1
  s_add_u32 s38, s38, 1
  s_waitcnt vmcnt(0)
  v_min3_u32 v6, v64, v66, v68
  v_min3_u32 v6, v6, v70, v72
  v_min3_u32 v6, v6, v74, v76
  v_min3_u32 v6, v6, v78, v80
  v_min3_u32 v6, v6, v82, v84
  v_min3_u32 v6, v6, v86, v88
  v_min3_u32 v6, v6, v90, v92
  v_min3_u32 v6, v6, v94, v96
  v_min3_u32 v6, v6, v98, v100
  v_min3_u32 v6, v6, v102, v104
  v_min3_u32 v6, v6, v106, v108
  v_min3_u32 v6, v6, v110, v112
  v_min3_u32 v6, v6, v114, v116
  v_min3_u32 v6, v6, v118, v120
  v_min3_u32 v6, v6, v122, v124
  v_min3_u32 v6, v6, v126, v128
  v_min3_u32 v6, v6, v130, v132
  v_min3_u32 v6, v6, v134, v136
  v_min3_u32 v6, v6, v138, v140
  v_min3_u32 v6, v6, v142, v144
  v_min3_u32 v6, v6, v146, v148
  v_min3_u32 v6, v6, v150, v152
  v_min3_u32 v6, v6, v154, v156
  v_min3_u32 v6, v6, v158, v160
  v_min3_u32 v6, v6, v162, v164
  v_min3_u32 v6, v6, v166, v168
  v_min3_u32 v6, v6, v170, v172
  v_min3_u32 v6, v6, v174, v176
  v_min3_u32 v6, v6, v178, v180
  v_min3_u32 v6, v6, v182, v184
  v_min3_u32 v6, v6, v186, v188
  v_min3_u32 v6, v6, v190, v192
  v_min3_u32 v6, v6, v194, v196
  v_min_u32 v6, v6, v198
  v_cmp_eq_u32 vcc, 0, v6
  s_cbranch_vccz .g2_kernel_gx50d
  s_mov_b64 exec, vcc
  s_sleep 2
  s_cmp_lt_u32 s38, 131072
  s_cbranch_scc1 .g2_kernel_gx50
.g2_kernel_gx50d:
  s_mov_b64 exec, -1
  v_add_f32 v64, v64, v128
  v_add_f32 v65, v65, v129
  v_add_f32 v66, v66, v130
  v_add_f32 v67, v67, v131
  v_add_f32 v68, v68, v132
  v_add_f32 v69, v69, v133
  v_add_f32 v70, v70, v134
  v_add_f32 v71, v71, v135
  v_add_f32 v72, v72, v136
  v_add_f32 v73, v73, v137
  v_add_f32 v74, v74, v138
  v_add_f32 v75, v75, v139
  v_add_f32 v76, v76, v140
  v_add_f32 v77, v77, v141
  v_add_f32 v78, v78, v142
  v_add_f32 v79, v79, v143
  v_add_f32 v80, v80, v144
  v_add_f32 v81, v81, v145
  v_add_f32 v82, v82, v146
  v_add_f32 v83, v83, v147
  v_add_f32 v84, v84, v148
  v_add_f32 v85, v85, v149
  v_add_f32 v86, v86, v150
  v_add_f32 v87, v87, v151
  v_add_f32 v88, v88, v152
  v_add_f32 v89, v89, v153
  v_add_f32 v90, v90, v154
  v_add_f32 v91, v91, v155
  v_add_f32 v92, v92, v156
  v_add_f32 v93, v93, v157
  v_add_f32 v94, v94, v158
  v_add_f32 v95, v95, v159
  v_add_f32 v96, v96, v160
  v_add_f32 v97, v97, v161
  v_add_f32 v98, v98, v162
  v_add_f32 v99, v99, v163
  v_add_f32 v100, v100, v164
  v_add_f32 v101, v101, v165
  v_add_f32 v102, v102, v166
  v_add_f32 v103, v103, v167
  v_add_f32 v104, v104, v168
  v_add_f32 v105, v105, v169
  v_add_f32 v106, v106, v170
  v_add_f32 v107, v107, v171
  v_add_f32 v108, v108, v172
  v_add_f32 v109, v109, v173
  v_add_f32 v110, v110, v174
  v_add_f32 v111, v111, v175
  v_add_f32 v112, v112, v176
  v_add_f32 v113, v113, v177
  v_add_f32 v114, v114, v178
  v_add_f32 v115, v115, v179
  v_add_f32 v116, v116, v180
  v_add_f32 v117, v117, v181
  v_add_f32 v118, v118, v182
  v_add_f32 v119, v119, v183
  v_add_f32 v120, v120, v184
  v_add_f32 v121, v121, v185
  v_add_f32 v122, v122, v186
  v_add_f32 v123, v123, v187
  v_add_f32 v124, v124, v188
  v_add_f32 v125, v125, v189
  v_add_f32 v126, v126, v190
  v_add_f32 v127, v127, v191
  v_add_f32 v64, v64, v96
  v_add_f32 v65, v65, v97
  v_add_f32 v66, v66, v98
  v_add_f32 v67, v67, v99
  v_add_f32 v68, v68, v100
  v_add_f32 v69, v69, v101
  v_add_f32 v70, v70, v102
  v_add_f32 v71, v71, v103
  v_add_f32 v72, v72, v104
  v_add_f32 v73, v73, v105
  v_add_f32 v74, v74, v106
  v_add_f32 v75, v75, v107
  v_add_f32 v76, v76, v108
  v_add_f32 v77, v77, v109
  v_add_f32 v78, v78, v110
  v_add_f32 v79, v79, v111
  v_add_f32 v80, v80, v112
  v_add_f32 v81, v81, v113
  v_add_f32 v82, v82, v114
  v_add_f32 v83, v83, v115
  v_add_f32 v84, v84, v116
  v_add_f32 v85, v85, v117
  v_add_f32 v86, v86, v118
  v_add_f32 v87, v87, v119
  v_add_f32 v88, v88, v120
  v_add_f32 v89, v89, v121
  v_add_f32 v90, v90, v122
  v_add_f32 v91, v91, v123
  v_add_f32 v92, v92, v124
  v_add_f32 v93, v93, v125
  v_add_f32 v94, v94, v126
  v_add_f32 v95, v95, v127
  v_add_f32 v64, v64, v80
  v_add_f32 v65, v65, v81
  v_add_f32 v66, v66, v82
  v_add_f32 v67, v67, v83
  v_add_f32 v68, v68, v84
  v_add_f32 v69, v69, v85
  v_add_f32 v70, v70, v86
  v_add_f32 v71, v71, v87
  v_add_f32 v72, v72, v88
  v_add_f32 v73, v73, v89
  v_add_f32 v74, v74, v90
  v_add_f32 v75, v75, v91
  v_add_f32 v76, v76, v92
  v_add_f32 v77, v77, v93
  v_add_f32 v78, v78, v94
  v_add_f32 v79, v79, v95
  v_add_f32 v64, v64, v72
  v_add_f32 v65, v65, v73
  v_add_f32 v66, v66, v74
  v_add_f32 v67, v67, v75
  v_add_f32 v68, v68, v76
  v_add_f32 v69, v69, v77
  v_add_f32 v70, v70, v78
  v_add_f32 v71, v71, v79
  v_add_f32 v64, v64, v68
  v_add_f32 v65, v65, v69
  v_add_f32 v66, v66, v70
  v_add_f32 v67, v67, v71
  v_mov_b32 v28, 0.0009765625
  v_mov_b32 v30, 1e-05
  v_readlane_b32 s21, v64, 56
  v_readlane_b32 s22, v66, 56
  s_nop 0
  v_mul_f32 v20, s21, v28
  v_fma_f32 v21, s22, v28, v30
  v_fma_f32 v21, -v20, v20, v21
  v_rsq_f32 v21, abs(v21)
  v_sub_f32 v20, v61, v20
  v_mul_f32 v22, v21, v60
  v_mul_f32 v23, v21, v20
  v_and_b32 v10, 15, v2
  v_lshrrev_b32 v11, 4, v2
  v_lshlrev_b32 v16, 2, v10
  v_lshl_add_u32 v16, v11, 8, v16
  v_add_u32 v16, 155648, v16
  s_sub_u32 s20, s79, 1
  s_and_b32 s21, s20, 3
  s_lshl_b32 s21, s21, 2
  s_add_u32 s21, s21, 156160
  v_lshl_add_u32 v17, v10, 4, s21
  v_cmp_eq_u32 vcc, 2, v11
  v_mov_b32 v18, 64
  v_mov_b32 v19, 256
  v_cndmask_b32 v17, v16, v17, vcc
  v_cndmask_b32 v18, v18, v19, vcc
  v_lshrrev_b32 v24, 2, v10
  v_lshlrev_b32 v24, 9, v24
  v_and_b32 v25, 3, v10
  v_lshl_add_u32 v24, v25, 1, v24
  s_and_b32 s21, s20, 31
  s_lshl_b32 s22, s21, 4
  s_lshr_b32 s23, s20, 5
  s_lshl_b32 s24, s23, 11
  s_add_u32 s22, s22, s24
  s_add_u32 s22, s22, 131072
  v_add_u32 v26, s22, v24
  s_and_b32 s22, s21, 7
  s_and_b32 s24, s21, 8
  s_lshl_b32 s24, s24, 1
  s_add_u32 s22, s22, s24
  s_and_b32 s24, s21, 16
  s_lshr_b32 s24, s24, 1
  s_add_u32 s22, s22, s24
  s_lshl_b32 s22, s22, 4
  v_add_u32 v24, s22, v24
  s_bfe_u32 s22, s21, 0x20002
  s_lshl_b32 s22, s22, 9
  s_add_u32 s22, s22, s24
  s_and_b32 s24, s21, 3
  s_lshl_b32 s24, s24, 1
  s_add_u32 s22, s22, s24
  s_add_u32 s22, s22, 2048
  v_lshl_add_u32 v25, v10, 4, s22
  v_cndmask_b32 v24, v24, v25, vcc
  v_cndmask_b32 v19, 8, v19, vcc
  v_add_u32 v25, v24, v19
  s_lshl_b32 s22, s18, 7
  s_lshl_b32 s24, s17, 2
  s_add_u32 s22, s22, s24
  s_add_u32 s22, s22, s23
  s_lshl_b32 s22, s22, 12
  s_add_u32 s22, s22, 0x1800000
  s_add_u32 s23, s22, 262144
  s_lshr_b32 s24, s20, 6
  s_lshl_b32 s24, s24, 8
  s_add_u32 s24, s24, s76
  v_cmp_eq_u32 vcc, 0, v11
  v_mov_b32 v27, 0.25503486164919736
  s_nop 0
  v_cndmask_b32 v27, 1.0, v27, vcc
  v_mul_f32 v21, v21, v27
  v_mul_f32 v22, v22, v27
  v_mul_f32 v23, v23, v27
  s_mov_b32 s62, 1
  s_mov_b32 s63, 0x1800000
  s_mov_b32 s70, 2
  s_mov_b32 s71, 155776
  v_mov_b32 v6, s71
  s_mov_b32 s38, 0
.g2_kernel_wg51:
  ds_read_b32 v7, v6 offset:56
  s_add_u32 s38, s38, 1
  s_waitcnt lgkmcnt(0)
  v_cmp_le_u32 vcc, 2, v7
  s_cbranch_vccnz .g2_kernel_wg51d
  s_sleep 1
  s_cmp_lt_u32 s38, 524288
  s_cbranch_scc1 .g2_kernel_wg51
.g2_kernel_wg51d:
  ds_read_b32 v32, v17 offset:5632
  ds_read_b32 v36, v16 offset:4864
  v_add_u32 v17, v17, v18
  ds_read_b32 v33, v17 offset:5632
  ds_read_b32 v37, v16 offset:4928
  v_add_u32 v17, v17, v18
  ds_read_b32 v34, v17 offset:5632
  ds_read_b32 v38, v16 offset:4992
  v_add_u32 v17, v17, v18
  ds_read_b32 v35, v17 offset:5632
  ds_read_b32 v39, v16 offset:5056
  s_waitcnt lgkmcnt(0)
  v_mul_f32 v32, v32, v22
  v_fmac_f32 v32, v64, v21
  v_fmac_f32 v32, v36, v23
  v_mul_f32 v33, v33, v22
  v_fmac_f32 v33, v65, v21
  v_fmac_f32 v33, v37, v23
  v_mul_f32 v34, v34, v22
  v_fmac_f32 v34, v66, v21
  v_fmac_f32 v34, v38, v23
  v_mul_f32 v35, v35, v22
  v_fmac_f32 v35, v67, v21
  v_fmac_f32 v35, v39, v23
  v_cvt_pk_bf16_f32 v32, v32, v33
  v_cvt_pk_bf16_f32 v34, v34, v35
  v_mov_b32 v9, s71
  v_mov_b32 v8, 2
  s_mov_b32 exec_lo, 0xffff0000
  s_mov_b32 exec_hi, 0xffff
  buffer_store_short v32, v24, s[4:7], s22 offen sc1
  buffer_store_short_d16_hi v32, v25, s[4:7], s22 offen sc1
  buffer_store_short v34, v24, s[4:7], s23 offen sc1
  buffer_store_short_d16_hi v34, v25, s[4:7], s23 offen sc1
  s_mov_b64 exec, 0xffff
  ds_write_b16 v26, v32 offset:8192
  ds_write_b16_d16_hi v26, v32 offset:8200
  ds_write_b16 v26, v34
  ds_write_b16_d16_hi v26, v34 offset:8
  ds_write_b32 v9, v5 offset:60
  s_mov_b32 exec_lo, 0
  s_mov_b32 exec_hi, 0xff0000
  ds_write_b32 v16, v192 offset:6912
  ds_write_b32 v16, v193 offset:6976
  ds_write_b32 v16, v194 offset:7040
  ds_write_b32 v16, v195 offset:7104
  ds_write_b32 v16, v196 offset:6944
  ds_write_b32 v16, v197 offset:7008
  ds_write_b32 v16, v198 offset:7072
  ds_write_b32 v16, v199 offset:7136
  s_mov_b64 exec, 1
  s_waitcnt vmcnt(0)
  buffer_store_dword v8, v4, s[4:7], s24 offen sc1
  buffer_store_dword v8, v4, s[4:7], s24 offen offset:128 sc1
  s_mov_b64 exec, -1
  s_branch .g2_kernel_v
.g2_kernel_c_no:
  s_mov_b32 s62, 1
  s_mov_b32 s63, 0x1800000
  s_mov_b32 s70, 2
  s_mov_b32 s71, 155776
  s_branch .g2_kernel_v
.g2_kernel_c_t3:
  s_mov_b32 s28, s56
  s_mov_b32 s29, s57
  s_mov_b32 s30, 0x400000
  s_mov_b32 s31, 0x00020000
  v_add_f32 v56, v56, v28
  v_add_f32 v57, v57, v29
  v_add_f32 v58, v58, v30
  v_add_f32 v59, v59, v31
  v_cvt_pk_bf16_f32 v56, v56, v57
  v_cvt_pk_bf16_f32 v58, v58, v59
  s_lshl_b32 s21, s77, 11
  s_lshl_b32 s22, s17, 7
  s_add_u32 s21, s21, s22
  s_lshl_b32 s22, s18, 4
  s_add_u32 s21, s21, s22
  s_mov_b32 exec_lo, 0x01010101
  s_mov_b32 exec_hi, 0x01010101
  buffer_store_short v56, v13, s[28:31], s21 offen
  buffer_store_short_d16_hi v56, v13, s[28:31], s21 offen offset:32
  buffer_store_short v58, v13, s[28:31], s21 offen offset:64
  buffer_store_short_d16_hi v58, v13, s[28:31], s21 offen offset:96
  s_mov_b64 exec, -1
  s_branch .g2_kernel_fin
.g2_kernel_c2:
  s_cmp_lg_u32 s62, 0
  s_cbranch_scc1 .g2_kernel_d_a
  s_cmp_lg_u32 s16, 7
  s_cbranch_scc1 .g2_kernel_d_a
  v_mov_b32 v6, s71
  s_mov_b32 s38, 0
.g2_kernel_wg53:
  ds_read_b32 v7, v6 offset:20
  s_add_u32 s38, s38, 1
  s_waitcnt lgkmcnt(0)
  v_cmp_le_u32 vcc, 4, v7
  s_cbranch_vccnz .g2_kernel_wg53d
  s_sleep 2
  s_cmp_lt_u32 s38, 524288
  s_cbranch_scc1 .g2_kernel_wg53
.g2_kernel_wg53d:
  s_sleep 20
  s_and_b32 s31, s19, 0xffffe000
  s_add_u32 s31, s31, 8
  v_and_b32 v6, 15, v2
  v_lshlrev_b32 v6, 9, v6
  v_lshrrev_b32 v7, 4, v2
  v_lshl_add_u32 v6, v7, 7, v6
  v_lshlrev_b32 v7, 2, v2
  v_add_u32 v7, 158208, v7
  s_mov_b32 m0, 158208
  s_mov_b32 s38, 0
.g2_kernel_pa54:
  buffer_load_dword v6, s[4:7], s31 offen sc1 lds
  s_add_u32 s38, s38, 1
  s_waitcnt vmcnt(0)
  ds_read_b32 v8, v7
  s_waitcnt lgkmcnt(0)
  v_cmp_ge_u32 vcc, s62, v8
  s_cbranch_vccz .g2_kernel_pa54d
  s_mov_b64 exec, vcc
  s_sleep 10
  s_cmp_lt_u32 s38, 131072
  s_cbranch_scc1 .g2_kernel_pa54
.g2_kernel_pa54d:
  s_mov_b64 exec, -1
.g2_kernel_d_a:
  s_setprio 2
  s_and_b32 s20, s16, 1
  v_bfe_u32 v8, v2, 1, 3
  v_lshlrev_b32 v8, 14, v8
  v_and_b32 v9, 1, v2
  v_lshl_add_u32 v8, v9, 10, v8
  v_lshrrev_b32 v9, 4, v2
  v_lshl_add_u32 v8, v9, 8, v8
  v_and_b32 v9, 15, v2
  v_lshlrev_b32 v9, 3, v9
  s_lshl_b32 s28, s20, 7
  s_add_u32 s28, s28, 162816
  v_add_u32 v10, s28, v9
  v_xor_b32 v11, 128, v10
  s_lshl_b32 s28, s20, 2
  s_add_u32 s28, s28, s71
  v_mov_b32 v12, s28
  v_xor_b32 v13, 4, v12
  s_lshl_b32 s26, s17, 4
  s_add_u32 s26, s26, s18
  s_lshl_b32 s26, s26, 1
  s_add_u32 s26, s26, s20
  s_lshl_b32 s26, s26, 11
  s_add_u32 s26, s26, s63
  s_add_u32 s26, s26, 0x1090000
  v_mov_b32 v6, s71
  s_mov_b32 s38, 0
.g2_kernel_wg55:
  ds_read_b32 v7, v6 offset:36
  s_add_u32 s38, s38, 1
  s_waitcnt lgkmcnt(0)
  v_cmp_le_u32 vcc, 1, v7
  s_cbranch_vccnz .g2_kernel_wg55d
  s_sleep 4
  s_cmp_lt_u32 s38, 524288
  s_cbranch_scc1 .g2_kernel_wg55
.g2_kernel_wg55d:
  s_cmp_ge_u32 s17, 14
  s_cbranch_scc1 .g2_kernel_d_none
  v_readfirstlane_b32 s77, v7
  s_sub_u32 s77, s77, 1
  s_and_b32 s77, s77, 2047
  s_lshr_b32 s24, s77, 7
  s_lshl_b32 s24, s24, 18
  s_bfe_u32 s28, s77, 0x30004
  s_lshl_b32 s28, s28, 11
  s_add_u32 s24, s24, s28
  s_and_b32 s28, s77, 15
  s_lshl_b32 s28, s28, 4
  s_add_u32 s24, s24, s28
  s_add_u32 s24, s24, s63
  s_add_u32 s24, s24, 0xc00000
  s_lshl_b32 s28, s20, 17
  s_add_u32 s24, s24, s28
  buffer_load_dwordx4 v[16:19], v8, s[4:7], s24 offen
  s_lshl_b32 s25, s77, 3
  s_add_u32 s25, s25, s63
  s_add_u32 s25, s25, 0x1080000
  s_mov_b32 s38, 0
.g2_kernel_gx56:
  buffer_load_dwordx2 v[20:21], v4, s[4:7], s25 offen sc1
  s_add_u32 s38, s38, 1
  s_waitcnt vmcnt(0)
  v_min_u32 v6, v21, v21
  v_cmp_eq_u32 vcc, 0, v6
  s_cbranch_vccz .g2_kernel_gx56d
  s_mov_b64 exec, vcc
  s_sleep 1
  s_cmp_lt_u32 s38, 131072
  s_cbranch_scc1 .g2_kernel_gx56
.g2_kernel_gx56d:
  s_mov_b64 exec, -1
  v_rsq_f32 v21, v21
  v_lshlrev_b32 v24, 16, v16
  v_and_b32 v25, 0xffff0000, v16
  v_lshlrev_b32 v26, 16, v17
  v_and_b32 v27, 0xffff0000, v17
  v_lshlrev_b32 v28, 16, v18
  v_and_b32 v29, 0xffff0000, v18
  v_lshlrev_b32 v30, 16, v19
  v_and_b32 v31, 0xffff0000, v19
  v_mul_f32 v20, v20, v21
  v_fma_f32 v24, v24, v21, -v20
  v_fma_f32 v25, v25, v21, -v20
  v_fma_f32 v26, v26, v21, -v20
  v_fma_f32 v27, v27, v21, -v20
  v_fma_f32 v28, v28, v21, -v20
  v_fma_f32 v29, v29, v21, -v20
  v_fma_f32 v30, v30, v21, -v20
  v_fma_f32 v31, v31, v21, -v20
  v_cvt_pk_bf16_f32 v16, v24, v25
  v_cvt_pk_bf16_f32 v17, v26, v27
  v_cvt_pk_bf16_f32 v18, v28, v29
  v_cvt_pk_bf16_f32 v19, v30, v31
  v_mov_b32 v24, v16 row_newbcast:0 row_mask:0xf bank_mask:0xf
  v_mov_b32 v25, v17 row_newbcast:0 row_mask:0xf bank_mask:0xf
  v_mov_b32 v26, v18 row_newbcast:0 row_mask:0xf bank_mask:0xf
  v_mov_b32 v27, v19 row_newbcast:0 row_mask:0xf bank_mask:0xf
  v_mov_b32 v28, v16 row_newbcast:1 row_mask:0xf bank_mask:0xf
  v_mov_b32 v29, v17 row_newbcast:1 row_mask:0xf bank_mask:0xf
  v_mov_b32 v30, v18 row_newbcast:1 row_mask:0xf bank_mask:0xf
  v_mov_b32 v31, v19 row_newbcast:1 row_mask:0xf bank_mask:0xf
  v_mfma_f32_16x16x32_bf16 v[32:35], v[24:27], v[64:67], 0
  v_mfma_f32_16x16x32_bf16 v[36:39], v[24:27], v[128:131], 0
  v_mov_b32 v24, v16 row_newbcast:2 row_mask:0xf bank_mask:0xf
  v_mov_b32 v25, v17 row_newbcast:2 row_mask:0xf bank_mask:0xf
  v_mov_b32 v26, v18 row_newbcast:2 row_mask:0xf bank_mask:0xf
  v_mov_b32 v27, v19 row_newbcast:2 row_mask:0xf bank_mask:0xf
  v_mfma_f32_16x16x32_bf16 v[32:35], v[28:31], v[68:71], v[32:35]
  v_mfma_f32_16x16x32_bf16 v[36:39], v[28:31], v[132:135], v[36:39]
  v_mov_b32 v28, v16 row_newbcast:3 row_mask:0xf bank_mask:0xf
  v_mov_b32 v29, v17 row_newbcast:3 row_mask:0xf bank_mask:0xf
  v_mov_b32 v30, v18 row_newbcast:3 row_mask:0xf bank_mask:0xf
  v_mov_b32 v31, v19 row_newbcast:3 row_mask:0xf bank_mask:0xf
  v_mfma_f32_16x16x32_bf16 v[32:35], v[24:27], v[72:75], v[32:35]
  v_mfma_f32_16x16x32_bf16 v[36:39], v[24:27], v[136:139], v[36:39]
  v_mov_b32 v24, v16 row_newbcast:4 row_mask:0xf bank_mask:0xf
  v_mov_b32 v25, v17 row_newbcast:4 row_mask:0xf bank_mask:0xf
  v_mov_b32 v26, v18 row_newbcast:4 row_mask:0xf bank_mask:0xf
  v_mov_b32 v27, v19 row_newbcast:4 row_mask:0xf bank_mask:0xf
  v_mfma_f32_16x16x32_bf16 v[32:35], v[28:31], v[76:79], v[32:35]
  v_mfma_f32_16x16x32_bf16 v[36:39], v[28:31], v[140:143], v[36:39]
  v_mov_b32 v28, v16 row_newbcast:5 row_mask:0xf bank_mask:0xf
  v_mov_b32 v29, v17 row_newbcast:5 row_mask:0xf bank_mask:0xf
  v_mov_b32 v30, v18 row_newbcast:5 row_mask:0xf bank_mask:0xf
  v_mov_b32 v31, v19 row_newbcast:5 row_mask:0xf bank_mask:0xf
  v_mfma_f32_16x16x32_bf16 v[32:35], v[24:27], v[80:83], v[32:35]
  v_mfma_f32_16x16x32_bf16 v[36:39], v[24:27], v[144:147], v[36:39]
  v_mov_b32 v24, v16 row_newbcast:6 row_mask:0xf bank_mask:0xf
  v_mov_b32 v25, v17 row_newbcast:6 row_mask:0xf bank_mask:0xf
  v_mov_b32 v26, v18 row_newbcast:6 row_mask:0xf bank_mask:0xf
  v_mov_b32 v27, v19 row_newbcast:6 row_mask:0xf bank_mask:0xf
  v_mfma_f32_16x16x32_bf16 v[32:35], v[28:31], v[84:87], v[32:35]
  v_mfma_f32_16x16x32_bf16 v[36:39], v[28:31], v[148:151], v[36:39]
  v_mov_b32 v28, v16 row_newbcast:7 row_mask:0xf bank_mask:0xf
  v_mov_b32 v29, v17 row_newbcast:7 row_mask:0xf bank_mask:0xf
  v_mov_b32 v30, v18 row_newbcast:7 row_mask:0xf bank_mask:0xf
  v_mov_b32 v31, v19 row_newbcast:7 row_mask:0xf bank_mask:0xf
  v_mfma_f32_16x16x32_bf16 v[32:35], v[24:27], v[88:91], v[32:35]
  v_mfma_f32_16x16x32_bf16 v[36:39], v[24:27], v[152:155], v[36:39]
  v_mov_b32 v24, v16 row_newbcast:8 row_mask:0xf bank_mask:0xf
  v_mov_b32 v25, v17 row_newbcast:8 row_mask:0xf bank_mask:0xf
  v_mov_b32 v26, v18 row_newbcast:8 row_mask:0xf bank_mask:0xf
  v_mov_b32 v27, v19 row_newbcast:8 row_mask:0xf bank_mask:0xf
  v_mfma_f32_16x16x32_bf16 v[32:35], v[28:31], v[92:95], v[32:35]
  v_mfma_f32_16x16x32_bf16 v[36:39], v[28:31], v[156:159], v[36:39]
  v_mov_b32 v28, v16 row_newbcast:9 row_mask:0xf bank_mask:0xf
  v_mov_b32 v29, v17 row_newbcast:9 row_mask:0xf bank_mask:0xf
  v_mov_b32 v30, v18 row_newbcast:9 row_mask:0xf bank_mask:0xf
  v_mov_b32 v31, v19 row_newbcast:9 row_mask:0xf bank_mask:0xf
  v_mfma_f32_16x16x32_bf16 v[32:35], v[24:27], v[96:99], v[32:35]
  v_mfma_f32_16x16x32_bf16 v[36:39], v[24:27], v[160:163], v[36:39]
  v_mov_b32 v24, v16 row_newbcast:10 row_mask:0xf bank_mask:0xf
  v_mov_b32 v25, v17 row_newbcast:10 row_mask:0xf bank_mask:0xf
  v_mov_b32 v26, v18 row_newbcast:10 row_mask:0xf bank_mask:0xf
  v_mov_b32 v27, v19 row_newbcast:10 row_mask:0xf bank_mask:0xf
  v_mfma_f32_16x16x32_bf16 v[32:35], v[28:31], v[100:103], v[32:35]
  v_mfma_f32_16x16x32_bf16 v[36:39], v[28:31], v[164:167], v[36:39]
  v_mov_b32 v28, v16 row_newbcast:11 row_mask:0xf bank_mask:0xf
  v_mov_b32 v29, v17 row_newbcast:11 row_mask:0xf bank_mask:0xf
  v_mov_b32 v30, v18 row_newbcast:11 row_mask:0xf bank_mask:0xf
  v_mov_b32 v31, v19 row_newbcast:11 row_mask:0xf bank_mask:0xf
  v_mfma_f32_16x16x32_bf16 v[32:35], v[24:27], v[104:107], v[32:35]
  v_mfma_f32_16x16x32_bf16 v[36:39], v[24:27], v[168:171], v[36:39]
  v_mov_b32 v24, v16 row_newbcast:12 row_mask:0xf bank_mask:0xf
  v_mov_b32 v25, v17 row_newbcast:12 row_mask:0xf bank_mask:0xf
  v_mov_b32 v26, v18 row_newbcast:12 row_mask:0xf bank_mask:0xf
  v_mov_b32 v27, v19 row_newbcast:12 row_mask:0xf bank_mask:0xf
  v_mfma_f32_16x16x32_bf16 v[32:35], v[28:31], v[108:111], v[32:35]
  v_mfma_f32_16x16x32_bf16 v[36:39], v[28:31], v[172:175], v[36:39]
  v_mov_b32 v28, v16 row_newbcast:13 row_mask:0xf bank_mask:0xf
  v_mov_b32 v29, v17 row_newbcast:13 row_mask:0xf bank_mask:0xf
  v_mov_b32 v30, v18 row_newbcast:13 row_mask:0xf bank_mask:0xf
  v_mov_b32 v31, v19 row_newbcast:13 row_mask:0xf bank_mask:0xf
  v_mfma_f32_16x16x32_bf16 v[32:35], v[24:27], v[112:115], v[32:35]
  v_mfma_f32_16x16x32_bf16 v[36:39], v[24:27], v[176:179], v[36:39]
  v_mov_b32 v24, v16 row_newbcast:14 row_mask:0xf bank_mask:0xf
  v_mov_b32 v25, v17 row_newbcast:14 row_mask:0xf bank_mask:0xf
  v_mov_b32 v26, v18 row_newbcast:14 row_mask:0xf bank_mask:0xf
  v_mov_b32 v27, v19 row_newbcast:14 row_mask:0xf bank_mask:0xf
  v_mfma_f32_16x16x32_bf16 v[32:35], v[28:31], v[116:119], v[32:35]
  v_mfma_f32_16x16x32_bf16 v[36:39], v[28:31], v[180:183], v[36:39]
  v_mov_b32 v28, v16 row_newbcast:15 row_mask:0xf bank_mask:0xf
  v_mov_b32 v29, v17 row_newbcast:15 row_mask:0xf bank_mask:0xf
  v_mov_b32 v30, v18 row_newbcast:15 row_mask:0xf bank_mask:0xf
  v_mov_b32 v31, v19 row_newbcast:15 row_mask:0xf bank_mask:0xf
  v_mfma_f32_16x16x32_bf16 v[32:35], v[24:27], v[120:123], v[32:35]
  v_mfma_f32_16x16x32_bf16 v[36:39], v[24:27], v[184:187], v[36:39]
  v_mfma_f32_16x16x32_bf16 v[32:35], v[28:31], v[124:127], v[32:35]
  v_mfma_f32_16x16x32_bf16 v[36:39], v[28:31], v[188:191], v[36:39]
  s_mov_b32 s38, 0
  s_mov_b32 s28, 0x00010001
  s_mov_b32 s29, 0x00100010
  s_nop 4
  v_mov_b32 v35, v36
  ds_write_b64 v10, v[34:35]
  ds_write_b32 v12, v5 offset:40
.g2_kernel_d_x:
  ds_read_b32 v6, v13 offset:40
  ds_read_b64 v[16:17], v11
  s_add_u32 s38, s38, 1
  s_waitcnt lgkmcnt(0)
  v_cmp_ne_u32 vcc, 0, v6
  s_cbranch_vccnz .g2_kernel_d_xd
  s_cmp_lt_u32 s38, 524288
  s_cbranch_scc1 .g2_kernel_d_x
.g2_kernel_d_xd:
  v_add_f32 v16, v16, v32
  v_add_f32 v17, v17, v36
  v_mul_f32 v18, -1.4426950408889634, v16
  v_exp_f32 v18, v18
  v_mul_f32 v16, v16, v17
  v_add_f32 v18, 1.0, v18
  v_rcp_f32 v18, v18
  s_nop 0
  v_mul_f32 v16, v16, v18
  s_nop 1
  v_mov_b32 v17, v16 quad_perm:[1,0,3,2] row_mask:0xf bank_mask:0xf
  v_cvt_pk_bf16_f32 v16, v16, v17
  s_nop 1
  v_mov_b32 v20, v16 row_newbcast:0 row_mask:0x5 bank_mask:0xf
  v_mov_b32 v21, v16 row_newbcast:2 row_mask:0x5 bank_mask:0xf
  v_mov_b32 v22, v16 row_newbcast:4 row_mask:0x5 bank_mask:0xf
  v_mov_b32 v23, v16 row_newbcast:6 row_mask:0x5 bank_mask:0xf
  v_mov_b32 v20, v16 row_newbcast:8 row_mask:0xa bank_mask:0xf
  v_mov_b32 v21, v16 row_newbcast:10 row_mask:0xa bank_mask:0xf
  v_mov_b32 v22, v16 row_newbcast:12 row_mask:0xa bank_mask:0xf
  v_mov_b32 v23, v16 row_newbcast:14 row_mask:0xa bank_mask:0xf
  v_cndmask_b32 v24, 0, v20, s[28:29]
  v_cndmask_b32 v25, 0, v21, s[28:29]
  v_cndmask_b32 v26, 0, v22, s[28:29]
  v_cndmask_b32 v27, 0, v23, s[28:29]
  s_lshl_b64 s[28:29], s[28:29], 1
  s_nop 0
  v_mfma_f32_16x16x32_bf16 v[40:43], v[24:27], v[192:195], 0
  v_mfma_f32_16x16x32_bf16 v[44:47], v[24:27], v[208:211], 0
  v_mfma_f32_16x16x32_bf16 v[48:51], v[24:27], v[224:227], 0
  v_mfma_f32_16x16x32_bf16 v[52:55], v[24:27], v[240:243], 0
  v_cndmask_b32 v28, 0, v20, s[28:29]
  v_cndmask_b32 v29, 0, v21, s[28:29]
  v_cndmask_b32 v30, 0, v22, s[28:29]
  v_cndmask_b32 v31, 0, v23, s[28:29]
  s_lshl_b64 s[28:29], s[28:29], 1
  s_nop 0
  v_mfma_f32_16x16x32_bf16 v[40:43], v[28:31], v[196:199], v[40:43]
  v_mfma_f32_16x16x32_bf16 v[44:47], v[28:31], v[212:215], v[44:47]
  v_mfma_f32_16x16x32_bf16 v[48:51], v[28:31], v[228:231], v[48:51]
  v_mfma_f32_16x16x32_bf16 v[52:55], v[28:31], v[244:247], v[52:55]
  v_cndmask_b32 v32, 0, v20, s[28:29]
  v_cndmask_b32 v33, 0, v21, s[28:29]
  v_cndmask_b32 v34, 0, v22, s[28:29]
  v_cndmask_b32 v35, 0, v23, s[28:29]
  s_lshl_b64 s[28:29], s[28:29], 1
  s_nop 0
  v_mfma_f32_16x16x32_bf16 v[40:43], v[32:35], v[200:203], v[40:43]
  v_mfma_f32_16x16x32_bf16 v[44:47], v[32:35], v[216:219], v[44:47]
  v_mfma_f32_16x16x32_bf16 v[48:51], v[32:35], v[232:235], v[48:51]
  v_mfma_f32_16x16x32_bf16 v[52:55], v[32:35], v[248:251], v[52:55]
  v_cndmask_b32 v36, 0, v20, s[28:29]
  v_cndmask_b32 v37, 0, v21, s[28:29]
  v_cndmask_b32 v38, 0, v22, s[28:29]
  v_cndmask_b32 v39, 0, v23, s[28:29]
  s_lshl_b64 s[28:29], s[28:29], 1
  s_nop 0
  v_mfma_f32_16x16x32_bf16 v[40:43], v[36:39], v[204:207], v[40:43]
  v_mfma_f32_16x16x32_bf16 v[44:47], v[36:39], v[220:223], v[44:47]
  v_mfma_f32_16x16x32_bf16 v[48:51], v[36:39], v[236:239], v[48:51]
  v_mfma_f32_16x16x32_bf16 v[52:55], v[36:39], v[252:255], v[52:55]
  s_mov_b32 exec_hi, 0
  s_nop 3
  v_or_b32 v40, 1, v40
  v_or_b32 v42, 1, v42
  buffer_store_dwordx4 v[40:43], v3, s[4:7], s26 offen offset:0 sc1
  v_or_b32 v44, 1, v44
  v_or_b32 v46, 1, v46
  buffer_store_dwordx4 v[44:47], v3, s[4:7], s26 offen offset:512 sc1
  v_or_b32 v48, 1, v48
  v_or_b32 v50, 1, v50
  buffer_store_dwordx4 v[48:51], v3, s[4:7], s26 offen offset:1024 sc1
  v_or_b32 v52, 1, v52
  v_or_b32 v54, 1, v54
  buffer_store_dwordx4 v[52:55], v3, s[4:7], s26 offen offset:1536 sc1
  s_mov_b64 exec, -1
  s_branch .g2_kernel_d_e
.g2_kernel_d_none:
  s_sleep 40
.g2_kernel_d_e:
  v_mov_b32 v6, s71
  s_mov_b64 exec, 1
  ds_add_u32 v6, v5 offset:48
  s_mov_b64 exec, -1
  s_cmp_lg_u32 s62, 0
  s_cbranch_scc1 .g2_kernel_fin
  s_mov_b32 s62, 1
  s_mov_b32 s63, 0x1800000
  s_mov_b32 s70, 2
  s_mov_b32 s71, 155776
  s_branch .g2_kernel_v
.g2_kernel_fin1:
.g2_kernel_fin:
.g2_kernel_end:
  s_endpgm
.g2_kernel_q_i2:
  v_mov_b32 v6, 155648
  s_mov_b32 s38, 0
.g2_kernel_wg1:
  ds_read_b32 v7, v6 offset:20
  s_add_u32 s38, s38, 1
  s_waitcnt lgkmcnt(0)
  v_cmp_le_u32 vcc, 4, v7
  s_cbranch_vccnz .g2_kernel_wg1d
  s_cmp_lt_u32 s38, 524288
  s_cbranch_scc1 .g2_kernel_wg1
.g2_kernel_wg1d:
  s_branch .g2_kernel_q_i3
.g2_kernel_q_spin:
  s_mov_b32 s38, 0
.g2_kernel_q_spinl:
  ds_read_b32 v151, v150
  s_add_u32 s38, s38, 1
  s_waitcnt lgkmcnt(0)
  v_cmp_lt_i32 vcc, s33, v151
  s_cbranch_vccnz .g2_kernel_q_spinr
  s_cmp_lt_u32 s38, 524288
  s_cbranch_scc1 .g2_kernel_q_spinl
.g2_kernel_q_spinr:
  s_setpc_b64 s[68:69]
.g2_kernel_q_wf:
  s_call_b64 s[68:69], .g2_kernel_q_spin
  s_branch .g2_kernel_q_backf
.g2_kernel_q_w7:
  s_call_b64 s[68:69], .g2_kernel_q_spin
  s_branch .g2_kernel_q_back7
.g2_kernel_q_w0:
  s_call_b64 s[68:69], .g2_kernel_q_spin
  s_branch .g2_kernel_q_back0
.g2_kernel_q_w1:
  s_call_b64 s[68:69], .g2_kernel_q_spin
  s_branch .g2_kernel_q_back1
.g2_kernel_q_w2:
  s_call_b64 s[68:69], .g2_kernel_q_spin
  s_branch .g2_kernel_q_back2
.g2_kernel_q_w3:
  s_call_b64 s[68:69], .g2_kernel_q_spin
  s_branch .g2_kernel_q_back3
.g2_kernel_q_w4:
  s_call_b64 s[68:69], .g2_kernel_q_spin
  s_branch .g2_kernel_q_back4
.g2_kernel_q_w5:
  s_call_b64 s[68:69], .g2_kernel_q_spin
  s_branch .g2_kernel_q_back5
.g2_kernel_q_w6:
  s_call_b64 s[68:69], .g2_kernel_q_spin
  s_branch .g2_kernel_q_back6
.g2_kernel_q_cons2:
  s_lshr_b32 s26, s16, 1
  s_lshl_b32 s26, s26, 13
  v_add_u32 v144, s26, v3
  v_add_u32 v145, 1024, v144
  s_branch .g2_kernel_q_cs
.g2_kernel_q_ew:
  s_mov_b32 s38, 0
.g2_kernel_q_ewl:
  ds_read_b32 v62, v13 offset:0
  ds_read_b32 v63, v58
  s_add_u32 s38, s38, 1
  s_waitcnt lgkmcnt(0)
  v_cmp_gt_u32 vcc, 2, v62
  v_cmp_gt_u32 s[14:15], s12, v63
  s_or_b64 vcc, vcc, s[14:15]
  s_cbranch_scc0 .g2_kernel_q_ec
  s_cmp_lt_u32 s38, 524288
  s_cbranch_scc1 .g2_kernel_q_ewl
.g2_kernel_q_ec:
  ds_read_b32 v57, v13 offset:24
  ds_read_b128 v[40:43], v52 offset:5120
  ds_read_b128 v[44:47], v52 offset:5184
  ds_read_b32 v24, v50 offset:2816
  ds_read_b32 v25, v50 offset:3328
  ds_read_b32 v26, v50 offset:2880
  ds_read_b32 v27, v50 offset:3392
  ds_read_b32 v28, v50 offset:2944
  ds_read_b32 v29, v50 offset:3456
  ds_read_b32 v30, v50 offset:3008
  ds_read_b32 v31, v50 offset:3520
  ds_read_b128 v[64:67], v51 offset:2816
  ds_read_b128 v[80:83], v51 offset:3328
  ds_read_b128 v[68:71], v51 offset:2880
  ds_read_b128 v[84:87], v51 offset:3392
  ds_read_b128 v[72:75], v51 offset:2944
  ds_read_b128 v[88:91], v51 offset:3456
  ds_read_b128 v[76:79], v51 offset:3008
  ds_read_b128 v[92:95], v51 offset:3520
  ds_read_b32 v48, v53 offset:5376
  ds_read_b32 v49, v53 offset:5440
  ds_read_b128 v[32:35], v52 offset:4864
  ds_read_b128 v[36:39], v52 offset:4928
  s_waitcnt lgkmcnt(0)
  s_branch .g2_kernel_q_eb
.g2_kernel_q_patch:
  v_readfirstlane_b32 s35, v57
  s_sub_u32 s28, s35, 1
  s_lshr_b32 s29, s28, 6
  s_lshr_b32 s30, s16, 1
  s_add_u32 s35, s35, 0x100
  s_cmp_lg_u32 s29, s30
  s_cbranch_scc1 .g2_kernel_q_pback
  s_add_u32 s35, s35, 0x100
  s_and_b32 s29, s28, 15
  s_mov_b32 s14, 0x00010001
  s_mov_b32 s15, 0x00010001
  s_lshl_b64 s[14:15], s[14:15], s29
  s_and_b32 s29, s28, 12
  s_lshl_b32 s29, s29, 2
  s_lshl_b64 s[30:31], 0xffff, s29
  v_subrev_u32 v96, 155648, v53
  v_lshlrev_b32 v96, 2, v96
  v_add_u32 v96, 155648, v96
  s_bfe_u32 s29, s28, 0x20004
  s_cmp_lg_u32 s29, 0
  s_cbranch_scc1 .g2_kernel_q_pv1
  s_mov_b64 exec, s[14:15]
  ds_write_b128 v52, v[160:163] offset:5632
  ds_write_b128 v52, v[176:179] offset:5696
  ds_write_b128 v52, v[192:195] offset:5888
  ds_write_b128 v52, v[208:211] offset:5952
  s_mov_b64 exec, s[30:31]
  ds_write_b128 v96, v[224:227] offset:6144
  ds_write_b128 v96, v[240:243] offset:6400
  s_mov_b64 exec, -1
  s_waitcnt lgkmcnt(0)
  s_branch .g2_kernel_q_pback
.g2_kernel_q_pv1:
  s_cmp_lg_u32 s29, 1
  s_cbranch_scc1 .g2_kernel_q_pv2
  s_mov_b64 exec, s[14:15]
  ds_write_b128 v52, v[164:167] offset:5632
  ds_write_b128 v52, v[180:183] offset:5696
  ds_write_b128 v52, v[196:199] offset:5888
  ds_write_b128 v52, v[212:215] offset:5952
  s_mov_b64 exec, s[30:31]
  ds_write_b128 v96, v[228:231] offset:6144
  ds_write_b128 v96, v[244:247] offset:6400
  s_mov_b64 exec, -1
  s_waitcnt lgkmcnt(0)
  s_branch .g2_kernel_q_pback
.g2_kernel_q_pv2:
  s_cmp_lg_u32 s29, 2
  s_cbranch_scc1 .g2_kernel_q_pv3
  s_mov_b64 exec, s[14:15]
  ds_write_b128 v52, v[168:171] offset:5632
  ds_write_b128 v52, v[184:187] offset:5696
  ds_write_b128 v52, v[200:203] offset:5888
  ds_write_b128 v52, v[216:219] offset:5952
  s_mov_b64 exec, s[30:31]
  ds_write_b128 v96, v[232:235] offset:6144
  ds_write_b128 v96, v[248:251] offset:6400
  s_mov_b64 exec, -1
  s_waitcnt lgkmcnt(0)
  s_branch .g2_kernel_q_pback
.g2_kernel_q_pv3:
  s_mov_b64 exec, s[14:15]
  ds_write_b128 v52, v[172:175] offset:5632
  ds_write_b128 v52, v[188:191] offset:5696
  ds_write_b128 v52, v[204:207] offset:5888
  ds_write_b128 v52, v[220:223] offset:5952
  s_mov_b64 exec, s[30:31]
  ds_write_b128 v96, v[236:239] offset:6144
  ds_write_b128 v96, v[252:255] offset:6400
  s_mov_b64 exec, -1
  s_waitcnt lgkmcnt(0)
  s_branch .g2_kernel_q_pback
.g2_kernel_q_nk:
  v_pk_mul_f32 v[152:153], v[32:33], v[24:25] op_sel:[0,1] op_sel_hi:[1,1]
  v_pk_mul_f32 v[154:155], v[34:35], v[24:25] op_sel:[0,1] op_sel_hi:[1,1]
  v_pk_mul_f32 v[156:157], v[36:37], v[24:25] op_sel:[0,1] op_sel_hi:[1,1]
  v_pk_mul_f32 v[158:159], v[38:39], v[24:25] op_sel:[0,1] op_sel_hi:[1,1]
  v_pk_fma_f32 v[160:161], v[160:161], v[24:25], v[152:153] op_sel_hi:[1,0,1]
  v_pk_fma_f32 v[162:163], v[162:163], v[24:25], v[154:155] op_sel_hi:[1,0,1]
  v_pk_fma_f32 v[176:177], v[176:177], v[24:25], v[156:157] op_sel_hi:[1,0,1]
  v_pk_fma_f32 v[178:179], v[178:179], v[24:25], v[158:159] op_sel_hi:[1,0,1]
  v_cvt_pk_bf16_f32 v160, v160, v161
  v_cvt_pk_bf16_f32 v161, v162, v163
  v_cvt_pk_bf16_f32 v162, v176, v177
  v_cvt_pk_bf16_f32 v163, v178, v179
  ds_write_b128 v61, v[160:163] offset:0
  v_pk_mul_f32 v[152:153], v[32:33], v[26:27] op_sel:[0,1] op_sel_hi:[1,1]
  v_pk_mul_f32 v[154:155], v[34:35], v[26:27] op_sel:[0,1] op_sel_hi:[1,1]
  v_pk_mul_f32 v[156:157], v[36:37], v[26:27] op_sel:[0,1] op_sel_hi:[1,1]
  v_pk_mul_f32 v[158:159], v[38:39], v[26:27] op_sel:[0,1] op_sel_hi:[1,1]
  v_pk_fma_f32 v[164:165], v[164:165], v[26:27], v[152:153] op_sel_hi:[1,0,1]
  v_pk_fma_f32 v[166:167], v[166:167], v[26:27], v[154:155] op_sel_hi:[1,0,1]
  v_pk_fma_f32 v[180:181], v[180:181], v[26:27], v[156:157] op_sel_hi:[1,0,1]
  v_pk_fma_f32 v[182:183], v[182:183], v[26:27], v[158:159] op_sel_hi:[1,0,1]
  v_cvt_pk_bf16_f32 v164, v164, v165
  v_cvt_pk_bf16_f32 v165, v166, v167
  v_cvt_pk_bf16_f32 v166, v180, v181
  v_cvt_pk_bf16_f32 v167, v182, v183
  ds_write_b128 v61, v[164:167] offset:256
  v_pk_mul_f32 v[152:153], v[32:33], v[28:29] op_sel:[0,1] op_sel_hi:[1,1]
  v_pk_mul_f32 v[154:155], v[34:35], v[28:29] op_sel:[0,1] op_sel_hi:[1,1]
  v_pk_mul_f32 v[156:157], v[36:37], v[28:29] op_sel:[0,1] op_sel_hi:[1,1]
  v_pk_mul_f32 v[158:159], v[38:39], v[28:29] op_sel:[0,1] op_sel_hi:[1,1]
  v_pk_fma_f32 v[168:169], v[168:169], v[28:29], v[152:153] op_sel_hi:[1,0,1]
  v_pk_fma_f32 v[170:171], v[170:171], v[28:29], v[154:155] op_sel_hi:[1,0,1]
  v_pk_fma_f32 v[184:185], v[184:185], v[28:29], v[156:157] op_sel_hi:[1,0,1]
  v_pk_fma_f32 v[186:187], v[186:187], v[28:29], v[158:159] op_sel_hi:[1,0,1]
  v_cvt_pk_bf16_f32 v168, v168, v169
  v_cvt_pk_bf16_f32 v169, v170, v171
  v_cvt_pk_bf16_f32 v170, v184, v185
  v_cvt_pk_bf16_f32 v171, v186, v187
  ds_write_b128 v61, v[168:171] offset:2048
  v_pk_mul_f32 v[152:153], v[32:33], v[30:31] op_sel:[0,1] op_sel_hi:[1,1]
  v_pk_mul_f32 v[154:155], v[34:35], v[30:31] op_sel:[0,1] op_sel_hi:[1,1]
  v_pk_mul_f32 v[156:157], v[36:37], v[30:31] op_sel:[0,1] op_sel_hi:[1,1]
  v_pk_mul_f32 v[158:159], v[38:39], v[30:31] op_sel:[0,1] op_sel_hi:[1,1]
  v_pk_fma_f32 v[172:173], v[172:173], v[30:31], v[152:153] op_sel_hi:[1,0,1]
  v_pk_fma_f32 v[174:175], v[174:175], v[30:31], v[154:155] op_sel_hi:[1,0,1]
  v_pk_fma_f32 v[188:189], v[188:189], v[30:31], v[156:157] op_sel_hi:[1,0,1]
  v_pk_fma_f32 v[190:191], v[190:191], v[30:31], v[158:159] op_sel_hi:[1,0,1]
  v_cvt_pk_bf16_f32 v172, v172, v173
  v_cvt_pk_bf16_f32 v173, v174, v175
  v_cvt_pk_bf16_f32 v174, v188, v189
  v_cvt_pk_bf16_f32 v175, v190, v191
  ds_write_b128 v61, v[172:175] offset:2304
  s_branch .g2_kernel_q_kd
.g2_kernel_r2:
  buffer_load_dwordx4 v[240:243], v22, s[4:7], s13 offen offset:0
  buffer_load_dwordx4 v[244:247], v22, s[4:7], s13 offen offset:512
  buffer_load_dwordx4 v[248:251], v22, s[4:7], s13 offen offset:1024
  buffer_load_dwordx4 v[252:255], v22, s[4:7], s13 offen offset:1536
  s_branch .g2_kernel_r3
.g2_kernel_a_t1c:
  s_call_b64 s[68:69], .g2_kernel_a_pick
  s_branch .g2_kernel_a_t1b
.g2_kernel_a_t2c:
  s_call_b64 s[68:69], .g2_kernel_a_pick
  s_branch .g2_kernel_a_t2b
.g2_kernel_a_t3c:
  s_call_b64 s[68:69], .g2_kernel_a_pick
  s_branch .g2_kernel_a_t3b
.g2_kernel_a_three:
  s_andn2_b32 s33, s36, s34
  s_cbranch_scc0 .g2_kernel_a_t1c
.g2_kernel_a_t1b:
  s_ff1_i32_b32 s33, s33
  s_bitset1_b32 s34, s33
  s_xor_b32 s33, s33, s24
  s_lshl_b32 s33, s33, s25
  s_add_u32 s22, s20, s33
  s_addc_u32 s23, s21, 0
  global_load_dwordx4 v[192:195], v3, s[22:23] offset:0
  global_load_dwordx4 v[196:199], v3, s[22:23] offset:1024
  global_load_dwordx4 v[200:203], v3, s[22:23] offset:2048
  global_load_dwordx4 v[204:207], v3, s[22:23] offset:3072
  s_andn2_b32 s33, s36, s34
  s_cbranch_scc0 .g2_kernel_a_t2c
.g2_kernel_a_t2b:
  s_ff1_i32_b32 s33, s33
  s_bitset1_b32 s34, s33
  s_xor_b32 s33, s33, s24
  s_lshl_b32 s33, s33, s25
  s_add_u32 s22, s20, s33
  s_addc_u32 s23, s21, 0
  global_load_dwordx4 v[208:211], v3, s[22:23] offset:0
  global_load_dwordx4 v[212:215], v3, s[22:23] offset:1024
  global_load_dwordx4 v[216:219], v3, s[22:23] offset:2048
  global_load_dwordx4 v[220:223], v3, s[22:23] offset:3072
  s_andn2_b32 s33, s36, s34
  s_cbranch_scc0 .g2_kernel_a_t3c
.g2_kernel_a_t3b:
  s_ff1_i32_b32 s33, s33
  s_bitset1_b32 s34, s33
  s_xor_b32 s33, s33, s24
  s_lshl_b32 s33, s33, s25
  s_add_u32 s22, s20, s33
  s_addc_u32 s23, s21, 0
  global_load_dwordx4 v[224:227], v3, s[22:23] offset:0
  global_load_dwordx4 v[228:231], v3, s[22:23] offset:1024
  global_load_dwordx4 v[232:235], v3, s[22:23] offset:2048
  global_load_dwordx4 v[236:239], v3, s[22:23] offset:3072
  s_setpc_b64 s[72:73]
.g2_kernel_a_o0c:
  s_call_b64 s[68:69], .g2_kernel_a_pick
  s_branch .g2_kernel_a_o0b
.g2_kernel_a_o1c:
  s_call_b64 s[68:69], .g2_kernel_a_pick
  s_branch .g2_kernel_a_o1b
.g2_kernel_a_o2c:
  s_call_b64 s[68:69], .g2_kernel_a_pick
  s_branch .g2_kernel_a_o2b
.g2_kernel_a_o3c:
  s_call_b64 s[68:69], .g2_kernel_a_pick
  s_branch .g2_kernel_a_o3b
.g2_kernel_a_r0c:
  s_call_b64 s[68:69], .g2_kernel_a_pick
  s_branch .g2_kernel_a_r0b
.g2_kernel_a_r1c:
  s_call_b64 s[68:69], .g2_kernel_a_pick
  s_branch .g2_kernel_a_r1b
.g2_kernel_a_r2c:
  s_call_b64 s[68:69], .g2_kernel_a_pick
  s_branch .g2_kernel_a_r2b
.g2_kernel_a_own:
  s_waitcnt vmcnt(0) lgkmcnt(0)
  s_mov_b64 exec, 1
  s_cmp_ge_u32 s35, 0x200
  s_cbranch_scc1 .g2_kernel_a_ow1
  buffer_store_dword v15, v4, s[4:7], s37 offen sc1
  s_branch .g2_kernel_a_ow2
.g2_kernel_a_ow1:
  ds_add_u32 v13, v5 offset:56
.g2_kernel_a_ow2:
  s_mov_b64 exec, -1
  s_add_u32 s37, s37, 64
  s_mov_b32 s14, 0
  s_andn2_b32 s33, s36, s34
  s_cbranch_scc0 .g2_kernel_a_o0c
.g2_kernel_a_o0b:
  s_ff1_i32_b32 s33, s33
  s_bitset1_b32 s34, s33
  s_lshl_b32 s28, s33, 0
  s_or_b32 s14, s14, s28
  s_xor_b32 s33, s33, s24
  s_lshl_b32 s33, s33, s25
  s_add_u32 s22, s20, s33
  s_addc_u32 s23, s21, 0
  global_load_dwordx4 v[176:179], v3, s[22:23] offset:0
  global_load_dwordx4 v[180:183], v3, s[22:23] offset:1024
  global_load_dwordx4 v[184:187], v3, s[22:23] offset:2048
  global_load_dwordx4 v[188:191], v3, s[22:23] offset:3072
  s_andn2_b32 s33, s36, s34
  s_cbranch_scc0 .g2_kernel_a_o1c
.g2_kernel_a_o1b:
  s_ff1_i32_b32 s33, s33
  s_bitset1_b32 s34, s33
  s_lshl_b32 s28, s33, 8
  s_or_b32 s14, s14, s28
  s_xor_b32 s33, s33, s24
  s_lshl_b32 s33, s33, s25
  s_add_u32 s22, s20, s33
  s_addc_u32 s23, s21, 0
  global_load_dwordx4 v[192:195], v3, s[22:23] offset:0
  global_load_dwordx4 v[196:199], v3, s[22:23] offset:1024
  global_load_dwordx4 v[200:203], v3, s[22:23] offset:2048
  global_load_dwordx4 v[204:207], v3, s[22:23] offset:3072
  s_andn2_b32 s33, s36, s34
  s_cbranch_scc0 .g2_kernel_a_o2c
.g2_kernel_a_o2b:
  s_ff1_i32_b32 s33, s33
  s_bitset1_b32 s34, s33
  s_lshl_b32 s28, s33, 16
  s_or_b32 s14, s14, s28
  s_xor_b32 s33, s33, s24
  s_lshl_b32 s33, s33, s25
  s_add_u32 s22, s20, s33
  s_addc_u32 s23, s21, 0
  global_load_dwordx4 v[208:211], v3, s[22:23] offset:0
  global_load_dwordx4 v[212:215], v3, s[22:23] offset:1024
  global_load_dwordx4 v[216:219], v3, s[22:23] offset:2048
  global_load_dwordx4 v[220:223], v3, s[22:23] offset:3072
  s_andn2_b32 s33, s36, s34
  s_cbranch_scc0 .g2_kernel_a_o3c
.g2_kernel_a_o3b:
  s_ff1_i32_b32 s33, s33
  s_bitset1_b32 s34, s33
  s_lshl_b32 s28, s33, 24
  s_or_b32 s14, s14, s28
  s_xor_b32 s33, s33, s24
  s_lshl_b32 s33, s33, s25
  s_add_u32 s22, s20, s33
  s_addc_u32 s23, s21, 0
  global_load_dwordx4 v[224:227], v3, s[22:23] offset:0
  global_load_dwordx4 v[228:231], v3, s[22:23] offset:1024
  global_load_dwordx4 v[232:235], v3, s[22:23] offset:2048
  global_load_dwordx4 v[236:239], v3, s[22:23] offset:3072
  s_and_b32 s15, s34, -2
  s_mov_b32 s34, -1
  s_mov_b32 s26, -1
  s_waitcnt vmcnt(12)
  s_branch .g2_kernel_a_ob
.g2_kernel_a_redo:
  v_mfma_f32_32x32x16_bf16 v[104:119], v[236:239], v[172:175], v[104:119]
  v_smfmac_f32_16x16x64_bf16 v[132:135], v[16:19], v[168:175], v20
  v_mov_b32 v6, s71
  s_mov_b32 s38, 0
.g2_kernel_wg3:
  ds_read_b32 v7, v6 offset:60
  s_add_u32 s38, s38, 1
  s_waitcnt lgkmcnt(0)
  v_cmp_le_u32 vcc, 1, v7
  s_cbranch_vccnz .g2_kernel_wg3d
  s_sleep 1
  s_cmp_lt_u32 s38, 524288
  s_cbranch_scc1 .g2_kernel_wg3
.g2_kernel_wg3d:
  s_mov_b32 s34, s15
  s_mov_b32 s26, 0
  s_mov_b32 s36, 0
  s_sub_u32 s28, s35, 1
  s_bfe_u32 s28, s28, 0x20005
  s_mov_b32 s35, 0
  s_waitcnt vmcnt(0)
  s_cmp_lg_u32 s28, 0
  s_cbranch_scc1 .g2_kernel_a_rd1
  ds_read_b128 v[24:27], v14 offset:8192
  ds_read_b128 v[28:31], v14 offset:9216
  v_mov_b32 v120, 0
  v_mov_b32 v121, 0
  s_waitcnt lgkmcnt(0)
  v_mfma_f32_32x32x16_bf16 v[136:151], v[176:179], v[24:27], 0
  v_mfma_f32_32x32x16_bf16 v[136:151], v[180:183], v[28:31], v[136:151]
  v_mfma_f32_32x32x16_bf16 v[152:167], v[192:195], v[24:27], 0
  v_mfma_f32_32x32x16_bf16 v[152:167], v[196:199], v[28:31], v[152:167]
  s_nop 9
  v_exp_f32 v136, v136
  v_exp_f32 v137, v137
  v_exp_f32 v138, v138
  v_exp_f32 v139, v139
  v_exp_f32 v140, v140
  v_exp_f32 v141, v141
  v_exp_f32 v142, v142
  v_exp_f32 v143, v143
  v_exp_f32 v144, v144
  v_exp_f32 v145, v145
  v_exp_f32 v146, v146
  v_exp_f32 v147, v147
  v_exp_f32 v148, v148
  v_exp_f32 v149, v149
  v_exp_f32 v150, v150
  v_exp_f32 v151, v151
  v_cvt_pk_bf16_f32 v168, v136, v137
  v_cvt_pk_bf16_f32 v169, v138, v139
  v_cvt_pk_bf16_f32 v170, v140, v141
  v_cvt_pk_bf16_f32 v171, v142, v143
  v_cvt_pk_bf16_f32 v172, v144, v145
  v_cvt_pk_bf16_f32 v173, v146, v147
  v_cvt_pk_bf16_f32 v174, v148, v149
  v_cvt_pk_bf16_f32 v175, v150, v151
  v_mfma_f32_32x32x16_bf16 v[56:71], v[184:187], v[168:171], 0
  s_nop 0
  v_mfma_f32_32x32x16_bf16 v[56:71], v[188:191], v[172:175], v[56:71]
  v_smfmac_f32_16x16x64_bf16 v[120:123], v[16:19], v[168:175], v20
  s_call_b64 s[72:73], .g2_kernel_a_ld0
  v_mfma_f32_32x32x16_bf16 v[136:151], v[208:211], v[24:27], 0
  v_mfma_f32_32x32x16_bf16 v[136:151], v[212:215], v[28:31], v[136:151]
  v_exp_f32 v152, v152
  v_exp_f32 v153, v153
  v_exp_f32 v154, v154
  v_exp_f32 v155, v155
  v_exp_f32 v156, v156
  v_exp_f32 v157, v157
  v_exp_f32 v158, v158
  v_exp_f32 v159, v159
  v_exp_f32 v160, v160
  v_exp_f32 v161, v161
  v_exp_f32 v162, v162
  v_exp_f32 v163, v163
  v_exp_f32 v164, v164
  v_exp_f32 v165, v165
  v_exp_f32 v166, v166
  v_exp_f32 v167, v167
  v_cvt_pk_bf16_f32 v168, v152, v153
  v_cvt_pk_bf16_f32 v169, v154, v155
  v_cvt_pk_bf16_f32 v170, v156, v157
  v_cvt_pk_bf16_f32 v171, v158, v159
  v_cvt_pk_bf16_f32 v172, v160, v161
  v_cvt_pk_bf16_f32 v173, v162, v163
  v_cvt_pk_bf16_f32 v174, v164, v165
  v_cvt_pk_bf16_f32 v175, v166, v167
  v_mfma_f32_32x32x16_bf16 v[56:71], v[200:203], v[168:171], v[56:71]
  s_nop 0
  v_mfma_f32_32x32x16_bf16 v[56:71], v[204:207], v[172:175], v[56:71]
  v_smfmac_f32_16x16x64_bf16 v[120:123], v[16:19], v[168:175], v20
  s_call_b64 s[72:73], .g2_kernel_a_ld1
  v_mfma_f32_32x32x16_bf16 v[152:167], v[224:227], v[24:27], 0
  v_mfma_f32_32x32x16_bf16 v[152:167], v[228:231], v[28:31], v[152:167]
  v_exp_f32 v136, v136
  v_exp_f32 v137, v137
  v_exp_f32 v138, v138
  v_exp_f32 v139, v139
  v_exp_f32 v140, v140
  v_exp_f32 v141, v141
  v_exp_f32 v142, v142
  v_exp_f32 v143, v143
  v_exp_f32 v144, v144
  v_exp_f32 v145, v145
  v_exp_f32 v146, v146
  v_exp_f32 v147, v147
  v_exp_f32 v148, v148
  v_exp_f32 v149, v149
  v_exp_f32 v150, v150
  v_exp_f32 v151, v151
  v_cvt_pk_bf16_f32 v168, v136, v137
  v_cvt_pk_bf16_f32 v169, v138, v139
  v_cvt_pk_bf16_f32 v170, v140, v141
  v_cvt_pk_bf16_f32 v171, v142, v143
  v_cvt_pk_bf16_f32 v172, v144, v145
  v_cvt_pk_bf16_f32 v173, v146, v147
  v_cvt_pk_bf16_f32 v174, v148, v149
  v_cvt_pk_bf16_f32 v175, v150, v151
  v_mfma_f32_32x32x16_bf16 v[56:71], v[216:219], v[168:171], v[56:71]
  s_nop 0
  v_mfma_f32_32x32x16_bf16 v[56:71], v[220:223], v[172:175], v[56:71]
  v_smfmac_f32_16x16x64_bf16 v[120:123], v[16:19], v[168:175], v20
  s_call_b64 s[72:73], .g2_kernel_a_ld2
  v_exp_f32 v152, v152
  v_exp_f32 v153, v153
  v_exp_f32 v154, v154
  v_exp_f32 v155, v155
  v_exp_f32 v156, v156
  v_exp_f32 v157, v157
  v_exp_f32 v158, v158
  v_exp_f32 v159, v159
  v_exp_f32 v160, v160
  v_exp_f32 v161, v161
  v_exp_f32 v162, v162
  v_exp_f32 v163, v163
  v_exp_f32 v164, v164
  v_exp_f32 v165, v165
  v_exp_f32 v166, v166
  v_exp_f32 v167, v167
  v_cvt_pk_bf16_f32 v168, v152, v153
  v_cvt_pk_bf16_f32 v169, v154, v155
  v_cvt_pk_bf16_f32 v170, v156, v157
  v_cvt_pk_bf16_f32 v171, v158, v159
  v_cvt_pk_bf16_f32 v172, v160, v161
  v_cvt_pk_bf16_f32 v173, v162, v163
  v_cvt_pk_bf16_f32 v174, v164, v165
  v_cvt_pk_bf16_f32 v175, v166, v167
  v_mfma_f32_32x32x16_bf16 v[56:71], v[232:235], v[168:171], v[56:71]
  s_nop 0
  v_mfma_f32_32x32x16_bf16 v[56:71], v[236:239], v[172:175], v[56:71]
  v_smfmac_f32_16x16x64_bf16 v[120:123], v[16:19], v[168:175], v20
  s_branch .g2_kernel_a_rde
.g2_kernel_a_rd1:
  s_cmp_lg_u32 s28, 1
  s_cbranch_scc1 .g2_kernel_a_rd2
  ds_read_b128 v[32:35], v14 offset:10240
  ds_read_b128 v[36:39], v14 offset:11264
  v_mov_b32 v124, 0
  v_mov_b32 v125, 0
  s_waitcnt lgkmcnt(0)
  v_mfma_f32_32x32x16_bf16 v[136:151], v[176:179], v[32:35], 0
  v_mfma_f32_32x32x16_bf16 v[136:151], v[180:183], v[36:39], v[136:151]
  v_mfma_f32_32x32x16_bf16 v[152:167], v[192:195], v[32:35], 0
  v_mfma_f32_32x32x16_bf16 v[152:167], v[196:199], v[36:39], v[152:167]
  s_nop 9
  v_exp_f32 v136, v136
  v_exp_f32 v137, v137
  v_exp_f32 v138, v138
  v_exp_f32 v139, v139
  v_exp_f32 v140, v140
  v_exp_f32 v141, v141
  v_exp_f32 v142, v142
  v_exp_f32 v143, v143
  v_exp_f32 v144, v144
  v_exp_f32 v145, v145
  v_exp_f32 v146, v146
  v_exp_f32 v147, v147
  v_exp_f32 v148, v148
  v_exp_f32 v149, v149
  v_exp_f32 v150, v150
  v_exp_f32 v151, v151
  v_cvt_pk_bf16_f32 v168, v136, v137
  v_cvt_pk_bf16_f32 v169, v138, v139
  v_cvt_pk_bf16_f32 v170, v140, v141
  v_cvt_pk_bf16_f32 v171, v142, v143
  v_cvt_pk_bf16_f32 v172, v144, v145
  v_cvt_pk_bf16_f32 v173, v146, v147
  v_cvt_pk_bf16_f32 v174, v148, v149
  v_cvt_pk_bf16_f32 v175, v150, v151
  v_mfma_f32_32x32x16_bf16 v[72:87], v[184:187], v[168:171], 0
  s_nop 0
  v_mfma_f32_32x32x16_bf16 v[72:87], v[188:191], v[172:175], v[72:87]
  v_smfmac_f32_16x16x64_bf16 v[124:127], v[16:19], v[168:175], v20
  s_call_b64 s[72:73], .g2_kernel_a_ld0
  v_mfma_f32_32x32x16_bf16 v[136:151], v[208:211], v[32:35], 0
  v_mfma_f32_32x32x16_bf16 v[136:151], v[212:215], v[36:39], v[136:151]
  v_exp_f32 v152, v152
  v_exp_f32 v153, v153
  v_exp_f32 v154, v154
  v_exp_f32 v155, v155
  v_exp_f32 v156, v156
  v_exp_f32 v157, v157
  v_exp_f32 v158, v158
  v_exp_f32 v159, v159
  v_exp_f32 v160, v160
  v_exp_f32 v161, v161
  v_exp_f32 v162, v162
  v_exp_f32 v163, v163
  v_exp_f32 v164, v164
  v_exp_f32 v165, v165
  v_exp_f32 v166, v166
  v_exp_f32 v167, v167
  v_cvt_pk_bf16_f32 v168, v152, v153
  v_cvt_pk_bf16_f32 v169, v154, v155
  v_cvt_pk_bf16_f32 v170, v156, v157
  v_cvt_pk_bf16_f32 v171, v158, v159
  v_cvt_pk_bf16_f32 v172, v160, v161
  v_cvt_pk_bf16_f32 v173, v162, v163
  v_cvt_pk_bf16_f32 v174, v164, v165
  v_cvt_pk_bf16_f32 v175, v166, v167
  v_mfma_f32_32x32x16_bf16 v[72:87], v[200:203], v[168:171], v[72:87]
  s_nop 0
  v_mfma_f32_32x32x16_bf16 v[72:87], v[204:207], v[172:175], v[72:87]
  v_smfmac_f32_16x16x64_bf16 v[124:127], v[16:19], v[168:175], v20
  s_call_b64 s[72:73], .g2_kernel_a_ld1
  v_mfma_f32_32x32x16_bf16 v[152:167], v[224:227], v[32:35], 0
  v_mfma_f32_32x32x16_bf16 v[152:167], v[228:231], v[36:39], v[152:167]
  v_exp_f32 v136, v136
  v_exp_f32 v137, v137
  v_exp_f32 v138, v138
  v_exp_f32 v139, v139
  v_exp_f32 v140, v140
  v_exp_f32 v141, v141
  v_exp_f32 v142, v142
  v_exp_f32 v143, v143
  v_exp_f32 v144, v144
  v_exp_f32 v145, v145
  v_exp_f32 v146, v146
  v_exp_f32 v147, v147
  v_exp_f32 v148, v148
  v_exp_f32 v149, v149
  v_exp_f32 v150, v150
  v_exp_f32 v151, v151
  v_cvt_pk_bf16_f32 v168, v136, v137
  v_cvt_pk_bf16_f32 v169, v138, v139
  v_cvt_pk_bf16_f32 v170, v140, v141
  v_cvt_pk_bf16_f32 v171, v142, v143
  v_cvt_pk_bf16_f32 v172, v144, v145
  v_cvt_pk_bf16_f32 v173, v146, v147
  v_cvt_pk_bf16_f32 v174, v148, v149
  v_cvt_pk_bf16_f32 v175, v150, v151
  v_mfma_f32_32x32x16_bf16 v[72:87], v[216:219], v[168:171], v[72:87]
  s_nop 0
  v_mfma_f32_32x32x16_bf16 v[72:87], v[220:223], v[172:175], v[72:87]
  v_smfmac_f32_16x16x64_bf16 v[124:127], v[16:19], v[168:175], v20
  s_call_b64 s[72:73], .g2_kernel_a_ld2
  v_exp_f32 v152, v152
  v_exp_f32 v153, v153
  v_exp_f32 v154, v154
  v_exp_f32 v155, v155
  v_exp_f32 v156, v156
  v_exp_f32 v157, v157
  v_exp_f32 v158, v158
  v_exp_f32 v159, v159
  v_exp_f32 v160, v160
  v_exp_f32 v161, v161
  v_exp_f32 v162, v162
  v_exp_f32 v163, v163
  v_exp_f32 v164, v164
  v_exp_f32 v165, v165
  v_exp_f32 v166, v166
  v_exp_f32 v167, v167
  v_cvt_pk_bf16_f32 v168, v152, v153
  v_cvt_pk_bf16_f32 v169, v154, v155
  v_cvt_pk_bf16_f32 v170, v156, v157
  v_cvt_pk_bf16_f32 v171, v158, v159
  v_cvt_pk_bf16_f32 v172, v160, v161
  v_cvt_pk_bf16_f32 v173, v162, v163
  v_cvt_pk_bf16_f32 v174, v164, v165
  v_cvt_pk_bf16_f32 v175, v166, v167
  v_mfma_f32_32x32x16_bf16 v[72:87], v[232:235], v[168:171], v[72:87]
  s_nop 0
  v_mfma_f32_32x32x16_bf16 v[72:87], v[236:239], v[172:175], v[72:87]
  v_smfmac_f32_16x16x64_bf16 v[124:127], v[16:19], v[168:175], v20
  s_branch .g2_kernel_a_rde
.g2_kernel_a_rd2:
  s_cmp_lg_u32 s28, 2
  s_cbranch_scc1 .g2_kernel_a_rd3
  ds_read_b128 v[40:43], v14 offset:12288
  ds_read_b128 v[44:47], v14 offset:13312
  v_mov_b32 v128, 0
  v_mov_b32 v129, 0
  s_waitcnt lgkmcnt(0)
  v_mfma_f32_32x32x16_bf16 v[136:151], v[176:179], v[40:43], 0
  v_mfma_f32_32x32x16_bf16 v[136:151], v[180:183], v[44:47], v[136:151]
  v_mfma_f32_32x32x16_bf16 v[152:167], v[192:195], v[40:43], 0
  v_mfma_f32_32x32x16_bf16 v[152:167], v[196:199], v[44:47], v[152:167]
  s_nop 9
  v_exp_f32 v136, v136
  v_exp_f32 v137, v137
  v_exp_f32 v138, v138
  v_exp_f32 v139, v139
  v_exp_f32 v140, v140
  v_exp_f32 v141, v141
  v_exp_f32 v142, v142
  v_exp_f32 v143, v143
  v_exp_f32 v144, v144
  v_exp_f32 v145, v145
  v_exp_f32 v146, v146
  v_exp_f32 v147, v147
  v_exp_f32 v148, v148
  v_exp_f32 v149, v149
  v_exp_f32 v150, v150
  v_exp_f32 v151, v151
  v_cvt_pk_bf16_f32 v168, v136, v137
  v_cvt_pk_bf16_f32 v169, v138, v139
  v_cvt_pk_bf16_f32 v170, v140, v141
  v_cvt_pk_bf16_f32 v171, v142, v143
  v_cvt_pk_bf16_f32 v172, v144, v145
  v_cvt_pk_bf16_f32 v173, v146, v147
  v_cvt_pk_bf16_f32 v174, v148, v149
  v_cvt_pk_bf16_f32 v175, v150, v151
  v_mfma_f32_32x32x16_bf16 v[88:103], v[184:187], v[168:171], 0
  s_nop 0
  v_mfma_f32_32x32x16_bf16 v[88:103], v[188:191], v[172:175], v[88:103]
  v_smfmac_f32_16x16x64_bf16 v[128:131], v[16:19], v[168:175], v20
  s_call_b64 s[72:73], .g2_kernel_a_ld0
  v_mfma_f32_32x32x16_bf16 v[136:151], v[208:211], v[40:43], 0
  v_mfma_f32_32x32x16_bf16 v[136:151], v[212:215], v[44:47], v[136:151]
  v_exp_f32 v152, v152
  v_exp_f32 v153, v153
  v_exp_f32 v154, v154
  v_exp_f32 v155, v155
  v_exp_f32 v156, v156
  v_exp_f32 v157, v157
  v_exp_f32 v158, v158
  v_exp_f32 v159, v159
  v_exp_f32 v160, v160
  v_exp_f32 v161, v161
  v_exp_f32 v162, v162
  v_exp_f32 v163, v163
  v_exp_f32 v164, v164
  v_exp_f32 v165, v165
  v_exp_f32 v166, v166
  v_exp_f32 v167, v167
  v_cvt_pk_bf16_f32 v168, v152, v153
  v_cvt_pk_bf16_f32 v169, v154, v155
  v_cvt_pk_bf16_f32 v170, v156, v157
  v_cvt_pk_bf16_f32 v171, v158, v159
  v_cvt_pk_bf16_f32 v172, v160, v161
  v_cvt_pk_bf16_f32 v173, v162, v163
  v_cvt_pk_bf16_f32 v174, v164, v165
  v_cvt_pk_bf16_f32 v175, v166, v167
  v_mfma_f32_32x32x16_bf16 v[88:103], v[200:203], v[168:171], v[88:103]
  s_nop 0
  v_mfma_f32_32x32x16_bf16 v[88:103], v[204:207], v[172:175], v[88:103]
  v_smfmac_f32_16x16x64_bf16 v[128:131], v[16:19], v[168:175], v20
  s_call_b64 s[72:73], .g2_kernel_a_ld1
  v_mfma_f32_32x32x16_bf16 v[152:167], v[224:227], v[40:43], 0
  v_mfma_f32_32x32x16_bf16 v[152:167], v[228:231], v[44:47], v[152:167]
  v_exp_f32 v136, v136
  v_exp_f32 v137, v137
  v_exp_f32 v138, v138
  v_exp_f32 v139, v139
  v_exp_f32 v140, v140
  v_exp_f32 v141, v141
  v_exp_f32 v142, v142
  v_exp_f32 v143, v143
  v_exp_f32 v144, v144
  v_exp_f32 v145, v145
  v_exp_f32 v146, v146
  v_exp_f32 v147, v147
  v_exp_f32 v148, v148
  v_exp_f32 v149, v149
  v_exp_f32 v150, v150
  v_exp_f32 v151, v151
  v_cvt_pk_bf16_f32 v168, v136, v137
  v_cvt_pk_bf16_f32 v169, v138, v139
  v_cvt_pk_bf16_f32 v170, v140, v141
  v_cvt_pk_bf16_f32 v171, v142, v143
  v_cvt_pk_bf16_f32 v172, v144, v145
  v_cvt_pk_bf16_f32 v173, v146, v147
  v_cvt_pk_bf16_f32 v174, v148, v149
  v_cvt_pk_bf16_f32 v175, v150, v151
  v_mfma_f32_32x32x16_bf16 v[88:103], v[216:219], v[168:171], v[88:103]
  s_nop 0
  v_mfma_f32_32x32x16_bf16 v[88:103], v[220:223], v[172:175], v[88:103]
  v_smfmac_f32_16x16x64_bf16 v[128:131], v[16:19], v[168:175], v20
  s_call_b64 s[72:73], .g2_kernel_a_ld2
  v_exp_f32 v152, v152
  v_exp_f32 v153, v153
  v_exp_f32 v154, v154
  v_exp_f32 v155, v155
  v_exp_f32 v156, v156
  v_exp_f32 v157, v157
  v_exp_f32 v158, v158
  v_exp_f32 v159, v159
  v_exp_f32 v160, v160
  v_exp_f32 v161, v161
  v_exp_f32 v162, v162
  v_exp_f32 v163, v163
  v_exp_f32 v164, v164
  v_exp_f32 v165, v165
  v_exp_f32 v166, v166
  v_exp_f32 v167, v167
  v_cvt_pk_bf16_f32 v168, v152, v153
  v_cvt_pk_bf16_f32 v169, v154, v155
  v_cvt_pk_bf16_f32 v170, v156, v157
  v_cvt_pk_bf16_f32 v171, v158, v159
  v_cvt_pk_bf16_f32 v172, v160, v161
  v_cvt_pk_bf16_f32 v173, v162, v163
  v_cvt_pk_bf16_f32 v174, v164, v165
  v_cvt_pk_bf16_f32 v175, v166, v167
  v_mfma_f32_32x32x16_bf16 v[88:103], v[232:235], v[168:171], v[88:103]
  s_nop 0
  v_mfma_f32_32x32x16_bf16 v[88:103], v[236:239], v[172:175], v[88:103]
  v_smfmac_f32_16x16x64_bf16 v[128:131], v[16:19], v[168:175], v20
  s_branch .g2_kernel_a_rde
.g2_kernel_a_rd3:
  ds_read_b128 v[48:51], v14 offset:14336
  ds_read_b128 v[52:55], v14 offset:15360
  v_mov_b32 v132, 0
  v_mov_b32 v133, 0
  s_waitcnt lgkmcnt(0)
  v_mfma_f32_32x32x16_bf16 v[136:151], v[176:179], v[48:51], 0
  v_mfma_f32_32x32x16_bf16 v[136:151], v[180:183], v[52:55], v[136:151]
  v_mfma_f32_32x32x16_bf16 v[152:167], v[192:195], v[48:51], 0
  v_mfma_f32_32x32x16_bf16 v[152:167], v[196:199], v[52:55], v[152:167]
  s_nop 9
  v_exp_f32 v136, v136
  v_exp_f32 v137, v137
  v_exp_f32 v138, v138
  v_exp_f32 v139, v139
  v_exp_f32 v140, v140
  v_exp_f32 v141, v141
  v_exp_f32 v142, v142
  v_exp_f32 v143, v143
  v_exp_f32 v144, v144
  v_exp_f32 v145, v145
  v_exp_f32 v146, v146
  v_exp_f32 v147, v147
  v_exp_f32 v148, v148
  v_exp_f32 v149, v149
  v_exp_f32 v150, v150
  v_exp_f32 v151, v151
  v_cvt_pk_bf16_f32 v168, v136, v137
  v_cvt_pk_bf16_f32 v169, v138, v139
  v_cvt_pk_bf16_f32 v170, v140, v141
  v_cvt_pk_bf16_f32 v171, v142, v143
  v_cvt_pk_bf16_f32 v172, v144, v145
  v_cvt_pk_bf16_f32 v173, v146, v147
  v_cvt_pk_bf16_f32 v174, v148, v149
  v_cvt_pk_bf16_f32 v175, v150, v151
  v_mfma_f32_32x32x16_bf16 v[104:119], v[184:187], v[168:171], 0
  s_nop 0
  v_mfma_f32_32x32x16_bf16 v[104:119], v[188:191], v[172:175], v[104:119]
  v_smfmac_f32_16x16x64_bf16 v[132:135], v[16:19], v[168:175], v20
  s_call_b64 s[72:73], .g2_kernel_a_ld0
  v_mfma_f32_32x32x16_bf16 v[136:151], v[208:211], v[48:51], 0
  v_mfma_f32_32x32x16_bf16 v[136:151], v[212:215], v[52:55], v[136:151]
  v_exp_f32 v152, v152
  v_exp_f32 v153, v153
  v_exp_f32 v154, v154
  v_exp_f32 v155, v155
  v_exp_f32 v156, v156
  v_exp_f32 v157, v157
  v_exp_f32 v158, v158
  v_exp_f32 v159, v159
  v_exp_f32 v160, v160
  v_exp_f32 v161, v161
  v_exp_f32 v162, v162
  v_exp_f32 v163, v163
  v_exp_f32 v164, v164
  v_exp_f32 v165, v165
  v_exp_f32 v166, v166
  v_exp_f32 v167, v167
  v_cvt_pk_bf16_f32 v168, v152, v153
  v_cvt_pk_bf16_f32 v169, v154, v155
  v_cvt_pk_bf16_f32 v170, v156, v157
  v_cvt_pk_bf16_f32 v171, v158, v159
  v_cvt_pk_bf16_f32 v172, v160, v161
  v_cvt_pk_bf16_f32 v173, v162, v163
  v_cvt_pk_bf16_f32 v174, v164, v165
  v_cvt_pk_bf16_f32 v175, v166, v167
  v_mfma_f32_32x32x16_bf16 v[104:119], v[200:203], v[168:171], v[104:119]
  s_nop 0
  v_mfma_f32_32x32x16_bf16 v[104:119], v[204:207], v[172:175], v[104:119]
  v_smfmac_f32_16x16x64_bf16 v[132:135], v[16:19], v[168:175], v20
  s_call_b64 s[72:73], .g2_kernel_a_ld1
  v_mfma_f32_32x32x16_bf16 v[152:167], v[224:227], v[48:51], 0
  v_mfma_f32_32x32x16_bf16 v[152:167], v[228:231], v[52:55], v[152:167]
  v_exp_f32 v136, v136
  v_exp_f32 v137, v137
  v_exp_f32 v138, v138
  v_exp_f32 v139, v139
  v_exp_f32 v140, v140
  v_exp_f32 v141, v141
  v_exp_f32 v142, v142
  v_exp_f32 v143, v143
  v_exp_f32 v144, v144
  v_exp_f32 v145, v145
  v_exp_f32 v146, v146
  v_exp_f32 v147, v147
  v_exp_f32 v148, v148
  v_exp_f32 v149, v149
  v_exp_f32 v150, v150
  v_exp_f32 v151, v151
  v_cvt_pk_bf16_f32 v168, v136, v137
  v_cvt_pk_bf16_f32 v169, v138, v139
  v_cvt_pk_bf16_f32 v170, v140, v141
  v_cvt_pk_bf16_f32 v171, v142, v143
  v_cvt_pk_bf16_f32 v172, v144, v145
  v_cvt_pk_bf16_f32 v173, v146, v147
  v_cvt_pk_bf16_f32 v174, v148, v149
  v_cvt_pk_bf16_f32 v175, v150, v151
  v_mfma_f32_32x32x16_bf16 v[104:119], v[216:219], v[168:171], v[104:119]
  s_nop 0
  v_mfma_f32_32x32x16_bf16 v[104:119], v[220:223], v[172:175], v[104:119]
  v_smfmac_f32_16x16x64_bf16 v[132:135], v[16:19], v[168:175], v20
  s_call_b64 s[72:73], .g2_kernel_a_ld2
  v_exp_f32 v152, v152
  v_exp_f32 v153, v153
  v_exp_f32 v154, v154
  v_exp_f32 v155, v155
  v_exp_f32 v156, v156
  v_exp_f32 v157, v157
  v_exp_f32 v158, v158
  v_exp_f32 v159, v159
  v_exp_f32 v160, v160
  v_exp_f32 v161, v161
  v_exp_f32 v162, v162
  v_exp_f32 v163, v163
  v_exp_f32 v164, v164
  v_exp_f32 v165, v165
  v_exp_f32 v166, v166
  v_exp_f32 v167, v167
  v_cvt_pk_bf16_f32 v168, v152, v153
  v_cvt_pk_bf16_f32 v169, v154, v155
  v_cvt_pk_bf16_f32 v170, v156, v157
  v_cvt_pk_bf16_f32 v171, v158, v159
  v_cvt_pk_bf16_f32 v172, v160, v161
  v_cvt_pk_bf16_f32 v173, v162, v163
  v_cvt_pk_bf16_f32 v174, v164, v165
  v_cvt_pk_bf16_f32 v175, v166, v167
  v_mfma_f32_32x32x16_bf16 v[104:119], v[232:235], v[168:171], v[104:119]
  s_nop 0
  v_mfma_f32_32x32x16_bf16 v[104:119], v[236:239], v[172:175], v[104:119]
  v_smfmac_f32_16x16x64_bf16 v[132:135], v[16:19], v[168:175], v20
  s_branch .g2_kernel_a_rde
.g2_kernel_a_rd4:
.g2_kernel_a_rde:
  v_mov_b32 v168, 0
  v_mov_b32 v169, 0
  v_mov_b32 v170, 0
  v_mov_b32 v171, 0
  v_mov_b32 v172, 0
  v_mov_b32 v173, 0
  v_mov_b32 v174, 0
  v_mov_b32 v175, 0
  s_waitcnt vmcnt(8)
  v_mfma_f32_32x32x16_bf16 v[136:151], v[176:179], v[24:27], 0
  v_mfma_f32_32x32x16_bf16 v[136:151], v[180:183], v[28:31], v[136:151]
  s_nop 10
  s_branch .g2_kernel_a_loop
.g2_kernel_a_ld0:
  s_andn2_b32 s33, s36, s34
  s_cbranch_scc0 .g2_kernel_a_r0c
.g2_kernel_a_r0b:
  s_ff1_i32_b32 s33, s33
  s_bitset1_b32 s34, s33
  s_xor_b32 s33, s33, s24
  s_lshl_b32 s33, s33, s25
  s_add_u32 s22, s20, s33
  s_addc_u32 s23, s21, 0
  global_load_dwordx4 v[176:179], v3, s[22:23] offset:0
  global_load_dwordx4 v[180:183], v3, s[22:23] offset:1024
  global_load_dwordx4 v[184:187], v3, s[22:23] offset:2048
  global_load_dwordx4 v[188:191], v3, s[22:23] offset:3072
  s_setpc_b64 s[72:73]
.g2_kernel_a_ld1:
  s_andn2_b32 s33, s36, s34
  s_cbranch_scc0 .g2_kernel_a_r1c
.g2_kernel_a_r1b:
  s_ff1_i32_b32 s33, s33
  s_bitset1_b32 s34, s33
  s_xor_b32 s33, s33, s24
  s_lshl_b32 s33, s33, s25
  s_add_u32 s22, s20, s33
  s_addc_u32 s23, s21, 0
  global_load_dwordx4 v[192:195], v3, s[22:23] offset:0
  global_load_dwordx4 v[196:199], v3, s[22:23] offset:1024
  global_load_dwordx4 v[200:203], v3, s[22:23] offset:2048
  global_load_dwordx4 v[204:207], v3, s[22:23] offset:3072
  s_setpc_b64 s[72:73]
.g2_kernel_a_ld2:
  s_andn2_b32 s33, s36, s34
  s_cbranch_scc0 .g2_kernel_a_r2c
.g2_kernel_a_r2b:
  s_ff1_i32_b32 s33, s33
  s_bitset1_b32 s34, s33
  s_xor_b32 s33, s33, s24
  s_lshl_b32 s33, s33, s25
  s_add_u32 s22, s20, s33
  s_addc_u32 s23, s21, 0
  global_load_dwordx4 v[208:211], v3, s[22:23] offset:0
  global_load_dwordx4 v[212:215], v3, s[22:23] offset:1024
  global_load_dwordx4 v[216:219], v3, s[22:23] offset:2048
  global_load_dwordx4 v[220:223], v3, s[22:23] offset:3072
  s_setpc_b64 s[72:73]
.g2_kernel_a_N0c:
  s_call_b64 s[68:69], .g2_kernel_a_pick
  s_branch .g2_kernel_a_N0b
.g2_kernel_a_N1c:
  s_call_b64 s[68:69], .g2_kernel_a_pick
  s_branch .g2_kernel_a_N1b
.g2_kernel_a_N2c:
  s_call_b64 s[68:69], .g2_kernel_a_pick
  s_branch .g2_kernel_a_N2b
.g2_kernel_a_N3c:
  s_call_b64 s[68:69], .g2_kernel_a_pick
  s_branch .g2_kernel_a_N3b
.g2_kernel_a_L3c:
  s_call_b64 s[68:69], .g2_kernel_a_pick
  s_branch .g2_kernel_a_L3b
.g2_kernel_a_G0c:
  s_call_b64 s[68:69], .g2_kernel_a_pick
  s_branch .g2_kernel_a_G0b
.g2_kernel_a_L3g:
  s_mov_b32 s38, 0
.g2_kernel_a_L3gl:
  ds_read_b32 v7, v13 offset:8
  s_add_u32 s38, s38, 1
  s_waitcnt lgkmcnt(0)
  v_cmp_gt_u32 vcc, s27, v7
  s_cbranch_vccz .g2_kernel_a_L3h
  s_cmp_lt_u32 s38, 524288
  s_cbranch_scc1 .g2_kernel_a_L3gl
  s_branch .g2_kernel_a_L3h
.g2_kernel_a_hold:
  s_lshl_b32 s33, 1, s14
  s_lshr_b32 s14, s14, 8
  s_setpc_b64 s[68:69]
.g2_kernel_a_pick:
  s_cmp_lg_u32 s34, -1
  s_cbranch_scc1 .g2_kernel_a_pk1
  s_cmp_eq_u32 s26, -1
  s_cbranch_scc1 .g2_kernel_a_hold
  s_add_u32 s26, s26, 1
  s_mov_b32 s34, 0xffff
  s_cmp_eq_u32 s26, 1
  s_cbranch_scc1 .g2_kernel_a_pk1
  v_and_b32 v8, 15, v2
  s_lshl_b32 s28, s16, 6
  s_add_u32 s28, s28, 157696
  v_lshl_add_u32 v8, v8, 2, s28
  s_lshl_b32 s28, s17, 2
  s_add_u32 s28, s28, s16
  s_lshl_b32 s28, s28, 16
  s_add_u32 s28, s28, s63
  s_add_u32 s28, s28, 0x800000
  s_add_u32 s20, s60, s28
  s_addc_u32 s21, s61, 0
  s_lshl_b32 s24, s18, 1
  s_and_b32 s24, s24, 6
  s_mov_b32 s25, 12
  s_mov_b32 s34, 0
  s_mov_b32 s36, 0xff
  s_mov_b32 s33, 0xff
  s_mov_b32 s38, 0
.g2_kernel_a_pk2:
  ds_read_b32 v7, v8
  s_add_u32 s38, s38, 1
  s_waitcnt lgkmcnt(0)
  v_cmp_ge_u32 vcc, s62, v7
  s_cbranch_vccz .g2_kernel_a_pkr
  s_cmp_lt_u32 s38, 524288
  s_cbranch_scc1 .g2_kernel_a_pk2
  s_branch .g2_kernel_a_pkr
.g2_kernel_a_pk1:
  s_mov_b32 s38, 0
.g2_kernel_a_pkl:
  ds_read_b32 v7, v8
  s_add_u32 s38, s38, 1
  s_waitcnt lgkmcnt(0)
  v_cmp_lt_u32 vcc, s62, v7
  s_mov_b32 s36, vcc_lo
  s_andn2_b32 s33, s36, s34
  s_cbranch_scc1 .g2_kernel_a_pkr
  s_cmp_lt_u32 s38, 524288
  s_cbranch_scc1 .g2_kernel_a_pkl
  s_not_b32 s33, s34
.g2_kernel_a_pkr:
  s_setpc_b64 s[68:69]
.g2_kernel_w_aw:
  v_mov_b32 v6, s71
  s_mov_b32 s38, 0
.g2_kernel_wg4:
  ds_read_b32 v7, v6 offset:52
  s_add_u32 s38, s38, 1
  s_waitcnt lgkmcnt(0)
  v_cmp_le_u32 vcc, 4, v7
  s_cbranch_vccnz .g2_kernel_wg4d
  s_sleep 1
  s_cmp_lt_u32 s38, 524288
  s_cbranch_scc1 .g2_kernel_wg4
.g2_kernel_wg4d:
  s_branch .g2_kernel_w_ab
.g2_kernel_w_pt:
  v_lshlrev_b32 v7, 5, v17
  v_add_u32 v7, 155648, v7
  s_mov_b64 exec, vcc
  ds_read_b128 v[240:243], v7 offset:7680
  ds_read_b128 v[244:247], v7 offset:7696
  ds_read_b128 v[248:251], v7 offset:7744
  ds_read_b128 v[252:255], v7 offset:7760
  s_waitcnt lgkmcnt(0)
  v_pk_add_f32 v[24:25], v[24:25], v[240:241]
  v_pk_add_f32 v[26:27], v[26:27], v[242:243]
  v_pk_add_f32 v[28:29], v[28:29], v[244:245]
  v_pk_add_f32 v[30:31], v[30:31], v[246:247]
  v_pk_add_f32 v[32:33], v[32:33], v[248:249]
  v_pk_add_f32 v[34:35], v[34:35], v[250:251]
  v_pk_add_f32 v[36:37], v[36:37], v[252:253]
  v_pk_add_f32 v[38:39], v[38:39], v[254:255]
  ds_read_b128 v[240:243], v7 offset:7808
  ds_read_b128 v[244:247], v7 offset:7824
  ds_read_b128 v[248:251], v7 offset:7872
  ds_read_b128 v[252:255], v7 offset:7888
  s_waitcnt lgkmcnt(0)
  v_pk_add_f32 v[40:41], v[40:41], v[240:241]
  v_pk_add_f32 v[42:43], v[42:43], v[242:243]
  v_pk_add_f32 v[44:45], v[44:45], v[244:245]
  v_pk_add_f32 v[46:47], v[46:47], v[246:247]
  v_pk_add_f32 v[48:49], v[48:49], v[248:249]
  v_pk_add_f32 v[50:51], v[50:51], v[250:251]
  v_pk_add_f32 v[52:53], v[52:53], v[252:253]
  v_pk_add_f32 v[54:55], v[54:55], v[254:255]
  s_mov_b64 exec, -1
  s_branch .g2_kernel_w_pb
.g2_kernel_w_i8c:
  s_mov_b32 s38, 0
  s_call_b64 s[68:69], .g2_kernel_w_pkl
  s_branch .g2_kernel_w_i8b
.g2_kernel_w_i9c:
  s_mov_b32 s38, 0
  s_call_b64 s[68:69], .g2_kernel_w_pkl
  s_branch .g2_kernel_w_i9b
.g2_kernel_w_i10c:
  s_mov_b32 s38, 0
  s_call_b64 s[68:69], .g2_kernel_w_pkl
  s_branch .g2_kernel_w_i10b
.g2_kernel_w_i11c:
  s_mov_b32 s38, 0
  s_call_b64 s[68:69], .g2_kernel_w_pkl
  s_branch .g2_kernel_w_i11b
.g2_kernel_w_v8:
  s_cmp_ge_u32 s8, 139264
  s_cselect_b32 s28, 139264, 0
  s_sub_u32 s28, s8, s28
  s_lshr_b32 s28, s28, 1
  s_add_u32 s28, s28, 32768
  s_add_u32 s22, s20, s28
  s_addc_u32 s23, s21, 0
  s_mov_b32 s38, 0
.g2_kernel_w_vl8:
  global_load_dwordx4 v[88:91], v3, s[22:23] offset:0 sc1
  global_load_dwordx4 v[92:95], v3, s[22:23] offset:1024 sc1
  global_load_dwordx4 v[96:99], v3, s[22:23] offset:2048 sc1
  global_load_dwordx4 v[100:103], v3, s[22:23] offset:3072 sc1
  s_add_u32 s38, s38, 1
  s_waitcnt vmcnt(0)
  v_min3_u32 v6, v88, v90, v92
  v_min3_u32 v7, v94, v96, v98
  v_min3_u32 v6, v6, v100, v102
  v_min_u32 v6, v6, v7
  v_cmp_eq_u32 vcc, 0, v6
  s_cbranch_vccz .g2_kernel_w_vb8
  s_cmp_lt_u32 s38, 131072
  s_cbranch_scc1 .g2_kernel_w_vl8
  s_branch .g2_kernel_w_vb8
.g2_kernel_w_i12c:
  s_mov_b32 s38, 0
  s_call_b64 s[68:69], .g2_kernel_w_pkl
  s_branch .g2_kernel_w_i12b
.g2_kernel_w_v9:
  s_cmp_ge_u32 s9, 139264
  s_cselect_b32 s28, 139264, 0
  s_sub_u32 s28, s9, s28
  s_lshr_b32 s28, s28, 1
  s_add_u32 s28, s28, 32768
  s_add_u32 s22, s20, s28
  s_addc_u32 s23, s21, 0
  s_mov_b32 s38, 0
.g2_kernel_w_vl9:
  global_load_dwordx4 v[176:179], v3, s[22:23] offset:0 sc1
  global_load_dwordx4 v[180:183], v3, s[22:23] offset:1024 sc1
  global_load_dwordx4 v[184:187], v3, s[22:23] offset:2048 sc1
  global_load_dwordx4 v[188:191], v3, s[22:23] offset:3072 sc1
  s_add_u32 s38, s38, 1
  s_waitcnt vmcnt(0)
  v_min3_u32 v6, v176, v178, v180
  v_min3_u32 v7, v182, v184, v186
  v_min3_u32 v6, v6, v188, v190
  v_min_u32 v6, v6, v7
  v_cmp_eq_u32 vcc, 0, v6
  s_cbranch_vccz .g2_kernel_w_vb9
  s_cmp_lt_u32 s38, 131072
  s_cbranch_scc1 .g2_kernel_w_vl9
  s_branch .g2_kernel_w_vb9
.g2_kernel_w_i13c:
  s_mov_b32 s38, 0
  s_call_b64 s[68:69], .g2_kernel_w_pkl
  s_branch .g2_kernel_w_i13b
.g2_kernel_w_v10:
  s_cmp_ge_u32 s10, 139264
  s_cselect_b32 s28, 139264, 0
  s_sub_u32 s28, s10, s28
  s_lshr_b32 s28, s28, 1
  s_add_u32 s28, s28, 32768
  s_add_u32 s22, s20, s28
  s_addc_u32 s23, s21, 0
  s_mov_b32 s38, 0
.g2_kernel_w_vl10:
  global_load_dwordx4 v[192:195], v3, s[22:23] offset:0 sc1
  global_load_dwordx4 v[196:199], v3, s[22:23] offset:1024 sc1
  global_load_dwordx4 v[200:203], v3, s[22:23] offset:2048 sc1
  global_load_dwordx4 v[204:207], v3, s[22:23] offset:3072 sc1
  s_add_u32 s38, s38, 1
  s_waitcnt vmcnt(0)
  v_min3_u32 v6, v192, v194, v196
  v_min3_u32 v7, v198, v200, v202
  v_min3_u32 v6, v6, v204, v206
  v_min_u32 v6, v6, v7
  v_cmp_eq_u32 vcc, 0, v6
  s_cbranch_vccz .g2_kernel_w_vb10
  s_cmp_lt_u32 s38, 131072
  s_cbranch_scc1 .g2_kernel_w_vl10
  s_branch .g2_kernel_w_vb10
.g2_kernel_w_i14c:
  s_mov_b32 s38, 524288
  s_call_b64 s[68:69], .g2_kernel_w_pkl
  s_branch .g2_kernel_w_i14b
.g2_kernel_w_v11:
  s_cmp_ge_u32 s11, 139264
  s_cselect_b32 s28, 139264, 0
  s_sub_u32 s28, s11, s28
  s_lshr_b32 s28, s28, 1
  s_add_u32 s28, s28, 32768
  s_add_u32 s22, s20, s28
  s_addc_u32 s23, s21, 0
  s_mov_b32 s38, 0
.g2_kernel_w_vl11:
  global_load_dwordx4 v[208:211], v3, s[22:23] offset:0 sc1
  global_load_dwordx4 v[212:215], v3, s[22:23] offset:1024 sc1
  global_load_dwordx4 v[216:219], v3, s[22:23] offset:2048 sc1
  global_load_dwordx4 v[220:223], v3, s[22:23] offset:3072 sc1
  s_add_u32 s38, s38, 1
  s_waitcnt vmcnt(0)
  v_min3_u32 v6, v208, v210, v212
  v_min3_u32 v7, v214, v216, v218
  v_min3_u32 v6, v6, v220, v222
  v_min_u32 v6, v6, v7
  v_cmp_eq_u32 vcc, 0, v6
  s_cbranch_vccz .g2_kernel_w_vb11
  s_cmp_lt_u32 s38, 131072
  s_cbranch_scc1 .g2_kernel_w_vl11
  s_branch .g2_kernel_w_vb11
.g2_kernel_w_i15c:
  s_mov_b32 s38, 524288
  s_call_b64 s[68:69], .g2_kernel_w_pkl
  s_branch .g2_kernel_w_i15b
.g2_kernel_w_v12:
  s_cmp_ge_u32 s12, 139264
  s_cselect_b32 s28, 139264, 0
  s_sub_u32 s28, s12, s28
  s_lshr_b32 s28, s28, 1
  s_add_u32 s28, s28, 32768
  s_add_u32 s22, s20, s28
  s_addc_u32 s23, s21, 0
  s_mov_b32 s38, 0
.g2_kernel_w_vl12:
  global_load_dwordx4 v[224:227], v3, s[22:23] offset:0 sc1
  global_load_dwordx4 v[228:231], v3, s[22:23] offset:1024 sc1
  global_load_dwordx4 v[232:235], v3, s[22:23] offset:2048 sc1
  global_load_dwordx4 v[236:239], v3, s[22:23] offset:3072 sc1
  s_add_u32 s38, s38, 1
  s_waitcnt vmcnt(0)
  v_min3_u32 v6, v224, v226, v228
  v_min3_u32 v7, v230, v232, v234
  v_min3_u32 v6, v6, v236, v238
  v_min_u32 v6, v6, v7
  v_cmp_eq_u32 vcc, 0, v6
  s_cbranch_vccz .g2_kernel_w_vb12
  s_cmp_lt_u32 s38, 131072
  s_cbranch_scc1 .g2_kernel_w_vl12
  s_branch .g2_kernel_w_vb12
.g2_kernel_w_v13:
  s_cmp_ge_u32 s13, 139264
  s_cselect_b32 s28, 139264, 0
  s_sub_u32 s28, s13, s28
  s_lshr_b32 s28, s28, 1
  s_add_u32 s28, s28, 32768
  s_add_u32 s22, s20, s28
  s_addc_u32 s23, s21, 0
  s_mov_b32 s38, 0
.g2_kernel_w_vl13:
  global_load_dwordx4 v[136:139], v3, s[22:23] offset:0 sc1
  global_load_dwordx4 v[140:143], v3, s[22:23] offset:1024 sc1
  global_load_dwordx4 v[144:147], v3, s[22:23] offset:2048 sc1
  global_load_dwordx4 v[148:151], v3, s[22:23] offset:3072 sc1
  s_add_u32 s38, s38, 1
  s_waitcnt vmcnt(0)
  v_min3_u32 v6, v136, v138, v140
  v_min3_u32 v7, v142, v144, v146
  v_min3_u32 v6, v6, v148, v150
  v_min_u32 v6, v6, v7
  v_cmp_eq_u32 vcc, 0, v6
  s_cbranch_vccz .g2_kernel_w_vb13
  s_cmp_lt_u32 s38, 131072
  s_cbranch_scc1 .g2_kernel_w_vl13
  s_branch .g2_kernel_w_vb13
.g2_kernel_w_v14:
  s_cmp_ge_u32 s14, 139264
  s_cselect_b32 s28, 139264, 0
  s_sub_u32 s28, s14, s28
  s_lshr_b32 s28, s28, 1
  s_add_u32 s28, s28, 32768
  s_add_u32 s22, s20, s28
  s_addc_u32 s23, s21, 0
  s_mov_b32 s38, 0
.g2_kernel_w_vl14:
  global_load_dwordx4 v[152:155], v3, s[22:23] offset:0 sc1
  global_load_dwordx4 v[156:159], v3, s[22:23] offset:1024 sc1
  global_load_dwordx4 v[160:163], v3, s[22:23] offset:2048 sc1
  global_load_dwordx4 v[164:167], v3, s[22:23] offset:3072 sc1
  s_add_u32 s38, s38, 1
  s_waitcnt vmcnt(0)
  v_min3_u32 v6, v152, v154, v156
  v_min3_u32 v7, v158, v160, v162
  v_min3_u32 v6, v6, v164, v166
  v_min_u32 v6, v6, v7
  v_cmp_eq_u32 vcc, 0, v6
  s_cbranch_vccz .g2_kernel_w_vb14
  s_cmp_lt_u32 s38, 131072
  s_cbranch_scc1 .g2_kernel_w_vl14
  s_branch .g2_kernel_w_vb14
.g2_kernel_w_v15:
  s_cmp_ge_u32 s15, 139264
  s_cselect_b32 s28, 139264, 0
  s_sub_u32 s28, s15, s28
  s_lshr_b32 s28, s28, 1
  s_add_u32 s28, s28, 32768
  s_add_u32 s22, s20, s28
  s_addc_u32 s23, s21, 0
  s_mov_b32 s38, 0
.g2_kernel_w_vl15:
  global_load_dwordx4 v[56:59], v3, s[22:23] offset:0 sc1
  global_load_dwordx4 v[60:63], v3, s[22:23] offset:1024 sc1
  global_load_dwordx4 v[64:67], v3, s[22:23] offset:2048 sc1
  global_load_dwordx4 v[68:71], v3, s[22:23] offset:3072 sc1
  s_add_u32 s38, s38, 1
  s_waitcnt vmcnt(0)
  v_min3_u32 v6, v56, v58, v60
  v_min3_u32 v7, v62, v64, v66
  v_min3_u32 v6, v6, v68, v70
  v_min_u32 v6, v6, v7
  v_cmp_eq_u32 vcc, 0, v6
  s_cbranch_vccz .g2_kernel_w_vb15
  s_cmp_lt_u32 s38, 131072
  s_cbranch_scc1 .g2_kernel_w_vl15
  s_branch .g2_kernel_w_vb15
.g2_kernel_w_bw:
  s_mov_b32 s38, 0
.g2_kernel_w_bwl:
  ds_read_b32 v16, v20 offset:12
  s_add_u32 s38, s38, 1
  s_waitcnt lgkmcnt(0)
  v_cmp_gt_u32 vcc, 4, v16
  s_cbranch_vccz .g2_kernel_w_bb
  s_cmp_lt_u32 s38, 524288
  s_cbranch_scc1 .g2_kernel_w_bwl
  s_branch .g2_kernel_w_bb
.g2_kernel_w_pick:
  s_mov_b32 s38, 0
.g2_kernel_w_pkl:
  ds_read_b64 v[6:7], v21
  s_add_u32 s38, s38, 1
  s_waitcnt lgkmcnt(0)
  v_min_u32 v6, v6, v7
  v_cmp_lt_u32 vcc, s62, v6
  s_and_b32 s36, vcc_lo, 0xff00
  s_andn2_b32 s33, s36, s34
  s_cbranch_scc1 .g2_kernel_w_pkr
  s_cmp_lt_u32 s38, 524288
  s_cbranch_scc1 .g2_kernel_w_pkl
  s_andn2_b32 s33, 0xff00, s34
.g2_kernel_w_pkr:
  s_setpc_b64 s[68:69]
.g2_kernel_p_spin:
  s_mov_b32 s38, 0
.g2_kernel_p_spinl:
  ds_read_b32 v10, v9
  s_add_u32 s38, s38, 1
  s_waitcnt lgkmcnt(0)
  v_cmp_gt_i32 vcc, s34, v10
  s_cbranch_vccz .g2_kernel_p_spinr
  s_sleep 1
  s_cmp_lt_u32 s38, 524288
  s_cbranch_scc1 .g2_kernel_p_spinl
.g2_kernel_p_spinr:
  s_setpc_b64 s[68:69]
.g2_kernel_p1_aw:
  s_call_b64 s[68:69], .g2_kernel_p_spin
  s_branch .g2_kernel_p1_ai
.g2_kernel_p1_bw:
  s_call_b64 s[68:69], .g2_kernel_p_spin
  s_branch .g2_kernel_p1_bi
.g2_kernel_v_may:
  s_cmp_lg_u32 s39, 0
  s_cbranch_scc1 .g2_kernel_v_mr
  s_and_b32 s28, s16, 3
  s_lshl_b32 s28, s28, 4
  s_add_u32 s28, s28, 155968
  v_mov_b32 v6, s28
  ds_read_b32 v7, v6
  s_waitcnt lgkmcnt(0)
  v_cmp_ne_u32 vcc, 0, v7
  s_cbranch_vccz .g2_kernel_v_mr
.g2_kernel_v_do:
  s_mov_b32 s39, 1
  s_mov_b32 s29, 0
  s_call_b64 s[68:69], .g2_kernel_v_cmb
  s_waitcnt vmcnt(0)
  v_mov_b32 v6, s71
  s_mov_b64 exec, 1
  ds_add_u32 v6, v5 offset:8
  s_mov_b64 exec, -1
  s_and_b32 s33, s16, 3
  s_lshl_b32 s33, s33, 7
  s_lshl_b32 s28, s29, 2
  s_add_u32 s33, s33, s28
  s_add_u32 s31, s19, s33
  v_mov_b32 v6, s70
  s_mov_b64 exec, 1
  buffer_store_dword v6, v4, s[4:7], s31 offen offset:0 sc1
  s_mov_b64 exec, -1
.g2_kernel_v_mr:
  s_setpc_b64 s[26:27]
.g2_kernel_v_wo:
  s_mov_b32 s8, s44
  s_mov_b32 s9, s45
  s_mov_b32 s10, 0x200000
  s_mov_b32 s11, 0x00020000
  v_lshrrev_b32 v6, 3, v2
  v_and_b32 v7, 7, v2
  v_bfe_u32 v8, v2, 4, 1
  v_lshlrev_b32 v8, 2, v8
  v_xor_b32 v7, v7, v8
  v_lshlrev_b32 v7, 4, v7
  v_lshl_add_u32 v6, v6, 11, v7
  s_and_b32 s31, s16, 3
  s_lshl_b32 s31, s31, 3
  s_add_u32 s31, s31, s29
  s_lshl_b32 s31, s31, 16
  s_lshl_b32 s33, s18, 7
  s_add_u32 s31, s31, s33
  s_mov_b32 m0, s30
  s_nop 0
  buffer_load_dwordx4 v6, s[8:11], s31 offen lds
  s_add_u32 m0, m0, 1024
  s_add_u32 s31, s31, 16384
  buffer_load_dwordx4 v6, s[8:11], s31 offen lds
  s_add_u32 m0, m0, 1024
  s_add_u32 s31, s31, 16384
  buffer_load_dwordx4 v6, s[8:11], s31 offen lds
  s_add_u32 m0, m0, 1024
  s_add_u32 s31, s31, 16384
  buffer_load_dwordx4 v6, s[8:11], s31 offen lds
  s_add_u32 m0, m0, 1024
  s_add_u32 s31, s31, 81920
  buffer_load_dwordx4 v6, s[8:11], s31 offen lds
  s_add_u32 m0, m0, 1024
  s_add_u32 s31, s31, 16384
  buffer_load_dwordx4 v6, s[8:11], s31 offen lds
  s_add_u32 m0, m0, 1024
  s_add_u32 s31, s31, 16384
  buffer_load_dwordx4 v6, s[8:11], s31 offen lds
  s_add_u32 m0, m0, 1024
  s_add_u32 s31, s31, 16384
  buffer_load_dwordx4 v6, s[8:11], s31 offen lds
  s_add_u32 m0, m0, 1024
  s_add_u32 s31, s31, 81920
  buffer_load_dwordx4 v6, s[8:11], s31 offen lds
  s_add_u32 m0, m0, 1024
  s_add_u32 s31, s31, 16384
  buffer_load_dwordx4 v6, s[8:11], s31 offen lds
  s_add_u32 m0, m0, 1024
  s_add_u32 s31, s31, 16384
  buffer_load_dwordx4 v6, s[8:11], s31 offen lds
  s_add_u32 m0, m0, 1024
  s_add_u32 s31, s31, 16384
  buffer_load_dwordx4 v6, s[8:11], s31 offen lds
  s_add_u32 m0, m0, 1024
  s_add_u32 s31, s31, 81920
  buffer_load_dwordx4 v6, s[8:11], s31 offen lds
  s_add_u32 m0, m0, 1024
  s_add_u32 s31, s31, 16384
  buffer_load_dwordx4 v6, s[8:11], s31 offen lds
  s_add_u32 m0, m0, 1024
  s_add_u32 s31, s31, 16384
  buffer_load_dwordx4 v6, s[8:11], s31 offen lds
  s_add_u32 m0, m0, 1024
  s_add_u32 s31, s31, 16384
  buffer_load_dwordx4 v6, s[8:11], s31 offen lds
  s_setpc_b64 s[68:69]
.g2_kernel_v_cmb:
  s_and_b32 s28, s16, 3
  s_lshl_b32 s30, s28, 2
  s_lshl_b32 s34, 15, s30
  v_and_b32 v6, 15, v2
  v_lshlrev_b32 v6, 2, v6
  v_add_u32 v6, 155968, v6
  s_lshl_b32 s30, s28, 14
  v_add_u32 v12, s30, v3
  v_and_b32 v13, 31, v2
  s_lshl_b32 s31, s28, 9
  s_add_u32 s31, s31, 161280
  v_lshl_add_u32 v13, v13, 2, s31
  s_lshl_b32 s33, s62, 1
  s_add_u32 s33, s33, s29
  s_lshl_b32 s31, s17, 2
  s_add_u32 s31, s31, s28
  s_lshl_b32 s31, s31, 1
  s_add_u32 s31, s31, s29
  s_lshl_b32 s31, s31, 4
  s_add_u32 s31, s31, s18
  s_lshl_b32 s31, s31, 11
  s_add_u32 s31, s31, s63
  s_add_u32 s35, s31, 0x800000
  v_mov_b32 v14, 8.673617379884035e-19
  v_mov_b32 v15, 1.152921504606847e+18
  s_mov_b32 s38, 0
.g2_kernel_v_cmbw:
  ds_read_b32 v7, v6
  s_add_u32 s38, s38, 1
  s_waitcnt lgkmcnt(0)
  v_cmp_ge_u32 vcc, s33, v7
  s_and_b32 s30, vcc_lo, s34
  s_cbranch_scc0 .g2_kernel_v_cmbd
  s_cmp_lg_u32 vcc_lo, -1
  s_cbranch_scc1 .g2_kernel_v_cmbq
  s_sleep 12
.g2_kernel_v_cmbq:
  s_cmp_lt_u32 s38, 524288
  s_cbranch_scc1 .g2_kernel_v_cmbw
.g2_kernel_v_cmbd:
  s_setprio 3
  s_lshl_b32 s30, s28, 2
  s_add_u32 s30, s30, s71
  v_mov_b32 v7, s30
  ds_read_b128 v[16:19], v12 offset:0
  ds_read_b128 v[20:23], v12 offset:1024
  ds_read_b128 v[24:27], v12 offset:2048
  ds_read_b128 v[28:31], v12 offset:3072
  ds_read_b128 v[32:35], v12 offset:4096
  ds_read_b128 v[36:39], v12 offset:5120
  ds_read_b128 v[40:43], v12 offset:6144
  ds_read_b128 v[44:47], v12 offset:7168
  ds_read_b128 v[48:51], v12 offset:8192
  ds_read_b128 v[52:55], v12 offset:9216
  ds_read_b128 v[56:59], v12 offset:10240
  ds_read_b128 v[60:63], v12 offset:11264
  s_waitcnt lgkmcnt(4)
  ds_read_b32 v8, v13 offset:0
  ds_read_b32 v9, v13 offset:128
  ds_read_b32 v10, v13 offset:256
  ds_read_b32 v11, v13 offset:384
  v_add_f32 v16, v16, v32
  v_add_f32 v17, v17, v33
  v_add_f32 v18, v18, v34
  v_add_f32 v19, v19, v35
  v_add_f32 v20, v20, v36
  v_add_f32 v21, v21, v37
  v_add_f32 v22, v22, v38
  v_add_f32 v23, v23, v39
  v_add_f32 v24, v24, v40
  v_add_f32 v25, v25, v41
  v_add_f32 v26, v26, v42
  v_add_f32 v27, v27, v43
  v_add_f32 v28, v28, v44
  v_add_f32 v29, v29, v45
  v_add_f32 v30, v30, v46
  v_add_f32 v31, v31, v47
  ds_read_b128 v[32:35], v12 offset:12288
  ds_read_b128 v[36:39], v12 offset:13312
  ds_read_b128 v[40:43], v12 offset:14336
  ds_read_b128 v[44:47], v12 offset:15360
  s_waitcnt lgkmcnt(4)
  v_add_f32 v16, v16, v48
  v_add_f32 v17, v17, v49
  v_add_f32 v18, v18, v50
  v_add_f32 v19, v19, v51
  v_add_f32 v20, v20, v52
  v_add_f32 v21, v21, v53
  v_add_f32 v22, v22, v54
  v_add_f32 v23, v23, v55
  v_add_f32 v24, v24, v56
  v_add_f32 v25, v25, v57
  v_add_f32 v26, v26, v58
  v_add_f32 v27, v27, v59
  v_add_f32 v28, v28, v60
  v_add_f32 v29, v29, v61
  v_add_f32 v30, v30, v62
  v_add_f32 v31, v31, v63
  v_add_f32 v8, v8, v10
  v_add_f32 v9, v9, v11
  v_add_f32 v9, v8, v9
  v_cmp_ge_f32 vcc, v9, v14
  v_cmp_le_f32 s[36:37], v9, v15
  v_rcp_f32 v10, v9
  v_mul_f32 v15, v15, v15
  v_mov_b32 v11, s29
  s_waitcnt lgkmcnt(0)
  ds_write_b32 v7, v11 offset:64
  v_add_f32 v16, v16, v32
  v_add_f32 v17, v17, v33
  v_add_f32 v18, v18, v34
  v_add_f32 v19, v19, v35
  v_add_f32 v20, v20, v36
  v_add_f32 v21, v21, v37
  v_add_f32 v22, v22, v38
  v_add_f32 v23, v23, v39
  v_add_f32 v24, v24, v40
  v_add_f32 v25, v25, v41
  v_add_f32 v26, v26, v42
  v_add_f32 v27, v27, v43
  v_add_f32 v28, v28, v44
  v_add_f32 v29, v29, v45
  v_add_f32 v30, v30, v46
  v_add_f32 v31, v31, v47
  s_and_b64 s[36:37], s[36:37], vcc
  v_maximum3_f32 v48, abs(v16), abs(v17), abs(v18)
  v_maximum3_f32 v49, abs(v19), abs(v20), abs(v21)
  v_maximum3_f32 v50, abs(v22), abs(v23), abs(v24)
  v_maximum3_f32 v51, abs(v25), abs(v26), abs(v27)
  v_maximum3_f32 v52, abs(v28), abs(v29), abs(v30)
  v_maximum3_f32 v48, v48, v49, abs(v31)
  v_maximum3_f32 v50, v50, v51, v52
  v_maximum3_f32 v48, v48, v50, v50
  v_cmp_le_f32 vcc, v48, v15
  s_and_b64 vcc, vcc, s[36:37]
  s_cmp_eq_u64 vcc, -1
  s_cbranch_scc0 .g2_kernel_v_cmbslow
.g2_kernel_v_cmbfin:
  v_mul_f32 v16, v16, v10
  v_mul_f32 v17, v17, v10
  v_mul_f32 v18, v18, v10
  v_mul_f32 v19, v19, v10
  v_mul_f32 v20, v20, v10
  v_mul_f32 v21, v21, v10
  v_mul_f32 v22, v22, v10
  v_mul_f32 v23, v23, v10
  v_cvt_pk_bf16_f32 v32, v16, v17
  v_cvt_pk_bf16_f32 v33, v18, v19
  v_cvt_pk_bf16_f32 v34, v20, v21
  v_cvt_pk_bf16_f32 v35, v22, v23
  v_max_u32 v32, 1, v32
  v_max_u32 v34, 1, v34
  buffer_store_dwordx4 v[32:35], v3, s[4:7], s35 offen offset:0 sc1
  v_mul_f32 v24, v24, v10
  v_mul_f32 v25, v25, v10
  v_mul_f32 v26, v26, v10
  v_mul_f32 v27, v27, v10
  v_mul_f32 v28, v28, v10
  v_mul_f32 v29, v29, v10
  v_mul_f32 v30, v30, v10
  v_mul_f32 v31, v31, v10
  v_cvt_pk_bf16_f32 v36, v24, v25
  v_cvt_pk_bf16_f32 v37, v26, v27
  v_cvt_pk_bf16_f32 v38, v28, v29
  v_cvt_pk_bf16_f32 v39, v30, v31
  v_max_u32 v36, 1, v36
  v_max_u32 v38, 1, v38
  buffer_store_dwordx4 v[36:39], v3, s[4:7], s35 offen offset:1024 sc1
  s_setprio 3
  s_setpc_b64 s[68:69]
.g2_kernel_v_cmbslow:
  s_setprio 0
  s_lshl_b32 s30, s28, 11
  s_mul_i32 s31, s29, -8192
  s_add_u32 s30, s30, s31
  s_add_u32 s30, s30, 139264
  v_add_u32 v6, s30, v3
  ds_read_b128 v[48:51], v6
  ds_read_b128 v[52:55], v6 offset:1024
  s_lshl_b32 s36, s18, 1
  s_add_u32 s36, s36, s29
  s_lshl_b32 s36, s36, 18
  s_add_u32 s36, s36, s63
  s_mov_b32 s30, s36
  s_mov_b32 s33, 64
  v_mov_b32 v10, 0xff800000
  s_waitcnt lgkmcnt(0)
.g2_kernel_v_cmbs1:
  buffer_load_dwordx4 v[56:59], v3, s[4:7], s30 offen offset:0
  buffer_load_dwordx4 v[60:63], v3, s[4:7], s30 offen offset:1024
  s_waitcnt vmcnt(0)
  v_mfma_f32_32x32x16_bf16 v[32:47], v[56:59], v[48:51], 0
  v_mfma_f32_32x32x16_bf16 v[32:47], v[60:63], v[52:55], v[32:47]
  s_nop 11
  v_max3_f32 v10, v10, v32, v33
  v_max3_f32 v10, v10, v34, v35
  v_max3_f32 v10, v10, v36, v37
  v_max3_f32 v10, v10, v38, v39
  v_max3_f32 v10, v10, v40, v41
  v_max3_f32 v10, v10, v42, v43
  v_max3_f32 v10, v10, v44, v45
  v_max3_f32 v10, v10, v46, v47
  s_add_u32 s30, s30, 4096
  s_sub_u32 s33, s33, 1
  s_cmp_lg_u32 s33, 0
  s_cbranch_scc1 .g2_kernel_v_cmbs1
  v_mov_b32 v11, v10
  s_nop 1
  v_permlane32_swap_b32 v11, v10
  v_max_f32 v10, v10, v11
  v_mov_b32 v9, 0
  v_mov_b32 v16, 0
  v_mov_b32 v17, 0
  v_mov_b32 v18, 0
  v_mov_b32 v19, 0
  v_mov_b32 v20, 0
  v_mov_b32 v21, 0
  v_mov_b32 v22, 0
  v_mov_b32 v23, 0
  v_mov_b32 v24, 0
  v_mov_b32 v25, 0
  v_mov_b32 v26, 0
  v_mov_b32 v27, 0
  v_mov_b32 v28, 0
  v_mov_b32 v29, 0
  v_mov_b32 v30, 0
  v_mov_b32 v31, 0
  s_mov_b32 s30, s36
  s_mov_b32 s33, 64
.g2_kernel_v_cmbs2:
  buffer_load_dwordx4 v[56:59], v3, s[4:7], s30 offen offset:0
  buffer_load_dwordx4 v[60:63], v3, s[4:7], s30 offen offset:1024
  s_waitcnt vmcnt(0)
  v_mfma_f32_32x32x16_bf16 v[32:47], v[56:59], v[48:51], 0
  v_mfma_f32_32x32x16_bf16 v[32:47], v[60:63], v[52:55], v[32:47]
  s_nop 11
  v_sub_f32 v32, v32, v10
  v_sub_f32 v33, v33, v10
  v_sub_f32 v34, v34, v10
  v_sub_f32 v35, v35, v10
  v_sub_f32 v36, v36, v10
  v_sub_f32 v37, v37, v10
  v_sub_f32 v38, v38, v10
  v_sub_f32 v39, v39, v10
  v_sub_f32 v40, v40, v10
  v_sub_f32 v41, v41, v10
  v_sub_f32 v42, v42, v10
  v_sub_f32 v43, v43, v10
  v_sub_f32 v44, v44, v10
  v_sub_f32 v45, v45, v10
  v_sub_f32 v46, v46, v10
  v_sub_f32 v47, v47, v10
  buffer_load_dwordx4 v[56:59], v3, s[4:7], s30 offen offset:2048
  buffer_load_dwordx4 v[60:63], v3, s[4:7], s30 offen offset:3072
  v_exp_f32 v32, v32
  v_exp_f32 v33, v33
  v_exp_f32 v34, v34
  v_exp_f32 v35, v35
  v_exp_f32 v36, v36
  v_exp_f32 v37, v37
  v_exp_f32 v38, v38
  v_exp_f32 v39, v39
  v_exp_f32 v40, v40
  v_exp_f32 v41, v41
  v_exp_f32 v42, v42
  v_exp_f32 v43, v43
  v_exp_f32 v44, v44
  v_exp_f32 v45, v45
  v_exp_f32 v46, v46
  v_exp_f32 v47, v47
  v_add_f32 v9, v9, v32
  v_add_f32 v9, v9, v33
  v_add_f32 v9, v9, v34
  v_add_f32 v9, v9, v35
  v_add_f32 v9, v9, v36
  v_add_f32 v9, v9, v37
  v_add_f32 v9, v9, v38
  v_add_f32 v9, v9, v39
  v_add_f32 v9, v9, v40
  v_add_f32 v9, v9, v41
  v_add_f32 v9, v9, v42
  v_add_f32 v9, v9, v43
  v_add_f32 v9, v9, v44
  v_add_f32 v9, v9, v45
  v_add_f32 v9, v9, v46
  v_add_f32 v9, v9, v47
  v_cvt_pk_bf16_f32 v32, v32, v33
  v_cvt_pk_bf16_f32 v33, v34, v35
  v_cvt_pk_bf16_f32 v34, v36, v37
  v_cvt_pk_bf16_f32 v35, v38, v39
  v_cvt_pk_bf16_f32 v36, v40, v41
  v_cvt_pk_bf16_f32 v37, v42, v43
  v_cvt_pk_bf16_f32 v38, v44, v45
  v_cvt_pk_bf16_f32 v39, v46, v47
  s_waitcnt vmcnt(0)
  v_mfma_f32_32x32x16_bf16 v[16:31], v[56:59], v[32:35], v[16:31]
  v_mfma_f32_32x32x16_bf16 v[16:31], v[60:63], v[36:39], v[16:31]
  s_nop 15
  s_add_u32 s30, s30, 4096
  s_sub_u32 s33, s33, 1
  s_cmp_lg_u32 s33, 0
  s_cbranch_scc1 .g2_kernel_v_cmbs2
  v_mov_b32 v11, v9
  s_nop 1
  v_permlane32_swap_b32 v11, v9
  v_add_f32 v9, v9, v11
  v_rcp_f32 v10, v9
  s_branch .g2_kernel_v_cmbfin
.g2_kernel_p2_xw:
  s_mov_b32 s38, 0
.g2_kernel_p2_xwl:
  ds_read_b32 v12, v11
  s_add_u32 s38, s38, 1
  s_waitcnt lgkmcnt(0)
  v_cmp_ne_u32 vcc, 0, v12
  s_and_b32 s37, vcc_lo, vcc_hi
  s_lshr_b32 s33, s37, 16
  s_and_b32 s37, s37, s33
  s_bitcmp1_b32 s37, s28
  s_cbranch_scc1 .g2_kernel_p2_xwr
  s_sleep 1
  s_cmp_lt_u32 s38, 524288
  s_cbranch_scc1 .g2_kernel_p2_xwl
.g2_kernel_p2_xwr:
  s_setpc_b64 s[68:69]
.g2_kernel_p2_x0w:
  s_call_b64 s[68:69], .g2_kernel_p2_xw
  s_branch .g2_kernel_p2_x0b
.g2_kernel_p2_x1w:
  s_call_b64 s[68:69], .g2_kernel_p2_xw
  s_branch .g2_kernel_p2_x1b
.g2_kernel_p2_x2w:
  s_call_b64 s[68:69], .g2_kernel_p2_xw
  s_branch .g2_kernel_p2_x2b
.g2_kernel_p2_aw:
  s_call_b64 s[68:69], .g2_kernel_p_spin
  s_branch .g2_kernel_p2_ai
.g2_kernel_p2_x3w:
  s_call_b64 s[68:69], .g2_kernel_p2_xw
  s_branch .g2_kernel_p2_x3b
.g2_kernel_p2_bw:
  s_call_b64 s[68:69], .g2_kernel_p_spin
  s_branch .g2_kernel_p2_bi
  .p2align 8
.g2_kernel_tab:
  .long 0, 1, 2, 3, 4, 5, 6, 7
  .long 8, 9, 10, 11, 12, 13, 14, 15
  .long 16, 17, 18, 19, 20, 21, 22, 23
  .long 24, 25, 26, 27, 28, 29, 30, 31
  .long 32, 33, 34, 35, 36, 37, 38, 39
  .long 40, 41, 42, 43, 44, 45, 46, 47
  .long 48, 49, 50, 51, 52, 53, 54, 55
  .long 56, 57, 58, 59, 60, 61, 62, 63
  .long 64, 65, 66, 67, 68, 69, 70, 71
.g2_kernel_cend:

.section .rodata,"a"
.p2align 6
.amdhsa_kernel g2_kernel
  .amdhsa_next_free_vgpr 256
  .amdhsa_next_free_sgpr 102
  .amdhsa_accum_offset 256
  .amdhsa_group_segment_fixed_size 0
  .amdhsa_kernarg_size 88
  .amdhsa_user_sgpr_count 2
  .amdhsa_user_sgpr_kernarg_segment_ptr 1
  .amdhsa_system_sgpr_workgroup_id_x 1
.end_amdhsa_kernel
```

```asm
; @launch kernel=g2_kernel grid=(256,1,1) block=(512,1,1) lds=163840
.amdgcn_target "amdgcn-amd-amdhsa--gfx950"
.text
.globl g2_kernel
.p2align 8
.type g2_kernel,@function
g2_kernel:
  s_cmp_ge_u32 s2, 256
  s_cbranch_scc1 .g2_kernel_end
  s_load_dwordx16 s[40:55], s[0:1], 0
  s_load_dwordx4 s[56:59], s[0:1], 64
  s_load_dwordx2 s[60:61], s[0:1], 80
  s_getpc_b64 s[64:65]
.g2_kernel_pc:
  s_mov_b32 s66, .g2_kernel_cend-.g2_kernel_pc
  s_mov_b32 s67, 0x00020000
  s_lshl_b32 s12, s2, 10
  s_and_b32 s12, s12, 0xe000
  v_lshrrev_b32 v3, 3, v0
  v_and_b32 v2, 7, v0
  v_and_b32 v3, 0x38, v3
  v_add_lshl_u32 v3, v3, v2, 7
  s_mov_b64 exec, 0xff
  buffer_load_dword v1, v3, s[64:67], s12 offen
  s_mov_b64 exec, -1
  v_lshrrev_b32 v3, 6, v0
  v_and_b32 v2, 63, v0
  v_readfirstlane_b32 s16, v3
  s_and_b32 s21, s2, 7
  s_lshr_b32 s22, s2, 3
  s_and_b32 s23, s21, 3
  s_lshl_b32 s23, s23, 2
  s_and_b32 s24, s22, 3
  s_add_u32 s18, s23, s24
  s_lshr_b32 s24, s21, 2
  s_lshl_b32 s24, s24, 3
  s_lshr_b32 s25, s22, 2
  s_add_u32 s17, s24, s25
  s_lshl_b32 s19, s17, 4
  s_add_u32 s19, s19, s18
  s_lshl_b32 s19, s19, 9
  s_add_u32 s19, s19, 0x3000000
  s_lshl_b32 s76, s18, 4
  s_add_u32 s76, s76, s17
  s_lshl_b32 s76, s76, 9
  s_add_u32 s76, s76, 0x3020000
  v_lshlrev_b32 v3, 4, v2
  v_mov_b32 v4, 0
  v_mov_b32 v5, 1
  s_mov_b32 s62, 0
  s_mov_b32 s63, 0
  s_mov_b32 s70, 1
  s_mov_b32 s71, 155648
  s_waitcnt lgkmcnt(0)
  s_mov_b32 s4, s60
  s_mov_b32 s5, s61
  s_mov_b32 s6, 0x3200000
  s_mov_b32 s7, 0x00020000
  s_cmp_ge_u32 s16, 4
  s_cbranch_scc1 .g2_kernel_svc
  v_mov_b32 v20, 0
  v_mov_b32 v21, 0
  v_mov_b32 v22, 0
  v_mov_b32 v23, 0
  v_lshlrev_b32 v24, 4, v0
  v_cmp_gt_u32 vcc, 2816, v24
  v_add_u32 v24, 155648, v24
  s_and_saveexec_b64 s[20:21], vcc
  s_cbranch_execz .g2_kernel_q_nz
  ds_write_b128 v24, v[20:23]
.g2_kernel_q_nz:
  s_mov_b64 exec, -1
  v_and_b32 v20, 15, v2
  v_lshrrev_b32 v21, 4, v2
  v_lshrrev_b32 v22, 1, v20
  v_xor_b32 v22, v22, v21
  v_lshlrev_b32 v22, 4, v22
  v_lshl_add_u32 v22, v20, 7, v22
  s_lshr_b32 s26, s16, 1
  s_lshl_b32 s26, s26, 13
  v_add_u32 v144, s26, v22
  v_xor_b32 v145, 64, v144
.g2_kernel_q_cs:
  s_and_b32 s27, s16, 1
  s_lshr_b32 s26, s16, 1
  v_bfe_u32 v20, v2, 2, 2
  v_lshrrev_b32 v49, 4, v2
  v_lshl_add_u32 v22, v49, 3, v20
  v_lshlrev_b32 v22, 7, v22
  v_lshrrev_b32 v23, 1, v20
  v_and_b32 v21, 1, v49
  v_xor_b32 v21, s27, v21
  v_lshl_add_u32 v23, v21, 1, v23
  v_lshl_add_u32 v22, v23, 5, v22
  v_and_b32 v23, 3, v2
  v_lshl_add_u32 v22, v23, 3, v22
  v_add_u32 v148, 65536, v22
  v_xor_b32 v149, 32, v148
  v_mov_b32 v146, v148
  v_mov_b32 v147, v149
  v_mov_b32 v150, 156160
  v_and_b32 v48, 15, v2
  s_lshl_b32 s28, s26, 8
  s_add_u32 s28, s28, 155648
  v_lshl_add_u32 v50, v48, 2, s28
  v_lshl_add_u32 v51, v49, 4, s28
  s_lshl_b32 s28, s27, 7
  s_add_u32 s28, s28, 155648
  v_lshl_add_u32 v52, v49, 4, s28
  v_lshl_add_u32 v53, v48, 2, s28
  v_lshlrev_b32 v54, 9, v49
  v_lshl_add_u32 v55, v48, 4, v54
  v_and_b32 v56, 8, v48
  v_lshl_add_u32 v54, v56, 4, v55
  v_mov_b32 v56, 0.25503486164919736
  v_lshlrev_b32 v58, 8, v2
  v_and_b32 v58, 0x300, v58
  v_add_u32 v58, 156416, v58
  s_lshl_b32 s8, s18, 1
  s_add_u32 s8, s8, s27
  s_lshl_b32 s8, s8, 6
  s_lshl_b32 s9, s17, 2
  s_add_u32 s8, s8, s9
  s_lshl_b32 s9, s26, 1
  s_add_u32 s8, s8, s9
  s_lshl_b32 s8, s8, 12
  s_add_u32 s8, s8, s63
  s_add_u32 s9, s8, 4096
  s_lshl_b32 s28, s26, 13
  s_lshl_b32 s10, s27, 14
  s_add_u32 s28, s28, s10
  v_add_u32 v59, s28, v54
  v_add_u32 v60, s28, v55
  s_lshl_b32 s28, s26, 12
  s_mul_i32 s10, s27, -8192
  s_add_u32 s28, s28, s10
  s_add_u32 s28, s28, 139264
  v_add_u32 v61, s28, v55
  s_mov_b32 s10, s27
  s_lshl_b32 s77, s18, 4
  s_add_u32 s77, s77, s17
  s_lshl_b32 s77, s77, 1
  s_add_u32 s77, s77, s26
  s_lshl_b32 s77, s77, 13
  s_add_u32 s77, s77, s63
  s_add_u32 s77, s77, 0x1400000
  s_lshl_b32 s28, s27, 30
  s_add_u32 s77, s77, s28
  s_lshl_b32 s12, s62, 5
  s_add_u32 s12, s12, 28
  v_and_b32 v6, 15, v2
  v_xor_b32 v6, s17, v6
  v_and_b32 v7, 16, v2
  v_add_u32 v6, v6, v7
  s_lshr_b32 s28, s16, 1
  s_lshl_b32 s28, s28, 7
  s_add_u32 s28, s28, 157440
  v_lshl_add_u32 v8, v6, 2, s28
  s_lshl_b32 s28, s16, 12
  v_add_u32 v9, s28, v3
  v_and_b32 v6, 31, v2
  s_lshl_b32 s28, s16, 7
  s_add_u32 s28, s28, 161280
  v_lshl_add_u32 v10, v6, 2, s28
  s_lshl_b32 s28, s16, 2
  s_add_u32 s28, s28, 155968
  v_mov_b32 v11, s28
  s_lshl_b32 s28, s62, 1
  s_add_u32 s28, s28, 1
  v_mov_b32 v12, s28
  v_mov_b32 v13, s71
  v_add_u32 v14, 131072, v3
  v_and_b32 v6, 4, v2
  v_cmp_eq_u32 vcc, 0, v6
  v_mov_b32 v7, 0x3f803f80
  v_and_b32 v6, 1, v2
  v_cndmask_b32 v16, 0, v7, vcc
  v_cndmask_b32 v17, 0, v7, vcc
  v_cndmask_b32 v18, v7, 0, vcc
  v_cndmask_b32 v19, v7, 0, vcc
  v_mul_u32_u24 v20, 0xaaaa, v6
  v_add_u32 v20, 0x4444, v20
  s_lshl_b32 s28, s18, 7
  s_add_u32 s28, s28, s16
  s_lshl_b32 s28, s28, 12
  s_add_u32 s28, s28, s63
  s_add_u32 s20, s60, s28
  s_addc_u32 s21, s61, 0
  s_mov_b32 s24, s17
  s_mov_b32 s25, 14
  s_mov_b32 s26, 0
  s_mov_b32 s27, 6
  s_mov_b32 s34, 0xffff0001
  s_mov_b32 s35, 0
  s_mov_b32 s36, 0
  s_mov_b32 s39, 0
  s_lshl_b32 s28, s16, 7
  s_add_u32 s37, s76, s28
  v_mov_b32 v15, s70
  v_lshrrev_b32 v6, 5, v2
  v_and_b32 v7, 15, v2
  v_lshlrev_b32 v22, 4, v7
  v_lshl_add_u32 v22, v6, 8, v22
  v_and_b32 v7, 16, v2
  v_lshl_add_u32 v22, v7, 7, v22
  v_and_b32 v7, 31, v2
  v_lshlrev_b32 v23, 4, v6
  v_lshl_add_u32 v23, v7, 11, v23
  s_lshl_b32 s28, s17, 2
  s_add_u32 s28, s28, s16
  s_lshl_b32 s28, s28, 16
  s_lshl_b32 s29, s18, 7
  s_add_u32 s28, s28, s29
  s_add_u32 s74, s40, s28
  s_addc_u32 s75, s41, 0
  s_lshl_b32 s13, s17, 4
  s_add_u32 s13, s13, s18
  s_lshl_b32 s13, s13, 2
  s_add_u32 s13, s13, s16
  s_lshl_b32 s13, s13, 12
  s_add_u32 s13, s13, 0xc00000
  s_lshl_b32 s28, s16, 8
  s_add_u32 m0, s28, 156416
  s_lshl_b32 s33, s62, 5
  s_lshl_b32 s31, s33, 2
  s_add_u32 s31, s31, .g2_kernel_tab-.g2_kernel_pc+4
  s_mov_b32 s29, 0
  s_cmp_lg_u32 s62, 0
  s_cbranch_scc1 .g2_kernel_q_i2
  s_waitcnt lgkmcnt(0)
  s_barrier
.g2_kernel_q_i3:
  s_call_b64 s[68:69], .g2_kernel_q_spin
  ds_read_b64_tr_b16 v[80:81], v146 offset:0
  ds_read_b64_tr_b16 v[82:83], v146 offset:512
  ds_read_b128 v[64:67], v144 offset:0
  ds_read_b128 v[68:71], v144 offset:2048
  ds_read_b128 v[72:75], v144 offset:4096
  ds_read_b128 v[76:79], v144 offset:6144
  ds_read_b64_tr_b16 v[84:85], v147 offset:0
  ds_read_b64_tr_b16 v[86:87], v147 offset:512
  ds_read_b64_tr_b16 v[88:89], v146 offset:4096
  ds_read_b64_tr_b16 v[90:91], v146 offset:4608
  ds_read_b64_tr_b16 v[92:93], v147 offset:4096
  ds_read_b64_tr_b16 v[94:95], v147 offset:4608
  ds_read_b64_tr_b16 v[96:97], v146 offset:8192
  ds_read_b64_tr_b16 v[98:99], v146 offset:8704
  ds_read_b64_tr_b16 v[100:101], v147 offset:8192
  ds_read_b64_tr_b16 v[102:103], v147 offset:8704
  s_mov_b32 s30, 12288
  s_add_u32 s33, s33, 1
  v_add_u32 v146, s30, v148
  v_add_u32 v147, s30, v149
  s_waitcnt lgkmcnt(0)
  v_mfma_f32_16x16x32_bf16 v[160:163], v[80:83], v[64:67], 0
  v_cmp_lt_i32 vcc, s33, v151
  v_mfma_f32_16x16x32_bf16 v[164:167], v[80:83], v[68:71], 0
  s_cbranch_vccz .g2_kernel_q_wf
.g2_kernel_q_backf:
  v_mfma_f32_16x16x32_bf16 v[168:171], v[80:83], v[72:75], 0
  ds_read_b64_tr_b16 v[120:121], v146 offset:0
  v_mfma_f32_16x16x32_bf16 v[172:175], v[80:83], v[76:79], 0
  ds_read_b64_tr_b16 v[122:123], v146 offset:512
  v_mfma_f32_16x16x32_bf16 v[188:191], v[84:87], v[76:79], 0
  ds_read_b128 v[104:107], v145 offset:0
  v_mfma_f32_16x16x32_bf16 v[184:187], v[84:87], v[72:75], 0
  ds_read_b128 v[108:111], v145 offset:2048
  v_mfma_f32_16x16x32_bf16 v[180:183], v[84:87], v[68:71], 0
  ds_read_b128 v[112:115], v145 offset:4096
  v_mfma_f32_16x16x32_bf16 v[176:179], v[84:87], v[64:67], 0
  ds_read_b128 v[116:119], v145 offset:6144
  v_mfma_f32_16x16x32_bf16 v[192:195], v[88:91], v[64:67], 0
  ds_read_b64_tr_b16 v[124:125], v147 offset:0
  v_mfma_f32_16x16x32_bf16 v[196:199], v[88:91], v[68:71], 0
  ds_read_b64_tr_b16 v[126:127], v147 offset:512
  v_mfma_f32_16x16x32_bf16 v[200:203], v[88:91], v[72:75], 0
  ds_read_b64_tr_b16 v[128:129], v146 offset:4096
  v_mfma_f32_16x16x32_bf16 v[204:207], v[88:91], v[76:79], 0
  ds_read_b64_tr_b16 v[130:131], v146 offset:4608
  v_mfma_f32_16x16x32_bf16 v[220:223], v[92:95], v[76:79], 0
  ds_read_b64_tr_b16 v[132:133], v147 offset:4096
  v_mfma_f32_16x16x32_bf16 v[216:219], v[92:95], v[72:75], 0
  ds_read_b64_tr_b16 v[134:135], v147 offset:4608
  v_mfma_f32_16x16x32_bf16 v[212:215], v[92:95], v[68:71], 0
  ds_read_b64_tr_b16 v[136:137], v146 offset:8192
  v_mfma_f32_16x16x32_bf16 v[208:211], v[92:95], v[64:67], 0
  ds_read_b64_tr_b16 v[138:139], v146 offset:8704
  v_mfma_f32_16x16x32_bf16 v[224:227], v[64:67], v[96:99], 0
  ds_read_b64_tr_b16 v[140:141], v147 offset:8192
  v_mfma_f32_16x16x32_bf16 v[228:231], v[68:71], v[96:99], 0
  ds_read_b64_tr_b16 v[142:143], v147 offset:8704
  v_mfma_f32_16x16x32_bf16 v[232:235], v[72:75], v[96:99], 0
  ds_read_b32 v151, v150
  s_add_u32 s30, s30, 12288
  v_mfma_f32_16x16x32_bf16 v[236:239], v[76:79], v[96:99], 0
  buffer_load_dword off, s[64:67], s31 lds
  s_cmp_eq_u32 s30, 86016
  v_mfma_f32_16x16x32_bf16 v[252:255], v[76:79], v[100:103], 0
  s_cselect_b32 s30, 0, s30
  s_add_u32 s31, s31, 4
  v_mfma_f32_16x16x32_bf16 v[248:251], v[72:75], v[100:103], 0
  v_add_u32 v146, s30, v148
  s_add_u32 s33, s33, 1
  v_mfma_f32_16x16x32_bf16 v[244:247], v[68:71], v[100:103], 0
  v_add_u32 v147, s30, v149
  v_mfma_f32_16x16x32_bf16 v[240:243], v[64:67], v[100:103], 0
  s_branch .g2_kernel_q_s1
  .p2align 6
.g2_kernel_q_loop:
  s_waitcnt lgkmcnt(0)
  v_mfma_f32_16x16x32_bf16 v[160:163], v[120:123], v[104:107], v[160:163]
  v_cmp_lt_i32 vcc, s33, v151
  v_mfma_f32_16x16x32_bf16 v[164:167], v[120:123], v[108:111], v[164:167]
  s_cbranch_vccz .g2_kernel_q_w7
.g2_kernel_q_back7:
  v_mfma_f32_16x16x32_bf16 v[168:171], v[120:123], v[112:115], v[168:171]
  ds_read_b64_tr_b16 v[80:81], v146 offset:0
  v_mfma_f32_16x16x32_bf16 v[172:175], v[120:123], v[116:119], v[172:175]
  ds_read_b64_tr_b16 v[82:83], v146 offset:512
  v_mfma_f32_16x16x32_bf16 v[188:191], v[124:127], v[116:119], v[188:191]
  ds_read_b128 v[64:67], v144 offset:0
  v_mfma_f32_16x16x32_bf16 v[184:187], v[124:127], v[112:115], v[184:187]
  ds_read_b128 v[68:71], v144 offset:2048
  v_mfma_f32_16x16x32_bf16 v[180:183], v[124:127], v[108:111], v[180:183]
  ds_read_b128 v[72:75], v144 offset:4096
  v_mfma_f32_16x16x32_bf16 v[176:179], v[124:127], v[104:107], v[176:179]
  ds_read_b128 v[76:79], v144 offset:6144
  v_mfma_f32_16x16x32_bf16 v[192:195], v[128:131], v[104:107], v[192:195]
  ds_read_b64_tr_b16 v[84:85], v147 offset:0
  v_mfma_f32_16x16x32_bf16 v[196:199], v[128:131], v[108:111], v[196:199]
  ds_read_b64_tr_b16 v[86:87], v147 offset:512
  v_mfma_f32_16x16x32_bf16 v[200:203], v[128:131], v[112:115], v[200:203]
  ds_read_b64_tr_b16 v[88:89], v146 offset:4096
  v_mfma_f32_16x16x32_bf16 v[204:207], v[128:131], v[116:119], v[204:207]
  ds_read_b64_tr_b16 v[90:91], v146 offset:4608
  v_mfma_f32_16x16x32_bf16 v[220:223], v[132:135], v[116:119], v[220:223]
  ds_read_b64_tr_b16 v[92:93], v147 offset:4096
  v_mfma_f32_16x16x32_bf16 v[216:219], v[132:135], v[112:115], v[216:219]
  ds_read_b64_tr_b16 v[94:95], v147 offset:4608
  v_mfma_f32_16x16x32_bf16 v[212:215], v[132:135], v[108:111], v[212:215]
  ds_read_b64_tr_b16 v[96:97], v146 offset:8192
  v_mfma_f32_16x16x32_bf16 v[208:211], v[132:135], v[104:107], v[208:211]
  ds_read_b64_tr_b16 v[98:99], v146 offset:8704
  v_mfma_f32_16x16x32_bf16 v[224:227], v[104:107], v[136:139], v[224:227]
  ds_read_b64_tr_b16 v[100:101], v147 offset:8192
  v_mfma_f32_16x16x32_bf16 v[228:231], v[108:111], v[136:139], v[228:231]
  ds_read_b64_tr_b16 v[102:103], v147 offset:8704
  v_mfma_f32_16x16x32_bf16 v[232:235], v[112:115], v[136:139], v[232:235]
  ds_read_b32 v151, v150
  s_add_u32 s30, s30, 12288
  v_mfma_f32_16x16x32_bf16 v[236:239], v[116:119], v[136:139], v[236:239]
  buffer_load_dword off, s[64:67], s31 lds
  s_cmp_eq_u32 s30, 86016
  v_mfma_f32_16x16x32_bf16 v[252:255], v[116:119], v[140:143], v[252:255]
  s_cselect_b32 s30, 0, s30
  s_add_u32 s31, s31, 4
  v_mfma_f32_16x16x32_bf16 v[248:251], v[112:115], v[140:143], v[248:251]
  v_add_u32 v146, s30, v148
  s_add_u32 s33, s33, 1
  v_mfma_f32_16x16x32_bf16 v[244:247], v[108:111], v[140:143], v[244:247]
  v_add_u32 v147, s30, v149
  v_mfma_f32_16x16x32_bf16 v[240:243], v[104:107], v[140:143], v[240:243]
  s_waitcnt lgkmcnt(0)
  v_mfma_f32_16x16x32_bf16 v[160:163], v[80:83], v[64:67], v[160:163]
  v_cmp_lt_i32 vcc, s33, v151
  v_mfma_f32_16x16x32_bf16 v[164:167], v[80:83], v[68:71], v[164:167]
  s_cbranch_vccz .g2_kernel_q_w0
.g2_kernel_q_back0:
  v_mfma_f32_16x16x32_bf16 v[168:171], v[80:83], v[72:75], v[168:171]
  ds_read_b64_tr_b16 v[120:121], v146 offset:0
  v_mfma_f32_16x16x32_bf16 v[172:175], v[80:83], v[76:79], v[172:175]
  ds_read_b64_tr_b16 v[122:123], v146 offset:512
  v_mfma_f32_16x16x32_bf16 v[188:191], v[84:87], v[76:79], v[188:191]
  ds_read_b128 v[104:107], v145 offset:0
  v_mfma_f32_16x16x32_bf16 v[184:187], v[84:87], v[72:75], v[184:187]
  ds_read_b128 v[108:111], v145 offset:2048
  v_mfma_f32_16x16x32_bf16 v[180:183], v[84:87], v[68:71], v[180:183]
  ds_read_b128 v[112:115], v145 offset:4096
  v_mfma_f32_16x16x32_bf16 v[176:179], v[84:87], v[64:67], v[176:179]
  ds_read_b128 v[116:119], v145 offset:6144
  v_mfma_f32_16x16x32_bf16 v[192:195], v[88:91], v[64:67], v[192:195]
  ds_read_b64_tr_b16 v[124:125], v147 offset:0
  v_mfma_f32_16x16x32_bf16 v[196:199], v[88:91], v[68:71], v[196:199]
  ds_read_b64_tr_b16 v[126:127], v147 offset:512
  v_mfma_f32_16x16x32_bf16 v[200:203], v[88:91], v[72:75], v[200:203]
  ds_read_b64_tr_b16 v[128:129], v146 offset:4096
  v_mfma_f32_16x16x32_bf16 v[204:207], v[88:91], v[76:79], v[204:207]
  ds_read_b64_tr_b16 v[130:131], v146 offset:4608
  v_mfma_f32_16x16x32_bf16 v[220:223], v[92:95], v[76:79], v[220:223]
  ds_read_b64_tr_b16 v[132:133], v147 offset:4096
  v_mfma_f32_16x16x32_bf16 v[216:219], v[92:95], v[72:75], v[216:219]
  ds_read_b64_tr_b16 v[134:135], v147 offset:4608
  v_mfma_f32_16x16x32_bf16 v[212:215], v[92:95], v[68:71], v[212:215]
  ds_read_b64_tr_b16 v[136:137], v146 offset:8192
  v_mfma_f32_16x16x32_bf16 v[208:211], v[92:95], v[64:67], v[208:211]
  ds_read_b64_tr_b16 v[138:139], v146 offset:8704
  v_mfma_f32_16x16x32_bf16 v[224:227], v[64:67], v[96:99], v[224:227]
  ds_read_b64_tr_b16 v[140:141], v147 offset:8192
  v_mfma_f32_16x16x32_bf16 v[228:231], v[68:71], v[96:99], v[228:231]
  ds_read_b64_tr_b16 v[142:143], v147 offset:8704
  v_mfma_f32_16x16x32_bf16 v[232:235], v[72:75], v[96:99], v[232:235]
  ds_read_b32 v151, v150
  s_add_u32 s30, s30, 12288
  v_mfma_f32_16x16x32_bf16 v[236:239], v[76:79], v[96:99], v[236:239]
  buffer_load_dword off, s[64:67], s31 lds
  s_cmp_eq_u32 s30, 86016
  v_mfma_f32_16x16x32_bf16 v[252:255], v[76:79], v[100:103], v[252:255]
  s_cselect_b32 s30, 0, s30
  s_add_u32 s31, s31, 4
  v_mfma_f32_16x16x32_bf16 v[248:251], v[72:75], v[100:103], v[248:251]
  v_add_u32 v146, s30, v148
  s_add_u32 s33, s33, 1
  v_mfma_f32_16x16x32_bf16 v[244:247], v[68:71], v[100:103], v[244:247]
  v_add_u32 v147, s30, v149
  v_mfma_f32_16x16x32_bf16 v[240:243], v[64:67], v[100:103], v[240:243]
.g2_kernel_q_s1:
  s_waitcnt lgkmcnt(0)
  v_mfma_f32_16x16x32_bf16 v[160:163], v[120:123], v[104:107], v[160:163]
  v_cmp_lt_i32 vcc, s33, v151
  v_mfma_f32_16x16x32_bf16 v[164:167], v[120:123], v[108:111], v[164:167]
  s_cbranch_vccz .g2_kernel_q_w1
.g2_kernel_q_back1:
  v_mfma_f32_16x16x32_bf16 v[168:171], v[120:123], v[112:115], v[168:171]
  ds_read_b64_tr_b16 v[80:81], v146 offset:0
  v_mfma_f32_16x16x32_bf16 v[172:175], v[120:123], v[116:119], v[172:175]
  ds_read_b64_tr_b16 v[82:83], v146 offset:512
  v_mfma_f32_16x16x32_bf16 v[188:191], v[124:127], v[116:119], v[188:191]
  ds_read_b128 v[64:67], v144 offset:16384
  v_mfma_f32_16x16x32_bf16 v[184:187], v[124:127], v[112:115], v[184:187]
  ds_read_b128 v[68:71], v144 offset:18432
  v_mfma_f32_16x16x32_bf16 v[180:183], v[124:127], v[108:111], v[180:183]
  ds_read_b128 v[72:75], v144 offset:20480
  v_mfma_f32_16x16x32_bf16 v[176:179], v[124:127], v[104:107], v[176:179]
  ds_read_b128 v[76:79], v144 offset:22528
  v_mfma_f32_16x16x32_bf16 v[192:195], v[128:131], v[104:107], v[192:195]
  ds_read_b64_tr_b16 v[84:85], v147 offset:0
  v_mfma_f32_16x16x32_bf16 v[196:199], v[128:131], v[108:111], v[196:199]
  ds_read_b64_tr_b16 v[86:87], v147 offset:512
  v_mfma_f32_16x16x32_bf16 v[200:203], v[128:131], v[112:115], v[200:203]
  ds_read_b64_tr_b16 v[88:89], v146 offset:4096
  v_mfma_f32_16x16x32_bf16 v[204:207], v[128:131], v[116:119], v[204:207]
  ds_read_b64_tr_b16 v[90:91], v146 offset:4608
  v_mfma_f32_16x16x32_bf16 v[220:223], v[132:135], v[116:119], v[220:223]
  ds_read_b64_tr_b16 v[92:93], v147 offset:4096
  v_mfma_f32_16x16x32_bf16 v[216:219], v[132:135], v[112:115], v[216:219]
  ds_read_b64_tr_b16 v[94:95], v147 offset:4608
  v_mfma_f32_16x16x32_bf16 v[212:215], v[132:135], v[108:111], v[212:215]
  ds_read_b64_tr_b16 v[96:97], v146 offset:8192
  v_mfma_f32_16x16x32_bf16 v[208:211], v[132:135], v[104:107], v[208:211]
  ds_read_b64_tr_b16 v[98:99], v146 offset:8704
  v_mfma_f32_16x16x32_bf16 v[224:227], v[104:107], v[136:139], v[224:227]
  ds_read_b64_tr_b16 v[100:101], v147 offset:8192
  v_mfma_f32_16x16x32_bf16 v[228:231], v[108:111], v[136:139], v[228:231]
  ds_read_b64_tr_b16 v[102:103], v147 offset:8704
  v_mfma_f32_16x16x32_bf16 v[232:235], v[112:115], v[136:139], v[232:235]
  ds_read_b32 v151, v150
  s_add_u32 s30, s30, 12288
  v_mfma_f32_16x16x32_bf16 v[236:239], v[116:119], v[136:139], v[236:239]
  buffer_load_dword off, s[64:67], s31 lds
  s_cmp_eq_u32 s30, 86016
  v_mfma_f32_16x16x32_bf16 v[252:255], v[116:119], v[140:143], v[252:255]
  s_cselect_b32 s30, 0, s30
  s_add_u32 s31, s31, 4
  v_mfma_f32_16x16x32_bf16 v[248:251], v[112:115], v[140:143], v[248:251]
  v_add_u32 v146, s30, v148
  s_add_u32 s33, s33, 1
  v_mfma_f32_16x16x32_bf16 v[244:247], v[108:111], v[140:143], v[244:247]
  v_add_u32 v147, s30, v149
  v_mfma_f32_16x16x32_bf16 v[240:243], v[104:107], v[140:143], v[240:243]
  s_waitcnt lgkmcnt(0)
  v_mfma_f32_16x16x32_bf16 v[160:163], v[80:83], v[64:67], v[160:163]
  v_cmp_lt_i32 vcc, s33, v151
  v_mfma_f32_16x16x32_bf16 v[164:167], v[80:83], v[68:71], v[164:167]
  s_cbranch_vccz .g2_kernel_q_w2
.g2_kernel_q_back2:
  v_mfma_f32_16x16x32_bf16 v[168:171], v[80:83], v[72:75], v[168:171]
  ds_read_b64_tr_b16 v[120:121], v146 offset:0
  v_mfma_f32_16x16x32_bf16 v[172:175], v[80:83], v[76:79], v[172:175]
  ds_read_b64_tr_b16 v[122:123], v146 offset:512
  v_mfma_f32_16x16x32_bf16 v[188:191], v[84:87], v[76:79], v[188:191]
  ds_read_b128 v[104:107], v145 offset:16384
  v_mfma_f32_16x16x32_bf16 v[184:187], v[84:87], v[72:75], v[184:187]
  ds_read_b128 v[108:111], v145 offset:18432
  v_mfma_f32_16x16x32_bf16 v[180:183], v[84:87], v[68:71], v[180:183]
  ds_read_b128 v[112:115], v145 offset:20480
  v_mfma_f32_16x16x32_bf16 v[176:179], v[84:87], v[64:67], v[176:179]
  ds_read_b128 v[116:119], v145 offset:22528
  v_mfma_f32_16x16x32_bf16 v[192:195], v[88:91], v[64:67], v[192:195]
  ds_read_b64_tr_b16 v[124:125], v147 offset:0
  v_mfma_f32_16x16x32_bf16 v[196:199], v[88:91], v[68:71], v[196:199]
  ds_read_b64_tr_b16 v[126:127], v147 offset:512
  v_mfma_f32_16x16x32_bf16 v[200:203], v[88:91], v[72:75], v[200:203]
  ds_read_b64_tr_b16 v[128:129], v146 offset:4096
  v_mfma_f32_16x16x32_bf16 v[204:207], v[88:91], v[76:79], v[204:207]
  ds_read_b64_tr_b16 v[130:131], v146 offset:4608
  v_mfma_f32_16x16x32_bf16 v[220:223], v[92:95], v[76:79], v[220:223]
  ds_read_b64_tr_b16 v[132:133], v147 offset:4096
  v_mfma_f32_16x16x32_bf16 v[216:219], v[92:95], v[72:75], v[216:219]
  ds_read_b64_tr_b16 v[134:135], v147 offset:4608
  v_mfma_f32_16x16x32_bf16 v[212:215], v[92:95], v[68:71], v[212:215]
  ds_read_b64_tr_b16 v[136:137], v146 offset:8192
  v_mfma_f32_16x16x32_bf16 v[208:211], v[92:95], v[64:67], v[208:211]
  ds_read_b64_tr_b16 v[138:139], v146 offset:8704
  v_mfma_f32_16x16x32_bf16 v[224:227], v[64:67], v[96:99], v[224:227]
  ds_read_b64_tr_b16 v[140:141], v147 offset:8192
  v_mfma_f32_16x16x32_bf16 v[228:231], v[68:71], v[96:99], v[228:231]
  ds_read_b64_tr_b16 v[142:143], v147 offset:8704
  v_mfma_f32_16x16x32_bf16 v[232:235], v[72:75], v[96:99], v[232:235]
  ds_read_b32 v151, v150
  s_add_u32 s30, s30, 12288
  v_mfma_f32_16x16x32_bf16 v[236:239], v[76:79], v[96:99], v[236:239]
  buffer_load_dword off, s[64:67], s31 lds
  s_cmp_eq_u32 s30, 86016
  v_mfma_f32_16x16x32_bf16 v[252:255], v[76:79], v[100:103], v[252:255]
  s_cselect_b32 s30, 0, s30
  s_add_u32 s31, s31, 4
  v_mfma_f32_16x16x32_bf16 v[248:251], v[72:75], v[100:103], v[248:251]
  v_add_u32 v146, s30, v148
  s_add_u32 s33, s33, 1
  v_mfma_f32_16x16x32_bf16 v[244:247], v[68:71], v[100:103], v[244:247]
  v_add_u32 v147, s30, v149
  v_mfma_f32_16x16x32_bf16 v[240:243], v[64:67], v[100:103], v[240:243]
  s_waitcnt lgkmcnt(0)
  v_mfma_f32_16x16x32_bf16 v[160:163], v[120:123], v[104:107], v[160:163]
  v_cmp_lt_i32 vcc, s33, v151
  v_mfma_f32_16x16x32_bf16 v[164:167], v[120:123], v[108:111], v[164:167]
  s_cbranch_vccz .g2_kernel_q_w3
.g2_kernel_q_back3:
  v_mfma_f32_16x16x32_bf16 v[168:171], v[120:123], v[112:115], v[168:171]
  ds_read_b64_tr_b16 v[80:81], v146 offset:0
  v_mfma_f32_16x16x32_bf16 v[172:175], v[120:123], v[116:119], v[172:175]
  ds_read_b64_tr_b16 v[82:83], v146 offset:512
  v_mfma_f32_16x16x32_bf16 v[188:191], v[124:127], v[116:119], v[188:191]
  ds_read_b128 v[64:67], v144 offset:32768
  v_mfma_f32_16x16x32_bf16 v[184:187], v[124:127], v[112:115], v[184:187]
  ds_read_b128 v[68:71], v144 offset:34816
  v_mfma_f32_16x16x32_bf16 v[180:183], v[124:127], v[108:111], v[180:183]
  ds_read_b128 v[72:75], v144 offset:36864
  v_mfma_f32_16x16x32_bf16 v[176:179], v[124:127], v[104:107], v[176:179]
  ds_read_b128 v[76:79], v144 offset:38912
  v_mfma_f32_16x16x32_bf16 v[192:195], v[128:131], v[104:107], v[192:195]
  ds_read_b64_tr_b16 v[84:85], v147 offset:0
  v_mfma_f32_16x16x32_bf16 v[196:199], v[128:131], v[108:111], v[196:199]
  ds_read_b64_tr_b16 v[86:87], v147 offset:512
  v_mfma_f32_16x16x32_bf16 v[200:203], v[128:131], v[112:115], v[200:203]
  ds_read_b64_tr_b16 v[88:89], v146 offset:4096
  v_mfma_f32_16x16x32_bf16 v[204:207], v[128:131], v[116:119], v[204:207]
  ds_read_b64_tr_b16 v[90:91], v146 offset:4608
  v_mfma_f32_16x16x32_bf16 v[220:223], v[132:135], v[116:119], v[220:223]
  ds_read_b64_tr_b16 v[92:93], v147 offset:4096
  v_mfma_f32_16x16x32_bf16 v[216:219], v[132:135], v[112:115], v[216:219]
  ds_read_b64_tr_b16 v[94:95], v147 offset:4608
  v_mfma_f32_16x16x32_bf16 v[212:215], v[132:135], v[108:111], v[212:215]
  ds_read_b64_tr_b16 v[96:97], v146 offset:8192
  v_mfma_f32_16x16x32_bf16 v[208:211], v[132:135], v[104:107], v[208:211]
  ds_read_b64_tr_b16 v[98:99], v146 offset:8704
  v_mfma_f32_16x16x32_bf16 v[224:227], v[104:107], v[136:139], v[224:227]
  ds_read_b64_tr_b16 v[100:101], v147 offset:8192
  v_mfma_f32_16x16x32_bf16 v[228:231], v[108:111], v[136:139], v[228:231]
  ds_read_b64_tr_b16 v[102:103], v147 offset:8704
  v_mfma_f32_16x16x32_bf16 v[232:235], v[112:115], v[136:139], v[232:235]
  ds_read_b32 v151, v150
  s_add_u32 s30, s30, 12288
  v_mfma_f32_16x16x32_bf16 v[236:239], v[116:119], v[136:139], v[236:239]
  buffer_load_dword off, s[64:67], s31 lds
  s_cmp_eq_u32 s30, 86016
  v_mfma_f32_16x16x32_bf16 v[252:255], v[116:119], v[140:143], v[252:255]
  s_cselect_b32 s30, 0, s30
  s_add_u32 s31, s31, 4
  v_mfma_f32_16x16x32_bf16 v[248:251], v[112:115], v[140:143], v[248:251]
  v_add_u32 v146, s30, v148
  s_add_u32 s33, s33, 1
  v_mfma_f32_16x16x32_bf16 v[244:247], v[108:111], v[140:143], v[244:247]
  v_add_u32 v147, s30, v149
  v_mfma_f32_16x16x32_bf16 v[240:243], v[104:107], v[140:143], v[240:243]
  s_waitcnt lgkmcnt(0)
  v_mfma_f32_16x16x32_bf16 v[160:163], v[80:83], v[64:67], v[160:163]
  v_cmp_lt_i32 vcc, s33, v151
  v_mfma_f32_16x16x32_bf16 v[164:167], v[80:83], v[68:71], v[164:167]
  s_cbranch_vccz .g2_kernel_q_w4
.g2_kernel_q_back4:
  v_mfma_f32_16x16x32_bf16 v[168:171], v[80:83], v[72:75], v[168:171]
  ds_read_b64_tr_b16 v[120:121], v146 offset:0
  v_mfma_f32_16x16x32_bf16 v[172:175], v[80:83], v[76:79], v[172:175]
  ds_read_b64_tr_b16 v[122:123], v146 offset:512
  v_mfma_f32_16x16x32_bf16 v[188:191], v[84:87], v[76:79], v[188:191]
  ds_read_b128 v[104:107], v145 offset:32768
  v_mfma_f32_16x16x32_bf16 v[184:187], v[84:87], v[72:75], v[184:187]
  ds_read_b128 v[108:111], v145 offset:34816
  v_mfma_f32_16x16x32_bf16 v[180:183], v[84:87], v[68:71], v[180:183]
  ds_read_b128 v[112:115], v145 offset:36864
  v_mfma_f32_16x16x32_bf16 v[176:179], v[84:87], v[64:67], v[176:179]
  ds_read_b128 v[116:119], v145 offset:38912
  v_mfma_f32_16x16x32_bf16 v[192:195], v[88:91], v[64:67], v[192:195]
  ds_read_b64_tr_b16 v[124:125], v147 offset:0
  v_mfma_f32_16x16x32_bf16 v[196:199], v[88:91], v[68:71], v[196:199]
  ds_read_b64_tr_b16 v[126:127], v147 offset:512
  v_mfma_f32_16x16x32_bf16 v[200:203], v[88:91], v[72:75], v[200:203]
  ds_read_b64_tr_b16 v[128:129], v146 offset:4096
  v_mfma_f32_16x16x32_bf16 v[204:207], v[88:91], v[76:79], v[204:207]
  ds_read_b64_tr_b16 v[130:131], v146 offset:4608
  v_mfma_f32_16x16x32_bf16 v[220:223], v[92:95], v[76:79], v[220:223]
  ds_read_b64_tr_b16 v[132:133], v147 offset:4096
  v_mfma_f32_16x16x32_bf16 v[216:219], v[92:95], v[72:75], v[216:219]
  ds_read_b64_tr_b16 v[134:135], v147 offset:4608
  v_mfma_f32_16x16x32_bf16 v[212:215], v[92:95], v[68:71], v[212:215]
  ds_read_b64_tr_b16 v[136:137], v146 offset:8192
  v_mfma_f32_16x16x32_bf16 v[208:211], v[92:95], v[64:67], v[208:211]
  ds_read_b64_tr_b16 v[138:139], v146 offset:8704
  v_mfma_f32_16x16x32_bf16 v[224:227], v[64:67], v[96:99], v[224:227]
  ds_read_b64_tr_b16 v[140:141], v147 offset:8192
  v_mfma_f32_16x16x32_bf16 v[228:231], v[68:71], v[96:99], v[228:231]
  ds_read_b64_tr_b16 v[142:143], v147 offset:8704
  v_mfma_f32_16x16x32_bf16 v[232:235], v[72:75], v[96:99], v[232:235]
  ds_read_b32 v151, v150
  s_add_u32 s30, s30, 12288
  v_mfma_f32_16x16x32_bf16 v[236:239], v[76:79], v[96:99], v[236:239]
  buffer_load_dword off, s[64:67], s31 lds
  s_cmp_eq_u32 s30, 86016
  v_mfma_f32_16x16x32_bf16 v[252:255], v[76:79], v[100:103], v[252:255]
  s_cselect_b32 s30, 0, s30
  s_add_u32 s31, s31, 4
  v_mfma_f32_16x16x32_bf16 v[248:251], v[72:75], v[100:103], v[248:251]
  v_add_u32 v146, s30, v148
  s_add_u32 s33, s33, 1
  v_mfma_f32_16x16x32_bf16 v[244:247], v[68:71], v[100:103], v[244:247]
  v_add_u32 v147, s30, v149
  v_mfma_f32_16x16x32_bf16 v[240:243], v[64:67], v[100:103], v[240:243]
  s_waitcnt lgkmcnt(0)
  v_mfma_f32_16x16x32_bf16 v[160:163], v[120:123], v[104:107], v[160:163]
  v_cmp_lt_i32 vcc, s33, v151
  v_mfma_f32_16x16x32_bf16 v[164:167], v[120:123], v[108:111], v[164:167]
  s_cbranch_vccz .g2_kernel_q_w5
.g2_kernel_q_back5:
  v_mfma_f32_16x16x32_bf16 v[168:171], v[120:123], v[112:115], v[168:171]
  ds_read_b64_tr_b16 v[80:81], v146 offset:0
  v_mfma_f32_16x16x32_bf16 v[172:175], v[120:123], v[116:119], v[172:175]
  ds_read_b64_tr_b16 v[82:83], v146 offset:512
  v_mfma_f32_16x16x32_bf16 v[188:191], v[124:127], v[116:119], v[188:191]
  ds_read_b128 v[64:67], v144 offset:49152
  v_mfma_f32_16x16x32_bf16 v[184:187], v[124:127], v[112:115], v[184:187]
  ds_read_b128 v[68:71], v144 offset:51200
  v_mfma_f32_16x16x32_bf16 v[180:183], v[124:127], v[108:111], v[180:183]
  ds_read_b128 v[72:75], v144 offset:53248
  v_mfma_f32_16x16x32_bf16 v[176:179], v[124:127], v[104:107], v[176:179]
  ds_read_b128 v[76:79], v144 offset:55296
  v_mfma_f32_16x16x32_bf16 v[192:195], v[128:131], v[104:107], v[192:195]
  ds_read_b64_tr_b16 v[84:85], v147 offset:0
  v_mfma_f32_16x16x32_bf16 v[196:199], v[128:131], v[108:111], v[196:199]
  ds_read_b64_tr_b16 v[86:87], v147 offset:512
  v_mfma_f32_16x16x32_bf16 v[200:203], v[128:131], v[112:115], v[200:203]
  ds_read_b64_tr_b16 v[88:89], v146 offset:4096
  v_mfma_f32_16x16x32_bf16 v[204:207], v[128:131], v[116:119], v[204:207]
  ds_read_b64_tr_b16 v[90:91], v146 offset:4608
  v_mfma_f32_16x16x32_bf16 v[220:223], v[132:135], v[116:119], v[220:223]
  ds_read_b64_tr_b16 v[92:93], v147 offset:4096
  v_mfma_f32_16x16x32_bf16 v[216:219], v[132:135], v[112:115], v[216:219]
  ds_read_b64_tr_b16 v[94:95], v147 offset:4608
  v_mfma_f32_16x16x32_bf16 v[212:215], v[132:135], v[108:111], v[212:215]
  ds_read_b64_tr_b16 v[96:97], v146 offset:8192
  v_mfma_f32_16x16x32_bf16 v[208:211], v[132:135], v[104:107], v[208:211]
  ds_read_b64_tr_b16 v[98:99], v146 offset:8704
  v_mfma_f32_16x16x32_bf16 v[224:227], v[104:107], v[136:139], v[224:227]
  ds_read_b64_tr_b16 v[100:101], v147 offset:8192
  v_mfma_f32_16x16x32_bf16 v[228:231], v[108:111], v[136:139], v[228:231]
  ds_read_b64_tr_b16 v[102:103], v147 offset:8704
  v_mfma_f32_16x16x32_bf16 v[232:235], v[112:115], v[136:139], v[232:235]
  ds_read_b32 v151, v150
  s_add_u32 s30, s30, 12288
  v_mfma_f32_16x16x32_bf16 v[236:239], v[116:119], v[136:139], v[236:239]
  buffer_load_dword off, s[64:67], s31 lds
  s_cmp_eq_u32 s30, 86016
  v_mfma_f32_16x16x32_bf16 v[252:255], v[116:119], v[140:143], v[252:255]
  s_cselect_b32 s30, 0, s30
  s_add_u32 s31, s31, 4
  v_mfma_f32_16x16x32_bf16 v[248:251], v[112:115], v[140:143], v[248:251]
  v_add_u32 v146, s30, v148
  s_add_u32 s33, s33, 1
  v_mfma_f32_16x16x32_bf16 v[244:247], v[108:111], v[140:143], v[244:247]
  v_add_u32 v147, s30, v149
  v_mfma_f32_16x16x32_bf16 v[240:243], v[104:107], v[140:143], v[240:243]
  s_waitcnt lgkmcnt(0)
  v_mfma_f32_16x16x32_bf16 v[160:163], v[80:83], v[64:67], v[160:163]
  v_cmp_lt_i32 vcc, s33, v151
  v_mfma_f32_16x16x32_bf16 v[164:167], v[80:83], v[68:71], v[164:167]
  s_cbranch_vccz .g2_kernel_q_w6
.g2_kernel_q_back6:
  v_mfma_f32_16x16x32_bf16 v[168:171], v[80:83], v[72:75], v[168:171]
  ds_read_b64_tr_b16 v[120:121], v146 offset:0
  v_mfma_f32_16x16x32_bf16 v[172:175], v[80:83], v[76:79], v[172:175]
  ds_read_b64_tr_b16 v[122:123], v146 offset:512
  v_mfma_f32_16x16x32_bf16 v[188:191], v[84:87], v[76:79], v[188:191]
  ds_read_b128 v[104:107], v145 offset:49152
  v_mfma_f32_16x16x32_bf16 v[184:187], v[84:87], v[72:75], v[184:187]
  ds_read_b128 v[108:111], v145 offset:51200
  v_mfma_f32_16x16x32_bf16 v[180:183], v[84:87], v[68:71], v[180:183]
  ds_read_b128 v[112:115], v145 offset:53248
  v_mfma_f32_16x16x32_bf16 v[176:179], v[84:87], v[64:67], v[176:179]
  ds_read_b128 v[116:119], v145 offset:55296
  v_mfma_f32_16x16x32_bf16 v[192:195], v[88:91], v[64:67], v[192:195]
  ds_read_b64_tr_b16 v[124:125], v147 offset:0
  v_mfma_f32_16x16x32_bf16 v[196:199], v[88:91], v[68:71], v[196:199]
  ds_read_b64_tr_b16 v[126:127], v147 offset:512
  v_mfma_f32_16x16x32_bf16 v[200:203], v[88:91], v[72:75], v[200:203]
  ds_read_b64_tr_b16 v[128:129], v146 offset:4096
  v_mfma_f32_16x16x32_bf16 v[204:207], v[88:91], v[76:79], v[204:207]
  ds_read_b64_tr_b16 v[130:131], v146 offset:4608
  v_mfma_f32_16x16x32_bf16 v[220:223], v[92:95], v[76:79], v[220:223]
  ds_read_b64_tr_b16 v[132:133], v147 offset:4096
  v_mfma_f32_16x16x32_bf16 v[216:219], v[92:95], v[72:75], v[216:219]
  ds_read_b64_tr_b16 v[134:135], v147 offset:4608
  v_mfma_f32_16x16x32_bf16 v[212:215], v[92:95], v[68:71], v[212:215]
  ds_read_b64_tr_b16 v[136:137], v146 offset:8192
  v_mfma_f32_16x16x32_bf16 v[208:211], v[92:95], v[64:67], v[208:211]
  ds_read_b64_tr_b16 v[138:139], v146 offset:8704
  v_mfma_f32_16x16x32_bf16 v[224:227], v[64:67], v[96:99], v[224:227]
  ds_read_b64_tr_b16 v[140:141], v147 offset:8192
  v_mfma_f32_16x16x32_bf16 v[228:231], v[68:71], v[96:99], v[228:231]
  ds_read_b64_tr_b16 v[142:143], v147 offset:8704
  v_mfma_f32_16x16x32_bf16 v[232:235], v[72:75], v[96:99], v[232:235]
  ds_read_b32 v151, v150
  s_add_u32 s30, s30, 12288
  v_mfma_f32_16x16x32_bf16 v[236:239], v[76:79], v[96:99], v[236:239]
  buffer_load_dword off, s[64:67], s31 lds
  s_cmp_eq_u32 s30, 86016
  v_mfma_f32_16x16x32_bf16 v[252:255], v[76:79], v[100:103], v[252:255]
  s_cselect_b32 s30, 0, s30
  s_add_u32 s31, s31, 4
  v_mfma_f32_16x16x32_bf16 v[248:251], v[72:75], v[100:103], v[248:251]
  v_add_u32 v146, s30, v148
  s_add_u32 s33, s33, 1
  v_mfma_f32_16x16x32_bf16 v[244:247], v[68:71], v[100:103], v[244:247]
  v_add_u32 v147, s30, v149
  s_add_u32 s29, s29, 1
  v_mfma_f32_16x16x32_bf16 v[240:243], v[64:67], v[100:103], v[240:243]
  s_cmp_lg_u32 s29, 4
  s_cbranch_scc1 .g2_kernel_q_loop
  s_waitcnt lgkmcnt(0)
  v_mfma_f32_16x16x32_bf16 v[192:195], v[128:131], v[104:107], v[192:195]
  ds_read_b32 v62, v13 offset:0
  ds_read_b32 v63, v58
  v_mfma_f32_16x16x32_bf16 v[196:199], v[128:131], v[108:111], v[196:199]
  ds_read_b32 v57, v13 offset:24
  ds_read_b32 v21, v13 offset:84
  v_mfma_f32_16x16x32_bf16 v[200:203], v[128:131], v[112:115], v[200:203]
  ds_read_b128 v[40:43], v52 offset:5120
  ds_read_b128 v[44:47], v52 offset:5184
  v_mfma_f32_16x16x32_bf16 v[204:207], v[128:131], v[116:119], v[204:207]
  ds_read_b32 v24, v50 offset:2816
  ds_read_b32 v25, v50 offset:3328
  v_mfma_f32_16x16x32_bf16 v[220:223], v[132:135], v[116:119], v[220:223]
  ds_read_b32 v26, v50 offset:2880
  ds_read_b32 v27, v50 offset:3392
  v_mfma_f32_16x16x32_bf16 v[216:219], v[132:135], v[112:115], v[216:219]
  ds_read_b32 v28, v50 offset:2944
  ds_read_b32 v29, v50 offset:3456
  v_mfma_f32_16x16x32_bf16 v[212:215], v[132:135], v[108:111], v[212:215]
  ds_read_b32 v30, v50 offset:3008
  ds_read_b32 v31, v50 offset:3520
  v_mfma_f32_16x16x32_bf16 v[208:211], v[132:135], v[104:107], v[208:211]
  ds_read_b128 v[64:67], v51 offset:2816
  ds_read_b128 v[80:83], v51 offset:3328
  v_mfma_f32_16x16x32_bf16 v[224:227], v[104:107], v[136:139], v[224:227]
  ds_read_b128 v[68:71], v51 offset:2880
  v_mfma_f32_16x16x32_bf16 v[228:231], v[108:111], v[136:139], v[228:231]
  ds_read_b128 v[84:87], v51 offset:3392
  v_mfma_f32_16x16x32_bf16 v[232:235], v[112:115], v[136:139], v[232:235]
  ds_read_b128 v[72:75], v51 offset:2944
  v_mfma_f32_16x16x32_bf16 v[236:239], v[116:119], v[136:139], v[236:239]
  ds_read_b128 v[88:91], v51 offset:3456
  v_mfma_f32_16x16x32_bf16 v[252:255], v[116:119], v[140:143], v[252:255]
  ds_read_b128 v[76:79], v51 offset:3008
  v_mfma_f32_16x16x32_bf16 v[248:251], v[112:115], v[140:143], v[248:251]
  ds_read_b128 v[92:95], v51 offset:3520
  v_mfma_f32_16x16x32_bf16 v[244:247], v[108:111], v[140:143], v[244:247]
  ds_read_b32 v48, v53 offset:5376
  v_mfma_f32_16x16x32_bf16 v[240:243], v[104:107], v[140:143], v[240:243]
  ds_read_b32 v49, v53 offset:5440
  v_mfma_f32_16x16x32_bf16 v[160:163], v[120:123], v[104:107], v[160:163]
  ds_read_b128 v[32:35], v52 offset:4864
  v_mfma_f32_16x16x32_bf16 v[164:167], v[120:123], v[108:111], v[164:167]
  ds_read_b128 v[36:39], v52 offset:4928
  v_mfma_f32_16x16x32_bf16 v[168:171], v[120:123], v[112:115], v[168:171]
  v_mfma_f32_16x16x32_bf16 v[172:175], v[120:123], v[116:119], v[172:175]
  v_mfma_f32_16x16x32_bf16 v[188:191], v[124:127], v[116:119], v[188:191]
  buffer_load_dword off, s[64:67], s31 lds
  v_mfma_f32_16x16x32_bf16 v[184:187], v[124:127], v[112:115], v[184:187]
  v_mfma_f32_16x16x32_bf16 v[180:183], v[124:127], v[108:111], v[180:183]
  v_mfma_f32_16x16x32_bf16 v[176:179], v[124:127], v[104:107], v[176:179]
  s_waitcnt lgkmcnt(0)
  v_cmp_gt_u32 vcc, 2, v62
  v_cmp_gt_u32 s[14:15], s12, v63
  s_or_b64 vcc, vcc, s[14:15]
  s_cbranch_scc1 .g2_kernel_q_ew
.g2_kernel_q_eb:
  v_cmp_ne_u32 vcc, 0, v57
  s_cbranch_vccnz .g2_kernel_q_patch
.g2_kernel_q_pback:
  s_add_u32 s79, s77, 4096
  s_cmp_lg_u32 s10, 0
  s_cbranch_scc1 .g2_kernel_q_nk
  v_pk_mul_f32 v[152:153], v[40:41], v[24:25] op_sel:[0,1] op_sel_hi:[1,1]
  v_pk_mul_f32 v[154:155], v[42:43], v[24:25] op_sel:[0,1] op_sel_hi:[1,1]
  v_pk_mul_f32 v[156:157], v[44:45], v[24:25] op_sel:[0,1] op_sel_hi:[1,1]
  v_pk_mul_f32 v[158:159], v[46:47], v[24:25] op_sel:[0,1] op_sel_hi:[1,1]
  v_pk_fma_f32 v[192:193], v[192:193], v[24:25], v[152:153] op_sel_hi:[1,0,1]
  v_pk_fma_f32 v[194:195], v[194:195], v[24:25], v[154:155] op_sel_hi:[1,0,1]
  v_pk_fma_f32 v[208:209], v[208:209], v[24:25], v[156:157] op_sel_hi:[1,0,1]
  v_pk_fma_f32 v[210:211], v[210:211], v[24:25], v[158:159] op_sel_hi:[1,0,1]
  v_cvt_pk_bf16_f32 v192, v192, v193
  v_cvt_pk_bf16_f32 v193, v194, v195
  v_cvt_pk_bf16_f32 v194, v208, v209
  v_cvt_pk_bf16_f32 v195, v210, v211
  buffer_store_dwordx4 v[192:195], v54, s[4:7], s8 offen offset:0 sc1
  v_pk_mul_f32 v[152:153], v[40:41], v[26:27] op_sel:[0,1] op_sel_hi:[1,1]
  v_pk_mul_f32 v[154:155], v[42:43], v[26:27] op_sel:[0,1] op_sel_hi:[1,1]
  v_pk_mul_f32 v[156:157], v[44:45], v[26:27] op_sel:[0,1] op_sel_hi:[1,1]
  v_pk_mul_f32 v[158:159], v[46:47], v[26:27] op_sel:[0,1] op_sel_hi:[1,1]
  v_pk_fma_f32 v[196:197], v[196:197], v[26:27], v[152:153] op_sel_hi:[1,0,1]
  v_pk_fma_f32 v[198:199], v[198:199], v[26:27], v[154:155] op_sel_hi:[1,0,1]
  v_pk_fma_f32 v[212:213], v[212:213], v[26:27], v[156:157] op_sel_hi:[1,0,1]
  v_pk_fma_f32 v[214:215], v[214:215], v[26:27], v[158:159] op_sel_hi:[1,0,1]
  v_cvt_pk_bf16_f32 v196, v196, v197
  v_cvt_pk_bf16_f32 v197, v198, v199
  v_cvt_pk_bf16_f32 v198, v212, v213
  v_cvt_pk_bf16_f32 v199, v214, v215
  buffer_store_dwordx4 v[196:199], v54, s[4:7], s8 offen offset:128 sc1
  v_pk_mul_f32 v[152:153], v[40:41], v[28:29] op_sel:[0,1] op_sel_hi:[1,1]
  v_pk_mul_f32 v[154:155], v[42:43], v[28:29] op_sel:[0,1] op_sel_hi:[1,1]
  v_pk_mul_f32 v[156:157], v[44:45], v[28:29] op_sel:[0,1] op_sel_hi:[1,1]
  v_pk_mul_f32 v[158:159], v[46:47], v[28:29] op_sel:[0,1] op_sel_hi:[1,1]
  v_pk_fma_f32 v[200:201], v[200:201], v[28:29], v[152:153] op_sel_hi:[1,0,1]
  v_pk_fma_f32 v[202:203], v[202:203], v[28:29], v[154:155] op_sel_hi:[1,0,1]
  v_pk_fma_f32 v[216:217], v[216:217], v[28:29], v[156:157] op_sel_hi:[1,0,1]
  v_pk_fma_f32 v[218:219], v[218:219], v[28:29], v[158:159] op_sel_hi:[1,0,1]
  v_cvt_pk_bf16_f32 v200, v200, v201
  v_cvt_pk_bf16_f32 v201, v202, v203
  v_cvt_pk_bf16_f32 v202, v216, v217
  v_cvt_pk_bf16_f32 v203, v218, v219
  buffer_store_dwordx4 v[200:203], v54, s[4:7], s9 offen offset:0 sc1
  v_pk_mul_f32 v[152:153], v[40:41], v[30:31] op_sel:[0,1] op_sel_hi:[1,1]
  v_pk_mul_f32 v[154:155], v[42:43], v[30:31] op_sel:[0,1] op_sel_hi:[1,1]
  v_pk_mul_f32 v[156:157], v[44:45], v[30:31] op_sel:[0,1] op_sel_hi:[1,1]
  v_pk_mul_f32 v[158:159], v[46:47], v[30:31] op_sel:[0,1] op_sel_hi:[1,1]
  v_pk_fma_f32 v[204:205], v[204:205], v[30:31], v[152:153] op_sel_hi:[1,0,1]
  v_pk_fma_f32 v[206:207], v[206:207], v[30:31], v[154:155] op_sel_hi:[1,0,1]
  v_pk_fma_f32 v[220:221], v[220:221], v[30:31], v[156:157] op_sel_hi:[1,0,1]
  v_pk_fma_f32 v[222:223], v[222:223], v[30:31], v[158:159] op_sel_hi:[1,0,1]
  v_cvt_pk_bf16_f32 v204, v204, v205
  v_cvt_pk_bf16_f32 v205, v206, v207
  v_cvt_pk_bf16_f32 v206, v220, v221
  v_cvt_pk_bf16_f32 v207, v222, v223
  buffer_store_dwordx4 v[204:207], v54, s[4:7], s9 offen offset:128 sc1
  v_pk_mul_f32 v[152:153], v[80:81], v[48:49] op_sel:[0,0] op_sel_hi:[1,0]
  v_pk_mul_f32 v[154:155], v[82:83], v[48:49] op_sel:[0,0] op_sel_hi:[1,0]
  v_pk_mul_f32 v[156:157], v[84:85], v[48:49] op_sel:[0,0] op_sel_hi:[1,0]
  v_pk_mul_f32 v[158:159], v[86:87], v[48:49] op_sel:[0,0] op_sel_hi:[1,0]
  v_pk_fma_f32 v[224:225], v[224:225], v[64:65], v[152:153]
  v_pk_fma_f32 v[226:227], v[226:227], v[66:67], v[154:155]
  v_pk_fma_f32 v[228:229], v[228:229], v[68:69], v[156:157]
  v_pk_fma_f32 v[230:231], v[230:231], v[70:71], v[158:159]
  v_cvt_pk_bf16_f32 v224, v224, v225
  v_cvt_pk_bf16_f32 v225, v226, v227
  v_cvt_pk_bf16_f32 v226, v228, v229
  v_cvt_pk_bf16_f32 v227, v230, v231
  buffer_store_dwordx4 v[224:227], v55, s[4:7], s8 offen offset:2048 sc1
  v_pk_mul_f32 v[152:153], v[80:81], v[48:49] op_sel:[0,1] op_sel_hi:[1,1]
  v_pk_mul_f32 v[154:155], v[82:83], v[48:49] op_sel:[0,1] op_sel_hi:[1,1]
  v_pk_mul_f32 v[156:157], v[84:85], v[48:49] op_sel:[0,1] op_sel_hi:[1,1]
  v_pk_mul_f32 v[158:159], v[86:87], v[48:49] op_sel:[0,1] op_sel_hi:[1,1]
  v_pk_fma_f32 v[240:241], v[240:241], v[64:65], v[152:153]
  v_pk_fma_f32 v[242:243], v[242:243], v[66:67], v[154:155]
  v_pk_fma_f32 v[244:245], v[244:245], v[68:69], v[156:157]
  v_pk_fma_f32 v[246:247], v[246:247], v[70:71], v[158:159]
  v_cvt_pk_bf16_f32 v240, v240, v241
  v_cvt_pk_bf16_f32 v241, v242, v243
  v_cvt_pk_bf16_f32 v242, v244, v245
  v_cvt_pk_bf16_f32 v243, v246, v247
  buffer_store_dwordx4 v[240:243], v55, s[4:7], s8 offen offset:2304 sc1
  v_pk_mul_f32 v[152:153], v[88:89], v[48:49] op_sel:[0,0] op_sel_hi:[1,0]
  v_pk_mul_f32 v[154:155], v[90:91], v[48:49] op_sel:[0,0] op_sel_hi:[1,0]
  v_pk_mul_f32 v[156:157], v[92:93], v[48:49] op_sel:[0,0] op_sel_hi:[1,0]
  v_pk_mul_f32 v[158:159], v[94:95], v[48:49] op_sel:[0,0] op_sel_hi:[1,0]
  v_pk_fma_f32 v[232:233], v[232:233], v[72:73], v[152:153]
  v_pk_fma_f32 v[234:235], v[234:235], v[74:75], v[154:155]
  v_pk_fma_f32 v[236:237], v[236:237], v[76:77], v[156:157]
  v_pk_fma_f32 v[238:239], v[238:239], v[78:79], v[158:159]
  v_cvt_pk_bf16_f32 v232, v232, v233
  v_cvt_pk_bf16_f32 v233, v234, v235
  v_cvt_pk_bf16_f32 v234, v236, v237
  v_cvt_pk_bf16_f32 v235, v238, v239
  buffer_store_dwordx4 v[232:235], v55, s[4:7], s9 offen offset:2048 sc1
  v_pk_mul_f32 v[152:153], v[88:89], v[48:49] op_sel:[0,1] op_sel_hi:[1,1]
  v_pk_mul_f32 v[154:155], v[90:91], v[48:49] op_sel:[0,1] op_sel_hi:[1,1]
  v_pk_mul_f32 v[156:157], v[92:93], v[48:49] op_sel:[0,1] op_sel_hi:[1,1]
  v_pk_mul_f32 v[158:159], v[94:95], v[48:49] op_sel:[0,1] op_sel_hi:[1,1]
  v_pk_fma_f32 v[248:249], v[248:249], v[72:73], v[152:153]
  v_pk_fma_f32 v[250:251], v[250:251], v[74:75], v[154:155]
  v_pk_fma_f32 v[252:253], v[252:253], v[76:77], v[156:157]
  v_pk_fma_f32 v[254:255], v[254:255], v[78:79], v[158:159]
  v_cvt_pk_bf16_f32 v248, v248, v249
  v_cvt_pk_bf16_f32 v249, v250, v251
  v_cvt_pk_bf16_f32 v250, v252, v253
  v_cvt_pk_bf16_f32 v251, v254, v255
  buffer_store_dwordx4 v[248:251], v55, s[4:7], s9 offen offset:2304 sc1
  v_pk_mul_f32 v[24:25], v[24:25], v[56:57] op_sel_hi:[1,0]
  v_pk_mul_f32 v[26:27], v[26:27], v[56:57] op_sel_hi:[1,0]
  v_pk_mul_f32 v[28:29], v[28:29], v[56:57] op_sel_hi:[1,0]
  v_pk_mul_f32 v[30:31], v[30:31], v[56:57] op_sel_hi:[1,0]
  ds_write_b128 v59, v[192:195] offset:0
  ds_write_b128 v59, v[196:199] offset:128
  v_pk_mul_f32 v[152:153], v[32:33], v[24:25] op_sel:[0,1] op_sel_hi:[1,1]
  v_pk_mul_f32 v[154:155], v[34:35], v[24:25] op_sel:[0,1] op_sel_hi:[1,1]
  v_pk_mul_f32 v[156:157], v[36:37], v[24:25] op_sel:[0,1] op_sel_hi:[1,1]
  v_pk_mul_f32 v[158:159], v[38:39], v[24:25] op_sel:[0,1] op_sel_hi:[1,1]
  v_pk_fma_f32 v[160:161], v[160:161], v[24:25], v[152:153] op_sel_hi:[1,0,1]
  v_pk_fma_f32 v[162:163], v[162:163], v[24:25], v[154:155] op_sel_hi:[1,0,1]
  v_pk_fma_f32 v[176:177], v[176:177], v[24:25], v[156:157] op_sel_hi:[1,0,1]
  v_pk_fma_f32 v[178:179], v[178:179], v[24:25], v[158:159] op_sel_hi:[1,0,1]
  v_cvt_pk_bf16_f32 v160, v160, v161
  v_cvt_pk_bf16_f32 v161, v162, v163
  v_cvt_pk_bf16_f32 v162, v176, v177
  v_cvt_pk_bf16_f32 v163, v178, v179
  ds_write_b128 v61, v[160:163] offset:0
  ds_write_b128 v59, v[200:203] offset:4096
  ds_write_b128 v59, v[204:207] offset:4224
  v_pk_mul_f32 v[152:153], v[32:33], v[26:27] op_sel:[0,1] op_sel_hi:[1,1]
  v_pk_mul_f32 v[154:155], v[34:35], v[26:27] op_sel:[0,1] op_sel_hi:[1,1]
  v_pk_mul_f32 v[156:157], v[36:37], v[26:27] op_sel:[0,1] op_sel_hi:[1,1]
  v_pk_mul_f32 v[158:159], v[38:39], v[26:27] op_sel:[0,1] op_sel_hi:[1,1]
  v_pk_fma_f32 v[164:165], v[164:165], v[26:27], v[152:153] op_sel_hi:[1,0,1]
  v_pk_fma_f32 v[166:167], v[166:167], v[26:27], v[154:155] op_sel_hi:[1,0,1]
  v_pk_fma_f32 v[180:181], v[180:181], v[26:27], v[156:157] op_sel_hi:[1,0,1]
  v_pk_fma_f32 v[182:183], v[182:183], v[26:27], v[158:159] op_sel_hi:[1,0,1]
  v_cvt_pk_bf16_f32 v164, v164, v165
  v_cvt_pk_bf16_f32 v165, v166, v167
  v_cvt_pk_bf16_f32 v166, v180, v181
  v_cvt_pk_bf16_f32 v167, v182, v183
  ds_write_b128 v61, v[164:167] offset:256
  ds_write_b128 v60, v[224:227] offset:2048
  ds_write_b128 v60, v[240:243] offset:2304
  v_pk_mul_f32 v[152:153], v[32:33], v[28:29] op_sel:[0,1] op_sel_hi:[1,1]
  v_pk_mul_f32 v[154:155], v[34:35], v[28:29] op_sel:[0,1] op_sel_hi:[1,1]
  v_pk_mul_f32 v[156:157], v[36:37], v[28:29] op_sel:[0,1] op_sel_hi:[1,1]
  v_pk_mul_f32 v[158:159], v[38:39], v[28:29] op_sel:[0,1] op_sel_hi:[1,1]
  v_pk_fma_f32 v[168:169], v[168:169], v[28:29], v[152:153] op_sel_hi:[1,0,1]
  v_pk_fma_f32 v[170:171], v[170:171], v[28:29], v[154:155] op_sel_hi:[1,0,1]
  v_pk_fma_f32 v[184:185], v[184:185], v[28:29], v[156:157] op_sel_hi:[1,0,1]
  v_pk_fma_f32 v[186:187], v[186:187], v[28:29], v[158:159] op_sel_hi:[1,0,1]
  v_cvt_pk_bf16_f32 v168, v168, v169
  v_cvt_pk_bf16_f32 v169, v170, v171
  v_cvt_pk_bf16_f32 v170, v184, v185
  v_cvt_pk_bf16_f32 v171, v186, v187
  ds_write_b128 v61, v[168:171] offset:2048
  ds_write_b128 v60, v[232:235] offset:6144
  ds_write_b128 v60, v[248:251] offset:6400
  v_pk_mul_f32 v[152:153], v[32:33], v[30:31] op_sel:[0,1] op_sel_hi:[1,1]
  v_pk_mul_f32 v[154:155], v[34:35], v[30:31] op_sel:[0,1] op_sel_hi:[1,1]
  v_pk_mul_f32 v[156:157], v[36:37], v[30:31] op_sel:[0,1] op_sel_hi:[1,1]
  v_pk_mul_f32 v[158:159], v[38:39], v[30:31] op_sel:[0,1] op_sel_hi:[1,1]
  v_pk_fma_f32 v[172:173], v[172:173], v[30:31], v[152:153] op_sel_hi:[1,0,1]
  v_pk_fma_f32 v[174:175], v[174:175], v[30:31], v[154:155] op_sel_hi:[1,0,1]
  v_pk_fma_f32 v[188:189], v[188:189], v[30:31], v[156:157] op_sel_hi:[1,0,1]
  v_pk_fma_f32 v[190:191], v[190:191], v[30:31], v[158:159] op_sel_hi:[1,0,1]
  v_cvt_pk_bf16_f32 v172, v172, v173
  v_cvt_pk_bf16_f32 v173, v174, v175
  v_cvt_pk_bf16_f32 v174, v188, v189
  v_cvt_pk_bf16_f32 v175, v190, v191
  ds_write_b128 v61, v[172:175] offset:2304
.g2_kernel_q_kd:
  s_mov_b64 exec, 1
  ds_add_u32 v13, v5 offset:4
  s_mov_b64 exec, -1
  v_mov_b32 v120, 0
  v_mov_b32 v121, 0
  v_mov_b32 v124, 0
  v_mov_b32 v125, 0
  v_mov_b32 v128, 0
  v_mov_b32 v129, 0
  v_mov_b32 v132, 0
  v_mov_b32 v133, 0
  s_cmp_lg_u32 s62, 0
  s_cbranch_scc1 .g2_kernel_r2
  global_load_dwordx4 v[240:243], v23, s[74:75] offset:0
  global_load_dwordx4 v[244:247], v23, s[74:75] offset:32
  global_load_dwordx4 v[248:251], v23, s[74:75] offset:64
  global_load_dwordx4 v[252:255], v23, s[74:75] offset:96
.g2_kernel_r3:
  v_mov_b32 v6, s71
  s_mov_b32 s38, 0
.g2_kernel_wg2:
  ds_read_b32 v7, v6 offset:4
  s_add_u32 s38, s38, 1
  s_waitcnt lgkmcnt(0)
  v_cmp_le_u32 vcc, 4, v7
  s_cbranch_vccnz .g2_kernel_wg2d
  s_cmp_lt_u32 s38, 524288
  s_cbranch_scc1 .g2_kernel_wg2
.g2_kernel_wg2d:
  ds_read_b128 v[176:179], v9 offset:0
  ds_read_b128 v[180:183], v9 offset:1024
  ds_read_b128 v[24:27], v14 offset:8192
  ds_read_b128 v[28:31], v14 offset:9216
  ds_read_b128 v[184:187], v9 offset:2048
  ds_read_b128 v[188:191], v9 offset:3072
  ds_read_b128 v[32:35], v14 offset:10240
  ds_read_b128 v[36:39], v14 offset:11264
  ds_read_b128 v[40:43], v14 offset:12288
  ds_read_b128 v[44:47], v14 offset:13312
  ds_read_b128 v[48:51], v14 offset:14336
  ds_read_b128 v[52:55], v14 offset:15360
  s_cmp_lg_u32 s35, 0
  s_cbranch_scc1 .g2_kernel_a_own
  s_waitcnt lgkmcnt(8)
.g2_kernel_a_ob:
  v_mfma_f32_32x32x16_bf16 v[136:151], v[176:179], v[24:27], 0
  v_mfma_f32_32x32x16_bf16 v[136:151], v[180:183], v[28:31], v[136:151]
  s_waitcnt lgkmcnt(0)
  s_nop 7
  v_mfma_f32_32x32x16_bf16 v[152:167], v[176:179], v[32:35], 0
  s_waitcnt vmcnt(4)
  s_mov_b64 exec, 1
  buffer_store_dword v15, v4, s[4:7], s37 offen sc1
  s_mov_b64 exec, -1
  v_exp_f32 v136, v136
  v_exp_f32 v137, v137
  v_exp_f32 v138, v138
  v_exp_f32 v139, v139
  v_exp_f32 v140, v140
  v_exp_f32 v141, v141
  v_exp_f32 v142, v142
  v_exp_f32 v143, v143
  v_mfma_f32_32x32x16_bf16 v[152:167], v[180:183], v[36:39], v[152:167]
  s_mov_b64 exec, 1
  ds_add_u32 v13, v5 offset:8
  s_mov_b64 exec, -1
  v_cvt_pk_bf16_f32 v168, v136, v137
  v_cvt_pk_bf16_f32 v169, v138, v139
  v_cvt_pk_bf16_f32 v170, v140, v141
  v_cvt_pk_bf16_f32 v171, v142, v143
  v_exp_f32 v144, v144
  v_exp_f32 v145, v145
  v_exp_f32 v146, v146
  v_exp_f32 v147, v147
  v_mfma_f32_32x32x16_bf16 v[56:71], v[184:187], v[168:171], 0
  v_exp_f32 v148, v148
  v_exp_f32 v149, v149
  v_exp_f32 v150, v150
  v_exp_f32 v151, v151
  v_cvt_pk_bf16_f32 v172, v144, v145
  v_cvt_pk_bf16_f32 v173, v146, v147
  v_cvt_pk_bf16_f32 v174, v148, v149
  v_cvt_pk_bf16_f32 v175, v150, v151
  v_mfma_f32_32x32x16_bf16 v[136:151], v[176:179], v[40:43], 0
  v_exp_f32 v152, v152
  v_exp_f32 v153, v153
  v_exp_f32 v154, v154
  v_mfma_f32_32x32x16_bf16 v[56:71], v[188:191], v[172:175], v[56:71]
  v_exp_f32 v155, v155
  v_exp_f32 v156, v156
  v_exp_f32 v157, v157
  v_smfmac_f32_16x16x64_bf16 v[120:123], v[16:19], v[168:175], v20
  v_exp_f32 v158, v158
  v_exp_f32 v159, v159
  v_mfma_f32_32x32x16_bf16 v[136:151], v[180:183], v[44:47], v[136:151]
  v_cvt_pk_bf16_f32 v168, v152, v153
  v_cvt_pk_bf16_f32 v169, v154, v155
  v_cvt_pk_bf16_f32 v170, v156, v157
  v_cvt_pk_bf16_f32 v171, v158, v159
  v_exp_f32 v160, v160
  v_exp_f32 v161, v161
  v_exp_f32 v162, v162
  v_exp_f32 v163, v163
  v_mfma_f32_32x32x16_bf16 v[72:87], v[184:187], v[168:171], 0
  v_exp_f32 v164, v164
  v_exp_f32 v165, v165
  v_exp_f32 v166, v166
  v_exp_f32 v167, v167
  v_cvt_pk_bf16_f32 v172, v160, v161
  v_cvt_pk_bf16_f32 v173, v162, v163
  v_cvt_pk_bf16_f32 v174, v164, v165
  v_cvt_pk_bf16_f32 v175, v166, v167
  v_mfma_f32_32x32x16_bf16 v[152:167], v[176:179], v[48:51], 0
  ds_read_b32 v7, v8
  v_exp_f32 v136, v136
  v_exp_f32 v137, v137
  v_exp_f32 v138, v138
  v_mfma_f32_32x32x16_bf16 v[72:87], v[188:191], v[172:175], v[72:87]
  v_exp_f32 v139, v139
  v_exp_f32 v140, v140
  v_exp_f32 v141, v141
  v_smfmac_f32_16x16x64_bf16 v[124:127], v[16:19], v[168:175], v20
  v_exp_f32 v142, v142
  v_exp_f32 v143, v143
  v_mfma_f32_32x32x16_bf16 v[152:167], v[180:183], v[52:55], v[152:167]
  s_waitcnt lgkmcnt(0)
  v_cmp_lt_u32 vcc, s62, v7
  v_cvt_pk_bf16_f32 v168, v136, v137
  v_cvt_pk_bf16_f32 v169, v138, v139
  v_cvt_pk_bf16_f32 v170, v140, v141
  v_cvt_pk_bf16_f32 v171, v142, v143
  v_exp_f32 v144, v144
  v_exp_f32 v145, v145
  v_exp_f32 v146, v146
  v_exp_f32 v147, v147
  v_mfma_f32_32x32x16_bf16 v[88:103], v[184:187], v[168:171], 0
  s_mov_b32 s36, vcc_lo
  s_andn2_b32 s33, s36, s34
  v_exp_f32 v148, v148
  v_exp_f32 v149, v149
  v_exp_f32 v150, v150
  v_exp_f32 v151, v151
  v_cvt_pk_bf16_f32 v172, v144, v145
  v_cvt_pk_bf16_f32 v173, v146, v147
  v_cvt_pk_bf16_f32 v174, v148, v149
  v_cvt_pk_bf16_f32 v175, v150, v151
  v_exp_f32 v152, v152
  v_exp_f32 v153, v153
  v_exp_f32 v154, v154
  v_mfma_f32_32x32x16_bf16 v[88:103], v[188:191], v[172:175], v[88:103]
  s_bcnt1_i32_b32 s39, s33
  s_cmp_lt_u32 s39, 3
  v_exp_f32 v155, v155
  v_exp_f32 v156, v156
  v_exp_f32 v157, v157
  v_smfmac_f32_16x16x64_bf16 v[128:131], v[16:19], v[168:175], v20
  s_cbranch_scc1 .g2_kernel_a_F0n
  s_call_b64 s[72:73], .g2_kernel_a_three
.g2_kernel_a_F0n:
  v_exp_f32 v158, v158
  v_exp_f32 v159, v159
  v_cvt_pk_bf16_f32 v168, v152, v153
  v_cvt_pk_bf16_f32 v169, v154, v155
  v_cvt_pk_bf16_f32 v170, v156, v157
  v_cvt_pk_bf16_f32 v171, v158, v159
  v_exp_f32 v160, v160
  v_exp_f32 v161, v161
  v_exp_f32 v162, v162
  v_exp_f32 v163, v163
  v_mfma_f32_32x32x16_bf16 v[104:119], v[184:187], v[168:171], 0
  v_exp_f32 v164, v164
  v_exp_f32 v165, v165
  v_exp_f32 v166, v166
  v_exp_f32 v167, v167
  v_cvt_pk_bf16_f32 v172, v160, v161
  v_cvt_pk_bf16_f32 v173, v162, v163
  v_cvt_pk_bf16_f32 v174, v164, v165
  v_cvt_pk_bf16_f32 v175, v166, v167
  s_add_u32 s39, s39, s35
  s_cmp_ge_u32 s39, 3
  s_cbranch_scc1 .g2_kernel_a_p1
  s_call_b64 s[72:73], .g2_kernel_a_three
.g2_kernel_a_p1:
  s_waitcnt vmcnt(10)
  v_mfma_f32_32x32x16_bf16 v[136:151], v[192:195], v[24:27], 0
  v_mfma_f32_32x32x16_bf16 v[136:151], v[196:199], v[28:31], v[136:151]
  s_waitcnt vmcnt(8)
  s_mov_b32 s32, 0
  s_nop 8
  s_branch .g2_kernel_a_n1
  .p2align 6
.g2_kernel_a_loop:
  v_mfma_f32_32x32x16_bf16 v[152:167], v[176:179], v[32:35], 0
  s_andn2_b32 s33, s36, s34
  v_exp_f32 v136, v136
  v_exp_f32 v137, v137
  v_exp_f32 v138, v138
  v_mfma_f32_32x32x16_bf16 v[104:119], v[236:239], v[172:175], v[104:119]
  s_cbranch_scc0 .g2_kernel_a_N0c
.g2_kernel_a_N0b:
  v_exp_f32 v139, v139
  v_exp_f32 v140, v140
  v_exp_f32 v141, v141
  v_smfmac_f32_16x16x64_bf16 v[132:135], v[16:19], v[168:175], v20
  s_ff1_i32_b32 s33, s33
  v_exp_f32 v142, v142
  v_exp_f32 v143, v143
  v_mfma_f32_32x32x16_bf16 v[152:167], v[180:183], v[36:39], v[152:167]
  s_bitset1_b32 s34, s33
  v_cvt_pk_bf16_f32 v168, v136, v137
  v_cvt_pk_bf16_f32 v169, v138, v139
  v_cvt_pk_bf16_f32 v170, v140, v141
  v_cvt_pk_bf16_f32 v171, v142, v143
  v_exp_f32 v144, v144
  v_exp_f32 v145, v145
  v_exp_f32 v146, v146
  v_exp_f32 v147, v147
  v_mfma_f32_32x32x16_bf16 v[56:71], v[184:187], v[168:171], v[56:71]
  s_xor_b32 s33, s33, s24
  v_exp_f32 v148, v148
  v_exp_f32 v149, v149
  v_exp_f32 v150, v150
  v_exp_f32 v151, v151
  v_cvt_pk_bf16_f32 v172, v144, v145
  v_cvt_pk_bf16_f32 v173, v146, v147
  v_cvt_pk_bf16_f32 v174, v148, v149
  v_cvt_pk_bf16_f32 v175, v150, v151
  v_mfma_f32_32x32x16_bf16 v[136:151], v[176:179], v[40:43], 0
  s_lshl_b32 s33, s33, s25
  v_exp_f32 v152, v152
  v_exp_f32 v153, v153
  v_exp_f32 v154, v154
  v_mfma_f32_32x32x16_bf16 v[56:71], v[188:191], v[172:175], v[56:71]
  s_add_u32 s22, s20, s33
  v_exp_f32 v155, v155
  v_exp_f32 v156, v156
  v_exp_f32 v157, v157
  v_smfmac_f32_16x16x64_bf16 v[120:123], v[16:19], v[168:175], v20
  s_addc_u32 s23, s21, 0
  v_exp_f32 v158, v158
  v_exp_f32 v159, v159
  v_mfma_f32_32x32x16_bf16 v[136:151], v[180:183], v[44:47], v[136:151]
  global_load_dwordx4 v[224:227], v3, s[22:23] offset:0
  global_load_dwordx4 v[228:231], v3, s[22:23] offset:1024
  global_load_dwordx4 v[232:235], v3, s[22:23] offset:2048
  global_load_dwordx4 v[236:239], v3, s[22:23] offset:3072
  v_cvt_pk_bf16_f32 v168, v152, v153
  v_cvt_pk_bf16_f32 v169, v154, v155
  v_cvt_pk_bf16_f32 v170, v156, v157
  v_cvt_pk_bf16_f32 v171, v158, v159
  v_exp_f32 v160, v160
  v_exp_f32 v161, v161
  v_exp_f32 v162, v162
  v_exp_f32 v163, v163
  v_mfma_f32_32x32x16_bf16 v[72:87], v[184:187], v[168:171], v[72:87]
  v_exp_f32 v164, v164
  v_exp_f32 v165, v165
  v_exp_f32 v166, v166
  v_exp_f32 v167, v167
  v_cvt_pk_bf16_f32 v172, v160, v161
  v_cvt_pk_bf16_f32 v173, v162, v163
  v_cvt_pk_bf16_f32 v174, v164, v165
  v_cvt_pk_bf16_f32 v175, v166, v167
  v_mfma_f32_32x32x16_bf16 v[152:167], v[176:179], v[48:51], 0
  v_exp_f32 v136, v136
  v_exp_f32 v137, v137
  v_exp_f32 v138, v138
  v_mfma_f32_32x32x16_bf16 v[72:87], v[188:191], v[172:175], v[72:87]
  v_exp_f32 v139, v139
  v_exp_f32 v140, v140
  v_exp_f32 v141, v141
  v_smfmac_f32_16x16x64_bf16 v[124:127], v[16:19], v[168:175], v20
  v_exp_f32 v142, v142
  v_exp_f32 v143, v143
  v_mfma_f32_32x32x16_bf16 v[152:167], v[180:183], v[52:55], v[152:167]
  v_cvt_pk_bf16_f32 v168, v136, v137
  v_cvt_pk_bf16_f32 v169, v138, v139
  v_cvt_pk_bf16_f32 v170, v140, v141
  v_cvt_pk_bf16_f32 v171, v142, v143
  v_exp_f32 v144, v144
  v_exp_f32 v145, v145
  v_exp_f32 v146, v146
  v_exp_f32 v147, v147
  v_mfma_f32_32x32x16_bf16 v[88:103], v[184:187], v[168:171], v[88:103]
  s_waitcnt vmcnt(8)
  v_exp_f32 v148, v148
  v_exp_f32 v149, v149
  v_exp_f32 v150, v150
  v_exp_f32 v151, v151
  v_cvt_pk_bf16_f32 v172, v144, v145
  v_cvt_pk_bf16_f32 v173, v146, v147
  v_cvt_pk_bf16_f32 v174, v148, v149
  v_cvt_pk_bf16_f32 v175, v150, v151
  v_mfma_f32_32x32x16_bf16 v[136:151], v[192:195], v[24:27], 0
  v_exp_f32 v152, v152
  v_exp_f32 v153, v153
  v_exp_f32 v154, v154
  v_mfma_f32_32x32x16_bf16 v[88:103], v[188:191], v[172:175], v[88:103]
  v_exp_f32 v155, v155
  v_exp_f32 v156, v156
  v_exp_f32 v157, v157
  v_smfmac_f32_16x16x64_bf16 v[128:131], v[16:19], v[168:175], v20
  v_exp_f32 v158, v158
  v_exp_f32 v159, v159
  v_mfma_f32_32x32x16_bf16 v[136:151], v[196:199], v[28:31], v[136:151]
  v_cvt_pk_bf16_f32 v168, v152, v153
  v_cvt_pk_bf16_f32 v169, v154, v155
  v_cvt_pk_bf16_f32 v170, v156, v157
  v_cvt_pk_bf16_f32 v171, v158, v159
  v_exp_f32 v160, v160
  v_exp_f32 v161, v161
  v_exp_f32 v162, v162
  v_exp_f32 v163, v163
  v_mfma_f32_32x32x16_bf16 v[104:119], v[184:187], v[168:171], v[104:119]
  v_exp_f32 v164, v164
  v_exp_f32 v165, v165
  v_exp_f32 v166, v166
  v_exp_f32 v167, v167
  v_cvt_pk_bf16_f32 v172, v160, v161
  v_cvt_pk_bf16_f32 v173, v162, v163
  v_cvt_pk_bf16_f32 v174, v164, v165
  v_cvt_pk_bf16_f32 v175, v166, v167
.g2_kernel_a_n1:
  v_mfma_f32_32x32x16_bf16 v[152:167], v[192:195], v[32:35], 0
  s_andn2_b32 s33, s36, s34
  v_exp_f32 v136, v136
  v_exp_f32 v137, v137
  v_exp_f32 v138, v138
  v_mfma_f32_32x32x16_bf16 v[104:119], v[188:191], v[172:175], v[104:119]
  s_cbranch_scc0 .g2_kernel_a_N1c
.g2_kernel_a_N1b:
  v_exp_f32 v139, v139
  v_exp_f32 v140, v140
  v_exp_f32 v141, v141
  v_smfmac_f32_16x16x64_bf16 v[132:135], v[16:19], v[168:175], v20
  s_ff1_i32_b32 s33, s33
  v_exp_f32 v142, v142
  v_exp_f32 v143, v143
  v_mfma_f32_32x32x16_bf16 v[152:167], v[196:199], v[36:39], v[152:167]
  s_bitset1_b32 s34, s33
  v_cvt_pk_bf16_f32 v168, v136, v137
  v_cvt_pk_bf16_f32 v169, v138, v139
  v_cvt_pk_bf16_f32 v170, v140, v141
  v_cvt_pk_bf16_f32 v171, v142, v143
  v_exp_f32 v144, v144
  v_exp_f32 v145, v145
  v_exp_f32 v146, v146
  v_exp_f32 v147, v147
  v_mfma_f32_32x32x16_bf16 v[56:71], v[200:203], v[168:171], v[56:71]
  s_xor_b32 s33, s33, s24
  v_exp_f32 v148, v148
  v_exp_f32 v149, v149
  v_exp_f32 v150, v150
  v_exp_f32 v151, v151
  v_cvt_pk_bf16_f32 v172, v144, v145
  v_cvt_pk_bf16_f32 v173, v146, v147
  v_cvt_pk_bf16_f32 v174, v148, v149
  v_cvt_pk_bf16_f32 v175, v150, v151
  v_mfma_f32_32x32x16_bf16 v[136:151], v[192:195], v[40:43], 0
  s_lshl_b32 s33, s33, s25
  v_exp_f32 v152, v152
  v_exp_f32 v153, v153
  v_exp_f32 v154, v154
  v_mfma_f32_32x32x16_bf16 v[56:71], v[204:207], v[172:175], v[56:71]
  s_add_u32 s22, s20, s33
  v_exp_f32 v155, v155
  v_exp_f32 v156, v156
  v_exp_f32 v157, v157
  v_smfmac_f32_16x16x64_bf16 v[120:123], v[16:19], v[168:175], v20
  s_addc_u32 s23, s21, 0
  v_exp_f32 v158, v158
  v_exp_f32 v159, v159
  v_mfma_f32_32x32x16_bf16 v[136:151], v[196:199], v[44:47], v[136:151]
  global_load_dwordx4 v[176:179], v3, s[22:23] offset:0
  global_load_dwordx4 v[180:183], v3, s[22:23] offset:1024
  global_load_dwordx4 v[184:187], v3, s[22:23] offset:2048
  global_load_dwordx4 v[188:191], v3, s[22:23] offset:3072
  v_cvt_pk_bf16_f32 v168, v152, v153
  v_cvt_pk_bf16_f32 v169, v154, v155
  v_cvt_pk_bf16_f32 v170, v156, v157
  v_cvt_pk_bf16_f32 v171, v158, v159
  v_exp_f32 v160, v160
  v_exp_f32 v161, v161
  v_exp_f32 v162, v162
  v_exp_f32 v163, v163
  v_mfma_f32_32x32x16_bf16 v[72:87], v[200:203], v[168:171], v[72:87]
  v_exp_f32 v164, v164
  v_exp_f32 v165, v165
  v_exp_f32 v166, v166
  v_exp_f32 v167, v167
  v_cvt_pk_bf16_f32 v172, v160, v161
  v_cvt_pk_bf16_f32 v173, v162, v163
  v_cvt_pk_bf16_f32 v174, v164, v165
  v_cvt_pk_bf16_f32 v175, v166, v167
  v_mfma_f32_32x32x16_bf16 v[152:167], v[192:195], v[48:51], 0
  v_exp_f32 v136, v136
  v_exp_f32 v137, v137
  v_exp_f32 v138, v138
  v_mfma_f32_32x32x16_bf16 v[72:87], v[204:207], v[172:175], v[72:87]
  v_exp_f32 v139, v139
  v_exp_f32 v140, v140
  v_exp_f32 v141, v141
  v_smfmac_f32_16x16x64_bf16 v[124:127], v[16:19], v[168:175], v20
  v_exp_f32 v142, v142
  v_exp_f32 v143, v143
  v_mfma_f32_32x32x16_bf16 v[152:167], v[196:199], v[52:55], v[152:167]
  v_cvt_pk_bf16_f32 v168, v136, v137
  v_cvt_pk_bf16_f32 v169, v138, v139
  v_cvt_pk_bf16_f32 v170, v140, v141
  v_cvt_pk_bf16_f32 v171, v142, v143
  v_exp_f32 v144, v144
  v_exp_f32 v145, v145
  v_exp_f32 v146, v146
  v_exp_f32 v147, v147
  v_mfma_f32_32x32x16_bf16 v[88:103], v[200:203], v[168:171], v[88:103]
  s_waitcnt vmcnt(8)
  v_exp_f32 v148, v148
  v_exp_f32 v149, v149
  v_exp_f32 v150, v150
  v_exp_f32 v151, v151
  v_cvt_pk_bf16_f32 v172, v144, v145
  v_cvt_pk_bf16_f32 v173, v146, v147
  v_cvt_pk_bf16_f32 v174, v148, v149
  v_cvt_pk_bf16_f32 v175, v150, v151
  v_mfma_f32_32x32x16_bf16 v[136:151], v[208:211], v[24:27], 0
  v_exp_f32 v152, v152
  v_exp_f32 v153, v153
  v_exp_f32 v154, v154
  v_mfma_f32_32x32x16_bf16 v[88:103], v[204:207], v[172:175], v[88:103]
  v_exp_f32 v155, v155
  v_exp_f32 v156, v156
  v_exp_f32 v157, v157
  v_smfmac_f32_16x16x64_bf16 v[128:131], v[16:19], v[168:175], v20
  v_exp_f32 v158, v158
  v_exp_f32 v159, v159
  v_mfma_f32_32x32x16_bf16 v[136:151], v[212:215], v[28:31], v[136:151]
  v_cvt_pk_bf16_f32 v168, v152, v153
  v_cvt_pk_bf16_f32 v169, v154, v155
  v_cvt_pk_bf16_f32 v170, v156, v157
  v_cvt_pk_bf16_f32 v171, v158, v159
  v_exp_f32 v160, v160
  v_exp_f32 v161, v161
  v_exp_f32 v162, v162
  v_exp_f32 v163, v163
  v_mfma_f32_32x32x16_bf16 v[104:119], v[200:203], v[168:171], v[104:119]
  v_exp_f32 v164, v164
  v_exp_f32 v165, v165
  v_exp_f32 v166, v166
  v_exp_f32 v167, v167
  v_cvt_pk_bf16_f32 v172, v160, v161
  v_cvt_pk_bf16_f32 v173, v162, v163
  v_cvt_pk_bf16_f32 v174, v164, v165
  v_cvt_pk_bf16_f32 v175, v166, v167
  v_mfma_f32_32x32x16_bf16 v[152:167], v[208:211], v[32:35], 0
  s_andn2_b32 s33, s36, s34
  v_exp_f32 v136, v136
  v_exp_f32 v137, v137
  v_exp_f32 v138, v138
  v_mfma_f32_32x32x16_bf16 v[104:119], v[204:207], v[172:175], v[104:119]
  s_cbranch_scc0 .g2_kernel_a_N2c
.g2_kernel_a_N2b:
  v_exp_f32 v139, v139
  v_exp_f32 v140, v140
  v_exp_f32 v141, v141
  v_smfmac_f32_16x16x64_bf16 v[132:135], v[16:19], v[168:175], v20
  s_ff1_i32_b32 s33, s33
  v_exp_f32 v142, v142
  v_exp_f32 v143, v143
  v_mfma_f32_32x32x16_bf16 v[152:167], v[212:215], v[36:39], v[152:167]
  s_bitset1_b32 s34, s33
  v_cvt_pk_bf16_f32 v168, v136, v137
  v_cvt_pk_bf16_f32 v169, v138, v139
  v_cvt_pk_bf16_f32 v170, v140, v141
  v_cvt_pk_bf16_f32 v171, v142, v143
  v_exp_f32 v144, v144
  v_exp_f32 v145, v145
  v_exp_f32 v146, v146
  v_exp_f32 v147, v147
  v_mfma_f32_32x32x16_bf16 v[56:71], v[216:219], v[168:171], v[56:71]
  s_xor_b32 s33, s33, s24
  v_exp_f32 v148, v148
  v_exp_f32 v149, v149
  v_exp_f32 v150, v150
  v_exp_f32 v151, v151
  v_cvt_pk_bf16_f32 v172, v144, v145
  v_cvt_pk_bf16_f32 v173, v146, v147
  v_cvt_pk_bf16_f32 v174, v148, v149
  v_cvt_pk_bf16_f32 v175, v150, v151
  v_mfma_f32_32x32x16_bf16 v[136:151], v[208:211], v[40:43], 0
  s_lshl_b32 s33, s33, s25
  v_exp_f32 v152, v152
  v_exp_f32 v153, v153
  v_exp_f32 v154, v154
  v_mfma_f32_32x32x16_bf16 v[56:71], v[220:223], v[172:175], v[56:71]
  s_add_u32 s22, s20, s33
  v_exp_f32 v155, v155
  v_exp_f32 v156, v156
  v_exp_f32 v157, v157
  v_smfmac_f32_16x16x64_bf16 v[120:123], v[16:19], v[168:175], v20
  s_addc_u32 s23, s21, 0
  v_exp_f32 v158, v158
  v_exp_f32 v159, v159
  v_mfma_f32_32x32x16_bf16 v[136:151], v[212:215], v[44:47], v[136:151]
  global_load_dwordx4 v[192:195], v3, s[22:23] offset:0
  global_load_dwordx4 v[196:199], v3, s[22:23] offset:1024
  global_load_dwordx4 v[200:203], v3, s[22:23] offset:2048
  global_load_dwordx4 v[204:207], v3, s[22:23] offset:3072
  v_cvt_pk_bf16_f32 v168, v152, v153
  v_cvt_pk_bf16_f32 v169, v154, v155
  v_cvt_pk_bf16_f32 v170, v156, v157
  v_cvt_pk_bf16_f32 v171, v158, v159
  v_exp_f32 v160, v160
  v_exp_f32 v161, v161
  v_exp_f32 v162, v162
  v_exp_f32 v163, v163
  v_mfma_f32_32x32x16_bf16 v[72:87], v[216:219], v[168:171], v[72:87]
  v_exp_f32 v164, v164
  v_exp_f32 v165, v165
  v_exp_f32 v166, v166
  v_exp_f32 v167, v167
  v_cvt_pk_bf16_f32 v172, v160, v161
  v_cvt_pk_bf16_f32 v173, v162, v163
  v_cvt_pk_bf16_f32 v174, v164, v165
  v_cvt_pk_bf16_f32 v175, v166, v167
  v_mfma_f32_32x32x16_bf16 v[152:167], v[208:211], v[48:51], 0
  v_exp_f32 v136, v136
  v_exp_f32 v137, v137
  v_exp_f32 v138, v138
  v_mfma_f32_32x32x16_bf16 v[72:87], v[220:223], v[172:175], v[72:87]
  v_exp_f32 v139, v139
  v_exp_f32 v140, v140
  v_exp_f32 v141, v141
  v_smfmac_f32_16x16x64_bf16 v[124:127], v[16:19], v[168:175], v20
  v_exp_f32 v142, v142
  v_exp_f32 v143, v143
  v_mfma_f32_32x32x16_bf16 v[152:167], v[212:215], v[52:55], v[152:167]
  v_cvt_pk_bf16_f32 v168, v136, v137
  v_cvt_pk_bf16_f32 v169, v138, v139
  v_cvt_pk_bf16_f32 v170, v140, v141
  v_cvt_pk_bf16_f32 v171, v142, v143
  v_exp_f32 v144, v144
  v_exp_f32 v145, v145
  v_exp_f32 v146, v146
  v_exp_f32 v147, v147
  v_mfma_f32_32x32x16_bf16 v[88:103], v[216:219], v[168:171], v[88:103]
  s_waitcnt vmcnt(8)
  v_exp_f32 v148, v148
  v_exp_f32 v149, v149
  v_exp_f32 v150, v150
  v_exp_f32 v151, v151
  v_cvt_pk_bf16_f32 v172, v144, v145
  v_cvt_pk_bf16_f32 v173, v146, v147
  v_cvt_pk_bf16_f32 v174, v148, v149
  v_cvt_pk_bf16_f32 v175, v150, v151
  v_mfma_f32_32x32x16_bf16 v[136:151], v[224:227], v[24:27], 0
  v_exp_f32 v152, v152
  v_exp_f32 v153, v153
  v_exp_f32 v154, v154
  v_mfma_f32_32x32x16_bf16 v[88:103], v[220:223], v[172:175], v[88:103]
  v_exp_f32 v155, v155
  v_exp_f32 v156, v156
  v_exp_f32 v157, v157
  v_smfmac_f32_16x16x64_bf16 v[128:131], v[16:19], v[168:175], v20
  v_exp_f32 v158, v158
  v_exp_f32 v159, v159
  v_mfma_f32_32x32x16_bf16 v[136:151], v[228:231], v[28:31], v[136:151]
  s_and_b32 s28, s32, 3
  v_cvt_pk_bf16_f32 v168, v152, v153
  v_cvt_pk_bf16_f32 v169, v154, v155
  v_cvt_pk_bf16_f32 v170, v156, v157
  v_cvt_pk_bf16_f32 v171, v158, v159
  v_exp_f32 v160, v160
  v_exp_f32 v161, v161
  v_exp_f32 v162, v162
  v_exp_f32 v163, v163
  v_mfma_f32_32x32x16_bf16 v[104:119], v[216:219], v[168:171], v[104:119]
  s_cmp_eq_u32 s28, 3
  v_exp_f32 v164, v164
  v_exp_f32 v165, v165
  v_exp_f32 v166, v166
  v_exp_f32 v167, v167
  v_cvt_pk_bf16_f32 v172, v160, v161
  v_cvt_pk_bf16_f32 v173, v162, v163
  v_cvt_pk_bf16_f32 v174, v164, v165
  v_cvt_pk_bf16_f32 v175, v166, v167
  s_cbranch_scc1 .g2_kernel_a_last
  v_mfma_f32_32x32x16_bf16 v[152:167], v[224:227], v[32:35], 0
  s_andn2_b32 s33, s36, s34
  v_exp_f32 v136, v136
  v_exp_f32 v137, v137
  v_exp_f32 v138, v138
  v_mfma_f32_32x32x16_bf16 v[104:119], v[220:223], v[172:175], v[104:119]
  s_cbranch_scc0 .g2_kernel_a_N3c
.g2_kernel_a_N3b:
  v_exp_f32 v139, v139
  v_exp_f32 v140, v140
  v_exp_f32 v141, v141
  v_smfmac_f32_16x16x64_bf16 v[132:135], v[16:19], v[168:175], v20
  s_ff1_i32_b32 s33, s33
  v_exp_f32 v142, v142
  v_exp_f32 v143, v143
  v_mfma_f32_32x32x16_bf16 v[152:167], v[228:231], v[36:39], v[152:167]
  s_bitset1_b32 s34, s33
  v_cvt_pk_bf16_f32 v168, v136, v137
  v_cvt_pk_bf16_f32 v169, v138, v139
  v_cvt_pk_bf16_f32 v170, v140, v141
  v_cvt_pk_bf16_f32 v171, v142, v143
  v_exp_f32 v144, v144
  v_exp_f32 v145, v145
  v_exp_f32 v146, v146
  v_exp_f32 v147, v147
  v_mfma_f32_32x32x16_bf16 v[56:71], v[232:235], v[168:171], v[56:71]
  s_xor_b32 s33, s33, s24
  v_exp_f32 v148, v148
  v_exp_f32 v149, v149
  v_exp_f32 v150, v150
  v_exp_f32 v151, v151
  v_cvt_pk_bf16_f32 v172, v144, v145
  v_cvt_pk_bf16_f32 v173, v146, v147
  v_cvt_pk_bf16_f32 v174, v148, v149
  v_cvt_pk_bf16_f32 v175, v150, v151
  v_mfma_f32_32x32x16_bf16 v[136:151], v[224:227], v[40:43], 0
  s_lshl_b32 s33, s33, s25
  v_exp_f32 v152, v152
  v_exp_f32 v153, v153
  v_exp_f32 v154, v154
  v_mfma_f32_32x32x16_bf16 v[56:71], v[236:239], v[172:175], v[56:71]
  s_add_u32 s22, s20, s33
  v_exp_f32 v155, v155
  v_exp_f32 v156, v156
  v_exp_f32 v157, v157
  v_smfmac_f32_16x16x64_bf16 v[120:123], v[16:19], v[168:175], v20
  s_addc_u32 s23, s21, 0
  v_exp_f32 v158, v158
  v_exp_f32 v159, v159
  v_mfma_f32_32x32x16_bf16 v[136:151], v[228:231], v[44:47], v[136:151]
  global_load_dwordx4 v[208:211], v3, s[22:23] offset:0
  global_load_dwordx4 v[212:215], v3, s[22:23] offset:1024
  global_load_dwordx4 v[216:219], v3, s[22:23] offset:2048
  global_load_dwordx4 v[220:223], v3, s[22:23] offset:3072
  v_cvt_pk_bf16_f32 v168, v152, v153
  v_cvt_pk_bf16_f32 v169, v154, v155
  v_cvt_pk_bf16_f32 v170, v156, v157
  v_cvt_pk_bf16_f32 v171, v158, v159
  v_exp_f32 v160, v160
  v_exp_f32 v161, v161
  v_exp_f32 v162, v162
  v_exp_f32 v163, v163
  v_mfma_f32_32x32x16_bf16 v[72:87], v[232:235], v[168:171], v[72:87]
  v_exp_f32 v164, v164
  v_exp_f32 v165, v165
  v_exp_f32 v166, v166
  v_exp_f32 v167, v167
  v_cvt_pk_bf16_f32 v172, v160, v161
  v_cvt_pk_bf16_f32 v173, v162, v163
  v_cvt_pk_bf16_f32 v174, v164, v165
  v_cvt_pk_bf16_f32 v175, v166, v167
  v_mfma_f32_32x32x16_bf16 v[152:167], v[224:227], v[48:51], 0
  v_exp_f32 v136, v136
  v_exp_f32 v137, v137
  v_exp_f32 v138, v138
  v_mfma_f32_32x32x16_bf16 v[72:87], v[236:239], v[172:175], v[72:87]
  v_exp_f32 v139, v139
  v_exp_f32 v140, v140
  v_exp_f32 v141, v141
  v_smfmac_f32_16x16x64_bf16 v[124:127], v[16:19], v[168:175], v20
  v_exp_f32 v142, v142
  v_exp_f32 v143, v143
  v_mfma_f32_32x32x16_bf16 v[152:167], v[228:231], v[52:55], v[152:167]
  v_cvt_pk_bf16_f32 v168, v136, v137
  v_cvt_pk_bf16_f32 v169, v138, v139
  v_cvt_pk_bf16_f32 v170, v140, v141
  v_cvt_pk_bf16_f32 v171, v142, v143
  v_exp_f32 v144, v144
  v_exp_f32 v145, v145
  v_exp_f32 v146, v146
  v_exp_f32 v147, v147
  v_mfma_f32_32x32x16_bf16 v[88:103], v[232:235], v[168:171], v[88:103]
  s_waitcnt vmcnt(8)
  v_exp_f32 v148, v148
  v_exp_f32 v149, v149
  v_exp_f32 v150, v150
  v_exp_f32 v151, v151
  v_cvt_pk_bf16_f32 v172, v144, v145
  v_cvt_pk_bf16_f32 v173, v146, v147
  v_cvt_pk_bf16_f32 v174, v148, v149
  v_cvt_pk_bf16_f32 v175, v150, v151
  v_mfma_f32_32x32x16_bf16 v[136:151], v[176:179], v[24:27], 0
  v_exp_f32 v152, v152
  v_exp_f32 v153, v153
  v_exp_f32 v154, v154
  v_mfma_f32_32x32x16_bf16 v[88:103], v[236:239], v[172:175], v[88:103]
  v_exp_f32 v155, v155
  v_exp_f32 v156, v156
  v_exp_f32 v157, v157
  v_smfmac_f32_16x16x64_bf16 v[128:131], v[16:19], v[168:175], v20
  v_exp_f32 v158, v158
  v_exp_f32 v159, v159
  v_mfma_f32_32x32x16_bf16 v[136:151], v[180:183], v[28:31], v[136:151]
  s_add_u32 s32, s32, 1
  v_cvt_pk_bf16_f32 v168, v152, v153
  v_cvt_pk_bf16_f32 v169, v154, v155
  v_cvt_pk_bf16_f32 v170, v156, v157
  v_cvt_pk_bf16_f32 v171, v158, v159
  v_exp_f32 v160, v160
  v_exp_f32 v161, v161
  v_exp_f32 v162, v162
  v_exp_f32 v163, v163
  v_mfma_f32_32x32x16_bf16 v[104:119], v[232:235], v[168:171], v[104:119]
  s_cmp_eq_u32 s35, 0
  v_exp_f32 v164, v164
  v_exp_f32 v165, v165
  v_exp_f32 v166, v166
  v_exp_f32 v167, v167
  v_cvt_pk_bf16_f32 v172, v160, v161
  v_cvt_pk_bf16_f32 v173, v162, v163
  v_cvt_pk_bf16_f32 v174, v164, v165
  v_cvt_pk_bf16_f32 v175, v166, v167
  s_cbranch_scc1 .g2_kernel_a_loop
  s_branch .g2_kernel_a_redo
.g2_kernel_a_last:
  v_mfma_f32_32x32x16_bf16 v[152:167], v[224:227], v[32:35], 0
  ds_read_b32 v21, v13 offset:8
  s_andn2_b32 s33, s36, s34
  v_exp_f32 v136, v136
  v_exp_f32 v137, v137
  v_exp_f32 v138, v138
  v_mfma_f32_32x32x16_bf16 v[104:119], v[220:223], v[172:175], v[104:119]
  s_cbranch_scc0 .g2_kernel_a_L3c
.g2_kernel_a_L3b:
  v_exp_f32 v139, v139
  v_exp_f32 v140, v140
  v_exp_f32 v141, v141
  v_smfmac_f32_16x16x64_bf16 v[132:135], v[16:19], v[168:175], v20
  s_ff1_i32_b32 s33, s33
  v_exp_f32 v142, v142
  v_exp_f32 v143, v143
  v_mfma_f32_32x32x16_bf16 v[152:167], v[228:231], v[36:39], v[152:167]
  s_bitset1_b32 s34, s33
  ds_read_b128 v[24:27], v14 offset:0
  v_cvt_pk_bf16_f32 v168, v136, v137
  v_cvt_pk_bf16_f32 v169, v138, v139
  v_cvt_pk_bf16_f32 v170, v140, v141
  v_cvt_pk_bf16_f32 v171, v142, v143
  v_exp_f32 v144, v144
  v_exp_f32 v145, v145
  v_exp_f32 v146, v146
  v_exp_f32 v147, v147
  v_mfma_f32_32x32x16_bf16 v[56:71], v[232:235], v[168:171], v[56:71]
  s_xor_b32 s33, s33, s24
  ds_read_b128 v[28:31], v14 offset:1024
  v_exp_f32 v148, v148
  v_exp_f32 v149, v149
  v_exp_f32 v150, v150
  v_exp_f32 v151, v151
  v_cvt_pk_bf16_f32 v172, v144, v145
  v_cvt_pk_bf16_f32 v173, v146, v147
  v_cvt_pk_bf16_f32 v174, v148, v149
  v_cvt_pk_bf16_f32 v175, v150, v151
  v_mfma_f32_32x32x16_bf16 v[136:151], v[224:227], v[40:43], 0
  s_waitcnt lgkmcnt(2)
  s_lshl_b32 s33, s33, s25
  v_exp_f32 v152, v152
  v_exp_f32 v153, v153
  v_exp_f32 v154, v154
  v_mfma_f32_32x32x16_bf16 v[56:71], v[236:239], v[172:175], v[56:71]
  v_cmp_gt_u32 vcc, s27, v21
  s_add_u32 s22, s20, s33
  v_exp_f32 v155, v155
  v_exp_f32 v156, v156
  v_exp_f32 v157, v157
  v_smfmac_f32_16x16x64_bf16 v[120:123], v[16:19], v[168:175], v20
  s_addc_u32 s23, s21, 0
  v_exp_f32 v158, v158
  v_exp_f32 v159, v159
  v_mfma_f32_32x32x16_bf16 v[136:151], v[228:231], v[44:47], v[136:151]
  global_load_dwordx4 v[208:211], v3, s[22:23] offset:0
  global_load_dwordx4 v[212:215], v3, s[22:23] offset:1024
  global_load_dwordx4 v[216:219], v3, s[22:23] offset:2048
  global_load_dwordx4 v[220:223], v3, s[22:23] offset:3072
  v_cvt_pk_bf16_f32 v168, v152, v153
  v_cvt_pk_bf16_f32 v169, v154, v155
  v_cvt_pk_bf16_f32 v170, v156, v157
  v_cvt_pk_bf16_f32 v171, v158, v159
  v_exp_f32 v160, v160
  v_exp_f32 v161, v161
  v_exp_f32 v162, v162
  v_exp_f32 v163, v163
  v_mfma_f32_32x32x16_bf16 v[72:87], v[232:235], v[168:171], v[72:87]
  s_cbranch_vccnz .g2_kernel_a_L3g
.g2_kernel_a_L3h:
  ds_read_b128 v[32:35], v14 offset:2048
  ds_read_b128 v[36:39], v14 offset:3072
  ds_write_b128 v9, v[56:59] offset:0
  v_add_f32 v6, v120, v121
  ds_write_b128 v9, v[60:63] offset:1024
  v_mov_b32 v120, 0
  v_exp_f32 v164, v164
  v_exp_f32 v165, v165
  v_exp_f32 v166, v166
  v_exp_f32 v167, v167
  v_cvt_pk_bf16_f32 v172, v160, v161
  v_cvt_pk_bf16_f32 v173, v162, v163
  v_cvt_pk_bf16_f32 v174, v164, v165
  v_cvt_pk_bf16_f32 v175, v166, v167
  v_mfma_f32_32x32x16_bf16 v[152:167], v[224:227], v[48:51], 0
  ds_write_b128 v9, v[64:67] offset:2048
  v_mov_b32 v121, 0
  v_exp_f32 v136, v136
  v_exp_f32 v137, v137
  v_exp_f32 v138, v138
  v_mfma_f32_32x32x16_bf16 v[72:87], v[236:239], v[172:175], v[72:87]
  ds_write_b128 v9, v[68:71] offset:3072
  ds_write_b32 v10, v6 offset:0
  ds_write_b32 v11, v12 offset:0
  v_exp_f32 v139, v139
  v_exp_f32 v140, v140
  v_exp_f32 v141, v141
  v_smfmac_f32_16x16x64_bf16 v[124:127], v[16:19], v[168:175], v20
  v_exp_f32 v142, v142
  v_exp_f32 v143, v143
  v_mfma_f32_32x32x16_bf16 v[152:167], v[228:231], v[52:55], v[152:167]
  ds_read_b128 v[40:43], v14 offset:4096
  s_wakeup
  v_cvt_pk_bf16_f32 v168, v136, v137
  v_cvt_pk_bf16_f32 v169, v138, v139
  v_cvt_pk_bf16_f32 v170, v140, v141
  v_cvt_pk_bf16_f32 v171, v142, v143
  v_exp_f32 v144, v144
  v_exp_f32 v145, v145
  v_exp_f32 v146, v146
  v_exp_f32 v147, v147
  v_mfma_f32_32x32x16_bf16 v[88:103], v[232:235], v[168:171], v[88:103]
  s_waitcnt vmcnt(8)
  ds_read_b128 v[44:47], v14 offset:5120
  ds_write_b128 v9, v[72:75] offset:16384
  v_add_f32 v6, v124, v125
  ds_write_b128 v9, v[76:79] offset:17408
  v_mov_b32 v124, 0
  v_exp_f32 v148, v148
  v_exp_f32 v149, v149
  v_exp_f32 v150, v150
  v_exp_f32 v151, v151
  v_cvt_pk_bf16_f32 v172, v144, v145
  v_cvt_pk_bf16_f32 v173, v146, v147
  v_cvt_pk_bf16_f32 v174, v148, v149
  v_cvt_pk_bf16_f32 v175, v150, v151
  s_waitcnt lgkmcnt(12)
  v_mfma_f32_32x32x16_bf16 v[136:151], v[176:179], v[24:27], 0
  ds_write_b128 v9, v[80:83] offset:18432
  v_mov_b32 v125, 0
  v_exp_f32 v152, v152
  v_exp_f32 v153, v153
  v_exp_f32 v154, v154
  v_mfma_f32_32x32x16_bf16 v[88:103], v[236:239], v[172:175], v[88:103]
  ds_write_b128 v9, v[84:87] offset:19456
  ds_write_b32 v10, v6 offset:512
  ds_write_b32 v11, v12 offset:16
  v_exp_f32 v155, v155
  v_exp_f32 v156, v156
  v_exp_f32 v157, v157
  v_smfmac_f32_16x16x64_bf16 v[128:131], v[16:19], v[168:175], v20
  v_exp_f32 v158, v158
  v_exp_f32 v159, v159
  v_mfma_f32_32x32x16_bf16 v[136:151], v[180:183], v[28:31], v[136:151]
  ds_read_b128 v[48:51], v14 offset:6144
  v_cvt_pk_bf16_f32 v168, v152, v153
  v_cvt_pk_bf16_f32 v169, v154, v155
  v_cvt_pk_bf16_f32 v170, v156, v157
  v_cvt_pk_bf16_f32 v171, v158, v159
  v_exp_f32 v160, v160
  v_exp_f32 v161, v161
  v_exp_f32 v162, v162
  v_exp_f32 v163, v163
  v_mfma_f32_32x32x16_bf16 v[104:119], v[232:235], v[168:171], v[104:119]
  ds_read_b128 v[52:55], v14 offset:7168
  ds_write_b128 v9, v[88:91] offset:32768
  v_add_f32 v6, v128, v129
  ds_write_b128 v9, v[92:95] offset:33792
  v_mov_b32 v128, 0
  ds_write_b128 v9, v[96:99] offset:34816
  v_mov_b32 v129, 0
  ds_write_b128 v9, v[100:103] offset:35840
  ds_write_b32 v10, v6 offset:1024
  ds_write_b32 v11, v12 offset:32
  s_add_u32 s32, s32, 1
  v_exp_f32 v164, v164
  v_exp_f32 v165, v165
  v_exp_f32 v166, v166
  v_exp_f32 v167, v167
  v_cvt_pk_bf16_f32 v172, v160, v161
  v_cvt_pk_bf16_f32 v173, v162, v163
  v_cvt_pk_bf16_f32 v174, v164, v165
  v_cvt_pk_bf16_f32 v175, v166, v167
  s_cmp_eq_u32 s32, 8
  s_cbranch_scc1 .g2_kernel_a_end
  s_waitcnt lgkmcnt(15)
  v_mfma_f32_32x32x16_bf16 v[152:167], v[176:179], v[32:35], 0
  s_andn2_b32 s33, s36, s34
  v_exp_f32 v136, v136
  v_exp_f32 v137, v137
  v_exp_f32 v138, v138
  v_mfma_f32_32x32x16_bf16 v[104:119], v[236:239], v[172:175], v[104:119]
  s_cbranch_scc0 .g2_kernel_a_G0c
.g2_kernel_a_G0b:
  v_exp_f32 v139, v139
  v_exp_f32 v140, v140
  v_exp_f32 v141, v141
  v_smfmac_f32_16x16x64_bf16 v[132:135], v[16:19], v[168:175], v20
  s_ff1_i32_b32 s33, s33
  v_exp_f32 v142, v142
  v_exp_f32 v143, v143
  v_mfma_f32_32x32x16_bf16 v[152:167], v[180:183], v[36:39], v[152:167]
  s_bitset1_b32 s34, s33
  v_cvt_pk_bf16_f32 v168, v136, v137
  v_cvt_pk_bf16_f32 v169, v138, v139
  v_cvt_pk_bf16_f32 v170, v140, v141
  v_cvt_pk_bf16_f32 v171, v142, v143
  v_exp_f32 v144, v144
  v_exp_f32 v145, v145
  v_exp_f32 v146, v146
  v_exp_f32 v147, v147
  s_waitcnt lgkmcnt(15)
  v_mfma_f32_32x32x16_bf16 v[56:71], v[184:187], v[168:171], 0
  s_xor_b32 s33, s33, s24
  ds_write_b128 v9, v[104:107] offset:49152
  v_add_f32 v6, v132, v133
  v_exp_f32 v148, v148
  v_exp_f32 v149, v149
  v_exp_f32 v150, v150
  v_exp_f32 v151, v151
  v_cvt_pk_bf16_f32 v172, v144, v145
  v_cvt_pk_bf16_f32 v173, v146, v147
  v_cvt_pk_bf16_f32 v174, v148, v149
  v_cvt_pk_bf16_f32 v175, v150, v151
  s_waitcnt lgkmcnt(15)
  v_mfma_f32_32x32x16_bf16 v[136:151], v[176:179], v[40:43], 0
  s_lshl_b32 s33, s33, s25
  ds_write_b128 v9, v[108:111] offset:50176
  v_mov_b32 v132, 0
  v_exp_f32 v152, v152
  v_exp_f32 v153, v153
  v_exp_f32 v154, v154
  v_mfma_f32_32x32x16_bf16 v[56:71], v[188:191], v[172:175], v[56:71]
  s_add_u32 s22, s20, s33
  ds_write_b128 v9, v[112:115] offset:51200
  v_mov_b32 v133, 0
  v_exp_f32 v155, v155
  v_exp_f32 v156, v156
  v_exp_f32 v157, v157
  v_smfmac_f32_16x16x64_bf16 v[120:123], v[16:19], v[168:175], v20
  s_addc_u32 s23, s21, 0
  ds_write_b128 v9, v[116:119] offset:52224
  v_exp_f32 v158, v158
  v_exp_f32 v159, v159
  v_mfma_f32_32x32x16_bf16 v[136:151], v[180:183], v[44:47], v[136:151]
  global_load_dwordx4 v[224:227], v3, s[22:23] offset:0
  global_load_dwordx4 v[228:231], v3, s[22:23] offset:1024
  global_load_dwordx4 v[232:235], v3, s[22:23] offset:2048
  global_load_dwordx4 v[236:239], v3, s[22:23] offset:3072
  v_cvt_pk_bf16_f32 v168, v152, v153
  v_cvt_pk_bf16_f32 v169, v154, v155
  v_cvt_pk_bf16_f32 v170, v156, v157
  v_cvt_pk_bf16_f32 v171, v158, v159
  v_exp_f32 v160, v160
  v_exp_f32 v161, v161
  v_exp_f32 v162, v162
  v_exp_f32 v163, v163
  s_waitcnt lgkmcnt(14)
  v_mfma_f32_32x32x16_bf16 v[72:87], v[184:187], v[168:171], 0
  ds_write_b32 v10, v6 offset:1536
  ds_write_b32 v11, v12 offset:48
  v_exp_f32 v164, v164
  v_exp_f32 v165, v165
  v_exp_f32 v166, v166
  v_exp_f32 v167, v167
  v_cvt_pk_bf16_f32 v172, v160, v161
  v_cvt_pk_bf16_f32 v173, v162, v163
  v_cvt_pk_bf16_f32 v174, v164, v165
  v_cvt_pk_bf16_f32 v175, v166, v167
  s_waitcnt lgkmcnt(12)
  v_mfma_f32_32x32x16_bf16 v[152:167], v[176:179], v[48:51], 0
  v_add_u32 v12, 1, v12
  v_exp_f32 v136, v136
  v_exp_f32 v137, v137
  v_exp_f32 v138, v138
  v_mfma_f32_32x32x16_bf16 v[72:87], v[188:191], v[172:175], v[72:87]
  v_exp_f32 v139, v139
  v_exp_f32 v140, v140
  v_exp_f32 v141, v141
  v_smfmac_f32_16x16x64_bf16 v[124:127], v[16:19], v[168:175], v20
  s_add_u32 s27, s27, 4
  v_exp_f32 v142, v142
  v_exp_f32 v143, v143
  v_mfma_f32_32x32x16_bf16 v[152:167], v[180:183], v[52:55], v[152:167]
  v_cvt_pk_bf16_f32 v168, v136, v137
  v_cvt_pk_bf16_f32 v169, v138, v139
  v_cvt_pk_bf16_f32 v170, v140, v141
  v_cvt_pk_bf16_f32 v171, v142, v143
  v_exp_f32 v144, v144
  v_exp_f32 v145, v145
  v_exp_f32 v146, v146
  v_exp_f32 v147, v147
  s_waitcnt lgkmcnt(8)
  v_mfma_f32_32x32x16_bf16 v[88:103], v[184:187], v[168:171], 0
  s_waitcnt vmcnt(8)
  v_exp_f32 v148, v148
  v_exp_f32 v149, v149
  v_exp_f32 v150, v150
  v_exp_f32 v151, v151
  v_cvt_pk_bf16_f32 v172, v144, v145
  v_cvt_pk_bf16_f32 v173, v146, v147
  v_cvt_pk_bf16_f32 v174, v148, v149
  v_cvt_pk_bf16_f32 v175, v150, v151
  v_mfma_f32_32x32x16_bf16 v[136:151], v[192:195], v[24:27], 0
  v_exp_f32 v152, v152
  v_exp_f32 v153, v153
  v_exp_f32 v154, v154
  v_mfma_f32_32x32x16_bf16 v[88:103], v[188:191], v[172:175], v[88:103]
  v_exp_f32 v155, v155
  v_exp_f32 v156, v156
  v_exp_f32 v157, v157
  v_smfmac_f32_16x16x64_bf16 v[128:131], v[16:19], v[168:175], v20
  v_exp_f32 v158, v158
  v_exp_f32 v159, v159
  v_mfma_f32_32x32x16_bf16 v[136:151], v[196:199], v[28:31], v[136:151]
  v_cvt_pk_bf16_f32 v168, v152, v153
  v_cvt_pk_bf16_f32 v169, v154, v155
  v_cvt_pk_bf16_f32 v170, v156, v157
  v_cvt_pk_bf16_f32 v171, v158, v159
  v_exp_f32 v160, v160
  v_exp_f32 v161, v161
  v_exp_f32 v162, v162
  v_exp_f32 v163, v163
  s_waitcnt lgkmcnt(2)
  v_mfma_f32_32x32x16_bf16 v[104:119], v[184:187], v[168:171], 0
  v_exp_f32 v164, v164
  v_exp_f32 v165, v165
  v_exp_f32 v166, v166
  v_exp_f32 v167, v167
  v_cvt_pk_bf16_f32 v172, v160, v161
  v_cvt_pk_bf16_f32 v173, v162, v163
  v_cvt_pk_bf16_f32 v174, v164, v165
  v_cvt_pk_bf16_f32 v175, v166, v167
  s_branch .g2_kernel_a_n1
.g2_kernel_a_end:
  v_mfma_f32_32x32x16_bf16 v[104:119], v[236:239], v[172:175], v[104:119]
  v_smfmac_f32_16x16x64_bf16 v[132:135], v[16:19], v[168:175], v20
  s_nop 10
  ds_write_b128 v9, v[104:107] offset:49152
  v_add_f32 v6, v132, v133
  ds_write_b128 v9, v[108:111] offset:50176
  v_mov_b32 v132, 0
  ds_write_b128 v9, v[112:115] offset:51200
  v_mov_b32 v133, 0
  ds_write_b128 v9, v[116:119] offset:52224
  ds_write_b32 v10, v6 offset:1536
  ds_write_b32 v11, v12 offset:48
  s_waitcnt lgkmcnt(6)
  v_mov_b32 v20, s71
  v_lshrrev_b32 v17, 5, v2
  v_and_b32 v18, 31, v2
  s_lshl_b32 s28, s16, 5
  v_add_u32 v19, s28, v18
  v_lshlrev_b32 v7, 2, v19
  v_add_u32 v7, 155648, v7
  ds_read_b32 v8, v7 offset:3840
  ds_read_b32 v9, v7 offset:4352
  ds_read_b32 v16, v20 offset:24
  ds_read_b32 v6, v20 offset:52
  v_add_u32 v19, 1, v19
  v_bfe_u32 v7, v2, 2, 2
  v_lshl_add_u32 v14, v17, 2, v7
  v_lshlrev_b32 v14, 7, v14
  v_lshrrev_b32 v7, 1, v7
  v_lshl_add_u32 v14, v7, 6, v14
  v_bfe_u32 v7, v2, 4, 1
  v_lshl_add_u32 v14, v7, 5, v14
  v_and_b32 v7, 1, v2
  v_lshl_add_u32 v14, v7, 4, v14
  v_bfe_u32 v7, v2, 1, 1
  v_lshl_add_u32 v14, v7, 3, v14
  v_xor_b32 v15, 64, v14
  v_and_b32 v7, 7, v2
  v_xor_b32 v7, s24, v7
  s_lshl_b32 s28, s16, 6
  s_add_u32 s28, s28, 157952
  v_lshl_add_u32 v21, v7, 3, s28
  v_lshlrev_b32 v24, 16, v240
  v_and_b32 v25, 0xffff0000, v240
  v_lshlrev_b32 v26, 16, v241
  v_and_b32 v27, 0xffff0000, v241
  v_lshlrev_b32 v28, 16, v242
  v_and_b32 v29, 0xffff0000, v242
  v_lshlrev_b32 v30, 16, v243
  v_and_b32 v31, 0xffff0000, v243
  v_lshlrev_b32 v32, 16, v244
  v_and_b32 v33, 0xffff0000, v244
  v_lshlrev_b32 v34, 16, v245
  v_and_b32 v35, 0xffff0000, v245
  v_lshlrev_b32 v36, 16, v246
  v_and_b32 v37, 0xffff0000, v246
  v_lshlrev_b32 v38, 16, v247
  v_and_b32 v39, 0xffff0000, v247
  v_lshlrev_b32 v40, 16, v248
  v_and_b32 v41, 0xffff0000, v248
  v_lshlrev_b32 v42, 16, v249
  v_and_b32 v43, 0xffff0000, v249
  v_lshlrev_b32 v44, 16, v250
  v_and_b32 v45, 0xffff0000, v250
  v_lshlrev_b32 v46, 16, v251
  v_and_b32 v47, 0xffff0000, v251
  v_lshlrev_b32 v48, 16, v252
  v_and_b32 v49, 0xffff0000, v252
  v_lshlrev_b32 v50, 16, v253
  v_and_b32 v51, 0xffff0000, v253
  v_lshlrev_b32 v52, 16, v254
  v_and_b32 v53, 0xffff0000, v254
  v_lshlrev_b32 v54, 16, v255
  v_and_b32 v55, 0xffff0000, v255
  s_waitcnt lgkmcnt(0)
  v_cmp_gt_u32 vcc, 4, v6
  s_cbranch_vccnz .g2_kernel_w_aw
.g2_kernel_w_ab:
  s_xor_b32 s28, s24, 0
  s_lshl_b32 s28, s28, 13
  s_add_u32 s28, s28, 65536
  v_add_u32 v10, s28, v14
  v_add_u32 v11, s28, v15
  ds_read_b64_tr_b16 v[104:105], v10 offset:0
  ds_read_b64_tr_b16 v[106:107], v10 offset:1024
  ds_read_b64_tr_b16 v[108:109], v11 offset:0
  ds_read_b64_tr_b16 v[110:111], v11 offset:1024
  ds_read_b64_tr_b16 v[112:113], v10 offset:2048
  ds_read_b64_tr_b16 v[114:115], v10 offset:3072
  ds_read_b64_tr_b16 v[116:117], v11 offset:2048
  ds_read_b64_tr_b16 v[118:119], v11 offset:3072
  ds_read_b64_tr_b16 v[120:121], v10 offset:4096
  ds_read_b64_tr_b16 v[122:123], v10 offset:5120
  ds_read_b64_tr_b16 v[124:125], v11 offset:4096
  ds_read_b64_tr_b16 v[126:127], v11 offset:5120
  s_andn2_b32 s33, s36, s34
  s_ff1_i32_b32 s33, s33
  s_bitset1_b32 s34, s33
  s_xor_b32 s33, s33, s24
  s_lshl_b32 s33, s33, 12
  s_add_u32 s22, s20, s33
  s_addc_u32 s23, s21, 0
  global_load_dwordx4 v[224:227], v3, s[22:23] offset:0
  global_load_dwordx4 v[228:231], v3, s[22:23] offset:1024
  global_load_dwordx4 v[232:235], v3, s[22:23] offset:2048
  global_load_dwordx4 v[236:239], v3, s[22:23] offset:3072
  v_pk_fma_f32 v[24:25], v[24:25], v[8:9], v[8:9] op_sel:[0,0,1] op_sel_hi:[1,0,1]
  v_pk_fma_f32 v[26:27], v[26:27], v[8:9], v[8:9] op_sel:[0,0,1] op_sel_hi:[1,0,1]
  v_pk_fma_f32 v[28:29], v[28:29], v[8:9], v[8:9] op_sel:[0,0,1] op_sel_hi:[1,0,1]
  v_pk_fma_f32 v[30:31], v[30:31], v[8:9], v[8:9] op_sel:[0,0,1] op_sel_hi:[1,0,1]
  v_pk_fma_f32 v[32:33], v[32:33], v[8:9], v[8:9] op_sel:[0,0,1] op_sel_hi:[1,0,1]
  v_pk_fma_f32 v[34:35], v[34:35], v[8:9], v[8:9] op_sel:[0,0,1] op_sel_hi:[1,0,1]
  v_pk_fma_f32 v[36:37], v[36:37], v[8:9], v[8:9] op_sel:[0,0,1] op_sel_hi:[1,0,1]
  v_pk_fma_f32 v[38:39], v[38:39], v[8:9], v[8:9] op_sel:[0,0,1] op_sel_hi:[1,0,1]
  v_pk_fma_f32 v[40:41], v[40:41], v[8:9], v[8:9] op_sel:[0,0,1] op_sel_hi:[1,0,1]
  v_pk_fma_f32 v[42:43], v[42:43], v[8:9], v[8:9] op_sel:[0,0,1] op_sel_hi:[1,0,1]
  v_pk_fma_f32 v[44:45], v[44:45], v[8:9], v[8:9] op_sel:[0,0,1] op_sel_hi:[1,0,1]
  v_pk_fma_f32 v[46:47], v[46:47], v[8:9], v[8:9] op_sel:[0,0,1] op_sel_hi:[1,0,1]
  v_pk_fma_f32 v[48:49], v[48:49], v[8:9], v[8:9] op_sel:[0,0,1] op_sel_hi:[1,0,1]
  v_pk_fma_f32 v[50:51], v[50:51], v[8:9], v[8:9] op_sel:[0,0,1] op_sel_hi:[1,0,1]
  v_pk_fma_f32 v[52:53], v[52:53], v[8:9], v[8:9] op_sel:[0,0,1] op_sel_hi:[1,0,1]
  v_pk_fma_f32 v[54:55], v[54:55], v[8:9], v[8:9] op_sel:[0,0,1] op_sel_hi:[1,0,1]
  v_cmp_eq_u32 vcc, v16, v19
  s_cbranch_vccnz .g2_kernel_w_pt
.g2_kernel_w_pb:
  s_mov_b32 s72, s48
  s_mov_b32 s73, s49
  s_mov_b32 s74, 0x800
  s_mov_b32 s75, 0x00020000
  s_waitcnt vmcnt(15) lgkmcnt(8)
  v_mfma_f32_32x32x16_bf16 v[24:39], v[104:107], v[176:179], v[24:39]
  s_xor_b32 s28, s24, 1
  s_lshl_b32 s28, s28, 13
  s_add_u32 s28, s28, 65536
  ds_read_b64_tr_b16 v[128:129], v10 offset:6144
  ds_read_b64_tr_b16 v[130:131], v10 offset:7168
  v_mfma_f32_32x32x16_bf16 v[40:55], v[108:111], v[176:179], v[40:55]
  v_add_u32 v12, s28, v14
  v_add_u32 v13, s28, v15
  s_andn2_b32 s33, s36, s34
  ds_read_b64_tr_b16 v[132:133], v11 offset:6144
  ds_read_b64_tr_b16 v[134:135], v11 offset:7168
  s_waitcnt vmcnt(14) lgkmcnt(8)
  v_mfma_f32_32x32x16_bf16 v[24:39], v[112:115], v[180:183], v[24:39]
  s_ff1_i32_b32 s33, s33
  s_bitset1_b32 s34, s33
  s_xor_b32 s33, s33, s24
  ds_read_b64_tr_b16 v[104:105], v12 offset:0
  ds_read_b64_tr_b16 v[106:107], v12 offset:1024
  v_mfma_f32_32x32x16_bf16 v[40:55], v[116:119], v[180:183], v[40:55]
  s_lshl_b32 s33, s33, 12
  s_add_u32 s22, s20, s33
  s_addc_u32 s23, s21, 0
  ds_read_b64_tr_b16 v[108:109], v13 offset:0
  ds_read_b64_tr_b16 v[110:111], v13 offset:1024
  s_waitcnt vmcnt(13) lgkmcnt(8)
  v_mfma_f32_32x32x16_bf16 v[24:39], v[120:123], v[184:187], v[24:39]
  global_load_dwordx4 v[136:139], v3, s[22:23] offset:0
  global_load_dwordx4 v[140:143], v3, s[22:23] offset:1024
  global_load_dwordx4 v[144:147], v3, s[22:23] offset:2048
  ds_read_b64_tr_b16 v[112:113], v12 offset:2048
  ds_read_b64_tr_b16 v[114:115], v12 offset:3072
  v_mfma_f32_32x32x16_bf16 v[40:55], v[124:127], v[184:187], v[40:55]
  global_load_dwordx4 v[148:151], v3, s[22:23] offset:3072
  ds_read_b64_tr_b16 v[116:117], v13 offset:2048
  ds_read_b64_tr_b16 v[118:119], v13 offset:3072
  s_waitcnt vmcnt(16) lgkmcnt(8)
  v_mfma_f32_32x32x16_bf16 v[24:39], v[128:131], v[188:191], v[24:39]
  ds_read_b64_tr_b16 v[120:121], v12 offset:4096
  ds_read_b64_tr_b16 v[122:123], v12 offset:5120
  v_mfma_f32_32x32x16_bf16 v[40:55], v[132:135], v[188:191], v[40:55]
  ds_read_b64_tr_b16 v[124:125], v13 offset:4096
  ds_read_b64_tr_b16 v[126:127], v13 offset:5120
  s_waitcnt vmcnt(15) lgkmcnt(8)
  v_mfma_f32_32x32x16_bf16 v[24:39], v[104:107], v[192:195], v[24:39]
  s_xor_b32 s28, s24, 2
  s_lshl_b32 s28, s28, 13
  s_add_u32 s28, s28, 65536
  ds_read_b64_tr_b16 v[128:129], v12 offset:6144
  ds_read_b64_tr_b16 v[130:131], v12 offset:7168
  v_mfma_f32_32x32x16_bf16 v[40:55], v[108:111], v[192:195], v[40:55]
  v_add_u32 v10, s28, v14
  v_add_u32 v11, s28, v15
  s_andn2_b32 s33, s36, s34
  ds_read_b64_tr_b16 v[132:133], v13 offset:6144
  ds_read_b64_tr_b16 v[134:135], v13 offset:7168
  s_waitcnt vmcnt(14) lgkmcnt(8)
  v_mfma_f32_32x32x16_bf16 v[24:39], v[112:115], v[196:199], v[24:39]
  s_ff1_i32_b32 s33, s33
  s_bitset1_b32 s34, s33
  s_xor_b32 s33, s33, s24
  ds_read_b64_tr_b16 v[104:105], v10 offset:0
  ds_read_b64_tr_b16 v[106:107], v10 offset:1024
  v_mfma_f32_32x32x16_bf16 v[40:55], v[116:119], v[196:199], v[40:55]
  s_lshl_b32 s33, s33, 12
  s_add_u32 s22, s20, s33
  s_addc_u32 s23, s21, 0
  ds_read_b64_tr_b16 v[108:109], v11 offset:0
  ds_read_b64_tr_b16 v[110:111], v11 offset:1024
  s_waitcnt vmcnt(13) lgkmcnt(8)
  v_mfma_f32_32x32x16_bf16 v[24:39], v[120:123], v[200:203], v[24:39]
  global_load_dwordx4 v[152:155], v3, s[22:23] offset:0
  global_load_dwordx4 v[156:159], v3, s[22:23] offset:1024
  global_load_dwordx4 v[160:163], v3, s[22:23] offset:2048
  ds_read_b64_tr_b16 v[112:113], v10 offset:2048
  ds_read_b64_tr_b16 v[114:115], v10 offset:3072
  v_mfma_f32_32x32x16_bf16 v[40:55], v[124:127], v[200:203], v[40:55]
  global_load_dwordx4 v[164:167], v3, s[22:23] offset:3072
  ds_read_b64_tr_b16 v[116:117], v11 offset:2048
  ds_read_b64_tr_b16 v[118:119], v11 offset:3072
  s_waitcnt vmcnt(16) lgkmcnt(8)
  v_mfma_f32_32x32x16_bf16 v[24:39], v[128:131], v[204:207], v[24:39]
  ds_read_b64_tr_b16 v[120:121], v10 offset:4096
  ds_read_b64_tr_b16 v[122:123], v10 offset:5120
  v_mfma_f32_32x32x16_bf16 v[40:55], v[132:135], v[204:207], v[40:55]
  ds_read_b64_tr_b16 v[124:125], v11 offset:4096
  ds_read_b64_tr_b16 v[126:127], v11 offset:5120
  s_waitcnt vmcnt(15) lgkmcnt(8)
  v_mfma_f32_32x32x16_bf16 v[24:39], v[104:107], v[208:211], v[24:39]
  s_xor_b32 s28, s24, 3
  s_lshl_b32 s28, s28, 13
  s_add_u32 s28, s28, 65536
  ds_read_b64_tr_b16 v[128:129], v10 offset:6144
  ds_read_b64_tr_b16 v[130:131], v10 offset:7168
  v_mfma_f32_32x32x16_bf16 v[40:55], v[108:111], v[208:211], v[40:55]
  v_add_u32 v12, s28, v14
  v_add_u32 v13, s28, v15
  s_andn2_b32 s33, s36, s34
  ds_read_b64_tr_b16 v[132:133], v11 offset:6144
  ds_read_b64_tr_b16 v[134:135], v11 offset:7168
  s_waitcnt vmcnt(14) lgkmcnt(8)
  v_mfma_f32_32x32x16_bf16 v[24:39], v[112:115], v[212:215], v[24:39]
  s_ff1_i32_b32 s33, s33
  s_bitset1_b32 s34, s33
  s_xor_b32 s33, s33, s24
  ds_read_b64_tr_b16 v[104:105], v12 offset:0
  ds_read_b64_tr_b16 v[106:107], v12 offset:1024
  v_mfma_f32_32x32x16_bf16 v[40:55], v[116:119], v[212:215], v[40:55]
  s_lshl_b32 s33, s33, 12
  s_add_u32 s22, s20, s33
  s_addc_u32 s23, s21, 0
  ds_read_b64_tr_b16 v[108:109], v13 offset:0
  ds_read_b64_tr_b16 v[110:111], v13 offset:1024
  s_waitcnt vmcnt(13) lgkmcnt(8)
  v_mfma_f32_32x32x16_bf16 v[24:39], v[120:123], v[216:219], v[24:39]
  global_load_dwordx4 v[56:59], v3, s[22:23] offset:0
  global_load_dwordx4 v[60:63], v3, s[22:23] offset:1024
  global_load_dwordx4 v[64:67], v3, s[22:23] offset:2048
  ds_read_b64_tr_b16 v[112:113], v12 offset:2048
  ds_read_b64_tr_b16 v[114:115], v12 offset:3072
  v_mfma_f32_32x32x16_bf16 v[40:55], v[124:127], v[216:219], v[40:55]
  global_load_dwordx4 v[68:71], v3, s[22:23] offset:3072
  ds_read_b64_tr_b16 v[116:117], v13 offset:2048
  ds_read_b64_tr_b16 v[118:119], v13 offset:3072
  s_waitcnt vmcnt(16) lgkmcnt(8)
  v_mfma_f32_32x32x16_bf16 v[24:39], v[128:131], v[220:223], v[24:39]
  ds_read_b64_tr_b16 v[120:121], v12 offset:4096
  ds_read_b64_tr_b16 v[122:123], v12 offset:5120
  v_mfma_f32_32x32x16_bf16 v[40:55], v[132:135], v[220:223], v[40:55]
  ds_read_b64_tr_b16 v[124:125], v13 offset:4096
  ds_read_b64_tr_b16 v[126:127], v13 offset:5120
  s_waitcnt vmcnt(15) lgkmcnt(8)
  v_mfma_f32_32x32x16_bf16 v[24:39], v[104:107], v[224:227], v[24:39]
  s_xor_b32 s28, s24, 4
  s_lshl_b32 s28, s28, 13
  s_add_u32 s28, s28, 65536
  ds_read_b64_tr_b16 v[128:129], v12 offset:6144
  ds_read_b64_tr_b16 v[130:131], v12 offset:7168
  v_mfma_f32_32x32x16_bf16 v[40:55], v[108:111], v[224:227], v[40:55]
  v_add_u32 v10, s28, v14
  v_add_u32 v11, s28, v15
  s_andn2_b32 s33, s36, s34
  ds_read_b64_tr_b16 v[132:133], v13 offset:6144
  ds_read_b64_tr_b16 v[134:135], v13 offset:7168
  s_waitcnt vmcnt(14) lgkmcnt(8)
  v_mfma_f32_32x32x16_bf16 v[24:39], v[112:115], v[228:231], v[24:39]
  s_ff1_i32_b32 s33, s33
  s_bitset1_b32 s34, s33
  s_xor_b32 s33, s33, s24
  ds_read_b64_tr_b16 v[104:105], v10 offset:0
  ds_read_b64_tr_b16 v[106:107], v10 offset:1024
  v_mfma_f32_32x32x16_bf16 v[40:55], v[116:119], v[228:231], v[40:55]
  s_lshl_b32 s33, s33, 12
  s_add_u32 s22, s20, s33
  s_addc_u32 s23, s21, 0
  ds_read_b64_tr_b16 v[108:109], v11 offset:0
  ds_read_b64_tr_b16 v[110:111], v11 offset:1024
  s_waitcnt vmcnt(13) lgkmcnt(8)
  v_mfma_f32_32x32x16_bf16 v[24:39], v[120:123], v[232:235], v[24:39]
  global_load_dwordx4 v[72:75], v3, s[22:23] offset:0
  global_load_dwordx4 v[76:79], v3, s[22:23] offset:1024
  global_load_dwordx4 v[80:83], v3, s[22:23] offset:2048
  ds_read_b64_tr_b16 v[112:113], v10 offset:2048
  ds_read_b64_tr_b16 v[114:115], v10 offset:3072
  v_mfma_f32_32x32x16_bf16 v[40:55], v[124:127], v[232:235], v[40:55]
  global_load_dwordx4 v[84:87], v3, s[22:23] offset:3072
  ds_read_b64_tr_b16 v[116:117], v11 offset:2048
  ds_read_b64_tr_b16 v[118:119], v11 offset:3072
  s_waitcnt vmcnt(16) lgkmcnt(8)
  v_mfma_f32_32x32x16_bf16 v[24:39], v[128:131], v[236:239], v[24:39]
  ds_read_b64_tr_b16 v[120:121], v10 offset:4096
  ds_read_b64_tr_b16 v[122:123], v10 offset:5120
  v_mfma_f32_32x32x16_bf16 v[40:55], v[132:135], v[236:239], v[40:55]
  ds_read_b64_tr_b16 v[124:125], v11 offset:4096
  ds_read_b64_tr_b16 v[126:127], v11 offset:5120
  s_waitcnt vmcnt(15) lgkmcnt(8)
  v_mfma_f32_32x32x16_bf16 v[24:39], v[104:107], v[136:139], v[24:39]
  s_xor_b32 s28, s24, 5
  s_lshl_b32 s28, s28, 13
  s_add_u32 s28, s28, 65536
  v_add_u32 v12, s28, v14
  ds_read_b64_tr_b16 v[128:129], v10 offset:6144
  ds_read_b64_tr_b16 v[130:131], v10 offset:7168
  v_mfma_f32_32x32x16_bf16 v[40:55], v[108:111], v[136:139], v[40:55]
  v_add_u32 v13, s28, v15
  s_andn2_b32 s33, s36, s34
  s_cbranch_scc0 .g2_kernel_w_i8c
.g2_kernel_w_i8b:
  s_ff1_i32_b32 s33, s33
  ds_read_b64_tr_b16 v[132:133], v11 offset:6144
  ds_read_b64_tr_b16 v[134:135], v11 offset:7168
  s_waitcnt vmcnt(14) lgkmcnt(8)
  v_mfma_f32_32x32x16_bf16 v[24:39], v[112:115], v[140:143], v[24:39]
  s_bitset1_b32 s34, s33
  s_xor_b32 s33, s33, s24
  s_and_b32 s8, s33, 7
  s_cmp_lt_u32 s8, 2
  ds_read_b64_tr_b16 v[104:105], v12 offset:0
  ds_read_b64_tr_b16 v[106:107], v12 offset:1024
  v_mfma_f32_32x32x16_bf16 v[40:55], v[116:119], v[140:143], v[40:55]
  s_cselect_b32 s28, 139264, 0
  s_lshl_b32 s8, s8, 13
  s_add_u32 s8, s8, s28
  s_lshl_b32 s33, s33, 12
  ds_read_b64_tr_b16 v[108:109], v13 offset:0
  ds_read_b64_tr_b16 v[110:111], v13 offset:1024
  s_waitcnt vmcnt(13) lgkmcnt(8)
  v_mfma_f32_32x32x16_bf16 v[24:39], v[120:123], v[144:147], v[24:39]
  s_add_u32 s22, s20, s33
  s_addc_u32 s23, s21, 0
  global_load_dwordx4 v[88:91], v3, s[22:23] offset:0
  global_load_dwordx4 v[92:95], v3, s[22:23] offset:1024
  ds_read_b64_tr_b16 v[112:113], v12 offset:2048
  ds_read_b64_tr_b16 v[114:115], v12 offset:3072
  v_mfma_f32_32x32x16_bf16 v[40:55], v[124:127], v[144:147], v[40:55]
  global_load_dwordx4 v[96:99], v3, s[22:23] offset:2048
  global_load_dwordx4 v[100:103], v3, s[22:23] offset:3072
  ds_read_b64_tr_b16 v[116:117], v13 offset:2048
  ds_read_b64_tr_b16 v[118:119], v13 offset:3072
  s_waitcnt vmcnt(16) lgkmcnt(8)
  v_mfma_f32_32x32x16_bf16 v[24:39], v[128:131], v[148:151], v[24:39]
  ds_read_b64_tr_b16 v[120:121], v12 offset:4096
  ds_read_b64_tr_b16 v[122:123], v12 offset:5120
  v_mfma_f32_32x32x16_bf16 v[40:55], v[132:135], v[148:151], v[40:55]
  ds_read_b64_tr_b16 v[124:125], v13 offset:4096
  ds_read_b64_tr_b16 v[126:127], v13 offset:5120
  s_waitcnt vmcnt(15) lgkmcnt(8)
  v_mfma_f32_32x32x16_bf16 v[24:39], v[104:107], v[152:155], v[24:39]
  s_xor_b32 s28, s24, 6
  s_lshl_b32 s28, s28, 13
  s_add_u32 s28, s28, 65536
  v_add_u32 v10, s28, v14
  v_add_u32 v11, s28, v15
  ds_read_b64_tr_b16 v[128:129], v12 offset:6144
  ds_read_b64_tr_b16 v[130:131], v12 offset:7168
  v_mfma_f32_32x32x16_bf16 v[40:55], v[108:111], v[152:155], v[40:55]
  s_andn2_b32 s33, s36, s34
  s_cbranch_scc0 .g2_kernel_w_i9c
.g2_kernel_w_i9b:
  s_ff1_i32_b32 s33, s33
  s_bitset1_b32 s34, s33
  s_xor_b32 s33, s33, s24
  ds_read_b64_tr_b16 v[132:133], v13 offset:6144
  ds_read_b64_tr_b16 v[134:135], v13 offset:7168
  s_waitcnt vmcnt(14) lgkmcnt(8)
  v_mfma_f32_32x32x16_bf16 v[24:39], v[112:115], v[156:159], v[24:39]
  s_and_b32 s9, s33, 7
  s_cmp_lt_u32 s9, 2
  s_cselect_b32 s28, 139264, 0
  s_lshl_b32 s9, s9, 13
  s_add_u32 s9, s9, s28
  ds_read_b64_tr_b16 v[104:105], v10 offset:0
  ds_read_b64_tr_b16 v[106:107], v10 offset:1024
  v_mfma_f32_32x32x16_bf16 v[40:55], v[116:119], v[156:159], v[40:55]
  s_lshl_b32 s33, s33, 12
  s_add_u32 s22, s20, s33
  s_addc_u32 s23, s21, 0
  global_load_dwordx4 v[176:179], v3, s[22:23] offset:0
  global_load_dwordx4 v[180:183], v3, s[22:23] offset:1024
  ds_read_b64_tr_b16 v[108:109], v11 offset:0
  ds_read_b64_tr_b16 v[110:111], v11 offset:1024
  s_waitcnt vmcnt(15) lgkmcnt(8)
  v_mfma_f32_32x32x16_bf16 v[24:39], v[120:123], v[160:163], v[24:39]
  global_load_dwordx4 v[184:187], v3, s[22:23] offset:2048
  global_load_dwordx4 v[188:191], v3, s[22:23] offset:3072
  v_lshlrev_b32 v16, 4, v17
  s_lshl_b32 s29, s18, 7
  buffer_load_dwordx4 v[240:243], v16, s[72:75], s29 offen offset:0
  ds_read_b64_tr_b16 v[112:113], v10 offset:2048
  ds_read_b64_tr_b16 v[114:115], v10 offset:3072
  v_mfma_f32_32x32x16_bf16 v[40:55], v[124:127], v[160:163], v[40:55]
  buffer_load_dwordx4 v[244:247], v16, s[72:75], s29 offen offset:32
  buffer_load_dwordx4 v[248:251], v16, s[72:75], s29 offen offset:64
  buffer_load_dwordx4 v[252:255], v16, s[72:75], s29 offen offset:96
  ds_read_b64_tr_b16 v[116:117], v11 offset:2048
  ds_read_b64_tr_b16 v[118:119], v11 offset:3072
  s_waitcnt vmcnt(20) lgkmcnt(8)
  v_mfma_f32_32x32x16_bf16 v[24:39], v[128:131], v[164:167], v[24:39]
  ds_read_b64_tr_b16 v[120:121], v10 offset:4096
  ds_read_b64_tr_b16 v[122:123], v10 offset:5120
  v_mfma_f32_32x32x16_bf16 v[40:55], v[132:135], v[164:167], v[40:55]
  ds_read_b64_tr_b16 v[124:125], v11 offset:4096
  ds_read_b64_tr_b16 v[126:127], v11 offset:5120
  s_waitcnt vmcnt(19) lgkmcnt(8)
  v_mfma_f32_32x32x16_bf16 v[24:39], v[104:107], v[56:59], v[24:39]
  s_xor_b32 s28, s24, 7
  s_lshl_b32 s28, s28, 13
  s_add_u32 s28, s28, 65536
  v_add_u32 v12, s28, v14
  ds_read_b64_tr_b16 v[128:129], v10 offset:6144
  ds_read_b64_tr_b16 v[130:131], v10 offset:7168
  v_mfma_f32_32x32x16_bf16 v[40:55], v[108:111], v[56:59], v[40:55]
  v_add_u32 v13, s28, v15
  s_andn2_b32 s33, s36, s34
  s_cbranch_scc0 .g2_kernel_w_i10c
.g2_kernel_w_i10b:
  s_ff1_i32_b32 s33, s33
  ds_read_b64_tr_b16 v[132:133], v11 offset:6144
  ds_read_b64_tr_b16 v[134:135], v11 offset:7168
  s_waitcnt vmcnt(18) lgkmcnt(8)
  v_mfma_f32_32x32x16_bf16 v[24:39], v[112:115], v[60:63], v[24:39]
  s_bitset1_b32 s34, s33
  s_xor_b32 s33, s33, s24
  s_and_b32 s10, s33, 7
  s_cmp_lt_u32 s10, 2
  ds_read_b64_tr_b16 v[104:105], v12 offset:0
  ds_read_b64_tr_b16 v[106:107], v12 offset:1024
  v_mfma_f32_32x32x16_bf16 v[40:55], v[116:119], v[60:63], v[40:55]
  s_cselect_b32 s28, 139264, 0
  s_lshl_b32 s10, s10, 13
  s_add_u32 s10, s10, s28
  s_lshl_b32 s33, s33, 12
  ds_read_b64_tr_b16 v[108:109], v13 offset:0
  ds_read_b64_tr_b16 v[110:111], v13 offset:1024
  s_waitcnt vmcnt(17) lgkmcnt(8)
  v_mfma_f32_32x32x16_bf16 v[24:39], v[120:123], v[64:67], v[24:39]
  s_add_u32 s22, s20, s33
  s_addc_u32 s23, s21, 0
  global_load_dwordx4 v[192:195], v3, s[22:23] offset:0
  global_load_dwordx4 v[196:199], v3, s[22:23] offset:1024
  ds_read_b64_tr_b16 v[112:113], v12 offset:2048
  ds_read_b64_tr_b16 v[114:115], v12 offset:3072
  v_mfma_f32_32x32x16_bf16 v[40:55], v[124:127], v[64:67], v[40:55]
  global_load_dwordx4 v[200:203], v3, s[22:23] offset:2048
  global_load_dwordx4 v[204:207], v3, s[22:23] offset:3072
  ds_read_b64_tr_b16 v[116:117], v13 offset:2048
  ds_read_b64_tr_b16 v[118:119], v13 offset:3072
  s_waitcnt vmcnt(20) lgkmcnt(8)
  v_mfma_f32_32x32x16_bf16 v[24:39], v[128:131], v[68:71], v[24:39]
  ds_read_b64_tr_b16 v[120:121], v12 offset:4096
  ds_read_b64_tr_b16 v[122:123], v12 offset:5120
  v_mfma_f32_32x32x16_bf16 v[40:55], v[132:135], v[68:71], v[40:55]
  ds_read_b64_tr_b16 v[124:125], v13 offset:4096
  ds_read_b64_tr_b16 v[126:127], v13 offset:5120
  s_waitcnt vmcnt(19) lgkmcnt(8)
  v_mfma_f32_32x32x16_bf16 v[24:39], v[104:107], v[72:75], v[24:39]
  s_andn2_b32 s33, s36, s34
  s_cbranch_scc0 .g2_kernel_w_i11c
.g2_kernel_w_i11b:
  s_ff1_i32_b32 s33, s33
  ds_read_b64_tr_b16 v[128:129], v12 offset:6144
  ds_read_b64_tr_b16 v[130:131], v12 offset:7168
  v_mfma_f32_32x32x16_bf16 v[40:55], v[108:111], v[72:75], v[40:55]
  s_bitset1_b32 s34, s33
  s_xor_b32 s33, s33, s24
  s_and_b32 s11, s33, 7
  ds_read_b64_tr_b16 v[132:133], v13 offset:6144
  ds_read_b64_tr_b16 v[134:135], v13 offset:7168
  s_waitcnt vmcnt(18) lgkmcnt(8)
  v_mfma_f32_32x32x16_bf16 v[24:39], v[112:115], v[76:79], v[24:39]
  s_cmp_lt_u32 s11, 2
  s_cselect_b32 s28, 139264, 0
  s_lshl_b32 s11, s11, 13
  v_mfma_f32_32x32x16_bf16 v[40:55], v[116:119], v[76:79], v[40:55]
  s_add_u32 s11, s11, s28
  s_lshl_b32 s33, s33, 12
  s_add_u32 s22, s20, s33
  s_waitcnt vmcnt(17) lgkmcnt(4)
  v_mfma_f32_32x32x16_bf16 v[24:39], v[120:123], v[80:83], v[24:39]
  s_addc_u32 s23, s21, 0
  global_load_dwordx4 v[208:211], v3, s[22:23] offset:0
  global_load_dwordx4 v[212:215], v3, s[22:23] offset:1024
  v_mfma_f32_32x32x16_bf16 v[40:55], v[124:127], v[80:83], v[40:55]
  global_load_dwordx4 v[216:219], v3, s[22:23] offset:2048
  global_load_dwordx4 v[220:223], v3, s[22:23] offset:3072
  s_waitcnt vmcnt(20) lgkmcnt(0)
  v_mfma_f32_32x32x16_bf16 v[24:39], v[128:131], v[84:87], v[24:39]
  v_mfma_f32_32x32x16_bf16 v[40:55], v[132:135], v[84:87], v[40:55]
  ds_read_b32 v16, v20 offset:12
  v_add_u32 v10, s8, v14
  v_add_u32 v11, s8, v15
  s_waitcnt lgkmcnt(0)
  v_cmp_gt_u32 vcc, 4, v16
  s_cbranch_vccnz .g2_kernel_w_bw
.g2_kernel_w_bb:
  ds_read_b64_tr_b16 v[104:105], v10 offset:0
  ds_read_b64_tr_b16 v[106:107], v10 offset:1024
  ds_read_b64_tr_b16 v[108:109], v11 offset:0
  ds_read_b64_tr_b16 v[110:111], v11 offset:1024
  ds_read_b64_tr_b16 v[112:113], v10 offset:2048
  ds_read_b64_tr_b16 v[114:115], v10 offset:3072
  ds_read_b64_tr_b16 v[116:117], v11 offset:2048
  ds_read_b64_tr_b16 v[118:119], v11 offset:3072
  ds_read_b64_tr_b16 v[120:121], v10 offset:4096
  ds_read_b64_tr_b16 v[122:123], v10 offset:5120
  ds_read_b64_tr_b16 v[124:125], v11 offset:4096
  ds_read_b64_tr_b16 v[126:127], v11 offset:5120
  s_waitcnt vmcnt(16)
  v_min3_u32 v6, v88, v90, v92
  v_min3_u32 v7, v94, v96, v98
  v_min3_u32 v6, v6, v100, v102
  v_min_u32 v6, v6, v7
  v_cmp_eq_u32 vcc, 0, v6
  s_cbranch_vccnz .g2_kernel_w_v8
.g2_kernel_w_vb8:
  s_waitcnt lgkmcnt(8)
  v_mfma_f32_32x32x16_bf16 v[24:39], v[104:107], v[88:91], v[24:39]
  v_add_u32 v12, s9, v14
  v_add_u32 v13, s9, v15
  s_andn2_b32 s33, s36, s34
  s_cbranch_scc0 .g2_kernel_w_i12c
.g2_kernel_w_i12b:
  ds_read_b64_tr_b16 v[128:129], v10 offset:6144
  ds_read_b64_tr_b16 v[130:131], v10 offset:7168
  v_mfma_f32_32x32x16_bf16 v[40:55], v[108:111], v[88:91], v[40:55]
  s_ff1_i32_b32 s33, s33
  s_bitset1_b32 s34, s33
  s_xor_b32 s33, s33, s24
  s_and_b32 s12, s33, 7
  ds_read_b64_tr_b16 v[132:133], v11 offset:6144
  ds_read_b64_tr_b16 v[134:135], v11 offset:7168
  s_waitcnt lgkmcnt(8)
  v_mfma_f32_32x32x16_bf16 v[24:39], v[112:115], v[92:95], v[24:39]
  s_cmp_lt_u32 s12, 2
  s_cselect_b32 s28, 139264, 0
  s_lshl_b32 s12, s12, 13
  s_add_u32 s12, s12, s28
  ds_read_b64_tr_b16 v[104:105], v12 offset:0
  ds_read_b64_tr_b16 v[106:107], v12 offset:1024
  v_mfma_f32_32x32x16_bf16 v[40:55], v[116:119], v[92:95], v[40:55]
  s_lshl_b32 s33, s33, 12
  s_add_u32 s22, s20, s33
  s_addc_u32 s23, s21, 0
  global_load_dwordx4 v[224:227], v3, s[22:23] offset:0
  ds_read_b64_tr_b16 v[108:109], v13 offset:0
  ds_read_b64_tr_b16 v[110:111], v13 offset:1024
  s_waitcnt lgkmcnt(8)
  v_mfma_f32_32x32x16_bf16 v[24:39], v[120:123], v[96:99], v[24:39]
  global_load_dwordx4 v[228:231], v3, s[22:23] offset:1024
  global_load_dwordx4 v[232:235], v3, s[22:23] offset:2048
  global_load_dwordx4 v[236:239], v3, s[22:23] offset:3072
  ds_read_b64_tr_b16 v[112:113], v12 offset:2048
  ds_read_b64_tr_b16 v[114:115], v12 offset:3072
  v_mfma_f32_32x32x16_bf16 v[40:55], v[124:127], v[96:99], v[40:55]
  ds_read_b64_tr_b16 v[116:117], v13 offset:2048
  ds_read_b64_tr_b16 v[118:119], v13 offset:3072
  s_waitcnt lgkmcnt(8)
  v_mfma_f32_32x32x16_bf16 v[24:39], v[128:131], v[100:103], v[24:39]
  ds_read_b64_tr_b16 v[120:121], v12 offset:4096
  ds_read_b64_tr_b16 v[122:123], v12 offset:5120
  s_waitcnt vmcnt(16)
  v_min3_u32 v6, v176, v178, v180
  v_min3_u32 v7, v182, v184, v186
  v_min3_u32 v6, v6, v188, v190
  v_min_u32 v6, v6, v7
  v_cmp_eq_u32 vcc, 0, v6
  v_mfma_f32_32x32x16_bf16 v[40:55], v[132:135], v[100:103], v[40:55]
  ds_read_b64_tr_b16 v[124:125], v13 offset:4096
  ds_read_b64_tr_b16 v[126:127], v13 offset:5120
  s_cbranch_vccnz .g2_kernel_w_v9
.g2_kernel_w_vb9:
  s_waitcnt lgkmcnt(8)
  v_mfma_f32_32x32x16_bf16 v[24:39], v[104:107], v[176:179], v[24:39]
  v_add_u32 v10, s10, v14
  v_add_u32 v11, s10, v15
  s_andn2_b32 s33, s36, s34
  s_cbranch_scc0 .g2_kernel_w_i13c
.g2_kernel_w_i13b:
  ds_read_b64_tr_b16 v[128:129], v12 offset:6144
  ds_read_b64_tr_b16 v[130:131], v12 offset:7168
  v_mfma_f32_32x32x16_bf16 v[40:55], v[108:111], v[176:179], v[40:55]
  s_ff1_i32_b32 s33, s33
  s_bitset1_b32 s34, s33
  s_xor_b32 s33, s33, s24
  s_and_b32 s13, s33, 7
  ds_read_b64_tr_b16 v[132:133], v13 offset:6144
  ds_read_b64_tr_b16 v[134:135], v13 offset:7168
  s_waitcnt lgkmcnt(8)
  v_mfma_f32_32x32x16_bf16 v[24:39], v[112:115], v[180:183], v[24:39]
  s_cmp_lt_u32 s13, 2
  s_cselect_b32 s28, 139264, 0
  s_lshl_b32 s13, s13, 13
  s_add_u32 s13, s13, s28
  ds_read_b64_tr_b16 v[104:105], v10 offset:0
  ds_read_b64_tr_b16 v[106:107], v10 offset:1024
  v_mfma_f32_32x32x16_bf16 v[40:55], v[116:119], v[180:183], v[40:55]
  s_lshl_b32 s33, s33, 12
  s_add_u32 s22, s20, s33
  s_addc_u32 s23, s21, 0
  global_load_dwordx4 v[136:139], v3, s[22:23] offset:0
  ds_read_b64_tr_b16 v[108:109], v11 offset:0
  ds_read_b64_tr_b16 v[110:111], v11 offset:1024
  s_waitcnt lgkmcnt(8)
  v_mfma_f32_32x32x16_bf16 v[24:39], v[120:123], v[184:187], v[24:39]
  global_load_dwordx4 v[140:143], v3, s[22:23] offset:1024
  global_load_dwordx4 v[144:147], v3, s[22:23] offset:2048
  global_load_dwordx4 v[148:151], v3, s[22:23] offset:3072
  ds_read_b64_tr_b16 v[112:113], v10 offset:2048
  ds_read_b64_tr_b16 v[114:115], v10 offset:3072
  v_mfma_f32_32x32x16_bf16 v[40:55], v[124:127], v[184:187], v[40:55]
  ds_read_b64_tr_b16 v[116:117], v11 offset:2048
  ds_read_b64_tr_b16 v[118:119], v11 offset:3072
  s_waitcnt lgkmcnt(8)
  v_mfma_f32_32x32x16_bf16 v[24:39], v[128:131], v[188:191], v[24:39]
  ds_read_b64_tr_b16 v[120:121], v10 offset:4096
  ds_read_b64_tr_b16 v[122:123], v10 offset:5120
  s_waitcnt vmcnt(12)
  v_min3_u32 v6, v192, v194, v196
  v_min3_u32 v7, v198, v200, v202
  v_min3_u32 v6, v6, v204, v206
  v_min_u32 v6, v6, v7
  v_cmp_eq_u32 vcc, 0, v6
  v_mfma_f32_32x32x16_bf16 v[40:55], v[132:135], v[188:191], v[40:55]
  ds_read_b64_tr_b16 v[124:125], v11 offset:4096
  ds_read_b64_tr_b16 v[126:127], v11 offset:5120
  s_cbranch_vccnz .g2_kernel_w_v10
.g2_kernel_w_vb10:
  s_waitcnt lgkmcnt(8)
  v_mfma_f32_32x32x16_bf16 v[24:39], v[104:107], v[192:195], v[24:39]
  v_add_u32 v12, s11, v14
  v_add_u32 v13, s11, v15
  s_andn2_b32 s33, s36, s34
  s_cbranch_scc0 .g2_kernel_w_i14c
.g2_kernel_w_i14b:
  ds_read_b64_tr_b16 v[128:129], v10 offset:6144
  ds_read_b64_tr_b16 v[130:131], v10 offset:7168
  v_mfma_f32_32x32x16_bf16 v[40:55], v[108:111], v[192:195], v[40:55]
  s_ff1_i32_b32 s33, s33
  s_bitset1_b32 s34, s33
  s_xor_b32 s33, s33, s24
  s_and_b32 s14, s33, 7
  ds_read_b64_tr_b16 v[132:133], v11 offset:6144
  ds_read_b64_tr_b16 v[134:135], v11 offset:7168
  s_waitcnt lgkmcnt(8)
  v_mfma_f32_32x32x16_bf16 v[24:39], v[112:115], v[196:199], v[24:39]
  s_cmp_lt_u32 s14, 2
  s_cselect_b32 s28, 139264, 0
  s_lshl_b32 s14, s14, 13
  s_add_u32 s14, s14, s28
  ds_read_b64_tr_b16 v[104:105], v12 offset:0
  ds_read_b64_tr_b16 v[106:107], v12 offset:1024
  v_mfma_f32_32x32x16_bf16 v[40:55], v[116:119], v[196:199], v[40:55]
  s_lshl_b32 s33, s33, 12
  s_add_u32 s22, s20, s33
  s_addc_u32 s23, s21, 0
  global_load_dwordx4 v[152:155], v3, s[22:23] offset:0 sc1
  ds_read_b64_tr_b16 v[108:109], v13 offset:0
  ds_read_b64_tr_b16 v[110:111], v13 offset:1024
  s_waitcnt lgkmcnt(8)
  v_mfma_f32_32x32x16_bf16 v[24:39], v[120:123], v[200:203], v[24:39]
  global_load_dwordx4 v[156:159], v3, s[22:23] offset:1024 sc1
  global_load_dwordx4 v[160:163], v3, s[22:23] offset:2048 sc1
  global_load_dwordx4 v[164:167], v3, s[22:23] offset:3072 sc1
  ds_read_b64_tr_b16 v[112:113], v12 offset:2048
  ds_read_b64_tr_b16 v[114:115], v12 offset:3072
  v_mfma_f32_32x32x16_bf16 v[40:55], v[124:127], v[200:203], v[40:55]
  ds_read_b64_tr_b16 v[116:117], v13 offset:2048
  ds_read_b64_tr_b16 v[118:119], v13 offset:3072
  s_waitcnt lgkmcnt(8)
  v_mfma_f32_32x32x16_bf16 v[24:39], v[128:131], v[204:207], v[24:39]
  ds_read_b64_tr_b16 v[120:121], v12 offset:4096
  ds_read_b64_tr_b16 v[122:123], v12 offset:5120
  s_waitcnt vmcnt(12)
  v_min3_u32 v6, v208, v210, v212
  v_min3_u32 v7, v214, v216, v218
  v_min3_u32 v6, v6, v220, v222
  v_min_u32 v6, v6, v7
  v_cmp_eq_u32 vcc, 0, v6
  v_mfma_f32_32x32x16_bf16 v[40:55], v[132:135], v[204:207], v[40:55]
  ds_read_b64_tr_b16 v[124:125], v13 offset:4096
  ds_read_b64_tr_b16 v[126:127], v13 offset:5120
  s_cbranch_vccnz .g2_kernel_w_v11
.g2_kernel_w_vb11:
  s_mov_b64 exec, 1
  ds_add_u32 v20, v5 offset:16
  s_mov_b64 exec, -1
  s_waitcnt lgkmcnt(8)
  v_mfma_f32_32x32x16_bf16 v[24:39], v[104:107], v[208:211], v[24:39]
  v_add_u32 v10, s12, v14
  v_add_u32 v11, s12, v15
  s_andn2_b32 s33, s36, s34
  s_cbranch_scc0 .g2_kernel_w_i15c
.g2_kernel_w_i15b:
  ds_read_b64_tr_b16 v[128:129], v12 offset:6144
  ds_read_b64_tr_b16 v[130:131], v12 offset:7168
  v_mfma_f32_32x32x16_bf16 v[40:55], v[108:111], v[208:211], v[40:55]
  s_ff1_i32_b32 s33, s33
  s_bitset1_b32 s34, s33
  s_xor_b32 s33, s33, s24
  s_and_b32 s15, s33, 7
  ds_read_b64_tr_b16 v[132:133], v13 offset:6144
  ds_read_b64_tr_b16 v[134:135], v13 offset:7168
  s_waitcnt lgkmcnt(8)
  v_mfma_f32_32x32x16_bf16 v[24:39], v[112:115], v[212:215], v[24:39]
  s_cmp_lt_u32 s15, 2
  s_cselect_b32 s28, 139264, 0
  s_lshl_b32 s15, s15, 13
  s_add_u32 s15, s15, s28
  ds_read_b64_tr_b16 v[104:105], v10 offset:0
  ds_read_b64_tr_b16 v[106:107], v10 offset:1024
  v_mfma_f32_32x32x16_bf16 v[40:55], v[116:119], v[212:215], v[40:55]
  s_lshl_b32 s33, s33, 12
  s_add_u32 s22, s20, s33
  s_addc_u32 s23, s21, 0
  global_load_dwordx4 v[56:59], v3, s[22:23] offset:0 sc1
  ds_read_b64_tr_b16 v[108:109], v11 offset:0
  ds_read_b64_tr_b16 v[110:111], v11 offset:1024
  s_waitcnt lgkmcnt(8)
  v_mfma_f32_32x32x16_bf16 v[24:39], v[120:123], v[216:219], v[24:39]
  global_load_dwordx4 v[60:63], v3, s[22:23] offset:1024 sc1
  global_load_dwordx4 v[64:67], v3, s[22:23] offset:2048 sc1
  global_load_dwordx4 v[68:71], v3, s[22:23] offset:3072 sc1
  ds_read_b64_tr_b16 v[112:113], v10 offset:2048
  ds_read_b64_tr_b16 v[114:115], v10 offset:3072
  v_mfma_f32_32x32x16_bf16 v[40:55], v[124:127], v[216:219], v[40:55]
  ds_read_b64_tr_b16 v[116:117], v11 offset:2048
  ds_read_b64_tr_b16 v[118:119], v11 offset:3072
  s_waitcnt lgkmcnt(8)
  v_mfma_f32_32x32x16_bf16 v[24:39], v[128:131], v[220:223], v[24:39]
  ds_read_b64_tr_b16 v[120:121], v10 offset:4096
  ds_read_b64_tr_b16 v[122:123], v10 offset:5120
  s_waitcnt vmcnt(12)
  v_min3_u32 v6, v224, v226, v228
  v_min3_u32 v7, v230, v232, v234
  v_min3_u32 v6, v6, v236, v238
  v_min_u32 v6, v6, v7
  v_cmp_eq_u32 vcc, 0, v6
  v_mfma_f32_32x32x16_bf16 v[40:55], v[132:135], v[220:223], v[40:55]
  ds_read_b64_tr_b16 v[124:125], v11 offset:4096
  ds_read_b64_tr_b16 v[126:127], v11 offset:5120
  s_cbranch_vccnz .g2_kernel_w_v12
.g2_kernel_w_vb12:
  s_waitcnt lgkmcnt(8)
  v_mfma_f32_32x32x16_bf16 v[24:39], v[104:107], v[224:227], v[24:39]
  v_add_u32 v12, s13, v14
  v_add_u32 v13, s13, v15
  ds_read_b64_tr_b16 v[128:129], v10 offset:6144
  ds_read_b64_tr_b16 v[130:131], v10 offset:7168
  v_mfma_f32_32x32x16_bf16 v[40:55], v[108:111], v[224:227], v[40:55]
  ds_read_b64_tr_b16 v[132:133], v11 offset:6144
  ds_read_b64_tr_b16 v[134:135], v11 offset:7168
  s_waitcnt lgkmcnt(8)
  v_mfma_f32_32x32x16_bf16 v[24:39], v[112:115], v[228:231], v[24:39]
  ds_read_b64_tr_b16 v[104:105], v12 offset:0
  ds_read_b64_tr_b16 v[106:107], v12 offset:1024
  v_mfma_f32_32x32x16_bf16 v[40:55], v[116:119], v[228:231], v[40:55]
  ds_read_b64_tr_b16 v[108:109], v13 offset:0
  ds_read_b64_tr_b16 v[110:111], v13 offset:1024
  s_waitcnt lgkmcnt(8)
  v_mfma_f32_32x32x16_bf16 v[24:39], v[120:123], v[232:235], v[24:39]
  ds_read_b64_tr_b16 v[112:113], v12 offset:2048
  ds_read_b64_tr_b16 v[114:115], v12 offset:3072
  v_mfma_f32_32x32x16_bf16 v[40:55], v[124:127], v[232:235], v[40:55]
  ds_read_b64_tr_b16 v[116:117], v13 offset:2048
  ds_read_b64_tr_b16 v[118:119], v13 offset:3072
  s_waitcnt lgkmcnt(8)
  v_mfma_f32_32x32x16_bf16 v[24:39], v[128:131], v[236:239], v[24:39]
  ds_read_b64_tr_b16 v[120:121], v12 offset:4096
  ds_read_b64_tr_b16 v[122:123], v12 offset:5120
  s_waitcnt vmcnt(8)
  v_min3_u32 v6, v136, v138, v140
  v_min3_u32 v7, v142, v144, v146
  v_min3_u32 v6, v6, v148, v150
  v_min_u32 v6, v6, v7
  v_cmp_eq_u32 vcc, 0, v6
  v_mfma_f32_32x32x16_bf16 v[40:55], v[132:135], v[236:239], v[40:55]
  ds_read_b64_tr_b16 v[124:125], v13 offset:4096
  ds_read_b64_tr_b16 v[126:127], v13 offset:5120
  s_cbranch_vccnz .g2_kernel_w_v13
.g2_kernel_w_vb13:
  s_waitcnt lgkmcnt(8)
  v_mfma_f32_32x32x16_bf16 v[24:39], v[104:107], v[136:139], v[24:39]
  v_add_u32 v10, s14, v14
  v_add_u32 v11, s14, v15
  ds_read_b64_tr_b16 v[128:129], v12 offset:6144
  ds_read_b64_tr_b16 v[130:131], v12 offset:7168
  v_mfma_f32_32x32x16_bf16 v[40:55], v[108:111], v[136:139], v[40:55]
  ds_read_b64_tr_b16 v[132:133], v13 offset:6144
  ds_read_b64_tr_b16 v[134:135], v13 offset:7168
  s_waitcnt lgkmcnt(8)
  v_mfma_f32_32x32x16_bf16 v[24:39], v[112:115], v[140:143], v[24:39]
  ds_read_b64_tr_b16 v[104:105], v10 offset:0
  ds_read_b64_tr_b16 v[106:107], v10 offset:1024
  v_mfma_f32_32x32x16_bf16 v[40:55], v[116:119], v[140:143], v[40:55]
  ds_read_b64_tr_b16 v[108:109], v11 offset:0
  ds_read_b64_tr_b16 v[110:111], v11 offset:1024
  s_waitcnt lgkmcnt(8)
  v_mfma_f32_32x32x16_bf16 v[24:39], v[120:123], v[144:147], v[24:39]
  ds_read_b64_tr_b16 v[112:113], v10 offset:2048
  ds_read_b64_tr_b16 v[114:115], v10 offset:3072
  v_mfma_f32_32x32x16_bf16 v[40:55], v[124:127], v[144:147], v[40:55]
  ds_read_b64_tr_b16 v[116:117], v11 offset:2048
  ds_read_b64_tr_b16 v[118:119], v11 offset:3072
  s_waitcnt lgkmcnt(8)
  v_mfma_f32_32x32x16_bf16 v[24:39], v[128:131], v[148:151], v[24:39]
  ds_read_b64_tr_b16 v[120:121], v10 offset:4096
  ds_read_b64_tr_b16 v[122:123], v10 offset:5120
  s_waitcnt vmcnt(4)
  v_min3_u32 v6, v152, v154, v156
  v_min3_u32 v7, v158, v160, v162
  v_min3_u32 v6, v6, v164, v166
  v_min_u32 v6, v6, v7
  v_cmp_eq_u32 vcc, 0, v6
  v_mfma_f32_32x32x16_bf16 v[40:55], v[132:135], v[148:151], v[40:55]
  ds_read_b64_tr_b16 v[124:125], v11 offset:4096
  ds_read_b64_tr_b16 v[126:127], v11 offset:5120
  s_cbranch_vccnz .g2_kernel_w_v14
.g2_kernel_w_vb14:
  s_waitcnt lgkmcnt(8)
  v_mfma_f32_32x32x16_bf16 v[24:39], v[104:107], v[152:155], v[24:39]
  v_add_u32 v12, s15, v14
  v_add_u32 v13, s15, v15
  ds_read_b64_tr_b16 v[128:129], v10 offset:6144
  ds_read_b64_tr_b16 v[130:131], v10 offset:7168
  v_mfma_f32_32x32x16_bf16 v[40:55], v[108:111], v[152:155], v[40:55]
  ds_read_b64_tr_b16 v[132:133], v11 offset:6144
  ds_read_b64_tr_b16 v[134:135], v11 offset:7168
  s_waitcnt lgkmcnt(8)
  v_mfma_f32_32x32x16_bf16 v[24:39], v[112:115], v[156:159], v[24:39]
  ds_read_b64_tr_b16 v[104:105], v12 offset:0
  ds_read_b64_tr_b16 v[106:107], v12 offset:1024
  v_mfma_f32_32x32x16_bf16 v[40:55], v[116:119], v[156:159], v[40:55]
  ds_read_b64_tr_b16 v[108:109], v13 offset:0
  ds_read_b64_tr_b16 v[110:111], v13 offset:1024
  s_waitcnt lgkmcnt(8)
  v_mfma_f32_32x32x16_bf16 v[24:39], v[120:123], v[160:163], v[24:39]
  ds_read_b64_tr_b16 v[112:113], v12 offset:2048
  ds_read_b64_tr_b16 v[114:115], v12 offset:3072
  v_mfma_f32_32x32x16_bf16 v[40:55], v[124:127], v[160:163], v[40:55]
  ds_read_b64_tr_b16 v[116:117], v13 offset:2048
  ds_read_b64_tr_b16 v[118:119], v13 offset:3072
  s_waitcnt lgkmcnt(8)
  v_mfma_f32_32x32x16_bf16 v[24:39], v[128:131], v[164:167], v[24:39]
  ds_read_b64_tr_b16 v[120:121], v12 offset:4096
  ds_read_b64_tr_b16 v[122:123], v12 offset:5120
  s_waitcnt vmcnt(0)
  v_min3_u32 v6, v56, v58, v60
  v_min3_u32 v7, v62, v64, v66
  v_min3_u32 v6, v6, v68, v70
  v_min_u32 v6, v6, v7
  v_cmp_eq_u32 vcc, 0, v6
  v_mfma_f32_32x32x16_bf16 v[40:55], v[132:135], v[164:167], v[40:55]
  ds_read_b64_tr_b16 v[124:125], v13 offset:4096
  ds_read_b64_tr_b16 v[126:127], v13 offset:5120
  s_cbranch_vccnz .g2_kernel_w_v15
.g2_kernel_w_vb15:
  s_waitcnt lgkmcnt(8)
  v_mfma_f32_32x32x16_bf16 v[24:39], v[104:107], v[56:59], v[24:39]
  ds_read_b64_tr_b16 v[128:129], v12 offset:6144
  ds_read_b64_tr_b16 v[130:131], v12 offset:7168
  v_mfma_f32_32x32x16_bf16 v[40:55], v[108:111], v[56:59], v[40:55]
  ds_read_b64_tr_b16 v[132:133], v13 offset:6144
  ds_read_b64_tr_b16 v[134:135], v13 offset:7168
  s_waitcnt lgkmcnt(8)
  v_mfma_f32_32x32x16_bf16 v[24:39], v[112:115], v[60:63], v[24:39]
  v_mfma_f32_32x32x16_bf16 v[40:55], v[116:119], v[60:63], v[40:55]
  s_waitcnt lgkmcnt(4)
  v_mfma_f32_32x32x16_bf16 v[24:39], v[120:123], v[64:67], v[24:39]
  v_mfma_f32_32x32x16_bf16 v[40:55], v[124:127], v[64:67], v[40:55]
  s_waitcnt lgkmcnt(0)
  v_mfma_f32_32x32x16_bf16 v[24:39], v[128:131], v[68:71], v[24:39]
  v_mfma_f32_32x32x16_bf16 v[40:55], v[132:135], v[68:71], v[40:55]
  s_lshl_b32 s28, s17, 4
  s_add_u32 s28, s28, s18
  s_lshl_b32 s28, s28, 2
  s_add_u32 s28, s28, s16
  s_lshl_b32 s28, s28, 12
  s_add_u32 s28, s28, s63
  s_add_u32 s28, s28, 0xc00000
  s_lshl_b32 s29, s16, 12
  v_add_u32 v6, s29, v22
  s_mov_b32 s36, 0x3f803f80
  v_mov_b32 v8, 0
  v_mov_b32 v9, 0
  v_mov_b32 v10, 0
  v_and_b32 v7, 24, v18
  v_lshlrev_b32 v7, 8, v7
  v_and_b32 v11, 7, v18
  v_lshl_add_u32 v7, v11, 4, v7
  v_cvt_pk_bf16_f32 v56, v24, v25
  v_cvt_pk_bf16_f32 v57, v26, v27
  v_cvt_pk_bf16_f32 v58, v28, v29
  v_cvt_pk_bf16_f32 v59, v30, v31
  buffer_store_dwordx4 v[56:59], v22, s[4:7], s28 offen offset:0 sc1
  v_cvt_pk_bf16_f32 v60, v32, v33
  v_cvt_pk_bf16_f32 v61, v34, v35
  v_cvt_pk_bf16_f32 v62, v36, v37
  v_cvt_pk_bf16_f32 v63, v38, v39
  buffer_store_dwordx4 v[60:63], v22, s[4:7], s28 offen offset:512 sc1
  v_cvt_pk_bf16_f32 v64, v40, v41
  v_cvt_pk_bf16_f32 v65, v42, v43
  v_cvt_pk_bf16_f32 v66, v44, v45
  v_cvt_pk_bf16_f32 v67, v46, v47
  buffer_store_dwordx4 v[64:67], v22, s[4:7], s28 offen offset:1024 sc1
  v_cvt_pk_bf16_f32 v68, v48, v49
  v_cvt_pk_bf16_f32 v69, v50, v51
  v_cvt_pk_bf16_f32 v70, v52, v53
  v_cvt_pk_bf16_f32 v71, v54, v55
  buffer_store_dwordx4 v[68:71], v22, s[4:7], s28 offen offset:1536 sc1
  ds_write_b128 v6, v[56:59] offset:0
  ds_write_b128 v6, v[60:63] offset:512
  ds_write_b128 v6, v[64:67] offset:1024
  ds_write_b128 v6, v[68:71] offset:1536
  s_mov_b64 exec, 1
  ds_add_u32 v20, v5 offset:20
  s_mov_b64 exec, -1
  s_lshl_b32 s28, s17, 2
  s_add_u32 s28, s28, s16
  s_lshl_b32 s28, s28, 13
  s_lshl_b32 s29, s18, 7
  s_add_u32 s28, s28, s29
  s_add_u32 s28, s28, s63
  s_add_u32 s28, s28, 0x1000000
  v_dot2c_f32_bf16 v8, s36, v56
  v_dot2c_f32_bf16 v9, v56, v56
  v_dot2c_f32_bf16 v10, v56, v240
  v_dot2c_f32_bf16 v8, s36, v57
  v_dot2c_f32_bf16 v9, v57, v57
  v_dot2c_f32_bf16 v10, v57, v241
  v_dot2c_f32_bf16 v8, s36, v58
  v_dot2c_f32_bf16 v9, v58, v58
  v_dot2c_f32_bf16 v10, v58, v242
  v_dot2c_f32_bf16 v8, s36, v59
  v_dot2c_f32_bf16 v9, v59, v59
  v_dot2c_f32_bf16 v10, v59, v243
  v_dot2c_f32_bf16 v8, s36, v60
  v_dot2c_f32_bf16 v9, v60, v60
  v_dot2c_f32_bf16 v10, v60, v244
  v_dot2c_f32_bf16 v8, s36, v61
  v_dot2c_f32_bf16 v9, v61, v61
  v_dot2c_f32_bf16 v10, v61, v245
  v_dot2c_f32_bf16 v8, s36, v62
  v_dot2c_f32_bf16 v9, v62, v62
  v_dot2c_f32_bf16 v10, v62, v246
  v_dot2c_f32_bf16 v8, s36, v63
  v_dot2c_f32_bf16 v9, v63, v63
  v_dot2c_f32_bf16 v10, v63, v247
  v_dot2c_f32_bf16 v8, s36, v64
  v_dot2c_f32_bf16 v9, v64, v64
  v_dot2c_f32_bf16 v10, v64, v248
  v_dot2c_f32_bf16 v8, s36, v65
  v_dot2c_f32_bf16 v9, v65, v65
  v_dot2c_f32_bf16 v10, v65, v249
  v_dot2c_f32_bf16 v8, s36, v66
  v_dot2c_f32_bf16 v9, v66, v66
  v_dot2c_f32_bf16 v10, v66, v250
  v_dot2c_f32_bf16 v8, s36, v67
  v_dot2c_f32_bf16 v9, v67, v67
  v_dot2c_f32_bf16 v10, v67, v251
  v_dot2c_f32_bf16 v8, s36, v68
  v_dot2c_f32_bf16 v9, v68, v68
  v_dot2c_f32_bf16 v10, v68, v252
  v_dot2c_f32_bf16 v8, s36, v69
  v_dot2c_f32_bf16 v9, v69, v69
  v_dot2c_f32_bf16 v10, v69, v253
  v_dot2c_f32_bf16 v8, s36, v70
  v_dot2c_f32_bf16 v9, v70, v70
  v_dot2c_f32_bf16 v10, v70, v254
  v_dot2c_f32_bf16 v8, s36, v71
  v_dot2c_f32_bf16 v9, v71, v71
  v_dot2c_f32_bf16 v10, v71, v255
  s_lshl_b32 s29, s16, 7
  s_add_u32 s37, s19, s29
  v_mov_b32 v24, v8
  v_mov_b32 v25, v9
  v_mov_b32 v26, v10
  v_mov_b32 v11, 1
  v_permlane32_swap_b32 v8, v24
  v_permlane32_swap_b32 v9, v25
  v_permlane32_swap_b32 v10, v26
  v_add_f32 v8, v8, v24
  v_add_f32 v9, v9, v25
  v_add_f32 v10, v10, v26
  v_or_b32 v8, 1, v8
  v_mov_b32 v16, s70
  s_mov_b32 exec_hi, 0
  s_waitcnt vmcnt(0)
  buffer_store_dwordx4 v[8:11], v7, s[4:7], s28 offen sc1
  s_mov_b64 exec, 1
  buffer_store_dword v16, v4, s[4:7], s37 offen offset:8 sc1
  s_mov_b64 exec, -1
  s_cmp_lg_u32 s62, 0
  s_cbranch_scc1 .g2_kernel_tail
  s_mov_b32 s62, 1
  s_mov_b32 s63, 0x1800000
  s_mov_b32 s70, 2
  s_mov_b32 s71, 155776
  s_branch .g2_kernel_q_cons2
.g2_kernel_tail:
  s_mov_b32 s28, s56
  s_mov_b32 s29, s57
  s_mov_b32 s30, 0x400000
  s_mov_b32 s31, 0x00020000
  v_lshlrev_b32 v24, 16, v56
  v_and_b32 v25, 0xffff0000, v56
  v_lshlrev_b32 v26, 16, v57
  v_and_b32 v27, 0xffff0000, v57
  v_lshlrev_b32 v28, 16, v58
  v_and_b32 v29, 0xffff0000, v58
  v_lshlrev_b32 v30, 16, v59
  v_and_b32 v31, 0xffff0000, v59
  v_lshlrev_b32 v32, 16, v60
  v_and_b32 v33, 0xffff0000, v60
  v_lshlrev_b32 v34, 16, v61
  v_and_b32 v35, 0xffff0000, v61
  v_lshlrev_b32 v36, 16, v62
  v_and_b32 v37, 0xffff0000, v62
  v_lshlrev_b32 v38, 16, v63
  v_and_b32 v39, 0xffff0000, v63
  v_lshlrev_b32 v40, 16, v64
  v_and_b32 v41, 0xffff0000, v64
  v_lshlrev_b32 v42, 16, v65
  v_and_b32 v43, 0xffff0000, v65
  v_lshlrev_b32 v44, 16, v66
  v_and_b32 v45, 0xffff0000, v66
  v_lshlrev_b32 v46, 16, v67
  v_and_b32 v47, 0xffff0000, v67
  v_lshlrev_b32 v48, 16, v68
  v_and_b32 v49, 0xffff0000, v68
  v_lshlrev_b32 v50, 16, v69
  v_and_b32 v51, 0xffff0000, v69
  v_lshlrev_b32 v52, 16, v70
  v_and_b32 v53, 0xffff0000, v70
  v_lshlrev_b32 v54, 16, v71
  v_and_b32 v55, 0xffff0000, v71
  v_lshlrev_b32 v10, 2, v19
  v_add_u32 v10, 155644, v10
  s_lshl_b32 s32, s17, 2
  s_add_u32 s32, s32, s16
  s_lshl_b32 s32, s32, 16
  s_lshl_b32 s33, s18, 7
  s_add_u32 s32, s32, s33
  v_mov_b32 v6, s71
  s_mov_b32 s38, 0
.g2_kernel_wg5:
  ds_read_b32 v7, v6 offset:28
  s_add_u32 s38, s38, 1
  s_waitcnt lgkmcnt(0)
  v_cmp_le_u32 vcc, 1, v7
  s_cbranch_vccnz .g2_kernel_wg5d
  s_sleep 2
  s_cmp_lt_u32 s38, 524288
  s_cbranch_scc1 .g2_kernel_wg5
.g2_kernel_wg5d:
  ds_read_b32 v8, v10 offset:3840
  ds_read_b32 v9, v10 offset:4352
  ds_read_b32 v16, v20 offset:32
  s_waitcnt lgkmcnt(0)
  v_cmp_ne_u32 vcc, v16, v19
  v_pk_fma_f32 v[24:25], v[24:25], v[8:9], v[8:9] op_sel:[0,0,1] op_sel_hi:[1,0,1]
  v_pk_fma_f32 v[26:27], v[26:27], v[8:9], v[8:9] op_sel:[0,0,1] op_sel_hi:[1,0,1]
  v_pk_fma_f32 v[28:29], v[28:29], v[8:9], v[8:9] op_sel:[0,0,1] op_sel_hi:[1,0,1]
  v_pk_fma_f32 v[30:31], v[30:31], v[8:9], v[8:9] op_sel:[0,0,1] op_sel_hi:[1,0,1]
  v_pk_fma_f32 v[32:33], v[32:33], v[8:9], v[8:9] op_sel:[0,0,1] op_sel_hi:[1,0,1]
  v_pk_fma_f32 v[34:35], v[34:35], v[8:9], v[8:9] op_sel:[0,0,1] op_sel_hi:[1,0,1]
  v_pk_fma_f32 v[36:37], v[36:37], v[8:9], v[8:9] op_sel:[0,0,1] op_sel_hi:[1,0,1]
  v_pk_fma_f32 v[38:39], v[38:39], v[8:9], v[8:9] op_sel:[0,0,1] op_sel_hi:[1,0,1]
  v_pk_fma_f32 v[40:41], v[40:41], v[8:9], v[8:9] op_sel:[0,0,1] op_sel_hi:[1,0,1]
  v_pk_fma_f32 v[42:43], v[42:43], v[8:9], v[8:9] op_sel:[0,0,1] op_sel_hi:[1,0,1]
  v_pk_fma_f32 v[44:45], v[44:45], v[8:9], v[8:9] op_sel:[0,0,1] op_sel_hi:[1,0,1]
  v_pk_fma_f32 v[46:47], v[46:47], v[8:9], v[8:9] op_sel:[0,0,1] op_sel_hi:[1,0,1]
  v_pk_fma_f32 v[48:49], v[48:49], v[8:9], v[8:9] op_sel:[0,0,1] op_sel_hi:[1,0,1]
  v_pk_fma_f32 v[50:51], v[50:51], v[8:9], v[8:9] op_sel:[0,0,1] op_sel_hi:[1,0,1]
  v_pk_fma_f32 v[52:53], v[52:53], v[8:9], v[8:9] op_sel:[0,0,1] op_sel_hi:[1,0,1]
  v_pk_fma_f32 v[54:55], v[54:55], v[8:9], v[8:9] op_sel:[0,0,1] op_sel_hi:[1,0,1]
  v_cvt_pk_bf16_f32 v56, v24, v25
  v_cvt_pk_bf16_f32 v57, v26, v27
  v_cvt_pk_bf16_f32 v58, v28, v29
  v_cvt_pk_bf16_f32 v59, v30, v31
  v_cvt_pk_bf16_f32 v60, v32, v33
  v_cvt_pk_bf16_f32 v61, v34, v35
  v_cvt_pk_bf16_f32 v62, v36, v37
  v_cvt_pk_bf16_f32 v63, v38, v39
  v_cvt_pk_bf16_f32 v64, v40, v41
  v_cvt_pk_bf16_f32 v65, v42, v43
  v_cvt_pk_bf16_f32 v66, v44, v45
  v_cvt_pk_bf16_f32 v67, v46, v47
  v_cvt_pk_bf16_f32 v68, v48, v49
  v_cvt_pk_bf16_f32 v69, v50, v51
  v_cvt_pk_bf16_f32 v70, v52, v53
  v_cvt_pk_bf16_f32 v71, v54, v55
  s_mov_b64 exec, vcc
  buffer_store_dwordx4 v[56:59], v23, s[28:31], s32 offen offset:0
  buffer_store_dwordx4 v[60:63], v23, s[28:31], s32 offen offset:32
  buffer_store_dwordx4 v[64:67], v23, s[28:31], s32 offen offset:64
  buffer_store_dwordx4 v[68:71], v23, s[28:31], s32 offen offset:96
  s_mov_b64 exec, -1
  s_branch .g2_kernel_fin
.g2_kernel_svc:
  s_cmp_eq_u32 s16, 5
  s_cbranch_scc1 .g2_kernel_s1
  s_cmp_eq_u32 s16, 6
  s_cbranch_scc1 .g2_kernel_s2
  s_cmp_eq_u32 s16, 7
  s_cbranch_scc1 .g2_kernel_s3
  s_mov_b32 s8, s40
  s_mov_b32 s9, s41
  s_mov_b32 s10, 0x400000
  s_mov_b32 s11, 0x00020000
  s_setprio 3
  v_lshrrev_b32 v20, 3, v2
  v_and_b32 v21, 7, v2
  v_lshrrev_b32 v22, 4, v2
  v_xor_b32 v23, v21, v22
  v_lshlrev_b32 v23, 4, v23
  v_lshl_add_u32 v24, v20, 11, v23
  v_xor_b32 v25, 64, v24
  s_lshl_b32 s32, s17, 18
  v_add_u32 v32, 0, v24
  v_add_u32 v33, 15360, v25
  v_add_u32 v34, 30720, v24
  v_add_u32 v35, 46080, v25
  v_add_u32 v36, 65536, v24
  v_add_u32 v37, 80896, v25
  v_add_u32 v38, 96256, v24
  v_add_u32 v39, 111616, v25
  v_add_u32 v40, 131072, v24
  v_add_u32 v41, 146432, v25
  v_add_u32 v42, 161792, v24
  v_add_u32 v43, 177152, v25
  v_add_u32 v44, 196608, v24
  v_add_u32 v45, 211968, v25
  v_add_u32 v46, 227328, v24
  v_add_u32 v47, 242688, v25
  s_mov_b32 s29, 0
  s_add_u32 m0, s29, 0
  s_nop 0
  buffer_load_dwordx4 v32, s[8:11], s32 offen offset:0 lds
  buffer_load_dwordx4 v33, s[8:11], s32 offen offset:1024 lds
  buffer_load_dwordx4 v34, s[8:11], s32 offen offset:2048 lds
  buffer_load_dwordx4 v35, s[8:11], s32 offen offset:3072 lds
  s_add_u32 m0, s29, 4096
  s_nop 0
  buffer_load_dwordx4 v36, s[8:11], s32 offen offset:0 lds
  buffer_load_dwordx4 v37, s[8:11], s32 offen offset:1024 lds
  buffer_load_dwordx4 v38, s[8:11], s32 offen offset:2048 lds
  buffer_load_dwordx4 v39, s[8:11], s32 offen offset:3072 lds
  s_add_u32 m0, s29, 8192
  s_nop 0
  buffer_load_dwordx4 v40, s[8:11], s32 offen offset:0 lds
  buffer_load_dwordx4 v41, s[8:11], s32 offen offset:1024 lds
  buffer_load_dwordx4 v42, s[8:11], s32 offen offset:2048 lds
  buffer_load_dwordx4 v43, s[8:11], s32 offen offset:3072 lds
  s_add_u32 m0, s29, 12288
  s_nop 0
  buffer_load_dwordx4 v44, s[8:11], s32 offen offset:0 lds
  buffer_load_dwordx4 v45, s[8:11], s32 offen offset:1024 lds
  buffer_load_dwordx4 v46, s[8:11], s32 offen offset:2048 lds
  buffer_load_dwordx4 v47, s[8:11], s32 offen offset:3072 lds
  s_add_u32 s32, s32, 128
  s_mov_b32 s12, s42
  s_mov_b32 s13, s43
  s_mov_b32 s14, 0x600000
  s_mov_b32 s15, 0x00020000
  v_lshrrev_b32 v28, 3, v2
  v_and_b32 v29, 7, v2
  v_bfe_u32 v30, v2, 4, 1
  v_lshlrev_b32 v30, 1, v30
  v_xor_b32 v31, v29, v30
  v_lshlrev_b32 v31, 4, v31
  v_mul_u32_u24 v28, 6144, v28
  v_add_u32 v28, v28, v31
  v_xor_b32 v29, 64, v28
  v_lshlrev_b32 v9, 8, v2
  v_and_b32 v9, 0x300, v9
  v_add_u32 v9, 156416, v9
  v_add_u32 v48, 0, v28
  v_add_u32 v49, 48128, v29
  v_add_u32 v50, 96256, v28
  v_add_u32 v51, 144384, v29
  v_add_u32 v52, 2048, v28
  v_add_u32 v53, 50176, v29
  v_add_u32 v54, 98304, v28
  v_add_u32 v55, 146432, v29
  v_add_u32 v56, 4096, v28
  v_add_u32 v57, 52224, v29
  v_add_u32 v58, 100352, v28
  v_add_u32 v59, 148480, v29
  s_lshl_b32 s36, s18, 7
  s_mov_b32 s30, 0
  s_add_u32 m0, s30, 65536
  s_nop 0
  buffer_load_dwordx4 v48, s[12:15], s36 offen offset:0 lds
  buffer_load_dwordx4 v49, s[12:15], s36 offen offset:1024 lds
  buffer_load_dwordx4 v50, s[12:15], s36 offen offset:2048 lds
  buffer_load_dwordx4 v51, s[12:15], s36 offen offset:3072 lds
  s_add_u32 m0, s30, 69632
  s_nop 0
  buffer_load_dwordx4 v52, s[12:15], s36 offen offset:0 lds
  buffer_load_dwordx4 v53, s[12:15], s36 offen offset:1024 lds
  buffer_load_dwordx4 v54, s[12:15], s36 offen offset:2048 lds
  buffer_load_dwordx4 v55, s[12:15], s36 offen offset:3072 lds
  s_add_u32 m0, s30, 73728
  s_nop 0
  buffer_load_dwordx4 v56, s[12:15], s36 offen offset:0 lds
  buffer_load_dwordx4 v57, s[12:15], s36 offen offset:1024 lds
  buffer_load_dwordx4 v58, s[12:15], s36 offen offset:2048 lds
  buffer_load_dwordx4 v59, s[12:15], s36 offen offset:3072 lds
  s_add_u32 s30, s30, 12288
  s_cmp_eq_u32 s30, 86016
  s_cselect_b32 s30, 0, s30
  s_barrier
  s_mov_b32 s35, .g2_kernel_tab-.g2_kernel_pc+4
  s_mov_b32 s34, -5
  v_mov_b32 v10, 0
  s_mov_b32 m0, 156160
  s_add_u32 s36, s36, 196608
  buffer_load_dword off, s[64:67], s35 lds
  s_add_u32 s35, s35, 4
  s_branch .g2_kernel_p1_o
  .p2align 6
.g2_kernel_p1_l:
  s_waitcnt lgkmcnt(0)
  v_cmp_gt_i32 vcc, s34, v10
  s_cbranch_vccnz .g2_kernel_p1_aw
.g2_kernel_p1_ai:
  s_add_u32 s29, s29, 16384
  s_and_b32 s29, s29, 0xffff
  s_add_u32 m0, s29, 0
  s_nop 0
  buffer_load_dwordx4 v32, s[8:11], s32 offen offset:0 lds
  buffer_load_dwordx4 v33, s[8:11], s32 offen offset:1024 lds
  buffer_load_dwordx4 v34, s[8:11], s32 offen offset:2048 lds
  buffer_load_dwordx4 v35, s[8:11], s32 offen offset:3072 lds
  s_add_u32 m0, s29, 4096
  s_nop 0
  buffer_load_dwordx4 v36, s[8:11], s32 offen offset:0 lds
  buffer_load_dwordx4 v37, s[8:11], s32 offen offset:1024 lds
  buffer_load_dwordx4 v38, s[8:11], s32 offen offset:2048 lds
  buffer_load_dwordx4 v39, s[8:11], s32 offen offset:3072 lds
  s_add_u32 m0, s29, 8192
  s_nop 0
  buffer_load_dwordx4 v40, s[8:11], s32 offen offset:0 lds
  buffer_load_dwordx4 v41, s[8:11], s32 offen offset:1024 lds
  buffer_load_dwordx4 v42, s[8:11], s32 offen offset:2048 lds
  buffer_load_dwordx4 v43, s[8:11], s32 offen offset:3072 lds
  s_add_u32 m0, s29, 12288
  s_nop 0
  buffer_load_dwordx4 v44, s[8:11], s32 offen offset:0 lds
  buffer_load_dwordx4 v45, s[8:11], s32 offen offset:1024 lds
  buffer_load_dwordx4 v46, s[8:11], s32 offen offset:2048 lds
  buffer_load_dwordx4 v47, s[8:11], s32 offen offset:3072 lds
  s_add_u32 s32, s32, 128
  s_add_u32 m0, s30, 65536
  s_nop 0
  buffer_load_dwordx4 v48, s[12:15], s36 offen offset:0 lds
  buffer_load_dwordx4 v49, s[12:15], s36 offen offset:1024 lds
  buffer_load_dwordx4 v50, s[12:15], s36 offen offset:2048 lds
  buffer_load_dwordx4 v51, s[12:15], s36 offen offset:3072 lds
  s_add_u32 m0, s30, 69632
  s_nop 0
  buffer_load_dwordx4 v52, s[12:15], s36 offen offset:0 lds
  buffer_load_dwordx4 v53, s[12:15], s36 offen offset:1024 lds
  buffer_load_dwordx4 v54, s[12:15], s36 offen offset:2048 lds
  buffer_load_dwordx4 v55, s[12:15], s36 offen offset:3072 lds
  s_add_u32 m0, s30, 73728
  s_nop 0
  buffer_load_dwordx4 v56, s[12:15], s36 offen offset:0 lds
  buffer_load_dwordx4 v57, s[12:15], s36 offen offset:1024 lds
  buffer_load_dwordx4 v58, s[12:15], s36 offen offset:2048 lds
  buffer_load_dwordx4 v59, s[12:15], s36 offen offset:3072 lds
  s_add_u32 s30, s30, 12288
  s_cmp_eq_u32 s30, 86016
  s_cselect_b32 s30, 0, s30
  ds_read_b32 v10, v9
  s_mov_b32 m0, 156160
  s_add_u32 s34, s34, 1
  buffer_load_dword off, s[64:67], s35 lds
  s_add_u32 s35, s35, 4
  s_add_u32 s36, s36, 196608
.g2_kernel_p1_o:
  s_waitcnt lgkmcnt(0)
  v_cmp_gt_i32 vcc, s34, v10
  s_cbranch_vccnz .g2_kernel_p1_bw
.g2_kernel_p1_bi:
  s_add_u32 m0, s30, 65536
  s_nop 0
  buffer_load_dwordx4 v48, s[12:15], s36 offen offset:0 lds
  buffer_load_dwordx4 v49, s[12:15], s36 offen offset:1024 lds
  buffer_load_dwordx4 v50, s[12:15], s36 offen offset:2048 lds
  buffer_load_dwordx4 v51, s[12:15], s36 offen offset:3072 lds
  s_add_u32 m0, s30, 69632
  s_nop 0
  buffer_load_dwordx4 v52, s[12:15], s36 offen offset:0 lds
  buffer_load_dwordx4 v53, s[12:15], s36 offen offset:1024 lds
  buffer_load_dwordx4 v54, s[12:15], s36 offen offset:2048 lds
  buffer_load_dwordx4 v55, s[12:15], s36 offen offset:3072 lds
  s_add_u32 m0, s30, 73728
  s_nop 0
  buffer_load_dwordx4 v56, s[12:15], s36 offen offset:0 lds
  buffer_load_dwordx4 v57, s[12:15], s36 offen offset:1024 lds
  buffer_load_dwordx4 v58, s[12:15], s36 offen offset:2048 lds
  buffer_load_dwordx4 v59, s[12:15], s36 offen offset:3072 lds
  s_add_u32 s30, s30, 12288
  s_cmp_eq_u32 s30, 86016
  s_cselect_b32 s30, 0, s30
  ds_read_b32 v10, v9
  s_mov_b32 m0, 156160
  s_add_u32 s34, s34, 1
  buffer_load_dword off, s[64:67], s35 lds
  s_add_u32 s35, s35, 4
  s_add_u32 s36, s36, 196608
  s_cmp_lt_i32 s34, 26
  s_cbranch_scc1 .g2_kernel_p1_l
  s_branch .g2_kernel_v
.g2_kernel_s1:
  s_mov_b32 s8, s40
  s_mov_b32 s9, s41
  s_mov_b32 s10, 0x400000
  s_mov_b32 s11, 0x00020000
  v_lshrrev_b32 v20, 3, v2
  v_and_b32 v21, 7, v2
  v_lshlrev_b32 v21, 4, v21
  v_lshl_add_u32 v21, v20, 11, v21
  s_lshl_b32 s30, s17, 4
  s_add_u32 s30, s30, s18
  s_lshl_b32 s33, s30, 5
  s_lshl_b32 s30, s30, 14
  s_barrier
  s_sleep 30
  buffer_load_dwordx4 v[64:67], v21, s[8:11], s30 offen offset:0
  buffer_load_dwordx4 v[68:71], v21, s[8:11], s30 offen offset:128
  buffer_load_dwordx4 v[72:75], v21, s[8:11], s30 offen offset:256
  buffer_load_dwordx4 v[76:79], v21, s[8:11], s30 offen offset:384
  buffer_load_dwordx4 v[80:83], v21, s[8:11], s30 offen offset:512
  buffer_load_dwordx4 v[84:87], v21, s[8:11], s30 offen offset:640
  buffer_load_dwordx4 v[88:91], v21, s[8:11], s30 offen offset:768
  buffer_load_dwordx4 v[92:95], v21, s[8:11], s30 offen offset:896
  buffer_load_dwordx4 v[96:99], v21, s[8:11], s30 offen offset:1024
  buffer_load_dwordx4 v[100:103], v21, s[8:11], s30 offen offset:1152
  buffer_load_dwordx4 v[104:107], v21, s[8:11], s30 offen offset:1280
  buffer_load_dwordx4 v[108:111], v21, s[8:11], s30 offen offset:1408
  buffer_load_dwordx4 v[112:115], v21, s[8:11], s30 offen offset:1536
  buffer_load_dwordx4 v[116:119], v21, s[8:11], s30 offen offset:1664
  buffer_load_dwordx4 v[120:123], v21, s[8:11], s30 offen offset:1792
  buffer_load_dwordx4 v[124:127], v21, s[8:11], s30 offen offset:1920
  v_mov_b32 v24, 0
  v_mov_b32 v25, 0
  v_mov_b32 v26, 0
  v_mov_b32 v27, 0
  s_waitcnt vmcnt(15)
  v_lshlrev_b32 v22, 16, v64
  v_and_b32 v64, 0xffff0000, v64
  v_add_f32 v24, v24, v22
  v_fmac_f32 v25, v22, v22
  v_add_f32 v26, v26, v64
  v_fmac_f32 v27, v64, v64
  v_lshlrev_b32 v22, 16, v65
  v_and_b32 v65, 0xffff0000, v65
  v_add_f32 v24, v24, v22
  v_fmac_f32 v25, v22, v22
  v_add_f32 v26, v26, v65
  v_fmac_f32 v27, v65, v65
  v_lshlrev_b32 v22, 16, v66
  v_and_b32 v66, 0xffff0000, v66
  v_add_f32 v24, v24, v22
  v_fmac_f32 v25, v22, v22
  v_add_f32 v26, v26, v66
  v_fmac_f32 v27, v66, v66
  v_lshlrev_b32 v22, 16, v67
  v_and_b32 v67, 0xffff0000, v67
  v_add_f32 v24, v24, v22
  v_fmac_f32 v25, v22, v22
  v_add_f32 v26, v26, v67
  v_fmac_f32 v27, v67, v67
  s_waitcnt vmcnt(14)
  v_lshlrev_b32 v22, 16, v68
  v_and_b32 v68, 0xffff0000, v68
  v_add_f32 v24, v24, v22
  v_fmac_f32 v25, v22, v22
  v_add_f32 v26, v26, v68
  v_fmac_f32 v27, v68, v68
  v_lshlrev_b32 v22, 16, v69
  v_and_b32 v69, 0xffff0000, v69
  v_add_f32 v24, v24, v22
  v_fmac_f32 v25, v22, v22
  v_add_f32 v26, v26, v69
  v_fmac_f32 v27, v69, v69
  v_lshlrev_b32 v22, 16, v70
  v_and_b32 v70, 0xffff0000, v70
  v_add_f32 v24, v24, v22
  v_fmac_f32 v25, v22, v22
  v_add_f32 v26, v26, v70
  v_fmac_f32 v27, v70, v70
  v_lshlrev_b32 v22, 16, v71
  v_and_b32 v71, 0xffff0000, v71
  v_add_f32 v24, v24, v22
  v_fmac_f32 v25, v22, v22
  v_add_f32 v26, v26, v71
  v_fmac_f32 v27, v71, v71
  s_waitcnt vmcnt(13)
  v_lshlrev_b32 v22, 16, v72
  v_and_b32 v72, 0xffff0000, v72
  v_add_f32 v24, v24, v22
  v_fmac_f32 v25, v22, v22
  v_add_f32 v26, v26, v72
  v_fmac_f32 v27, v72, v72
  v_lshlrev_b32 v22, 16, v73
  v_and_b32 v73, 0xffff0000, v73
  v_add_f32 v24, v24, v22
  v_fmac_f32 v25, v22, v22
  v_add_f32 v26, v26, v73
  v_fmac_f32 v27, v73, v73
  v_lshlrev_b32 v22, 16, v74
  v_and_b32 v74, 0xffff0000, v74
  v_add_f32 v24, v24, v22
  v_fmac_f32 v25, v22, v22
  v_add_f32 v26, v26, v74
  v_fmac_f32 v27, v74, v74
  v_lshlrev_b32 v22, 16, v75
  v_and_b32 v75, 0xffff0000, v75
  v_add_f32 v24, v24, v22
  v_fmac_f32 v25, v22, v22
  v_add_f32 v26, v26, v75
  v_fmac_f32 v27, v75, v75
  s_waitcnt vmcnt(12)
  v_lshlrev_b32 v22, 16, v76
  v_and_b32 v76, 0xffff0000, v76
  v_add_f32 v24, v24, v22
  v_fmac_f32 v25, v22, v22
  v_add_f32 v26, v26, v76
  v_fmac_f32 v27, v76, v76
  v_lshlrev_b32 v22, 16, v77
  v_and_b32 v77, 0xffff0000, v77
  v_add_f32 v24, v24, v22
  v_fmac_f32 v25, v22, v22
  v_add_f32 v26, v26, v77
  v_fmac_f32 v27, v77, v77
  v_lshlrev_b32 v22, 16, v78
  v_and_b32 v78, 0xffff0000, v78
  v_add_f32 v24, v24, v22
  v_fmac_f32 v25, v22, v22
  v_add_f32 v26, v26, v78
  v_fmac_f32 v27, v78, v78
  v_lshlrev_b32 v22, 16, v79
  v_and_b32 v79, 0xffff0000, v79
  v_add_f32 v24, v24, v22
  v_fmac_f32 v25, v22, v22
  v_add_f32 v26, v26, v79
  v_fmac_f32 v27, v79, v79
  s_waitcnt vmcnt(11)
  v_lshlrev_b32 v22, 16, v80
  v_and_b32 v80, 0xffff0000, v80
  v_add_f32 v24, v24, v22
  v_fmac_f32 v25, v22, v22
  v_add_f32 v26, v26, v80
  v_fmac_f32 v27, v80, v80
  v_lshlrev_b32 v22, 16, v81
  v_and_b32 v81, 0xffff0000, v81
  v_add_f32 v24, v24, v22
  v_fmac_f32 v25, v22, v22
  v_add_f32 v26, v26, v81
  v_fmac_f32 v27, v81, v81
  v_lshlrev_b32 v22, 16, v82
  v_and_b32 v82, 0xffff0000, v82
  v_add_f32 v24, v24, v22
  v_fmac_f32 v25, v22, v22
  v_add_f32 v26, v26, v82
  v_fmac_f32 v27, v82, v82
  v_lshlrev_b32 v22, 16, v83
  v_and_b32 v83, 0xffff0000, v83
  v_add_f32 v24, v24, v22
  v_fmac_f32 v25, v22, v22
  v_add_f32 v26, v26, v83
  v_fmac_f32 v27, v83, v83
  s_waitcnt vmcnt(10)
  v_lshlrev_b32 v22, 16, v84
  v_and_b32 v84, 0xffff0000, v84
  v_add_f32 v24, v24, v22
  v_fmac_f32 v25, v22, v22
  v_add_f32 v26, v26, v84
  v_fmac_f32 v27, v84, v84
  v_lshlrev_b32 v22, 16, v85
  v_and_b32 v85, 0xffff0000, v85
  v_add_f32 v24, v24, v22
  v_fmac_f32 v25, v22, v22
  v_add_f32 v26, v26, v85
  v_fmac_f32 v27, v85, v85
  v_lshlrev_b32 v22, 16, v86
  v_and_b32 v86, 0xffff0000, v86
  v_add_f32 v24, v24, v22
  v_fmac_f32 v25, v22, v22
  v_add_f32 v26, v26, v86
  v_fmac_f32 v27, v86, v86
  v_lshlrev_b32 v22, 16, v87
  v_and_b32 v87, 0xffff0000, v87
  v_add_f32 v24, v24, v22
  v_fmac_f32 v25, v22, v22
  v_add_f32 v26, v26, v87
  v_fmac_f32 v27, v87, v87
  s_waitcnt vmcnt(9)
  v_lshlrev_b32 v22, 16, v88
  v_and_b32 v88, 0xffff0000, v88
  v_add_f32 v24, v24, v22
  v_fmac_f32 v25, v22, v22
  v_add_f32 v26, v26, v88
  v_fmac_f32 v27, v88, v88
  v_lshlrev_b32 v22, 16, v89
  v_and_b32 v89, 0xffff0000, v89
  v_add_f32 v24, v24, v22
  v_fmac_f32 v25, v22, v22
  v_add_f32 v26, v26, v89
  v_fmac_f32 v27, v89, v89
  v_lshlrev_b32 v22, 16, v90
  v_and_b32 v90, 0xffff0000, v90
  v_add_f32 v24, v24, v22
  v_fmac_f32 v25, v22, v22
  v_add_f32 v26, v26, v90
  v_fmac_f32 v27, v90, v90
  v_lshlrev_b32 v22, 16, v91
  v_and_b32 v91, 0xffff0000, v91
  v_add_f32 v24, v24, v22
  v_fmac_f32 v25, v22, v22
  v_add_f32 v26, v26, v91
  v_fmac_f32 v27, v91, v91
  s_waitcnt vmcnt(8)
  v_lshlrev_b32 v22, 16, v92
  v_and_b32 v92, 0xffff0000, v92
  v_add_f32 v24, v24, v22
  v_fmac_f32 v25, v22, v22
  v_add_f32 v26, v26, v92
  v_fmac_f32 v27, v92, v92
  v_lshlrev_b32 v22, 16, v93
  v_and_b32 v93, 0xffff0000, v93
  v_add_f32 v24, v24, v22
  v_fmac_f32 v25, v22, v22
  v_add_f32 v26, v26, v93
  v_fmac_f32 v27, v93, v93
  v_lshlrev_b32 v22, 16, v94
  v_and_b32 v94, 0xffff0000, v94
  v_add_f32 v24, v24, v22
  v_fmac_f32 v25, v22, v22
  v_add_f32 v26, v26, v94
  v_fmac_f32 v27, v94, v94
  v_lshlrev_b32 v22, 16, v95
  v_and_b32 v95, 0xffff0000, v95
  v_add_f32 v24, v24, v22
  v_fmac_f32 v25, v22, v22
  v_add_f32 v26, v26, v95
  v_fmac_f32 v27, v95, v95
  s_waitcnt vmcnt(7)
  v_lshlrev_b32 v22, 16, v96
  v_and_b32 v96, 0xffff0000, v96
  v_add_f32 v24, v24, v22
  v_fmac_f32 v25, v22, v22
  v_add_f32 v26, v26, v96
  v_fmac_f32 v27, v96, v96
  v_lshlrev_b32 v22, 16, v97
  v_and_b32 v97, 0xffff0000, v97
  v_add_f32 v24, v24, v22
  v_fmac_f32 v25, v22, v22
  v_add_f32 v26, v26, v97
  v_fmac_f32 v27, v97, v97
  v_lshlrev_b32 v22, 16, v98
  v_and_b32 v98, 0xffff0000, v98
  v_add_f32 v24, v24, v22
  v_fmac_f32 v25, v22, v22
  v_add_f32 v26, v26, v98
  v_fmac_f32 v27, v98, v98
  v_lshlrev_b32 v22, 16, v99
  v_and_b32 v99, 0xffff0000, v99
  v_add_f32 v24, v24, v22
  v_fmac_f32 v25, v22, v22
  v_add_f32 v26, v26, v99
  v_fmac_f32 v27, v99, v99
  s_waitcnt vmcnt(6)
  v_lshlrev_b32 v22, 16, v100
  v_and_b32 v100, 0xffff0000, v100
  v_add_f32 v24, v24, v22
  v_fmac_f32 v25, v22, v22
  v_add_f32 v26, v26, v100
  v_fmac_f32 v27, v100, v100
  v_lshlrev_b32 v22, 16, v101
  v_and_b32 v101, 0xffff0000, v101
  v_add_f32 v24, v24, v22
  v_fmac_f32 v25, v22, v22
  v_add_f32 v26, v26, v101
  v_fmac_f32 v27, v101, v101
  v_lshlrev_b32 v22, 16, v102
  v_and_b32 v102, 0xffff0000, v102
  v_add_f32 v24, v24, v22
  v_fmac_f32 v25, v22, v22
  v_add_f32 v26, v26, v102
  v_fmac_f32 v27, v102, v102
  v_lshlrev_b32 v22, 16, v103
  v_and_b32 v103, 0xffff0000, v103
  v_add_f32 v24, v24, v22
  v_fmac_f32 v25, v22, v22
  v_add_f32 v26, v26, v103
  v_fmac_f32 v27, v103, v103
  s_waitcnt vmcnt(5)
  v_lshlrev_b32 v22, 16, v104
  v_and_b32 v104, 0xffff0000, v104
  v_add_f32 v24, v24, v22
  v_fmac_f32 v25, v22, v22
  v_add_f32 v26, v26, v104
  v_fmac_f32 v27, v104, v104
  v_lshlrev_b32 v22, 16, v105
  v_and_b32 v105, 0xffff0000, v105
  v_add_f32 v24, v24, v22
  v_fmac_f32 v25, v22, v22
  v_add_f32 v26, v26, v105
  v_fmac_f32 v27, v105, v105
  v_lshlrev_b32 v22, 16, v106
  v_and_b32 v106, 0xffff0000, v106
  v_add_f32 v24, v24, v22
  v_fmac_f32 v25, v22, v22
  v_add_f32 v26, v26, v106
  v_fmac_f32 v27, v106, v106
  v_lshlrev_b32 v22, 16, v107
  v_and_b32 v107, 0xffff0000, v107
  v_add_f32 v24, v24, v22
  v_fmac_f32 v25, v22, v22
  v_add_f32 v26, v26, v107
  v_fmac_f32 v27, v107, v107
  s_waitcnt vmcnt(4)
  v_lshlrev_b32 v22, 16, v108
  v_and_b32 v108, 0xffff0000, v108
  v_add_f32 v24, v24, v22
  v_fmac_f32 v25, v22, v22
  v_add_f32 v26, v26, v108
  v_fmac_f32 v27, v108, v108
  v_lshlrev_b32 v22, 16, v109
  v_and_b32 v109, 0xffff0000, v109
  v_add_f32 v24, v24, v22
  v_fmac_f32 v25, v22, v22
  v_add_f32 v26, v26, v109
  v_fmac_f32 v27, v109, v109
  v_lshlrev_b32 v22, 16, v110
  v_and_b32 v110, 0xffff0000, v110
  v_add_f32 v24, v24, v22
  v_fmac_f32 v25, v22, v22
  v_add_f32 v26, v26, v110
  v_fmac_f32 v27, v110, v110
  v_lshlrev_b32 v22, 16, v111
  v_and_b32 v111, 0xffff0000, v111
  v_add_f32 v24, v24, v22
  v_fmac_f32 v25, v22, v22
  v_add_f32 v26, v26, v111
  v_fmac_f32 v27, v111, v111
  s_waitcnt vmcnt(3)
  v_lshlrev_b32 v22, 16, v112
  v_and_b32 v112, 0xffff0000, v112
  v_add_f32 v24, v24, v22
  v_fmac_f32 v25, v22, v22
  v_add_f32 v26, v26, v112
  v_fmac_f32 v27, v112, v112
  v_lshlrev_b32 v22, 16, v113
  v_and_b32 v113, 0xffff0000, v113
  v_add_f32 v24, v24, v22
  v_fmac_f32 v25, v22, v22
  v_add_f32 v26, v26, v113
  v_fmac_f32 v27, v113, v113
  v_lshlrev_b32 v22, 16, v114
  v_and_b32 v114, 0xffff0000, v114
  v_add_f32 v24, v24, v22
  v_fmac_f32 v25, v22, v22
  v_add_f32 v26, v26, v114
  v_fmac_f32 v27, v114, v114
  v_lshlrev_b32 v22, 16, v115
  v_and_b32 v115, 0xffff0000, v115
  v_add_f32 v24, v24, v22
  v_fmac_f32 v25, v22, v22
  v_add_f32 v26, v26, v115
  v_fmac_f32 v27, v115, v115
  s_waitcnt vmcnt(2)
  v_lshlrev_b32 v22, 16, v116
  v_and_b32 v116, 0xffff0000, v116
  v_add_f32 v24, v24, v22
  v_fmac_f32 v25, v22, v22
  v_add_f32 v26, v26, v116
  v_fmac_f32 v27, v116, v116
  v_lshlrev_b32 v22, 16, v117
  v_and_b32 v117, 0xffff0000, v117
  v_add_f32 v24, v24, v22
  v_fmac_f32 v25, v22, v22
  v_add_f32 v26, v26, v117
  v_fmac_f32 v27, v117, v117
  v_lshlrev_b32 v22, 16, v118
  v_and_b32 v118, 0xffff0000, v118
  v_add_f32 v24, v24, v22
  v_fmac_f32 v25, v22, v22
  v_add_f32 v26, v26, v118
  v_fmac_f32 v27, v118, v118
  v_lshlrev_b32 v22, 16, v119
  v_and_b32 v119, 0xffff0000, v119
  v_add_f32 v24, v24, v22
  v_fmac_f32 v25, v22, v22
  v_add_f32 v26, v26, v119
  v_fmac_f32 v27, v119, v119
  s_waitcnt vmcnt(1)
  v_lshlrev_b32 v22, 16, v120
  v_and_b32 v120, 0xffff0000, v120
  v_add_f32 v24, v24, v22
  v_fmac_f32 v25, v22, v22
  v_add_f32 v26, v26, v120
  v_fmac_f32 v27, v120, v120
  v_lshlrev_b32 v22, 16, v121
  v_and_b32 v121, 0xffff0000, v121
  v_add_f32 v24, v24, v22
  v_fmac_f32 v25, v22, v22
  v_add_f32 v26, v26, v121
  v_fmac_f32 v27, v121, v121
  v_lshlrev_b32 v22, 16, v122
  v_and_b32 v122, 0xffff0000, v122
  v_add_f32 v24, v24, v22
  v_fmac_f32 v25, v22, v22
  v_add_f32 v26, v26, v122
  v_fmac_f32 v27, v122, v122
  v_lshlrev_b32 v22, 16, v123
  v_and_b32 v123, 0xffff0000, v123
  v_add_f32 v24, v24, v22
  v_fmac_f32 v25, v22, v22
  v_add_f32 v26, v26, v123
  v_fmac_f32 v27, v123, v123
  s_waitcnt vmcnt(0)
  v_lshlrev_b32 v22, 16, v124
  v_and_b32 v124, 0xffff0000, v124
  v_add_f32 v24, v24, v22
  v_fmac_f32 v25, v22, v22
  v_add_f32 v26, v26, v124
  v_fmac_f32 v27, v124, v124
  v_lshlrev_b32 v22, 16, v125
  v_and_b32 v125, 0xffff0000, v125
  v_add_f32 v24, v24, v22
  v_fmac_f32 v25, v22, v22
  v_add_f32 v26, v26, v125
  v_fmac_f32 v27, v125, v125
  v_lshlrev_b32 v22, 16, v126
  v_and_b32 v126, 0xffff0000, v126
  v_add_f32 v24, v24, v22
  v_fmac_f32 v25, v22, v22
  v_add_f32 v26, v26, v126
  v_fmac_f32 v27, v126, v126
  v_lshlrev_b32 v22, 16, v127
  v_and_b32 v127, 0xffff0000, v127
  v_add_f32 v24, v24, v22
  v_fmac_f32 v25, v22, v22
  v_add_f32 v26, v26, v127
  v_fmac_f32 v27, v127, v127
  v_add_f32 v24, v24, v26
  v_add_f32 v25, v25, v27
  s_nop 0
  v_add_f32 v24, v24, v24 quad_perm:[1,0,3,2] row_mask:0xf bank_mask:0xf
  v_add_f32 v25, v25, v25 quad_perm:[1,0,3,2] row_mask:0xf bank_mask:0xf
  s_nop 0
  v_add_f32 v24, v24, v24 quad_perm:[2,3,0,1] row_mask:0xf bank_mask:0xf
  v_add_f32 v25, v25, v25 quad_perm:[2,3,0,1] row_mask:0xf bank_mask:0xf
  s_nop 0
  v_add_f32 v24, v24, v24 row_half_mirror row_mask:0xf bank_mask:0xf
  v_add_f32 v25, v25, v25 row_half_mirror row_mask:0xf bank_mask:0xf
  v_mov_b32 v26, 0.0009765625
  v_mul_f32 v24, v26, v24
  v_mul_f32 v27, v24, v24
  v_fma_f32 v25, v25, v26, -v27
  v_max_f32 v25, 0, v25
  v_add_f32 v25, 1e-05, v25
  v_rsq_f32 v25, v25
  v_lshlrev_b32 v20, 2, v20
  v_mul_f32 v24, v24, v25
  v_sub_f32 v24, 0, v24
  s_add_u32 s33, s33, 0x3070000
  s_add_u32 s34, s33, 0x2000
  s_mov_b32 exec_lo, 0x01010101
  s_mov_b32 exec_hi, 0x01010101
  buffer_store_dword v25, v20, s[4:7], s33 offen sc1
  buffer_store_dword v24, v20, s[4:7], s34 offen sc1
  s_mov_b64 exec, -1
  s_mov_b32 s12, s58
  s_mov_b32 s13, s59
  s_mov_b32 s14, 0x100
  s_mov_b32 s15, 0x00020000
  s_mov_b32 s38, 0
  s_mov_b64 exec, 1
.g2_kernel_gt6:
  buffer_load_dword v6, v4, s[12:15], 0 offen sc1
  s_add_u32 s38, s38, 1
  s_waitcnt vmcnt(0)
  v_cmp_eq_u32 vcc, 0x60, v6
  s_cbranch_vccnz .g2_kernel_gt6d
  s_sleep 8
  s_cmp_lt_u32 s38, 131072
  s_cbranch_scc1 .g2_kernel_gt6
.g2_kernel_gt6d:
  s_mov_b64 exec, -1
  v_mov_b32 v6, s70
  s_mov_b64 exec, 1
  buffer_store_dword v6, v4, s[4:7], s19 offen offset:12 sc1
  s_mov_b64 exec, -1
  v_mov_b32 v6, 155648
  s_mov_b32 s38, 0
.g2_kernel_wg7:
  ds_read_b32 v7, v6 offset:512
  s_add_u32 s38, s38, 1
  s_waitcnt lgkmcnt(0)
  v_cmp_le_u32 vcc, 27, v7
  s_cbranch_vccnz .g2_kernel_wg7d
  s_sleep 4
  s_cmp_lt_u32 s38, 524288
  s_cbranch_scc1 .g2_kernel_wg7
.g2_kernel_wg7d:
  s_and_b32 s31, s19, 0xffffe000
  s_add_u32 s31, s31, 12
  v_and_b32 v6, 15, v2
  v_lshlrev_b32 v6, 9, v6
  v_lshrrev_b32 v7, 4, v2
  v_lshl_add_u32 v6, v7, 7, v6
  v_lshlrev_b32 v7, 2, v2
  v_add_u32 v7, 157952, v7
  s_mov_b32 m0, 157952
  s_mov_b32 s38, 0
  s_bfm_b64 exec, 16, 0
.g2_kernel_pa8:
  buffer_load_dword v6, s[4:7], s31 offen sc1 lds
  s_add_u32 s38, s38, 1
  s_waitcnt vmcnt(0)
  ds_read_b32 v8, v7
  s_waitcnt lgkmcnt(0)
  v_cmp_ge_u32 vcc, s62, v8
  s_cbranch_vccz .g2_kernel_pa8d
  s_mov_b64 exec, vcc
  s_sleep 16
  s_cmp_lt_u32 s38, 131072
  s_cbranch_scc1 .g2_kernel_pa8
.g2_kernel_pa8d:
  s_mov_b64 exec, -1
  s_lshl_b32 s33, s17, 9
  s_add_u32 s33, s33, 0x3070000
  s_add_u32 s34, s33, 0x2000
  s_mov_b32 exec_hi, 0
  s_mov_b32 m0, 158464
  s_nop 0
  buffer_load_dwordx4 v3, s[4:7], s33 offen sc1 lds
  s_mov_b32 m0, 158976
  s_nop 0
  buffer_load_dwordx4 v3, s[4:7], s34 offen sc1 lds
  s_mov_b64 exec, -1
  v_mov_b32 v20, 1.0
  v_mov_b32 v21, 1.0
  v_mov_b32 v22, 0
  v_mov_b32 v23, 0
  v_lshlrev_b32 v24, 3, v2
  v_add_u32 v24, 155648, v24
  v_mov_b32 v6, 155648
  s_mov_b32 s38, 0
.g2_kernel_wg9:
  ds_read_b32 v7, v6 offset:512
  s_add_u32 s38, s38, 1
  s_waitcnt lgkmcnt(0)
  v_cmp_le_u32 vcc, 32, v7
  s_cbranch_vccnz .g2_kernel_wg9d
  s_sleep 2
  s_cmp_lt_u32 s38, 524288
  s_cbranch_scc1 .g2_kernel_wg9
.g2_kernel_wg9d:
  ds_write_b64 v24, v[20:21] offset:3840
  ds_write_b64 v24, v[22:23] offset:4352
  v_lshlrev_b32 v24, 2, v2
  v_add_u32 v24, 155648, v24
  ds_write_b32 v24, v4 offset:2304
  s_waitcnt vmcnt(0)
  v_mov_b32 v6, s71
  s_mov_b64 exec, 1
  ds_add_u32 v6, v5 offset:0
  s_mov_b64 exec, -1
  s_branch .g2_kernel_v
.g2_kernel_s2:
  s_mov_b32 s8, s42
  s_mov_b32 s9, s43
  s_mov_b32 s10, 0x600000
  s_mov_b32 s11, 0x00020000
  v_lshrrev_b32 v20, 3, v2
  v_and_b32 v21, 7, v2
  v_mul_u32_u24 v20, 6144, v20
  v_lshl_add_u32 v20, v21, 4, v20
  s_mul_i32 s30, s17, 393216
  s_lshl_b32 s31, s18, 7
  s_add_u32 s30, s30, s31
  s_add_u32 s31, s30, 4096
  s_barrier
  s_sleep 30
  buffer_load_dwordx4 v[64:67], v20, s[8:11], s30 offen
  buffer_load_dwordx4 v[68:71], v20, s[8:11], s30 offen offset:2048
  buffer_load_dwordx4 v[72:75], v20, s[8:11], s31 offen
  s_add_u32 s30, s30, 49152
  s_add_u32 s31, s31, 49152
  buffer_load_dwordx4 v[76:79], v20, s[8:11], s30 offen
  buffer_load_dwordx4 v[80:83], v20, s[8:11], s30 offen offset:2048
  buffer_load_dwordx4 v[84:87], v20, s[8:11], s31 offen
  s_add_u32 s30, s30, 49152
  s_add_u32 s31, s31, 49152
  buffer_load_dwordx4 v[88:91], v20, s[8:11], s30 offen
  buffer_load_dwordx4 v[92:95], v20, s[8:11], s30 offen offset:2048
  buffer_load_dwordx4 v[96:99], v20, s[8:11], s31 offen
  s_add_u32 s30, s30, 49152
  s_add_u32 s31, s31, 49152
  buffer_load_dwordx4 v[100:103], v20, s[8:11], s30 offen
  buffer_load_dwordx4 v[104:107], v20, s[8:11], s30 offen offset:2048
  buffer_load_dwordx4 v[108:111], v20, s[8:11], s31 offen
  s_add_u32 s30, s30, 49152
  s_add_u32 s31, s31, 49152
  buffer_load_dwordx4 v[112:115], v20, s[8:11], s30 offen
  buffer_load_dwordx4 v[116:119], v20, s[8:11], s30 offen offset:2048
  buffer_load_dwordx4 v[120:123], v20, s[8:11], s31 offen
  s_add_u32 s30, s30, 49152
  s_add_u32 s31, s31, 49152
  buffer_load_dwordx4 v[124:127], v20, s[8:11], s30 offen
  buffer_load_dwordx4 v[128:131], v20, s[8:11], s30 offen offset:2048
  buffer_load_dwordx4 v[132:135], v20, s[8:11], s31 offen
  s_add_u32 s30, s30, 49152
  s_add_u32 s31, s31, 49152
  buffer_load_dwordx4 v[136:139], v20, s[8:11], s30 offen
  buffer_load_dwordx4 v[140:143], v20, s[8:11], s30 offen offset:2048
  buffer_load_dwordx4 v[144:147], v20, s[8:11], s31 offen
  s_add_u32 s30, s30, 49152
  s_add_u32 s31, s31, 49152
  buffer_load_dwordx4 v[148:151], v20, s[8:11], s30 offen
  buffer_load_dwordx4 v[152:155], v20, s[8:11], s30 offen offset:2048
  buffer_load_dwordx4 v[156:159], v20, s[8:11], s31 offen
  s_add_u32 s30, s30, 49152
  s_add_u32 s31, s31, 49152
  v_lshlrev_b32 v21, 5, v21
  v_lshrrev_b32 v22, 5, v2
  v_lshl_add_u32 v21, v22, 4, v21
  v_bfe_u32 v22, v2, 4, 1
  v_lshl_add_u32 v21, v22, 3, v21
  s_lshl_b32 s30, s18, 4
  s_add_u32 s30, s30, s17
  s_mul_i32 s30, s30, 768
  s_add_u32 s30, s30, 0x3080000
  s_waitcnt vmcnt(23)
  v_lshlrev_b32 v160, 16, v64
  v_and_b32 v161, 0xffff0000, v64
  v_lshlrev_b32 v162, 16, v65
  v_and_b32 v163, 0xffff0000, v65
  v_lshlrev_b32 v164, 16, v66
  v_and_b32 v165, 0xffff0000, v66
  v_lshlrev_b32 v166, 16, v67
  v_and_b32 v167, 0xffff0000, v67
  s_waitcnt vmcnt(22)
  v_lshlrev_b32 v168, 16, v68
  v_and_b32 v169, 0xffff0000, v68
  v_lshlrev_b32 v170, 16, v69
  v_and_b32 v171, 0xffff0000, v69
  v_lshlrev_b32 v172, 16, v70
  v_and_b32 v173, 0xffff0000, v70
  v_lshlrev_b32 v174, 16, v71
  v_and_b32 v175, 0xffff0000, v71
  s_waitcnt vmcnt(21)
  v_lshlrev_b32 v176, 16, v72
  v_and_b32 v177, 0xffff0000, v72
  v_lshlrev_b32 v178, 16, v73
  v_and_b32 v179, 0xffff0000, v73
  v_lshlrev_b32 v180, 16, v74
  v_and_b32 v181, 0xffff0000, v74
  v_lshlrev_b32 v182, 16, v75
  v_and_b32 v183, 0xffff0000, v75
  s_waitcnt vmcnt(20)
  v_lshlrev_b32 v184, 16, v76
  v_and_b32 v185, 0xffff0000, v76
  v_lshlrev_b32 v186, 16, v77
  v_and_b32 v187, 0xffff0000, v77
  v_lshlrev_b32 v188, 16, v78
  v_and_b32 v189, 0xffff0000, v78
  v_lshlrev_b32 v190, 16, v79
  v_and_b32 v191, 0xffff0000, v79
  v_add_f32 v160, v160, v184
  v_add_f32 v161, v161, v185
  v_add_f32 v162, v162, v186
  v_add_f32 v163, v163, v187
  v_add_f32 v164, v164, v188
  v_add_f32 v165, v165, v189
  v_add_f32 v166, v166, v190
  v_add_f32 v167, v167, v191
  s_waitcnt vmcnt(19)
  v_lshlrev_b32 v184, 16, v80
  v_and_b32 v185, 0xffff0000, v80
  v_lshlrev_b32 v186, 16, v81
  v_and_b32 v187, 0xffff0000, v81
  v_lshlrev_b32 v188, 16, v82
  v_and_b32 v189, 0xffff0000, v82
  v_lshlrev_b32 v190, 16, v83
  v_and_b32 v191, 0xffff0000, v83
  v_add_f32 v168, v168, v184
  v_add_f32 v169, v169, v185
  v_add_f32 v170, v170, v186
  v_add_f32 v171, v171, v187
  v_add_f32 v172, v172, v188
  v_add_f32 v173, v173, v189
  v_add_f32 v174, v174, v190
  v_add_f32 v175, v175, v191
  s_waitcnt vmcnt(18)
  v_lshlrev_b32 v184, 16, v84
  v_and_b32 v185, 0xffff0000, v84
  v_lshlrev_b32 v186, 16, v85
  v_and_b32 v187, 0xffff0000, v85
  v_lshlrev_b32 v188, 16, v86
  v_and_b32 v189, 0xffff0000, v86
  v_lshlrev_b32 v190, 16, v87
  v_and_b32 v191, 0xffff0000, v87
  v_add_f32 v176, v176, v184
  v_add_f32 v177, v177, v185
  v_add_f32 v178, v178, v186
  v_add_f32 v179, v179, v187
  v_add_f32 v180, v180, v188
  v_add_f32 v181, v181, v189
  v_add_f32 v182, v182, v190
  v_add_f32 v183, v183, v191
  s_waitcnt vmcnt(17)
  v_lshlrev_b32 v184, 16, v88
  v_and_b32 v185, 0xffff0000, v88
  v_lshlrev_b32 v186, 16, v89
  v_and_b32 v187, 0xffff0000, v89
  v_lshlrev_b32 v188, 16, v90
  v_and_b32 v189, 0xffff0000, v90
  v_lshlrev_b32 v190, 16, v91
  v_and_b32 v191, 0xffff0000, v91
  v_add_f32 v160, v160, v184
  v_add_f32 v161, v161, v185
  v_add_f32 v162, v162, v186
  v_add_f32 v163, v163, v187
  v_add_f32 v164, v164, v188
  v_add_f32 v165, v165, v189
  v_add_f32 v166, v166, v190
  v_add_f32 v167, v167, v191
  s_waitcnt vmcnt(16)
  v_lshlrev_b32 v184, 16, v92
  v_and_b32 v185, 0xffff0000, v92
  v_lshlrev_b32 v186, 16, v93
  v_and_b32 v187, 0xffff0000, v93
  v_lshlrev_b32 v188, 16, v94
  v_and_b32 v189, 0xffff0000, v94
  v_lshlrev_b32 v190, 16, v95
  v_and_b32 v191, 0xffff0000, v95
  v_add_f32 v168, v168, v184
  v_add_f32 v169, v169, v185
  v_add_f32 v170, v170, v186
  v_add_f32 v171, v171, v187
  v_add_f32 v172, v172, v188
  v_add_f32 v173, v173, v189
  v_add_f32 v174, v174, v190
  v_add_f32 v175, v175, v191
  s_waitcnt vmcnt(15)
  v_lshlrev_b32 v184, 16, v96
  v_and_b32 v185, 0xffff0000, v96
  v_lshlrev_b32 v186, 16, v97
  v_and_b32 v187, 0xffff0000, v97
  v_lshlrev_b32 v188, 16, v98
  v_and_b32 v189, 0xffff0000, v98
  v_lshlrev_b32 v190, 16, v99
  v_and_b32 v191, 0xffff0000, v99
  v_add_f32 v176, v176, v184
  v_add_f32 v177, v177, v185
  v_add_f32 v178, v178, v186
  v_add_f32 v179, v179, v187
  v_add_f32 v180, v180, v188
  v_add_f32 v181, v181, v189
  v_add_f32 v182, v182, v190
  v_add_f32 v183, v183, v191
  s_waitcnt vmcnt(14)
  v_lshlrev_b32 v184, 16, v100
  v_and_b32 v185, 0xffff0000, v100
  v_lshlrev_b32 v186, 16, v101
  v_and_b32 v187, 0xffff0000, v101
  v_lshlrev_b32 v188, 16, v102
  v_and_b32 v189, 0xffff0000, v102
  v_lshlrev_b32 v190, 16, v103
  v_and_b32 v191, 0xffff0000, v103
  v_add_f32 v160, v160, v184
  v_add_f32 v161, v161, v185
  v_add_f32 v162, v162, v186
  v_add_f32 v163, v163, v187
  v_add_f32 v164, v164, v188
  v_add_f32 v165, v165, v189
  v_add_f32 v166, v166, v190
  v_add_f32 v167, v167, v191
  s_waitcnt vmcnt(13)
  v_lshlrev_b32 v184, 16, v104
  v_and_b32 v185, 0xffff0000, v104
  v_lshlrev_b32 v186, 16, v105
  v_and_b32 v187, 0xffff0000, v105
  v_lshlrev_b32 v188, 16, v106
  v_and_b32 v189, 0xffff0000, v106
  v_lshlrev_b32 v190, 16, v107
  v_and_b32 v191, 0xffff0000, v107
  v_add_f32 v168, v168, v184
  v_add_f32 v169, v169, v185
  v_add_f32 v170, v170, v186
  v_add_f32 v171, v171, v187
  v_add_f32 v172, v172, v188
  v_add_f32 v173, v173, v189
  v_add_f32 v174, v174, v190
  v_add_f32 v175, v175, v191
  s_waitcnt vmcnt(12)
  v_lshlrev_b32 v184, 16, v108
  v_and_b32 v185, 0xffff0000, v108
  v_lshlrev_b32 v186, 16, v109
  v_and_b32 v187, 0xffff0000, v109
  v_lshlrev_b32 v188, 16, v110
  v_and_b32 v189, 0xffff0000, v110
  v_lshlrev_b32 v190, 16, v111
  v_and_b32 v191, 0xffff0000, v111
  v_add_f32 v176, v176, v184
  v_add_f32 v177, v177, v185
  v_add_f32 v178, v178, v186
  v_add_f32 v179, v179, v187
  v_add_f32 v180, v180, v188
  v_add_f32 v181, v181, v189
  v_add_f32 v182, v182, v190
  v_add_f32 v183, v183, v191
  s_waitcnt vmcnt(11)
  v_lshlrev_b32 v184, 16, v112
  v_and_b32 v185, 0xffff0000, v112
  v_lshlrev_b32 v186, 16, v113
  v_and_b32 v187, 0xffff0000, v113
  v_lshlrev_b32 v188, 16, v114
  v_and_b32 v189, 0xffff0000, v114
  v_lshlrev_b32 v190, 16, v115
  v_and_b32 v191, 0xffff0000, v115
  v_add_f32 v160, v160, v184
  v_add_f32 v161, v161, v185
  v_add_f32 v162, v162, v186
  v_add_f32 v163, v163, v187
  v_add_f32 v164, v164, v188
  v_add_f32 v165, v165, v189
  v_add_f32 v166, v166, v190
  v_add_f32 v167, v167, v191
  s_waitcnt vmcnt(10)
  v_lshlrev_b32 v184, 16, v116
  v_and_b32 v185, 0xffff0000, v116
  v_lshlrev_b32 v186, 16, v117
  v_and_b32 v187, 0xffff0000, v117
  v_lshlrev_b32 v188, 16, v118
  v_and_b32 v189, 0xffff0000, v118
  v_lshlrev_b32 v190, 16, v119
  v_and_b32 v191, 0xffff0000, v119
  v_add_f32 v168, v168, v184
  v_add_f32 v169, v169, v185
  v_add_f32 v170, v170, v186
  v_add_f32 v171, v171, v187
  v_add_f32 v172, v172, v188
  v_add_f32 v173, v173, v189
  v_add_f32 v174, v174, v190
  v_add_f32 v175, v175, v191
  s_waitcnt vmcnt(9)
  v_lshlrev_b32 v184, 16, v120
  v_and_b32 v185, 0xffff0000, v120
  v_lshlrev_b32 v186, 16, v121
  v_and_b32 v187, 0xffff0000, v121
  v_lshlrev_b32 v188, 16, v122
  v_and_b32 v189, 0xffff0000, v122
  v_lshlrev_b32 v190, 16, v123
  v_and_b32 v191, 0xffff0000, v123
  v_add_f32 v176, v176, v184
  v_add_f32 v177, v177, v185
  v_add_f32 v178, v178, v186
  v_add_f32 v179, v179, v187
  v_add_f32 v180, v180, v188
  v_add_f32 v181, v181, v189
  v_add_f32 v182, v182, v190
  v_add_f32 v183, v183, v191
  s_waitcnt vmcnt(8)
  v_lshlrev_b32 v184, 16, v124
  v_and_b32 v185, 0xffff0000, v124
  v_lshlrev_b32 v186, 16, v125
  v_and_b32 v187, 0xffff0000, v125
  v_lshlrev_b32 v188, 16, v126
  v_and_b32 v189, 0xffff0000, v126
  v_lshlrev_b32 v190, 16, v127
  v_and_b32 v191, 0xffff0000, v127
  v_add_f32 v160, v160, v184
  v_add_f32 v161, v161, v185
  v_add_f32 v162, v162, v186
  v_add_f32 v163, v163, v187
  v_add_f32 v164, v164, v188
  v_add_f32 v165, v165, v189
  v_add_f32 v166, v166, v190
  v_add_f32 v167, v167, v191
  s_waitcnt vmcnt(7)
  v_lshlrev_b32 v184, 16, v128
  v_and_b32 v185, 0xffff0000, v128
  v_lshlrev_b32 v186, 16, v129
  v_and_b32 v187, 0xffff0000, v129
  v_lshlrev_b32 v188, 16, v130
  v_and_b32 v189, 0xffff0000, v130
  v_lshlrev_b32 v190, 16, v131
  v_and_b32 v191, 0xffff0000, v131
  v_add_f32 v168, v168, v184
  v_add_f32 v169, v169, v185
  v_add_f32 v170, v170, v186
  v_add_f32 v171, v171, v187
  v_add_f32 v172, v172, v188
  v_add_f32 v173, v173, v189
  v_add_f32 v174, v174, v190
  v_add_f32 v175, v175, v191
  s_waitcnt vmcnt(6)
  v_lshlrev_b32 v184, 16, v132
  v_and_b32 v185, 0xffff0000, v132
  v_lshlrev_b32 v186, 16, v133
  v_and_b32 v187, 0xffff0000, v133
  v_lshlrev_b32 v188, 16, v134
  v_and_b32 v189, 0xffff0000, v134
  v_lshlrev_b32 v190, 16, v135
  v_and_b32 v191, 0xffff0000, v135
  v_add_f32 v176, v176, v184
  v_add_f32 v177, v177, v185
  v_add_f32 v178, v178, v186
  v_add_f32 v179, v179, v187
  v_add_f32 v180, v180, v188
  v_add_f32 v181, v181, v189
  v_add_f32 v182, v182, v190
  v_add_f32 v183, v183, v191
  s_waitcnt vmcnt(5)
  v_lshlrev_b32 v184, 16, v136
  v_and_b32 v185, 0xffff0000, v136
  v_lshlrev_b32 v186, 16, v137
  v_and_b32 v187, 0xffff0000, v137
  v_lshlrev_b32 v188, 16, v138
  v_and_b32 v189, 0xffff0000, v138
  v_lshlrev_b32 v190, 16, v139
  v_and_b32 v191, 0xffff0000, v139
  v_add_f32 v160, v160, v184
  v_add_f32 v161, v161, v185
  v_add_f32 v162, v162, v186
  v_add_f32 v163, v163, v187
  v_add_f32 v164, v164, v188
  v_add_f32 v165, v165, v189
  v_add_f32 v166, v166, v190
  v_add_f32 v167, v167, v191
  s_waitcnt vmcnt(4)
  v_lshlrev_b32 v184, 16, v140
  v_and_b32 v185, 0xffff0000, v140
  v_lshlrev_b32 v186, 16, v141
  v_and_b32 v187, 0xffff0000, v141
  v_lshlrev_b32 v188, 16, v142
  v_and_b32 v189, 0xffff0000, v142
  v_lshlrev_b32 v190, 16, v143
  v_and_b32 v191, 0xffff0000, v143
  v_add_f32 v168, v168, v184
  v_add_f32 v169, v169, v185
  v_add_f32 v170, v170, v186
  v_add_f32 v171, v171, v187
  v_add_f32 v172, v172, v188
  v_add_f32 v173, v173, v189
  v_add_f32 v174, v174, v190
  v_add_f32 v175, v175, v191
  s_waitcnt vmcnt(3)
  v_lshlrev_b32 v184, 16, v144
  v_and_b32 v185, 0xffff0000, v144
  v_lshlrev_b32 v186, 16, v145
  v_and_b32 v187, 0xffff0000, v145
  v_lshlrev_b32 v188, 16, v146
  v_and_b32 v189, 0xffff0000, v146
  v_lshlrev_b32 v190, 16, v147
  v_and_b32 v191, 0xffff0000, v147
  v_add_f32 v176, v176, v184
  v_add_f32 v177, v177, v185
  v_add_f32 v178, v178, v186
  v_add_f32 v179, v179, v187
  v_add_f32 v180, v180, v188
  v_add_f32 v181, v181, v189
  v_add_f32 v182, v182, v190
  v_add_f32 v183, v183, v191
  s_waitcnt vmcnt(2)
  v_lshlrev_b32 v184, 16, v148
  v_and_b32 v185, 0xffff0000, v148
  v_lshlrev_b32 v186, 16, v149
  v_and_b32 v187, 0xffff0000, v149
  v_lshlrev_b32 v188, 16, v150
  v_and_b32 v189, 0xffff0000, v150
  v_lshlrev_b32 v190, 16, v151
  v_and_b32 v191, 0xffff0000, v151
  v_add_f32 v160, v160, v184
  v_add_f32 v161, v161, v185
  v_add_f32 v162, v162, v186
  v_add_f32 v163, v163, v187
  v_add_f32 v164, v164, v188
  v_add_f32 v165, v165, v189
  v_add_f32 v166, v166, v190
  v_add_f32 v167, v167, v191
  s_waitcnt vmcnt(1)
  v_lshlrev_b32 v184, 16, v152
  v_and_b32 v185, 0xffff0000, v152
  v_lshlrev_b32 v186, 16, v153
  v_and_b32 v187, 0xffff0000, v153
  v_lshlrev_b32 v188, 16, v154
  v_and_b32 v189, 0xffff0000, v154
  v_lshlrev_b32 v190, 16, v155
  v_and_b32 v191, 0xffff0000, v155
  v_add_f32 v168, v168, v184
  v_add_f32 v169, v169, v185
  v_add_f32 v170, v170, v186
  v_add_f32 v171, v171, v187
  v_add_f32 v172, v172, v188
  v_add_f32 v173, v173, v189
  v_add_f32 v174, v174, v190
  v_add_f32 v175, v175, v191
  s_waitcnt vmcnt(0)
  v_lshlrev_b32 v184, 16, v156
  v_and_b32 v185, 0xffff0000, v156
  v_lshlrev_b32 v186, 16, v157
  v_and_b32 v187, 0xffff0000, v157
  v_lshlrev_b32 v188, 16, v158
  v_and_b32 v189, 0xffff0000, v158
  v_lshlrev_b32 v190, 16, v159
  v_and_b32 v191, 0xffff0000, v159
  v_add_f32 v176, v176, v184
  v_add_f32 v177, v177, v185
  v_add_f32 v178, v178, v186
  v_add_f32 v179, v179, v187
  v_add_f32 v180, v180, v188
  v_add_f32 v181, v181, v189
  v_add_f32 v182, v182, v190
  v_add_f32 v183, v183, v191
  v_permlane32_swap_b32 v160, v164
  v_permlane32_swap_b32 v161, v165
  v_permlane32_swap_b32 v162, v166
  v_permlane32_swap_b32 v163, v167
  v_add_f32 v160, v160, v164
  v_add_f32 v161, v161, v165
  v_add_f32 v162, v162, v166
  v_add_f32 v163, v163, v167
  s_nop 0
  v_permlane16_swap_b32 v160, v162
  v_permlane16_swap_b32 v161, v163
  v_add_f32 v160, v160, v162
  v_add_f32 v161, v161, v163
  s_nop 0
  v_add_f32 v160, v160, v160 row_ror:8 row_mask:0xf bank_mask:0xf
  v_add_f32 v161, v161, v161 row_ror:8 row_mask:0xf bank_mask:0xf
  v_permlane32_swap_b32 v168, v172
  v_permlane32_swap_b32 v169, v173
  v_permlane32_swap_b32 v170, v174
  v_permlane32_swap_b32 v171, v175
  v_add_f32 v168, v168, v172
  v_add_f32 v169, v169, v173
  v_add_f32 v170, v170, v174
  v_add_f32 v171, v171, v175
  s_nop 0
  v_permlane16_swap_b32 v168, v170
  v_permlane16_swap_b32 v169, v171
  v_add_f32 v168, v168, v170
  v_add_f32 v169, v169, v171
  s_nop 0
  v_add_f32 v168, v168, v168 row_ror:8 row_mask:0xf bank_mask:0xf
  v_add_f32 v169, v169, v169 row_ror:8 row_mask:0xf bank_mask:0xf
  v_permlane32_swap_b32 v176, v180
  v_permlane32_swap_b32 v177, v181
  v_permlane32_swap_b32 v178, v182
  v_permlane32_swap_b32 v179, v183
  v_add_f32 v176, v176, v180
  v_add_f32 v177, v177, v181
  v_add_f32 v178, v178, v182
  v_add_f32 v179, v179, v183
  s_nop 0
  v_permlane16_swap_b32 v176, v178
  v_permlane16_swap_b32 v177, v179
  v_add_f32 v176, v176, v178
  v_add_f32 v177, v177, v179
  s_nop 0
  v_add_f32 v176, v176, v176 row_ror:8 row_mask:0xf bank_mask:0xf
  v_add_f32 v177, v177, v177 row_ror:8 row_mask:0xf bank_mask:0xf
  s_mov_b32 exec_lo, 0x00ff00ff
  s_mov_b32 exec_hi, 0x00ff00ff
  buffer_store_dwordx2 v[160:161], v21, s[4:7], s30 offen offset:0 sc1
  buffer_store_dwordx2 v[168:169], v21, s[4:7], s30 offen offset:256 sc1
  buffer_store_dwordx2 v[176:177], v21, s[4:7], s30 offen offset:512 sc1
  s_mov_b64 exec, -1
  s_mov_b32 s12, s58
  s_mov_b32 s13, s59
  s_mov_b32 s14, 0x100
  s_mov_b32 s15, 0x00020000
  s_mov_b32 s38, 0
  s_mov_b64 exec, 1
.g2_kernel_gt10:
  buffer_load_dword v6, v4, s[12:15], 0 offen sc1
  s_add_u32 s38, s38, 1
  s_waitcnt vmcnt(0)
  v_cmp_eq_u32 vcc, 0x60, v6
  s_cbranch_vccnz .g2_kernel_gt10d
  s_sleep 8
  s_cmp_lt_u32 s38, 131072
  s_cbranch_scc1 .g2_kernel_gt10
.g2_kernel_gt10d:
  s_mov_b64 exec, -1
  v_mov_b32 v6, s70
  s_mov_b64 exec, 1
  buffer_store_dword v6, v4, s[4:7], s76 offen offset:4 sc1
  s_mov_b64 exec, -1
  v_mov_b32 v6, 155648
  s_mov_b32 s38, 0
.g2_kernel_wg11:
  ds_read_b32 v7, v6 offset:512
  s_add_u32 s38, s38, 1
  s_waitcnt lgkmcnt(0)
  v_cmp_le_u32 vcc, 27, v7
  s_cbranch_vccnz .g2_kernel_wg11d
  s_sleep 4
  s_cmp_lt_u32 s38, 524288
  s_cbranch_scc1 .g2_kernel_wg11
.g2_kernel_wg11d:
  s_and_b32 s31, s76, 0xffffe000
  s_add_u32 s31, s31, 4
  v_and_b32 v6, 15, v2
  v_lshlrev_b32 v6, 9, v6
  v_lshrrev_b32 v7, 4, v2
  v_lshl_add_u32 v6, v7, 7, v6
  v_lshlrev_b32 v7, 2, v2
  v_add_u32 v7, 157696, v7
  s_mov_b32 m0, 157696
  s_mov_b32 s38, 0
  s_bfm_b64 exec, 16, 0
.g2_kernel_pa12:
  buffer_load_dword v6, s[4:7], s31 offen sc1 lds
  s_add_u32 s38, s38, 1
  s_waitcnt vmcnt(0)
  ds_read_b32 v8, v7
  s_waitcnt lgkmcnt(0)
  v_cmp_ge_u32 vcc, s62, v8
  s_cbranch_vccz .g2_kernel_pa12d
  s_mov_b64 exec, vcc
  s_sleep 16
  s_cmp_lt_u32 s38, 131072
  s_cbranch_scc1 .g2_kernel_pa12
.g2_kernel_pa12d:
  s_mov_b64 exec, -1
  s_mul_i32 s30, s18, 12288
  s_add_u32 s30, s30, 0x3080000
  s_mov_b32 exec_hi, 0xffff
  buffer_load_dwordx4 v[64:67], v3, s[4:7], s30 offen offset:0 sc1
  buffer_load_dwordx4 v[68:71], v3, s[4:7], s30 offen offset:768 sc1
  buffer_load_dwordx4 v[72:75], v3, s[4:7], s30 offen offset:1536 sc1
  buffer_load_dwordx4 v[76:79], v3, s[4:7], s30 offen offset:2304 sc1
  s_add_u32 s30, s30, 3072
  buffer_load_dwordx4 v[80:83], v3, s[4:7], s30 offen offset:0 sc1
  buffer_load_dwordx4 v[84:87], v3, s[4:7], s30 offen offset:768 sc1
  buffer_load_dwordx4 v[88:91], v3, s[4:7], s30 offen offset:1536 sc1
  buffer_load_dwordx4 v[92:95], v3, s[4:7], s30 offen offset:2304 sc1
  s_add_u32 s30, s30, 3072
  buffer_load_dwordx4 v[96:99], v3, s[4:7], s30 offen offset:0 sc1
  buffer_load_dwordx4 v[100:103], v3, s[4:7], s30 offen offset:768 sc1
  buffer_load_dwordx4 v[104:107], v3, s[4:7], s30 offen offset:1536 sc1
  buffer_load_dwordx4 v[108:111], v3, s[4:7], s30 offen offset:2304 sc1
  s_add_u32 s30, s30, 3072
  buffer_load_dwordx4 v[112:115], v3, s[4:7], s30 offen offset:0 sc1
  buffer_load_dwordx4 v[116:119], v3, s[4:7], s30 offen offset:768 sc1
  buffer_load_dwordx4 v[120:123], v3, s[4:7], s30 offen offset:1536 sc1
  buffer_load_dwordx4 v[124:127], v3, s[4:7], s30 offen offset:2304 sc1
  s_add_u32 s30, s30, 3072
  s_waitcnt vmcnt(14)
  v_add_f32 v64, v64, v68
  v_add_f32 v65, v65, v69
  v_add_f32 v66, v66, v70
  v_add_f32 v67, v67, v71
  s_waitcnt vmcnt(13)
  v_add_f32 v64, v64, v72
  v_add_f32 v65, v65, v73
  v_add_f32 v66, v66, v74
  v_add_f32 v67, v67, v75
  s_waitcnt vmcnt(12)
  v_add_f32 v64, v64, v76
  v_add_f32 v65, v65, v77
  v_add_f32 v66, v66, v78
  v_add_f32 v67, v67, v79
  s_waitcnt vmcnt(11)
  v_add_f32 v64, v64, v80
  v_add_f32 v65, v65, v81
  v_add_f32 v66, v66, v82
  v_add_f32 v67, v67, v83
  s_waitcnt vmcnt(10)
  v_add_f32 v64, v64, v84
  v_add_f32 v65, v65, v85
  v_add_f32 v66, v66, v86
  v_add_f32 v67, v67, v87
  s_waitcnt vmcnt(9)
  v_add_f32 v64, v64, v88
  v_add_f32 v65, v65, v89
  v_add_f32 v66, v66, v90
  v_add_f32 v67, v67, v91
  s_waitcnt vmcnt(8)
  v_add_f32 v64, v64, v92
  v_add_f32 v65, v65, v93
  v_add_f32 v66, v66, v94
  v_add_f32 v67, v67, v95
  s_waitcnt vmcnt(7)
  v_add_f32 v64, v64, v96
  v_add_f32 v65, v65, v97
  v_add_f32 v66, v66, v98
  v_add_f32 v67, v67, v99
  s_waitcnt vmcnt(6)
  v_add_f32 v64, v64, v100
  v_add_f32 v65, v65, v101
  v_add_f32 v66, v66, v102
  v_add_f32 v67, v67, v103
  s_waitcnt vmcnt(5)
  v_add_f32 v64, v64, v104
  v_add_f32 v65, v65, v105
  v_add_f32 v66, v66, v106
  v_add_f32 v67, v67, v107
  s_waitcnt vmcnt(4)
  v_add_f32 v64, v64, v108
  v_add_f32 v65, v65, v109
  v_add_f32 v66, v66, v110
  v_add_f32 v67, v67, v111
  s_waitcnt vmcnt(3)
  v_add_f32 v64, v64, v112
  v_add_f32 v65, v65, v113
  v_add_f32 v66, v66, v114
  v_add_f32 v67, v67, v115
  s_waitcnt vmcnt(2)
  v_add_f32 v64, v64, v116
  v_add_f32 v65, v65, v117
  v_add_f32 v66, v66, v118
  v_add_f32 v67, v67, v119
  s_waitcnt vmcnt(1)
  v_add_f32 v64, v64, v120
  v_add_f32 v65, v65, v121
  v_add_f32 v66, v66, v122
  v_add_f32 v67, v67, v123
  s_waitcnt vmcnt(0)
  v_add_f32 v64, v64, v124
  v_add_f32 v65, v65, v125
  v_add_f32 v66, v66, v126
  v_add_f32 v67, v67, v127
  s_mov_b64 exec, -1
  v_mov_b32 v6, 155648
  s_mov_b32 s38, 0
.g2_kernel_wg13:
  ds_read_b32 v7, v6 offset:512
  s_add_u32 s38, s38, 1
  s_waitcnt lgkmcnt(0)
  v_cmp_le_u32 vcc, 32, v7
  s_cbranch_vccnz .g2_kernel_wg13d
  s_sleep 2
  s_cmp_lt_u32 s38, 524288
  s_cbranch_scc1 .g2_kernel_wg13
.g2_kernel_wg13d:
  v_lshlrev_b32 v24, 2, v2
  v_add_u32 v24, 155648, v24
  ds_write_b32 v24, v4 offset:2048
  v_add_u32 v24, 155648, v3
  s_mov_b32 exec_hi, 0xffff
  ds_write_b128 v24, v[64:67] offset:4864
  s_mov_b64 exec, -1
  v_mov_b32 v6, s71
  s_mov_b64 exec, 1
  ds_add_u32 v6, v5 offset:0
  s_mov_b64 exec, -1
  s_branch .g2_kernel_v
.g2_kernel_s3:
  s_mov_b32 s12, s58
  s_mov_b32 s13, s59
  s_mov_b32 s14, 0x100
  s_mov_b32 s15, 0x00020000
  s_mov_b32 s20, s48
  s_mov_b32 s21, s49
  s_mov_b32 s22, 0x800
  s_mov_b32 s23, 0x00020000
  v_mov_b32 v12, 0
  v_mov_b32 v13, 0
  v_mov_b32 v14, 0
  v_mov_b32 v15, 0
  s_cmp_ge_u32 s2, 96
  s_cbranch_scc1 .g2_kernel_zm14
  s_lshl_b32 s36, s2, 12
  s_add_u32 s36, s36, 0x3000000
  buffer_store_dwordx4 v[12:15], v3, s[4:7], s36 offen sc1
  buffer_store_dwordx4 v[12:15], v3, s[4:7], s36 offen offset:1024 sc1
  buffer_store_dwordx4 v[12:15], v3, s[4:7], s36 offen offset:2048 sc1
  buffer_store_dwordx4 v[12:15], v3, s[4:7], s36 offen offset:3072 sc1
.g2_kernel_zm14:
  s_barrier
  s_cbranch_scc1 .g2_kernel_zm14b
  s_mov_b64 exec, 1
  s_waitcnt vmcnt(0)
  buffer_atomic_add v5, v4, s[12:15], 0 offen sc1
  s_mov_b64 exec, -1
.g2_kernel_zm14b:
  v_lshlrev_b32 v20, 5, v2
  buffer_load_dwordx4 v[24:27], v20, s[20:23], 0 offen
  buffer_load_dwordx4 v[28:31], v20, s[20:23], 0 offen offset:16
  v_mov_b32 v20, 0
  s_waitcnt vmcnt(0)
  v_lshlrev_b32 v21, 16, v24
  v_and_b32 v22, 0xffff0000, v24
  v_add_f32 v20, v20, v21
  v_add_f32 v20, v20, v22
  v_lshlrev_b32 v21, 16, v25
  v_and_b32 v22, 0xffff0000, v25
  v_add_f32 v20, v20, v21
  v_add_f32 v20, v20, v22
  v_lshlrev_b32 v21, 16, v26
  v_and_b32 v22, 0xffff0000, v26
  v_add_f32 v20, v20, v21
  v_add_f32 v20, v20, v22
  v_lshlrev_b32 v21, 16, v27
  v_and_b32 v22, 0xffff0000, v27
  v_add_f32 v20, v20, v21
  v_add_f32 v20, v20, v22
  v_lshlrev_b32 v21, 16, v28
  v_and_b32 v22, 0xffff0000, v28
  v_add_f32 v20, v20, v21
  v_add_f32 v20, v20, v22
  v_lshlrev_b32 v21, 16, v29
  v_and_b32 v22, 0xffff0000, v29
  v_add_f32 v20, v20, v21
  v_add_f32 v20, v20, v22
  v_lshlrev_b32 v21, 16, v30
  v_and_b32 v22, 0xffff0000, v30
  v_add_f32 v20, v20, v21
  v_add_f32 v20, v20, v22
  v_lshlrev_b32 v21, 16, v31
  v_and_b32 v22, 0xffff0000, v31
  v_add_f32 v20, v20, v21
  v_add_f32 v20, v20, v22
  s_nop 1
  v_add_f32 v20, v20, v20 quad_perm:[1,0,3,2] row_mask:0xf bank_mask:0xf
  s_nop 1
  v_add_f32 v20, v20, v20 quad_perm:[2,3,0,1] row_mask:0xf bank_mask:0xf
  s_nop 1
  v_add_f32 v20, v20, v20 row_half_mirror row_mask:0xf bank_mask:0xf
  s_nop 1
  v_add_f32 v20, v20, v20 row_mirror row_mask:0xf bank_mask:0xf
  s_nop 0
  v_readlane_b32 s20, v20, 16
  v_readlane_b32 s21, v20, 32
  v_readlane_b32 s22, v20, 48
  v_add_f32 v20, s20, v20
  v_add_f32 v20, s21, v20
  v_add_f32 v20, s22, v20
  v_mul_f32 v20, 0x3a800000, v20
  v_mov_b32 v6, 155648
  s_mov_b32 s38, 0
.g2_kernel_wg15:
  ds_read_b32 v7, v6 offset:512
  s_add_u32 s38, s38, 1
  s_waitcnt lgkmcnt(0)
  v_cmp_le_u32 vcc, 32, v7
  s_cbranch_vccnz .g2_kernel_wg15d
  s_sleep 2
  s_cmp_lt_u32 s38, 524288
  s_cbranch_scc1 .g2_kernel_wg15
.g2_kernel_wg15d:
  v_mov_b32 v21, 155648
  s_mov_b64 exec, 1
  ds_write_b32 v21, v20 offset:256
  s_mov_b64 exec, -1
.g2_kernel_v:
  s_setprio 3
  s_cmp_lg_u32 s16, 4
  s_cbranch_scc1 .g2_kernel_v_1
  v_mov_b32 v6, s71
  s_mov_b32 s38, 0
.g2_kernel_wg16:
  ds_read_b32 v7, v6 offset:4
  s_add_u32 s38, s38, 1
  s_waitcnt lgkmcnt(0)
  v_cmp_le_u32 vcc, 4, v7
  s_cbranch_vccnz .g2_kernel_wg16d
  s_sleep 1
  s_cmp_lt_u32 s38, 524288
  s_cbranch_scc1 .g2_kernel_wg16
.g2_kernel_wg16d:
  s_sleep 2
  s_and_b32 s31, s76, 0xffffe000
  s_add_u32 s31, s31, 0
  v_and_b32 v6, 15, v2
  v_lshlrev_b32 v6, 9, v6
  v_lshrrev_b32 v7, 4, v2
  v_lshl_add_u32 v6, v7, 7, v6
  v_lshlrev_b32 v7, 2, v2
  v_add_u32 v7, 157440, v7
  s_mov_b32 m0, 157440
  s_mov_b32 s38, 0
  s_mov_b32 exec_lo, 0xffff
  s_mov_b32 exec_hi, 0xffff
.g2_kernel_pa17:
  buffer_load_dword v6, s[4:7], s31 offen sc1 lds
  s_add_u32 s38, s38, 1
  s_waitcnt vmcnt(0)
  ds_read_b32 v8, v7
  s_waitcnt lgkmcnt(0)
  v_cmp_ge_u32 vcc, s62, v8
  s_cbranch_vccz .g2_kernel_pa17d
  s_mov_b64 exec, vcc
  s_sleep 2
  s_cmp_lt_u32 s38, 131072
  s_cbranch_scc1 .g2_kernel_pa17
.g2_kernel_pa17d:
  s_mov_b64 exec, -1
  v_mov_b32 v6, s71
  s_mov_b64 exec, 1
  ds_add_u32 v6, v5 offset:80
  s_mov_b64 exec, -1
.g2_kernel_v_1:
  s_cmp_lt_u32 s16, 6
  s_cbranch_scc1 .g2_kernel_v_2
  v_mov_b32 v6, s71
  s_mov_b32 s38, 0
.g2_kernel_wg18:
  ds_read_b32 v7, v6 offset:4
  s_add_u32 s38, s38, 1
  s_waitcnt lgkmcnt(0)
  v_cmp_le_u32 vcc, 4, v7
  s_cbranch_vccnz .g2_kernel_wg18d
  s_sleep 4
  s_cmp_lt_u32 s38, 524288
  s_cbranch_scc1 .g2_kernel_wg18
.g2_kernel_wg18d:
  s_and_b32 s28, s16, 1
  s_lshl_b32 s30, s28, 13
  s_add_u32 s31, s30, 16384
  v_add_u32 v8, s31, v3
  ds_read_b32 v9, v6 offset:24
  ds_read_b128 v[16:19], v8 offset:0
  ds_read_b128 v[20:23], v8 offset:1024
  ds_read_b128 v[24:27], v8 offset:2048
  ds_read_b128 v[28:31], v8 offset:3072
  ds_read_b128 v[32:35], v8 offset:4096
  ds_read_b128 v[36:39], v8 offset:5120
  ds_read_b128 v[40:43], v8 offset:6144
  ds_read_b128 v[44:47], v8 offset:7168
  s_lshl_b32 s31, s18, 5
  s_add_u32 s31, s31, s17
  s_add_u32 s31, s31, 16
  s_lshl_b32 s31, s31, 14
  s_add_u32 s30, s30, s31
  s_add_u32 s30, s30, s63
  s_add_u32 s31, s30, 4096
  s_lshl_b32 s33, s28, 8
  s_add_u32 s33, s33, 128
  s_waitcnt lgkmcnt(0)
  v_readfirstlane_b32 s29, v9
  v_mov_b32 v6, s71
  s_mov_b64 exec, 1
  ds_add_u32 v6, v5 offset:8
  s_mov_b64 exec, -1
  s_sleep 40
  buffer_store_dwordx4 v[16:19], v3, s[4:7], s30 offen offset:0 sc1
  buffer_store_dwordx4 v[20:23], v3, s[4:7], s30 offen offset:1024 sc1
  buffer_store_dwordx4 v[24:27], v3, s[4:7], s30 offen offset:2048 sc1
  buffer_store_dwordx4 v[28:31], v3, s[4:7], s30 offen offset:3072 sc1
  buffer_store_dwordx4 v[32:35], v3, s[4:7], s31 offen offset:0 sc1
  buffer_store_dwordx4 v[36:39], v3, s[4:7], s31 offen offset:1024 sc1
  buffer_store_dwordx4 v[40:43], v3, s[4:7], s31 offen offset:2048 sc1
  buffer_store_dwordx4 v[44:47], v3, s[4:7], s31 offen offset:3072 sc1
  s_sub_u32 s29, s29, 1
  s_lshr_b32 s29, s29, 6
  s_waitcnt vmcnt(0)
  s_cmp_eq_u32 s29, s28
  s_cbranch_scc1 .g2_kernel_v_1h
  s_add_u32 s31, s76, s33
  v_mov_b32 v6, s70
  s_mov_b64 exec, 1
  buffer_store_dword v6, v4, s[4:7], s31 offen offset:0 sc1
  s_mov_b64 exec, -1
  s_branch .g2_kernel_v_2
.g2_kernel_v_1h:
  v_mov_b32 v6, s71
  s_mov_b64 exec, 1
  ds_add_u32 v6, v5 offset:56
  s_mov_b64 exec, -1
.g2_kernel_v_2:
  v_mov_b32 v6, s71
  s_mov_b32 s38, 0
.g2_kernel_wg19:
  ds_read_b32 v7, v6 offset:80
  s_add_u32 s38, s38, 1
  s_waitcnt lgkmcnt(0)
  v_cmp_le_u32 vcc, 1, v7
  s_cbranch_vccnz .g2_kernel_wg19d
  s_sleep 8
  s_cmp_lt_u32 s38, 524288
  s_cbranch_scc1 .g2_kernel_wg19
.g2_kernel_wg19d:
  s_sleep 20
  s_mov_b32 s39, 0
  v_mov_b32 v12, 0
  v_mov_b32 v13, 0
  v_mov_b32 v14, 0
  v_mov_b32 v15, 0
  s_lshl_b32 s30, s17, 2
  s_and_b32 s31, s16, 3
  s_add_u32 s30, s30, s31
  s_lshl_b32 s30, s30, 4
  s_add_u32 s30, s30, s18
  s_lshl_b32 s30, s30, 9
  s_add_u32 s30, s30, s63
  s_add_u32 s30, s30, 0x1000000
  s_mov_b32 exec_hi, 0
  buffer_store_dwordx4 v[12:15], v3, s[4:7], s30 offen sc1
  s_mov_b64 exec, -1
  s_lshl_b32 s30, s17, 2
  s_add_u32 s30, s30, s31
  s_lshl_b32 s30, s30, 5
  s_add_u32 s30, s30, s18
  s_lshl_b32 s30, s30, 11
  s_add_u32 s30, s30, s63
  s_add_u32 s30, s30, 0x808000
  buffer_store_dwordx4 v[12:15], v3, s[4:7], s30 offen sc1
  buffer_store_dwordx4 v[12:15], v3, s[4:7], s30 offen offset:1024 sc1
  s_cmp_lg_u32 s62, 5
  s_cbranch_scc1 .g2_kernel_zs20k
  s_lshl_b32 s30, s18, 4
  s_add_u32 s30, s30, s17
  s_lshl_b32 s30, s30, 2
  s_add_u32 s30, s30, s31
  s_lshl_b32 s30, s30, 12
  s_add_u32 s30, s30, 0x2c00000
  buffer_store_dwordx4 v[12:15], v3, s[4:7], s30 offen sc1
  buffer_store_dwordx4 v[12:15], v3, s[4:7], s30 offen offset:1024 sc1
  buffer_store_dwordx4 v[12:15], v3, s[4:7], s30 offen offset:2048 sc1
  buffer_store_dwordx4 v[12:15], v3, s[4:7], s30 offen offset:3072 sc1
.g2_kernel_zs20k:
  s_lshl_b32 s30, s17, 4
  s_add_u32 s30, s30, s18
  s_cmp_lt_u32 s16, 5
  s_cbranch_scc1 .g2_kernel_zs20
  s_cmp_eq_u32 s16, 5
  s_cbranch_scc1 .g2_kernel_zs20a
  s_cmp_lg_u32 s62, 0
  s_cbranch_scc1 .g2_kernel_zs20
  s_lshl_b32 s30, s30, 1
  s_and_b32 s31, s16, 1
  s_add_u32 s30, s30, s31
  s_lshl_b32 s30, s30, 11
  s_add_u32 s31, s30, 0x1090000
  buffer_store_dwordx4 v[12:15], v3, s[4:7], s31 offen sc1
  buffer_store_dwordx4 v[12:15], v3, s[4:7], s31 offen offset:1024 sc1
  s_add_u32 s31, s30, 0x2890000
  buffer_store_dwordx4 v[12:15], v3, s[4:7], s31 offen sc1
  buffer_store_dwordx4 v[12:15], v3, s[4:7], s31 offen offset:1024 sc1
  s_add_u32 s31, s30, 0x2b00000
  buffer_store_dwordx4 v[12:15], v3, s[4:7], s31 offen sc1
  buffer_store_dwordx4 v[12:15], v3, s[4:7], s31 offen offset:1024 sc1
  s_branch .g2_kernel_zs20
.g2_kernel_zs20a:
  s_lshl_b32 s30, s30, 6
  s_add_u32 s30, s30, s63
  s_add_u32 s30, s30, 0x1080000
  s_mov_b64 exec, 15
  buffer_store_dwordx4 v[12:15], v3, s[4:7], s30 offen sc1
  s_mov_b64 exec, -1
  s_and_b32 s30, s18, 14
  s_lshl_b32 s30, s30, 4
  s_add_u32 s30, s30, s17
  s_lshl_b32 s30, s30, 1
  s_and_b32 s31, s18, 1
  s_add_u32 s30, s30, s31
  s_lshl_b32 s30, s30, 10
  s_add_u32 s30, s30, s63
  s_add_u32 s30, s30, 0x1190000
  s_add_u32 s31, s30, 32768
  buffer_store_dwordx4 v[12:15], v3, s[4:7], s30 offen sc1
  buffer_store_dwordx4 v[12:15], v3, s[4:7], s31 offen sc1
.g2_kernel_zs20:
  s_cmp_eq_u32 s16, 4
  s_cbranch_scc1 .g2_kernel_v_3
  s_cmp_lg_u32 s62, 0
  s_cbranch_scc1 .g2_kernel_g_e
  s_and_b32 s22, s16, 3
  s_lshl_b32 s22, s22, 14
  s_add_u32 s22, s22, 65536
  v_bfe_u32 v8, v2, 2, 2
  v_lshrrev_b32 v9, 4, v2
  v_and_b32 v10, 3, v2
  v_lshlrev_b32 v10, 3, v10
  v_add_u32 v10, s22, v10
  s_cmp_eq_u32 s16, 5
  s_cbranch_scc1 .g2_kernel_g_p
  s_cmp_ge_u32 s17, 14
  s_cbranch_scc1 .g2_kernel_g_e
  v_lshrrev_b32 v6, 1, v2
  v_mul_u32_u24 v6, 7168, v6
  v_and_b32 v7, 1, v2
  v_lshl_add_u32 v250, v7, 4, v6
  v_lshl_add_u32 v11, v9, 3, v8
  v_lshl_add_u32 v251, v11, 5, v10
  v_and_b32 v11, 1, v9
  v_lshl_add_u32 v11, v11, 3, v8
  v_lshl_add_u32 v11, v11, 10, v10
  v_lshrrev_b32 v7, 1, v9
  v_lshl_add_u32 v252, v7, 7, v11
  s_lshl_b32 s24, s17, 4
  s_add_u32 s24, s24, s18
  s_and_b32 s25, s16, 1
  s_mov_b32 s12, s50
  s_mov_b32 s13, s51
  s_mov_b32 s14, 0x700000
  s_mov_b32 s15, 0x00020000
  s_mul_i32 s20, s25, 3670016
  s_lshl_b32 s31, s24, 5
  s_add_u32 s20, s20, s31
  s_lshl_b32 s31, s18, 2
  s_mov_b32 s23, s31
  s_mov_b32 s21, 16
.g2_kernel_gl21:
  s_call_b64 s[26:27], .g2_kernel_v_may
  s_and_b32 s23, s23, 15
  s_lshl_b32 s30, s23, 10
  s_add_u32 s30, s30, 0
  s_add_u32 m0, s30, s22
  s_mul_i32 s30, s23, 229376
  s_add_u32 s30, s30, s20
  buffer_load_dwordx4 v250, s[12:15], s30 offen lds
  s_add_u32 s23, s23, 1
  s_sub_u32 s21, s21, 1
  s_sleep 2
  s_waitcnt vmcnt(4)
  s_cmp_lg_u32 s21, 0
  s_cbranch_scc1 .g2_kernel_gl21
  s_waitcnt vmcnt(0)
  ds_read_b64_tr_b16 v[64:65], v251 offset:0
  ds_read_b64_tr_b16 v[66:67], v251 offset:128
  ds_read_b64_tr_b16 v[68:69], v251 offset:1024
  ds_read_b64_tr_b16 v[70:71], v251 offset:1152
  ds_read_b64_tr_b16 v[72:73], v251 offset:2048
  ds_read_b64_tr_b16 v[74:75], v251 offset:2176
  ds_read_b64_tr_b16 v[76:77], v251 offset:3072
  ds_read_b64_tr_b16 v[78:79], v251 offset:3200
  ds_read_b64_tr_b16 v[80:81], v251 offset:4096
  ds_read_b64_tr_b16 v[82:83], v251 offset:4224
  ds_read_b64_tr_b16 v[84:85], v251 offset:5120
  ds_read_b64_tr_b16 v[86:87], v251 offset:5248
  ds_read_b64_tr_b16 v[88:89], v251 offset:6144
  ds_read_b64_tr_b16 v[90:91], v251 offset:6272
  ds_read_b64_tr_b16 v[92:93], v251 offset:7168
  ds_read_b64_tr_b16 v[94:95], v251 offset:7296
  ds_read_b64_tr_b16 v[96:97], v251 offset:8192
  ds_read_b64_tr_b16 v[98:99], v251 offset:8320
  ds_read_b64_tr_b16 v[100:101], v251 offset:9216
  ds_read_b64_tr_b16 v[102:103], v251 offset:9344
  ds_read_b64_tr_b16 v[104:105], v251 offset:10240
  ds_read_b64_tr_b16 v[106:107], v251 offset:10368
  ds_read_b64_tr_b16 v[108:109], v251 offset:11264
  ds_read_b64_tr_b16 v[110:111], v251 offset:11392
  ds_read_b64_tr_b16 v[112:113], v251 offset:12288
  ds_read_b64_tr_b16 v[114:115], v251 offset:12416
  ds_read_b64_tr_b16 v[116:117], v251 offset:13312
  ds_read_b64_tr_b16 v[118:119], v251 offset:13440
  ds_read_b64_tr_b16 v[120:121], v251 offset:14336
  ds_read_b64_tr_b16 v[122:123], v251 offset:14464
  ds_read_b64_tr_b16 v[124:125], v251 offset:15360
  ds_read_b64_tr_b16 v[126:127], v251 offset:15488
  s_waitcnt lgkmcnt(0)
  s_mov_b32 s12, s52
  s_mov_b32 s13, s53
  s_mov_b32 s14, 0x700000
  s_mov_b32 s15, 0x00020000
  s_mul_i32 s20, s25, 3670016
  s_lshl_b32 s31, s24, 5
  s_add_u32 s20, s20, s31
  s_lshl_b32 s31, s18, 2
  s_mov_b32 s23, s31
  s_mov_b32 s21, 16
.g2_kernel_gl22:
  s_call_b64 s[26:27], .g2_kernel_v_may
  s_and_b32 s23, s23, 15
  s_lshl_b32 s30, s23, 10
  s_add_u32 s30, s30, 0
  s_add_u32 m0, s30, s22
  s_mul_i32 s30, s23, 229376
  s_add_u32 s30, s30, s20
  buffer_load_dwordx4 v250, s[12:15], s30 offen lds
  s_add_u32 s23, s23, 1
  s_sub_u32 s21, s21, 1
  s_sleep 2
  s_waitcnt vmcnt(4)
  s_cmp_lg_u32 s21, 0
  s_cbranch_scc1 .g2_kernel_gl22
  s_waitcnt vmcnt(0)
  ds_read_b64_tr_b16 v[128:129], v251 offset:0
  ds_read_b64_tr_b16 v[130:131], v251 offset:128
  ds_read_b64_tr_b16 v[132:133], v251 offset:1024
  ds_read_b64_tr_b16 v[134:135], v251 offset:1152
  ds_read_b64_tr_b16 v[136:137], v251 offset:2048
  ds_read_b64_tr_b16 v[138:139], v251 offset:2176
  ds_read_b64_tr_b16 v[140:141], v251 offset:3072
  ds_read_b64_tr_b16 v[142:143], v251 offset:3200
  ds_read_b64_tr_b16 v[144:145], v251 offset:4096
  ds_read_b64_tr_b16 v[146:147], v251 offset:4224
  ds_read_b64_tr_b16 v[148:149], v251 offset:5120
  ds_read_b64_tr_b16 v[150:151], v251 offset:5248
  ds_read_b64_tr_b16 v[152:153], v251 offset:6144
  ds_read_b64_tr_b16 v[154:155], v251 offset:6272
  ds_read_b64_tr_b16 v[156:157], v251 offset:7168
  ds_read_b64_tr_b16 v[158:159], v251 offset:7296
  ds_read_b64_tr_b16 v[160:161], v251 offset:8192
  ds_read_b64_tr_b16 v[162:163], v251 offset:8320
  ds_read_b64_tr_b16 v[164:165], v251 offset:9216
  ds_read_b64_tr_b16 v[166:167], v251 offset:9344
  ds_read_b64_tr_b16 v[168:169], v251 offset:10240
  ds_read_b64_tr_b16 v[170:171], v251 offset:10368
  ds_read_b64_tr_b16 v[172:173], v251 offset:11264
  ds_read_b64_tr_b16 v[174:175], v251 offset:11392
  ds_read_b64_tr_b16 v[176:177], v251 offset:12288
  ds_read_b64_tr_b16 v[178:179], v251 offset:12416
  ds_read_b64_tr_b16 v[180:181], v251 offset:13312
  ds_read_b64_tr_b16 v[182:183], v251 offset:13440
  ds_read_b64_tr_b16 v[184:185], v251 offset:14336
  ds_read_b64_tr_b16 v[186:187], v251 offset:14464
  ds_read_b64_tr_b16 v[188:189], v251 offset:15360
  ds_read_b64_tr_b16 v[190:191], v251 offset:15488
  s_waitcnt lgkmcnt(0)
  s_mov_b32 s12, s54
  s_mov_b32 s13, s55
  s_mov_b32 s14, 0x700000
  s_mov_b32 s15, 0x00020000
  s_lshl_b32 s20, s24, 15
  s_lshl_b32 s31, s25, 10
  s_add_u32 s20, s20, s31
  s_mov_b32 s23, 0
  s_mov_b32 s21, 16
.g2_kernel_gl23:
  s_call_b64 s[26:27], .g2_kernel_v_may
  s_and_b32 s23, s23, 15
  s_lshl_b32 s30, s23, 10
  s_add_u32 s30, s30, 0
  s_add_u32 m0, s30, s22
  s_mul_i32 s30, s23, 2048
  s_add_u32 s30, s30, s20
  buffer_load_dwordx4 v3, s[12:15], s30 offen lds
  s_add_u32 s23, s23, 1
  s_sub_u32 s21, s21, 1
  s_sleep 1
  s_waitcnt vmcnt(4)
  s_cmp_lg_u32 s21, 0
  s_cbranch_scc1 .g2_kernel_gl23
  v_mov_b32 v11, v252
  s_waitcnt vmcnt(0)
  ds_read_b64_tr_b16 v[192:193], v11 offset:0
  ds_read_b64_tr_b16 v[194:195], v11 offset:4096
  ds_read_b64_tr_b16 v[196:197], v11 offset:32
  ds_read_b64_tr_b16 v[198:199], v11 offset:4128
  ds_read_b64_tr_b16 v[200:201], v11 offset:64
  ds_read_b64_tr_b16 v[202:203], v11 offset:4160
  ds_read_b64_tr_b16 v[204:205], v11 offset:96
  ds_read_b64_tr_b16 v[206:207], v11 offset:4192
  ds_read_b64_tr_b16 v[208:209], v11 offset:256
  ds_read_b64_tr_b16 v[210:211], v11 offset:4352
  ds_read_b64_tr_b16 v[212:213], v11 offset:288
  ds_read_b64_tr_b16 v[214:215], v11 offset:4384
  ds_read_b64_tr_b16 v[216:217], v11 offset:320
  ds_read_b64_tr_b16 v[218:219], v11 offset:4416
  ds_read_b64_tr_b16 v[220:221], v11 offset:352
  ds_read_b64_tr_b16 v[222:223], v11 offset:4448
  ds_read_b64_tr_b16 v[224:225], v11 offset:512
  ds_read_b64_tr_b16 v[226:227], v11 offset:4608
  ds_read_b64_tr_b16 v[228:229], v11 offset:544
  ds_read_b64_tr_b16 v[230:231], v11 offset:4640
  ds_read_b64_tr_b16 v[232:233], v11 offset:576
  ds_read_b64_tr_b16 v[234:235], v11 offset:4672
  ds_read_b64_tr_b16 v[236:237], v11 offset:608
  ds_read_b64_tr_b16 v[238:239], v11 offset:4704
  ds_read_b64_tr_b16 v[240:241], v11 offset:768
  ds_read_b64_tr_b16 v[242:243], v11 offset:4864
  ds_read_b64_tr_b16 v[244:245], v11 offset:800
  ds_read_b64_tr_b16 v[246:247], v11 offset:4896
  ds_read_b64_tr_b16 v[248:249], v11 offset:832
  ds_read_b64_tr_b16 v[250:251], v11 offset:4928
  ds_read_b64_tr_b16 v[252:253], v11 offset:864
  ds_read_b64_tr_b16 v[254:255], v11 offset:4960
  s_waitcnt lgkmcnt(0)
  s_branch .g2_kernel_g_e
.g2_kernel_g_p:
  s_mov_b32 s12, s42
  s_mov_b32 s13, s43
  s_mov_b32 s14, 0x600000
  s_mov_b32 s15, 0x00020000
  v_mul_u32_u24 v6, 6144, v9
  v_and_b32 v7, 15, v2
  v_lshl_add_u32 v250, v7, 4, v6
  v_lshl_add_u32 v11, v8, 2, v9
  v_lshl_add_u32 v251, v11, 9, v10
  s_lshl_b32 s20, s17, 3
  s_and_b32 s31, s18, 1
  s_add_u32 s20, s20, s31
  s_mul_i32 s20, s20, 49152
  s_and_b32 s31, s18, 14
  s_lshl_b32 s31, s31, 7
  s_add_u32 s20, s20, s31
  s_mov_b32 s23, 0
  s_mov_b32 s21, 8
.g2_kernel_gl24:
  s_call_b64 s[26:27], .g2_kernel_v_may
  s_and_b32 s23, s23, 7
  s_lshl_b32 s30, s23, 10
  s_add_u32 s30, s30, 0
  s_add_u32 m0, s30, s22
  s_mul_i32 s30, s23, 49152
  s_add_u32 s30, s30, s20
  s_and_b32 s31, s23, 1
  s_mul_i32 s31, s31, -24576
  s_add_u32 s30, s30, s31
  buffer_load_dwordx4 v250, s[12:15], s30 offen lds
  s_add_u32 s23, s23, 1
  s_sub_u32 s21, s21, 1
  s_sleep 2
  s_waitcnt vmcnt(4)
  s_cmp_lg_u32 s21, 0
  s_cbranch_scc1 .g2_kernel_gl24
  s_add_u32 s20, s20, 2048
  s_mov_b32 s23, 0
  s_mov_b32 s21, 8
.g2_kernel_gl25:
  s_call_b64 s[26:27], .g2_kernel_v_may
  s_and_b32 s23, s23, 7
  s_lshl_b32 s30, s23, 10
  s_add_u32 s30, s30, 8192
  s_add_u32 m0, s30, s22
  s_mul_i32 s30, s23, 49152
  s_add_u32 s30, s30, s20
  s_and_b32 s31, s23, 1
  s_mul_i32 s31, s31, -24576
  s_add_u32 s30, s30, s31
  buffer_load_dwordx4 v250, s[12:15], s30 offen lds
  s_add_u32 s23, s23, 1
  s_sub_u32 s21, s21, 1
  s_sleep 2
  s_waitcnt vmcnt(4)
  s_cmp_lg_u32 s21, 0
  s_cbranch_scc1 .g2_kernel_gl25
  s_add_u32 s20, s20, 2048
  s_waitcnt vmcnt(0)
  ds_read_b64_tr_b16 v[64:65], v251 offset:0
  ds_read_b64_tr_b16 v[66:67], v251 offset:256
  ds_read_b64_tr_b16 v[68:69], v251 offset:32
  ds_read_b64_tr_b16 v[70:71], v251 offset:288
  ds_read_b64_tr_b16 v[72:73], v251 offset:64
  ds_read_b64_tr_b16 v[74:75], v251 offset:320
  ds_read_b64_tr_b16 v[76:77], v251 offset:96
  ds_read_b64_tr_b16 v[78:79], v251 offset:352
  ds_read_b64_tr_b16 v[80:81], v251 offset:128
  ds_read_b64_tr_b16 v[82:83], v251 offset:384
  ds_read_b64_tr_b16 v[84:85], v251 offset:160
  ds_read_b64_tr_b16 v[86:87], v251 offset:416
  ds_read_b64_tr_b16 v[88:89], v251 offset:192
  ds_read_b64_tr_b16 v[90:91], v251 offset:448
  ds_read_b64_tr_b16 v[92:93], v251 offset:224
  ds_read_b64_tr_b16 v[94:95], v251 offset:480
  ds_read_b64_tr_b16 v[96:97], v251 offset:8192
  ds_read_b64_tr_b16 v[98:99], v251 offset:8448
  ds_read_b64_tr_b16 v[100:101], v251 offset:8224
  ds_read_b64_tr_b16 v[102:103], v251 offset:8480
  ds_read_b64_tr_b16 v[104:105], v251 offset:8256
  ds_read_b64_tr_b16 v[106:107], v251 offset:8512
  ds_read_b64_tr_b16 v[108:109], v251 offset:8288
  ds_read_b64_tr_b16 v[110:111], v251 offset:8544
  ds_read_b64_tr_b16 v[112:113], v251 offset:8320
  ds_read_b64_tr_b16 v[114:115], v251 offset:8576
  ds_read_b64_tr_b16 v[116:117], v251 offset:8352
  ds_read_b64_tr_b16 v[118:119], v251 offset:8608
  ds_read_b64_tr_b16 v[120:121], v251 offset:8384
  ds_read_b64_tr_b16 v[122:123], v251 offset:8640
  ds_read_b64_tr_b16 v[124:125], v251 offset:8416
  ds_read_b64_tr_b16 v[126:127], v251 offset:8672
  s_waitcnt lgkmcnt(0)
  s_mov_b32 s23, 0
  s_mov_b32 s21, 8
.g2_kernel_gl26:
  s_call_b64 s[26:27], .g2_kernel_v_may
  s_and_b32 s23, s23, 7
  s_lshl_b32 s30, s23, 10
  s_add_u32 s30, s30, 0
  s_add_u32 m0, s30, s22
  s_mul_i32 s30, s23, 49152
  s_add_u32 s30, s30, s20
  s_and_b32 s31, s23, 1
  s_mul_i32 s31, s31, -24576
  s_add_u32 s30, s30, s31
  buffer_load_dwordx4 v250, s[12:15], s30 offen lds
  s_add_u32 s23, s23, 1
  s_sub_u32 s21, s21, 1
  s_sleep 2
  s_waitcnt vmcnt(4)
  s_cmp_lg_u32 s21, 0
  s_cbranch_scc1 .g2_kernel_gl26
  s_add_u32 s20, s20, 2048
  s_waitcnt vmcnt(0)
  ds_read_b64_tr_b16 v[128:129], v251 offset:0
  ds_read_b64_tr_b16 v[130:131], v251 offset:256
  ds_read_b64_tr_b16 v[132:133], v251 offset:32
  ds_read_b64_tr_b16 v[134:135], v251 offset:288
  ds_read_b64_tr_b16 v[136:137], v251 offset:64
  ds_read_b64_tr_b16 v[138:139], v251 offset:320
  ds_read_b64_tr_b16 v[140:141], v251 offset:96
  ds_read_b64_tr_b16 v[142:143], v251 offset:352
  ds_read_b64_tr_b16 v[144:145], v251 offset:128
  ds_read_b64_tr_b16 v[146:147], v251 offset:384
  ds_read_b64_tr_b16 v[148:149], v251 offset:160
  ds_read_b64_tr_b16 v[150:151], v251 offset:416
  ds_read_b64_tr_b16 v[152:153], v251 offset:192
  ds_read_b64_tr_b16 v[154:155], v251 offset:448
  ds_read_b64_tr_b16 v[156:157], v251 offset:224
  ds_read_b64_tr_b16 v[158:159], v251 offset:480
  s_waitcnt lgkmcnt(0)
.g2_kernel_g_e:
.g2_kernel_v_3:
  s_mov_b32 s29, 0
  s_and_b32 s30, s16, 3
  s_lshl_b32 s30, s30, 14
  s_add_u32 s30, s30, 65536
  s_call_b64 s[68:69], .g2_kernel_v_wo
  s_waitcnt vmcnt(0)
  v_mov_b32 v6, s71
  s_mov_b64 exec, 1
  ds_add_u32 v6, v5 offset:52
  s_mov_b64 exec, -1
  s_cmp_lg_u32 s16, 4
  s_cbranch_scc1 .g2_kernel_v_3a
  s_and_b32 s31, s76, 0xffffe000
  s_add_u32 s31, s31, 0
  v_and_b32 v6, 15, v2
  v_lshlrev_b32 v6, 9, v6
  v_lshrrev_b32 v7, 4, v2
  v_lshl_add_u32 v6, v7, 7, v6
  v_lshlrev_b32 v7, 2, v2
  v_add_u32 v7, 157440, v7
  s_mov_b32 m0, 157440
  s_mov_b32 s38, 0
  s_mov_b32 exec_lo, 0xffff0000
  s_mov_b32 exec_hi, 0xffff0000
.g2_kernel_pa27:
  buffer_load_dword v6, s[4:7], s31 offen sc1 lds
  s_add_u32 s38, s38, 1
  s_waitcnt vmcnt(0)
  ds_read_b32 v8, v7
  s_waitcnt lgkmcnt(0)
  v_cmp_ge_u32 vcc, s62, v8
  s_cbranch_vccz .g2_kernel_pa27d
  s_mov_b64 exec, vcc
  s_sleep 16
  s_cmp_lt_u32 s38, 131072
  s_cbranch_scc1 .g2_kernel_pa27
.g2_kernel_pa27d:
  s_mov_b64 exec, -1
.g2_kernel_v_3a:
  s_cmp_lg_u32 s39, 0
  s_cbranch_scc1 .g2_kernel_v_3b
  s_call_b64 s[26:27], .g2_kernel_v_do
.g2_kernel_v_3b:
  s_cmp_lg_u32 s16, 4
  s_cbranch_scc1 .g2_kernel_v_4
  v_mov_b32 v6, s71
  s_mov_b32 s38, 0
.g2_kernel_wg28:
  ds_read_b32 v7, v6 offset:8
  s_add_u32 s38, s38, 1
  s_waitcnt lgkmcnt(0)
  v_cmp_le_u32 vcc, 10, v7
  s_cbranch_vccnz .g2_kernel_wg28d
  s_sleep 8
  s_cmp_lt_u32 s38, 524288
  s_cbranch_scc1 .g2_kernel_wg28
.g2_kernel_wg28d:
  s_mov_b32 s29, 1
  s_mov_b32 s30, 139264
  s_call_b64 s[68:69], .g2_kernel_v_wo
  s_add_u32 s31, s31, 81920
  s_sleep 6
  s_waitcnt vmcnt(4)
  buffer_load_dwordx4 v[64:67], v6, s[8:11], s31 offen
  s_add_u32 s31, s31, 16384
  buffer_load_dwordx4 v[68:71], v6, s[8:11], s31 offen
  s_add_u32 s31, s31, 16384
  buffer_load_dwordx4 v[72:75], v6, s[8:11], s31 offen
  s_add_u32 s31, s31, 16384
  buffer_load_dwordx4 v[76:79], v6, s[8:11], s31 offen
  s_add_u32 s31, s31, 81920
  s_sleep 6
  s_waitcnt vmcnt(4)
  buffer_load_dwordx4 v[80:83], v6, s[8:11], s31 offen
  s_add_u32 s31, s31, 16384
  buffer_load_dwordx4 v[84:87], v6, s[8:11], s31 offen
  s_add_u32 s31, s31, 16384
  buffer_load_dwordx4 v[88:91], v6, s[8:11], s31 offen
  s_add_u32 s31, s31, 16384
  buffer_load_dwordx4 v[92:95], v6, s[8:11], s31 offen
  s_add_u32 s31, s31, 81920
  s_sleep 6
  s_waitcnt vmcnt(4)
  buffer_load_dwordx4 v[96:99], v6, s[8:11], s31 offen
  s_add_u32 s31, s31, 16384
  buffer_load_dwordx4 v[100:103], v6, s[8:11], s31 offen
  s_add_u32 s31, s31, 16384
  buffer_load_dwordx4 v[104:107], v6, s[8:11], s31 offen
  s_add_u32 s31, s31, 16384
  buffer_load_dwordx4 v[108:111], v6, s[8:11], s31 offen
  s_add_u32 s31, s31, 81920
  s_sleep 6
  s_waitcnt vmcnt(4)
  buffer_load_dwordx4 v[112:115], v6, s[8:11], s31 offen
  s_add_u32 s31, s31, 16384
  buffer_load_dwordx4 v[116:119], v6, s[8:11], s31 offen
  s_add_u32 s31, s31, 16384
  buffer_load_dwordx4 v[120:123], v6, s[8:11], s31 offen
  s_add_u32 s31, s31, 16384
  buffer_load_dwordx4 v[124:127], v6, s[8:11], s31 offen
  s_add_u32 s31, s31, 81920
  s_sleep 6
  s_waitcnt vmcnt(4)
  buffer_load_dwordx4 v[128:131], v6, s[8:11], s31 offen
  s_add_u32 s31, s31, 16384
  buffer_load_dwordx4 v[132:135], v6, s[8:11], s31 offen
  s_add_u32 s31, s31, 16384
  buffer_load_dwordx4 v[136:139], v6, s[8:11], s31 offen
  s_add_u32 s31, s31, 16384
  buffer_load_dwordx4 v[140:143], v6, s[8:11], s31 offen
  s_add_u32 s31, s31, 81920
  s_sleep 6
  s_waitcnt vmcnt(4)
  buffer_load_dwordx4 v[144:147], v6, s[8:11], s31 offen
  s_add_u32 s31, s31, 16384
  buffer_load_dwordx4 v[148:151], v6, s[8:11], s31 offen
  s_add_u32 s31, s31, 16384
  buffer_load_dwordx4 v[152:155], v6, s[8:11], s31 offen
  s_add_u32 s31, s31, 16384
  buffer_load_dwordx4 v[156:159], v6, s[8:11], s31 offen
  s_add_u32 s31, s31, 81920
  s_sleep 6
  s_waitcnt vmcnt(4)
  buffer_load_dwordx4 v[160:163], v6, s[8:11], s31 offen
  s_add_u32 s31, s31, 16384
  buffer_load_dwordx4 v[164:167], v6, s[8:11], s31 offen
  s_add_u32 s31, s31, 16384
  buffer_load_dwordx4 v[168:171], v6, s[8:11], s31 offen
  s_add_u32 s31, s31, 16384
  buffer_load_dwordx4 v[172:175], v6, s[8:11], s31 offen
  s_add_u32 s31, s31, 81920
  s_sleep 6
  s_waitcnt vmcnt(4)
  buffer_load_dwordx4 v[176:179], v6, s[8:11], s31 offen
  s_add_u32 s31, s31, 16384
  buffer_load_dwordx4 v[180:183], v6, s[8:11], s31 offen
  s_add_u32 s31, s31, 16384
  buffer_load_dwordx4 v[184:187], v6, s[8:11], s31 offen
  s_add_u32 s31, s31, 16384
  buffer_load_dwordx4 v[188:191], v6, s[8:11], s31 offen
  s_add_u32 s31, s31, 81920
  s_sleep 6
  s_waitcnt vmcnt(4)
  buffer_load_dwordx4 v[192:195], v6, s[8:11], s31 offen
  s_add_u32 s31, s31, 16384
  buffer_load_dwordx4 v[196:199], v6, s[8:11], s31 offen
  s_add_u32 s31, s31, 16384
  buffer_load_dwordx4 v[200:203], v6, s[8:11], s31 offen
  s_add_u32 s31, s31, 16384
  buffer_load_dwordx4 v[204:207], v6, s[8:11], s31 offen
  s_add_u32 s31, s31, 81920
  s_sleep 6
  s_waitcnt vmcnt(4)
  buffer_load_dwordx4 v[208:211], v6, s[8:11], s31 offen
  s_add_u32 s31, s31, 16384
  buffer_load_dwordx4 v[212:215], v6, s[8:11], s31 offen
  s_add_u32 s31, s31, 16384
  buffer_load_dwordx4 v[216:219], v6, s[8:11], s31 offen
  s_add_u32 s31, s31, 16384
  buffer_load_dwordx4 v[220:223], v6, s[8:11], s31 offen
  s_add_u32 s31, s31, 81920
  s_sleep 6
  s_waitcnt vmcnt(4)
  buffer_load_dwordx4 v[224:227], v6, s[8:11], s31 offen
  s_add_u32 s31, s31, 16384
  buffer_load_dwordx4 v[228:231], v6, s[8:11], s31 offen
  s_add_u32 s31, s31, 16384
  buffer_load_dwordx4 v[232:235], v6, s[8:11], s31 offen
  s_add_u32 s31, s31, 16384
  buffer_load_dwordx4 v[236:239], v6, s[8:11], s31 offen
  s_add_u32 s31, s31, 81920
  s_sleep 6
  s_waitcnt vmcnt(4)
  buffer_load_dwordx4 v[240:243], v6, s[8:11], s31 offen
  s_add_u32 s31, s31, 16384
  buffer_load_dwordx4 v[244:247], v6, s[8:11], s31 offen
  s_add_u32 s31, s31, 16384
  buffer_load_dwordx4 v[248:251], v6, s[8:11], s31 offen
  s_add_u32 s31, s31, 16384
  buffer_load_dwordx4 v[252:255], v6, s[8:11], s31 offen
.g2_kernel_v_4:
  s_cmp_lg_u32 s16, 5
  s_cbranch_scc1 .g2_kernel_v_5
  s_sleep 64
  s_and_b32 s31, s19, 0xffffe000
  s_add_u32 s31, s31, 0
  v_and_b32 v6, 15, v2
  v_lshlrev_b32 v6, 9, v6
  v_lshrrev_b32 v7, 4, v2
  v_lshl_add_u32 v6, v7, 7, v6
  v_lshlrev_b32 v7, 2, v2
  v_add_u32 v7, 157696, v7
  s_mov_b32 m0, 157696
  s_mov_b32 s38, 0
.g2_kernel_pa29:
  buffer_load_dword v6, s[4:7], s31 offen sc1 lds
  s_add_u32 s38, s38, 1
  s_waitcnt vmcnt(0)
  ds_read_b32 v8, v7
  s_waitcnt lgkmcnt(0)
  v_cmp_ge_u32 vcc, s62, v8
  s_cbranch_vccz .g2_kernel_pa29d
  s_mov_b64 exec, vcc
  s_sleep 32
  s_cmp_lt_u32 s38, 131072
  s_cbranch_scc1 .g2_kernel_pa29
.g2_kernel_pa29d:
  s_mov_b64 exec, -1
  v_lshlrev_b32 v6, 7, v2
  s_lshl_b32 s30, s17, 2
  s_and_b32 s31, s18, 3
  s_add_u32 s30, s30, s31
  s_lshl_b32 s30, s30, 16
  s_add_u32 s30, s30, s63
  s_add_u32 s30, s30, 0x800000
  s_sleep 8
  buffer_load_dword v1, v6, s[4:7], s30 offen
  s_add_u32 s30, s30, 8192
  s_sleep 8
  buffer_load_dword v1, v6, s[4:7], s30 offen
  s_add_u32 s30, s30, 8192
  s_sleep 8
  buffer_load_dword v1, v6, s[4:7], s30 offen
  s_add_u32 s30, s30, 8192
  s_sleep 8
  buffer_load_dword v1, v6, s[4:7], s30 offen
  s_add_u32 s30, s30, 8192
  s_and_b32 s31, s19, 0xffffe000
  s_add_u32 s31, s31, 4
  v_and_b32 v7, 15, v2
  v_lshlrev_b32 v7, 9, v7
  v_lshrrev_b32 v9, 4, v2
  v_lshl_add_u32 v7, v9, 7, v7
  s_and_b32 s33, s18, 3
  s_lshl_b32 s33, s33, 6
  s_add_u32 s33, s33, 157952
  v_lshl_add_u32 v9, v9, 2, s33
  v_lshlrev_b32 v10, 2, v2
  v_add_u32 v10, 157952, v10
  v_mov_b32 v11, 155968
  s_lshl_b32 s33, s62, 1
  s_add_u32 s33, s33, 1
  s_mov_b32 m0, 157952
  s_mov_b64 s[8:9], -1
  s_mov_b64 s[10:11], -1
  s_mov_b64 s[12:13], -1
  s_mov_b64 s[14:15], -1
  s_mov_b64 s[20:21], -1
  s_add_u32 s34, s30, 8192
  s_add_u32 s35, s30, 16384
  s_add_u32 s36, s30, 24576
  s_mov_b32 s38, 0
  s_sleep 8
.g2_kernel_bp30:
  s_mov_b64 exec, s[20:21]
  buffer_load_dword v7, s[4:7], s31 offen sc1 lds
  s_mov_b64 exec, -1
  s_add_u32 s38, s38, 1
  s_waitcnt vmcnt(0)
  ds_read_b32 v12, v10
  ds_read_b32 v13, v9
  ds_read_b32 v14, v9 offset:16
  ds_read_b32 v15, v9 offset:32
  ds_read_b32 v16, v9 offset:48
  s_waitcnt lgkmcnt(0)
  v_cmp_ge_u32 s[20:21], s62, v12
  v_cmp_lt_u32 vcc, s62, v13
  s_and_b64 exec, vcc, s[8:9]
  s_cbranch_scc0 .g2_kernel_bp30n0
  s_andn2_b64 s[8:9], s[8:9], vcc
  buffer_load_dword v1, v6, s[4:7], s30 offen
.g2_kernel_bp30n0:
  s_mov_b64 exec, -1
  v_cmp_lt_u32 vcc, s62, v14
  s_and_b64 exec, vcc, s[10:11]
  s_cbranch_scc0 .g2_kernel_bp30n1
  s_andn2_b64 s[10:11], s[10:11], vcc
  buffer_load_dword v1, v6, s[4:7], s34 offen
.g2_kernel_bp30n1:
  s_mov_b64 exec, -1
  v_cmp_lt_u32 vcc, s62, v15
  s_and_b64 exec, vcc, s[12:13]
  s_cbranch_scc0 .g2_kernel_bp30n2
  s_andn2_b64 s[12:13], s[12:13], vcc
  buffer_load_dword v1, v6, s[4:7], s35 offen
.g2_kernel_bp30n2:
  s_mov_b64 exec, -1
  v_cmp_lt_u32 vcc, s62, v16
  s_and_b64 exec, vcc, s[14:15]
  s_cbranch_scc0 .g2_kernel_bp30n3
  s_andn2_b64 s[14:15], s[14:15], vcc
  buffer_load_dword v1, v6, s[4:7], s36 offen
.g2_kernel_bp30n3:
  s_mov_b64 exec, -1
  s_sleep 10
  ds_read_b32 v12, v11
  s_waitcnt lgkmcnt(0)
  v_cmp_lt_u32 vcc, s33, v12
  s_cbranch_vccnz .g2_kernel_bp30d
  s_cmp_lt_u32 s38, 131072
  s_cbranch_scc1 .g2_kernel_bp30
.g2_kernel_bp30d:
.g2_kernel_v_5:
  s_mov_b32 s29, 1
  s_call_b64 s[68:69], .g2_kernel_v_cmb
  s_and_b32 s33, s16, 3
  s_lshl_b32 s33, s33, 7
  s_lshl_b32 s28, s29, 2
  s_add_u32 s33, s33, s28
  s_add_u32 s31, s19, s33
  v_mov_b32 v6, s70
  s_mov_b64 exec, 1
  buffer_store_dword v6, v4, s[4:7], s31 offen offset:0 sc1
  s_mov_b64 exec, -1
  s_cmp_lg_u32 s16, 4
  s_cbranch_scc1 .g2_kernel_v_8
  s_waitcnt vmcnt(3)
  v_mov_b32 v6, s71
  s_mov_b32 s38, 0
.g2_kernel_wg31:
  ds_read_b32 v7, v6 offset:76
  s_add_u32 s38, s38, 1
  s_waitcnt lgkmcnt(0)
  v_cmp_le_u32 vcc, 1, v7
  s_cbranch_vccnz .g2_kernel_wg31d
  s_sleep 1
  s_cmp_lt_u32 s38, 524288
  s_cbranch_scc1 .g2_kernel_wg31
.g2_kernel_wg31d:
  ds_write_b128 v3, v[192:195] offset:49152
  ds_write_b128 v3, v[196:199] offset:50176
  ds_write_b128 v3, v[200:203] offset:51200
  ds_write_b128 v3, v[204:207] offset:52224
  ds_write_b128 v3, v[208:211] offset:53248
  ds_write_b128 v3, v[212:215] offset:54272
  ds_write_b128 v3, v[216:219] offset:55296
  ds_write_b128 v3, v[220:223] offset:56320
  ds_write_b128 v3, v[224:227] offset:57344
  ds_write_b128 v3, v[228:231] offset:58368
  ds_write_b128 v3, v[232:235] offset:59392
  ds_write_b128 v3, v[236:239] offset:60416
  ds_write_b128 v3, v[240:243] offset:61440
  ds_write_b128 v3, v[244:247] offset:62464
  ds_write_b128 v3, v[248:251] offset:63488
  ds_write_b128 v3, v[252:255] offset:64512
  v_mov_b32 v6, s71
  s_mov_b32 s38, 0
.g2_kernel_wg32:
  ds_read_b32 v7, v6 offset:68
  s_add_u32 s38, s38, 1
  s_waitcnt lgkmcnt(0)
  v_cmp_le_u32 vcc, 1, v7
  s_cbranch_vccnz .g2_kernel_wg32d
  s_sleep 1
  s_cmp_lt_u32 s38, 524288
  s_cbranch_scc1 .g2_kernel_wg32
.g2_kernel_wg32d:
  ds_write_b128 v3, v[64:67] offset:16384
  ds_write_b128 v3, v[68:71] offset:17408
  ds_write_b128 v3, v[72:75] offset:18432
  ds_write_b128 v3, v[76:79] offset:19456
  ds_write_b128 v3, v[80:83] offset:20480
  ds_write_b128 v3, v[84:87] offset:21504
  ds_write_b128 v3, v[88:91] offset:22528
  ds_write_b128 v3, v[92:95] offset:23552
  ds_write_b128 v3, v[96:99] offset:24576
  ds_write_b128 v3, v[100:103] offset:25600
  ds_write_b128 v3, v[104:107] offset:26624
  ds_write_b128 v3, v[108:111] offset:27648
  ds_write_b128 v3, v[112:115] offset:28672
  ds_write_b128 v3, v[116:119] offset:29696
  ds_write_b128 v3, v[120:123] offset:30720
  ds_write_b128 v3, v[124:127] offset:31744
  v_mov_b32 v6, s71
  s_mov_b32 s38, 0
.g2_kernel_wg33:
  ds_read_b32 v7, v6 offset:72
  s_add_u32 s38, s38, 1
  s_waitcnt lgkmcnt(0)
  v_cmp_le_u32 vcc, 1, v7
  s_cbranch_vccnz .g2_kernel_wg33d
  s_sleep 1
  s_cmp_lt_u32 s38, 524288
  s_cbranch_scc1 .g2_kernel_wg33
.g2_kernel_wg33d:
  ds_write_b128 v3, v[128:131] offset:32768
  ds_write_b128 v3, v[132:135] offset:33792
  ds_write_b128 v3, v[136:139] offset:34816
  ds_write_b128 v3, v[140:143] offset:35840
  ds_write_b128 v3, v[144:147] offset:36864
  ds_write_b128 v3, v[148:151] offset:37888
  ds_write_b128 v3, v[152:155] offset:38912
  ds_write_b128 v3, v[156:159] offset:39936
  ds_write_b128 v3, v[160:163] offset:40960
  ds_write_b128 v3, v[164:167] offset:41984
  ds_write_b128 v3, v[168:171] offset:43008
  ds_write_b128 v3, v[172:175] offset:44032
  ds_write_b128 v3, v[176:179] offset:45056
  ds_write_b128 v3, v[180:183] offset:46080
  ds_write_b128 v3, v[184:187] offset:47104
  ds_write_b128 v3, v[188:191] offset:48128
  v_mov_b32 v8, 4
  ds_write_b32 v6, v8 offset:12
.g2_kernel_v_8:
  s_cmp_eq_u32 s16, 5
  s_cbranch_scc1 .g2_kernel_c1
  s_cmp_lg_u32 s16, 4
  s_cbranch_scc1 .g2_kernel_c2
  s_cmp_lg_u32 s62, 0
  s_cbranch_scc1 .g2_kernel_fin1
  s_setprio 3
  s_mov_b32 s12, s42
  s_mov_b32 s13, s43
  s_mov_b32 s14, 0x600000
  s_mov_b32 s15, 0x00020000
  v_lshrrev_b32 v28, 3, v2
  v_and_b32 v29, 7, v2
  v_bfe_u32 v30, v2, 4, 1
  v_lshlrev_b32 v30, 1, v30
  v_xor_b32 v31, v29, v30
  v_lshlrev_b32 v31, 4, v31
  v_mul_u32_u24 v28, 6144, v28
  v_add_u32 v28, v28, v31
  v_xor_b32 v29, 64, v28
  v_lshlrev_b32 v9, 8, v2
  v_and_b32 v9, 0x300, v9
  v_add_u32 v9, 156416, v9
  v_add_u32 v48, 0, v28
  v_add_u32 v49, 48128, v29
  v_add_u32 v50, 96256, v28
  v_add_u32 v51, 144384, v29
  v_add_u32 v52, 2048, v28
  v_add_u32 v53, 50176, v29
  v_add_u32 v54, 98304, v28
  v_add_u32 v55, 146432, v29
  v_add_u32 v56, 4096, v28
  v_add_u32 v57, 52224, v29
  v_add_u32 v58, 100352, v28
  v_add_u32 v59, 148480, v29
  v_and_b32 v11, 15, v2
  v_xor_b32 v11, s18, v11
  v_and_b32 v12, 48, v2
  v_add_u32 v11, v11, v12
  v_lshlrev_b32 v11, 2, v11
  v_add_u32 v11, 158208, v11
  s_lshl_b32 s39, s18, 7
  s_lshl_b32 s32, s17, 18
  s_add_u32 s32, s32, 0xc00000
  s_mov_b32 s30, 0
  s_mov_b32 s29, 0
  s_mov_b32 s37, 0
  v_mov_b32 v6, s71
  s_mov_b32 s38, 0
.g2_kernel_wg34:
  ds_read_b32 v7, v6 offset:16
  s_add_u32 s38, s38, 1
  s_waitcnt lgkmcnt(0)
  v_cmp_le_u32 vcc, 4, v7
  s_cbranch_vccnz .g2_kernel_wg34d
  s_sleep 2
  s_cmp_lt_u32 s38, 524288
  s_cbranch_scc1 .g2_kernel_wg34
.g2_kernel_wg34d:
  s_xor_b32 s36, s18, 0
  s_mul_i32 s36, s36, 393216
  s_add_u32 s36, s36, s39
  s_add_u32 m0, s30, 65536
  s_nop 0
  buffer_load_dwordx4 v48, s[12:15], s36 offen offset:0 lds
  buffer_load_dwordx4 v49, s[12:15], s36 offen offset:1024 lds
  buffer_load_dwordx4 v50, s[12:15], s36 offen offset:2048 lds
  buffer_load_dwordx4 v51, s[12:15], s36 offen offset:3072 lds
  s_add_u32 m0, s30, 69632
  s_nop 0
  buffer_load_dwordx4 v52, s[12:15], s36 offen offset:0 lds
  buffer_load_dwordx4 v53, s[12:15], s36 offen offset:1024 lds
  buffer_load_dwordx4 v54, s[12:15], s36 offen offset:2048 lds
  buffer_load_dwordx4 v55, s[12:15], s36 offen offset:3072 lds
  s_add_u32 m0, s30, 73728
  s_nop 0
  buffer_load_dwordx4 v56, s[12:15], s36 offen offset:0 lds
  buffer_load_dwordx4 v57, s[12:15], s36 offen offset:1024 lds
  buffer_load_dwordx4 v58, s[12:15], s36 offen offset:2048 lds
  buffer_load_dwordx4 v59, s[12:15], s36 offen offset:3072 lds
  s_add_u32 s30, s30, 12288
  s_cmp_eq_u32 s30, 86016
  s_cselect_b32 s30, 0, s30
  s_xor_b32 s36, s18, 0
  s_mul_i32 s36, s36, 393216
  s_add_u32 s36, s36, s39
  s_add_u32 s36, s36, 196608
  s_add_u32 m0, s30, 65536
  s_nop 0
  buffer_load_dwordx4 v48, s[12:15], s36 offen offset:0 lds
  buffer_load_dwordx4 v49, s[12:15], s36 offen offset:1024 lds
  buffer_load_dwordx4 v50, s[12:15], s36 offen offset:2048 lds
  buffer_load_dwordx4 v51, s[12:15], s36 offen offset:3072 lds
  s_add_u32 m0, s30, 69632
  s_nop 0
  buffer_load_dwordx4 v52, s[12:15], s36 offen offset:0 lds
  buffer_load_dwordx4 v53, s[12:15], s36 offen offset:1024 lds
  buffer_load_dwordx4 v54, s[12:15], s36 offen offset:2048 lds
  buffer_load_dwordx4 v55, s[12:15], s36 offen offset:3072 lds
  s_add_u32 m0, s30, 73728
  s_nop 0
  buffer_load_dwordx4 v56, s[12:15], s36 offen offset:0 lds
  buffer_load_dwordx4 v57, s[12:15], s36 offen offset:1024 lds
  buffer_load_dwordx4 v58, s[12:15], s36 offen offset:2048 lds
  buffer_load_dwordx4 v59, s[12:15], s36 offen offset:3072 lds
  s_add_u32 s30, s30, 12288
  s_cmp_eq_u32 s30, 86016
  s_cselect_b32 s30, 0, s30
  s_mov_b32 m0, 156160
  s_mov_b32 s35, .g2_kernel_tab-.g2_kernel_pc+136
  buffer_load_dword off, s[64:67], s35 lds
  s_xor_b32 s36, s18, 1
  s_mul_i32 s36, s36, 393216
  s_add_u32 s36, s36, s39
  s_add_u32 m0, s30, 65536
  s_nop 0
  buffer_load_dwordx4 v48, s[12:15], s36 offen offset:0 lds
  buffer_load_dwordx4 v49, s[12:15], s36 offen offset:1024 lds
  buffer_load_dwordx4 v50, s[12:15], s36 offen offset:2048 lds
  buffer_load_dwordx4 v51, s[12:15], s36 offen offset:3072 lds
  s_add_u32 m0, s30, 69632
  s_nop 0
  buffer_load_dwordx4 v52, s[12:15], s36 offen offset:0 lds
  buffer_load_dwordx4 v53, s[12:15], s36 offen offset:1024 lds
  buffer_load_dwordx4 v54, s[12:15], s36 offen offset:2048 lds
  buffer_load_dwordx4 v55, s[12:15], s36 offen offset:3072 lds
  s_add_u32 m0, s30, 73728
  s_nop 0
  buffer_load_dwordx4 v56, s[12:15], s36 offen offset:0 lds
  buffer_load_dwordx4 v57, s[12:15], s36 offen offset:1024 lds
  buffer_load_dwordx4 v58, s[12:15], s36 offen offset:2048 lds
  buffer_load_dwordx4 v59, s[12:15], s36 offen offset:3072 lds
  s_add_u32 s30, s30, 12288
  s_cmp_eq_u32 s30, 86016
  s_cselect_b32 s30, 0, s30
  s_xor_b32 s36, s18, 1
  s_mul_i32 s36, s36, 393216
  s_add_u32 s36, s36, s39
  s_add_u32 s36, s36, 196608
  s_add_u32 m0, s30, 65536
  s_nop 0
  buffer_load_dwordx4 v48, s[12:15], s36 offen offset:0 lds
  buffer_load_dwordx4 v49, s[12:15], s36 offen offset:1024 lds
  buffer_load_dwordx4 v50, s[12:15], s36 offen offset:2048 lds
  buffer_load_dwordx4 v51, s[12:15], s36 offen offset:3072 lds
  s_add_u32 m0, s30, 69632
  s_nop 0
  buffer_load_dwordx4 v52, s[12:15], s36 offen offset:0 lds
  buffer_load_dwordx4 v53, s[12:15], s36 offen offset:1024 lds
  buffer_load_dwordx4 v54, s[12:15], s36 offen offset:2048 lds
  buffer_load_dwordx4 v55, s[12:15], s36 offen offset:3072 lds
  s_add_u32 m0, s30, 73728
  s_nop 0
  buffer_load_dwordx4 v56, s[12:15], s36 offen offset:0 lds
  buffer_load_dwordx4 v57, s[12:15], s36 offen offset:1024 lds
  buffer_load_dwordx4 v58, s[12:15], s36 offen offset:2048 lds
  buffer_load_dwordx4 v59, s[12:15], s36 offen offset:3072 lds
  s_add_u32 s30, s30, 12288
  s_cmp_eq_u32 s30, 86016
  s_cselect_b32 s30, 0, s30
  s_xor_b32 s36, s18, 2
  s_mul_i32 s36, s36, 393216
  s_add_u32 s36, s36, s39
  s_add_u32 m0, s30, 65536
  s_nop 0
  buffer_load_dwordx4 v48, s[12:15], s36 offen offset:0 lds
  buffer_load_dwordx4 v49, s[12:15], s36 offen offset:1024 lds
  buffer_load_dwordx4 v50, s[12:15], s36 offen offset:2048 lds
  buffer_load_dwordx4 v51, s[12:15], s36 offen offset:3072 lds
  s_add_u32 m0, s30, 69632
  s_nop 0
  buffer_load_dwordx4 v52, s[12:15], s36 offen offset:0 lds
  buffer_load_dwordx4 v53, s[12:15], s36 offen offset:1024 lds
  buffer_load_dwordx4 v54, s[12:15], s36 offen offset:2048 lds
  buffer_load_dwordx4 v55, s[12:15], s36 offen offset:3072 lds
  s_add_u32 m0, s30, 73728
  s_nop 0
  buffer_load_dwordx4 v56, s[12:15], s36 offen offset:0 lds
  buffer_load_dwordx4 v57, s[12:15], s36 offen offset:1024 lds
  buffer_load_dwordx4 v58, s[12:15], s36 offen offset:2048 lds
  buffer_load_dwordx4 v59, s[12:15], s36 offen offset:3072 lds
  s_add_u32 s30, s30, 12288
  s_cmp_eq_u32 s30, 86016
  s_cselect_b32 s30, 0, s30
  v_mov_b32 v6, s71
  s_mov_b32 s38, 0
.g2_kernel_wg35:
  ds_read_b32 v7, v6 offset:20
  s_add_u32 s38, s38, 1
  s_waitcnt lgkmcnt(0)
  v_cmp_le_u32 vcc, 4, v7
  s_cbranch_vccnz .g2_kernel_wg35d
  s_sleep 1
  s_cmp_lt_u32 s38, 524288
  s_cbranch_scc1 .g2_kernel_wg35
.g2_kernel_wg35d:
  s_mov_b32 s62, 1
  s_mov_b32 s63, 0x1800000
  s_mov_b32 s70, 2
  s_mov_b32 s71, 155776
  s_xor_b32 s36, s18, 2
  s_mul_i32 s36, s36, 393216
  s_add_u32 s36, s36, s39
  s_add_u32 s36, s36, 196608
  s_add_u32 m0, s30, 65536
  s_nop 0
  buffer_load_dwordx4 v48, s[12:15], s36 offen offset:0 lds
  buffer_load_dwordx4 v49, s[12:15], s36 offen offset:1024 lds
  buffer_load_dwordx4 v50, s[12:15], s36 offen offset:2048 lds
  buffer_load_dwordx4 v51, s[12:15], s36 offen offset:3072 lds
  s_add_u32 m0, s30, 69632
  s_nop 0
  buffer_load_dwordx4 v52, s[12:15], s36 offen offset:0 lds
  buffer_load_dwordx4 v53, s[12:15], s36 offen offset:1024 lds
  buffer_load_dwordx4 v54, s[12:15], s36 offen offset:2048 lds
  buffer_load_dwordx4 v55, s[12:15], s36 offen offset:3072 lds
  s_add_u32 m0, s30, 73728
  s_nop 0
  buffer_load_dwordx4 v56, s[12:15], s36 offen offset:0 lds
  buffer_load_dwordx4 v57, s[12:15], s36 offen offset:1024 lds
  buffer_load_dwordx4 v58, s[12:15], s36 offen offset:2048 lds
  buffer_load_dwordx4 v59, s[12:15], s36 offen offset:3072 lds
  s_add_u32 s30, s30, 12288
  s_cmp_eq_u32 s30, 86016
  s_cselect_b32 s30, 0, s30
  s_xor_b32 s36, s18, 3
  s_mul_i32 s36, s36, 393216
  s_add_u32 s36, s36, s39
  s_add_u32 m0, s30, 65536
  s_nop 0
  buffer_load_dwordx4 v48, s[12:15], s36 offen offset:0 lds
  buffer_load_dwordx4 v49, s[12:15], s36 offen offset:1024 lds
  buffer_load_dwordx4 v50, s[12:15], s36 offen offset:2048 lds
  buffer_load_dwordx4 v51, s[12:15], s36 offen offset:3072 lds
  s_add_u32 m0, s30, 69632
  s_nop 0
  buffer_load_dwordx4 v52, s[12:15], s36 offen offset:0 lds
  buffer_load_dwordx4 v53, s[12:15], s36 offen offset:1024 lds
  buffer_load_dwordx4 v54, s[12:15], s36 offen offset:2048 lds
  buffer_load_dwordx4 v55, s[12:15], s36 offen offset:3072 lds
  s_add_u32 m0, s30, 73728
  s_nop 0
  buffer_load_dwordx4 v56, s[12:15], s36 offen offset:0 lds
  buffer_load_dwordx4 v57, s[12:15], s36 offen offset:1024 lds
  buffer_load_dwordx4 v58, s[12:15], s36 offen offset:2048 lds
  buffer_load_dwordx4 v59, s[12:15], s36 offen offset:3072 lds
  s_add_u32 s30, s30, 12288
  s_cmp_eq_u32 s30, 86016
  s_cselect_b32 s30, 0, s30
  s_mov_b32 s28, 1
  s_mov_b32 s29, 16384
  s_bitcmp1_b32 s37, s28
  s_cbranch_scc0 .g2_kernel_p2_x0w
.g2_kernel_p2_x0b:
  s_xor_b32 s33, s28, s18
  s_lshl_b32 s33, s33, 14
  s_add_u32 s33, s33, s32
  s_add_u32 m0, s29, 0
  s_nop 0
  buffer_load_dwordx4 v3, s[4:7], s33 offen offset:0 lds
  buffer_load_dwordx4 v3, s[4:7], s33 offen offset:1024 lds
  buffer_load_dwordx4 v3, s[4:7], s33 offen offset:2048 lds
  buffer_load_dwordx4 v3, s[4:7], s33 offen offset:3072 lds
  s_add_u32 m0, s29, 4096
  s_add_u32 s33, s33, 4096
  buffer_load_dwordx4 v3, s[4:7], s33 offen offset:0 lds
  buffer_load_dwordx4 v3, s[4:7], s33 offen offset:1024 lds
  buffer_load_dwordx4 v3, s[4:7], s33 offen offset:2048 lds
  buffer_load_dwordx4 v3, s[4:7], s33 offen offset:3072 lds
  s_add_u32 m0, s29, 8192
  s_add_u32 s33, s33, 4096
  buffer_load_dwordx4 v3, s[4:7], s33 offen offset:0 lds
  buffer_load_dwordx4 v3, s[4:7], s33 offen offset:1024 lds
  buffer_load_dwordx4 v3, s[4:7], s33 offen offset:2048 lds
  buffer_load_dwordx4 v3, s[4:7], s33 offen offset:3072 lds
  s_add_u32 m0, s29, 12288
  s_add_u32 s33, s33, 4096
  buffer_load_dwordx4 v3, s[4:7], s33 offen offset:0 lds
  buffer_load_dwordx4 v3, s[4:7], s33 offen offset:1024 lds
  buffer_load_dwordx4 v3, s[4:7], s33 offen offset:2048 lds
  buffer_load_dwordx4 v3, s[4:7], s33 offen offset:3072 lds
  s_mov_b32 m0, 156160
  s_mov_b32 s35, .g2_kernel_tab-.g2_kernel_pc+144
  buffer_load_dword off, s[64:67], s35 lds
  s_mov_b32 s28, 2
  s_mov_b32 s29, 32768
  s_bitcmp1_b32 s37, s28
  s_cbranch_scc0 .g2_kernel_p2_x1w
.g2_kernel_p2_x1b:
  s_xor_b32 s33, s28, s18
  s_lshl_b32 s33, s33, 14
  s_add_u32 s33, s33, s32
  s_add_u32 m0, s29, 0
  s_nop 0
  buffer_load_dwordx4 v3, s[4:7], s33 offen offset:0 lds
  buffer_load_dwordx4 v3, s[4:7], s33 offen offset:1024 lds
  buffer_load_dwordx4 v3, s[4:7], s33 offen offset:2048 lds
  buffer_load_dwordx4 v3, s[4:7], s33 offen offset:3072 lds
  s_add_u32 m0, s29, 4096
  s_add_u32 s33, s33, 4096
  buffer_load_dwordx4 v3, s[4:7], s33 offen offset:0 lds
  buffer_load_dwordx4 v3, s[4:7], s33 offen offset:1024 lds
  buffer_load_dwordx4 v3, s[4:7], s33 offen offset:2048 lds
  buffer_load_dwordx4 v3, s[4:7], s33 offen offset:3072 lds
  s_add_u32 m0, s29, 8192
  s_add_u32 s33, s33, 4096
  buffer_load_dwordx4 v3, s[4:7], s33 offen offset:0 lds
  buffer_load_dwordx4 v3, s[4:7], s33 offen offset:1024 lds
  buffer_load_dwordx4 v3, s[4:7], s33 offen offset:2048 lds
  buffer_load_dwordx4 v3, s[4:7], s33 offen offset:3072 lds
  s_add_u32 m0, s29, 12288
  s_add_u32 s33, s33, 4096
  buffer_load_dwordx4 v3, s[4:7], s33 offen offset:0 lds
  buffer_load_dwordx4 v3, s[4:7], s33 offen offset:1024 lds
  buffer_load_dwordx4 v3, s[4:7], s33 offen offset:2048 lds
  buffer_load_dwordx4 v3, s[4:7], s33 offen offset:3072 lds
  s_mov_b32 m0, 156160
  s_mov_b32 s35, .g2_kernel_tab-.g2_kernel_pc+152
  buffer_load_dword off, s[64:67], s35 lds
  s_mov_b32 s28, 3
  s_mov_b32 s29, 49152
  s_bitcmp1_b32 s37, s28
  s_cbranch_scc0 .g2_kernel_p2_x2w
.g2_kernel_p2_x2b:
  s_xor_b32 s33, s28, s18
  s_lshl_b32 s33, s33, 14
  s_add_u32 s33, s33, s32
  s_add_u32 m0, s29, 0
  s_nop 0
  buffer_load_dwordx4 v3, s[4:7], s33 offen offset:0 lds
  buffer_load_dwordx4 v3, s[4:7], s33 offen offset:1024 lds
  buffer_load_dwordx4 v3, s[4:7], s33 offen offset:2048 lds
  buffer_load_dwordx4 v3, s[4:7], s33 offen offset:3072 lds
  s_add_u32 m0, s29, 4096
  s_add_u32 s33, s33, 4096
  buffer_load_dwordx4 v3, s[4:7], s33 offen offset:0 lds
  buffer_load_dwordx4 v3, s[4:7], s33 offen offset:1024 lds
  buffer_load_dwordx4 v3, s[4:7], s33 offen offset:2048 lds
  buffer_load_dwordx4 v3, s[4:7], s33 offen offset:3072 lds
  s_add_u32 m0, s29, 8192
  s_add_u32 s33, s33, 4096
  buffer_load_dwordx4 v3, s[4:7], s33 offen offset:0 lds
  buffer_load_dwordx4 v3, s[4:7], s33 offen offset:1024 lds
  buffer_load_dwordx4 v3, s[4:7], s33 offen offset:2048 lds
  buffer_load_dwordx4 v3, s[4:7], s33 offen offset:3072 lds
  s_add_u32 m0, s29, 12288
  s_add_u32 s33, s33, 4096
  buffer_load_dwordx4 v3, s[4:7], s33 offen offset:0 lds
  buffer_load_dwordx4 v3, s[4:7], s33 offen offset:1024 lds
  buffer_load_dwordx4 v3, s[4:7], s33 offen offset:2048 lds
  buffer_load_dwordx4 v3, s[4:7], s33 offen offset:3072 lds
  s_mov_b32 m0, 156160
  s_mov_b32 s35, .g2_kernel_tab-.g2_kernel_pc+156
  buffer_load_dword off, s[64:67], s35 lds
  s_xor_b32 s36, s18, 3
  s_mul_i32 s36, s36, 393216
  s_add_u32 s36, s36, s39
  s_add_u32 s36, s36, 196608
  ds_read_b32 v10, v9
  s_mov_b32 s34, 33
  s_mov_b32 s35, .g2_kernel_tab-.g2_kernel_pc+160
  s_branch .g2_kernel_p2_o
  .p2align 6
.g2_kernel_p2_l:
  s_waitcnt lgkmcnt(0)
  v_cmp_gt_i32 vcc, s34, v10
  s_cbranch_vccnz .g2_kernel_p2_aw
.g2_kernel_p2_ai:
  s_add_u32 s29, s29, 16384
  s_and_b32 s29, s29, 0xffff
  s_bitcmp1_b32 s37, s28
  s_cbranch_scc0 .g2_kernel_p2_x3w
.g2_kernel_p2_x3b:
  s_xor_b32 s33, s28, s18
  s_lshl_b32 s33, s33, 14
  s_add_u32 s33, s33, s32
  s_add_u32 m0, s29, 0
  s_nop 0
  buffer_load_dwordx4 v3, s[4:7], s33 offen offset:0 lds
  buffer_load_dwordx4 v3, s[4:7], s33 offen offset:1024 lds
  buffer_load_dwordx4 v3, s[4:7], s33 offen offset:2048 lds
  buffer_load_dwordx4 v3, s[4:7], s33 offen offset:3072 lds
  s_add_u32 m0, s29, 4096
  s_add_u32 s33, s33, 4096
  buffer_load_dwordx4 v3, s[4:7], s33 offen offset:0 lds
  buffer_load_dwordx4 v3, s[4:7], s33 offen offset:1024 lds
  buffer_load_dwordx4 v3, s[4:7], s33 offen offset:2048 lds
  buffer_load_dwordx4 v3, s[4:7], s33 offen offset:3072 lds
  s_add_u32 m0, s29, 8192
  s_add_u32 s33, s33, 4096
  buffer_load_dwordx4 v3, s[4:7], s33 offen offset:0 lds
  buffer_load_dwordx4 v3, s[4:7], s33 offen offset:1024 lds
  buffer_load_dwordx4 v3, s[4:7], s33 offen offset:2048 lds
  buffer_load_dwordx4 v3, s[4:7], s33 offen offset:3072 lds
  s_add_u32 m0, s29, 12288
  s_add_u32 s33, s33, 4096
  buffer_load_dwordx4 v3, s[4:7], s33 offen offset:0 lds
  buffer_load_dwordx4 v3, s[4:7], s33 offen offset:1024 lds
  buffer_load_dwordx4 v3, s[4:7], s33 offen offset:2048 lds
  buffer_load_dwordx4 v3, s[4:7], s33 offen offset:3072 lds
  s_add_u32 m0, s30, 65536
  s_nop 0
  buffer_load_dwordx4 v48, s[12:15], s36 offen offset:0 lds
  buffer_load_dwordx4 v49, s[12:15], s36 offen offset:1024 lds
  buffer_load_dwordx4 v50, s[12:15], s36 offen offset:2048 lds
  buffer_load_dwordx4 v51, s[12:15], s36 offen offset:3072 lds
  s_add_u32 m0, s30, 69632
  s_nop 0
  buffer_load_dwordx4 v52, s[12:15], s36 offen offset:0 lds
  buffer_load_dwordx4 v53, s[12:15], s36 offen offset:1024 lds
  buffer_load_dwordx4 v54, s[12:15], s36 offen offset:2048 lds
  buffer_load_dwordx4 v55, s[12:15], s36 offen offset:3072 lds
  s_add_u32 m0, s30, 73728
  s_nop 0
  buffer_load_dwordx4 v56, s[12:15], s36 offen offset:0 lds
  buffer_load_dwordx4 v57, s[12:15], s36 offen offset:1024 lds
  buffer_load_dwordx4 v58, s[12:15], s36 offen offset:2048 lds
  buffer_load_dwordx4 v59, s[12:15], s36 offen offset:3072 lds
  s_add_u32 s30, s30, 12288
  s_cmp_eq_u32 s30, 86016
  s_cselect_b32 s30, 0, s30
  ds_read_b32 v10, v9
  s_mov_b32 m0, 156160
  s_add_u32 s34, s34, 1
  buffer_load_dword off, s[64:67], s35 lds
  s_add_u32 s35, s35, 4
  s_add_u32 s36, s36, 196608
.g2_kernel_p2_o:
  s_waitcnt lgkmcnt(0)
  v_cmp_gt_i32 vcc, s34, v10
  s_cbranch_vccnz .g2_kernel_p2_bw
.g2_kernel_p2_bi:
  s_add_u32 m0, s30, 65536
  s_nop 0
  buffer_load_dwordx4 v48, s[12:15], s36 offen offset:0 lds
  buffer_load_dwordx4 v49, s[12:15], s36 offen offset:1024 lds
  buffer_load_dwordx4 v50, s[12:15], s36 offen offset:2048 lds
  buffer_load_dwordx4 v51, s[12:15], s36 offen offset:3072 lds
  s_add_u32 m0, s30, 69632
  s_nop 0
  buffer_load_dwordx4 v52, s[12:15], s36 offen offset:0 lds
  buffer_load_dwordx4 v53, s[12:15], s36 offen offset:1024 lds
  buffer_load_dwordx4 v54, s[12:15], s36 offen offset:2048 lds
  buffer_load_dwordx4 v55, s[12:15], s36 offen offset:3072 lds
  s_add_u32 m0, s30, 73728
  s_nop 0
  buffer_load_dwordx4 v56, s[12:15], s36 offen offset:0 lds
  buffer_load_dwordx4 v57, s[12:15], s36 offen offset:1024 lds
  buffer_load_dwordx4 v58, s[12:15], s36 offen offset:2048 lds
  buffer_load_dwordx4 v59, s[12:15], s36 offen offset:3072 lds
  s_add_u32 s30, s30, 12288
  s_cmp_eq_u32 s30, 86016
  s_cselect_b32 s30, 0, s30
  ds_read_b32 v10, v9
  s_mov_b32 m0, 156160
  s_add_u32 s34, s34, 1
  buffer_load_dword off, s[64:67], s35 lds
  s_add_u32 s35, s35, 4
  s_add_u32 s28, s28, 1
  s_xor_b32 s36, s18, s28
  s_mul_i32 s36, s36, 393216
  s_add_u32 s36, s36, s39
  s_cmp_lt_i32 s34, 58
  s_cbranch_scc1 .g2_kernel_p2_l
  s_branch .g2_kernel_v
.g2_kernel_c1:
  v_mov_b32 v6, s71
  s_mov_b32 s38, 0
.g2_kernel_wg36:
  ds_read_b32 v7, v6 offset:76
  s_add_u32 s38, s38, 1
  s_waitcnt lgkmcnt(0)
  v_cmp_le_u32 vcc, 1, v7
  s_cbranch_vccnz .g2_kernel_wg36d
  s_sleep 1
  s_cmp_lt_u32 s38, 524288
  s_cbranch_scc1 .g2_kernel_wg36
.g2_kernel_wg36d:
  s_sleep 4
  s_and_b32 s31, s19, 0xffffe000
  s_add_u32 s31, s31, 4
  v_and_b32 v6, 15, v2
  v_lshlrev_b32 v6, 9, v6
  v_lshrrev_b32 v7, 4, v2
  v_lshl_add_u32 v6, v7, 7, v6
  v_lshlrev_b32 v7, 2, v2
  v_add_u32 v7, 157952, v7
  s_mov_b32 m0, 157952
  s_mov_b32 s38, 0
.g2_kernel_pa37:
  buffer_load_dword v6, s[4:7], s31 offen sc1 lds
  s_add_u32 s38, s38, 1
  s_waitcnt vmcnt(0)
  ds_read_b32 v8, v7
  s_waitcnt lgkmcnt(0)
  v_cmp_ge_u32 vcc, s62, v8
  s_cbranch_vccz .g2_kernel_pa37d
  s_mov_b64 exec, vcc
  s_sleep 4
  s_cmp_lt_u32 s38, 131072
  s_cbranch_scc1 .g2_kernel_pa37
.g2_kernel_pa37d:
  s_mov_b64 exec, -1
  s_setprio 2
  s_mov_b32 s39, 0
  s_lshl_b32 s30, s17, 4
  s_add_u32 s30, s30, s18
  s_lshl_b32 s20, s30, 11
  s_add_u32 s20, s20, s63
  s_add_u32 s20, s20, 0x1000000
  s_lshl_b32 s21, s30, 6
  s_add_u32 s21, s21, s63
  s_add_u32 s21, s21, 0x1080000
  s_lshl_b32 s23, s62, 16
  s_add_u32 s23, s23, 0x3040000
  s_lshl_b32 s22, s30, 5
  s_add_u32 s22, s22, s23
  s_and_b32 s28, s2, 7
  s_lshl_b32 s28, s28, 13
  s_add_u32 s23, s23, s28
  v_mov_b32 v9, 155648
  ds_read_b32 v26, v9 offset:256
  v_lshrrev_b32 v24, 4, v2
  v_lshlrev_b32 v25, 3, v24
  v_lshlrev_b32 v27, 13, v2
  v_and_b32 v31, 15, v2
  v_lshlrev_b32 v31, 7, v31
  v_lshl_add_u32 v31, v24, 4, v31
  v_mov_b32 v28, 0.0009765625
  v_mov_b32 v30, 1e-05
  v_mov_b32 v6, s71
  s_mov_b32 s38, 0
.g2_kernel_wg39:
  ds_read_b32 v7, v6 offset:20
  s_add_u32 s38, s38, 1
  s_waitcnt lgkmcnt(0)
  v_cmp_le_u32 vcc, 4, v7
  s_cbranch_vccnz .g2_kernel_wg39d
  s_sleep 1
  s_cmp_lt_u32 s38, 524288
  s_cbranch_scc1 .g2_kernel_wg39
.g2_kernel_wg39d:
  s_sleep 12
  s_cmp_lg_u32 s62, 0
  s_cbranch_scc1 .g2_kernel_nap40
  s_sleep 24
.g2_kernel_nap40:
  s_mov_b32 s38, 0
.g2_kernel_gx41:
  buffer_load_dwordx4 v[16:19], v31, s[4:7], s20 offen offset:0 sc1
  buffer_load_dwordx4 v[20:23], v31, s[4:7], s20 offen offset:64 sc1
  s_add_u32 s38, s38, 1
  s_waitcnt vmcnt(0)
  v_min3_u32 v6, v16, v19, v20
  v_min_u32 v6, v6, v23
  v_cmp_eq_u32 vcc, 0, v6
  s_cbranch_vccz .g2_kernel_gx41d
  s_mov_b64 exec, vcc
  s_sleep 1
  s_cmp_lg_u32 s62, 0
  s_cbranch_scc1 .g2_kernel_nap42
  s_sleep 23
.g2_kernel_nap42:
  s_cmp_lt_u32 s38, 131072
  s_cbranch_scc1 .g2_kernel_gx41
.g2_kernel_gx41d:
  s_mov_b64 exec, -1
  v_add_f32 v16, v16, v16 row_ror:8 row_mask:0xf bank_mask:0xf
  v_add_f32 v17, v17, v17 row_ror:8 row_mask:0xf bank_mask:0xf
  v_add_f32 v18, v18, v18 row_ror:8 row_mask:0xf bank_mask:0xf
  v_add_f32 v20, v20, v20 row_ror:8 row_mask:0xf bank_mask:0xf
  v_add_f32 v21, v21, v21 row_ror:8 row_mask:0xf bank_mask:0xf
  v_add_f32 v22, v22, v22 row_ror:8 row_mask:0xf bank_mask:0xf
  v_add_f32 v16, v16, v16 row_ror:4 row_mask:0xf bank_mask:0xf
  v_add_f32 v17, v17, v17 row_ror:4 row_mask:0xf bank_mask:0xf
  v_add_f32 v18, v18, v18 row_ror:4 row_mask:0xf bank_mask:0xf
  v_add_f32 v20, v20, v20 row_ror:4 row_mask:0xf bank_mask:0xf
  v_add_f32 v21, v21, v21 row_ror:4 row_mask:0xf bank_mask:0xf
  v_add_f32 v22, v22, v22 row_ror:4 row_mask:0xf bank_mask:0xf
  v_add_f32 v16, v16, v16 row_ror:2 row_mask:0xf bank_mask:0xf
  v_add_f32 v17, v17, v17 row_ror:2 row_mask:0xf bank_mask:0xf
  v_add_f32 v18, v18, v18 row_ror:2 row_mask:0xf bank_mask:0xf
  v_add_f32 v20, v20, v20 row_ror:2 row_mask:0xf bank_mask:0xf
  v_add_f32 v21, v21, v21 row_ror:2 row_mask:0xf bank_mask:0xf
  v_add_f32 v22, v22, v22 row_ror:2 row_mask:0xf bank_mask:0xf
  v_add_f32 v16, v16, v16 row_ror:1 row_mask:0xf bank_mask:0xf
  v_add_f32 v17, v17, v17 row_ror:1 row_mask:0xf bank_mask:0xf
  v_add_f32 v18, v18, v18 row_ror:1 row_mask:0xf bank_mask:0xf
  v_add_f32 v20, v20, v20 row_ror:1 row_mask:0xf bank_mask:0xf
  v_add_f32 v21, v21, v21 row_ror:1 row_mask:0xf bank_mask:0xf
  v_add_f32 v22, v22, v22 row_ror:1 row_mask:0xf bank_mask:0xf
  v_fma_f32 v18, -v16, v26, v18
  v_mul_f32 v16, v28, v16
  v_mul_f32 v19, v16, v16
  v_fma_f32 v17, v17, v28, -v19
  v_max_f32 v17, 0, v17
  v_add_f32 v17, v30, v17
  v_rsq_f32 v19, v17
  v_fma_f32 v22, -v20, v26, v22
  v_mul_f32 v20, v28, v20
  v_mul_f32 v23, v20, v20
  v_fma_f32 v21, v21, v28, -v23
  v_max_f32 v21, 0, v21
  v_add_f32 v21, v30, v21
  v_rsq_f32 v23, v21
  v_mul_f32 v18, v18, v19
  v_mul_f32 v22, v22, v23
  v_and_or_b32 v18, v18, -8, v24
  v_or_b32 v29, 4, v24
  v_and_or_b32 v22, v22, -8, v29
  v_max_f32 v10, v18, v22
  v_mov_b32 v11, 1
  s_nop 0
  v_max_f32 v10, v10, v10 row_bcast:15 row_mask:0xa bank_mask:0xf
  s_nop 1
  v_max_f32 v10, v10, v10 row_bcast:31 row_mask:0xc bank_mask:0xf
  s_nop 0
  v_readlane_b32 s28, v10, 63
  s_nop 1
  v_mov_b32 v10, s28
  s_mov_b64 exec, 0xff
  buffer_store_dwordx2 v[10:11], v27, s[4:7], s22 offen sc1
  s_mov_b32 exec_lo, 0x00010001
  s_mov_b32 exec_hi, 0x00010001
  buffer_store_dwordx2 v[16:17], v25, s[4:7], s21 offen sc1
  buffer_store_dwordx2 v[20:21], v25, s[4:7], s21 offen offset:32 sc1
  s_mov_b64 exec, -1
  s_cmp_lg_u32 s62, 0
  s_cbranch_scc1 .g2_kernel_c_t3
  s_sleep 30
  s_mov_b64 s[8:9], -1
  s_mov_b64 s[10:11], -1
  s_mov_b64 s[12:13], -1
  s_mov_b64 s[14:15], -1
  s_call_b64 s[68:69], .g2_kernel_amax
  s_add_u32 s28, s77, 1
  v_mov_b32 v10, s28
  v_mov_b32 v9, s71
  ds_write_b32 v9, v10 offset:36
  s_lshr_b32 s24, s77, 7
  s_lshl_b32 s24, s24, 18
  s_bfe_u32 s28, s77, 0x30004
  s_lshl_b32 s28, s28, 11
  s_add_u32 s24, s24, s28
  s_and_b32 s28, s77, 15
  s_lshl_b32 s28, s28, 4
  s_add_u32 s24, s24, s28
  s_add_u32 s24, s24, s63
  s_add_u32 s24, s24, 0xc00000
  s_lshl_b32 s28, s17, 14
  s_add_u32 s24, s24, s28
  s_and_b32 s28, s18, 1
  s_lshl_b32 s28, s28, 8
  s_add_u32 s24, s24, s28
  v_lshrrev_b32 v12, 3, v2
  v_lshlrev_b32 v13, 1, v12
  s_waitcnt lgkmcnt(0)
  s_wakeup
  buffer_load_ushort v56, v13, s[4:7], s24 offen offset:0
  buffer_load_ushort v57, v13, s[4:7], s24 offen offset:512
  buffer_load_ushort v58, v13, s[4:7], s24 offen offset:1024
  buffer_load_ushort v59, v13, s[4:7], s24 offen offset:1536
  s_lshl_b32 s25, s77, 3
  s_add_u32 s25, s25, s63
  s_add_u32 s25, s25, 0x1080000
  s_lshl_b32 s21, s17, 10
  s_add_u32 s21, s21, s63
  s_add_u32 s21, s21, 0x1080000
  s_mov_b32 s38, 0
.g2_kernel_gx43:
  buffer_load_dwordx4 v[16:19], v3, s[4:7], s21 offen sc1
  buffer_load_dwordx2 v[20:21], v4, s[4:7], s25 offen sc1
  s_add_u32 s38, s38, 1
  s_waitcnt vmcnt(0)
  v_min3_u32 v6, v17, v19, v21
  v_cmp_eq_u32 vcc, 0, v6
  s_cbranch_vccz .g2_kernel_gx43d
  s_mov_b64 exec, vcc
  s_sleep 1
  s_cmp_lt_u32 s38, 131072
  s_cbranch_scc1 .g2_kernel_gx43
.g2_kernel_gx43d:
  s_mov_b64 exec, -1
  s_lshr_b32 s28, s77, 7
  s_and_b32 s79, s77, 127
  s_add_u32 s79, s79, 1
  s_cmp_eq_u32 s28, s17
  s_cselect_b32 s79, s79, 0
  v_rsq_f32 v22, v17
  v_rsq_f32 v23, v19
  v_rsq_f32 v21, v21
  v_mov_b32 v62, -1.4426950408889634
  v_mul_f32 v62, s27, v62
  v_exp_f32 v62, v62
  v_lshlrev_b32 v14, 3, v2
  v_add_u32 v14, 155648, v14
  v_mov_b32 v15, s79
  v_add_f32 v52, 1.0, v22
  v_mul_f32 v54, v16, v22
  v_sub_f32 v54, 0, v54
  v_add_f32 v53, 1.0, v23
  v_mul_f32 v55, v18, v23
  v_sub_f32 v55, 0, v55
  v_add_f32 v62, 1.0, v62
  v_rcp_f32 v62, v62
  v_add_f32 v60, 1.0, v21
  v_mul_f32 v61, v20, v21
  v_sub_f32 v61, 0, v61
  v_sub_f32 v17, v17, v30
  v_mul_f32 v48, v52, v52
  v_fma_f32 v48, v48, v17, v30
  v_rsq_f32 v48, v48
  s_nop 0
  v_mul_f32 v48, v48, v52
  v_mul_f32 v50, v48, v16
  v_sub_f32 v50, 0, v50
  v_sub_f32 v19, v19, v30
  v_mul_f32 v49, v53, v53
  v_fma_f32 v49, v49, v19, v30
  v_rsq_f32 v49, v49
  s_nop 0
  v_mul_f32 v49, v49, v53
  v_mul_f32 v51, v49, v18
  v_sub_f32 v51, 0, v51
  v_lshlrev_b32 v56, 16, v56
  v_fma_f32 v56, v56, v60, v61
  v_lshlrev_b32 v57, 16, v57
  v_fma_f32 v57, v57, v60, v61
  v_lshlrev_b32 v58, 16, v58
  v_fma_f32 v58, v58, v60, v61
  v_lshlrev_b32 v59, 16, v59
  v_fma_f32 v59, v59, v60, v61
  v_and_b32 v10, 7, v2
  v_lshlrev_b32 v10, 12, v10
  v_lshl_add_u32 v10, v12, 4, v10
  s_lshl_b32 s20, s17, 1
  s_and_b32 s28, s18, 1
  s_add_u32 s20, s20, s28
  s_lshl_b32 s20, s20, 7
  s_add_u32 s20, s20, s63
  s_add_u32 s20, s20, 0x1090000
  s_and_b32 s26, s18, 14
  s_lshl_b32 s26, s26, 4
  s_add_u32 s26, s26, s17
  s_lshl_b32 s26, s26, 1
  s_and_b32 s28, s18, 1
  s_add_u32 s26, s26, s28
  s_lshl_b32 s26, s26, 10
  s_add_u32 s26, s26, s63
  s_add_u32 s26, s26, 0x1190000
  s_add_u32 s25, s26, 32768
  ds_write_b64 v14, v[48:49] offset:2816
  ds_write_b64 v14, v[50:51] offset:3328
  ds_write_b64 v14, v[52:53] offset:3840
  ds_write_b64 v14, v[54:55] offset:4352
  s_lshr_b32 s28, s77, 7
  s_xor_b32 s28, s28, s17
  v_mov_b32 v8, s28
  ds_write_b32 v9, v8 offset:212
  v_mov_b32 v8, 2
  ds_write_b32 v9, v15 offset:152
  ds_write_b32 v9, v8 offset:128
  v_mov_b32 v6, s71
  s_mov_b32 s38, 0
.g2_kernel_wg44:
  ds_read_b32 v7, v6 offset:48
  s_add_u32 s38, s38, 1
  s_waitcnt lgkmcnt(0)
  v_cmp_le_u32 vcc, 2, v7
  s_cbranch_vccnz .g2_kernel_wg44d
  s_sleep 1
  s_cmp_lt_u32 s38, 524288
  s_cbranch_scc1 .g2_kernel_wg44
.g2_kernel_wg44d:
  s_sleep 8
  s_cmp_lg_u32 s62, 0
  s_cbranch_scc1 .g2_kernel_nap45
  s_sleep 22
.g2_kernel_nap45:
  s_mov_b32 s38, 0
.g2_kernel_gx46:
  s_mov_b32 s21, s20
  buffer_load_dwordx4 v[160:163], v10, s[4:7], s21 offen sc1
  s_add_u32 s21, s21, 32768
  buffer_load_dwordx4 v[164:167], v10, s[4:7], s21 offen sc1
  s_add_u32 s21, s21, 32768
  buffer_load_dwordx4 v[168:171], v10, s[4:7], s21 offen sc1
  s_add_u32 s21, s21, 32768
  buffer_load_dwordx4 v[172:175], v10, s[4:7], s21 offen sc1
  s_add_u32 s21, s21, 32768
  buffer_load_dwordx4 v[176:179], v10, s[4:7], s21 offen sc1
  s_add_u32 s21, s21, 32768
  buffer_load_dwordx4 v[180:183], v10, s[4:7], s21 offen sc1
  s_add_u32 s21, s21, 32768
  buffer_load_dwordx4 v[184:187], v10, s[4:7], s21 offen sc1
  s_add_u32 s21, s21, 32768
  buffer_load_dwordx4 v[188:191], v10, s[4:7], s21 offen sc1
  s_add_u32 s21, s21, 32768
  buffer_load_dwordx4 v[192:195], v10, s[4:7], s21 offen sc1
  s_add_u32 s21, s21, 32768
  buffer_load_dwordx4 v[196:199], v10, s[4:7], s21 offen sc1
  s_add_u32 s21, s21, 32768
  buffer_load_dwordx4 v[200:203], v10, s[4:7], s21 offen sc1
  s_add_u32 s21, s21, 32768
  buffer_load_dwordx4 v[204:207], v10, s[4:7], s21 offen sc1
  s_add_u32 s21, s21, 32768
  buffer_load_dwordx4 v[208:211], v10, s[4:7], s21 offen sc1
  s_add_u32 s21, s21, 32768
  buffer_load_dwordx4 v[212:215], v10, s[4:7], s21 offen sc1
  s_add_u32 s21, s21, 32768
  buffer_load_dwordx4 v[216:219], v10, s[4:7], s21 offen sc1
  s_add_u32 s21, s21, 32768
  buffer_load_dwordx4 v[220:223], v10, s[4:7], s21 offen sc1
  s_add_u32 s21, s21, 32768
  buffer_load_dwordx4 v[224:227], v10, s[4:7], s21 offen sc1
  s_add_u32 s21, s21, 32768
  buffer_load_dwordx4 v[228:231], v10, s[4:7], s21 offen sc1
  s_add_u32 s21, s21, 32768
  buffer_load_dwordx4 v[232:235], v10, s[4:7], s21 offen sc1
  s_add_u32 s21, s21, 32768
  buffer_load_dwordx4 v[236:239], v10, s[4:7], s21 offen sc1
  s_add_u32 s21, s21, 32768
  buffer_load_dwordx4 v[240:243], v10, s[4:7], s21 offen sc1
  s_add_u32 s21, s21, 32768
  buffer_load_dwordx4 v[244:247], v10, s[4:7], s21 offen sc1
  s_add_u32 s21, s21, 32768
  buffer_load_dwordx4 v[248:251], v10, s[4:7], s21 offen sc1
  s_add_u32 s21, s21, 32768
  buffer_load_dwordx4 v[252:255], v10, s[4:7], s21 offen sc1
  s_add_u32 s21, s21, 32768
  buffer_load_dwordx4 v[16:19], v10, s[4:7], s21 offen sc1
  s_add_u32 s21, s21, 32768
  buffer_load_dwordx4 v[20:23], v10, s[4:7], s21 offen sc1
  s_add_u32 s21, s21, 32768
  buffer_load_dwordx4 v[24:27], v10, s[4:7], s21 offen sc1
  s_add_u32 s21, s21, 32768
  buffer_load_dwordx4 v[28:31], v10, s[4:7], s21 offen sc1
  s_add_u32 s21, s21, 32768
  s_add_u32 s38, s38, 1
  s_waitcnt vmcnt(0)
  v_min3_u32 v6, v160, v162, v164
  v_min3_u32 v6, v6, v166, v168
  v_min3_u32 v6, v6, v170, v172
  v_min3_u32 v6, v6, v174, v176
  v_min3_u32 v6, v6, v178, v180
  v_min3_u32 v6, v6, v182, v184
  v_min3_u32 v6, v6, v186, v188
  v_min3_u32 v6, v6, v190, v192
  v_min3_u32 v6, v6, v194, v196
  v_min3_u32 v6, v6, v198, v200
  v_min3_u32 v6, v6, v202, v204
  v_min3_u32 v6, v6, v206, v208
  v_min3_u32 v6, v6, v210, v212
  v_min3_u32 v6, v6, v214, v216
  v_min3_u32 v6, v6, v218, v220
  v_min3_u32 v6, v6, v222, v224
  v_min3_u32 v6, v6, v226, v228
  v_min3_u32 v6, v6, v230, v232
  v_min3_u32 v6, v6, v234, v236
  v_min3_u32 v6, v6, v238, v240
  v_min3_u32 v6, v6, v242, v244
  v_min3_u32 v6, v6, v246, v248
  v_min3_u32 v6, v6, v250, v252
  v_min3_u32 v6, v6, v254, v16
  v_min3_u32 v6, v6, v18, v20
  v_min3_u32 v6, v6, v22, v24
  v_min3_u32 v6, v6, v26, v28
  v_min_u32 v6, v6, v30
  v_cmp_eq_u32 vcc, 0, v6
  s_cbranch_vccz .g2_kernel_gx46d
  s_mov_b64 exec, vcc
  s_sleep 1
  s_cmp_lg_u32 s62, 0
  s_cbranch_scc1 .g2_kernel_nap47
  s_sleep 11
.g2_kernel_nap47:
  s_cmp_lt_u32 s38, 131072
  s_cbranch_scc1 .g2_kernel_gx46
.g2_kernel_gx46d:
  s_mov_b64 exec, -1
  v_add_f32 v164, v164, v160
  v_add_f32 v165, v165, v161
  v_add_f32 v166, v166, v162
  v_add_f32 v167, v167, v163
  v_add_f32 v172, v172, v168
  v_add_f32 v173, v173, v169
  v_add_f32 v174, v174, v170
  v_add_f32 v175, v175, v171
  v_add_f32 v180, v180, v176
  v_add_f32 v181, v181, v177
  v_add_f32 v182, v182, v178
  v_add_f32 v183, v183, v179
  v_add_f32 v188, v188, v184
  v_add_f32 v189, v189, v185
  v_add_f32 v190, v190, v186
  v_add_f32 v191, v191, v187
  v_add_f32 v196, v196, v192
  v_add_f32 v197, v197, v193
  v_add_f32 v198, v198, v194
  v_add_f32 v199, v199, v195
  v_add_f32 v204, v204, v200
  v_add_f32 v205, v205, v201
  v_add_f32 v206, v206, v202
  v_add_f32 v207, v207, v203
  v_add_f32 v212, v212, v208
  v_add_f32 v213, v213, v209
  v_add_f32 v214, v214, v210
  v_add_f32 v215, v215, v211
  v_add_f32 v220, v220, v216
  v_add_f32 v221, v221, v217
  v_add_f32 v222, v222, v218
  v_add_f32 v223, v223, v219
  v_add_f32 v228, v228, v224
  v_add_f32 v229, v229, v225
  v_add_f32 v230, v230, v226
  v_add_f32 v231, v231, v227
  v_add_f32 v236, v236, v232
  v_add_f32 v237, v237, v233
  v_add_f32 v238, v238, v234
  v_add_f32 v239, v239, v235
  v_add_f32 v244, v244, v240
  v_add_f32 v245, v245, v241
  v_add_f32 v246, v246, v242
  v_add_f32 v247, v247, v243
  v_add_f32 v252, v252, v248
  v_add_f32 v253, v253, v249
  v_add_f32 v254, v254, v250
  v_add_f32 v255, v255, v251
  v_add_f32 v20, v20, v16
  v_add_f32 v21, v21, v17
  v_add_f32 v22, v22, v18
  v_add_f32 v23, v23, v19
  v_add_f32 v28, v28, v24
  v_add_f32 v29, v29, v25
  v_add_f32 v30, v30, v26
  v_add_f32 v31, v31, v27
  v_add_f32 v172, v172, v164
  v_add_f32 v173, v173, v165
  v_add_f32 v174, v174, v166
  v_add_f32 v175, v175, v167
  v_add_f32 v188, v188, v180
  v_add_f32 v189, v189, v181
  v_add_f32 v190, v190, v182
  v_add_f32 v191, v191, v183
  v_add_f32 v204, v204, v196
  v_add_f32 v205, v205, v197
  v_add_f32 v206, v206, v198
  v_add_f32 v207, v207, v199
  v_add_f32 v220, v220, v212
  v_add_f32 v221, v221, v213
  v_add_f32 v222, v222, v214
  v_add_f32 v223, v223, v215
  v_add_f32 v236, v236, v228
  v_add_f32 v237, v237, v229
  v_add_f32 v238, v238, v230
  v_add_f32 v239, v239, v231
  v_add_f32 v252, v252, v244
  v_add_f32 v253, v253, v245
  v_add_f32 v254, v254, v246
  v_add_f32 v255, v255, v247
  v_add_f32 v28, v28, v20
  v_add_f32 v29, v29, v21
  v_add_f32 v30, v30, v22
  v_add_f32 v31, v31, v23
  v_add_f32 v188, v188, v172
  v_add_f32 v189, v189, v173
  v_add_f32 v190, v190, v174
  v_add_f32 v191, v191, v175
  v_add_f32 v220, v220, v204
  v_add_f32 v221, v221, v205
  v_add_f32 v222, v222, v206
  v_add_f32 v223, v223, v207
  v_add_f32 v252, v252, v236
  v_add_f32 v253, v253, v237
  v_add_f32 v254, v254, v238
  v_add_f32 v255, v255, v239
  v_add_f32 v220, v220, v188
  v_add_f32 v221, v221, v189
  v_add_f32 v222, v222, v190
  v_add_f32 v223, v223, v191
  v_add_f32 v28, v28, v252
  v_add_f32 v29, v29, v253
  v_add_f32 v30, v30, v254
  v_add_f32 v31, v31, v255
  v_add_f32 v28, v28, v220
  v_add_f32 v29, v29, v221
  v_add_f32 v30, v30, v222
  v_add_f32 v31, v31, v223
  v_add_f32 v28, v28, v28 quad_perm:[1,0,3,2] row_mask:0xf bank_mask:0xf
  v_add_f32 v29, v29, v29 quad_perm:[1,0,3,2] row_mask:0xf bank_mask:0xf
  v_add_f32 v30, v30, v30 quad_perm:[1,0,3,2] row_mask:0xf bank_mask:0xf
  v_add_f32 v31, v31, v31 quad_perm:[1,0,3,2] row_mask:0xf bank_mask:0xf
  v_add_f32 v28, v28, v28 quad_perm:[2,3,0,1] row_mask:0xf bank_mask:0xf
  v_add_f32 v29, v29, v29 quad_perm:[2,3,0,1] row_mask:0xf bank_mask:0xf
  v_add_f32 v30, v30, v30 quad_perm:[2,3,0,1] row_mask:0xf bank_mask:0xf
  v_add_f32 v31, v31, v31 quad_perm:[2,3,0,1] row_mask:0xf bank_mask:0xf
  v_add_f32 v28, v28, v28 row_half_mirror row_mask:0xf bank_mask:0xf
  v_add_f32 v29, v29, v29 row_half_mirror row_mask:0xf bank_mask:0xf
  v_add_f32 v30, v30, v30 row_half_mirror row_mask:0xf bank_mask:0xf
  v_add_f32 v31, v31, v31 row_half_mirror row_mask:0xf bank_mask:0xf
  v_mul_f32 v28, v28, v62
  v_mul_f32 v29, v29, v62
  v_mul_f32 v30, v30, v62
  v_mul_f32 v31, v31, v62
  v_cvt_pk_bf16_f32 v16, v28, v29
  v_cvt_pk_bf16_f32 v17, v30, v31
  s_mov_b32 s28, 0x00010001
  s_mov_b32 s29, 0x00010001
  v_mov_b32 v18, v16 row_ror:8 row_mask:0xf bank_mask:0xf
  v_mov_b32 v19, v17 row_ror:8 row_mask:0xf bank_mask:0xf
  v_lshlrev_b32 v28, 16, v16
  v_and_b32 v29, 0xffff0000, v16
  v_lshlrev_b32 v30, 16, v17
  v_and_b32 v31, 0xffff0000, v17
  v_cndmask_b32 v32, 0, v16, s[28:29]
  v_cndmask_b32 v33, 0, v17, s[28:29]
  v_cndmask_b32 v34, 0, v18, s[28:29]
  v_cndmask_b32 v35, 0, v19, s[28:29]
  s_lshl_b64 s[28:29], s[28:29], 1
  s_nop 0
  v_mfma_f32_16x16x32_bf16 v[160:163], v[32:35], v[64:67], 0
  v_mfma_f32_16x16x32_bf16 v[164:167], v[32:35], v[80:83], 0
  v_mfma_f32_16x16x32_bf16 v[168:171], v[32:35], v[96:99], 0
  v_mfma_f32_16x16x32_bf16 v[172:175], v[32:35], v[112:115], 0
  v_mfma_f32_16x16x32_bf16 v[176:179], v[32:35], v[128:131], 0
  v_mfma_f32_16x16x32_bf16 v[180:183], v[32:35], v[144:147], 0
  v_cndmask_b32 v36, 0, v16, s[28:29]
  v_cndmask_b32 v37, 0, v17, s[28:29]
  v_cndmask_b32 v38, 0, v18, s[28:29]
  v_cndmask_b32 v39, 0, v19, s[28:29]
  s_lshl_b64 s[28:29], s[28:29], 1
  s_nop 0
  v_mfma_f32_16x16x32_bf16 v[160:163], v[36:39], v[68:71], v[160:163]
  v_mfma_f32_16x16x32_bf16 v[164:167], v[36:39], v[84:87], v[164:167]
  v_mfma_f32_16x16x32_bf16 v[168:171], v[36:39], v[100:103], v[168:171]
  v_mfma_f32_16x16x32_bf16 v[172:175], v[36:39], v[116:119], v[172:175]
  v_mfma_f32_16x16x32_bf16 v[176:179], v[36:39], v[132:135], v[176:179]
  v_mfma_f32_16x16x32_bf16 v[180:183], v[36:39], v[148:151], v[180:183]
  v_cndmask_b32 v40, 0, v16, s[28:29]
  v_cndmask_b32 v41, 0, v17, s[28:29]
  v_cndmask_b32 v42, 0, v18, s[28:29]
  v_cndmask_b32 v43, 0, v19, s[28:29]
  s_lshl_b64 s[28:29], s[28:29], 1
  s_nop 0
  v_mfma_f32_16x16x32_bf16 v[160:163], v[40:43], v[72:75], v[160:163]
  v_mfma_f32_16x16x32_bf16 v[164:167], v[40:43], v[88:91], v[164:167]
  v_mfma_f32_16x16x32_bf16 v[168:171], v[40:43], v[104:107], v[168:171]
  v_mfma_f32_16x16x32_bf16 v[172:175], v[40:43], v[120:123], v[172:175]
  v_mfma_f32_16x16x32_bf16 v[176:179], v[40:43], v[136:139], v[176:179]
  v_mfma_f32_16x16x32_bf16 v[180:183], v[40:43], v[152:155], v[180:183]
  v_cndmask_b32 v44, 0, v16, s[28:29]
  v_cndmask_b32 v45, 0, v17, s[28:29]
  v_cndmask_b32 v46, 0, v18, s[28:29]
  v_cndmask_b32 v47, 0, v19, s[28:29]
  s_lshl_b64 s[28:29], s[28:29], 1
  s_nop 0
  v_mfma_f32_16x16x32_bf16 v[160:163], v[44:47], v[76:79], v[160:163]
  v_mfma_f32_16x16x32_bf16 v[164:167], v[44:47], v[92:95], v[164:167]
  v_mfma_f32_16x16x32_bf16 v[168:171], v[44:47], v[108:111], v[168:171]
  v_mfma_f32_16x16x32_bf16 v[172:175], v[44:47], v[124:127], v[172:175]
  v_mfma_f32_16x16x32_bf16 v[176:179], v[44:47], v[140:143], v[176:179]
  v_mfma_f32_16x16x32_bf16 v[180:183], v[44:47], v[156:159], v[180:183]
  v_add_f32 v56, v56, v28
  v_add_f32 v57, v57, v29
  v_add_f32 v58, v58, v30
  v_add_f32 v59, v59, v31
  v_add_f32 v20, v56, v57
  v_mul_f32 v22, v56, v56
  v_add_f32 v21, v58, v59
  v_fmac_f32 v22, v57, v57
  v_add_f32 v20, v20, v21
  v_fmac_f32 v22, v58, v58
  v_fmac_f32 v22, v59, v59
  v_or_b32 v28, 1, v28
  v_or_b32 v30, 1, v30
  v_add_f32 v20, v20, v20 row_ror:8 row_mask:0xf bank_mask:0xf
  v_add_f32 v22, v22, v22 row_ror:8 row_mask:0xf bank_mask:0xf
  v_lshlrev_b32 v11, 4, v12
  v_add_f32 v20, v20, v20 row_bcast:15 row_mask:0xa bank_mask:0xf
  v_add_f32 v22, v22, v22 row_bcast:15 row_mask:0xa bank_mask:0xf
  s_mov_b32 exec_lo, 0x01010101
  s_mov_b32 exec_hi, 0x01010101
  buffer_store_dwordx4 v[28:31], v11, s[4:7], s26 offen offset:768 sc1
  buffer_store_dwordx4 v[28:31], v11, s[4:7], s25 offen offset:768 sc1
  s_mov_b64 exec, -1
  v_add_f32 v20, v20, v20 row_bcast:31 row_mask:0xc bank_mask:0xf
  v_add_f32 v22, v22, v22 row_bcast:31 row_mask:0xc bank_mask:0xf
  v_or_b32 v20, 1, v20
  v_or_b32 v22, 1, v22
  s_mov_b32 exec_lo, 0
  s_mov_b32 exec_hi, 0x80000000
  buffer_store_dwordx4 v[20:23], v4, s[4:7], s26 offen offset:896 sc1
  buffer_store_dwordx4 v[20:23], v4, s[4:7], s25 offen offset:896 sc1
  s_mov_b64 exec, 0xffff
  v_or_b32 v160, 1, v160
  v_or_b32 v162, 1, v162
  buffer_store_dwordx4 v[160:163], v3, s[4:7], s26 offen offset:0 sc1
  v_or_b32 v164, 1, v164
  v_or_b32 v166, 1, v166
  buffer_store_dwordx4 v[164:167], v3, s[4:7], s25 offen offset:0 sc1
  v_or_b32 v168, 1, v168
  v_or_b32 v170, 1, v170
  buffer_store_dwordx4 v[168:171], v3, s[4:7], s26 offen offset:256 sc1
  v_or_b32 v172, 1, v172
  v_or_b32 v174, 1, v174
  buffer_store_dwordx4 v[172:175], v3, s[4:7], s25 offen offset:256 sc1
  v_or_b32 v176, 1, v176
  v_or_b32 v178, 1, v178
  buffer_store_dwordx4 v[176:179], v3, s[4:7], s26 offen offset:512 sc1
  v_or_b32 v180, 1, v180
  v_or_b32 v182, 1, v182
  buffer_store_dwordx4 v[180:183], v3, s[4:7], s25 offen offset:512 sc1
  s_mov_b64 exec, -1
  s_cmp_eq_u32 s79, 0
  s_cbranch_scc1 .g2_kernel_c_no
  s_lshl_b32 s20, s18, 15
  s_add_u32 s20, s20, 0x1190000
  s_lshl_b32 s22, s18, 11
  s_add_u32 s22, s22, s20
  v_lshlrev_b32 v16, 10, v2
  s_sleep 16
  s_mov_b32 s38, 0
  s_mov_b32 exec_hi, 0
.g2_kernel_gx48:
  buffer_load_dword v17, v16, s[4:7], s20 offen offset:752 sc1
  s_add_u32 s38, s38, 1
  s_waitcnt vmcnt(0)
  v_min_u32 v6, v17, v17
  v_cmp_eq_u32 vcc, 0, v6
  s_cbranch_vccz .g2_kernel_gx48d
  s_mov_b64 exec, vcc
  s_sleep 6
  s_cmp_lt_u32 s38, 131072
  s_cbranch_scc1 .g2_kernel_gx48
.g2_kernel_gx48d:
  s_mov_b64 exec, -1
  s_mov_b32 s38, 0
  s_bfm_b64 exec, 57, 0
.g2_kernel_gx49:
  s_mov_b32 s21, s20
  buffer_load_dwordx4 v[64:67], v3, s[4:7], s21 offen offset:0 sc1
  buffer_load_dwordx4 v[68:71], v3, s[4:7], s21 offen offset:1024 sc1
  buffer_load_dwordx4 v[72:75], v3, s[4:7], s21 offen offset:2048 sc1
  buffer_load_dwordx4 v[76:79], v3, s[4:7], s21 offen offset:3072 sc1
  s_add_u32 s21, s21, 4096
  buffer_load_dwordx4 v[80:83], v3, s[4:7], s21 offen offset:0 sc1
  buffer_load_dwordx4 v[84:87], v3, s[4:7], s21 offen offset:1024 sc1
  buffer_load_dwordx4 v[88:91], v3, s[4:7], s21 offen offset:2048 sc1
  buffer_load_dwordx4 v[92:95], v3, s[4:7], s21 offen offset:3072 sc1
  s_add_u32 s21, s21, 4096
  buffer_load_dwordx4 v[96:99], v3, s[4:7], s21 offen offset:0 sc1
  buffer_load_dwordx4 v[100:103], v3, s[4:7], s21 offen offset:1024 sc1
  buffer_load_dwordx4 v[104:107], v3, s[4:7], s21 offen offset:2048 sc1
  buffer_load_dwordx4 v[108:111], v3, s[4:7], s21 offen offset:3072 sc1
  s_add_u32 s21, s21, 4096
  buffer_load_dwordx4 v[112:115], v3, s[4:7], s21 offen offset:0 sc1
  buffer_load_dwordx4 v[116:119], v3, s[4:7], s21 offen offset:1024 sc1
  buffer_load_dwordx4 v[120:123], v3, s[4:7], s21 offen offset:2048 sc1
  buffer_load_dwordx4 v[124:127], v3, s[4:7], s21 offen offset:3072 sc1
  s_add_u32 s21, s21, 4096
  buffer_load_dwordx4 v[128:131], v3, s[4:7], s21 offen offset:0 sc1
  buffer_load_dwordx4 v[132:135], v3, s[4:7], s21 offen offset:1024 sc1
  buffer_load_dwordx4 v[136:139], v3, s[4:7], s21 offen offset:2048 sc1
  buffer_load_dwordx4 v[140:143], v3, s[4:7], s21 offen offset:3072 sc1
  s_add_u32 s21, s21, 4096
  buffer_load_dwordx4 v[144:147], v3, s[4:7], s21 offen offset:0 sc1
  buffer_load_dwordx4 v[148:151], v3, s[4:7], s21 offen offset:1024 sc1
  buffer_load_dwordx4 v[152:155], v3, s[4:7], s21 offen offset:2048 sc1
  buffer_load_dwordx4 v[156:159], v3, s[4:7], s21 offen offset:3072 sc1
  s_add_u32 s21, s21, 4096
  buffer_load_dwordx4 v[160:163], v3, s[4:7], s21 offen offset:0 sc1
  buffer_load_dwordx4 v[164:167], v3, s[4:7], s21 offen offset:1024 sc1
  buffer_load_dwordx4 v[168:171], v3, s[4:7], s21 offen offset:2048 sc1
  buffer_load_dwordx4 v[172:175], v3, s[4:7], s21 offen offset:3072 sc1
  s_add_u32 s21, s21, 4096
  buffer_load_dwordx4 v[176:179], v3, s[4:7], s21 offen offset:0 sc1
  buffer_load_dwordx4 v[180:183], v3, s[4:7], s21 offen offset:1024 sc1
  buffer_load_dwordx4 v[184:187], v3, s[4:7], s21 offen offset:2048 sc1
  buffer_load_dwordx4 v[188:191], v3, s[4:7], s21 offen offset:3072 sc1
  s_add_u32 s21, s21, 4096
  buffer_load_dwordx4 v[192:195], v3, s[4:7], s22 offen offset:0 sc1
  buffer_load_dwordx4 v[196:199], v3, s[4:7], s22 offen offset:1024 sc1
  s_add_u32 s38, s38, 1
  s_waitcnt vmcnt(0)
  v_min3_u32 v6, v64, v66, v68
  v_min3_u32 v6, v6, v70, v72
  v_min3_u32 v6, v6, v74, v76
  v_min3_u32 v6, v6, v78, v80
  v_min3_u32 v6, v6, v82, v84
  v_min3_u32 v6, v6, v86, v88
  v_min3_u32 v6, v6, v90, v92
  v_min3_u32 v6, v6, v94, v96
  v_min3_u32 v6, v6, v98, v100
  v_min3_u32 v6, v6, v102, v104
  v_min3_u32 v6, v6, v106, v108
  v_min3_u32 v6, v6, v110, v112
  v_min3_u32 v6, v6, v114, v116
  v_min3_u32 v6, v6, v118, v120
  v_min3_u32 v6, v6, v122, v124
  v_min3_u32 v6, v6, v126, v128
  v_min3_u32 v6, v6, v130, v132
  v_min3_u32 v6, v6, v134, v136
  v_min3_u32 v6, v6, v138, v140
  v_min3_u32 v6, v6, v142, v144
  v_min3_u32 v6, v6, v146, v148
  v_min3_u32 v6, v6, v150, v152
  v_min3_u32 v6, v6, v154, v156
  v_min3_u32 v6, v6, v158, v160
  v_min3_u32 v6, v6, v162, v164
  v_min3_u32 v6, v6, v166, v168
  v_min3_u32 v6, v6, v170, v172
  v_min3_u32 v6, v6, v174, v176
  v_min3_u32 v6, v6, v178, v180
  v_min3_u32 v6, v6, v182, v184
  v_min3_u32 v6, v6, v186, v188
  v_min3_u32 v6, v6, v190, v192
  v_min3_u32 v6, v6, v194, v196
  v_min_u32 v6, v6, v198
  v_cmp_eq_u32 vcc, 0, v6
  s_cbranch_vccz .g2_kernel_gx49d
  s_mov_b64 exec, vcc
  s_sleep 2
  s_cmp_lt_u32 s38, 131072
  s_cbranch_scc1 .g2_kernel_gx49
.g2_kernel_gx49d:
  s_mov_b64 exec, -1
  v_add_f32 v64, v64, v128
  v_add_f32 v65, v65, v129
  v_add_f32 v66, v66, v130
  v_add_f32 v67, v67, v131
  v_add_f32 v68, v68, v132
  v_add_f32 v69, v69, v133
  v_add_f32 v70, v70, v134
  v_add_f32 v71, v71, v135
  v_add_f32 v72, v72, v136
  v_add_f32 v73, v73, v137
  v_add_f32 v74, v74, v138
  v_add_f32 v75, v75, v139
  v_add_f32 v76, v76, v140
  v_add_f32 v77, v77, v141
  v_add_f32 v78, v78, v142
  v_add_f32 v79, v79, v143
  v_add_f32 v80, v80, v144
  v_add_f32 v81, v81, v145
  v_add_f32 v82, v82, v146
  v_add_f32 v83, v83, v147
  v_add_f32 v84, v84, v148
  v_add_f32 v85, v85, v149
  v_add_f32 v86, v86, v150
  v_add_f32 v87, v87, v151
  v_add_f32 v88, v88, v152
  v_add_f32 v89, v89, v153
  v_add_f32 v90, v90, v154
  v_add_f32 v91, v91, v155
  v_add_f32 v92, v92, v156
  v_add_f32 v93, v93, v157
  v_add_f32 v94, v94, v158
  v_add_f32 v95, v95, v159
  v_add_f32 v96, v96, v160
  v_add_f32 v97, v97, v161
  v_add_f32 v98, v98, v162
  v_add_f32 v99, v99, v163
  v_add_f32 v100, v100, v164
  v_add_f32 v101, v101, v165
  v_add_f32 v102, v102, v166
  v_add_f32 v103, v103, v167
  v_add_f32 v104, v104, v168
  v_add_f32 v105, v105, v169
  v_add_f32 v106, v106, v170
  v_add_f32 v107, v107, v171
  v_add_f32 v108, v108, v172
  v_add_f32 v109, v109, v173
  v_add_f32 v110, v110, v174
  v_add_f32 v111, v111, v175
  v_add_f32 v112, v112, v176
  v_add_f32 v113, v113, v177
  v_add_f32 v114, v114, v178
  v_add_f32 v115, v115, v179
  v_add_f32 v116, v116, v180
  v_add_f32 v117, v117, v181
  v_add_f32 v118, v118, v182
  v_add_f32 v119, v119, v183
  v_add_f32 v120, v120, v184
  v_add_f32 v121, v121, v185
  v_add_f32 v122, v122, v186
  v_add_f32 v123, v123, v187
  v_add_f32 v124, v124, v188
  v_add_f32 v125, v125, v189
  v_add_f32 v126, v126, v190
  v_add_f32 v127, v127, v191
  v_add_f32 v64, v64, v96
  v_add_f32 v65, v65, v97
  v_add_f32 v66, v66, v98
  v_add_f32 v67, v67, v99
  v_add_f32 v68, v68, v100
  v_add_f32 v69, v69, v101
  v_add_f32 v70, v70, v102
  v_add_f32 v71, v71, v103
  v_add_f32 v72, v72, v104
  v_add_f32 v73, v73, v105
  v_add_f32 v74, v74, v106
  v_add_f32 v75, v75, v107
  v_add_f32 v76, v76, v108
  v_add_f32 v77, v77, v109
  v_add_f32 v78, v78, v110
  v_add_f32 v79, v79, v111
  v_add_f32 v80, v80, v112
  v_add_f32 v81, v81, v113
  v_add_f32 v82, v82, v114
  v_add_f32 v83, v83, v115
  v_add_f32 v84, v84, v116
  v_add_f32 v85, v85, v117
  v_add_f32 v86, v86, v118
  v_add_f32 v87, v87, v119
  v_add_f32 v88, v88, v120
  v_add_f32 v89, v89, v121
  v_add_f32 v90, v90, v122
  v_add_f32 v91, v91, v123
  v_add_f32 v92, v92, v124
  v_add_f32 v93, v93, v125
  v_add_f32 v94, v94, v126
  v_add_f32 v95, v95, v127
  v_add_f32 v64, v64, v80
  v_add_f32 v65, v65, v81
  v_add_f32 v66, v66, v82
  v_add_f32 v67, v67, v83
  v_add_f32 v68, v68, v84
  v_add_f32 v69, v69, v85
  v_add_f32 v70, v70, v86
  v_add_f32 v71, v71, v87
  v_add_f32 v72, v72, v88
  v_add_f32 v73, v73, v89
  v_add_f32 v74, v74, v90
  v_add_f32 v75, v75, v91
  v_add_f32 v76, v76, v92
  v_add_f32 v77, v77, v93
  v_add_f32 v78, v78, v94
  v_add_f32 v79, v79, v95
  v_add_f32 v64, v64, v72
  v_add_f32 v65, v65, v73
  v_add_f32 v66, v66, v74
  v_add_f32 v67, v67, v75
  v_add_f32 v68, v68, v76
  v_add_f32 v69, v69, v77
  v_add_f32 v70, v70, v78
  v_add_f32 v71, v71, v79
  v_add_f32 v64, v64, v68
  v_add_f32 v65, v65, v69
  v_add_f32 v66, v66, v70
  v_add_f32 v67, v67, v71
  v_mov_b32 v28, 0.0009765625
  v_mov_b32 v30, 1e-05
  v_readlane_b32 s21, v64, 56
  v_readlane_b32 s22, v66, 56
  s_nop 0
  v_mul_f32 v20, s21, v28
  v_fma_f32 v21, s22, v28, v30
  v_fma_f32 v21, -v20, v20, v21
  v_rsq_f32 v21, abs(v21)
  v_sub_f32 v20, v61, v20
  v_mul_f32 v22, v21, v60
  v_mul_f32 v23, v21, v20
  v_and_b32 v10, 15, v2
  v_lshrrev_b32 v11, 4, v2
  v_lshlrev_b32 v16, 2, v10
  v_lshl_add_u32 v16, v11, 8, v16
  v_add_u32 v16, 155648, v16
  s_sub_u32 s20, s79, 1
  s_and_b32 s21, s20, 3
  s_lshl_b32 s21, s21, 2
  s_add_u32 s21, s21, 156160
  v_lshl_add_u32 v17, v10, 4, s21
  v_cmp_eq_u32 vcc, 2, v11
  v_mov_b32 v18, 64
  v_mov_b32 v19, 256
  v_cndmask_b32 v17, v16, v17, vcc
  v_cndmask_b32 v18, v18, v19, vcc
  v_lshrrev_b32 v24, 2, v10
  v_lshlrev_b32 v24, 9, v24
  v_and_b32 v25, 3, v10
  v_lshl_add_u32 v24, v25, 1, v24
  s_and_b32 s21, s20, 31
  s_lshl_b32 s22, s21, 4
  s_lshr_b32 s23, s20, 5
  s_lshl_b32 s24, s23, 11
  s_add_u32 s22, s22, s24
  s_add_u32 s22, s22, 131072
  v_add_u32 v26, s22, v24
  s_and_b32 s22, s21, 7
  s_and_b32 s24, s21, 8
  s_lshl_b32 s24, s24, 1
  s_add_u32 s22, s22, s24
  s_and_b32 s24, s21, 16
  s_lshr_b32 s24, s24, 1
  s_add_u32 s22, s22, s24
  s_lshl_b32 s22, s22, 4
  v_add_u32 v24, s22, v24
  s_bfe_u32 s22, s21, 0x20002
  s_lshl_b32 s22, s22, 9
  s_add_u32 s22, s22, s24
  s_and_b32 s24, s21, 3
  s_lshl_b32 s24, s24, 1
  s_add_u32 s22, s22, s24
  s_add_u32 s22, s22, 2048
  v_lshl_add_u32 v25, v10, 4, s22
  v_cndmask_b32 v24, v24, v25, vcc
  v_cndmask_b32 v19, 8, v19, vcc
  v_add_u32 v25, v24, v19
  s_lshl_b32 s22, s18, 7
  s_lshl_b32 s24, s17, 2
  s_add_u32 s22, s22, s24
  s_add_u32 s22, s22, s23
  s_lshl_b32 s22, s22, 12
  s_add_u32 s22, s22, 0x1800000
  s_add_u32 s23, s22, 262144
  s_lshr_b32 s24, s20, 6
  s_lshl_b32 s24, s24, 8
  s_add_u32 s24, s24, s76
  v_cmp_eq_u32 vcc, 0, v11
  v_mov_b32 v27, 0.25503486164919736
  s_nop 0
  v_cndmask_b32 v27, 1.0, v27, vcc
  v_mul_f32 v21, v21, v27
  v_mul_f32 v22, v22, v27
  v_mul_f32 v23, v23, v27
  s_mov_b32 s62, 1
  s_mov_b32 s63, 0x1800000
  s_mov_b32 s70, 2
  s_mov_b32 s71, 155776
  v_mov_b32 v6, s71
  s_mov_b32 s38, 0
.g2_kernel_wg50:
  ds_read_b32 v7, v6 offset:56
  s_add_u32 s38, s38, 1
  s_waitcnt lgkmcnt(0)
  v_cmp_le_u32 vcc, 2, v7
  s_cbranch_vccnz .g2_kernel_wg50d
  s_sleep 1
  s_cmp_lt_u32 s38, 524288
  s_cbranch_scc1 .g2_kernel_wg50
.g2_kernel_wg50d:
  ds_read_b32 v32, v17 offset:5632
  ds_read_b32 v36, v16 offset:4864
  v_add_u32 v17, v17, v18
  ds_read_b32 v33, v17 offset:5632
  ds_read_b32 v37, v16 offset:4928
  v_add_u32 v17, v17, v18
  ds_read_b32 v34, v17 offset:5632
  ds_read_b32 v38, v16 offset:4992
  v_add_u32 v17, v17, v18
  ds_read_b32 v35, v17 offset:5632
  ds_read_b32 v39, v16 offset:5056
  s_waitcnt lgkmcnt(0)
  v_mul_f32 v32, v32, v22
  v_fmac_f32 v32, v64, v21
  v_fmac_f32 v32, v36, v23
  v_mul_f32 v33, v33, v22
  v_fmac_f32 v33, v65, v21
  v_fmac_f32 v33, v37, v23
  v_mul_f32 v34, v34, v22
  v_fmac_f32 v34, v66, v21
  v_fmac_f32 v34, v38, v23
  v_mul_f32 v35, v35, v22
  v_fmac_f32 v35, v67, v21
  v_fmac_f32 v35, v39, v23
  v_cvt_pk_bf16_f32 v32, v32, v33
  v_cvt_pk_bf16_f32 v34, v34, v35
  v_mov_b32 v9, s71
  v_mov_b32 v8, 2
  s_mov_b32 exec_lo, 0xffff0000
  s_mov_b32 exec_hi, 0xffff
  buffer_store_short v32, v24, s[4:7], s22 offen sc1
  buffer_store_short_d16_hi v32, v25, s[4:7], s22 offen sc1
  buffer_store_short v34, v24, s[4:7], s23 offen sc1
  buffer_store_short_d16_hi v34, v25, s[4:7], s23 offen sc1
  s_mov_b64 exec, 0xffff
  ds_write_b16 v26, v32 offset:8192
  ds_write_b16_d16_hi v26, v32 offset:8200
  ds_write_b16 v26, v34
  ds_write_b16_d16_hi v26, v34 offset:8
  ds_write_b32 v9, v5 offset:60
  s_mov_b32 exec_lo, 0
  s_mov_b32 exec_hi, 0xff0000
  ds_write_b32 v16, v192 offset:6912
  ds_write_b32 v16, v193 offset:6976
  ds_write_b32 v16, v194 offset:7040
  ds_write_b32 v16, v195 offset:7104
  ds_write_b32 v16, v196 offset:6944
  ds_write_b32 v16, v197 offset:7008
  ds_write_b32 v16, v198 offset:7072
  ds_write_b32 v16, v199 offset:7136
  s_mov_b64 exec, 1
  s_waitcnt vmcnt(0)
  buffer_store_dword v8, v4, s[4:7], s24 offen sc1
  buffer_store_dword v8, v4, s[4:7], s24 offen offset:128 sc1
  s_mov_b64 exec, -1
  s_branch .g2_kernel_v
.g2_kernel_c_no:
  s_mov_b32 s62, 1
  s_mov_b32 s63, 0x1800000
  s_mov_b32 s70, 2
  s_mov_b32 s71, 155776
  s_branch .g2_kernel_v
.g2_kernel_c_t3:
  s_lshr_b32 s33, s77, 7
  s_lshl_b32 s28, s33, 4
  s_lshl_b64 s[34:35], 0xffff, s28
  s_lshr_b32 s28, s33, 2
  s_cmp_eq_u32 s28, 0
  s_cselect_b64 s[8:9], s[34:35], 0
  s_cmp_eq_u32 s28, 1
  s_cselect_b64 s[10:11], s[34:35], 0
  s_cmp_eq_u32 s28, 2
  s_cselect_b64 s[12:13], s[34:35], 0
  s_cmp_eq_u32 s28, 3
  s_cselect_b64 s[14:15], s[34:35], 0
  s_lshl_b32 s21, s17, 10
  s_add_u32 s21, s21, 0x2880000
  v_lshlrev_b32 v14, 3, v2
  v_add_u32 v14, 155648, v14
  v_mov_b32 v9, s71
  s_cmp_eq_u32 s33, s17
  s_cbranch_scc0 .g2_kernel_c_u1
  s_sleep 6
  s_call_b64 s[72:73], .g2_kernel_c_ph2
  s_branch .g2_kernel_c_u2
.g2_kernel_c_u1:
  v_mov_b32 v6, s71
  s_mov_b32 s38, 0
.g2_kernel_wg51:
  ds_read_b32 v7, v6 offset:36
  s_add_u32 s38, s38, 1
  s_waitcnt lgkmcnt(0)
  v_cmp_le_u32 vcc, 1, v7
  s_cbranch_vccnz .g2_kernel_wg51d
  s_sleep 1
  s_cmp_lt_u32 s38, 524288
  s_cbranch_scc1 .g2_kernel_wg51
.g2_kernel_wg51d:
  v_readfirstlane_b32 s77, v7
  s_sub_u32 s77, s77, 1
.g2_kernel_c_u2:
  s_mov_b32 s38, 0
.g2_kernel_gx52:
  buffer_load_dwordx4 v[16:19], v3, s[4:7], s21 offen sc1
  s_add_u32 s38, s38, 1
  s_waitcnt vmcnt(0)
  v_min_u32 v6, v17, v19
  v_cmp_eq_u32 vcc, 0, v6
  s_cbranch_vccz .g2_kernel_gx52d
  s_mov_b64 exec, vcc
  s_cmp_lt_u32 s38, 131072
  s_cbranch_scc1 .g2_kernel_gx52
.g2_kernel_gx52d:
  s_mov_b64 exec, -1
  s_lshr_b32 s28, s77, 7
  s_and_b32 s79, s77, 127
  s_add_u32 s79, s79, 1
  s_cmp_eq_u32 s28, s17
  s_cselect_b32 s79, s79, 0
  v_rsq_f32 v22, v17
  v_rsq_f32 v23, v19
  v_mov_b32 v15, s79
  v_add_f32 v52, 1.0, v22
  v_mul_f32 v54, v16, v22
  v_sub_f32 v54, 0, v54
  v_add_f32 v53, 1.0, v23
  v_mul_f32 v55, v18, v23
  v_sub_f32 v55, 0, v55
  ds_write_b64 v14, v[52:53] offset:3840
  ds_write_b64 v14, v[54:55] offset:4352
  ds_write_b32 v9, v15 offset:32
  ds_write_b32 v9, v5 offset:28
  s_cmp_eq_u32 s33, s17
  s_cbranch_scc1 .g2_kernel_fin
  s_sleep 40
  s_mov_b32 s39, 1
  s_call_b64 s[72:73], .g2_kernel_c_ph2
  s_branch .g2_kernel_fin
.g2_kernel_c_ph2:
  s_call_b64 s[68:69], .g2_kernel_amax
  v_mov_b32 v6, s71
  s_mov_b32 s38, 0
.g2_kernel_wg53:
  ds_read_b32 v7, v6 offset:36
  s_add_u32 s38, s38, 1
  s_waitcnt lgkmcnt(0)
  v_cmp_le_u32 vcc, 1, v7
  s_cbranch_vccnz .g2_kernel_wg53d
  s_cmp_lt_u32 s38, 524288
  s_cbranch_scc1 .g2_kernel_wg53
.g2_kernel_wg53d:
  ds_read_b32 v8, v9 offset:96
  v_readfirstlane_b32 s28, v7
  s_sub_u32 s28, s28, 1
  s_add_u32 s29, s77, 2
  s_waitcnt lgkmcnt(0)
  v_cmp_gt_f32 vcc, s27, v8
  s_cmp_lg_u64 vcc, 0
  s_cselect_b32 s77, s77, s28
  s_cselect_b32 s29, s29, 1
  v_mov_b32 v10, s29
  v_mov_b32 v11, s27
  ds_write_b64 v9, v[10:11] offset:88
  s_setpc_b64 s[72:73]
.g2_kernel_c2:
  s_cmp_lg_u32 s62, 0
  s_cbranch_scc1 .g2_kernel_d_a
  s_cmp_lg_u32 s16, 7
  s_cbranch_scc1 .g2_kernel_d_a
  v_mov_b32 v6, s71
  s_mov_b32 s38, 0
.g2_kernel_wg56:
  ds_read_b32 v7, v6 offset:20
  s_add_u32 s38, s38, 1
  s_waitcnt lgkmcnt(0)
  v_cmp_le_u32 vcc, 4, v7
  s_cbranch_vccnz .g2_kernel_wg56d
  s_sleep 2
  s_cmp_lt_u32 s38, 524288
  s_cbranch_scc1 .g2_kernel_wg56
.g2_kernel_wg56d:
  s_sleep 20
  s_and_b32 s31, s19, 0xffffe000
  s_add_u32 s31, s31, 8
  v_and_b32 v6, 15, v2
  v_lshlrev_b32 v6, 9, v6
  v_lshrrev_b32 v7, 4, v2
  v_lshl_add_u32 v6, v7, 7, v6
  v_lshlrev_b32 v7, 2, v2
  v_add_u32 v7, 158208, v7
  s_mov_b32 m0, 158208
  s_mov_b32 s38, 0
.g2_kernel_pa57:
  buffer_load_dword v6, s[4:7], s31 offen sc1 lds
  s_add_u32 s38, s38, 1
  s_waitcnt vmcnt(0)
  ds_read_b32 v8, v7
  s_waitcnt lgkmcnt(0)
  v_cmp_ge_u32 vcc, s62, v8
  s_cbranch_vccz .g2_kernel_pa57d
  s_mov_b64 exec, vcc
  s_sleep 10
  s_cmp_lt_u32 s38, 131072
  s_cbranch_scc1 .g2_kernel_pa57
.g2_kernel_pa57d:
  s_mov_b64 exec, -1
.g2_kernel_d_a:
  s_setprio 2
  s_and_b32 s20, s16, 1
  v_bfe_u32 v8, v2, 1, 3
  v_lshlrev_b32 v8, 14, v8
  v_and_b32 v9, 1, v2
  v_lshl_add_u32 v8, v9, 10, v8
  v_lshrrev_b32 v9, 4, v2
  v_lshl_add_u32 v8, v9, 8, v8
  v_and_b32 v9, 15, v2
  v_lshlrev_b32 v9, 3, v9
  s_lshl_b32 s28, s20, 7
  s_add_u32 s28, s28, 162816
  v_add_u32 v10, s28, v9
  v_xor_b32 v11, 128, v10
  s_lshl_b32 s28, s20, 2
  s_add_u32 s28, s28, s71
  v_mov_b32 v12, s28
  v_xor_b32 v13, 4, v12
  s_lshl_b32 s26, s17, 4
  s_add_u32 s26, s26, s18
  s_lshl_b32 s26, s26, 1
  s_add_u32 s26, s26, s20
  s_lshl_b32 s26, s26, 11
  s_add_u32 s26, s26, s63
  s_add_u32 s26, s26, 0x1090000
  s_mov_b32 s32, 0
  s_mov_b32 s39, 0
  s_lshl_b32 s28, s62, 3
  s_add_u32 s28, s28, s16
  s_cmp_lg_u32 s28, 14
  s_cbranch_scc1 .g2_kernel_d_w
  s_lshr_b32 s33, s77, 7
  s_lshl_b32 s28, s33, 4
  s_lshl_b64 s[34:35], 0xffff, s28
  s_lshr_b32 s28, s33, 2
  s_cmp_eq_u32 s28, 0
  s_cselect_b64 s[8:9], s[34:35], 0
  s_cmp_eq_u32 s28, 1
  s_cselect_b64 s[10:11], s[34:35], 0
  s_cmp_eq_u32 s28, 2
  s_cselect_b64 s[12:13], s[34:35], 0
  s_cmp_eq_u32 s28, 3
  s_cselect_b64 s[14:15], s[34:35], 0
  s_not_b64 s[8:9], s[8:9]
  s_not_b64 s[10:11], s[10:11]
  s_not_b64 s[12:13], s[12:13]
  s_not_b64 s[14:15], s[14:15]
  s_and_b32 s28, s2, 7
  s_lshl_b32 s28, s28, 13
  s_add_u32 s23, s28, 0x3050000
  s_cmp_eq_u32 s33, s17
  s_cbranch_scc1 .g2_kernel_d_v
  v_mov_b32 v6, s71
  s_mov_b32 s38, 0
.g2_kernel_wg58:
  ds_read_b32 v7, v6 offset:20
  s_add_u32 s38, s38, 1
  s_waitcnt lgkmcnt(0)
  v_cmp_le_u32 vcc, 4, v7
  s_cbranch_vccnz .g2_kernel_wg58d
  s_sleep 1
  s_cmp_lt_u32 s38, 524288
  s_cbranch_scc1 .g2_kernel_wg58
.g2_kernel_wg58d:
.g2_kernel_d_v:
  s_sleep 30
  s_call_b64 s[68:69], .g2_kernel_amax
  s_add_u32 s28, s77, 1
  v_mov_b32 v6, s27
  v_mov_b32 v7, s28
  ds_write_b32 v12, v6 offset:96
  ds_write_b32 v12, v7 offset:36
  s_waitcnt lgkmcnt(0)
  s_wakeup
  s_branch .g2_kernel_d_r
.g2_kernel_d_w:
  v_mov_b32 v6, s71
  s_mov_b32 s38, 0
.g2_kernel_wg59:
  ds_read_b32 v7, v6 offset:36
  s_add_u32 s38, s38, 1
  s_waitcnt lgkmcnt(0)
  v_cmp_le_u32 vcc, 1, v7
  s_cbranch_vccnz .g2_kernel_wg59d
  s_sleep 4
  s_cmp_lt_u32 s38, 524288
  s_cbranch_scc1 .g2_kernel_wg59
.g2_kernel_wg59d:
  v_readfirstlane_b32 s77, v7
  s_sub_u32 s77, s77, 1
.g2_kernel_d_r:
  s_and_b32 s77, s77, 2047
  s_lshr_b32 s24, s77, 7
  s_lshl_b32 s24, s24, 18
  s_bfe_u32 s28, s77, 0x30004
  s_lshl_b32 s28, s28, 11
  s_add_u32 s24, s24, s28
  s_and_b32 s28, s77, 15
  s_lshl_b32 s28, s28, 4
  s_add_u32 s24, s24, s28
  s_add_u32 s24, s24, s63
  s_add_u32 s24, s24, 0xc00000
  s_lshl_b32 s28, s17, 14
  s_add_u32 s21, s24, s28
  s_and_b32 s28, s18, 8
  s_lshl_b32 s28, s28, 5
  s_add_u32 s21, s21, s28
  s_and_b32 s28, s18, 7
  s_lshl_b32 s28, s28, 1
  s_add_u32 s21, s21, s28
  s_lshl_b32 s28, s20, 17
  s_add_u32 s24, s24, s28
  buffer_load_dwordx4 v[16:19], v8, s[4:7], s24 offen
  buffer_load_ushort v56, v4, s[4:7], s21 offen
  buffer_load_ushort v57, v4, s[4:7], s21 offen offset:512
  buffer_load_ushort v58, v4, s[4:7], s21 offen offset:1024
  buffer_load_ushort v59, v4, s[4:7], s21 offen offset:1536
  s_lshl_b32 s25, s77, 3
  s_add_u32 s25, s25, s63
  s_add_u32 s25, s25, 0x1080000
  s_mov_b32 s38, 0
.g2_kernel_gx60:
  buffer_load_dwordx2 v[20:21], v4, s[4:7], s25 offen sc1
  s_add_u32 s38, s38, 1
  s_waitcnt vmcnt(0)
  v_min_u32 v6, v21, v21
  v_cmp_eq_u32 vcc, 0, v6
  s_cbranch_vccz .g2_kernel_gx60d
  s_mov_b64 exec, vcc
  s_sleep 1
  s_cmp_lt_u32 s38, 131072
  s_cbranch_scc1 .g2_kernel_gx60
.g2_kernel_gx60d:
  s_mov_b64 exec, -1
  v_rsq_f32 v21, v21
  v_lshlrev_b32 v24, 16, v16
  v_and_b32 v25, 0xffff0000, v16
  v_lshlrev_b32 v26, 16, v17
  v_and_b32 v27, 0xffff0000, v17
  v_lshlrev_b32 v28, 16, v18
  v_and_b32 v29, 0xffff0000, v18
  v_lshlrev_b32 v30, 16, v19
  v_and_b32 v31, 0xffff0000, v19
  v_mul_f32 v20, v20, v21
  v_mov_b32 v60, v20
  v_add_f32 v61, 1.0, v21
  s_cmp_ge_u32 s17, 14
  s_cbranch_scc1 .g2_kernel_d_none
  v_fma_f32 v24, v24, v21, -v20
  v_fma_f32 v25, v25, v21, -v20
  v_fma_f32 v26, v26, v21, -v20
  v_fma_f32 v27, v27, v21, -v20
  v_fma_f32 v28, v28, v21, -v20
  v_fma_f32 v29, v29, v21, -v20
  v_fma_f32 v30, v30, v21, -v20
  v_fma_f32 v31, v31, v21, -v20
  v_cvt_pk_bf16_f32 v16, v24, v25
  v_cvt_pk_bf16_f32 v17, v26, v27
  v_cvt_pk_bf16_f32 v18, v28, v29
  v_cvt_pk_bf16_f32 v19, v30, v31
  v_mov_b32 v24, v16 row_newbcast:0 row_mask:0xf bank_mask:0xf
  v_mov_b32 v25, v17 row_newbcast:0 row_mask:0xf bank_mask:0xf
  v_mov_b32 v26, v18 row_newbcast:0 row_mask:0xf bank_mask:0xf
  v_mov_b32 v27, v19 row_newbcast:0 row_mask:0xf bank_mask:0xf
  v_mov_b32 v28, v16 row_newbcast:1 row_mask:0xf bank_mask:0xf
  v_mov_b32 v29, v17 row_newbcast:1 row_mask:0xf bank_mask:0xf
  v_mov_b32 v30, v18 row_newbcast:1 row_mask:0xf bank_mask:0xf
  v_mov_b32 v31, v19 row_newbcast:1 row_mask:0xf bank_mask:0xf
  v_mfma_f32_16x16x32_bf16 v[32:35], v[24:27], v[64:67], 0
  v_mfma_f32_16x16x32_bf16 v[36:39], v[24:27], v[128:131], 0
  v_mov_b32 v24, v16 row_newbcast:2 row_mask:0xf bank_mask:0xf
  v_mov_b32 v25, v17 row_newbcast:2 row_mask:0xf bank_mask:0xf
  v_mov_b32 v26, v18 row_newbcast:2 row_mask:0xf bank_mask:0xf
  v_mov_b32 v27, v19 row_newbcast:2 row_mask:0xf bank_mask:0xf
  v_mfma_f32_16x16x32_bf16 v[32:35], v[28:31], v[68:71], v[32:35]
  v_mfma_f32_16x16x32_bf16 v[36:39], v[28:31], v[132:135], v[36:39]
  v_mov_b32 v28, v16 row_newbcast:3 row_mask:0xf bank_mask:0xf
  v_mov_b32 v29, v17 row_newbcast:3 row_mask:0xf bank_mask:0xf
  v_mov_b32 v30, v18 row_newbcast:3 row_mask:0xf bank_mask:0xf
  v_mov_b32 v31, v19 row_newbcast:3 row_mask:0xf bank_mask:0xf
  v_mfma_f32_16x16x32_bf16 v[32:35], v[24:27], v[72:75], v[32:35]
  v_mfma_f32_16x16x32_bf16 v[36:39], v[24:27], v[136:139], v[36:39]
  v_mov_b32 v24, v16 row_newbcast:4 row_mask:0xf bank_mask:0xf
  v_mov_b32 v25, v17 row_newbcast:4 row_mask:0xf bank_mask:0xf
  v_mov_b32 v26, v18 row_newbcast:4 row_mask:0xf bank_mask:0xf
  v_mov_b32 v27, v19 row_newbcast:4 row_mask:0xf bank_mask:0xf
  v_mfma_f32_16x16x32_bf16 v[32:35], v[28:31], v[76:79], v[32:35]
  v_mfma_f32_16x16x32_bf16 v[36:39], v[28:31], v[140:143], v[36:39]
  v_mov_b32 v28, v16 row_newbcast:5 row_mask:0xf bank_mask:0xf
  v_mov_b32 v29, v17 row_newbcast:5 row_mask:0xf bank_mask:0xf
  v_mov_b32 v30, v18 row_newbcast:5 row_mask:0xf bank_mask:0xf
  v_mov_b32 v31, v19 row_newbcast:5 row_mask:0xf bank_mask:0xf
  v_mfma_f32_16x16x32_bf16 v[32:35], v[24:27], v[80:83], v[32:35]
  v_mfma_f32_16x16x32_bf16 v[36:39], v[24:27], v[144:147], v[36:39]
  v_mov_b32 v24, v16 row_newbcast:6 row_mask:0xf bank_mask:0xf
  v_mov_b32 v25, v17 row_newbcast:6 row_mask:0xf bank_mask:0xf
  v_mov_b32 v26, v18 row_newbcast:6 row_mask:0xf bank_mask:0xf
  v_mov_b32 v27, v19 row_newbcast:6 row_mask:0xf bank_mask:0xf
  v_mfma_f32_16x16x32_bf16 v[32:35], v[28:31], v[84:87], v[32:35]
  v_mfma_f32_16x16x32_bf16 v[36:39], v[28:31], v[148:151], v[36:39]
  v_mov_b32 v28, v16 row_newbcast:7 row_mask:0xf bank_mask:0xf
  v_mov_b32 v29, v17 row_newbcast:7 row_mask:0xf bank_mask:0xf
  v_mov_b32 v30, v18 row_newbcast:7 row_mask:0xf bank_mask:0xf
  v_mov_b32 v31, v19 row_newbcast:7 row_mask:0xf bank_mask:0xf
  v_mfma_f32_16x16x32_bf16 v[32:35], v[24:27], v[88:91], v[32:35]
  v_mfma_f32_16x16x32_bf16 v[36:39], v[24:27], v[152:155], v[36:39]
  v_mov_b32 v24, v16 row_newbcast:8 row_mask:0xf bank_mask:0xf
  v_mov_b32 v25, v17 row_newbcast:8 row_mask:0xf bank_mask:0xf
  v_mov_b32 v26, v18 row_newbcast:8 row_mask:0xf bank_mask:0xf
  v_mov_b32 v27, v19 row_newbcast:8 row_mask:0xf bank_mask:0xf
  v_mfma_f32_16x16x32_bf16 v[32:35], v[28:31], v[92:95], v[32:35]
  v_mfma_f32_16x16x32_bf16 v[36:39], v[28:31], v[156:159], v[36:39]
  v_mov_b32 v28, v16 row_newbcast:9 row_mask:0xf bank_mask:0xf
  v_mov_b32 v29, v17 row_newbcast:9 row_mask:0xf bank_mask:0xf
  v_mov_b32 v30, v18 row_newbcast:9 row_mask:0xf bank_mask:0xf
  v_mov_b32 v31, v19 row_newbcast:9 row_mask:0xf bank_mask:0xf
  v_mfma_f32_16x16x32_bf16 v[32:35], v[24:27], v[96:99], v[32:35]
  v_mfma_f32_16x16x32_bf16 v[36:39], v[24:27], v[160:163], v[36:39]
  v_mov_b32 v24, v16 row_newbcast:10 row_mask:0xf bank_mask:0xf
  v_mov_b32 v25, v17 row_newbcast:10 row_mask:0xf bank_mask:0xf
  v_mov_b32 v26, v18 row_newbcast:10 row_mask:0xf bank_mask:0xf
  v_mov_b32 v27, v19 row_newbcast:10 row_mask:0xf bank_mask:0xf
  v_mfma_f32_16x16x32_bf16 v[32:35], v[28:31], v[100:103], v[32:35]
  v_mfma_f32_16x16x32_bf16 v[36:39], v[28:31], v[164:167], v[36:39]
  v_mov_b32 v28, v16 row_newbcast:11 row_mask:0xf bank_mask:0xf
  v_mov_b32 v29, v17 row_newbcast:11 row_mask:0xf bank_mask:0xf
  v_mov_b32 v30, v18 row_newbcast:11 row_mask:0xf bank_mask:0xf
  v_mov_b32 v31, v19 row_newbcast:11 row_mask:0xf bank_mask:0xf
  v_mfma_f32_16x16x32_bf16 v[32:35], v[24:27], v[104:107], v[32:35]
  v_mfma_f32_16x16x32_bf16 v[36:39], v[24:27], v[168:171], v[36:39]
  v_mov_b32 v24, v16 row_newbcast:12 row_mask:0xf bank_mask:0xf
  v_mov_b32 v25, v17 row_newbcast:12 row_mask:0xf bank_mask:0xf
  v_mov_b32 v26, v18 row_newbcast:12 row_mask:0xf bank_mask:0xf
  v_mov_b32 v27, v19 row_newbcast:12 row_mask:0xf bank_mask:0xf
  v_mfma_f32_16x16x32_bf16 v[32:35], v[28:31], v[108:111], v[32:35]
  v_mfma_f32_16x16x32_bf16 v[36:39], v[28:31], v[172:175], v[36:39]
  v_mov_b32 v28, v16 row_newbcast:13 row_mask:0xf bank_mask:0xf
  v_mov_b32 v29, v17 row_newbcast:13 row_mask:0xf bank_mask:0xf
  v_mov_b32 v30, v18 row_newbcast:13 row_mask:0xf bank_mask:0xf
  v_mov_b32 v31, v19 row_newbcast:13 row_mask:0xf bank_mask:0xf
  v_mfma_f32_16x16x32_bf16 v[32:35], v[24:27], v[112:115], v[32:35]
  v_mfma_f32_16x16x32_bf16 v[36:39], v[24:27], v[176:179], v[36:39]
  v_mov_b32 v24, v16 row_newbcast:14 row_mask:0xf bank_mask:0xf
  v_mov_b32 v25, v17 row_newbcast:14 row_mask:0xf bank_mask:0xf
  v_mov_b32 v26, v18 row_newbcast:14 row_mask:0xf bank_mask:0xf
  v_mov_b32 v27, v19 row_newbcast:14 row_mask:0xf bank_mask:0xf
  v_mfma_f32_16x16x32_bf16 v[32:35], v[28:31], v[116:119], v[32:35]
  v_mfma_f32_16x16x32_bf16 v[36:39], v[28:31], v[180:183], v[36:39]
  v_mov_b32 v28, v16 row_newbcast:15 row_mask:0xf bank_mask:0xf
  v_mov_b32 v29, v17 row_newbcast:15 row_mask:0xf bank_mask:0xf
  v_mov_b32 v30, v18 row_newbcast:15 row_mask:0xf bank_mask:0xf
  v_mov_b32 v31, v19 row_newbcast:15 row_mask:0xf bank_mask:0xf
  v_mfma_f32_16x16x32_bf16 v[32:35], v[24:27], v[120:123], v[32:35]
  v_mfma_f32_16x16x32_bf16 v[36:39], v[24:27], v[184:187], v[36:39]
  v_mfma_f32_16x16x32_bf16 v[32:35], v[28:31], v[124:127], v[32:35]
  v_mfma_f32_16x16x32_bf16 v[36:39], v[28:31], v[188:191], v[36:39]
  s_mov_b32 s38, 0
  s_add_u32 s28, s32, 1
  v_mov_b32 v14, s28
  s_mov_b32 s28, 0x00010001
  s_mov_b32 s29, 0x00100010
  s_nop 2
  v_mov_b32 v35, v36
  ds_write_b64 v10, v[34:35]
  ds_write_b32 v12, v14 offset:40
.g2_kernel_d_x:
  ds_read_b32 v6, v13 offset:40
  ds_read_b64 v[16:17], v11
  s_add_u32 s38, s38, 1
  s_waitcnt lgkmcnt(0)
  v_cmp_lt_u32 vcc, s32, v6
  s_cbranch_vccnz .g2_kernel_d_xd
  s_cmp_lt_u32 s38, 524288
  s_cbranch_scc1 .g2_kernel_d_x
.g2_kernel_d_xd:
  v_add_f32 v16, v16, v32
  v_add_f32 v17, v17, v36
  v_mul_f32 v18, -1.4426950408889634, v16
  v_exp_f32 v18, v18
  v_mul_f32 v16, v16, v17
  v_add_f32 v18, 1.0, v18
  v_rcp_f32 v18, v18
  s_nop 0
  v_mul_f32 v16, v16, v18
  s_nop 1
  v_mov_b32 v17, v16 quad_perm:[1,0,3,2] row_mask:0xf bank_mask:0xf
  v_cvt_pk_bf16_f32 v16, v16, v17
  s_nop 1
  v_mov_b32 v20, v16 row_newbcast:0 row_mask:0x5 bank_mask:0xf
  v_mov_b32 v21, v16 row_newbcast:2 row_mask:0x5 bank_mask:0xf
  v_mov_b32 v22, v16 row_newbcast:4 row_mask:0x5 bank_mask:0xf
  v_mov_b32 v23, v16 row_newbcast:6 row_mask:0x5 bank_mask:0xf
  v_mov_b32 v20, v16 row_newbcast:8 row_mask:0xa bank_mask:0xf
  v_mov_b32 v21, v16 row_newbcast:10 row_mask:0xa bank_mask:0xf
  v_mov_b32 v22, v16 row_newbcast:12 row_mask:0xa bank_mask:0xf
  v_mov_b32 v23, v16 row_newbcast:14 row_mask:0xa bank_mask:0xf
  v_cndmask_b32 v24, 0, v20, s[28:29]
  v_cndmask_b32 v25, 0, v21, s[28:29]
  v_cndmask_b32 v26, 0, v22, s[28:29]
  v_cndmask_b32 v27, 0, v23, s[28:29]
  s_lshl_b64 s[28:29], s[28:29], 1
  s_nop 0
  v_mfma_f32_16x16x32_bf16 v[40:43], v[24:27], v[192:195], 0
  v_mfma_f32_16x16x32_bf16 v[44:47], v[24:27], v[208:211], 0
  v_mfma_f32_16x16x32_bf16 v[48:51], v[24:27], v[224:227], 0
  v_mfma_f32_16x16x32_bf16 v[52:55], v[24:27], v[240:243], 0
  v_cndmask_b32 v28, 0, v20, s[28:29]
  v_cndmask_b32 v29, 0, v21, s[28:29]
  v_cndmask_b32 v30, 0, v22, s[28:29]
  v_cndmask_b32 v31, 0, v23, s[28:29]
  s_lshl_b64 s[28:29], s[28:29], 1
  s_nop 0
  v_mfma_f32_16x16x32_bf16 v[40:43], v[28:31], v[196:199], v[40:43]
  v_mfma_f32_16x16x32_bf16 v[44:47], v[28:31], v[212:215], v[44:47]
  v_mfma_f32_16x16x32_bf16 v[48:51], v[28:31], v[228:231], v[48:51]
  v_mfma_f32_16x16x32_bf16 v[52:55], v[28:31], v[244:247], v[52:55]
  v_cndmask_b32 v32, 0, v20, s[28:29]
  v_cndmask_b32 v33, 0, v21, s[28:29]
  v_cndmask_b32 v34, 0, v22, s[28:29]
  v_cndmask_b32 v35, 0, v23, s[28:29]
  s_lshl_b64 s[28:29], s[28:29], 1
  s_nop 0
  v_mfma_f32_16x16x32_bf16 v[40:43], v[32:35], v[200:203], v[40:43]
  v_mfma_f32_16x16x32_bf16 v[44:47], v[32:35], v[216:219], v[44:47]
  v_mfma_f32_16x16x32_bf16 v[48:51], v[32:35], v[232:235], v[48:51]
  v_mfma_f32_16x16x32_bf16 v[52:55], v[32:35], v[248:251], v[52:55]
  v_cndmask_b32 v36, 0, v20, s[28:29]
  v_cndmask_b32 v37, 0, v21, s[28:29]
  v_cndmask_b32 v38, 0, v22, s[28:29]
  v_cndmask_b32 v39, 0, v23, s[28:29]
  s_lshl_b64 s[28:29], s[28:29], 1
  s_nop 0
  v_mfma_f32_16x16x32_bf16 v[40:43], v[36:39], v[204:207], v[40:43]
  v_mfma_f32_16x16x32_bf16 v[44:47], v[36:39], v[220:223], v[44:47]
  v_mfma_f32_16x16x32_bf16 v[48:51], v[36:39], v[236:239], v[48:51]
  v_mfma_f32_16x16x32_bf16 v[52:55], v[36:39], v[252:255], v[52:55]
  s_mov_b32 exec_hi, 0
  s_nop 3
  v_or_b32 v40, 1, v40
  v_or_b32 v42, 1, v42
  buffer_store_dwordx4 v[40:43], v3, s[4:7], s26 offen offset:0 sc1
  v_or_b32 v44, 1, v44
  v_or_b32 v46, 1, v46
  buffer_store_dwordx4 v[44:47], v3, s[4:7], s26 offen offset:512 sc1
  v_or_b32 v48, 1, v48
  v_or_b32 v50, 1, v50
  buffer_store_dwordx4 v[48:51], v3, s[4:7], s26 offen offset:1024 sc1
  v_or_b32 v52, 1, v52
  v_or_b32 v54, 1, v54
  buffer_store_dwordx4 v[52:55], v3, s[4:7], s26 offen offset:1536 sc1
  s_mov_b64 exec, -1
  s_branch .g2_kernel_d_e
.g2_kernel_d_none:
  s_sleep 24
.g2_kernel_d_e:
  v_mov_b32 v6, s71
  s_mov_b64 exec, 1
  ds_add_u32 v6, v5 offset:48
  s_mov_b64 exec, -1
  s_cmp_lg_u32 s62, 0
  s_cbranch_scc1 .g2_kernel_d_t
  s_mov_b32 s62, 1
  s_mov_b32 s63, 0x1800000
  s_mov_b32 s70, 2
  s_mov_b32 s71, 155776
  s_branch .g2_kernel_v
.g2_kernel_d_t:
  s_cmp_lg_u32 s20, 0
  s_cbranch_scc1 .g2_kernel_d_t1
  v_mov_b32 v62, -1.4426950408889634
  v_mul_f32 v62, s27, v62
  v_exp_f32 v62, v62
  v_lshlrev_b32 v14, 12, v2
  v_min_u32 v15, 126976, v14
  s_lshl_b32 s21, s17, 4
  s_add_u32 s21, s21, s18
  s_lshl_b32 s21, s21, 4
  s_mul_i32 s22, s32, 0x270000
  s_add_u32 s21, s21, s22
  s_add_u32 s21, s21, 0x2890000
  s_add_u32 s22, s21, 262144
  s_add_u32 s24, s21, 524288
  s_add_u32 s25, s21, 786432
  v_add_f32 v62, 1.0, v62
  v_rcp_f32 v62, v62
  v_lshlrev_b32 v56, 16, v56
  v_fma_f32 v56, v56, v61, -v60
  v_lshlrev_b32 v57, 16, v57
  v_fma_f32 v57, v57, v61, -v60
  v_lshlrev_b32 v58, 16, v58
  v_fma_f32 v58, v58, v61, -v60
  v_lshlrev_b32 v59, 16, v59
  v_fma_f32 v59, v59, v61, -v60
  s_sleep 8
  s_mov_b32 s38, 0
.g2_kernel_gx61:
  buffer_load_dwordx4 v[16:19], v14, s[4:7], s21 offen sc1
  buffer_load_dwordx4 v[20:23], v14, s[4:7], s22 offen sc1
  buffer_load_dwordx4 v[24:27], v14, s[4:7], s24 offen sc1
  buffer_load_dwordx4 v[28:31], v15, s[4:7], s25 offen sc1
  s_add_u32 s38, s38, 1
  s_waitcnt vmcnt(0)
  v_min3_u32 v6, v16, v18, v20
  v_min3_u32 v6, v6, v22, v24
  v_min3_u32 v6, v6, v26, v28
  v_min_u32 v6, v6, v30
  v_cmp_eq_u32 vcc, 0, v6
  s_cbranch_vccz .g2_kernel_gx61d
  s_mov_b64 exec, vcc
  s_cmp_lt_u32 s38, 131072
  s_cbranch_scc1 .g2_kernel_gx61
.g2_kernel_gx61d:
  s_mov_b64 exec, -1
  v_add_f32 v16, v16, v20
  v_add_f32 v17, v17, v21
  v_add_f32 v18, v18, v22
  v_add_f32 v19, v19, v23
  s_mov_b32 exec_hi, 0
  v_add_f32 v24, v24, v28
  v_add_f32 v25, v25, v29
  v_add_f32 v26, v26, v30
  v_add_f32 v27, v27, v31
  s_mov_b64 exec, -1
  v_add_f32 v16, v16, v24
  v_add_f32 v17, v17, v25
  v_add_f32 v18, v18, v26
  v_add_f32 v19, v19, v27
  v_add_f32 v16, v16, v16 row_ror:8 row_mask:0xf bank_mask:0xf
  v_add_f32 v17, v17, v17 row_ror:8 row_mask:0xf bank_mask:0xf
  v_add_f32 v18, v18, v18 row_ror:8 row_mask:0xf bank_mask:0xf
  v_add_f32 v19, v19, v19 row_ror:8 row_mask:0xf bank_mask:0xf
  v_add_f32 v16, v16, v16 row_ror:4 row_mask:0xf bank_mask:0xf
  v_add_f32 v17, v17, v17 row_ror:4 row_mask:0xf bank_mask:0xf
  v_add_f32 v18, v18, v18 row_ror:4 row_mask:0xf bank_mask:0xf
  v_add_f32 v19, v19, v19 row_ror:4 row_mask:0xf bank_mask:0xf
  v_add_f32 v16, v16, v16 row_ror:2 row_mask:0xf bank_mask:0xf
  v_add_f32 v17, v17, v17 row_ror:2 row_mask:0xf bank_mask:0xf
  v_add_f32 v18, v18, v18 row_ror:2 row_mask:0xf bank_mask:0xf
  v_add_f32 v19, v19, v19 row_ror:2 row_mask:0xf bank_mask:0xf
  v_add_f32 v16, v16, v16 row_ror:1 row_mask:0xf bank_mask:0xf
  v_add_f32 v17, v17, v17 row_ror:1 row_mask:0xf bank_mask:0xf
  v_add_f32 v18, v18, v18 row_ror:1 row_mask:0xf bank_mask:0xf
  v_add_f32 v19, v19, v19 row_ror:1 row_mask:0xf bank_mask:0xf
  v_add_f32 v16, v16, v16 row_bcast:15 row_mask:0xa bank_mask:0xf
  v_add_f32 v17, v17, v17 row_bcast:15 row_mask:0xa bank_mask:0xf
  v_add_f32 v18, v18, v18 row_bcast:15 row_mask:0xa bank_mask:0xf
  v_add_f32 v19, v19, v19 row_bcast:15 row_mask:0xa bank_mask:0xf
  v_add_f32 v16, v16, v16 row_bcast:31 row_mask:0xc bank_mask:0xf
  v_add_f32 v17, v17, v17 row_bcast:31 row_mask:0xc bank_mask:0xf
  v_add_f32 v18, v18, v18 row_bcast:31 row_mask:0xc bank_mask:0xf
  v_add_f32 v19, v19, v19 row_bcast:31 row_mask:0xc bank_mask:0xf
  s_lshl_b32 s24, s77, 11
  s_lshl_b32 s25, s17, 7
  s_add_u32 s24, s24, s25
  s_lshl_b32 s25, s18, 1
  s_add_u32 s24, s24, s25
.g2_kernel_d_t1:
  v_mov_b32 v6, s71
  s_mov_b32 s38, 0
.g2_kernel_wg62:
  ds_read_b32 v7, v6 offset:88
  s_add_u32 s38, s38, 1
  s_waitcnt lgkmcnt(0)
  v_cmp_le_u32 vcc, 1, v7
  s_cbranch_vccnz .g2_kernel_wg62d
  s_cmp_lt_u32 s38, 524288
  s_cbranch_scc1 .g2_kernel_wg62
.g2_kernel_wg62d:
  ds_read_b32 v6, v6 offset:92
  v_readfirstlane_b32 s33, v7
  s_cmp_lg_u32 s32, 0
  s_cselect_b32 s33, 1, s33
  s_cmp_lg_u32 s20, 0
  s_cbranch_scc1 .g2_kernel_d_t2
  s_cmp_lg_u32 s33, 1
  s_cbranch_scc1 .g2_kernel_d_t4
  v_fmac_f32 v56, v16, v62
  v_fmac_f32 v57, v17, v62
  v_fmac_f32 v58, v18, v62
  v_fmac_f32 v59, v19, v62
.g2_kernel_d_t4:
  s_mov_b32 s28, s56
  s_mov_b32 s29, s57
  s_mov_b32 s30, 0x400000
  s_mov_b32 s31, 0x00020000
  v_cvt_pk_bf16_f32 v56, v56, v57
  v_cvt_pk_bf16_f32 v58, v58, v59
  s_mov_b32 exec_lo, 0
  s_mov_b32 exec_hi, 0x80000000
  buffer_store_short v56, v4, s[28:31], s24 offen
  buffer_store_short_d16_hi v56, v4, s[28:31], s24 offen offset:32
  buffer_store_short v58, v4, s[28:31], s24 offen offset:64
  buffer_store_short_d16_hi v58, v4, s[28:31], s24 offen offset:96
  s_mov_b64 exec, -1
.g2_kernel_d_t2:
  s_cmp_eq_u32 s33, 1
  s_cbranch_scc1 .g2_kernel_fin
  s_waitcnt vmcnt(0) lgkmcnt(0)
  v_readfirstlane_b32 s27, v6
  s_sub_u32 s77, s33, 2
  s_mov_b32 s32, 1
  s_add_u32 s26, s26, 0x270000
  s_branch .g2_kernel_d_r
.g2_kernel_fin1:
.g2_kernel_fin:
.g2_kernel_end:
  s_endpgm
.g2_kernel_q_i2:
  v_mov_b32 v6, 155648
  s_mov_b32 s38, 0
.g2_kernel_wg1:
  ds_read_b32 v7, v6 offset:20
  s_add_u32 s38, s38, 1
  s_waitcnt lgkmcnt(0)
  v_cmp_le_u32 vcc, 4, v7
  s_cbranch_vccnz .g2_kernel_wg1d
  s_cmp_lt_u32 s38, 524288
  s_cbranch_scc1 .g2_kernel_wg1
.g2_kernel_wg1d:
  s_branch .g2_kernel_q_i3
.g2_kernel_q_spin:
  s_mov_b32 s38, 0
.g2_kernel_q_spinl:
  ds_read_b32 v151, v150
  s_add_u32 s38, s38, 1
  s_waitcnt lgkmcnt(0)
  v_cmp_lt_i32 vcc, s33, v151
  s_cbranch_vccnz .g2_kernel_q_spinr
  s_cmp_lt_u32 s38, 524288
  s_cbranch_scc1 .g2_kernel_q_spinl
.g2_kernel_q_spinr:
  s_setpc_b64 s[68:69]
.g2_kernel_q_wf:
  s_call_b64 s[68:69], .g2_kernel_q_spin
  s_branch .g2_kernel_q_backf
.g2_kernel_q_w7:
  s_call_b64 s[68:69], .g2_kernel_q_spin
  s_branch .g2_kernel_q_back7
.g2_kernel_q_w0:
  s_call_b64 s[68:69], .g2_kernel_q_spin
  s_branch .g2_kernel_q_back0
.g2_kernel_q_w1:
  s_call_b64 s[68:69], .g2_kernel_q_spin
  s_branch .g2_kernel_q_back1
.g2_kernel_q_w2:
  s_call_b64 s[68:69], .g2_kernel_q_spin
  s_branch .g2_kernel_q_back2
.g2_kernel_q_w3:
  s_call_b64 s[68:69], .g2_kernel_q_spin
  s_branch .g2_kernel_q_back3
.g2_kernel_q_w4:
  s_call_b64 s[68:69], .g2_kernel_q_spin
  s_branch .g2_kernel_q_back4
.g2_kernel_q_w5:
  s_call_b64 s[68:69], .g2_kernel_q_spin
  s_branch .g2_kernel_q_back5
.g2_kernel_q_w6:
  s_call_b64 s[68:69], .g2_kernel_q_spin
  s_branch .g2_kernel_q_back6
.g2_kernel_q_cons2:
  s_lshr_b32 s26, s16, 1
  s_lshl_b32 s26, s26, 13
  v_add_u32 v144, s26, v3
  v_add_u32 v145, 1024, v144
  s_branch .g2_kernel_q_cs
.g2_kernel_q_ew:
  s_mov_b32 s38, 0
.g2_kernel_q_ewl:
  ds_read_b32 v62, v13 offset:0
  ds_read_b32 v63, v58
  s_add_u32 s38, s38, 1
  s_waitcnt lgkmcnt(0)
  v_cmp_gt_u32 vcc, 2, v62
  v_cmp_gt_u32 s[14:15], s12, v63
  s_or_b64 vcc, vcc, s[14:15]
  s_cbranch_scc0 .g2_kernel_q_ec
  s_cmp_lt_u32 s38, 524288
  s_cbranch_scc1 .g2_kernel_q_ewl
.g2_kernel_q_ec:
  ds_read_b32 v57, v13 offset:24
  ds_read_b32 v21, v13 offset:84
  ds_read_b128 v[40:43], v52 offset:5120
  ds_read_b128 v[44:47], v52 offset:5184
  ds_read_b32 v24, v50 offset:2816
  ds_read_b32 v25, v50 offset:3328
  ds_read_b32 v26, v50 offset:2880
  ds_read_b32 v27, v50 offset:3392
  ds_read_b32 v28, v50 offset:2944
  ds_read_b32 v29, v50 offset:3456
  ds_read_b32 v30, v50 offset:3008
  ds_read_b32 v31, v50 offset:3520
  ds_read_b128 v[64:67], v51 offset:2816
  ds_read_b128 v[80:83], v51 offset:3328
  ds_read_b128 v[68:71], v51 offset:2880
  ds_read_b128 v[84:87], v51 offset:3392
  ds_read_b128 v[72:75], v51 offset:2944
  ds_read_b128 v[88:91], v51 offset:3456
  ds_read_b128 v[76:79], v51 offset:3008
  ds_read_b128 v[92:95], v51 offset:3520
  ds_read_b32 v48, v53 offset:5376
  ds_read_b32 v49, v53 offset:5440
  ds_read_b128 v[32:35], v52 offset:4864
  ds_read_b128 v[36:39], v52 offset:4928
  s_waitcnt lgkmcnt(0)
  s_branch .g2_kernel_q_eb
.g2_kernel_q_patch:
  v_readfirstlane_b32 s35, v57
  s_sub_u32 s28, s35, 1
  s_lshr_b32 s29, s28, 6
  s_lshr_b32 s30, s16, 1
  s_add_u32 s35, s35, 0x100
  s_cmp_lg_u32 s29, s30
  s_cbranch_scc1 .g2_kernel_q_pback
  s_add_u32 s35, s35, 0x100
  s_mov_b32 s77, 0x40000000
  s_and_b32 s29, s28, 15
  s_mov_b32 s14, 0x00010001
  s_mov_b32 s15, 0x00010001
  s_lshl_b64 s[14:15], s[14:15], s29
  s_and_b32 s29, s28, 12
  s_lshl_b32 s29, s29, 2
  s_lshl_b64 s[30:31], 0xffff, s29
  v_subrev_u32 v96, 155648, v53
  v_lshlrev_b32 v96, 2, v96
  v_add_u32 v96, 155648, v96
  s_bfe_u32 s29, s28, 0x20004
  s_cmp_lg_u32 s29, 0
  s_cbranch_scc1 .g2_kernel_q_pv1
  s_mov_b64 exec, s[14:15]
  ds_write_b128 v52, v[160:163] offset:5632
  ds_write_b128 v52, v[176:179] offset:5696
  ds_write_b128 v52, v[192:195] offset:5888
  ds_write_b128 v52, v[208:211] offset:5952
  s_mov_b64 exec, s[30:31]
  ds_write_b128 v96, v[224:227] offset:6144
  ds_write_b128 v96, v[240:243] offset:6400
  s_mov_b64 exec, -1
  s_waitcnt lgkmcnt(0)
  s_branch .g2_kernel_q_pback
.g2_kernel_q_pv1:
  s_cmp_lg_u32 s29, 1
  s_cbranch_scc1 .g2_kernel_q_pv2
  s_mov_b64 exec, s[14:15]
  ds_write_b128 v52, v[164:167] offset:5632
  ds_write_b128 v52, v[180:183] offset:5696
  ds_write_b128 v52, v[196:199] offset:5888
  ds_write_b128 v52, v[212:215] offset:5952
  s_mov_b64 exec, s[30:31]
  ds_write_b128 v96, v[228:231] offset:6144
  ds_write_b128 v96, v[244:247] offset:6400
  s_mov_b64 exec, -1
  s_waitcnt lgkmcnt(0)
  s_branch .g2_kernel_q_pback
.g2_kernel_q_pv2:
  s_cmp_lg_u32 s29, 2
  s_cbranch_scc1 .g2_kernel_q_pv3
  s_mov_b64 exec, s[14:15]
  ds_write_b128 v52, v[168:171] offset:5632
  ds_write_b128 v52, v[184:187] offset:5696
  ds_write_b128 v52, v[200:203] offset:5888
  ds_write_b128 v52, v[216:219] offset:5952
  s_mov_b64 exec, s[30:31]
  ds_write_b128 v96, v[232:235] offset:6144
  ds_write_b128 v96, v[248:251] offset:6400
  s_mov_b64 exec, -1
  s_waitcnt lgkmcnt(0)
  s_branch .g2_kernel_q_pback
.g2_kernel_q_pv3:
  s_mov_b64 exec, s[14:15]
  ds_write_b128 v52, v[172:175] offset:5632
  ds_write_b128 v52, v[188:191] offset:5696
  ds_write_b128 v52, v[204:207] offset:5888
  ds_write_b128 v52, v[220:223] offset:5952
  s_mov_b64 exec, s[30:31]
  ds_write_b128 v96, v[236:239] offset:6144
  ds_write_b128 v96, v[252:255] offset:6400
  s_mov_b64 exec, -1
  s_waitcnt lgkmcnt(0)
  s_branch .g2_kernel_q_pback
.g2_kernel_q_nk:
  v_pk_mul_f32 v[152:153], v[40:41], v[24:25] op_sel:[0,1] op_sel_hi:[1,1]
  v_pk_mul_f32 v[154:155], v[42:43], v[24:25] op_sel:[0,1] op_sel_hi:[1,1]
  v_pk_mul_f32 v[156:157], v[44:45], v[24:25] op_sel:[0,1] op_sel_hi:[1,1]
  v_pk_mul_f32 v[158:159], v[46:47], v[24:25] op_sel:[0,1] op_sel_hi:[1,1]
  v_pk_fma_f32 v[192:193], v[192:193], v[24:25], v[152:153] op_sel_hi:[1,0,1]
  v_pk_fma_f32 v[194:195], v[194:195], v[24:25], v[154:155] op_sel_hi:[1,0,1]
  v_pk_fma_f32 v[208:209], v[208:209], v[24:25], v[156:157] op_sel_hi:[1,0,1]
  v_pk_fma_f32 v[210:211], v[210:211], v[24:25], v[158:159] op_sel_hi:[1,0,1]
  v_cvt_pk_bf16_f32 v192, v192, v193
  v_cvt_pk_bf16_f32 v193, v194, v195
  v_cvt_pk_bf16_f32 v194, v208, v209
  v_cvt_pk_bf16_f32 v195, v210, v211
  ds_write_b128 v59, v[192:195] offset:0
  v_pk_mul_f32 v[152:153], v[40:41], v[26:27] op_sel:[0,1] op_sel_hi:[1,1]
  v_pk_mul_f32 v[154:155], v[42:43], v[26:27] op_sel:[0,1] op_sel_hi:[1,1]
  v_pk_mul_f32 v[156:157], v[44:45], v[26:27] op_sel:[0,1] op_sel_hi:[1,1]
  v_pk_mul_f32 v[158:159], v[46:47], v[26:27] op_sel:[0,1] op_sel_hi:[1,1]
  v_pk_fma_f32 v[196:197], v[196:197], v[26:27], v[152:153] op_sel_hi:[1,0,1]
  v_pk_fma_f32 v[198:199], v[198:199], v[26:27], v[154:155] op_sel_hi:[1,0,1]
  v_pk_fma_f32 v[212:213], v[212:213], v[26:27], v[156:157] op_sel_hi:[1,0,1]
  v_pk_fma_f32 v[214:215], v[214:215], v[26:27], v[158:159] op_sel_hi:[1,0,1]
  v_cvt_pk_bf16_f32 v196, v196, v197
  v_cvt_pk_bf16_f32 v197, v198, v199
  v_cvt_pk_bf16_f32 v198, v212, v213
  v_cvt_pk_bf16_f32 v199, v214, v215
  ds_write_b128 v59, v[196:199] offset:128
  v_pk_mul_f32 v[152:153], v[40:41], v[28:29] op_sel:[0,1] op_sel_hi:[1,1]
  v_pk_mul_f32 v[154:155], v[42:43], v[28:29] op_sel:[0,1] op_sel_hi:[1,1]
  v_pk_mul_f32 v[156:157], v[44:45], v[28:29] op_sel:[0,1] op_sel_hi:[1,1]
  v_pk_mul_f32 v[158:159], v[46:47], v[28:29] op_sel:[0,1] op_sel_hi:[1,1]
  v_pk_fma_f32 v[200:201], v[200:201], v[28:29], v[152:153] op_sel_hi:[1,0,1]
  v_pk_fma_f32 v[202:203], v[202:203], v[28:29], v[154:155] op_sel_hi:[1,0,1]
  v_pk_fma_f32 v[216:217], v[216:217], v[28:29], v[156:157] op_sel_hi:[1,0,1]
  v_pk_fma_f32 v[218:219], v[218:219], v[28:29], v[158:159] op_sel_hi:[1,0,1]
  v_cvt_pk_bf16_f32 v200, v200, v201
  v_cvt_pk_bf16_f32 v201, v202, v203
  v_cvt_pk_bf16_f32 v202, v216, v217
  v_cvt_pk_bf16_f32 v203, v218, v219
  ds_write_b128 v59, v[200:203] offset:4096
  v_pk_mul_f32 v[152:153], v[40:41], v[30:31] op_sel:[0,1] op_sel_hi:[1,1]
  v_pk_mul_f32 v[154:155], v[42:43], v[30:31] op_sel:[0,1] op_sel_hi:[1,1]
  v_pk_mul_f32 v[156:157], v[44:45], v[30:31] op_sel:[0,1] op_sel_hi:[1,1]
  v_pk_mul_f32 v[158:159], v[46:47], v[30:31] op_sel:[0,1] op_sel_hi:[1,1]
  v_pk_fma_f32 v[204:205], v[204:205], v[30:31], v[152:153] op_sel_hi:[1,0,1]
  v_pk_fma_f32 v[206:207], v[206:207], v[30:31], v[154:155] op_sel_hi:[1,0,1]
  v_pk_fma_f32 v[220:221], v[220:221], v[30:31], v[156:157] op_sel_hi:[1,0,1]
  v_pk_fma_f32 v[222:223], v[222:223], v[30:31], v[158:159] op_sel_hi:[1,0,1]
  v_cvt_pk_bf16_f32 v204, v204, v205
  v_cvt_pk_bf16_f32 v205, v206, v207
  v_cvt_pk_bf16_f32 v206, v220, v221
  v_cvt_pk_bf16_f32 v207, v222, v223
  ds_write_b128 v59, v[204:207] offset:4224
  v_pk_mul_f32 v[152:153], v[80:81], v[48:49] op_sel:[0,0] op_sel_hi:[1,0]
  v_pk_mul_f32 v[154:155], v[82:83], v[48:49] op_sel:[0,0] op_sel_hi:[1,0]
  v_pk_mul_f32 v[156:157], v[84:85], v[48:49] op_sel:[0,0] op_sel_hi:[1,0]
  v_pk_mul_f32 v[158:159], v[86:87], v[48:49] op_sel:[0,0] op_sel_hi:[1,0]
  v_pk_fma_f32 v[224:225], v[224:225], v[64:65], v[152:153]
  v_pk_fma_f32 v[226:227], v[226:227], v[66:67], v[154:155]
  v_pk_fma_f32 v[228:229], v[228:229], v[68:69], v[156:157]
  v_pk_fma_f32 v[230:231], v[230:231], v[70:71], v[158:159]
  v_cvt_pk_bf16_f32 v224, v224, v225
  v_cvt_pk_bf16_f32 v225, v226, v227
  v_cvt_pk_bf16_f32 v226, v228, v229
  v_cvt_pk_bf16_f32 v227, v230, v231
  ds_write_b128 v60, v[224:227] offset:2048
  v_pk_mul_f32 v[152:153], v[80:81], v[48:49] op_sel:[0,1] op_sel_hi:[1,1]
  v_pk_mul_f32 v[154:155], v[82:83], v[48:49] op_sel:[0,1] op_sel_hi:[1,1]
  v_pk_mul_f32 v[156:157], v[84:85], v[48:49] op_sel:[0,1] op_sel_hi:[1,1]
  v_pk_mul_f32 v[158:159], v[86:87], v[48:49] op_sel:[0,1] op_sel_hi:[1,1]
  v_pk_fma_f32 v[240:241], v[240:241], v[64:65], v[152:153]
  v_pk_fma_f32 v[242:243], v[242:243], v[66:67], v[154:155]
  v_pk_fma_f32 v[244:245], v[244:245], v[68:69], v[156:157]
  v_pk_fma_f32 v[246:247], v[246:247], v[70:71], v[158:159]
  v_cvt_pk_bf16_f32 v240, v240, v241
  v_cvt_pk_bf16_f32 v241, v242, v243
  v_cvt_pk_bf16_f32 v242, v244, v245
  v_cvt_pk_bf16_f32 v243, v246, v247
  ds_write_b128 v60, v[240:243] offset:2304
  v_pk_mul_f32 v[152:153], v[88:89], v[48:49] op_sel:[0,0] op_sel_hi:[1,0]
  v_pk_mul_f32 v[154:155], v[90:91], v[48:49] op_sel:[0,0] op_sel_hi:[1,0]
  v_pk_mul_f32 v[156:157], v[92:93], v[48:49] op_sel:[0,0] op_sel_hi:[1,0]
  v_pk_mul_f32 v[158:159], v[94:95], v[48:49] op_sel:[0,0] op_sel_hi:[1,0]
  v_pk_fma_f32 v[232:233], v[232:233], v[72:73], v[152:153]
  v_pk_fma_f32 v[234:235], v[234:235], v[74:75], v[154:155]
  v_pk_fma_f32 v[236:237], v[236:237], v[76:77], v[156:157]
  v_pk_fma_f32 v[238:239], v[238:239], v[78:79], v[158:159]
  v_cvt_pk_bf16_f32 v232, v232, v233
  v_cvt_pk_bf16_f32 v233, v234, v235
  v_cvt_pk_bf16_f32 v234, v236, v237
  v_cvt_pk_bf16_f32 v235, v238, v239
  ds_write_b128 v60, v[232:235] offset:6144
  v_pk_mul_f32 v[152:153], v[88:89], v[48:49] op_sel:[0,1] op_sel_hi:[1,1]
  v_pk_mul_f32 v[154:155], v[90:91], v[48:49] op_sel:[0,1] op_sel_hi:[1,1]
  v_pk_mul_f32 v[156:157], v[92:93], v[48:49] op_sel:[0,1] op_sel_hi:[1,1]
  v_pk_mul_f32 v[158:159], v[94:95], v[48:49] op_sel:[0,1] op_sel_hi:[1,1]
  v_pk_fma_f32 v[248:249], v[248:249], v[72:73], v[152:153]
  v_pk_fma_f32 v[250:251], v[250:251], v[74:75], v[154:155]
  v_pk_fma_f32 v[252:253], v[252:253], v[76:77], v[156:157]
  v_pk_fma_f32 v[254:255], v[254:255], v[78:79], v[158:159]
  v_cvt_pk_bf16_f32 v248, v248, v249
  v_cvt_pk_bf16_f32 v249, v250, v251
  v_cvt_pk_bf16_f32 v250, v252, v253
  v_cvt_pk_bf16_f32 v251, v254, v255
  ds_write_b128 v60, v[248:251] offset:6400
  v_pk_mul_f32 v[24:25], v[24:25], v[56:57] op_sel_hi:[1,0]
  v_pk_mul_f32 v[26:27], v[26:27], v[56:57] op_sel_hi:[1,0]
  v_pk_mul_f32 v[28:29], v[28:29], v[56:57] op_sel_hi:[1,0]
  v_pk_mul_f32 v[30:31], v[30:31], v[56:57] op_sel_hi:[1,0]
  v_pk_mul_f32 v[152:153], v[32:33], v[24:25] op_sel:[0,1] op_sel_hi:[1,1]
  v_pk_mul_f32 v[154:155], v[34:35], v[24:25] op_sel:[0,1] op_sel_hi:[1,1]
  v_pk_mul_f32 v[156:157], v[36:37], v[24:25] op_sel:[0,1] op_sel_hi:[1,1]
  v_pk_mul_f32 v[158:159], v[38:39], v[24:25] op_sel:[0,1] op_sel_hi:[1,1]
  v_pk_fma_f32 v[160:161], v[160:161], v[24:25], v[152:153] op_sel_hi:[1,0,1]
  v_pk_fma_f32 v[162:163], v[162:163], v[24:25], v[154:155] op_sel_hi:[1,0,1]
  v_pk_fma_f32 v[176:177], v[176:177], v[24:25], v[156:157] op_sel_hi:[1,0,1]
  v_pk_fma_f32 v[178:179], v[178:179], v[24:25], v[158:159] op_sel_hi:[1,0,1]
  v_cvt_pk_bf16_f32 v160, v160, v161
  v_cvt_pk_bf16_f32 v161, v162, v163
  v_cvt_pk_bf16_f32 v162, v176, v177
  v_cvt_pk_bf16_f32 v163, v178, v179
  ds_write_b128 v61, v[160:163] offset:0
  v_pk_mul_f32 v[152:153], v[32:33], v[26:27] op_sel:[0,1] op_sel_hi:[1,1]
  v_pk_mul_f32 v[154:155], v[34:35], v[26:27] op_sel:[0,1] op_sel_hi:[1,1]
  v_pk_mul_f32 v[156:157], v[36:37], v[26:27] op_sel:[0,1] op_sel_hi:[1,1]
  v_pk_mul_f32 v[158:159], v[38:39], v[26:27] op_sel:[0,1] op_sel_hi:[1,1]
  v_pk_fma_f32 v[164:165], v[164:165], v[26:27], v[152:153] op_sel_hi:[1,0,1]
  v_pk_fma_f32 v[166:167], v[166:167], v[26:27], v[154:155] op_sel_hi:[1,0,1]
  v_pk_fma_f32 v[180:181], v[180:181], v[26:27], v[156:157] op_sel_hi:[1,0,1]
  v_pk_fma_f32 v[182:183], v[182:183], v[26:27], v[158:159] op_sel_hi:[1,0,1]
  v_cvt_pk_bf16_f32 v164, v164, v165
  v_cvt_pk_bf16_f32 v165, v166, v167
  v_cvt_pk_bf16_f32 v166, v180, v181
  v_cvt_pk_bf16_f32 v167, v182, v183
  ds_write_b128 v61, v[164:167] offset:256
  v_pk_mul_f32 v[152:153], v[32:33], v[28:29] op_sel:[0,1] op_sel_hi:[1,1]
  v_pk_mul_f32 v[154:155], v[34:35], v[28:29] op_sel:[0,1] op_sel_hi:[1,1]
  v_pk_mul_f32 v[156:157], v[36:37], v[28:29] op_sel:[0,1] op_sel_hi:[1,1]
  v_pk_mul_f32 v[158:159], v[38:39], v[28:29] op_sel:[0,1] op_sel_hi:[1,1]
  v_pk_fma_f32 v[168:169], v[168:169], v[28:29], v[152:153] op_sel_hi:[1,0,1]
  v_pk_fma_f32 v[170:171], v[170:171], v[28:29], v[154:155] op_sel_hi:[1,0,1]
  v_pk_fma_f32 v[184:185], v[184:185], v[28:29], v[156:157] op_sel_hi:[1,0,1]
  v_pk_fma_f32 v[186:187], v[186:187], v[28:29], v[158:159] op_sel_hi:[1,0,1]
  v_cvt_pk_bf16_f32 v168, v168, v169
  v_cvt_pk_bf16_f32 v169, v170, v171
  v_cvt_pk_bf16_f32 v170, v184, v185
  v_cvt_pk_bf16_f32 v171, v186, v187
  ds_write_b128 v61, v[168:171] offset:2048
  v_pk_mul_f32 v[152:153], v[32:33], v[30:31] op_sel:[0,1] op_sel_hi:[1,1]
  v_pk_mul_f32 v[154:155], v[34:35], v[30:31] op_sel:[0,1] op_sel_hi:[1,1]
  v_pk_mul_f32 v[156:157], v[36:37], v[30:31] op_sel:[0,1] op_sel_hi:[1,1]
  v_pk_mul_f32 v[158:159], v[38:39], v[30:31] op_sel:[0,1] op_sel_hi:[1,1]
  v_pk_fma_f32 v[172:173], v[172:173], v[30:31], v[152:153] op_sel_hi:[1,0,1]
  v_pk_fma_f32 v[174:175], v[174:175], v[30:31], v[154:155] op_sel_hi:[1,0,1]
  v_pk_fma_f32 v[188:189], v[188:189], v[30:31], v[156:157] op_sel_hi:[1,0,1]
  v_pk_fma_f32 v[190:191], v[190:191], v[30:31], v[158:159] op_sel_hi:[1,0,1]
  v_cvt_pk_bf16_f32 v172, v172, v173
  v_cvt_pk_bf16_f32 v173, v174, v175
  v_cvt_pk_bf16_f32 v174, v188, v189
  v_cvt_pk_bf16_f32 v175, v190, v191
  ds_write_b128 v61, v[172:175] offset:2304
  s_add_u32 s37, s37, 32
  s_and_b32 s35, s35, 0x1ff
  s_cmp_lg_u32 s35, 0
  s_cselect_b32 s28, 0x100, 0
  s_or_b32 s35, s35, s28
  s_branch .g2_kernel_q_kd
.g2_kernel_r2:
  buffer_load_dwordx4 v[240:243], v22, s[4:7], s13 offen offset:0
  buffer_load_dwordx4 v[244:247], v22, s[4:7], s13 offen offset:512
  buffer_load_dwordx4 v[248:251], v22, s[4:7], s13 offen offset:1024
  buffer_load_dwordx4 v[252:255], v22, s[4:7], s13 offen offset:1536
  s_branch .g2_kernel_r3
.g2_kernel_a_t1c:
  s_call_b64 s[68:69], .g2_kernel_a_pick
  s_branch .g2_kernel_a_t1b
.g2_kernel_a_t2c:
  s_call_b64 s[68:69], .g2_kernel_a_pick
  s_branch .g2_kernel_a_t2b
.g2_kernel_a_t3c:
  s_call_b64 s[68:69], .g2_kernel_a_pick
  s_branch .g2_kernel_a_t3b
.g2_kernel_a_three:
  s_andn2_b32 s33, s36, s34
  s_cbranch_scc0 .g2_kernel_a_t1c
.g2_kernel_a_t1b:
  s_ff1_i32_b32 s33, s33
  s_bitset1_b32 s34, s33
  s_xor_b32 s33, s33, s24
  s_lshl_b32 s33, s33, s25
  s_add_u32 s22, s20, s33
  s_addc_u32 s23, s21, 0
  global_load_dwordx4 v[192:195], v3, s[22:23] offset:0
  global_load_dwordx4 v[196:199], v3, s[22:23] offset:1024
  global_load_dwordx4 v[200:203], v3, s[22:23] offset:2048
  global_load_dwordx4 v[204:207], v3, s[22:23] offset:3072
  s_andn2_b32 s33, s36, s34
  s_cbranch_scc0 .g2_kernel_a_t2c
.g2_kernel_a_t2b:
  s_ff1_i32_b32 s33, s33
  s_bitset1_b32 s34, s33
  s_xor_b32 s33, s33, s24
  s_lshl_b32 s33, s33, s25
  s_add_u32 s22, s20, s33
  s_addc_u32 s23, s21, 0
  global_load_dwordx4 v[208:211], v3, s[22:23] offset:0
  global_load_dwordx4 v[212:215], v3, s[22:23] offset:1024
  global_load_dwordx4 v[216:219], v3, s[22:23] offset:2048
  global_load_dwordx4 v[220:223], v3, s[22:23] offset:3072
  s_andn2_b32 s33, s36, s34
  s_cbranch_scc0 .g2_kernel_a_t3c
.g2_kernel_a_t3b:
  s_ff1_i32_b32 s33, s33
  s_bitset1_b32 s34, s33
  s_xor_b32 s33, s33, s24
  s_lshl_b32 s33, s33, s25
  s_add_u32 s22, s20, s33
  s_addc_u32 s23, s21, 0
  global_load_dwordx4 v[224:227], v3, s[22:23] offset:0
  global_load_dwordx4 v[228:231], v3, s[22:23] offset:1024
  global_load_dwordx4 v[232:235], v3, s[22:23] offset:2048
  global_load_dwordx4 v[236:239], v3, s[22:23] offset:3072
  s_setpc_b64 s[72:73]
.g2_kernel_a_o0c:
  s_call_b64 s[68:69], .g2_kernel_a_pick
  s_branch .g2_kernel_a_o0b
.g2_kernel_a_o1c:
  s_call_b64 s[68:69], .g2_kernel_a_pick
  s_branch .g2_kernel_a_o1b
.g2_kernel_a_o2c:
  s_call_b64 s[68:69], .g2_kernel_a_pick
  s_branch .g2_kernel_a_o2b
.g2_kernel_a_o3c:
  s_call_b64 s[68:69], .g2_kernel_a_pick
  s_branch .g2_kernel_a_o3b
.g2_kernel_a_r0c:
  s_call_b64 s[68:69], .g2_kernel_a_pick
  s_branch .g2_kernel_a_r0b
.g2_kernel_a_r1c:
  s_call_b64 s[68:69], .g2_kernel_a_pick
  s_branch .g2_kernel_a_r1b
.g2_kernel_a_r2c:
  s_call_b64 s[68:69], .g2_kernel_a_pick
  s_branch .g2_kernel_a_r2b
.g2_kernel_a_own:
  s_waitcnt vmcnt(0) lgkmcnt(0)
  s_mov_b64 exec, 1
  s_cmp_ge_u32 s35, 0x200
  s_cbranch_scc1 .g2_kernel_a_ow1
  buffer_store_dword v15, v4, s[4:7], s37 offen sc1
  s_branch .g2_kernel_a_ow2
.g2_kernel_a_ow1:
  ds_add_u32 v13, v5 offset:56
.g2_kernel_a_ow2:
  s_mov_b64 exec, -1
  s_add_u32 s37, s37, 64
  s_mov_b32 s14, 0
  s_andn2_b32 s33, s36, s34
  s_cbranch_scc0 .g2_kernel_a_o0c
.g2_kernel_a_o0b:
  s_ff1_i32_b32 s33, s33
  s_bitset1_b32 s34, s33
  s_lshl_b32 s28, s33, 0
  s_or_b32 s14, s14, s28
  s_xor_b32 s33, s33, s24
  s_lshl_b32 s33, s33, s25
  s_add_u32 s22, s20, s33
  s_addc_u32 s23, s21, 0
  global_load_dwordx4 v[176:179], v3, s[22:23] offset:0
  global_load_dwordx4 v[180:183], v3, s[22:23] offset:1024
  global_load_dwordx4 v[184:187], v3, s[22:23] offset:2048
  global_load_dwordx4 v[188:191], v3, s[22:23] offset:3072
  s_andn2_b32 s33, s36, s34
  s_cbranch_scc0 .g2_kernel_a_o1c
.g2_kernel_a_o1b:
  s_ff1_i32_b32 s33, s33
  s_bitset1_b32 s34, s33
  s_lshl_b32 s28, s33, 8
  s_or_b32 s14, s14, s28
  s_xor_b32 s33, s33, s24
  s_lshl_b32 s33, s33, s25
  s_add_u32 s22, s20, s33
  s_addc_u32 s23, s21, 0
  global_load_dwordx4 v[192:195], v3, s[22:23] offset:0
  global_load_dwordx4 v[196:199], v3, s[22:23] offset:1024
  global_load_dwordx4 v[200:203], v3, s[22:23] offset:2048
  global_load_dwordx4 v[204:207], v3, s[22:23] offset:3072
  s_andn2_b32 s33, s36, s34
  s_cbranch_scc0 .g2_kernel_a_o2c
.g2_kernel_a_o2b:
  s_ff1_i32_b32 s33, s33
  s_bitset1_b32 s34, s33
  s_lshl_b32 s28, s33, 16
  s_or_b32 s14, s14, s28
  s_xor_b32 s33, s33, s24
  s_lshl_b32 s33, s33, s25
  s_add_u32 s22, s20, s33
  s_addc_u32 s23, s21, 0
  global_load_dwordx4 v[208:211], v3, s[22:23] offset:0
  global_load_dwordx4 v[212:215], v3, s[22:23] offset:1024
  global_load_dwordx4 v[216:219], v3, s[22:23] offset:2048
  global_load_dwordx4 v[220:223], v3, s[22:23] offset:3072
  s_andn2_b32 s33, s36, s34
  s_cbranch_scc0 .g2_kernel_a_o3c
.g2_kernel_a_o3b:
  s_ff1_i32_b32 s33, s33
  s_bitset1_b32 s34, s33
  s_lshl_b32 s28, s33, 24
  s_or_b32 s14, s14, s28
  s_xor_b32 s33, s33, s24
  s_lshl_b32 s33, s33, s25
  s_add_u32 s22, s20, s33
  s_addc_u32 s23, s21, 0
  global_load_dwordx4 v[224:227], v3, s[22:23] offset:0
  global_load_dwordx4 v[228:231], v3, s[22:23] offset:1024
  global_load_dwordx4 v[232:235], v3, s[22:23] offset:2048
  global_load_dwordx4 v[236:239], v3, s[22:23] offset:3072
  s_and_b32 s15, s34, -2
  s_mov_b32 s34, -1
  s_mov_b32 s26, -1
  s_waitcnt vmcnt(12)
  s_branch .g2_kernel_a_ob
.g2_kernel_a_redo:
  v_mfma_f32_32x32x16_bf16 v[104:119], v[236:239], v[172:175], v[104:119]
  v_smfmac_f32_16x16x64_bf16 v[132:135], v[16:19], v[168:175], v20
  v_mov_b32 v6, s71
  s_mov_b32 s38, 0
.g2_kernel_wg3:
  ds_read_b32 v7, v6 offset:60
  s_add_u32 s38, s38, 1
  s_waitcnt lgkmcnt(0)
  v_cmp_le_u32 vcc, 1, v7
  s_cbranch_vccnz .g2_kernel_wg3d
  s_sleep 1
  s_cmp_lt_u32 s38, 524288
  s_cbranch_scc1 .g2_kernel_wg3
.g2_kernel_wg3d:
  s_mov_b32 s34, s15
  s_mov_b32 s26, 0
  s_mov_b32 s36, 0
  s_sub_u32 s28, s35, 1
  s_bfe_u32 s28, s28, 0x20005
  s_mov_b32 s35, 0
  s_waitcnt vmcnt(0)
  s_cmp_lg_u32 s28, 0
  s_cbranch_scc1 .g2_kernel_a_rd1
  ds_read_b128 v[24:27], v14 offset:8192
  ds_read_b128 v[28:31], v14 offset:9216
  v_mov_b32 v120, 0
  v_mov_b32 v121, 0
  s_waitcnt lgkmcnt(0)
  v_mfma_f32_32x32x16_bf16 v[136:151], v[176:179], v[24:27], 0
  v_mfma_f32_32x32x16_bf16 v[136:151], v[180:183], v[28:31], v[136:151]
  v_mfma_f32_32x32x16_bf16 v[152:167], v[192:195], v[24:27], 0
  v_mfma_f32_32x32x16_bf16 v[152:167], v[196:199], v[28:31], v[152:167]
  s_nop 9
  v_exp_f32 v136, v136
  v_exp_f32 v137, v137
  v_exp_f32 v138, v138
  v_exp_f32 v139, v139
  v_exp_f32 v140, v140
  v_exp_f32 v141, v141
  v_exp_f32 v142, v142
  v_exp_f32 v143, v143
  v_exp_f32 v144, v144
  v_exp_f32 v145, v145
  v_exp_f32 v146, v146
  v_exp_f32 v147, v147
  v_exp_f32 v148, v148
  v_exp_f32 v149, v149
  v_exp_f32 v150, v150
  v_exp_f32 v151, v151
  v_cvt_pk_bf16_f32 v168, v136, v137
  v_cvt_pk_bf16_f32 v169, v138, v139
  v_cvt_pk_bf16_f32 v170, v140, v141
  v_cvt_pk_bf16_f32 v171, v142, v143
  v_cvt_pk_bf16_f32 v172, v144, v145
  v_cvt_pk_bf16_f32 v173, v146, v147
  v_cvt_pk_bf16_f32 v174, v148, v149
  v_cvt_pk_bf16_f32 v175, v150, v151
  v_mfma_f32_32x32x16_bf16 v[56:71], v[184:187], v[168:171], 0
  s_nop 0
  v_mfma_f32_32x32x16_bf16 v[56:71], v[188:191], v[172:175], v[56:71]
  v_smfmac_f32_16x16x64_bf16 v[120:123], v[16:19], v[168:175], v20
  s_call_b64 s[72:73], .g2_kernel_a_ld0
  v_mfma_f32_32x32x16_bf16 v[136:151], v[208:211], v[24:27], 0
  v_mfma_f32_32x32x16_bf16 v[136:151], v[212:215], v[28:31], v[136:151]
  v_exp_f32 v152, v152
  v_exp_f32 v153, v153
  v_exp_f32 v154, v154
  v_exp_f32 v155, v155
  v_exp_f32 v156, v156
  v_exp_f32 v157, v157
  v_exp_f32 v158, v158
  v_exp_f32 v159, v159
  v_exp_f32 v160, v160
  v_exp_f32 v161, v161
  v_exp_f32 v162, v162
  v_exp_f32 v163, v163
  v_exp_f32 v164, v164
  v_exp_f32 v165, v165
  v_exp_f32 v166, v166
  v_exp_f32 v167, v167
  v_cvt_pk_bf16_f32 v168, v152, v153
  v_cvt_pk_bf16_f32 v169, v154, v155
  v_cvt_pk_bf16_f32 v170, v156, v157
  v_cvt_pk_bf16_f32 v171, v158, v159
  v_cvt_pk_bf16_f32 v172, v160, v161
  v_cvt_pk_bf16_f32 v173, v162, v163
  v_cvt_pk_bf16_f32 v174, v164, v165
  v_cvt_pk_bf16_f32 v175, v166, v167
  v_mfma_f32_32x32x16_bf16 v[56:71], v[200:203], v[168:171], v[56:71]
  s_nop 0
  v_mfma_f32_32x32x16_bf16 v[56:71], v[204:207], v[172:175], v[56:71]
  v_smfmac_f32_16x16x64_bf16 v[120:123], v[16:19], v[168:175], v20
  s_call_b64 s[72:73], .g2_kernel_a_ld1
  v_mfma_f32_32x32x16_bf16 v[152:167], v[224:227], v[24:27], 0
  v_mfma_f32_32x32x16_bf16 v[152:167], v[228:231], v[28:31], v[152:167]
  v_exp_f32 v136, v136
  v_exp_f32 v137, v137
  v_exp_f32 v138, v138
  v_exp_f32 v139, v139
  v_exp_f32 v140, v140
  v_exp_f32 v141, v141
  v_exp_f32 v142, v142
  v_exp_f32 v143, v143
  v_exp_f32 v144, v144
  v_exp_f32 v145, v145
  v_exp_f32 v146, v146
  v_exp_f32 v147, v147
  v_exp_f32 v148, v148
  v_exp_f32 v149, v149
  v_exp_f32 v150, v150
  v_exp_f32 v151, v151
  v_cvt_pk_bf16_f32 v168, v136, v137
  v_cvt_pk_bf16_f32 v169, v138, v139
  v_cvt_pk_bf16_f32 v170, v140, v141
  v_cvt_pk_bf16_f32 v171, v142, v143
  v_cvt_pk_bf16_f32 v172, v144, v145
  v_cvt_pk_bf16_f32 v173, v146, v147
  v_cvt_pk_bf16_f32 v174, v148, v149
  v_cvt_pk_bf16_f32 v175, v150, v151
  v_mfma_f32_32x32x16_bf16 v[56:71], v[216:219], v[168:171], v[56:71]
  s_nop 0
  v_mfma_f32_32x32x16_bf16 v[56:71], v[220:223], v[172:175], v[56:71]
  v_smfmac_f32_16x16x64_bf16 v[120:123], v[16:19], v[168:175], v20
  s_call_b64 s[72:73], .g2_kernel_a_ld2
  v_exp_f32 v152, v152
  v_exp_f32 v153, v153
  v_exp_f32 v154, v154
  v_exp_f32 v155, v155
  v_exp_f32 v156, v156
  v_exp_f32 v157, v157
  v_exp_f32 v158, v158
  v_exp_f32 v159, v159
  v_exp_f32 v160, v160
  v_exp_f32 v161, v161
  v_exp_f32 v162, v162
  v_exp_f32 v163, v163
  v_exp_f32 v164, v164
  v_exp_f32 v165, v165
  v_exp_f32 v166, v166
  v_exp_f32 v167, v167
  v_cvt_pk_bf16_f32 v168, v152, v153
  v_cvt_pk_bf16_f32 v169, v154, v155
  v_cvt_pk_bf16_f32 v170, v156, v157
  v_cvt_pk_bf16_f32 v171, v158, v159
  v_cvt_pk_bf16_f32 v172, v160, v161
  v_cvt_pk_bf16_f32 v173, v162, v163
  v_cvt_pk_bf16_f32 v174, v164, v165
  v_cvt_pk_bf16_f32 v175, v166, v167
  v_mfma_f32_32x32x16_bf16 v[56:71], v[232:235], v[168:171], v[56:71]
  s_nop 0
  v_mfma_f32_32x32x16_bf16 v[56:71], v[236:239], v[172:175], v[56:71]
  v_smfmac_f32_16x16x64_bf16 v[120:123], v[16:19], v[168:175], v20
  s_branch .g2_kernel_a_rde
.g2_kernel_a_rd1:
  s_cmp_lg_u32 s28, 1
  s_cbranch_scc1 .g2_kernel_a_rd2
  ds_read_b128 v[32:35], v14 offset:10240
  ds_read_b128 v[36:39], v14 offset:11264
  v_mov_b32 v124, 0
  v_mov_b32 v125, 0
  s_waitcnt lgkmcnt(0)
  v_mfma_f32_32x32x16_bf16 v[136:151], v[176:179], v[32:35], 0
  v_mfma_f32_32x32x16_bf16 v[136:151], v[180:183], v[36:39], v[136:151]
  v_mfma_f32_32x32x16_bf16 v[152:167], v[192:195], v[32:35], 0
  v_mfma_f32_32x32x16_bf16 v[152:167], v[196:199], v[36:39], v[152:167]
  s_nop 9
  v_exp_f32 v136, v136
  v_exp_f32 v137, v137
  v_exp_f32 v138, v138
  v_exp_f32 v139, v139
  v_exp_f32 v140, v140
  v_exp_f32 v141, v141
  v_exp_f32 v142, v142
  v_exp_f32 v143, v143
  v_exp_f32 v144, v144
  v_exp_f32 v145, v145
  v_exp_f32 v146, v146
  v_exp_f32 v147, v147
  v_exp_f32 v148, v148
  v_exp_f32 v149, v149
  v_exp_f32 v150, v150
  v_exp_f32 v151, v151
  v_cvt_pk_bf16_f32 v168, v136, v137
  v_cvt_pk_bf16_f32 v169, v138, v139
  v_cvt_pk_bf16_f32 v170, v140, v141
  v_cvt_pk_bf16_f32 v171, v142, v143
  v_cvt_pk_bf16_f32 v172, v144, v145
  v_cvt_pk_bf16_f32 v173, v146, v147
  v_cvt_pk_bf16_f32 v174, v148, v149
  v_cvt_pk_bf16_f32 v175, v150, v151
  v_mfma_f32_32x32x16_bf16 v[72:87], v[184:187], v[168:171], 0
  s_nop 0
  v_mfma_f32_32x32x16_bf16 v[72:87], v[188:191], v[172:175], v[72:87]
  v_smfmac_f32_16x16x64_bf16 v[124:127], v[16:19], v[168:175], v20
  s_call_b64 s[72:73], .g2_kernel_a_ld0
  v_mfma_f32_32x32x16_bf16 v[136:151], v[208:211], v[32:35], 0
  v_mfma_f32_32x32x16_bf16 v[136:151], v[212:215], v[36:39], v[136:151]
  v_exp_f32 v152, v152
  v_exp_f32 v153, v153
  v_exp_f32 v154, v154
  v_exp_f32 v155, v155
  v_exp_f32 v156, v156
  v_exp_f32 v157, v157
  v_exp_f32 v158, v158
  v_exp_f32 v159, v159
  v_exp_f32 v160, v160
  v_exp_f32 v161, v161
  v_exp_f32 v162, v162
  v_exp_f32 v163, v163
  v_exp_f32 v164, v164
  v_exp_f32 v165, v165
  v_exp_f32 v166, v166
  v_exp_f32 v167, v167
  v_cvt_pk_bf16_f32 v168, v152, v153
  v_cvt_pk_bf16_f32 v169, v154, v155
  v_cvt_pk_bf16_f32 v170, v156, v157
  v_cvt_pk_bf16_f32 v171, v158, v159
  v_cvt_pk_bf16_f32 v172, v160, v161
  v_cvt_pk_bf16_f32 v173, v162, v163
  v_cvt_pk_bf16_f32 v174, v164, v165
  v_cvt_pk_bf16_f32 v175, v166, v167
  v_mfma_f32_32x32x16_bf16 v[72:87], v[200:203], v[168:171], v[72:87]
  s_nop 0
  v_mfma_f32_32x32x16_bf16 v[72:87], v[204:207], v[172:175], v[72:87]
  v_smfmac_f32_16x16x64_bf16 v[124:127], v[16:19], v[168:175], v20
  s_call_b64 s[72:73], .g2_kernel_a_ld1
  v_mfma_f32_32x32x16_bf16 v[152:167], v[224:227], v[32:35], 0
  v_mfma_f32_32x32x16_bf16 v[152:167], v[228:231], v[36:39], v[152:167]
  v_exp_f32 v136, v136
  v_exp_f32 v137, v137
  v_exp_f32 v138, v138
  v_exp_f32 v139, v139
  v_exp_f32 v140, v140
  v_exp_f32 v141, v141
  v_exp_f32 v142, v142
  v_exp_f32 v143, v143
  v_exp_f32 v144, v144
  v_exp_f32 v145, v145
  v_exp_f32 v146, v146
  v_exp_f32 v147, v147
  v_exp_f32 v148, v148
  v_exp_f32 v149, v149
  v_exp_f32 v150, v150
  v_exp_f32 v151, v151
  v_cvt_pk_bf16_f32 v168, v136, v137
  v_cvt_pk_bf16_f32 v169, v138, v139
  v_cvt_pk_bf16_f32 v170, v140, v141
  v_cvt_pk_bf16_f32 v171, v142, v143
  v_cvt_pk_bf16_f32 v172, v144, v145
  v_cvt_pk_bf16_f32 v173, v146, v147
  v_cvt_pk_bf16_f32 v174, v148, v149
  v_cvt_pk_bf16_f32 v175, v150, v151
  v_mfma_f32_32x32x16_bf16 v[72:87], v[216:219], v[168:171], v[72:87]
  s_nop 0
  v_mfma_f32_32x32x16_bf16 v[72:87], v[220:223], v[172:175], v[72:87]
  v_smfmac_f32_16x16x64_bf16 v[124:127], v[16:19], v[168:175], v20
  s_call_b64 s[72:73], .g2_kernel_a_ld2
  v_exp_f32 v152, v152
  v_exp_f32 v153, v153
  v_exp_f32 v154, v154
  v_exp_f32 v155, v155
  v_exp_f32 v156, v156
  v_exp_f32 v157, v157
  v_exp_f32 v158, v158
  v_exp_f32 v159, v159
  v_exp_f32 v160, v160
  v_exp_f32 v161, v161
  v_exp_f32 v162, v162
  v_exp_f32 v163, v163
  v_exp_f32 v164, v164
  v_exp_f32 v165, v165
  v_exp_f32 v166, v166
  v_exp_f32 v167, v167
  v_cvt_pk_bf16_f32 v168, v152, v153
  v_cvt_pk_bf16_f32 v169, v154, v155
  v_cvt_pk_bf16_f32 v170, v156, v157
  v_cvt_pk_bf16_f32 v171, v158, v159
  v_cvt_pk_bf16_f32 v172, v160, v161
  v_cvt_pk_bf16_f32 v173, v162, v163
  v_cvt_pk_bf16_f32 v174, v164, v165
  v_cvt_pk_bf16_f32 v175, v166, v167
  v_mfma_f32_32x32x16_bf16 v[72:87], v[232:235], v[168:171], v[72:87]
  s_nop 0
  v_mfma_f32_32x32x16_bf16 v[72:87], v[236:239], v[172:175], v[72:87]
  v_smfmac_f32_16x16x64_bf16 v[124:127], v[16:19], v[168:175], v20
  s_branch .g2_kernel_a_rde
.g2_kernel_a_rd2:
  s_cmp_lg_u32 s28, 2
  s_cbranch_scc1 .g2_kernel_a_rd3
  ds_read_b128 v[40:43], v14 offset:12288
  ds_read_b128 v[44:47], v14 offset:13312
  v_mov_b32 v128, 0
  v_mov_b32 v129, 0
  s_waitcnt lgkmcnt(0)
  v_mfma_f32_32x32x16_bf16 v[136:151], v[176:179], v[40:43], 0
  v_mfma_f32_32x32x16_bf16 v[136:151], v[180:183], v[44:47], v[136:151]
  v_mfma_f32_32x32x16_bf16 v[152:167], v[192:195], v[40:43], 0
  v_mfma_f32_32x32x16_bf16 v[152:167], v[196:199], v[44:47], v[152:167]
  s_nop 9
  v_exp_f32 v136, v136
  v_exp_f32 v137, v137
  v_exp_f32 v138, v138
  v_exp_f32 v139, v139
  v_exp_f32 v140, v140
  v_exp_f32 v141, v141
  v_exp_f32 v142, v142
  v_exp_f32 v143, v143
  v_exp_f32 v144, v144
  v_exp_f32 v145, v145
  v_exp_f32 v146, v146
  v_exp_f32 v147, v147
  v_exp_f32 v148, v148
  v_exp_f32 v149, v149
  v_exp_f32 v150, v150
  v_exp_f32 v151, v151
  v_cvt_pk_bf16_f32 v168, v136, v137
  v_cvt_pk_bf16_f32 v169, v138, v139
  v_cvt_pk_bf16_f32 v170, v140, v141
  v_cvt_pk_bf16_f32 v171, v142, v143
  v_cvt_pk_bf16_f32 v172, v144, v145
  v_cvt_pk_bf16_f32 v173, v146, v147
  v_cvt_pk_bf16_f32 v174, v148, v149
  v_cvt_pk_bf16_f32 v175, v150, v151
  v_mfma_f32_32x32x16_bf16 v[88:103], v[184:187], v[168:171], 0
  s_nop 0
  v_mfma_f32_32x32x16_bf16 v[88:103], v[188:191], v[172:175], v[88:103]
  v_smfmac_f32_16x16x64_bf16 v[128:131], v[16:19], v[168:175], v20
  s_call_b64 s[72:73], .g2_kernel_a_ld0
  v_mfma_f32_32x32x16_bf16 v[136:151], v[208:211], v[40:43], 0
  v_mfma_f32_32x32x16_bf16 v[136:151], v[212:215], v[44:47], v[136:151]
  v_exp_f32 v152, v152
  v_exp_f32 v153, v153
  v_exp_f32 v154, v154
  v_exp_f32 v155, v155
  v_exp_f32 v156, v156
  v_exp_f32 v157, v157
  v_exp_f32 v158, v158
  v_exp_f32 v159, v159
  v_exp_f32 v160, v160
  v_exp_f32 v161, v161
  v_exp_f32 v162, v162
  v_exp_f32 v163, v163
  v_exp_f32 v164, v164
  v_exp_f32 v165, v165
  v_exp_f32 v166, v166
  v_exp_f32 v167, v167
  v_cvt_pk_bf16_f32 v168, v152, v153
  v_cvt_pk_bf16_f32 v169, v154, v155
  v_cvt_pk_bf16_f32 v170, v156, v157
  v_cvt_pk_bf16_f32 v171, v158, v159
  v_cvt_pk_bf16_f32 v172, v160, v161
  v_cvt_pk_bf16_f32 v173, v162, v163
  v_cvt_pk_bf16_f32 v174, v164, v165
  v_cvt_pk_bf16_f32 v175, v166, v167
  v_mfma_f32_32x32x16_bf16 v[88:103], v[200:203], v[168:171], v[88:103]
  s_nop 0
  v_mfma_f32_32x32x16_bf16 v[88:103], v[204:207], v[172:175], v[88:103]
  v_smfmac_f32_16x16x64_bf16 v[128:131], v[16:19], v[168:175], v20
  s_call_b64 s[72:73], .g2_kernel_a_ld1
  v_mfma_f32_32x32x16_bf16 v[152:167], v[224:227], v[40:43], 0
  v_mfma_f32_32x32x16_bf16 v[152:167], v[228:231], v[44:47], v[152:167]
  v_exp_f32 v136, v136
  v_exp_f32 v137, v137
  v_exp_f32 v138, v138
  v_exp_f32 v139, v139
  v_exp_f32 v140, v140
  v_exp_f32 v141, v141
  v_exp_f32 v142, v142
  v_exp_f32 v143, v143
  v_exp_f32 v144, v144
  v_exp_f32 v145, v145
  v_exp_f32 v146, v146
  v_exp_f32 v147, v147
  v_exp_f32 v148, v148
  v_exp_f32 v149, v149
  v_exp_f32 v150, v150
  v_exp_f32 v151, v151
  v_cvt_pk_bf16_f32 v168, v136, v137
  v_cvt_pk_bf16_f32 v169, v138, v139
  v_cvt_pk_bf16_f32 v170, v140, v141
  v_cvt_pk_bf16_f32 v171, v142, v143
  v_cvt_pk_bf16_f32 v172, v144, v145
  v_cvt_pk_bf16_f32 v173, v146, v147
  v_cvt_pk_bf16_f32 v174, v148, v149
  v_cvt_pk_bf16_f32 v175, v150, v151
  v_mfma_f32_32x32x16_bf16 v[88:103], v[216:219], v[168:171], v[88:103]
  s_nop 0
  v_mfma_f32_32x32x16_bf16 v[88:103], v[220:223], v[172:175], v[88:103]
  v_smfmac_f32_16x16x64_bf16 v[128:131], v[16:19], v[168:175], v20
  s_call_b64 s[72:73], .g2_kernel_a_ld2
  v_exp_f32 v152, v152
  v_exp_f32 v153, v153
  v_exp_f32 v154, v154
  v_exp_f32 v155, v155
  v_exp_f32 v156, v156
  v_exp_f32 v157, v157
  v_exp_f32 v158, v158
  v_exp_f32 v159, v159
  v_exp_f32 v160, v160
  v_exp_f32 v161, v161
  v_exp_f32 v162, v162
  v_exp_f32 v163, v163
  v_exp_f32 v164, v164
  v_exp_f32 v165, v165
  v_exp_f32 v166, v166
  v_exp_f32 v167, v167
  v_cvt_pk_bf16_f32 v168, v152, v153
  v_cvt_pk_bf16_f32 v169, v154, v155
  v_cvt_pk_bf16_f32 v170, v156, v157
  v_cvt_pk_bf16_f32 v171, v158, v159
  v_cvt_pk_bf16_f32 v172, v160, v161
  v_cvt_pk_bf16_f32 v173, v162, v163
  v_cvt_pk_bf16_f32 v174, v164, v165
  v_cvt_pk_bf16_f32 v175, v166, v167
  v_mfma_f32_32x32x16_bf16 v[88:103], v[232:235], v[168:171], v[88:103]
  s_nop 0
  v_mfma_f32_32x32x16_bf16 v[88:103], v[236:239], v[172:175], v[88:103]
  v_smfmac_f32_16x16x64_bf16 v[128:131], v[16:19], v[168:175], v20
  s_branch .g2_kernel_a_rde
.g2_kernel_a_rd3:
  ds_read_b128 v[48:51], v14 offset:14336
  ds_read_b128 v[52:55], v14 offset:15360
  v_mov_b32 v132, 0
  v_mov_b32 v133, 0
  s_waitcnt lgkmcnt(0)
  v_mfma_f32_32x32x16_bf16 v[136:151], v[176:179], v[48:51], 0
  v_mfma_f32_32x32x16_bf16 v[136:151], v[180:183], v[52:55], v[136:151]
  v_mfma_f32_32x32x16_bf16 v[152:167], v[192:195], v[48:51], 0
  v_mfma_f32_32x32x16_bf16 v[152:167], v[196:199], v[52:55], v[152:167]
  s_nop 9
  v_exp_f32 v136, v136
  v_exp_f32 v137, v137
  v_exp_f32 v138, v138
  v_exp_f32 v139, v139
  v_exp_f32 v140, v140
  v_exp_f32 v141, v141
  v_exp_f32 v142, v142
  v_exp_f32 v143, v143
  v_exp_f32 v144, v144
  v_exp_f32 v145, v145
  v_exp_f32 v146, v146
  v_exp_f32 v147, v147
  v_exp_f32 v148, v148
  v_exp_f32 v149, v149
  v_exp_f32 v150, v150
  v_exp_f32 v151, v151
  v_cvt_pk_bf16_f32 v168, v136, v137
  v_cvt_pk_bf16_f32 v169, v138, v139
  v_cvt_pk_bf16_f32 v170, v140, v141
  v_cvt_pk_bf16_f32 v171, v142, v143
  v_cvt_pk_bf16_f32 v172, v144, v145
  v_cvt_pk_bf16_f32 v173, v146, v147
  v_cvt_pk_bf16_f32 v174, v148, v149
  v_cvt_pk_bf16_f32 v175, v150, v151
  v_mfma_f32_32x32x16_bf16 v[104:119], v[184:187], v[168:171], 0
  s_nop 0
  v_mfma_f32_32x32x16_bf16 v[104:119], v[188:191], v[172:175], v[104:119]
  v_smfmac_f32_16x16x64_bf16 v[132:135], v[16:19], v[168:175], v20
  s_call_b64 s[72:73], .g2_kernel_a_ld0
  v_mfma_f32_32x32x16_bf16 v[136:151], v[208:211], v[48:51], 0
  v_mfma_f32_32x32x16_bf16 v[136:151], v[212:215], v[52:55], v[136:151]
  v_exp_f32 v152, v152
  v_exp_f32 v153, v153
  v_exp_f32 v154, v154
  v_exp_f32 v155, v155
  v_exp_f32 v156, v156
  v_exp_f32 v157, v157
  v_exp_f32 v158, v158
  v_exp_f32 v159, v159
  v_exp_f32 v160, v160
  v_exp_f32 v161, v161
  v_exp_f32 v162, v162
  v_exp_f32 v163, v163
  v_exp_f32 v164, v164
  v_exp_f32 v165, v165
  v_exp_f32 v166, v166
  v_exp_f32 v167, v167
  v_cvt_pk_bf16_f32 v168, v152, v153
  v_cvt_pk_bf16_f32 v169, v154, v155
  v_cvt_pk_bf16_f32 v170, v156, v157
  v_cvt_pk_bf16_f32 v171, v158, v159
  v_cvt_pk_bf16_f32 v172, v160, v161
  v_cvt_pk_bf16_f32 v173, v162, v163
  v_cvt_pk_bf16_f32 v174, v164, v165
  v_cvt_pk_bf16_f32 v175, v166, v167
  v_mfma_f32_32x32x16_bf16 v[104:119], v[200:203], v[168:171], v[104:119]
  s_nop 0
  v_mfma_f32_32x32x16_bf16 v[104:119], v[204:207], v[172:175], v[104:119]
  v_smfmac_f32_16x16x64_bf16 v[132:135], v[16:19], v[168:175], v20
  s_call_b64 s[72:73], .g2_kernel_a_ld1
  v_mfma_f32_32x32x16_bf16 v[152:167], v[224:227], v[48:51], 0
  v_mfma_f32_32x32x16_bf16 v[152:167], v[228:231], v[52:55], v[152:167]
  v_exp_f32 v136, v136
  v_exp_f32 v137, v137
  v_exp_f32 v138, v138
  v_exp_f32 v139, v139
  v_exp_f32 v140, v140
  v_exp_f32 v141, v141
  v_exp_f32 v142, v142
  v_exp_f32 v143, v143
  v_exp_f32 v144, v144
  v_exp_f32 v145, v145
  v_exp_f32 v146, v146
  v_exp_f32 v147, v147
  v_exp_f32 v148, v148
  v_exp_f32 v149, v149
  v_exp_f32 v150, v150
  v_exp_f32 v151, v151
  v_cvt_pk_bf16_f32 v168, v136, v137
  v_cvt_pk_bf16_f32 v169, v138, v139
  v_cvt_pk_bf16_f32 v170, v140, v141
  v_cvt_pk_bf16_f32 v171, v142, v143
  v_cvt_pk_bf16_f32 v172, v144, v145
  v_cvt_pk_bf16_f32 v173, v146, v147
  v_cvt_pk_bf16_f32 v174, v148, v149
  v_cvt_pk_bf16_f32 v175, v150, v151
  v_mfma_f32_32x32x16_bf16 v[104:119], v[216:219], v[168:171], v[104:119]
  s_nop 0
  v_mfma_f32_32x32x16_bf16 v[104:119], v[220:223], v[172:175], v[104:119]
  v_smfmac_f32_16x16x64_bf16 v[132:135], v[16:19], v[168:175], v20
  s_call_b64 s[72:73], .g2_kernel_a_ld2
  v_exp_f32 v152, v152
  v_exp_f32 v153, v153
  v_exp_f32 v154, v154
  v_exp_f32 v155, v155
  v_exp_f32 v156, v156
  v_exp_f32 v157, v157
  v_exp_f32 v158, v158
  v_exp_f32 v159, v159
  v_exp_f32 v160, v160
  v_exp_f32 v161, v161
  v_exp_f32 v162, v162
  v_exp_f32 v163, v163
  v_exp_f32 v164, v164
  v_exp_f32 v165, v165
  v_exp_f32 v166, v166
  v_exp_f32 v167, v167
  v_cvt_pk_bf16_f32 v168, v152, v153
  v_cvt_pk_bf16_f32 v169, v154, v155
  v_cvt_pk_bf16_f32 v170, v156, v157
  v_cvt_pk_bf16_f32 v171, v158, v159
  v_cvt_pk_bf16_f32 v172, v160, v161
  v_cvt_pk_bf16_f32 v173, v162, v163
  v_cvt_pk_bf16_f32 v174, v164, v165
  v_cvt_pk_bf16_f32 v175, v166, v167
  v_mfma_f32_32x32x16_bf16 v[104:119], v[232:235], v[168:171], v[104:119]
  s_nop 0
  v_mfma_f32_32x32x16_bf16 v[104:119], v[236:239], v[172:175], v[104:119]
  v_smfmac_f32_16x16x64_bf16 v[132:135], v[16:19], v[168:175], v20
  s_branch .g2_kernel_a_rde
.g2_kernel_a_rd4:
.g2_kernel_a_rde:
  v_mov_b32 v168, 0
  v_mov_b32 v169, 0
  v_mov_b32 v170, 0
  v_mov_b32 v171, 0
  v_mov_b32 v172, 0
  v_mov_b32 v173, 0
  v_mov_b32 v174, 0
  v_mov_b32 v175, 0
  s_waitcnt vmcnt(8)
  v_mfma_f32_32x32x16_bf16 v[136:151], v[176:179], v[24:27], 0
  v_mfma_f32_32x32x16_bf16 v[136:151], v[180:183], v[28:31], v[136:151]
  s_nop 10
  s_branch .g2_kernel_a_loop
.g2_kernel_a_ld0:
  s_andn2_b32 s33, s36, s34
  s_cbranch_scc0 .g2_kernel_a_r0c
.g2_kernel_a_r0b:
  s_ff1_i32_b32 s33, s33
  s_bitset1_b32 s34, s33
  s_xor_b32 s33, s33, s24
  s_lshl_b32 s33, s33, s25
  s_add_u32 s22, s20, s33
  s_addc_u32 s23, s21, 0
  global_load_dwordx4 v[176:179], v3, s[22:23] offset:0
  global_load_dwordx4 v[180:183], v3, s[22:23] offset:1024
  global_load_dwordx4 v[184:187], v3, s[22:23] offset:2048
  global_load_dwordx4 v[188:191], v3, s[22:23] offset:3072
  s_setpc_b64 s[72:73]
.g2_kernel_a_ld1:
  s_andn2_b32 s33, s36, s34
  s_cbranch_scc0 .g2_kernel_a_r1c
.g2_kernel_a_r1b:
  s_ff1_i32_b32 s33, s33
  s_bitset1_b32 s34, s33
  s_xor_b32 s33, s33, s24
  s_lshl_b32 s33, s33, s25
  s_add_u32 s22, s20, s33
  s_addc_u32 s23, s21, 0
  global_load_dwordx4 v[192:195], v3, s[22:23] offset:0
  global_load_dwordx4 v[196:199], v3, s[22:23] offset:1024
  global_load_dwordx4 v[200:203], v3, s[22:23] offset:2048
  global_load_dwordx4 v[204:207], v3, s[22:23] offset:3072
  s_setpc_b64 s[72:73]
.g2_kernel_a_ld2:
  s_andn2_b32 s33, s36, s34
  s_cbranch_scc0 .g2_kernel_a_r2c
.g2_kernel_a_r2b:
  s_ff1_i32_b32 s33, s33
  s_bitset1_b32 s34, s33
  s_xor_b32 s33, s33, s24
  s_lshl_b32 s33, s33, s25
  s_add_u32 s22, s20, s33
  s_addc_u32 s23, s21, 0
  global_load_dwordx4 v[208:211], v3, s[22:23] offset:0
  global_load_dwordx4 v[212:215], v3, s[22:23] offset:1024
  global_load_dwordx4 v[216:219], v3, s[22:23] offset:2048
  global_load_dwordx4 v[220:223], v3, s[22:23] offset:3072
  s_setpc_b64 s[72:73]
.g2_kernel_a_N0c:
  s_call_b64 s[68:69], .g2_kernel_a_pick
  s_branch .g2_kernel_a_N0b
.g2_kernel_a_N1c:
  s_call_b64 s[68:69], .g2_kernel_a_pick
  s_branch .g2_kernel_a_N1b
.g2_kernel_a_N2c:
  s_call_b64 s[68:69], .g2_kernel_a_pick
  s_branch .g2_kernel_a_N2b
.g2_kernel_a_N3c:
  s_call_b64 s[68:69], .g2_kernel_a_pick
  s_branch .g2_kernel_a_N3b
.g2_kernel_a_L3c:
  s_call_b64 s[68:69], .g2_kernel_a_pick
  s_branch .g2_kernel_a_L3b
.g2_kernel_a_G0c:
  s_call_b64 s[68:69], .g2_kernel_a_pick
  s_branch .g2_kernel_a_G0b
.g2_kernel_a_L3g:
  s_mov_b32 s38, 0
.g2_kernel_a_L3gl:
  ds_read_b32 v7, v13 offset:8
  s_add_u32 s38, s38, 1
  s_waitcnt lgkmcnt(0)
  v_cmp_gt_u32 vcc, s27, v7
  s_cbranch_vccz .g2_kernel_a_L3h
  s_cmp_lt_u32 s38, 524288
  s_cbranch_scc1 .g2_kernel_a_L3gl
  s_branch .g2_kernel_a_L3h
.g2_kernel_a_hold:
  s_lshl_b32 s33, 1, s14
  s_lshr_b32 s14, s14, 8
  s_setpc_b64 s[68:69]
.g2_kernel_a_pick:
  s_cmp_lg_u32 s34, -1
  s_cbranch_scc1 .g2_kernel_a_pk1
  s_cmp_eq_u32 s26, -1
  s_cbranch_scc1 .g2_kernel_a_hold
  s_add_u32 s26, s26, 1
  s_mov_b32 s34, 0xffff
  s_cmp_eq_u32 s26, 1
  s_cbranch_scc1 .g2_kernel_a_pk1
  v_and_b32 v8, 15, v2
  s_lshl_b32 s28, s16, 6
  s_add_u32 s28, s28, 157696
  v_lshl_add_u32 v8, v8, 2, s28
  s_lshl_b32 s28, s17, 2
  s_add_u32 s28, s28, s16
  s_lshl_b32 s28, s28, 16
  s_add_u32 s28, s28, s63
  s_add_u32 s28, s28, 0x800000
  s_add_u32 s20, s60, s28
  s_addc_u32 s21, s61, 0
  s_lshl_b32 s24, s18, 1
  s_and_b32 s24, s24, 6
  s_mov_b32 s25, 12
  s_mov_b32 s34, 0
  s_mov_b32 s36, 0xff
  s_mov_b32 s33, 0xff
  s_mov_b32 s38, 0
.g2_kernel_a_pk2:
  ds_read_b32 v7, v8
  s_add_u32 s38, s38, 1
  s_waitcnt lgkmcnt(0)
  v_cmp_ge_u32 vcc, s62, v7
  s_cbranch_vccz .g2_kernel_a_pkr
  s_cmp_lt_u32 s38, 524288
  s_cbranch_scc1 .g2_kernel_a_pk2
  s_branch .g2_kernel_a_pkr
.g2_kernel_a_pk1:
  s_mov_b32 s38, 0
.g2_kernel_a_pkl:
  ds_read_b32 v7, v8
  s_add_u32 s38, s38, 1
  s_waitcnt lgkmcnt(0)
  v_cmp_lt_u32 vcc, s62, v7
  s_mov_b32 s36, vcc_lo
  s_andn2_b32 s33, s36, s34
  s_cbranch_scc1 .g2_kernel_a_pkr
  s_cmp_lt_u32 s38, 524288
  s_cbranch_scc1 .g2_kernel_a_pkl
  s_not_b32 s33, s34
.g2_kernel_a_pkr:
  s_setpc_b64 s[68:69]
.g2_kernel_w_aw:
  v_mov_b32 v6, s71
  s_mov_b32 s38, 0
.g2_kernel_wg4:
  ds_read_b32 v7, v6 offset:52
  s_add_u32 s38, s38, 1
  s_waitcnt lgkmcnt(0)
  v_cmp_le_u32 vcc, 4, v7
  s_cbranch_vccnz .g2_kernel_wg4d
  s_sleep 1
  s_cmp_lt_u32 s38, 524288
  s_cbranch_scc1 .g2_kernel_wg4
.g2_kernel_wg4d:
  s_branch .g2_kernel_w_ab
.g2_kernel_w_pt:
  v_lshlrev_b32 v7, 5, v17
  v_add_u32 v7, 155648, v7
  s_mov_b64 exec, vcc
  ds_read_b128 v[240:243], v7 offset:7680
  ds_read_b128 v[244:247], v7 offset:7696
  ds_read_b128 v[248:251], v7 offset:7744
  ds_read_b128 v[252:255], v7 offset:7760
  s_waitcnt lgkmcnt(0)
  v_pk_add_f32 v[24:25], v[24:25], v[240:241]
  v_pk_add_f32 v[26:27], v[26:27], v[242:243]
  v_pk_add_f32 v[28:29], v[28:29], v[244:245]
  v_pk_add_f32 v[30:31], v[30:31], v[246:247]
  v_pk_add_f32 v[32:33], v[32:33], v[248:249]
  v_pk_add_f32 v[34:35], v[34:35], v[250:251]
  v_pk_add_f32 v[36:37], v[36:37], v[252:253]
  v_pk_add_f32 v[38:39], v[38:39], v[254:255]
  ds_read_b128 v[240:243], v7 offset:7808
  ds_read_b128 v[244:247], v7 offset:7824
  ds_read_b128 v[248:251], v7 offset:7872
  ds_read_b128 v[252:255], v7 offset:7888
  s_waitcnt lgkmcnt(0)
  v_pk_add_f32 v[40:41], v[40:41], v[240:241]
  v_pk_add_f32 v[42:43], v[42:43], v[242:243]
  v_pk_add_f32 v[44:45], v[44:45], v[244:245]
  v_pk_add_f32 v[46:47], v[46:47], v[246:247]
  v_pk_add_f32 v[48:49], v[48:49], v[248:249]
  v_pk_add_f32 v[50:51], v[50:51], v[250:251]
  v_pk_add_f32 v[52:53], v[52:53], v[252:253]
  v_pk_add_f32 v[54:55], v[54:55], v[254:255]
  s_mov_b64 exec, -1
  s_branch .g2_kernel_w_pb
.g2_kernel_w_i8c:
  s_mov_b32 s38, 0
  s_call_b64 s[68:69], .g2_kernel_w_pkl
  s_branch .g2_kernel_w_i8b
.g2_kernel_w_i9c:
  s_mov_b32 s38, 0
  s_call_b64 s[68:69], .g2_kernel_w_pkl
  s_branch .g2_kernel_w_i9b
.g2_kernel_w_i10c:
  s_mov_b32 s38, 0
  s_call_b64 s[68:69], .g2_kernel_w_pkl
  s_branch .g2_kernel_w_i10b
.g2_kernel_w_i11c:
  s_mov_b32 s38, 0
  s_call_b64 s[68:69], .g2_kernel_w_pkl
  s_branch .g2_kernel_w_i11b
.g2_kernel_w_v8:
  s_cmp_ge_u32 s8, 139264
  s_cselect_b32 s28, 139264, 0
  s_sub_u32 s28, s8, s28
  s_lshr_b32 s28, s28, 1
  s_add_u32 s28, s28, 32768
  s_add_u32 s22, s20, s28
  s_addc_u32 s23, s21, 0
  s_mov_b32 s38, 0
.g2_kernel_w_vl8:
  global_load_dwordx4 v[88:91], v3, s[22:23] offset:0 sc1
  global_load_dwordx4 v[92:95], v3, s[22:23] offset:1024 sc1
  global_load_dwordx4 v[96:99], v3, s[22:23] offset:2048 sc1
  global_load_dwordx4 v[100:103], v3, s[22:23] offset:3072 sc1
  s_add_u32 s38, s38, 1
  s_waitcnt vmcnt(0)
  v_min3_u32 v6, v88, v90, v92
  v_min3_u32 v7, v94, v96, v98
  v_min3_u32 v6, v6, v100, v102
  v_min_u32 v6, v6, v7
  v_cmp_eq_u32 vcc, 0, v6
  s_cbranch_vccz .g2_kernel_w_vb8
  s_cmp_lt_u32 s38, 131072
  s_cbranch_scc1 .g2_kernel_w_vl8
  s_branch .g2_kernel_w_vb8
.g2_kernel_w_i12c:
  s_mov_b32 s38, 0
  s_call_b64 s[68:69], .g2_kernel_w_pkl
  s_branch .g2_kernel_w_i12b
.g2_kernel_w_v9:
  s_cmp_ge_u32 s9, 139264
  s_cselect_b32 s28, 139264, 0
  s_sub_u32 s28, s9, s28
  s_lshr_b32 s28, s28, 1
  s_add_u32 s28, s28, 32768
  s_add_u32 s22, s20, s28
  s_addc_u32 s23, s21, 0
  s_mov_b32 s38, 0
.g2_kernel_w_vl9:
  global_load_dwordx4 v[176:179], v3, s[22:23] offset:0 sc1
  global_load_dwordx4 v[180:183], v3, s[22:23] offset:1024 sc1
  global_load_dwordx4 v[184:187], v3, s[22:23] offset:2048 sc1
  global_load_dwordx4 v[188:191], v3, s[22:23] offset:3072 sc1
  s_add_u32 s38, s38, 1
  s_waitcnt vmcnt(0)
  v_min3_u32 v6, v176, v178, v180
  v_min3_u32 v7, v182, v184, v186
  v_min3_u32 v6, v6, v188, v190
  v_min_u32 v6, v6, v7
  v_cmp_eq_u32 vcc, 0, v6
  s_cbranch_vccz .g2_kernel_w_vb9
  s_cmp_lt_u32 s38, 131072
  s_cbranch_scc1 .g2_kernel_w_vl9
  s_branch .g2_kernel_w_vb9
.g2_kernel_w_i13c:
  s_mov_b32 s38, 0
  s_call_b64 s[68:69], .g2_kernel_w_pkl
  s_branch .g2_kernel_w_i13b
.g2_kernel_w_v10:
  s_cmp_ge_u32 s10, 139264
  s_cselect_b32 s28, 139264, 0
  s_sub_u32 s28, s10, s28
  s_lshr_b32 s28, s28, 1
  s_add_u32 s28, s28, 32768
  s_add_u32 s22, s20, s28
  s_addc_u32 s23, s21, 0
  s_mov_b32 s38, 0
.g2_kernel_w_vl10:
  global_load_dwordx4 v[192:195], v3, s[22:23] offset:0 sc1
  global_load_dwordx4 v[196:199], v3, s[22:23] offset:1024 sc1
  global_load_dwordx4 v[200:203], v3, s[22:23] offset:2048 sc1
  global_load_dwordx4 v[204:207], v3, s[22:23] offset:3072 sc1
  s_add_u32 s38, s38, 1
  s_waitcnt vmcnt(0)
  v_min3_u32 v6, v192, v194, v196
  v_min3_u32 v7, v198, v200, v202
  v_min3_u32 v6, v6, v204, v206
  v_min_u32 v6, v6, v7
  v_cmp_eq_u32 vcc, 0, v6
  s_cbranch_vccz .g2_kernel_w_vb10
  s_cmp_lt_u32 s38, 131072
  s_cbranch_scc1 .g2_kernel_w_vl10
  s_branch .g2_kernel_w_vb10
.g2_kernel_w_i14c:
  s_mov_b32 s38, 524288
  s_call_b64 s[68:69], .g2_kernel_w_pkl
  s_branch .g2_kernel_w_i14b
.g2_kernel_w_v11:
  s_cmp_ge_u32 s11, 139264
  s_cselect_b32 s28, 139264, 0
  s_sub_u32 s28, s11, s28
  s_lshr_b32 s28, s28, 1
  s_add_u32 s28, s28, 32768
  s_add_u32 s22, s20, s28
  s_addc_u32 s23, s21, 0
  s_mov_b32 s38, 0
.g2_kernel_w_vl11:
  global_load_dwordx4 v[208:211], v3, s[22:23] offset:0 sc1
  global_load_dwordx4 v[212:215], v3, s[22:23] offset:1024 sc1
  global_load_dwordx4 v[216:219], v3, s[22:23] offset:2048 sc1
  global_load_dwordx4 v[220:223], v3, s[22:23] offset:3072 sc1
  s_add_u32 s38, s38, 1
  s_waitcnt vmcnt(0)
  v_min3_u32 v6, v208, v210, v212
  v_min3_u32 v7, v214, v216, v218
  v_min3_u32 v6, v6, v220, v222
  v_min_u32 v6, v6, v7
  v_cmp_eq_u32 vcc, 0, v6
  s_cbranch_vccz .g2_kernel_w_vb11
  s_cmp_lt_u32 s38, 131072
  s_cbranch_scc1 .g2_kernel_w_vl11
  s_branch .g2_kernel_w_vb11
.g2_kernel_w_i15c:
  s_mov_b32 s38, 524288
  s_call_b64 s[68:69], .g2_kernel_w_pkl
  s_branch .g2_kernel_w_i15b
.g2_kernel_w_v12:
  s_cmp_ge_u32 s12, 139264
  s_cselect_b32 s28, 139264, 0
  s_sub_u32 s28, s12, s28
  s_lshr_b32 s28, s28, 1
  s_add_u32 s28, s28, 32768
  s_add_u32 s22, s20, s28
  s_addc_u32 s23, s21, 0
  s_mov_b32 s38, 0
.g2_kernel_w_vl12:
  global_load_dwordx4 v[224:227], v3, s[22:23] offset:0 sc1
  global_load_dwordx4 v[228:231], v3, s[22:23] offset:1024 sc1
  global_load_dwordx4 v[232:235], v3, s[22:23] offset:2048 sc1
  global_load_dwordx4 v[236:239], v3, s[22:23] offset:3072 sc1
  s_add_u32 s38, s38, 1
  s_waitcnt vmcnt(0)
  v_min3_u32 v6, v224, v226, v228
  v_min3_u32 v7, v230, v232, v234
  v_min3_u32 v6, v6, v236, v238
  v_min_u32 v6, v6, v7
  v_cmp_eq_u32 vcc, 0, v6
  s_cbranch_vccz .g2_kernel_w_vb12
  s_cmp_lt_u32 s38, 131072
  s_cbranch_scc1 .g2_kernel_w_vl12
  s_branch .g2_kernel_w_vb12
.g2_kernel_w_v13:
  s_cmp_ge_u32 s13, 139264
  s_cselect_b32 s28, 139264, 0
  s_sub_u32 s28, s13, s28
  s_lshr_b32 s28, s28, 1
  s_add_u32 s28, s28, 32768
  s_add_u32 s22, s20, s28
  s_addc_u32 s23, s21, 0
  s_mov_b32 s38, 0
.g2_kernel_w_vl13:
  global_load_dwordx4 v[136:139], v3, s[22:23] offset:0 sc1
  global_load_dwordx4 v[140:143], v3, s[22:23] offset:1024 sc1
  global_load_dwordx4 v[144:147], v3, s[22:23] offset:2048 sc1
  global_load_dwordx4 v[148:151], v3, s[22:23] offset:3072 sc1
  s_add_u32 s38, s38, 1
  s_waitcnt vmcnt(0)
  v_min3_u32 v6, v136, v138, v140
  v_min3_u32 v7, v142, v144, v146
  v_min3_u32 v6, v6, v148, v150
  v_min_u32 v6, v6, v7
  v_cmp_eq_u32 vcc, 0, v6
  s_cbranch_vccz .g2_kernel_w_vb13
  s_cmp_lt_u32 s38, 131072
  s_cbranch_scc1 .g2_kernel_w_vl13
  s_branch .g2_kernel_w_vb13
.g2_kernel_w_v14:
  s_cmp_ge_u32 s14, 139264
  s_cselect_b32 s28, 139264, 0
  s_sub_u32 s28, s14, s28
  s_lshr_b32 s28, s28, 1
  s_add_u32 s28, s28, 32768
  s_add_u32 s22, s20, s28
  s_addc_u32 s23, s21, 0
  s_mov_b32 s38, 0
.g2_kernel_w_vl14:
  global_load_dwordx4 v[152:155], v3, s[22:23] offset:0 sc1
  global_load_dwordx4 v[156:159], v3, s[22:23] offset:1024 sc1
  global_load_dwordx4 v[160:163], v3, s[22:23] offset:2048 sc1
  global_load_dwordx4 v[164:167], v3, s[22:23] offset:3072 sc1
  s_add_u32 s38, s38, 1
  s_waitcnt vmcnt(0)
  v_min3_u32 v6, v152, v154, v156
  v_min3_u32 v7, v158, v160, v162
  v_min3_u32 v6, v6, v164, v166
  v_min_u32 v6, v6, v7
  v_cmp_eq_u32 vcc, 0, v6
  s_cbranch_vccz .g2_kernel_w_vb14
  s_cmp_lt_u32 s38, 131072
  s_cbranch_scc1 .g2_kernel_w_vl14
  s_branch .g2_kernel_w_vb14
.g2_kernel_w_v15:
  s_cmp_ge_u32 s15, 139264
  s_cselect_b32 s28, 139264, 0
  s_sub_u32 s28, s15, s28
  s_lshr_b32 s28, s28, 1
  s_add_u32 s28, s28, 32768
  s_add_u32 s22, s20, s28
  s_addc_u32 s23, s21, 0
  s_mov_b32 s38, 0
.g2_kernel_w_vl15:
  global_load_dwordx4 v[56:59], v3, s[22:23] offset:0 sc1
  global_load_dwordx4 v[60:63], v3, s[22:23] offset:1024 sc1
  global_load_dwordx4 v[64:67], v3, s[22:23] offset:2048 sc1
  global_load_dwordx4 v[68:71], v3, s[22:23] offset:3072 sc1
  s_add_u32 s38, s38, 1
  s_waitcnt vmcnt(0)
  v_min3_u32 v6, v56, v58, v60
  v_min3_u32 v7, v62, v64, v66
  v_min3_u32 v6, v6, v68, v70
  v_min_u32 v6, v6, v7
  v_cmp_eq_u32 vcc, 0, v6
  s_cbranch_vccz .g2_kernel_w_vb15
  s_cmp_lt_u32 s38, 131072
  s_cbranch_scc1 .g2_kernel_w_vl15
  s_branch .g2_kernel_w_vb15
.g2_kernel_w_bw:
  s_mov_b32 s38, 0
.g2_kernel_w_bwl:
  ds_read_b32 v16, v20 offset:12
  s_add_u32 s38, s38, 1
  s_waitcnt lgkmcnt(0)
  v_cmp_gt_u32 vcc, 4, v16
  s_cbranch_vccz .g2_kernel_w_bb
  s_cmp_lt_u32 s38, 524288
  s_cbranch_scc1 .g2_kernel_w_bwl
  s_branch .g2_kernel_w_bb
.g2_kernel_w_pick:
  s_mov_b32 s38, 0
.g2_kernel_w_pkl:
  ds_read_b64 v[6:7], v21
  s_add_u32 s38, s38, 1
  s_waitcnt lgkmcnt(0)
  v_min_u32 v6, v6, v7
  v_cmp_lt_u32 vcc, s62, v6
  s_and_b32 s36, vcc_lo, 0xff00
  s_andn2_b32 s33, s36, s34
  s_cbranch_scc1 .g2_kernel_w_pkr
  s_cmp_lt_u32 s38, 524288
  s_cbranch_scc1 .g2_kernel_w_pkl
  s_andn2_b32 s33, 0xff00, s34
.g2_kernel_w_pkr:
  s_setpc_b64 s[68:69]
.g2_kernel_p_spin:
  s_mov_b32 s38, 0
.g2_kernel_p_spinl:
  ds_read_b32 v10, v9
  s_add_u32 s38, s38, 1
  s_waitcnt lgkmcnt(0)
  v_cmp_gt_i32 vcc, s34, v10
  s_cbranch_vccz .g2_kernel_p_spinr
  s_sleep 1
  s_cmp_lt_u32 s38, 524288
  s_cbranch_scc1 .g2_kernel_p_spinl
.g2_kernel_p_spinr:
  s_setpc_b64 s[68:69]
.g2_kernel_p1_aw:
  s_call_b64 s[68:69], .g2_kernel_p_spin
  s_branch .g2_kernel_p1_ai
.g2_kernel_p1_bw:
  s_call_b64 s[68:69], .g2_kernel_p_spin
  s_branch .g2_kernel_p1_bi
.g2_kernel_v_may:
  s_cmp_lg_u32 s39, 0
  s_cbranch_scc1 .g2_kernel_v_mr
  s_and_b32 s28, s16, 3
  s_lshl_b32 s28, s28, 4
  s_add_u32 s28, s28, 155968
  v_mov_b32 v6, s28
  ds_read_b32 v7, v6
  s_waitcnt lgkmcnt(0)
  v_cmp_ne_u32 vcc, 0, v7
  s_cbranch_vccz .g2_kernel_v_mr
.g2_kernel_v_do:
  s_mov_b32 s39, 1
  s_mov_b32 s29, 0
  s_call_b64 s[68:69], .g2_kernel_v_cmb
  s_waitcnt vmcnt(0)
  v_mov_b32 v6, s71
  s_mov_b64 exec, 1
  ds_add_u32 v6, v5 offset:8
  s_mov_b64 exec, -1
  s_and_b32 s33, s16, 3
  s_lshl_b32 s33, s33, 7
  s_lshl_b32 s28, s29, 2
  s_add_u32 s33, s33, s28
  s_add_u32 s31, s19, s33
  v_mov_b32 v6, s70
  s_mov_b64 exec, 1
  buffer_store_dword v6, v4, s[4:7], s31 offen offset:0 sc1
  s_mov_b64 exec, -1
.g2_kernel_v_mr:
  s_setpc_b64 s[26:27]
.g2_kernel_v_wo:
  s_mov_b32 s8, s44
  s_mov_b32 s9, s45
  s_mov_b32 s10, 0x200000
  s_mov_b32 s11, 0x00020000
  v_lshrrev_b32 v6, 3, v2
  v_and_b32 v7, 7, v2
  v_bfe_u32 v8, v2, 4, 1
  v_lshlrev_b32 v8, 2, v8
  v_xor_b32 v7, v7, v8
  v_lshlrev_b32 v7, 4, v7
  v_lshl_add_u32 v6, v6, 11, v7
  s_and_b32 s31, s16, 3
  s_lshl_b32 s31, s31, 3
  s_add_u32 s31, s31, s29
  s_lshl_b32 s31, s31, 16
  s_lshl_b32 s33, s18, 7
  s_add_u32 s31, s31, s33
  s_mov_b32 m0, s30
  s_nop 0
  buffer_load_dwordx4 v6, s[8:11], s31 offen lds
  s_add_u32 m0, m0, 1024
  s_add_u32 s31, s31, 16384
  buffer_load_dwordx4 v6, s[8:11], s31 offen lds
  s_add_u32 m0, m0, 1024
  s_add_u32 s31, s31, 16384
  buffer_load_dwordx4 v6, s[8:11], s31 offen lds
  s_add_u32 m0, m0, 1024
  s_add_u32 s31, s31, 16384
  buffer_load_dwordx4 v6, s[8:11], s31 offen lds
  s_add_u32 m0, m0, 1024
  s_add_u32 s31, s31, 81920
  buffer_load_dwordx4 v6, s[8:11], s31 offen lds
  s_add_u32 m0, m0, 1024
  s_add_u32 s31, s31, 16384
  buffer_load_dwordx4 v6, s[8:11], s31 offen lds
  s_add_u32 m0, m0, 1024
  s_add_u32 s31, s31, 16384
  buffer_load_dwordx4 v6, s[8:11], s31 offen lds
  s_add_u32 m0, m0, 1024
  s_add_u32 s31, s31, 16384
  buffer_load_dwordx4 v6, s[8:11], s31 offen lds
  s_add_u32 m0, m0, 1024
  s_add_u32 s31, s31, 81920
  buffer_load_dwordx4 v6, s[8:11], s31 offen lds
  s_add_u32 m0, m0, 1024
  s_add_u32 s31, s31, 16384
  buffer_load_dwordx4 v6, s[8:11], s31 offen lds
  s_add_u32 m0, m0, 1024
  s_add_u32 s31, s31, 16384
  buffer_load_dwordx4 v6, s[8:11], s31 offen lds
  s_add_u32 m0, m0, 1024
  s_add_u32 s31, s31, 16384
  buffer_load_dwordx4 v6, s[8:11], s31 offen lds
  s_add_u32 m0, m0, 1024
  s_add_u32 s31, s31, 81920
  buffer_load_dwordx4 v6, s[8:11], s31 offen lds
  s_add_u32 m0, m0, 1024
  s_add_u32 s31, s31, 16384
  buffer_load_dwordx4 v6, s[8:11], s31 offen lds
  s_add_u32 m0, m0, 1024
  s_add_u32 s31, s31, 16384
  buffer_load_dwordx4 v6, s[8:11], s31 offen lds
  s_add_u32 m0, m0, 1024
  s_add_u32 s31, s31, 16384
  buffer_load_dwordx4 v6, s[8:11], s31 offen lds
  s_setpc_b64 s[68:69]
.g2_kernel_v_cmb:
  s_and_b32 s28, s16, 3
  s_lshl_b32 s30, s28, 2
  s_lshl_b32 s34, 15, s30
  v_and_b32 v6, 15, v2
  v_lshlrev_b32 v6, 2, v6
  v_add_u32 v6, 155968, v6
  s_lshl_b32 s30, s28, 14
  v_add_u32 v12, s30, v3
  v_and_b32 v13, 31, v2
  s_lshl_b32 s31, s28, 9
  s_add_u32 s31, s31, 161280
  v_lshl_add_u32 v13, v13, 2, s31
  s_lshl_b32 s33, s62, 1
  s_add_u32 s33, s33, s29
  s_lshl_b32 s31, s17, 2
  s_add_u32 s31, s31, s28
  s_lshl_b32 s31, s31, 1
  s_add_u32 s31, s31, s29
  s_lshl_b32 s31, s31, 4
  s_add_u32 s31, s31, s18
  s_lshl_b32 s31, s31, 11
  s_add_u32 s31, s31, s63
  s_add_u32 s35, s31, 0x800000
  v_mov_b32 v14, 8.673617379884035e-19
  v_mov_b32 v15, 1.152921504606847e+18
  s_mov_b32 s38, 0
.g2_kernel_v_cmbw:
  ds_read_b32 v7, v6
  s_add_u32 s38, s38, 1
  s_waitcnt lgkmcnt(0)
  v_cmp_ge_u32 vcc, s33, v7
  s_and_b32 s30, vcc_lo, s34
  s_cbranch_scc0 .g2_kernel_v_cmbd
  s_cmp_lg_u32 vcc_lo, -1
  s_cbranch_scc1 .g2_kernel_v_cmbq
  s_sleep 12
.g2_kernel_v_cmbq:
  s_cmp_lt_u32 s38, 524288
  s_cbranch_scc1 .g2_kernel_v_cmbw
.g2_kernel_v_cmbd:
  s_setprio 3
  s_lshl_b32 s30, s28, 2
  s_add_u32 s30, s30, s71
  v_mov_b32 v7, s30
  ds_read_b128 v[16:19], v12 offset:0
  ds_read_b128 v[20:23], v12 offset:1024
  ds_read_b128 v[24:27], v12 offset:2048
  ds_read_b128 v[28:31], v12 offset:3072
  ds_read_b128 v[32:35], v12 offset:4096
  ds_read_b128 v[36:39], v12 offset:5120
  ds_read_b128 v[40:43], v12 offset:6144
  ds_read_b128 v[44:47], v12 offset:7168
  ds_read_b128 v[48:51], v12 offset:8192
  ds_read_b128 v[52:55], v12 offset:9216
  ds_read_b128 v[56:59], v12 offset:10240
  ds_read_b128 v[60:63], v12 offset:11264
  s_waitcnt lgkmcnt(4)
  ds_read_b32 v8, v13 offset:0
  ds_read_b32 v9, v13 offset:128
  ds_read_b32 v10, v13 offset:256
  ds_read_b32 v11, v13 offset:384
  v_add_f32 v16, v16, v32
  v_add_f32 v17, v17, v33
  v_add_f32 v18, v18, v34
  v_add_f32 v19, v19, v35
  v_add_f32 v20, v20, v36
  v_add_f32 v21, v21, v37
  v_add_f32 v22, v22, v38
  v_add_f32 v23, v23, v39
  v_add_f32 v24, v24, v40
  v_add_f32 v25, v25, v41
  v_add_f32 v26, v26, v42
  v_add_f32 v27, v27, v43
  v_add_f32 v28, v28, v44
  v_add_f32 v29, v29, v45
  v_add_f32 v30, v30, v46
  v_add_f32 v31, v31, v47
  ds_read_b128 v[32:35], v12 offset:12288
  ds_read_b128 v[36:39], v12 offset:13312
  ds_read_b128 v[40:43], v12 offset:14336
  ds_read_b128 v[44:47], v12 offset:15360
  s_waitcnt lgkmcnt(4)
  v_add_f32 v16, v16, v48
  v_add_f32 v17, v17, v49
  v_add_f32 v18, v18, v50
  v_add_f32 v19, v19, v51
  v_add_f32 v20, v20, v52
  v_add_f32 v21, v21, v53
  v_add_f32 v22, v22, v54
  v_add_f32 v23, v23, v55
  v_add_f32 v24, v24, v56
  v_add_f32 v25, v25, v57
  v_add_f32 v26, v26, v58
  v_add_f32 v27, v27, v59
  v_add_f32 v28, v28, v60
  v_add_f32 v29, v29, v61
  v_add_f32 v30, v30, v62
  v_add_f32 v31, v31, v63
  v_add_f32 v8, v8, v10
  v_add_f32 v9, v9, v11
  v_add_f32 v9, v8, v9
  v_cmp_ge_f32 vcc, v9, v14
  v_cmp_le_f32 s[36:37], v9, v15
  v_rcp_f32 v10, v9
  v_mul_f32 v15, v15, v15
  v_mov_b32 v11, s29
  s_waitcnt lgkmcnt(0)
  ds_write_b32 v7, v11 offset:64
  v_add_f32 v16, v16, v32
  v_add_f32 v17, v17, v33
  v_add_f32 v18, v18, v34
  v_add_f32 v19, v19, v35
  v_add_f32 v20, v20, v36
  v_add_f32 v21, v21, v37
  v_add_f32 v22, v22, v38
  v_add_f32 v23, v23, v39
  v_add_f32 v24, v24, v40
  v_add_f32 v25, v25, v41
  v_add_f32 v26, v26, v42
  v_add_f32 v27, v27, v43
  v_add_f32 v28, v28, v44
  v_add_f32 v29, v29, v45
  v_add_f32 v30, v30, v46
  v_add_f32 v31, v31, v47
  s_and_b64 s[36:37], s[36:37], vcc
  v_maximum3_f32 v48, abs(v16), abs(v17), abs(v18)
  v_maximum3_f32 v49, abs(v19), abs(v20), abs(v21)
  v_maximum3_f32 v50, abs(v22), abs(v23), abs(v24)
  v_maximum3_f32 v51, abs(v25), abs(v26), abs(v27)
  v_maximum3_f32 v52, abs(v28), abs(v29), abs(v30)
  v_maximum3_f32 v48, v48, v49, abs(v31)
  v_maximum3_f32 v50, v50, v51, v52
  v_maximum3_f32 v48, v48, v50, v50
  v_cmp_le_f32 vcc, v48, v15
  s_and_b64 vcc, vcc, s[36:37]
  s_cmp_eq_u64 vcc, -1
  s_cbranch_scc0 .g2_kernel_v_cmbslow
.g2_kernel_v_cmbfin:
  v_mul_f32 v16, v16, v10
  v_mul_f32 v17, v17, v10
  v_mul_f32 v18, v18, v10
  v_mul_f32 v19, v19, v10
  v_mul_f32 v20, v20, v10
  v_mul_f32 v21, v21, v10
  v_mul_f32 v22, v22, v10
  v_mul_f32 v23, v23, v10
  v_cvt_pk_bf16_f32 v32, v16, v17
  v_cvt_pk_bf16_f32 v33, v18, v19
  v_cvt_pk_bf16_f32 v34, v20, v21
  v_cvt_pk_bf16_f32 v35, v22, v23
  v_max_u32 v32, 1, v32
  v_max_u32 v34, 1, v34
  buffer_store_dwordx4 v[32:35], v3, s[4:7], s35 offen offset:0 sc1
  v_mul_f32 v24, v24, v10
  v_mul_f32 v25, v25, v10
  v_mul_f32 v26, v26, v10
  v_mul_f32 v27, v27, v10
  v_mul_f32 v28, v28, v10
  v_mul_f32 v29, v29, v10
  v_mul_f32 v30, v30, v10
  v_mul_f32 v31, v31, v10
  v_cvt_pk_bf16_f32 v36, v24, v25
  v_cvt_pk_bf16_f32 v37, v26, v27
  v_cvt_pk_bf16_f32 v38, v28, v29
  v_cvt_pk_bf16_f32 v39, v30, v31
  v_max_u32 v36, 1, v36
  v_max_u32 v38, 1, v38
  buffer_store_dwordx4 v[36:39], v3, s[4:7], s35 offen offset:1024 sc1
  s_setprio 3
  s_setpc_b64 s[68:69]
.g2_kernel_v_cmbslow:
  s_setprio 0
  s_lshl_b32 s30, s28, 11
  s_mul_i32 s31, s29, -8192
  s_add_u32 s30, s30, s31
  s_add_u32 s30, s30, 139264
  v_add_u32 v6, s30, v3
  ds_read_b128 v[48:51], v6
  ds_read_b128 v[52:55], v6 offset:1024
  s_lshl_b32 s36, s18, 1
  s_add_u32 s36, s36, s29
  s_lshl_b32 s36, s36, 18
  s_add_u32 s36, s36, s63
  s_mov_b32 s30, s36
  s_mov_b32 s33, 64
  v_mov_b32 v10, 0xff800000
  s_waitcnt lgkmcnt(0)
.g2_kernel_v_cmbs1:
  buffer_load_dwordx4 v[56:59], v3, s[4:7], s30 offen offset:0
  buffer_load_dwordx4 v[60:63], v3, s[4:7], s30 offen offset:1024
  s_waitcnt vmcnt(0)
  v_mfma_f32_32x32x16_bf16 v[32:47], v[56:59], v[48:51], 0
  v_mfma_f32_32x32x16_bf16 v[32:47], v[60:63], v[52:55], v[32:47]
  s_nop 11
  v_max3_f32 v10, v10, v32, v33
  v_max3_f32 v10, v10, v34, v35
  v_max3_f32 v10, v10, v36, v37
  v_max3_f32 v10, v10, v38, v39
  v_max3_f32 v10, v10, v40, v41
  v_max3_f32 v10, v10, v42, v43
  v_max3_f32 v10, v10, v44, v45
  v_max3_f32 v10, v10, v46, v47
  s_add_u32 s30, s30, 4096
  s_sub_u32 s33, s33, 1
  s_cmp_lg_u32 s33, 0
  s_cbranch_scc1 .g2_kernel_v_cmbs1
  v_mov_b32 v11, v10
  s_nop 1
  v_permlane32_swap_b32 v11, v10
  v_max_f32 v10, v10, v11
  v_mov_b32 v9, 0
  v_mov_b32 v16, 0
  v_mov_b32 v17, 0
  v_mov_b32 v18, 0
  v_mov_b32 v19, 0
  v_mov_b32 v20, 0
  v_mov_b32 v21, 0
  v_mov_b32 v22, 0
  v_mov_b32 v23, 0
  v_mov_b32 v24, 0
  v_mov_b32 v25, 0
  v_mov_b32 v26, 0
  v_mov_b32 v27, 0
  v_mov_b32 v28, 0
  v_mov_b32 v29, 0
  v_mov_b32 v30, 0
  v_mov_b32 v31, 0
  s_mov_b32 s30, s36
  s_mov_b32 s33, 64
.g2_kernel_v_cmbs2:
  buffer_load_dwordx4 v[56:59], v3, s[4:7], s30 offen offset:0
  buffer_load_dwordx4 v[60:63], v3, s[4:7], s30 offen offset:1024
  s_waitcnt vmcnt(0)
  v_mfma_f32_32x32x16_bf16 v[32:47], v[56:59], v[48:51], 0
  v_mfma_f32_32x32x16_bf16 v[32:47], v[60:63], v[52:55], v[32:47]
  s_nop 11
  v_sub_f32 v32, v32, v10
  v_sub_f32 v33, v33, v10
  v_sub_f32 v34, v34, v10
  v_sub_f32 v35, v35, v10
  v_sub_f32 v36, v36, v10
  v_sub_f32 v37, v37, v10
  v_sub_f32 v38, v38, v10
  v_sub_f32 v39, v39, v10
  v_sub_f32 v40, v40, v10
  v_sub_f32 v41, v41, v10
  v_sub_f32 v42, v42, v10
  v_sub_f32 v43, v43, v10
  v_sub_f32 v44, v44, v10
  v_sub_f32 v45, v45, v10
  v_sub_f32 v46, v46, v10
  v_sub_f32 v47, v47, v10
  buffer_load_dwordx4 v[56:59], v3, s[4:7], s30 offen offset:2048
  buffer_load_dwordx4 v[60:63], v3, s[4:7], s30 offen offset:3072
  v_exp_f32 v32, v32
  v_exp_f32 v33, v33
  v_exp_f32 v34, v34
  v_exp_f32 v35, v35
  v_exp_f32 v36, v36
  v_exp_f32 v37, v37
  v_exp_f32 v38, v38
  v_exp_f32 v39, v39
  v_exp_f32 v40, v40
  v_exp_f32 v41, v41
  v_exp_f32 v42, v42
  v_exp_f32 v43, v43
  v_exp_f32 v44, v44
  v_exp_f32 v45, v45
  v_exp_f32 v46, v46
  v_exp_f32 v47, v47
  v_add_f32 v9, v9, v32
  v_add_f32 v9, v9, v33
  v_add_f32 v9, v9, v34
  v_add_f32 v9, v9, v35
  v_add_f32 v9, v9, v36
  v_add_f32 v9, v9, v37
  v_add_f32 v9, v9, v38
  v_add_f32 v9, v9, v39
  v_add_f32 v9, v9, v40
  v_add_f32 v9, v9, v41
  v_add_f32 v9, v9, v42
  v_add_f32 v9, v9, v43
  v_add_f32 v9, v9, v44
  v_add_f32 v9, v9, v45
  v_add_f32 v9, v9, v46
  v_add_f32 v9, v9, v47
  v_cvt_pk_bf16_f32 v32, v32, v33
  v_cvt_pk_bf16_f32 v33, v34, v35
  v_cvt_pk_bf16_f32 v34, v36, v37
  v_cvt_pk_bf16_f32 v35, v38, v39
  v_cvt_pk_bf16_f32 v36, v40, v41
  v_cvt_pk_bf16_f32 v37, v42, v43
  v_cvt_pk_bf16_f32 v38, v44, v45
  v_cvt_pk_bf16_f32 v39, v46, v47
  s_waitcnt vmcnt(0)
  v_mfma_f32_32x32x16_bf16 v[16:31], v[56:59], v[32:35], v[16:31]
  v_mfma_f32_32x32x16_bf16 v[16:31], v[60:63], v[36:39], v[16:31]
  s_nop 15
  s_add_u32 s30, s30, 4096
  s_sub_u32 s33, s33, 1
  s_cmp_lg_u32 s33, 0
  s_cbranch_scc1 .g2_kernel_v_cmbs2
  v_mov_b32 v11, v9
  s_nop 1
  v_permlane32_swap_b32 v11, v9
  v_add_f32 v9, v9, v11
  v_rcp_f32 v10, v9
  s_branch .g2_kernel_v_cmbfin
.g2_kernel_p2_xw:
  s_mov_b32 s38, 0
.g2_kernel_p2_xwl:
  ds_read_b32 v12, v11
  s_add_u32 s38, s38, 1
  s_waitcnt lgkmcnt(0)
  v_cmp_ne_u32 vcc, 0, v12
  s_and_b32 s37, vcc_lo, vcc_hi
  s_lshr_b32 s33, s37, 16
  s_and_b32 s37, s37, s33
  s_bitcmp1_b32 s37, s28
  s_cbranch_scc1 .g2_kernel_p2_xwr
  s_sleep 1
  s_cmp_lt_u32 s38, 524288
  s_cbranch_scc1 .g2_kernel_p2_xwl
.g2_kernel_p2_xwr:
  s_setpc_b64 s[68:69]
.g2_kernel_p2_x0w:
  s_call_b64 s[68:69], .g2_kernel_p2_xw
  s_branch .g2_kernel_p2_x0b
.g2_kernel_p2_x1w:
  s_call_b64 s[68:69], .g2_kernel_p2_xw
  s_branch .g2_kernel_p2_x1b
.g2_kernel_p2_x2w:
  s_call_b64 s[68:69], .g2_kernel_p2_xw
  s_branch .g2_kernel_p2_x2b
.g2_kernel_p2_aw:
  s_call_b64 s[68:69], .g2_kernel_p_spin
  s_branch .g2_kernel_p2_ai
.g2_kernel_p2_x3w:
  s_call_b64 s[68:69], .g2_kernel_p2_xw
  s_branch .g2_kernel_p2_x3b
.g2_kernel_p2_bw:
  s_call_b64 s[68:69], .g2_kernel_p_spin
  s_branch .g2_kernel_p2_bi
.g2_kernel_amax:
  v_mov_b32 v16, 0xff7fffff
  v_mov_b32 v17, 1
  v_mov_b32 v18, 0xff7fffff
  v_mov_b32 v19, 1
  v_mov_b32 v20, 0xff7fffff
  v_mov_b32 v21, 1
  v_mov_b32 v22, 0xff7fffff
  v_mov_b32 v23, 1
  s_mov_b32 s38, 0
  s_mov_b64 vcc, -1
  v_lshlrev_b32 v7, 5, v2
  s_add_u32 s28, s23, 4096
.g2_kernel_amaxl:
  s_and_b64 exec, vcc, s[8:9]
  s_cbranch_scc0 .g2_kernel_amaxn0
  buffer_load_dwordx2 v[16:17], v7, s[4:7], s23 offen offset:0 sc1
.g2_kernel_amaxn0:
  s_and_b64 exec, vcc, s[10:11]
  s_cbranch_scc0 .g2_kernel_amaxn1
  buffer_load_dwordx2 v[18:19], v7, s[4:7], s23 offen offset:2048 sc1
.g2_kernel_amaxn1:
  s_and_b64 exec, vcc, s[12:13]
  s_cbranch_scc0 .g2_kernel_amaxn2
  buffer_load_dwordx2 v[20:21], v7, s[4:7], s28 offen offset:0 sc1
.g2_kernel_amaxn2:
  s_and_b64 exec, vcc, s[14:15]
  s_cbranch_scc0 .g2_kernel_amaxn3
  buffer_load_dwordx2 v[22:23], v7, s[4:7], s28 offen offset:2048 sc1
.g2_kernel_amaxn3:
  s_mov_b64 exec, -1
  s_add_u32 s38, s38, 1
  s_waitcnt vmcnt(0)
  v_min3_u32 v6, v17, v19, v21
  v_min_u32 v6, v6, v23
  v_cmp_eq_u32 vcc, 0, v6
  s_cbranch_vccz .g2_kernel_amaxd
  s_sleep 2
  s_cmp_lg_u32 s62, 0
  s_cbranch_scc1 .g2_kernel_nap54
  s_sleep 22
.g2_kernel_nap54:
  s_cmp_eq_u32 s39, 1
  s_cbranch_scc0 .g2_kernel_amaxz
  s_sleep 8
.g2_kernel_amaxz:
  s_cmp_lt_u32 s38, 131072
  s_cbranch_scc1 .g2_kernel_amaxl
.g2_kernel_amaxd:
  s_mov_b32 s28, 0xffffffe7
  v_and_or_b32 v16, v16, s28, 0
  v_and_or_b32 v18, v18, s28, 8
  v_and_or_b32 v20, v20, s28, 16
  v_and_or_b32 v22, v22, s28, 24
  v_max3_f32 v6, v16, v18, v20
  v_max_f32 v6, v6, v22
  s_nop 1
  v_max_f32 v7, v6, v6 row_ror:8 row_mask:0xf bank_mask:0xf
  s_nop 1
  v_max_f32 v7, v7, v7 row_ror:4 row_mask:0xf bank_mask:0xf
  s_nop 1
  v_max_f32 v7, v7, v7 row_ror:2 row_mask:0xf bank_mask:0xf
  s_nop 1
  v_max_f32 v7, v7, v7 row_ror:1 row_mask:0xf bank_mask:0xf
  s_nop 1
  v_max_f32 v7, v7, v7 row_bcast:15 row_mask:0xa bank_mask:0xf
  s_nop 1
  v_max_f32 v7, v7, v7 row_bcast:31 row_mask:0xc bank_mask:0xf
  s_nop 0
  v_readlane_b32 s27, v7, 63
  s_nop 1
  v_cmp_eq_u32 vcc, s27, v6
  s_ff1_i32_b64 s77, vcc
  s_lshl_b32 s77, s77, 3
  s_and_b32 s28, s27, 7
  s_add_u32 s77, s77, s28
  s_and_b32 s28, s27, 24
  s_lshl_b32 s28, s28, 6
  s_add_u32 s77, s77, s28
  s_and_b32 s77, s77, 2047
  s_setpc_b64 s[68:69]
  .p2align 8
.g2_kernel_tab:
  .long 0, 1, 2, 3, 4, 5, 6, 7
  .long 8, 9, 10, 11, 12, 13, 14, 15
  .long 16, 17, 18, 19, 20, 21, 22, 23
  .long 24, 25, 26, 27, 28, 29, 30, 31
  .long 32, 33, 34, 35, 36, 37, 38, 39
  .long 40, 41, 42, 43, 44, 45, 46, 47
  .long 48, 49, 50, 51, 52, 53, 54, 55
  .long 56, 57, 58, 59, 60, 61, 62, 63
  .long 64, 65, 66, 67, 68, 69, 70, 71
.g2_kernel_cend:

.section .rodata,"a"
.p2align 6
.amdhsa_kernel g2_kernel
  .amdhsa_next_free_vgpr 256
  .amdhsa_next_free_sgpr 102
  .amdhsa_accum_offset 256
  .amdhsa_group_segment_fixed_size 0
  .amdhsa_kernarg_size 88
  .amdhsa_user_sgpr_count 2
  .amdhsa_user_sgpr_kernarg_segment_ptr 1
  .amdhsa_system_sgpr_workgroup_id_x 1
.end_amdhsa_kernel
```

```asm
; @launch kernel=g2_kernel grid=(256,1,1) block=(512,1,1) lds=163840
.amdgcn_target "amdgcn-amd-amdhsa--gfx950"
.text
.globl g2_kernel
.p2align 8
.type g2_kernel,@function
g2_kernel:
  s_cmp_ge_u32 s2, 256
  s_cbranch_scc1 .g2_kernel_end
  s_load_dwordx16 s[40:55], s[0:1], 0
  s_load_dwordx4 s[56:59], s[0:1], 64
  s_load_dwordx2 s[60:61], s[0:1], 80
  s_getpc_b64 s[64:65]
.g2_kernel_pc:
  s_mov_b32 s66, .g2_kernel_cend-.g2_kernel_pc
  s_mov_b32 s67, 0x00020000
  s_lshl_b32 s12, s2, 10
  s_and_b32 s12, s12, 0xe000
  v_lshrrev_b32 v3, 3, v0
  v_and_b32 v2, 7, v0
  v_and_b32 v3, 0x38, v3
  v_add_lshl_u32 v3, v3, v2, 7
  s_mov_b64 exec, 0xff
  buffer_load_dword v1, v3, s[64:67], s12 offen
  s_mov_b64 exec, -1
  v_lshrrev_b32 v3, 6, v0
  v_and_b32 v2, 63, v0
  v_readfirstlane_b32 s16, v3
  s_and_b32 s21, s2, 7
  s_lshr_b32 s22, s2, 3
  s_and_b32 s23, s21, 3
  s_lshl_b32 s23, s23, 2
  s_and_b32 s24, s22, 3
  s_add_u32 s18, s23, s24
  s_lshr_b32 s24, s21, 2
  s_lshl_b32 s24, s24, 3
  s_lshr_b32 s25, s22, 2
  s_add_u32 s17, s24, s25
  s_lshl_b32 s19, s17, 4
  s_add_u32 s19, s19, s18
  s_lshl_b32 s19, s19, 9
  s_add_u32 s19, s19, 0x3000000
  s_lshl_b32 s76, s18, 4
  s_add_u32 s76, s76, s17
  s_lshl_b32 s76, s76, 9
  s_add_u32 s76, s76, 0x3020000
  v_lshlrev_b32 v3, 4, v2
  v_mov_b32 v4, 0
  v_mov_b32 v5, 1
  s_mov_b32 s62, 0
  s_mov_b32 s63, 0
  s_mov_b32 s70, 1
  s_mov_b32 s71, 155648
  s_waitcnt lgkmcnt(0)
  s_mov_b32 s4, s60
  s_mov_b32 s5, s61
  s_mov_b32 s6, 0x3200000
  s_mov_b32 s7, 0x00020000
  s_cmp_ge_u32 s16, 4
  s_cbranch_scc1 .g2_kernel_svc
  v_mov_b32 v20, 0
  v_mov_b32 v21, 0
  v_mov_b32 v22, 0
  v_mov_b32 v23, 0
  v_lshlrev_b32 v24, 4, v0
  v_cmp_gt_u32 vcc, 2816, v24
  v_add_u32 v24, 155648, v24
  s_and_saveexec_b64 s[20:21], vcc
  s_cbranch_execz .g2_kernel_q_nz
  ds_write_b128 v24, v[20:23]
.g2_kernel_q_nz:
  s_mov_b64 exec, -1
  v_and_b32 v20, 15, v2
  v_lshrrev_b32 v21, 4, v2
  v_lshrrev_b32 v22, 1, v20
  v_xor_b32 v22, v22, v21
  v_lshlrev_b32 v22, 4, v22
  v_lshl_add_u32 v22, v20, 7, v22
  s_lshr_b32 s26, s16, 1
  s_lshl_b32 s26, s26, 13
  v_add_u32 v144, s26, v22
  v_xor_b32 v145, 64, v144
.g2_kernel_q_cs:
  s_and_b32 s27, s16, 1
  s_lshr_b32 s26, s16, 1
  v_bfe_u32 v20, v2, 2, 2
  v_lshrrev_b32 v49, 4, v2
  v_lshl_add_u32 v22, v49, 3, v20
  v_lshlrev_b32 v22, 7, v22
  v_lshrrev_b32 v23, 1, v20
  v_and_b32 v21, 1, v49
  v_xor_b32 v21, s27, v21
  v_lshl_add_u32 v23, v21, 1, v23
  v_lshl_add_u32 v22, v23, 5, v22
  v_and_b32 v23, 3, v2
  v_lshl_add_u32 v22, v23, 3, v22
  v_add_u32 v148, 65536, v22
  v_xor_b32 v149, 32, v148
  v_mov_b32 v146, v148
  v_mov_b32 v147, v149
  v_mov_b32 v150, 156160
  v_and_b32 v48, 15, v2
  s_lshl_b32 s28, s26, 8
  s_add_u32 s28, s28, 155648
  v_lshl_add_u32 v50, v48, 2, s28
  v_lshl_add_u32 v51, v49, 4, s28
  s_lshl_b32 s28, s27, 7
  s_add_u32 s28, s28, 155648
  v_lshl_add_u32 v52, v49, 4, s28
  v_lshl_add_u32 v53, v48, 2, s28
  v_lshlrev_b32 v54, 9, v49
  v_lshl_add_u32 v55, v48, 4, v54
  v_and_b32 v56, 8, v48
  v_lshl_add_u32 v54, v56, 4, v55
  v_mov_b32 v56, 0.25503486164919736
  v_lshlrev_b32 v58, 8, v2
  v_and_b32 v58, 0x300, v58
  v_add_u32 v58, 156416, v58
  s_lshl_b32 s8, s18, 1
  s_add_u32 s8, s8, s27
  s_lshl_b32 s8, s8, 6
  s_lshl_b32 s9, s17, 2
  s_add_u32 s8, s8, s9
  s_lshl_b32 s9, s26, 1
  s_add_u32 s8, s8, s9
  s_lshl_b32 s8, s8, 12
  s_add_u32 s8, s8, s63
  s_add_u32 s9, s8, 4096
  s_lshl_b32 s28, s26, 13
  s_lshl_b32 s10, s27, 14
  s_add_u32 s28, s28, s10
  v_add_u32 v59, s28, v54
  v_add_u32 v60, s28, v55
  s_lshl_b32 s28, s26, 12
  s_mul_i32 s10, s27, -8192
  s_add_u32 s28, s28, s10
  s_add_u32 s28, s28, 139264
  v_add_u32 v61, s28, v55
  s_mov_b32 s10, s27
  s_lshl_b32 s77, s18, 4
  s_add_u32 s77, s77, s17
  s_lshl_b32 s77, s77, 1
  s_add_u32 s77, s77, s26
  s_lshl_b32 s77, s77, 13
  s_add_u32 s77, s77, s63
  s_add_u32 s77, s77, 0x1400000
  s_lshl_b32 s28, s27, 30
  s_add_u32 s77, s77, s28
  s_lshl_b32 s12, s62, 5
  s_add_u32 s12, s12, 28
  v_and_b32 v6, 15, v2
  v_xor_b32 v6, s17, v6
  v_and_b32 v7, 16, v2
  v_add_u32 v6, v6, v7
  s_lshr_b32 s28, s16, 1
  s_lshl_b32 s28, s28, 7
  s_add_u32 s28, s28, 157440
  v_lshl_add_u32 v8, v6, 2, s28
  s_lshl_b32 s28, s16, 12
  v_add_u32 v9, s28, v3
  v_and_b32 v6, 31, v2
  s_lshl_b32 s28, s16, 7
  s_add_u32 s28, s28, 161280
  v_lshl_add_u32 v10, v6, 2, s28
  s_lshl_b32 s28, s16, 2
  s_add_u32 s28, s28, 155968
  v_mov_b32 v11, s28
  s_lshl_b32 s28, s62, 1
  s_add_u32 s28, s28, 1
  v_mov_b32 v12, s28
  v_mov_b32 v13, s71
  v_add_u32 v14, 131072, v3
  v_and_b32 v6, 4, v2
  v_cmp_eq_u32 vcc, 0, v6
  v_mov_b32 v7, 0x3f803f80
  v_and_b32 v6, 1, v2
  v_cndmask_b32 v16, 0, v7, vcc
  v_cndmask_b32 v17, 0, v7, vcc
  v_cndmask_b32 v18, v7, 0, vcc
  v_cndmask_b32 v19, v7, 0, vcc
  v_mul_u32_u24 v20, 0xaaaa, v6
  v_add_u32 v20, 0x4444, v20
  s_lshl_b32 s28, s18, 7
  s_add_u32 s28, s28, s16
  s_lshl_b32 s28, s28, 12
  s_add_u32 s28, s28, s63
  s_add_u32 s20, s60, s28
  s_addc_u32 s21, s61, 0
  s_mov_b32 s24, s17
  s_mov_b32 s25, 14
  s_mov_b32 s26, 0
  s_mov_b32 s27, 6
  s_mov_b32 s34, 0xffff0001
  s_mov_b32 s35, 0
  s_mov_b32 s36, 0
  s_mov_b32 s39, 0
  s_lshl_b32 s28, s16, 7
  s_add_u32 s37, s76, s28
  v_mov_b32 v15, s70
  v_lshrrev_b32 v6, 5, v2
  v_and_b32 v7, 15, v2
  v_lshlrev_b32 v22, 4, v7
  v_lshl_add_u32 v22, v6, 8, v22
  v_and_b32 v7, 16, v2
  v_lshl_add_u32 v22, v7, 7, v22
  v_and_b32 v7, 31, v2
  v_lshlrev_b32 v23, 4, v6
  v_lshl_add_u32 v23, v7, 11, v23
  s_lshl_b32 s28, s17, 2
  s_add_u32 s28, s28, s16
  s_lshl_b32 s28, s28, 16
  s_lshl_b32 s29, s18, 7
  s_add_u32 s28, s28, s29
  s_add_u32 s74, s40, s28
  s_addc_u32 s75, s41, 0
  s_lshl_b32 s13, s17, 4
  s_add_u32 s13, s13, s18
  s_lshl_b32 s13, s13, 2
  s_add_u32 s13, s13, s16
  s_lshl_b32 s13, s13, 12
  s_add_u32 s13, s13, 0xc00000
  s_lshl_b32 s28, s16, 8
  s_add_u32 m0, s28, 156416
  s_lshl_b32 s33, s62, 5
  s_lshl_b32 s31, s33, 2
  s_add_u32 s31, s31, .g2_kernel_tab-.g2_kernel_pc+4
  s_mov_b32 s29, 0
  s_cmp_lg_u32 s62, 0
  s_cbranch_scc1 .g2_kernel_q_i2
  s_waitcnt lgkmcnt(0)
  s_barrier
.g2_kernel_q_i3:
  s_call_b64 s[68:69], .g2_kernel_q_spin
  ds_read_b64_tr_b16 v[80:81], v146 offset:0
  ds_read_b64_tr_b16 v[82:83], v146 offset:512
  ds_read_b128 v[64:67], v144 offset:0
  ds_read_b128 v[68:71], v144 offset:2048
  ds_read_b128 v[72:75], v144 offset:4096
  ds_read_b128 v[76:79], v144 offset:6144
  ds_read_b64_tr_b16 v[84:85], v147 offset:0
  ds_read_b64_tr_b16 v[86:87], v147 offset:512
  ds_read_b64_tr_b16 v[88:89], v146 offset:4096
  ds_read_b64_tr_b16 v[90:91], v146 offset:4608
  ds_read_b64_tr_b16 v[92:93], v147 offset:4096
  ds_read_b64_tr_b16 v[94:95], v147 offset:4608
  ds_read_b64_tr_b16 v[96:97], v146 offset:8192
  ds_read_b64_tr_b16 v[98:99], v146 offset:8704
  ds_read_b64_tr_b16 v[100:101], v147 offset:8192
  ds_read_b64_tr_b16 v[102:103], v147 offset:8704
  s_mov_b32 s30, 12288
  s_add_u32 s33, s33, 1
  v_add_u32 v146, s30, v148
  v_add_u32 v147, s30, v149
  s_waitcnt lgkmcnt(0)
  v_mfma_f32_16x16x32_bf16 v[160:163], v[80:83], v[64:67], 0
  v_cmp_lt_i32 vcc, s33, v151
  v_mfma_f32_16x16x32_bf16 v[164:167], v[80:83], v[68:71], 0
  s_cbranch_vccz .g2_kernel_q_wf
.g2_kernel_q_backf:
  v_mfma_f32_16x16x32_bf16 v[168:171], v[80:83], v[72:75], 0
  ds_read_b64_tr_b16 v[120:121], v146 offset:0
  v_mfma_f32_16x16x32_bf16 v[172:175], v[80:83], v[76:79], 0
  ds_read_b64_tr_b16 v[122:123], v146 offset:512
  v_mfma_f32_16x16x32_bf16 v[188:191], v[84:87], v[76:79], 0
  ds_read_b128 v[104:107], v145 offset:0
  v_mfma_f32_16x16x32_bf16 v[184:187], v[84:87], v[72:75], 0
  ds_read_b128 v[108:111], v145 offset:2048
  v_mfma_f32_16x16x32_bf16 v[180:183], v[84:87], v[68:71], 0
  ds_read_b128 v[112:115], v145 offset:4096
  v_mfma_f32_16x16x32_bf16 v[176:179], v[84:87], v[64:67], 0
  ds_read_b128 v[116:119], v145 offset:6144
  v_mfma_f32_16x16x32_bf16 v[192:195], v[88:91], v[64:67], 0
  ds_read_b64_tr_b16 v[124:125], v147 offset:0
  v_mfma_f32_16x16x32_bf16 v[196:199], v[88:91], v[68:71], 0
  ds_read_b64_tr_b16 v[126:127], v147 offset:512
  v_mfma_f32_16x16x32_bf16 v[200:203], v[88:91], v[72:75], 0
  ds_read_b64_tr_b16 v[128:129], v146 offset:4096
  v_mfma_f32_16x16x32_bf16 v[204:207], v[88:91], v[76:79], 0
  ds_read_b64_tr_b16 v[130:131], v146 offset:4608
  v_mfma_f32_16x16x32_bf16 v[220:223], v[92:95], v[76:79], 0
  ds_read_b64_tr_b16 v[132:133], v147 offset:4096
  v_mfma_f32_16x16x32_bf16 v[216:219], v[92:95], v[72:75], 0
  ds_read_b64_tr_b16 v[134:135], v147 offset:4608
  v_mfma_f32_16x16x32_bf16 v[212:215], v[92:95], v[68:71], 0
  ds_read_b64_tr_b16 v[136:137], v146 offset:8192
  v_mfma_f32_16x16x32_bf16 v[208:211], v[92:95], v[64:67], 0
  ds_read_b64_tr_b16 v[138:139], v146 offset:8704
  v_mfma_f32_16x16x32_bf16 v[224:227], v[64:67], v[96:99], 0
  ds_read_b64_tr_b16 v[140:141], v147 offset:8192
  v_mfma_f32_16x16x32_bf16 v[228:231], v[68:71], v[96:99], 0
  ds_read_b64_tr_b16 v[142:143], v147 offset:8704
  v_mfma_f32_16x16x32_bf16 v[232:235], v[72:75], v[96:99], 0
  ds_read_b32 v151, v150
  s_add_u32 s30, s30, 12288
  v_mfma_f32_16x16x32_bf16 v[236:239], v[76:79], v[96:99], 0
  buffer_load_dword off, s[64:67], s31 lds
  s_cmp_eq_u32 s30, 86016
  v_mfma_f32_16x16x32_bf16 v[252:255], v[76:79], v[100:103], 0
  s_cselect_b32 s30, 0, s30
  s_add_u32 s31, s31, 4
  v_mfma_f32_16x16x32_bf16 v[248:251], v[72:75], v[100:103], 0
  v_add_u32 v146, s30, v148
  s_add_u32 s33, s33, 1
  v_mfma_f32_16x16x32_bf16 v[244:247], v[68:71], v[100:103], 0
  v_add_u32 v147, s30, v149
  v_mfma_f32_16x16x32_bf16 v[240:243], v[64:67], v[100:103], 0
  s_branch .g2_kernel_q_s1
  .p2align 6
.g2_kernel_q_loop:
  s_waitcnt lgkmcnt(0)
  v_mfma_f32_16x16x32_bf16 v[160:163], v[120:123], v[104:107], v[160:163]
  v_cmp_lt_i32 vcc, s33, v151
  v_mfma_f32_16x16x32_bf16 v[164:167], v[120:123], v[108:111], v[164:167]
  s_cbranch_vccz .g2_kernel_q_w7
.g2_kernel_q_back7:
  v_mfma_f32_16x16x32_bf16 v[168:171], v[120:123], v[112:115], v[168:171]
  ds_read_b64_tr_b16 v[80:81], v146 offset:0
  v_mfma_f32_16x16x32_bf16 v[172:175], v[120:123], v[116:119], v[172:175]
  ds_read_b64_tr_b16 v[82:83], v146 offset:512
  v_mfma_f32_16x16x32_bf16 v[188:191], v[124:127], v[116:119], v[188:191]
  ds_read_b128 v[64:67], v144 offset:0
  v_mfma_f32_16x16x32_bf16 v[184:187], v[124:127], v[112:115], v[184:187]
  ds_read_b128 v[68:71], v144 offset:2048
  v_mfma_f32_16x16x32_bf16 v[180:183], v[124:127], v[108:111], v[180:183]
  ds_read_b128 v[72:75], v144 offset:4096
  v_mfma_f32_16x16x32_bf16 v[176:179], v[124:127], v[104:107], v[176:179]
  ds_read_b128 v[76:79], v144 offset:6144
  v_mfma_f32_16x16x32_bf16 v[192:195], v[128:131], v[104:107], v[192:195]
  ds_read_b64_tr_b16 v[84:85], v147 offset:0
  v_mfma_f32_16x16x32_bf16 v[196:199], v[128:131], v[108:111], v[196:199]
  ds_read_b64_tr_b16 v[86:87], v147 offset:512
  v_mfma_f32_16x16x32_bf16 v[200:203], v[128:131], v[112:115], v[200:203]
  ds_read_b64_tr_b16 v[88:89], v146 offset:4096
  v_mfma_f32_16x16x32_bf16 v[204:207], v[128:131], v[116:119], v[204:207]
  ds_read_b64_tr_b16 v[90:91], v146 offset:4608
  v_mfma_f32_16x16x32_bf16 v[220:223], v[132:135], v[116:119], v[220:223]
  ds_read_b64_tr_b16 v[92:93], v147 offset:4096
  v_mfma_f32_16x16x32_bf16 v[216:219], v[132:135], v[112:115], v[216:219]
  ds_read_b64_tr_b16 v[94:95], v147 offset:4608
  v_mfma_f32_16x16x32_bf16 v[212:215], v[132:135], v[108:111], v[212:215]
  ds_read_b64_tr_b16 v[96:97], v146 offset:8192
  v_mfma_f32_16x16x32_bf16 v[208:211], v[132:135], v[104:107], v[208:211]
  ds_read_b64_tr_b16 v[98:99], v146 offset:8704
  v_mfma_f32_16x16x32_bf16 v[224:227], v[104:107], v[136:139], v[224:227]
  ds_read_b64_tr_b16 v[100:101], v147 offset:8192
  v_mfma_f32_16x16x32_bf16 v[228:231], v[108:111], v[136:139], v[228:231]
  ds_read_b64_tr_b16 v[102:103], v147 offset:8704
  v_mfma_f32_16x16x32_bf16 v[232:235], v[112:115], v[136:139], v[232:235]
  ds_read_b32 v151, v150
  s_add_u32 s30, s30, 12288
  v_mfma_f32_16x16x32_bf16 v[236:239], v[116:119], v[136:139], v[236:239]
  buffer_load_dword off, s[64:67], s31 lds
  s_cmp_eq_u32 s30, 86016
  v_mfma_f32_16x16x32_bf16 v[252:255], v[116:119], v[140:143], v[252:255]
  s_cselect_b32 s30, 0, s30
  s_add_u32 s31, s31, 4
  v_mfma_f32_16x16x32_bf16 v[248:251], v[112:115], v[140:143], v[248:251]
  v_add_u32 v146, s30, v148
  s_add_u32 s33, s33, 1
  v_mfma_f32_16x16x32_bf16 v[244:247], v[108:111], v[140:143], v[244:247]
  v_add_u32 v147, s30, v149
  v_mfma_f32_16x16x32_bf16 v[240:243], v[104:107], v[140:143], v[240:243]
  s_waitcnt lgkmcnt(0)
  v_mfma_f32_16x16x32_bf16 v[160:163], v[80:83], v[64:67], v[160:163]
  v_cmp_lt_i32 vcc, s33, v151
  v_mfma_f32_16x16x32_bf16 v[164:167], v[80:83], v[68:71], v[164:167]
  s_cbranch_vccz .g2_kernel_q_w0
.g2_kernel_q_back0:
  v_mfma_f32_16x16x32_bf16 v[168:171], v[80:83], v[72:75], v[168:171]
  ds_read_b64_tr_b16 v[120:121], v146 offset:0
  v_mfma_f32_16x16x32_bf16 v[172:175], v[80:83], v[76:79], v[172:175]
  ds_read_b64_tr_b16 v[122:123], v146 offset:512
  v_mfma_f32_16x16x32_bf16 v[188:191], v[84:87], v[76:79], v[188:191]
  ds_read_b128 v[104:107], v145 offset:0
  v_mfma_f32_16x16x32_bf16 v[184:187], v[84:87], v[72:75], v[184:187]
  ds_read_b128 v[108:111], v145 offset:2048
  v_mfma_f32_16x16x32_bf16 v[180:183], v[84:87], v[68:71], v[180:183]
  ds_read_b128 v[112:115], v145 offset:4096
  v_mfma_f32_16x16x32_bf16 v[176:179], v[84:87], v[64:67], v[176:179]
  ds_read_b128 v[116:119], v145 offset:6144
  v_mfma_f32_16x16x32_bf16 v[192:195], v[88:91], v[64:67], v[192:195]
  ds_read_b64_tr_b16 v[124:125], v147 offset:0
  v_mfma_f32_16x16x32_bf16 v[196:199], v[88:91], v[68:71], v[196:199]
  ds_read_b64_tr_b16 v[126:127], v147 offset:512
  v_mfma_f32_16x16x32_bf16 v[200:203], v[88:91], v[72:75], v[200:203]
  ds_read_b64_tr_b16 v[128:129], v146 offset:4096
  v_mfma_f32_16x16x32_bf16 v[204:207], v[88:91], v[76:79], v[204:207]
  ds_read_b64_tr_b16 v[130:131], v146 offset:4608
  v_mfma_f32_16x16x32_bf16 v[220:223], v[92:95], v[76:79], v[220:223]
  ds_read_b64_tr_b16 v[132:133], v147 offset:4096
  v_mfma_f32_16x16x32_bf16 v[216:219], v[92:95], v[72:75], v[216:219]
  ds_read_b64_tr_b16 v[134:135], v147 offset:4608
  v_mfma_f32_16x16x32_bf16 v[212:215], v[92:95], v[68:71], v[212:215]
  ds_read_b64_tr_b16 v[136:137], v146 offset:8192
  v_mfma_f32_16x16x32_bf16 v[208:211], v[92:95], v[64:67], v[208:211]
  ds_read_b64_tr_b16 v[138:139], v146 offset:8704
  v_mfma_f32_16x16x32_bf16 v[224:227], v[64:67], v[96:99], v[224:227]
  ds_read_b64_tr_b16 v[140:141], v147 offset:8192
  v_mfma_f32_16x16x32_bf16 v[228:231], v[68:71], v[96:99], v[228:231]
  ds_read_b64_tr_b16 v[142:143], v147 offset:8704
  v_mfma_f32_16x16x32_bf16 v[232:235], v[72:75], v[96:99], v[232:235]
  ds_read_b32 v151, v150
  s_add_u32 s30, s30, 12288
  v_mfma_f32_16x16x32_bf16 v[236:239], v[76:79], v[96:99], v[236:239]
  buffer_load_dword off, s[64:67], s31 lds
  s_cmp_eq_u32 s30, 86016
  v_mfma_f32_16x16x32_bf16 v[252:255], v[76:79], v[100:103], v[252:255]
  s_cselect_b32 s30, 0, s30
  s_add_u32 s31, s31, 4
  v_mfma_f32_16x16x32_bf16 v[248:251], v[72:75], v[100:103], v[248:251]
  v_add_u32 v146, s30, v148
  s_add_u32 s33, s33, 1
  v_mfma_f32_16x16x32_bf16 v[244:247], v[68:71], v[100:103], v[244:247]
  v_add_u32 v147, s30, v149
  v_mfma_f32_16x16x32_bf16 v[240:243], v[64:67], v[100:103], v[240:243]
.g2_kernel_q_s1:
  s_waitcnt lgkmcnt(0)
  v_mfma_f32_16x16x32_bf16 v[160:163], v[120:123], v[104:107], v[160:163]
  v_cmp_lt_i32 vcc, s33, v151
  v_mfma_f32_16x16x32_bf16 v[164:167], v[120:123], v[108:111], v[164:167]
  s_cbranch_vccz .g2_kernel_q_w1
.g2_kernel_q_back1:
  v_mfma_f32_16x16x32_bf16 v[168:171], v[120:123], v[112:115], v[168:171]
  ds_read_b64_tr_b16 v[80:81], v146 offset:0
  v_mfma_f32_16x16x32_bf16 v[172:175], v[120:123], v[116:119], v[172:175]
  ds_read_b64_tr_b16 v[82:83], v146 offset:512
  v_mfma_f32_16x16x32_bf16 v[188:191], v[124:127], v[116:119], v[188:191]
  ds_read_b128 v[64:67], v144 offset:16384
  v_mfma_f32_16x16x32_bf16 v[184:187], v[124:127], v[112:115], v[184:187]
  ds_read_b128 v[68:71], v144 offset:18432
  v_mfma_f32_16x16x32_bf16 v[180:183], v[124:127], v[108:111], v[180:183]
  ds_read_b128 v[72:75], v144 offset:20480
  v_mfma_f32_16x16x32_bf16 v[176:179], v[124:127], v[104:107], v[176:179]
  ds_read_b128 v[76:79], v144 offset:22528
  v_mfma_f32_16x16x32_bf16 v[192:195], v[128:131], v[104:107], v[192:195]
  ds_read_b64_tr_b16 v[84:85], v147 offset:0
  v_mfma_f32_16x16x32_bf16 v[196:199], v[128:131], v[108:111], v[196:199]
  ds_read_b64_tr_b16 v[86:87], v147 offset:512
  v_mfma_f32_16x16x32_bf16 v[200:203], v[128:131], v[112:115], v[200:203]
  ds_read_b64_tr_b16 v[88:89], v146 offset:4096
  v_mfma_f32_16x16x32_bf16 v[204:207], v[128:131], v[116:119], v[204:207]
  ds_read_b64_tr_b16 v[90:91], v146 offset:4608
  v_mfma_f32_16x16x32_bf16 v[220:223], v[132:135], v[116:119], v[220:223]
  ds_read_b64_tr_b16 v[92:93], v147 offset:4096
  v_mfma_f32_16x16x32_bf16 v[216:219], v[132:135], v[112:115], v[216:219]
  ds_read_b64_tr_b16 v[94:95], v147 offset:4608
  v_mfma_f32_16x16x32_bf16 v[212:215], v[132:135], v[108:111], v[212:215]
  ds_read_b64_tr_b16 v[96:97], v146 offset:8192
  v_mfma_f32_16x16x32_bf16 v[208:211], v[132:135], v[104:107], v[208:211]
  ds_read_b64_tr_b16 v[98:99], v146 offset:8704
  v_mfma_f32_16x16x32_bf16 v[224:227], v[104:107], v[136:139], v[224:227]
  ds_read_b64_tr_b16 v[100:101], v147 offset:8192
  v_mfma_f32_16x16x32_bf16 v[228:231], v[108:111], v[136:139], v[228:231]
  ds_read_b64_tr_b16 v[102:103], v147 offset:8704
  v_mfma_f32_16x16x32_bf16 v[232:235], v[112:115], v[136:139], v[232:235]
  ds_read_b32 v151, v150
  s_add_u32 s30, s30, 12288
  v_mfma_f32_16x16x32_bf16 v[236:239], v[116:119], v[136:139], v[236:239]
  buffer_load_dword off, s[64:67], s31 lds
  s_cmp_eq_u32 s30, 86016
  v_mfma_f32_16x16x32_bf16 v[252:255], v[116:119], v[140:143], v[252:255]
  s_cselect_b32 s30, 0, s30
  s_add_u32 s31, s31, 4
  v_mfma_f32_16x16x32_bf16 v[248:251], v[112:115], v[140:143], v[248:251]
  v_add_u32 v146, s30, v148
  s_add_u32 s33, s33, 1
  v_mfma_f32_16x16x32_bf16 v[244:247], v[108:111], v[140:143], v[244:247]
  v_add_u32 v147, s30, v149
  v_mfma_f32_16x16x32_bf16 v[240:243], v[104:107], v[140:143], v[240:243]
  s_waitcnt lgkmcnt(0)
  v_mfma_f32_16x16x32_bf16 v[160:163], v[80:83], v[64:67], v[160:163]
  v_cmp_lt_i32 vcc, s33, v151
  v_mfma_f32_16x16x32_bf16 v[164:167], v[80:83], v[68:71], v[164:167]
  s_cbranch_vccz .g2_kernel_q_w2
.g2_kernel_q_back2:
  v_mfma_f32_16x16x32_bf16 v[168:171], v[80:83], v[72:75], v[168:171]
  ds_read_b64_tr_b16 v[120:121], v146 offset:0
  v_mfma_f32_16x16x32_bf16 v[172:175], v[80:83], v[76:79], v[172:175]
  ds_read_b64_tr_b16 v[122:123], v146 offset:512
  v_mfma_f32_16x16x32_bf16 v[188:191], v[84:87], v[76:79], v[188:191]
  ds_read_b128 v[104:107], v145 offset:16384
  v_mfma_f32_16x16x32_bf16 v[184:187], v[84:87], v[72:75], v[184:187]
  ds_read_b128 v[108:111], v145 offset:18432
  v_mfma_f32_16x16x32_bf16 v[180:183], v[84:87], v[68:71], v[180:183]
  ds_read_b128 v[112:115], v145 offset:20480
  v_mfma_f32_16x16x32_bf16 v[176:179], v[84:87], v[64:67], v[176:179]
  ds_read_b128 v[116:119], v145 offset:22528
  v_mfma_f32_16x16x32_bf16 v[192:195], v[88:91], v[64:67], v[192:195]
  ds_read_b64_tr_b16 v[124:125], v147 offset:0
  v_mfma_f32_16x16x32_bf16 v[196:199], v[88:91], v[68:71], v[196:199]
  ds_read_b64_tr_b16 v[126:127], v147 offset:512
  v_mfma_f32_16x16x32_bf16 v[200:203], v[88:91], v[72:75], v[200:203]
  ds_read_b64_tr_b16 v[128:129], v146 offset:4096
  v_mfma_f32_16x16x32_bf16 v[204:207], v[88:91], v[76:79], v[204:207]
  ds_read_b64_tr_b16 v[130:131], v146 offset:4608
  v_mfma_f32_16x16x32_bf16 v[220:223], v[92:95], v[76:79], v[220:223]
  ds_read_b64_tr_b16 v[132:133], v147 offset:4096
  v_mfma_f32_16x16x32_bf16 v[216:219], v[92:95], v[72:75], v[216:219]
  ds_read_b64_tr_b16 v[134:135], v147 offset:4608
  v_mfma_f32_16x16x32_bf16 v[212:215], v[92:95], v[68:71], v[212:215]
  ds_read_b64_tr_b16 v[136:137], v146 offset:8192
  v_mfma_f32_16x16x32_bf16 v[208:211], v[92:95], v[64:67], v[208:211]
  ds_read_b64_tr_b16 v[138:139], v146 offset:8704
  v_mfma_f32_16x16x32_bf16 v[224:227], v[64:67], v[96:99], v[224:227]
  ds_read_b64_tr_b16 v[140:141], v147 offset:8192
  v_mfma_f32_16x16x32_bf16 v[228:231], v[68:71], v[96:99], v[228:231]
  ds_read_b64_tr_b16 v[142:143], v147 offset:8704
  v_mfma_f32_16x16x32_bf16 v[232:235], v[72:75], v[96:99], v[232:235]
  ds_read_b32 v151, v150
  s_add_u32 s30, s30, 12288
  v_mfma_f32_16x16x32_bf16 v[236:239], v[76:79], v[96:99], v[236:239]
  buffer_load_dword off, s[64:67], s31 lds
  s_cmp_eq_u32 s30, 86016
  v_mfma_f32_16x16x32_bf16 v[252:255], v[76:79], v[100:103], v[252:255]
  s_cselect_b32 s30, 0, s30
  s_add_u32 s31, s31, 4
  v_mfma_f32_16x16x32_bf16 v[248:251], v[72:75], v[100:103], v[248:251]
  v_add_u32 v146, s30, v148
  s_add_u32 s33, s33, 1
  v_mfma_f32_16x16x32_bf16 v[244:247], v[68:71], v[100:103], v[244:247]
  v_add_u32 v147, s30, v149
  v_mfma_f32_16x16x32_bf16 v[240:243], v[64:67], v[100:103], v[240:243]
  s_waitcnt lgkmcnt(0)
  v_mfma_f32_16x16x32_bf16 v[160:163], v[120:123], v[104:107], v[160:163]
  v_cmp_lt_i32 vcc, s33, v151
  v_mfma_f32_16x16x32_bf16 v[164:167], v[120:123], v[108:111], v[164:167]
  s_cbranch_vccz .g2_kernel_q_w3
.g2_kernel_q_back3:
  v_mfma_f32_16x16x32_bf16 v[168:171], v[120:123], v[112:115], v[168:171]
  ds_read_b64_tr_b16 v[80:81], v146 offset:0
  v_mfma_f32_16x16x32_bf16 v[172:175], v[120:123], v[116:119], v[172:175]
  ds_read_b64_tr_b16 v[82:83], v146 offset:512
  v_mfma_f32_16x16x32_bf16 v[188:191], v[124:127], v[116:119], v[188:191]
  ds_read_b128 v[64:67], v144 offset:32768
  v_mfma_f32_16x16x32_bf16 v[184:187], v[124:127], v[112:115], v[184:187]
  ds_read_b128 v[68:71], v144 offset:34816
  v_mfma_f32_16x16x32_bf16 v[180:183], v[124:127], v[108:111], v[180:183]
  ds_read_b128 v[72:75], v144 offset:36864
  v_mfma_f32_16x16x32_bf16 v[176:179], v[124:127], v[104:107], v[176:179]
  ds_read_b128 v[76:79], v144 offset:38912
  v_mfma_f32_16x16x32_bf16 v[192:195], v[128:131], v[104:107], v[192:195]
  ds_read_b64_tr_b16 v[84:85], v147 offset:0
  v_mfma_f32_16x16x32_bf16 v[196:199], v[128:131], v[108:111], v[196:199]
  ds_read_b64_tr_b16 v[86:87], v147 offset:512
  v_mfma_f32_16x16x32_bf16 v[200:203], v[128:131], v[112:115], v[200:203]
  ds_read_b64_tr_b16 v[88:89], v146 offset:4096
  v_mfma_f32_16x16x32_bf16 v[204:207], v[128:131], v[116:119], v[204:207]
  ds_read_b64_tr_b16 v[90:91], v146 offset:4608
  v_mfma_f32_16x16x32_bf16 v[220:223], v[132:135], v[116:119], v[220:223]
  ds_read_b64_tr_b16 v[92:93], v147 offset:4096
  v_mfma_f32_16x16x32_bf16 v[216:219], v[132:135], v[112:115], v[216:219]
  ds_read_b64_tr_b16 v[94:95], v147 offset:4608
  v_mfma_f32_16x16x32_bf16 v[212:215], v[132:135], v[108:111], v[212:215]
  ds_read_b64_tr_b16 v[96:97], v146 offset:8192
  v_mfma_f32_16x16x32_bf16 v[208:211], v[132:135], v[104:107], v[208:211]
  ds_read_b64_tr_b16 v[98:99], v146 offset:8704
  v_mfma_f32_16x16x32_bf16 v[224:227], v[104:107], v[136:139], v[224:227]
  ds_read_b64_tr_b16 v[100:101], v147 offset:8192
  v_mfma_f32_16x16x32_bf16 v[228:231], v[108:111], v[136:139], v[228:231]
  ds_read_b64_tr_b16 v[102:103], v147 offset:8704
  v_mfma_f32_16x16x32_bf16 v[232:235], v[112:115], v[136:139], v[232:235]
  ds_read_b32 v151, v150
  s_add_u32 s30, s30, 12288
  v_mfma_f32_16x16x32_bf16 v[236:239], v[116:119], v[136:139], v[236:239]
  buffer_load_dword off, s[64:67], s31 lds
  s_cmp_eq_u32 s30, 86016
  v_mfma_f32_16x16x32_bf16 v[252:255], v[116:119], v[140:143], v[252:255]
  s_cselect_b32 s30, 0, s30
  s_add_u32 s31, s31, 4
  v_mfma_f32_16x16x32_bf16 v[248:251], v[112:115], v[140:143], v[248:251]
  v_add_u32 v146, s30, v148
  s_add_u32 s33, s33, 1
  v_mfma_f32_16x16x32_bf16 v[244:247], v[108:111], v[140:143], v[244:247]
  v_add_u32 v147, s30, v149
  v_mfma_f32_16x16x32_bf16 v[240:243], v[104:107], v[140:143], v[240:243]
  s_waitcnt lgkmcnt(0)
  v_mfma_f32_16x16x32_bf16 v[160:163], v[80:83], v[64:67], v[160:163]
  v_cmp_lt_i32 vcc, s33, v151
  v_mfma_f32_16x16x32_bf16 v[164:167], v[80:83], v[68:71], v[164:167]
  s_cbranch_vccz .g2_kernel_q_w4
.g2_kernel_q_back4:
  v_mfma_f32_16x16x32_bf16 v[168:171], v[80:83], v[72:75], v[168:171]
  ds_read_b64_tr_b16 v[120:121], v146 offset:0
  v_mfma_f32_16x16x32_bf16 v[172:175], v[80:83], v[76:79], v[172:175]
  ds_read_b64_tr_b16 v[122:123], v146 offset:512
  v_mfma_f32_16x16x32_bf16 v[188:191], v[84:87], v[76:79], v[188:191]
  ds_read_b128 v[104:107], v145 offset:32768
  v_mfma_f32_16x16x32_bf16 v[184:187], v[84:87], v[72:75], v[184:187]
  ds_read_b128 v[108:111], v145 offset:34816
  v_mfma_f32_16x16x32_bf16 v[180:183], v[84:87], v[68:71], v[180:183]
  ds_read_b128 v[112:115], v145 offset:36864
  v_mfma_f32_16x16x32_bf16 v[176:179], v[84:87], v[64:67], v[176:179]
  ds_read_b128 v[116:119], v145 offset:38912
  v_mfma_f32_16x16x32_bf16 v[192:195], v[88:91], v[64:67], v[192:195]
  ds_read_b64_tr_b16 v[124:125], v147 offset:0
  v_mfma_f32_16x16x32_bf16 v[196:199], v[88:91], v[68:71], v[196:199]
  ds_read_b64_tr_b16 v[126:127], v147 offset:512
  v_mfma_f32_16x16x32_bf16 v[200:203], v[88:91], v[72:75], v[200:203]
  ds_read_b64_tr_b16 v[128:129], v146 offset:4096
  v_mfma_f32_16x16x32_bf16 v[204:207], v[88:91], v[76:79], v[204:207]
  ds_read_b64_tr_b16 v[130:131], v146 offset:4608
  v_mfma_f32_16x16x32_bf16 v[220:223], v[92:95], v[76:79], v[220:223]
  ds_read_b64_tr_b16 v[132:133], v147 offset:4096
  v_mfma_f32_16x16x32_bf16 v[216:219], v[92:95], v[72:75], v[216:219]
  ds_read_b64_tr_b16 v[134:135], v147 offset:4608
  v_mfma_f32_16x16x32_bf16 v[212:215], v[92:95], v[68:71], v[212:215]
  ds_read_b64_tr_b16 v[136:137], v146 offset:8192
  v_mfma_f32_16x16x32_bf16 v[208:211], v[92:95], v[64:67], v[208:211]
  ds_read_b64_tr_b16 v[138:139], v146 offset:8704
  v_mfma_f32_16x16x32_bf16 v[224:227], v[64:67], v[96:99], v[224:227]
  ds_read_b64_tr_b16 v[140:141], v147 offset:8192
  v_mfma_f32_16x16x32_bf16 v[228:231], v[68:71], v[96:99], v[228:231]
  ds_read_b64_tr_b16 v[142:143], v147 offset:8704
  v_mfma_f32_16x16x32_bf16 v[232:235], v[72:75], v[96:99], v[232:235]
  ds_read_b32 v151, v150
  s_add_u32 s30, s30, 12288
  v_mfma_f32_16x16x32_bf16 v[236:239], v[76:79], v[96:99], v[236:239]
  buffer_load_dword off, s[64:67], s31 lds
  s_cmp_eq_u32 s30, 86016
  v_mfma_f32_16x16x32_bf16 v[252:255], v[76:79], v[100:103], v[252:255]
  s_cselect_b32 s30, 0, s30
  s_add_u32 s31, s31, 4
  v_mfma_f32_16x16x32_bf16 v[248:251], v[72:75], v[100:103], v[248:251]
  v_add_u32 v146, s30, v148
  s_add_u32 s33, s33, 1
  v_mfma_f32_16x16x32_bf16 v[244:247], v[68:71], v[100:103], v[244:247]
  v_add_u32 v147, s30, v149
  v_mfma_f32_16x16x32_bf16 v[240:243], v[64:67], v[100:103], v[240:243]
  s_waitcnt lgkmcnt(0)
  v_mfma_f32_16x16x32_bf16 v[160:163], v[120:123], v[104:107], v[160:163]
  v_cmp_lt_i32 vcc, s33, v151
  v_mfma_f32_16x16x32_bf16 v[164:167], v[120:123], v[108:111], v[164:167]
  s_cbranch_vccz .g2_kernel_q_w5
.g2_kernel_q_back5:
  v_mfma_f32_16x16x32_bf16 v[168:171], v[120:123], v[112:115], v[168:171]
  ds_read_b64_tr_b16 v[80:81], v146 offset:0
  v_mfma_f32_16x16x32_bf16 v[172:175], v[120:123], v[116:119], v[172:175]
  ds_read_b64_tr_b16 v[82:83], v146 offset:512
  v_mfma_f32_16x16x32_bf16 v[188:191], v[124:127], v[116:119], v[188:191]
  ds_read_b128 v[64:67], v144 offset:49152
  v_mfma_f32_16x16x32_bf16 v[184:187], v[124:127], v[112:115], v[184:187]
  ds_read_b128 v[68:71], v144 offset:51200
  v_mfma_f32_16x16x32_bf16 v[180:183], v[124:127], v[108:111], v[180:183]
  ds_read_b128 v[72:75], v144 offset:53248
  v_mfma_f32_16x16x32_bf16 v[176:179], v[124:127], v[104:107], v[176:179]
  ds_read_b128 v[76:79], v144 offset:55296
  v_mfma_f32_16x16x32_bf16 v[192:195], v[128:131], v[104:107], v[192:195]
  ds_read_b64_tr_b16 v[84:85], v147 offset:0
  v_mfma_f32_16x16x32_bf16 v[196:199], v[128:131], v[108:111], v[196:199]
  ds_read_b64_tr_b16 v[86:87], v147 offset:512
  v_mfma_f32_16x16x32_bf16 v[200:203], v[128:131], v[112:115], v[200:203]
  ds_read_b64_tr_b16 v[88:89], v146 offset:4096
  v_mfma_f32_16x16x32_bf16 v[204:207], v[128:131], v[116:119], v[204:207]
  ds_read_b64_tr_b16 v[90:91], v146 offset:4608
  v_mfma_f32_16x16x32_bf16 v[220:223], v[132:135], v[116:119], v[220:223]
  ds_read_b64_tr_b16 v[92:93], v147 offset:4096
  v_mfma_f32_16x16x32_bf16 v[216:219], v[132:135], v[112:115], v[216:219]
  ds_read_b64_tr_b16 v[94:95], v147 offset:4608
  v_mfma_f32_16x16x32_bf16 v[212:215], v[132:135], v[108:111], v[212:215]
  ds_read_b64_tr_b16 v[96:97], v146 offset:8192
  v_mfma_f32_16x16x32_bf16 v[208:211], v[132:135], v[104:107], v[208:211]
  ds_read_b64_tr_b16 v[98:99], v146 offset:8704
  v_mfma_f32_16x16x32_bf16 v[224:227], v[104:107], v[136:139], v[224:227]
  ds_read_b64_tr_b16 v[100:101], v147 offset:8192
  v_mfma_f32_16x16x32_bf16 v[228:231], v[108:111], v[136:139], v[228:231]
  ds_read_b64_tr_b16 v[102:103], v147 offset:8704
  v_mfma_f32_16x16x32_bf16 v[232:235], v[112:115], v[136:139], v[232:235]
  ds_read_b32 v151, v150
  s_add_u32 s30, s30, 12288
  v_mfma_f32_16x16x32_bf16 v[236:239], v[116:119], v[136:139], v[236:239]
  buffer_load_dword off, s[64:67], s31 lds
  s_cmp_eq_u32 s30, 86016
  v_mfma_f32_16x16x32_bf16 v[252:255], v[116:119], v[140:143], v[252:255]
  s_cselect_b32 s30, 0, s30
  s_add_u32 s31, s31, 4
  v_mfma_f32_16x16x32_bf16 v[248:251], v[112:115], v[140:143], v[248:251]
  v_add_u32 v146, s30, v148
  s_add_u32 s33, s33, 1
  v_mfma_f32_16x16x32_bf16 v[244:247], v[108:111], v[140:143], v[244:247]
  v_add_u32 v147, s30, v149
  v_mfma_f32_16x16x32_bf16 v[240:243], v[104:107], v[140:143], v[240:243]
  s_waitcnt lgkmcnt(0)
  v_mfma_f32_16x16x32_bf16 v[160:163], v[80:83], v[64:67], v[160:163]
  v_cmp_lt_i32 vcc, s33, v151
  v_mfma_f32_16x16x32_bf16 v[164:167], v[80:83], v[68:71], v[164:167]
  s_cbranch_vccz .g2_kernel_q_w6
.g2_kernel_q_back6:
  v_mfma_f32_16x16x32_bf16 v[168:171], v[80:83], v[72:75], v[168:171]
  ds_read_b64_tr_b16 v[120:121], v146 offset:0
  v_mfma_f32_16x16x32_bf16 v[172:175], v[80:83], v[76:79], v[172:175]
  ds_read_b64_tr_b16 v[122:123], v146 offset:512
  v_mfma_f32_16x16x32_bf16 v[188:191], v[84:87], v[76:79], v[188:191]
  ds_read_b128 v[104:107], v145 offset:49152
  v_mfma_f32_16x16x32_bf16 v[184:187], v[84:87], v[72:75], v[184:187]
  ds_read_b128 v[108:111], v145 offset:51200
  v_mfma_f32_16x16x32_bf16 v[180:183], v[84:87], v[68:71], v[180:183]
  ds_read_b128 v[112:115], v145 offset:53248
  v_mfma_f32_16x16x32_bf16 v[176:179], v[84:87], v[64:67], v[176:179]
  ds_read_b128 v[116:119], v145 offset:55296
  v_mfma_f32_16x16x32_bf16 v[192:195], v[88:91], v[64:67], v[192:195]
  ds_read_b64_tr_b16 v[124:125], v147 offset:0
  v_mfma_f32_16x16x32_bf16 v[196:199], v[88:91], v[68:71], v[196:199]
  ds_read_b64_tr_b16 v[126:127], v147 offset:512
  v_mfma_f32_16x16x32_bf16 v[200:203], v[88:91], v[72:75], v[200:203]
  ds_read_b64_tr_b16 v[128:129], v146 offset:4096
  v_mfma_f32_16x16x32_bf16 v[204:207], v[88:91], v[76:79], v[204:207]
  ds_read_b64_tr_b16 v[130:131], v146 offset:4608
  v_mfma_f32_16x16x32_bf16 v[220:223], v[92:95], v[76:79], v[220:223]
  ds_read_b64_tr_b16 v[132:133], v147 offset:4096
  v_mfma_f32_16x16x32_bf16 v[216:219], v[92:95], v[72:75], v[216:219]
  ds_read_b64_tr_b16 v[134:135], v147 offset:4608
  v_mfma_f32_16x16x32_bf16 v[212:215], v[92:95], v[68:71], v[212:215]
  ds_read_b64_tr_b16 v[136:137], v146 offset:8192
  v_mfma_f32_16x16x32_bf16 v[208:211], v[92:95], v[64:67], v[208:211]
  ds_read_b64_tr_b16 v[138:139], v146 offset:8704
  v_mfma_f32_16x16x32_bf16 v[224:227], v[64:67], v[96:99], v[224:227]
  ds_read_b64_tr_b16 v[140:141], v147 offset:8192
  v_mfma_f32_16x16x32_bf16 v[228:231], v[68:71], v[96:99], v[228:231]
  ds_read_b64_tr_b16 v[142:143], v147 offset:8704
  v_mfma_f32_16x16x32_bf16 v[232:235], v[72:75], v[96:99], v[232:235]
  ds_read_b32 v151, v150
  s_add_u32 s30, s30, 12288
  v_mfma_f32_16x16x32_bf16 v[236:239], v[76:79], v[96:99], v[236:239]
  buffer_load_dword off, s[64:67], s31 lds
  s_cmp_eq_u32 s30, 86016
  v_mfma_f32_16x16x32_bf16 v[252:255], v[76:79], v[100:103], v[252:255]
  s_cselect_b32 s30, 0, s30
  s_add_u32 s31, s31, 4
  v_mfma_f32_16x16x32_bf16 v[248:251], v[72:75], v[100:103], v[248:251]
  v_add_u32 v146, s30, v148
  s_add_u32 s33, s33, 1
  v_mfma_f32_16x16x32_bf16 v[244:247], v[68:71], v[100:103], v[244:247]
  v_add_u32 v147, s30, v149
  s_add_u32 s29, s29, 1
  v_mfma_f32_16x16x32_bf16 v[240:243], v[64:67], v[100:103], v[240:243]
  s_cmp_lg_u32 s29, 4
  s_cbranch_scc1 .g2_kernel_q_loop
  s_waitcnt lgkmcnt(0)
  v_mfma_f32_16x16x32_bf16 v[192:195], v[128:131], v[104:107], v[192:195]
  ds_read_b32 v62, v13 offset:0
  ds_read_b32 v63, v58
  v_mfma_f32_16x16x32_bf16 v[196:199], v[128:131], v[108:111], v[196:199]
  ds_read_b32 v57, v13 offset:24
  ds_read_b32 v21, v13 offset:84
  v_mfma_f32_16x16x32_bf16 v[200:203], v[128:131], v[112:115], v[200:203]
  ds_read_b128 v[40:43], v52 offset:5120
  ds_read_b128 v[44:47], v52 offset:5184
  v_mfma_f32_16x16x32_bf16 v[204:207], v[128:131], v[116:119], v[204:207]
  ds_read_b32 v24, v50 offset:2816
  ds_read_b32 v25, v50 offset:3328
  v_mfma_f32_16x16x32_bf16 v[220:223], v[132:135], v[116:119], v[220:223]
  ds_read_b32 v26, v50 offset:2880
  ds_read_b32 v27, v50 offset:3392
  v_mfma_f32_16x16x32_bf16 v[216:219], v[132:135], v[112:115], v[216:219]
  ds_read_b32 v28, v50 offset:2944
  ds_read_b32 v29, v50 offset:3456
  v_mfma_f32_16x16x32_bf16 v[212:215], v[132:135], v[108:111], v[212:215]
  ds_read_b32 v30, v50 offset:3008
  ds_read_b32 v31, v50 offset:3520
  v_mfma_f32_16x16x32_bf16 v[208:211], v[132:135], v[104:107], v[208:211]
  ds_read_b128 v[64:67], v51 offset:2816
  ds_read_b128 v[80:83], v51 offset:3328
  v_mfma_f32_16x16x32_bf16 v[224:227], v[104:107], v[136:139], v[224:227]
  ds_read_b128 v[68:71], v51 offset:2880
  v_mfma_f32_16x16x32_bf16 v[228:231], v[108:111], v[136:139], v[228:231]
  ds_read_b128 v[84:87], v51 offset:3392
  v_mfma_f32_16x16x32_bf16 v[232:235], v[112:115], v[136:139], v[232:235]
  ds_read_b128 v[72:75], v51 offset:2944
  v_mfma_f32_16x16x32_bf16 v[236:239], v[116:119], v[136:139], v[236:239]
  ds_read_b128 v[88:91], v51 offset:3456
  v_mfma_f32_16x16x32_bf16 v[252:255], v[116:119], v[140:143], v[252:255]
  ds_read_b128 v[76:79], v51 offset:3008
  v_mfma_f32_16x16x32_bf16 v[248:251], v[112:115], v[140:143], v[248:251]
  ds_read_b128 v[92:95], v51 offset:3520
  v_mfma_f32_16x16x32_bf16 v[244:247], v[108:111], v[140:143], v[244:247]
  ds_read_b32 v48, v53 offset:5376
  v_mfma_f32_16x16x32_bf16 v[240:243], v[104:107], v[140:143], v[240:243]
  ds_read_b32 v49, v53 offset:5440
  v_mfma_f32_16x16x32_bf16 v[160:163], v[120:123], v[104:107], v[160:163]
  ds_read_b128 v[32:35], v52 offset:4864
  v_mfma_f32_16x16x32_bf16 v[164:167], v[120:123], v[108:111], v[164:167]
  ds_read_b128 v[36:39], v52 offset:4928
  v_mfma_f32_16x16x32_bf16 v[168:171], v[120:123], v[112:115], v[168:171]
  v_mfma_f32_16x16x32_bf16 v[172:175], v[120:123], v[116:119], v[172:175]
  v_mfma_f32_16x16x32_bf16 v[188:191], v[124:127], v[116:119], v[188:191]
  buffer_load_dword off, s[64:67], s31 lds
  v_mfma_f32_16x16x32_bf16 v[184:187], v[124:127], v[112:115], v[184:187]
  v_mfma_f32_16x16x32_bf16 v[180:183], v[124:127], v[108:111], v[180:183]
  v_mfma_f32_16x16x32_bf16 v[176:179], v[124:127], v[104:107], v[176:179]
  s_waitcnt lgkmcnt(0)
  v_cmp_gt_u32 vcc, 2, v62
  v_cmp_gt_u32 s[14:15], s12, v63
  s_or_b64 vcc, vcc, s[14:15]
  s_cbranch_scc1 .g2_kernel_q_ew
.g2_kernel_q_eb:
  v_cmp_ne_u32 vcc, 0, v57
  s_cbranch_vccnz .g2_kernel_q_patch
.g2_kernel_q_pback:
  s_add_u32 s79, s77, 4096
  s_cmp_lg_u32 s10, 0
  s_cbranch_scc1 .g2_kernel_q_nk
  v_pk_mul_f32 v[152:153], v[40:41], v[24:25] op_sel:[0,1] op_sel_hi:[1,1]
  v_pk_mul_f32 v[154:155], v[42:43], v[24:25] op_sel:[0,1] op_sel_hi:[1,1]
  v_pk_mul_f32 v[156:157], v[44:45], v[24:25] op_sel:[0,1] op_sel_hi:[1,1]
  v_pk_mul_f32 v[158:159], v[46:47], v[24:25] op_sel:[0,1] op_sel_hi:[1,1]
  v_pk_fma_f32 v[192:193], v[192:193], v[24:25], v[152:153] op_sel_hi:[1,0,1]
  v_pk_fma_f32 v[194:195], v[194:195], v[24:25], v[154:155] op_sel_hi:[1,0,1]
  v_pk_fma_f32 v[208:209], v[208:209], v[24:25], v[156:157] op_sel_hi:[1,0,1]
  v_pk_fma_f32 v[210:211], v[210:211], v[24:25], v[158:159] op_sel_hi:[1,0,1]
  v_cvt_pk_bf16_f32 v192, v192, v193
  v_cvt_pk_bf16_f32 v193, v194, v195
  v_cvt_pk_bf16_f32 v194, v208, v209
  v_cvt_pk_bf16_f32 v195, v210, v211
  buffer_store_dwordx4 v[192:195], v54, s[4:7], s8 offen offset:0 sc1
  v_pk_mul_f32 v[152:153], v[40:41], v[26:27] op_sel:[0,1] op_sel_hi:[1,1]
  v_pk_mul_f32 v[154:155], v[42:43], v[26:27] op_sel:[0,1] op_sel_hi:[1,1]
  v_pk_mul_f32 v[156:157], v[44:45], v[26:27] op_sel:[0,1] op_sel_hi:[1,1]
  v_pk_mul_f32 v[158:159], v[46:47], v[26:27] op_sel:[0,1] op_sel_hi:[1,1]
  v_pk_fma_f32 v[196:197], v[196:197], v[26:27], v[152:153] op_sel_hi:[1,0,1]
  v_pk_fma_f32 v[198:199], v[198:199], v[26:27], v[154:155] op_sel_hi:[1,0,1]
  v_pk_fma_f32 v[212:213], v[212:213], v[26:27], v[156:157] op_sel_hi:[1,0,1]
  v_pk_fma_f32 v[214:215], v[214:215], v[26:27], v[158:159] op_sel_hi:[1,0,1]
  v_cvt_pk_bf16_f32 v196, v196, v197
  v_cvt_pk_bf16_f32 v197, v198, v199
  v_cvt_pk_bf16_f32 v198, v212, v213
  v_cvt_pk_bf16_f32 v199, v214, v215
  buffer_store_dwordx4 v[196:199], v54, s[4:7], s8 offen offset:128 sc1
  v_pk_mul_f32 v[152:153], v[40:41], v[28:29] op_sel:[0,1] op_sel_hi:[1,1]
  v_pk_mul_f32 v[154:155], v[42:43], v[28:29] op_sel:[0,1] op_sel_hi:[1,1]
  v_pk_mul_f32 v[156:157], v[44:45], v[28:29] op_sel:[0,1] op_sel_hi:[1,1]
  v_pk_mul_f32 v[158:159], v[46:47], v[28:29] op_sel:[0,1] op_sel_hi:[1,1]
  v_pk_fma_f32 v[200:201], v[200:201], v[28:29], v[152:153] op_sel_hi:[1,0,1]
  v_pk_fma_f32 v[202:203], v[202:203], v[28:29], v[154:155] op_sel_hi:[1,0,1]
  v_pk_fma_f32 v[216:217], v[216:217], v[28:29], v[156:157] op_sel_hi:[1,0,1]
  v_pk_fma_f32 v[218:219], v[218:219], v[28:29], v[158:159] op_sel_hi:[1,0,1]
  v_cvt_pk_bf16_f32 v200, v200, v201
  v_cvt_pk_bf16_f32 v201, v202, v203
  v_cvt_pk_bf16_f32 v202, v216, v217
  v_cvt_pk_bf16_f32 v203, v218, v219
  buffer_store_dwordx4 v[200:203], v54, s[4:7], s9 offen offset:0 sc1
  v_pk_mul_f32 v[152:153], v[40:41], v[30:31] op_sel:[0,1] op_sel_hi:[1,1]
  v_pk_mul_f32 v[154:155], v[42:43], v[30:31] op_sel:[0,1] op_sel_hi:[1,1]
  v_pk_mul_f32 v[156:157], v[44:45], v[30:31] op_sel:[0,1] op_sel_hi:[1,1]
  v_pk_mul_f32 v[158:159], v[46:47], v[30:31] op_sel:[0,1] op_sel_hi:[1,1]
  v_pk_fma_f32 v[204:205], v[204:205], v[30:31], v[152:153] op_sel_hi:[1,0,1]
  v_pk_fma_f32 v[206:207], v[206:207], v[30:31], v[154:155] op_sel_hi:[1,0,1]
  v_pk_fma_f32 v[220:221], v[220:221], v[30:31], v[156:157] op_sel_hi:[1,0,1]
  v_pk_fma_f32 v[222:223], v[222:223], v[30:31], v[158:159] op_sel_hi:[1,0,1]
  v_cvt_pk_bf16_f32 v204, v204, v205
  v_cvt_pk_bf16_f32 v205, v206, v207
  v_cvt_pk_bf16_f32 v206, v220, v221
  v_cvt_pk_bf16_f32 v207, v222, v223
  buffer_store_dwordx4 v[204:207], v54, s[4:7], s9 offen offset:128 sc1
  v_pk_mul_f32 v[152:153], v[80:81], v[48:49] op_sel:[0,0] op_sel_hi:[1,0]
  v_pk_mul_f32 v[154:155], v[82:83], v[48:49] op_sel:[0,0] op_sel_hi:[1,0]
  v_pk_mul_f32 v[156:157], v[84:85], v[48:49] op_sel:[0,0] op_sel_hi:[1,0]
  v_pk_mul_f32 v[158:159], v[86:87], v[48:49] op_sel:[0,0] op_sel_hi:[1,0]
  v_pk_fma_f32 v[224:225], v[224:225], v[64:65], v[152:153]
  v_pk_fma_f32 v[226:227], v[226:227], v[66:67], v[154:155]
  v_pk_fma_f32 v[228:229], v[228:229], v[68:69], v[156:157]
  v_pk_fma_f32 v[230:231], v[230:231], v[70:71], v[158:159]
  v_cvt_pk_bf16_f32 v224, v224, v225
  v_cvt_pk_bf16_f32 v225, v226, v227
  v_cvt_pk_bf16_f32 v226, v228, v229
  v_cvt_pk_bf16_f32 v227, v230, v231
  buffer_store_dwordx4 v[224:227], v55, s[4:7], s8 offen offset:2048 sc1
  v_pk_mul_f32 v[152:153], v[80:81], v[48:49] op_sel:[0,1] op_sel_hi:[1,1]
  v_pk_mul_f32 v[154:155], v[82:83], v[48:49] op_sel:[0,1] op_sel_hi:[1,1]
  v_pk_mul_f32 v[156:157], v[84:85], v[48:49] op_sel:[0,1] op_sel_hi:[1,1]
  v_pk_mul_f32 v[158:159], v[86:87], v[48:49] op_sel:[0,1] op_sel_hi:[1,1]
  v_pk_fma_f32 v[240:241], v[240:241], v[64:65], v[152:153]
  v_pk_fma_f32 v[242:243], v[242:243], v[66:67], v[154:155]
  v_pk_fma_f32 v[244:245], v[244:245], v[68:69], v[156:157]
  v_pk_fma_f32 v[246:247], v[246:247], v[70:71], v[158:159]
  v_cvt_pk_bf16_f32 v240, v240, v241
  v_cvt_pk_bf16_f32 v241, v242, v243
  v_cvt_pk_bf16_f32 v242, v244, v245
  v_cvt_pk_bf16_f32 v243, v246, v247
  buffer_store_dwordx4 v[240:243], v55, s[4:7], s8 offen offset:2304 sc1
  v_pk_mul_f32 v[152:153], v[88:89], v[48:49] op_sel:[0,0] op_sel_hi:[1,0]
  v_pk_mul_f32 v[154:155], v[90:91], v[48:49] op_sel:[0,0] op_sel_hi:[1,0]
  v_pk_mul_f32 v[156:157], v[92:93], v[48:49] op_sel:[0,0] op_sel_hi:[1,0]
  v_pk_mul_f32 v[158:159], v[94:95], v[48:49] op_sel:[0,0] op_sel_hi:[1,0]
  v_pk_fma_f32 v[232:233], v[232:233], v[72:73], v[152:153]
  v_pk_fma_f32 v[234:235], v[234:235], v[74:75], v[154:155]
  v_pk_fma_f32 v[236:237], v[236:237], v[76:77], v[156:157]
  v_pk_fma_f32 v[238:239], v[238:239], v[78:79], v[158:159]
  v_cvt_pk_bf16_f32 v232, v232, v233
  v_cvt_pk_bf16_f32 v233, v234, v235
  v_cvt_pk_bf16_f32 v234, v236, v237
  v_cvt_pk_bf16_f32 v235, v238, v239
  buffer_store_dwordx4 v[232:235], v55, s[4:7], s9 offen offset:2048 sc1
  v_pk_mul_f32 v[152:153], v[88:89], v[48:49] op_sel:[0,1] op_sel_hi:[1,1]
  v_pk_mul_f32 v[154:155], v[90:91], v[48:49] op_sel:[0,1] op_sel_hi:[1,1]
  v_pk_mul_f32 v[156:157], v[92:93], v[48:49] op_sel:[0,1] op_sel_hi:[1,1]
  v_pk_mul_f32 v[158:159], v[94:95], v[48:49] op_sel:[0,1] op_sel_hi:[1,1]
  v_pk_fma_f32 v[248:249], v[248:249], v[72:73], v[152:153]
  v_pk_fma_f32 v[250:251], v[250:251], v[74:75], v[154:155]
  v_pk_fma_f32 v[252:253], v[252:253], v[76:77], v[156:157]
  v_pk_fma_f32 v[254:255], v[254:255], v[78:79], v[158:159]
  v_cvt_pk_bf16_f32 v248, v248, v249
  v_cvt_pk_bf16_f32 v249, v250, v251
  v_cvt_pk_bf16_f32 v250, v252, v253
  v_cvt_pk_bf16_f32 v251, v254, v255
  buffer_store_dwordx4 v[248:251], v55, s[4:7], s9 offen offset:2304 sc1
  v_pk_mul_f32 v[24:25], v[24:25], v[56:57] op_sel_hi:[1,0]
  v_pk_mul_f32 v[26:27], v[26:27], v[56:57] op_sel_hi:[1,0]
  v_pk_mul_f32 v[28:29], v[28:29], v[56:57] op_sel_hi:[1,0]
  v_pk_mul_f32 v[30:31], v[30:31], v[56:57] op_sel_hi:[1,0]
  ds_write_b128 v59, v[192:195] offset:0
  ds_write_b128 v59, v[196:199] offset:128
  v_pk_mul_f32 v[152:153], v[32:33], v[24:25] op_sel:[0,1] op_sel_hi:[1,1]
  v_pk_mul_f32 v[154:155], v[34:35], v[24:25] op_sel:[0,1] op_sel_hi:[1,1]
  v_pk_mul_f32 v[156:157], v[36:37], v[24:25] op_sel:[0,1] op_sel_hi:[1,1]
  v_pk_mul_f32 v[158:159], v[38:39], v[24:25] op_sel:[0,1] op_sel_hi:[1,1]
  v_pk_fma_f32 v[160:161], v[160:161], v[24:25], v[152:153] op_sel_hi:[1,0,1]
  v_pk_fma_f32 v[162:163], v[162:163], v[24:25], v[154:155] op_sel_hi:[1,0,1]
  v_pk_fma_f32 v[176:177], v[176:177], v[24:25], v[156:157] op_sel_hi:[1,0,1]
  v_pk_fma_f32 v[178:179], v[178:179], v[24:25], v[158:159] op_sel_hi:[1,0,1]
  v_cvt_pk_bf16_f32 v160, v160, v161
  v_cvt_pk_bf16_f32 v161, v162, v163
  v_cvt_pk_bf16_f32 v162, v176, v177
  v_cvt_pk_bf16_f32 v163, v178, v179
  ds_write_b128 v61, v[160:163] offset:0
  ds_write_b128 v59, v[200:203] offset:4096
  ds_write_b128 v59, v[204:207] offset:4224
  v_pk_mul_f32 v[152:153], v[32:33], v[26:27] op_sel:[0,1] op_sel_hi:[1,1]
  v_pk_mul_f32 v[154:155], v[34:35], v[26:27] op_sel:[0,1] op_sel_hi:[1,1]
  v_pk_mul_f32 v[156:157], v[36:37], v[26:27] op_sel:[0,1] op_sel_hi:[1,1]
  v_pk_mul_f32 v[158:159], v[38:39], v[26:27] op_sel:[0,1] op_sel_hi:[1,1]
  v_pk_fma_f32 v[164:165], v[164:165], v[26:27], v[152:153] op_sel_hi:[1,0,1]
  v_pk_fma_f32 v[166:167], v[166:167], v[26:27], v[154:155] op_sel_hi:[1,0,1]
  v_pk_fma_f32 v[180:181], v[180:181], v[26:27], v[156:157] op_sel_hi:[1,0,1]
  v_pk_fma_f32 v[182:183], v[182:183], v[26:27], v[158:159] op_sel_hi:[1,0,1]
  v_cvt_pk_bf16_f32 v164, v164, v165
  v_cvt_pk_bf16_f32 v165, v166, v167
  v_cvt_pk_bf16_f32 v166, v180, v181
  v_cvt_pk_bf16_f32 v167, v182, v183
  ds_write_b128 v61, v[164:167] offset:256
  ds_write_b128 v60, v[224:227] offset:2048
  ds_write_b128 v60, v[240:243] offset:2304
  v_pk_mul_f32 v[152:153], v[32:33], v[28:29] op_sel:[0,1] op_sel_hi:[1,1]
  v_pk_mul_f32 v[154:155], v[34:35], v[28:29] op_sel:[0,1] op_sel_hi:[1,1]
  v_pk_mul_f32 v[156:157], v[36:37], v[28:29] op_sel:[0,1] op_sel_hi:[1,1]
  v_pk_mul_f32 v[158:159], v[38:39], v[28:29] op_sel:[0,1] op_sel_hi:[1,1]
  v_pk_fma_f32 v[168:169], v[168:169], v[28:29], v[152:153] op_sel_hi:[1,0,1]
  v_pk_fma_f32 v[170:171], v[170:171], v[28:29], v[154:155] op_sel_hi:[1,0,1]
  v_pk_fma_f32 v[184:185], v[184:185], v[28:29], v[156:157] op_sel_hi:[1,0,1]
  v_pk_fma_f32 v[186:187], v[186:187], v[28:29], v[158:159] op_sel_hi:[1,0,1]
  v_cvt_pk_bf16_f32 v168, v168, v169
  v_cvt_pk_bf16_f32 v169, v170, v171
  v_cvt_pk_bf16_f32 v170, v184, v185
  v_cvt_pk_bf16_f32 v171, v186, v187
  ds_write_b128 v61, v[168:171] offset:2048
  ds_write_b128 v60, v[232:235] offset:6144
  ds_write_b128 v60, v[248:251] offset:6400
  v_pk_mul_f32 v[152:153], v[32:33], v[30:31] op_sel:[0,1] op_sel_hi:[1,1]
  v_pk_mul_f32 v[154:155], v[34:35], v[30:31] op_sel:[0,1] op_sel_hi:[1,1]
  v_pk_mul_f32 v[156:157], v[36:37], v[30:31] op_sel:[0,1] op_sel_hi:[1,1]
  v_pk_mul_f32 v[158:159], v[38:39], v[30:31] op_sel:[0,1] op_sel_hi:[1,1]
  v_pk_fma_f32 v[172:173], v[172:173], v[30:31], v[152:153] op_sel_hi:[1,0,1]
  v_pk_fma_f32 v[174:175], v[174:175], v[30:31], v[154:155] op_sel_hi:[1,0,1]
  v_pk_fma_f32 v[188:189], v[188:189], v[30:31], v[156:157] op_sel_hi:[1,0,1]
  v_pk_fma_f32 v[190:191], v[190:191], v[30:31], v[158:159] op_sel_hi:[1,0,1]
  v_cvt_pk_bf16_f32 v172, v172, v173
  v_cvt_pk_bf16_f32 v173, v174, v175
  v_cvt_pk_bf16_f32 v174, v188, v189
  v_cvt_pk_bf16_f32 v175, v190, v191
  ds_write_b128 v61, v[172:175] offset:2304
.g2_kernel_q_kd:
  s_mov_b64 exec, 1
  ds_add_u32 v13, v5 offset:4
  s_mov_b64 exec, -1
  v_mov_b32 v120, 0
  v_mov_b32 v121, 0
  v_mov_b32 v124, 0
  v_mov_b32 v125, 0
  v_mov_b32 v128, 0
  v_mov_b32 v129, 0
  v_mov_b32 v132, 0
  v_mov_b32 v133, 0
  s_cmp_lg_u32 s62, 0
  s_cbranch_scc1 .g2_kernel_r2
  global_load_dwordx4 v[240:243], v23, s[74:75] offset:0
  global_load_dwordx4 v[244:247], v23, s[74:75] offset:32
  global_load_dwordx4 v[248:251], v23, s[74:75] offset:64
  global_load_dwordx4 v[252:255], v23, s[74:75] offset:96
.g2_kernel_r3:
  v_mov_b32 v6, s71
  s_mov_b32 s38, 0
.g2_kernel_wg2:
  ds_read_b32 v7, v6 offset:4
  s_add_u32 s38, s38, 1
  s_waitcnt lgkmcnt(0)
  v_cmp_le_u32 vcc, 4, v7
  s_cbranch_vccnz .g2_kernel_wg2d
  s_cmp_lt_u32 s38, 524288
  s_cbranch_scc1 .g2_kernel_wg2
.g2_kernel_wg2d:
  ds_read_b128 v[176:179], v9 offset:0
  ds_read_b128 v[180:183], v9 offset:1024
  ds_read_b128 v[24:27], v14 offset:8192
  ds_read_b128 v[28:31], v14 offset:9216
  ds_read_b128 v[184:187], v9 offset:2048
  ds_read_b128 v[188:191], v9 offset:3072
  ds_read_b128 v[32:35], v14 offset:10240
  ds_read_b128 v[36:39], v14 offset:11264
  ds_read_b128 v[40:43], v14 offset:12288
  ds_read_b128 v[44:47], v14 offset:13312
  ds_read_b128 v[48:51], v14 offset:14336
  ds_read_b128 v[52:55], v14 offset:15360
  s_cmp_lg_u32 s35, 0
  s_cbranch_scc1 .g2_kernel_a_own
  s_waitcnt lgkmcnt(8)
.g2_kernel_a_ob:
  v_mfma_f32_32x32x16_bf16 v[136:151], v[176:179], v[24:27], 0
  v_mfma_f32_32x32x16_bf16 v[136:151], v[180:183], v[28:31], v[136:151]
  s_waitcnt lgkmcnt(0)
  s_nop 7
  v_mfma_f32_32x32x16_bf16 v[152:167], v[176:179], v[32:35], 0
  s_waitcnt vmcnt(4)
  s_mov_b64 exec, 1
  buffer_store_dword v15, v4, s[4:7], s37 offen sc1
  s_mov_b64 exec, -1
  v_exp_f32 v136, v136
  v_exp_f32 v137, v137
  v_exp_f32 v138, v138
  v_exp_f32 v139, v139
  v_exp_f32 v140, v140
  v_exp_f32 v141, v141
  v_exp_f32 v142, v142
  v_exp_f32 v143, v143
  v_mfma_f32_32x32x16_bf16 v[152:167], v[180:183], v[36:39], v[152:167]
  s_mov_b64 exec, 1
  ds_add_u32 v13, v5 offset:8
  s_mov_b64 exec, -1
  v_cvt_pk_bf16_f32 v168, v136, v137
  v_cvt_pk_bf16_f32 v169, v138, v139
  v_cvt_pk_bf16_f32 v170, v140, v141
  v_cvt_pk_bf16_f32 v171, v142, v143
  v_exp_f32 v144, v144
  v_exp_f32 v145, v145
  v_exp_f32 v146, v146
  v_exp_f32 v147, v147
  v_mfma_f32_32x32x16_bf16 v[56:71], v[184:187], v[168:171], 0
  v_exp_f32 v148, v148
  v_exp_f32 v149, v149
  v_exp_f32 v150, v150
  v_exp_f32 v151, v151
  v_cvt_pk_bf16_f32 v172, v144, v145
  v_cvt_pk_bf16_f32 v173, v146, v147
  v_cvt_pk_bf16_f32 v174, v148, v149
  v_cvt_pk_bf16_f32 v175, v150, v151
  v_mfma_f32_32x32x16_bf16 v[136:151], v[176:179], v[40:43], 0
  v_exp_f32 v152, v152
  v_exp_f32 v153, v153
  v_exp_f32 v154, v154
  v_mfma_f32_32x32x16_bf16 v[56:71], v[188:191], v[172:175], v[56:71]
  v_exp_f32 v155, v155
  v_exp_f32 v156, v156
  v_exp_f32 v157, v157
  v_smfmac_f32_16x16x64_bf16 v[120:123], v[16:19], v[168:175], v20
  v_exp_f32 v158, v158
  v_exp_f32 v159, v159
  v_mfma_f32_32x32x16_bf16 v[136:151], v[180:183], v[44:47], v[136:151]
  v_cvt_pk_bf16_f32 v168, v152, v153
  v_cvt_pk_bf16_f32 v169, v154, v155
  v_cvt_pk_bf16_f32 v170, v156, v157
  v_cvt_pk_bf16_f32 v171, v158, v159
  v_exp_f32 v160, v160
  v_exp_f32 v161, v161
  v_exp_f32 v162, v162
  v_exp_f32 v163, v163
  v_mfma_f32_32x32x16_bf16 v[72:87], v[184:187], v[168:171], 0
  v_exp_f32 v164, v164
  v_exp_f32 v165, v165
  v_exp_f32 v166, v166
  v_exp_f32 v167, v167
  v_cvt_pk_bf16_f32 v172, v160, v161
  v_cvt_pk_bf16_f32 v173, v162, v163
  v_cvt_pk_bf16_f32 v174, v164, v165
  v_cvt_pk_bf16_f32 v175, v166, v167
  v_mfma_f32_32x32x16_bf16 v[152:167], v[176:179], v[48:51], 0
  ds_read_b32 v7, v8
  v_exp_f32 v136, v136
  v_exp_f32 v137, v137
  v_exp_f32 v138, v138
  v_mfma_f32_32x32x16_bf16 v[72:87], v[188:191], v[172:175], v[72:87]
  v_exp_f32 v139, v139
  v_exp_f32 v140, v140
  v_exp_f32 v141, v141
  v_smfmac_f32_16x16x64_bf16 v[124:127], v[16:19], v[168:175], v20
  v_exp_f32 v142, v142
  v_exp_f32 v143, v143
  v_mfma_f32_32x32x16_bf16 v[152:167], v[180:183], v[52:55], v[152:167]
  s_waitcnt lgkmcnt(0)
  v_cmp_lt_u32 vcc, s62, v7
  v_cvt_pk_bf16_f32 v168, v136, v137
  v_cvt_pk_bf16_f32 v169, v138, v139
  v_cvt_pk_bf16_f32 v170, v140, v141
  v_cvt_pk_bf16_f32 v171, v142, v143
  v_exp_f32 v144, v144
  v_exp_f32 v145, v145
  v_exp_f32 v146, v146
  v_exp_f32 v147, v147
  v_mfma_f32_32x32x16_bf16 v[88:103], v[184:187], v[168:171], 0
  s_mov_b32 s36, vcc_lo
  s_andn2_b32 s33, s36, s34
  v_exp_f32 v148, v148
  v_exp_f32 v149, v149
  v_exp_f32 v150, v150
  v_exp_f32 v151, v151
  v_cvt_pk_bf16_f32 v172, v144, v145
  v_cvt_pk_bf16_f32 v173, v146, v147
  v_cvt_pk_bf16_f32 v174, v148, v149
  v_cvt_pk_bf16_f32 v175, v150, v151
  v_exp_f32 v152, v152
  v_exp_f32 v153, v153
  v_exp_f32 v154, v154
  v_mfma_f32_32x32x16_bf16 v[88:103], v[188:191], v[172:175], v[88:103]
  s_bcnt1_i32_b32 s39, s33
  s_cmp_lt_u32 s39, 3
  v_exp_f32 v155, v155
  v_exp_f32 v156, v156
  v_exp_f32 v157, v157
  v_smfmac_f32_16x16x64_bf16 v[128:131], v[16:19], v[168:175], v20
  s_cbranch_scc1 .g2_kernel_a_F0n
  s_call_b64 s[72:73], .g2_kernel_a_three
.g2_kernel_a_F0n:
  v_exp_f32 v158, v158
  v_exp_f32 v159, v159
  v_cvt_pk_bf16_f32 v168, v152, v153
  v_cvt_pk_bf16_f32 v169, v154, v155
  v_cvt_pk_bf16_f32 v170, v156, v157
  v_cvt_pk_bf16_f32 v171, v158, v159
  v_exp_f32 v160, v160
  v_exp_f32 v161, v161
  v_exp_f32 v162, v162
  v_exp_f32 v163, v163
  v_mfma_f32_32x32x16_bf16 v[104:119], v[184:187], v[168:171], 0
  v_exp_f32 v164, v164
  v_exp_f32 v165, v165
  v_exp_f32 v166, v166
  v_exp_f32 v167, v167
  v_cvt_pk_bf16_f32 v172, v160, v161
  v_cvt_pk_bf16_f32 v173, v162, v163
  v_cvt_pk_bf16_f32 v174, v164, v165
  v_cvt_pk_bf16_f32 v175, v166, v167
  s_add_u32 s39, s39, s35
  s_cmp_ge_u32 s39, 3
  s_cbranch_scc1 .g2_kernel_a_p1
  s_call_b64 s[72:73], .g2_kernel_a_three
.g2_kernel_a_p1:
  s_waitcnt vmcnt(10)
  v_mfma_f32_32x32x16_bf16 v[136:151], v[192:195], v[24:27], 0
  v_mfma_f32_32x32x16_bf16 v[136:151], v[196:199], v[28:31], v[136:151]
  s_waitcnt vmcnt(8)
  s_mov_b32 s32, 0
  s_nop 8
  s_branch .g2_kernel_a_n1
  .p2align 6
.g2_kernel_a_loop:
  v_mfma_f32_32x32x16_bf16 v[152:167], v[176:179], v[32:35], 0
  s_andn2_b32 s33, s36, s34
  v_exp_f32 v136, v136
  v_exp_f32 v137, v137
  v_exp_f32 v138, v138
  v_mfma_f32_32x32x16_bf16 v[104:119], v[236:239], v[172:175], v[104:119]
  s_cbranch_scc0 .g2_kernel_a_N0c
.g2_kernel_a_N0b:
  v_exp_f32 v139, v139
  v_exp_f32 v140, v140
  v_exp_f32 v141, v141
  v_smfmac_f32_16x16x64_bf16 v[132:135], v[16:19], v[168:175], v20
  s_ff1_i32_b32 s33, s33
  v_exp_f32 v142, v142
  v_exp_f32 v143, v143
  v_mfma_f32_32x32x16_bf16 v[152:167], v[180:183], v[36:39], v[152:167]
  s_bitset1_b32 s34, s33
  v_cvt_pk_bf16_f32 v168, v136, v137
  v_cvt_pk_bf16_f32 v169, v138, v139
  v_cvt_pk_bf16_f32 v170, v140, v141
  v_cvt_pk_bf16_f32 v171, v142, v143
  v_exp_f32 v144, v144
  v_exp_f32 v145, v145
  v_exp_f32 v146, v146
  v_exp_f32 v147, v147
  v_mfma_f32_32x32x16_bf16 v[56:71], v[184:187], v[168:171], v[56:71]
  s_xor_b32 s33, s33, s24
  v_exp_f32 v148, v148
  v_exp_f32 v149, v149
  v_exp_f32 v150, v150
  v_exp_f32 v151, v151
  v_cvt_pk_bf16_f32 v172, v144, v145
  v_cvt_pk_bf16_f32 v173, v146, v147
  v_cvt_pk_bf16_f32 v174, v148, v149
  v_cvt_pk_bf16_f32 v175, v150, v151
  v_mfma_f32_32x32x16_bf16 v[136:151], v[176:179], v[40:43], 0
  s_lshl_b32 s33, s33, s25
  v_exp_f32 v152, v152
  v_exp_f32 v153, v153
  v_exp_f32 v154, v154
  v_mfma_f32_32x32x16_bf16 v[56:71], v[188:191], v[172:175], v[56:71]
  s_add_u32 s22, s20, s33
  v_exp_f32 v155, v155
  v_exp_f32 v156, v156
  v_exp_f32 v157, v157
  v_smfmac_f32_16x16x64_bf16 v[120:123], v[16:19], v[168:175], v20
  s_addc_u32 s23, s21, 0
  v_exp_f32 v158, v158
  v_exp_f32 v159, v159
  v_mfma_f32_32x32x16_bf16 v[136:151], v[180:183], v[44:47], v[136:151]
  v_cvt_pk_bf16_f32 v168, v152, v153
  v_cvt_pk_bf16_f32 v169, v154, v155
  v_cvt_pk_bf16_f32 v170, v156, v157
  v_cvt_pk_bf16_f32 v171, v158, v159
  v_exp_f32 v160, v160
  v_exp_f32 v161, v161
  v_exp_f32 v162, v162
  v_exp_f32 v163, v163
  v_mfma_f32_32x32x16_bf16 v[72:87], v[184:187], v[168:171], v[72:87]
  v_exp_f32 v164, v164
  v_exp_f32 v165, v165
  v_exp_f32 v166, v166
  v_exp_f32 v167, v167
  v_cvt_pk_bf16_f32 v172, v160, v161
  v_cvt_pk_bf16_f32 v173, v162, v163
  v_cvt_pk_bf16_f32 v174, v164, v165
  v_cvt_pk_bf16_f32 v175, v166, v167
  v_mfma_f32_32x32x16_bf16 v[152:167], v[176:179], v[48:51], 0
  v_exp_f32 v136, v136
  v_exp_f32 v137, v137
  v_exp_f32 v138, v138
  v_mfma_f32_32x32x16_bf16 v[72:87], v[188:191], v[172:175], v[72:87]
  v_exp_f32 v139, v139
  v_exp_f32 v140, v140
  v_exp_f32 v141, v141
  v_smfmac_f32_16x16x64_bf16 v[124:127], v[16:19], v[168:175], v20
  global_load_dwordx4 v[224:227], v3, s[22:23] offset:0
  global_load_dwordx4 v[228:231], v3, s[22:23] offset:1024
  global_load_dwordx4 v[232:235], v3, s[22:23] offset:2048
  global_load_dwordx4 v[236:239], v3, s[22:23] offset:3072
  v_exp_f32 v142, v142
  v_exp_f32 v143, v143
  v_mfma_f32_32x32x16_bf16 v[152:167], v[180:183], v[52:55], v[152:167]
  v_cvt_pk_bf16_f32 v168, v136, v137
  v_cvt_pk_bf16_f32 v169, v138, v139
  v_cvt_pk_bf16_f32 v170, v140, v141
  v_cvt_pk_bf16_f32 v171, v142, v143
  v_exp_f32 v144, v144
  v_exp_f32 v145, v145
  v_exp_f32 v146, v146
  v_exp_f32 v147, v147
  v_mfma_f32_32x32x16_bf16 v[88:103], v[184:187], v[168:171], v[88:103]
  s_waitcnt vmcnt(8)
  v_exp_f32 v148, v148
  v_exp_f32 v149, v149
  v_exp_f32 v150, v150
  v_exp_f32 v151, v151
  v_cvt_pk_bf16_f32 v172, v144, v145
  v_cvt_pk_bf16_f32 v173, v146, v147
  v_cvt_pk_bf16_f32 v174, v148, v149
  v_cvt_pk_bf16_f32 v175, v150, v151
  v_mfma_f32_32x32x16_bf16 v[136:151], v[192:195], v[24:27], 0
  v_exp_f32 v152, v152
  v_exp_f32 v153, v153
  v_exp_f32 v154, v154
  v_mfma_f32_32x32x16_bf16 v[88:103], v[188:191], v[172:175], v[88:103]
  v_exp_f32 v155, v155
  v_exp_f32 v156, v156
  v_exp_f32 v157, v157
  v_smfmac_f32_16x16x64_bf16 v[128:131], v[16:19], v[168:175], v20
  v_exp_f32 v158, v158
  v_exp_f32 v159, v159
  v_mfma_f32_32x32x16_bf16 v[136:151], v[196:199], v[28:31], v[136:151]
  v_cvt_pk_bf16_f32 v168, v152, v153
  v_cvt_pk_bf16_f32 v169, v154, v155
  v_cvt_pk_bf16_f32 v170, v156, v157
  v_cvt_pk_bf16_f32 v171, v158, v159
  v_exp_f32 v160, v160
  v_exp_f32 v161, v161
  v_exp_f32 v162, v162
  v_exp_f32 v163, v163
  v_mfma_f32_32x32x16_bf16 v[104:119], v[184:187], v[168:171], v[104:119]
  v_exp_f32 v164, v164
  v_exp_f32 v165, v165
  v_exp_f32 v166, v166
  v_exp_f32 v167, v167
  v_cvt_pk_bf16_f32 v172, v160, v161
  v_cvt_pk_bf16_f32 v173, v162, v163
  v_cvt_pk_bf16_f32 v174, v164, v165
  v_cvt_pk_bf16_f32 v175, v166, v167
.g2_kernel_a_n1:
  v_mfma_f32_32x32x16_bf16 v[152:167], v[192:195], v[32:35], 0
  s_andn2_b32 s33, s36, s34
  v_exp_f32 v136, v136
  v_exp_f32 v137, v137
  v_exp_f32 v138, v138
  v_mfma_f32_32x32x16_bf16 v[104:119], v[188:191], v[172:175], v[104:119]
  s_cbranch_scc0 .g2_kernel_a_N1c
.g2_kernel_a_N1b:
  v_exp_f32 v139, v139
  v_exp_f32 v140, v140
  v_exp_f32 v141, v141
  v_smfmac_f32_16x16x64_bf16 v[132:135], v[16:19], v[168:175], v20
  s_ff1_i32_b32 s33, s33
  v_exp_f32 v142, v142
  v_exp_f32 v143, v143
  v_mfma_f32_32x32x16_bf16 v[152:167], v[196:199], v[36:39], v[152:167]
  s_bitset1_b32 s34, s33
  v_cvt_pk_bf16_f32 v168, v136, v137
  v_cvt_pk_bf16_f32 v169, v138, v139
  v_cvt_pk_bf16_f32 v170, v140, v141
  v_cvt_pk_bf16_f32 v171, v142, v143
  v_exp_f32 v144, v144
  v_exp_f32 v145, v145
  v_exp_f32 v146, v146
  v_exp_f32 v147, v147
  v_mfma_f32_32x32x16_bf16 v[56:71], v[200:203], v[168:171], v[56:71]
  s_xor_b32 s33, s33, s24
  v_exp_f32 v148, v148
  v_exp_f32 v149, v149
  v_exp_f32 v150, v150
  v_exp_f32 v151, v151
  v_cvt_pk_bf16_f32 v172, v144, v145
  v_cvt_pk_bf16_f32 v173, v146, v147
  v_cvt_pk_bf16_f32 v174, v148, v149
  v_cvt_pk_bf16_f32 v175, v150, v151
  v_mfma_f32_32x32x16_bf16 v[136:151], v[192:195], v[40:43], 0
  s_lshl_b32 s33, s33, s25
  v_exp_f32 v152, v152
  v_exp_f32 v153, v153
  v_exp_f32 v154, v154
  v_mfma_f32_32x32x16_bf16 v[56:71], v[204:207], v[172:175], v[56:71]
  s_add_u32 s22, s20, s33
  v_exp_f32 v155, v155
  v_exp_f32 v156, v156
  v_exp_f32 v157, v157
  v_smfmac_f32_16x16x64_bf16 v[120:123], v[16:19], v[168:175], v20
  s_addc_u32 s23, s21, 0
  v_exp_f32 v158, v158
  v_exp_f32 v159, v159
  v_mfma_f32_32x32x16_bf16 v[136:151], v[196:199], v[44:47], v[136:151]
  v_cvt_pk_bf16_f32 v168, v152, v153
  v_cvt_pk_bf16_f32 v169, v154, v155
  v_cvt_pk_bf16_f32 v170, v156, v157
  v_cvt_pk_bf16_f32 v171, v158, v159
  v_exp_f32 v160, v160
  v_exp_f32 v161, v161
  v_exp_f32 v162, v162
  v_exp_f32 v163, v163
  v_mfma_f32_32x32x16_bf16 v[72:87], v[200:203], v[168:171], v[72:87]
  v_exp_f32 v164, v164
  v_exp_f32 v165, v165
  v_exp_f32 v166, v166
  v_exp_f32 v167, v167
  v_cvt_pk_bf16_f32 v172, v160, v161
  v_cvt_pk_bf16_f32 v173, v162, v163
  v_cvt_pk_bf16_f32 v174, v164, v165
  v_cvt_pk_bf16_f32 v175, v166, v167
  v_mfma_f32_32x32x16_bf16 v[152:167], v[192:195], v[48:51], 0
  v_exp_f32 v136, v136
  v_exp_f32 v137, v137
  v_exp_f32 v138, v138
  v_mfma_f32_32x32x16_bf16 v[72:87], v[204:207], v[172:175], v[72:87]
  v_exp_f32 v139, v139
  v_exp_f32 v140, v140
  v_exp_f32 v141, v141
  v_smfmac_f32_16x16x64_bf16 v[124:127], v[16:19], v[168:175], v20
  global_load_dwordx4 v[176:179], v3, s[22:23] offset:0
  global_load_dwordx4 v[180:183], v3, s[22:23] offset:1024
  global_load_dwordx4 v[184:187], v3, s[22:23] offset:2048
  global_load_dwordx4 v[188:191], v3, s[22:23] offset:3072
  v_exp_f32 v142, v142
  v_exp_f32 v143, v143
  v_mfma_f32_32x32x16_bf16 v[152:167], v[196:199], v[52:55], v[152:167]
  v_cvt_pk_bf16_f32 v168, v136, v137
  v_cvt_pk_bf16_f32 v169, v138, v139
  v_cvt_pk_bf16_f32 v170, v140, v141
  v_cvt_pk_bf16_f32 v171, v142, v143
  v_exp_f32 v144, v144
  v_exp_f32 v145, v145
  v_exp_f32 v146, v146
  v_exp_f32 v147, v147
  v_mfma_f32_32x32x16_bf16 v[88:103], v[200:203], v[168:171], v[88:103]
  s_waitcnt vmcnt(8)
  v_exp_f32 v148, v148
  v_exp_f32 v149, v149
  v_exp_f32 v150, v150
  v_exp_f32 v151, v151
  v_cvt_pk_bf16_f32 v172, v144, v145
  v_cvt_pk_bf16_f32 v173, v146, v147
  v_cvt_pk_bf16_f32 v174, v148, v149
  v_cvt_pk_bf16_f32 v175, v150, v151
  v_mfma_f32_32x32x16_bf16 v[136:151], v[208:211], v[24:27], 0
  v_exp_f32 v152, v152
  v_exp_f32 v153, v153
  v_exp_f32 v154, v154
  v_mfma_f32_32x32x16_bf16 v[88:103], v[204:207], v[172:175], v[88:103]
  v_exp_f32 v155, v155
  v_exp_f32 v156, v156
  v_exp_f32 v157, v157
  v_smfmac_f32_16x16x64_bf16 v[128:131], v[16:19], v[168:175], v20
  v_exp_f32 v158, v158
  v_exp_f32 v159, v159
  v_mfma_f32_32x32x16_bf16 v[136:151], v[212:215], v[28:31], v[136:151]
  v_cvt_pk_bf16_f32 v168, v152, v153
  v_cvt_pk_bf16_f32 v169, v154, v155
  v_cvt_pk_bf16_f32 v170, v156, v157
  v_cvt_pk_bf16_f32 v171, v158, v159
  v_exp_f32 v160, v160
  v_exp_f32 v161, v161
  v_exp_f32 v162, v162
  v_exp_f32 v163, v163
  v_mfma_f32_32x32x16_bf16 v[104:119], v[200:203], v[168:171], v[104:119]
  v_exp_f32 v164, v164
  v_exp_f32 v165, v165
  v_exp_f32 v166, v166
  v_exp_f32 v167, v167
  v_cvt_pk_bf16_f32 v172, v160, v161
  v_cvt_pk_bf16_f32 v173, v162, v163
  v_cvt_pk_bf16_f32 v174, v164, v165
  v_cvt_pk_bf16_f32 v175, v166, v167
  v_mfma_f32_32x32x16_bf16 v[152:167], v[208:211], v[32:35], 0
  s_andn2_b32 s33, s36, s34
  v_exp_f32 v136, v136
  v_exp_f32 v137, v137
  v_exp_f32 v138, v138
  v_mfma_f32_32x32x16_bf16 v[104:119], v[204:207], v[172:175], v[104:119]
  s_cbranch_scc0 .g2_kernel_a_N2c
.g2_kernel_a_N2b:
  v_exp_f32 v139, v139
  v_exp_f32 v140, v140
  v_exp_f32 v141, v141
  v_smfmac_f32_16x16x64_bf16 v[132:135], v[16:19], v[168:175], v20
  s_ff1_i32_b32 s33, s33
  v_exp_f32 v142, v142
  v_exp_f32 v143, v143
  v_mfma_f32_32x32x16_bf16 v[152:167], v[212:215], v[36:39], v[152:167]
  s_bitset1_b32 s34, s33
  v_cvt_pk_bf16_f32 v168, v136, v137
  v_cvt_pk_bf16_f32 v169, v138, v139
  v_cvt_pk_bf16_f32 v170, v140, v141
  v_cvt_pk_bf16_f32 v171, v142, v143
  v_exp_f32 v144, v144
  v_exp_f32 v145, v145
  v_exp_f32 v146, v146
  v_exp_f32 v147, v147
  v_mfma_f32_32x32x16_bf16 v[56:71], v[216:219], v[168:171], v[56:71]
  s_xor_b32 s33, s33, s24
  v_exp_f32 v148, v148
  v_exp_f32 v149, v149
  v_exp_f32 v150, v150
  v_exp_f32 v151, v151
  v_cvt_pk_bf16_f32 v172, v144, v145
  v_cvt_pk_bf16_f32 v173, v146, v147
  v_cvt_pk_bf16_f32 v174, v148, v149
  v_cvt_pk_bf16_f32 v175, v150, v151
  v_mfma_f32_32x32x16_bf16 v[136:151], v[208:211], v[40:43], 0
  s_lshl_b32 s33, s33, s25
  v_exp_f32 v152, v152
  v_exp_f32 v153, v153
  v_exp_f32 v154, v154
  v_mfma_f32_32x32x16_bf16 v[56:71], v[220:223], v[172:175], v[56:71]
  s_add_u32 s22, s20, s33
  v_exp_f32 v155, v155
  v_exp_f32 v156, v156
  v_exp_f32 v157, v157
  v_smfmac_f32_16x16x64_bf16 v[120:123], v[16:19], v[168:175], v20
  s_addc_u32 s23, s21, 0
  v_exp_f32 v158, v158
  v_exp_f32 v159, v159
  v_mfma_f32_32x32x16_bf16 v[136:151], v[212:215], v[44:47], v[136:151]
  v_cvt_pk_bf16_f32 v168, v152, v153
  v_cvt_pk_bf16_f32 v169, v154, v155
  v_cvt_pk_bf16_f32 v170, v156, v157
  v_cvt_pk_bf16_f32 v171, v158, v159
  v_exp_f32 v160, v160
  v_exp_f32 v161, v161
  v_exp_f32 v162, v162
  v_exp_f32 v163, v163
  v_mfma_f32_32x32x16_bf16 v[72:87], v[216:219], v[168:171], v[72:87]
  v_exp_f32 v164, v164
  v_exp_f32 v165, v165
  v_exp_f32 v166, v166
  v_exp_f32 v167, v167
  v_cvt_pk_bf16_f32 v172, v160, v161
  v_cvt_pk_bf16_f32 v173, v162, v163
  v_cvt_pk_bf16_f32 v174, v164, v165
  v_cvt_pk_bf16_f32 v175, v166, v167
  v_mfma_f32_32x32x16_bf16 v[152:167], v[208:211], v[48:51], 0
  v_exp_f32 v136, v136
  v_exp_f32 v137, v137
  v_exp_f32 v138, v138
  v_mfma_f32_32x32x16_bf16 v[72:87], v[220:223], v[172:175], v[72:87]
  v_exp_f32 v139, v139
  v_exp_f32 v140, v140
  v_exp_f32 v141, v141
  v_smfmac_f32_16x16x64_bf16 v[124:127], v[16:19], v[168:175], v20
  global_load_dwordx4 v[192:195], v3, s[22:23] offset:0
  global_load_dwordx4 v[196:199], v3, s[22:23] offset:1024
  global_load_dwordx4 v[200:203], v3, s[22:23] offset:2048
  global_load_dwordx4 v[204:207], v3, s[22:23] offset:3072
  v_exp_f32 v142, v142
  v_exp_f32 v143, v143
  v_mfma_f32_32x32x16_bf16 v[152:167], v[212:215], v[52:55], v[152:167]
  v_cvt_pk_bf16_f32 v168, v136, v137
  v_cvt_pk_bf16_f32 v169, v138, v139
  v_cvt_pk_bf16_f32 v170, v140, v141
  v_cvt_pk_bf16_f32 v171, v142, v143
  v_exp_f32 v144, v144
  v_exp_f32 v145, v145
  v_exp_f32 v146, v146
  v_exp_f32 v147, v147
  v_mfma_f32_32x32x16_bf16 v[88:103], v[216:219], v[168:171], v[88:103]
  s_waitcnt vmcnt(8)
  v_exp_f32 v148, v148
  v_exp_f32 v149, v149
  v_exp_f32 v150, v150
  v_exp_f32 v151, v151
  v_cvt_pk_bf16_f32 v172, v144, v145
  v_cvt_pk_bf16_f32 v173, v146, v147
  v_cvt_pk_bf16_f32 v174, v148, v149
  v_cvt_pk_bf16_f32 v175, v150, v151
  v_mfma_f32_32x32x16_bf16 v[136:151], v[224:227], v[24:27], 0
  v_exp_f32 v152, v152
  v_exp_f32 v153, v153
  v_exp_f32 v154, v154
  v_mfma_f32_32x32x16_bf16 v[88:103], v[220:223], v[172:175], v[88:103]
  v_exp_f32 v155, v155
  v_exp_f32 v156, v156
  v_exp_f32 v157, v157
  v_smfmac_f32_16x16x64_bf16 v[128:131], v[16:19], v[168:175], v20
  v_exp_f32 v158, v158
  v_exp_f32 v159, v159
  v_mfma_f32_32x32x16_bf16 v[136:151], v[228:231], v[28:31], v[136:151]
  s_and_b32 s28, s32, 3
  v_cvt_pk_bf16_f32 v168, v152, v153
  v_cvt_pk_bf16_f32 v169, v154, v155
  v_cvt_pk_bf16_f32 v170, v156, v157
  v_cvt_pk_bf16_f32 v171, v158, v159
  v_exp_f32 v160, v160
  v_exp_f32 v161, v161
  v_exp_f32 v162, v162
  v_exp_f32 v163, v163
  v_mfma_f32_32x32x16_bf16 v[104:119], v[216:219], v[168:171], v[104:119]
  s_cmp_eq_u32 s28, 3
  v_exp_f32 v164, v164
  v_exp_f32 v165, v165
  v_exp_f32 v166, v166
  v_exp_f32 v167, v167
  v_cvt_pk_bf16_f32 v172, v160, v161
  v_cvt_pk_bf16_f32 v173, v162, v163
  v_cvt_pk_bf16_f32 v174, v164, v165
  v_cvt_pk_bf16_f32 v175, v166, v167
  s_cbranch_scc1 .g2_kernel_a_last
  v_mfma_f32_32x32x16_bf16 v[152:167], v[224:227], v[32:35], 0
  s_andn2_b32 s33, s36, s34
  v_exp_f32 v136, v136
  v_exp_f32 v137, v137
  v_exp_f32 v138, v138
  v_mfma_f32_32x32x16_bf16 v[104:119], v[220:223], v[172:175], v[104:119]
  s_cbranch_scc0 .g2_kernel_a_N3c
.g2_kernel_a_N3b:
  v_exp_f32 v139, v139
  v_exp_f32 v140, v140
  v_exp_f32 v141, v141
  v_smfmac_f32_16x16x64_bf16 v[132:135], v[16:19], v[168:175], v20
  s_ff1_i32_b32 s33, s33
  v_exp_f32 v142, v142
  v_exp_f32 v143, v143
  v_mfma_f32_32x32x16_bf16 v[152:167], v[228:231], v[36:39], v[152:167]
  s_bitset1_b32 s34, s33
  v_cvt_pk_bf16_f32 v168, v136, v137
  v_cvt_pk_bf16_f32 v169, v138, v139
  v_cvt_pk_bf16_f32 v170, v140, v141
  v_cvt_pk_bf16_f32 v171, v142, v143
  v_exp_f32 v144, v144
  v_exp_f32 v145, v145
  v_exp_f32 v146, v146
  v_exp_f32 v147, v147
  v_mfma_f32_32x32x16_bf16 v[56:71], v[232:235], v[168:171], v[56:71]
  s_xor_b32 s33, s33, s24
  v_exp_f32 v148, v148
  v_exp_f32 v149, v149
  v_exp_f32 v150, v150
  v_exp_f32 v151, v151
  v_cvt_pk_bf16_f32 v172, v144, v145
  v_cvt_pk_bf16_f32 v173, v146, v147
  v_cvt_pk_bf16_f32 v174, v148, v149
  v_cvt_pk_bf16_f32 v175, v150, v151
  v_mfma_f32_32x32x16_bf16 v[136:151], v[224:227], v[40:43], 0
  s_lshl_b32 s33, s33, s25
  v_exp_f32 v152, v152
  v_exp_f32 v153, v153
  v_exp_f32 v154, v154
  v_mfma_f32_32x32x16_bf16 v[56:71], v[236:239], v[172:175], v[56:71]
  s_add_u32 s22, s20, s33
  v_exp_f32 v155, v155
  v_exp_f32 v156, v156
  v_exp_f32 v157, v157
  v_smfmac_f32_16x16x64_bf16 v[120:123], v[16:19], v[168:175], v20
  s_addc_u32 s23, s21, 0
  v_exp_f32 v158, v158
  v_exp_f32 v159, v159
  v_mfma_f32_32x32x16_bf16 v[136:151], v[228:231], v[44:47], v[136:151]
  v_cvt_pk_bf16_f32 v168, v152, v153
  v_cvt_pk_bf16_f32 v169, v154, v155
  v_cvt_pk_bf16_f32 v170, v156, v157
  v_cvt_pk_bf16_f32 v171, v158, v159
  v_exp_f32 v160, v160
  v_exp_f32 v161, v161
  v_exp_f32 v162, v162
  v_exp_f32 v163, v163
  v_mfma_f32_32x32x16_bf16 v[72:87], v[232:235], v[168:171], v[72:87]
  v_exp_f32 v164, v164
  v_exp_f32 v165, v165
  v_exp_f32 v166, v166
  v_exp_f32 v167, v167
  v_cvt_pk_bf16_f32 v172, v160, v161
  v_cvt_pk_bf16_f32 v173, v162, v163
  v_cvt_pk_bf16_f32 v174, v164, v165
  v_cvt_pk_bf16_f32 v175, v166, v167
  v_mfma_f32_32x32x16_bf16 v[152:167], v[224:227], v[48:51], 0
  v_exp_f32 v136, v136
  v_exp_f32 v137, v137
  v_exp_f32 v138, v138
  v_mfma_f32_32x32x16_bf16 v[72:87], v[236:239], v[172:175], v[72:87]
  v_exp_f32 v139, v139
  v_exp_f32 v140, v140
  v_exp_f32 v141, v141
  v_smfmac_f32_16x16x64_bf16 v[124:127], v[16:19], v[168:175], v20
  global_load_dwordx4 v[208:211], v3, s[22:23] offset:0
  global_load_dwordx4 v[212:215], v3, s[22:23] offset:1024
  global_load_dwordx4 v[216:219], v3, s[22:23] offset:2048
  global_load_dwordx4 v[220:223], v3, s[22:23] offset:3072
  v_exp_f32 v142, v142
  v_exp_f32 v143, v143
  v_mfma_f32_32x32x16_bf16 v[152:167], v[228:231], v[52:55], v[152:167]
  v_cvt_pk_bf16_f32 v168, v136, v137
  v_cvt_pk_bf16_f32 v169, v138, v139
  v_cvt_pk_bf16_f32 v170, v140, v141
  v_cvt_pk_bf16_f32 v171, v142, v143
  v_exp_f32 v144, v144
  v_exp_f32 v145, v145
  v_exp_f32 v146, v146
  v_exp_f32 v147, v147
  v_mfma_f32_32x32x16_bf16 v[88:103], v[232:235], v[168:171], v[88:103]
  s_waitcnt vmcnt(8)
  v_exp_f32 v148, v148
  v_exp_f32 v149, v149
  v_exp_f32 v150, v150
  v_exp_f32 v151, v151
  v_cvt_pk_bf16_f32 v172, v144, v145
  v_cvt_pk_bf16_f32 v173, v146, v147
  v_cvt_pk_bf16_f32 v174, v148, v149
  v_cvt_pk_bf16_f32 v175, v150, v151
  v_mfma_f32_32x32x16_bf16 v[136:151], v[176:179], v[24:27], 0
  v_exp_f32 v152, v152
  v_exp_f32 v153, v153
  v_exp_f32 v154, v154
  v_mfma_f32_32x32x16_bf16 v[88:103], v[236:239], v[172:175], v[88:103]
  v_exp_f32 v155, v155
  v_exp_f32 v156, v156
  v_exp_f32 v157, v157
  v_smfmac_f32_16x16x64_bf16 v[128:131], v[16:19], v[168:175], v20
  v_exp_f32 v158, v158
  v_exp_f32 v159, v159
  v_mfma_f32_32x32x16_bf16 v[136:151], v[180:183], v[28:31], v[136:151]
  s_add_u32 s32, s32, 1
  v_cvt_pk_bf16_f32 v168, v152, v153
  v_cvt_pk_bf16_f32 v169, v154, v155
  v_cvt_pk_bf16_f32 v170, v156, v157
  v_cvt_pk_bf16_f32 v171, v158, v159
  v_exp_f32 v160, v160
  v_exp_f32 v161, v161
  v_exp_f32 v162, v162
  v_exp_f32 v163, v163
  v_mfma_f32_32x32x16_bf16 v[104:119], v[232:235], v[168:171], v[104:119]
  s_cmp_eq_u32 s35, 0
  v_exp_f32 v164, v164
  v_exp_f32 v165, v165
  v_exp_f32 v166, v166
  v_exp_f32 v167, v167
  v_cvt_pk_bf16_f32 v172, v160, v161
  v_cvt_pk_bf16_f32 v173, v162, v163
  v_cvt_pk_bf16_f32 v174, v164, v165
  v_cvt_pk_bf16_f32 v175, v166, v167
  s_cbranch_scc1 .g2_kernel_a_loop
  s_branch .g2_kernel_a_redo
.g2_kernel_a_last:
  v_mfma_f32_32x32x16_bf16 v[152:167], v[224:227], v[32:35], 0
  ds_read_b32 v21, v13 offset:8
  s_andn2_b32 s33, s36, s34
  v_exp_f32 v136, v136
  v_exp_f32 v137, v137
  v_exp_f32 v138, v138
  v_mfma_f32_32x32x16_bf16 v[104:119], v[220:223], v[172:175], v[104:119]
  s_cbranch_scc0 .g2_kernel_a_L3c
.g2_kernel_a_L3b:
  v_exp_f32 v139, v139
  v_exp_f32 v140, v140
  v_exp_f32 v141, v141
  v_smfmac_f32_16x16x64_bf16 v[132:135], v[16:19], v[168:175], v20
  s_ff1_i32_b32 s33, s33
  v_exp_f32 v142, v142
  v_exp_f32 v143, v143
  v_mfma_f32_32x32x16_bf16 v[152:167], v[228:231], v[36:39], v[152:167]
  s_bitset1_b32 s34, s33
  ds_read_b128 v[24:27], v14 offset:0
  v_cvt_pk_bf16_f32 v168, v136, v137
  v_cvt_pk_bf16_f32 v169, v138, v139
  v_cvt_pk_bf16_f32 v170, v140, v141
  v_cvt_pk_bf16_f32 v171, v142, v143
  v_exp_f32 v144, v144
  v_exp_f32 v145, v145
  v_exp_f32 v146, v146
  v_exp_f32 v147, v147
  v_mfma_f32_32x32x16_bf16 v[56:71], v[232:235], v[168:171], v[56:71]
  s_xor_b32 s33, s33, s24
  ds_read_b128 v[28:31], v14 offset:1024
  v_exp_f32 v148, v148
  v_exp_f32 v149, v149
  v_exp_f32 v150, v150
  v_exp_f32 v151, v151
  v_cvt_pk_bf16_f32 v172, v144, v145
  v_cvt_pk_bf16_f32 v173, v146, v147
  v_cvt_pk_bf16_f32 v174, v148, v149
  v_cvt_pk_bf16_f32 v175, v150, v151
  v_mfma_f32_32x32x16_bf16 v[136:151], v[224:227], v[40:43], 0
  s_waitcnt lgkmcnt(2)
  s_lshl_b32 s33, s33, s25
  v_exp_f32 v152, v152
  v_exp_f32 v153, v153
  v_exp_f32 v154, v154
  v_mfma_f32_32x32x16_bf16 v[56:71], v[236:239], v[172:175], v[56:71]
  v_cmp_gt_u32 vcc, s27, v21
  s_add_u32 s22, s20, s33
  v_exp_f32 v155, v155
  v_exp_f32 v156, v156
  v_exp_f32 v157, v157
  v_smfmac_f32_16x16x64_bf16 v[120:123], v[16:19], v[168:175], v20
  s_addc_u32 s23, s21, 0
  v_exp_f32 v158, v158
  v_exp_f32 v159, v159
  v_mfma_f32_32x32x16_bf16 v[136:151], v[228:231], v[44:47], v[136:151]
  v_cvt_pk_bf16_f32 v168, v152, v153
  v_cvt_pk_bf16_f32 v169, v154, v155
  v_cvt_pk_bf16_f32 v170, v156, v157
  v_cvt_pk_bf16_f32 v171, v158, v159
  v_exp_f32 v160, v160
  v_exp_f32 v161, v161
  v_exp_f32 v162, v162
  v_exp_f32 v163, v163
  v_mfma_f32_32x32x16_bf16 v[72:87], v[232:235], v[168:171], v[72:87]
  s_cbranch_vccnz .g2_kernel_a_L3g
.g2_kernel_a_L3h:
  ds_read_b128 v[32:35], v14 offset:2048
  ds_read_b128 v[36:39], v14 offset:3072
  ds_write_b128 v9, v[56:59] offset:0
  v_add_f32 v6, v120, v121
  ds_write_b128 v9, v[60:63] offset:1024
  v_mov_b32 v120, 0
  v_exp_f32 v164, v164
  v_exp_f32 v165, v165
  v_exp_f32 v166, v166
  v_exp_f32 v167, v167
  v_cvt_pk_bf16_f32 v172, v160, v161
  v_cvt_pk_bf16_f32 v173, v162, v163
  v_cvt_pk_bf16_f32 v174, v164, v165
  v_cvt_pk_bf16_f32 v175, v166, v167
  v_mfma_f32_32x32x16_bf16 v[152:167], v[224:227], v[48:51], 0
  ds_write_b128 v9, v[64:67] offset:2048
  v_mov_b32 v121, 0
  v_exp_f32 v136, v136
  v_exp_f32 v137, v137
  v_exp_f32 v138, v138
  v_mfma_f32_32x32x16_bf16 v[72:87], v[236:239], v[172:175], v[72:87]
  ds_write_b128 v9, v[68:71] offset:3072
  ds_write_b32 v10, v6 offset:0
  ds_write_b32 v11, v12 offset:0
  v_exp_f32 v139, v139
  v_exp_f32 v140, v140
  v_exp_f32 v141, v141
  v_smfmac_f32_16x16x64_bf16 v[124:127], v[16:19], v[168:175], v20
  global_load_dwordx4 v[208:211], v3, s[22:23] offset:0
  global_load_dwordx4 v[212:215], v3, s[22:23] offset:1024
  global_load_dwordx4 v[216:219], v3, s[22:23] offset:2048
  global_load_dwordx4 v[220:223], v3, s[22:23] offset:3072
  v_exp_f32 v142, v142
  v_exp_f32 v143, v143
  v_mfma_f32_32x32x16_bf16 v[152:167], v[228:231], v[52:55], v[152:167]
  ds_read_b128 v[40:43], v14 offset:4096
  s_wakeup
  v_cvt_pk_bf16_f32 v168, v136, v137
  v_cvt_pk_bf16_f32 v169, v138, v139
  v_cvt_pk_bf16_f32 v170, v140, v141
  v_cvt_pk_bf16_f32 v171, v142, v143
  v_exp_f32 v144, v144
  v_exp_f32 v145, v145
  v_exp_f32 v146, v146
  v_exp_f32 v147, v147
  v_mfma_f32_32x32x16_bf16 v[88:103], v[232:235], v[168:171], v[88:103]
  s_waitcnt vmcnt(8)
  ds_read_b128 v[44:47], v14 offset:5120
  ds_write_b128 v9, v[72:75] offset:16384
  v_add_f32 v6, v124, v125
  ds_write_b128 v9, v[76:79] offset:17408
  v_mov_b32 v124, 0
  v_exp_f32 v148, v148
  v_exp_f32 v149, v149
  v_exp_f32 v150, v150
  v_exp_f32 v151, v151
  v_cvt_pk_bf16_f32 v172, v144, v145
  v_cvt_pk_bf16_f32 v173, v146, v147
  v_cvt_pk_bf16_f32 v174, v148, v149
  v_cvt_pk_bf16_f32 v175, v150, v151
  s_waitcnt lgkmcnt(12)
  v_mfma_f32_32x32x16_bf16 v[136:151], v[176:179], v[24:27], 0
  ds_write_b128 v9, v[80:83] offset:18432
  v_mov_b32 v125, 0
  v_exp_f32 v152, v152
  v_exp_f32 v153, v153
  v_exp_f32 v154, v154
  v_mfma_f32_32x32x16_bf16 v[88:103], v[236:239], v[172:175], v[88:103]
  ds_write_b128 v9, v[84:87] offset:19456
  ds_write_b32 v10, v6 offset:512
  ds_write_b32 v11, v12 offset:16
  v_exp_f32 v155, v155
  v_exp_f32 v156, v156
  v_exp_f32 v157, v157
  v_smfmac_f32_16x16x64_bf16 v[128:131], v[16:19], v[168:175], v20
  v_exp_f32 v158, v158
  v_exp_f32 v159, v159
  v_mfma_f32_32x32x16_bf16 v[136:151], v[180:183], v[28:31], v[136:151]
  ds_read_b128 v[48:51], v14 offset:6144
  v_cvt_pk_bf16_f32 v168, v152, v153
  v_cvt_pk_bf16_f32 v169, v154, v155
  v_cvt_pk_bf16_f32 v170, v156, v157
  v_cvt_pk_bf16_f32 v171, v158, v159
  v_exp_f32 v160, v160
  v_exp_f32 v161, v161
  v_exp_f32 v162, v162
  v_exp_f32 v163, v163
  v_mfma_f32_32x32x16_bf16 v[104:119], v[232:235], v[168:171], v[104:119]
  ds_read_b128 v[52:55], v14 offset:7168
  ds_write_b128 v9, v[88:91] offset:32768
  v_add_f32 v6, v128, v129
  ds_write_b128 v9, v[92:95] offset:33792
  v_mov_b32 v128, 0
  ds_write_b128 v9, v[96:99] offset:34816
  v_mov_b32 v129, 0
  ds_write_b128 v9, v[100:103] offset:35840
  ds_write_b32 v10, v6 offset:1024
  ds_write_b32 v11, v12 offset:32
  s_add_u32 s32, s32, 1
  v_exp_f32 v164, v164
  v_exp_f32 v165, v165
  v_exp_f32 v166, v166
  v_exp_f32 v167, v167
  v_cvt_pk_bf16_f32 v172, v160, v161
  v_cvt_pk_bf16_f32 v173, v162, v163
  v_cvt_pk_bf16_f32 v174, v164, v165
  v_cvt_pk_bf16_f32 v175, v166, v167
  s_cmp_eq_u32 s32, 8
  s_cbranch_scc1 .g2_kernel_a_end
  s_waitcnt lgkmcnt(15)
  v_mfma_f32_32x32x16_bf16 v[152:167], v[176:179], v[32:35], 0
  s_andn2_b32 s33, s36, s34
  v_exp_f32 v136, v136
  v_exp_f32 v137, v137
  v_exp_f32 v138, v138
  v_mfma_f32_32x32x16_bf16 v[104:119], v[236:239], v[172:175], v[104:119]
  s_cbranch_scc0 .g2_kernel_a_G0c
.g2_kernel_a_G0b:
  v_exp_f32 v139, v139
  v_exp_f32 v140, v140
  v_exp_f32 v141, v141
  v_smfmac_f32_16x16x64_bf16 v[132:135], v[16:19], v[168:175], v20
  s_ff1_i32_b32 s33, s33
  v_exp_f32 v142, v142
  v_exp_f32 v143, v143
  v_mfma_f32_32x32x16_bf16 v[152:167], v[180:183], v[36:39], v[152:167]
  s_bitset1_b32 s34, s33
  v_cvt_pk_bf16_f32 v168, v136, v137
  v_cvt_pk_bf16_f32 v169, v138, v139
  v_cvt_pk_bf16_f32 v170, v140, v141
  v_cvt_pk_bf16_f32 v171, v142, v143
  v_exp_f32 v144, v144
  v_exp_f32 v145, v145
  v_exp_f32 v146, v146
  v_exp_f32 v147, v147
  s_waitcnt lgkmcnt(15)
  v_mfma_f32_32x32x16_bf16 v[56:71], v[184:187], v[168:171], 0
  s_xor_b32 s33, s33, s24
  ds_write_b128 v9, v[104:107] offset:49152
  v_add_f32 v6, v132, v133
  v_exp_f32 v148, v148
  v_exp_f32 v149, v149
  v_exp_f32 v150, v150
  v_exp_f32 v151, v151
  v_cvt_pk_bf16_f32 v172, v144, v145
  v_cvt_pk_bf16_f32 v173, v146, v147
  v_cvt_pk_bf16_f32 v174, v148, v149
  v_cvt_pk_bf16_f32 v175, v150, v151
  s_waitcnt lgkmcnt(15)
  v_mfma_f32_32x32x16_bf16 v[136:151], v[176:179], v[40:43], 0
  s_lshl_b32 s33, s33, s25
  ds_write_b128 v9, v[108:111] offset:50176
  v_mov_b32 v132, 0
  v_exp_f32 v152, v152
  v_exp_f32 v153, v153
  v_exp_f32 v154, v154
  v_mfma_f32_32x32x16_bf16 v[56:71], v[188:191], v[172:175], v[56:71]
  s_add_u32 s22, s20, s33
  ds_write_b128 v9, v[112:115] offset:51200
  v_mov_b32 v133, 0
  v_exp_f32 v155, v155
  v_exp_f32 v156, v156
  v_exp_f32 v157, v157
  v_smfmac_f32_16x16x64_bf16 v[120:123], v[16:19], v[168:175], v20
  s_addc_u32 s23, s21, 0
  ds_write_b128 v9, v[116:119] offset:52224
  v_exp_f32 v158, v158
  v_exp_f32 v159, v159
  v_mfma_f32_32x32x16_bf16 v[136:151], v[180:183], v[44:47], v[136:151]
  v_cvt_pk_bf16_f32 v168, v152, v153
  v_cvt_pk_bf16_f32 v169, v154, v155
  v_cvt_pk_bf16_f32 v170, v156, v157
  v_cvt_pk_bf16_f32 v171, v158, v159
  v_exp_f32 v160, v160
  v_exp_f32 v161, v161
  v_exp_f32 v162, v162
  v_exp_f32 v163, v163
  s_waitcnt lgkmcnt(14)
  v_mfma_f32_32x32x16_bf16 v[72:87], v[184:187], v[168:171], 0
  ds_write_b32 v10, v6 offset:1536
  ds_write_b32 v11, v12 offset:48
  v_exp_f32 v164, v164
  v_exp_f32 v165, v165
  v_exp_f32 v166, v166
  v_exp_f32 v167, v167
  v_cvt_pk_bf16_f32 v172, v160, v161
  v_cvt_pk_bf16_f32 v173, v162, v163
  v_cvt_pk_bf16_f32 v174, v164, v165
  v_cvt_pk_bf16_f32 v175, v166, v167
  s_waitcnt lgkmcnt(12)
  v_mfma_f32_32x32x16_bf16 v[152:167], v[176:179], v[48:51], 0
  v_add_u32 v12, 1, v12
  v_exp_f32 v136, v136
  v_exp_f32 v137, v137
  v_exp_f32 v138, v138
  v_mfma_f32_32x32x16_bf16 v[72:87], v[188:191], v[172:175], v[72:87]
  v_exp_f32 v139, v139
  v_exp_f32 v140, v140
  v_exp_f32 v141, v141
  v_smfmac_f32_16x16x64_bf16 v[124:127], v[16:19], v[168:175], v20
  global_load_dwordx4 v[224:227], v3, s[22:23] offset:0
  global_load_dwordx4 v[228:231], v3, s[22:23] offset:1024
  global_load_dwordx4 v[232:235], v3, s[22:23] offset:2048
  global_load_dwordx4 v[236:239], v3, s[22:23] offset:3072
  s_add_u32 s27, s27, 4
  v_exp_f32 v142, v142
  v_exp_f32 v143, v143
  v_mfma_f32_32x32x16_bf16 v[152:167], v[180:183], v[52:55], v[152:167]
  v_cvt_pk_bf16_f32 v168, v136, v137
  v_cvt_pk_bf16_f32 v169, v138, v139
  v_cvt_pk_bf16_f32 v170, v140, v141
  v_cvt_pk_bf16_f32 v171, v142, v143
  v_exp_f32 v144, v144
  v_exp_f32 v145, v145
  v_exp_f32 v146, v146
  v_exp_f32 v147, v147
  s_waitcnt lgkmcnt(8)
  v_mfma_f32_32x32x16_bf16 v[88:103], v[184:187], v[168:171], 0
  s_waitcnt vmcnt(8)
  v_exp_f32 v148, v148
  v_exp_f32 v149, v149
  v_exp_f32 v150, v150
  v_exp_f32 v151, v151
  v_cvt_pk_bf16_f32 v172, v144, v145
  v_cvt_pk_bf16_f32 v173, v146, v147
  v_cvt_pk_bf16_f32 v174, v148, v149
  v_cvt_pk_bf16_f32 v175, v150, v151
  v_mfma_f32_32x32x16_bf16 v[136:151], v[192:195], v[24:27], 0
  v_exp_f32 v152, v152
  v_exp_f32 v153, v153
  v_exp_f32 v154, v154
  v_mfma_f32_32x32x16_bf16 v[88:103], v[188:191], v[172:175], v[88:103]
  v_exp_f32 v155, v155
  v_exp_f32 v156, v156
  v_exp_f32 v157, v157
  v_smfmac_f32_16x16x64_bf16 v[128:131], v[16:19], v[168:175], v20
  v_exp_f32 v158, v158
  v_exp_f32 v159, v159
  v_mfma_f32_32x32x16_bf16 v[136:151], v[196:199], v[28:31], v[136:151]
  v_cvt_pk_bf16_f32 v168, v152, v153
  v_cvt_pk_bf16_f32 v169, v154, v155
  v_cvt_pk_bf16_f32 v170, v156, v157
  v_cvt_pk_bf16_f32 v171, v158, v159
  v_exp_f32 v160, v160
  v_exp_f32 v161, v161
  v_exp_f32 v162, v162
  v_exp_f32 v163, v163
  s_waitcnt lgkmcnt(2)
  v_mfma_f32_32x32x16_bf16 v[104:119], v[184:187], v[168:171], 0
  v_exp_f32 v164, v164
  v_exp_f32 v165, v165
  v_exp_f32 v166, v166
  v_exp_f32 v167, v167
  v_cvt_pk_bf16_f32 v172, v160, v161
  v_cvt_pk_bf16_f32 v173, v162, v163
  v_cvt_pk_bf16_f32 v174, v164, v165
  v_cvt_pk_bf16_f32 v175, v166, v167
  s_branch .g2_kernel_a_n1
.g2_kernel_a_end:
  v_mfma_f32_32x32x16_bf16 v[104:119], v[236:239], v[172:175], v[104:119]
  v_smfmac_f32_16x16x64_bf16 v[132:135], v[16:19], v[168:175], v20
  s_nop 10
  ds_write_b128 v9, v[104:107] offset:49152
  v_add_f32 v6, v132, v133
  ds_write_b128 v9, v[108:111] offset:50176
  v_mov_b32 v132, 0
  ds_write_b128 v9, v[112:115] offset:51200
  v_mov_b32 v133, 0
  ds_write_b128 v9, v[116:119] offset:52224
  ds_write_b32 v10, v6 offset:1536
  ds_write_b32 v11, v12 offset:48
  s_waitcnt lgkmcnt(6)
  v_mov_b32 v20, s71
  v_lshrrev_b32 v17, 5, v2
  v_and_b32 v18, 31, v2
  s_lshl_b32 s28, s16, 5
  v_add_u32 v19, s28, v18
  v_lshlrev_b32 v7, 2, v19
  v_add_u32 v7, 155648, v7
  ds_read_b32 v8, v7 offset:3840
  ds_read_b32 v9, v7 offset:4352
  ds_read_b32 v16, v20 offset:24
  ds_read_b32 v6, v20 offset:52
  v_add_u32 v19, 1, v19
  v_bfe_u32 v7, v2, 2, 2
  v_lshl_add_u32 v14, v17, 2, v7
  v_lshlrev_b32 v14, 7, v14
  v_lshrrev_b32 v7, 1, v7
  v_lshl_add_u32 v14, v7, 6, v14
  v_bfe_u32 v7, v2, 4, 1
  v_lshl_add_u32 v14, v7, 5, v14
  v_and_b32 v7, 1, v2
  v_lshl_add_u32 v14, v7, 4, v14
  v_bfe_u32 v7, v2, 1, 1
  v_lshl_add_u32 v14, v7, 3, v14
  v_xor_b32 v15, 64, v14
  v_and_b32 v7, 7, v2
  v_xor_b32 v7, s24, v7
  s_lshl_b32 s28, s16, 6
  s_add_u32 s28, s28, 157952
  v_lshl_add_u32 v21, v7, 3, s28
  v_lshlrev_b32 v24, 16, v240
  v_and_b32 v25, 0xffff0000, v240
  v_lshlrev_b32 v26, 16, v241
  v_and_b32 v27, 0xffff0000, v241
  v_lshlrev_b32 v28, 16, v242
  v_and_b32 v29, 0xffff0000, v242
  v_lshlrev_b32 v30, 16, v243
  v_and_b32 v31, 0xffff0000, v243
  v_lshlrev_b32 v32, 16, v244
  v_and_b32 v33, 0xffff0000, v244
  v_lshlrev_b32 v34, 16, v245
  v_and_b32 v35, 0xffff0000, v245
  v_lshlrev_b32 v36, 16, v246
  v_and_b32 v37, 0xffff0000, v246
  v_lshlrev_b32 v38, 16, v247
  v_and_b32 v39, 0xffff0000, v247
  v_lshlrev_b32 v40, 16, v248
  v_and_b32 v41, 0xffff0000, v248
  v_lshlrev_b32 v42, 16, v249
  v_and_b32 v43, 0xffff0000, v249
  v_lshlrev_b32 v44, 16, v250
  v_and_b32 v45, 0xffff0000, v250
  v_lshlrev_b32 v46, 16, v251
  v_and_b32 v47, 0xffff0000, v251
  v_lshlrev_b32 v48, 16, v252
  v_and_b32 v49, 0xffff0000, v252
  v_lshlrev_b32 v50, 16, v253
  v_and_b32 v51, 0xffff0000, v253
  v_lshlrev_b32 v52, 16, v254
  v_and_b32 v53, 0xffff0000, v254
  v_lshlrev_b32 v54, 16, v255
  v_and_b32 v55, 0xffff0000, v255
  s_waitcnt lgkmcnt(0)
  v_cmp_gt_u32 vcc, 4, v6
  s_cbranch_vccnz .g2_kernel_w_aw
.g2_kernel_w_ab:
  s_xor_b32 s28, s24, 0
  s_lshl_b32 s28, s28, 13
  s_add_u32 s28, s28, 65536
  v_add_u32 v10, s28, v14
  v_add_u32 v11, s28, v15
  ds_read_b64_tr_b16 v[104:105], v10 offset:0
  ds_read_b64_tr_b16 v[106:107], v10 offset:1024
  ds_read_b64_tr_b16 v[108:109], v11 offset:0
  ds_read_b64_tr_b16 v[110:111], v11 offset:1024
  ds_read_b64_tr_b16 v[112:113], v10 offset:2048
  ds_read_b64_tr_b16 v[114:115], v10 offset:3072
  ds_read_b64_tr_b16 v[116:117], v11 offset:2048
  ds_read_b64_tr_b16 v[118:119], v11 offset:3072
  ds_read_b64_tr_b16 v[120:121], v10 offset:4096
  ds_read_b64_tr_b16 v[122:123], v10 offset:5120
  ds_read_b64_tr_b16 v[124:125], v11 offset:4096
  ds_read_b64_tr_b16 v[126:127], v11 offset:5120
  s_andn2_b32 s33, s36, s34
  s_ff1_i32_b32 s33, s33
  s_bitset1_b32 s34, s33
  s_xor_b32 s33, s33, s24
  s_lshl_b32 s33, s33, 12
  s_add_u32 s22, s20, s33
  s_addc_u32 s23, s21, 0
  global_load_dwordx4 v[224:227], v3, s[22:23] offset:0
  global_load_dwordx4 v[228:231], v3, s[22:23] offset:1024
  global_load_dwordx4 v[232:235], v3, s[22:23] offset:2048
  global_load_dwordx4 v[236:239], v3, s[22:23] offset:3072
  v_pk_fma_f32 v[24:25], v[24:25], v[8:9], v[8:9] op_sel:[0,0,1] op_sel_hi:[1,0,1]
  v_pk_fma_f32 v[26:27], v[26:27], v[8:9], v[8:9] op_sel:[0,0,1] op_sel_hi:[1,0,1]
  v_pk_fma_f32 v[28:29], v[28:29], v[8:9], v[8:9] op_sel:[0,0,1] op_sel_hi:[1,0,1]
  v_pk_fma_f32 v[30:31], v[30:31], v[8:9], v[8:9] op_sel:[0,0,1] op_sel_hi:[1,0,1]
  v_pk_fma_f32 v[32:33], v[32:33], v[8:9], v[8:9] op_sel:[0,0,1] op_sel_hi:[1,0,1]
  v_pk_fma_f32 v[34:35], v[34:35], v[8:9], v[8:9] op_sel:[0,0,1] op_sel_hi:[1,0,1]
  v_pk_fma_f32 v[36:37], v[36:37], v[8:9], v[8:9] op_sel:[0,0,1] op_sel_hi:[1,0,1]
  v_pk_fma_f32 v[38:39], v[38:39], v[8:9], v[8:9] op_sel:[0,0,1] op_sel_hi:[1,0,1]
  v_pk_fma_f32 v[40:41], v[40:41], v[8:9], v[8:9] op_sel:[0,0,1] op_sel_hi:[1,0,1]
  v_pk_fma_f32 v[42:43], v[42:43], v[8:9], v[8:9] op_sel:[0,0,1] op_sel_hi:[1,0,1]
  v_pk_fma_f32 v[44:45], v[44:45], v[8:9], v[8:9] op_sel:[0,0,1] op_sel_hi:[1,0,1]
  v_pk_fma_f32 v[46:47], v[46:47], v[8:9], v[8:9] op_sel:[0,0,1] op_sel_hi:[1,0,1]
  v_pk_fma_f32 v[48:49], v[48:49], v[8:9], v[8:9] op_sel:[0,0,1] op_sel_hi:[1,0,1]
  v_pk_fma_f32 v[50:51], v[50:51], v[8:9], v[8:9] op_sel:[0,0,1] op_sel_hi:[1,0,1]
  v_pk_fma_f32 v[52:53], v[52:53], v[8:9], v[8:9] op_sel:[0,0,1] op_sel_hi:[1,0,1]
  v_pk_fma_f32 v[54:55], v[54:55], v[8:9], v[8:9] op_sel:[0,0,1] op_sel_hi:[1,0,1]
  v_cmp_eq_u32 vcc, v16, v19
  s_cbranch_vccnz .g2_kernel_w_pt
.g2_kernel_w_pb:
  s_mov_b32 s72, s48
  s_mov_b32 s73, s49
  s_mov_b32 s74, 0x800
  s_mov_b32 s75, 0x00020000
  s_waitcnt vmcnt(15) lgkmcnt(8)
  v_mfma_f32_32x32x16_bf16 v[24:39], v[104:107], v[176:179], v[24:39]
  s_xor_b32 s28, s24, 1
  s_lshl_b32 s28, s28, 13
  s_add_u32 s28, s28, 65536
  ds_read_b64_tr_b16 v[128:129], v10 offset:6144
  ds_read_b64_tr_b16 v[130:131], v10 offset:7168
  v_mfma_f32_32x32x16_bf16 v[40:55], v[108:111], v[176:179], v[40:55]
  v_add_u32 v12, s28, v14
  v_add_u32 v13, s28, v15
  s_andn2_b32 s33, s36, s34
  ds_read_b64_tr_b16 v[132:133], v11 offset:6144
  ds_read_b64_tr_b16 v[134:135], v11 offset:7168
  s_waitcnt vmcnt(14) lgkmcnt(8)
  v_mfma_f32_32x32x16_bf16 v[24:39], v[112:115], v[180:183], v[24:39]
  s_ff1_i32_b32 s33, s33
  s_bitset1_b32 s34, s33
  s_xor_b32 s33, s33, s24
  ds_read_b64_tr_b16 v[104:105], v12 offset:0
  ds_read_b64_tr_b16 v[106:107], v12 offset:1024
  v_mfma_f32_32x32x16_bf16 v[40:55], v[116:119], v[180:183], v[40:55]
  s_lshl_b32 s33, s33, 12
  s_add_u32 s22, s20, s33
  s_addc_u32 s23, s21, 0
  ds_read_b64_tr_b16 v[108:109], v13 offset:0
  ds_read_b64_tr_b16 v[110:111], v13 offset:1024
  s_waitcnt vmcnt(13) lgkmcnt(8)
  v_mfma_f32_32x32x16_bf16 v[24:39], v[120:123], v[184:187], v[24:39]
  global_load_dwordx4 v[136:139], v3, s[22:23] offset:0
  global_load_dwordx4 v[140:143], v3, s[22:23] offset:1024
  global_load_dwordx4 v[144:147], v3, s[22:23] offset:2048
  ds_read_b64_tr_b16 v[112:113], v12 offset:2048
  ds_read_b64_tr_b16 v[114:115], v12 offset:3072
  v_mfma_f32_32x32x16_bf16 v[40:55], v[124:127], v[184:187], v[40:55]
  global_load_dwordx4 v[148:151], v3, s[22:23] offset:3072
  ds_read_b64_tr_b16 v[116:117], v13 offset:2048
  ds_read_b64_tr_b16 v[118:119], v13 offset:3072
  s_waitcnt vmcnt(16) lgkmcnt(8)
  v_mfma_f32_32x32x16_bf16 v[24:39], v[128:131], v[188:191], v[24:39]
  ds_read_b64_tr_b16 v[120:121], v12 offset:4096
  ds_read_b64_tr_b16 v[122:123], v12 offset:5120
  v_mfma_f32_32x32x16_bf16 v[40:55], v[132:135], v[188:191], v[40:55]
  ds_read_b64_tr_b16 v[124:125], v13 offset:4096
  ds_read_b64_tr_b16 v[126:127], v13 offset:5120
  s_waitcnt vmcnt(15) lgkmcnt(8)
  v_mfma_f32_32x32x16_bf16 v[24:39], v[104:107], v[192:195], v[24:39]
  s_xor_b32 s28, s24, 2
  s_lshl_b32 s28, s28, 13
  s_add_u32 s28, s28, 65536
  ds_read_b64_tr_b16 v[128:129], v12 offset:6144
  ds_read_b64_tr_b16 v[130:131], v12 offset:7168
  v_mfma_f32_32x32x16_bf16 v[40:55], v[108:111], v[192:195], v[40:55]
  v_add_u32 v10, s28, v14
  v_add_u32 v11, s28, v15
  s_andn2_b32 s33, s36, s34
  ds_read_b64_tr_b16 v[132:133], v13 offset:6144
  ds_read_b64_tr_b16 v[134:135], v13 offset:7168
  s_waitcnt vmcnt(14) lgkmcnt(8)
  v_mfma_f32_32x32x16_bf16 v[24:39], v[112:115], v[196:199], v[24:39]
  s_ff1_i32_b32 s33, s33
  s_bitset1_b32 s34, s33
  s_xor_b32 s33, s33, s24
  ds_read_b64_tr_b16 v[104:105], v10 offset:0
  ds_read_b64_tr_b16 v[106:107], v10 offset:1024
  v_mfma_f32_32x32x16_bf16 v[40:55], v[116:119], v[196:199], v[40:55]
  s_lshl_b32 s33, s33, 12
  s_add_u32 s22, s20, s33
  s_addc_u32 s23, s21, 0
  ds_read_b64_tr_b16 v[108:109], v11 offset:0
  ds_read_b64_tr_b16 v[110:111], v11 offset:1024
  s_waitcnt vmcnt(13) lgkmcnt(8)
  v_mfma_f32_32x32x16_bf16 v[24:39], v[120:123], v[200:203], v[24:39]
  global_load_dwordx4 v[152:155], v3, s[22:23] offset:0
  global_load_dwordx4 v[156:159], v3, s[22:23] offset:1024
  global_load_dwordx4 v[160:163], v3, s[22:23] offset:2048
  ds_read_b64_tr_b16 v[112:113], v10 offset:2048
  ds_read_b64_tr_b16 v[114:115], v10 offset:3072
  v_mfma_f32_32x32x16_bf16 v[40:55], v[124:127], v[200:203], v[40:55]
  global_load_dwordx4 v[164:167], v3, s[22:23] offset:3072
  ds_read_b64_tr_b16 v[116:117], v11 offset:2048
  ds_read_b64_tr_b16 v[118:119], v11 offset:3072
  s_waitcnt vmcnt(16) lgkmcnt(8)
  v_mfma_f32_32x32x16_bf16 v[24:39], v[128:131], v[204:207], v[24:39]
  ds_read_b64_tr_b16 v[120:121], v10 offset:4096
  ds_read_b64_tr_b16 v[122:123], v10 offset:5120
  v_mfma_f32_32x32x16_bf16 v[40:55], v[132:135], v[204:207], v[40:55]
  ds_read_b64_tr_b16 v[124:125], v11 offset:4096
  ds_read_b64_tr_b16 v[126:127], v11 offset:5120
  s_waitcnt vmcnt(15) lgkmcnt(8)
  v_mfma_f32_32x32x16_bf16 v[24:39], v[104:107], v[208:211], v[24:39]
  s_xor_b32 s28, s24, 3
  s_lshl_b32 s28, s28, 13
  s_add_u32 s28, s28, 65536
  ds_read_b64_tr_b16 v[128:129], v10 offset:6144
  ds_read_b64_tr_b16 v[130:131], v10 offset:7168
  v_mfma_f32_32x32x16_bf16 v[40:55], v[108:111], v[208:211], v[40:55]
  v_add_u32 v12, s28, v14
  v_add_u32 v13, s28, v15
  s_andn2_b32 s33, s36, s34
  ds_read_b64_tr_b16 v[132:133], v11 offset:6144
  ds_read_b64_tr_b16 v[134:135], v11 offset:7168
  s_waitcnt vmcnt(14) lgkmcnt(8)
  v_mfma_f32_32x32x16_bf16 v[24:39], v[112:115], v[212:215], v[24:39]
  s_ff1_i32_b32 s33, s33
  s_bitset1_b32 s34, s33
  s_xor_b32 s33, s33, s24
  ds_read_b64_tr_b16 v[104:105], v12 offset:0
  ds_read_b64_tr_b16 v[106:107], v12 offset:1024
  v_mfma_f32_32x32x16_bf16 v[40:55], v[116:119], v[212:215], v[40:55]
  s_lshl_b32 s33, s33, 12
  s_add_u32 s22, s20, s33
  s_addc_u32 s23, s21, 0
  ds_read_b64_tr_b16 v[108:109], v13 offset:0
  ds_read_b64_tr_b16 v[110:111], v13 offset:1024
  s_waitcnt vmcnt(13) lgkmcnt(8)
  v_mfma_f32_32x32x16_bf16 v[24:39], v[120:123], v[216:219], v[24:39]
  global_load_dwordx4 v[56:59], v3, s[22:23] offset:0
  global_load_dwordx4 v[60:63], v3, s[22:23] offset:1024
  global_load_dwordx4 v[64:67], v3, s[22:23] offset:2048
  ds_read_b64_tr_b16 v[112:113], v12 offset:2048
  ds_read_b64_tr_b16 v[114:115], v12 offset:3072
  v_mfma_f32_32x32x16_bf16 v[40:55], v[124:127], v[216:219], v[40:55]
  global_load_dwordx4 v[68:71], v3, s[22:23] offset:3072
  ds_read_b64_tr_b16 v[116:117], v13 offset:2048
  ds_read_b64_tr_b16 v[118:119], v13 offset:3072
  s_waitcnt vmcnt(16) lgkmcnt(8)
  v_mfma_f32_32x32x16_bf16 v[24:39], v[128:131], v[220:223], v[24:39]
  ds_read_b64_tr_b16 v[120:121], v12 offset:4096
  ds_read_b64_tr_b16 v[122:123], v12 offset:5120
  v_mfma_f32_32x32x16_bf16 v[40:55], v[132:135], v[220:223], v[40:55]
  ds_read_b64_tr_b16 v[124:125], v13 offset:4096
  ds_read_b64_tr_b16 v[126:127], v13 offset:5120
  s_waitcnt vmcnt(15) lgkmcnt(8)
  v_mfma_f32_32x32x16_bf16 v[24:39], v[104:107], v[224:227], v[24:39]
  s_xor_b32 s28, s24, 4
  s_lshl_b32 s28, s28, 13
  s_add_u32 s28, s28, 65536
  ds_read_b64_tr_b16 v[128:129], v12 offset:6144
  ds_read_b64_tr_b16 v[130:131], v12 offset:7168
  v_mfma_f32_32x32x16_bf16 v[40:55], v[108:111], v[224:227], v[40:55]
  v_add_u32 v10, s28, v14
  v_add_u32 v11, s28, v15
  s_andn2_b32 s33, s36, s34
  ds_read_b64_tr_b16 v[132:133], v13 offset:6144
  ds_read_b64_tr_b16 v[134:135], v13 offset:7168
  s_waitcnt vmcnt(14) lgkmcnt(8)
  v_mfma_f32_32x32x16_bf16 v[24:39], v[112:115], v[228:231], v[24:39]
  s_ff1_i32_b32 s33, s33
  s_bitset1_b32 s34, s33
  s_xor_b32 s33, s33, s24
  ds_read_b64_tr_b16 v[104:105], v10 offset:0
  ds_read_b64_tr_b16 v[106:107], v10 offset:1024
  v_mfma_f32_32x32x16_bf16 v[40:55], v[116:119], v[228:231], v[40:55]
  s_lshl_b32 s33, s33, 12
  s_add_u32 s22, s20, s33
  s_addc_u32 s23, s21, 0
  ds_read_b64_tr_b16 v[108:109], v11 offset:0
  ds_read_b64_tr_b16 v[110:111], v11 offset:1024
  s_waitcnt vmcnt(13) lgkmcnt(8)
  v_mfma_f32_32x32x16_bf16 v[24:39], v[120:123], v[232:235], v[24:39]
  global_load_dwordx4 v[72:75], v3, s[22:23] offset:0
  global_load_dwordx4 v[76:79], v3, s[22:23] offset:1024
  global_load_dwordx4 v[80:83], v3, s[22:23] offset:2048
  ds_read_b64_tr_b16 v[112:113], v10 offset:2048
  ds_read_b64_tr_b16 v[114:115], v10 offset:3072
  v_mfma_f32_32x32x16_bf16 v[40:55], v[124:127], v[232:235], v[40:55]
  global_load_dwordx4 v[84:87], v3, s[22:23] offset:3072
  ds_read_b64_tr_b16 v[116:117], v11 offset:2048
  ds_read_b64_tr_b16 v[118:119], v11 offset:3072
  s_waitcnt vmcnt(16) lgkmcnt(8)
  v_mfma_f32_32x32x16_bf16 v[24:39], v[128:131], v[236:239], v[24:39]
  ds_read_b64_tr_b16 v[120:121], v10 offset:4096
  ds_read_b64_tr_b16 v[122:123], v10 offset:5120
  v_mfma_f32_32x32x16_bf16 v[40:55], v[132:135], v[236:239], v[40:55]
  ds_read_b64_tr_b16 v[124:125], v11 offset:4096
  ds_read_b64_tr_b16 v[126:127], v11 offset:5120
  s_waitcnt vmcnt(15) lgkmcnt(8)
  v_mfma_f32_32x32x16_bf16 v[24:39], v[104:107], v[136:139], v[24:39]
  s_xor_b32 s28, s24, 5
  s_lshl_b32 s28, s28, 13
  s_add_u32 s28, s28, 65536
  v_add_u32 v12, s28, v14
  ds_read_b64_tr_b16 v[128:129], v10 offset:6144
  ds_read_b64_tr_b16 v[130:131], v10 offset:7168
  v_mfma_f32_32x32x16_bf16 v[40:55], v[108:111], v[136:139], v[40:55]
  v_add_u32 v13, s28, v15
  s_andn2_b32 s33, s36, s34
  s_cbranch_scc0 .g2_kernel_w_i8c
.g2_kernel_w_i8b:
  s_ff1_i32_b32 s33, s33
  ds_read_b64_tr_b16 v[132:133], v11 offset:6144
  ds_read_b64_tr_b16 v[134:135], v11 offset:7168
  s_waitcnt vmcnt(14) lgkmcnt(8)
  v_mfma_f32_32x32x16_bf16 v[24:39], v[112:115], v[140:143], v[24:39]
  s_bitset1_b32 s34, s33
  s_xor_b32 s33, s33, s24
  s_and_b32 s8, s33, 7
  s_cmp_lt_u32 s8, 2
  ds_read_b64_tr_b16 v[104:105], v12 offset:0
  ds_read_b64_tr_b16 v[106:107], v12 offset:1024
  v_mfma_f32_32x32x16_bf16 v[40:55], v[116:119], v[140:143], v[40:55]
  s_cselect_b32 s28, 139264, 0
  s_lshl_b32 s8, s8, 13
  s_add_u32 s8, s8, s28
  s_lshl_b32 s33, s33, 12
  ds_read_b64_tr_b16 v[108:109], v13 offset:0
  ds_read_b64_tr_b16 v[110:111], v13 offset:1024
  s_waitcnt vmcnt(13) lgkmcnt(8)
  v_mfma_f32_32x32x16_bf16 v[24:39], v[120:123], v[144:147], v[24:39]
  s_add_u32 s22, s20, s33
  s_addc_u32 s23, s21, 0
  global_load_dwordx4 v[88:91], v3, s[22:23] offset:0
  global_load_dwordx4 v[92:95], v3, s[22:23] offset:1024
  ds_read_b64_tr_b16 v[112:113], v12 offset:2048
  ds_read_b64_tr_b16 v[114:115], v12 offset:3072
  v_mfma_f32_32x32x16_bf16 v[40:55], v[124:127], v[144:147], v[40:55]
  global_load_dwordx4 v[96:99], v3, s[22:23] offset:2048
  global_load_dwordx4 v[100:103], v3, s[22:23] offset:3072
  ds_read_b64_tr_b16 v[116:117], v13 offset:2048
  ds_read_b64_tr_b16 v[118:119], v13 offset:3072
  s_waitcnt vmcnt(16) lgkmcnt(8)
  v_mfma_f32_32x32x16_bf16 v[24:39], v[128:131], v[148:151], v[24:39]
  ds_read_b64_tr_b16 v[120:121], v12 offset:4096
  ds_read_b64_tr_b16 v[122:123], v12 offset:5120
  v_mfma_f32_32x32x16_bf16 v[40:55], v[132:135], v[148:151], v[40:55]
  ds_read_b64_tr_b16 v[124:125], v13 offset:4096
  ds_read_b64_tr_b16 v[126:127], v13 offset:5120
  s_waitcnt vmcnt(15) lgkmcnt(8)
  v_mfma_f32_32x32x16_bf16 v[24:39], v[104:107], v[152:155], v[24:39]
  s_xor_b32 s28, s24, 6
  s_lshl_b32 s28, s28, 13
  s_add_u32 s28, s28, 65536
  v_add_u32 v10, s28, v14
  v_add_u32 v11, s28, v15
  ds_read_b64_tr_b16 v[128:129], v12 offset:6144
  ds_read_b64_tr_b16 v[130:131], v12 offset:7168
  v_mfma_f32_32x32x16_bf16 v[40:55], v[108:111], v[152:155], v[40:55]
  s_andn2_b32 s33, s36, s34
  s_cbranch_scc0 .g2_kernel_w_i9c
.g2_kernel_w_i9b:
  s_ff1_i32_b32 s33, s33
  s_bitset1_b32 s34, s33
  s_xor_b32 s33, s33, s24
  ds_read_b64_tr_b16 v[132:133], v13 offset:6144
  ds_read_b64_tr_b16 v[134:135], v13 offset:7168
  s_waitcnt vmcnt(14) lgkmcnt(8)
  v_mfma_f32_32x32x16_bf16 v[24:39], v[112:115], v[156:159], v[24:39]
  s_and_b32 s9, s33, 7
  s_cmp_lt_u32 s9, 2
  s_cselect_b32 s28, 139264, 0
  s_lshl_b32 s9, s9, 13
  s_add_u32 s9, s9, s28
  ds_read_b64_tr_b16 v[104:105], v10 offset:0
  ds_read_b64_tr_b16 v[106:107], v10 offset:1024
  v_mfma_f32_32x32x16_bf16 v[40:55], v[116:119], v[156:159], v[40:55]
  s_lshl_b32 s33, s33, 12
  s_add_u32 s22, s20, s33
  s_addc_u32 s23, s21, 0
  global_load_dwordx4 v[176:179], v3, s[22:23] offset:0
  global_load_dwordx4 v[180:183], v3, s[22:23] offset:1024
  ds_read_b64_tr_b16 v[108:109], v11 offset:0
  ds_read_b64_tr_b16 v[110:111], v11 offset:1024
  s_waitcnt vmcnt(15) lgkmcnt(8)
  v_mfma_f32_32x32x16_bf16 v[24:39], v[120:123], v[160:163], v[24:39]
  global_load_dwordx4 v[184:187], v3, s[22:23] offset:2048
  global_load_dwordx4 v[188:191], v3, s[22:23] offset:3072
  v_lshlrev_b32 v16, 4, v17
  s_lshl_b32 s29, s18, 7
  buffer_load_dwordx4 v[240:243], v16, s[72:75], s29 offen offset:0
  ds_read_b64_tr_b16 v[112:113], v10 offset:2048
  ds_read_b64_tr_b16 v[114:115], v10 offset:3072
  v_mfma_f32_32x32x16_bf16 v[40:55], v[124:127], v[160:163], v[40:55]
  buffer_load_dwordx4 v[244:247], v16, s[72:75], s29 offen offset:32
  buffer_load_dwordx4 v[248:251], v16, s[72:75], s29 offen offset:64
  buffer_load_dwordx4 v[252:255], v16, s[72:75], s29 offen offset:96
  ds_read_b64_tr_b16 v[116:117], v11 offset:2048
  ds_read_b64_tr_b16 v[118:119], v11 offset:3072
  s_waitcnt vmcnt(20) lgkmcnt(8)
  v_mfma_f32_32x32x16_bf16 v[24:39], v[128:131], v[164:167], v[24:39]
  ds_read_b64_tr_b16 v[120:121], v10 offset:4096
  ds_read_b64_tr_b16 v[122:123], v10 offset:5120
  v_mfma_f32_32x32x16_bf16 v[40:55], v[132:135], v[164:167], v[40:55]
  ds_read_b64_tr_b16 v[124:125], v11 offset:4096
  ds_read_b64_tr_b16 v[126:127], v11 offset:5120
  s_waitcnt vmcnt(19) lgkmcnt(8)
  v_mfma_f32_32x32x16_bf16 v[24:39], v[104:107], v[56:59], v[24:39]
  s_xor_b32 s28, s24, 7
  s_lshl_b32 s28, s28, 13
  s_add_u32 s28, s28, 65536
  v_add_u32 v12, s28, v14
  ds_read_b64_tr_b16 v[128:129], v10 offset:6144
  ds_read_b64_tr_b16 v[130:131], v10 offset:7168
  v_mfma_f32_32x32x16_bf16 v[40:55], v[108:111], v[56:59], v[40:55]
  v_add_u32 v13, s28, v15
  s_andn2_b32 s33, s36, s34
  s_cbranch_scc0 .g2_kernel_w_i10c
.g2_kernel_w_i10b:
  s_ff1_i32_b32 s33, s33
  ds_read_b64_tr_b16 v[132:133], v11 offset:6144
  ds_read_b64_tr_b16 v[134:135], v11 offset:7168
  s_waitcnt vmcnt(18) lgkmcnt(8)
  v_mfma_f32_32x32x16_bf16 v[24:39], v[112:115], v[60:63], v[24:39]
  s_bitset1_b32 s34, s33
  s_xor_b32 s33, s33, s24
  s_and_b32 s10, s33, 7
  s_cmp_lt_u32 s10, 2
  ds_read_b64_tr_b16 v[104:105], v12 offset:0
  ds_read_b64_tr_b16 v[106:107], v12 offset:1024
  v_mfma_f32_32x32x16_bf16 v[40:55], v[116:119], v[60:63], v[40:55]
  s_cselect_b32 s28, 139264, 0
  s_lshl_b32 s10, s10, 13
  s_add_u32 s10, s10, s28
  s_lshl_b32 s33, s33, 12
  ds_read_b64_tr_b16 v[108:109], v13 offset:0
  ds_read_b64_tr_b16 v[110:111], v13 offset:1024
  s_waitcnt vmcnt(17) lgkmcnt(8)
  v_mfma_f32_32x32x16_bf16 v[24:39], v[120:123], v[64:67], v[24:39]
  s_add_u32 s22, s20, s33
  s_addc_u32 s23, s21, 0
  global_load_dwordx4 v[192:195], v3, s[22:23] offset:0
  global_load_dwordx4 v[196:199], v3, s[22:23] offset:1024
  ds_read_b64_tr_b16 v[112:113], v12 offset:2048
  ds_read_b64_tr_b16 v[114:115], v12 offset:3072
  v_mfma_f32_32x32x16_bf16 v[40:55], v[124:127], v[64:67], v[40:55]
  global_load_dwordx4 v[200:203], v3, s[22:23] offset:2048
  global_load_dwordx4 v[204:207], v3, s[22:23] offset:3072
  ds_read_b64_tr_b16 v[116:117], v13 offset:2048
  ds_read_b64_tr_b16 v[118:119], v13 offset:3072
  s_waitcnt vmcnt(20) lgkmcnt(8)
  v_mfma_f32_32x32x16_bf16 v[24:39], v[128:131], v[68:71], v[24:39]
  ds_read_b64_tr_b16 v[120:121], v12 offset:4096
  ds_read_b64_tr_b16 v[122:123], v12 offset:5120
  v_mfma_f32_32x32x16_bf16 v[40:55], v[132:135], v[68:71], v[40:55]
  ds_read_b64_tr_b16 v[124:125], v13 offset:4096
  ds_read_b64_tr_b16 v[126:127], v13 offset:5120
  s_waitcnt vmcnt(19) lgkmcnt(8)
  v_mfma_f32_32x32x16_bf16 v[24:39], v[104:107], v[72:75], v[24:39]
  s_andn2_b32 s33, s36, s34
  s_cbranch_scc0 .g2_kernel_w_i11c
.g2_kernel_w_i11b:
  s_ff1_i32_b32 s33, s33
  ds_read_b64_tr_b16 v[128:129], v12 offset:6144
  ds_read_b64_tr_b16 v[130:131], v12 offset:7168
  v_mfma_f32_32x32x16_bf16 v[40:55], v[108:111], v[72:75], v[40:55]
  s_bitset1_b32 s34, s33
  s_xor_b32 s33, s33, s24
  s_and_b32 s11, s33, 7
  ds_read_b64_tr_b16 v[132:133], v13 offset:6144
  ds_read_b64_tr_b16 v[134:135], v13 offset:7168
  s_waitcnt vmcnt(18) lgkmcnt(8)
  v_mfma_f32_32x32x16_bf16 v[24:39], v[112:115], v[76:79], v[24:39]
  s_cmp_lt_u32 s11, 2
  s_cselect_b32 s28, 139264, 0
  s_lshl_b32 s11, s11, 13
  v_mfma_f32_32x32x16_bf16 v[40:55], v[116:119], v[76:79], v[40:55]
  s_add_u32 s11, s11, s28
  s_lshl_b32 s33, s33, 12
  s_add_u32 s22, s20, s33
  s_waitcnt vmcnt(17) lgkmcnt(4)
  v_mfma_f32_32x32x16_bf16 v[24:39], v[120:123], v[80:83], v[24:39]
  s_addc_u32 s23, s21, 0
  global_load_dwordx4 v[208:211], v3, s[22:23] offset:0
  global_load_dwordx4 v[212:215], v3, s[22:23] offset:1024
  v_mfma_f32_32x32x16_bf16 v[40:55], v[124:127], v[80:83], v[40:55]
  global_load_dwordx4 v[216:219], v3, s[22:23] offset:2048
  global_load_dwordx4 v[220:223], v3, s[22:23] offset:3072
  s_waitcnt vmcnt(20) lgkmcnt(0)
  v_mfma_f32_32x32x16_bf16 v[24:39], v[128:131], v[84:87], v[24:39]
  v_mfma_f32_32x32x16_bf16 v[40:55], v[132:135], v[84:87], v[40:55]
  ds_read_b32 v16, v20 offset:12
  v_add_u32 v10, s8, v14
  v_add_u32 v11, s8, v15
  s_waitcnt lgkmcnt(0)
  v_cmp_gt_u32 vcc, 4, v16
  s_cbranch_vccnz .g2_kernel_w_bw
.g2_kernel_w_bb:
  ds_read_b64_tr_b16 v[104:105], v10 offset:0
  ds_read_b64_tr_b16 v[106:107], v10 offset:1024
  ds_read_b64_tr_b16 v[108:109], v11 offset:0
  ds_read_b64_tr_b16 v[110:111], v11 offset:1024
  ds_read_b64_tr_b16 v[112:113], v10 offset:2048
  ds_read_b64_tr_b16 v[114:115], v10 offset:3072
  ds_read_b64_tr_b16 v[116:117], v11 offset:2048
  ds_read_b64_tr_b16 v[118:119], v11 offset:3072
  ds_read_b64_tr_b16 v[120:121], v10 offset:4096
  ds_read_b64_tr_b16 v[122:123], v10 offset:5120
  ds_read_b64_tr_b16 v[124:125], v11 offset:4096
  ds_read_b64_tr_b16 v[126:127], v11 offset:5120
  s_waitcnt vmcnt(16)
  v_min3_u32 v6, v88, v90, v92
  v_min3_u32 v7, v94, v96, v98
  v_min3_u32 v6, v6, v100, v102
  v_min_u32 v6, v6, v7
  v_cmp_eq_u32 vcc, 0, v6
  s_cbranch_vccnz .g2_kernel_w_v8
.g2_kernel_w_vb8:
  s_waitcnt lgkmcnt(8)
  v_mfma_f32_32x32x16_bf16 v[24:39], v[104:107], v[88:91], v[24:39]
  v_add_u32 v12, s9, v14
  v_add_u32 v13, s9, v15
  s_andn2_b32 s33, s36, s34
  s_cbranch_scc0 .g2_kernel_w_i12c
.g2_kernel_w_i12b:
  ds_read_b64_tr_b16 v[128:129], v10 offset:6144
  ds_read_b64_tr_b16 v[130:131], v10 offset:7168
  v_mfma_f32_32x32x16_bf16 v[40:55], v[108:111], v[88:91], v[40:55]
  s_ff1_i32_b32 s33, s33
  s_bitset1_b32 s34, s33
  s_xor_b32 s33, s33, s24
  s_and_b32 s12, s33, 7
  ds_read_b64_tr_b16 v[132:133], v11 offset:6144
  ds_read_b64_tr_b16 v[134:135], v11 offset:7168
  s_waitcnt lgkmcnt(8)
  v_mfma_f32_32x32x16_bf16 v[24:39], v[112:115], v[92:95], v[24:39]
  s_cmp_lt_u32 s12, 2
  s_cselect_b32 s28, 139264, 0
  s_lshl_b32 s12, s12, 13
  s_add_u32 s12, s12, s28
  ds_read_b64_tr_b16 v[104:105], v12 offset:0
  ds_read_b64_tr_b16 v[106:107], v12 offset:1024
  v_mfma_f32_32x32x16_bf16 v[40:55], v[116:119], v[92:95], v[40:55]
  s_lshl_b32 s33, s33, 12
  s_add_u32 s22, s20, s33
  s_addc_u32 s23, s21, 0
  global_load_dwordx4 v[224:227], v3, s[22:23] offset:0
  ds_read_b64_tr_b16 v[108:109], v13 offset:0
  ds_read_b64_tr_b16 v[110:111], v13 offset:1024
  s_waitcnt lgkmcnt(8)
  v_mfma_f32_32x32x16_bf16 v[24:39], v[120:123], v[96:99], v[24:39]
  global_load_dwordx4 v[228:231], v3, s[22:23] offset:1024
  global_load_dwordx4 v[232:235], v3, s[22:23] offset:2048
  global_load_dwordx4 v[236:239], v3, s[22:23] offset:3072
  ds_read_b64_tr_b16 v[112:113], v12 offset:2048
  ds_read_b64_tr_b16 v[114:115], v12 offset:3072
  v_mfma_f32_32x32x16_bf16 v[40:55], v[124:127], v[96:99], v[40:55]
  ds_read_b64_tr_b16 v[116:117], v13 offset:2048
  ds_read_b64_tr_b16 v[118:119], v13 offset:3072
  s_waitcnt lgkmcnt(8)
  v_mfma_f32_32x32x16_bf16 v[24:39], v[128:131], v[100:103], v[24:39]
  ds_read_b64_tr_b16 v[120:121], v12 offset:4096
  ds_read_b64_tr_b16 v[122:123], v12 offset:5120
  s_waitcnt vmcnt(16)
  v_min3_u32 v6, v176, v178, v180
  v_min3_u32 v7, v182, v184, v186
  v_min3_u32 v6, v6, v188, v190
  v_min_u32 v6, v6, v7
  v_cmp_eq_u32 vcc, 0, v6
  v_mfma_f32_32x32x16_bf16 v[40:55], v[132:135], v[100:103], v[40:55]
  ds_read_b64_tr_b16 v[124:125], v13 offset:4096
  ds_read_b64_tr_b16 v[126:127], v13 offset:5120
  s_cbranch_vccnz .g2_kernel_w_v9
.g2_kernel_w_vb9:
  s_waitcnt lgkmcnt(8)
  v_mfma_f32_32x32x16_bf16 v[24:39], v[104:107], v[176:179], v[24:39]
  v_add_u32 v10, s10, v14
  v_add_u32 v11, s10, v15
  s_andn2_b32 s33, s36, s34
  s_cbranch_scc0 .g2_kernel_w_i13c
.g2_kernel_w_i13b:
  ds_read_b64_tr_b16 v[128:129], v12 offset:6144
  ds_read_b64_tr_b16 v[130:131], v12 offset:7168
  v_mfma_f32_32x32x16_bf16 v[40:55], v[108:111], v[176:179], v[40:55]
  s_ff1_i32_b32 s33, s33
  s_bitset1_b32 s34, s33
  s_xor_b32 s33, s33, s24
  s_and_b32 s13, s33, 7
  ds_read_b64_tr_b16 v[132:133], v13 offset:6144
  ds_read_b64_tr_b16 v[134:135], v13 offset:7168
  s_waitcnt lgkmcnt(8)
  v_mfma_f32_32x32x16_bf16 v[24:39], v[112:115], v[180:183], v[24:39]
  s_cmp_lt_u32 s13, 2
  s_cselect_b32 s28, 139264, 0
  s_lshl_b32 s13, s13, 13
  s_add_u32 s13, s13, s28
  ds_read_b64_tr_b16 v[104:105], v10 offset:0
  ds_read_b64_tr_b16 v[106:107], v10 offset:1024
  v_mfma_f32_32x32x16_bf16 v[40:55], v[116:119], v[180:183], v[40:55]
  s_lshl_b32 s33, s33, 12
  s_add_u32 s22, s20, s33
  s_addc_u32 s23, s21, 0
  global_load_dwordx4 v[136:139], v3, s[22:23] offset:0
  ds_read_b64_tr_b16 v[108:109], v11 offset:0
  ds_read_b64_tr_b16 v[110:111], v11 offset:1024
  s_waitcnt lgkmcnt(8)
  v_mfma_f32_32x32x16_bf16 v[24:39], v[120:123], v[184:187], v[24:39]
  global_load_dwordx4 v[140:143], v3, s[22:23] offset:1024
  global_load_dwordx4 v[144:147], v3, s[22:23] offset:2048
  global_load_dwordx4 v[148:151], v3, s[22:23] offset:3072
  ds_read_b64_tr_b16 v[112:113], v10 offset:2048
  ds_read_b64_tr_b16 v[114:115], v10 offset:3072
  v_mfma_f32_32x32x16_bf16 v[40:55], v[124:127], v[184:187], v[40:55]
  ds_read_b64_tr_b16 v[116:117], v11 offset:2048
  ds_read_b64_tr_b16 v[118:119], v11 offset:3072
  s_waitcnt lgkmcnt(8)
  v_mfma_f32_32x32x16_bf16 v[24:39], v[128:131], v[188:191], v[24:39]
  ds_read_b64_tr_b16 v[120:121], v10 offset:4096
  ds_read_b64_tr_b16 v[122:123], v10 offset:5120
  s_waitcnt vmcnt(12)
  v_min3_u32 v6, v192, v194, v196
  v_min3_u32 v7, v198, v200, v202
  v_min3_u32 v6, v6, v204, v206
  v_min_u32 v6, v6, v7
  v_cmp_eq_u32 vcc, 0, v6
  v_mfma_f32_32x32x16_bf16 v[40:55], v[132:135], v[188:191], v[40:55]
  ds_read_b64_tr_b16 v[124:125], v11 offset:4096
  ds_read_b64_tr_b16 v[126:127], v11 offset:5120
  s_cbranch_vccnz .g2_kernel_w_v10
.g2_kernel_w_vb10:
  s_waitcnt lgkmcnt(8)
  v_mfma_f32_32x32x16_bf16 v[24:39], v[104:107], v[192:195], v[24:39]
  v_add_u32 v12, s11, v14
  v_add_u32 v13, s11, v15
  s_andn2_b32 s33, s36, s34
  s_cbranch_scc0 .g2_kernel_w_i14c
.g2_kernel_w_i14b:
  ds_read_b64_tr_b16 v[128:129], v10 offset:6144
  ds_read_b64_tr_b16 v[130:131], v10 offset:7168
  v_mfma_f32_32x32x16_bf16 v[40:55], v[108:111], v[192:195], v[40:55]
  s_ff1_i32_b32 s33, s33
  s_bitset1_b32 s34, s33
  s_xor_b32 s33, s33, s24
  s_and_b32 s14, s33, 7
  ds_read_b64_tr_b16 v[132:133], v11 offset:6144
  ds_read_b64_tr_b16 v[134:135], v11 offset:7168
  s_waitcnt lgkmcnt(8)
  v_mfma_f32_32x32x16_bf16 v[24:39], v[112:115], v[196:199], v[24:39]
  s_cmp_lt_u32 s14, 2
  s_cselect_b32 s28, 139264, 0
  s_lshl_b32 s14, s14, 13
  s_add_u32 s14, s14, s28
  ds_read_b64_tr_b16 v[104:105], v12 offset:0
  ds_read_b64_tr_b16 v[106:107], v12 offset:1024
  v_mfma_f32_32x32x16_bf16 v[40:55], v[116:119], v[196:199], v[40:55]
  s_lshl_b32 s33, s33, 12
  s_add_u32 s22, s20, s33
  s_addc_u32 s23, s21, 0
  global_load_dwordx4 v[152:155], v3, s[22:23] offset:0 sc1
  ds_read_b64_tr_b16 v[108:109], v13 offset:0
  ds_read_b64_tr_b16 v[110:111], v13 offset:1024
  s_waitcnt lgkmcnt(8)
  v_mfma_f32_32x32x16_bf16 v[24:39], v[120:123], v[200:203], v[24:39]
  global_load_dwordx4 v[156:159], v3, s[22:23] offset:1024 sc1
  global_load_dwordx4 v[160:163], v3, s[22:23] offset:2048 sc1
  global_load_dwordx4 v[164:167], v3, s[22:23] offset:3072 sc1
  ds_read_b64_tr_b16 v[112:113], v12 offset:2048
  ds_read_b64_tr_b16 v[114:115], v12 offset:3072
  v_mfma_f32_32x32x16_bf16 v[40:55], v[124:127], v[200:203], v[40:55]
  ds_read_b64_tr_b16 v[116:117], v13 offset:2048
  ds_read_b64_tr_b16 v[118:119], v13 offset:3072
  s_waitcnt lgkmcnt(8)
  v_mfma_f32_32x32x16_bf16 v[24:39], v[128:131], v[204:207], v[24:39]
  ds_read_b64_tr_b16 v[120:121], v12 offset:4096
  ds_read_b64_tr_b16 v[122:123], v12 offset:5120
  s_waitcnt vmcnt(12)
  v_min3_u32 v6, v208, v210, v212
  v_min3_u32 v7, v214, v216, v218
  v_min3_u32 v6, v6, v220, v222
  v_min_u32 v6, v6, v7
  v_cmp_eq_u32 vcc, 0, v6
  v_mfma_f32_32x32x16_bf16 v[40:55], v[132:135], v[204:207], v[40:55]
  ds_read_b64_tr_b16 v[124:125], v13 offset:4096
  ds_read_b64_tr_b16 v[126:127], v13 offset:5120
  s_cbranch_vccnz .g2_kernel_w_v11
.g2_kernel_w_vb11:
  s_mov_b64 exec, 1
  ds_add_u32 v20, v5 offset:16
  s_mov_b64 exec, -1
  s_waitcnt lgkmcnt(8)
  v_mfma_f32_32x32x16_bf16 v[24:39], v[104:107], v[208:211], v[24:39]
  v_add_u32 v10, s12, v14
  v_add_u32 v11, s12, v15
  s_andn2_b32 s33, s36, s34
  s_cbranch_scc0 .g2_kernel_w_i15c
.g2_kernel_w_i15b:
  ds_read_b64_tr_b16 v[128:129], v12 offset:6144
  ds_read_b64_tr_b16 v[130:131], v12 offset:7168
  v_mfma_f32_32x32x16_bf16 v[40:55], v[108:111], v[208:211], v[40:55]
  s_ff1_i32_b32 s33, s33
  s_bitset1_b32 s34, s33
  s_xor_b32 s33, s33, s24
  s_and_b32 s15, s33, 7
  ds_read_b64_tr_b16 v[132:133], v13 offset:6144
  ds_read_b64_tr_b16 v[134:135], v13 offset:7168
  s_waitcnt lgkmcnt(8)
  v_mfma_f32_32x32x16_bf16 v[24:39], v[112:115], v[212:215], v[24:39]
  s_cmp_lt_u32 s15, 2
  s_cselect_b32 s28, 139264, 0
  s_lshl_b32 s15, s15, 13
  s_add_u32 s15, s15, s28
  ds_read_b64_tr_b16 v[104:105], v10 offset:0
  ds_read_b64_tr_b16 v[106:107], v10 offset:1024
  v_mfma_f32_32x32x16_bf16 v[40:55], v[116:119], v[212:215], v[40:55]
  s_lshl_b32 s33, s33, 12
  s_add_u32 s22, s20, s33
  s_addc_u32 s23, s21, 0
  global_load_dwordx4 v[56:59], v3, s[22:23] offset:0 sc1
  ds_read_b64_tr_b16 v[108:109], v11 offset:0
  ds_read_b64_tr_b16 v[110:111], v11 offset:1024
  s_waitcnt lgkmcnt(8)
  v_mfma_f32_32x32x16_bf16 v[24:39], v[120:123], v[216:219], v[24:39]
  global_load_dwordx4 v[60:63], v3, s[22:23] offset:1024 sc1
  global_load_dwordx4 v[64:67], v3, s[22:23] offset:2048 sc1
  global_load_dwordx4 v[68:71], v3, s[22:23] offset:3072 sc1
  ds_read_b64_tr_b16 v[112:113], v10 offset:2048
  ds_read_b64_tr_b16 v[114:115], v10 offset:3072
  v_mfma_f32_32x32x16_bf16 v[40:55], v[124:127], v[216:219], v[40:55]
  ds_read_b64_tr_b16 v[116:117], v11 offset:2048
  ds_read_b64_tr_b16 v[118:119], v11 offset:3072
  s_waitcnt lgkmcnt(8)
  v_mfma_f32_32x32x16_bf16 v[24:39], v[128:131], v[220:223], v[24:39]
  ds_read_b64_tr_b16 v[120:121], v10 offset:4096
  ds_read_b64_tr_b16 v[122:123], v10 offset:5120
  s_waitcnt vmcnt(12)
  v_min3_u32 v6, v224, v226, v228
  v_min3_u32 v7, v230, v232, v234
  v_min3_u32 v6, v6, v236, v238
  v_min_u32 v6, v6, v7
  v_cmp_eq_u32 vcc, 0, v6
  v_mfma_f32_32x32x16_bf16 v[40:55], v[132:135], v[220:223], v[40:55]
  ds_read_b64_tr_b16 v[124:125], v11 offset:4096
  ds_read_b64_tr_b16 v[126:127], v11 offset:5120
  s_cbranch_vccnz .g2_kernel_w_v12
.g2_kernel_w_vb12:
  s_waitcnt lgkmcnt(8)
  v_mfma_f32_32x32x16_bf16 v[24:39], v[104:107], v[224:227], v[24:39]
  v_add_u32 v12, s13, v14
  v_add_u32 v13, s13, v15
  ds_read_b64_tr_b16 v[128:129], v10 offset:6144
  ds_read_b64_tr_b16 v[130:131], v10 offset:7168
  v_mfma_f32_32x32x16_bf16 v[40:55], v[108:111], v[224:227], v[40:55]
  ds_read_b64_tr_b16 v[132:133], v11 offset:6144
  ds_read_b64_tr_b16 v[134:135], v11 offset:7168
  s_waitcnt lgkmcnt(8)
  v_mfma_f32_32x32x16_bf16 v[24:39], v[112:115], v[228:231], v[24:39]
  ds_read_b64_tr_b16 v[104:105], v12 offset:0
  ds_read_b64_tr_b16 v[106:107], v12 offset:1024
  v_mfma_f32_32x32x16_bf16 v[40:55], v[116:119], v[228:231], v[40:55]
  ds_read_b64_tr_b16 v[108:109], v13 offset:0
  ds_read_b64_tr_b16 v[110:111], v13 offset:1024
  s_waitcnt lgkmcnt(8)
  v_mfma_f32_32x32x16_bf16 v[24:39], v[120:123], v[232:235], v[24:39]
  ds_read_b64_tr_b16 v[112:113], v12 offset:2048
  ds_read_b64_tr_b16 v[114:115], v12 offset:3072
  v_mfma_f32_32x32x16_bf16 v[40:55], v[124:127], v[232:235], v[40:55]
  ds_read_b64_tr_b16 v[116:117], v13 offset:2048
  ds_read_b64_tr_b16 v[118:119], v13 offset:3072
  s_waitcnt lgkmcnt(8)
  v_mfma_f32_32x32x16_bf16 v[24:39], v[128:131], v[236:239], v[24:39]
  ds_read_b64_tr_b16 v[120:121], v12 offset:4096
  ds_read_b64_tr_b16 v[122:123], v12 offset:5120
  s_waitcnt vmcnt(8)
  v_min3_u32 v6, v136, v138, v140
  v_min3_u32 v7, v142, v144, v146
  v_min3_u32 v6, v6, v148, v150
  v_min_u32 v6, v6, v7
  v_cmp_eq_u32 vcc, 0, v6
  v_mfma_f32_32x32x16_bf16 v[40:55], v[132:135], v[236:239], v[40:55]
  ds_read_b64_tr_b16 v[124:125], v13 offset:4096
  ds_read_b64_tr_b16 v[126:127], v13 offset:5120
  s_cbranch_vccnz .g2_kernel_w_v13
.g2_kernel_w_vb13:
  s_waitcnt lgkmcnt(8)
  v_mfma_f32_32x32x16_bf16 v[24:39], v[104:107], v[136:139], v[24:39]
  v_add_u32 v10, s14, v14
  v_add_u32 v11, s14, v15
  ds_read_b64_tr_b16 v[128:129], v12 offset:6144
  ds_read_b64_tr_b16 v[130:131], v12 offset:7168
  v_mfma_f32_32x32x16_bf16 v[40:55], v[108:111], v[136:139], v[40:55]
  ds_read_b64_tr_b16 v[132:133], v13 offset:6144
  ds_read_b64_tr_b16 v[134:135], v13 offset:7168
  s_waitcnt lgkmcnt(8)
  v_mfma_f32_32x32x16_bf16 v[24:39], v[112:115], v[140:143], v[24:39]
  ds_read_b64_tr_b16 v[104:105], v10 offset:0
  ds_read_b64_tr_b16 v[106:107], v10 offset:1024
  v_mfma_f32_32x32x16_bf16 v[40:55], v[116:119], v[140:143], v[40:55]
  ds_read_b64_tr_b16 v[108:109], v11 offset:0
  ds_read_b64_tr_b16 v[110:111], v11 offset:1024
  s_waitcnt lgkmcnt(8)
  v_mfma_f32_32x32x16_bf16 v[24:39], v[120:123], v[144:147], v[24:39]
  ds_read_b64_tr_b16 v[112:113], v10 offset:2048
  ds_read_b64_tr_b16 v[114:115], v10 offset:3072
  v_mfma_f32_32x32x16_bf16 v[40:55], v[124:127], v[144:147], v[40:55]
  ds_read_b64_tr_b16 v[116:117], v11 offset:2048
  ds_read_b64_tr_b16 v[118:119], v11 offset:3072
  s_waitcnt lgkmcnt(8)
  v_mfma_f32_32x32x16_bf16 v[24:39], v[128:131], v[148:151], v[24:39]
  ds_read_b64_tr_b16 v[120:121], v10 offset:4096
  ds_read_b64_tr_b16 v[122:123], v10 offset:5120
  s_waitcnt vmcnt(4)
  v_min3_u32 v6, v152, v154, v156
  v_min3_u32 v7, v158, v160, v162
  v_min3_u32 v6, v6, v164, v166
  v_min_u32 v6, v6, v7
  v_cmp_eq_u32 vcc, 0, v6
  v_mfma_f32_32x32x16_bf16 v[40:55], v[132:135], v[148:151], v[40:55]
  ds_read_b64_tr_b16 v[124:125], v11 offset:4096
  ds_read_b64_tr_b16 v[126:127], v11 offset:5120
  s_cbranch_vccnz .g2_kernel_w_v14
.g2_kernel_w_vb14:
  s_waitcnt lgkmcnt(8)
  v_mfma_f32_32x32x16_bf16 v[24:39], v[104:107], v[152:155], v[24:39]
  v_add_u32 v12, s15, v14
  v_add_u32 v13, s15, v15
  ds_read_b64_tr_b16 v[128:129], v10 offset:6144
  ds_read_b64_tr_b16 v[130:131], v10 offset:7168
  v_mfma_f32_32x32x16_bf16 v[40:55], v[108:111], v[152:155], v[40:55]
  ds_read_b64_tr_b16 v[132:133], v11 offset:6144
  ds_read_b64_tr_b16 v[134:135], v11 offset:7168
  s_waitcnt lgkmcnt(8)
  v_mfma_f32_32x32x16_bf16 v[24:39], v[112:115], v[156:159], v[24:39]
  ds_read_b64_tr_b16 v[104:105], v12 offset:0
  ds_read_b64_tr_b16 v[106:107], v12 offset:1024
  v_mfma_f32_32x32x16_bf16 v[40:55], v[116:119], v[156:159], v[40:55]
  ds_read_b64_tr_b16 v[108:109], v13 offset:0
  ds_read_b64_tr_b16 v[110:111], v13 offset:1024
  s_waitcnt lgkmcnt(8)
  v_mfma_f32_32x32x16_bf16 v[24:39], v[120:123], v[160:163], v[24:39]
  ds_read_b64_tr_b16 v[112:113], v12 offset:2048
  ds_read_b64_tr_b16 v[114:115], v12 offset:3072
  v_mfma_f32_32x32x16_bf16 v[40:55], v[124:127], v[160:163], v[40:55]
  ds_read_b64_tr_b16 v[116:117], v13 offset:2048
  ds_read_b64_tr_b16 v[118:119], v13 offset:3072
  s_waitcnt lgkmcnt(8)
  v_mfma_f32_32x32x16_bf16 v[24:39], v[128:131], v[164:167], v[24:39]
  ds_read_b64_tr_b16 v[120:121], v12 offset:4096
  ds_read_b64_tr_b16 v[122:123], v12 offset:5120
  s_waitcnt vmcnt(0)
  v_min3_u32 v6, v56, v58, v60
  v_min3_u32 v7, v62, v64, v66
  v_min3_u32 v6, v6, v68, v70
  v_min_u32 v6, v6, v7
  v_cmp_eq_u32 vcc, 0, v6
  v_mfma_f32_32x32x16_bf16 v[40:55], v[132:135], v[164:167], v[40:55]
  ds_read_b64_tr_b16 v[124:125], v13 offset:4096
  ds_read_b64_tr_b16 v[126:127], v13 offset:5120
  s_cbranch_vccnz .g2_kernel_w_v15
.g2_kernel_w_vb15:
  s_waitcnt lgkmcnt(8)
  v_mfma_f32_32x32x16_bf16 v[24:39], v[104:107], v[56:59], v[24:39]
  ds_read_b64_tr_b16 v[128:129], v12 offset:6144
  ds_read_b64_tr_b16 v[130:131], v12 offset:7168
  v_mfma_f32_32x32x16_bf16 v[40:55], v[108:111], v[56:59], v[40:55]
  ds_read_b64_tr_b16 v[132:133], v13 offset:6144
  ds_read_b64_tr_b16 v[134:135], v13 offset:7168
  s_waitcnt lgkmcnt(8)
  v_mfma_f32_32x32x16_bf16 v[24:39], v[112:115], v[60:63], v[24:39]
  v_mfma_f32_32x32x16_bf16 v[40:55], v[116:119], v[60:63], v[40:55]
  s_waitcnt lgkmcnt(4)
  v_mfma_f32_32x32x16_bf16 v[24:39], v[120:123], v[64:67], v[24:39]
  v_mfma_f32_32x32x16_bf16 v[40:55], v[124:127], v[64:67], v[40:55]
  s_waitcnt lgkmcnt(0)
  v_mfma_f32_32x32x16_bf16 v[24:39], v[128:131], v[68:71], v[24:39]
  v_mfma_f32_32x32x16_bf16 v[40:55], v[132:135], v[68:71], v[40:55]
  s_lshl_b32 s28, s17, 4
  s_add_u32 s28, s28, s18
  s_lshl_b32 s28, s28, 2
  s_add_u32 s28, s28, s16
  s_lshl_b32 s28, s28, 12
  s_add_u32 s28, s28, s63
  s_add_u32 s28, s28, 0xc00000
  s_lshl_b32 s29, s16, 12
  v_add_u32 v6, s29, v22
  s_mov_b32 s36, 0x3f803f80
  v_mov_b32 v8, 0
  v_mov_b32 v9, 0
  v_mov_b32 v10, 0
  v_and_b32 v7, 24, v18
  v_lshlrev_b32 v7, 8, v7
  v_and_b32 v11, 7, v18
  v_lshl_add_u32 v7, v11, 4, v7
  v_cvt_pk_bf16_f32 v56, v24, v25
  v_cvt_pk_bf16_f32 v57, v26, v27
  v_cvt_pk_bf16_f32 v58, v28, v29
  v_cvt_pk_bf16_f32 v59, v30, v31
  buffer_store_dwordx4 v[56:59], v22, s[4:7], s28 offen offset:0 sc1
  v_cvt_pk_bf16_f32 v60, v32, v33
  v_cvt_pk_bf16_f32 v61, v34, v35
  v_cvt_pk_bf16_f32 v62, v36, v37
  v_cvt_pk_bf16_f32 v63, v38, v39
  buffer_store_dwordx4 v[60:63], v22, s[4:7], s28 offen offset:512 sc1
  v_cvt_pk_bf16_f32 v64, v40, v41
  v_cvt_pk_bf16_f32 v65, v42, v43
  v_cvt_pk_bf16_f32 v66, v44, v45
  v_cvt_pk_bf16_f32 v67, v46, v47
  buffer_store_dwordx4 v[64:67], v22, s[4:7], s28 offen offset:1024 sc1
  v_cvt_pk_bf16_f32 v68, v48, v49
  v_cvt_pk_bf16_f32 v69, v50, v51
  v_cvt_pk_bf16_f32 v70, v52, v53
  v_cvt_pk_bf16_f32 v71, v54, v55
  buffer_store_dwordx4 v[68:71], v22, s[4:7], s28 offen offset:1536 sc1
  ds_write_b128 v6, v[56:59] offset:0
  ds_write_b128 v6, v[60:63] offset:512
  ds_write_b128 v6, v[64:67] offset:1024
  ds_write_b128 v6, v[68:71] offset:1536
  s_mov_b64 exec, 1
  ds_add_u32 v20, v5 offset:20
  s_mov_b64 exec, -1
  s_lshl_b32 s28, s17, 2
  s_add_u32 s28, s28, s16
  s_lshl_b32 s28, s28, 13
  s_lshl_b32 s29, s18, 7
  s_add_u32 s28, s28, s29
  s_add_u32 s28, s28, s63
  s_add_u32 s28, s28, 0x1000000
  v_dot2c_f32_bf16 v8, s36, v56
  v_dot2c_f32_bf16 v9, v56, v56
  v_dot2c_f32_bf16 v10, v56, v240
  v_dot2c_f32_bf16 v8, s36, v57
  v_dot2c_f32_bf16 v9, v57, v57
  v_dot2c_f32_bf16 v10, v57, v241
  v_dot2c_f32_bf16 v8, s36, v58
  v_dot2c_f32_bf16 v9, v58, v58
  v_dot2c_f32_bf16 v10, v58, v242
  v_dot2c_f32_bf16 v8, s36, v59
  v_dot2c_f32_bf16 v9, v59, v59
  v_dot2c_f32_bf16 v10, v59, v243
  v_dot2c_f32_bf16 v8, s36, v60
  v_dot2c_f32_bf16 v9, v60, v60
  v_dot2c_f32_bf16 v10, v60, v244
  v_dot2c_f32_bf16 v8, s36, v61
  v_dot2c_f32_bf16 v9, v61, v61
  v_dot2c_f32_bf16 v10, v61, v245
  v_dot2c_f32_bf16 v8, s36, v62
  v_dot2c_f32_bf16 v9, v62, v62
  v_dot2c_f32_bf16 v10, v62, v246
  v_dot2c_f32_bf16 v8, s36, v63
  v_dot2c_f32_bf16 v9, v63, v63
  v_dot2c_f32_bf16 v10, v63, v247
  v_dot2c_f32_bf16 v8, s36, v64
  v_dot2c_f32_bf16 v9, v64, v64
  v_dot2c_f32_bf16 v10, v64, v248
  v_dot2c_f32_bf16 v8, s36, v65
  v_dot2c_f32_bf16 v9, v65, v65
  v_dot2c_f32_bf16 v10, v65, v249
  v_dot2c_f32_bf16 v8, s36, v66
  v_dot2c_f32_bf16 v9, v66, v66
  v_dot2c_f32_bf16 v10, v66, v250
  v_dot2c_f32_bf16 v8, s36, v67
  v_dot2c_f32_bf16 v9, v67, v67
  v_dot2c_f32_bf16 v10, v67, v251
  v_dot2c_f32_bf16 v8, s36, v68
  v_dot2c_f32_bf16 v9, v68, v68
  v_dot2c_f32_bf16 v10, v68, v252
  v_dot2c_f32_bf16 v8, s36, v69
  v_dot2c_f32_bf16 v9, v69, v69
  v_dot2c_f32_bf16 v10, v69, v253
  v_dot2c_f32_bf16 v8, s36, v70
  v_dot2c_f32_bf16 v9, v70, v70
  v_dot2c_f32_bf16 v10, v70, v254
  v_dot2c_f32_bf16 v8, s36, v71
  v_dot2c_f32_bf16 v9, v71, v71
  v_dot2c_f32_bf16 v10, v71, v255
  s_lshl_b32 s29, s16, 7
  s_add_u32 s37, s19, s29
  v_mov_b32 v24, v8
  v_mov_b32 v25, v9
  v_mov_b32 v26, v10
  v_mov_b32 v11, 1
  v_permlane32_swap_b32 v8, v24
  v_permlane32_swap_b32 v9, v25
  v_permlane32_swap_b32 v10, v26
  v_add_f32 v8, v8, v24
  v_add_f32 v9, v9, v25
  v_add_f32 v10, v10, v26
  v_or_b32 v8, 1, v8
  v_mov_b32 v16, s70
  s_mov_b32 exec_hi, 0
  s_waitcnt vmcnt(0)
  buffer_store_dwordx4 v[8:11], v7, s[4:7], s28 offen sc1
  s_mov_b64 exec, 1
  buffer_store_dword v16, v4, s[4:7], s37 offen offset:8 sc1
  s_mov_b64 exec, -1
  s_cmp_lg_u32 s62, 0
  s_cbranch_scc1 .g2_kernel_tail
  s_mov_b32 s62, 1
  s_mov_b32 s63, 0x1800000
  s_mov_b32 s70, 2
  s_mov_b32 s71, 155776
  s_branch .g2_kernel_q_cons2
.g2_kernel_tail:
  s_mov_b32 s28, s56
  s_mov_b32 s29, s57
  s_mov_b32 s30, 0x400000
  s_mov_b32 s31, 0x00020000
  v_lshlrev_b32 v24, 16, v56
  v_and_b32 v25, 0xffff0000, v56
  v_lshlrev_b32 v26, 16, v57
  v_and_b32 v27, 0xffff0000, v57
  v_lshlrev_b32 v28, 16, v58
  v_and_b32 v29, 0xffff0000, v58
  v_lshlrev_b32 v30, 16, v59
  v_and_b32 v31, 0xffff0000, v59
  v_lshlrev_b32 v32, 16, v60
  v_and_b32 v33, 0xffff0000, v60
  v_lshlrev_b32 v34, 16, v61
  v_and_b32 v35, 0xffff0000, v61
  v_lshlrev_b32 v36, 16, v62
  v_and_b32 v37, 0xffff0000, v62
  v_lshlrev_b32 v38, 16, v63
  v_and_b32 v39, 0xffff0000, v63
  v_lshlrev_b32 v40, 16, v64
  v_and_b32 v41, 0xffff0000, v64
  v_lshlrev_b32 v42, 16, v65
  v_and_b32 v43, 0xffff0000, v65
  v_lshlrev_b32 v44, 16, v66
  v_and_b32 v45, 0xffff0000, v66
  v_lshlrev_b32 v46, 16, v67
  v_and_b32 v47, 0xffff0000, v67
  v_lshlrev_b32 v48, 16, v68
  v_and_b32 v49, 0xffff0000, v68
  v_lshlrev_b32 v50, 16, v69
  v_and_b32 v51, 0xffff0000, v69
  v_lshlrev_b32 v52, 16, v70
  v_and_b32 v53, 0xffff0000, v70
  v_lshlrev_b32 v54, 16, v71
  v_and_b32 v55, 0xffff0000, v71
  v_lshlrev_b32 v10, 2, v19
  v_add_u32 v10, 155644, v10
  s_lshl_b32 s32, s17, 2
  s_add_u32 s32, s32, s16
  s_lshl_b32 s32, s32, 16
  s_lshl_b32 s33, s18, 7
  s_add_u32 s32, s32, s33
  v_mov_b32 v6, s71
  s_mov_b32 s38, 0
.g2_kernel_wg5:
  ds_read_b32 v7, v6 offset:28
  s_add_u32 s38, s38, 1
  s_waitcnt lgkmcnt(0)
  v_cmp_le_u32 vcc, 1, v7
  s_cbranch_vccnz .g2_kernel_wg5d
  s_sleep 2
  s_cmp_lt_u32 s38, 524288
  s_cbranch_scc1 .g2_kernel_wg5
.g2_kernel_wg5d:
  ds_read_b32 v8, v10 offset:3840
  ds_read_b32 v9, v10 offset:4352
  ds_read_b32 v16, v20 offset:32
  s_waitcnt lgkmcnt(0)
  v_cmp_ne_u32 vcc, v16, v19
  v_pk_fma_f32 v[24:25], v[24:25], v[8:9], v[8:9] op_sel:[0,0,1] op_sel_hi:[1,0,1]
  v_pk_fma_f32 v[26:27], v[26:27], v[8:9], v[8:9] op_sel:[0,0,1] op_sel_hi:[1,0,1]
  v_pk_fma_f32 v[28:29], v[28:29], v[8:9], v[8:9] op_sel:[0,0,1] op_sel_hi:[1,0,1]
  v_pk_fma_f32 v[30:31], v[30:31], v[8:9], v[8:9] op_sel:[0,0,1] op_sel_hi:[1,0,1]
  v_pk_fma_f32 v[32:33], v[32:33], v[8:9], v[8:9] op_sel:[0,0,1] op_sel_hi:[1,0,1]
  v_pk_fma_f32 v[34:35], v[34:35], v[8:9], v[8:9] op_sel:[0,0,1] op_sel_hi:[1,0,1]
  v_pk_fma_f32 v[36:37], v[36:37], v[8:9], v[8:9] op_sel:[0,0,1] op_sel_hi:[1,0,1]
  v_pk_fma_f32 v[38:39], v[38:39], v[8:9], v[8:9] op_sel:[0,0,1] op_sel_hi:[1,0,1]
  v_pk_fma_f32 v[40:41], v[40:41], v[8:9], v[8:9] op_sel:[0,0,1] op_sel_hi:[1,0,1]
  v_pk_fma_f32 v[42:43], v[42:43], v[8:9], v[8:9] op_sel:[0,0,1] op_sel_hi:[1,0,1]
  v_pk_fma_f32 v[44:45], v[44:45], v[8:9], v[8:9] op_sel:[0,0,1] op_sel_hi:[1,0,1]
  v_pk_fma_f32 v[46:47], v[46:47], v[8:9], v[8:9] op_sel:[0,0,1] op_sel_hi:[1,0,1]
  v_pk_fma_f32 v[48:49], v[48:49], v[8:9], v[8:9] op_sel:[0,0,1] op_sel_hi:[1,0,1]
  v_pk_fma_f32 v[50:51], v[50:51], v[8:9], v[8:9] op_sel:[0,0,1] op_sel_hi:[1,0,1]
  v_pk_fma_f32 v[52:53], v[52:53], v[8:9], v[8:9] op_sel:[0,0,1] op_sel_hi:[1,0,1]
  v_pk_fma_f32 v[54:55], v[54:55], v[8:9], v[8:9] op_sel:[0,0,1] op_sel_hi:[1,0,1]
  v_cvt_pk_bf16_f32 v56, v24, v25
  v_cvt_pk_bf16_f32 v57, v26, v27
  v_cvt_pk_bf16_f32 v58, v28, v29
  v_cvt_pk_bf16_f32 v59, v30, v31
  v_cvt_pk_bf16_f32 v60, v32, v33
  v_cvt_pk_bf16_f32 v61, v34, v35
  v_cvt_pk_bf16_f32 v62, v36, v37
  v_cvt_pk_bf16_f32 v63, v38, v39
  v_cvt_pk_bf16_f32 v64, v40, v41
  v_cvt_pk_bf16_f32 v65, v42, v43
  v_cvt_pk_bf16_f32 v66, v44, v45
  v_cvt_pk_bf16_f32 v67, v46, v47
  v_cvt_pk_bf16_f32 v68, v48, v49
  v_cvt_pk_bf16_f32 v69, v50, v51
  v_cvt_pk_bf16_f32 v70, v52, v53
  v_cvt_pk_bf16_f32 v71, v54, v55
  s_mov_b64 exec, vcc
  buffer_store_dwordx4 v[56:59], v23, s[28:31], s32 offen offset:0
  buffer_store_dwordx4 v[60:63], v23, s[28:31], s32 offen offset:32
  buffer_store_dwordx4 v[64:67], v23, s[28:31], s32 offen offset:64
  buffer_store_dwordx4 v[68:71], v23, s[28:31], s32 offen offset:96
  s_mov_b64 exec, -1
  s_branch .g2_kernel_fin
.g2_kernel_svc:
  s_cmp_eq_u32 s16, 5
  s_cbranch_scc1 .g2_kernel_s1
  s_cmp_eq_u32 s16, 6
  s_cbranch_scc1 .g2_kernel_s2
  s_cmp_eq_u32 s16, 7
  s_cbranch_scc1 .g2_kernel_s3
  s_mov_b32 s8, s40
  s_mov_b32 s9, s41
  s_mov_b32 s10, 0x400000
  s_mov_b32 s11, 0x00020000
  s_setprio 3
  v_lshrrev_b32 v20, 3, v2
  v_and_b32 v21, 7, v2
  v_lshrrev_b32 v22, 4, v2
  v_xor_b32 v23, v21, v22
  v_lshlrev_b32 v23, 4, v23
  v_lshl_add_u32 v24, v20, 11, v23
  v_xor_b32 v25, 64, v24
  s_lshl_b32 s32, s17, 18
  v_add_u32 v32, 0, v24
  v_add_u32 v33, 15360, v25
  v_add_u32 v34, 30720, v24
  v_add_u32 v35, 46080, v25
  v_add_u32 v36, 65536, v24
  v_add_u32 v37, 80896, v25
  v_add_u32 v38, 96256, v24
  v_add_u32 v39, 111616, v25
  v_add_u32 v40, 131072, v24
  v_add_u32 v41, 146432, v25
  v_add_u32 v42, 161792, v24
  v_add_u32 v43, 177152, v25
  v_add_u32 v44, 196608, v24
  v_add_u32 v45, 211968, v25
  v_add_u32 v46, 227328, v24
  v_add_u32 v47, 242688, v25
  s_mov_b32 s29, 0
  s_add_u32 m0, s29, 0
  s_waitcnt vmcnt(63)
  buffer_load_dwordx4 v32, s[8:11], s32 offen offset:0 lds
  buffer_load_dwordx4 v33, s[8:11], s32 offen offset:1024 lds
  buffer_load_dwordx4 v34, s[8:11], s32 offen offset:2048 lds
  buffer_load_dwordx4 v35, s[8:11], s32 offen offset:3072 lds
  s_add_u32 m0, s29, 4096
  s_waitcnt vmcnt(63)
  buffer_load_dwordx4 v36, s[8:11], s32 offen offset:0 lds
  buffer_load_dwordx4 v37, s[8:11], s32 offen offset:1024 lds
  buffer_load_dwordx4 v38, s[8:11], s32 offen offset:2048 lds
  buffer_load_dwordx4 v39, s[8:11], s32 offen offset:3072 lds
  s_add_u32 m0, s29, 8192
  s_waitcnt vmcnt(63)
  buffer_load_dwordx4 v40, s[8:11], s32 offen offset:0 lds
  buffer_load_dwordx4 v41, s[8:11], s32 offen offset:1024 lds
  buffer_load_dwordx4 v42, s[8:11], s32 offen offset:2048 lds
  buffer_load_dwordx4 v43, s[8:11], s32 offen offset:3072 lds
  s_add_u32 m0, s29, 12288
  s_waitcnt vmcnt(63)
  buffer_load_dwordx4 v44, s[8:11], s32 offen offset:0 lds
  buffer_load_dwordx4 v45, s[8:11], s32 offen offset:1024 lds
  buffer_load_dwordx4 v46, s[8:11], s32 offen offset:2048 lds
  buffer_load_dwordx4 v47, s[8:11], s32 offen offset:3072 lds
  s_add_u32 s32, s32, 128
  s_mov_b32 s12, s42
  s_mov_b32 s13, s43
  s_mov_b32 s14, 0x600000
  s_mov_b32 s15, 0x00020000
  v_lshrrev_b32 v28, 3, v2
  v_and_b32 v29, 7, v2
  v_bfe_u32 v30, v2, 4, 1
  v_lshlrev_b32 v30, 1, v30
  v_xor_b32 v31, v29, v30
  v_lshlrev_b32 v31, 4, v31
  v_mul_u32_u24 v28, 6144, v28
  v_add_u32 v28, v28, v31
  v_xor_b32 v29, 64, v28
  v_lshlrev_b32 v9, 8, v2
  v_and_b32 v9, 0x300, v9
  v_add_u32 v9, 156416, v9
  v_add_u32 v48, 0, v28
  v_add_u32 v49, 48128, v29
  v_add_u32 v50, 96256, v28
  v_add_u32 v51, 144384, v29
  v_add_u32 v52, 2048, v28
  v_add_u32 v53, 50176, v29
  v_add_u32 v54, 98304, v28
  v_add_u32 v55, 146432, v29
  v_add_u32 v56, 4096, v28
  v_add_u32 v57, 52224, v29
  v_add_u32 v58, 100352, v28
  v_add_u32 v59, 148480, v29
  s_lshl_b32 s36, s18, 7
  s_mov_b32 s30, 0
  s_add_u32 m0, s30, 65536
  s_waitcnt vmcnt(63)
  buffer_load_dwordx4 v48, s[12:15], s36 offen offset:0 lds
  buffer_load_dwordx4 v49, s[12:15], s36 offen offset:1024 lds
  buffer_load_dwordx4 v50, s[12:15], s36 offen offset:2048 lds
  buffer_load_dwordx4 v51, s[12:15], s36 offen offset:3072 lds
  s_add_u32 m0, s30, 69632
  s_waitcnt vmcnt(63)
  buffer_load_dwordx4 v52, s[12:15], s36 offen offset:0 lds
  buffer_load_dwordx4 v53, s[12:15], s36 offen offset:1024 lds
  buffer_load_dwordx4 v54, s[12:15], s36 offen offset:2048 lds
  buffer_load_dwordx4 v55, s[12:15], s36 offen offset:3072 lds
  s_add_u32 m0, s30, 73728
  s_waitcnt vmcnt(63)
  buffer_load_dwordx4 v56, s[12:15], s36 offen offset:0 lds
  buffer_load_dwordx4 v57, s[12:15], s36 offen offset:1024 lds
  buffer_load_dwordx4 v58, s[12:15], s36 offen offset:2048 lds
  buffer_load_dwordx4 v59, s[12:15], s36 offen offset:3072 lds
  s_add_u32 s30, s30, 12288
  s_cmp_eq_u32 s30, 86016
  s_cselect_b32 s30, 0, s30
  s_barrier
  s_mov_b32 s35, .g2_kernel_tab-.g2_kernel_pc+4
  s_mov_b32 s34, -5
  v_mov_b32 v10, 0
  s_mov_b32 m0, 156160
  s_add_u32 s36, s36, 196608
  buffer_load_dword off, s[64:67], s35 lds
  s_add_u32 s35, s35, 4
  s_branch .g2_kernel_p1_o
  .p2align 6
.g2_kernel_p1_l:
  s_waitcnt lgkmcnt(0)
  v_cmp_gt_i32 vcc, s34, v10
  s_cbranch_vccnz .g2_kernel_p1_aw
.g2_kernel_p1_ai:
  s_add_u32 s29, s29, 16384
  s_and_b32 s29, s29, 0xffff
  s_add_u32 m0, s29, 0
  s_waitcnt vmcnt(63)
  buffer_load_dwordx4 v32, s[8:11], s32 offen offset:0 lds
  buffer_load_dwordx4 v33, s[8:11], s32 offen offset:1024 lds
  buffer_load_dwordx4 v34, s[8:11], s32 offen offset:2048 lds
  buffer_load_dwordx4 v35, s[8:11], s32 offen offset:3072 lds
  s_add_u32 m0, s29, 4096
  s_waitcnt vmcnt(63)
  buffer_load_dwordx4 v36, s[8:11], s32 offen offset:0 lds
  buffer_load_dwordx4 v37, s[8:11], s32 offen offset:1024 lds
  buffer_load_dwordx4 v38, s[8:11], s32 offen offset:2048 lds
  buffer_load_dwordx4 v39, s[8:11], s32 offen offset:3072 lds
  s_add_u32 m0, s29, 8192
  s_waitcnt vmcnt(63)
  buffer_load_dwordx4 v40, s[8:11], s32 offen offset:0 lds
  buffer_load_dwordx4 v41, s[8:11], s32 offen offset:1024 lds
  buffer_load_dwordx4 v42, s[8:11], s32 offen offset:2048 lds
  buffer_load_dwordx4 v43, s[8:11], s32 offen offset:3072 lds
  s_add_u32 m0, s29, 12288
  s_waitcnt vmcnt(63)
  buffer_load_dwordx4 v44, s[8:11], s32 offen offset:0 lds
  buffer_load_dwordx4 v45, s[8:11], s32 offen offset:1024 lds
  buffer_load_dwordx4 v46, s[8:11], s32 offen offset:2048 lds
  buffer_load_dwordx4 v47, s[8:11], s32 offen offset:3072 lds
  s_add_u32 s32, s32, 128
  s_add_u32 m0, s30, 65536
  s_waitcnt vmcnt(63)
  buffer_load_dwordx4 v48, s[12:15], s36 offen offset:0 lds
  buffer_load_dwordx4 v49, s[12:15], s36 offen offset:1024 lds
  buffer_load_dwordx4 v50, s[12:15], s36 offen offset:2048 lds
  buffer_load_dwordx4 v51, s[12:15], s36 offen offset:3072 lds
  s_add_u32 m0, s30, 69632
  s_waitcnt vmcnt(63)
  buffer_load_dwordx4 v52, s[12:15], s36 offen offset:0 lds
  buffer_load_dwordx4 v53, s[12:15], s36 offen offset:1024 lds
  buffer_load_dwordx4 v54, s[12:15], s36 offen offset:2048 lds
  buffer_load_dwordx4 v55, s[12:15], s36 offen offset:3072 lds
  s_add_u32 m0, s30, 73728
  s_waitcnt vmcnt(63)
  buffer_load_dwordx4 v56, s[12:15], s36 offen offset:0 lds
  buffer_load_dwordx4 v57, s[12:15], s36 offen offset:1024 lds
  buffer_load_dwordx4 v58, s[12:15], s36 offen offset:2048 lds
  buffer_load_dwordx4 v59, s[12:15], s36 offen offset:3072 lds
  s_add_u32 s30, s30, 12288
  s_cmp_eq_u32 s30, 86016
  s_cselect_b32 s30, 0, s30
  ds_read_b32 v10, v9
  s_mov_b32 m0, 156160
  s_add_u32 s34, s34, 1
  buffer_load_dword off, s[64:67], s35 lds
  s_add_u32 s35, s35, 4
  s_add_u32 s36, s36, 196608
.g2_kernel_p1_o:
  s_waitcnt lgkmcnt(0)
  v_cmp_gt_i32 vcc, s34, v10
  s_cbranch_vccnz .g2_kernel_p1_bw
.g2_kernel_p1_bi:
  s_add_u32 m0, s30, 65536
  s_waitcnt vmcnt(63)
  buffer_load_dwordx4 v48, s[12:15], s36 offen offset:0 lds
  buffer_load_dwordx4 v49, s[12:15], s36 offen offset:1024 lds
  buffer_load_dwordx4 v50, s[12:15], s36 offen offset:2048 lds
  buffer_load_dwordx4 v51, s[12:15], s36 offen offset:3072 lds
  s_add_u32 m0, s30, 69632
  s_waitcnt vmcnt(63)
  buffer_load_dwordx4 v52, s[12:15], s36 offen offset:0 lds
  buffer_load_dwordx4 v53, s[12:15], s36 offen offset:1024 lds
  buffer_load_dwordx4 v54, s[12:15], s36 offen offset:2048 lds
  buffer_load_dwordx4 v55, s[12:15], s36 offen offset:3072 lds
  s_add_u32 m0, s30, 73728
  s_waitcnt vmcnt(63)
  buffer_load_dwordx4 v56, s[12:15], s36 offen offset:0 lds
  buffer_load_dwordx4 v57, s[12:15], s36 offen offset:1024 lds
  buffer_load_dwordx4 v58, s[12:15], s36 offen offset:2048 lds
  buffer_load_dwordx4 v59, s[12:15], s36 offen offset:3072 lds
  s_add_u32 s30, s30, 12288
  s_cmp_eq_u32 s30, 86016
  s_cselect_b32 s30, 0, s30
  ds_read_b32 v10, v9
  s_mov_b32 m0, 156160
  s_add_u32 s34, s34, 1
  buffer_load_dword off, s[64:67], s35 lds
  s_add_u32 s35, s35, 4
  s_add_u32 s36, s36, 196608
  s_cmp_lt_i32 s34, 26
  s_cbranch_scc1 .g2_kernel_p1_l
  s_branch .g2_kernel_v
.g2_kernel_s1:
  s_mov_b32 s8, s40
  s_mov_b32 s9, s41
  s_mov_b32 s10, 0x400000
  s_mov_b32 s11, 0x00020000
  v_lshrrev_b32 v20, 3, v2
  v_and_b32 v21, 7, v2
  v_lshlrev_b32 v21, 4, v21
  v_lshl_add_u32 v21, v20, 11, v21
  s_lshl_b32 s30, s17, 4
  s_add_u32 s30, s30, s18
  s_lshl_b32 s33, s30, 5
  s_lshl_b32 s30, s30, 14
  s_barrier
  s_sleep 30
  buffer_load_dwordx4 v[64:67], v21, s[8:11], s30 offen offset:0
  buffer_load_dwordx4 v[68:71], v21, s[8:11], s30 offen offset:128
  buffer_load_dwordx4 v[72:75], v21, s[8:11], s30 offen offset:256
  buffer_load_dwordx4 v[76:79], v21, s[8:11], s30 offen offset:384
  buffer_load_dwordx4 v[80:83], v21, s[8:11], s30 offen offset:512
  buffer_load_dwordx4 v[84:87], v21, s[8:11], s30 offen offset:640
  buffer_load_dwordx4 v[88:91], v21, s[8:11], s30 offen offset:768
  buffer_load_dwordx4 v[92:95], v21, s[8:11], s30 offen offset:896
  buffer_load_dwordx4 v[96:99], v21, s[8:11], s30 offen offset:1024
  buffer_load_dwordx4 v[100:103], v21, s[8:11], s30 offen offset:1152
  buffer_load_dwordx4 v[104:107], v21, s[8:11], s30 offen offset:1280
  buffer_load_dwordx4 v[108:111], v21, s[8:11], s30 offen offset:1408
  buffer_load_dwordx4 v[112:115], v21, s[8:11], s30 offen offset:1536
  buffer_load_dwordx4 v[116:119], v21, s[8:11], s30 offen offset:1664
  buffer_load_dwordx4 v[120:123], v21, s[8:11], s30 offen offset:1792
  buffer_load_dwordx4 v[124:127], v21, s[8:11], s30 offen offset:1920
  v_mov_b32 v24, 0
  v_mov_b32 v25, 0
  v_mov_b32 v26, 0
  v_mov_b32 v27, 0
  s_waitcnt vmcnt(15)
  v_lshlrev_b32 v22, 16, v64
  v_and_b32 v64, 0xffff0000, v64
  v_add_f32 v24, v24, v22
  v_fmac_f32 v25, v22, v22
  v_add_f32 v26, v26, v64
  v_fmac_f32 v27, v64, v64
  v_lshlrev_b32 v22, 16, v65
  v_and_b32 v65, 0xffff0000, v65
  v_add_f32 v24, v24, v22
  v_fmac_f32 v25, v22, v22
  v_add_f32 v26, v26, v65
  v_fmac_f32 v27, v65, v65
  v_lshlrev_b32 v22, 16, v66
  v_and_b32 v66, 0xffff0000, v66
  v_add_f32 v24, v24, v22
  v_fmac_f32 v25, v22, v22
  v_add_f32 v26, v26, v66
  v_fmac_f32 v27, v66, v66
  v_lshlrev_b32 v22, 16, v67
  v_and_b32 v67, 0xffff0000, v67
  v_add_f32 v24, v24, v22
  v_fmac_f32 v25, v22, v22
  v_add_f32 v26, v26, v67
  v_fmac_f32 v27, v67, v67
  s_waitcnt vmcnt(14)
  v_lshlrev_b32 v22, 16, v68
  v_and_b32 v68, 0xffff0000, v68
  v_add_f32 v24, v24, v22
  v_fmac_f32 v25, v22, v22
  v_add_f32 v26, v26, v68
  v_fmac_f32 v27, v68, v68
  v_lshlrev_b32 v22, 16, v69
  v_and_b32 v69, 0xffff0000, v69
  v_add_f32 v24, v24, v22
  v_fmac_f32 v25, v22, v22
  v_add_f32 v26, v26, v69
  v_fmac_f32 v27, v69, v69
  v_lshlrev_b32 v22, 16, v70
  v_and_b32 v70, 0xffff0000, v70
  v_add_f32 v24, v24, v22
  v_fmac_f32 v25, v22, v22
  v_add_f32 v26, v26, v70
  v_fmac_f32 v27, v70, v70
  v_lshlrev_b32 v22, 16, v71
  v_and_b32 v71, 0xffff0000, v71
  v_add_f32 v24, v24, v22
  v_fmac_f32 v25, v22, v22
  v_add_f32 v26, v26, v71
  v_fmac_f32 v27, v71, v71
  s_waitcnt vmcnt(13)
  v_lshlrev_b32 v22, 16, v72
  v_and_b32 v72, 0xffff0000, v72
  v_add_f32 v24, v24, v22
  v_fmac_f32 v25, v22, v22
  v_add_f32 v26, v26, v72
  v_fmac_f32 v27, v72, v72
  v_lshlrev_b32 v22, 16, v73
  v_and_b32 v73, 0xffff0000, v73
  v_add_f32 v24, v24, v22
  v_fmac_f32 v25, v22, v22
  v_add_f32 v26, v26, v73
  v_fmac_f32 v27, v73, v73
  v_lshlrev_b32 v22, 16, v74
  v_and_b32 v74, 0xffff0000, v74
  v_add_f32 v24, v24, v22
  v_fmac_f32 v25, v22, v22
  v_add_f32 v26, v26, v74
  v_fmac_f32 v27, v74, v74
  v_lshlrev_b32 v22, 16, v75
  v_and_b32 v75, 0xffff0000, v75
  v_add_f32 v24, v24, v22
  v_fmac_f32 v25, v22, v22
  v_add_f32 v26, v26, v75
  v_fmac_f32 v27, v75, v75
  s_waitcnt vmcnt(12)
  v_lshlrev_b32 v22, 16, v76
  v_and_b32 v76, 0xffff0000, v76
  v_add_f32 v24, v24, v22
  v_fmac_f32 v25, v22, v22
  v_add_f32 v26, v26, v76
  v_fmac_f32 v27, v76, v76
  v_lshlrev_b32 v22, 16, v77
  v_and_b32 v77, 0xffff0000, v77
  v_add_f32 v24, v24, v22
  v_fmac_f32 v25, v22, v22
  v_add_f32 v26, v26, v77
  v_fmac_f32 v27, v77, v77
  v_lshlrev_b32 v22, 16, v78
  v_and_b32 v78, 0xffff0000, v78
  v_add_f32 v24, v24, v22
  v_fmac_f32 v25, v22, v22
  v_add_f32 v26, v26, v78
  v_fmac_f32 v27, v78, v78
  v_lshlrev_b32 v22, 16, v79
  v_and_b32 v79, 0xffff0000, v79
  v_add_f32 v24, v24, v22
  v_fmac_f32 v25, v22, v22
  v_add_f32 v26, v26, v79
  v_fmac_f32 v27, v79, v79
  s_waitcnt vmcnt(11)
  v_lshlrev_b32 v22, 16, v80
  v_and_b32 v80, 0xffff0000, v80
  v_add_f32 v24, v24, v22
  v_fmac_f32 v25, v22, v22
  v_add_f32 v26, v26, v80
  v_fmac_f32 v27, v80, v80
  v_lshlrev_b32 v22, 16, v81
  v_and_b32 v81, 0xffff0000, v81
  v_add_f32 v24, v24, v22
  v_fmac_f32 v25, v22, v22
  v_add_f32 v26, v26, v81
  v_fmac_f32 v27, v81, v81
  v_lshlrev_b32 v22, 16, v82
  v_and_b32 v82, 0xffff0000, v82
  v_add_f32 v24, v24, v22
  v_fmac_f32 v25, v22, v22
  v_add_f32 v26, v26, v82
  v_fmac_f32 v27, v82, v82
  v_lshlrev_b32 v22, 16, v83
  v_and_b32 v83, 0xffff0000, v83
  v_add_f32 v24, v24, v22
  v_fmac_f32 v25, v22, v22
  v_add_f32 v26, v26, v83
  v_fmac_f32 v27, v83, v83
  s_waitcnt vmcnt(10)
  v_lshlrev_b32 v22, 16, v84
  v_and_b32 v84, 0xffff0000, v84
  v_add_f32 v24, v24, v22
  v_fmac_f32 v25, v22, v22
  v_add_f32 v26, v26, v84
  v_fmac_f32 v27, v84, v84
  v_lshlrev_b32 v22, 16, v85
  v_and_b32 v85, 0xffff0000, v85
  v_add_f32 v24, v24, v22
  v_fmac_f32 v25, v22, v22
  v_add_f32 v26, v26, v85
  v_fmac_f32 v27, v85, v85
  v_lshlrev_b32 v22, 16, v86
  v_and_b32 v86, 0xffff0000, v86
  v_add_f32 v24, v24, v22
  v_fmac_f32 v25, v22, v22
  v_add_f32 v26, v26, v86
  v_fmac_f32 v27, v86, v86
  v_lshlrev_b32 v22, 16, v87
  v_and_b32 v87, 0xffff0000, v87
  v_add_f32 v24, v24, v22
  v_fmac_f32 v25, v22, v22
  v_add_f32 v26, v26, v87
  v_fmac_f32 v27, v87, v87
  s_waitcnt vmcnt(9)
  v_lshlrev_b32 v22, 16, v88
  v_and_b32 v88, 0xffff0000, v88
  v_add_f32 v24, v24, v22
  v_fmac_f32 v25, v22, v22
  v_add_f32 v26, v26, v88
  v_fmac_f32 v27, v88, v88
  v_lshlrev_b32 v22, 16, v89
  v_and_b32 v89, 0xffff0000, v89
  v_add_f32 v24, v24, v22
  v_fmac_f32 v25, v22, v22
  v_add_f32 v26, v26, v89
  v_fmac_f32 v27, v89, v89
  v_lshlrev_b32 v22, 16, v90
  v_and_b32 v90, 0xffff0000, v90
  v_add_f32 v24, v24, v22
  v_fmac_f32 v25, v22, v22
  v_add_f32 v26, v26, v90
  v_fmac_f32 v27, v90, v90
  v_lshlrev_b32 v22, 16, v91
  v_and_b32 v91, 0xffff0000, v91
  v_add_f32 v24, v24, v22
  v_fmac_f32 v25, v22, v22
  v_add_f32 v26, v26, v91
  v_fmac_f32 v27, v91, v91
  s_waitcnt vmcnt(8)
  v_lshlrev_b32 v22, 16, v92
  v_and_b32 v92, 0xffff0000, v92
  v_add_f32 v24, v24, v22
  v_fmac_f32 v25, v22, v22
  v_add_f32 v26, v26, v92
  v_fmac_f32 v27, v92, v92
  v_lshlrev_b32 v22, 16, v93
  v_and_b32 v93, 0xffff0000, v93
  v_add_f32 v24, v24, v22
  v_fmac_f32 v25, v22, v22
  v_add_f32 v26, v26, v93
  v_fmac_f32 v27, v93, v93
  v_lshlrev_b32 v22, 16, v94
  v_and_b32 v94, 0xffff0000, v94
  v_add_f32 v24, v24, v22
  v_fmac_f32 v25, v22, v22
  v_add_f32 v26, v26, v94
  v_fmac_f32 v27, v94, v94
  v_lshlrev_b32 v22, 16, v95
  v_and_b32 v95, 0xffff0000, v95
  v_add_f32 v24, v24, v22
  v_fmac_f32 v25, v22, v22
  v_add_f32 v26, v26, v95
  v_fmac_f32 v27, v95, v95
  s_waitcnt vmcnt(7)
  v_lshlrev_b32 v22, 16, v96
  v_and_b32 v96, 0xffff0000, v96
  v_add_f32 v24, v24, v22
  v_fmac_f32 v25, v22, v22
  v_add_f32 v26, v26, v96
  v_fmac_f32 v27, v96, v96
  v_lshlrev_b32 v22, 16, v97
  v_and_b32 v97, 0xffff0000, v97
  v_add_f32 v24, v24, v22
  v_fmac_f32 v25, v22, v22
  v_add_f32 v26, v26, v97
  v_fmac_f32 v27, v97, v97
  v_lshlrev_b32 v22, 16, v98
  v_and_b32 v98, 0xffff0000, v98
  v_add_f32 v24, v24, v22
  v_fmac_f32 v25, v22, v22
  v_add_f32 v26, v26, v98
  v_fmac_f32 v27, v98, v98
  v_lshlrev_b32 v22, 16, v99
  v_and_b32 v99, 0xffff0000, v99
  v_add_f32 v24, v24, v22
  v_fmac_f32 v25, v22, v22
  v_add_f32 v26, v26, v99
  v_fmac_f32 v27, v99, v99
  s_waitcnt vmcnt(6)
  v_lshlrev_b32 v22, 16, v100
  v_and_b32 v100, 0xffff0000, v100
  v_add_f32 v24, v24, v22
  v_fmac_f32 v25, v22, v22
  v_add_f32 v26, v26, v100
  v_fmac_f32 v27, v100, v100
  v_lshlrev_b32 v22, 16, v101
  v_and_b32 v101, 0xffff0000, v101
  v_add_f32 v24, v24, v22
  v_fmac_f32 v25, v22, v22
  v_add_f32 v26, v26, v101
  v_fmac_f32 v27, v101, v101
  v_lshlrev_b32 v22, 16, v102
  v_and_b32 v102, 0xffff0000, v102
  v_add_f32 v24, v24, v22
  v_fmac_f32 v25, v22, v22
  v_add_f32 v26, v26, v102
  v_fmac_f32 v27, v102, v102
  v_lshlrev_b32 v22, 16, v103
  v_and_b32 v103, 0xffff0000, v103
  v_add_f32 v24, v24, v22
  v_fmac_f32 v25, v22, v22
  v_add_f32 v26, v26, v103
  v_fmac_f32 v27, v103, v103
  s_waitcnt vmcnt(5)
  v_lshlrev_b32 v22, 16, v104
  v_and_b32 v104, 0xffff0000, v104
  v_add_f32 v24, v24, v22
  v_fmac_f32 v25, v22, v22
  v_add_f32 v26, v26, v104
  v_fmac_f32 v27, v104, v104
  v_lshlrev_b32 v22, 16, v105
  v_and_b32 v105, 0xffff0000, v105
  v_add_f32 v24, v24, v22
  v_fmac_f32 v25, v22, v22
  v_add_f32 v26, v26, v105
  v_fmac_f32 v27, v105, v105
  v_lshlrev_b32 v22, 16, v106
  v_and_b32 v106, 0xffff0000, v106
  v_add_f32 v24, v24, v22
  v_fmac_f32 v25, v22, v22
  v_add_f32 v26, v26, v106
  v_fmac_f32 v27, v106, v106
  v_lshlrev_b32 v22, 16, v107
  v_and_b32 v107, 0xffff0000, v107
  v_add_f32 v24, v24, v22
  v_fmac_f32 v25, v22, v22
  v_add_f32 v26, v26, v107
  v_fmac_f32 v27, v107, v107
  s_waitcnt vmcnt(4)
  v_lshlrev_b32 v22, 16, v108
  v_and_b32 v108, 0xffff0000, v108
  v_add_f32 v24, v24, v22
  v_fmac_f32 v25, v22, v22
  v_add_f32 v26, v26, v108
  v_fmac_f32 v27, v108, v108
  v_lshlrev_b32 v22, 16, v109
  v_and_b32 v109, 0xffff0000, v109
  v_add_f32 v24, v24, v22
  v_fmac_f32 v25, v22, v22
  v_add_f32 v26, v26, v109
  v_fmac_f32 v27, v109, v109
  v_lshlrev_b32 v22, 16, v110
  v_and_b32 v110, 0xffff0000, v110
  v_add_f32 v24, v24, v22
  v_fmac_f32 v25, v22, v22
  v_add_f32 v26, v26, v110
  v_fmac_f32 v27, v110, v110
  v_lshlrev_b32 v22, 16, v111
  v_and_b32 v111, 0xffff0000, v111
  v_add_f32 v24, v24, v22
  v_fmac_f32 v25, v22, v22
  v_add_f32 v26, v26, v111
  v_fmac_f32 v27, v111, v111
  s_waitcnt vmcnt(3)
  v_lshlrev_b32 v22, 16, v112
  v_and_b32 v112, 0xffff0000, v112
  v_add_f32 v24, v24, v22
  v_fmac_f32 v25, v22, v22
  v_add_f32 v26, v26, v112
  v_fmac_f32 v27, v112, v112
  v_lshlrev_b32 v22, 16, v113
  v_and_b32 v113, 0xffff0000, v113
  v_add_f32 v24, v24, v22
  v_fmac_f32 v25, v22, v22
  v_add_f32 v26, v26, v113
  v_fmac_f32 v27, v113, v113
  v_lshlrev_b32 v22, 16, v114
  v_and_b32 v114, 0xffff0000, v114
  v_add_f32 v24, v24, v22
  v_fmac_f32 v25, v22, v22
  v_add_f32 v26, v26, v114
  v_fmac_f32 v27, v114, v114
  v_lshlrev_b32 v22, 16, v115
  v_and_b32 v115, 0xffff0000, v115
  v_add_f32 v24, v24, v22
  v_fmac_f32 v25, v22, v22
  v_add_f32 v26, v26, v115
  v_fmac_f32 v27, v115, v115
  s_waitcnt vmcnt(2)
  v_lshlrev_b32 v22, 16, v116
  v_and_b32 v116, 0xffff0000, v116
  v_add_f32 v24, v24, v22
  v_fmac_f32 v25, v22, v22
  v_add_f32 v26, v26, v116
  v_fmac_f32 v27, v116, v116
  v_lshlrev_b32 v22, 16, v117
  v_and_b32 v117, 0xffff0000, v117
  v_add_f32 v24, v24, v22
  v_fmac_f32 v25, v22, v22
  v_add_f32 v26, v26, v117
  v_fmac_f32 v27, v117, v117
  v_lshlrev_b32 v22, 16, v118
  v_and_b32 v118, 0xffff0000, v118
  v_add_f32 v24, v24, v22
  v_fmac_f32 v25, v22, v22
  v_add_f32 v26, v26, v118
  v_fmac_f32 v27, v118, v118
  v_lshlrev_b32 v22, 16, v119
  v_and_b32 v119, 0xffff0000, v119
  v_add_f32 v24, v24, v22
  v_fmac_f32 v25, v22, v22
  v_add_f32 v26, v26, v119
  v_fmac_f32 v27, v119, v119
  s_waitcnt vmcnt(1)
  v_lshlrev_b32 v22, 16, v120
  v_and_b32 v120, 0xffff0000, v120
  v_add_f32 v24, v24, v22
  v_fmac_f32 v25, v22, v22
  v_add_f32 v26, v26, v120
  v_fmac_f32 v27, v120, v120
  v_lshlrev_b32 v22, 16, v121
  v_and_b32 v121, 0xffff0000, v121
  v_add_f32 v24, v24, v22
  v_fmac_f32 v25, v22, v22
  v_add_f32 v26, v26, v121
  v_fmac_f32 v27, v121, v121
  v_lshlrev_b32 v22, 16, v122
  v_and_b32 v122, 0xffff0000, v122
  v_add_f32 v24, v24, v22
  v_fmac_f32 v25, v22, v22
  v_add_f32 v26, v26, v122
  v_fmac_f32 v27, v122, v122
  v_lshlrev_b32 v22, 16, v123
  v_and_b32 v123, 0xffff0000, v123
  v_add_f32 v24, v24, v22
  v_fmac_f32 v25, v22, v22
  v_add_f32 v26, v26, v123
  v_fmac_f32 v27, v123, v123
  s_waitcnt vmcnt(0)
  v_lshlrev_b32 v22, 16, v124
  v_and_b32 v124, 0xffff0000, v124
  v_add_f32 v24, v24, v22
  v_fmac_f32 v25, v22, v22
  v_add_f32 v26, v26, v124
  v_fmac_f32 v27, v124, v124
  v_lshlrev_b32 v22, 16, v125
  v_and_b32 v125, 0xffff0000, v125
  v_add_f32 v24, v24, v22
  v_fmac_f32 v25, v22, v22
  v_add_f32 v26, v26, v125
  v_fmac_f32 v27, v125, v125
  v_lshlrev_b32 v22, 16, v126
  v_and_b32 v126, 0xffff0000, v126
  v_add_f32 v24, v24, v22
  v_fmac_f32 v25, v22, v22
  v_add_f32 v26, v26, v126
  v_fmac_f32 v27, v126, v126
  v_lshlrev_b32 v22, 16, v127
  v_and_b32 v127, 0xffff0000, v127
  v_add_f32 v24, v24, v22
  v_fmac_f32 v25, v22, v22
  v_add_f32 v26, v26, v127
  v_fmac_f32 v27, v127, v127
  v_add_f32 v24, v24, v26
  v_add_f32 v25, v25, v27
  s_nop 0
  v_add_f32 v24, v24, v24 quad_perm:[1,0,3,2] row_mask:0xf bank_mask:0xf
  v_add_f32 v25, v25, v25 quad_perm:[1,0,3,2] row_mask:0xf bank_mask:0xf
  s_nop 0
  v_add_f32 v24, v24, v24 quad_perm:[2,3,0,1] row_mask:0xf bank_mask:0xf
  v_add_f32 v25, v25, v25 quad_perm:[2,3,0,1] row_mask:0xf bank_mask:0xf
  s_nop 0
  v_add_f32 v24, v24, v24 row_half_mirror row_mask:0xf bank_mask:0xf
  v_add_f32 v25, v25, v25 row_half_mirror row_mask:0xf bank_mask:0xf
  v_mov_b32 v26, 0.0009765625
  v_mul_f32 v24, v26, v24
  v_mul_f32 v27, v24, v24
  v_fma_f32 v25, v25, v26, -v27
  v_max_f32 v25, 0, v25
  v_add_f32 v25, 1e-05, v25
  v_rsq_f32 v25, v25
  v_lshlrev_b32 v20, 2, v20
  v_mul_f32 v24, v24, v25
  v_sub_f32 v24, 0, v24
  s_add_u32 s33, s33, 0x3070000
  s_add_u32 s34, s33, 0x2000
  s_mov_b32 exec_lo, 0x01010101
  s_mov_b32 exec_hi, 0x01010101
  buffer_store_dword v25, v20, s[4:7], s33 offen sc1
  buffer_store_dword v24, v20, s[4:7], s34 offen sc1
  s_mov_b64 exec, -1
  s_mov_b32 s12, s58
  s_mov_b32 s13, s59
  s_mov_b32 s14, 0x100
  s_mov_b32 s15, 0x00020000
  s_mov_b32 s38, 0
  s_mov_b64 exec, 1
.g2_kernel_gt6:
  buffer_load_dword v6, v4, s[12:15], 0 offen sc1
  s_add_u32 s38, s38, 1
  s_waitcnt vmcnt(0)
  v_cmp_eq_u32 vcc, 0x60, v6
  s_cbranch_vccnz .g2_kernel_gt6d
  s_sleep 8
  s_cmp_lt_u32 s38, 131072
  s_cbranch_scc1 .g2_kernel_gt6
.g2_kernel_gt6d:
  s_mov_b64 exec, -1
  v_mov_b32 v6, s70
  s_mov_b64 exec, 1
  buffer_store_dword v6, v4, s[4:7], s19 offen offset:12 sc1
  s_mov_b64 exec, -1
  v_mov_b32 v6, 155648
  s_mov_b32 s38, 0
.g2_kernel_wg7:
  ds_read_b32 v7, v6 offset:512
  s_add_u32 s38, s38, 1
  s_waitcnt lgkmcnt(0)
  v_cmp_le_u32 vcc, 27, v7
  s_cbranch_vccnz .g2_kernel_wg7d
  s_sleep 4
  s_cmp_lt_u32 s38, 524288
  s_cbranch_scc1 .g2_kernel_wg7
.g2_kernel_wg7d:
  s_and_b32 s31, s19, 0xffffe000
  s_add_u32 s31, s31, 12
  v_and_b32 v6, 15, v2
  v_lshlrev_b32 v6, 9, v6
  v_lshrrev_b32 v7, 4, v2
  v_lshl_add_u32 v6, v7, 7, v6
  v_lshlrev_b32 v7, 2, v2
  v_add_u32 v7, 157952, v7
  s_mov_b32 m0, 157952
  s_mov_b32 s38, 0
  s_bfm_b64 exec, 16, 0
.g2_kernel_pa8:
  buffer_load_dword v6, s[4:7], s31 offen sc1 lds
  s_add_u32 s38, s38, 1
  s_waitcnt vmcnt(0)
  ds_read_b32 v8, v7
  s_waitcnt lgkmcnt(0)
  v_cmp_ge_u32 vcc, s62, v8
  s_cbranch_vccz .g2_kernel_pa8d
  s_mov_b64 exec, vcc
  s_sleep 16
  s_cmp_lt_u32 s38, 131072
  s_cbranch_scc1 .g2_kernel_pa8
.g2_kernel_pa8d:
  s_mov_b64 exec, -1
  s_lshl_b32 s33, s17, 9
  s_add_u32 s33, s33, 0x3070000
  s_add_u32 s34, s33, 0x2000
  s_mov_b32 exec_hi, 0
  s_mov_b32 m0, 158464
  s_nop 0
  buffer_load_dwordx4 v3, s[4:7], s33 offen sc1 lds
  s_mov_b32 m0, 158976
  s_nop 0
  buffer_load_dwordx4 v3, s[4:7], s34 offen sc1 lds
  s_mov_b64 exec, -1
  v_mov_b32 v20, 1.0
  v_mov_b32 v21, 1.0
  v_mov_b32 v22, 0
  v_mov_b32 v23, 0
  v_lshlrev_b32 v24, 3, v2
  v_add_u32 v24, 155648, v24
  v_mov_b32 v6, 155648
  s_mov_b32 s38, 0
.g2_kernel_wg9:
  ds_read_b32 v7, v6 offset:512
  s_add_u32 s38, s38, 1
  s_waitcnt lgkmcnt(0)
  v_cmp_le_u32 vcc, 32, v7
  s_cbranch_vccnz .g2_kernel_wg9d
  s_sleep 2
  s_cmp_lt_u32 s38, 524288
  s_cbranch_scc1 .g2_kernel_wg9
.g2_kernel_wg9d:
  ds_write_b64 v24, v[20:21] offset:3840
  ds_write_b64 v24, v[22:23] offset:4352
  v_lshlrev_b32 v24, 2, v2
  v_add_u32 v24, 155648, v24
  ds_write_b32 v24, v4 offset:2304
  s_waitcnt vmcnt(0)
  v_mov_b32 v6, s71
  s_mov_b64 exec, 1
  ds_add_u32 v6, v5 offset:0
  s_mov_b64 exec, -1
  s_branch .g2_kernel_v
.g2_kernel_s2:
  s_mov_b32 s8, s42
  s_mov_b32 s9, s43
  s_mov_b32 s10, 0x600000
  s_mov_b32 s11, 0x00020000
  v_lshrrev_b32 v20, 3, v2
  v_and_b32 v21, 7, v2
  v_mul_u32_u24 v20, 6144, v20
  v_lshl_add_u32 v20, v21, 4, v20
  s_mul_i32 s30, s17, 393216
  s_lshl_b32 s31, s18, 7
  s_add_u32 s30, s30, s31
  s_add_u32 s31, s30, 4096
  s_barrier
  s_sleep 30
  buffer_load_dwordx4 v[64:67], v20, s[8:11], s30 offen
  buffer_load_dwordx4 v[68:71], v20, s[8:11], s30 offen offset:2048
  buffer_load_dwordx4 v[72:75], v20, s[8:11], s31 offen
  s_add_u32 s30, s30, 49152
  s_add_u32 s31, s31, 49152
  buffer_load_dwordx4 v[76:79], v20, s[8:11], s30 offen
  buffer_load_dwordx4 v[80:83], v20, s[8:11], s30 offen offset:2048
  buffer_load_dwordx4 v[84:87], v20, s[8:11], s31 offen
  s_add_u32 s30, s30, 49152
  s_add_u32 s31, s31, 49152
  buffer_load_dwordx4 v[88:91], v20, s[8:11], s30 offen
  buffer_load_dwordx4 v[92:95], v20, s[8:11], s30 offen offset:2048
  buffer_load_dwordx4 v[96:99], v20, s[8:11], s31 offen
  s_add_u32 s30, s30, 49152
  s_add_u32 s31, s31, 49152
  buffer_load_dwordx4 v[100:103], v20, s[8:11], s30 offen
  buffer_load_dwordx4 v[104:107], v20, s[8:11], s30 offen offset:2048
  buffer_load_dwordx4 v[108:111], v20, s[8:11], s31 offen
  s_add_u32 s30, s30, 49152
  s_add_u32 s31, s31, 49152
  buffer_load_dwordx4 v[112:115], v20, s[8:11], s30 offen
  buffer_load_dwordx4 v[116:119], v20, s[8:11], s30 offen offset:2048
  buffer_load_dwordx4 v[120:123], v20, s[8:11], s31 offen
  s_add_u32 s30, s30, 49152
  s_add_u32 s31, s31, 49152
  buffer_load_dwordx4 v[124:127], v20, s[8:11], s30 offen
  buffer_load_dwordx4 v[128:131], v20, s[8:11], s30 offen offset:2048
  buffer_load_dwordx4 v[132:135], v20, s[8:11], s31 offen
  s_add_u32 s30, s30, 49152
  s_add_u32 s31, s31, 49152
  buffer_load_dwordx4 v[136:139], v20, s[8:11], s30 offen
  buffer_load_dwordx4 v[140:143], v20, s[8:11], s30 offen offset:2048
  buffer_load_dwordx4 v[144:147], v20, s[8:11], s31 offen
  s_add_u32 s30, s30, 49152
  s_add_u32 s31, s31, 49152
  buffer_load_dwordx4 v[148:151], v20, s[8:11], s30 offen
  buffer_load_dwordx4 v[152:155], v20, s[8:11], s30 offen offset:2048
  buffer_load_dwordx4 v[156:159], v20, s[8:11], s31 offen
  s_add_u32 s30, s30, 49152
  s_add_u32 s31, s31, 49152
  v_lshlrev_b32 v21, 5, v21
  v_lshrrev_b32 v22, 5, v2
  v_lshl_add_u32 v21, v22, 4, v21
  v_bfe_u32 v22, v2, 4, 1
  v_lshl_add_u32 v21, v22, 3, v21
  s_lshl_b32 s30, s18, 4
  s_add_u32 s30, s30, s17
  s_mul_i32 s30, s30, 768
  s_add_u32 s30, s30, 0x3080000
  s_waitcnt vmcnt(23)
  v_lshlrev_b32 v160, 16, v64
  v_and_b32 v161, 0xffff0000, v64
  v_lshlrev_b32 v162, 16, v65
  v_and_b32 v163, 0xffff0000, v65
  v_lshlrev_b32 v164, 16, v66
  v_and_b32 v165, 0xffff0000, v66
  v_lshlrev_b32 v166, 16, v67
  v_and_b32 v167, 0xffff0000, v67
  s_waitcnt vmcnt(22)
  v_lshlrev_b32 v168, 16, v68
  v_and_b32 v169, 0xffff0000, v68
  v_lshlrev_b32 v170, 16, v69
  v_and_b32 v171, 0xffff0000, v69
  v_lshlrev_b32 v172, 16, v70
  v_and_b32 v173, 0xffff0000, v70
  v_lshlrev_b32 v174, 16, v71
  v_and_b32 v175, 0xffff0000, v71
  s_waitcnt vmcnt(21)
  v_lshlrev_b32 v176, 16, v72
  v_and_b32 v177, 0xffff0000, v72
  v_lshlrev_b32 v178, 16, v73
  v_and_b32 v179, 0xffff0000, v73
  v_lshlrev_b32 v180, 16, v74
  v_and_b32 v181, 0xffff0000, v74
  v_lshlrev_b32 v182, 16, v75
  v_and_b32 v183, 0xffff0000, v75
  s_waitcnt vmcnt(20)
  v_lshlrev_b32 v184, 16, v76
  v_and_b32 v185, 0xffff0000, v76
  v_lshlrev_b32 v186, 16, v77
  v_and_b32 v187, 0xffff0000, v77
  v_lshlrev_b32 v188, 16, v78
  v_and_b32 v189, 0xffff0000, v78
  v_lshlrev_b32 v190, 16, v79
  v_and_b32 v191, 0xffff0000, v79
  v_add_f32 v160, v160, v184
  v_add_f32 v161, v161, v185
  v_add_f32 v162, v162, v186
  v_add_f32 v163, v163, v187
  v_add_f32 v164, v164, v188
  v_add_f32 v165, v165, v189
  v_add_f32 v166, v166, v190
  v_add_f32 v167, v167, v191
  s_waitcnt vmcnt(19)
  v_lshlrev_b32 v184, 16, v80
  v_and_b32 v185, 0xffff0000, v80
  v_lshlrev_b32 v186, 16, v81
  v_and_b32 v187, 0xffff0000, v81
  v_lshlrev_b32 v188, 16, v82
  v_and_b32 v189, 0xffff0000, v82
  v_lshlrev_b32 v190, 16, v83
  v_and_b32 v191, 0xffff0000, v83
  v_add_f32 v168, v168, v184
  v_add_f32 v169, v169, v185
  v_add_f32 v170, v170, v186
  v_add_f32 v171, v171, v187
  v_add_f32 v172, v172, v188
  v_add_f32 v173, v173, v189
  v_add_f32 v174, v174, v190
  v_add_f32 v175, v175, v191
  s_waitcnt vmcnt(18)
  v_lshlrev_b32 v184, 16, v84
  v_and_b32 v185, 0xffff0000, v84
  v_lshlrev_b32 v186, 16, v85
  v_and_b32 v187, 0xffff0000, v85
  v_lshlrev_b32 v188, 16, v86
  v_and_b32 v189, 0xffff0000, v86
  v_lshlrev_b32 v190, 16, v87
  v_and_b32 v191, 0xffff0000, v87
  v_add_f32 v176, v176, v184
  v_add_f32 v177, v177, v185
  v_add_f32 v178, v178, v186
  v_add_f32 v179, v179, v187
  v_add_f32 v180, v180, v188
  v_add_f32 v181, v181, v189
  v_add_f32 v182, v182, v190
  v_add_f32 v183, v183, v191
  s_waitcnt vmcnt(17)
  v_lshlrev_b32 v184, 16, v88
  v_and_b32 v185, 0xffff0000, v88
  v_lshlrev_b32 v186, 16, v89
  v_and_b32 v187, 0xffff0000, v89
  v_lshlrev_b32 v188, 16, v90
  v_and_b32 v189, 0xffff0000, v90
  v_lshlrev_b32 v190, 16, v91
  v_and_b32 v191, 0xffff0000, v91
  v_add_f32 v160, v160, v184
  v_add_f32 v161, v161, v185
  v_add_f32 v162, v162, v186
  v_add_f32 v163, v163, v187
  v_add_f32 v164, v164, v188
  v_add_f32 v165, v165, v189
  v_add_f32 v166, v166, v190
  v_add_f32 v167, v167, v191
  s_waitcnt vmcnt(16)
  v_lshlrev_b32 v184, 16, v92
  v_and_b32 v185, 0xffff0000, v92
  v_lshlrev_b32 v186, 16, v93
  v_and_b32 v187, 0xffff0000, v93
  v_lshlrev_b32 v188, 16, v94
  v_and_b32 v189, 0xffff0000, v94
  v_lshlrev_b32 v190, 16, v95
  v_and_b32 v191, 0xffff0000, v95
  v_add_f32 v168, v168, v184
  v_add_f32 v169, v169, v185
  v_add_f32 v170, v170, v186
  v_add_f32 v171, v171, v187
  v_add_f32 v172, v172, v188
  v_add_f32 v173, v173, v189
  v_add_f32 v174, v174, v190
  v_add_f32 v175, v175, v191
  s_waitcnt vmcnt(15)
  v_lshlrev_b32 v184, 16, v96
  v_and_b32 v185, 0xffff0000, v96
  v_lshlrev_b32 v186, 16, v97
  v_and_b32 v187, 0xffff0000, v97
  v_lshlrev_b32 v188, 16, v98
  v_and_b32 v189, 0xffff0000, v98
  v_lshlrev_b32 v190, 16, v99
  v_and_b32 v191, 0xffff0000, v99
  v_add_f32 v176, v176, v184
  v_add_f32 v177, v177, v185
  v_add_f32 v178, v178, v186
  v_add_f32 v179, v179, v187
  v_add_f32 v180, v180, v188
  v_add_f32 v181, v181, v189
  v_add_f32 v182, v182, v190
  v_add_f32 v183, v183, v191
  s_waitcnt vmcnt(14)
  v_lshlrev_b32 v184, 16, v100
  v_and_b32 v185, 0xffff0000, v100
  v_lshlrev_b32 v186, 16, v101
  v_and_b32 v187, 0xffff0000, v101
  v_lshlrev_b32 v188, 16, v102
  v_and_b32 v189, 0xffff0000, v102
  v_lshlrev_b32 v190, 16, v103
  v_and_b32 v191, 0xffff0000, v103
  v_add_f32 v160, v160, v184
  v_add_f32 v161, v161, v185
  v_add_f32 v162, v162, v186
  v_add_f32 v163, v163, v187
  v_add_f32 v164, v164, v188
  v_add_f32 v165, v165, v189
  v_add_f32 v166, v166, v190
  v_add_f32 v167, v167, v191
  s_waitcnt vmcnt(13)
  v_lshlrev_b32 v184, 16, v104
  v_and_b32 v185, 0xffff0000, v104
  v_lshlrev_b32 v186, 16, v105
  v_and_b32 v187, 0xffff0000, v105
  v_lshlrev_b32 v188, 16, v106
  v_and_b32 v189, 0xffff0000, v106
  v_lshlrev_b32 v190, 16, v107
  v_and_b32 v191, 0xffff0000, v107
  v_add_f32 v168, v168, v184
  v_add_f32 v169, v169, v185
  v_add_f32 v170, v170, v186
  v_add_f32 v171, v171, v187
  v_add_f32 v172, v172, v188
  v_add_f32 v173, v173, v189
  v_add_f32 v174, v174, v190
  v_add_f32 v175, v175, v191
  s_waitcnt vmcnt(12)
  v_lshlrev_b32 v184, 16, v108
  v_and_b32 v185, 0xffff0000, v108
  v_lshlrev_b32 v186, 16, v109
  v_and_b32 v187, 0xffff0000, v109
  v_lshlrev_b32 v188, 16, v110
  v_and_b32 v189, 0xffff0000, v110
  v_lshlrev_b32 v190, 16, v111
  v_and_b32 v191, 0xffff0000, v111
  v_add_f32 v176, v176, v184
  v_add_f32 v177, v177, v185
  v_add_f32 v178, v178, v186
  v_add_f32 v179, v179, v187
  v_add_f32 v180, v180, v188
  v_add_f32 v181, v181, v189
  v_add_f32 v182, v182, v190
  v_add_f32 v183, v183, v191
  s_waitcnt vmcnt(11)
  v_lshlrev_b32 v184, 16, v112
  v_and_b32 v185, 0xffff0000, v112
  v_lshlrev_b32 v186, 16, v113
  v_and_b32 v187, 0xffff0000, v113
  v_lshlrev_b32 v188, 16, v114
  v_and_b32 v189, 0xffff0000, v114
  v_lshlrev_b32 v190, 16, v115
  v_and_b32 v191, 0xffff0000, v115
  v_add_f32 v160, v160, v184
  v_add_f32 v161, v161, v185
  v_add_f32 v162, v162, v186
  v_add_f32 v163, v163, v187
  v_add_f32 v164, v164, v188
  v_add_f32 v165, v165, v189
  v_add_f32 v166, v166, v190
  v_add_f32 v167, v167, v191
  s_waitcnt vmcnt(10)
  v_lshlrev_b32 v184, 16, v116
  v_and_b32 v185, 0xffff0000, v116
  v_lshlrev_b32 v186, 16, v117
  v_and_b32 v187, 0xffff0000, v117
  v_lshlrev_b32 v188, 16, v118
  v_and_b32 v189, 0xffff0000, v118
  v_lshlrev_b32 v190, 16, v119
  v_and_b32 v191, 0xffff0000, v119
  v_add_f32 v168, v168, v184
  v_add_f32 v169, v169, v185
  v_add_f32 v170, v170, v186
  v_add_f32 v171, v171, v187
  v_add_f32 v172, v172, v188
  v_add_f32 v173, v173, v189
  v_add_f32 v174, v174, v190
  v_add_f32 v175, v175, v191
  s_waitcnt vmcnt(9)
  v_lshlrev_b32 v184, 16, v120
  v_and_b32 v185, 0xffff0000, v120
  v_lshlrev_b32 v186, 16, v121
  v_and_b32 v187, 0xffff0000, v121
  v_lshlrev_b32 v188, 16, v122
  v_and_b32 v189, 0xffff0000, v122
  v_lshlrev_b32 v190, 16, v123
  v_and_b32 v191, 0xffff0000, v123
  v_add_f32 v176, v176, v184
  v_add_f32 v177, v177, v185
  v_add_f32 v178, v178, v186
  v_add_f32 v179, v179, v187
  v_add_f32 v180, v180, v188
  v_add_f32 v181, v181, v189
  v_add_f32 v182, v182, v190
  v_add_f32 v183, v183, v191
  s_waitcnt vmcnt(8)
  v_lshlrev_b32 v184, 16, v124
  v_and_b32 v185, 0xffff0000, v124
  v_lshlrev_b32 v186, 16, v125
  v_and_b32 v187, 0xffff0000, v125
  v_lshlrev_b32 v188, 16, v126
  v_and_b32 v189, 0xffff0000, v126
  v_lshlrev_b32 v190, 16, v127
  v_and_b32 v191, 0xffff0000, v127
  v_add_f32 v160, v160, v184
  v_add_f32 v161, v161, v185
  v_add_f32 v162, v162, v186
  v_add_f32 v163, v163, v187
  v_add_f32 v164, v164, v188
  v_add_f32 v165, v165, v189
  v_add_f32 v166, v166, v190
  v_add_f32 v167, v167, v191
  s_waitcnt vmcnt(7)
  v_lshlrev_b32 v184, 16, v128
  v_and_b32 v185, 0xffff0000, v128
  v_lshlrev_b32 v186, 16, v129
  v_and_b32 v187, 0xffff0000, v129
  v_lshlrev_b32 v188, 16, v130
  v_and_b32 v189, 0xffff0000, v130
  v_lshlrev_b32 v190, 16, v131
  v_and_b32 v191, 0xffff0000, v131
  v_add_f32 v168, v168, v184
  v_add_f32 v169, v169, v185
  v_add_f32 v170, v170, v186
  v_add_f32 v171, v171, v187
  v_add_f32 v172, v172, v188
  v_add_f32 v173, v173, v189
  v_add_f32 v174, v174, v190
  v_add_f32 v175, v175, v191
  s_waitcnt vmcnt(6)
  v_lshlrev_b32 v184, 16, v132
  v_and_b32 v185, 0xffff0000, v132
  v_lshlrev_b32 v186, 16, v133
  v_and_b32 v187, 0xffff0000, v133
  v_lshlrev_b32 v188, 16, v134
  v_and_b32 v189, 0xffff0000, v134
  v_lshlrev_b32 v190, 16, v135
  v_and_b32 v191, 0xffff0000, v135
  v_add_f32 v176, v176, v184
  v_add_f32 v177, v177, v185
  v_add_f32 v178, v178, v186
  v_add_f32 v179, v179, v187
  v_add_f32 v180, v180, v188
  v_add_f32 v181, v181, v189
  v_add_f32 v182, v182, v190
  v_add_f32 v183, v183, v191
  s_waitcnt vmcnt(5)
  v_lshlrev_b32 v184, 16, v136
  v_and_b32 v185, 0xffff0000, v136
  v_lshlrev_b32 v186, 16, v137
  v_and_b32 v187, 0xffff0000, v137
  v_lshlrev_b32 v188, 16, v138
  v_and_b32 v189, 0xffff0000, v138
  v_lshlrev_b32 v190, 16, v139
  v_and_b32 v191, 0xffff0000, v139
  v_add_f32 v160, v160, v184
  v_add_f32 v161, v161, v185
  v_add_f32 v162, v162, v186
  v_add_f32 v163, v163, v187
  v_add_f32 v164, v164, v188
  v_add_f32 v165, v165, v189
  v_add_f32 v166, v166, v190
  v_add_f32 v167, v167, v191
  s_waitcnt vmcnt(4)
  v_lshlrev_b32 v184, 16, v140
  v_and_b32 v185, 0xffff0000, v140
  v_lshlrev_b32 v186, 16, v141
  v_and_b32 v187, 0xffff0000, v141
  v_lshlrev_b32 v188, 16, v142
  v_and_b32 v189, 0xffff0000, v142
  v_lshlrev_b32 v190, 16, v143
  v_and_b32 v191, 0xffff0000, v143
  v_add_f32 v168, v168, v184
  v_add_f32 v169, v169, v185
  v_add_f32 v170, v170, v186
  v_add_f32 v171, v171, v187
  v_add_f32 v172, v172, v188
  v_add_f32 v173, v173, v189
  v_add_f32 v174, v174, v190
  v_add_f32 v175, v175, v191
  s_waitcnt vmcnt(3)
  v_lshlrev_b32 v184, 16, v144
  v_and_b32 v185, 0xffff0000, v144
  v_lshlrev_b32 v186, 16, v145
  v_and_b32 v187, 0xffff0000, v145
  v_lshlrev_b32 v188, 16, v146
  v_and_b32 v189, 0xffff0000, v146
  v_lshlrev_b32 v190, 16, v147
  v_and_b32 v191, 0xffff0000, v147
  v_add_f32 v176, v176, v184
  v_add_f32 v177, v177, v185
  v_add_f32 v178, v178, v186
  v_add_f32 v179, v179, v187
  v_add_f32 v180, v180, v188
  v_add_f32 v181, v181, v189
  v_add_f32 v182, v182, v190
  v_add_f32 v183, v183, v191
  s_waitcnt vmcnt(2)
  v_lshlrev_b32 v184, 16, v148
  v_and_b32 v185, 0xffff0000, v148
  v_lshlrev_b32 v186, 16, v149
  v_and_b32 v187, 0xffff0000, v149
  v_lshlrev_b32 v188, 16, v150
  v_and_b32 v189, 0xffff0000, v150
  v_lshlrev_b32 v190, 16, v151
  v_and_b32 v191, 0xffff0000, v151
  v_add_f32 v160, v160, v184
  v_add_f32 v161, v161, v185
  v_add_f32 v162, v162, v186
  v_add_f32 v163, v163, v187
  v_add_f32 v164, v164, v188
  v_add_f32 v165, v165, v189
  v_add_f32 v166, v166, v190
  v_add_f32 v167, v167, v191
  s_waitcnt vmcnt(1)
  v_lshlrev_b32 v184, 16, v152
  v_and_b32 v185, 0xffff0000, v152
  v_lshlrev_b32 v186, 16, v153
  v_and_b32 v187, 0xffff0000, v153
  v_lshlrev_b32 v188, 16, v154
  v_and_b32 v189, 0xffff0000, v154
  v_lshlrev_b32 v190, 16, v155
  v_and_b32 v191, 0xffff0000, v155
  v_add_f32 v168, v168, v184
  v_add_f32 v169, v169, v185
  v_add_f32 v170, v170, v186
  v_add_f32 v171, v171, v187
  v_add_f32 v172, v172, v188
  v_add_f32 v173, v173, v189
  v_add_f32 v174, v174, v190
  v_add_f32 v175, v175, v191
  s_waitcnt vmcnt(0)
  v_lshlrev_b32 v184, 16, v156
  v_and_b32 v185, 0xffff0000, v156
  v_lshlrev_b32 v186, 16, v157
  v_and_b32 v187, 0xffff0000, v157
  v_lshlrev_b32 v188, 16, v158
  v_and_b32 v189, 0xffff0000, v158
  v_lshlrev_b32 v190, 16, v159
  v_and_b32 v191, 0xffff0000, v159
  v_add_f32 v176, v176, v184
  v_add_f32 v177, v177, v185
  v_add_f32 v178, v178, v186
  v_add_f32 v179, v179, v187
  v_add_f32 v180, v180, v188
  v_add_f32 v181, v181, v189
  v_add_f32 v182, v182, v190
  v_add_f32 v183, v183, v191
  v_permlane32_swap_b32 v160, v164
  v_permlane32_swap_b32 v161, v165
  v_permlane32_swap_b32 v162, v166
  v_permlane32_swap_b32 v163, v167
  v_add_f32 v160, v160, v164
  v_add_f32 v161, v161, v165
  v_add_f32 v162, v162, v166
  v_add_f32 v163, v163, v167
  s_nop 0
  v_permlane16_swap_b32 v160, v162
  v_permlane16_swap_b32 v161, v163
  v_add_f32 v160, v160, v162
  v_add_f32 v161, v161, v163
  s_nop 0
  v_add_f32 v160, v160, v160 row_ror:8 row_mask:0xf bank_mask:0xf
  v_add_f32 v161, v161, v161 row_ror:8 row_mask:0xf bank_mask:0xf
  v_permlane32_swap_b32 v168, v172
  v_permlane32_swap_b32 v169, v173
  v_permlane32_swap_b32 v170, v174
  v_permlane32_swap_b32 v171, v175
  v_add_f32 v168, v168, v172
  v_add_f32 v169, v169, v173
  v_add_f32 v170, v170, v174
  v_add_f32 v171, v171, v175
  s_nop 0
  v_permlane16_swap_b32 v168, v170
  v_permlane16_swap_b32 v169, v171
  v_add_f32 v168, v168, v170
  v_add_f32 v169, v169, v171
  s_nop 0
  v_add_f32 v168, v168, v168 row_ror:8 row_mask:0xf bank_mask:0xf
  v_add_f32 v169, v169, v169 row_ror:8 row_mask:0xf bank_mask:0xf
  v_permlane32_swap_b32 v176, v180
  v_permlane32_swap_b32 v177, v181
  v_permlane32_swap_b32 v178, v182
  v_permlane32_swap_b32 v179, v183
  v_add_f32 v176, v176, v180
  v_add_f32 v177, v177, v181
  v_add_f32 v178, v178, v182
  v_add_f32 v179, v179, v183
  s_nop 0
  v_permlane16_swap_b32 v176, v178
  v_permlane16_swap_b32 v177, v179
  v_add_f32 v176, v176, v178
  v_add_f32 v177, v177, v179
  s_nop 0
  v_add_f32 v176, v176, v176 row_ror:8 row_mask:0xf bank_mask:0xf
  v_add_f32 v177, v177, v177 row_ror:8 row_mask:0xf bank_mask:0xf
  s_mov_b32 exec_lo, 0x00ff00ff
  s_mov_b32 exec_hi, 0x00ff00ff
  buffer_store_dwordx2 v[160:161], v21, s[4:7], s30 offen offset:0 sc1
  buffer_store_dwordx2 v[168:169], v21, s[4:7], s30 offen offset:256 sc1
  buffer_store_dwordx2 v[176:177], v21, s[4:7], s30 offen offset:512 sc1
  s_mov_b64 exec, -1
  s_mov_b32 s12, s58
  s_mov_b32 s13, s59
  s_mov_b32 s14, 0x100
  s_mov_b32 s15, 0x00020000
  s_mov_b32 s38, 0
  s_mov_b64 exec, 1
.g2_kernel_gt10:
  buffer_load_dword v6, v4, s[12:15], 0 offen sc1
  s_add_u32 s38, s38, 1
  s_waitcnt vmcnt(0)
  v_cmp_eq_u32 vcc, 0x60, v6
  s_cbranch_vccnz .g2_kernel_gt10d
  s_sleep 8
  s_cmp_lt_u32 s38, 131072
  s_cbranch_scc1 .g2_kernel_gt10
.g2_kernel_gt10d:
  s_mov_b64 exec, -1
  v_mov_b32 v6, s70
  s_mov_b64 exec, 1
  buffer_store_dword v6, v4, s[4:7], s76 offen offset:4 sc1
  s_mov_b64 exec, -1
  v_mov_b32 v6, 155648
  s_mov_b32 s38, 0
.g2_kernel_wg11:
  ds_read_b32 v7, v6 offset:512
  s_add_u32 s38, s38, 1
  s_waitcnt lgkmcnt(0)
  v_cmp_le_u32 vcc, 27, v7
  s_cbranch_vccnz .g2_kernel_wg11d
  s_sleep 4
  s_cmp_lt_u32 s38, 524288
  s_cbranch_scc1 .g2_kernel_wg11
.g2_kernel_wg11d:
  s_and_b32 s31, s76, 0xffffe000
  s_add_u32 s31, s31, 4
  v_and_b32 v6, 15, v2
  v_lshlrev_b32 v6, 9, v6
  v_lshrrev_b32 v7, 4, v2
  v_lshl_add_u32 v6, v7, 7, v6
  v_lshlrev_b32 v7, 2, v2
  v_add_u32 v7, 157696, v7
  s_mov_b32 m0, 157696
  s_mov_b32 s38, 0
  s_bfm_b64 exec, 16, 0
.g2_kernel_pa12:
  buffer_load_dword v6, s[4:7], s31 offen sc1 lds
  s_add_u32 s38, s38, 1
  s_waitcnt vmcnt(0)
  ds_read_b32 v8, v7
  s_waitcnt lgkmcnt(0)
  v_cmp_ge_u32 vcc, s62, v8
  s_cbranch_vccz .g2_kernel_pa12d
  s_mov_b64 exec, vcc
  s_sleep 16
  s_cmp_lt_u32 s38, 131072
  s_cbranch_scc1 .g2_kernel_pa12
.g2_kernel_pa12d:
  s_mov_b64 exec, -1
  s_mul_i32 s30, s18, 12288
  s_add_u32 s30, s30, 0x3080000
  s_mov_b32 exec_hi, 0xffff
  buffer_load_dwordx4 v[64:67], v3, s[4:7], s30 offen offset:0 sc1
  buffer_load_dwordx4 v[68:71], v3, s[4:7], s30 offen offset:768 sc1
  buffer_load_dwordx4 v[72:75], v3, s[4:7], s30 offen offset:1536 sc1
  buffer_load_dwordx4 v[76:79], v3, s[4:7], s30 offen offset:2304 sc1
  s_add_u32 s30, s30, 3072
  buffer_load_dwordx4 v[80:83], v3, s[4:7], s30 offen offset:0 sc1
  buffer_load_dwordx4 v[84:87], v3, s[4:7], s30 offen offset:768 sc1
  buffer_load_dwordx4 v[88:91], v3, s[4:7], s30 offen offset:1536 sc1
  buffer_load_dwordx4 v[92:95], v3, s[4:7], s30 offen offset:2304 sc1
  s_add_u32 s30, s30, 3072
  buffer_load_dwordx4 v[96:99], v3, s[4:7], s30 offen offset:0 sc1
  buffer_load_dwordx4 v[100:103], v3, s[4:7], s30 offen offset:768 sc1
  buffer_load_dwordx4 v[104:107], v3, s[4:7], s30 offen offset:1536 sc1
  buffer_load_dwordx4 v[108:111], v3, s[4:7], s30 offen offset:2304 sc1
  s_add_u32 s30, s30, 3072
  buffer_load_dwordx4 v[112:115], v3, s[4:7], s30 offen offset:0 sc1
  buffer_load_dwordx4 v[116:119], v3, s[4:7], s30 offen offset:768 sc1
  buffer_load_dwordx4 v[120:123], v3, s[4:7], s30 offen offset:1536 sc1
  buffer_load_dwordx4 v[124:127], v3, s[4:7], s30 offen offset:2304 sc1
  s_add_u32 s30, s30, 3072
  s_waitcnt vmcnt(14)
  v_add_f32 v64, v64, v68
  v_add_f32 v65, v65, v69
  v_add_f32 v66, v66, v70
  v_add_f32 v67, v67, v71
  s_waitcnt vmcnt(13)
  v_add_f32 v64, v64, v72
  v_add_f32 v65, v65, v73
  v_add_f32 v66, v66, v74
  v_add_f32 v67, v67, v75
  s_waitcnt vmcnt(12)
  v_add_f32 v64, v64, v76
  v_add_f32 v65, v65, v77
  v_add_f32 v66, v66, v78
  v_add_f32 v67, v67, v79
  s_waitcnt vmcnt(11)
  v_add_f32 v64, v64, v80
  v_add_f32 v65, v65, v81
  v_add_f32 v66, v66, v82
  v_add_f32 v67, v67, v83
  s_waitcnt vmcnt(10)
  v_add_f32 v64, v64, v84
  v_add_f32 v65, v65, v85
  v_add_f32 v66, v66, v86
  v_add_f32 v67, v67, v87
  s_waitcnt vmcnt(9)
  v_add_f32 v64, v64, v88
  v_add_f32 v65, v65, v89
  v_add_f32 v66, v66, v90
  v_add_f32 v67, v67, v91
  s_waitcnt vmcnt(8)
  v_add_f32 v64, v64, v92
  v_add_f32 v65, v65, v93
  v_add_f32 v66, v66, v94
  v_add_f32 v67, v67, v95
  s_waitcnt vmcnt(7)
  v_add_f32 v64, v64, v96
  v_add_f32 v65, v65, v97
  v_add_f32 v66, v66, v98
  v_add_f32 v67, v67, v99
  s_waitcnt vmcnt(6)
  v_add_f32 v64, v64, v100
  v_add_f32 v65, v65, v101
  v_add_f32 v66, v66, v102
  v_add_f32 v67, v67, v103
  s_waitcnt vmcnt(5)
  v_add_f32 v64, v64, v104
  v_add_f32 v65, v65, v105
  v_add_f32 v66, v66, v106
  v_add_f32 v67, v67, v107
  s_waitcnt vmcnt(4)
  v_add_f32 v64, v64, v108
  v_add_f32 v65, v65, v109
  v_add_f32 v66, v66, v110
  v_add_f32 v67, v67, v111
  s_waitcnt vmcnt(3)
  v_add_f32 v64, v64, v112
  v_add_f32 v65, v65, v113
  v_add_f32 v66, v66, v114
  v_add_f32 v67, v67, v115
  s_waitcnt vmcnt(2)
  v_add_f32 v64, v64, v116
  v_add_f32 v65, v65, v117
  v_add_f32 v66, v66, v118
  v_add_f32 v67, v67, v119
  s_waitcnt vmcnt(1)
  v_add_f32 v64, v64, v120
  v_add_f32 v65, v65, v121
  v_add_f32 v66, v66, v122
  v_add_f32 v67, v67, v123
  s_waitcnt vmcnt(0)
  v_add_f32 v64, v64, v124
  v_add_f32 v65, v65, v125
  v_add_f32 v66, v66, v126
  v_add_f32 v67, v67, v127
  s_mov_b64 exec, -1
  v_mov_b32 v6, 155648
  s_mov_b32 s38, 0
.g2_kernel_wg13:
  ds_read_b32 v7, v6 offset:512
  s_add_u32 s38, s38, 1
  s_waitcnt lgkmcnt(0)
  v_cmp_le_u32 vcc, 32, v7
  s_cbranch_vccnz .g2_kernel_wg13d
  s_sleep 2
  s_cmp_lt_u32 s38, 524288
  s_cbranch_scc1 .g2_kernel_wg13
.g2_kernel_wg13d:
  v_lshlrev_b32 v24, 2, v2
  v_add_u32 v24, 155648, v24
  ds_write_b32 v24, v4 offset:2048
  v_add_u32 v24, 155648, v3
  s_mov_b32 exec_hi, 0xffff
  ds_write_b128 v24, v[64:67] offset:4864
  s_mov_b64 exec, -1
  v_mov_b32 v6, s71
  s_mov_b64 exec, 1
  ds_add_u32 v6, v5 offset:0
  s_mov_b64 exec, -1
  s_branch .g2_kernel_v
.g2_kernel_s3:
  s_mov_b32 s12, s58
  s_mov_b32 s13, s59
  s_mov_b32 s14, 0x100
  s_mov_b32 s15, 0x00020000
  s_mov_b32 s20, s48
  s_mov_b32 s21, s49
  s_mov_b32 s22, 0x800
  s_mov_b32 s23, 0x00020000
  v_mov_b32 v12, 0
  v_mov_b32 v13, 0
  v_mov_b32 v14, 0
  v_mov_b32 v15, 0
  s_cmp_ge_u32 s2, 96
  s_cbranch_scc1 .g2_kernel_zm14
  s_lshl_b32 s36, s2, 12
  s_add_u32 s36, s36, 0x3000000
  buffer_store_dwordx4 v[12:15], v3, s[4:7], s36 offen sc1
  buffer_store_dwordx4 v[12:15], v3, s[4:7], s36 offen offset:1024 sc1
  buffer_store_dwordx4 v[12:15], v3, s[4:7], s36 offen offset:2048 sc1
  buffer_store_dwordx4 v[12:15], v3, s[4:7], s36 offen offset:3072 sc1
.g2_kernel_zm14:
  s_barrier
  s_cbranch_scc1 .g2_kernel_zm14b
  s_mov_b64 exec, 1
  s_waitcnt vmcnt(0)
  buffer_atomic_add v5, v4, s[12:15], 0 offen sc1
  s_mov_b64 exec, -1
.g2_kernel_zm14b:
  s_and_b32 s36, s18, 7
  s_cmp_ge_u32 s36, 3
  s_cbranch_scc1 .g2_kernel_c315
  s_mov_b32 s24, s42
  s_mov_b32 s25, s43
  s_mov_b32 s26, 0x600000
  s_mov_b32 s27, 0x00020000
  v_mul_u32_u24 v7, 6144, v2
  s_lshl_b32 s36, s36, 11
  s_or_b32 s37, s18, 3
  s_lshl_b32 s37, s37, 7
  s_add_u32 s36, s36, s37
  s_and_b32 s37, s17, 7
  s_mul_i32 s37, s37, 393216
  s_add_u32 s36, s36, s37
  s_add_u32 s37, s36, 3145728
  s_sleep 0
  buffer_load_dword v1, v7, s[24:27], s36 offen
  s_sleep 30
  buffer_load_dword v1, v7, s[24:27], s37 offen
.g2_kernel_c315:
  v_lshlrev_b32 v20, 5, v2
  buffer_load_dwordx4 v[24:27], v20, s[20:23], 0 offen
  buffer_load_dwordx4 v[28:31], v20, s[20:23], 0 offen offset:16
  v_mov_b32 v20, 0
  s_waitcnt vmcnt(0)
  v_lshlrev_b32 v21, 16, v24
  v_and_b32 v22, 0xffff0000, v24
  v_add_f32 v20, v20, v21
  v_add_f32 v20, v20, v22
  v_lshlrev_b32 v21, 16, v25
  v_and_b32 v22, 0xffff0000, v25
  v_add_f32 v20, v20, v21
  v_add_f32 v20, v20, v22
  v_lshlrev_b32 v21, 16, v26
  v_and_b32 v22, 0xffff0000, v26
  v_add_f32 v20, v20, v21
  v_add_f32 v20, v20, v22
  v_lshlrev_b32 v21, 16, v27
  v_and_b32 v22, 0xffff0000, v27
  v_add_f32 v20, v20, v21
  v_add_f32 v20, v20, v22
  v_lshlrev_b32 v21, 16, v28
  v_and_b32 v22, 0xffff0000, v28
  v_add_f32 v20, v20, v21
  v_add_f32 v20, v20, v22
  v_lshlrev_b32 v21, 16, v29
  v_and_b32 v22, 0xffff0000, v29
  v_add_f32 v20, v20, v21
  v_add_f32 v20, v20, v22
  v_lshlrev_b32 v21, 16, v30
  v_and_b32 v22, 0xffff0000, v30
  v_add_f32 v20, v20, v21
  v_add_f32 v20, v20, v22
  v_lshlrev_b32 v21, 16, v31
  v_and_b32 v22, 0xffff0000, v31
  v_add_f32 v20, v20, v21
  v_add_f32 v20, v20, v22
  s_nop 1
  v_add_f32 v20, v20, v20 quad_perm:[1,0,3,2] row_mask:0xf bank_mask:0xf
  s_nop 1
  v_add_f32 v20, v20, v20 quad_perm:[2,3,0,1] row_mask:0xf bank_mask:0xf
  s_nop 1
  v_add_f32 v20, v20, v20 row_half_mirror row_mask:0xf bank_mask:0xf
  s_nop 1
  v_add_f32 v20, v20, v20 row_mirror row_mask:0xf bank_mask:0xf
  s_nop 0
  v_readlane_b32 s20, v20, 16
  v_readlane_b32 s21, v20, 32
  v_readlane_b32 s22, v20, 48
  v_add_f32 v20, s20, v20
  v_add_f32 v20, s21, v20
  v_add_f32 v20, s22, v20
  v_mul_f32 v20, 0x3a800000, v20
  v_mov_b32 v6, 155648
  s_mov_b32 s38, 0
.g2_kernel_wg16:
  ds_read_b32 v7, v6 offset:512
  s_add_u32 s38, s38, 1
  s_waitcnt lgkmcnt(0)
  v_cmp_le_u32 vcc, 32, v7
  s_cbranch_vccnz .g2_kernel_wg16d
  s_sleep 2
  s_cmp_lt_u32 s38, 524288
  s_cbranch_scc1 .g2_kernel_wg16
.g2_kernel_wg16d:
  v_mov_b32 v21, 155648
  s_mov_b64 exec, 1
  ds_write_b32 v21, v20 offset:256
  s_mov_b64 exec, -1
.g2_kernel_v:
  s_setprio 3
  s_cmp_lg_u32 s16, 4
  s_cbranch_scc1 .g2_kernel_v_1
  v_mov_b32 v6, s71
  s_mov_b32 s38, 0
.g2_kernel_wg17:
  ds_read_b32 v7, v6 offset:4
  s_add_u32 s38, s38, 1
  s_waitcnt lgkmcnt(0)
  v_cmp_le_u32 vcc, 4, v7
  s_cbranch_vccnz .g2_kernel_wg17d
  s_sleep 1
  s_cmp_lt_u32 s38, 524288
  s_cbranch_scc1 .g2_kernel_wg17
.g2_kernel_wg17d:
  s_sleep 2
  s_and_b32 s31, s76, 0xffffe000
  s_add_u32 s31, s31, 0
  v_and_b32 v6, 15, v2
  v_lshlrev_b32 v6, 9, v6
  v_lshrrev_b32 v7, 4, v2
  v_lshl_add_u32 v6, v7, 7, v6
  v_lshlrev_b32 v7, 2, v2
  v_add_u32 v7, 157440, v7
  s_mov_b32 m0, 157440
  s_mov_b32 s38, 0
  s_mov_b32 exec_lo, 0xffff
  s_mov_b32 exec_hi, 0xffff
.g2_kernel_pa18:
  buffer_load_dword v6, s[4:7], s31 offen sc1 lds
  s_add_u32 s38, s38, 1
  s_waitcnt vmcnt(0)
  ds_read_b32 v8, v7
  s_waitcnt lgkmcnt(0)
  v_cmp_ge_u32 vcc, s62, v8
  s_cbranch_vccz .g2_kernel_pa18d
  s_mov_b64 exec, vcc
  s_sleep 2
  s_cmp_lt_u32 s38, 131072
  s_cbranch_scc1 .g2_kernel_pa18
.g2_kernel_pa18d:
  s_mov_b64 exec, -1
  v_mov_b32 v6, s71
  s_mov_b64 exec, 1
  ds_add_u32 v6, v5 offset:80
  s_mov_b64 exec, -1
.g2_kernel_v_1:
  s_cmp_lt_u32 s16, 6
  s_cbranch_scc1 .g2_kernel_v_2
  v_mov_b32 v6, s71
  s_mov_b32 s38, 0
.g2_kernel_wg19:
  ds_read_b32 v7, v6 offset:4
  s_add_u32 s38, s38, 1
  s_waitcnt lgkmcnt(0)
  v_cmp_le_u32 vcc, 4, v7
  s_cbranch_vccnz .g2_kernel_wg19d
  s_sleep 4
  s_cmp_lt_u32 s38, 524288
  s_cbranch_scc1 .g2_kernel_wg19
.g2_kernel_wg19d:
  s_and_b32 s28, s16, 1
  s_lshl_b32 s30, s28, 13
  s_add_u32 s31, s30, 16384
  v_add_u32 v8, s31, v3
  ds_read_b32 v9, v6 offset:24
  ds_read_b128 v[16:19], v8 offset:0
  ds_read_b128 v[20:23], v8 offset:1024
  ds_read_b128 v[24:27], v8 offset:2048
  ds_read_b128 v[28:31], v8 offset:3072
  ds_read_b128 v[32:35], v8 offset:4096
  ds_read_b128 v[36:39], v8 offset:5120
  ds_read_b128 v[40:43], v8 offset:6144
  ds_read_b128 v[44:47], v8 offset:7168
  s_lshl_b32 s31, s18, 5
  s_add_u32 s31, s31, s17
  s_add_u32 s31, s31, 16
  s_lshl_b32 s31, s31, 14
  s_add_u32 s30, s30, s31
  s_add_u32 s30, s30, s63
  s_add_u32 s31, s30, 4096
  s_lshl_b32 s33, s28, 8
  s_add_u32 s33, s33, 128
  s_waitcnt lgkmcnt(0)
  v_readfirstlane_b32 s29, v9
  v_mov_b32 v6, s71
  s_mov_b64 exec, 1
  ds_add_u32 v6, v5 offset:8
  s_mov_b64 exec, -1
  s_sleep 40
  buffer_store_dwordx4 v[16:19], v3, s[4:7], s30 offen offset:0 sc1
  buffer_store_dwordx4 v[20:23], v3, s[4:7], s30 offen offset:1024 sc1
  buffer_store_dwordx4 v[24:27], v3, s[4:7], s30 offen offset:2048 sc1
  buffer_store_dwordx4 v[28:31], v3, s[4:7], s30 offen offset:3072 sc1
  buffer_store_dwordx4 v[32:35], v3, s[4:7], s31 offen offset:0 sc1
  buffer_store_dwordx4 v[36:39], v3, s[4:7], s31 offen offset:1024 sc1
  buffer_store_dwordx4 v[40:43], v3, s[4:7], s31 offen offset:2048 sc1
  buffer_store_dwordx4 v[44:47], v3, s[4:7], s31 offen offset:3072 sc1
  s_sub_u32 s29, s29, 1
  s_lshr_b32 s29, s29, 6
  s_waitcnt vmcnt(0)
  s_cmp_eq_u32 s29, s28
  s_cbranch_scc1 .g2_kernel_v_1h
  s_add_u32 s31, s76, s33
  v_mov_b32 v6, s70
  s_mov_b64 exec, 1
  buffer_store_dword v6, v4, s[4:7], s31 offen offset:0 sc1
  s_mov_b64 exec, -1
  s_branch .g2_kernel_v_2
.g2_kernel_v_1h:
  v_mov_b32 v6, s71
  s_mov_b64 exec, 1
  ds_add_u32 v6, v5 offset:56
  s_mov_b64 exec, -1
.g2_kernel_v_2:
  v_mov_b32 v6, s71
  s_mov_b32 s38, 0
.g2_kernel_wg20:
  ds_read_b32 v7, v6 offset:80
  s_add_u32 s38, s38, 1
  s_waitcnt lgkmcnt(0)
  v_cmp_le_u32 vcc, 1, v7
  s_cbranch_vccnz .g2_kernel_wg20d
  s_sleep 8
  s_cmp_lt_u32 s38, 524288
  s_cbranch_scc1 .g2_kernel_wg20
.g2_kernel_wg20d:
  s_sleep 20
  s_mov_b32 s39, 0
  v_mov_b32 v12, 0
  v_mov_b32 v13, 0
  v_mov_b32 v14, 0
  v_mov_b32 v15, 0
  s_lshl_b32 s30, s17, 2
  s_and_b32 s31, s16, 3
  s_add_u32 s30, s30, s31
  s_lshl_b32 s30, s30, 4
  s_add_u32 s30, s30, s18
  s_lshl_b32 s30, s30, 9
  s_add_u32 s30, s30, s63
  s_add_u32 s30, s30, 0x1000000
  s_mov_b32 exec_hi, 0
  buffer_store_dwordx4 v[12:15], v3, s[4:7], s30 offen sc1
  s_mov_b64 exec, -1
  s_lshl_b32 s30, s17, 2
  s_add_u32 s30, s30, s31
  s_lshl_b32 s30, s30, 5
  s_add_u32 s30, s30, s18
  s_lshl_b32 s30, s30, 11
  s_add_u32 s30, s30, s63
  s_add_u32 s30, s30, 0x808000
  buffer_store_dwordx4 v[12:15], v3, s[4:7], s30 offen sc1
  buffer_store_dwordx4 v[12:15], v3, s[4:7], s30 offen offset:1024 sc1
  s_cmp_lg_u32 s62, 5
  s_cbranch_scc1 .g2_kernel_zs21k
  s_lshl_b32 s30, s18, 4
  s_add_u32 s30, s30, s17
  s_lshl_b32 s30, s30, 2
  s_add_u32 s30, s30, s31
  s_lshl_b32 s30, s30, 12
  s_add_u32 s30, s30, 0x2c00000
  buffer_store_dwordx4 v[12:15], v3, s[4:7], s30 offen sc1
  buffer_store_dwordx4 v[12:15], v3, s[4:7], s30 offen offset:1024 sc1
  buffer_store_dwordx4 v[12:15], v3, s[4:7], s30 offen offset:2048 sc1
  buffer_store_dwordx4 v[12:15], v3, s[4:7], s30 offen offset:3072 sc1
.g2_kernel_zs21k:
  s_lshl_b32 s30, s17, 4
  s_add_u32 s30, s30, s18
  s_cmp_lt_u32 s16, 5
  s_cbranch_scc1 .g2_kernel_zs21
  s_cmp_eq_u32 s16, 5
  s_cbranch_scc1 .g2_kernel_zs21a
  s_cmp_lg_u32 s62, 0
  s_cbranch_scc1 .g2_kernel_zs21
  s_lshl_b32 s30, s30, 1
  s_and_b32 s31, s16, 1
  s_add_u32 s30, s30, s31
  s_lshl_b32 s30, s30, 11
  s_add_u32 s31, s30, 0x1090000
  buffer_store_dwordx4 v[12:15], v3, s[4:7], s31 offen sc1
  buffer_store_dwordx4 v[12:15], v3, s[4:7], s31 offen offset:1024 sc1
  s_add_u32 s31, s30, 0x2890000
  buffer_store_dwordx4 v[12:15], v3, s[4:7], s31 offen sc1
  buffer_store_dwordx4 v[12:15], v3, s[4:7], s31 offen offset:1024 sc1
  s_add_u32 s31, s30, 0x2b00000
  buffer_store_dwordx4 v[12:15], v3, s[4:7], s31 offen sc1
  buffer_store_dwordx4 v[12:15], v3, s[4:7], s31 offen offset:1024 sc1
  s_branch .g2_kernel_zs21
.g2_kernel_zs21a:
  s_lshl_b32 s30, s30, 6
  s_add_u32 s30, s30, s63
  s_add_u32 s30, s30, 0x1080000
  s_mov_b64 exec, 15
  buffer_store_dwordx4 v[12:15], v3, s[4:7], s30 offen sc1
  s_mov_b64 exec, -1
  s_and_b32 s30, s18, 14
  s_lshl_b32 s30, s30, 4
  s_add_u32 s30, s30, s17
  s_lshl_b32 s30, s30, 1
  s_and_b32 s31, s18, 1
  s_add_u32 s30, s30, s31
  s_lshl_b32 s30, s30, 10
  s_add_u32 s30, s30, s63
  s_add_u32 s30, s30, 0x1190000
  s_add_u32 s31, s30, 32768
  buffer_store_dwordx4 v[12:15], v3, s[4:7], s30 offen sc1
  buffer_store_dwordx4 v[12:15], v3, s[4:7], s31 offen sc1
.g2_kernel_zs21:
  s_cmp_eq_u32 s16, 4
  s_cbranch_scc1 .g2_kernel_v_3
  s_cmp_lg_u32 s62, 0
  s_cbranch_scc1 .g2_kernel_g_e
  s_and_b32 s22, s16, 3
  s_lshl_b32 s22, s22, 14
  s_add_u32 s22, s22, 65536
  v_bfe_u32 v8, v2, 2, 2
  v_lshrrev_b32 v9, 4, v2
  v_and_b32 v10, 3, v2
  v_lshlrev_b32 v10, 3, v10
  v_add_u32 v10, s22, v10
  s_cmp_eq_u32 s16, 5
  s_cbranch_scc1 .g2_kernel_g_p
  s_cmp_ge_u32 s17, 14
  s_cbranch_scc1 .g2_kernel_g_e
  v_lshrrev_b32 v6, 1, v2
  v_mul_u32_u24 v6, 7168, v6
  v_and_b32 v7, 1, v2
  v_lshl_add_u32 v250, v7, 4, v6
  v_lshl_add_u32 v11, v9, 3, v8
  v_lshl_add_u32 v251, v11, 5, v10
  v_and_b32 v11, 1, v9
  v_lshl_add_u32 v11, v11, 3, v8
  v_lshl_add_u32 v11, v11, 10, v10
  v_lshrrev_b32 v7, 1, v9
  v_lshl_add_u32 v252, v7, 7, v11
  s_lshl_b32 s24, s17, 4
  s_add_u32 s24, s24, s18
  s_and_b32 s25, s16, 1
  s_mov_b32 s12, s50
  s_mov_b32 s13, s51
  s_mov_b32 s14, 0x700000
  s_mov_b32 s15, 0x00020000
  s_mul_i32 s20, s25, 3670016
  s_lshl_b32 s31, s24, 5
  s_add_u32 s20, s20, s31
  s_lshl_b32 s31, s18, 2
  s_mov_b32 s23, s31
  s_mov_b32 s21, 16
.g2_kernel_gl22:
  s_call_b64 s[26:27], .g2_kernel_v_may
  s_and_b32 s23, s23, 15
  s_lshl_b32 s30, s23, 10
  s_add_u32 s30, s30, 0
  s_add_u32 m0, s30, s22
  s_mul_i32 s30, s23, 229376
  s_add_u32 s30, s30, s20
  buffer_load_dwordx4 v250, s[12:15], s30 offen lds
  s_add_u32 s23, s23, 1
  s_sub_u32 s21, s21, 1
  s_sleep 2
  s_waitcnt vmcnt(4)
  s_cmp_lg_u32 s21, 0
  s_cbranch_scc1 .g2_kernel_gl22
  s_waitcnt vmcnt(0)
  ds_read_b64_tr_b16 v[64:65], v251 offset:0
  ds_read_b64_tr_b16 v[66:67], v251 offset:128
  ds_read_b64_tr_b16 v[68:69], v251 offset:1024
  ds_read_b64_tr_b16 v[70:71], v251 offset:1152
  ds_read_b64_tr_b16 v[72:73], v251 offset:2048
  ds_read_b64_tr_b16 v[74:75], v251 offset:2176
  ds_read_b64_tr_b16 v[76:77], v251 offset:3072
  ds_read_b64_tr_b16 v[78:79], v251 offset:3200
  ds_read_b64_tr_b16 v[80:81], v251 offset:4096
  ds_read_b64_tr_b16 v[82:83], v251 offset:4224
  ds_read_b64_tr_b16 v[84:85], v251 offset:5120
  ds_read_b64_tr_b16 v[86:87], v251 offset:5248
  ds_read_b64_tr_b16 v[88:89], v251 offset:6144
  ds_read_b64_tr_b16 v[90:91], v251 offset:6272
  ds_read_b64_tr_b16 v[92:93], v251 offset:7168
  ds_read_b64_tr_b16 v[94:95], v251 offset:7296
  ds_read_b64_tr_b16 v[96:97], v251 offset:8192
  ds_read_b64_tr_b16 v[98:99], v251 offset:8320
  ds_read_b64_tr_b16 v[100:101], v251 offset:9216
  ds_read_b64_tr_b16 v[102:103], v251 offset:9344
  ds_read_b64_tr_b16 v[104:105], v251 offset:10240
  ds_read_b64_tr_b16 v[106:107], v251 offset:10368
  ds_read_b64_tr_b16 v[108:109], v251 offset:11264
  ds_read_b64_tr_b16 v[110:111], v251 offset:11392
  ds_read_b64_tr_b16 v[112:113], v251 offset:12288
  ds_read_b64_tr_b16 v[114:115], v251 offset:12416
  ds_read_b64_tr_b16 v[116:117], v251 offset:13312
  ds_read_b64_tr_b16 v[118:119], v251 offset:13440
  ds_read_b64_tr_b16 v[120:121], v251 offset:14336
  ds_read_b64_tr_b16 v[122:123], v251 offset:14464
  ds_read_b64_tr_b16 v[124:125], v251 offset:15360
  ds_read_b64_tr_b16 v[126:127], v251 offset:15488
  s_waitcnt lgkmcnt(0)
  s_mov_b32 s12, s52
  s_mov_b32 s13, s53
  s_mov_b32 s14, 0x700000
  s_mov_b32 s15, 0x00020000
  s_mul_i32 s20, s25, 3670016
  s_lshl_b32 s31, s24, 5
  s_add_u32 s20, s20, s31
  s_lshl_b32 s31, s18, 2
  s_mov_b32 s23, s31
  s_mov_b32 s21, 16
.g2_kernel_gl23:
  s_call_b64 s[26:27], .g2_kernel_v_may
  s_and_b32 s23, s23, 15
  s_lshl_b32 s30, s23, 10
  s_add_u32 s30, s30, 0
  s_add_u32 m0, s30, s22
  s_mul_i32 s30, s23, 229376
  s_add_u32 s30, s30, s20
  buffer_load_dwordx4 v250, s[12:15], s30 offen lds
  s_add_u32 s23, s23, 1
  s_sub_u32 s21, s21, 1
  s_sleep 2
  s_waitcnt vmcnt(4)
  s_cmp_lg_u32 s21, 0
  s_cbranch_scc1 .g2_kernel_gl23
  s_waitcnt vmcnt(0)
  ds_read_b64_tr_b16 v[128:129], v251 offset:0
  ds_read_b64_tr_b16 v[130:131], v251 offset:128
  ds_read_b64_tr_b16 v[132:133], v251 offset:1024
  ds_read_b64_tr_b16 v[134:135], v251 offset:1152
  ds_read_b64_tr_b16 v[136:137], v251 offset:2048
  ds_read_b64_tr_b16 v[138:139], v251 offset:2176
  ds_read_b64_tr_b16 v[140:141], v251 offset:3072
  ds_read_b64_tr_b16 v[142:143], v251 offset:3200
  ds_read_b64_tr_b16 v[144:145], v251 offset:4096
  ds_read_b64_tr_b16 v[146:147], v251 offset:4224
  ds_read_b64_tr_b16 v[148:149], v251 offset:5120
  ds_read_b64_tr_b16 v[150:151], v251 offset:5248
  ds_read_b64_tr_b16 v[152:153], v251 offset:6144
  ds_read_b64_tr_b16 v[154:155], v251 offset:6272
  ds_read_b64_tr_b16 v[156:157], v251 offset:7168
  ds_read_b64_tr_b16 v[158:159], v251 offset:7296
  ds_read_b64_tr_b16 v[160:161], v251 offset:8192
  ds_read_b64_tr_b16 v[162:163], v251 offset:8320
  ds_read_b64_tr_b16 v[164:165], v251 offset:9216
  ds_read_b64_tr_b16 v[166:167], v251 offset:9344
  ds_read_b64_tr_b16 v[168:169], v251 offset:10240
  ds_read_b64_tr_b16 v[170:171], v251 offset:10368
  ds_read_b64_tr_b16 v[172:173], v251 offset:11264
  ds_read_b64_tr_b16 v[174:175], v251 offset:11392
  ds_read_b64_tr_b16 v[176:177], v251 offset:12288
  ds_read_b64_tr_b16 v[178:179], v251 offset:12416
  ds_read_b64_tr_b16 v[180:181], v251 offset:13312
  ds_read_b64_tr_b16 v[182:183], v251 offset:13440
  ds_read_b64_tr_b16 v[184:185], v251 offset:14336
  ds_read_b64_tr_b16 v[186:187], v251 offset:14464
  ds_read_b64_tr_b16 v[188:189], v251 offset:15360
  ds_read_b64_tr_b16 v[190:191], v251 offset:15488
  s_waitcnt lgkmcnt(0)
  s_mov_b32 s12, s54
  s_mov_b32 s13, s55
  s_mov_b32 s14, 0x700000
  s_mov_b32 s15, 0x00020000
  s_lshl_b32 s20, s24, 15
  s_lshl_b32 s31, s25, 10
  s_add_u32 s20, s20, s31
  s_mov_b32 s23, 0
  s_mov_b32 s21, 16
.g2_kernel_gl24:
  s_call_b64 s[26:27], .g2_kernel_v_may
  s_and_b32 s23, s23, 15
  s_lshl_b32 s30, s23, 10
  s_add_u32 s30, s30, 0
  s_add_u32 m0, s30, s22
  s_mul_i32 s30, s23, 2048
  s_add_u32 s30, s30, s20
  buffer_load_dwordx4 v3, s[12:15], s30 offen lds
  s_add_u32 s23, s23, 1
  s_sub_u32 s21, s21, 1
  s_sleep 1
  s_waitcnt vmcnt(4)
  s_cmp_lg_u32 s21, 0
  s_cbranch_scc1 .g2_kernel_gl24
  v_mov_b32 v11, v252
  s_waitcnt vmcnt(0)
  ds_read_b64_tr_b16 v[192:193], v11 offset:0
  ds_read_b64_tr_b16 v[194:195], v11 offset:4096
  ds_read_b64_tr_b16 v[196:197], v11 offset:32
  ds_read_b64_tr_b16 v[198:199], v11 offset:4128
  ds_read_b64_tr_b16 v[200:201], v11 offset:64
  ds_read_b64_tr_b16 v[202:203], v11 offset:4160
  ds_read_b64_tr_b16 v[204:205], v11 offset:96
  ds_read_b64_tr_b16 v[206:207], v11 offset:4192
  ds_read_b64_tr_b16 v[208:209], v11 offset:256
  ds_read_b64_tr_b16 v[210:211], v11 offset:4352
  ds_read_b64_tr_b16 v[212:213], v11 offset:288
  ds_read_b64_tr_b16 v[214:215], v11 offset:4384
  ds_read_b64_tr_b16 v[216:217], v11 offset:320
  ds_read_b64_tr_b16 v[218:219], v11 offset:4416
  ds_read_b64_tr_b16 v[220:221], v11 offset:352
  ds_read_b64_tr_b16 v[222:223], v11 offset:4448
  ds_read_b64_tr_b16 v[224:225], v11 offset:512
  ds_read_b64_tr_b16 v[226:227], v11 offset:4608
  ds_read_b64_tr_b16 v[228:229], v11 offset:544
  ds_read_b64_tr_b16 v[230:231], v11 offset:4640
  ds_read_b64_tr_b16 v[232:233], v11 offset:576
  ds_read_b64_tr_b16 v[234:235], v11 offset:4672
  ds_read_b64_tr_b16 v[236:237], v11 offset:608
  ds_read_b64_tr_b16 v[238:239], v11 offset:4704
  ds_read_b64_tr_b16 v[240:241], v11 offset:768
  ds_read_b64_tr_b16 v[242:243], v11 offset:4864
  ds_read_b64_tr_b16 v[244:245], v11 offset:800
  ds_read_b64_tr_b16 v[246:247], v11 offset:4896
  ds_read_b64_tr_b16 v[248:249], v11 offset:832
  ds_read_b64_tr_b16 v[250:251], v11 offset:4928
  ds_read_b64_tr_b16 v[252:253], v11 offset:864
  ds_read_b64_tr_b16 v[254:255], v11 offset:4960
  s_waitcnt lgkmcnt(0)
  s_branch .g2_kernel_g_e
.g2_kernel_g_p:
  s_mov_b32 s12, s42
  s_mov_b32 s13, s43
  s_mov_b32 s14, 0x600000
  s_mov_b32 s15, 0x00020000
  v_mul_u32_u24 v6, 6144, v9
  v_and_b32 v7, 15, v2
  v_lshl_add_u32 v250, v7, 4, v6
  v_lshl_add_u32 v11, v8, 2, v9
  v_lshl_add_u32 v251, v11, 9, v10
  s_lshl_b32 s20, s17, 3
  s_and_b32 s31, s18, 1
  s_add_u32 s20, s20, s31
  s_mul_i32 s20, s20, 49152
  s_and_b32 s31, s18, 14
  s_lshl_b32 s31, s31, 7
  s_add_u32 s20, s20, s31
  s_mov_b32 s23, 0
  s_mov_b32 s21, 8
.g2_kernel_gl25:
  s_call_b64 s[26:27], .g2_kernel_v_may
  s_and_b32 s23, s23, 7
  s_lshl_b32 s30, s23, 10
  s_add_u32 s30, s30, 0
  s_add_u32 m0, s30, s22
  s_mul_i32 s30, s23, 49152
  s_add_u32 s30, s30, s20
  s_and_b32 s31, s23, 1
  s_mul_i32 s31, s31, -24576
  s_add_u32 s30, s30, s31
  buffer_load_dwordx4 v250, s[12:15], s30 offen lds
  s_add_u32 s23, s23, 1
  s_sub_u32 s21, s21, 1
  s_sleep 2
  s_waitcnt vmcnt(4)
  s_cmp_lg_u32 s21, 0
  s_cbranch_scc1 .g2_kernel_gl25
  s_add_u32 s20, s20, 2048
  s_mov_b32 s23, 0
  s_mov_b32 s21, 8
.g2_kernel_gl26:
  s_call_b64 s[26:27], .g2_kernel_v_may
  s_and_b32 s23, s23, 7
  s_lshl_b32 s30, s23, 10
  s_add_u32 s30, s30, 8192
  s_add_u32 m0, s30, s22
  s_mul_i32 s30, s23, 49152
  s_add_u32 s30, s30, s20
  s_and_b32 s31, s23, 1
  s_mul_i32 s31, s31, -24576
  s_add_u32 s30, s30, s31
  buffer_load_dwordx4 v250, s[12:15], s30 offen lds
  s_add_u32 s23, s23, 1
  s_sub_u32 s21, s21, 1
  s_sleep 2
  s_waitcnt vmcnt(4)
  s_cmp_lg_u32 s21, 0
  s_cbranch_scc1 .g2_kernel_gl26
  s_add_u32 s20, s20, 2048
  s_waitcnt vmcnt(0)
  ds_read_b64_tr_b16 v[64:65], v251 offset:0
  ds_read_b64_tr_b16 v[66:67], v251 offset:256
  ds_read_b64_tr_b16 v[68:69], v251 offset:32
  ds_read_b64_tr_b16 v[70:71], v251 offset:288
  ds_read_b64_tr_b16 v[72:73], v251 offset:64
  ds_read_b64_tr_b16 v[74:75], v251 offset:320
  ds_read_b64_tr_b16 v[76:77], v251 offset:96
  ds_read_b64_tr_b16 v[78:79], v251 offset:352
  ds_read_b64_tr_b16 v[80:81], v251 offset:128
  ds_read_b64_tr_b16 v[82:83], v251 offset:384
  ds_read_b64_tr_b16 v[84:85], v251 offset:160
  ds_read_b64_tr_b16 v[86:87], v251 offset:416
  ds_read_b64_tr_b16 v[88:89], v251 offset:192
  ds_read_b64_tr_b16 v[90:91], v251 offset:448
  ds_read_b64_tr_b16 v[92:93], v251 offset:224
  ds_read_b64_tr_b16 v[94:95], v251 offset:480
  ds_read_b64_tr_b16 v[96:97], v251 offset:8192
  ds_read_b64_tr_b16 v[98:99], v251 offset:8448
  ds_read_b64_tr_b16 v[100:101], v251 offset:8224
  ds_read_b64_tr_b16 v[102:103], v251 offset:8480
  ds_read_b64_tr_b16 v[104:105], v251 offset:8256
  ds_read_b64_tr_b16 v[106:107], v251 offset:8512
  ds_read_b64_tr_b16 v[108:109], v251 offset:8288
  ds_read_b64_tr_b16 v[110:111], v251 offset:8544
  ds_read_b64_tr_b16 v[112:113], v251 offset:8320
  ds_read_b64_tr_b16 v[114:115], v251 offset:8576
  ds_read_b64_tr_b16 v[116:117], v251 offset:8352
  ds_read_b64_tr_b16 v[118:119], v251 offset:8608
  ds_read_b64_tr_b16 v[120:121], v251 offset:8384
  ds_read_b64_tr_b16 v[122:123], v251 offset:8640
  ds_read_b64_tr_b16 v[124:125], v251 offset:8416
  ds_read_b64_tr_b16 v[126:127], v251 offset:8672
  s_waitcnt lgkmcnt(0)
  s_mov_b32 s23, 0
  s_mov_b32 s21, 8
.g2_kernel_gl27:
  s_call_b64 s[26:27], .g2_kernel_v_may
  s_and_b32 s23, s23, 7
  s_lshl_b32 s30, s23, 10
  s_add_u32 s30, s30, 0
  s_add_u32 m0, s30, s22
  s_mul_i32 s30, s23, 49152
  s_add_u32 s30, s30, s20
  s_and_b32 s31, s23, 1
  s_mul_i32 s31, s31, -24576
  s_add_u32 s30, s30, s31
  buffer_load_dwordx4 v250, s[12:15], s30 offen lds
  s_add_u32 s23, s23, 1
  s_sub_u32 s21, s21, 1
  s_sleep 2
  s_waitcnt vmcnt(4)
  s_cmp_lg_u32 s21, 0
  s_cbranch_scc1 .g2_kernel_gl27
  s_add_u32 s20, s20, 2048
  s_waitcnt vmcnt(0)
  ds_read_b64_tr_b16 v[128:129], v251 offset:0
  ds_read_b64_tr_b16 v[130:131], v251 offset:256
  ds_read_b64_tr_b16 v[132:133], v251 offset:32
  ds_read_b64_tr_b16 v[134:135], v251 offset:288
  ds_read_b64_tr_b16 v[136:137], v251 offset:64
  ds_read_b64_tr_b16 v[138:139], v251 offset:320
  ds_read_b64_tr_b16 v[140:141], v251 offset:96
  ds_read_b64_tr_b16 v[142:143], v251 offset:352
  ds_read_b64_tr_b16 v[144:145], v251 offset:128
  ds_read_b64_tr_b16 v[146:147], v251 offset:384
  ds_read_b64_tr_b16 v[148:149], v251 offset:160
  ds_read_b64_tr_b16 v[150:151], v251 offset:416
  ds_read_b64_tr_b16 v[152:153], v251 offset:192
  ds_read_b64_tr_b16 v[154:155], v251 offset:448
  ds_read_b64_tr_b16 v[156:157], v251 offset:224
  ds_read_b64_tr_b16 v[158:159], v251 offset:480
  s_waitcnt lgkmcnt(0)
.g2_kernel_g_e:
.g2_kernel_v_3:
  s_mov_b32 s29, 0
  s_and_b32 s30, s16, 3
  s_lshl_b32 s30, s30, 14
  s_add_u32 s30, s30, 65536
  s_call_b64 s[68:69], .g2_kernel_v_wo
  s_waitcnt vmcnt(0)
  v_mov_b32 v6, s71
  s_mov_b64 exec, 1
  ds_add_u32 v6, v5 offset:52
  s_mov_b64 exec, -1
  s_cmp_lg_u32 s16, 4
  s_cbranch_scc1 .g2_kernel_v_3a
  s_and_b32 s31, s76, 0xffffe000
  s_add_u32 s31, s31, 0
  v_and_b32 v6, 15, v2
  v_lshlrev_b32 v6, 9, v6
  v_lshrrev_b32 v7, 4, v2
  v_lshl_add_u32 v6, v7, 7, v6
  v_lshlrev_b32 v7, 2, v2
  v_add_u32 v7, 157440, v7
  s_mov_b32 m0, 157440
  s_mov_b32 s38, 0
  s_mov_b32 exec_lo, 0xffff0000
  s_mov_b32 exec_hi, 0xffff0000
.g2_kernel_pa28:
  buffer_load_dword v6, s[4:7], s31 offen sc1 lds
  s_add_u32 s38, s38, 1
  s_waitcnt vmcnt(0)
  ds_read_b32 v8, v7
  s_waitcnt lgkmcnt(0)
  v_cmp_ge_u32 vcc, s62, v8
  s_cbranch_vccz .g2_kernel_pa28d
  s_mov_b64 exec, vcc
  s_sleep 16
  s_cmp_lt_u32 s38, 131072
  s_cbranch_scc1 .g2_kernel_pa28
.g2_kernel_pa28d:
  s_mov_b64 exec, -1
.g2_kernel_v_3a:
  s_cmp_lg_u32 s39, 0
  s_cbranch_scc1 .g2_kernel_v_3b
  s_call_b64 s[26:27], .g2_kernel_v_do
.g2_kernel_v_3b:
  s_cmp_lg_u32 s16, 4
  s_cbranch_scc1 .g2_kernel_v_4
  v_mov_b32 v6, s71
  s_mov_b32 s38, 0
.g2_kernel_wg29:
  ds_read_b32 v7, v6 offset:8
  s_add_u32 s38, s38, 1
  s_waitcnt lgkmcnt(0)
  v_cmp_le_u32 vcc, 10, v7
  s_cbranch_vccnz .g2_kernel_wg29d
  s_sleep 8
  s_cmp_lt_u32 s38, 524288
  s_cbranch_scc1 .g2_kernel_wg29
.g2_kernel_wg29d:
  s_mov_b32 s29, 1
  s_mov_b32 s30, 139264
  s_call_b64 s[68:69], .g2_kernel_v_wo
  s_add_u32 s31, s31, 81920
  s_sleep 6
  s_waitcnt vmcnt(4)
  buffer_load_dwordx4 v[64:67], v6, s[8:11], s31 offen
  s_add_u32 s31, s31, 16384
  buffer_load_dwordx4 v[68:71], v6, s[8:11], s31 offen
  s_add_u32 s31, s31, 16384
  buffer_load_dwordx4 v[72:75], v6, s[8:11], s31 offen
  s_add_u32 s31, s31, 16384
  buffer_load_dwordx4 v[76:79], v6, s[8:11], s31 offen
  s_add_u32 s31, s31, 81920
  s_sleep 6
  s_waitcnt vmcnt(4)
  buffer_load_dwordx4 v[80:83], v6, s[8:11], s31 offen
  s_add_u32 s31, s31, 16384
  buffer_load_dwordx4 v[84:87], v6, s[8:11], s31 offen
  s_add_u32 s31, s31, 16384
  buffer_load_dwordx4 v[88:91], v6, s[8:11], s31 offen
  s_add_u32 s31, s31, 16384
  buffer_load_dwordx4 v[92:95], v6, s[8:11], s31 offen
  s_add_u32 s31, s31, 81920
  s_sleep 6
  s_waitcnt vmcnt(4)
  buffer_load_dwordx4 v[96:99], v6, s[8:11], s31 offen
  s_add_u32 s31, s31, 16384
  buffer_load_dwordx4 v[100:103], v6, s[8:11], s31 offen
  s_add_u32 s31, s31, 16384
  buffer_load_dwordx4 v[104:107], v6, s[8:11], s31 offen
  s_add_u32 s31, s31, 16384
  buffer_load_dwordx4 v[108:111], v6, s[8:11], s31 offen
  s_add_u32 s31, s31, 81920
  s_sleep 6
  s_waitcnt vmcnt(4)
  buffer_load_dwordx4 v[112:115], v6, s[8:11], s31 offen
  s_add_u32 s31, s31, 16384
  buffer_load_dwordx4 v[116:119], v6, s[8:11], s31 offen
  s_add_u32 s31, s31, 16384
  buffer_load_dwordx4 v[120:123], v6, s[8:11], s31 offen
  s_add_u32 s31, s31, 16384
  buffer_load_dwordx4 v[124:127], v6, s[8:11], s31 offen
  s_add_u32 s31, s31, 81920
  s_sleep 6
  s_waitcnt vmcnt(4)
  buffer_load_dwordx4 v[128:131], v6, s[8:11], s31 offen
  s_add_u32 s31, s31, 16384
  buffer_load_dwordx4 v[132:135], v6, s[8:11], s31 offen
  s_add_u32 s31, s31, 16384
  buffer_load_dwordx4 v[136:139], v6, s[8:11], s31 offen
  s_add_u32 s31, s31, 16384
  buffer_load_dwordx4 v[140:143], v6, s[8:11], s31 offen
  s_add_u32 s31, s31, 81920
  s_sleep 6
  s_waitcnt vmcnt(4)
  buffer_load_dwordx4 v[144:147], v6, s[8:11], s31 offen
  s_add_u32 s31, s31, 16384
  buffer_load_dwordx4 v[148:151], v6, s[8:11], s31 offen
  s_add_u32 s31, s31, 16384
  buffer_load_dwordx4 v[152:155], v6, s[8:11], s31 offen
  s_add_u32 s31, s31, 16384
  buffer_load_dwordx4 v[156:159], v6, s[8:11], s31 offen
  s_add_u32 s31, s31, 81920
  s_sleep 6
  s_waitcnt vmcnt(4)
  buffer_load_dwordx4 v[160:163], v6, s[8:11], s31 offen
  s_add_u32 s31, s31, 16384
  buffer_load_dwordx4 v[164:167], v6, s[8:11], s31 offen
  s_add_u32 s31, s31, 16384
  buffer_load_dwordx4 v[168:171], v6, s[8:11], s31 offen
  s_add_u32 s31, s31, 16384
  buffer_load_dwordx4 v[172:175], v6, s[8:11], s31 offen
  s_add_u32 s31, s31, 81920
  s_sleep 6
  s_waitcnt vmcnt(4)
  buffer_load_dwordx4 v[176:179], v6, s[8:11], s31 offen
  s_add_u32 s31, s31, 16384
  buffer_load_dwordx4 v[180:183], v6, s[8:11], s31 offen
  s_add_u32 s31, s31, 16384
  buffer_load_dwordx4 v[184:187], v6, s[8:11], s31 offen
  s_add_u32 s31, s31, 16384
  buffer_load_dwordx4 v[188:191], v6, s[8:11], s31 offen
  s_add_u32 s31, s31, 81920
  s_sleep 6
  s_waitcnt vmcnt(4)
  buffer_load_dwordx4 v[192:195], v6, s[8:11], s31 offen
  s_add_u32 s31, s31, 16384
  buffer_load_dwordx4 v[196:199], v6, s[8:11], s31 offen
  s_add_u32 s31, s31, 16384
  buffer_load_dwordx4 v[200:203], v6, s[8:11], s31 offen
  s_add_u32 s31, s31, 16384
  buffer_load_dwordx4 v[204:207], v6, s[8:11], s31 offen
  s_add_u32 s31, s31, 81920
  s_sleep 6
  s_waitcnt vmcnt(4)
  buffer_load_dwordx4 v[208:211], v6, s[8:11], s31 offen
  s_add_u32 s31, s31, 16384
  buffer_load_dwordx4 v[212:215], v6, s[8:11], s31 offen
  s_add_u32 s31, s31, 16384
  buffer_load_dwordx4 v[216:219], v6, s[8:11], s31 offen
  s_add_u32 s31, s31, 16384
  buffer_load_dwordx4 v[220:223], v6, s[8:11], s31 offen
  s_add_u32 s31, s31, 81920
  s_sleep 6
  s_waitcnt vmcnt(4)
  buffer_load_dwordx4 v[224:227], v6, s[8:11], s31 offen
  s_add_u32 s31, s31, 16384
  buffer_load_dwordx4 v[228:231], v6, s[8:11], s31 offen
  s_add_u32 s31, s31, 16384
  buffer_load_dwordx4 v[232:235], v6, s[8:11], s31 offen
  s_add_u32 s31, s31, 16384
  buffer_load_dwordx4 v[236:239], v6, s[8:11], s31 offen
  s_add_u32 s31, s31, 81920
  s_sleep 6
  s_waitcnt vmcnt(4)
  buffer_load_dwordx4 v[240:243], v6, s[8:11], s31 offen
  s_add_u32 s31, s31, 16384
  buffer_load_dwordx4 v[244:247], v6, s[8:11], s31 offen
  s_add_u32 s31, s31, 16384
  buffer_load_dwordx4 v[248:251], v6, s[8:11], s31 offen
  s_add_u32 s31, s31, 16384
  buffer_load_dwordx4 v[252:255], v6, s[8:11], s31 offen
.g2_kernel_v_4:
  s_cmp_lg_u32 s16, 5
  s_cbranch_scc1 .g2_kernel_v_5
  s_sleep 64
  s_and_b32 s31, s19, 0xffffe000
  s_add_u32 s31, s31, 0
  v_and_b32 v6, 15, v2
  v_lshlrev_b32 v6, 9, v6
  v_lshrrev_b32 v7, 4, v2
  v_lshl_add_u32 v6, v7, 7, v6
  v_lshlrev_b32 v7, 2, v2
  v_add_u32 v7, 157696, v7
  s_mov_b32 m0, 157696
  s_mov_b32 s38, 0
.g2_kernel_pa30:
  buffer_load_dword v6, s[4:7], s31 offen sc1 lds
  s_add_u32 s38, s38, 1
  s_waitcnt vmcnt(0)
  ds_read_b32 v8, v7
  s_waitcnt lgkmcnt(0)
  v_cmp_ge_u32 vcc, s62, v8
  s_cbranch_vccz .g2_kernel_pa30d
  s_mov_b64 exec, vcc
  s_sleep 32
  s_cmp_lt_u32 s38, 131072
  s_cbranch_scc1 .g2_kernel_pa30
.g2_kernel_pa30d:
  s_mov_b64 exec, -1
  v_lshlrev_b32 v6, 7, v2
  s_lshl_b32 s30, s17, 2
  s_and_b32 s31, s18, 3
  s_add_u32 s30, s30, s31
  s_lshl_b32 s30, s30, 16
  s_add_u32 s30, s30, s63
  s_add_u32 s30, s30, 0x800000
  s_sleep 8
  buffer_load_dword v1, v6, s[4:7], s30 offen
  s_add_u32 s30, s30, 8192
  s_sleep 8
  buffer_load_dword v1, v6, s[4:7], s30 offen
  s_add_u32 s30, s30, 8192
  s_sleep 8
  buffer_load_dword v1, v6, s[4:7], s30 offen
  s_add_u32 s30, s30, 8192
  s_sleep 8
  buffer_load_dword v1, v6, s[4:7], s30 offen
  s_add_u32 s30, s30, 8192
  s_lshl_b32 s28, s2, 10
  s_and_b32 s28, s28, 0xe000
  v_lshlrev_b32 v7, 7, v2
  buffer_load_dword v1, v7, s[64:67], s28 offen
  s_and_b32 s31, s19, 0xffffe000
  s_add_u32 s31, s31, 4
  v_and_b32 v7, 15, v2
  v_lshlrev_b32 v7, 9, v7
  v_lshrrev_b32 v9, 4, v2
  v_lshl_add_u32 v7, v9, 7, v7
  s_and_b32 s33, s18, 3
  s_lshl_b32 s33, s33, 6
  s_add_u32 s33, s33, 157952
  v_lshl_add_u32 v9, v9, 2, s33
  v_lshlrev_b32 v10, 2, v2
  v_add_u32 v10, 157952, v10
  v_mov_b32 v11, 155968
  s_lshl_b32 s33, s62, 1
  s_add_u32 s33, s33, 1
  s_mov_b32 m0, 157952
  s_mov_b64 s[8:9], -1
  s_mov_b64 s[10:11], -1
  s_mov_b64 s[12:13], -1
  s_mov_b64 s[14:15], -1
  s_mov_b64 s[20:21], -1
  s_add_u32 s34, s30, 8192
  s_add_u32 s35, s30, 16384
  s_add_u32 s36, s30, 24576
  s_mov_b32 s38, 0
  s_sleep 8
.g2_kernel_bp31:
  s_mov_b64 exec, s[20:21]
  buffer_load_dword v7, s[4:7], s31 offen sc1 lds
  s_mov_b64 exec, -1
  s_add_u32 s38, s38, 1
  s_waitcnt vmcnt(0)
  ds_read_b32 v12, v10
  ds_read_b32 v13, v9
  ds_read_b32 v14, v9 offset:16
  ds_read_b32 v15, v9 offset:32
  ds_read_b32 v16, v9 offset:48
  s_waitcnt lgkmcnt(0)
  v_cmp_ge_u32 s[20:21], s62, v12
  v_cmp_lt_u32 vcc, s62, v13
  s_and_b64 exec, vcc, s[8:9]
  s_cbranch_scc0 .g2_kernel_bp31n0
  s_andn2_b64 s[8:9], s[8:9], vcc
  buffer_load_dword v1, v6, s[4:7], s30 offen
.g2_kernel_bp31n0:
  s_mov_b64 exec, -1
  v_cmp_lt_u32 vcc, s62, v14
  s_and_b64 exec, vcc, s[10:11]
  s_cbranch_scc0 .g2_kernel_bp31n1
  s_andn2_b64 s[10:11], s[10:11], vcc
  buffer_load_dword v1, v6, s[4:7], s34 offen
.g2_kernel_bp31n1:
  s_mov_b64 exec, -1
  v_cmp_lt_u32 vcc, s62, v15
  s_and_b64 exec, vcc, s[12:13]
  s_cbranch_scc0 .g2_kernel_bp31n2
  s_andn2_b64 s[12:13], s[12:13], vcc
  buffer_load_dword v1, v6, s[4:7], s35 offen
.g2_kernel_bp31n2:
  s_mov_b64 exec, -1
  v_cmp_lt_u32 vcc, s62, v16
  s_and_b64 exec, vcc, s[14:15]
  s_cbranch_scc0 .g2_kernel_bp31n3
  s_andn2_b64 s[14:15], s[14:15], vcc
  buffer_load_dword v1, v6, s[4:7], s36 offen
.g2_kernel_bp31n3:
  s_mov_b64 exec, -1
  s_sleep 10
  ds_read_b32 v12, v11
  s_waitcnt lgkmcnt(0)
  v_cmp_lt_u32 vcc, s33, v12
  s_cbranch_vccnz .g2_kernel_bp31d
  s_cmp_lt_u32 s38, 131072
  s_cbranch_scc1 .g2_kernel_bp31
.g2_kernel_bp31d:
.g2_kernel_v_5:
  s_mov_b32 s29, 1
  s_call_b64 s[68:69], .g2_kernel_v_cmb
  s_and_b32 s33, s16, 3
  s_lshl_b32 s33, s33, 7
  s_lshl_b32 s28, s29, 2
  s_add_u32 s33, s33, s28
  s_add_u32 s31, s19, s33
  v_mov_b32 v6, s70
  s_mov_b64 exec, 1
  buffer_store_dword v6, v4, s[4:7], s31 offen offset:0 sc1
  s_mov_b64 exec, -1
  s_cmp_lg_u32 s16, 4
  s_cbranch_scc1 .g2_kernel_v_8
  s_waitcnt vmcnt(3)
  v_mov_b32 v6, s71
  s_mov_b32 s38, 0
.g2_kernel_wg32:
  ds_read_b32 v7, v6 offset:76
  s_add_u32 s38, s38, 1
  s_waitcnt lgkmcnt(0)
  v_cmp_le_u32 vcc, 1, v7
  s_cbranch_vccnz .g2_kernel_wg32d
  s_sleep 1
  s_cmp_lt_u32 s38, 524288
  s_cbranch_scc1 .g2_kernel_wg32
.g2_kernel_wg32d:
  ds_write_b128 v3, v[192:195] offset:49152
  ds_write_b128 v3, v[196:199] offset:50176
  ds_write_b128 v3, v[200:203] offset:51200
  ds_write_b128 v3, v[204:207] offset:52224
  ds_write_b128 v3, v[208:211] offset:53248
  ds_write_b128 v3, v[212:215] offset:54272
  ds_write_b128 v3, v[216:219] offset:55296
  ds_write_b128 v3, v[220:223] offset:56320
  ds_write_b128 v3, v[224:227] offset:57344
  ds_write_b128 v3, v[228:231] offset:58368
  ds_write_b128 v3, v[232:235] offset:59392
  ds_write_b128 v3, v[236:239] offset:60416
  ds_write_b128 v3, v[240:243] offset:61440
  ds_write_b128 v3, v[244:247] offset:62464
  ds_write_b128 v3, v[248:251] offset:63488
  ds_write_b128 v3, v[252:255] offset:64512
  v_mov_b32 v6, s71
  s_mov_b32 s38, 0
.g2_kernel_wg33:
  ds_read_b32 v7, v6 offset:68
  s_add_u32 s38, s38, 1
  s_waitcnt lgkmcnt(0)
  v_cmp_le_u32 vcc, 1, v7
  s_cbranch_vccnz .g2_kernel_wg33d
  s_sleep 1
  s_cmp_lt_u32 s38, 524288
  s_cbranch_scc1 .g2_kernel_wg33
.g2_kernel_wg33d:
  ds_write_b128 v3, v[64:67] offset:16384
  ds_write_b128 v3, v[68:71] offset:17408
  ds_write_b128 v3, v[72:75] offset:18432
  ds_write_b128 v3, v[76:79] offset:19456
  ds_write_b128 v3, v[80:83] offset:20480
  ds_write_b128 v3, v[84:87] offset:21504
  ds_write_b128 v3, v[88:91] offset:22528
  ds_write_b128 v3, v[92:95] offset:23552
  ds_write_b128 v3, v[96:99] offset:24576
  ds_write_b128 v3, v[100:103] offset:25600
  ds_write_b128 v3, v[104:107] offset:26624
  ds_write_b128 v3, v[108:111] offset:27648
  ds_write_b128 v3, v[112:115] offset:28672
  ds_write_b128 v3, v[116:119] offset:29696
  ds_write_b128 v3, v[120:123] offset:30720
  ds_write_b128 v3, v[124:127] offset:31744
  v_mov_b32 v6, s71
  s_mov_b32 s38, 0
.g2_kernel_wg34:
  ds_read_b32 v7, v6 offset:72
  s_add_u32 s38, s38, 1
  s_waitcnt lgkmcnt(0)
  v_cmp_le_u32 vcc, 1, v7
  s_cbranch_vccnz .g2_kernel_wg34d
  s_sleep 1
  s_cmp_lt_u32 s38, 524288
  s_cbranch_scc1 .g2_kernel_wg34
.g2_kernel_wg34d:
  ds_write_b128 v3, v[128:131] offset:32768
  ds_write_b128 v3, v[132:135] offset:33792
  ds_write_b128 v3, v[136:139] offset:34816
  ds_write_b128 v3, v[140:143] offset:35840
  ds_write_b128 v3, v[144:147] offset:36864
  ds_write_b128 v3, v[148:151] offset:37888
  ds_write_b128 v3, v[152:155] offset:38912
  ds_write_b128 v3, v[156:159] offset:39936
  ds_write_b128 v3, v[160:163] offset:40960
  ds_write_b128 v3, v[164:167] offset:41984
  ds_write_b128 v3, v[168:171] offset:43008
  ds_write_b128 v3, v[172:175] offset:44032
  ds_write_b128 v3, v[176:179] offset:45056
  ds_write_b128 v3, v[180:183] offset:46080
  ds_write_b128 v3, v[184:187] offset:47104
  ds_write_b128 v3, v[188:191] offset:48128
  v_mov_b32 v8, 4
  ds_write_b32 v6, v8 offset:12
.g2_kernel_v_8:
  s_cmp_eq_u32 s16, 5
  s_cbranch_scc1 .g2_kernel_c1
  s_cmp_lg_u32 s16, 4
  s_cbranch_scc1 .g2_kernel_c2
  s_cmp_lg_u32 s62, 0
  s_cbranch_scc1 .g2_kernel_fin1
  s_setprio 3
  s_mov_b32 s12, s42
  s_mov_b32 s13, s43
  s_mov_b32 s14, 0x600000
  s_mov_b32 s15, 0x00020000
  v_lshrrev_b32 v28, 3, v2
  v_and_b32 v29, 7, v2
  v_bfe_u32 v30, v2, 4, 1
  v_lshlrev_b32 v30, 1, v30
  v_xor_b32 v31, v29, v30
  v_lshlrev_b32 v31, 4, v31
  v_mul_u32_u24 v28, 6144, v28
  v_add_u32 v28, v28, v31
  v_xor_b32 v29, 64, v28
  v_lshlrev_b32 v9, 8, v2
  v_and_b32 v9, 0x300, v9
  v_add_u32 v9, 156416, v9
  v_add_u32 v48, 0, v28
  v_add_u32 v49, 48128, v29
  v_add_u32 v50, 96256, v28
  v_add_u32 v51, 144384, v29
  v_add_u32 v52, 2048, v28
  v_add_u32 v53, 50176, v29
  v_add_u32 v54, 98304, v28
  v_add_u32 v55, 146432, v29
  v_add_u32 v56, 4096, v28
  v_add_u32 v57, 52224, v29
  v_add_u32 v58, 100352, v28
  v_add_u32 v59, 148480, v29
  v_and_b32 v11, 15, v2
  v_xor_b32 v11, s18, v11
  v_and_b32 v12, 48, v2
  v_add_u32 v11, v11, v12
  v_lshlrev_b32 v11, 2, v11
  v_add_u32 v11, 158208, v11
  s_lshl_b32 s39, s18, 7
  s_lshl_b32 s32, s17, 18
  s_add_u32 s32, s32, 0xc00000
  s_mov_b32 s30, 0
  s_mov_b32 s29, 0
  s_mov_b32 s37, 0
  v_mov_b32 v6, s71
  s_mov_b32 s38, 0
.g2_kernel_wg35:
  ds_read_b32 v7, v6 offset:16
  s_add_u32 s38, s38, 1
  s_waitcnt lgkmcnt(0)
  v_cmp_le_u32 vcc, 4, v7
  s_cbranch_vccnz .g2_kernel_wg35d
  s_sleep 2
  s_cmp_lt_u32 s38, 524288
  s_cbranch_scc1 .g2_kernel_wg35
.g2_kernel_wg35d:
  s_xor_b32 s36, s18, 0
  s_mul_i32 s36, s36, 393216
  s_add_u32 s36, s36, s39
  s_add_u32 m0, s30, 65536
  s_waitcnt vmcnt(63)
  buffer_load_dwordx4 v48, s[12:15], s36 offen offset:0 lds
  buffer_load_dwordx4 v49, s[12:15], s36 offen offset:1024 lds
  buffer_load_dwordx4 v50, s[12:15], s36 offen offset:2048 lds
  buffer_load_dwordx4 v51, s[12:15], s36 offen offset:3072 lds
  s_add_u32 m0, s30, 69632
  s_waitcnt vmcnt(63)
  buffer_load_dwordx4 v52, s[12:15], s36 offen offset:0 lds
  buffer_load_dwordx4 v53, s[12:15], s36 offen offset:1024 lds
  buffer_load_dwordx4 v54, s[12:15], s36 offen offset:2048 lds
  buffer_load_dwordx4 v55, s[12:15], s36 offen offset:3072 lds
  s_add_u32 m0, s30, 73728
  s_waitcnt vmcnt(63)
  buffer_load_dwordx4 v56, s[12:15], s36 offen offset:0 lds
  buffer_load_dwordx4 v57, s[12:15], s36 offen offset:1024 lds
  buffer_load_dwordx4 v58, s[12:15], s36 offen offset:2048 lds
  buffer_load_dwordx4 v59, s[12:15], s36 offen offset:3072 lds
  s_add_u32 s30, s30, 12288
  s_cmp_eq_u32 s30, 86016
  s_cselect_b32 s30, 0, s30
  s_xor_b32 s36, s18, 0
  s_mul_i32 s36, s36, 393216
  s_add_u32 s36, s36, s39
  s_add_u32 s36, s36, 196608
  s_add_u32 m0, s30, 65536
  s_waitcnt vmcnt(63)
  buffer_load_dwordx4 v48, s[12:15], s36 offen offset:0 lds
  buffer_load_dwordx4 v49, s[12:15], s36 offen offset:1024 lds
  buffer_load_dwordx4 v50, s[12:15], s36 offen offset:2048 lds
  buffer_load_dwordx4 v51, s[12:15], s36 offen offset:3072 lds
  s_add_u32 m0, s30, 69632
  s_waitcnt vmcnt(63)
  buffer_load_dwordx4 v52, s[12:15], s36 offen offset:0 lds
  buffer_load_dwordx4 v53, s[12:15], s36 offen offset:1024 lds
  buffer_load_dwordx4 v54, s[12:15], s36 offen offset:2048 lds
  buffer_load_dwordx4 v55, s[12:15], s36 offen offset:3072 lds
  s_add_u32 m0, s30, 73728
  s_waitcnt vmcnt(63)
  buffer_load_dwordx4 v56, s[12:15], s36 offen offset:0 lds
  buffer_load_dwordx4 v57, s[12:15], s36 offen offset:1024 lds
  buffer_load_dwordx4 v58, s[12:15], s36 offen offset:2048 lds
  buffer_load_dwordx4 v59, s[12:15], s36 offen offset:3072 lds
  s_add_u32 s30, s30, 12288
  s_cmp_eq_u32 s30, 86016
  s_cselect_b32 s30, 0, s30
  s_mov_b32 m0, 156160
  s_mov_b32 s35, .g2_kernel_tab-.g2_kernel_pc+136
  buffer_load_dword off, s[64:67], s35 lds
  s_xor_b32 s36, s18, 1
  s_mul_i32 s36, s36, 393216
  s_add_u32 s36, s36, s39
  s_add_u32 m0, s30, 65536
  s_waitcnt vmcnt(63)
  buffer_load_dwordx4 v48, s[12:15], s36 offen offset:0 lds
  buffer_load_dwordx4 v49, s[12:15], s36 offen offset:1024 lds
  buffer_load_dwordx4 v50, s[12:15], s36 offen offset:2048 lds
  buffer_load_dwordx4 v51, s[12:15], s36 offen offset:3072 lds
  s_add_u32 m0, s30, 69632
  s_waitcnt vmcnt(63)
  buffer_load_dwordx4 v52, s[12:15], s36 offen offset:0 lds
  buffer_load_dwordx4 v53, s[12:15], s36 offen offset:1024 lds
  buffer_load_dwordx4 v54, s[12:15], s36 offen offset:2048 lds
  buffer_load_dwordx4 v55, s[12:15], s36 offen offset:3072 lds
  s_add_u32 m0, s30, 73728
  s_waitcnt vmcnt(63)
  buffer_load_dwordx4 v56, s[12:15], s36 offen offset:0 lds
  buffer_load_dwordx4 v57, s[12:15], s36 offen offset:1024 lds
  buffer_load_dwordx4 v58, s[12:15], s36 offen offset:2048 lds
  buffer_load_dwordx4 v59, s[12:15], s36 offen offset:3072 lds
  s_add_u32 s30, s30, 12288
  s_cmp_eq_u32 s30, 86016
  s_cselect_b32 s30, 0, s30
  s_xor_b32 s36, s18, 1
  s_mul_i32 s36, s36, 393216
  s_add_u32 s36, s36, s39
  s_add_u32 s36, s36, 196608
  s_add_u32 m0, s30, 65536
  s_waitcnt vmcnt(63)
  buffer_load_dwordx4 v48, s[12:15], s36 offen offset:0 lds
  buffer_load_dwordx4 v49, s[12:15], s36 offen offset:1024 lds
  buffer_load_dwordx4 v50, s[12:15], s36 offen offset:2048 lds
  buffer_load_dwordx4 v51, s[12:15], s36 offen offset:3072 lds
  s_add_u32 m0, s30, 69632
  s_waitcnt vmcnt(63)
  buffer_load_dwordx4 v52, s[12:15], s36 offen offset:0 lds
  buffer_load_dwordx4 v53, s[12:15], s36 offen offset:1024 lds
  buffer_load_dwordx4 v54, s[12:15], s36 offen offset:2048 lds
  buffer_load_dwordx4 v55, s[12:15], s36 offen offset:3072 lds
  s_add_u32 m0, s30, 73728
  s_waitcnt vmcnt(63)
  buffer_load_dwordx4 v56, s[12:15], s36 offen offset:0 lds
  buffer_load_dwordx4 v57, s[12:15], s36 offen offset:1024 lds
  buffer_load_dwordx4 v58, s[12:15], s36 offen offset:2048 lds
  buffer_load_dwordx4 v59, s[12:15], s36 offen offset:3072 lds
  s_add_u32 s30, s30, 12288
  s_cmp_eq_u32 s30, 86016
  s_cselect_b32 s30, 0, s30
  s_xor_b32 s36, s18, 2
  s_mul_i32 s36, s36, 393216
  s_add_u32 s36, s36, s39
  s_add_u32 m0, s30, 65536
  s_waitcnt vmcnt(63)
  buffer_load_dwordx4 v48, s[12:15], s36 offen offset:0 lds
  buffer_load_dwordx4 v49, s[12:15], s36 offen offset:1024 lds
  buffer_load_dwordx4 v50, s[12:15], s36 offen offset:2048 lds
  buffer_load_dwordx4 v51, s[12:15], s36 offen offset:3072 lds
  s_add_u32 m0, s30, 69632
  s_waitcnt vmcnt(63)
  buffer_load_dwordx4 v52, s[12:15], s36 offen offset:0 lds
  buffer_load_dwordx4 v53, s[12:15], s36 offen offset:1024 lds
  buffer_load_dwordx4 v54, s[12:15], s36 offen offset:2048 lds
  buffer_load_dwordx4 v55, s[12:15], s36 offen offset:3072 lds
  s_add_u32 m0, s30, 73728
  s_waitcnt vmcnt(63)
  buffer_load_dwordx4 v56, s[12:15], s36 offen offset:0 lds
  buffer_load_dwordx4 v57, s[12:15], s36 offen offset:1024 lds
  buffer_load_dwordx4 v58, s[12:15], s36 offen offset:2048 lds
  buffer_load_dwordx4 v59, s[12:15], s36 offen offset:3072 lds
  s_add_u32 s30, s30, 12288
  s_cmp_eq_u32 s30, 86016
  s_cselect_b32 s30, 0, s30
  v_mov_b32 v6, s71
  s_mov_b32 s38, 0
.g2_kernel_wg36:
  ds_read_b32 v7, v6 offset:20
  s_add_u32 s38, s38, 1
  s_waitcnt lgkmcnt(0)
  v_cmp_le_u32 vcc, 4, v7
  s_cbranch_vccnz .g2_kernel_wg36d
  s_sleep 1
  s_cmp_lt_u32 s38, 524288
  s_cbranch_scc1 .g2_kernel_wg36
.g2_kernel_wg36d:
  s_mov_b32 s62, 1
  s_mov_b32 s63, 0x1800000
  s_mov_b32 s70, 2
  s_mov_b32 s71, 155776
  s_xor_b32 s36, s18, 2
  s_mul_i32 s36, s36, 393216
  s_add_u32 s36, s36, s39
  s_add_u32 s36, s36, 196608
  s_add_u32 m0, s30, 65536
  s_waitcnt vmcnt(63)
  buffer_load_dwordx4 v48, s[12:15], s36 offen offset:0 lds
  buffer_load_dwordx4 v49, s[12:15], s36 offen offset:1024 lds
  buffer_load_dwordx4 v50, s[12:15], s36 offen offset:2048 lds
  buffer_load_dwordx4 v51, s[12:15], s36 offen offset:3072 lds
  s_add_u32 m0, s30, 69632
  s_waitcnt vmcnt(63)
  buffer_load_dwordx4 v52, s[12:15], s36 offen offset:0 lds
  buffer_load_dwordx4 v53, s[12:15], s36 offen offset:1024 lds
  buffer_load_dwordx4 v54, s[12:15], s36 offen offset:2048 lds
  buffer_load_dwordx4 v55, s[12:15], s36 offen offset:3072 lds
  s_add_u32 m0, s30, 73728
  s_waitcnt vmcnt(63)
  buffer_load_dwordx4 v56, s[12:15], s36 offen offset:0 lds
  buffer_load_dwordx4 v57, s[12:15], s36 offen offset:1024 lds
  buffer_load_dwordx4 v58, s[12:15], s36 offen offset:2048 lds
  buffer_load_dwordx4 v59, s[12:15], s36 offen offset:3072 lds
  s_add_u32 s30, s30, 12288
  s_cmp_eq_u32 s30, 86016
  s_cselect_b32 s30, 0, s30
  s_xor_b32 s36, s18, 3
  s_mul_i32 s36, s36, 393216
  s_add_u32 s36, s36, s39
  s_add_u32 m0, s30, 65536
  s_waitcnt vmcnt(63)
  buffer_load_dwordx4 v48, s[12:15], s36 offen offset:0 lds
  buffer_load_dwordx4 v49, s[12:15], s36 offen offset:1024 lds
  buffer_load_dwordx4 v50, s[12:15], s36 offen offset:2048 lds
  buffer_load_dwordx4 v51, s[12:15], s36 offen offset:3072 lds
  s_add_u32 m0, s30, 69632
  s_waitcnt vmcnt(63)
  buffer_load_dwordx4 v52, s[12:15], s36 offen offset:0 lds
  buffer_load_dwordx4 v53, s[12:15], s36 offen offset:1024 lds
  buffer_load_dwordx4 v54, s[12:15], s36 offen offset:2048 lds
  buffer_load_dwordx4 v55, s[12:15], s36 offen offset:3072 lds
  s_add_u32 m0, s30, 73728
  s_waitcnt vmcnt(63)
  buffer_load_dwordx4 v56, s[12:15], s36 offen offset:0 lds
  buffer_load_dwordx4 v57, s[12:15], s36 offen offset:1024 lds
  buffer_load_dwordx4 v58, s[12:15], s36 offen offset:2048 lds
  buffer_load_dwordx4 v59, s[12:15], s36 offen offset:3072 lds
  s_add_u32 s30, s30, 12288
  s_cmp_eq_u32 s30, 86016
  s_cselect_b32 s30, 0, s30
  s_mov_b32 s28, 1
  s_mov_b32 s29, 16384
  s_bitcmp1_b32 s37, s28
  s_cbranch_scc0 .g2_kernel_p2_x0w
.g2_kernel_p2_x0b:
  s_xor_b32 s33, s28, s18
  s_lshl_b32 s33, s33, 14
  s_add_u32 s33, s33, s32
  s_add_u32 m0, s29, 0
  s_waitcnt vmcnt(63)
  buffer_load_dwordx4 v3, s[4:7], s33 offen offset:0 lds
  buffer_load_dwordx4 v3, s[4:7], s33 offen offset:1024 lds
  buffer_load_dwordx4 v3, s[4:7], s33 offen offset:2048 lds
  buffer_load_dwordx4 v3, s[4:7], s33 offen offset:3072 lds
  s_add_u32 m0, s29, 4096
  s_waitcnt vmcnt(63)
  s_add_u32 s33, s33, 4096
  buffer_load_dwordx4 v3, s[4:7], s33 offen offset:0 lds
  buffer_load_dwordx4 v3, s[4:7], s33 offen offset:1024 lds
  buffer_load_dwordx4 v3, s[4:7], s33 offen offset:2048 lds
  buffer_load_dwordx4 v3, s[4:7], s33 offen offset:3072 lds
  s_add_u32 m0, s29, 8192
  s_waitcnt vmcnt(63)
  s_add_u32 s33, s33, 4096
  buffer_load_dwordx4 v3, s[4:7], s33 offen offset:0 lds
  buffer_load_dwordx4 v3, s[4:7], s33 offen offset:1024 lds
  buffer_load_dwordx4 v3, s[4:7], s33 offen offset:2048 lds
  buffer_load_dwordx4 v3, s[4:7], s33 offen offset:3072 lds
  s_add_u32 m0, s29, 12288
  s_waitcnt vmcnt(63)
  s_add_u32 s33, s33, 4096
  buffer_load_dwordx4 v3, s[4:7], s33 offen offset:0 lds
  buffer_load_dwordx4 v3, s[4:7], s33 offen offset:1024 lds
  buffer_load_dwordx4 v3, s[4:7], s33 offen offset:2048 lds
  buffer_load_dwordx4 v3, s[4:7], s33 offen offset:3072 lds
  s_mov_b32 m0, 156160
  s_mov_b32 s35, .g2_kernel_tab-.g2_kernel_pc+144
  buffer_load_dword off, s[64:67], s35 lds
  s_mov_b32 s28, 2
  s_mov_b32 s29, 32768
  s_bitcmp1_b32 s37, s28
  s_cbranch_scc0 .g2_kernel_p2_x1w
.g2_kernel_p2_x1b:
  s_xor_b32 s33, s28, s18
  s_lshl_b32 s33, s33, 14
  s_add_u32 s33, s33, s32
  s_add_u32 m0, s29, 0
  s_waitcnt vmcnt(63)
  buffer_load_dwordx4 v3, s[4:7], s33 offen offset:0 lds
  buffer_load_dwordx4 v3, s[4:7], s33 offen offset:1024 lds
  buffer_load_dwordx4 v3, s[4:7], s33 offen offset:2048 lds
  buffer_load_dwordx4 v3, s[4:7], s33 offen offset:3072 lds
  s_add_u32 m0, s29, 4096
  s_waitcnt vmcnt(63)
  s_add_u32 s33, s33, 4096
  buffer_load_dwordx4 v3, s[4:7], s33 offen offset:0 lds
  buffer_load_dwordx4 v3, s[4:7], s33 offen offset:1024 lds
  buffer_load_dwordx4 v3, s[4:7], s33 offen offset:2048 lds
  buffer_load_dwordx4 v3, s[4:7], s33 offen offset:3072 lds
  s_add_u32 m0, s29, 8192
  s_waitcnt vmcnt(63)
  s_add_u32 s33, s33, 4096
  buffer_load_dwordx4 v3, s[4:7], s33 offen offset:0 lds
  buffer_load_dwordx4 v3, s[4:7], s33 offen offset:1024 lds
  buffer_load_dwordx4 v3, s[4:7], s33 offen offset:2048 lds
  buffer_load_dwordx4 v3, s[4:7], s33 offen offset:3072 lds
  s_add_u32 m0, s29, 12288
  s_waitcnt vmcnt(63)
  s_add_u32 s33, s33, 4096
  buffer_load_dwordx4 v3, s[4:7], s33 offen offset:0 lds
  buffer_load_dwordx4 v3, s[4:7], s33 offen offset:1024 lds
  buffer_load_dwordx4 v3, s[4:7], s33 offen offset:2048 lds
  buffer_load_dwordx4 v3, s[4:7], s33 offen offset:3072 lds
  s_mov_b32 m0, 156160
  s_mov_b32 s35, .g2_kernel_tab-.g2_kernel_pc+152
  buffer_load_dword off, s[64:67], s35 lds
  s_mov_b32 s28, 3
  s_mov_b32 s29, 49152
  s_bitcmp1_b32 s37, s28
  s_cbranch_scc0 .g2_kernel_p2_x2w
.g2_kernel_p2_x2b:
  s_xor_b32 s33, s28, s18
  s_lshl_b32 s33, s33, 14
  s_add_u32 s33, s33, s32
  s_add_u32 m0, s29, 0
  s_waitcnt vmcnt(63)
  buffer_load_dwordx4 v3, s[4:7], s33 offen offset:0 lds
  buffer_load_dwordx4 v3, s[4:7], s33 offen offset:1024 lds
  buffer_load_dwordx4 v3, s[4:7], s33 offen offset:2048 lds
  buffer_load_dwordx4 v3, s[4:7], s33 offen offset:3072 lds
  s_add_u32 m0, s29, 4096
  s_waitcnt vmcnt(63)
  s_add_u32 s33, s33, 4096
  buffer_load_dwordx4 v3, s[4:7], s33 offen offset:0 lds
  buffer_load_dwordx4 v3, s[4:7], s33 offen offset:1024 lds
  buffer_load_dwordx4 v3, s[4:7], s33 offen offset:2048 lds
  buffer_load_dwordx4 v3, s[4:7], s33 offen offset:3072 lds
  s_add_u32 m0, s29, 8192
  s_waitcnt vmcnt(63)
  s_add_u32 s33, s33, 4096
  buffer_load_dwordx4 v3, s[4:7], s33 offen offset:0 lds
  buffer_load_dwordx4 v3, s[4:7], s33 offen offset:1024 lds
  buffer_load_dwordx4 v3, s[4:7], s33 offen offset:2048 lds
  buffer_load_dwordx4 v3, s[4:7], s33 offen offset:3072 lds
  s_add_u32 m0, s29, 12288
  s_waitcnt vmcnt(63)
  s_add_u32 s33, s33, 4096
  buffer_load_dwordx4 v3, s[4:7], s33 offen offset:0 lds
  buffer_load_dwordx4 v3, s[4:7], s33 offen offset:1024 lds
  buffer_load_dwordx4 v3, s[4:7], s33 offen offset:2048 lds
  buffer_load_dwordx4 v3, s[4:7], s33 offen offset:3072 lds
  s_mov_b32 m0, 156160
  s_mov_b32 s35, .g2_kernel_tab-.g2_kernel_pc+156
  buffer_load_dword off, s[64:67], s35 lds
  s_xor_b32 s36, s18, 3
  s_mul_i32 s36, s36, 393216
  s_add_u32 s36, s36, s39
  s_add_u32 s36, s36, 196608
  ds_read_b32 v10, v9
  s_mov_b32 s34, 33
  s_mov_b32 s35, .g2_kernel_tab-.g2_kernel_pc+160
  s_branch .g2_kernel_p2_o
  .p2align 6
.g2_kernel_p2_l:
  s_waitcnt lgkmcnt(0)
  v_cmp_gt_i32 vcc, s34, v10
  s_cbranch_vccnz .g2_kernel_p2_aw
.g2_kernel_p2_ai:
  s_add_u32 s29, s29, 16384
  s_and_b32 s29, s29, 0xffff
  s_bitcmp1_b32 s37, s28
  s_cbranch_scc0 .g2_kernel_p2_x3w
.g2_kernel_p2_x3b:
  s_xor_b32 s33, s28, s18
  s_lshl_b32 s33, s33, 14
  s_add_u32 s33, s33, s32
  s_add_u32 m0, s29, 0
  s_waitcnt vmcnt(63)
  buffer_load_dwordx4 v3, s[4:7], s33 offen offset:0 lds
  buffer_load_dwordx4 v3, s[4:7], s33 offen offset:1024 lds
  buffer_load_dwordx4 v3, s[4:7], s33 offen offset:2048 lds
  buffer_load_dwordx4 v3, s[4:7], s33 offen offset:3072 lds
  s_add_u32 m0, s29, 4096
  s_waitcnt vmcnt(63)
  s_add_u32 s33, s33, 4096
  buffer_load_dwordx4 v3, s[4:7], s33 offen offset:0 lds
  buffer_load_dwordx4 v3, s[4:7], s33 offen offset:1024 lds
  buffer_load_dwordx4 v3, s[4:7], s33 offen offset:2048 lds
  buffer_load_dwordx4 v3, s[4:7], s33 offen offset:3072 lds
  s_add_u32 m0, s29, 8192
  s_waitcnt vmcnt(63)
  s_add_u32 s33, s33, 4096
  buffer_load_dwordx4 v3, s[4:7], s33 offen offset:0 lds
  buffer_load_dwordx4 v3, s[4:7], s33 offen offset:1024 lds
  buffer_load_dwordx4 v3, s[4:7], s33 offen offset:2048 lds
  buffer_load_dwordx4 v3, s[4:7], s33 offen offset:3072 lds
  s_add_u32 m0, s29, 12288
  s_waitcnt vmcnt(63)
  s_add_u32 s33, s33, 4096
  buffer_load_dwordx4 v3, s[4:7], s33 offen offset:0 lds
  buffer_load_dwordx4 v3, s[4:7], s33 offen offset:1024 lds
  buffer_load_dwordx4 v3, s[4:7], s33 offen offset:2048 lds
  buffer_load_dwordx4 v3, s[4:7], s33 offen offset:3072 lds
  s_add_u32 m0, s30, 65536
  s_waitcnt vmcnt(63)
  buffer_load_dwordx4 v48, s[12:15], s36 offen offset:0 lds
  buffer_load_dwordx4 v49, s[12:15], s36 offen offset:1024 lds
  buffer_load_dwordx4 v50, s[12:15], s36 offen offset:2048 lds
  buffer_load_dwordx4 v51, s[12:15], s36 offen offset:3072 lds
  s_add_u32 m0, s30, 69632
  s_waitcnt vmcnt(63)
  buffer_load_dwordx4 v52, s[12:15], s36 offen offset:0 lds
  buffer_load_dwordx4 v53, s[12:15], s36 offen offset:1024 lds
  buffer_load_dwordx4 v54, s[12:15], s36 offen offset:2048 lds
  buffer_load_dwordx4 v55, s[12:15], s36 offen offset:3072 lds
  s_add_u32 m0, s30, 73728
  s_waitcnt vmcnt(63)
  buffer_load_dwordx4 v56, s[12:15], s36 offen offset:0 lds
  buffer_load_dwordx4 v57, s[12:15], s36 offen offset:1024 lds
  buffer_load_dwordx4 v58, s[12:15], s36 offen offset:2048 lds
  buffer_load_dwordx4 v59, s[12:15], s36 offen offset:3072 lds
  s_add_u32 s30, s30, 12288
  s_cmp_eq_u32 s30, 86016
  s_cselect_b32 s30, 0, s30
  ds_read_b32 v10, v9
  s_mov_b32 m0, 156160
  s_add_u32 s34, s34, 1
  buffer_load_dword off, s[64:67], s35 lds
  s_add_u32 s35, s35, 4
  s_add_u32 s36, s36, 196608
.g2_kernel_p2_o:
  s_waitcnt lgkmcnt(0)
  v_cmp_gt_i32 vcc, s34, v10
  s_cbranch_vccnz .g2_kernel_p2_bw
.g2_kernel_p2_bi:
  s_add_u32 m0, s30, 65536
  s_waitcnt vmcnt(63)
  buffer_load_dwordx4 v48, s[12:15], s36 offen offset:0 lds
  buffer_load_dwordx4 v49, s[12:15], s36 offen offset:1024 lds
  buffer_load_dwordx4 v50, s[12:15], s36 offen offset:2048 lds
  buffer_load_dwordx4 v51, s[12:15], s36 offen offset:3072 lds
  s_add_u32 m0, s30, 69632
  s_waitcnt vmcnt(63)
  buffer_load_dwordx4 v52, s[12:15], s36 offen offset:0 lds
  buffer_load_dwordx4 v53, s[12:15], s36 offen offset:1024 lds
  buffer_load_dwordx4 v54, s[12:15], s36 offen offset:2048 lds
  buffer_load_dwordx4 v55, s[12:15], s36 offen offset:3072 lds
  s_add_u32 m0, s30, 73728
  s_waitcnt vmcnt(63)
  buffer_load_dwordx4 v56, s[12:15], s36 offen offset:0 lds
  buffer_load_dwordx4 v57, s[12:15], s36 offen offset:1024 lds
  buffer_load_dwordx4 v58, s[12:15], s36 offen offset:2048 lds
  buffer_load_dwordx4 v59, s[12:15], s36 offen offset:3072 lds
  s_add_u32 s30, s30, 12288
  s_cmp_eq_u32 s30, 86016
  s_cselect_b32 s30, 0, s30
  ds_read_b32 v10, v9
  s_mov_b32 m0, 156160
  s_add_u32 s34, s34, 1
  buffer_load_dword off, s[64:67], s35 lds
  s_add_u32 s35, s35, 4
  s_add_u32 s28, s28, 1
  s_xor_b32 s36, s18, s28
  s_mul_i32 s36, s36, 393216
  s_add_u32 s36, s36, s39
  s_cmp_lt_i32 s34, 58
  s_cbranch_scc1 .g2_kernel_p2_l
  s_branch .g2_kernel_v
.g2_kernel_c1:
  v_mov_b32 v6, s71
  s_mov_b32 s38, 0
.g2_kernel_wg37:
  ds_read_b32 v7, v6 offset:76
  s_add_u32 s38, s38, 1
  s_waitcnt lgkmcnt(0)
  v_cmp_le_u32 vcc, 1, v7
  s_cbranch_vccnz .g2_kernel_wg37d
  s_sleep 1
  s_cmp_lt_u32 s38, 524288
  s_cbranch_scc1 .g2_kernel_wg37
.g2_kernel_wg37d:
  s_sleep 4
  s_and_b32 s31, s19, 0xffffe000
  s_add_u32 s31, s31, 4
  v_and_b32 v6, 15, v2
  v_lshlrev_b32 v6, 9, v6
  v_lshrrev_b32 v7, 4, v2
  v_lshl_add_u32 v6, v7, 7, v6
  v_lshlrev_b32 v7, 2, v2
  v_add_u32 v7, 157952, v7
  s_mov_b32 m0, 157952
  s_mov_b32 s38, 0
.g2_kernel_pa38:
  buffer_load_dword v6, s[4:7], s31 offen sc1 lds
  s_add_u32 s38, s38, 1
  s_waitcnt vmcnt(0)
  ds_read_b32 v8, v7
  s_waitcnt lgkmcnt(0)
  v_cmp_ge_u32 vcc, s62, v8
  s_cbranch_vccz .g2_kernel_pa38d
  s_mov_b64 exec, vcc
  s_sleep 4
  s_cmp_lt_u32 s38, 131072
  s_cbranch_scc1 .g2_kernel_pa38
.g2_kernel_pa38d:
  s_mov_b64 exec, -1
  s_setprio 2
  s_mov_b32 s39, 0
  s_lshl_b32 s30, s17, 4
  s_add_u32 s30, s30, s18
  s_lshl_b32 s20, s30, 11
  s_add_u32 s20, s20, s63
  s_add_u32 s20, s20, 0x1000000
  s_lshl_b32 s21, s30, 6
  s_add_u32 s21, s21, s63
  s_add_u32 s21, s21, 0x1080000
  s_lshl_b32 s23, s62, 16
  s_add_u32 s23, s23, 0x3040000
  s_lshl_b32 s22, s30, 5
  s_add_u32 s22, s22, s23
  s_and_b32 s28, s2, 7
  s_lshl_b32 s28, s28, 13
  s_add_u32 s23, s23, s28
  v_mov_b32 v9, 155648
  ds_read_b32 v26, v9 offset:256
  v_lshrrev_b32 v24, 4, v2
  v_lshlrev_b32 v25, 3, v24
  v_lshlrev_b32 v27, 13, v2
  v_and_b32 v31, 15, v2
  v_lshlrev_b32 v31, 7, v31
  v_lshl_add_u32 v31, v24, 4, v31
  v_mov_b32 v28, 0.0009765625
  v_mov_b32 v30, 1e-05
  v_mov_b32 v6, s71
  s_mov_b32 s38, 0
.g2_kernel_wg40:
  ds_read_b32 v7, v6 offset:20
  s_add_u32 s38, s38, 1
  s_waitcnt lgkmcnt(0)
  v_cmp_le_u32 vcc, 4, v7
  s_cbranch_vccnz .g2_kernel_wg40d
  s_sleep 1
  s_cmp_lt_u32 s38, 524288
  s_cbranch_scc1 .g2_kernel_wg40
.g2_kernel_wg40d:
  s_sleep 12
  s_cmp_lg_u32 s62, 0
  s_cbranch_scc1 .g2_kernel_nap41
  s_sleep 24
.g2_kernel_nap41:
  s_mov_b32 s38, 0
.g2_kernel_gx42:
  buffer_load_dwordx4 v[16:19], v31, s[4:7], s20 offen offset:0 sc1
  buffer_load_dwordx4 v[20:23], v31, s[4:7], s20 offen offset:64 sc1
  s_add_u32 s38, s38, 1
  s_waitcnt vmcnt(0)
  v_min3_u32 v6, v16, v19, v20
  v_min_u32 v6, v6, v23
  v_cmp_eq_u32 vcc, 0, v6
  s_cbranch_vccz .g2_kernel_gx42d
  s_mov_b64 exec, vcc
  s_sleep 1
  s_cmp_lg_u32 s62, 0
  s_cbranch_scc1 .g2_kernel_nap43
  s_sleep 23
.g2_kernel_nap43:
  s_cmp_lt_u32 s38, 131072
  s_cbranch_scc1 .g2_kernel_gx42
.g2_kernel_gx42d:
  s_mov_b64 exec, -1
  v_add_f32 v16, v16, v16 row_ror:8 row_mask:0xf bank_mask:0xf
  v_add_f32 v17, v17, v17 row_ror:8 row_mask:0xf bank_mask:0xf
  v_add_f32 v18, v18, v18 row_ror:8 row_mask:0xf bank_mask:0xf
  v_add_f32 v20, v20, v20 row_ror:8 row_mask:0xf bank_mask:0xf
  v_add_f32 v21, v21, v21 row_ror:8 row_mask:0xf bank_mask:0xf
  v_add_f32 v22, v22, v22 row_ror:8 row_mask:0xf bank_mask:0xf
  v_add_f32 v16, v16, v16 row_ror:4 row_mask:0xf bank_mask:0xf
  v_add_f32 v17, v17, v17 row_ror:4 row_mask:0xf bank_mask:0xf
  v_add_f32 v18, v18, v18 row_ror:4 row_mask:0xf bank_mask:0xf
  v_add_f32 v20, v20, v20 row_ror:4 row_mask:0xf bank_mask:0xf
  v_add_f32 v21, v21, v21 row_ror:4 row_mask:0xf bank_mask:0xf
  v_add_f32 v22, v22, v22 row_ror:4 row_mask:0xf bank_mask:0xf
  v_add_f32 v16, v16, v16 row_ror:2 row_mask:0xf bank_mask:0xf
  v_add_f32 v17, v17, v17 row_ror:2 row_mask:0xf bank_mask:0xf
  v_add_f32 v18, v18, v18 row_ror:2 row_mask:0xf bank_mask:0xf
  v_add_f32 v20, v20, v20 row_ror:2 row_mask:0xf bank_mask:0xf
  v_add_f32 v21, v21, v21 row_ror:2 row_mask:0xf bank_mask:0xf
  v_add_f32 v22, v22, v22 row_ror:2 row_mask:0xf bank_mask:0xf
  v_add_f32 v16, v16, v16 row_ror:1 row_mask:0xf bank_mask:0xf
  v_add_f32 v17, v17, v17 row_ror:1 row_mask:0xf bank_mask:0xf
  v_add_f32 v18, v18, v18 row_ror:1 row_mask:0xf bank_mask:0xf
  v_add_f32 v20, v20, v20 row_ror:1 row_mask:0xf bank_mask:0xf
  v_add_f32 v21, v21, v21 row_ror:1 row_mask:0xf bank_mask:0xf
  v_add_f32 v22, v22, v22 row_ror:1 row_mask:0xf bank_mask:0xf
  v_fma_f32 v18, -v16, v26, v18
  v_mul_f32 v16, v28, v16
  v_mul_f32 v19, v16, v16
  v_fma_f32 v17, v17, v28, -v19
  v_max_f32 v17, 0, v17
  v_add_f32 v17, v30, v17
  v_rsq_f32 v19, v17
  v_fma_f32 v22, -v20, v26, v22
  v_mul_f32 v20, v28, v20
  v_mul_f32 v23, v20, v20
  v_fma_f32 v21, v21, v28, -v23
  v_max_f32 v21, 0, v21
  v_add_f32 v21, v30, v21
  v_rsq_f32 v23, v21
  v_mul_f32 v18, v18, v19
  v_mul_f32 v22, v22, v23
  v_and_or_b32 v18, v18, -8, v24
  v_or_b32 v29, 4, v24
  v_and_or_b32 v22, v22, -8, v29
  v_max_f32 v10, v18, v22
  v_mov_b32 v11, 1
  s_nop 0
  v_max_f32 v10, v10, v10 row_bcast:15 row_mask:0xa bank_mask:0xf
  s_nop 1
  v_max_f32 v10, v10, v10 row_bcast:31 row_mask:0xc bank_mask:0xf
  s_nop 0
  v_readlane_b32 s28, v10, 63
  s_nop 1
  v_mov_b32 v10, s28
  s_mov_b64 exec, 0xff
  buffer_store_dwordx2 v[10:11], v27, s[4:7], s22 offen sc1
  s_mov_b32 exec_lo, 0x00010001
  s_mov_b32 exec_hi, 0x00010001
  buffer_store_dwordx2 v[16:17], v25, s[4:7], s21 offen sc1
  buffer_store_dwordx2 v[20:21], v25, s[4:7], s21 offen offset:32 sc1
  s_mov_b64 exec, -1
  s_cmp_lg_u32 s62, 0
  s_cbranch_scc1 .g2_kernel_c_t3
  s_sleep 30
  s_mov_b64 s[8:9], -1
  s_mov_b64 s[10:11], -1
  s_mov_b64 s[12:13], -1
  s_mov_b64 s[14:15], -1
  s_call_b64 s[68:69], .g2_kernel_amax
  s_add_u32 s28, s77, 1
  v_mov_b32 v10, s28
  v_mov_b32 v9, s71
  ds_write_b32 v9, v10 offset:36
  s_lshr_b32 s24, s77, 7
  s_lshl_b32 s24, s24, 18
  s_bfe_u32 s28, s77, 0x30004
  s_lshl_b32 s28, s28, 11
  s_add_u32 s24, s24, s28
  s_and_b32 s28, s77, 15
  s_lshl_b32 s28, s28, 4
  s_add_u32 s24, s24, s28
  s_add_u32 s24, s24, s63
  s_add_u32 s24, s24, 0xc00000
  s_lshl_b32 s28, s17, 14
  s_add_u32 s24, s24, s28
  s_and_b32 s28, s18, 1
  s_lshl_b32 s28, s28, 8
  s_add_u32 s24, s24, s28
  v_lshrrev_b32 v12, 3, v2
  v_lshlrev_b32 v13, 1, v12
  s_waitcnt lgkmcnt(0)
  s_wakeup
  buffer_load_ushort v56, v13, s[4:7], s24 offen offset:0
  buffer_load_ushort v57, v13, s[4:7], s24 offen offset:512
  buffer_load_ushort v58, v13, s[4:7], s24 offen offset:1024
  buffer_load_ushort v59, v13, s[4:7], s24 offen offset:1536
  s_lshl_b32 s25, s77, 3
  s_add_u32 s25, s25, s63
  s_add_u32 s25, s25, 0x1080000
  s_lshl_b32 s21, s17, 10
  s_add_u32 s21, s21, s63
  s_add_u32 s21, s21, 0x1080000
  s_mov_b32 s38, 0
.g2_kernel_gx44:
  buffer_load_dwordx4 v[16:19], v3, s[4:7], s21 offen sc1
  buffer_load_dwordx2 v[20:21], v4, s[4:7], s25 offen sc1
  s_add_u32 s38, s38, 1
  s_waitcnt vmcnt(0)
  v_min3_u32 v6, v17, v19, v21
  v_cmp_eq_u32 vcc, 0, v6
  s_cbranch_vccz .g2_kernel_gx44d
  s_mov_b64 exec, vcc
  s_sleep 1
  s_cmp_lt_u32 s38, 131072
  s_cbranch_scc1 .g2_kernel_gx44
.g2_kernel_gx44d:
  s_mov_b64 exec, -1
  s_lshr_b32 s28, s77, 7
  s_and_b32 s79, s77, 127
  s_add_u32 s79, s79, 1
  s_cmp_eq_u32 s28, s17
  s_cselect_b32 s79, s79, 0
  v_rsq_f32 v22, v17
  v_rsq_f32 v23, v19
  v_rsq_f32 v21, v21
  v_mov_b32 v62, -1.4426950408889634
  v_mul_f32 v62, s27, v62
  v_exp_f32 v62, v62
  v_lshlrev_b32 v14, 3, v2
  v_add_u32 v14, 155648, v14
  v_mov_b32 v15, s79
  v_add_f32 v52, 1.0, v22
  v_mul_f32 v54, v16, v22
  v_sub_f32 v54, 0, v54
  v_add_f32 v53, 1.0, v23
  v_mul_f32 v55, v18, v23
  v_sub_f32 v55, 0, v55
  v_add_f32 v62, 1.0, v62
  v_rcp_f32 v62, v62
  v_add_f32 v60, 1.0, v21
  v_mul_f32 v61, v20, v21
  v_sub_f32 v61, 0, v61
  v_sub_f32 v17, v17, v30
  v_mul_f32 v48, v52, v52
  v_fma_f32 v48, v48, v17, v30
  v_rsq_f32 v48, v48
  s_nop 0
  v_mul_f32 v48, v48, v52
  v_mul_f32 v50, v48, v16
  v_sub_f32 v50, 0, v50
  v_sub_f32 v19, v19, v30
  v_mul_f32 v49, v53, v53
  v_fma_f32 v49, v49, v19, v30
  v_rsq_f32 v49, v49
  s_nop 0
  v_mul_f32 v49, v49, v53
  v_mul_f32 v51, v49, v18
  v_sub_f32 v51, 0, v51
  v_lshlrev_b32 v56, 16, v56
  v_fma_f32 v56, v56, v60, v61
  v_lshlrev_b32 v57, 16, v57
  v_fma_f32 v57, v57, v60, v61
  v_lshlrev_b32 v58, 16, v58
  v_fma_f32 v58, v58, v60, v61
  v_lshlrev_b32 v59, 16, v59
  v_fma_f32 v59, v59, v60, v61
  v_and_b32 v10, 7, v2
  v_lshlrev_b32 v10, 12, v10
  v_lshl_add_u32 v10, v12, 4, v10
  s_lshl_b32 s20, s17, 1
  s_and_b32 s28, s18, 1
  s_add_u32 s20, s20, s28
  s_lshl_b32 s20, s20, 7
  s_add_u32 s20, s20, s63
  s_add_u32 s20, s20, 0x1090000
  s_and_b32 s26, s18, 14
  s_lshl_b32 s26, s26, 4
  s_add_u32 s26, s26, s17
  s_lshl_b32 s26, s26, 1
  s_and_b32 s28, s18, 1
  s_add_u32 s26, s26, s28
  s_lshl_b32 s26, s26, 10
  s_add_u32 s26, s26, s63
  s_add_u32 s26, s26, 0x1190000
  s_add_u32 s25, s26, 32768
  ds_write_b64 v14, v[48:49] offset:2816
  ds_write_b64 v14, v[50:51] offset:3328
  ds_write_b64 v14, v[52:53] offset:3840
  ds_write_b64 v14, v[54:55] offset:4352
  s_lshr_b32 s28, s77, 7
  s_xor_b32 s28, s28, s17
  v_mov_b32 v8, s28
  ds_write_b32 v9, v8 offset:212
  v_mov_b32 v8, 2
  ds_write_b32 v9, v15 offset:152
  ds_write_b32 v9, v8 offset:128
  s_lshl_b32 s28, s2, 10
  s_and_b32 s28, s28, 0xe000
  v_lshlrev_b32 v7, 7, v2
  buffer_load_dword v1, v7, s[64:67], s28 offen
  v_mov_b32 v6, s71
  s_mov_b32 s38, 0
.g2_kernel_wg45:
  ds_read_b32 v7, v6 offset:48
  s_add_u32 s38, s38, 1
  s_waitcnt lgkmcnt(0)
  v_cmp_le_u32 vcc, 2, v7
  s_cbranch_vccnz .g2_kernel_wg45d
  s_sleep 1
  s_cmp_lt_u32 s38, 524288
  s_cbranch_scc1 .g2_kernel_wg45
.g2_kernel_wg45d:
  s_sleep 8
  s_cmp_lg_u32 s62, 0
  s_cbranch_scc1 .g2_kernel_nap46
  s_sleep 22
.g2_kernel_nap46:
  s_mov_b32 s38, 0
.g2_kernel_gx47:
  s_mov_b32 s21, s20
  buffer_load_dwordx4 v[160:163], v10, s[4:7], s21 offen sc1
  s_add_u32 s21, s21, 32768
  buffer_load_dwordx4 v[164:167], v10, s[4:7], s21 offen sc1
  s_add_u32 s21, s21, 32768
  buffer_load_dwordx4 v[168:171], v10, s[4:7], s21 offen sc1
  s_add_u32 s21, s21, 32768
  buffer_load_dwordx4 v[172:175], v10, s[4:7], s21 offen sc1
  s_add_u32 s21, s21, 32768
  buffer_load_dwordx4 v[176:179], v10, s[4:7], s21 offen sc1
  s_add_u32 s21, s21, 32768
  buffer_load_dwordx4 v[180:183], v10, s[4:7], s21 offen sc1
  s_add_u32 s21, s21, 32768
  buffer_load_dwordx4 v[184:187], v10, s[4:7], s21 offen sc1
  s_add_u32 s21, s21, 32768
  buffer_load_dwordx4 v[188:191], v10, s[4:7], s21 offen sc1
  s_add_u32 s21, s21, 32768
  buffer_load_dwordx4 v[192:195], v10, s[4:7], s21 offen sc1
  s_add_u32 s21, s21, 32768
  buffer_load_dwordx4 v[196:199], v10, s[4:7], s21 offen sc1
  s_add_u32 s21, s21, 32768
  buffer_load_dwordx4 v[200:203], v10, s[4:7], s21 offen sc1
  s_add_u32 s21, s21, 32768
  buffer_load_dwordx4 v[204:207], v10, s[4:7], s21 offen sc1
  s_add_u32 s21, s21, 32768
  buffer_load_dwordx4 v[208:211], v10, s[4:7], s21 offen sc1
  s_add_u32 s21, s21, 32768
  buffer_load_dwordx4 v[212:215], v10, s[4:7], s21 offen sc1
  s_add_u32 s21, s21, 32768
  buffer_load_dwordx4 v[216:219], v10, s[4:7], s21 offen sc1
  s_add_u32 s21, s21, 32768
  buffer_load_dwordx4 v[220:223], v10, s[4:7], s21 offen sc1
  s_add_u32 s21, s21, 32768
  buffer_load_dwordx4 v[224:227], v10, s[4:7], s21 offen sc1
  s_add_u32 s21, s21, 32768
  buffer_load_dwordx4 v[228:231], v10, s[4:7], s21 offen sc1
  s_add_u32 s21, s21, 32768
  buffer_load_dwordx4 v[232:235], v10, s[4:7], s21 offen sc1
  s_add_u32 s21, s21, 32768
  buffer_load_dwordx4 v[236:239], v10, s[4:7], s21 offen sc1
  s_add_u32 s21, s21, 32768
  buffer_load_dwordx4 v[240:243], v10, s[4:7], s21 offen sc1
  s_add_u32 s21, s21, 32768
  buffer_load_dwordx4 v[244:247], v10, s[4:7], s21 offen sc1
  s_add_u32 s21, s21, 32768
  buffer_load_dwordx4 v[248:251], v10, s[4:7], s21 offen sc1
  s_add_u32 s21, s21, 32768
  buffer_load_dwordx4 v[252:255], v10, s[4:7], s21 offen sc1
  s_add_u32 s21, s21, 32768
  buffer_load_dwordx4 v[16:19], v10, s[4:7], s21 offen sc1
  s_add_u32 s21, s21, 32768
  buffer_load_dwordx4 v[20:23], v10, s[4:7], s21 offen sc1
  s_add_u32 s21, s21, 32768
  buffer_load_dwordx4 v[24:27], v10, s[4:7], s21 offen sc1
  s_add_u32 s21, s21, 32768
  buffer_load_dwordx4 v[28:31], v10, s[4:7], s21 offen sc1
  s_add_u32 s21, s21, 32768
  s_add_u32 s38, s38, 1
  s_waitcnt vmcnt(0)
  v_min3_u32 v6, v160, v162, v164
  v_min3_u32 v6, v6, v166, v168
  v_min3_u32 v6, v6, v170, v172
  v_min3_u32 v6, v6, v174, v176
  v_min3_u32 v6, v6, v178, v180
  v_min3_u32 v6, v6, v182, v184
  v_min3_u32 v6, v6, v186, v188
  v_min3_u32 v6, v6, v190, v192
  v_min3_u32 v6, v6, v194, v196
  v_min3_u32 v6, v6, v198, v200
  v_min3_u32 v6, v6, v202, v204
  v_min3_u32 v6, v6, v206, v208
  v_min3_u32 v6, v6, v210, v212
  v_min3_u32 v6, v6, v214, v216
  v_min3_u32 v6, v6, v218, v220
  v_min3_u32 v6, v6, v222, v224
  v_min3_u32 v6, v6, v226, v228
  v_min3_u32 v6, v6, v230, v232
  v_min3_u32 v6, v6, v234, v236
  v_min3_u32 v6, v6, v238, v240
  v_min3_u32 v6, v6, v242, v244
  v_min3_u32 v6, v6, v246, v248
  v_min3_u32 v6, v6, v250, v252
  v_min3_u32 v6, v6, v254, v16
  v_min3_u32 v6, v6, v18, v20
  v_min3_u32 v6, v6, v22, v24
  v_min3_u32 v6, v6, v26, v28
  v_min_u32 v6, v6, v30
  v_cmp_eq_u32 vcc, 0, v6
  s_cbranch_vccz .g2_kernel_gx47d
  s_mov_b64 exec, vcc
  s_sleep 1
  s_cmp_lg_u32 s62, 0
  s_cbranch_scc1 .g2_kernel_nap48
  s_sleep 11
.g2_kernel_nap48:
  s_cmp_lt_u32 s38, 131072
  s_cbranch_scc1 .g2_kernel_gx47
.g2_kernel_gx47d:
  s_mov_b64 exec, -1
  v_add_f32 v164, v164, v160
  v_add_f32 v165, v165, v161
  v_add_f32 v166, v166, v162
  v_add_f32 v167, v167, v163
  v_add_f32 v172, v172, v168
  v_add_f32 v173, v173, v169
  v_add_f32 v174, v174, v170
  v_add_f32 v175, v175, v171
  v_add_f32 v180, v180, v176
  v_add_f32 v181, v181, v177
  v_add_f32 v182, v182, v178
  v_add_f32 v183, v183, v179
  v_add_f32 v188, v188, v184
  v_add_f32 v189, v189, v185
  v_add_f32 v190, v190, v186
  v_add_f32 v191, v191, v187
  v_add_f32 v196, v196, v192
  v_add_f32 v197, v197, v193
  v_add_f32 v198, v198, v194
  v_add_f32 v199, v199, v195
  v_add_f32 v204, v204, v200
  v_add_f32 v205, v205, v201
  v_add_f32 v206, v206, v202
  v_add_f32 v207, v207, v203
  v_add_f32 v212, v212, v208
  v_add_f32 v213, v213, v209
  v_add_f32 v214, v214, v210
  v_add_f32 v215, v215, v211
  v_add_f32 v220, v220, v216
  v_add_f32 v221, v221, v217
  v_add_f32 v222, v222, v218
  v_add_f32 v223, v223, v219
  v_add_f32 v228, v228, v224
  v_add_f32 v229, v229, v225
  v_add_f32 v230, v230, v226
  v_add_f32 v231, v231, v227
  v_add_f32 v236, v236, v232
  v_add_f32 v237, v237, v233
  v_add_f32 v238, v238, v234
  v_add_f32 v239, v239, v235
  v_add_f32 v244, v244, v240
  v_add_f32 v245, v245, v241
  v_add_f32 v246, v246, v242
  v_add_f32 v247, v247, v243
  v_add_f32 v252, v252, v248
  v_add_f32 v253, v253, v249
  v_add_f32 v254, v254, v250
  v_add_f32 v255, v255, v251
  v_add_f32 v20, v20, v16
  v_add_f32 v21, v21, v17
  v_add_f32 v22, v22, v18
  v_add_f32 v23, v23, v19
  v_add_f32 v28, v28, v24
  v_add_f32 v29, v29, v25
  v_add_f32 v30, v30, v26
  v_add_f32 v31, v31, v27
  v_add_f32 v172, v172, v164
  v_add_f32 v173, v173, v165
  v_add_f32 v174, v174, v166
  v_add_f32 v175, v175, v167
  v_add_f32 v188, v188, v180
  v_add_f32 v189, v189, v181
  v_add_f32 v190, v190, v182
  v_add_f32 v191, v191, v183
  v_add_f32 v204, v204, v196
  v_add_f32 v205, v205, v197
  v_add_f32 v206, v206, v198
  v_add_f32 v207, v207, v199
  v_add_f32 v220, v220, v212
  v_add_f32 v221, v221, v213
  v_add_f32 v222, v222, v214
  v_add_f32 v223, v223, v215
  v_add_f32 v236, v236, v228
  v_add_f32 v237, v237, v229
  v_add_f32 v238, v238, v230
  v_add_f32 v239, v239, v231
  v_add_f32 v252, v252, v244
  v_add_f32 v253, v253, v245
  v_add_f32 v254, v254, v246
  v_add_f32 v255, v255, v247
  v_add_f32 v28, v28, v20
  v_add_f32 v29, v29, v21
  v_add_f32 v30, v30, v22
  v_add_f32 v31, v31, v23
  v_add_f32 v188, v188, v172
  v_add_f32 v189, v189, v173
  v_add_f32 v190, v190, v174
  v_add_f32 v191, v191, v175
  v_add_f32 v220, v220, v204
  v_add_f32 v221, v221, v205
  v_add_f32 v222, v222, v206
  v_add_f32 v223, v223, v207
  v_add_f32 v252, v252, v236
  v_add_f32 v253, v253, v237
  v_add_f32 v254, v254, v238
  v_add_f32 v255, v255, v239
  v_add_f32 v220, v220, v188
  v_add_f32 v221, v221, v189
  v_add_f32 v222, v222, v190
  v_add_f32 v223, v223, v191
  v_add_f32 v28, v28, v252
  v_add_f32 v29, v29, v253
  v_add_f32 v30, v30, v254
  v_add_f32 v31, v31, v255
  v_add_f32 v28, v28, v220
  v_add_f32 v29, v29, v221
  v_add_f32 v30, v30, v222
  v_add_f32 v31, v31, v223
  v_add_f32 v28, v28, v28 quad_perm:[1,0,3,2] row_mask:0xf bank_mask:0xf
  v_add_f32 v29, v29, v29 quad_perm:[1,0,3,2] row_mask:0xf bank_mask:0xf
  v_add_f32 v30, v30, v30 quad_perm:[1,0,3,2] row_mask:0xf bank_mask:0xf
  v_add_f32 v31, v31, v31 quad_perm:[1,0,3,2] row_mask:0xf bank_mask:0xf
  v_add_f32 v28, v28, v28 quad_perm:[2,3,0,1] row_mask:0xf bank_mask:0xf
  v_add_f32 v29, v29, v29 quad_perm:[2,3,0,1] row_mask:0xf bank_mask:0xf
  v_add_f32 v30, v30, v30 quad_perm:[2,3,0,1] row_mask:0xf bank_mask:0xf
  v_add_f32 v31, v31, v31 quad_perm:[2,3,0,1] row_mask:0xf bank_mask:0xf
  v_add_f32 v28, v28, v28 row_half_mirror row_mask:0xf bank_mask:0xf
  v_add_f32 v29, v29, v29 row_half_mirror row_mask:0xf bank_mask:0xf
  v_add_f32 v30, v30, v30 row_half_mirror row_mask:0xf bank_mask:0xf
  v_add_f32 v31, v31, v31 row_half_mirror row_mask:0xf bank_mask:0xf
  v_mul_f32 v28, v28, v62
  v_mul_f32 v29, v29, v62
  v_mul_f32 v30, v30, v62
  v_mul_f32 v31, v31, v62
  v_cvt_pk_bf16_f32 v16, v28, v29
  v_cvt_pk_bf16_f32 v17, v30, v31
  s_mov_b32 s28, 0x00010001
  s_mov_b32 s29, 0x00010001
  v_mov_b32 v18, v16 row_ror:8 row_mask:0xf bank_mask:0xf
  v_mov_b32 v19, v17 row_ror:8 row_mask:0xf bank_mask:0xf
  v_lshlrev_b32 v28, 16, v16
  v_and_b32 v29, 0xffff0000, v16
  v_lshlrev_b32 v30, 16, v17
  v_and_b32 v31, 0xffff0000, v17
  v_cndmask_b32 v32, 0, v16, s[28:29]
  v_cndmask_b32 v33, 0, v17, s[28:29]
  v_cndmask_b32 v34, 0, v18, s[28:29]
  v_cndmask_b32 v35, 0, v19, s[28:29]
  s_lshl_b64 s[28:29], s[28:29], 1
  s_nop 0
  v_mfma_f32_16x16x32_bf16 v[160:163], v[32:35], v[64:67], 0
  v_mfma_f32_16x16x32_bf16 v[164:167], v[32:35], v[80:83], 0
  v_mfma_f32_16x16x32_bf16 v[168:171], v[32:35], v[96:99], 0
  v_mfma_f32_16x16x32_bf16 v[172:175], v[32:35], v[112:115], 0
  v_mfma_f32_16x16x32_bf16 v[176:179], v[32:35], v[128:131], 0
  v_mfma_f32_16x16x32_bf16 v[180:183], v[32:35], v[144:147], 0
  v_cndmask_b32 v36, 0, v16, s[28:29]
  v_cndmask_b32 v37, 0, v17, s[28:29]
  v_cndmask_b32 v38, 0, v18, s[28:29]
  v_cndmask_b32 v39, 0, v19, s[28:29]
  s_lshl_b64 s[28:29], s[28:29], 1
  s_nop 0
  v_mfma_f32_16x16x32_bf16 v[160:163], v[36:39], v[68:71], v[160:163]
  v_mfma_f32_16x16x32_bf16 v[164:167], v[36:39], v[84:87], v[164:167]
  v_mfma_f32_16x16x32_bf16 v[168:171], v[36:39], v[100:103], v[168:171]
  v_mfma_f32_16x16x32_bf16 v[172:175], v[36:39], v[116:119], v[172:175]
  v_mfma_f32_16x16x32_bf16 v[176:179], v[36:39], v[132:135], v[176:179]
  v_mfma_f32_16x16x32_bf16 v[180:183], v[36:39], v[148:151], v[180:183]
  v_cndmask_b32 v40, 0, v16, s[28:29]
  v_cndmask_b32 v41, 0, v17, s[28:29]
  v_cndmask_b32 v42, 0, v18, s[28:29]
  v_cndmask_b32 v43, 0, v19, s[28:29]
  s_lshl_b64 s[28:29], s[28:29], 1
  s_nop 0
  v_mfma_f32_16x16x32_bf16 v[160:163], v[40:43], v[72:75], v[160:163]
  v_mfma_f32_16x16x32_bf16 v[164:167], v[40:43], v[88:91], v[164:167]
  v_mfma_f32_16x16x32_bf16 v[168:171], v[40:43], v[104:107], v[168:171]
  v_mfma_f32_16x16x32_bf16 v[172:175], v[40:43], v[120:123], v[172:175]
  v_mfma_f32_16x16x32_bf16 v[176:179], v[40:43], v[136:139], v[176:179]
  v_mfma_f32_16x16x32_bf16 v[180:183], v[40:43], v[152:155], v[180:183]
  v_cndmask_b32 v44, 0, v16, s[28:29]
  v_cndmask_b32 v45, 0, v17, s[28:29]
  v_cndmask_b32 v46, 0, v18, s[28:29]
  v_cndmask_b32 v47, 0, v19, s[28:29]
  s_lshl_b64 s[28:29], s[28:29], 1
  s_nop 0
  v_mfma_f32_16x16x32_bf16 v[160:163], v[44:47], v[76:79], v[160:163]
  v_mfma_f32_16x16x32_bf16 v[164:167], v[44:47], v[92:95], v[164:167]
  v_mfma_f32_16x16x32_bf16 v[168:171], v[44:47], v[108:111], v[168:171]
  v_mfma_f32_16x16x32_bf16 v[172:175], v[44:47], v[124:127], v[172:175]
  v_mfma_f32_16x16x32_bf16 v[176:179], v[44:47], v[140:143], v[176:179]
  v_mfma_f32_16x16x32_bf16 v[180:183], v[44:47], v[156:159], v[180:183]
  v_add_f32 v56, v56, v28
  v_add_f32 v57, v57, v29
  v_add_f32 v58, v58, v30
  v_add_f32 v59, v59, v31
  v_add_f32 v20, v56, v57
  v_mul_f32 v22, v56, v56
  v_add_f32 v21, v58, v59
  v_fmac_f32 v22, v57, v57
  v_add_f32 v20, v20, v21
  v_fmac_f32 v22, v58, v58
  v_fmac_f32 v22, v59, v59
  v_or_b32 v28, 1, v28
  v_or_b32 v30, 1, v30
  v_add_f32 v20, v20, v20 row_ror:8 row_mask:0xf bank_mask:0xf
  v_add_f32 v22, v22, v22 row_ror:8 row_mask:0xf bank_mask:0xf
  v_lshlrev_b32 v11, 4, v12
  v_add_f32 v20, v20, v20 row_bcast:15 row_mask:0xa bank_mask:0xf
  v_add_f32 v22, v22, v22 row_bcast:15 row_mask:0xa bank_mask:0xf
  s_mov_b32 exec_lo, 0x01010101
  s_mov_b32 exec_hi, 0x01010101
  buffer_store_dwordx4 v[28:31], v11, s[4:7], s26 offen offset:768 sc1
  buffer_store_dwordx4 v[28:31], v11, s[4:7], s25 offen offset:768 sc1
  s_mov_b64 exec, -1
  v_add_f32 v20, v20, v20 row_bcast:31 row_mask:0xc bank_mask:0xf
  v_add_f32 v22, v22, v22 row_bcast:31 row_mask:0xc bank_mask:0xf
  v_or_b32 v20, 1, v20
  v_or_b32 v22, 1, v22
  s_mov_b32 exec_lo, 0
  s_mov_b32 exec_hi, 0x80000000
  buffer_store_dwordx4 v[20:23], v4, s[4:7], s26 offen offset:896 sc1
  buffer_store_dwordx4 v[20:23], v4, s[4:7], s25 offen offset:896 sc1
  s_mov_b64 exec, 0xffff
  v_or_b32 v160, 1, v160
  v_or_b32 v162, 1, v162
  buffer_store_dwordx4 v[160:163], v3, s[4:7], s26 offen offset:0 sc1
  v_or_b32 v164, 1, v164
  v_or_b32 v166, 1, v166
  buffer_store_dwordx4 v[164:167], v3, s[4:7], s25 offen offset:0 sc1
  v_or_b32 v168, 1, v168
  v_or_b32 v170, 1, v170
  buffer_store_dwordx4 v[168:171], v3, s[4:7], s26 offen offset:256 sc1
  v_or_b32 v172, 1, v172
  v_or_b32 v174, 1, v174
  buffer_store_dwordx4 v[172:175], v3, s[4:7], s25 offen offset:256 sc1
  v_or_b32 v176, 1, v176
  v_or_b32 v178, 1, v178
  buffer_store_dwordx4 v[176:179], v3, s[4:7], s26 offen offset:512 sc1
  v_or_b32 v180, 1, v180
  v_or_b32 v182, 1, v182
  buffer_store_dwordx4 v[180:183], v3, s[4:7], s25 offen offset:512 sc1
  s_mov_b64 exec, -1
  s_cmp_eq_u32 s79, 0
  s_cbranch_scc1 .g2_kernel_c_no
  s_lshl_b32 s20, s18, 15
  s_add_u32 s20, s20, 0x1190000
  s_lshl_b32 s22, s18, 11
  s_add_u32 s22, s22, s20
  v_lshlrev_b32 v16, 10, v2
  s_sleep 16
  s_mov_b32 s38, 0
  s_mov_b32 exec_hi, 0
.g2_kernel_gx49:
  buffer_load_dword v17, v16, s[4:7], s20 offen offset:752 sc1
  s_add_u32 s38, s38, 1
  s_waitcnt vmcnt(0)
  v_min_u32 v6, v17, v17
  v_cmp_eq_u32 vcc, 0, v6
  s_cbranch_vccz .g2_kernel_gx49d
  s_mov_b64 exec, vcc
  s_sleep 6
  s_cmp_lt_u32 s38, 131072
  s_cbranch_scc1 .g2_kernel_gx49
.g2_kernel_gx49d:
  s_mov_b64 exec, -1
  s_mov_b32 s38, 0
  s_bfm_b64 exec, 57, 0
.g2_kernel_gx50:
  s_mov_b32 s21, s20
  buffer_load_dwordx4 v[64:67], v3, s[4:7], s21 offen offset:0 sc1
  buffer_load_dwordx4 v[68:71], v3, s[4:7], s21 offen offset:1024 sc1
  buffer_load_dwordx4 v[72:75], v3, s[4:7], s21 offen offset:2048 sc1
  buffer_load_dwordx4 v[76:79], v3, s[4:7], s21 offen offset:3072 sc1
  s_add_u32 s21, s21, 4096
  buffer_load_dwordx4 v[80:83], v3, s[4:7], s21 offen offset:0 sc1
  buffer_load_dwordx4 v[84:87], v3, s[4:7], s21 offen offset:1024 sc1
  buffer_load_dwordx4 v[88:91], v3, s[4:7], s21 offen offset:2048 sc1
  buffer_load_dwordx4 v[92:95], v3, s[4:7], s21 offen offset:3072 sc1
  s_add_u32 s21, s21, 4096
  buffer_load_dwordx4 v[96:99], v3, s[4:7], s21 offen offset:0 sc1
  buffer_load_dwordx4 v[100:103], v3, s[4:7], s21 offen offset:1024 sc1
  buffer_load_dwordx4 v[104:107], v3, s[4:7], s21 offen offset:2048 sc1
  buffer_load_dwordx4 v[108:111], v3, s[4:7], s21 offen offset:3072 sc1
  s_add_u32 s21, s21, 4096
  buffer_load_dwordx4 v[112:115], v3, s[4:7], s21 offen offset:0 sc1
  buffer_load_dwordx4 v[116:119], v3, s[4:7], s21 offen offset:1024 sc1
  buffer_load_dwordx4 v[120:123], v3, s[4:7], s21 offen offset:2048 sc1
  buffer_load_dwordx4 v[124:127], v3, s[4:7], s21 offen offset:3072 sc1
  s_add_u32 s21, s21, 4096
  buffer_load_dwordx4 v[128:131], v3, s[4:7], s21 offen offset:0 sc1
  buffer_load_dwordx4 v[132:135], v3, s[4:7], s21 offen offset:1024 sc1
  buffer_load_dwordx4 v[136:139], v3, s[4:7], s21 offen offset:2048 sc1
  buffer_load_dwordx4 v[140:143], v3, s[4:7], s21 offen offset:3072 sc1
  s_add_u32 s21, s21, 4096
  buffer_load_dwordx4 v[144:147], v3, s[4:7], s21 offen offset:0 sc1
  buffer_load_dwordx4 v[148:151], v3, s[4:7], s21 offen offset:1024 sc1
  buffer_load_dwordx4 v[152:155], v3, s[4:7], s21 offen offset:2048 sc1
  buffer_load_dwordx4 v[156:159], v3, s[4:7], s21 offen offset:3072 sc1
  s_add_u32 s21, s21, 4096
  buffer_load_dwordx4 v[160:163], v3, s[4:7], s21 offen offset:0 sc1
  buffer_load_dwordx4 v[164:167], v3, s[4:7], s21 offen offset:1024 sc1
  buffer_load_dwordx4 v[168:171], v3, s[4:7], s21 offen offset:2048 sc1
  buffer_load_dwordx4 v[172:175], v3, s[4:7], s21 offen offset:3072 sc1
  s_add_u32 s21, s21, 4096
  buffer_load_dwordx4 v[176:179], v3, s[4:7], s21 offen offset:0 sc1
  buffer_load_dwordx4 v[180:183], v3, s[4:7], s21 offen offset:1024 sc1
  buffer_load_dwordx4 v[184:187], v3, s[4:7], s21 offen offset:2048 sc1
  buffer_load_dwordx4 v[188:191], v3, s[4:7], s21 offen offset:3072 sc1
  s_add_u32 s21, s21, 4096
  buffer_load_dwordx4 v[192:195], v3, s[4:7], s22 offen offset:0 sc1
  buffer_load_dwordx4 v[196:199], v3, s[4:7], s22 offen offset:1024 sc1
  s_add_u32 s38, s38, 1
  s_waitcnt vmcnt(0)
  v_min3_u32 v6, v64, v66, v68
  v_min3_u32 v6, v6, v70, v72
  v_min3_u32 v6, v6, v74, v76
  v_min3_u32 v6, v6, v78, v80
  v_min3_u32 v6, v6, v82, v84
  v_min3_u32 v6, v6, v86, v88
  v_min3_u32 v6, v6, v90, v92
  v_min3_u32 v6, v6, v94, v96
  v_min3_u32 v6, v6, v98, v100
  v_min3_u32 v6, v6, v102, v104
  v_min3_u32 v6, v6, v106, v108
  v_min3_u32 v6, v6, v110, v112
  v_min3_u32 v6, v6, v114, v116
  v_min3_u32 v6, v6, v118, v120
  v_min3_u32 v6, v6, v122, v124
  v_min3_u32 v6, v6, v126, v128
  v_min3_u32 v6, v6, v130, v132
  v_min3_u32 v6, v6, v134, v136
  v_min3_u32 v6, v6, v138, v140
  v_min3_u32 v6, v6, v142, v144
  v_min3_u32 v6, v6, v146, v148
  v_min3_u32 v6, v6, v150, v152
  v_min3_u32 v6, v6, v154, v156
  v_min3_u32 v6, v6, v158, v160
  v_min3_u32 v6, v6, v162, v164
  v_min3_u32 v6, v6, v166, v168
  v_min3_u32 v6, v6, v170, v172
  v_min3_u32 v6, v6, v174, v176
  v_min3_u32 v6, v6, v178, v180
  v_min3_u32 v6, v6, v182, v184
  v_min3_u32 v6, v6, v186, v188
  v_min3_u32 v6, v6, v190, v192
  v_min3_u32 v6, v6, v194, v196
  v_min_u32 v6, v6, v198
  v_cmp_eq_u32 vcc, 0, v6
  s_cbranch_vccz .g2_kernel_gx50d
  s_mov_b64 exec, vcc
  s_sleep 2
  s_cmp_lt_u32 s38, 131072
  s_cbranch_scc1 .g2_kernel_gx50
.g2_kernel_gx50d:
  s_mov_b64 exec, -1
  v_add_f32 v64, v64, v128
  v_add_f32 v65, v65, v129
  v_add_f32 v66, v66, v130
  v_add_f32 v67, v67, v131
  v_add_f32 v68, v68, v132
  v_add_f32 v69, v69, v133
  v_add_f32 v70, v70, v134
  v_add_f32 v71, v71, v135
  v_add_f32 v72, v72, v136
  v_add_f32 v73, v73, v137
  v_add_f32 v74, v74, v138
  v_add_f32 v75, v75, v139
  v_add_f32 v76, v76, v140
  v_add_f32 v77, v77, v141
  v_add_f32 v78, v78, v142
  v_add_f32 v79, v79, v143
  v_add_f32 v80, v80, v144
  v_add_f32 v81, v81, v145
  v_add_f32 v82, v82, v146
  v_add_f32 v83, v83, v147
  v_add_f32 v84, v84, v148
  v_add_f32 v85, v85, v149
  v_add_f32 v86, v86, v150
  v_add_f32 v87, v87, v151
  v_add_f32 v88, v88, v152
  v_add_f32 v89, v89, v153
  v_add_f32 v90, v90, v154
  v_add_f32 v91, v91, v155
  v_add_f32 v92, v92, v156
  v_add_f32 v93, v93, v157
  v_add_f32 v94, v94, v158
  v_add_f32 v95, v95, v159
  v_add_f32 v96, v96, v160
  v_add_f32 v97, v97, v161
  v_add_f32 v98, v98, v162
  v_add_f32 v99, v99, v163
  v_add_f32 v100, v100, v164
  v_add_f32 v101, v101, v165
  v_add_f32 v102, v102, v166
  v_add_f32 v103, v103, v167
  v_add_f32 v104, v104, v168
  v_add_f32 v105, v105, v169
  v_add_f32 v106, v106, v170
  v_add_f32 v107, v107, v171
  v_add_f32 v108, v108, v172
  v_add_f32 v109, v109, v173
  v_add_f32 v110, v110, v174
  v_add_f32 v111, v111, v175
  v_add_f32 v112, v112, v176
  v_add_f32 v113, v113, v177
  v_add_f32 v114, v114, v178
  v_add_f32 v115, v115, v179
  v_add_f32 v116, v116, v180
  v_add_f32 v117, v117, v181
  v_add_f32 v118, v118, v182
  v_add_f32 v119, v119, v183
  v_add_f32 v120, v120, v184
  v_add_f32 v121, v121, v185
  v_add_f32 v122, v122, v186
  v_add_f32 v123, v123, v187
  v_add_f32 v124, v124, v188
  v_add_f32 v125, v125, v189
  v_add_f32 v126, v126, v190
  v_add_f32 v127, v127, v191
  v_add_f32 v64, v64, v96
  v_add_f32 v65, v65, v97
  v_add_f32 v66, v66, v98
  v_add_f32 v67, v67, v99
  v_add_f32 v68, v68, v100
  v_add_f32 v69, v69, v101
  v_add_f32 v70, v70, v102
  v_add_f32 v71, v71, v103
  v_add_f32 v72, v72, v104
  v_add_f32 v73, v73, v105
  v_add_f32 v74, v74, v106
  v_add_f32 v75, v75, v107
  v_add_f32 v76, v76, v108
  v_add_f32 v77, v77, v109
  v_add_f32 v78, v78, v110
  v_add_f32 v79, v79, v111
  v_add_f32 v80, v80, v112
  v_add_f32 v81, v81, v113
  v_add_f32 v82, v82, v114
  v_add_f32 v83, v83, v115
  v_add_f32 v84, v84, v116
  v_add_f32 v85, v85, v117
  v_add_f32 v86, v86, v118
  v_add_f32 v87, v87, v119
  v_add_f32 v88, v88, v120
  v_add_f32 v89, v89, v121
  v_add_f32 v90, v90, v122
  v_add_f32 v91, v91, v123
  v_add_f32 v92, v92, v124
  v_add_f32 v93, v93, v125
  v_add_f32 v94, v94, v126
  v_add_f32 v95, v95, v127
  v_add_f32 v64, v64, v80
  v_add_f32 v65, v65, v81
  v_add_f32 v66, v66, v82
  v_add_f32 v67, v67, v83
  v_add_f32 v68, v68, v84
  v_add_f32 v69, v69, v85
  v_add_f32 v70, v70, v86
  v_add_f32 v71, v71, v87
  v_add_f32 v72, v72, v88
  v_add_f32 v73, v73, v89
  v_add_f32 v74, v74, v90
  v_add_f32 v75, v75, v91
  v_add_f32 v76, v76, v92
  v_add_f32 v77, v77, v93
  v_add_f32 v78, v78, v94
  v_add_f32 v79, v79, v95
  v_add_f32 v64, v64, v72
  v_add_f32 v65, v65, v73
  v_add_f32 v66, v66, v74
  v_add_f32 v67, v67, v75
  v_add_f32 v68, v68, v76
  v_add_f32 v69, v69, v77
  v_add_f32 v70, v70, v78
  v_add_f32 v71, v71, v79
  v_add_f32 v64, v64, v68
  v_add_f32 v65, v65, v69
  v_add_f32 v66, v66, v70
  v_add_f32 v67, v67, v71
  v_mov_b32 v28, 0.0009765625
  v_mov_b32 v30, 1e-05
  v_readlane_b32 s21, v64, 56
  v_readlane_b32 s22, v66, 56
  s_nop 0
  v_mul_f32 v20, s21, v28
  v_fma_f32 v21, s22, v28, v30
  v_fma_f32 v21, -v20, v20, v21
  v_rsq_f32 v21, abs(v21)
  v_sub_f32 v20, v61, v20
  v_mul_f32 v22, v21, v60
  v_mul_f32 v23, v21, v20
  v_and_b32 v10, 15, v2
  v_lshrrev_b32 v11, 4, v2
  v_lshlrev_b32 v16, 2, v10
  v_lshl_add_u32 v16, v11, 8, v16
  v_add_u32 v16, 155648, v16
  s_sub_u32 s20, s79, 1
  s_and_b32 s21, s20, 3
  s_lshl_b32 s21, s21, 2
  s_add_u32 s21, s21, 156160
  v_lshl_add_u32 v17, v10, 4, s21
  v_cmp_eq_u32 vcc, 2, v11
  v_mov_b32 v18, 64
  v_mov_b32 v19, 256
  v_cndmask_b32 v17, v16, v17, vcc
  v_cndmask_b32 v18, v18, v19, vcc
  v_lshrrev_b32 v24, 2, v10
  v_lshlrev_b32 v24, 9, v24
  v_and_b32 v25, 3, v10
  v_lshl_add_u32 v24, v25, 1, v24
  s_and_b32 s21, s20, 31
  s_lshl_b32 s22, s21, 4
  s_lshr_b32 s23, s20, 5
  s_lshl_b32 s24, s23, 11
  s_add_u32 s22, s22, s24
  s_add_u32 s22, s22, 131072
  v_add_u32 v26, s22, v24
  s_and_b32 s22, s21, 7
  s_and_b32 s24, s21, 8
  s_lshl_b32 s24, s24, 1
  s_add_u32 s22, s22, s24
  s_and_b32 s24, s21, 16
  s_lshr_b32 s24, s24, 1
  s_add_u32 s22, s22, s24
  s_lshl_b32 s22, s22, 4
  v_add_u32 v24, s22, v24
  s_bfe_u32 s22, s21, 0x20002
  s_lshl_b32 s22, s22, 9
  s_add_u32 s22, s22, s24
  s_and_b32 s24, s21, 3
  s_lshl_b32 s24, s24, 1
  s_add_u32 s22, s22, s24
  s_add_u32 s22, s22, 2048
  v_lshl_add_u32 v25, v10, 4, s22
  v_cndmask_b32 v24, v24, v25, vcc
  v_cndmask_b32 v19, 8, v19, vcc
  v_add_u32 v25, v24, v19
  s_lshl_b32 s22, s18, 7
  s_lshl_b32 s24, s17, 2
  s_add_u32 s22, s22, s24
  s_add_u32 s22, s22, s23
  s_lshl_b32 s22, s22, 12
  s_add_u32 s22, s22, 0x1800000
  s_add_u32 s23, s22, 262144
  s_lshr_b32 s24, s20, 6
  s_lshl_b32 s24, s24, 8
  s_add_u32 s24, s24, s76
  v_cmp_eq_u32 vcc, 0, v11
  v_mov_b32 v27, 0.25503486164919736
  s_nop 0
  v_cndmask_b32 v27, 1.0, v27, vcc
  v_mul_f32 v21, v21, v27
  v_mul_f32 v22, v22, v27
  v_mul_f32 v23, v23, v27
  s_mov_b32 s62, 1
  s_mov_b32 s63, 0x1800000
  s_mov_b32 s70, 2
  s_mov_b32 s71, 155776
  v_mov_b32 v6, s71
  s_mov_b32 s38, 0
.g2_kernel_wg51:
  ds_read_b32 v7, v6 offset:56
  s_add_u32 s38, s38, 1
  s_waitcnt lgkmcnt(0)
  v_cmp_le_u32 vcc, 2, v7
  s_cbranch_vccnz .g2_kernel_wg51d
  s_sleep 1
  s_cmp_lt_u32 s38, 524288
  s_cbranch_scc1 .g2_kernel_wg51
.g2_kernel_wg51d:
  ds_read_b32 v32, v17 offset:5632
  ds_read_b32 v36, v16 offset:4864
  v_add_u32 v17, v17, v18
  ds_read_b32 v33, v17 offset:5632
  ds_read_b32 v37, v16 offset:4928
  v_add_u32 v17, v17, v18
  ds_read_b32 v34, v17 offset:5632
  ds_read_b32 v38, v16 offset:4992
  v_add_u32 v17, v17, v18
  ds_read_b32 v35, v17 offset:5632
  ds_read_b32 v39, v16 offset:5056
  s_waitcnt lgkmcnt(0)
  v_mul_f32 v32, v32, v22
  v_fmac_f32 v32, v64, v21
  v_fmac_f32 v32, v36, v23
  v_mul_f32 v33, v33, v22
  v_fmac_f32 v33, v65, v21
  v_fmac_f32 v33, v37, v23
  v_mul_f32 v34, v34, v22
  v_fmac_f32 v34, v66, v21
  v_fmac_f32 v34, v38, v23
  v_mul_f32 v35, v35, v22
  v_fmac_f32 v35, v67, v21
  v_fmac_f32 v35, v39, v23
  v_cvt_pk_bf16_f32 v32, v32, v33
  v_cvt_pk_bf16_f32 v34, v34, v35
  v_mov_b32 v9, s71
  v_mov_b32 v8, 2
  s_mov_b32 exec_lo, 0xffff0000
  s_mov_b32 exec_hi, 0xffff
  buffer_store_short v32, v24, s[4:7], s22 offen sc1
  buffer_store_short_d16_hi v32, v25, s[4:7], s22 offen sc1
  buffer_store_short v34, v24, s[4:7], s23 offen sc1
  buffer_store_short_d16_hi v34, v25, s[4:7], s23 offen sc1
  s_mov_b64 exec, 0xffff
  ds_write_b16 v26, v32 offset:8192
  ds_write_b16_d16_hi v26, v32 offset:8200
  ds_write_b16 v26, v34
  ds_write_b16_d16_hi v26, v34 offset:8
  ds_write_b32 v9, v5 offset:60
  s_mov_b32 exec_lo, 0
  s_mov_b32 exec_hi, 0xff0000
  ds_write_b32 v16, v192 offset:6912
  ds_write_b32 v16, v193 offset:6976
  ds_write_b32 v16, v194 offset:7040
  ds_write_b32 v16, v195 offset:7104
  ds_write_b32 v16, v196 offset:6944
  ds_write_b32 v16, v197 offset:7008
  ds_write_b32 v16, v198 offset:7072
  ds_write_b32 v16, v199 offset:7136
  s_mov_b64 exec, 1
  s_waitcnt vmcnt(0)
  buffer_store_dword v8, v4, s[4:7], s24 offen sc1
  buffer_store_dword v8, v4, s[4:7], s24 offen offset:128 sc1
  s_mov_b64 exec, -1
  s_branch .g2_kernel_v
.g2_kernel_c_no:
  s_mov_b32 s62, 1
  s_mov_b32 s63, 0x1800000
  s_mov_b32 s70, 2
  s_mov_b32 s71, 155776
  s_branch .g2_kernel_v
.g2_kernel_c_t3:
  s_lshr_b32 s33, s77, 7
  s_lshl_b32 s28, s33, 4
  s_lshl_b64 s[34:35], 0xffff, s28
  s_lshr_b32 s28, s33, 2
  s_cmp_eq_u32 s28, 0
  s_cselect_b64 s[8:9], s[34:35], 0
  s_cmp_eq_u32 s28, 1
  s_cselect_b64 s[10:11], s[34:35], 0
  s_cmp_eq_u32 s28, 2
  s_cselect_b64 s[12:13], s[34:35], 0
  s_cmp_eq_u32 s28, 3
  s_cselect_b64 s[14:15], s[34:35], 0
  s_lshl_b32 s21, s17, 10
  s_add_u32 s21, s21, 0x2880000
  v_lshlrev_b32 v14, 3, v2
  v_add_u32 v14, 155648, v14
  v_mov_b32 v9, s71
  s_cmp_eq_u32 s33, s17
  s_cbranch_scc0 .g2_kernel_c_u1
  s_sleep 6
  s_call_b64 s[72:73], .g2_kernel_c_ph2
  s_branch .g2_kernel_c_u2
.g2_kernel_c_u1:
  v_mov_b32 v6, s71
  s_mov_b32 s38, 0
.g2_kernel_wg52:
  ds_read_b32 v7, v6 offset:36
  s_add_u32 s38, s38, 1
  s_waitcnt lgkmcnt(0)
  v_cmp_le_u32 vcc, 1, v7
  s_cbranch_vccnz .g2_kernel_wg52d
  s_sleep 1
  s_cmp_lt_u32 s38, 524288
  s_cbranch_scc1 .g2_kernel_wg52
.g2_kernel_wg52d:
  v_readfirstlane_b32 s77, v7
  s_sub_u32 s77, s77, 1
.g2_kernel_c_u2:
  s_mov_b32 s38, 0
.g2_kernel_gx53:
  buffer_load_dwordx4 v[16:19], v3, s[4:7], s21 offen sc1
  s_add_u32 s38, s38, 1
  s_waitcnt vmcnt(0)
  v_min_u32 v6, v17, v19
  v_cmp_eq_u32 vcc, 0, v6
  s_cbranch_vccz .g2_kernel_gx53d
  s_mov_b64 exec, vcc
  s_cmp_lt_u32 s38, 131072
  s_cbranch_scc1 .g2_kernel_gx53
.g2_kernel_gx53d:
  s_mov_b64 exec, -1
  s_lshr_b32 s28, s77, 7
  s_and_b32 s79, s77, 127
  s_add_u32 s79, s79, 1
  s_cmp_eq_u32 s28, s17
  s_cselect_b32 s79, s79, 0
  v_rsq_f32 v22, v17
  v_rsq_f32 v23, v19
  v_mov_b32 v15, s79
  v_add_f32 v52, 1.0, v22
  v_mul_f32 v54, v16, v22
  v_sub_f32 v54, 0, v54
  v_add_f32 v53, 1.0, v23
  v_mul_f32 v55, v18, v23
  v_sub_f32 v55, 0, v55
  ds_write_b64 v14, v[52:53] offset:3840
  ds_write_b64 v14, v[54:55] offset:4352
  ds_write_b32 v9, v15 offset:32
  ds_write_b32 v9, v5 offset:28
  s_cmp_eq_u32 s33, s17
  s_cbranch_scc1 .g2_kernel_fin
  s_sleep 40
  s_mov_b32 s39, 1
  s_call_b64 s[72:73], .g2_kernel_c_ph2
  s_branch .g2_kernel_fin
.g2_kernel_c_ph2:
  s_call_b64 s[68:69], .g2_kernel_amax
  v_mov_b32 v6, s71
  s_mov_b32 s38, 0
.g2_kernel_wg54:
  ds_read_b32 v7, v6 offset:36
  s_add_u32 s38, s38, 1
  s_waitcnt lgkmcnt(0)
  v_cmp_le_u32 vcc, 1, v7
  s_cbranch_vccnz .g2_kernel_wg54d
  s_cmp_lt_u32 s38, 524288
  s_cbranch_scc1 .g2_kernel_wg54
.g2_kernel_wg54d:
  ds_read_b32 v8, v9 offset:96
  v_readfirstlane_b32 s28, v7
  s_sub_u32 s28, s28, 1
  s_add_u32 s29, s77, 2
  s_waitcnt lgkmcnt(0)
  v_cmp_gt_f32 vcc, s27, v8
  s_cmp_lg_u64 vcc, 0
  s_cselect_b32 s77, s77, s28
  s_cselect_b32 s29, s29, 1
  v_mov_b32 v10, s29
  v_mov_b32 v11, s27
  ds_write_b64 v9, v[10:11] offset:88
  s_setpc_b64 s[72:73]
.g2_kernel_c2:
  s_cmp_lg_u32 s62, 0
  s_cbranch_scc1 .g2_kernel_d_a
  s_cmp_lg_u32 s16, 7
  s_cbranch_scc1 .g2_kernel_d_a
  v_mov_b32 v6, s71
  s_mov_b32 s38, 0
.g2_kernel_wg57:
  ds_read_b32 v7, v6 offset:20
  s_add_u32 s38, s38, 1
  s_waitcnt lgkmcnt(0)
  v_cmp_le_u32 vcc, 4, v7
  s_cbranch_vccnz .g2_kernel_wg57d
  s_sleep 2
  s_cmp_lt_u32 s38, 524288
  s_cbranch_scc1 .g2_kernel_wg57
.g2_kernel_wg57d:
  s_sleep 20
  s_and_b32 s31, s19, 0xffffe000
  s_add_u32 s31, s31, 8
  v_and_b32 v6, 15, v2
  v_lshlrev_b32 v6, 9, v6
  v_lshrrev_b32 v7, 4, v2
  v_lshl_add_u32 v6, v7, 7, v6
  v_lshlrev_b32 v7, 2, v2
  v_add_u32 v7, 158208, v7
  s_mov_b32 m0, 158208
  s_mov_b32 s38, 0
.g2_kernel_pa58:
  buffer_load_dword v6, s[4:7], s31 offen sc1 lds
  s_add_u32 s38, s38, 1
  s_waitcnt vmcnt(0)
  ds_read_b32 v8, v7
  s_waitcnt lgkmcnt(0)
  v_cmp_ge_u32 vcc, s62, v8
  s_cbranch_vccz .g2_kernel_pa58d
  s_mov_b64 exec, vcc
  s_sleep 10
  s_cmp_lt_u32 s38, 131072
  s_cbranch_scc1 .g2_kernel_pa58
.g2_kernel_pa58d:
  s_mov_b64 exec, -1
.g2_kernel_d_a:
  s_setprio 2
  s_and_b32 s20, s16, 1
  v_bfe_u32 v8, v2, 1, 3
  v_lshlrev_b32 v8, 14, v8
  v_and_b32 v9, 1, v2
  v_lshl_add_u32 v8, v9, 10, v8
  v_lshrrev_b32 v9, 4, v2
  v_lshl_add_u32 v8, v9, 8, v8
  v_and_b32 v9, 15, v2
  v_lshlrev_b32 v9, 3, v9
  s_lshl_b32 s28, s20, 7
  s_add_u32 s28, s28, 163584
  v_add_u32 v10, s28, v9
  v_xor_b32 v11, 128, v10
  s_lshl_b32 s28, s20, 2
  s_add_u32 s28, s28, s71
  v_mov_b32 v12, s28
  v_xor_b32 v13, 4, v12
  s_lshl_b32 s26, s17, 4
  s_add_u32 s26, s26, s18
  s_lshl_b32 s26, s26, 1
  s_add_u32 s26, s26, s20
  s_lshl_b32 s26, s26, 11
  s_add_u32 s26, s26, s63
  s_add_u32 s26, s26, 0x1090000
  s_mov_b32 s32, 0
  s_mov_b32 s39, 0
  s_lshl_b32 s28, s62, 3
  s_add_u32 s28, s28, s16
  s_cmp_lg_u32 s28, 14
  s_cbranch_scc1 .g2_kernel_d_w
  s_lshr_b32 s33, s77, 7
  s_lshl_b32 s28, s33, 4
  s_lshl_b64 s[34:35], 0xffff, s28
  s_lshr_b32 s28, s33, 2
  s_cmp_eq_u32 s28, 0
  s_cselect_b64 s[8:9], s[34:35], 0
  s_cmp_eq_u32 s28, 1
  s_cselect_b64 s[10:11], s[34:35], 0
  s_cmp_eq_u32 s28, 2
  s_cselect_b64 s[12:13], s[34:35], 0
  s_cmp_eq_u32 s28, 3
  s_cselect_b64 s[14:15], s[34:35], 0
  s_not_b64 s[8:9], s[8:9]
  s_not_b64 s[10:11], s[10:11]
  s_not_b64 s[12:13], s[12:13]
  s_not_b64 s[14:15], s[14:15]
  s_and_b32 s28, s2, 7
  s_lshl_b32 s28, s28, 13
  s_add_u32 s23, s28, 0x3050000
  s_cmp_eq_u32 s33, s17
  s_cbranch_scc1 .g2_kernel_d_v
  v_mov_b32 v6, s71
  s_mov_b32 s38, 0
.g2_kernel_wg59:
  ds_read_b32 v7, v6 offset:20
  s_add_u32 s38, s38, 1
  s_waitcnt lgkmcnt(0)
  v_cmp_le_u32 vcc, 4, v7
  s_cbranch_vccnz .g2_kernel_wg59d
  s_sleep 1
  s_cmp_lt_u32 s38, 524288
  s_cbranch_scc1 .g2_kernel_wg59
.g2_kernel_wg59d:
.g2_kernel_d_v:
  s_sleep 60
  s_call_b64 s[68:69], .g2_kernel_amax
  s_add_u32 s28, s77, 1
  v_mov_b32 v6, s27
  v_mov_b32 v7, s28
  ds_write_b32 v12, v6 offset:96
  ds_write_b32 v12, v7 offset:36
  s_waitcnt lgkmcnt(0)
  s_wakeup
  s_branch .g2_kernel_d_r
.g2_kernel_d_w:
  v_mov_b32 v6, s71
  s_mov_b32 s38, 0
.g2_kernel_wg60:
  ds_read_b32 v7, v6 offset:36
  s_add_u32 s38, s38, 1
  s_waitcnt lgkmcnt(0)
  v_cmp_le_u32 vcc, 1, v7
  s_cbranch_vccnz .g2_kernel_wg60d
  s_sleep 4
  s_cmp_lt_u32 s38, 524288
  s_cbranch_scc1 .g2_kernel_wg60
.g2_kernel_wg60d:
  v_readfirstlane_b32 s77, v7
  s_sub_u32 s77, s77, 1
.g2_kernel_d_r:
  s_and_b32 s77, s77, 2047
  s_lshr_b32 s24, s77, 7
  s_lshl_b32 s24, s24, 18
  s_bfe_u32 s28, s77, 0x30004
  s_lshl_b32 s28, s28, 11
  s_add_u32 s24, s24, s28
  s_and_b32 s28, s77, 15
  s_lshl_b32 s28, s28, 4
  s_add_u32 s24, s24, s28
  s_add_u32 s24, s24, s63
  s_add_u32 s24, s24, 0xc00000
  s_lshl_b32 s28, s17, 14
  s_add_u32 s21, s24, s28
  s_and_b32 s28, s18, 8
  s_lshl_b32 s28, s28, 5
  s_add_u32 s21, s21, s28
  s_and_b32 s28, s18, 7
  s_lshl_b32 s28, s28, 1
  s_add_u32 s21, s21, s28
  s_lshl_b32 s28, s20, 17
  s_add_u32 s24, s24, s28
  buffer_load_dwordx4 v[16:19], v8, s[4:7], s24 offen
  buffer_load_ushort v56, v4, s[4:7], s21 offen
  buffer_load_ushort v57, v4, s[4:7], s21 offen offset:512
  buffer_load_ushort v58, v4, s[4:7], s21 offen offset:1024
  buffer_load_ushort v59, v4, s[4:7], s21 offen offset:1536
  s_lshl_b32 s25, s77, 3
  s_add_u32 s25, s25, s63
  s_add_u32 s25, s25, 0x1080000
  s_mov_b32 s38, 0
.g2_kernel_gx61:
  buffer_load_dwordx2 v[20:21], v4, s[4:7], s25 offen sc1
  s_add_u32 s38, s38, 1
  s_waitcnt vmcnt(0)
  v_min_u32 v6, v21, v21
  v_cmp_eq_u32 vcc, 0, v6
  s_cbranch_vccz .g2_kernel_gx61d
  s_mov_b64 exec, vcc
  s_sleep 1
  s_cmp_lt_u32 s38, 131072
  s_cbranch_scc1 .g2_kernel_gx61
.g2_kernel_gx61d:
  s_mov_b64 exec, -1
  v_rsq_f32 v21, v21
  v_lshlrev_b32 v24, 16, v16
  v_and_b32 v25, 0xffff0000, v16
  v_lshlrev_b32 v26, 16, v17
  v_and_b32 v27, 0xffff0000, v17
  v_lshlrev_b32 v28, 16, v18
  v_and_b32 v29, 0xffff0000, v18
  v_lshlrev_b32 v30, 16, v19
  v_and_b32 v31, 0xffff0000, v19
  v_mul_f32 v20, v20, v21
  v_mov_b32 v60, v20
  v_add_f32 v61, 1.0, v21
  s_cmp_ge_u32 s17, 14
  s_cbranch_scc1 .g2_kernel_d_none
  v_fma_f32 v24, v24, v21, -v20
  v_fma_f32 v25, v25, v21, -v20
  v_fma_f32 v26, v26, v21, -v20
  v_fma_f32 v27, v27, v21, -v20
  v_fma_f32 v28, v28, v21, -v20
  v_fma_f32 v29, v29, v21, -v20
  v_fma_f32 v30, v30, v21, -v20
  v_fma_f32 v31, v31, v21, -v20
  v_cvt_pk_bf16_f32 v16, v24, v25
  v_cvt_pk_bf16_f32 v17, v26, v27
  v_cvt_pk_bf16_f32 v18, v28, v29
  v_cvt_pk_bf16_f32 v19, v30, v31
  v_mov_b32 v24, v16 row_newbcast:0 row_mask:0xf bank_mask:0xf
  v_mov_b32 v25, v17 row_newbcast:0 row_mask:0xf bank_mask:0xf
  v_mov_b32 v26, v18 row_newbcast:0 row_mask:0xf bank_mask:0xf
  v_mov_b32 v27, v19 row_newbcast:0 row_mask:0xf bank_mask:0xf
  v_mov_b32 v28, v16 row_newbcast:1 row_mask:0xf bank_mask:0xf
  v_mov_b32 v29, v17 row_newbcast:1 row_mask:0xf bank_mask:0xf
  v_mov_b32 v30, v18 row_newbcast:1 row_mask:0xf bank_mask:0xf
  v_mov_b32 v31, v19 row_newbcast:1 row_mask:0xf bank_mask:0xf
  v_mfma_f32_16x16x32_bf16 v[32:35], v[24:27], v[64:67], 0
  v_mfma_f32_16x16x32_bf16 v[36:39], v[24:27], v[128:131], 0
  v_mov_b32 v24, v16 row_newbcast:2 row_mask:0xf bank_mask:0xf
  v_mov_b32 v25, v17 row_newbcast:2 row_mask:0xf bank_mask:0xf
  v_mov_b32 v26, v18 row_newbcast:2 row_mask:0xf bank_mask:0xf
  v_mov_b32 v27, v19 row_newbcast:2 row_mask:0xf bank_mask:0xf
  v_mfma_f32_16x16x32_bf16 v[32:35], v[28:31], v[68:71], v[32:35]
  v_mfma_f32_16x16x32_bf16 v[36:39], v[28:31], v[132:135], v[36:39]
  v_mov_b32 v28, v16 row_newbcast:3 row_mask:0xf bank_mask:0xf
  v_mov_b32 v29, v17 row_newbcast:3 row_mask:0xf bank_mask:0xf
  v_mov_b32 v30, v18 row_newbcast:3 row_mask:0xf bank_mask:0xf
  v_mov_b32 v31, v19 row_newbcast:3 row_mask:0xf bank_mask:0xf
  v_mfma_f32_16x16x32_bf16 v[32:35], v[24:27], v[72:75], v[32:35]
  v_mfma_f32_16x16x32_bf16 v[36:39], v[24:27], v[136:139], v[36:39]
  v_mov_b32 v24, v16 row_newbcast:4 row_mask:0xf bank_mask:0xf
  v_mov_b32 v25, v17 row_newbcast:4 row_mask:0xf bank_mask:0xf
  v_mov_b32 v26, v18 row_newbcast:4 row_mask:0xf bank_mask:0xf
  v_mov_b32 v27, v19 row_newbcast:4 row_mask:0xf bank_mask:0xf
  v_mfma_f32_16x16x32_bf16 v[32:35], v[28:31], v[76:79], v[32:35]
  v_mfma_f32_16x16x32_bf16 v[36:39], v[28:31], v[140:143], v[36:39]
  v_mov_b32 v28, v16 row_newbcast:5 row_mask:0xf bank_mask:0xf
  v_mov_b32 v29, v17 row_newbcast:5 row_mask:0xf bank_mask:0xf
  v_mov_b32 v30, v18 row_newbcast:5 row_mask:0xf bank_mask:0xf
  v_mov_b32 v31, v19 row_newbcast:5 row_mask:0xf bank_mask:0xf
  v_mfma_f32_16x16x32_bf16 v[32:35], v[24:27], v[80:83], v[32:35]
  v_mfma_f32_16x16x32_bf16 v[36:39], v[24:27], v[144:147], v[36:39]
  v_mov_b32 v24, v16 row_newbcast:6 row_mask:0xf bank_mask:0xf
  v_mov_b32 v25, v17 row_newbcast:6 row_mask:0xf bank_mask:0xf
  v_mov_b32 v26, v18 row_newbcast:6 row_mask:0xf bank_mask:0xf
  v_mov_b32 v27, v19 row_newbcast:6 row_mask:0xf bank_mask:0xf
  v_mfma_f32_16x16x32_bf16 v[32:35], v[28:31], v[84:87], v[32:35]
  v_mfma_f32_16x16x32_bf16 v[36:39], v[28:31], v[148:151], v[36:39]
  v_mov_b32 v28, v16 row_newbcast:7 row_mask:0xf bank_mask:0xf
  v_mov_b32 v29, v17 row_newbcast:7 row_mask:0xf bank_mask:0xf
  v_mov_b32 v30, v18 row_newbcast:7 row_mask:0xf bank_mask:0xf
  v_mov_b32 v31, v19 row_newbcast:7 row_mask:0xf bank_mask:0xf
  v_mfma_f32_16x16x32_bf16 v[32:35], v[24:27], v[88:91], v[32:35]
  v_mfma_f32_16x16x32_bf16 v[36:39], v[24:27], v[152:155], v[36:39]
  v_mov_b32 v24, v16 row_newbcast:8 row_mask:0xf bank_mask:0xf
  v_mov_b32 v25, v17 row_newbcast:8 row_mask:0xf bank_mask:0xf
  v_mov_b32 v26, v18 row_newbcast:8 row_mask:0xf bank_mask:0xf
  v_mov_b32 v27, v19 row_newbcast:8 row_mask:0xf bank_mask:0xf
  v_mfma_f32_16x16x32_bf16 v[32:35], v[28:31], v[92:95], v[32:35]
  v_mfma_f32_16x16x32_bf16 v[36:39], v[28:31], v[156:159], v[36:39]
  v_mov_b32 v28, v16 row_newbcast:9 row_mask:0xf bank_mask:0xf
  v_mov_b32 v29, v17 row_newbcast:9 row_mask:0xf bank_mask:0xf
  v_mov_b32 v30, v18 row_newbcast:9 row_mask:0xf bank_mask:0xf
  v_mov_b32 v31, v19 row_newbcast:9 row_mask:0xf bank_mask:0xf
  v_mfma_f32_16x16x32_bf16 v[32:35], v[24:27], v[96:99], v[32:35]
  v_mfma_f32_16x16x32_bf16 v[36:39], v[24:27], v[160:163], v[36:39]
  v_mov_b32 v24, v16 row_newbcast:10 row_mask:0xf bank_mask:0xf
  v_mov_b32 v25, v17 row_newbcast:10 row_mask:0xf bank_mask:0xf
  v_mov_b32 v26, v18 row_newbcast:10 row_mask:0xf bank_mask:0xf
  v_mov_b32 v27, v19 row_newbcast:10 row_mask:0xf bank_mask:0xf
  v_mfma_f32_16x16x32_bf16 v[32:35], v[28:31], v[100:103], v[32:35]
  v_mfma_f32_16x16x32_bf16 v[36:39], v[28:31], v[164:167], v[36:39]
  v_mov_b32 v28, v16 row_newbcast:11 row_mask:0xf bank_mask:0xf
  v_mov_b32 v29, v17 row_newbcast:11 row_mask:0xf bank_mask:0xf
  v_mov_b32 v30, v18 row_newbcast:11 row_mask:0xf bank_mask:0xf
  v_mov_b32 v31, v19 row_newbcast:11 row_mask:0xf bank_mask:0xf
  v_mfma_f32_16x16x32_bf16 v[32:35], v[24:27], v[104:107], v[32:35]
  v_mfma_f32_16x16x32_bf16 v[36:39], v[24:27], v[168:171], v[36:39]
  v_mov_b32 v24, v16 row_newbcast:12 row_mask:0xf bank_mask:0xf
  v_mov_b32 v25, v17 row_newbcast:12 row_mask:0xf bank_mask:0xf
  v_mov_b32 v26, v18 row_newbcast:12 row_mask:0xf bank_mask:0xf
  v_mov_b32 v27, v19 row_newbcast:12 row_mask:0xf bank_mask:0xf
  v_mfma_f32_16x16x32_bf16 v[32:35], v[28:31], v[108:111], v[32:35]
  v_mfma_f32_16x16x32_bf16 v[36:39], v[28:31], v[172:175], v[36:39]
  v_mov_b32 v28, v16 row_newbcast:13 row_mask:0xf bank_mask:0xf
  v_mov_b32 v29, v17 row_newbcast:13 row_mask:0xf bank_mask:0xf
  v_mov_b32 v30, v18 row_newbcast:13 row_mask:0xf bank_mask:0xf
  v_mov_b32 v31, v19 row_newbcast:13 row_mask:0xf bank_mask:0xf
  v_mfma_f32_16x16x32_bf16 v[32:35], v[24:27], v[112:115], v[32:35]
  v_mfma_f32_16x16x32_bf16 v[36:39], v[24:27], v[176:179], v[36:39]
  v_mov_b32 v24, v16 row_newbcast:14 row_mask:0xf bank_mask:0xf
  v_mov_b32 v25, v17 row_newbcast:14 row_mask:0xf bank_mask:0xf
  v_mov_b32 v26, v18 row_newbcast:14 row_mask:0xf bank_mask:0xf
  v_mov_b32 v27, v19 row_newbcast:14 row_mask:0xf bank_mask:0xf
  v_mfma_f32_16x16x32_bf16 v[32:35], v[28:31], v[116:119], v[32:35]
  v_mfma_f32_16x16x32_bf16 v[36:39], v[28:31], v[180:183], v[36:39]
  v_mov_b32 v28, v16 row_newbcast:15 row_mask:0xf bank_mask:0xf
  v_mov_b32 v29, v17 row_newbcast:15 row_mask:0xf bank_mask:0xf
  v_mov_b32 v30, v18 row_newbcast:15 row_mask:0xf bank_mask:0xf
  v_mov_b32 v31, v19 row_newbcast:15 row_mask:0xf bank_mask:0xf
  v_mfma_f32_16x16x32_bf16 v[32:35], v[24:27], v[120:123], v[32:35]
  v_mfma_f32_16x16x32_bf16 v[36:39], v[24:27], v[184:187], v[36:39]
  v_mfma_f32_16x16x32_bf16 v[32:35], v[28:31], v[124:127], v[32:35]
  v_mfma_f32_16x16x32_bf16 v[36:39], v[28:31], v[188:191], v[36:39]
  s_mov_b32 s38, 0
  s_add_u32 s28, s32, 1
  v_mov_b32 v14, s28
  s_mov_b32 s28, 0x00010001
  s_mov_b32 s29, 0x00100010
  s_nop 2
  v_mov_b32 v35, v36
  ds_write_b64 v10, v[34:35]
  ds_write_b32 v12, v14 offset:40
.g2_kernel_d_x:
  ds_read_b32 v6, v13 offset:40
  ds_read_b64 v[16:17], v11
  s_add_u32 s38, s38, 1
  s_waitcnt lgkmcnt(0)
  v_cmp_lt_u32 vcc, s32, v6
  s_cbranch_vccnz .g2_kernel_d_xd
  s_cmp_lt_u32 s38, 524288
  s_cbranch_scc1 .g2_kernel_d_x
.g2_kernel_d_xd:
  v_add_f32 v16, v16, v32
  v_add_f32 v17, v17, v36
  v_mul_f32 v18, -1.4426950408889634, v16
  v_exp_f32 v18, v18
  v_mul_f32 v16, v16, v17
  v_add_f32 v18, 1.0, v18
  v_rcp_f32 v18, v18
  s_nop 0
  v_mul_f32 v16, v16, v18
  s_nop 1
  v_mov_b32 v17, v16 quad_perm:[1,0,3,2] row_mask:0xf bank_mask:0xf
  v_cvt_pk_bf16_f32 v16, v16, v17
  s_nop 1
  v_mov_b32 v20, v16 row_newbcast:0 row_mask:0x5 bank_mask:0xf
  v_mov_b32 v21, v16 row_newbcast:2 row_mask:0x5 bank_mask:0xf
  v_mov_b32 v22, v16 row_newbcast:4 row_mask:0x5 bank_mask:0xf
  v_mov_b32 v23, v16 row_newbcast:6 row_mask:0x5 bank_mask:0xf
  v_mov_b32 v20, v16 row_newbcast:8 row_mask:0xa bank_mask:0xf
  v_mov_b32 v21, v16 row_newbcast:10 row_mask:0xa bank_mask:0xf
  v_mov_b32 v22, v16 row_newbcast:12 row_mask:0xa bank_mask:0xf
  v_mov_b32 v23, v16 row_newbcast:14 row_mask:0xa bank_mask:0xf
  v_cndmask_b32 v24, 0, v20, s[28:29]
  v_cndmask_b32 v25, 0, v21, s[28:29]
  v_cndmask_b32 v26, 0, v22, s[28:29]
  v_cndmask_b32 v27, 0, v23, s[28:29]
  s_lshl_b64 s[28:29], s[28:29], 1
  s_nop 0
  v_mfma_f32_16x16x32_bf16 v[40:43], v[24:27], v[192:195], 0
  v_mfma_f32_16x16x32_bf16 v[44:47], v[24:27], v[208:211], 0
  v_mfma_f32_16x16x32_bf16 v[48:51], v[24:27], v[224:227], 0
  v_mfma_f32_16x16x32_bf16 v[52:55], v[24:27], v[240:243], 0
  v_cndmask_b32 v28, 0, v20, s[28:29]
  v_cndmask_b32 v29, 0, v21, s[28:29]
  v_cndmask_b32 v30, 0, v22, s[28:29]
  v_cndmask_b32 v31, 0, v23, s[28:29]
  s_lshl_b64 s[28:29], s[28:29], 1
  s_nop 0
  v_mfma_f32_16x16x32_bf16 v[40:43], v[28:31], v[196:199], v[40:43]
  v_mfma_f32_16x16x32_bf16 v[44:47], v[28:31], v[212:215], v[44:47]
  v_mfma_f32_16x16x32_bf16 v[48:51], v[28:31], v[228:231], v[48:51]
  v_mfma_f32_16x16x32_bf16 v[52:55], v[28:31], v[244:247], v[52:55]
  v_cndmask_b32 v32, 0, v20, s[28:29]
  v_cndmask_b32 v33, 0, v21, s[28:29]
  v_cndmask_b32 v34, 0, v22, s[28:29]
  v_cndmask_b32 v35, 0, v23, s[28:29]
  s_lshl_b64 s[28:29], s[28:29], 1
  s_nop 0
  v_mfma_f32_16x16x32_bf16 v[40:43], v[32:35], v[200:203], v[40:43]
  v_mfma_f32_16x16x32_bf16 v[44:47], v[32:35], v[216:219], v[44:47]
  v_mfma_f32_16x16x32_bf16 v[48:51], v[32:35], v[232:235], v[48:51]
  v_mfma_f32_16x16x32_bf16 v[52:55], v[32:35], v[248:251], v[52:55]
  v_cndmask_b32 v36, 0, v20, s[28:29]
  v_cndmask_b32 v37, 0, v21, s[28:29]
  v_cndmask_b32 v38, 0, v22, s[28:29]
  v_cndmask_b32 v39, 0, v23, s[28:29]
  s_lshl_b64 s[28:29], s[28:29], 1
  s_nop 0
  v_mfma_f32_16x16x32_bf16 v[40:43], v[36:39], v[204:207], v[40:43]
  v_mfma_f32_16x16x32_bf16 v[44:47], v[36:39], v[220:223], v[44:47]
  v_mfma_f32_16x16x32_bf16 v[48:51], v[36:39], v[236:239], v[48:51]
  v_mfma_f32_16x16x32_bf16 v[52:55], v[36:39], v[252:255], v[52:55]
  s_mov_b32 exec_hi, 0
  s_nop 3
  v_or_b32 v40, 1, v40
  v_or_b32 v42, 1, v42
  buffer_store_dwordx4 v[40:43], v3, s[4:7], s26 offen offset:0 sc1
  v_or_b32 v44, 1, v44
  v_or_b32 v46, 1, v46
  buffer_store_dwordx4 v[44:47], v3, s[4:7], s26 offen offset:512 sc1
  v_or_b32 v48, 1, v48
  v_or_b32 v50, 1, v50
  buffer_store_dwordx4 v[48:51], v3, s[4:7], s26 offen offset:1024 sc1
  v_or_b32 v52, 1, v52
  v_or_b32 v54, 1, v54
  buffer_store_dwordx4 v[52:55], v3, s[4:7], s26 offen offset:1536 sc1
  s_mov_b64 exec, -1
  s_branch .g2_kernel_d_e
.g2_kernel_d_none:
  s_sleep 24
.g2_kernel_d_e:
  v_mov_b32 v6, s71
  s_mov_b64 exec, 1
  ds_add_u32 v6, v5 offset:48
  s_mov_b64 exec, -1
  s_cmp_lg_u32 s62, 0
  s_cbranch_scc1 .g2_kernel_d_t
  s_mov_b32 s62, 1
  s_mov_b32 s63, 0x1800000
  s_mov_b32 s70, 2
  s_mov_b32 s71, 155776
  s_branch .g2_kernel_v
.g2_kernel_d_t:
  s_cmp_lg_u32 s20, 0
  s_cbranch_scc1 .g2_kernel_d_t1
  v_mov_b32 v62, -1.4426950408889634
  v_mul_f32 v62, s27, v62
  v_exp_f32 v62, v62
  v_lshlrev_b32 v14, 12, v2
  v_min_u32 v15, 126976, v14
  s_lshl_b32 s21, s17, 4
  s_add_u32 s21, s21, s18
  s_lshl_b32 s21, s21, 4
  s_mul_i32 s22, s32, 0x270000
  s_add_u32 s21, s21, s22
  s_add_u32 s21, s21, 0x2890000
  s_add_u32 s22, s21, 262144
  s_add_u32 s24, s21, 524288
  s_add_u32 s25, s21, 786432
  v_add_f32 v62, 1.0, v62
  v_rcp_f32 v62, v62
  v_lshlrev_b32 v56, 16, v56
  v_fma_f32 v56, v56, v61, -v60
  v_lshlrev_b32 v57, 16, v57
  v_fma_f32 v57, v57, v61, -v60
  v_lshlrev_b32 v58, 16, v58
  v_fma_f32 v58, v58, v61, -v60
  v_lshlrev_b32 v59, 16, v59
  v_fma_f32 v59, v59, v61, -v60
  s_sleep 8
  s_mov_b32 s38, 0
.g2_kernel_gx62:
  buffer_load_dwordx4 v[16:19], v14, s[4:7], s21 offen sc1
  buffer_load_dwordx4 v[20:23], v14, s[4:7], s22 offen sc1
  buffer_load_dwordx4 v[24:27], v14, s[4:7], s24 offen sc1
  buffer_load_dwordx4 v[28:31], v15, s[4:7], s25 offen sc1
  s_add_u32 s38, s38, 1
  s_waitcnt vmcnt(0)
  v_min3_u32 v6, v16, v18, v20
  v_min3_u32 v6, v6, v22, v24
  v_min3_u32 v6, v6, v26, v28
  v_min_u32 v6, v6, v30
  v_cmp_eq_u32 vcc, 0, v6
  s_cbranch_vccz .g2_kernel_gx62d
  s_mov_b64 exec, vcc
  s_cmp_lt_u32 s38, 131072
  s_cbranch_scc1 .g2_kernel_gx62
.g2_kernel_gx62d:
  s_mov_b64 exec, -1
  v_add_f32 v16, v16, v20
  v_add_f32 v17, v17, v21
  v_add_f32 v18, v18, v22
  v_add_f32 v19, v19, v23
  s_mov_b32 exec_hi, 0
  v_add_f32 v24, v24, v28
  v_add_f32 v25, v25, v29
  v_add_f32 v26, v26, v30
  v_add_f32 v27, v27, v31
  s_mov_b64 exec, -1
  v_add_f32 v16, v16, v24
  v_add_f32 v17, v17, v25
  v_add_f32 v18, v18, v26
  v_add_f32 v19, v19, v27
  v_add_f32 v16, v16, v16 row_ror:8 row_mask:0xf bank_mask:0xf
  v_add_f32 v17, v17, v17 row_ror:8 row_mask:0xf bank_mask:0xf
  v_add_f32 v18, v18, v18 row_ror:8 row_mask:0xf bank_mask:0xf
  v_add_f32 v19, v19, v19 row_ror:8 row_mask:0xf bank_mask:0xf
  v_add_f32 v16, v16, v16 row_ror:4 row_mask:0xf bank_mask:0xf
  v_add_f32 v17, v17, v17 row_ror:4 row_mask:0xf bank_mask:0xf
  v_add_f32 v18, v18, v18 row_ror:4 row_mask:0xf bank_mask:0xf
  v_add_f32 v19, v19, v19 row_ror:4 row_mask:0xf bank_mask:0xf
  v_add_f32 v16, v16, v16 row_ror:2 row_mask:0xf bank_mask:0xf
  v_add_f32 v17, v17, v17 row_ror:2 row_mask:0xf bank_mask:0xf
  v_add_f32 v18, v18, v18 row_ror:2 row_mask:0xf bank_mask:0xf
  v_add_f32 v19, v19, v19 row_ror:2 row_mask:0xf bank_mask:0xf
  v_add_f32 v16, v16, v16 row_ror:1 row_mask:0xf bank_mask:0xf
  v_add_f32 v17, v17, v17 row_ror:1 row_mask:0xf bank_mask:0xf
  v_add_f32 v18, v18, v18 row_ror:1 row_mask:0xf bank_mask:0xf
  v_add_f32 v19, v19, v19 row_ror:1 row_mask:0xf bank_mask:0xf
  v_add_f32 v16, v16, v16 row_bcast:15 row_mask:0xa bank_mask:0xf
  v_add_f32 v17, v17, v17 row_bcast:15 row_mask:0xa bank_mask:0xf
  v_add_f32 v18, v18, v18 row_bcast:15 row_mask:0xa bank_mask:0xf
  v_add_f32 v19, v19, v19 row_bcast:15 row_mask:0xa bank_mask:0xf
  v_add_f32 v16, v16, v16 row_bcast:31 row_mask:0xc bank_mask:0xf
  v_add_f32 v17, v17, v17 row_bcast:31 row_mask:0xc bank_mask:0xf
  v_add_f32 v18, v18, v18 row_bcast:31 row_mask:0xc bank_mask:0xf
  v_add_f32 v19, v19, v19 row_bcast:31 row_mask:0xc bank_mask:0xf
  s_lshl_b32 s24, s77, 11
  s_lshl_b32 s25, s17, 7
  s_add_u32 s24, s24, s25
  s_lshl_b32 s25, s18, 1
  s_add_u32 s24, s24, s25
.g2_kernel_d_t1:
  v_mov_b32 v6, s71
  s_mov_b32 s38, 0
.g2_kernel_wg63:
  ds_read_b32 v7, v6 offset:88
  s_add_u32 s38, s38, 1
  s_waitcnt lgkmcnt(0)
  v_cmp_le_u32 vcc, 1, v7
  s_cbranch_vccnz .g2_kernel_wg63d
  s_cmp_lt_u32 s38, 524288
  s_cbranch_scc1 .g2_kernel_wg63
.g2_kernel_wg63d:
  ds_read_b32 v6, v6 offset:92
  v_readfirstlane_b32 s33, v7
  s_cmp_lg_u32 s32, 0
  s_cselect_b32 s33, 1, s33
  s_cmp_lg_u32 s20, 0
  s_cbranch_scc1 .g2_kernel_d_t2
  s_cmp_lg_u32 s33, 1
  s_cbranch_scc1 .g2_kernel_d_t4
  v_fmac_f32 v56, v16, v62
  v_fmac_f32 v57, v17, v62
  v_fmac_f32 v58, v18, v62
  v_fmac_f32 v59, v19, v62
.g2_kernel_d_t4:
  s_mov_b32 s28, s56
  s_mov_b32 s29, s57
  s_mov_b32 s30, 0x400000
  s_mov_b32 s31, 0x00020000
  v_cvt_pk_bf16_f32 v56, v56, v57
  v_cvt_pk_bf16_f32 v58, v58, v59
  s_mov_b32 exec_lo, 0
  s_mov_b32 exec_hi, 0x80000000
  buffer_store_short v56, v4, s[28:31], s24 offen
  buffer_store_short_d16_hi v56, v4, s[28:31], s24 offen offset:32
  buffer_store_short v58, v4, s[28:31], s24 offen offset:64
  buffer_store_short_d16_hi v58, v4, s[28:31], s24 offen offset:96
  s_mov_b64 exec, -1
.g2_kernel_d_t2:
  s_cmp_eq_u32 s33, 1
  s_cbranch_scc1 .g2_kernel_fin
  s_waitcnt vmcnt(0) lgkmcnt(0)
  v_readfirstlane_b32 s27, v6
  s_sub_u32 s77, s33, 2
  s_mov_b32 s32, 1
  s_add_u32 s26, s26, 0x270000
  s_branch .g2_kernel_d_r
.g2_kernel_fin1:
.g2_kernel_fin:
.g2_kernel_end:
  s_endpgm
.g2_kernel_q_i2:
  v_mov_b32 v6, 155648
  s_mov_b32 s38, 0
.g2_kernel_wg1:
  ds_read_b32 v7, v6 offset:20
  s_add_u32 s38, s38, 1
  s_waitcnt lgkmcnt(0)
  v_cmp_le_u32 vcc, 4, v7
  s_cbranch_vccnz .g2_kernel_wg1d
  s_cmp_lt_u32 s38, 524288
  s_cbranch_scc1 .g2_kernel_wg1
.g2_kernel_wg1d:
  s_branch .g2_kernel_q_i3
.g2_kernel_q_spin:
  s_mov_b32 s38, 0
.g2_kernel_q_spinl:
  ds_read_b32 v151, v150
  s_add_u32 s38, s38, 1
  s_waitcnt lgkmcnt(0)
  v_cmp_lt_i32 vcc, s33, v151
  s_cbranch_vccnz .g2_kernel_q_spinr
  s_cmp_lt_u32 s38, 524288
  s_cbranch_scc1 .g2_kernel_q_spinl
.g2_kernel_q_spinr:
  s_setpc_b64 s[68:69]
.g2_kernel_q_wf:
  s_call_b64 s[68:69], .g2_kernel_q_spin
  s_branch .g2_kernel_q_backf
.g2_kernel_q_w7:
  s_call_b64 s[68:69], .g2_kernel_q_spin
  s_branch .g2_kernel_q_back7
.g2_kernel_q_w0:
  s_call_b64 s[68:69], .g2_kernel_q_spin
  s_branch .g2_kernel_q_back0
.g2_kernel_q_w1:
  s_call_b64 s[68:69], .g2_kernel_q_spin
  s_branch .g2_kernel_q_back1
.g2_kernel_q_w2:
  s_call_b64 s[68:69], .g2_kernel_q_spin
  s_branch .g2_kernel_q_back2
.g2_kernel_q_w3:
  s_call_b64 s[68:69], .g2_kernel_q_spin
  s_branch .g2_kernel_q_back3
.g2_kernel_q_w4:
  s_call_b64 s[68:69], .g2_kernel_q_spin
  s_branch .g2_kernel_q_back4
.g2_kernel_q_w5:
  s_call_b64 s[68:69], .g2_kernel_q_spin
  s_branch .g2_kernel_q_back5
.g2_kernel_q_w6:
  s_call_b64 s[68:69], .g2_kernel_q_spin
  s_branch .g2_kernel_q_back6
.g2_kernel_q_cons2:
  s_lshr_b32 s26, s16, 1
  s_lshl_b32 s26, s26, 13
  v_add_u32 v144, s26, v3
  v_add_u32 v145, 1024, v144
  s_branch .g2_kernel_q_cs
.g2_kernel_q_ew:
  s_mov_b32 s38, 0
.g2_kernel_q_ewl:
  ds_read_b32 v62, v13 offset:0
  ds_read_b32 v63, v58
  s_add_u32 s38, s38, 1
  s_waitcnt lgkmcnt(0)
  v_cmp_gt_u32 vcc, 2, v62
  v_cmp_gt_u32 s[14:15], s12, v63
  s_or_b64 vcc, vcc, s[14:15]
  s_cbranch_scc0 .g2_kernel_q_ec
  s_cmp_lt_u32 s38, 524288
  s_cbranch_scc1 .g2_kernel_q_ewl
.g2_kernel_q_ec:
  ds_read_b32 v57, v13 offset:24
  ds_read_b32 v21, v13 offset:84
  ds_read_b128 v[40:43], v52 offset:5120
  ds_read_b128 v[44:47], v52 offset:5184
  ds_read_b32 v24, v50 offset:2816
  ds_read_b32 v25, v50 offset:3328
  ds_read_b32 v26, v50 offset:2880
  ds_read_b32 v27, v50 offset:3392
  ds_read_b32 v28, v50 offset:2944
  ds_read_b32 v29, v50 offset:3456
  ds_read_b32 v30, v50 offset:3008
  ds_read_b32 v31, v50 offset:3520
  ds_read_b128 v[64:67], v51 offset:2816
  ds_read_b128 v[80:83], v51 offset:3328
  ds_read_b128 v[68:71], v51 offset:2880
  ds_read_b128 v[84:87], v51 offset:3392
  ds_read_b128 v[72:75], v51 offset:2944
  ds_read_b128 v[88:91], v51 offset:3456
  ds_read_b128 v[76:79], v51 offset:3008
  ds_read_b128 v[92:95], v51 offset:3520
  ds_read_b32 v48, v53 offset:5376
  ds_read_b32 v49, v53 offset:5440
  ds_read_b128 v[32:35], v52 offset:4864
  ds_read_b128 v[36:39], v52 offset:4928
  s_waitcnt lgkmcnt(0)
  s_branch .g2_kernel_q_eb
.g2_kernel_q_patch:
  v_readfirstlane_b32 s35, v57
  s_sub_u32 s28, s35, 1
  s_lshr_b32 s29, s28, 6
  s_lshr_b32 s30, s16, 1
  s_add_u32 s35, s35, 0x100
  s_cmp_lg_u32 s29, s30
  s_cbranch_scc1 .g2_kernel_q_pback
  s_add_u32 s35, s35, 0x100
  s_mov_b32 s77, 0x40000000
  s_and_b32 s29, s28, 15
  s_mov_b32 s14, 0x00010001
  s_mov_b32 s15, 0x00010001
  s_lshl_b64 s[14:15], s[14:15], s29
  s_and_b32 s29, s28, 12
  s_lshl_b32 s29, s29, 2
  s_lshl_b64 s[30:31], 0xffff, s29
  v_subrev_u32 v96, 155648, v53
  v_lshlrev_b32 v96, 2, v96
  v_add_u32 v96, 155648, v96
  s_bfe_u32 s29, s28, 0x20004
  s_cmp_lg_u32 s29, 0
  s_cbranch_scc1 .g2_kernel_q_pv1
  s_mov_b64 exec, s[14:15]
  ds_write_b128 v52, v[160:163] offset:5632
  ds_write_b128 v52, v[176:179] offset:5696
  ds_write_b128 v52, v[192:195] offset:5888
  ds_write_b128 v52, v[208:211] offset:5952
  s_mov_b64 exec, s[30:31]
  ds_write_b128 v96, v[224:227] offset:6144
  ds_write_b128 v96, v[240:243] offset:6400
  s_mov_b64 exec, -1
  s_waitcnt lgkmcnt(0)
  s_branch .g2_kernel_q_pback
.g2_kernel_q_pv1:
  s_cmp_lg_u32 s29, 1
  s_cbranch_scc1 .g2_kernel_q_pv2
  s_mov_b64 exec, s[14:15]
  ds_write_b128 v52, v[164:167] offset:5632
  ds_write_b128 v52, v[180:183] offset:5696
  ds_write_b128 v52, v[196:199] offset:5888
  ds_write_b128 v52, v[212:215] offset:5952
  s_mov_b64 exec, s[30:31]
  ds_write_b128 v96, v[228:231] offset:6144
  ds_write_b128 v96, v[244:247] offset:6400
  s_mov_b64 exec, -1
  s_waitcnt lgkmcnt(0)
  s_branch .g2_kernel_q_pback
.g2_kernel_q_pv2:
  s_cmp_lg_u32 s29, 2
  s_cbranch_scc1 .g2_kernel_q_pv3
  s_mov_b64 exec, s[14:15]
  ds_write_b128 v52, v[168:171] offset:5632
  ds_write_b128 v52, v[184:187] offset:5696
  ds_write_b128 v52, v[200:203] offset:5888
  ds_write_b128 v52, v[216:219] offset:5952
  s_mov_b64 exec, s[30:31]
  ds_write_b128 v96, v[232:235] offset:6144
  ds_write_b128 v96, v[248:251] offset:6400
  s_mov_b64 exec, -1
  s_waitcnt lgkmcnt(0)
  s_branch .g2_kernel_q_pback
.g2_kernel_q_pv3:
  s_mov_b64 exec, s[14:15]
  ds_write_b128 v52, v[172:175] offset:5632
  ds_write_b128 v52, v[188:191] offset:5696
  ds_write_b128 v52, v[204:207] offset:5888
  ds_write_b128 v52, v[220:223] offset:5952
  s_mov_b64 exec, s[30:31]
  ds_write_b128 v96, v[236:239] offset:6144
  ds_write_b128 v96, v[252:255] offset:6400
  s_mov_b64 exec, -1
  s_waitcnt lgkmcnt(0)
  s_branch .g2_kernel_q_pback
.g2_kernel_q_nk:
  v_pk_mul_f32 v[152:153], v[40:41], v[24:25] op_sel:[0,1] op_sel_hi:[1,1]
  v_pk_mul_f32 v[154:155], v[42:43], v[24:25] op_sel:[0,1] op_sel_hi:[1,1]
  v_pk_mul_f32 v[156:157], v[44:45], v[24:25] op_sel:[0,1] op_sel_hi:[1,1]
  v_pk_mul_f32 v[158:159], v[46:47], v[24:25] op_sel:[0,1] op_sel_hi:[1,1]
  v_pk_fma_f32 v[192:193], v[192:193], v[24:25], v[152:153] op_sel_hi:[1,0,1]
  v_pk_fma_f32 v[194:195], v[194:195], v[24:25], v[154:155] op_sel_hi:[1,0,1]
  v_pk_fma_f32 v[208:209], v[208:209], v[24:25], v[156:157] op_sel_hi:[1,0,1]
  v_pk_fma_f32 v[210:211], v[210:211], v[24:25], v[158:159] op_sel_hi:[1,0,1]
  v_cvt_pk_bf16_f32 v192, v192, v193
  v_cvt_pk_bf16_f32 v193, v194, v195
  v_cvt_pk_bf16_f32 v194, v208, v209
  v_cvt_pk_bf16_f32 v195, v210, v211
  ds_write_b128 v59, v[192:195] offset:0
  v_pk_mul_f32 v[152:153], v[40:41], v[26:27] op_sel:[0,1] op_sel_hi:[1,1]
  v_pk_mul_f32 v[154:155], v[42:43], v[26:27] op_sel:[0,1] op_sel_hi:[1,1]
  v_pk_mul_f32 v[156:157], v[44:45], v[26:27] op_sel:[0,1] op_sel_hi:[1,1]
  v_pk_mul_f32 v[158:159], v[46:47], v[26:27] op_sel:[0,1] op_sel_hi:[1,1]
  v_pk_fma_f32 v[196:197], v[196:197], v[26:27], v[152:153] op_sel_hi:[1,0,1]
  v_pk_fma_f32 v[198:199], v[198:199], v[26:27], v[154:155] op_sel_hi:[1,0,1]
  v_pk_fma_f32 v[212:213], v[212:213], v[26:27], v[156:157] op_sel_hi:[1,0,1]
  v_pk_fma_f32 v[214:215], v[214:215], v[26:27], v[158:159] op_sel_hi:[1,0,1]
  v_cvt_pk_bf16_f32 v196, v196, v197
  v_cvt_pk_bf16_f32 v197, v198, v199
  v_cvt_pk_bf16_f32 v198, v212, v213
  v_cvt_pk_bf16_f32 v199, v214, v215
  ds_write_b128 v59, v[196:199] offset:128
  v_pk_mul_f32 v[152:153], v[40:41], v[28:29] op_sel:[0,1] op_sel_hi:[1,1]
  v_pk_mul_f32 v[154:155], v[42:43], v[28:29] op_sel:[0,1] op_sel_hi:[1,1]
  v_pk_mul_f32 v[156:157], v[44:45], v[28:29] op_sel:[0,1] op_sel_hi:[1,1]
  v_pk_mul_f32 v[158:159], v[46:47], v[28:29] op_sel:[0,1] op_sel_hi:[1,1]
  v_pk_fma_f32 v[200:201], v[200:201], v[28:29], v[152:153] op_sel_hi:[1,0,1]
  v_pk_fma_f32 v[202:203], v[202:203], v[28:29], v[154:155] op_sel_hi:[1,0,1]
  v_pk_fma_f32 v[216:217], v[216:217], v[28:29], v[156:157] op_sel_hi:[1,0,1]
  v_pk_fma_f32 v[218:219], v[218:219], v[28:29], v[158:159] op_sel_hi:[1,0,1]
  v_cvt_pk_bf16_f32 v200, v200, v201
  v_cvt_pk_bf16_f32 v201, v202, v203
  v_cvt_pk_bf16_f32 v202, v216, v217
  v_cvt_pk_bf16_f32 v203, v218, v219
  ds_write_b128 v59, v[200:203] offset:4096
  v_pk_mul_f32 v[152:153], v[40:41], v[30:31] op_sel:[0,1] op_sel_hi:[1,1]
  v_pk_mul_f32 v[154:155], v[42:43], v[30:31] op_sel:[0,1] op_sel_hi:[1,1]
  v_pk_mul_f32 v[156:157], v[44:45], v[30:31] op_sel:[0,1] op_sel_hi:[1,1]
  v_pk_mul_f32 v[158:159], v[46:47], v[30:31] op_sel:[0,1] op_sel_hi:[1,1]
  v_pk_fma_f32 v[204:205], v[204:205], v[30:31], v[152:153] op_sel_hi:[1,0,1]
  v_pk_fma_f32 v[206:207], v[206:207], v[30:31], v[154:155] op_sel_hi:[1,0,1]
  v_pk_fma_f32 v[220:221], v[220:221], v[30:31], v[156:157] op_sel_hi:[1,0,1]
  v_pk_fma_f32 v[222:223], v[222:223], v[30:31], v[158:159] op_sel_hi:[1,0,1]
  v_cvt_pk_bf16_f32 v204, v204, v205
  v_cvt_pk_bf16_f32 v205, v206, v207
  v_cvt_pk_bf16_f32 v206, v220, v221
  v_cvt_pk_bf16_f32 v207, v222, v223
  ds_write_b128 v59, v[204:207] offset:4224
  v_pk_mul_f32 v[152:153], v[80:81], v[48:49] op_sel:[0,0] op_sel_hi:[1,0]
  v_pk_mul_f32 v[154:155], v[82:83], v[48:49] op_sel:[0,0] op_sel_hi:[1,0]
  v_pk_mul_f32 v[156:157], v[84:85], v[48:49] op_sel:[0,0] op_sel_hi:[1,0]
  v_pk_mul_f32 v[158:159], v[86:87], v[48:49] op_sel:[0,0] op_sel_hi:[1,0]
  v_pk_fma_f32 v[224:225], v[224:225], v[64:65], v[152:153]
  v_pk_fma_f32 v[226:227], v[226:227], v[66:67], v[154:155]
  v_pk_fma_f32 v[228:229], v[228:229], v[68:69], v[156:157]
  v_pk_fma_f32 v[230:231], v[230:231], v[70:71], v[158:159]
  v_cvt_pk_bf16_f32 v224, v224, v225
  v_cvt_pk_bf16_f32 v225, v226, v227
  v_cvt_pk_bf16_f32 v226, v228, v229
  v_cvt_pk_bf16_f32 v227, v230, v231
  ds_write_b128 v60, v[224:227] offset:2048
  v_pk_mul_f32 v[152:153], v[80:81], v[48:49] op_sel:[0,1] op_sel_hi:[1,1]
  v_pk_mul_f32 v[154:155], v[82:83], v[48:49] op_sel:[0,1] op_sel_hi:[1,1]
  v_pk_mul_f32 v[156:157], v[84:85], v[48:49] op_sel:[0,1] op_sel_hi:[1,1]
  v_pk_mul_f32 v[158:159], v[86:87], v[48:49] op_sel:[0,1] op_sel_hi:[1,1]
  v_pk_fma_f32 v[240:241], v[240:241], v[64:65], v[152:153]
  v_pk_fma_f32 v[242:243], v[242:243], v[66:67], v[154:155]
  v_pk_fma_f32 v[244:245], v[244:245], v[68:69], v[156:157]
  v_pk_fma_f32 v[246:247], v[246:247], v[70:71], v[158:159]
  v_cvt_pk_bf16_f32 v240, v240, v241
  v_cvt_pk_bf16_f32 v241, v242, v243
  v_cvt_pk_bf16_f32 v242, v244, v245
  v_cvt_pk_bf16_f32 v243, v246, v247
  ds_write_b128 v60, v[240:243] offset:2304
  v_pk_mul_f32 v[152:153], v[88:89], v[48:49] op_sel:[0,0] op_sel_hi:[1,0]
  v_pk_mul_f32 v[154:155], v[90:91], v[48:49] op_sel:[0,0] op_sel_hi:[1,0]
  v_pk_mul_f32 v[156:157], v[92:93], v[48:49] op_sel:[0,0] op_sel_hi:[1,0]
  v_pk_mul_f32 v[158:159], v[94:95], v[48:49] op_sel:[0,0] op_sel_hi:[1,0]
  v_pk_fma_f32 v[232:233], v[232:233], v[72:73], v[152:153]
  v_pk_fma_f32 v[234:235], v[234:235], v[74:75], v[154:155]
  v_pk_fma_f32 v[236:237], v[236:237], v[76:77], v[156:157]
  v_pk_fma_f32 v[238:239], v[238:239], v[78:79], v[158:159]
  v_cvt_pk_bf16_f32 v232, v232, v233
  v_cvt_pk_bf16_f32 v233, v234, v235
  v_cvt_pk_bf16_f32 v234, v236, v237
  v_cvt_pk_bf16_f32 v235, v238, v239
  ds_write_b128 v60, v[232:235] offset:6144
  v_pk_mul_f32 v[152:153], v[88:89], v[48:49] op_sel:[0,1] op_sel_hi:[1,1]
  v_pk_mul_f32 v[154:155], v[90:91], v[48:49] op_sel:[0,1] op_sel_hi:[1,1]
  v_pk_mul_f32 v[156:157], v[92:93], v[48:49] op_sel:[0,1] op_sel_hi:[1,1]
  v_pk_mul_f32 v[158:159], v[94:95], v[48:49] op_sel:[0,1] op_sel_hi:[1,1]
  v_pk_fma_f32 v[248:249], v[248:249], v[72:73], v[152:153]
  v_pk_fma_f32 v[250:251], v[250:251], v[74:75], v[154:155]
  v_pk_fma_f32 v[252:253], v[252:253], v[76:77], v[156:157]
  v_pk_fma_f32 v[254:255], v[254:255], v[78:79], v[158:159]
  v_cvt_pk_bf16_f32 v248, v248, v249
  v_cvt_pk_bf16_f32 v249, v250, v251
  v_cvt_pk_bf16_f32 v250, v252, v253
  v_cvt_pk_bf16_f32 v251, v254, v255
  ds_write_b128 v60, v[248:251] offset:6400
  v_pk_mul_f32 v[24:25], v[24:25], v[56:57] op_sel_hi:[1,0]
  v_pk_mul_f32 v[26:27], v[26:27], v[56:57] op_sel_hi:[1,0]
  v_pk_mul_f32 v[28:29], v[28:29], v[56:57] op_sel_hi:[1,0]
  v_pk_mul_f32 v[30:31], v[30:31], v[56:57] op_sel_hi:[1,0]
  v_pk_mul_f32 v[152:153], v[32:33], v[24:25] op_sel:[0,1] op_sel_hi:[1,1]
  v_pk_mul_f32 v[154:155], v[34:35], v[24:25] op_sel:[0,1] op_sel_hi:[1,1]
  v_pk_mul_f32 v[156:157], v[36:37], v[24:25] op_sel:[0,1] op_sel_hi:[1,1]
  v_pk_mul_f32 v[158:159], v[38:39], v[24:25] op_sel:[0,1] op_sel_hi:[1,1]
  v_pk_fma_f32 v[160:161], v[160:161], v[24:25], v[152:153] op_sel_hi:[1,0,1]
  v_pk_fma_f32 v[162:163], v[162:163], v[24:25], v[154:155] op_sel_hi:[1,0,1]
  v_pk_fma_f32 v[176:177], v[176:177], v[24:25], v[156:157] op_sel_hi:[1,0,1]
  v_pk_fma_f32 v[178:179], v[178:179], v[24:25], v[158:159] op_sel_hi:[1,0,1]
  v_cvt_pk_bf16_f32 v160, v160, v161
  v_cvt_pk_bf16_f32 v161, v162, v163
  v_cvt_pk_bf16_f32 v162, v176, v177
  v_cvt_pk_bf16_f32 v163, v178, v179
  ds_write_b128 v61, v[160:163] offset:0
  v_pk_mul_f32 v[152:153], v[32:33], v[26:27] op_sel:[0,1] op_sel_hi:[1,1]
  v_pk_mul_f32 v[154:155], v[34:35], v[26:27] op_sel:[0,1] op_sel_hi:[1,1]
  v_pk_mul_f32 v[156:157], v[36:37], v[26:27] op_sel:[0,1] op_sel_hi:[1,1]
  v_pk_mul_f32 v[158:159], v[38:39], v[26:27] op_sel:[0,1] op_sel_hi:[1,1]
  v_pk_fma_f32 v[164:165], v[164:165], v[26:27], v[152:153] op_sel_hi:[1,0,1]
  v_pk_fma_f32 v[166:167], v[166:167], v[26:27], v[154:155] op_sel_hi:[1,0,1]
  v_pk_fma_f32 v[180:181], v[180:181], v[26:27], v[156:157] op_sel_hi:[1,0,1]
  v_pk_fma_f32 v[182:183], v[182:183], v[26:27], v[158:159] op_sel_hi:[1,0,1]
  v_cvt_pk_bf16_f32 v164, v164, v165
  v_cvt_pk_bf16_f32 v165, v166, v167
  v_cvt_pk_bf16_f32 v166, v180, v181
  v_cvt_pk_bf16_f32 v167, v182, v183
  ds_write_b128 v61, v[164:167] offset:256
  v_pk_mul_f32 v[152:153], v[32:33], v[28:29] op_sel:[0,1] op_sel_hi:[1,1]
  v_pk_mul_f32 v[154:155], v[34:35], v[28:29] op_sel:[0,1] op_sel_hi:[1,1]
  v_pk_mul_f32 v[156:157], v[36:37], v[28:29] op_sel:[0,1] op_sel_hi:[1,1]
  v_pk_mul_f32 v[158:159], v[38:39], v[28:29] op_sel:[0,1] op_sel_hi:[1,1]
  v_pk_fma_f32 v[168:169], v[168:169], v[28:29], v[152:153] op_sel_hi:[1,0,1]
  v_pk_fma_f32 v[170:171], v[170:171], v[28:29], v[154:155] op_sel_hi:[1,0,1]
  v_pk_fma_f32 v[184:185], v[184:185], v[28:29], v[156:157] op_sel_hi:[1,0,1]
  v_pk_fma_f32 v[186:187], v[186:187], v[28:29], v[158:159] op_sel_hi:[1,0,1]
  v_cvt_pk_bf16_f32 v168, v168, v169
  v_cvt_pk_bf16_f32 v169, v170, v171
  v_cvt_pk_bf16_f32 v170, v184, v185
  v_cvt_pk_bf16_f32 v171, v186, v187
  ds_write_b128 v61, v[168:171] offset:2048
  v_pk_mul_f32 v[152:153], v[32:33], v[30:31] op_sel:[0,1] op_sel_hi:[1,1]
  v_pk_mul_f32 v[154:155], v[34:35], v[30:31] op_sel:[0,1] op_sel_hi:[1,1]
  v_pk_mul_f32 v[156:157], v[36:37], v[30:31] op_sel:[0,1] op_sel_hi:[1,1]
  v_pk_mul_f32 v[158:159], v[38:39], v[30:31] op_sel:[0,1] op_sel_hi:[1,1]
  v_pk_fma_f32 v[172:173], v[172:173], v[30:31], v[152:153] op_sel_hi:[1,0,1]
  v_pk_fma_f32 v[174:175], v[174:175], v[30:31], v[154:155] op_sel_hi:[1,0,1]
  v_pk_fma_f32 v[188:189], v[188:189], v[30:31], v[156:157] op_sel_hi:[1,0,1]
  v_pk_fma_f32 v[190:191], v[190:191], v[30:31], v[158:159] op_sel_hi:[1,0,1]
  v_cvt_pk_bf16_f32 v172, v172, v173
  v_cvt_pk_bf16_f32 v173, v174, v175
  v_cvt_pk_bf16_f32 v174, v188, v189
  v_cvt_pk_bf16_f32 v175, v190, v191
  ds_write_b128 v61, v[172:175] offset:2304
  s_add_u32 s37, s37, 32
  s_and_b32 s35, s35, 0x1ff
  s_cmp_lg_u32 s35, 0
  s_cselect_b32 s28, 0x100, 0
  s_or_b32 s35, s35, s28
  s_branch .g2_kernel_q_kd
.g2_kernel_r2:
  buffer_load_dwordx4 v[240:243], v22, s[4:7], s13 offen offset:0
  buffer_load_dwordx4 v[244:247], v22, s[4:7], s13 offen offset:512
  buffer_load_dwordx4 v[248:251], v22, s[4:7], s13 offen offset:1024
  buffer_load_dwordx4 v[252:255], v22, s[4:7], s13 offen offset:1536
  s_branch .g2_kernel_r3
.g2_kernel_a_t1c:
  s_call_b64 s[68:69], .g2_kernel_a_pick
  s_branch .g2_kernel_a_t1b
.g2_kernel_a_t2c:
  s_call_b64 s[68:69], .g2_kernel_a_pick
  s_branch .g2_kernel_a_t2b
.g2_kernel_a_t3c:
  s_call_b64 s[68:69], .g2_kernel_a_pick
  s_branch .g2_kernel_a_t3b
.g2_kernel_a_three:
  s_andn2_b32 s33, s36, s34
  s_cbranch_scc0 .g2_kernel_a_t1c
.g2_kernel_a_t1b:
  s_ff1_i32_b32 s33, s33
  s_bitset1_b32 s34, s33
  s_xor_b32 s33, s33, s24
  s_lshl_b32 s33, s33, s25
  s_add_u32 s22, s20, s33
  s_addc_u32 s23, s21, 0
  global_load_dwordx4 v[192:195], v3, s[22:23] offset:0
  global_load_dwordx4 v[196:199], v3, s[22:23] offset:1024
  global_load_dwordx4 v[200:203], v3, s[22:23] offset:2048
  global_load_dwordx4 v[204:207], v3, s[22:23] offset:3072
  s_andn2_b32 s33, s36, s34
  s_cbranch_scc0 .g2_kernel_a_t2c
.g2_kernel_a_t2b:
  s_ff1_i32_b32 s33, s33
  s_bitset1_b32 s34, s33
  s_xor_b32 s33, s33, s24
  s_lshl_b32 s33, s33, s25
  s_add_u32 s22, s20, s33
  s_addc_u32 s23, s21, 0
  global_load_dwordx4 v[208:211], v3, s[22:23] offset:0
  global_load_dwordx4 v[212:215], v3, s[22:23] offset:1024
  global_load_dwordx4 v[216:219], v3, s[22:23] offset:2048
  global_load_dwordx4 v[220:223], v3, s[22:23] offset:3072
  s_andn2_b32 s33, s36, s34
  s_cbranch_scc0 .g2_kernel_a_t3c
.g2_kernel_a_t3b:
  s_ff1_i32_b32 s33, s33
  s_bitset1_b32 s34, s33
  s_xor_b32 s33, s33, s24
  s_lshl_b32 s33, s33, s25
  s_add_u32 s22, s20, s33
  s_addc_u32 s23, s21, 0
  global_load_dwordx4 v[224:227], v3, s[22:23] offset:0
  global_load_dwordx4 v[228:231], v3, s[22:23] offset:1024
  global_load_dwordx4 v[232:235], v3, s[22:23] offset:2048
  global_load_dwordx4 v[236:239], v3, s[22:23] offset:3072
  s_setpc_b64 s[72:73]
.g2_kernel_a_o0c:
  s_call_b64 s[68:69], .g2_kernel_a_pick
  s_branch .g2_kernel_a_o0b
.g2_kernel_a_o1c:
  s_call_b64 s[68:69], .g2_kernel_a_pick
  s_branch .g2_kernel_a_o1b
.g2_kernel_a_o2c:
  s_call_b64 s[68:69], .g2_kernel_a_pick
  s_branch .g2_kernel_a_o2b
.g2_kernel_a_o3c:
  s_call_b64 s[68:69], .g2_kernel_a_pick
  s_branch .g2_kernel_a_o3b
.g2_kernel_a_r0c:
  s_call_b64 s[68:69], .g2_kernel_a_pick
  s_branch .g2_kernel_a_r0b
.g2_kernel_a_r1c:
  s_call_b64 s[68:69], .g2_kernel_a_pick
  s_branch .g2_kernel_a_r1b
.g2_kernel_a_r2c:
  s_call_b64 s[68:69], .g2_kernel_a_pick
  s_branch .g2_kernel_a_r2b
.g2_kernel_a_own:
  s_waitcnt vmcnt(0) lgkmcnt(0)
  s_mov_b64 exec, 1
  s_cmp_ge_u32 s35, 0x200
  s_cbranch_scc1 .g2_kernel_a_ow1
  buffer_store_dword v15, v4, s[4:7], s37 offen sc1
  s_branch .g2_kernel_a_ow2
.g2_kernel_a_ow1:
  ds_add_u32 v13, v5 offset:56
.g2_kernel_a_ow2:
  s_mov_b64 exec, -1
  s_add_u32 s37, s37, 64
  s_mov_b32 s14, 0
  s_andn2_b32 s33, s36, s34
  s_cbranch_scc0 .g2_kernel_a_o0c
.g2_kernel_a_o0b:
  s_ff1_i32_b32 s33, s33
  s_bitset1_b32 s34, s33
  s_lshl_b32 s28, s33, 0
  s_or_b32 s14, s14, s28
  s_xor_b32 s33, s33, s24
  s_lshl_b32 s33, s33, s25
  s_add_u32 s22, s20, s33
  s_addc_u32 s23, s21, 0
  global_load_dwordx4 v[176:179], v3, s[22:23] offset:0
  global_load_dwordx4 v[180:183], v3, s[22:23] offset:1024
  global_load_dwordx4 v[184:187], v3, s[22:23] offset:2048
  global_load_dwordx4 v[188:191], v3, s[22:23] offset:3072
  s_andn2_b32 s33, s36, s34
  s_cbranch_scc0 .g2_kernel_a_o1c
.g2_kernel_a_o1b:
  s_ff1_i32_b32 s33, s33
  s_bitset1_b32 s34, s33
  s_lshl_b32 s28, s33, 8
  s_or_b32 s14, s14, s28
  s_xor_b32 s33, s33, s24
  s_lshl_b32 s33, s33, s25
  s_add_u32 s22, s20, s33
  s_addc_u32 s23, s21, 0
  global_load_dwordx4 v[192:195], v3, s[22:23] offset:0
  global_load_dwordx4 v[196:199], v3, s[22:23] offset:1024
  global_load_dwordx4 v[200:203], v3, s[22:23] offset:2048
  global_load_dwordx4 v[204:207], v3, s[22:23] offset:3072
  s_andn2_b32 s33, s36, s34
  s_cbranch_scc0 .g2_kernel_a_o2c
.g2_kernel_a_o2b:
  s_ff1_i32_b32 s33, s33
  s_bitset1_b32 s34, s33
  s_lshl_b32 s28, s33, 16
  s_or_b32 s14, s14, s28
  s_xor_b32 s33, s33, s24
  s_lshl_b32 s33, s33, s25
  s_add_u32 s22, s20, s33
  s_addc_u32 s23, s21, 0
  global_load_dwordx4 v[208:211], v3, s[22:23] offset:0
  global_load_dwordx4 v[212:215], v3, s[22:23] offset:1024
  global_load_dwordx4 v[216:219], v3, s[22:23] offset:2048
  global_load_dwordx4 v[220:223], v3, s[22:23] offset:3072
  s_andn2_b32 s33, s36, s34
  s_cbranch_scc0 .g2_kernel_a_o3c
.g2_kernel_a_o3b:
  s_ff1_i32_b32 s33, s33
  s_bitset1_b32 s34, s33
  s_lshl_b32 s28, s33, 24
  s_or_b32 s14, s14, s28
  s_xor_b32 s33, s33, s24
  s_lshl_b32 s33, s33, s25
  s_add_u32 s22, s20, s33
  s_addc_u32 s23, s21, 0
  global_load_dwordx4 v[224:227], v3, s[22:23] offset:0
  global_load_dwordx4 v[228:231], v3, s[22:23] offset:1024
  global_load_dwordx4 v[232:235], v3, s[22:23] offset:2048
  global_load_dwordx4 v[236:239], v3, s[22:23] offset:3072
  s_and_b32 s15, s34, -2
  s_mov_b32 s34, -1
  s_mov_b32 s26, -1
  s_waitcnt vmcnt(12)
  s_branch .g2_kernel_a_ob
.g2_kernel_a_redo:
  v_mfma_f32_32x32x16_bf16 v[104:119], v[236:239], v[172:175], v[104:119]
  v_smfmac_f32_16x16x64_bf16 v[132:135], v[16:19], v[168:175], v20
  v_mov_b32 v6, s71
  s_mov_b32 s38, 0
.g2_kernel_wg3:
  ds_read_b32 v7, v6 offset:60
  s_add_u32 s38, s38, 1
  s_waitcnt lgkmcnt(0)
  v_cmp_le_u32 vcc, 1, v7
  s_cbranch_vccnz .g2_kernel_wg3d
  s_sleep 1
  s_cmp_lt_u32 s38, 524288
  s_cbranch_scc1 .g2_kernel_wg3
.g2_kernel_wg3d:
  ds_read_b32 v7, v8
  s_mov_b32 s34, s15
  s_mov_b32 s26, 0
  s_waitcnt lgkmcnt(0)
  v_cmp_lt_u32 vcc, s62, v7
  s_mov_b32 s36, vcc_lo
  s_sub_u32 s28, s35, 1
  s_bfe_u32 s28, s28, 0x20005
  s_mov_b32 s35, 0
  s_waitcnt vmcnt(0)
  s_cmp_lg_u32 s28, 0
  s_cbranch_scc1 .g2_kernel_a_rd1
  ds_read_b128 v[24:27], v14 offset:8192
  ds_read_b128 v[28:31], v14 offset:9216
  v_mov_b32 v120, 0
  v_mov_b32 v121, 0
  s_waitcnt lgkmcnt(0)
  v_mfma_f32_32x32x16_bf16 v[136:151], v[176:179], v[24:27], 0
  v_mfma_f32_32x32x16_bf16 v[136:151], v[180:183], v[28:31], v[136:151]
  v_mfma_f32_32x32x16_bf16 v[152:167], v[192:195], v[24:27], 0
  s_nop 10
  v_exp_f32 v136, v136
  v_exp_f32 v137, v137
  v_exp_f32 v138, v138
  v_exp_f32 v139, v139
  v_exp_f32 v140, v140
  v_exp_f32 v141, v141
  v_exp_f32 v142, v142
  v_exp_f32 v143, v143
  v_mfma_f32_32x32x16_bf16 v[152:167], v[196:199], v[28:31], v[152:167]
  v_cvt_pk_bf16_f32 v168, v136, v137
  v_cvt_pk_bf16_f32 v169, v138, v139
  v_cvt_pk_bf16_f32 v170, v140, v141
  v_cvt_pk_bf16_f32 v171, v142, v143
  v_exp_f32 v144, v144
  v_exp_f32 v145, v145
  v_exp_f32 v146, v146
  v_exp_f32 v147, v147
  v_mfma_f32_32x32x16_bf16 v[56:71], v[184:187], v[168:171], 0
  v_exp_f32 v148, v148
  v_exp_f32 v149, v149
  v_exp_f32 v150, v150
  v_exp_f32 v151, v151
  v_cvt_pk_bf16_f32 v172, v144, v145
  v_cvt_pk_bf16_f32 v173, v146, v147
  v_cvt_pk_bf16_f32 v174, v148, v149
  v_cvt_pk_bf16_f32 v175, v150, v151
  v_mfma_f32_32x32x16_bf16 v[136:151], v[208:211], v[24:27], 0
  v_exp_f32 v152, v152
  v_exp_f32 v153, v153
  v_exp_f32 v154, v154
  v_mfma_f32_32x32x16_bf16 v[56:71], v[188:191], v[172:175], v[56:71]
  s_call_b64 s[72:73], .g2_kernel_a_ld0
  v_exp_f32 v155, v155
  v_exp_f32 v156, v156
  v_exp_f32 v157, v157
  v_smfmac_f32_16x16x64_bf16 v[120:123], v[16:19], v[168:175], v20
  v_exp_f32 v158, v158
  v_exp_f32 v159, v159
  v_mfma_f32_32x32x16_bf16 v[136:151], v[212:215], v[28:31], v[136:151]
  v_cvt_pk_bf16_f32 v168, v152, v153
  v_cvt_pk_bf16_f32 v169, v154, v155
  v_cvt_pk_bf16_f32 v170, v156, v157
  v_cvt_pk_bf16_f32 v171, v158, v159
  v_exp_f32 v160, v160
  v_exp_f32 v161, v161
  v_exp_f32 v162, v162
  v_exp_f32 v163, v163
  v_mfma_f32_32x32x16_bf16 v[56:71], v[200:203], v[168:171], v[56:71]
  v_exp_f32 v164, v164
  v_exp_f32 v165, v165
  v_exp_f32 v166, v166
  v_exp_f32 v167, v167
  v_cvt_pk_bf16_f32 v172, v160, v161
  v_cvt_pk_bf16_f32 v173, v162, v163
  v_cvt_pk_bf16_f32 v174, v164, v165
  v_cvt_pk_bf16_f32 v175, v166, v167
  v_mfma_f32_32x32x16_bf16 v[152:167], v[224:227], v[24:27], 0
  v_exp_f32 v136, v136
  v_exp_f32 v137, v137
  v_exp_f32 v138, v138
  v_mfma_f32_32x32x16_bf16 v[56:71], v[204:207], v[172:175], v[56:71]
  s_call_b64 s[72:73], .g2_kernel_a_ld1
  v_exp_f32 v139, v139
  v_exp_f32 v140, v140
  v_exp_f32 v141, v141
  v_smfmac_f32_16x16x64_bf16 v[120:123], v[16:19], v[168:175], v20
  v_exp_f32 v142, v142
  v_exp_f32 v143, v143
  v_mfma_f32_32x32x16_bf16 v[152:167], v[228:231], v[28:31], v[152:167]
  v_cvt_pk_bf16_f32 v168, v136, v137
  v_cvt_pk_bf16_f32 v169, v138, v139
  v_cvt_pk_bf16_f32 v170, v140, v141
  v_cvt_pk_bf16_f32 v171, v142, v143
  v_exp_f32 v144, v144
  v_exp_f32 v145, v145
  v_exp_f32 v146, v146
  v_exp_f32 v147, v147
  v_mfma_f32_32x32x16_bf16 v[56:71], v[216:219], v[168:171], v[56:71]
  v_exp_f32 v148, v148
  v_exp_f32 v149, v149
  v_exp_f32 v150, v150
  v_exp_f32 v151, v151
  v_cvt_pk_bf16_f32 v172, v144, v145
  v_cvt_pk_bf16_f32 v173, v146, v147
  v_cvt_pk_bf16_f32 v174, v148, v149
  v_cvt_pk_bf16_f32 v175, v150, v151
  v_exp_f32 v152, v152
  v_exp_f32 v153, v153
  v_exp_f32 v154, v154
  v_mfma_f32_32x32x16_bf16 v[56:71], v[220:223], v[172:175], v[56:71]
  s_call_b64 s[72:73], .g2_kernel_a_ld2
  v_exp_f32 v155, v155
  v_exp_f32 v156, v156
  v_exp_f32 v157, v157
  v_smfmac_f32_16x16x64_bf16 v[120:123], v[16:19], v[168:175], v20
  v_exp_f32 v158, v158
  v_exp_f32 v159, v159
  v_cvt_pk_bf16_f32 v168, v152, v153
  v_cvt_pk_bf16_f32 v169, v154, v155
  v_cvt_pk_bf16_f32 v170, v156, v157
  v_cvt_pk_bf16_f32 v171, v158, v159
  v_exp_f32 v160, v160
  v_exp_f32 v161, v161
  v_exp_f32 v162, v162
  v_exp_f32 v163, v163
  v_mfma_f32_32x32x16_bf16 v[56:71], v[232:235], v[168:171], v[56:71]
  v_exp_f32 v164, v164
  v_exp_f32 v165, v165
  v_exp_f32 v166, v166
  v_exp_f32 v167, v167
  v_cvt_pk_bf16_f32 v172, v160, v161
  v_cvt_pk_bf16_f32 v173, v162, v163
  v_cvt_pk_bf16_f32 v174, v164, v165
  v_cvt_pk_bf16_f32 v175, v166, v167
  s_nop 1
  v_mfma_f32_32x32x16_bf16 v[56:71], v[236:239], v[172:175], v[56:71]
  v_smfmac_f32_16x16x64_bf16 v[120:123], v[16:19], v[168:175], v20
  s_branch .g2_kernel_a_rde
.g2_kernel_a_rd1:
  s_cmp_lg_u32 s28, 1
  s_cbranch_scc1 .g2_kernel_a_rd2
  ds_read_b128 v[32:35], v14 offset:10240
  ds_read_b128 v[36:39], v14 offset:11264
  v_mov_b32 v124, 0
  v_mov_b32 v125, 0
  s_waitcnt lgkmcnt(0)
  v_mfma_f32_32x32x16_bf16 v[136:151], v[176:179], v[32:35], 0
  v_mfma_f32_32x32x16_bf16 v[136:151], v[180:183], v[36:39], v[136:151]
  v_mfma_f32_32x32x16_bf16 v[152:167], v[192:195], v[32:35], 0
  s_nop 10
  v_exp_f32 v136, v136
  v_exp_f32 v137, v137
  v_exp_f32 v138, v138
  v_exp_f32 v139, v139
  v_exp_f32 v140, v140
  v_exp_f32 v141, v141
  v_exp_f32 v142, v142
  v_exp_f32 v143, v143
  v_mfma_f32_32x32x16_bf16 v[152:167], v[196:199], v[36:39], v[152:167]
  v_cvt_pk_bf16_f32 v168, v136, v137
  v_cvt_pk_bf16_f32 v169, v138, v139
  v_cvt_pk_bf16_f32 v170, v140, v141
  v_cvt_pk_bf16_f32 v171, v142, v143
  v_exp_f32 v144, v144
  v_exp_f32 v145, v145
  v_exp_f32 v146, v146
  v_exp_f32 v147, v147
  v_mfma_f32_32x32x16_bf16 v[72:87], v[184:187], v[168:171], 0
  v_exp_f32 v148, v148
  v_exp_f32 v149, v149
  v_exp_f32 v150, v150
  v_exp_f32 v151, v151
  v_cvt_pk_bf16_f32 v172, v144, v145
  v_cvt_pk_bf16_f32 v173, v146, v147
  v_cvt_pk_bf16_f32 v174, v148, v149
  v_cvt_pk_bf16_f32 v175, v150, v151
  v_mfma_f32_32x32x16_bf16 v[136:151], v[208:211], v[32:35], 0
  v_exp_f32 v152, v152
  v_exp_f32 v153, v153
  v_exp_f32 v154, v154
  v_mfma_f32_32x32x16_bf16 v[72:87], v[188:191], v[172:175], v[72:87]
  s_call_b64 s[72:73], .g2_kernel_a_ld0
  v_exp_f32 v155, v155
  v_exp_f32 v156, v156
  v_exp_f32 v157, v157
  v_smfmac_f32_16x16x64_bf16 v[124:127], v[16:19], v[168:175], v20
  v_exp_f32 v158, v158
  v_exp_f32 v159, v159
  v_mfma_f32_32x32x16_bf16 v[136:151], v[212:215], v[36:39], v[136:151]
  v_cvt_pk_bf16_f32 v168, v152, v153
  v_cvt_pk_bf16_f32 v169, v154, v155
  v_cvt_pk_bf16_f32 v170, v156, v157
  v_cvt_pk_bf16_f32 v171, v158, v159
  v_exp_f32 v160, v160
  v_exp_f32 v161, v161
  v_exp_f32 v162, v162
  v_exp_f32 v163, v163
  v_mfma_f32_32x32x16_bf16 v[72:87], v[200:203], v[168:171], v[72:87]
  v_exp_f32 v164, v164
  v_exp_f32 v165, v165
  v_exp_f32 v166, v166
  v_exp_f32 v167, v167
  v_cvt_pk_bf16_f32 v172, v160, v161
  v_cvt_pk_bf16_f32 v173, v162, v163
  v_cvt_pk_bf16_f32 v174, v164, v165
  v_cvt_pk_bf16_f32 v175, v166, v167
  v_mfma_f32_32x32x16_bf16 v[152:167], v[224:227], v[32:35], 0
  v_exp_f32 v136, v136
  v_exp_f32 v137, v137
  v_exp_f32 v138, v138
  v_mfma_f32_32x32x16_bf16 v[72:87], v[204:207], v[172:175], v[72:87]
  s_call_b64 s[72:73], .g2_kernel_a_ld1
  v_exp_f32 v139, v139
  v_exp_f32 v140, v140
  v_exp_f32 v141, v141
  v_smfmac_f32_16x16x64_bf16 v[124:127], v[16:19], v[168:175], v20
  v_exp_f32 v142, v142
  v_exp_f32 v143, v143
  v_mfma_f32_32x32x16_bf16 v[152:167], v[228:231], v[36:39], v[152:167]
  v_cvt_pk_bf16_f32 v168, v136, v137
  v_cvt_pk_bf16_f32 v169, v138, v139
  v_cvt_pk_bf16_f32 v170, v140, v141
  v_cvt_pk_bf16_f32 v171, v142, v143
  v_exp_f32 v144, v144
  v_exp_f32 v145, v145
  v_exp_f32 v146, v146
  v_exp_f32 v147, v147
  v_mfma_f32_32x32x16_bf16 v[72:87], v[216:219], v[168:171], v[72:87]
  v_exp_f32 v148, v148
  v_exp_f32 v149, v149
  v_exp_f32 v150, v150
  v_exp_f32 v151, v151
  v_cvt_pk_bf16_f32 v172, v144, v145
  v_cvt_pk_bf16_f32 v173, v146, v147
  v_cvt_pk_bf16_f32 v174, v148, v149
  v_cvt_pk_bf16_f32 v175, v150, v151
  v_exp_f32 v152, v152
  v_exp_f32 v153, v153
  v_exp_f32 v154, v154
  v_mfma_f32_32x32x16_bf16 v[72:87], v[220:223], v[172:175], v[72:87]
  s_call_b64 s[72:73], .g2_kernel_a_ld2
  v_exp_f32 v155, v155
  v_exp_f32 v156, v156
  v_exp_f32 v157, v157
  v_smfmac_f32_16x16x64_bf16 v[124:127], v[16:19], v[168:175], v20
  v_exp_f32 v158, v158
  v_exp_f32 v159, v159
  v_cvt_pk_bf16_f32 v168, v152, v153
  v_cvt_pk_bf16_f32 v169, v154, v155
  v_cvt_pk_bf16_f32 v170, v156, v157
  v_cvt_pk_bf16_f32 v171, v158, v159
  v_exp_f32 v160, v160
  v_exp_f32 v161, v161
  v_exp_f32 v162, v162
  v_exp_f32 v163, v163
  v_mfma_f32_32x32x16_bf16 v[72:87], v[232:235], v[168:171], v[72:87]
  v_exp_f32 v164, v164
  v_exp_f32 v165, v165
  v_exp_f32 v166, v166
  v_exp_f32 v167, v167
  v_cvt_pk_bf16_f32 v172, v160, v161
  v_cvt_pk_bf16_f32 v173, v162, v163
  v_cvt_pk_bf16_f32 v174, v164, v165
  v_cvt_pk_bf16_f32 v175, v166, v167
  s_nop 1
  v_mfma_f32_32x32x16_bf16 v[72:87], v[236:239], v[172:175], v[72:87]
  v_smfmac_f32_16x16x64_bf16 v[124:127], v[16:19], v[168:175], v20
  s_branch .g2_kernel_a_rde
.g2_kernel_a_rd2:
  s_cmp_lg_u32 s28, 2
  s_cbranch_scc1 .g2_kernel_a_rd3
  ds_read_b128 v[40:43], v14 offset:12288
  ds_read_b128 v[44:47], v14 offset:13312
  v_mov_b32 v128, 0
  v_mov_b32 v129, 0
  s_waitcnt lgkmcnt(0)
  v_mfma_f32_32x32x16_bf16 v[136:151], v[176:179], v[40:43], 0
  v_mfma_f32_32x32x16_bf16 v[136:151], v[180:183], v[44:47], v[136:151]
  v_mfma_f32_32x32x16_bf16 v[152:167], v[192:195], v[40:43], 0
  s_nop 10
  v_exp_f32 v136, v136
  v_exp_f32 v137, v137
  v_exp_f32 v138, v138
  v_exp_f32 v139, v139
  v_exp_f32 v140, v140
  v_exp_f32 v141, v141
  v_exp_f32 v142, v142
  v_exp_f32 v143, v143
  v_mfma_f32_32x32x16_bf16 v[152:167], v[196:199], v[44:47], v[152:167]
  v_cvt_pk_bf16_f32 v168, v136, v137
  v_cvt_pk_bf16_f32 v169, v138, v139
  v_cvt_pk_bf16_f32 v170, v140, v141
  v_cvt_pk_bf16_f32 v171, v142, v143
  v_exp_f32 v144, v144
  v_exp_f32 v145, v145
  v_exp_f32 v146, v146
  v_exp_f32 v147, v147
  v_mfma_f32_32x32x16_bf16 v[88:103], v[184:187], v[168:171], 0
  v_exp_f32 v148, v148
  v_exp_f32 v149, v149
  v_exp_f32 v150, v150
  v_exp_f32 v151, v151
  v_cvt_pk_bf16_f32 v172, v144, v145
  v_cvt_pk_bf16_f32 v173, v146, v147
  v_cvt_pk_bf16_f32 v174, v148, v149
  v_cvt_pk_bf16_f32 v175, v150, v151
  v_mfma_f32_32x32x16_bf16 v[136:151], v[208:211], v[40:43], 0
  v_exp_f32 v152, v152
  v_exp_f32 v153, v153
  v_exp_f32 v154, v154
  v_mfma_f32_32x32x16_bf16 v[88:103], v[188:191], v[172:175], v[88:103]
  s_call_b64 s[72:73], .g2_kernel_a_ld0
  v_exp_f32 v155, v155
  v_exp_f32 v156, v156
  v_exp_f32 v157, v157
  v_smfmac_f32_16x16x64_bf16 v[128:131], v[16:19], v[168:175], v20
  v_exp_f32 v158, v158
  v_exp_f32 v159, v159
  v_mfma_f32_32x32x16_bf16 v[136:151], v[212:215], v[44:47], v[136:151]
  v_cvt_pk_bf16_f32 v168, v152, v153
  v_cvt_pk_bf16_f32 v169, v154, v155
  v_cvt_pk_bf16_f32 v170, v156, v157
  v_cvt_pk_bf16_f32 v171, v158, v159
  v_exp_f32 v160, v160
  v_exp_f32 v161, v161
  v_exp_f32 v162, v162
  v_exp_f32 v163, v163
  v_mfma_f32_32x32x16_bf16 v[88:103], v[200:203], v[168:171], v[88:103]
  v_exp_f32 v164, v164
  v_exp_f32 v165, v165
  v_exp_f32 v166, v166
  v_exp_f32 v167, v167
  v_cvt_pk_bf16_f32 v172, v160, v161
  v_cvt_pk_bf16_f32 v173, v162, v163
  v_cvt_pk_bf16_f32 v174, v164, v165
  v_cvt_pk_bf16_f32 v175, v166, v167
  v_mfma_f32_32x32x16_bf16 v[152:167], v[224:227], v[40:43], 0
  v_exp_f32 v136, v136
  v_exp_f32 v137, v137
  v_exp_f32 v138, v138
  v_mfma_f32_32x32x16_bf16 v[88:103], v[204:207], v[172:175], v[88:103]
  s_call_b64 s[72:73], .g2_kernel_a_ld1
  v_exp_f32 v139, v139
  v_exp_f32 v140, v140
  v_exp_f32 v141, v141
  v_smfmac_f32_16x16x64_bf16 v[128:131], v[16:19], v[168:175], v20
  v_exp_f32 v142, v142
  v_exp_f32 v143, v143
  v_mfma_f32_32x32x16_bf16 v[152:167], v[228:231], v[44:47], v[152:167]
  v_cvt_pk_bf16_f32 v168, v136, v137
  v_cvt_pk_bf16_f32 v169, v138, v139
  v_cvt_pk_bf16_f32 v170, v140, v141
  v_cvt_pk_bf16_f32 v171, v142, v143
  v_exp_f32 v144, v144
  v_exp_f32 v145, v145
  v_exp_f32 v146, v146
  v_exp_f32 v147, v147
  v_mfma_f32_32x32x16_bf16 v[88:103], v[216:219], v[168:171], v[88:103]
  v_exp_f32 v148, v148
  v_exp_f32 v149, v149
  v_exp_f32 v150, v150
  v_exp_f32 v151, v151
  v_cvt_pk_bf16_f32 v172, v144, v145
  v_cvt_pk_bf16_f32 v173, v146, v147
  v_cvt_pk_bf16_f32 v174, v148, v149
  v_cvt_pk_bf16_f32 v175, v150, v151
  v_exp_f32 v152, v152
  v_exp_f32 v153, v153
  v_exp_f32 v154, v154
  v_mfma_f32_32x32x16_bf16 v[88:103], v[220:223], v[172:175], v[88:103]
  s_call_b64 s[72:73], .g2_kernel_a_ld2
  v_exp_f32 v155, v155
  v_exp_f32 v156, v156
  v_exp_f32 v157, v157
  v_smfmac_f32_16x16x64_bf16 v[128:131], v[16:19], v[168:175], v20
  v_exp_f32 v158, v158
  v_exp_f32 v159, v159
  v_cvt_pk_bf16_f32 v168, v152, v153
  v_cvt_pk_bf16_f32 v169, v154, v155
  v_cvt_pk_bf16_f32 v170, v156, v157
  v_cvt_pk_bf16_f32 v171, v158, v159
  v_exp_f32 v160, v160
  v_exp_f32 v161, v161
  v_exp_f32 v162, v162
  v_exp_f32 v163, v163
  v_mfma_f32_32x32x16_bf16 v[88:103], v[232:235], v[168:171], v[88:103]
  v_exp_f32 v164, v164
  v_exp_f32 v165, v165
  v_exp_f32 v166, v166
  v_exp_f32 v167, v167
  v_cvt_pk_bf16_f32 v172, v160, v161
  v_cvt_pk_bf16_f32 v173, v162, v163
  v_cvt_pk_bf16_f32 v174, v164, v165
  v_cvt_pk_bf16_f32 v175, v166, v167
  s_nop 1
  v_mfma_f32_32x32x16_bf16 v[88:103], v[236:239], v[172:175], v[88:103]
  v_smfmac_f32_16x16x64_bf16 v[128:131], v[16:19], v[168:175], v20
  s_branch .g2_kernel_a_rde
.g2_kernel_a_rd3:
  ds_read_b128 v[48:51], v14 offset:14336
  ds_read_b128 v[52:55], v14 offset:15360
  v_mov_b32 v132, 0
  v_mov_b32 v133, 0
  s_waitcnt lgkmcnt(0)
  v_mfma_f32_32x32x16_bf16 v[136:151], v[176:179], v[48:51], 0
  v_mfma_f32_32x32x16_bf16 v[136:151], v[180:183], v[52:55], v[136:151]
  v_mfma_f32_32x32x16_bf16 v[152:167], v[192:195], v[48:51], 0
  s_nop 10
  v_exp_f32 v136, v136
  v_exp_f32 v137, v137
  v_exp_f32 v138, v138
  v_exp_f32 v139, v139
  v_exp_f32 v140, v140
  v_exp_f32 v141, v141
  v_exp_f32 v142, v142
  v_exp_f32 v143, v143
  v_mfma_f32_32x32x16_bf16 v[152:167], v[196:199], v[52:55], v[152:167]
  v_cvt_pk_bf16_f32 v168, v136, v137
  v_cvt_pk_bf16_f32 v169, v138, v139
  v_cvt_pk_bf16_f32 v170, v140, v141
  v_cvt_pk_bf16_f32 v171, v142, v143
  v_exp_f32 v144, v144
  v_exp_f32 v145, v145
  v_exp_f32 v146, v146
  v_exp_f32 v147, v147
  v_mfma_f32_32x32x16_bf16 v[104:119], v[184:187], v[168:171], 0
  v_exp_f32 v148, v148
  v_exp_f32 v149, v149
  v_exp_f32 v150, v150
  v_exp_f32 v151, v151
  v_cvt_pk_bf16_f32 v172, v144, v145
  v_cvt_pk_bf16_f32 v173, v146, v147
  v_cvt_pk_bf16_f32 v174, v148, v149
  v_cvt_pk_bf16_f32 v175, v150, v151
  v_mfma_f32_32x32x16_bf16 v[136:151], v[208:211], v[48:51], 0
  v_exp_f32 v152, v152
  v_exp_f32 v153, v153
  v_exp_f32 v154, v154
  v_mfma_f32_32x32x16_bf16 v[104:119], v[188:191], v[172:175], v[104:119]
  s_call_b64 s[72:73], .g2_kernel_a_ld0
  v_exp_f32 v155, v155
  v_exp_f32 v156, v156
  v_exp_f32 v157, v157
  v_smfmac_f32_16x16x64_bf16 v[132:135], v[16:19], v[168:175], v20
  v_exp_f32 v158, v158
  v_exp_f32 v159, v159
  v_mfma_f32_32x32x16_bf16 v[136:151], v[212:215], v[52:55], v[136:151]
  v_cvt_pk_bf16_f32 v168, v152, v153
  v_cvt_pk_bf16_f32 v169, v154, v155
  v_cvt_pk_bf16_f32 v170, v156, v157
  v_cvt_pk_bf16_f32 v171, v158, v159
  v_exp_f32 v160, v160
  v_exp_f32 v161, v161
  v_exp_f32 v162, v162
  v_exp_f32 v163, v163
  v_mfma_f32_32x32x16_bf16 v[104:119], v[200:203], v[168:171], v[104:119]
  v_exp_f32 v164, v164
  v_exp_f32 v165, v165
  v_exp_f32 v166, v166
  v_exp_f32 v167, v167
  v_cvt_pk_bf16_f32 v172, v160, v161
  v_cvt_pk_bf16_f32 v173, v162, v163
  v_cvt_pk_bf16_f32 v174, v164, v165
  v_cvt_pk_bf16_f32 v175, v166, v167
  v_mfma_f32_32x32x16_bf16 v[152:167], v[224:227], v[48:51], 0
  v_exp_f32 v136, v136
  v_exp_f32 v137, v137
  v_exp_f32 v138, v138
  v_mfma_f32_32x32x16_bf16 v[104:119], v[204:207], v[172:175], v[104:119]
  s_call_b64 s[72:73], .g2_kernel_a_ld1
  v_exp_f32 v139, v139
  v_exp_f32 v140, v140
  v_exp_f32 v141, v141
  v_smfmac_f32_16x16x64_bf16 v[132:135], v[16:19], v[168:175], v20
  v_exp_f32 v142, v142
  v_exp_f32 v143, v143
  v_mfma_f32_32x32x16_bf16 v[152:167], v[228:231], v[52:55], v[152:167]
  v_cvt_pk_bf16_f32 v168, v136, v137
  v_cvt_pk_bf16_f32 v169, v138, v139
  v_cvt_pk_bf16_f32 v170, v140, v141
  v_cvt_pk_bf16_f32 v171, v142, v143
  v_exp_f32 v144, v144
  v_exp_f32 v145, v145
  v_exp_f32 v146, v146
  v_exp_f32 v147, v147
  v_mfma_f32_32x32x16_bf16 v[104:119], v[216:219], v[168:171], v[104:119]
  v_exp_f32 v148, v148
  v_exp_f32 v149, v149
  v_exp_f32 v150, v150
  v_exp_f32 v151, v151
  v_cvt_pk_bf16_f32 v172, v144, v145
  v_cvt_pk_bf16_f32 v173, v146, v147
  v_cvt_pk_bf16_f32 v174, v148, v149
  v_cvt_pk_bf16_f32 v175, v150, v151
  v_exp_f32 v152, v152
  v_exp_f32 v153, v153
  v_exp_f32 v154, v154
  v_mfma_f32_32x32x16_bf16 v[104:119], v[220:223], v[172:175], v[104:119]
  s_call_b64 s[72:73], .g2_kernel_a_ld2
  v_exp_f32 v155, v155
  v_exp_f32 v156, v156
  v_exp_f32 v157, v157
  v_smfmac_f32_16x16x64_bf16 v[132:135], v[16:19], v[168:175], v20
  v_exp_f32 v158, v158
  v_exp_f32 v159, v159
  v_cvt_pk_bf16_f32 v168, v152, v153
  v_cvt_pk_bf16_f32 v169, v154, v155
  v_cvt_pk_bf16_f32 v170, v156, v157
  v_cvt_pk_bf16_f32 v171, v158, v159
  v_exp_f32 v160, v160
  v_exp_f32 v161, v161
  v_exp_f32 v162, v162
  v_exp_f32 v163, v163
  v_mfma_f32_32x32x16_bf16 v[104:119], v[232:235], v[168:171], v[104:119]
  v_exp_f32 v164, v164
  v_exp_f32 v165, v165
  v_exp_f32 v166, v166
  v_exp_f32 v167, v167
  v_cvt_pk_bf16_f32 v172, v160, v161
  v_cvt_pk_bf16_f32 v173, v162, v163
  v_cvt_pk_bf16_f32 v174, v164, v165
  v_cvt_pk_bf16_f32 v175, v166, v167
  s_nop 1
  v_mfma_f32_32x32x16_bf16 v[104:119], v[236:239], v[172:175], v[104:119]
  v_smfmac_f32_16x16x64_bf16 v[132:135], v[16:19], v[168:175], v20
  s_branch .g2_kernel_a_rde
.g2_kernel_a_rd4:
.g2_kernel_a_rde:
  v_mov_b32 v168, 0
  v_mov_b32 v169, 0
  v_mov_b32 v170, 0
  v_mov_b32 v171, 0
  v_mov_b32 v172, 0
  v_mov_b32 v173, 0
  v_mov_b32 v174, 0
  v_mov_b32 v175, 0
  s_waitcnt vmcnt(8)
  v_mfma_f32_32x32x16_bf16 v[136:151], v[176:179], v[24:27], 0
  v_mfma_f32_32x32x16_bf16 v[136:151], v[180:183], v[28:31], v[136:151]
  s_nop 10
  s_branch .g2_kernel_a_loop
.g2_kernel_a_ld0:
  s_andn2_b32 s33, s36, s34
  s_cbranch_scc0 .g2_kernel_a_r0c
.g2_kernel_a_r0b:
  s_ff1_i32_b32 s33, s33
  s_bitset1_b32 s34, s33
  s_xor_b32 s33, s33, s24
  s_lshl_b32 s33, s33, s25
  s_add_u32 s22, s20, s33
  s_addc_u32 s23, s21, 0
  global_load_dwordx4 v[176:179], v3, s[22:23] offset:0
  global_load_dwordx4 v[180:183], v3, s[22:23] offset:1024
  global_load_dwordx4 v[184:187], v3, s[22:23] offset:2048
  global_load_dwordx4 v[188:191], v3, s[22:23] offset:3072
  s_setpc_b64 s[72:73]
.g2_kernel_a_ld1:
  s_andn2_b32 s33, s36, s34
  s_cbranch_scc0 .g2_kernel_a_r1c
.g2_kernel_a_r1b:
  s_ff1_i32_b32 s33, s33
  s_bitset1_b32 s34, s33
  s_xor_b32 s33, s33, s24
  s_lshl_b32 s33, s33, s25
  s_add_u32 s22, s20, s33
  s_addc_u32 s23, s21, 0
  global_load_dwordx4 v[192:195], v3, s[22:23] offset:0
  global_load_dwordx4 v[196:199], v3, s[22:23] offset:1024
  global_load_dwordx4 v[200:203], v3, s[22:23] offset:2048
  global_load_dwordx4 v[204:207], v3, s[22:23] offset:3072
  s_setpc_b64 s[72:73]
.g2_kernel_a_ld2:
  s_andn2_b32 s33, s36, s34
  s_cbranch_scc0 .g2_kernel_a_r2c
.g2_kernel_a_r2b:
  s_ff1_i32_b32 s33, s33
  s_bitset1_b32 s34, s33
  s_xor_b32 s33, s33, s24
  s_lshl_b32 s33, s33, s25
  s_add_u32 s22, s20, s33
  s_addc_u32 s23, s21, 0
  global_load_dwordx4 v[208:211], v3, s[22:23] offset:0
  global_load_dwordx4 v[212:215], v3, s[22:23] offset:1024
  global_load_dwordx4 v[216:219], v3, s[22:23] offset:2048
  global_load_dwordx4 v[220:223], v3, s[22:23] offset:3072
  s_setpc_b64 s[72:73]
.g2_kernel_a_N0c:
  s_call_b64 s[68:69], .g2_kernel_a_pick
  s_branch .g2_kernel_a_N0b
.g2_kernel_a_N1c:
  s_call_b64 s[68:69], .g2_kernel_a_pick
  s_branch .g2_kernel_a_N1b
.g2_kernel_a_N2c:
  s_call_b64 s[68:69], .g2_kernel_a_pick
  s_branch .g2_kernel_a_N2b
.g2_kernel_a_N3c:
  s_call_b64 s[68:69], .g2_kernel_a_pick
  s_branch .g2_kernel_a_N3b
.g2_kernel_a_L3c:
  s_call_b64 s[68:69], .g2_kernel_a_pick
  s_branch .g2_kernel_a_L3b
.g2_kernel_a_G0c:
  s_call_b64 s[68:69], .g2_kernel_a_pick
  s_branch .g2_kernel_a_G0b
.g2_kernel_a_L3g:
  s_mov_b32 s38, 0
.g2_kernel_a_L3gl:
  ds_read_b32 v7, v13 offset:8
  s_add_u32 s38, s38, 1
  s_waitcnt lgkmcnt(0)
  v_cmp_gt_u32 vcc, s27, v7
  s_cbranch_vccz .g2_kernel_a_L3h
  s_cmp_lt_u32 s38, 524288
  s_cbranch_scc1 .g2_kernel_a_L3gl
  s_branch .g2_kernel_a_L3h
.g2_kernel_a_hold:
  s_lshl_b32 s33, 1, s14
  s_lshr_b32 s14, s14, 8
  s_setpc_b64 s[68:69]
.g2_kernel_a_pick:
  s_cmp_lg_u32 s34, -1
  s_cbranch_scc1 .g2_kernel_a_pk1
  s_cmp_eq_u32 s26, -1
  s_cbranch_scc1 .g2_kernel_a_hold
  s_add_u32 s26, s26, 1
  s_mov_b32 s34, 0xffff
  s_cmp_eq_u32 s26, 1
  s_cbranch_scc1 .g2_kernel_a_pk1
  v_and_b32 v8, 15, v2
  s_lshl_b32 s28, s16, 6
  s_add_u32 s28, s28, 157696
  v_lshl_add_u32 v8, v8, 2, s28
  s_lshl_b32 s28, s17, 2
  s_add_u32 s28, s28, s16
  s_lshl_b32 s28, s28, 16
  s_add_u32 s28, s28, s63
  s_add_u32 s28, s28, 0x800000
  s_add_u32 s20, s60, s28
  s_addc_u32 s21, s61, 0
  s_lshl_b32 s24, s18, 1
  s_and_b32 s24, s24, 6
  s_mov_b32 s25, 12
  s_mov_b32 s34, 0
  s_mov_b32 s36, 0xff
  s_mov_b32 s33, 0xff
  s_mov_b32 s38, 0
.g2_kernel_a_pk2:
  ds_read_b32 v7, v8
  s_add_u32 s38, s38, 1
  s_waitcnt lgkmcnt(0)
  v_cmp_ge_u32 vcc, s62, v7
  s_cbranch_vccz .g2_kernel_a_pkr
  s_cmp_lt_u32 s38, 524288
  s_cbranch_scc1 .g2_kernel_a_pk2
  s_branch .g2_kernel_a_pkr
.g2_kernel_a_pk1:
  s_mov_b32 s38, 0
.g2_kernel_a_pkl:
  ds_read_b32 v7, v8
  s_add_u32 s38, s38, 1
  s_waitcnt lgkmcnt(0)
  v_cmp_lt_u32 vcc, s62, v7
  s_mov_b32 s36, vcc_lo
  s_andn2_b32 s33, s36, s34
  s_cbranch_scc1 .g2_kernel_a_pkr
  s_cmp_lt_u32 s38, 524288
  s_cbranch_scc1 .g2_kernel_a_pkl
  s_not_b32 s33, s34
.g2_kernel_a_pkr:
  s_setpc_b64 s[68:69]
.g2_kernel_w_aw:
  v_mov_b32 v6, s71
  s_mov_b32 s38, 0
.g2_kernel_wg4:
  ds_read_b32 v7, v6 offset:52
  s_add_u32 s38, s38, 1
  s_waitcnt lgkmcnt(0)
  v_cmp_le_u32 vcc, 4, v7
  s_cbranch_vccnz .g2_kernel_wg4d
  s_sleep 1
  s_cmp_lt_u32 s38, 524288
  s_cbranch_scc1 .g2_kernel_wg4
.g2_kernel_wg4d:
  s_branch .g2_kernel_w_ab
.g2_kernel_w_pt:
  v_lshlrev_b32 v7, 5, v17
  v_add_u32 v7, 155648, v7
  s_mov_b64 exec, vcc
  ds_read_b128 v[240:243], v7 offset:7680
  ds_read_b128 v[244:247], v7 offset:7696
  ds_read_b128 v[248:251], v7 offset:7744
  ds_read_b128 v[252:255], v7 offset:7760
  s_waitcnt lgkmcnt(0)
  v_pk_add_f32 v[24:25], v[24:25], v[240:241]
  v_pk_add_f32 v[26:27], v[26:27], v[242:243]
  v_pk_add_f32 v[28:29], v[28:29], v[244:245]
  v_pk_add_f32 v[30:31], v[30:31], v[246:247]
  v_pk_add_f32 v[32:33], v[32:33], v[248:249]
  v_pk_add_f32 v[34:35], v[34:35], v[250:251]
  v_pk_add_f32 v[36:37], v[36:37], v[252:253]
  v_pk_add_f32 v[38:39], v[38:39], v[254:255]
  ds_read_b128 v[240:243], v7 offset:7808
  ds_read_b128 v[244:247], v7 offset:7824
  ds_read_b128 v[248:251], v7 offset:7872
  ds_read_b128 v[252:255], v7 offset:7888
  s_waitcnt lgkmcnt(0)
  v_pk_add_f32 v[40:41], v[40:41], v[240:241]
  v_pk_add_f32 v[42:43], v[42:43], v[242:243]
  v_pk_add_f32 v[44:45], v[44:45], v[244:245]
  v_pk_add_f32 v[46:47], v[46:47], v[246:247]
  v_pk_add_f32 v[48:49], v[48:49], v[248:249]
  v_pk_add_f32 v[50:51], v[50:51], v[250:251]
  v_pk_add_f32 v[52:53], v[52:53], v[252:253]
  v_pk_add_f32 v[54:55], v[54:55], v[254:255]
  s_mov_b64 exec, -1
  s_branch .g2_kernel_w_pb
.g2_kernel_w_i8c:
  s_mov_b32 s38, 0
  s_call_b64 s[68:69], .g2_kernel_w_pkl
  s_branch .g2_kernel_w_i8b
.g2_kernel_w_i9c:
  s_mov_b32 s38, 0
  s_call_b64 s[68:69], .g2_kernel_w_pkl
  s_branch .g2_kernel_w_i9b
.g2_kernel_w_i10c:
  s_mov_b32 s38, 0
  s_call_b64 s[68:69], .g2_kernel_w_pkl
  s_branch .g2_kernel_w_i10b
.g2_kernel_w_i11c:
  s_mov_b32 s38, 0
  s_call_b64 s[68:69], .g2_kernel_w_pkl
  s_branch .g2_kernel_w_i11b
.g2_kernel_w_v8:
  s_cmp_ge_u32 s8, 139264
  s_cselect_b32 s28, 139264, 0
  s_sub_u32 s28, s8, s28
  s_lshr_b32 s28, s28, 1
  s_add_u32 s28, s28, 32768
  s_add_u32 s22, s20, s28
  s_addc_u32 s23, s21, 0
  s_mov_b32 s38, 0
.g2_kernel_w_vl8:
  global_load_dwordx4 v[88:91], v3, s[22:23] offset:0 sc1
  global_load_dwordx4 v[92:95], v3, s[22:23] offset:1024 sc1
  global_load_dwordx4 v[96:99], v3, s[22:23] offset:2048 sc1
  global_load_dwordx4 v[100:103], v3, s[22:23] offset:3072 sc1
  s_add_u32 s38, s38, 1
  s_waitcnt vmcnt(0)
  v_min3_u32 v6, v88, v90, v92
  v_min3_u32 v7, v94, v96, v98
  v_min3_u32 v6, v6, v100, v102
  v_min_u32 v6, v6, v7
  v_cmp_eq_u32 vcc, 0, v6
  s_cbranch_vccz .g2_kernel_w_vb8
  s_cmp_lt_u32 s38, 131072
  s_cbranch_scc1 .g2_kernel_w_vl8
  s_branch .g2_kernel_w_vb8
.g2_kernel_w_i12c:
  s_mov_b32 s38, 0
  s_call_b64 s[68:69], .g2_kernel_w_pkl
  s_branch .g2_kernel_w_i12b
.g2_kernel_w_v9:
  s_cmp_ge_u32 s9, 139264
  s_cselect_b32 s28, 139264, 0
  s_sub_u32 s28, s9, s28
  s_lshr_b32 s28, s28, 1
  s_add_u32 s28, s28, 32768
  s_add_u32 s22, s20, s28
  s_addc_u32 s23, s21, 0
  s_mov_b32 s38, 0
.g2_kernel_w_vl9:
  global_load_dwordx4 v[176:179], v3, s[22:23] offset:0 sc1
  global_load_dwordx4 v[180:183], v3, s[22:23] offset:1024 sc1
  global_load_dwordx4 v[184:187], v3, s[22:23] offset:2048 sc1
  global_load_dwordx4 v[188:191], v3, s[22:23] offset:3072 sc1
  s_add_u32 s38, s38, 1
  s_waitcnt vmcnt(0)
  v_min3_u32 v6, v176, v178, v180
  v_min3_u32 v7, v182, v184, v186
  v_min3_u32 v6, v6, v188, v190
  v_min_u32 v6, v6, v7
  v_cmp_eq_u32 vcc, 0, v6
  s_cbranch_vccz .g2_kernel_w_vb9
  s_cmp_lt_u32 s38, 131072
  s_cbranch_scc1 .g2_kernel_w_vl9
  s_branch .g2_kernel_w_vb9
.g2_kernel_w_i13c:
  s_mov_b32 s38, 0
  s_call_b64 s[68:69], .g2_kernel_w_pkl
  s_branch .g2_kernel_w_i13b
.g2_kernel_w_v10:
  s_cmp_ge_u32 s10, 139264
  s_cselect_b32 s28, 139264, 0
  s_sub_u32 s28, s10, s28
  s_lshr_b32 s28, s28, 1
  s_add_u32 s28, s28, 32768
  s_add_u32 s22, s20, s28
  s_addc_u32 s23, s21, 0
  s_mov_b32 s38, 0
.g2_kernel_w_vl10:
  global_load_dwordx4 v[192:195], v3, s[22:23] offset:0 sc1
  global_load_dwordx4 v[196:199], v3, s[22:23] offset:1024 sc1
  global_load_dwordx4 v[200:203], v3, s[22:23] offset:2048 sc1
  global_load_dwordx4 v[204:207], v3, s[22:23] offset:3072 sc1
  s_add_u32 s38, s38, 1
  s_waitcnt vmcnt(0)
  v_min3_u32 v6, v192, v194, v196
  v_min3_u32 v7, v198, v200, v202
  v_min3_u32 v6, v6, v204, v206
  v_min_u32 v6, v6, v7
  v_cmp_eq_u32 vcc, 0, v6
  s_cbranch_vccz .g2_kernel_w_vb10
  s_cmp_lt_u32 s38, 131072
  s_cbranch_scc1 .g2_kernel_w_vl10
  s_branch .g2_kernel_w_vb10
.g2_kernel_w_i14c:
  s_mov_b32 s38, 524288
  s_call_b64 s[68:69], .g2_kernel_w_pkl
  s_branch .g2_kernel_w_i14b
.g2_kernel_w_v11:
  s_cmp_ge_u32 s11, 139264
  s_cselect_b32 s28, 139264, 0
  s_sub_u32 s28, s11, s28
  s_lshr_b32 s28, s28, 1
  s_add_u32 s28, s28, 32768
  s_add_u32 s22, s20, s28
  s_addc_u32 s23, s21, 0
  s_mov_b32 s38, 0
.g2_kernel_w_vl11:
  global_load_dwordx4 v[208:211], v3, s[22:23] offset:0 sc1
  global_load_dwordx4 v[212:215], v3, s[22:23] offset:1024 sc1
  global_load_dwordx4 v[216:219], v3, s[22:23] offset:2048 sc1
  global_load_dwordx4 v[220:223], v3, s[22:23] offset:3072 sc1
  s_add_u32 s38, s38, 1
  s_waitcnt vmcnt(0)
  v_min3_u32 v6, v208, v210, v212
  v_min3_u32 v7, v214, v216, v218
  v_min3_u32 v6, v6, v220, v222
  v_min_u32 v6, v6, v7
  v_cmp_eq_u32 vcc, 0, v6
  s_cbranch_vccz .g2_kernel_w_vb11
  s_cmp_lt_u32 s38, 131072
  s_cbranch_scc1 .g2_kernel_w_vl11
  s_branch .g2_kernel_w_vb11
.g2_kernel_w_i15c:
  s_mov_b32 s38, 524288
  s_call_b64 s[68:69], .g2_kernel_w_pkl
  s_branch .g2_kernel_w_i15b
.g2_kernel_w_v12:
  s_cmp_ge_u32 s12, 139264
  s_cselect_b32 s28, 139264, 0
  s_sub_u32 s28, s12, s28
  s_lshr_b32 s28, s28, 1
  s_add_u32 s28, s28, 32768
  s_add_u32 s22, s20, s28
  s_addc_u32 s23, s21, 0
  s_mov_b32 s38, 0
.g2_kernel_w_vl12:
  global_load_dwordx4 v[224:227], v3, s[22:23] offset:0 sc1
  global_load_dwordx4 v[228:231], v3, s[22:23] offset:1024 sc1
  global_load_dwordx4 v[232:235], v3, s[22:23] offset:2048 sc1
  global_load_dwordx4 v[236:239], v3, s[22:23] offset:3072 sc1
  s_add_u32 s38, s38, 1
  s_waitcnt vmcnt(0)
  v_min3_u32 v6, v224, v226, v228
  v_min3_u32 v7, v230, v232, v234
  v_min3_u32 v6, v6, v236, v238
  v_min_u32 v6, v6, v7
  v_cmp_eq_u32 vcc, 0, v6
  s_cbranch_vccz .g2_kernel_w_vb12
  s_cmp_lt_u32 s38, 131072
  s_cbranch_scc1 .g2_kernel_w_vl12
  s_branch .g2_kernel_w_vb12
.g2_kernel_w_v13:
  s_cmp_ge_u32 s13, 139264
  s_cselect_b32 s28, 139264, 0
  s_sub_u32 s28, s13, s28
  s_lshr_b32 s28, s28, 1
  s_add_u32 s28, s28, 32768
  s_add_u32 s22, s20, s28
  s_addc_u32 s23, s21, 0
  s_mov_b32 s38, 0
.g2_kernel_w_vl13:
  global_load_dwordx4 v[136:139], v3, s[22:23] offset:0 sc1
  global_load_dwordx4 v[140:143], v3, s[22:23] offset:1024 sc1
  global_load_dwordx4 v[144:147], v3, s[22:23] offset:2048 sc1
  global_load_dwordx4 v[148:151], v3, s[22:23] offset:3072 sc1
  s_add_u32 s38, s38, 1
  s_waitcnt vmcnt(0)
  v_min3_u32 v6, v136, v138, v140
  v_min3_u32 v7, v142, v144, v146
  v_min3_u32 v6, v6, v148, v150
  v_min_u32 v6, v6, v7
  v_cmp_eq_u32 vcc, 0, v6
  s_cbranch_vccz .g2_kernel_w_vb13
  s_cmp_lt_u32 s38, 131072
  s_cbranch_scc1 .g2_kernel_w_vl13
  s_branch .g2_kernel_w_vb13
.g2_kernel_w_v14:
  s_cmp_ge_u32 s14, 139264
  s_cselect_b32 s28, 139264, 0
  s_sub_u32 s28, s14, s28
  s_lshr_b32 s28, s28, 1
  s_add_u32 s28, s28, 32768
  s_add_u32 s22, s20, s28
  s_addc_u32 s23, s21, 0
  s_mov_b32 s38, 0
.g2_kernel_w_vl14:
  global_load_dwordx4 v[152:155], v3, s[22:23] offset:0 sc1
  global_load_dwordx4 v[156:159], v3, s[22:23] offset:1024 sc1
  global_load_dwordx4 v[160:163], v3, s[22:23] offset:2048 sc1
  global_load_dwordx4 v[164:167], v3, s[22:23] offset:3072 sc1
  s_add_u32 s38, s38, 1
  s_waitcnt vmcnt(0)
  v_min3_u32 v6, v152, v154, v156
  v_min3_u32 v7, v158, v160, v162
  v_min3_u32 v6, v6, v164, v166
  v_min_u32 v6, v6, v7
  v_cmp_eq_u32 vcc, 0, v6
  s_cbranch_vccz .g2_kernel_w_vb14
  s_cmp_lt_u32 s38, 131072
  s_cbranch_scc1 .g2_kernel_w_vl14
  s_branch .g2_kernel_w_vb14
.g2_kernel_w_v15:
  s_cmp_ge_u32 s15, 139264
  s_cselect_b32 s28, 139264, 0
  s_sub_u32 s28, s15, s28
  s_lshr_b32 s28, s28, 1
  s_add_u32 s28, s28, 32768
  s_add_u32 s22, s20, s28
  s_addc_u32 s23, s21, 0
  s_mov_b32 s38, 0
.g2_kernel_w_vl15:
  global_load_dwordx4 v[56:59], v3, s[22:23] offset:0 sc1
  global_load_dwordx4 v[60:63], v3, s[22:23] offset:1024 sc1
  global_load_dwordx4 v[64:67], v3, s[22:23] offset:2048 sc1
  global_load_dwordx4 v[68:71], v3, s[22:23] offset:3072 sc1
  s_add_u32 s38, s38, 1
  s_waitcnt vmcnt(0)
  v_min3_u32 v6, v56, v58, v60
  v_min3_u32 v7, v62, v64, v66
  v_min3_u32 v6, v6, v68, v70
  v_min_u32 v6, v6, v7
  v_cmp_eq_u32 vcc, 0, v6
  s_cbranch_vccz .g2_kernel_w_vb15
  s_cmp_lt_u32 s38, 131072
  s_cbranch_scc1 .g2_kernel_w_vl15
  s_branch .g2_kernel_w_vb15
.g2_kernel_w_bw:
  s_mov_b32 s38, 0
.g2_kernel_w_bwl:
  ds_read_b32 v16, v20 offset:12
  s_add_u32 s38, s38, 1
  s_waitcnt lgkmcnt(0)
  v_cmp_gt_u32 vcc, 4, v16
  s_cbranch_vccz .g2_kernel_w_bb
  s_cmp_lt_u32 s38, 524288
  s_cbranch_scc1 .g2_kernel_w_bwl
  s_branch .g2_kernel_w_bb
.g2_kernel_w_pick:
  s_mov_b32 s38, 0
.g2_kernel_w_pkl:
  ds_read_b64 v[6:7], v21
  s_add_u32 s38, s38, 1
  s_waitcnt lgkmcnt(0)
  v_min_u32 v6, v6, v7
  v_cmp_lt_u32 vcc, s62, v6
  s_and_b32 s36, vcc_lo, 0xff00
  s_andn2_b32 s33, s36, s34
  s_cbranch_scc1 .g2_kernel_w_pkr
  s_cmp_lt_u32 s38, 524288
  s_cbranch_scc1 .g2_kernel_w_pkl
  s_andn2_b32 s33, 0xff00, s34
.g2_kernel_w_pkr:
  s_setpc_b64 s[68:69]
.g2_kernel_p_spin:
  s_mov_b32 s38, 0
.g2_kernel_p_spinl:
  ds_read_b32 v10, v9
  s_add_u32 s38, s38, 1
  s_waitcnt lgkmcnt(0)
  v_cmp_gt_i32 vcc, s34, v10
  s_cbranch_vccz .g2_kernel_p_spinr
  s_sleep 1
  s_cmp_lt_u32 s38, 524288
  s_cbranch_scc1 .g2_kernel_p_spinl
.g2_kernel_p_spinr:
  s_setpc_b64 s[68:69]
.g2_kernel_p1_aw:
  s_call_b64 s[68:69], .g2_kernel_p_spin
  s_branch .g2_kernel_p1_ai
.g2_kernel_p1_bw:
  s_call_b64 s[68:69], .g2_kernel_p_spin
  s_branch .g2_kernel_p1_bi
.g2_kernel_v_may:
  s_cmp_lg_u32 s39, 0
  s_cbranch_scc1 .g2_kernel_v_mr
  s_and_b32 s28, s16, 3
  s_lshl_b32 s28, s28, 4
  s_add_u32 s28, s28, 155968
  v_mov_b32 v6, s28
  ds_read_b32 v7, v6
  s_waitcnt lgkmcnt(0)
  v_cmp_ne_u32 vcc, 0, v7
  s_cbranch_vccz .g2_kernel_v_mr
.g2_kernel_v_do:
  s_mov_b32 s39, 1
  s_mov_b32 s29, 0
  s_call_b64 s[68:69], .g2_kernel_v_cmb
  s_waitcnt vmcnt(0)
  v_mov_b32 v6, s71
  s_mov_b64 exec, 1
  ds_add_u32 v6, v5 offset:8
  s_mov_b64 exec, -1
  s_and_b32 s33, s16, 3
  s_lshl_b32 s33, s33, 7
  s_lshl_b32 s28, s29, 2
  s_add_u32 s33, s33, s28
  s_add_u32 s31, s19, s33
  v_mov_b32 v6, s70
  s_mov_b64 exec, 1
  buffer_store_dword v6, v4, s[4:7], s31 offen offset:0 sc1
  s_mov_b64 exec, -1
.g2_kernel_v_mr:
  s_setpc_b64 s[26:27]
.g2_kernel_v_wo:
  s_mov_b32 s8, s44
  s_mov_b32 s9, s45
  s_mov_b32 s10, 0x200000
  s_mov_b32 s11, 0x00020000
  v_lshrrev_b32 v6, 3, v2
  v_and_b32 v7, 7, v2
  v_bfe_u32 v8, v2, 4, 1
  v_lshlrev_b32 v8, 2, v8
  v_xor_b32 v7, v7, v8
  v_lshlrev_b32 v7, 4, v7
  v_lshl_add_u32 v6, v6, 11, v7
  s_and_b32 s31, s16, 3
  s_lshl_b32 s31, s31, 3
  s_add_u32 s31, s31, s29
  s_lshl_b32 s31, s31, 16
  s_lshl_b32 s33, s18, 7
  s_add_u32 s31, s31, s33
  s_mov_b32 m0, s30
  s_nop 0
  buffer_load_dwordx4 v6, s[8:11], s31 offen lds
  s_add_u32 m0, m0, 1024
  s_add_u32 s31, s31, 16384
  buffer_load_dwordx4 v6, s[8:11], s31 offen lds
  s_add_u32 m0, m0, 1024
  s_add_u32 s31, s31, 16384
  buffer_load_dwordx4 v6, s[8:11], s31 offen lds
  s_add_u32 m0, m0, 1024
  s_add_u32 s31, s31, 16384
  buffer_load_dwordx4 v6, s[8:11], s31 offen lds
  s_add_u32 m0, m0, 1024
  s_add_u32 s31, s31, 81920
  buffer_load_dwordx4 v6, s[8:11], s31 offen lds
  s_add_u32 m0, m0, 1024
  s_add_u32 s31, s31, 16384
  buffer_load_dwordx4 v6, s[8:11], s31 offen lds
  s_add_u32 m0, m0, 1024
  s_add_u32 s31, s31, 16384
  buffer_load_dwordx4 v6, s[8:11], s31 offen lds
  s_add_u32 m0, m0, 1024
  s_add_u32 s31, s31, 16384
  buffer_load_dwordx4 v6, s[8:11], s31 offen lds
  s_add_u32 m0, m0, 1024
  s_add_u32 s31, s31, 81920
  buffer_load_dwordx4 v6, s[8:11], s31 offen lds
  s_add_u32 m0, m0, 1024
  s_add_u32 s31, s31, 16384
  buffer_load_dwordx4 v6, s[8:11], s31 offen lds
  s_add_u32 m0, m0, 1024
  s_add_u32 s31, s31, 16384
  buffer_load_dwordx4 v6, s[8:11], s31 offen lds
  s_add_u32 m0, m0, 1024
  s_add_u32 s31, s31, 16384
  buffer_load_dwordx4 v6, s[8:11], s31 offen lds
  s_add_u32 m0, m0, 1024
  s_add_u32 s31, s31, 81920
  buffer_load_dwordx4 v6, s[8:11], s31 offen lds
  s_add_u32 m0, m0, 1024
  s_add_u32 s31, s31, 16384
  buffer_load_dwordx4 v6, s[8:11], s31 offen lds
  s_add_u32 m0, m0, 1024
  s_add_u32 s31, s31, 16384
  buffer_load_dwordx4 v6, s[8:11], s31 offen lds
  s_add_u32 m0, m0, 1024
  s_add_u32 s31, s31, 16384
  buffer_load_dwordx4 v6, s[8:11], s31 offen lds
  s_setpc_b64 s[68:69]
.g2_kernel_v_cmb:
  s_and_b32 s28, s16, 3
  s_lshl_b32 s30, s28, 2
  s_lshl_b32 s34, 15, s30
  v_and_b32 v6, 15, v2
  v_lshlrev_b32 v6, 2, v6
  v_add_u32 v6, 155968, v6
  s_lshl_b32 s30, s28, 14
  v_add_u32 v12, s30, v3
  v_and_b32 v13, 31, v2
  s_lshl_b32 s31, s28, 9
  s_add_u32 s31, s31, 161280
  v_lshl_add_u32 v13, v13, 2, s31
  s_lshl_b32 s33, s62, 1
  s_add_u32 s33, s33, s29
  s_lshl_b32 s31, s17, 2
  s_add_u32 s31, s31, s28
  s_lshl_b32 s31, s31, 1
  s_add_u32 s31, s31, s29
  s_lshl_b32 s31, s31, 4
  s_add_u32 s31, s31, s18
  s_lshl_b32 s31, s31, 11
  s_add_u32 s31, s31, s63
  s_add_u32 s35, s31, 0x800000
  v_mov_b32 v14, 8.673617379884035e-19
  v_mov_b32 v15, 1.152921504606847e+18
  s_mov_b32 s38, 0
.g2_kernel_v_cmbw:
  ds_read_b32 v7, v6
  s_add_u32 s38, s38, 1
  s_waitcnt lgkmcnt(0)
  v_cmp_ge_u32 vcc, s33, v7
  s_and_b32 s30, vcc_lo, s34
  s_cbranch_scc0 .g2_kernel_v_cmbd
  s_cmp_lg_u32 vcc_lo, -1
  s_cbranch_scc1 .g2_kernel_v_cmbq
  s_sleep 12
.g2_kernel_v_cmbq:
  s_cmp_lt_u32 s38, 524288
  s_cbranch_scc1 .g2_kernel_v_cmbw
.g2_kernel_v_cmbd:
  s_setprio 3
  s_lshl_b32 s30, s28, 2
  s_add_u32 s30, s30, s71
  v_mov_b32 v7, s30
  ds_read_b128 v[16:19], v12 offset:0
  ds_read_b128 v[20:23], v12 offset:1024
  ds_read_b128 v[24:27], v12 offset:2048
  ds_read_b128 v[28:31], v12 offset:3072
  ds_read_b128 v[32:35], v12 offset:4096
  ds_read_b128 v[36:39], v12 offset:5120
  ds_read_b128 v[40:43], v12 offset:6144
  ds_read_b128 v[44:47], v12 offset:7168
  ds_read_b128 v[48:51], v12 offset:8192
  ds_read_b128 v[52:55], v12 offset:9216
  ds_read_b128 v[56:59], v12 offset:10240
  ds_read_b128 v[60:63], v12 offset:11264
  s_waitcnt lgkmcnt(4)
  ds_read_b32 v8, v13 offset:0
  ds_read_b32 v9, v13 offset:128
  ds_read_b32 v10, v13 offset:256
  ds_read_b32 v11, v13 offset:384
  v_add_f32 v16, v16, v32
  v_add_f32 v17, v17, v33
  v_add_f32 v18, v18, v34
  v_add_f32 v19, v19, v35
  v_add_f32 v20, v20, v36
  v_add_f32 v21, v21, v37
  v_add_f32 v22, v22, v38
  v_add_f32 v23, v23, v39
  v_add_f32 v24, v24, v40
  v_add_f32 v25, v25, v41
  v_add_f32 v26, v26, v42
  v_add_f32 v27, v27, v43
  v_add_f32 v28, v28, v44
  v_add_f32 v29, v29, v45
  v_add_f32 v30, v30, v46
  v_add_f32 v31, v31, v47
  ds_read_b128 v[32:35], v12 offset:12288
  ds_read_b128 v[36:39], v12 offset:13312
  ds_read_b128 v[40:43], v12 offset:14336
  ds_read_b128 v[44:47], v12 offset:15360
  s_waitcnt lgkmcnt(4)
  v_add_f32 v16, v16, v48
  v_add_f32 v17, v17, v49
  v_add_f32 v18, v18, v50
  v_add_f32 v19, v19, v51
  v_add_f32 v20, v20, v52
  v_add_f32 v21, v21, v53
  v_add_f32 v22, v22, v54
  v_add_f32 v23, v23, v55
  v_add_f32 v24, v24, v56
  v_add_f32 v25, v25, v57
  v_add_f32 v26, v26, v58
  v_add_f32 v27, v27, v59
  v_add_f32 v28, v28, v60
  v_add_f32 v29, v29, v61
  v_add_f32 v30, v30, v62
  v_add_f32 v31, v31, v63
  v_add_f32 v8, v8, v10
  v_add_f32 v9, v9, v11
  v_add_f32 v9, v8, v9
  v_cmp_ge_f32 vcc, v9, v14
  v_cmp_le_f32 s[36:37], v9, v15
  v_rcp_f32 v10, v9
  v_mul_f32 v15, v15, v15
  v_mov_b32 v11, s29
  s_waitcnt lgkmcnt(0)
  ds_write_b32 v7, v11 offset:64
  v_add_f32 v16, v16, v32
  v_add_f32 v17, v17, v33
  v_add_f32 v18, v18, v34
  v_add_f32 v19, v19, v35
  v_add_f32 v20, v20, v36
  v_add_f32 v21, v21, v37
  v_add_f32 v22, v22, v38
  v_add_f32 v23, v23, v39
  v_add_f32 v24, v24, v40
  v_add_f32 v25, v25, v41
  v_add_f32 v26, v26, v42
  v_add_f32 v27, v27, v43
  v_add_f32 v28, v28, v44
  v_add_f32 v29, v29, v45
  v_add_f32 v30, v30, v46
  v_add_f32 v31, v31, v47
  s_and_b64 s[36:37], s[36:37], vcc
  v_maximum3_f32 v48, abs(v16), abs(v17), abs(v18)
  v_maximum3_f32 v49, abs(v19), abs(v20), abs(v21)
  v_maximum3_f32 v50, abs(v22), abs(v23), abs(v24)
  v_maximum3_f32 v51, abs(v25), abs(v26), abs(v27)
  v_maximum3_f32 v52, abs(v28), abs(v29), abs(v30)
  v_maximum3_f32 v48, v48, v49, abs(v31)
  v_maximum3_f32 v50, v50, v51, v52
  v_maximum3_f32 v48, v48, v50, v50
  v_cmp_le_f32 vcc, v48, v15
  s_and_b64 vcc, vcc, s[36:37]
  s_cmp_eq_u64 vcc, -1
  s_cbranch_scc0 .g2_kernel_v_cmbslow
.g2_kernel_v_cmbfin:
  v_mul_f32 v16, v16, v10
  v_mul_f32 v17, v17, v10
  v_mul_f32 v18, v18, v10
  v_mul_f32 v19, v19, v10
  v_mul_f32 v20, v20, v10
  v_mul_f32 v21, v21, v10
  v_mul_f32 v22, v22, v10
  v_mul_f32 v23, v23, v10
  v_cvt_pk_bf16_f32 v32, v16, v17
  v_cvt_pk_bf16_f32 v33, v18, v19
  v_cvt_pk_bf16_f32 v34, v20, v21
  v_cvt_pk_bf16_f32 v35, v22, v23
  v_max_u32 v32, 1, v32
  v_max_u32 v34, 1, v34
  buffer_store_dwordx4 v[32:35], v3, s[4:7], s35 offen offset:0 sc1
  v_mul_f32 v24, v24, v10
  v_mul_f32 v25, v25, v10
  v_mul_f32 v26, v26, v10
  v_mul_f32 v27, v27, v10
  v_mul_f32 v28, v28, v10
  v_mul_f32 v29, v29, v10
  v_mul_f32 v30, v30, v10
  v_mul_f32 v31, v31, v10
  v_cvt_pk_bf16_f32 v36, v24, v25
  v_cvt_pk_bf16_f32 v37, v26, v27
  v_cvt_pk_bf16_f32 v38, v28, v29
  v_cvt_pk_bf16_f32 v39, v30, v31
  v_max_u32 v36, 1, v36
  v_max_u32 v38, 1, v38
  buffer_store_dwordx4 v[36:39], v3, s[4:7], s35 offen offset:1024 sc1
  s_setprio 3
  s_setpc_b64 s[68:69]
.g2_kernel_v_cmbslow:
  s_setprio 0
  s_lshl_b32 s30, s28, 11
  s_mul_i32 s31, s29, -8192
  s_add_u32 s30, s30, s31
  s_add_u32 s30, s30, 139264
  v_add_u32 v6, s30, v3
  ds_read_b128 v[48:51], v6
  ds_read_b128 v[52:55], v6 offset:1024
  s_lshl_b32 s36, s18, 1
  s_add_u32 s36, s36, s29
  s_lshl_b32 s36, s36, 18
  s_add_u32 s36, s36, s63
  s_mov_b32 s30, s36
  s_mov_b32 s33, 64
  v_mov_b32 v10, 0xff800000
  s_waitcnt lgkmcnt(0)
.g2_kernel_v_cmbs1:
  buffer_load_dwordx4 v[56:59], v3, s[4:7], s30 offen offset:0
  buffer_load_dwordx4 v[60:63], v3, s[4:7], s30 offen offset:1024
  s_waitcnt vmcnt(0)
  v_mfma_f32_32x32x16_bf16 v[32:47], v[56:59], v[48:51], 0
  v_mfma_f32_32x32x16_bf16 v[32:47], v[60:63], v[52:55], v[32:47]
  s_nop 11
  v_max3_f32 v10, v10, v32, v33
  v_max3_f32 v10, v10, v34, v35
  v_max3_f32 v10, v10, v36, v37
  v_max3_f32 v10, v10, v38, v39
  v_max3_f32 v10, v10, v40, v41
  v_max3_f32 v10, v10, v42, v43
  v_max3_f32 v10, v10, v44, v45
  v_max3_f32 v10, v10, v46, v47
  s_add_u32 s30, s30, 4096
  s_sub_u32 s33, s33, 1
  s_cmp_lg_u32 s33, 0
  s_cbranch_scc1 .g2_kernel_v_cmbs1
  v_mov_b32 v11, v10
  s_nop 1
  v_permlane32_swap_b32 v11, v10
  v_max_f32 v10, v10, v11
  v_mov_b32 v9, 0
  v_mov_b32 v16, 0
  v_mov_b32 v17, 0
  v_mov_b32 v18, 0
  v_mov_b32 v19, 0
  v_mov_b32 v20, 0
  v_mov_b32 v21, 0
  v_mov_b32 v22, 0
  v_mov_b32 v23, 0
  v_mov_b32 v24, 0
  v_mov_b32 v25, 0
  v_mov_b32 v26, 0
  v_mov_b32 v27, 0
  v_mov_b32 v28, 0
  v_mov_b32 v29, 0
  v_mov_b32 v30, 0
  v_mov_b32 v31, 0
  s_mov_b32 s30, s36
  s_mov_b32 s33, 64
.g2_kernel_v_cmbs2:
  buffer_load_dwordx4 v[56:59], v3, s[4:7], s30 offen offset:0
  buffer_load_dwordx4 v[60:63], v3, s[4:7], s30 offen offset:1024
  s_waitcnt vmcnt(0)
  v_mfma_f32_32x32x16_bf16 v[32:47], v[56:59], v[48:51], 0
  v_mfma_f32_32x32x16_bf16 v[32:47], v[60:63], v[52:55], v[32:47]
  s_nop 11
  v_sub_f32 v32, v32, v10
  v_sub_f32 v33, v33, v10
  v_sub_f32 v34, v34, v10
  v_sub_f32 v35, v35, v10
  v_sub_f32 v36, v36, v10
  v_sub_f32 v37, v37, v10
  v_sub_f32 v38, v38, v10
  v_sub_f32 v39, v39, v10
  v_sub_f32 v40, v40, v10
  v_sub_f32 v41, v41, v10
  v_sub_f32 v42, v42, v10
  v_sub_f32 v43, v43, v10
  v_sub_f32 v44, v44, v10
  v_sub_f32 v45, v45, v10
  v_sub_f32 v46, v46, v10
  v_sub_f32 v47, v47, v10
  buffer_load_dwordx4 v[56:59], v3, s[4:7], s30 offen offset:2048
  buffer_load_dwordx4 v[60:63], v3, s[4:7], s30 offen offset:3072
  v_exp_f32 v32, v32
  v_exp_f32 v33, v33
  v_exp_f32 v34, v34
  v_exp_f32 v35, v35
  v_exp_f32 v36, v36
  v_exp_f32 v37, v37
  v_exp_f32 v38, v38
  v_exp_f32 v39, v39
  v_exp_f32 v40, v40
  v_exp_f32 v41, v41
  v_exp_f32 v42, v42
  v_exp_f32 v43, v43
  v_exp_f32 v44, v44
  v_exp_f32 v45, v45
  v_exp_f32 v46, v46
  v_exp_f32 v47, v47
  v_add_f32 v9, v9, v32
  v_add_f32 v9, v9, v33
  v_add_f32 v9, v9, v34
  v_add_f32 v9, v9, v35
  v_add_f32 v9, v9, v36
  v_add_f32 v9, v9, v37
  v_add_f32 v9, v9, v38
  v_add_f32 v9, v9, v39
  v_add_f32 v9, v9, v40
  v_add_f32 v9, v9, v41
  v_add_f32 v9, v9, v42
  v_add_f32 v9, v9, v43
  v_add_f32 v9, v9, v44
  v_add_f32 v9, v9, v45
  v_add_f32 v9, v9, v46
  v_add_f32 v9, v9, v47
  v_cvt_pk_bf16_f32 v32, v32, v33
  v_cvt_pk_bf16_f32 v33, v34, v35
  v_cvt_pk_bf16_f32 v34, v36, v37
  v_cvt_pk_bf16_f32 v35, v38, v39
  v_cvt_pk_bf16_f32 v36, v40, v41
  v_cvt_pk_bf16_f32 v37, v42, v43
  v_cvt_pk_bf16_f32 v38, v44, v45
  v_cvt_pk_bf16_f32 v39, v46, v47
  s_waitcnt vmcnt(0)
  v_mfma_f32_32x32x16_bf16 v[16:31], v[56:59], v[32:35], v[16:31]
  v_mfma_f32_32x32x16_bf16 v[16:31], v[60:63], v[36:39], v[16:31]
  s_nop 15
  s_add_u32 s30, s30, 4096
  s_sub_u32 s33, s33, 1
  s_cmp_lg_u32 s33, 0
  s_cbranch_scc1 .g2_kernel_v_cmbs2
  v_mov_b32 v11, v9
  s_nop 1
  v_permlane32_swap_b32 v11, v9
  v_add_f32 v9, v9, v11
  v_rcp_f32 v10, v9
  s_branch .g2_kernel_v_cmbfin
.g2_kernel_p2_xw:
  s_mov_b32 s38, 0
.g2_kernel_p2_xwl:
  ds_read_b32 v12, v11
  s_add_u32 s38, s38, 1
  s_waitcnt lgkmcnt(0)
  v_cmp_ne_u32 vcc, 0, v12
  s_and_b32 s37, vcc_lo, vcc_hi
  s_lshr_b32 s33, s37, 16
  s_and_b32 s37, s37, s33
  s_bitcmp1_b32 s37, s28
  s_cbranch_scc1 .g2_kernel_p2_xwr
  s_sleep 1
  s_cmp_lt_u32 s38, 524288
  s_cbranch_scc1 .g2_kernel_p2_xwl
.g2_kernel_p2_xwr:
  s_setpc_b64 s[68:69]
.g2_kernel_p2_x0w:
  s_call_b64 s[68:69], .g2_kernel_p2_xw
  s_branch .g2_kernel_p2_x0b
.g2_kernel_p2_x1w:
  s_call_b64 s[68:69], .g2_kernel_p2_xw
  s_branch .g2_kernel_p2_x1b
.g2_kernel_p2_x2w:
  s_call_b64 s[68:69], .g2_kernel_p2_xw
  s_branch .g2_kernel_p2_x2b
.g2_kernel_p2_aw:
  s_call_b64 s[68:69], .g2_kernel_p_spin
  s_branch .g2_kernel_p2_ai
.g2_kernel_p2_x3w:
  s_call_b64 s[68:69], .g2_kernel_p2_xw
  s_branch .g2_kernel_p2_x3b
.g2_kernel_p2_bw:
  s_call_b64 s[68:69], .g2_kernel_p_spin
  s_branch .g2_kernel_p2_bi
.g2_kernel_amax:
  v_mov_b32 v16, 0xff7fffff
  v_mov_b32 v17, 1
  v_mov_b32 v18, 0xff7fffff
  v_mov_b32 v19, 1
  v_mov_b32 v20, 0xff7fffff
  v_mov_b32 v21, 1
  v_mov_b32 v22, 0xff7fffff
  v_mov_b32 v23, 1
  s_mov_b32 s38, 0
  s_mov_b64 vcc, -1
  v_lshlrev_b32 v7, 5, v2
  s_add_u32 s28, s23, 4096
.g2_kernel_amaxl:
  s_and_b64 exec, vcc, s[8:9]
  s_cbranch_scc0 .g2_kernel_amaxn0
  buffer_load_dwordx2 v[16:17], v7, s[4:7], s23 offen offset:0 sc1
.g2_kernel_amaxn0:
  s_and_b64 exec, vcc, s[10:11]
  s_cbranch_scc0 .g2_kernel_amaxn1
  buffer_load_dwordx2 v[18:19], v7, s[4:7], s23 offen offset:2048 sc1
.g2_kernel_amaxn1:
  s_and_b64 exec, vcc, s[12:13]
  s_cbranch_scc0 .g2_kernel_amaxn2
  buffer_load_dwordx2 v[20:21], v7, s[4:7], s28 offen offset:0 sc1
.g2_kernel_amaxn2:
  s_and_b64 exec, vcc, s[14:15]
  s_cbranch_scc0 .g2_kernel_amaxn3
  buffer_load_dwordx2 v[22:23], v7, s[4:7], s28 offen offset:2048 sc1
.g2_kernel_amaxn3:
  s_mov_b64 exec, -1
  s_add_u32 s38, s38, 1
  s_waitcnt vmcnt(0)
  v_min3_u32 v6, v17, v19, v21
  v_min_u32 v6, v6, v23
  v_cmp_eq_u32 vcc, 0, v6
  s_cbranch_vccz .g2_kernel_amaxd
  s_sleep 4
  s_cmp_lg_u32 s62, 0
  s_cbranch_scc1 .g2_kernel_nap55
  s_sleep 20
.g2_kernel_nap55:
  s_cmp_eq_u32 s39, 1
  s_cbranch_scc0 .g2_kernel_amaxz
  s_sleep 8
.g2_kernel_amaxz:
  s_cmp_lt_u32 s38, 131072
  s_cbranch_scc1 .g2_kernel_amaxl
.g2_kernel_amaxd:
  s_mov_b32 s28, 0xffffffe7
  v_and_or_b32 v16, v16, s28, 0
  v_and_or_b32 v18, v18, s28, 8
  v_and_or_b32 v20, v20, s28, 16
  v_and_or_b32 v22, v22, s28, 24
  v_max3_f32 v6, v16, v18, v20
  v_max_f32 v6, v6, v22
  s_nop 1
  v_max_f32 v7, v6, v6 row_ror:8 row_mask:0xf bank_mask:0xf
  s_nop 1
  v_max_f32 v7, v7, v7 row_ror:4 row_mask:0xf bank_mask:0xf
  s_nop 1
  v_max_f32 v7, v7, v7 row_ror:2 row_mask:0xf bank_mask:0xf
  s_nop 1
  v_max_f32 v7, v7, v7 row_ror:1 row_mask:0xf bank_mask:0xf
  s_nop 1
  v_max_f32 v7, v7, v7 row_bcast:15 row_mask:0xa bank_mask:0xf
  s_nop 1
  v_max_f32 v7, v7, v7 row_bcast:31 row_mask:0xc bank_mask:0xf
  s_nop 0
  v_readlane_b32 s27, v7, 63
  s_nop 1
  v_cmp_eq_u32 vcc, s27, v6
  s_ff1_i32_b64 s77, vcc
  s_lshl_b32 s77, s77, 3
  s_and_b32 s28, s27, 7
  s_add_u32 s77, s77, s28
  s_and_b32 s28, s27, 24
  s_lshl_b32 s28, s28, 6
  s_add_u32 s77, s77, s28
  s_and_b32 s77, s77, 2047
  s_setpc_b64 s[68:69]
  .p2align 8
.g2_kernel_tab:
  .long 0, 1, 2, 3, 4, 5, 6, 7
  .long 8, 9, 10, 11, 12, 13, 14, 15
  .long 16, 17, 18, 19, 20, 21, 22, 23
  .long 24, 25, 26, 27, 28, 29, 30, 31
  .long 32, 33, 34, 35, 36, 37, 38, 39
  .long 40, 41, 42, 43, 44, 45, 46, 47
  .long 48, 49, 50, 51, 52, 53, 54, 55
  .long 56, 57, 58, 59, 60, 61, 62, 63
  .long 64, 65, 66, 67, 68, 69, 70, 71
.g2_kernel_cend:

.section .rodata,"a"
.p2align 6
.amdhsa_kernel g2_kernel
  .amdhsa_next_free_vgpr 256
  .amdhsa_next_free_sgpr 102
  .amdhsa_accum_offset 256
  .amdhsa_group_segment_fixed_size 0
  .amdhsa_kernarg_size 88
  .amdhsa_user_sgpr_count 2
  .amdhsa_user_sgpr_kernarg_segment_ptr 1
  .amdhsa_system_sgpr_workgroup_id_x 1
.end_amdhsa_kernel
```

```asm
; @launch kernel=g2_kernel grid=(256,1,1) block=(512,1,1) lds=163840
.amdgcn_target "amdgcn-amd-amdhsa--gfx950"
.text
.globl g2_kernel
.p2align 8
.type g2_kernel,@function
g2_kernel:
  s_cmp_ge_u32 s2, 256
  s_cbranch_scc1 .g2_kernel_end
  s_load_dwordx16 s[40:55], s[0:1], 0
  s_load_dwordx4 s[56:59], s[0:1], 64
  s_load_dwordx2 s[60:61], s[0:1], 80
  s_getpc_b64 s[64:65]
.g2_kernel_pc:
  s_mov_b32 s66, .g2_kernel_cend-.g2_kernel_pc
  s_mov_b32 s67, 0x00020000
  s_lshl_b32 s12, s2, 10
  s_and_b32 s12, s12, 0xe000
  v_lshrrev_b32 v3, 3, v0
  v_and_b32 v2, 7, v0
  v_and_b32 v3, 0x38, v3
  v_add_lshl_u32 v3, v3, v2, 7
  s_mov_b64 exec, 0xff
  buffer_load_dword v1, v3, s[64:67], s12 offen
  s_mov_b64 exec, -1
  v_lshrrev_b32 v3, 6, v0
  v_and_b32 v2, 63, v0
  v_readfirstlane_b32 s16, v3
  s_and_b32 s21, s2, 7
  s_lshr_b32 s22, s2, 3
  s_and_b32 s23, s21, 3
  s_lshl_b32 s23, s23, 2
  s_and_b32 s24, s22, 3
  s_add_u32 s18, s23, s24
  s_lshr_b32 s24, s21, 2
  s_lshl_b32 s24, s24, 3
  s_lshr_b32 s25, s22, 2
  s_add_u32 s17, s24, s25
  s_lshl_b32 s19, s17, 4
  s_add_u32 s19, s19, s18
  s_lshl_b32 s19, s19, 9
  s_add_u32 s19, s19, 0x3000000
  s_lshl_b32 s76, s18, 4
  s_add_u32 s76, s76, s17
  s_lshl_b32 s76, s76, 9
  s_add_u32 s76, s76, 0x3020000
  v_lshlrev_b32 v3, 4, v2
  v_mov_b32 v4, 0
  v_mov_b32 v5, 1
  s_mov_b32 s62, 0
  s_mov_b32 s63, 0
  s_mov_b32 s70, 1
  s_mov_b32 s71, 155648
  s_waitcnt lgkmcnt(0)
  s_mov_b32 s4, s60
  s_mov_b32 s5, s61
  s_mov_b32 s6, 0x3200000
  s_mov_b32 s7, 0x00020000
  s_cmp_ge_u32 s16, 4
  s_cbranch_scc1 .g2_kernel_svc
  v_mov_b32 v20, 0
  v_mov_b32 v21, 0
  v_mov_b32 v22, 0
  v_mov_b32 v23, 0
  v_lshlrev_b32 v24, 4, v0
  v_cmp_gt_u32 vcc, 2816, v24
  v_add_u32 v24, 155648, v24
  s_and_saveexec_b64 s[20:21], vcc
  s_cbranch_execz .g2_kernel_q_nz
  ds_write_b128 v24, v[20:23]
.g2_kernel_q_nz:
  s_mov_b64 exec, -1
  v_and_b32 v20, 15, v2
  v_lshrrev_b32 v21, 4, v2
  v_lshrrev_b32 v22, 1, v20
  v_xor_b32 v22, v22, v21
  v_lshlrev_b32 v22, 4, v22
  v_lshl_add_u32 v22, v20, 7, v22
  s_lshr_b32 s26, s16, 1
  s_lshl_b32 s26, s26, 13
  v_add_u32 v144, s26, v22
  v_xor_b32 v145, 64, v144
.g2_kernel_q_cs:
  s_and_b32 s27, s16, 1
  s_lshr_b32 s26, s16, 1
  v_bfe_u32 v20, v2, 2, 2
  v_lshrrev_b32 v49, 4, v2
  v_lshl_add_u32 v22, v49, 3, v20
  v_lshlrev_b32 v22, 7, v22
  v_lshrrev_b32 v23, 1, v20
  v_and_b32 v21, 1, v49
  v_xor_b32 v21, s27, v21
  v_lshl_add_u32 v23, v21, 1, v23
  v_lshl_add_u32 v22, v23, 5, v22
  v_and_b32 v23, 3, v2
  v_lshl_add_u32 v22, v23, 3, v22
  v_add_u32 v148, 65536, v22
  v_xor_b32 v149, 32, v148
  v_mov_b32 v146, v148
  v_mov_b32 v147, v149
  v_mov_b32 v150, 156160
  v_and_b32 v48, 15, v2
  s_lshl_b32 s28, s26, 8
  s_add_u32 s28, s28, 155648
  v_lshl_add_u32 v50, v48, 2, s28
  v_lshl_add_u32 v51, v49, 4, s28
  s_lshl_b32 s28, s27, 7
  s_add_u32 s28, s28, 155648
  v_lshl_add_u32 v52, v49, 4, s28
  v_lshl_add_u32 v53, v48, 2, s28
  v_lshlrev_b32 v54, 9, v49
  v_lshl_add_u32 v55, v48, 4, v54
  v_and_b32 v56, 8, v48
  v_lshl_add_u32 v54, v56, 4, v55
  v_mov_b32 v56, 0.25503486164919736
  v_lshlrev_b32 v58, 8, v2
  v_and_b32 v58, 0x300, v58
  v_add_u32 v58, 156416, v58
  s_lshl_b32 s8, s18, 1
  s_add_u32 s8, s8, s27
  s_lshl_b32 s8, s8, 6
  s_lshl_b32 s9, s17, 2
  s_add_u32 s8, s8, s9
  s_lshl_b32 s9, s26, 1
  s_add_u32 s8, s8, s9
  s_lshl_b32 s8, s8, 12
  s_add_u32 s8, s8, s63
  s_add_u32 s9, s8, 4096
  s_lshl_b32 s28, s26, 13
  s_lshl_b32 s10, s27, 14
  s_add_u32 s28, s28, s10
  v_add_u32 v59, s28, v54
  v_add_u32 v60, s28, v55
  s_lshl_b32 s28, s26, 12
  s_mul_i32 s10, s27, -8192
  s_add_u32 s28, s28, s10
  s_add_u32 s28, s28, 139264
  v_add_u32 v61, s28, v55
  s_mov_b32 s10, s27
  s_lshl_b32 s77, s18, 4
  s_add_u32 s77, s77, s17
  s_lshl_b32 s77, s77, 1
  s_add_u32 s77, s77, s26
  s_lshl_b32 s77, s77, 13
  s_add_u32 s77, s77, s63
  s_add_u32 s77, s77, 0x1400000
  s_lshl_b32 s28, s27, 30
  s_add_u32 s77, s77, s28
  s_lshl_b32 s12, s62, 5
  s_add_u32 s12, s12, 28
  v_and_b32 v6, 15, v2
  v_xor_b32 v6, s17, v6
  v_and_b32 v7, 16, v2
  v_add_u32 v6, v6, v7
  s_lshr_b32 s28, s16, 1
  s_lshl_b32 s28, s28, 7
  s_add_u32 s28, s28, 157440
  v_lshl_add_u32 v8, v6, 2, s28
  s_lshl_b32 s28, s16, 12
  v_add_u32 v9, s28, v3
  v_and_b32 v6, 31, v2
  s_lshl_b32 s28, s16, 7
  s_add_u32 s28, s28, 161280
  v_lshl_add_u32 v10, v6, 2, s28
  s_lshl_b32 s28, s16, 2
  s_add_u32 s28, s28, 155968
  v_mov_b32 v11, s28
  s_lshl_b32 s28, s62, 1
  s_add_u32 s28, s28, 1
  v_mov_b32 v12, s28
  v_mov_b32 v13, s71
  v_add_u32 v14, 131072, v3
  v_and_b32 v6, 4, v2
  v_cmp_eq_u32 vcc, 0, v6
  v_mov_b32 v7, 0x3f803f80
  v_and_b32 v6, 1, v2
  v_cndmask_b32 v16, 0, v7, vcc
  v_cndmask_b32 v17, 0, v7, vcc
  v_cndmask_b32 v18, v7, 0, vcc
  v_cndmask_b32 v19, v7, 0, vcc
  v_mul_u32_u24 v20, 0xaaaa, v6
  v_add_u32 v20, 0x4444, v20
  s_lshl_b32 s28, s18, 7
  s_add_u32 s28, s28, s16
  s_lshl_b32 s28, s28, 12
  s_add_u32 s28, s28, s63
  s_add_u32 s20, s60, s28
  s_addc_u32 s21, s61, 0
  s_mov_b32 s24, s17
  s_mov_b32 s25, 14
  s_mov_b32 s26, 0
  s_mov_b32 s27, 6
  s_mov_b32 s34, 0xffff0001
  s_mov_b32 s35, 0
  s_mov_b32 s36, 0
  s_mov_b32 s39, 0
  s_lshl_b32 s28, s16, 7
  s_add_u32 s37, s76, s28
  v_mov_b32 v15, s70
  v_lshrrev_b32 v6, 5, v2
  v_and_b32 v7, 15, v2
  v_lshlrev_b32 v22, 4, v7
  v_lshl_add_u32 v22, v6, 8, v22
  v_and_b32 v7, 16, v2
  v_lshl_add_u32 v22, v7, 7, v22
  v_and_b32 v7, 31, v2
  v_lshlrev_b32 v23, 4, v6
  v_lshl_add_u32 v23, v7, 11, v23
  s_lshl_b32 s28, s17, 2
  s_add_u32 s28, s28, s16
  s_lshl_b32 s28, s28, 16
  s_lshl_b32 s29, s18, 7
  s_add_u32 s28, s28, s29
  s_add_u32 s74, s40, s28
  s_addc_u32 s75, s41, 0
  s_lshl_b32 s13, s17, 4
  s_add_u32 s13, s13, s18
  s_lshl_b32 s13, s13, 2
  s_add_u32 s13, s13, s16
  s_lshl_b32 s13, s13, 12
  s_add_u32 s13, s13, 0xc00000
  s_lshl_b32 s28, s16, 8
  s_add_u32 m0, s28, 156416
  s_lshl_b32 s33, s62, 5
  s_lshl_b32 s31, s33, 2
  s_add_u32 s31, s31, .g2_kernel_tab-.g2_kernel_pc+4
  s_mov_b32 s29, 0
  s_cmp_lg_u32 s62, 0
  s_cbranch_scc1 .g2_kernel_q_i2
  s_waitcnt lgkmcnt(0)
  s_barrier
.g2_kernel_q_i3:
  s_call_b64 s[68:69], .g2_kernel_q_spin
  ds_read_b64_tr_b16 v[80:81], v146 offset:0
  ds_read_b64_tr_b16 v[82:83], v146 offset:512
  ds_read_b128 v[64:67], v144 offset:0
  ds_read_b128 v[68:71], v144 offset:2048
  ds_read_b128 v[72:75], v144 offset:4096
  ds_read_b128 v[76:79], v144 offset:6144
  ds_read_b64_tr_b16 v[84:85], v147 offset:0
  ds_read_b64_tr_b16 v[86:87], v147 offset:512
  ds_read_b64_tr_b16 v[88:89], v146 offset:4096
  ds_read_b64_tr_b16 v[90:91], v146 offset:4608
  ds_read_b64_tr_b16 v[92:93], v147 offset:4096
  ds_read_b64_tr_b16 v[94:95], v147 offset:4608
  ds_read_b64_tr_b16 v[96:97], v146 offset:8192
  ds_read_b64_tr_b16 v[98:99], v146 offset:8704
  ds_read_b64_tr_b16 v[100:101], v147 offset:8192
  ds_read_b64_tr_b16 v[102:103], v147 offset:8704
  s_mov_b32 s30, 12288
  s_add_u32 s33, s33, 1
  v_add_u32 v146, s30, v148
  v_add_u32 v147, s30, v149
  s_waitcnt lgkmcnt(0)
  v_mfma_f32_16x16x32_bf16 v[160:163], v[80:83], v[64:67], 0
  v_cmp_lt_i32 vcc, s33, v151
  v_mfma_f32_16x16x32_bf16 v[164:167], v[80:83], v[68:71], 0
  s_cbranch_vccz .g2_kernel_q_wf
.g2_kernel_q_backf:
  v_mfma_f32_16x16x32_bf16 v[168:171], v[80:83], v[72:75], 0
  ds_read_b64_tr_b16 v[120:121], v146 offset:0
  v_mfma_f32_16x16x32_bf16 v[172:175], v[80:83], v[76:79], 0
  ds_read_b64_tr_b16 v[122:123], v146 offset:512
  v_mfma_f32_16x16x32_bf16 v[188:191], v[84:87], v[76:79], 0
  ds_read_b128 v[104:107], v145 offset:0
  v_mfma_f32_16x16x32_bf16 v[184:187], v[84:87], v[72:75], 0
  ds_read_b128 v[108:111], v145 offset:2048
  v_mfma_f32_16x16x32_bf16 v[180:183], v[84:87], v[68:71], 0
  ds_read_b128 v[112:115], v145 offset:4096
  v_mfma_f32_16x16x32_bf16 v[176:179], v[84:87], v[64:67], 0
  ds_read_b128 v[116:119], v145 offset:6144
  v_mfma_f32_16x16x32_bf16 v[192:195], v[88:91], v[64:67], 0
  ds_read_b64_tr_b16 v[124:125], v147 offset:0
  v_mfma_f32_16x16x32_bf16 v[196:199], v[88:91], v[68:71], 0
  ds_read_b64_tr_b16 v[126:127], v147 offset:512
  v_mfma_f32_16x16x32_bf16 v[200:203], v[88:91], v[72:75], 0
  ds_read_b64_tr_b16 v[128:129], v146 offset:4096
  v_mfma_f32_16x16x32_bf16 v[204:207], v[88:91], v[76:79], 0
  ds_read_b64_tr_b16 v[130:131], v146 offset:4608
  v_mfma_f32_16x16x32_bf16 v[220:223], v[92:95], v[76:79], 0
  ds_read_b64_tr_b16 v[132:133], v147 offset:4096
  v_mfma_f32_16x16x32_bf16 v[216:219], v[92:95], v[72:75], 0
  ds_read_b64_tr_b16 v[134:135], v147 offset:4608
  v_mfma_f32_16x16x32_bf16 v[212:215], v[92:95], v[68:71], 0
  ds_read_b64_tr_b16 v[136:137], v146 offset:8192
  v_mfma_f32_16x16x32_bf16 v[208:211], v[92:95], v[64:67], 0
  ds_read_b64_tr_b16 v[138:139], v146 offset:8704
  v_mfma_f32_16x16x32_bf16 v[224:227], v[64:67], v[96:99], 0
  ds_read_b64_tr_b16 v[140:141], v147 offset:8192
  v_mfma_f32_16x16x32_bf16 v[228:231], v[68:71], v[96:99], 0
  ds_read_b64_tr_b16 v[142:143], v147 offset:8704
  v_mfma_f32_16x16x32_bf16 v[232:235], v[72:75], v[96:99], 0
  ds_read_b32 v151, v150
  s_add_u32 s30, s30, 12288
  v_mfma_f32_16x16x32_bf16 v[236:239], v[76:79], v[96:99], 0
  buffer_load_dword off, s[64:67], s31 lds
  s_cmp_eq_u32 s30, 86016
  v_mfma_f32_16x16x32_bf16 v[252:255], v[76:79], v[100:103], 0
  s_cselect_b32 s30, 0, s30
  s_add_u32 s31, s31, 4
  v_mfma_f32_16x16x32_bf16 v[248:251], v[72:75], v[100:103], 0
  v_add_u32 v146, s30, v148
  s_add_u32 s33, s33, 1
  v_mfma_f32_16x16x32_bf16 v[244:247], v[68:71], v[100:103], 0
  v_add_u32 v147, s30, v149
  v_mfma_f32_16x16x32_bf16 v[240:243], v[64:67], v[100:103], 0
  s_branch .g2_kernel_q_s1
  .p2align 6
.g2_kernel_q_loop:
  s_waitcnt lgkmcnt(0)
  v_mfma_f32_16x16x32_bf16 v[160:163], v[120:123], v[104:107], v[160:163]
  v_cmp_lt_i32 vcc, s33, v151
  v_mfma_f32_16x16x32_bf16 v[164:167], v[120:123], v[108:111], v[164:167]
  s_cbranch_vccz .g2_kernel_q_w7
.g2_kernel_q_back7:
  v_mfma_f32_16x16x32_bf16 v[168:171], v[120:123], v[112:115], v[168:171]
  ds_read_b64_tr_b16 v[80:81], v146 offset:0
  v_mfma_f32_16x16x32_bf16 v[172:175], v[120:123], v[116:119], v[172:175]
  ds_read_b64_tr_b16 v[82:83], v146 offset:512
  v_mfma_f32_16x16x32_bf16 v[188:191], v[124:127], v[116:119], v[188:191]
  ds_read_b128 v[64:67], v144 offset:0
  v_mfma_f32_16x16x32_bf16 v[184:187], v[124:127], v[112:115], v[184:187]
  ds_read_b128 v[68:71], v144 offset:2048
  v_mfma_f32_16x16x32_bf16 v[180:183], v[124:127], v[108:111], v[180:183]
  ds_read_b128 v[72:75], v144 offset:4096
  v_mfma_f32_16x16x32_bf16 v[176:179], v[124:127], v[104:107], v[176:179]
  ds_read_b128 v[76:79], v144 offset:6144
  v_mfma_f32_16x16x32_bf16 v[192:195], v[128:131], v[104:107], v[192:195]
  ds_read_b64_tr_b16 v[84:85], v147 offset:0
  v_mfma_f32_16x16x32_bf16 v[196:199], v[128:131], v[108:111], v[196:199]
  ds_read_b64_tr_b16 v[86:87], v147 offset:512
  v_mfma_f32_16x16x32_bf16 v[200:203], v[128:131], v[112:115], v[200:203]
  ds_read_b64_tr_b16 v[88:89], v146 offset:4096
  v_mfma_f32_16x16x32_bf16 v[204:207], v[128:131], v[116:119], v[204:207]
  ds_read_b64_tr_b16 v[90:91], v146 offset:4608
  v_mfma_f32_16x16x32_bf16 v[220:223], v[132:135], v[116:119], v[220:223]
  ds_read_b64_tr_b16 v[92:93], v147 offset:4096
  v_mfma_f32_16x16x32_bf16 v[216:219], v[132:135], v[112:115], v[216:219]
  ds_read_b64_tr_b16 v[94:95], v147 offset:4608
  v_mfma_f32_16x16x32_bf16 v[212:215], v[132:135], v[108:111], v[212:215]
  ds_read_b64_tr_b16 v[96:97], v146 offset:8192
  v_mfma_f32_16x16x32_bf16 v[208:211], v[132:135], v[104:107], v[208:211]
  ds_read_b64_tr_b16 v[98:99], v146 offset:8704
  v_mfma_f32_16x16x32_bf16 v[224:227], v[104:107], v[136:139], v[224:227]
  ds_read_b64_tr_b16 v[100:101], v147 offset:8192
  v_mfma_f32_16x16x32_bf16 v[228:231], v[108:111], v[136:139], v[228:231]
  ds_read_b64_tr_b16 v[102:103], v147 offset:8704
  v_mfma_f32_16x16x32_bf16 v[232:235], v[112:115], v[136:139], v[232:235]
  ds_read_b32 v151, v150
  s_add_u32 s30, s30, 12288
  v_mfma_f32_16x16x32_bf16 v[236:239], v[116:119], v[136:139], v[236:239]
  buffer_load_dword off, s[64:67], s31 lds
  s_cmp_eq_u32 s30, 86016
  v_mfma_f32_16x16x32_bf16 v[252:255], v[116:119], v[140:143], v[252:255]
  s_cselect_b32 s30, 0, s30
  s_add_u32 s31, s31, 4
  v_mfma_f32_16x16x32_bf16 v[248:251], v[112:115], v[140:143], v[248:251]
  v_add_u32 v146, s30, v148
  s_add_u32 s33, s33, 1
  v_mfma_f32_16x16x32_bf16 v[244:247], v[108:111], v[140:143], v[244:247]
  v_add_u32 v147, s30, v149
  v_mfma_f32_16x16x32_bf16 v[240:243], v[104:107], v[140:143], v[240:243]
  s_waitcnt lgkmcnt(0)
  v_mfma_f32_16x16x32_bf16 v[160:163], v[80:83], v[64:67], v[160:163]
  v_cmp_lt_i32 vcc, s33, v151
  v_mfma_f32_16x16x32_bf16 v[164:167], v[80:83], v[68:71], v[164:167]
  s_cbranch_vccz .g2_kernel_q_w0
.g2_kernel_q_back0:
  v_mfma_f32_16x16x32_bf16 v[168:171], v[80:83], v[72:75], v[168:171]
  ds_read_b64_tr_b16 v[120:121], v146 offset:0
  v_mfma_f32_16x16x32_bf16 v[172:175], v[80:83], v[76:79], v[172:175]
  ds_read_b64_tr_b16 v[122:123], v146 offset:512
  v_mfma_f32_16x16x32_bf16 v[188:191], v[84:87], v[76:79], v[188:191]
  ds_read_b128 v[104:107], v145 offset:0
  v_mfma_f32_16x16x32_bf16 v[184:187], v[84:87], v[72:75], v[184:187]
  ds_read_b128 v[108:111], v145 offset:2048
  v_mfma_f32_16x16x32_bf16 v[180:183], v[84:87], v[68:71], v[180:183]
  ds_read_b128 v[112:115], v145 offset:4096
  v_mfma_f32_16x16x32_bf16 v[176:179], v[84:87], v[64:67], v[176:179]
  ds_read_b128 v[116:119], v145 offset:6144
  v_mfma_f32_16x16x32_bf16 v[192:195], v[88:91], v[64:67], v[192:195]
  ds_read_b64_tr_b16 v[124:125], v147 offset:0
  v_mfma_f32_16x16x32_bf16 v[196:199], v[88:91], v[68:71], v[196:199]
  ds_read_b64_tr_b16 v[126:127], v147 offset:512
  v_mfma_f32_16x16x32_bf16 v[200:203], v[88:91], v[72:75], v[200:203]
  ds_read_b64_tr_b16 v[128:129], v146 offset:4096
  v_mfma_f32_16x16x32_bf16 v[204:207], v[88:91], v[76:79], v[204:207]
  ds_read_b64_tr_b16 v[130:131], v146 offset:4608
  v_mfma_f32_16x16x32_bf16 v[220:223], v[92:95], v[76:79], v[220:223]
  ds_read_b64_tr_b16 v[132:133], v147 offset:4096
  v_mfma_f32_16x16x32_bf16 v[216:219], v[92:95], v[72:75], v[216:219]
  ds_read_b64_tr_b16 v[134:135], v147 offset:4608
  v_mfma_f32_16x16x32_bf16 v[212:215], v[92:95], v[68:71], v[212:215]
  ds_read_b64_tr_b16 v[136:137], v146 offset:8192
  v_mfma_f32_16x16x32_bf16 v[208:211], v[92:95], v[64:67], v[208:211]
  ds_read_b64_tr_b16 v[138:139], v146 offset:8704
  v_mfma_f32_16x16x32_bf16 v[224:227], v[64:67], v[96:99], v[224:227]
  ds_read_b64_tr_b16 v[140:141], v147 offset:8192
  v_mfma_f32_16x16x32_bf16 v[228:231], v[68:71], v[96:99], v[228:231]
  ds_read_b64_tr_b16 v[142:143], v147 offset:8704
  v_mfma_f32_16x16x32_bf16 v[232:235], v[72:75], v[96:99], v[232:235]
  ds_read_b32 v151, v150
  s_add_u32 s30, s30, 12288
  v_mfma_f32_16x16x32_bf16 v[236:239], v[76:79], v[96:99], v[236:239]
  buffer_load_dword off, s[64:67], s31 lds
  s_cmp_eq_u32 s30, 86016
  v_mfma_f32_16x16x32_bf16 v[252:255], v[76:79], v[100:103], v[252:255]
  s_cselect_b32 s30, 0, s30
  s_add_u32 s31, s31, 4
  v_mfma_f32_16x16x32_bf16 v[248:251], v[72:75], v[100:103], v[248:251]
  v_add_u32 v146, s30, v148
  s_add_u32 s33, s33, 1
  v_mfma_f32_16x16x32_bf16 v[244:247], v[68:71], v[100:103], v[244:247]
  v_add_u32 v147, s30, v149
  v_mfma_f32_16x16x32_bf16 v[240:243], v[64:67], v[100:103], v[240:243]
.g2_kernel_q_s1:
  s_waitcnt lgkmcnt(0)
  v_mfma_f32_16x16x32_bf16 v[160:163], v[120:123], v[104:107], v[160:163]
  v_cmp_lt_i32 vcc, s33, v151
  v_mfma_f32_16x16x32_bf16 v[164:167], v[120:123], v[108:111], v[164:167]
  s_cbranch_vccz .g2_kernel_q_w1
.g2_kernel_q_back1:
  v_mfma_f32_16x16x32_bf16 v[168:171], v[120:123], v[112:115], v[168:171]
  ds_read_b64_tr_b16 v[80:81], v146 offset:0
  v_mfma_f32_16x16x32_bf16 v[172:175], v[120:123], v[116:119], v[172:175]
  ds_read_b64_tr_b16 v[82:83], v146 offset:512
  v_mfma_f32_16x16x32_bf16 v[188:191], v[124:127], v[116:119], v[188:191]
  ds_read_b128 v[64:67], v144 offset:16384
  v_mfma_f32_16x16x32_bf16 v[184:187], v[124:127], v[112:115], v[184:187]
  ds_read_b128 v[68:71], v144 offset:18432
  v_mfma_f32_16x16x32_bf16 v[180:183], v[124:127], v[108:111], v[180:183]
  ds_read_b128 v[72:75], v144 offset:20480
  v_mfma_f32_16x16x32_bf16 v[176:179], v[124:127], v[104:107], v[176:179]
  ds_read_b128 v[76:79], v144 offset:22528
  v_mfma_f32_16x16x32_bf16 v[192:195], v[128:131], v[104:107], v[192:195]
  ds_read_b64_tr_b16 v[84:85], v147 offset:0
  v_mfma_f32_16x16x32_bf16 v[196:199], v[128:131], v[108:111], v[196:199]
  ds_read_b64_tr_b16 v[86:87], v147 offset:512
  v_mfma_f32_16x16x32_bf16 v[200:203], v[128:131], v[112:115], v[200:203]
  ds_read_b64_tr_b16 v[88:89], v146 offset:4096
  v_mfma_f32_16x16x32_bf16 v[204:207], v[128:131], v[116:119], v[204:207]
  ds_read_b64_tr_b16 v[90:91], v146 offset:4608
  v_mfma_f32_16x16x32_bf16 v[220:223], v[132:135], v[116:119], v[220:223]
  ds_read_b64_tr_b16 v[92:93], v147 offset:4096
  v_mfma_f32_16x16x32_bf16 v[216:219], v[132:135], v[112:115], v[216:219]
  ds_read_b64_tr_b16 v[94:95], v147 offset:4608
  v_mfma_f32_16x16x32_bf16 v[212:215], v[132:135], v[108:111], v[212:215]
  ds_read_b64_tr_b16 v[96:97], v146 offset:8192
  v_mfma_f32_16x16x32_bf16 v[208:211], v[132:135], v[104:107], v[208:211]
  ds_read_b64_tr_b16 v[98:99], v146 offset:8704
  v_mfma_f32_16x16x32_bf16 v[224:227], v[104:107], v[136:139], v[224:227]
  ds_read_b64_tr_b16 v[100:101], v147 offset:8192
  v_mfma_f32_16x16x32_bf16 v[228:231], v[108:111], v[136:139], v[228:231]
  ds_read_b64_tr_b16 v[102:103], v147 offset:8704
  v_mfma_f32_16x16x32_bf16 v[232:235], v[112:115], v[136:139], v[232:235]
  ds_read_b32 v151, v150
  s_add_u32 s30, s30, 12288
  v_mfma_f32_16x16x32_bf16 v[236:239], v[116:119], v[136:139], v[236:239]
  buffer_load_dword off, s[64:67], s31 lds
  s_cmp_eq_u32 s30, 86016
  v_mfma_f32_16x16x32_bf16 v[252:255], v[116:119], v[140:143], v[252:255]
  s_cselect_b32 s30, 0, s30
  s_add_u32 s31, s31, 4
  v_mfma_f32_16x16x32_bf16 v[248:251], v[112:115], v[140:143], v[248:251]
  v_add_u32 v146, s30, v148
  s_add_u32 s33, s33, 1
  v_mfma_f32_16x16x32_bf16 v[244:247], v[108:111], v[140:143], v[244:247]
  v_add_u32 v147, s30, v149
  v_mfma_f32_16x16x32_bf16 v[240:243], v[104:107], v[140:143], v[240:243]
  s_waitcnt lgkmcnt(0)
  v_mfma_f32_16x16x32_bf16 v[160:163], v[80:83], v[64:67], v[160:163]
  v_cmp_lt_i32 vcc, s33, v151
  v_mfma_f32_16x16x32_bf16 v[164:167], v[80:83], v[68:71], v[164:167]
  s_cbranch_vccz .g2_kernel_q_w2
.g2_kernel_q_back2:
  v_mfma_f32_16x16x32_bf16 v[168:171], v[80:83], v[72:75], v[168:171]
  ds_read_b64_tr_b16 v[120:121], v146 offset:0
  v_mfma_f32_16x16x32_bf16 v[172:175], v[80:83], v[76:79], v[172:175]
  ds_read_b64_tr_b16 v[122:123], v146 offset:512
  v_mfma_f32_16x16x32_bf16 v[188:191], v[84:87], v[76:79], v[188:191]
  ds_read_b128 v[104:107], v145 offset:16384
  v_mfma_f32_16x16x32_bf16 v[184:187], v[84:87], v[72:75], v[184:187]
  ds_read_b128 v[108:111], v145 offset:18432
  v_mfma_f32_16x16x32_bf16 v[180:183], v[84:87], v[68:71], v[180:183]
  ds_read_b128 v[112:115], v145 offset:20480
  v_mfma_f32_16x16x32_bf16 v[176:179], v[84:87], v[64:67], v[176:179]
  ds_read_b128 v[116:119], v145 offset:22528
  v_mfma_f32_16x16x32_bf16 v[192:195], v[88:91], v[64:67], v[192:195]
  ds_read_b64_tr_b16 v[124:125], v147 offset:0
  v_mfma_f32_16x16x32_bf16 v[196:199], v[88:91], v[68:71], v[196:199]
  ds_read_b64_tr_b16 v[126:127], v147 offset:512
  v_mfma_f32_16x16x32_bf16 v[200:203], v[88:91], v[72:75], v[200:203]
  ds_read_b64_tr_b16 v[128:129], v146 offset:4096
  v_mfma_f32_16x16x32_bf16 v[204:207], v[88:91], v[76:79], v[204:207]
  ds_read_b64_tr_b16 v[130:131], v146 offset:4608
  v_mfma_f32_16x16x32_bf16 v[220:223], v[92:95], v[76:79], v[220:223]
  ds_read_b64_tr_b16 v[132:133], v147 offset:4096
  v_mfma_f32_16x16x32_bf16 v[216:219], v[92:95], v[72:75], v[216:219]
  ds_read_b64_tr_b16 v[134:135], v147 offset:4608
  v_mfma_f32_16x16x32_bf16 v[212:215], v[92:95], v[68:71], v[212:215]
  ds_read_b64_tr_b16 v[136:137], v146 offset:8192
  v_mfma_f32_16x16x32_bf16 v[208:211], v[92:95], v[64:67], v[208:211]
  ds_read_b64_tr_b16 v[138:139], v146 offset:8704
  v_mfma_f32_16x16x32_bf16 v[224:227], v[64:67], v[96:99], v[224:227]
  ds_read_b64_tr_b16 v[140:141], v147 offset:8192
  v_mfma_f32_16x16x32_bf16 v[228:231], v[68:71], v[96:99], v[228:231]
  ds_read_b64_tr_b16 v[142:143], v147 offset:8704
  v_mfma_f32_16x16x32_bf16 v[232:235], v[72:75], v[96:99], v[232:235]
  ds_read_b32 v151, v150
  s_add_u32 s30, s30, 12288
  v_mfma_f32_16x16x32_bf16 v[236:239], v[76:79], v[96:99], v[236:239]
  buffer_load_dword off, s[64:67], s31 lds
  s_cmp_eq_u32 s30, 86016
  v_mfma_f32_16x16x32_bf16 v[252:255], v[76:79], v[100:103], v[252:255]
  s_cselect_b32 s30, 0, s30
  s_add_u32 s31, s31, 4
  v_mfma_f32_16x16x32_bf16 v[248:251], v[72:75], v[100:103], v[248:251]
  v_add_u32 v146, s30, v148
  s_add_u32 s33, s33, 1
  v_mfma_f32_16x16x32_bf16 v[244:247], v[68:71], v[100:103], v[244:247]
  v_add_u32 v147, s30, v149
  v_mfma_f32_16x16x32_bf16 v[240:243], v[64:67], v[100:103], v[240:243]
  s_waitcnt lgkmcnt(0)
  v_mfma_f32_16x16x32_bf16 v[160:163], v[120:123], v[104:107], v[160:163]
  v_cmp_lt_i32 vcc, s33, v151
  v_mfma_f32_16x16x32_bf16 v[164:167], v[120:123], v[108:111], v[164:167]
  s_cbranch_vccz .g2_kernel_q_w3
.g2_kernel_q_back3:
  v_mfma_f32_16x16x32_bf16 v[168:171], v[120:123], v[112:115], v[168:171]
  ds_read_b64_tr_b16 v[80:81], v146 offset:0
  v_mfma_f32_16x16x32_bf16 v[172:175], v[120:123], v[116:119], v[172:175]
  ds_read_b64_tr_b16 v[82:83], v146 offset:512
  v_mfma_f32_16x16x32_bf16 v[188:191], v[124:127], v[116:119], v[188:191]
  ds_read_b128 v[64:67], v144 offset:32768
  v_mfma_f32_16x16x32_bf16 v[184:187], v[124:127], v[112:115], v[184:187]
  ds_read_b128 v[68:71], v144 offset:34816
  v_mfma_f32_16x16x32_bf16 v[180:183], v[124:127], v[108:111], v[180:183]
  ds_read_b128 v[72:75], v144 offset:36864
  v_mfma_f32_16x16x32_bf16 v[176:179], v[124:127], v[104:107], v[176:179]
  ds_read_b128 v[76:79], v144 offset:38912
  v_mfma_f32_16x16x32_bf16 v[192:195], v[128:131], v[104:107], v[192:195]
  ds_read_b64_tr_b16 v[84:85], v147 offset:0
  v_mfma_f32_16x16x32_bf16 v[196:199], v[128:131], v[108:111], v[196:199]
  ds_read_b64_tr_b16 v[86:87], v147 offset:512
  v_mfma_f32_16x16x32_bf16 v[200:203], v[128:131], v[112:115], v[200:203]
  ds_read_b64_tr_b16 v[88:89], v146 offset:4096
  v_mfma_f32_16x16x32_bf16 v[204:207], v[128:131], v[116:119], v[204:207]
  ds_read_b64_tr_b16 v[90:91], v146 offset:4608
  v_mfma_f32_16x16x32_bf16 v[220:223], v[132:135], v[116:119], v[220:223]
  ds_read_b64_tr_b16 v[92:93], v147 offset:4096
  v_mfma_f32_16x16x32_bf16 v[216:219], v[132:135], v[112:115], v[216:219]
  ds_read_b64_tr_b16 v[94:95], v147 offset:4608
  v_mfma_f32_16x16x32_bf16 v[212:215], v[132:135], v[108:111], v[212:215]
  ds_read_b64_tr_b16 v[96:97], v146 offset:8192
  v_mfma_f32_16x16x32_bf16 v[208:211], v[132:135], v[104:107], v[208:211]
  ds_read_b64_tr_b16 v[98:99], v146 offset:8704
  v_mfma_f32_16x16x32_bf16 v[224:227], v[104:107], v[136:139], v[224:227]
  ds_read_b64_tr_b16 v[100:101], v147 offset:8192
  v_mfma_f32_16x16x32_bf16 v[228:231], v[108:111], v[136:139], v[228:231]
  ds_read_b64_tr_b16 v[102:103], v147 offset:8704
  v_mfma_f32_16x16x32_bf16 v[232:235], v[112:115], v[136:139], v[232:235]
  ds_read_b32 v151, v150
  s_add_u32 s30, s30, 12288
  v_mfma_f32_16x16x32_bf16 v[236:239], v[116:119], v[136:139], v[236:239]
  buffer_load_dword off, s[64:67], s31 lds
  s_cmp_eq_u32 s30, 86016
  v_mfma_f32_16x16x32_bf16 v[252:255], v[116:119], v[140:143], v[252:255]
  s_cselect_b32 s30, 0, s30
  s_add_u32 s31, s31, 4
  v_mfma_f32_16x16x32_bf16 v[248:251], v[112:115], v[140:143], v[248:251]
  v_add_u32 v146, s30, v148
  s_add_u32 s33, s33, 1
  v_mfma_f32_16x16x32_bf16 v[244:247], v[108:111], v[140:143], v[244:247]
  v_add_u32 v147, s30, v149
  v_mfma_f32_16x16x32_bf16 v[240:243], v[104:107], v[140:143], v[240:243]
  s_waitcnt lgkmcnt(0)
  v_mfma_f32_16x16x32_bf16 v[160:163], v[80:83], v[64:67], v[160:163]
  v_cmp_lt_i32 vcc, s33, v151
  v_mfma_f32_16x16x32_bf16 v[164:167], v[80:83], v[68:71], v[164:167]
  s_cbranch_vccz .g2_kernel_q_w4
.g2_kernel_q_back4:
  v_mfma_f32_16x16x32_bf16 v[168:171], v[80:83], v[72:75], v[168:171]
  ds_read_b64_tr_b16 v[120:121], v146 offset:0
  v_mfma_f32_16x16x32_bf16 v[172:175], v[80:83], v[76:79], v[172:175]
  ds_read_b64_tr_b16 v[122:123], v146 offset:512
  v_mfma_f32_16x16x32_bf16 v[188:191], v[84:87], v[76:79], v[188:191]
  ds_read_b128 v[104:107], v145 offset:32768
  v_mfma_f32_16x16x32_bf16 v[184:187], v[84:87], v[72:75], v[184:187]
  ds_read_b128 v[108:111], v145 offset:34816
  v_mfma_f32_16x16x32_bf16 v[180:183], v[84:87], v[68:71], v[180:183]
  ds_read_b128 v[112:115], v145 offset:36864
  v_mfma_f32_16x16x32_bf16 v[176:179], v[84:87], v[64:67], v[176:179]
  ds_read_b128 v[116:119], v145 offset:38912
  v_mfma_f32_16x16x32_bf16 v[192:195], v[88:91], v[64:67], v[192:195]
  ds_read_b64_tr_b16 v[124:125], v147 offset:0
  v_mfma_f32_16x16x32_bf16 v[196:199], v[88:91], v[68:71], v[196:199]
  ds_read_b64_tr_b16 v[126:127], v147 offset:512
  v_mfma_f32_16x16x32_bf16 v[200:203], v[88:91], v[72:75], v[200:203]
  ds_read_b64_tr_b16 v[128:129], v146 offset:4096
  v_mfma_f32_16x16x32_bf16 v[204:207], v[88:91], v[76:79], v[204:207]
  ds_read_b64_tr_b16 v[130:131], v146 offset:4608
  v_mfma_f32_16x16x32_bf16 v[220:223], v[92:95], v[76:79], v[220:223]
  ds_read_b64_tr_b16 v[132:133], v147 offset:4096
  v_mfma_f32_16x16x32_bf16 v[216:219], v[92:95], v[72:75], v[216:219]
  ds_read_b64_tr_b16 v[134:135], v147 offset:4608
  v_mfma_f32_16x16x32_bf16 v[212:215], v[92:95], v[68:71], v[212:215]
  ds_read_b64_tr_b16 v[136:137], v146 offset:8192
  v_mfma_f32_16x16x32_bf16 v[208:211], v[92:95], v[64:67], v[208:211]
  ds_read_b64_tr_b16 v[138:139], v146 offset:8704
  v_mfma_f32_16x16x32_bf16 v[224:227], v[64:67], v[96:99], v[224:227]
  ds_read_b64_tr_b16 v[140:141], v147 offset:8192
  v_mfma_f32_16x16x32_bf16 v[228:231], v[68:71], v[96:99], v[228:231]
  ds_read_b64_tr_b16 v[142:143], v147 offset:8704
  v_mfma_f32_16x16x32_bf16 v[232:235], v[72:75], v[96:99], v[232:235]
  ds_read_b32 v151, v150
  s_add_u32 s30, s30, 12288
  v_mfma_f32_16x16x32_bf16 v[236:239], v[76:79], v[96:99], v[236:239]
  buffer_load_dword off, s[64:67], s31 lds
  s_cmp_eq_u32 s30, 86016
  v_mfma_f32_16x16x32_bf16 v[252:255], v[76:79], v[100:103], v[252:255]
  s_cselect_b32 s30, 0, s30
  s_add_u32 s31, s31, 4
  v_mfma_f32_16x16x32_bf16 v[248:251], v[72:75], v[100:103], v[248:251]
  v_add_u32 v146, s30, v148
  s_add_u32 s33, s33, 1
  v_mfma_f32_16x16x32_bf16 v[244:247], v[68:71], v[100:103], v[244:247]
  v_add_u32 v147, s30, v149
  v_mfma_f32_16x16x32_bf16 v[240:243], v[64:67], v[100:103], v[240:243]
  s_waitcnt lgkmcnt(0)
  v_mfma_f32_16x16x32_bf16 v[160:163], v[120:123], v[104:107], v[160:163]
  v_cmp_lt_i32 vcc, s33, v151
  v_mfma_f32_16x16x32_bf16 v[164:167], v[120:123], v[108:111], v[164:167]
  s_cbranch_vccz .g2_kernel_q_w5
.g2_kernel_q_back5:
  v_mfma_f32_16x16x32_bf16 v[168:171], v[120:123], v[112:115], v[168:171]
  ds_read_b64_tr_b16 v[80:81], v146 offset:0
  v_mfma_f32_16x16x32_bf16 v[172:175], v[120:123], v[116:119], v[172:175]
  ds_read_b64_tr_b16 v[82:83], v146 offset:512
  v_mfma_f32_16x16x32_bf16 v[188:191], v[124:127], v[116:119], v[188:191]
  ds_read_b128 v[64:67], v144 offset:49152
  v_mfma_f32_16x16x32_bf16 v[184:187], v[124:127], v[112:115], v[184:187]
  ds_read_b128 v[68:71], v144 offset:51200
  v_mfma_f32_16x16x32_bf16 v[180:183], v[124:127], v[108:111], v[180:183]
  ds_read_b128 v[72:75], v144 offset:53248
  v_mfma_f32_16x16x32_bf16 v[176:179], v[124:127], v[104:107], v[176:179]
  ds_read_b128 v[76:79], v144 offset:55296
  v_mfma_f32_16x16x32_bf16 v[192:195], v[128:131], v[104:107], v[192:195]
  ds_read_b64_tr_b16 v[84:85], v147 offset:0
  v_mfma_f32_16x16x32_bf16 v[196:199], v[128:131], v[108:111], v[196:199]
  ds_read_b64_tr_b16 v[86:87], v147 offset:512
  v_mfma_f32_16x16x32_bf16 v[200:203], v[128:131], v[112:115], v[200:203]
  ds_read_b64_tr_b16 v[88:89], v146 offset:4096
  v_mfma_f32_16x16x32_bf16 v[204:207], v[128:131], v[116:119], v[204:207]
  ds_read_b64_tr_b16 v[90:91], v146 offset:4608
  v_mfma_f32_16x16x32_bf16 v[220:223], v[132:135], v[116:119], v[220:223]
  ds_read_b64_tr_b16 v[92:93], v147 offset:4096
  v_mfma_f32_16x16x32_bf16 v[216:219], v[132:135], v[112:115], v[216:219]
  ds_read_b64_tr_b16 v[94:95], v147 offset:4608
  v_mfma_f32_16x16x32_bf16 v[212:215], v[132:135], v[108:111], v[212:215]
  ds_read_b64_tr_b16 v[96:97], v146 offset:8192
  v_mfma_f32_16x16x32_bf16 v[208:211], v[132:135], v[104:107], v[208:211]
  ds_read_b64_tr_b16 v[98:99], v146 offset:8704
  v_mfma_f32_16x16x32_bf16 v[224:227], v[104:107], v[136:139], v[224:227]
  ds_read_b64_tr_b16 v[100:101], v147 offset:8192
  v_mfma_f32_16x16x32_bf16 v[228:231], v[108:111], v[136:139], v[228:231]
  ds_read_b64_tr_b16 v[102:103], v147 offset:8704
  v_mfma_f32_16x16x32_bf16 v[232:235], v[112:115], v[136:139], v[232:235]
  ds_read_b32 v151, v150
  s_add_u32 s30, s30, 12288
  v_mfma_f32_16x16x32_bf16 v[236:239], v[116:119], v[136:139], v[236:239]
  buffer_load_dword off, s[64:67], s31 lds
  s_cmp_eq_u32 s30, 86016
  v_mfma_f32_16x16x32_bf16 v[252:255], v[116:119], v[140:143], v[252:255]
  s_cselect_b32 s30, 0, s30
  s_add_u32 s31, s31, 4
  v_mfma_f32_16x16x32_bf16 v[248:251], v[112:115], v[140:143], v[248:251]
  v_add_u32 v146, s30, v148
  s_add_u32 s33, s33, 1
  v_mfma_f32_16x16x32_bf16 v[244:247], v[108:111], v[140:143], v[244:247]
  v_add_u32 v147, s30, v149
  v_mfma_f32_16x16x32_bf16 v[240:243], v[104:107], v[140:143], v[240:243]
  s_waitcnt lgkmcnt(0)
  v_mfma_f32_16x16x32_bf16 v[160:163], v[80:83], v[64:67], v[160:163]
  v_cmp_lt_i32 vcc, s33, v151
  v_mfma_f32_16x16x32_bf16 v[164:167], v[80:83], v[68:71], v[164:167]
  s_cbranch_vccz .g2_kernel_q_w6
.g2_kernel_q_back6:
  v_mfma_f32_16x16x32_bf16 v[168:171], v[80:83], v[72:75], v[168:171]
  ds_read_b64_tr_b16 v[120:121], v146 offset:0
  v_mfma_f32_16x16x32_bf16 v[172:175], v[80:83], v[76:79], v[172:175]
  ds_read_b64_tr_b16 v[122:123], v146 offset:512
  v_mfma_f32_16x16x32_bf16 v[188:191], v[84:87], v[76:79], v[188:191]
  ds_read_b128 v[104:107], v145 offset:49152
  v_mfma_f32_16x16x32_bf16 v[184:187], v[84:87], v[72:75], v[184:187]
  ds_read_b128 v[108:111], v145 offset:51200
  v_mfma_f32_16x16x32_bf16 v[180:183], v[84:87], v[68:71], v[180:183]
  ds_read_b128 v[112:115], v145 offset:53248
  v_mfma_f32_16x16x32_bf16 v[176:179], v[84:87], v[64:67], v[176:179]
  ds_read_b128 v[116:119], v145 offset:55296
  v_mfma_f32_16x16x32_bf16 v[192:195], v[88:91], v[64:67], v[192:195]
  ds_read_b64_tr_b16 v[124:125], v147 offset:0
  v_mfma_f32_16x16x32_bf16 v[196:199], v[88:91], v[68:71], v[196:199]
  ds_read_b64_tr_b16 v[126:127], v147 offset:512
  v_mfma_f32_16x16x32_bf16 v[200:203], v[88:91], v[72:75], v[200:203]
  ds_read_b64_tr_b16 v[128:129], v146 offset:4096
  v_mfma_f32_16x16x32_bf16 v[204:207], v[88:91], v[76:79], v[204:207]
  ds_read_b64_tr_b16 v[130:131], v146 offset:4608
  v_mfma_f32_16x16x32_bf16 v[220:223], v[92:95], v[76:79], v[220:223]
  ds_read_b64_tr_b16 v[132:133], v147 offset:4096
  v_mfma_f32_16x16x32_bf16 v[216:219], v[92:95], v[72:75], v[216:219]
  ds_read_b64_tr_b16 v[134:135], v147 offset:4608
  v_mfma_f32_16x16x32_bf16 v[212:215], v[92:95], v[68:71], v[212:215]
  ds_read_b64_tr_b16 v[136:137], v146 offset:8192
  v_mfma_f32_16x16x32_bf16 v[208:211], v[92:95], v[64:67], v[208:211]
  ds_read_b64_tr_b16 v[138:139], v146 offset:8704
  v_mfma_f32_16x16x32_bf16 v[224:227], v[64:67], v[96:99], v[224:227]
  ds_read_b64_tr_b16 v[140:141], v147 offset:8192
  v_mfma_f32_16x16x32_bf16 v[228:231], v[68:71], v[96:99], v[228:231]
  ds_read_b64_tr_b16 v[142:143], v147 offset:8704
  v_mfma_f32_16x16x32_bf16 v[232:235], v[72:75], v[96:99], v[232:235]
  ds_read_b32 v151, v150
  s_add_u32 s30, s30, 12288
  v_mfma_f32_16x16x32_bf16 v[236:239], v[76:79], v[96:99], v[236:239]
  buffer_load_dword off, s[64:67], s31 lds
  s_cmp_eq_u32 s30, 86016
  v_mfma_f32_16x16x32_bf16 v[252:255], v[76:79], v[100:103], v[252:255]
  s_cselect_b32 s30, 0, s30
  s_add_u32 s31, s31, 4
  v_mfma_f32_16x16x32_bf16 v[248:251], v[72:75], v[100:103], v[248:251]
  v_add_u32 v146, s30, v148
  s_add_u32 s33, s33, 1
  v_mfma_f32_16x16x32_bf16 v[244:247], v[68:71], v[100:103], v[244:247]
  v_add_u32 v147, s30, v149
  s_add_u32 s29, s29, 1
  v_mfma_f32_16x16x32_bf16 v[240:243], v[64:67], v[100:103], v[240:243]
  s_cmp_lg_u32 s29, 4
  s_cbranch_scc1 .g2_kernel_q_loop
  s_waitcnt lgkmcnt(0)
  v_mfma_f32_16x16x32_bf16 v[192:195], v[128:131], v[104:107], v[192:195]
  ds_read_b32 v62, v13 offset:0
  ds_read_b32 v63, v58
  v_mfma_f32_16x16x32_bf16 v[196:199], v[128:131], v[108:111], v[196:199]
  ds_read_b32 v57, v13 offset:24
  ds_read_b32 v21, v13 offset:84
  v_mfma_f32_16x16x32_bf16 v[200:203], v[128:131], v[112:115], v[200:203]
  ds_read_b128 v[40:43], v52 offset:5120
  ds_read_b128 v[44:47], v52 offset:5184
  v_mfma_f32_16x16x32_bf16 v[204:207], v[128:131], v[116:119], v[204:207]
  ds_read_b32 v24, v50 offset:2816
  ds_read_b32 v25, v50 offset:3328
  v_mfma_f32_16x16x32_bf16 v[220:223], v[132:135], v[116:119], v[220:223]
  ds_read_b32 v26, v50 offset:2880
  ds_read_b32 v27, v50 offset:3392
  v_mfma_f32_16x16x32_bf16 v[216:219], v[132:135], v[112:115], v[216:219]
  ds_read_b32 v28, v50 offset:2944
  ds_read_b32 v29, v50 offset:3456
  v_mfma_f32_16x16x32_bf16 v[212:215], v[132:135], v[108:111], v[212:215]
  ds_read_b32 v30, v50 offset:3008
  ds_read_b32 v31, v50 offset:3520
  v_mfma_f32_16x16x32_bf16 v[208:211], v[132:135], v[104:107], v[208:211]
  ds_read_b128 v[64:67], v51 offset:2816
  ds_read_b128 v[80:83], v51 offset:3328
  v_mfma_f32_16x16x32_bf16 v[224:227], v[104:107], v[136:139], v[224:227]
  ds_read_b128 v[68:71], v51 offset:2880
  v_mfma_f32_16x16x32_bf16 v[228:231], v[108:111], v[136:139], v[228:231]
  ds_read_b128 v[84:87], v51 offset:3392
  v_mfma_f32_16x16x32_bf16 v[232:235], v[112:115], v[136:139], v[232:235]
  ds_read_b128 v[72:75], v51 offset:2944
  v_mfma_f32_16x16x32_bf16 v[236:239], v[116:119], v[136:139], v[236:239]
  ds_read_b128 v[88:91], v51 offset:3456
  v_mfma_f32_16x16x32_bf16 v[252:255], v[116:119], v[140:143], v[252:255]
  ds_read_b128 v[76:79], v51 offset:3008
  v_mfma_f32_16x16x32_bf16 v[248:251], v[112:115], v[140:143], v[248:251]
  ds_read_b128 v[92:95], v51 offset:3520
  v_mfma_f32_16x16x32_bf16 v[244:247], v[108:111], v[140:143], v[244:247]
  ds_read_b32 v48, v53 offset:5376
  v_mfma_f32_16x16x32_bf16 v[240:243], v[104:107], v[140:143], v[240:243]
  ds_read_b32 v49, v53 offset:5440
  v_mfma_f32_16x16x32_bf16 v[160:163], v[120:123], v[104:107], v[160:163]
  ds_read_b128 v[32:35], v52 offset:4864
  v_mfma_f32_16x16x32_bf16 v[164:167], v[120:123], v[108:111], v[164:167]
  ds_read_b128 v[36:39], v52 offset:4928
  v_mfma_f32_16x16x32_bf16 v[168:171], v[120:123], v[112:115], v[168:171]
  v_mfma_f32_16x16x32_bf16 v[172:175], v[120:123], v[116:119], v[172:175]
  v_mfma_f32_16x16x32_bf16 v[188:191], v[124:127], v[116:119], v[188:191]
  buffer_load_dword off, s[64:67], s31 lds
  v_mfma_f32_16x16x32_bf16 v[184:187], v[124:127], v[112:115], v[184:187]
  v_mfma_f32_16x16x32_bf16 v[180:183], v[124:127], v[108:111], v[180:183]
  v_mfma_f32_16x16x32_bf16 v[176:179], v[124:127], v[104:107], v[176:179]
  s_waitcnt lgkmcnt(0)
  v_cmp_gt_u32 vcc, 2, v62
  v_cmp_gt_u32 s[14:15], s12, v63
  s_or_b64 vcc, vcc, s[14:15]
  s_cbranch_scc1 .g2_kernel_q_ew
.g2_kernel_q_eb:
  v_cmp_ne_u32 vcc, 0, v57
  s_cbranch_vccnz .g2_kernel_q_patch
.g2_kernel_q_pback:
  s_add_u32 s79, s77, 4096
  s_cmp_lg_u32 s10, 0
  s_cbranch_scc1 .g2_kernel_q_nk
  v_pk_mul_f32 v[152:153], v[40:41], v[24:25] op_sel:[0,1] op_sel_hi:[1,1]
  v_pk_mul_f32 v[154:155], v[42:43], v[24:25] op_sel:[0,1] op_sel_hi:[1,1]
  v_pk_mul_f32 v[156:157], v[44:45], v[24:25] op_sel:[0,1] op_sel_hi:[1,1]
  v_pk_mul_f32 v[158:159], v[46:47], v[24:25] op_sel:[0,1] op_sel_hi:[1,1]
  v_pk_fma_f32 v[192:193], v[192:193], v[24:25], v[152:153] op_sel_hi:[1,0,1]
  v_pk_fma_f32 v[194:195], v[194:195], v[24:25], v[154:155] op_sel_hi:[1,0,1]
  v_pk_fma_f32 v[208:209], v[208:209], v[24:25], v[156:157] op_sel_hi:[1,0,1]
  v_pk_fma_f32 v[210:211], v[210:211], v[24:25], v[158:159] op_sel_hi:[1,0,1]
  v_cvt_pk_bf16_f32 v192, v192, v193
  v_cvt_pk_bf16_f32 v193, v194, v195
  v_cvt_pk_bf16_f32 v194, v208, v209
  v_cvt_pk_bf16_f32 v195, v210, v211
  buffer_store_dwordx4 v[192:195], v54, s[4:7], s8 offen offset:0 sc1
  v_pk_mul_f32 v[152:153], v[40:41], v[26:27] op_sel:[0,1] op_sel_hi:[1,1]
  v_pk_mul_f32 v[154:155], v[42:43], v[26:27] op_sel:[0,1] op_sel_hi:[1,1]
  v_pk_mul_f32 v[156:157], v[44:45], v[26:27] op_sel:[0,1] op_sel_hi:[1,1]
  v_pk_mul_f32 v[158:159], v[46:47], v[26:27] op_sel:[0,1] op_sel_hi:[1,1]
  v_pk_fma_f32 v[196:197], v[196:197], v[26:27], v[152:153] op_sel_hi:[1,0,1]
  v_pk_fma_f32 v[198:199], v[198:199], v[26:27], v[154:155] op_sel_hi:[1,0,1]
  v_pk_fma_f32 v[212:213], v[212:213], v[26:27], v[156:157] op_sel_hi:[1,0,1]
  v_pk_fma_f32 v[214:215], v[214:215], v[26:27], v[158:159] op_sel_hi:[1,0,1]
  v_cvt_pk_bf16_f32 v196, v196, v197
  v_cvt_pk_bf16_f32 v197, v198, v199
  v_cvt_pk_bf16_f32 v198, v212, v213
  v_cvt_pk_bf16_f32 v199, v214, v215
  buffer_store_dwordx4 v[196:199], v54, s[4:7], s8 offen offset:128 sc1
  v_pk_mul_f32 v[152:153], v[40:41], v[28:29] op_sel:[0,1] op_sel_hi:[1,1]
  v_pk_mul_f32 v[154:155], v[42:43], v[28:29] op_sel:[0,1] op_sel_hi:[1,1]
  v_pk_mul_f32 v[156:157], v[44:45], v[28:29] op_sel:[0,1] op_sel_hi:[1,1]
  v_pk_mul_f32 v[158:159], v[46:47], v[28:29] op_sel:[0,1] op_sel_hi:[1,1]
  v_pk_fma_f32 v[200:201], v[200:201], v[28:29], v[152:153] op_sel_hi:[1,0,1]
  v_pk_fma_f32 v[202:203], v[202:203], v[28:29], v[154:155] op_sel_hi:[1,0,1]
  v_pk_fma_f32 v[216:217], v[216:217], v[28:29], v[156:157] op_sel_hi:[1,0,1]
  v_pk_fma_f32 v[218:219], v[218:219], v[28:29], v[158:159] op_sel_hi:[1,0,1]
  v_cvt_pk_bf16_f32 v200, v200, v201
  v_cvt_pk_bf16_f32 v201, v202, v203
  v_cvt_pk_bf16_f32 v202, v216, v217
  v_cvt_pk_bf16_f32 v203, v218, v219
  buffer_store_dwordx4 v[200:203], v54, s[4:7], s9 offen offset:0 sc1
  v_pk_mul_f32 v[152:153], v[40:41], v[30:31] op_sel:[0,1] op_sel_hi:[1,1]
  v_pk_mul_f32 v[154:155], v[42:43], v[30:31] op_sel:[0,1] op_sel_hi:[1,1]
  v_pk_mul_f32 v[156:157], v[44:45], v[30:31] op_sel:[0,1] op_sel_hi:[1,1]
  v_pk_mul_f32 v[158:159], v[46:47], v[30:31] op_sel:[0,1] op_sel_hi:[1,1]
  v_pk_fma_f32 v[204:205], v[204:205], v[30:31], v[152:153] op_sel_hi:[1,0,1]
  v_pk_fma_f32 v[206:207], v[206:207], v[30:31], v[154:155] op_sel_hi:[1,0,1]
  v_pk_fma_f32 v[220:221], v[220:221], v[30:31], v[156:157] op_sel_hi:[1,0,1]
  v_pk_fma_f32 v[222:223], v[222:223], v[30:31], v[158:159] op_sel_hi:[1,0,1]
  v_cvt_pk_bf16_f32 v204, v204, v205
  v_cvt_pk_bf16_f32 v205, v206, v207
  v_cvt_pk_bf16_f32 v206, v220, v221
  v_cvt_pk_bf16_f32 v207, v222, v223
  buffer_store_dwordx4 v[204:207], v54, s[4:7], s9 offen offset:128 sc1
  v_pk_mul_f32 v[152:153], v[80:81], v[48:49] op_sel:[0,0] op_sel_hi:[1,0]
  v_pk_mul_f32 v[154:155], v[82:83], v[48:49] op_sel:[0,0] op_sel_hi:[1,0]
  v_pk_mul_f32 v[156:157], v[84:85], v[48:49] op_sel:[0,0] op_sel_hi:[1,0]
  v_pk_mul_f32 v[158:159], v[86:87], v[48:49] op_sel:[0,0] op_sel_hi:[1,0]
  v_pk_fma_f32 v[224:225], v[224:225], v[64:65], v[152:153]
  v_pk_fma_f32 v[226:227], v[226:227], v[66:67], v[154:155]
  v_pk_fma_f32 v[228:229], v[228:229], v[68:69], v[156:157]
  v_pk_fma_f32 v[230:231], v[230:231], v[70:71], v[158:159]
  v_cvt_pk_bf16_f32 v224, v224, v225
  v_cvt_pk_bf16_f32 v225, v226, v227
  v_cvt_pk_bf16_f32 v226, v228, v229
  v_cvt_pk_bf16_f32 v227, v230, v231
  buffer_store_dwordx4 v[224:227], v55, s[4:7], s8 offen offset:2048 sc1
  v_pk_mul_f32 v[152:153], v[80:81], v[48:49] op_sel:[0,1] op_sel_hi:[1,1]
  v_pk_mul_f32 v[154:155], v[82:83], v[48:49] op_sel:[0,1] op_sel_hi:[1,1]
  v_pk_mul_f32 v[156:157], v[84:85], v[48:49] op_sel:[0,1] op_sel_hi:[1,1]
  v_pk_mul_f32 v[158:159], v[86:87], v[48:49] op_sel:[0,1] op_sel_hi:[1,1]
  v_pk_fma_f32 v[240:241], v[240:241], v[64:65], v[152:153]
  v_pk_fma_f32 v[242:243], v[242:243], v[66:67], v[154:155]
  v_pk_fma_f32 v[244:245], v[244:245], v[68:69], v[156:157]
  v_pk_fma_f32 v[246:247], v[246:247], v[70:71], v[158:159]
  v_cvt_pk_bf16_f32 v240, v240, v241
  v_cvt_pk_bf16_f32 v241, v242, v243
  v_cvt_pk_bf16_f32 v242, v244, v245
  v_cvt_pk_bf16_f32 v243, v246, v247
  buffer_store_dwordx4 v[240:243], v55, s[4:7], s8 offen offset:2304 sc1
  v_pk_mul_f32 v[152:153], v[88:89], v[48:49] op_sel:[0,0] op_sel_hi:[1,0]
  v_pk_mul_f32 v[154:155], v[90:91], v[48:49] op_sel:[0,0] op_sel_hi:[1,0]
  v_pk_mul_f32 v[156:157], v[92:93], v[48:49] op_sel:[0,0] op_sel_hi:[1,0]
  v_pk_mul_f32 v[158:159], v[94:95], v[48:49] op_sel:[0,0] op_sel_hi:[1,0]
  v_pk_fma_f32 v[232:233], v[232:233], v[72:73], v[152:153]
  v_pk_fma_f32 v[234:235], v[234:235], v[74:75], v[154:155]
  v_pk_fma_f32 v[236:237], v[236:237], v[76:77], v[156:157]
  v_pk_fma_f32 v[238:239], v[238:239], v[78:79], v[158:159]
  v_cvt_pk_bf16_f32 v232, v232, v233
  v_cvt_pk_bf16_f32 v233, v234, v235
  v_cvt_pk_bf16_f32 v234, v236, v237
  v_cvt_pk_bf16_f32 v235, v238, v239
  buffer_store_dwordx4 v[232:235], v55, s[4:7], s9 offen offset:2048 sc1
  v_pk_mul_f32 v[152:153], v[88:89], v[48:49] op_sel:[0,1] op_sel_hi:[1,1]
  v_pk_mul_f32 v[154:155], v[90:91], v[48:49] op_sel:[0,1] op_sel_hi:[1,1]
  v_pk_mul_f32 v[156:157], v[92:93], v[48:49] op_sel:[0,1] op_sel_hi:[1,1]
  v_pk_mul_f32 v[158:159], v[94:95], v[48:49] op_sel:[0,1] op_sel_hi:[1,1]
  v_pk_fma_f32 v[248:249], v[248:249], v[72:73], v[152:153]
  v_pk_fma_f32 v[250:251], v[250:251], v[74:75], v[154:155]
  v_pk_fma_f32 v[252:253], v[252:253], v[76:77], v[156:157]
  v_pk_fma_f32 v[254:255], v[254:255], v[78:79], v[158:159]
  v_cvt_pk_bf16_f32 v248, v248, v249
  v_cvt_pk_bf16_f32 v249, v250, v251
  v_cvt_pk_bf16_f32 v250, v252, v253
  v_cvt_pk_bf16_f32 v251, v254, v255
  buffer_store_dwordx4 v[248:251], v55, s[4:7], s9 offen offset:2304 sc1
  v_pk_mul_f32 v[24:25], v[24:25], v[56:57] op_sel_hi:[1,0]
  v_pk_mul_f32 v[26:27], v[26:27], v[56:57] op_sel_hi:[1,0]
  v_pk_mul_f32 v[28:29], v[28:29], v[56:57] op_sel_hi:[1,0]
  v_pk_mul_f32 v[30:31], v[30:31], v[56:57] op_sel_hi:[1,0]
  ds_write_b128 v59, v[192:195] offset:0
  ds_write_b128 v59, v[196:199] offset:128
  v_pk_mul_f32 v[152:153], v[32:33], v[24:25] op_sel:[0,1] op_sel_hi:[1,1]
  v_pk_mul_f32 v[154:155], v[34:35], v[24:25] op_sel:[0,1] op_sel_hi:[1,1]
  v_pk_mul_f32 v[156:157], v[36:37], v[24:25] op_sel:[0,1] op_sel_hi:[1,1]
  v_pk_mul_f32 v[158:159], v[38:39], v[24:25] op_sel:[0,1] op_sel_hi:[1,1]
  v_pk_fma_f32 v[160:161], v[160:161], v[24:25], v[152:153] op_sel_hi:[1,0,1]
  v_pk_fma_f32 v[162:163], v[162:163], v[24:25], v[154:155] op_sel_hi:[1,0,1]
  v_pk_fma_f32 v[176:177], v[176:177], v[24:25], v[156:157] op_sel_hi:[1,0,1]
  v_pk_fma_f32 v[178:179], v[178:179], v[24:25], v[158:159] op_sel_hi:[1,0,1]
  v_cvt_pk_bf16_f32 v160, v160, v161
  v_cvt_pk_bf16_f32 v161, v162, v163
  v_cvt_pk_bf16_f32 v162, v176, v177
  v_cvt_pk_bf16_f32 v163, v178, v179
  ds_write_b128 v61, v[160:163] offset:0
  ds_write_b128 v59, v[200:203] offset:4096
  ds_write_b128 v59, v[204:207] offset:4224
  v_pk_mul_f32 v[152:153], v[32:33], v[26:27] op_sel:[0,1] op_sel_hi:[1,1]
  v_pk_mul_f32 v[154:155], v[34:35], v[26:27] op_sel:[0,1] op_sel_hi:[1,1]
  v_pk_mul_f32 v[156:157], v[36:37], v[26:27] op_sel:[0,1] op_sel_hi:[1,1]
  v_pk_mul_f32 v[158:159], v[38:39], v[26:27] op_sel:[0,1] op_sel_hi:[1,1]
  v_pk_fma_f32 v[164:165], v[164:165], v[26:27], v[152:153] op_sel_hi:[1,0,1]
  v_pk_fma_f32 v[166:167], v[166:167], v[26:27], v[154:155] op_sel_hi:[1,0,1]
  v_pk_fma_f32 v[180:181], v[180:181], v[26:27], v[156:157] op_sel_hi:[1,0,1]
  v_pk_fma_f32 v[182:183], v[182:183], v[26:27], v[158:159] op_sel_hi:[1,0,1]
  v_cvt_pk_bf16_f32 v164, v164, v165
  v_cvt_pk_bf16_f32 v165, v166, v167
  v_cvt_pk_bf16_f32 v166, v180, v181
  v_cvt_pk_bf16_f32 v167, v182, v183
  ds_write_b128 v61, v[164:167] offset:256
  ds_write_b128 v60, v[224:227] offset:2048
  ds_write_b128 v60, v[240:243] offset:2304
  v_pk_mul_f32 v[152:153], v[32:33], v[28:29] op_sel:[0,1] op_sel_hi:[1,1]
  v_pk_mul_f32 v[154:155], v[34:35], v[28:29] op_sel:[0,1] op_sel_hi:[1,1]
  v_pk_mul_f32 v[156:157], v[36:37], v[28:29] op_sel:[0,1] op_sel_hi:[1,1]
  v_pk_mul_f32 v[158:159], v[38:39], v[28:29] op_sel:[0,1] op_sel_hi:[1,1]
  v_pk_fma_f32 v[168:169], v[168:169], v[28:29], v[152:153] op_sel_hi:[1,0,1]
  v_pk_fma_f32 v[170:171], v[170:171], v[28:29], v[154:155] op_sel_hi:[1,0,1]
  v_pk_fma_f32 v[184:185], v[184:185], v[28:29], v[156:157] op_sel_hi:[1,0,1]
  v_pk_fma_f32 v[186:187], v[186:187], v[28:29], v[158:159] op_sel_hi:[1,0,1]
  v_cvt_pk_bf16_f32 v168, v168, v169
  v_cvt_pk_bf16_f32 v169, v170, v171
  v_cvt_pk_bf16_f32 v170, v184, v185
  v_cvt_pk_bf16_f32 v171, v186, v187
  ds_write_b128 v61, v[168:171] offset:2048
  ds_write_b128 v60, v[232:235] offset:6144
  ds_write_b128 v60, v[248:251] offset:6400
  v_pk_mul_f32 v[152:153], v[32:33], v[30:31] op_sel:[0,1] op_sel_hi:[1,1]
  v_pk_mul_f32 v[154:155], v[34:35], v[30:31] op_sel:[0,1] op_sel_hi:[1,1]
  v_pk_mul_f32 v[156:157], v[36:37], v[30:31] op_sel:[0,1] op_sel_hi:[1,1]
  v_pk_mul_f32 v[158:159], v[38:39], v[30:31] op_sel:[0,1] op_sel_hi:[1,1]
  v_pk_fma_f32 v[172:173], v[172:173], v[30:31], v[152:153] op_sel_hi:[1,0,1]
  v_pk_fma_f32 v[174:175], v[174:175], v[30:31], v[154:155] op_sel_hi:[1,0,1]
  v_pk_fma_f32 v[188:189], v[188:189], v[30:31], v[156:157] op_sel_hi:[1,0,1]
  v_pk_fma_f32 v[190:191], v[190:191], v[30:31], v[158:159] op_sel_hi:[1,0,1]
  v_cvt_pk_bf16_f32 v172, v172, v173
  v_cvt_pk_bf16_f32 v173, v174, v175
  v_cvt_pk_bf16_f32 v174, v188, v189
  v_cvt_pk_bf16_f32 v175, v190, v191
  ds_write_b128 v61, v[172:175] offset:2304
.g2_kernel_q_kd:
  s_mov_b64 exec, 1
  ds_add_u32 v13, v5 offset:4
  s_mov_b64 exec, -1
  v_mov_b32 v120, 0
  v_mov_b32 v121, 0
  v_mov_b32 v124, 0
  v_mov_b32 v125, 0
  v_mov_b32 v128, 0
  v_mov_b32 v129, 0
  v_mov_b32 v132, 0
  v_mov_b32 v133, 0
  s_cmp_lg_u32 s62, 0
  s_cbranch_scc1 .g2_kernel_r2
  global_load_dwordx4 v[240:243], v23, s[74:75] offset:0
  global_load_dwordx4 v[244:247], v23, s[74:75] offset:32
  global_load_dwordx4 v[248:251], v23, s[74:75] offset:64
  global_load_dwordx4 v[252:255], v23, s[74:75] offset:96
.g2_kernel_r3:
  v_mov_b32 v6, s71
  s_mov_b32 s38, 0
.g2_kernel_wg2:
  ds_read_b32 v7, v6 offset:4
  s_add_u32 s38, s38, 1
  s_waitcnt lgkmcnt(0)
  v_cmp_le_u32 vcc, 4, v7
  s_cbranch_vccnz .g2_kernel_wg2d
  s_cmp_lt_u32 s38, 524288
  s_cbranch_scc1 .g2_kernel_wg2
.g2_kernel_wg2d:
  ds_read_b128 v[176:179], v9 offset:0
  ds_read_b128 v[180:183], v9 offset:1024
  ds_read_b128 v[24:27], v14 offset:8192
  ds_read_b128 v[28:31], v14 offset:9216
  ds_read_b128 v[184:187], v9 offset:2048
  ds_read_b128 v[188:191], v9 offset:3072
  ds_read_b128 v[32:35], v14 offset:10240
  ds_read_b128 v[36:39], v14 offset:11264
  ds_read_b128 v[40:43], v14 offset:12288
  ds_read_b128 v[44:47], v14 offset:13312
  ds_read_b128 v[48:51], v14 offset:14336
  ds_read_b128 v[52:55], v14 offset:15360
  s_cmp_lg_u32 s35, 0
  s_cbranch_scc1 .g2_kernel_a_own
  s_waitcnt lgkmcnt(8)
.g2_kernel_a_ob:
  v_mfma_f32_32x32x16_bf16 v[136:151], v[176:179], v[24:27], 0
  v_mfma_f32_32x32x16_bf16 v[136:151], v[180:183], v[28:31], v[136:151]
  s_waitcnt lgkmcnt(0)
  s_nop 7
  v_mfma_f32_32x32x16_bf16 v[152:167], v[176:179], v[32:35], 0
  s_waitcnt vmcnt(4)
  s_mov_b64 exec, 1
  buffer_store_dword v15, v4, s[4:7], s37 offen sc1
  s_mov_b64 exec, -1
  v_exp_f32 v136, v136
  v_exp_f32 v137, v137
  v_exp_f32 v138, v138
  v_exp_f32 v139, v139
  v_exp_f32 v140, v140
  v_exp_f32 v141, v141
  v_exp_f32 v142, v142
  v_exp_f32 v143, v143
  v_mfma_f32_32x32x16_bf16 v[152:167], v[180:183], v[36:39], v[152:167]
  s_mov_b64 exec, 1
  ds_add_u32 v13, v5 offset:8
  s_mov_b64 exec, -1
  v_cvt_pk_bf16_f32 v168, v136, v137
  v_cvt_pk_bf16_f32 v169, v138, v139
  v_cvt_pk_bf16_f32 v170, v140, v141
  v_cvt_pk_bf16_f32 v171, v142, v143
  v_exp_f32 v144, v144
  v_exp_f32 v145, v145
  v_exp_f32 v146, v146
  v_exp_f32 v147, v147
  v_mfma_f32_32x32x16_bf16 v[56:71], v[184:187], v[168:171], 0
  v_exp_f32 v148, v148
  v_exp_f32 v149, v149
  v_exp_f32 v150, v150
  v_exp_f32 v151, v151
  v_cvt_pk_bf16_f32 v172, v144, v145
  v_cvt_pk_bf16_f32 v173, v146, v147
  v_cvt_pk_bf16_f32 v174, v148, v149
  v_cvt_pk_bf16_f32 v175, v150, v151
  v_mfma_f32_32x32x16_bf16 v[136:151], v[176:179], v[40:43], 0
  v_exp_f32 v152, v152
  v_exp_f32 v153, v153
  v_exp_f32 v154, v154
  v_mfma_f32_32x32x16_bf16 v[56:71], v[188:191], v[172:175], v[56:71]
  v_exp_f32 v155, v155
  v_exp_f32 v156, v156
  v_exp_f32 v157, v157
  v_smfmac_f32_16x16x64_bf16 v[120:123], v[16:19], v[168:175], v20
  v_exp_f32 v158, v158
  v_exp_f32 v159, v159
  v_mfma_f32_32x32x16_bf16 v[136:151], v[180:183], v[44:47], v[136:151]
  v_cvt_pk_bf16_f32 v168, v152, v153
  v_cvt_pk_bf16_f32 v169, v154, v155
  v_cvt_pk_bf16_f32 v170, v156, v157
  v_cvt_pk_bf16_f32 v171, v158, v159
  v_exp_f32 v160, v160
  v_exp_f32 v161, v161
  v_exp_f32 v162, v162
  v_exp_f32 v163, v163
  v_mfma_f32_32x32x16_bf16 v[72:87], v[184:187], v[168:171], 0
  v_exp_f32 v164, v164
  v_exp_f32 v165, v165
  v_exp_f32 v166, v166
  v_exp_f32 v167, v167
  v_cvt_pk_bf16_f32 v172, v160, v161
  v_cvt_pk_bf16_f32 v173, v162, v163
  v_cvt_pk_bf16_f32 v174, v164, v165
  v_cvt_pk_bf16_f32 v175, v166, v167
  v_mfma_f32_32x32x16_bf16 v[152:167], v[176:179], v[48:51], 0
  ds_read_b32 v7, v8
  v_exp_f32 v136, v136
  v_exp_f32 v137, v137
  v_exp_f32 v138, v138
  v_mfma_f32_32x32x16_bf16 v[72:87], v[188:191], v[172:175], v[72:87]
  s_lshl_b32 s28, s16, 11
  v_exp_f32 v139, v139
  v_exp_f32 v140, v140
  v_exp_f32 v141, v141
  v_smfmac_f32_16x16x64_bf16 v[124:127], v[16:19], v[168:175], v20
  v_add_u32 v9, s28, v3
  v_exp_f32 v142, v142
  v_exp_f32 v143, v143
  v_mfma_f32_32x32x16_bf16 v[152:167], v[180:183], v[52:55], v[152:167]
  s_waitcnt lgkmcnt(0)
  v_cmp_lt_u32 vcc, s62, v7
  v_cvt_pk_bf16_f32 v168, v136, v137
  v_cvt_pk_bf16_f32 v169, v138, v139
  v_cvt_pk_bf16_f32 v170, v140, v141
  v_cvt_pk_bf16_f32 v171, v142, v143
  v_exp_f32 v144, v144
  v_exp_f32 v145, v145
  v_exp_f32 v146, v146
  v_exp_f32 v147, v147
  v_mfma_f32_32x32x16_bf16 v[88:103], v[184:187], v[168:171], 0
  s_mov_b32 s36, vcc_lo
  s_andn2_b32 s33, s36, s34
  v_exp_f32 v148, v148
  v_exp_f32 v149, v149
  v_exp_f32 v150, v150
  v_exp_f32 v151, v151
  v_cvt_pk_bf16_f32 v172, v144, v145
  v_cvt_pk_bf16_f32 v173, v146, v147
  v_cvt_pk_bf16_f32 v174, v148, v149
  v_cvt_pk_bf16_f32 v175, v150, v151
  v_exp_f32 v152, v152
  v_exp_f32 v153, v153
  v_exp_f32 v154, v154
  v_mfma_f32_32x32x16_bf16 v[88:103], v[188:191], v[172:175], v[88:103]
  s_bcnt1_i32_b32 s39, s33
  s_cmp_lt_u32 s39, 3
  v_exp_f32 v155, v155
  v_exp_f32 v156, v156
  v_exp_f32 v157, v157
  v_smfmac_f32_16x16x64_bf16 v[128:131], v[16:19], v[168:175], v20
  s_cbranch_scc1 .g2_kernel_a_F0n
  s_call_b64 s[72:73], .g2_kernel_a_three
.g2_kernel_a_F0n:
  v_exp_f32 v158, v158
  v_exp_f32 v159, v159
  v_cvt_pk_bf16_f32 v168, v152, v153
  v_cvt_pk_bf16_f32 v169, v154, v155
  v_cvt_pk_bf16_f32 v170, v156, v157
  v_cvt_pk_bf16_f32 v171, v158, v159
  v_exp_f32 v160, v160
  v_exp_f32 v161, v161
  v_exp_f32 v162, v162
  v_exp_f32 v163, v163
  v_mfma_f32_32x32x16_bf16 v[104:119], v[184:187], v[168:171], 0
  v_exp_f32 v164, v164
  v_exp_f32 v165, v165
  v_exp_f32 v166, v166
  v_exp_f32 v167, v167
  v_cvt_pk_bf16_f32 v172, v160, v161
  v_cvt_pk_bf16_f32 v173, v162, v163
  v_cvt_pk_bf16_f32 v174, v164, v165
  v_cvt_pk_bf16_f32 v175, v166, v167
  s_add_u32 s39, s39, s35
  s_cmp_ge_u32 s39, 3
  s_cbranch_scc1 .g2_kernel_a_p1
  s_call_b64 s[72:73], .g2_kernel_a_three
.g2_kernel_a_p1:
  s_waitcnt vmcnt(10)
  v_mfma_f32_32x32x16_bf16 v[136:151], v[192:195], v[24:27], 0
  v_mfma_f32_32x32x16_bf16 v[136:151], v[196:199], v[28:31], v[136:151]
  s_waitcnt vmcnt(8)
  s_mov_b32 s32, 0
  s_nop 8
  s_branch .g2_kernel_a_n1
  .p2align 6
.g2_kernel_a_loop:
  v_mfma_f32_32x32x16_bf16 v[152:167], v[176:179], v[32:35], 0
  s_andn2_b32 s33, s36, s34
  v_exp_f32 v136, v136
  v_exp_f32 v137, v137
  v_exp_f32 v138, v138
  v_mfma_f32_32x32x16_bf16 v[104:119], v[236:239], v[172:175], v[104:119]
  s_cbranch_scc0 .g2_kernel_a_N0c
.g2_kernel_a_N0b:
  v_exp_f32 v139, v139
  v_exp_f32 v140, v140
  v_exp_f32 v141, v141
  v_smfmac_f32_16x16x64_bf16 v[132:135], v[16:19], v[168:175], v20
  s_ff1_i32_b32 s33, s33
  v_exp_f32 v142, v142
  v_exp_f32 v143, v143
  v_mfma_f32_32x32x16_bf16 v[152:167], v[180:183], v[36:39], v[152:167]
  s_bitset1_b32 s34, s33
  v_cvt_pk_bf16_f32 v168, v136, v137
  v_cvt_pk_bf16_f32 v169, v138, v139
  v_cvt_pk_bf16_f32 v170, v140, v141
  v_cvt_pk_bf16_f32 v171, v142, v143
  v_exp_f32 v144, v144
  v_exp_f32 v145, v145
  v_exp_f32 v146, v146
  v_exp_f32 v147, v147
  v_mfma_f32_32x32x16_bf16 v[56:71], v[184:187], v[168:171], v[56:71]
  s_xor_b32 s33, s33, s24
  v_exp_f32 v148, v148
  v_exp_f32 v149, v149
  v_exp_f32 v150, v150
  v_exp_f32 v151, v151
  v_cvt_pk_bf16_f32 v172, v144, v145
  v_cvt_pk_bf16_f32 v173, v146, v147
  v_cvt_pk_bf16_f32 v174, v148, v149
  v_cvt_pk_bf16_f32 v175, v150, v151
  v_mfma_f32_32x32x16_bf16 v[136:151], v[176:179], v[40:43], 0
  s_lshl_b32 s33, s33, s25
  v_exp_f32 v152, v152
  v_exp_f32 v153, v153
  v_exp_f32 v154, v154
  v_mfma_f32_32x32x16_bf16 v[56:71], v[188:191], v[172:175], v[56:71]
  s_add_u32 s22, s20, s33
  v_exp_f32 v155, v155
  v_exp_f32 v156, v156
  v_exp_f32 v157, v157
  v_smfmac_f32_16x16x64_bf16 v[120:123], v[16:19], v[168:175], v20
  s_addc_u32 s23, s21, 0
  v_exp_f32 v158, v158
  v_exp_f32 v159, v159
  v_mfma_f32_32x32x16_bf16 v[136:151], v[180:183], v[44:47], v[136:151]
  v_cvt_pk_bf16_f32 v168, v152, v153
  v_cvt_pk_bf16_f32 v169, v154, v155
  v_cvt_pk_bf16_f32 v170, v156, v157
  v_cvt_pk_bf16_f32 v171, v158, v159
  v_exp_f32 v160, v160
  v_exp_f32 v161, v161
  v_exp_f32 v162, v162
  v_exp_f32 v163, v163
  v_mfma_f32_32x32x16_bf16 v[72:87], v[184:187], v[168:171], v[72:87]
  v_exp_f32 v164, v164
  v_exp_f32 v165, v165
  v_exp_f32 v166, v166
  v_exp_f32 v167, v167
  v_cvt_pk_bf16_f32 v172, v160, v161
  v_cvt_pk_bf16_f32 v173, v162, v163
  v_cvt_pk_bf16_f32 v174, v164, v165
  v_cvt_pk_bf16_f32 v175, v166, v167
  v_mfma_f32_32x32x16_bf16 v[152:167], v[176:179], v[48:51], 0
  v_exp_f32 v136, v136
  v_exp_f32 v137, v137
  v_exp_f32 v138, v138
  v_mfma_f32_32x32x16_bf16 v[72:87], v[188:191], v[172:175], v[72:87]
  v_exp_f32 v139, v139
  v_exp_f32 v140, v140
  v_exp_f32 v141, v141
  v_smfmac_f32_16x16x64_bf16 v[124:127], v[16:19], v[168:175], v20
  global_load_dwordx4 v[224:227], v3, s[22:23] offset:0
  global_load_dwordx4 v[228:231], v3, s[22:23] offset:1024
  global_load_dwordx4 v[232:235], v3, s[22:23] offset:2048
  global_load_dwordx4 v[236:239], v3, s[22:23] offset:3072
  v_exp_f32 v142, v142
  v_exp_f32 v143, v143
  v_mfma_f32_32x32x16_bf16 v[152:167], v[180:183], v[52:55], v[152:167]
  v_cvt_pk_bf16_f32 v168, v136, v137
  v_cvt_pk_bf16_f32 v169, v138, v139
  v_cvt_pk_bf16_f32 v170, v140, v141
  v_cvt_pk_bf16_f32 v171, v142, v143
  v_exp_f32 v144, v144
  v_exp_f32 v145, v145
  v_exp_f32 v146, v146
  v_exp_f32 v147, v147
  v_mfma_f32_32x32x16_bf16 v[88:103], v[184:187], v[168:171], v[88:103]
  s_waitcnt vmcnt(8)
  v_exp_f32 v148, v148
  v_exp_f32 v149, v149
  v_exp_f32 v150, v150
  v_exp_f32 v151, v151
  v_cvt_pk_bf16_f32 v172, v144, v145
  v_cvt_pk_bf16_f32 v173, v146, v147
  v_cvt_pk_bf16_f32 v174, v148, v149
  v_cvt_pk_bf16_f32 v175, v150, v151
  v_mfma_f32_32x32x16_bf16 v[136:151], v[192:195], v[24:27], 0
  v_exp_f32 v152, v152
  v_exp_f32 v153, v153
  v_exp_f32 v154, v154
  v_mfma_f32_32x32x16_bf16 v[88:103], v[188:191], v[172:175], v[88:103]
  v_exp_f32 v155, v155
  v_exp_f32 v156, v156
  v_exp_f32 v157, v157
  v_smfmac_f32_16x16x64_bf16 v[128:131], v[16:19], v[168:175], v20
  v_exp_f32 v158, v158
  v_exp_f32 v159, v159
  v_mfma_f32_32x32x16_bf16 v[136:151], v[196:199], v[28:31], v[136:151]
  v_cvt_pk_bf16_f32 v168, v152, v153
  v_cvt_pk_bf16_f32 v169, v154, v155
  v_cvt_pk_bf16_f32 v170, v156, v157
  v_cvt_pk_bf16_f32 v171, v158, v159
  v_exp_f32 v160, v160
  v_exp_f32 v161, v161
  v_exp_f32 v162, v162
  v_exp_f32 v163, v163
  v_mfma_f32_32x32x16_bf16 v[104:119], v[184:187], v[168:171], v[104:119]
  v_exp_f32 v164, v164
  v_exp_f32 v165, v165
  v_exp_f32 v166, v166
  v_exp_f32 v167, v167
  v_cvt_pk_bf16_f32 v172, v160, v161
  v_cvt_pk_bf16_f32 v173, v162, v163
  v_cvt_pk_bf16_f32 v174, v164, v165
  v_cvt_pk_bf16_f32 v175, v166, v167
.g2_kernel_a_n1:
  v_mfma_f32_32x32x16_bf16 v[152:167], v[192:195], v[32:35], 0
  s_andn2_b32 s33, s36, s34
  v_exp_f32 v136, v136
  v_exp_f32 v137, v137
  v_exp_f32 v138, v138
  v_mfma_f32_32x32x16_bf16 v[104:119], v[188:191], v[172:175], v[104:119]
  s_cbranch_scc0 .g2_kernel_a_N1c
.g2_kernel_a_N1b:
  v_exp_f32 v139, v139
  v_exp_f32 v140, v140
  v_exp_f32 v141, v141
  v_smfmac_f32_16x16x64_bf16 v[132:135], v[16:19], v[168:175], v20
  s_ff1_i32_b32 s33, s33
  v_exp_f32 v142, v142
  v_exp_f32 v143, v143
  v_mfma_f32_32x32x16_bf16 v[152:167], v[196:199], v[36:39], v[152:167]
  s_bitset1_b32 s34, s33
  v_cvt_pk_bf16_f32 v168, v136, v137
  v_cvt_pk_bf16_f32 v169, v138, v139
  v_cvt_pk_bf16_f32 v170, v140, v141
  v_cvt_pk_bf16_f32 v171, v142, v143
  v_exp_f32 v144, v144
  v_exp_f32 v145, v145
  v_exp_f32 v146, v146
  v_exp_f32 v147, v147
  v_mfma_f32_32x32x16_bf16 v[56:71], v[200:203], v[168:171], v[56:71]
  s_xor_b32 s33, s33, s24
  v_exp_f32 v148, v148
  v_exp_f32 v149, v149
  v_exp_f32 v150, v150
  v_exp_f32 v151, v151
  v_cvt_pk_bf16_f32 v172, v144, v145
  v_cvt_pk_bf16_f32 v173, v146, v147
  v_cvt_pk_bf16_f32 v174, v148, v149
  v_cvt_pk_bf16_f32 v175, v150, v151
  v_mfma_f32_32x32x16_bf16 v[136:151], v[192:195], v[40:43], 0
  s_lshl_b32 s33, s33, s25
  v_exp_f32 v152, v152
  v_exp_f32 v153, v153
  v_exp_f32 v154, v154
  v_mfma_f32_32x32x16_bf16 v[56:71], v[204:207], v[172:175], v[56:71]
  s_add_u32 s22, s20, s33
  v_exp_f32 v155, v155
  v_exp_f32 v156, v156
  v_exp_f32 v157, v157
  v_smfmac_f32_16x16x64_bf16 v[120:123], v[16:19], v[168:175], v20
  s_addc_u32 s23, s21, 0
  v_exp_f32 v158, v158
  v_exp_f32 v159, v159
  v_mfma_f32_32x32x16_bf16 v[136:151], v[196:199], v[44:47], v[136:151]
  v_cvt_pk_bf16_f32 v168, v152, v153
  v_cvt_pk_bf16_f32 v169, v154, v155
  v_cvt_pk_bf16_f32 v170, v156, v157
  v_cvt_pk_bf16_f32 v171, v158, v159
  v_exp_f32 v160, v160
  v_exp_f32 v161, v161
  v_exp_f32 v162, v162
  v_exp_f32 v163, v163
  v_mfma_f32_32x32x16_bf16 v[72:87], v[200:203], v[168:171], v[72:87]
  v_exp_f32 v164, v164
  v_exp_f32 v165, v165
  v_exp_f32 v166, v166
  v_exp_f32 v167, v167
  v_cvt_pk_bf16_f32 v172, v160, v161
  v_cvt_pk_bf16_f32 v173, v162, v163
  v_cvt_pk_bf16_f32 v174, v164, v165
  v_cvt_pk_bf16_f32 v175, v166, v167
  v_mfma_f32_32x32x16_bf16 v[152:167], v[192:195], v[48:51], 0
  v_exp_f32 v136, v136
  v_exp_f32 v137, v137
  v_exp_f32 v138, v138
  v_mfma_f32_32x32x16_bf16 v[72:87], v[204:207], v[172:175], v[72:87]
  v_exp_f32 v139, v139
  v_exp_f32 v140, v140
  v_exp_f32 v141, v141
  v_smfmac_f32_16x16x64_bf16 v[124:127], v[16:19], v[168:175], v20
  global_load_dwordx4 v[176:179], v3, s[22:23] offset:0
  global_load_dwordx4 v[180:183], v3, s[22:23] offset:1024
  global_load_dwordx4 v[184:187], v3, s[22:23] offset:2048
  global_load_dwordx4 v[188:191], v3, s[22:23] offset:3072
  v_exp_f32 v142, v142
  v_exp_f32 v143, v143
  v_mfma_f32_32x32x16_bf16 v[152:167], v[196:199], v[52:55], v[152:167]
  v_cvt_pk_bf16_f32 v168, v136, v137
  v_cvt_pk_bf16_f32 v169, v138, v139
  v_cvt_pk_bf16_f32 v170, v140, v141
  v_cvt_pk_bf16_f32 v171, v142, v143
  v_exp_f32 v144, v144
  v_exp_f32 v145, v145
  v_exp_f32 v146, v146
  v_exp_f32 v147, v147
  v_mfma_f32_32x32x16_bf16 v[88:103], v[200:203], v[168:171], v[88:103]
  s_waitcnt vmcnt(8)
  v_exp_f32 v148, v148
  v_exp_f32 v149, v149
  v_exp_f32 v150, v150
  v_exp_f32 v151, v151
  v_cvt_pk_bf16_f32 v172, v144, v145
  v_cvt_pk_bf16_f32 v173, v146, v147
  v_cvt_pk_bf16_f32 v174, v148, v149
  v_cvt_pk_bf16_f32 v175, v150, v151
  v_mfma_f32_32x32x16_bf16 v[136:151], v[208:211], v[24:27], 0
  v_exp_f32 v152, v152
  v_exp_f32 v153, v153
  v_exp_f32 v154, v154
  v_mfma_f32_32x32x16_bf16 v[88:103], v[204:207], v[172:175], v[88:103]
  v_exp_f32 v155, v155
  v_exp_f32 v156, v156
  v_exp_f32 v157, v157
  v_smfmac_f32_16x16x64_bf16 v[128:131], v[16:19], v[168:175], v20
  v_exp_f32 v158, v158
  v_exp_f32 v159, v159
  v_mfma_f32_32x32x16_bf16 v[136:151], v[212:215], v[28:31], v[136:151]
  v_cvt_pk_bf16_f32 v168, v152, v153
  v_cvt_pk_bf16_f32 v169, v154, v155
  v_cvt_pk_bf16_f32 v170, v156, v157
  v_cvt_pk_bf16_f32 v171, v158, v159
  v_exp_f32 v160, v160
  v_exp_f32 v161, v161
  v_exp_f32 v162, v162
  v_exp_f32 v163, v163
  v_mfma_f32_32x32x16_bf16 v[104:119], v[200:203], v[168:171], v[104:119]
  v_exp_f32 v164, v164
  v_exp_f32 v165, v165
  v_exp_f32 v166, v166
  v_exp_f32 v167, v167
  v_cvt_pk_bf16_f32 v172, v160, v161
  v_cvt_pk_bf16_f32 v173, v162, v163
  v_cvt_pk_bf16_f32 v174, v164, v165
  v_cvt_pk_bf16_f32 v175, v166, v167
  v_mfma_f32_32x32x16_bf16 v[152:167], v[208:211], v[32:35], 0
  s_andn2_b32 s33, s36, s34
  v_exp_f32 v136, v136
  v_exp_f32 v137, v137
  v_exp_f32 v138, v138
  v_mfma_f32_32x32x16_bf16 v[104:119], v[204:207], v[172:175], v[104:119]
  s_cbranch_scc0 .g2_kernel_a_N2c
.g2_kernel_a_N2b:
  v_exp_f32 v139, v139
  v_exp_f32 v140, v140
  v_exp_f32 v141, v141
  v_smfmac_f32_16x16x64_bf16 v[132:135], v[16:19], v[168:175], v20
  s_ff1_i32_b32 s33, s33
  v_exp_f32 v142, v142
  v_exp_f32 v143, v143
  v_mfma_f32_32x32x16_bf16 v[152:167], v[212:215], v[36:39], v[152:167]
  s_bitset1_b32 s34, s33
  v_cvt_pk_bf16_f32 v168, v136, v137
  v_cvt_pk_bf16_f32 v169, v138, v139
  v_cvt_pk_bf16_f32 v170, v140, v141
  v_cvt_pk_bf16_f32 v171, v142, v143
  v_exp_f32 v144, v144
  v_exp_f32 v145, v145
  v_exp_f32 v146, v146
  v_exp_f32 v147, v147
  v_mfma_f32_32x32x16_bf16 v[56:71], v[216:219], v[168:171], v[56:71]
  s_xor_b32 s33, s33, s24
  v_exp_f32 v148, v148
  v_exp_f32 v149, v149
  v_exp_f32 v150, v150
  v_exp_f32 v151, v151
  v_cvt_pk_bf16_f32 v172, v144, v145
  v_cvt_pk_bf16_f32 v173, v146, v147
  v_cvt_pk_bf16_f32 v174, v148, v149
  v_cvt_pk_bf16_f32 v175, v150, v151
  v_mfma_f32_32x32x16_bf16 v[136:151], v[208:211], v[40:43], 0
  s_lshl_b32 s33, s33, s25
  v_exp_f32 v152, v152
  v_exp_f32 v153, v153
  v_exp_f32 v154, v154
  v_mfma_f32_32x32x16_bf16 v[56:71], v[220:223], v[172:175], v[56:71]
  s_add_u32 s22, s20, s33
  v_exp_f32 v155, v155
  v_exp_f32 v156, v156
  v_exp_f32 v157, v157
  v_smfmac_f32_16x16x64_bf16 v[120:123], v[16:19], v[168:175], v20
  s_addc_u32 s23, s21, 0
  v_exp_f32 v158, v158
  v_exp_f32 v159, v159
  v_mfma_f32_32x32x16_bf16 v[136:151], v[212:215], v[44:47], v[136:151]
  v_cvt_pk_bf16_f32 v168, v152, v153
  v_cvt_pk_bf16_f32 v169, v154, v155
  v_cvt_pk_bf16_f32 v170, v156, v157
  v_cvt_pk_bf16_f32 v171, v158, v159
  v_exp_f32 v160, v160
  v_exp_f32 v161, v161
  v_exp_f32 v162, v162
  v_exp_f32 v163, v163
  v_mfma_f32_32x32x16_bf16 v[72:87], v[216:219], v[168:171], v[72:87]
  v_exp_f32 v164, v164
  v_exp_f32 v165, v165
  v_exp_f32 v166, v166
  v_exp_f32 v167, v167
  v_cvt_pk_bf16_f32 v172, v160, v161
  v_cvt_pk_bf16_f32 v173, v162, v163
  v_cvt_pk_bf16_f32 v174, v164, v165
  v_cvt_pk_bf16_f32 v175, v166, v167
  v_mfma_f32_32x32x16_bf16 v[152:167], v[208:211], v[48:51], 0
  v_exp_f32 v136, v136
  v_exp_f32 v137, v137
  v_exp_f32 v138, v138
  v_mfma_f32_32x32x16_bf16 v[72:87], v[220:223], v[172:175], v[72:87]
  v_exp_f32 v139, v139
  v_exp_f32 v140, v140
  v_exp_f32 v141, v141
  v_smfmac_f32_16x16x64_bf16 v[124:127], v[16:19], v[168:175], v20
  global_load_dwordx4 v[192:195], v3, s[22:23] offset:0
  global_load_dwordx4 v[196:199], v3, s[22:23] offset:1024
  global_load_dwordx4 v[200:203], v3, s[22:23] offset:2048
  global_load_dwordx4 v[204:207], v3, s[22:23] offset:3072
  v_exp_f32 v142, v142
  v_exp_f32 v143, v143
  v_mfma_f32_32x32x16_bf16 v[152:167], v[212:215], v[52:55], v[152:167]
  v_cvt_pk_bf16_f32 v168, v136, v137
  v_cvt_pk_bf16_f32 v169, v138, v139
  v_cvt_pk_bf16_f32 v170, v140, v141
  v_cvt_pk_bf16_f32 v171, v142, v143
  v_exp_f32 v144, v144
  v_exp_f32 v145, v145
  v_exp_f32 v146, v146
  v_exp_f32 v147, v147
  v_mfma_f32_32x32x16_bf16 v[88:103], v[216:219], v[168:171], v[88:103]
  s_waitcnt vmcnt(8)
  v_exp_f32 v148, v148
  v_exp_f32 v149, v149
  v_exp_f32 v150, v150
  v_exp_f32 v151, v151
  v_cvt_pk_bf16_f32 v172, v144, v145
  v_cvt_pk_bf16_f32 v173, v146, v147
  v_cvt_pk_bf16_f32 v174, v148, v149
  v_cvt_pk_bf16_f32 v175, v150, v151
  v_mfma_f32_32x32x16_bf16 v[136:151], v[224:227], v[24:27], 0
  v_exp_f32 v152, v152
  v_exp_f32 v153, v153
  v_exp_f32 v154, v154
  v_mfma_f32_32x32x16_bf16 v[88:103], v[220:223], v[172:175], v[88:103]
  v_exp_f32 v155, v155
  v_exp_f32 v156, v156
  v_exp_f32 v157, v157
  v_smfmac_f32_16x16x64_bf16 v[128:131], v[16:19], v[168:175], v20
  v_exp_f32 v158, v158
  v_exp_f32 v159, v159
  v_mfma_f32_32x32x16_bf16 v[136:151], v[228:231], v[28:31], v[136:151]
  s_and_b32 s28, s32, 3
  v_cvt_pk_bf16_f32 v168, v152, v153
  v_cvt_pk_bf16_f32 v169, v154, v155
  v_cvt_pk_bf16_f32 v170, v156, v157
  v_cvt_pk_bf16_f32 v171, v158, v159
  v_exp_f32 v160, v160
  v_exp_f32 v161, v161
  v_exp_f32 v162, v162
  v_exp_f32 v163, v163
  v_mfma_f32_32x32x16_bf16 v[104:119], v[216:219], v[168:171], v[104:119]
  s_cmp_eq_u32 s28, 3
  v_exp_f32 v164, v164
  v_exp_f32 v165, v165
  v_exp_f32 v166, v166
  v_exp_f32 v167, v167
  v_cvt_pk_bf16_f32 v172, v160, v161
  v_cvt_pk_bf16_f32 v173, v162, v163
  v_cvt_pk_bf16_f32 v174, v164, v165
  v_cvt_pk_bf16_f32 v175, v166, v167
  s_cbranch_scc1 .g2_kernel_a_last
  v_mfma_f32_32x32x16_bf16 v[152:167], v[224:227], v[32:35], 0
  s_andn2_b32 s33, s36, s34
  v_exp_f32 v136, v136
  v_exp_f32 v137, v137
  v_exp_f32 v138, v138
  v_mfma_f32_32x32x16_bf16 v[104:119], v[220:223], v[172:175], v[104:119]
  s_cbranch_scc0 .g2_kernel_a_N3c
.g2_kernel_a_N3b:
  v_exp_f32 v139, v139
  v_exp_f32 v140, v140
  v_exp_f32 v141, v141
  v_smfmac_f32_16x16x64_bf16 v[132:135], v[16:19], v[168:175], v20
  s_ff1_i32_b32 s33, s33
  v_exp_f32 v142, v142
  v_exp_f32 v143, v143
  v_mfma_f32_32x32x16_bf16 v[152:167], v[228:231], v[36:39], v[152:167]
  s_bitset1_b32 s34, s33
  v_cvt_pk_bf16_f32 v168, v136, v137
  v_cvt_pk_bf16_f32 v169, v138, v139
  v_cvt_pk_bf16_f32 v170, v140, v141
  v_cvt_pk_bf16_f32 v171, v142, v143
  v_exp_f32 v144, v144
  v_exp_f32 v145, v145
  v_exp_f32 v146, v146
  v_exp_f32 v147, v147
  v_mfma_f32_32x32x16_bf16 v[56:71], v[232:235], v[168:171], v[56:71]
  s_xor_b32 s33, s33, s24
  v_exp_f32 v148, v148
  v_exp_f32 v149, v149
  v_exp_f32 v150, v150
  v_exp_f32 v151, v151
  v_cvt_pk_bf16_f32 v172, v144, v145
  v_cvt_pk_bf16_f32 v173, v146, v147
  v_cvt_pk_bf16_f32 v174, v148, v149
  v_cvt_pk_bf16_f32 v175, v150, v151
  v_mfma_f32_32x32x16_bf16 v[136:151], v[224:227], v[40:43], 0
  s_lshl_b32 s33, s33, s25
  v_exp_f32 v152, v152
  v_exp_f32 v153, v153
  v_exp_f32 v154, v154
  v_mfma_f32_32x32x16_bf16 v[56:71], v[236:239], v[172:175], v[56:71]
  s_add_u32 s22, s20, s33
  v_exp_f32 v155, v155
  v_exp_f32 v156, v156
  v_exp_f32 v157, v157
  v_smfmac_f32_16x16x64_bf16 v[120:123], v[16:19], v[168:175], v20
  s_addc_u32 s23, s21, 0
  v_exp_f32 v158, v158
  v_exp_f32 v159, v159
  v_mfma_f32_32x32x16_bf16 v[136:151], v[228:231], v[44:47], v[136:151]
  v_cvt_pk_bf16_f32 v168, v152, v153
  v_cvt_pk_bf16_f32 v169, v154, v155
  v_cvt_pk_bf16_f32 v170, v156, v157
  v_cvt_pk_bf16_f32 v171, v158, v159
  v_exp_f32 v160, v160
  v_exp_f32 v161, v161
  v_exp_f32 v162, v162
  v_exp_f32 v163, v163
  v_mfma_f32_32x32x16_bf16 v[72:87], v[232:235], v[168:171], v[72:87]
  v_exp_f32 v164, v164
  v_exp_f32 v165, v165
  v_exp_f32 v166, v166
  v_exp_f32 v167, v167
  v_cvt_pk_bf16_f32 v172, v160, v161
  v_cvt_pk_bf16_f32 v173, v162, v163
  v_cvt_pk_bf16_f32 v174, v164, v165
  v_cvt_pk_bf16_f32 v175, v166, v167
  v_mfma_f32_32x32x16_bf16 v[152:167], v[224:227], v[48:51], 0
  v_exp_f32 v136, v136
  v_exp_f32 v137, v137
  v_exp_f32 v138, v138
  v_mfma_f32_32x32x16_bf16 v[72:87], v[236:239], v[172:175], v[72:87]
  v_exp_f32 v139, v139
  v_exp_f32 v140, v140
  v_exp_f32 v141, v141
  v_smfmac_f32_16x16x64_bf16 v[124:127], v[16:19], v[168:175], v20
  global_load_dwordx4 v[208:211], v3, s[22:23] offset:0
  global_load_dwordx4 v[212:215], v3, s[22:23] offset:1024
  global_load_dwordx4 v[216:219], v3, s[22:23] offset:2048
  global_load_dwordx4 v[220:223], v3, s[22:23] offset:3072
  v_exp_f32 v142, v142
  v_exp_f32 v143, v143
  v_mfma_f32_32x32x16_bf16 v[152:167], v[228:231], v[52:55], v[152:167]
  v_cvt_pk_bf16_f32 v168, v136, v137
  v_cvt_pk_bf16_f32 v169, v138, v139
  v_cvt_pk_bf16_f32 v170, v140, v141
  v_cvt_pk_bf16_f32 v171, v142, v143
  v_exp_f32 v144, v144
  v_exp_f32 v145, v145
  v_exp_f32 v146, v146
  v_exp_f32 v147, v147
  v_mfma_f32_32x32x16_bf16 v[88:103], v[232:235], v[168:171], v[88:103]
  s_waitcnt vmcnt(8)
  v_exp_f32 v148, v148
  v_exp_f32 v149, v149
  v_exp_f32 v150, v150
  v_exp_f32 v151, v151
  v_cvt_pk_bf16_f32 v172, v144, v145
  v_cvt_pk_bf16_f32 v173, v146, v147
  v_cvt_pk_bf16_f32 v174, v148, v149
  v_cvt_pk_bf16_f32 v175, v150, v151
  v_mfma_f32_32x32x16_bf16 v[136:151], v[176:179], v[24:27], 0
  v_exp_f32 v152, v152
  v_exp_f32 v153, v153
  v_exp_f32 v154, v154
  v_mfma_f32_32x32x16_bf16 v[88:103], v[236:239], v[172:175], v[88:103]
  v_exp_f32 v155, v155
  v_exp_f32 v156, v156
  v_exp_f32 v157, v157
  v_smfmac_f32_16x16x64_bf16 v[128:131], v[16:19], v[168:175], v20
  v_exp_f32 v158, v158
  v_exp_f32 v159, v159
  v_mfma_f32_32x32x16_bf16 v[136:151], v[180:183], v[28:31], v[136:151]
  s_add_u32 s32, s32, 1
  v_cvt_pk_bf16_f32 v168, v152, v153
  v_cvt_pk_bf16_f32 v169, v154, v155
  v_cvt_pk_bf16_f32 v170, v156, v157
  v_cvt_pk_bf16_f32 v171, v158, v159
  v_exp_f32 v160, v160
  v_exp_f32 v161, v161
  v_exp_f32 v162, v162
  v_exp_f32 v163, v163
  v_mfma_f32_32x32x16_bf16 v[104:119], v[232:235], v[168:171], v[104:119]
  s_cmp_eq_u32 s35, 0
  v_exp_f32 v164, v164
  v_exp_f32 v165, v165
  v_exp_f32 v166, v166
  v_exp_f32 v167, v167
  v_cvt_pk_bf16_f32 v172, v160, v161
  v_cvt_pk_bf16_f32 v173, v162, v163
  v_cvt_pk_bf16_f32 v174, v164, v165
  v_cvt_pk_bf16_f32 v175, v166, v167
  s_cbranch_scc1 .g2_kernel_a_loop
  s_branch .g2_kernel_a_redo
.g2_kernel_a_last:
  v_mfma_f32_32x32x16_bf16 v[152:167], v[224:227], v[32:35], 0
  ds_read_b32 v21, v13 offset:8
  s_andn2_b32 s33, s36, s34
  v_exp_f32 v136, v136
  v_exp_f32 v137, v137
  v_exp_f32 v138, v138
  v_mfma_f32_32x32x16_bf16 v[104:119], v[220:223], v[172:175], v[104:119]
  s_cbranch_scc0 .g2_kernel_a_L3c
.g2_kernel_a_L3b:
  v_exp_f32 v139, v139
  v_exp_f32 v140, v140
  v_exp_f32 v141, v141
  v_smfmac_f32_16x16x64_bf16 v[132:135], v[16:19], v[168:175], v20
  s_ff1_i32_b32 s33, s33
  v_exp_f32 v142, v142
  v_exp_f32 v143, v143
  v_mfma_f32_32x32x16_bf16 v[152:167], v[228:231], v[36:39], v[152:167]
  s_bitset1_b32 s34, s33
  ds_read_b128 v[24:27], v14 offset:0
  v_cvt_pk_bf16_f32 v168, v136, v137
  v_cvt_pk_bf16_f32 v169, v138, v139
  v_cvt_pk_bf16_f32 v170, v140, v141
  v_cvt_pk_bf16_f32 v171, v142, v143
  v_exp_f32 v144, v144
  v_exp_f32 v145, v145
  v_exp_f32 v146, v146
  v_exp_f32 v147, v147
  v_mfma_f32_32x32x16_bf16 v[56:71], v[232:235], v[168:171], v[56:71]
  s_xor_b32 s33, s33, s24
  ds_read_b128 v[28:31], v14 offset:1024
  v_exp_f32 v148, v148
  v_exp_f32 v149, v149
  v_exp_f32 v150, v150
  v_exp_f32 v151, v151
  v_cvt_pk_bf16_f32 v172, v144, v145
  v_cvt_pk_bf16_f32 v173, v146, v147
  v_cvt_pk_bf16_f32 v174, v148, v149
  v_cvt_pk_bf16_f32 v175, v150, v151
  v_mfma_f32_32x32x16_bf16 v[136:151], v[224:227], v[40:43], 0
  s_waitcnt lgkmcnt(2)
  s_lshl_b32 s33, s33, s25
  v_exp_f32 v152, v152
  v_exp_f32 v153, v153
  v_exp_f32 v154, v154
  v_mfma_f32_32x32x16_bf16 v[56:71], v[236:239], v[172:175], v[56:71]
  v_cmp_gt_u32 vcc, s27, v21
  s_add_u32 s22, s20, s33
  v_exp_f32 v155, v155
  v_exp_f32 v156, v156
  v_exp_f32 v157, v157
  v_smfmac_f32_16x16x64_bf16 v[120:123], v[16:19], v[168:175], v20
  s_addc_u32 s23, s21, 0
  v_exp_f32 v158, v158
  v_exp_f32 v159, v159
  v_mfma_f32_32x32x16_bf16 v[136:151], v[228:231], v[44:47], v[136:151]
  v_cvt_pk_bf16_f32 v168, v152, v153
  v_cvt_pk_bf16_f32 v169, v154, v155
  v_cvt_pk_bf16_f32 v170, v156, v157
  v_cvt_pk_bf16_f32 v171, v158, v159
  v_exp_f32 v160, v160
  v_exp_f32 v161, v161
  v_exp_f32 v162, v162
  v_exp_f32 v163, v163
  v_mfma_f32_32x32x16_bf16 v[72:87], v[232:235], v[168:171], v[72:87]
  s_cbranch_vccnz .g2_kernel_a_L3g
.g2_kernel_a_L3h:
  ds_read_b128 v[32:35], v14 offset:2048
  ds_read_b128 v[36:39], v14 offset:3072
  v_cvt_pk_bf16_f32 v56, v56, v57
  v_cvt_pk_bf16_f32 v57, v58, v59
  v_cvt_pk_bf16_f32 v58, v60, v61
  v_cvt_pk_bf16_f32 v59, v62, v63
  v_add_f32 v6, v120, v121
  v_exp_f32 v164, v164
  v_exp_f32 v165, v165
  v_exp_f32 v166, v166
  v_exp_f32 v167, v167
  v_cvt_pk_bf16_f32 v172, v160, v161
  v_cvt_pk_bf16_f32 v173, v162, v163
  v_cvt_pk_bf16_f32 v174, v164, v165
  v_cvt_pk_bf16_f32 v175, v166, v167
  v_mfma_f32_32x32x16_bf16 v[152:167], v[224:227], v[48:51], 0
  ds_write_b128 v9, v[56:59] offset:0
  v_cvt_pk_bf16_f32 v60, v64, v65
  v_cvt_pk_bf16_f32 v61, v66, v67
  v_cvt_pk_bf16_f32 v62, v68, v69
  v_cvt_pk_bf16_f32 v63, v70, v71
  v_exp_f32 v136, v136
  v_exp_f32 v137, v137
  v_exp_f32 v138, v138
  v_mfma_f32_32x32x16_bf16 v[72:87], v[236:239], v[172:175], v[72:87]
  ds_write_b128 v9, v[60:63] offset:1024
  v_mov_b32 v120, 0
  v_mov_b32 v121, 0
  v_exp_f32 v139, v139
  v_exp_f32 v140, v140
  v_exp_f32 v141, v141
  v_smfmac_f32_16x16x64_bf16 v[124:127], v[16:19], v[168:175], v20
  global_load_dwordx4 v[208:211], v3, s[22:23] offset:0
  global_load_dwordx4 v[212:215], v3, s[22:23] offset:1024
  global_load_dwordx4 v[216:219], v3, s[22:23] offset:2048
  global_load_dwordx4 v[220:223], v3, s[22:23] offset:3072
  ds_write_b32 v10, v6 offset:0
  ds_write_b32 v11, v12 offset:0
  v_exp_f32 v142, v142
  v_exp_f32 v143, v143
  v_mfma_f32_32x32x16_bf16 v[152:167], v[228:231], v[52:55], v[152:167]
  ds_read_b128 v[40:43], v14 offset:4096
  s_wakeup
  v_cvt_pk_bf16_f32 v168, v136, v137
  v_cvt_pk_bf16_f32 v169, v138, v139
  v_cvt_pk_bf16_f32 v170, v140, v141
  v_cvt_pk_bf16_f32 v171, v142, v143
  v_exp_f32 v144, v144
  v_exp_f32 v145, v145
  v_exp_f32 v146, v146
  v_exp_f32 v147, v147
  v_mfma_f32_32x32x16_bf16 v[88:103], v[232:235], v[168:171], v[88:103]
  s_waitcnt vmcnt(8)
  ds_read_b128 v[44:47], v14 offset:5120
  v_cvt_pk_bf16_f32 v72, v72, v73
  v_cvt_pk_bf16_f32 v73, v74, v75
  v_cvt_pk_bf16_f32 v74, v76, v77
  v_cvt_pk_bf16_f32 v75, v78, v79
  v_add_f32 v6, v124, v125
  v_exp_f32 v148, v148
  v_exp_f32 v149, v149
  v_exp_f32 v150, v150
  v_exp_f32 v151, v151
  v_cvt_pk_bf16_f32 v172, v144, v145
  v_cvt_pk_bf16_f32 v173, v146, v147
  v_cvt_pk_bf16_f32 v174, v148, v149
  v_cvt_pk_bf16_f32 v175, v150, v151
  s_waitcnt lgkmcnt(8)
  v_mfma_f32_32x32x16_bf16 v[136:151], v[176:179], v[24:27], 0
  ds_write_b128 v9, v[72:75] offset:8192
  v_cvt_pk_bf16_f32 v76, v80, v81
  v_cvt_pk_bf16_f32 v77, v82, v83
  v_cvt_pk_bf16_f32 v78, v84, v85
  v_cvt_pk_bf16_f32 v79, v86, v87
  v_exp_f32 v152, v152
  v_exp_f32 v153, v153
  v_exp_f32 v154, v154
  v_mfma_f32_32x32x16_bf16 v[88:103], v[236:239], v[172:175], v[88:103]
  ds_write_b128 v9, v[76:79] offset:9216
  v_mov_b32 v124, 0
  v_mov_b32 v125, 0
  v_exp_f32 v155, v155
  v_exp_f32 v156, v156
  v_exp_f32 v157, v157
  v_smfmac_f32_16x16x64_bf16 v[128:131], v[16:19], v[168:175], v20
  ds_write_b32 v10, v6 offset:512
  ds_write_b32 v11, v12 offset:16
  v_exp_f32 v158, v158
  v_exp_f32 v159, v159
  v_mfma_f32_32x32x16_bf16 v[136:151], v[180:183], v[28:31], v[136:151]
  ds_read_b128 v[48:51], v14 offset:6144
  s_wakeup
  v_cvt_pk_bf16_f32 v168, v152, v153
  v_cvt_pk_bf16_f32 v169, v154, v155
  v_cvt_pk_bf16_f32 v170, v156, v157
  v_cvt_pk_bf16_f32 v171, v158, v159
  v_exp_f32 v160, v160
  v_exp_f32 v161, v161
  v_exp_f32 v162, v162
  v_exp_f32 v163, v163
  v_mfma_f32_32x32x16_bf16 v[104:119], v[232:235], v[168:171], v[104:119]
  ds_read_b128 v[52:55], v14 offset:7168
  v_cvt_pk_bf16_f32 v88, v88, v89
  v_cvt_pk_bf16_f32 v89, v90, v91
  v_cvt_pk_bf16_f32 v90, v92, v93
  v_cvt_pk_bf16_f32 v91, v94, v95
  v_add_f32 v6, v128, v129
  ds_write_b128 v9, v[88:91] offset:16384
  v_cvt_pk_bf16_f32 v92, v96, v97
  v_cvt_pk_bf16_f32 v93, v98, v99
  v_cvt_pk_bf16_f32 v94, v100, v101
  v_cvt_pk_bf16_f32 v95, v102, v103
  ds_write_b128 v9, v[92:95] offset:17408
  v_mov_b32 v128, 0
  v_mov_b32 v129, 0
  ds_write_b32 v10, v6 offset:1024
  ds_write_b32 v11, v12 offset:32
  s_add_u32 s32, s32, 1
  v_exp_f32 v164, v164
  v_exp_f32 v165, v165
  v_exp_f32 v166, v166
  v_exp_f32 v167, v167
  v_cvt_pk_bf16_f32 v172, v160, v161
  v_cvt_pk_bf16_f32 v173, v162, v163
  v_cvt_pk_bf16_f32 v174, v164, v165
  v_cvt_pk_bf16_f32 v175, v166, v167
  s_cmp_eq_u32 s32, 8
  s_cbranch_scc1 .g2_kernel_a_end
  s_waitcnt lgkmcnt(15)
  v_mfma_f32_32x32x16_bf16 v[152:167], v[176:179], v[32:35], 0
  s_andn2_b32 s33, s36, s34
  v_exp_f32 v136, v136
  v_exp_f32 v137, v137
  v_exp_f32 v138, v138
  v_mfma_f32_32x32x16_bf16 v[104:119], v[236:239], v[172:175], v[104:119]
  s_cbranch_scc0 .g2_kernel_a_G0c
.g2_kernel_a_G0b:
  v_exp_f32 v139, v139
  v_exp_f32 v140, v140
  v_exp_f32 v141, v141
  v_smfmac_f32_16x16x64_bf16 v[132:135], v[16:19], v[168:175], v20
  s_ff1_i32_b32 s33, s33
  v_exp_f32 v142, v142
  v_exp_f32 v143, v143
  v_mfma_f32_32x32x16_bf16 v[152:167], v[180:183], v[36:39], v[152:167]
  s_bitset1_b32 s34, s33
  v_cvt_pk_bf16_f32 v168, v136, v137
  v_cvt_pk_bf16_f32 v169, v138, v139
  v_cvt_pk_bf16_f32 v170, v140, v141
  v_cvt_pk_bf16_f32 v171, v142, v143
  v_exp_f32 v144, v144
  v_exp_f32 v145, v145
  v_exp_f32 v146, v146
  v_exp_f32 v147, v147
  s_waitcnt lgkmcnt(14)
  v_mfma_f32_32x32x16_bf16 v[56:71], v[184:187], v[168:171], 0
  s_xor_b32 s33, s33, s24
  v_cvt_pk_bf16_f32 v104, v104, v105
  v_cvt_pk_bf16_f32 v105, v106, v107
  v_cvt_pk_bf16_f32 v106, v108, v109
  v_cvt_pk_bf16_f32 v107, v110, v111
  v_add_f32 v6, v132, v133
  v_exp_f32 v148, v148
  v_exp_f32 v149, v149
  v_exp_f32 v150, v150
  v_exp_f32 v151, v151
  v_cvt_pk_bf16_f32 v172, v144, v145
  v_cvt_pk_bf16_f32 v173, v146, v147
  v_cvt_pk_bf16_f32 v174, v148, v149
  v_cvt_pk_bf16_f32 v175, v150, v151
  s_waitcnt lgkmcnt(10)
  v_mfma_f32_32x32x16_bf16 v[136:151], v[176:179], v[40:43], 0
  s_lshl_b32 s33, s33, s25
  ds_write_b128 v9, v[104:107] offset:24576
  v_cvt_pk_bf16_f32 v108, v112, v113
  v_cvt_pk_bf16_f32 v109, v114, v115
  v_cvt_pk_bf16_f32 v110, v116, v117
  v_cvt_pk_bf16_f32 v111, v118, v119
  v_exp_f32 v152, v152
  v_exp_f32 v153, v153
  v_exp_f32 v154, v154
  v_mfma_f32_32x32x16_bf16 v[56:71], v[188:191], v[172:175], v[56:71]
  s_add_u32 s22, s20, s33
  ds_write_b128 v9, v[108:111] offset:25600
  v_mov_b32 v132, 0
  v_mov_b32 v133, 0
  v_exp_f32 v155, v155
  v_exp_f32 v156, v156
  v_exp_f32 v157, v157
  v_smfmac_f32_16x16x64_bf16 v[120:123], v[16:19], v[168:175], v20
  s_addc_u32 s23, s21, 0
  ds_write_b32 v10, v6 offset:1536
  v_exp_f32 v158, v158
  v_exp_f32 v159, v159
  v_mfma_f32_32x32x16_bf16 v[136:151], v[180:183], v[44:47], v[136:151]
  v_cvt_pk_bf16_f32 v168, v152, v153
  v_cvt_pk_bf16_f32 v169, v154, v155
  v_cvt_pk_bf16_f32 v170, v156, v157
  v_cvt_pk_bf16_f32 v171, v158, v159
  v_exp_f32 v160, v160
  v_exp_f32 v161, v161
  v_exp_f32 v162, v162
  v_exp_f32 v163, v163
  s_waitcnt lgkmcnt(11)
  v_mfma_f32_32x32x16_bf16 v[72:87], v[184:187], v[168:171], 0
  ds_write_b32 v11, v12 offset:48
  v_exp_f32 v164, v164
  v_exp_f32 v165, v165
  v_exp_f32 v166, v166
  v_exp_f32 v167, v167
  v_cvt_pk_bf16_f32 v172, v160, v161
  v_cvt_pk_bf16_f32 v173, v162, v163
  v_cvt_pk_bf16_f32 v174, v164, v165
  v_cvt_pk_bf16_f32 v175, v166, v167
  s_waitcnt lgkmcnt(8)
  v_mfma_f32_32x32x16_bf16 v[152:167], v[176:179], v[48:51], 0
  v_add_u32 v12, 1, v12
  v_exp_f32 v136, v136
  v_exp_f32 v137, v137
  v_exp_f32 v138, v138
  v_mfma_f32_32x32x16_bf16 v[72:87], v[188:191], v[172:175], v[72:87]
  v_exp_f32 v139, v139
  v_exp_f32 v140, v140
  v_exp_f32 v141, v141
  v_smfmac_f32_16x16x64_bf16 v[124:127], v[16:19], v[168:175], v20
  global_load_dwordx4 v[224:227], v3, s[22:23] offset:0
  global_load_dwordx4 v[228:231], v3, s[22:23] offset:1024
  global_load_dwordx4 v[232:235], v3, s[22:23] offset:2048
  global_load_dwordx4 v[236:239], v3, s[22:23] offset:3072
  s_add_u32 s27, s27, 4
  v_exp_f32 v142, v142
  v_exp_f32 v143, v143
  v_mfma_f32_32x32x16_bf16 v[152:167], v[180:183], v[52:55], v[152:167]
  v_cvt_pk_bf16_f32 v168, v136, v137
  v_cvt_pk_bf16_f32 v169, v138, v139
  v_cvt_pk_bf16_f32 v170, v140, v141
  v_cvt_pk_bf16_f32 v171, v142, v143
  v_exp_f32 v144, v144
  v_exp_f32 v145, v145
  v_exp_f32 v146, v146
  v_exp_f32 v147, v147
  s_waitcnt lgkmcnt(6)
  v_mfma_f32_32x32x16_bf16 v[88:103], v[184:187], v[168:171], 0
  s_waitcnt vmcnt(8)
  v_exp_f32 v148, v148
  v_exp_f32 v149, v149
  v_exp_f32 v150, v150
  v_exp_f32 v151, v151
  v_cvt_pk_bf16_f32 v172, v144, v145
  v_cvt_pk_bf16_f32 v173, v146, v147
  v_cvt_pk_bf16_f32 v174, v148, v149
  v_cvt_pk_bf16_f32 v175, v150, v151
  v_mfma_f32_32x32x16_bf16 v[136:151], v[192:195], v[24:27], 0
  v_exp_f32 v152, v152
  v_exp_f32 v153, v153
  v_exp_f32 v154, v154
  v_mfma_f32_32x32x16_bf16 v[88:103], v[188:191], v[172:175], v[88:103]
  v_exp_f32 v155, v155
  v_exp_f32 v156, v156
  v_exp_f32 v157, v157
  v_smfmac_f32_16x16x64_bf16 v[128:131], v[16:19], v[168:175], v20
  v_exp_f32 v158, v158
  v_exp_f32 v159, v159
  v_mfma_f32_32x32x16_bf16 v[136:151], v[196:199], v[28:31], v[136:151]
  v_cvt_pk_bf16_f32 v168, v152, v153
  v_cvt_pk_bf16_f32 v169, v154, v155
  v_cvt_pk_bf16_f32 v170, v156, v157
  v_cvt_pk_bf16_f32 v171, v158, v159
  v_exp_f32 v160, v160
  v_exp_f32 v161, v161
  v_exp_f32 v162, v162
  v_exp_f32 v163, v163
  s_waitcnt lgkmcnt(2)
  v_mfma_f32_32x32x16_bf16 v[104:119], v[184:187], v[168:171], 0
  v_exp_f32 v164, v164
  v_exp_f32 v165, v165
  v_exp_f32 v166, v166
  v_exp_f32 v167, v167
  v_cvt_pk_bf16_f32 v172, v160, v161
  v_cvt_pk_bf16_f32 v173, v162, v163
  v_cvt_pk_bf16_f32 v174, v164, v165
  v_cvt_pk_bf16_f32 v175, v166, v167
  s_branch .g2_kernel_a_n1
.g2_kernel_a_end:
  v_mfma_f32_32x32x16_bf16 v[104:119], v[236:239], v[172:175], v[104:119]
  v_smfmac_f32_16x16x64_bf16 v[132:135], v[16:19], v[168:175], v20
  s_wakeup
  s_nop 9
  v_cvt_pk_bf16_f32 v104, v104, v105
  v_cvt_pk_bf16_f32 v105, v106, v107
  v_cvt_pk_bf16_f32 v106, v108, v109
  v_cvt_pk_bf16_f32 v107, v110, v111
  v_add_f32 v6, v132, v133
  ds_write_b128 v9, v[104:107] offset:24576
  v_cvt_pk_bf16_f32 v108, v112, v113
  v_cvt_pk_bf16_f32 v109, v114, v115
  v_cvt_pk_bf16_f32 v110, v116, v117
  v_cvt_pk_bf16_f32 v111, v118, v119
  ds_write_b128 v9, v[108:111] offset:25600
  v_mov_b32 v132, 0
  v_mov_b32 v133, 0
  ds_write_b32 v10, v6 offset:1536
  ds_write_b32 v11, v12 offset:48
  s_waitcnt lgkmcnt(4)
  v_mov_b32 v20, s71
  v_lshrrev_b32 v17, 5, v2
  v_and_b32 v18, 31, v2
  s_lshl_b32 s28, s16, 5
  v_add_u32 v19, s28, v18
  v_lshlrev_b32 v7, 2, v19
  v_add_u32 v7, 155648, v7
  ds_read_b32 v8, v7 offset:3840
  ds_read_b32 v9, v7 offset:4352
  ds_read_b32 v16, v20 offset:24
  ds_read_b32 v6, v20 offset:52
  v_add_u32 v19, 1, v19
  v_bfe_u32 v7, v2, 2, 2
  v_lshl_add_u32 v14, v17, 2, v7
  v_lshlrev_b32 v14, 7, v14
  v_lshrrev_b32 v7, 1, v7
  v_lshl_add_u32 v14, v7, 6, v14
  v_bfe_u32 v7, v2, 4, 1
  v_lshl_add_u32 v14, v7, 5, v14
  v_and_b32 v7, 1, v2
  v_lshl_add_u32 v14, v7, 4, v14
  v_bfe_u32 v7, v2, 1, 1
  v_lshl_add_u32 v14, v7, 3, v14
  v_xor_b32 v15, 64, v14
  v_and_b32 v7, 7, v2
  v_xor_b32 v7, s24, v7
  s_lshl_b32 s28, s16, 6
  s_add_u32 s28, s28, 157952
  v_lshl_add_u32 v21, v7, 3, s28
  v_lshlrev_b32 v24, 16, v240
  v_and_b32 v25, 0xffff0000, v240
  v_lshlrev_b32 v26, 16, v241
  v_and_b32 v27, 0xffff0000, v241
  v_lshlrev_b32 v28, 16, v242
  v_and_b32 v29, 0xffff0000, v242
  v_lshlrev_b32 v30, 16, v243
  v_and_b32 v31, 0xffff0000, v243
  v_lshlrev_b32 v32, 16, v244
  v_and_b32 v33, 0xffff0000, v244
  v_lshlrev_b32 v34, 16, v245
  v_and_b32 v35, 0xffff0000, v245
  v_lshlrev_b32 v36, 16, v246
  v_and_b32 v37, 0xffff0000, v246
  v_lshlrev_b32 v38, 16, v247
  v_and_b32 v39, 0xffff0000, v247
  v_lshlrev_b32 v40, 16, v248
  v_and_b32 v41, 0xffff0000, v248
  v_lshlrev_b32 v42, 16, v249
  v_and_b32 v43, 0xffff0000, v249
  v_lshlrev_b32 v44, 16, v250
  v_and_b32 v45, 0xffff0000, v250
  v_lshlrev_b32 v46, 16, v251
  v_and_b32 v47, 0xffff0000, v251
  v_lshlrev_b32 v48, 16, v252
  v_and_b32 v49, 0xffff0000, v252
  v_lshlrev_b32 v50, 16, v253
  v_and_b32 v51, 0xffff0000, v253
  v_lshlrev_b32 v52, 16, v254
  v_and_b32 v53, 0xffff0000, v254
  v_lshlrev_b32 v54, 16, v255
  v_and_b32 v55, 0xffff0000, v255
  s_waitcnt lgkmcnt(0)
  v_cmp_gt_u32 vcc, 4, v6
  s_cbranch_vccnz .g2_kernel_w_aw
.g2_kernel_w_ab:
  s_xor_b32 s28, s24, 0
  s_lshl_b32 s28, s28, 13
  s_add_u32 s28, s28, 65536
  v_add_u32 v10, s28, v14
  v_add_u32 v11, s28, v15
  ds_read_b64_tr_b16 v[104:105], v10 offset:0
  ds_read_b64_tr_b16 v[106:107], v10 offset:1024
  ds_read_b64_tr_b16 v[108:109], v11 offset:0
  ds_read_b64_tr_b16 v[110:111], v11 offset:1024
  ds_read_b64_tr_b16 v[112:113], v10 offset:2048
  ds_read_b64_tr_b16 v[114:115], v10 offset:3072
  ds_read_b64_tr_b16 v[116:117], v11 offset:2048
  ds_read_b64_tr_b16 v[118:119], v11 offset:3072
  ds_read_b64_tr_b16 v[120:121], v10 offset:4096
  ds_read_b64_tr_b16 v[122:123], v10 offset:5120
  ds_read_b64_tr_b16 v[124:125], v11 offset:4096
  ds_read_b64_tr_b16 v[126:127], v11 offset:5120
  s_andn2_b32 s33, s36, s34
  s_ff1_i32_b32 s33, s33
  s_bitset1_b32 s34, s33
  s_xor_b32 s33, s33, s24
  s_lshl_b32 s33, s33, 12
  s_add_u32 s22, s20, s33
  s_addc_u32 s23, s21, 0
  global_load_dwordx4 v[224:227], v3, s[22:23] offset:0
  global_load_dwordx4 v[228:231], v3, s[22:23] offset:1024
  global_load_dwordx4 v[232:235], v3, s[22:23] offset:2048
  global_load_dwordx4 v[236:239], v3, s[22:23] offset:3072
  v_pk_fma_f32 v[24:25], v[24:25], v[8:9], v[8:9] op_sel:[0,0,1] op_sel_hi:[1,0,1]
  v_pk_fma_f32 v[26:27], v[26:27], v[8:9], v[8:9] op_sel:[0,0,1] op_sel_hi:[1,0,1]
  v_pk_fma_f32 v[28:29], v[28:29], v[8:9], v[8:9] op_sel:[0,0,1] op_sel_hi:[1,0,1]
  v_pk_fma_f32 v[30:31], v[30:31], v[8:9], v[8:9] op_sel:[0,0,1] op_sel_hi:[1,0,1]
  v_pk_fma_f32 v[32:33], v[32:33], v[8:9], v[8:9] op_sel:[0,0,1] op_sel_hi:[1,0,1]
  v_pk_fma_f32 v[34:35], v[34:35], v[8:9], v[8:9] op_sel:[0,0,1] op_sel_hi:[1,0,1]
  v_pk_fma_f32 v[36:37], v[36:37], v[8:9], v[8:9] op_sel:[0,0,1] op_sel_hi:[1,0,1]
  v_pk_fma_f32 v[38:39], v[38:39], v[8:9], v[8:9] op_sel:[0,0,1] op_sel_hi:[1,0,1]
  v_pk_fma_f32 v[40:41], v[40:41], v[8:9], v[8:9] op_sel:[0,0,1] op_sel_hi:[1,0,1]
  v_pk_fma_f32 v[42:43], v[42:43], v[8:9], v[8:9] op_sel:[0,0,1] op_sel_hi:[1,0,1]
  v_pk_fma_f32 v[44:45], v[44:45], v[8:9], v[8:9] op_sel:[0,0,1] op_sel_hi:[1,0,1]
  v_pk_fma_f32 v[46:47], v[46:47], v[8:9], v[8:9] op_sel:[0,0,1] op_sel_hi:[1,0,1]
  v_pk_fma_f32 v[48:49], v[48:49], v[8:9], v[8:9] op_sel:[0,0,1] op_sel_hi:[1,0,1]
  v_pk_fma_f32 v[50:51], v[50:51], v[8:9], v[8:9] op_sel:[0,0,1] op_sel_hi:[1,0,1]
  v_pk_fma_f32 v[52:53], v[52:53], v[8:9], v[8:9] op_sel:[0,0,1] op_sel_hi:[1,0,1]
  v_pk_fma_f32 v[54:55], v[54:55], v[8:9], v[8:9] op_sel:[0,0,1] op_sel_hi:[1,0,1]
  v_cmp_eq_u32 vcc, v16, v19
  s_cbranch_vccnz .g2_kernel_w_pt
.g2_kernel_w_pb:
  s_mov_b32 s72, s48
  s_mov_b32 s73, s49
  s_mov_b32 s74, 0x800
  s_mov_b32 s75, 0x00020000
  s_waitcnt vmcnt(15) lgkmcnt(8)
  v_mfma_f32_32x32x16_bf16 v[24:39], v[104:107], v[176:179], v[24:39]
  s_xor_b32 s28, s24, 1
  s_lshl_b32 s28, s28, 13
  s_add_u32 s28, s28, 65536
  ds_read_b64_tr_b16 v[128:129], v10 offset:6144
  ds_read_b64_tr_b16 v[130:131], v10 offset:7168
  v_mfma_f32_32x32x16_bf16 v[40:55], v[108:111], v[176:179], v[40:55]
  v_add_u32 v12, s28, v14
  v_add_u32 v13, s28, v15
  s_andn2_b32 s33, s36, s34
  ds_read_b64_tr_b16 v[132:133], v11 offset:6144
  ds_read_b64_tr_b16 v[134:135], v11 offset:7168
  s_waitcnt vmcnt(14) lgkmcnt(8)
  v_mfma_f32_32x32x16_bf16 v[24:39], v[112:115], v[180:183], v[24:39]
  s_ff1_i32_b32 s33, s33
  s_bitset1_b32 s34, s33
  s_xor_b32 s33, s33, s24
  ds_read_b64_tr_b16 v[104:105], v12 offset:0
  ds_read_b64_tr_b16 v[106:107], v12 offset:1024
  v_mfma_f32_32x32x16_bf16 v[40:55], v[116:119], v[180:183], v[40:55]
  s_lshl_b32 s33, s33, 12
  s_add_u32 s22, s20, s33
  s_addc_u32 s23, s21, 0
  ds_read_b64_tr_b16 v[108:109], v13 offset:0
  ds_read_b64_tr_b16 v[110:111], v13 offset:1024
  s_waitcnt vmcnt(13) lgkmcnt(8)
  v_mfma_f32_32x32x16_bf16 v[24:39], v[120:123], v[184:187], v[24:39]
  global_load_dwordx4 v[136:139], v3, s[22:23] offset:0
  global_load_dwordx4 v[140:143], v3, s[22:23] offset:1024
  global_load_dwordx4 v[144:147], v3, s[22:23] offset:2048
  ds_read_b64_tr_b16 v[112:113], v12 offset:2048
  ds_read_b64_tr_b16 v[114:115], v12 offset:3072
  v_mfma_f32_32x32x16_bf16 v[40:55], v[124:127], v[184:187], v[40:55]
  global_load_dwordx4 v[148:151], v3, s[22:23] offset:3072
  ds_read_b64_tr_b16 v[116:117], v13 offset:2048
  ds_read_b64_tr_b16 v[118:119], v13 offset:3072
  s_waitcnt vmcnt(16) lgkmcnt(8)
  v_mfma_f32_32x32x16_bf16 v[24:39], v[128:131], v[188:191], v[24:39]
  ds_read_b64_tr_b16 v[120:121], v12 offset:4096
  ds_read_b64_tr_b16 v[122:123], v12 offset:5120
  v_mfma_f32_32x32x16_bf16 v[40:55], v[132:135], v[188:191], v[40:55]
  ds_read_b64_tr_b16 v[124:125], v13 offset:4096
  ds_read_b64_tr_b16 v[126:127], v13 offset:5120
  s_waitcnt vmcnt(15) lgkmcnt(8)
  v_mfma_f32_32x32x16_bf16 v[24:39], v[104:107], v[192:195], v[24:39]
  s_xor_b32 s28, s24, 2
  s_lshl_b32 s28, s28, 13
  s_add_u32 s28, s28, 65536
  ds_read_b64_tr_b16 v[128:129], v12 offset:6144
  ds_read_b64_tr_b16 v[130:131], v12 offset:7168
  v_mfma_f32_32x32x16_bf16 v[40:55], v[108:111], v[192:195], v[40:55]
  v_add_u32 v10, s28, v14
  v_add_u32 v11, s28, v15
  s_andn2_b32 s33, s36, s34
  ds_read_b64_tr_b16 v[132:133], v13 offset:6144
  ds_read_b64_tr_b16 v[134:135], v13 offset:7168
  s_waitcnt vmcnt(14) lgkmcnt(8)
  v_mfma_f32_32x32x16_bf16 v[24:39], v[112:115], v[196:199], v[24:39]
  s_ff1_i32_b32 s33, s33
  s_bitset1_b32 s34, s33
  s_xor_b32 s33, s33, s24
  ds_read_b64_tr_b16 v[104:105], v10 offset:0
  ds_read_b64_tr_b16 v[106:107], v10 offset:1024
  v_mfma_f32_32x32x16_bf16 v[40:55], v[116:119], v[196:199], v[40:55]
  s_lshl_b32 s33, s33, 12
  s_add_u32 s22, s20, s33
  s_addc_u32 s23, s21, 0
  ds_read_b64_tr_b16 v[108:109], v11 offset:0
  ds_read_b64_tr_b16 v[110:111], v11 offset:1024
  s_waitcnt vmcnt(13) lgkmcnt(8)
  v_mfma_f32_32x32x16_bf16 v[24:39], v[120:123], v[200:203], v[24:39]
  global_load_dwordx4 v[152:155], v3, s[22:23] offset:0
  global_load_dwordx4 v[156:159], v3, s[22:23] offset:1024
  global_load_dwordx4 v[160:163], v3, s[22:23] offset:2048
  ds_read_b64_tr_b16 v[112:113], v10 offset:2048
  ds_read_b64_tr_b16 v[114:115], v10 offset:3072
  v_mfma_f32_32x32x16_bf16 v[40:55], v[124:127], v[200:203], v[40:55]
  global_load_dwordx4 v[164:167], v3, s[22:23] offset:3072
  ds_read_b64_tr_b16 v[116:117], v11 offset:2048
  ds_read_b64_tr_b16 v[118:119], v11 offset:3072
  s_waitcnt vmcnt(16) lgkmcnt(8)
  v_mfma_f32_32x32x16_bf16 v[24:39], v[128:131], v[204:207], v[24:39]
  ds_read_b64_tr_b16 v[120:121], v10 offset:4096
  ds_read_b64_tr_b16 v[122:123], v10 offset:5120
  v_mfma_f32_32x32x16_bf16 v[40:55], v[132:135], v[204:207], v[40:55]
  ds_read_b64_tr_b16 v[124:125], v11 offset:4096
  ds_read_b64_tr_b16 v[126:127], v11 offset:5120
  s_waitcnt vmcnt(15) lgkmcnt(8)
  v_mfma_f32_32x32x16_bf16 v[24:39], v[104:107], v[208:211], v[24:39]
  s_xor_b32 s28, s24, 3
  s_lshl_b32 s28, s28, 13
  s_add_u32 s28, s28, 65536
  ds_read_b64_tr_b16 v[128:129], v10 offset:6144
  ds_read_b64_tr_b16 v[130:131], v10 offset:7168
  v_mfma_f32_32x32x16_bf16 v[40:55], v[108:111], v[208:211], v[40:55]
  v_add_u32 v12, s28, v14
  v_add_u32 v13, s28, v15
  s_andn2_b32 s33, s36, s34
  ds_read_b64_tr_b16 v[132:133], v11 offset:6144
  ds_read_b64_tr_b16 v[134:135], v11 offset:7168
  s_waitcnt vmcnt(14) lgkmcnt(8)
  v_mfma_f32_32x32x16_bf16 v[24:39], v[112:115], v[212:215], v[24:39]
  s_ff1_i32_b32 s33, s33
  s_bitset1_b32 s34, s33
  s_xor_b32 s33, s33, s24
  ds_read_b64_tr_b16 v[104:105], v12 offset:0
  ds_read_b64_tr_b16 v[106:107], v12 offset:1024
  v_mfma_f32_32x32x16_bf16 v[40:55], v[116:119], v[212:215], v[40:55]
  s_lshl_b32 s33, s33, 12
  s_add_u32 s22, s20, s33
  s_addc_u32 s23, s21, 0
  ds_read_b64_tr_b16 v[108:109], v13 offset:0
  ds_read_b64_tr_b16 v[110:111], v13 offset:1024
  s_waitcnt vmcnt(13) lgkmcnt(8)
  v_mfma_f32_32x32x16_bf16 v[24:39], v[120:123], v[216:219], v[24:39]
  global_load_dwordx4 v[56:59], v3, s[22:23] offset:0
  global_load_dwordx4 v[60:63], v3, s[22:23] offset:1024
  global_load_dwordx4 v[64:67], v3, s[22:23] offset:2048
  ds_read_b64_tr_b16 v[112:113], v12 offset:2048
  ds_read_b64_tr_b16 v[114:115], v12 offset:3072
  v_mfma_f32_32x32x16_bf16 v[40:55], v[124:127], v[216:219], v[40:55]
  global_load_dwordx4 v[68:71], v3, s[22:23] offset:3072
  ds_read_b64_tr_b16 v[116:117], v13 offset:2048
  ds_read_b64_tr_b16 v[118:119], v13 offset:3072
  s_waitcnt vmcnt(16) lgkmcnt(8)
  v_mfma_f32_32x32x16_bf16 v[24:39], v[128:131], v[220:223], v[24:39]
  ds_read_b64_tr_b16 v[120:121], v12 offset:4096
  ds_read_b64_tr_b16 v[122:123], v12 offset:5120
  v_mfma_f32_32x32x16_bf16 v[40:55], v[132:135], v[220:223], v[40:55]
  ds_read_b64_tr_b16 v[124:125], v13 offset:4096
  ds_read_b64_tr_b16 v[126:127], v13 offset:5120
  s_waitcnt vmcnt(15) lgkmcnt(8)
  v_mfma_f32_32x32x16_bf16 v[24:39], v[104:107], v[224:227], v[24:39]
  s_xor_b32 s28, s24, 4
  s_lshl_b32 s28, s28, 13
  s_add_u32 s28, s28, 65536
  ds_read_b64_tr_b16 v[128:129], v12 offset:6144
  ds_read_b64_tr_b16 v[130:131], v12 offset:7168
  v_mfma_f32_32x32x16_bf16 v[40:55], v[108:111], v[224:227], v[40:55]
  v_add_u32 v10, s28, v14
  v_add_u32 v11, s28, v15
  s_andn2_b32 s33, s36, s34
  ds_read_b64_tr_b16 v[132:133], v13 offset:6144
  ds_read_b64_tr_b16 v[134:135], v13 offset:7168
  s_waitcnt vmcnt(14) lgkmcnt(8)
  v_mfma_f32_32x32x16_bf16 v[24:39], v[112:115], v[228:231], v[24:39]
  s_ff1_i32_b32 s33, s33
  s_bitset1_b32 s34, s33
  s_xor_b32 s33, s33, s24
  ds_read_b64_tr_b16 v[104:105], v10 offset:0
  ds_read_b64_tr_b16 v[106:107], v10 offset:1024
  v_mfma_f32_32x32x16_bf16 v[40:55], v[116:119], v[228:231], v[40:55]
  s_lshl_b32 s33, s33, 12
  s_add_u32 s22, s20, s33
  s_addc_u32 s23, s21, 0
  ds_read_b64_tr_b16 v[108:109], v11 offset:0
  ds_read_b64_tr_b16 v[110:111], v11 offset:1024
  s_waitcnt vmcnt(13) lgkmcnt(8)
  v_mfma_f32_32x32x16_bf16 v[24:39], v[120:123], v[232:235], v[24:39]
  global_load_dwordx4 v[72:75], v3, s[22:23] offset:0
  global_load_dwordx4 v[76:79], v3, s[22:23] offset:1024
  global_load_dwordx4 v[80:83], v3, s[22:23] offset:2048
  ds_read_b64_tr_b16 v[112:113], v10 offset:2048
  ds_read_b64_tr_b16 v[114:115], v10 offset:3072
  v_mfma_f32_32x32x16_bf16 v[40:55], v[124:127], v[232:235], v[40:55]
  global_load_dwordx4 v[84:87], v3, s[22:23] offset:3072
  ds_read_b64_tr_b16 v[116:117], v11 offset:2048
  ds_read_b64_tr_b16 v[118:119], v11 offset:3072
  s_waitcnt vmcnt(16) lgkmcnt(8)
  v_mfma_f32_32x32x16_bf16 v[24:39], v[128:131], v[236:239], v[24:39]
  ds_read_b64_tr_b16 v[120:121], v10 offset:4096
  ds_read_b64_tr_b16 v[122:123], v10 offset:5120
  v_mfma_f32_32x32x16_bf16 v[40:55], v[132:135], v[236:239], v[40:55]
  ds_read_b64_tr_b16 v[124:125], v11 offset:4096
  ds_read_b64_tr_b16 v[126:127], v11 offset:5120
  s_waitcnt vmcnt(15) lgkmcnt(8)
  v_mfma_f32_32x32x16_bf16 v[24:39], v[104:107], v[136:139], v[24:39]
  s_xor_b32 s28, s24, 5
  s_lshl_b32 s28, s28, 13
  s_add_u32 s28, s28, 65536
  v_add_u32 v12, s28, v14
  ds_read_b64_tr_b16 v[128:129], v10 offset:6144
  ds_read_b64_tr_b16 v[130:131], v10 offset:7168
  v_mfma_f32_32x32x16_bf16 v[40:55], v[108:111], v[136:139], v[40:55]
  v_add_u32 v13, s28, v15
  s_andn2_b32 s33, s36, s34
  s_cbranch_scc0 .g2_kernel_w_i8c
.g2_kernel_w_i8b:
  s_ff1_i32_b32 s33, s33
  ds_read_b64_tr_b16 v[132:133], v11 offset:6144
  ds_read_b64_tr_b16 v[134:135], v11 offset:7168
  s_waitcnt vmcnt(14) lgkmcnt(8)
  v_mfma_f32_32x32x16_bf16 v[24:39], v[112:115], v[140:143], v[24:39]
  s_bitset1_b32 s34, s33
  s_xor_b32 s33, s33, s24
  s_and_b32 s8, s33, 7
  s_cmp_lt_u32 s8, 2
  ds_read_b64_tr_b16 v[104:105], v12 offset:0
  ds_read_b64_tr_b16 v[106:107], v12 offset:1024
  v_mfma_f32_32x32x16_bf16 v[40:55], v[116:119], v[140:143], v[40:55]
  s_cselect_b32 s28, 139264, 0
  s_lshl_b32 s8, s8, 13
  s_add_u32 s8, s8, s28
  s_lshl_b32 s33, s33, 12
  ds_read_b64_tr_b16 v[108:109], v13 offset:0
  ds_read_b64_tr_b16 v[110:111], v13 offset:1024
  s_waitcnt vmcnt(13) lgkmcnt(8)
  v_mfma_f32_32x32x16_bf16 v[24:39], v[120:123], v[144:147], v[24:39]
  s_add_u32 s22, s20, s33
  s_addc_u32 s23, s21, 0
  global_load_dwordx4 v[88:91], v3, s[22:23] offset:0
  global_load_dwordx4 v[92:95], v3, s[22:23] offset:1024
  ds_read_b64_tr_b16 v[112:113], v12 offset:2048
  ds_read_b64_tr_b16 v[114:115], v12 offset:3072
  v_mfma_f32_32x32x16_bf16 v[40:55], v[124:127], v[144:147], v[40:55]
  global_load_dwordx4 v[96:99], v3, s[22:23] offset:2048
  global_load_dwordx4 v[100:103], v3, s[22:23] offset:3072
  ds_read_b64_tr_b16 v[116:117], v13 offset:2048
  ds_read_b64_tr_b16 v[118:119], v13 offset:3072
  s_waitcnt vmcnt(16) lgkmcnt(8)
  v_mfma_f32_32x32x16_bf16 v[24:39], v[128:131], v[148:151], v[24:39]
  ds_read_b64_tr_b16 v[120:121], v12 offset:4096
  ds_read_b64_tr_b16 v[122:123], v12 offset:5120
  v_mfma_f32_32x32x16_bf16 v[40:55], v[132:135], v[148:151], v[40:55]
  ds_read_b64_tr_b16 v[124:125], v13 offset:4096
  ds_read_b64_tr_b16 v[126:127], v13 offset:5120
  s_waitcnt vmcnt(15) lgkmcnt(8)
  v_mfma_f32_32x32x16_bf16 v[24:39], v[104:107], v[152:155], v[24:39]
  s_xor_b32 s28, s24, 6
  s_lshl_b32 s28, s28, 13
  s_add_u32 s28, s28, 65536
  v_add_u32 v10, s28, v14
  v_add_u32 v11, s28, v15
  ds_read_b64_tr_b16 v[128:129], v12 offset:6144
  ds_read_b64_tr_b16 v[130:131], v12 offset:7168
  v_mfma_f32_32x32x16_bf16 v[40:55], v[108:111], v[152:155], v[40:55]
  s_andn2_b32 s33, s36, s34
  s_cbranch_scc0 .g2_kernel_w_i9c
.g2_kernel_w_i9b:
  s_ff1_i32_b32 s33, s33
  s_bitset1_b32 s34, s33
  s_xor_b32 s33, s33, s24
  ds_read_b64_tr_b16 v[132:133], v13 offset:6144
  ds_read_b64_tr_b16 v[134:135], v13 offset:7168
  s_waitcnt vmcnt(14) lgkmcnt(8)
  v_mfma_f32_32x32x16_bf16 v[24:39], v[112:115], v[156:159], v[24:39]
  s_and_b32 s9, s33, 7
  s_cmp_lt_u32 s9, 2
  s_cselect_b32 s28, 139264, 0
  s_lshl_b32 s9, s9, 13
  s_add_u32 s9, s9, s28
  ds_read_b64_tr_b16 v[104:105], v10 offset:0
  ds_read_b64_tr_b16 v[106:107], v10 offset:1024
  v_mfma_f32_32x32x16_bf16 v[40:55], v[116:119], v[156:159], v[40:55]
  s_lshl_b32 s33, s33, 12
  s_add_u32 s22, s20, s33
  s_addc_u32 s23, s21, 0
  global_load_dwordx4 v[176:179], v3, s[22:23] offset:0
  global_load_dwordx4 v[180:183], v3, s[22:23] offset:1024
  ds_read_b64_tr_b16 v[108:109], v11 offset:0
  ds_read_b64_tr_b16 v[110:111], v11 offset:1024
  s_waitcnt vmcnt(15) lgkmcnt(8)
  v_mfma_f32_32x32x16_bf16 v[24:39], v[120:123], v[160:163], v[24:39]
  global_load_dwordx4 v[184:187], v3, s[22:23] offset:2048
  global_load_dwordx4 v[188:191], v3, s[22:23] offset:3072
  v_lshlrev_b32 v16, 4, v17
  s_lshl_b32 s29, s18, 7
  buffer_load_dwordx4 v[240:243], v16, s[72:75], s29 offen offset:0
  ds_read_b64_tr_b16 v[112:113], v10 offset:2048
  ds_read_b64_tr_b16 v[114:115], v10 offset:3072
  v_mfma_f32_32x32x16_bf16 v[40:55], v[124:127], v[160:163], v[40:55]
  buffer_load_dwordx4 v[244:247], v16, s[72:75], s29 offen offset:32
  buffer_load_dwordx4 v[248:251], v16, s[72:75], s29 offen offset:64
  buffer_load_dwordx4 v[252:255], v16, s[72:75], s29 offen offset:96
  ds_read_b64_tr_b16 v[116:117], v11 offset:2048
  ds_read_b64_tr_b16 v[118:119], v11 offset:3072
  s_waitcnt vmcnt(20) lgkmcnt(8)
  v_mfma_f32_32x32x16_bf16 v[24:39], v[128:131], v[164:167], v[24:39]
  ds_read_b64_tr_b16 v[120:121], v10 offset:4096
  ds_read_b64_tr_b16 v[122:123], v10 offset:5120
  v_mfma_f32_32x32x16_bf16 v[40:55], v[132:135], v[164:167], v[40:55]
  ds_read_b64_tr_b16 v[124:125], v11 offset:4096
  ds_read_b64_tr_b16 v[126:127], v11 offset:5120
  s_waitcnt vmcnt(19) lgkmcnt(8)
  v_mfma_f32_32x32x16_bf16 v[24:39], v[104:107], v[56:59], v[24:39]
  s_xor_b32 s28, s24, 7
  s_lshl_b32 s28, s28, 13
  s_add_u32 s28, s28, 65536
  v_add_u32 v12, s28, v14
  ds_read_b64_tr_b16 v[128:129], v10 offset:6144
  ds_read_b64_tr_b16 v[130:131], v10 offset:7168
  v_mfma_f32_32x32x16_bf16 v[40:55], v[108:111], v[56:59], v[40:55]
  v_add_u32 v13, s28, v15
  s_andn2_b32 s33, s36, s34
  s_cbranch_scc0 .g2_kernel_w_i10c
.g2_kernel_w_i10b:
  s_ff1_i32_b32 s33, s33
  ds_read_b64_tr_b16 v[132:133], v11 offset:6144
  ds_read_b64_tr_b16 v[134:135], v11 offset:7168
  s_waitcnt vmcnt(18) lgkmcnt(8)
  v_mfma_f32_32x32x16_bf16 v[24:39], v[112:115], v[60:63], v[24:39]
  s_bitset1_b32 s34, s33
  s_xor_b32 s33, s33, s24
  s_and_b32 s10, s33, 7
  s_cmp_lt_u32 s10, 2
  ds_read_b64_tr_b16 v[104:105], v12 offset:0
  ds_read_b64_tr_b16 v[106:107], v12 offset:1024
  v_mfma_f32_32x32x16_bf16 v[40:55], v[116:119], v[60:63], v[40:55]
  s_cselect_b32 s28, 139264, 0
  s_lshl_b32 s10, s10, 13
  s_add_u32 s10, s10, s28
  s_lshl_b32 s33, s33, 12
  ds_read_b64_tr_b16 v[108:109], v13 offset:0
  ds_read_b64_tr_b16 v[110:111], v13 offset:1024
  s_waitcnt vmcnt(17) lgkmcnt(8)
  v_mfma_f32_32x32x16_bf16 v[24:39], v[120:123], v[64:67], v[24:39]
  s_add_u32 s22, s20, s33
  s_addc_u32 s23, s21, 0
  global_load_dwordx4 v[192:195], v3, s[22:23] offset:0
  global_load_dwordx4 v[196:199], v3, s[22:23] offset:1024
  ds_read_b64_tr_b16 v[112:113], v12 offset:2048
  ds_read_b64_tr_b16 v[114:115], v12 offset:3072
  v_mfma_f32_32x32x16_bf16 v[40:55], v[124:127], v[64:67], v[40:55]
  global_load_dwordx4 v[200:203], v3, s[22:23] offset:2048
  global_load_dwordx4 v[204:207], v3, s[22:23] offset:3072
  ds_read_b64_tr_b16 v[116:117], v13 offset:2048
  ds_read_b64_tr_b16 v[118:119], v13 offset:3072
  s_waitcnt vmcnt(20) lgkmcnt(8)
  v_mfma_f32_32x32x16_bf16 v[24:39], v[128:131], v[68:71], v[24:39]
  ds_read_b64_tr_b16 v[120:121], v12 offset:4096
  ds_read_b64_tr_b16 v[122:123], v12 offset:5120
  v_mfma_f32_32x32x16_bf16 v[40:55], v[132:135], v[68:71], v[40:55]
  ds_read_b64_tr_b16 v[124:125], v13 offset:4096
  ds_read_b64_tr_b16 v[126:127], v13 offset:5120
  s_waitcnt vmcnt(19) lgkmcnt(8)
  v_mfma_f32_32x32x16_bf16 v[24:39], v[104:107], v[72:75], v[24:39]
  s_andn2_b32 s33, s36, s34
  s_cbranch_scc0 .g2_kernel_w_i11c
.g2_kernel_w_i11b:
  s_ff1_i32_b32 s33, s33
  ds_read_b64_tr_b16 v[128:129], v12 offset:6144
  ds_read_b64_tr_b16 v[130:131], v12 offset:7168
  v_mfma_f32_32x32x16_bf16 v[40:55], v[108:111], v[72:75], v[40:55]
  s_bitset1_b32 s34, s33
  s_xor_b32 s33, s33, s24
  s_and_b32 s11, s33, 7
  ds_read_b64_tr_b16 v[132:133], v13 offset:6144
  ds_read_b64_tr_b16 v[134:135], v13 offset:7168
  s_waitcnt vmcnt(18) lgkmcnt(8)
  v_mfma_f32_32x32x16_bf16 v[24:39], v[112:115], v[76:79], v[24:39]
  s_cmp_lt_u32 s11, 2
  s_cselect_b32 s28, 139264, 0
  s_lshl_b32 s11, s11, 13
  v_mfma_f32_32x32x16_bf16 v[40:55], v[116:119], v[76:79], v[40:55]
  s_add_u32 s11, s11, s28
  s_lshl_b32 s33, s33, 12
  s_add_u32 s22, s20, s33
  s_waitcnt vmcnt(17) lgkmcnt(4)
  v_mfma_f32_32x32x16_bf16 v[24:39], v[120:123], v[80:83], v[24:39]
  s_addc_u32 s23, s21, 0
  global_load_dwordx4 v[208:211], v3, s[22:23] offset:0
  global_load_dwordx4 v[212:215], v3, s[22:23] offset:1024
  v_mfma_f32_32x32x16_bf16 v[40:55], v[124:127], v[80:83], v[40:55]
  global_load_dwordx4 v[216:219], v3, s[22:23] offset:2048
  global_load_dwordx4 v[220:223], v3, s[22:23] offset:3072
  s_waitcnt vmcnt(20) lgkmcnt(0)
  v_mfma_f32_32x32x16_bf16 v[24:39], v[128:131], v[84:87], v[24:39]
  v_mfma_f32_32x32x16_bf16 v[40:55], v[132:135], v[84:87], v[40:55]
  ds_read_b32 v16, v20 offset:12
  v_add_u32 v10, s8, v14
  v_add_u32 v11, s8, v15
  s_waitcnt lgkmcnt(0)
  v_cmp_gt_u32 vcc, 4, v16
  s_cbranch_vccnz .g2_kernel_w_bw
.g2_kernel_w_bb:
  ds_read_b64_tr_b16 v[104:105], v10 offset:0
  ds_read_b64_tr_b16 v[106:107], v10 offset:1024
  ds_read_b64_tr_b16 v[108:109], v11 offset:0
  ds_read_b64_tr_b16 v[110:111], v11 offset:1024
  ds_read_b64_tr_b16 v[112:113], v10 offset:2048
  ds_read_b64_tr_b16 v[114:115], v10 offset:3072
  ds_read_b64_tr_b16 v[116:117], v11 offset:2048
  ds_read_b64_tr_b16 v[118:119], v11 offset:3072
  ds_read_b64_tr_b16 v[120:121], v10 offset:4096
  ds_read_b64_tr_b16 v[122:123], v10 offset:5120
  ds_read_b64_tr_b16 v[124:125], v11 offset:4096
  ds_read_b64_tr_b16 v[126:127], v11 offset:5120
  s_waitcnt vmcnt(16)
  v_min3_u32 v6, v88, v90, v92
  v_min3_u32 v7, v94, v96, v98
  v_min3_u32 v6, v6, v100, v102
  v_min_u32 v6, v6, v7
  v_cmp_eq_u32 vcc, 0, v6
  s_cbranch_vccnz .g2_kernel_w_v8
.g2_kernel_w_vb8:
  s_waitcnt lgkmcnt(8)
  v_mfma_f32_32x32x16_bf16 v[24:39], v[104:107], v[88:91], v[24:39]
  v_add_u32 v12, s9, v14
  v_add_u32 v13, s9, v15
  s_andn2_b32 s33, s36, s34
  s_cbranch_scc0 .g2_kernel_w_i12c
.g2_kernel_w_i12b:
  ds_read_b64_tr_b16 v[128:129], v10 offset:6144
  ds_read_b64_tr_b16 v[130:131], v10 offset:7168
  v_mfma_f32_32x32x16_bf16 v[40:55], v[108:111], v[88:91], v[40:55]
  s_ff1_i32_b32 s33, s33
  s_bitset1_b32 s34, s33
  s_xor_b32 s33, s33, s24
  s_and_b32 s12, s33, 7
  ds_read_b64_tr_b16 v[132:133], v11 offset:6144
  ds_read_b64_tr_b16 v[134:135], v11 offset:7168
  s_waitcnt lgkmcnt(8)
  v_mfma_f32_32x32x16_bf16 v[24:39], v[112:115], v[92:95], v[24:39]
  s_cmp_lt_u32 s12, 2
  s_cselect_b32 s28, 139264, 0
  s_lshl_b32 s12, s12, 13
  s_add_u32 s12, s12, s28
  ds_read_b64_tr_b16 v[104:105], v12 offset:0
  ds_read_b64_tr_b16 v[106:107], v12 offset:1024
  v_mfma_f32_32x32x16_bf16 v[40:55], v[116:119], v[92:95], v[40:55]
  s_lshl_b32 s33, s33, 12
  s_add_u32 s22, s20, s33
  s_addc_u32 s23, s21, 0
  global_load_dwordx4 v[224:227], v3, s[22:23] offset:0
  ds_read_b64_tr_b16 v[108:109], v13 offset:0
  ds_read_b64_tr_b16 v[110:111], v13 offset:1024
  s_waitcnt lgkmcnt(8)
  v_mfma_f32_32x32x16_bf16 v[24:39], v[120:123], v[96:99], v[24:39]
  global_load_dwordx4 v[228:231], v3, s[22:23] offset:1024
  global_load_dwordx4 v[232:235], v3, s[22:23] offset:2048
  global_load_dwordx4 v[236:239], v3, s[22:23] offset:3072
  ds_read_b64_tr_b16 v[112:113], v12 offset:2048
  ds_read_b64_tr_b16 v[114:115], v12 offset:3072
  v_mfma_f32_32x32x16_bf16 v[40:55], v[124:127], v[96:99], v[40:55]
  ds_read_b64_tr_b16 v[116:117], v13 offset:2048
  ds_read_b64_tr_b16 v[118:119], v13 offset:3072
  s_waitcnt lgkmcnt(8)
  v_mfma_f32_32x32x16_bf16 v[24:39], v[128:131], v[100:103], v[24:39]
  ds_read_b64_tr_b16 v[120:121], v12 offset:4096
  ds_read_b64_tr_b16 v[122:123], v12 offset:5120
  s_waitcnt vmcnt(16)
  v_min3_u32 v6, v176, v178, v180
  v_min3_u32 v7, v182, v184, v186
  v_min3_u32 v6, v6, v188, v190
  v_min_u32 v6, v6, v7
  v_cmp_eq_u32 vcc, 0, v6
  v_mfma_f32_32x32x16_bf16 v[40:55], v[132:135], v[100:103], v[40:55]
  ds_read_b64_tr_b16 v[124:125], v13 offset:4096
  ds_read_b64_tr_b16 v[126:127], v13 offset:5120
  s_cbranch_vccnz .g2_kernel_w_v9
.g2_kernel_w_vb9:
  s_waitcnt lgkmcnt(8)
  v_mfma_f32_32x32x16_bf16 v[24:39], v[104:107], v[176:179], v[24:39]
  v_add_u32 v10, s10, v14
  v_add_u32 v11, s10, v15
  s_andn2_b32 s33, s36, s34
  s_cbranch_scc0 .g2_kernel_w_i13c
.g2_kernel_w_i13b:
  ds_read_b64_tr_b16 v[128:129], v12 offset:6144
  ds_read_b64_tr_b16 v[130:131], v12 offset:7168
  v_mfma_f32_32x32x16_bf16 v[40:55], v[108:111], v[176:179], v[40:55]
  s_ff1_i32_b32 s33, s33
  s_bitset1_b32 s34, s33
  s_xor_b32 s33, s33, s24
  s_and_b32 s13, s33, 7
  ds_read_b64_tr_b16 v[132:133], v13 offset:6144
  ds_read_b64_tr_b16 v[134:135], v13 offset:7168
  s_waitcnt lgkmcnt(8)
  v_mfma_f32_32x32x16_bf16 v[24:39], v[112:115], v[180:183], v[24:39]
  s_cmp_lt_u32 s13, 2
  s_cselect_b32 s28, 139264, 0
  s_lshl_b32 s13, s13, 13
  s_add_u32 s13, s13, s28
  ds_read_b64_tr_b16 v[104:105], v10 offset:0
  ds_read_b64_tr_b16 v[106:107], v10 offset:1024
  v_mfma_f32_32x32x16_bf16 v[40:55], v[116:119], v[180:183], v[40:55]
  s_lshl_b32 s33, s33, 12
  s_add_u32 s22, s20, s33
  s_addc_u32 s23, s21, 0
  global_load_dwordx4 v[136:139], v3, s[22:23] offset:0
  ds_read_b64_tr_b16 v[108:109], v11 offset:0
  ds_read_b64_tr_b16 v[110:111], v11 offset:1024
  s_waitcnt lgkmcnt(8)
  v_mfma_f32_32x32x16_bf16 v[24:39], v[120:123], v[184:187], v[24:39]
  global_load_dwordx4 v[140:143], v3, s[22:23] offset:1024
  global_load_dwordx4 v[144:147], v3, s[22:23] offset:2048
  global_load_dwordx4 v[148:151], v3, s[22:23] offset:3072
  ds_read_b64_tr_b16 v[112:113], v10 offset:2048
  ds_read_b64_tr_b16 v[114:115], v10 offset:3072
  v_mfma_f32_32x32x16_bf16 v[40:55], v[124:127], v[184:187], v[40:55]
  ds_read_b64_tr_b16 v[116:117], v11 offset:2048
  ds_read_b64_tr_b16 v[118:119], v11 offset:3072
  s_waitcnt lgkmcnt(8)
  v_mfma_f32_32x32x16_bf16 v[24:39], v[128:131], v[188:191], v[24:39]
  ds_read_b64_tr_b16 v[120:121], v10 offset:4096
  ds_read_b64_tr_b16 v[122:123], v10 offset:5120
  s_waitcnt vmcnt(12)
  v_min3_u32 v6, v192, v194, v196
  v_min3_u32 v7, v198, v200, v202
  v_min3_u32 v6, v6, v204, v206
  v_min_u32 v6, v6, v7
  v_cmp_eq_u32 vcc, 0, v6
  v_mfma_f32_32x32x16_bf16 v[40:55], v[132:135], v[188:191], v[40:55]
  ds_read_b64_tr_b16 v[124:125], v11 offset:4096
  ds_read_b64_tr_b16 v[126:127], v11 offset:5120
  s_cbranch_vccnz .g2_kernel_w_v10
.g2_kernel_w_vb10:
  s_waitcnt lgkmcnt(8)
  v_mfma_f32_32x32x16_bf16 v[24:39], v[104:107], v[192:195], v[24:39]
  v_add_u32 v12, s11, v14
  v_add_u32 v13, s11, v15
  s_andn2_b32 s33, s36, s34
  s_cbranch_scc0 .g2_kernel_w_i14c
.g2_kernel_w_i14b:
  ds_read_b64_tr_b16 v[128:129], v10 offset:6144
  ds_read_b64_tr_b16 v[130:131], v10 offset:7168
  v_mfma_f32_32x32x16_bf16 v[40:55], v[108:111], v[192:195], v[40:55]
  s_ff1_i32_b32 s33, s33
  s_bitset1_b32 s34, s33
  s_xor_b32 s33, s33, s24
  s_and_b32 s14, s33, 7
  ds_read_b64_tr_b16 v[132:133], v11 offset:6144
  ds_read_b64_tr_b16 v[134:135], v11 offset:7168
  s_waitcnt lgkmcnt(8)
  v_mfma_f32_32x32x16_bf16 v[24:39], v[112:115], v[196:199], v[24:39]
  s_cmp_lt_u32 s14, 2
  s_cselect_b32 s28, 139264, 0
  s_lshl_b32 s14, s14, 13
  s_add_u32 s14, s14, s28
  ds_read_b64_tr_b16 v[104:105], v12 offset:0
  ds_read_b64_tr_b16 v[106:107], v12 offset:1024
  v_mfma_f32_32x32x16_bf16 v[40:55], v[116:119], v[196:199], v[40:55]
  s_lshl_b32 s33, s33, 12
  s_add_u32 s22, s20, s33
  s_addc_u32 s23, s21, 0
  global_load_dwordx4 v[152:155], v3, s[22:23] offset:0 sc1
  ds_read_b64_tr_b16 v[108:109], v13 offset:0
  ds_read_b64_tr_b16 v[110:111], v13 offset:1024
  s_waitcnt lgkmcnt(8)
  v_mfma_f32_32x32x16_bf16 v[24:39], v[120:123], v[200:203], v[24:39]
  global_load_dwordx4 v[156:159], v3, s[22:23] offset:1024 sc1
  global_load_dwordx4 v[160:163], v3, s[22:23] offset:2048 sc1
  global_load_dwordx4 v[164:167], v3, s[22:23] offset:3072 sc1
  ds_read_b64_tr_b16 v[112:113], v12 offset:2048
  ds_read_b64_tr_b16 v[114:115], v12 offset:3072
  v_mfma_f32_32x32x16_bf16 v[40:55], v[124:127], v[200:203], v[40:55]
  ds_read_b64_tr_b16 v[116:117], v13 offset:2048
  ds_read_b64_tr_b16 v[118:119], v13 offset:3072
  s_waitcnt lgkmcnt(8)
  v_mfma_f32_32x32x16_bf16 v[24:39], v[128:131], v[204:207], v[24:39]
  ds_read_b64_tr_b16 v[120:121], v12 offset:4096
  ds_read_b64_tr_b16 v[122:123], v12 offset:5120
  s_waitcnt vmcnt(12)
  v_min3_u32 v6, v208, v210, v212
  v_min3_u32 v7, v214, v216, v218
  v_min3_u32 v6, v6, v220, v222
  v_min_u32 v6, v6, v7
  v_cmp_eq_u32 vcc, 0, v6
  v_mfma_f32_32x32x16_bf16 v[40:55], v[132:135], v[204:207], v[40:55]
  ds_read_b64_tr_b16 v[124:125], v13 offset:4096
  ds_read_b64_tr_b16 v[126:127], v13 offset:5120
  s_cbranch_vccnz .g2_kernel_w_v11
.g2_kernel_w_vb11:
  s_mov_b64 exec, 1
  ds_add_u32 v20, v5 offset:16
  s_mov_b64 exec, -1
  s_waitcnt lgkmcnt(8)
  v_mfma_f32_32x32x16_bf16 v[24:39], v[104:107], v[208:211], v[24:39]
  v_add_u32 v10, s12, v14
  v_add_u32 v11, s12, v15
  s_andn2_b32 s33, s36, s34
  s_cbranch_scc0 .g2_kernel_w_i15c
.g2_kernel_w_i15b:
  ds_read_b64_tr_b16 v[128:129], v12 offset:6144
  ds_read_b64_tr_b16 v[130:131], v12 offset:7168
  v_mfma_f32_32x32x16_bf16 v[40:55], v[108:111], v[208:211], v[40:55]
  s_ff1_i32_b32 s33, s33
  s_bitset1_b32 s34, s33
  s_xor_b32 s33, s33, s24
  s_and_b32 s15, s33, 7
  ds_read_b64_tr_b16 v[132:133], v13 offset:6144
  ds_read_b64_tr_b16 v[134:135], v13 offset:7168
  s_waitcnt lgkmcnt(8)
  v_mfma_f32_32x32x16_bf16 v[24:39], v[112:115], v[212:215], v[24:39]
  s_cmp_lt_u32 s15, 2
  s_cselect_b32 s28, 139264, 0
  s_lshl_b32 s15, s15, 13
  s_add_u32 s15, s15, s28
  ds_read_b64_tr_b16 v[104:105], v10 offset:0
  ds_read_b64_tr_b16 v[106:107], v10 offset:1024
  v_mfma_f32_32x32x16_bf16 v[40:55], v[116:119], v[212:215], v[40:55]
  s_lshl_b32 s33, s33, 12
  s_add_u32 s22, s20, s33
  s_addc_u32 s23, s21, 0
  global_load_dwordx4 v[56:59], v3, s[22:23] offset:0 sc1
  ds_read_b64_tr_b16 v[108:109], v11 offset:0
  ds_read_b64_tr_b16 v[110:111], v11 offset:1024
  s_waitcnt lgkmcnt(8)
  v_mfma_f32_32x32x16_bf16 v[24:39], v[120:123], v[216:219], v[24:39]
  global_load_dwordx4 v[60:63], v3, s[22:23] offset:1024 sc1
  global_load_dwordx4 v[64:67], v3, s[22:23] offset:2048 sc1
  global_load_dwordx4 v[68:71], v3, s[22:23] offset:3072 sc1
  ds_read_b64_tr_b16 v[112:113], v10 offset:2048
  ds_read_b64_tr_b16 v[114:115], v10 offset:3072
  v_mfma_f32_32x32x16_bf16 v[40:55], v[124:127], v[216:219], v[40:55]
  ds_read_b64_tr_b16 v[116:117], v11 offset:2048
  ds_read_b64_tr_b16 v[118:119], v11 offset:3072
  s_waitcnt lgkmcnt(8)
  v_mfma_f32_32x32x16_bf16 v[24:39], v[128:131], v[220:223], v[24:39]
  ds_read_b64_tr_b16 v[120:121], v10 offset:4096
  ds_read_b64_tr_b16 v[122:123], v10 offset:5120
  s_waitcnt vmcnt(12)
  v_min3_u32 v6, v224, v226, v228
  v_min3_u32 v7, v230, v232, v234
  v_min3_u32 v6, v6, v236, v238
  v_min_u32 v6, v6, v7
  v_cmp_eq_u32 vcc, 0, v6
  v_mfma_f32_32x32x16_bf16 v[40:55], v[132:135], v[220:223], v[40:55]
  ds_read_b64_tr_b16 v[124:125], v11 offset:4096
  ds_read_b64_tr_b16 v[126:127], v11 offset:5120
  s_cbranch_vccnz .g2_kernel_w_v12
.g2_kernel_w_vb12:
  s_waitcnt lgkmcnt(8)
  v_mfma_f32_32x32x16_bf16 v[24:39], v[104:107], v[224:227], v[24:39]
  v_add_u32 v12, s13, v14
  v_add_u32 v13, s13, v15
  ds_read_b64_tr_b16 v[128:129], v10 offset:6144
  ds_read_b64_tr_b16 v[130:131], v10 offset:7168
  v_mfma_f32_32x32x16_bf16 v[40:55], v[108:111], v[224:227], v[40:55]
  ds_read_b64_tr_b16 v[132:133], v11 offset:6144
  ds_read_b64_tr_b16 v[134:135], v11 offset:7168
  s_waitcnt lgkmcnt(8)
  v_mfma_f32_32x32x16_bf16 v[24:39], v[112:115], v[228:231], v[24:39]
  ds_read_b64_tr_b16 v[104:105], v12 offset:0
  ds_read_b64_tr_b16 v[106:107], v12 offset:1024
  v_mfma_f32_32x32x16_bf16 v[40:55], v[116:119], v[228:231], v[40:55]
  ds_read_b64_tr_b16 v[108:109], v13 offset:0
  ds_read_b64_tr_b16 v[110:111], v13 offset:1024
  s_waitcnt lgkmcnt(8)
  v_mfma_f32_32x32x16_bf16 v[24:39], v[120:123], v[232:235], v[24:39]
  ds_read_b64_tr_b16 v[112:113], v12 offset:2048
  ds_read_b64_tr_b16 v[114:115], v12 offset:3072
  v_mfma_f32_32x32x16_bf16 v[40:55], v[124:127], v[232:235], v[40:55]
  ds_read_b64_tr_b16 v[116:117], v13 offset:2048
  ds_read_b64_tr_b16 v[118:119], v13 offset:3072
  s_waitcnt lgkmcnt(8)
  v_mfma_f32_32x32x16_bf16 v[24:39], v[128:131], v[236:239], v[24:39]
  ds_read_b64_tr_b16 v[120:121], v12 offset:4096
  ds_read_b64_tr_b16 v[122:123], v12 offset:5120
  s_waitcnt vmcnt(8)
  v_min3_u32 v6, v136, v138, v140
  v_min3_u32 v7, v142, v144, v146
  v_min3_u32 v6, v6, v148, v150
  v_min_u32 v6, v6, v7
  v_cmp_eq_u32 vcc, 0, v6
  v_mfma_f32_32x32x16_bf16 v[40:55], v[132:135], v[236:239], v[40:55]
  ds_read_b64_tr_b16 v[124:125], v13 offset:4096
  ds_read_b64_tr_b16 v[126:127], v13 offset:5120
  s_cbranch_vccnz .g2_kernel_w_v13
.g2_kernel_w_vb13:
  s_waitcnt lgkmcnt(8)
  v_mfma_f32_32x32x16_bf16 v[24:39], v[104:107], v[136:139], v[24:39]
  v_add_u32 v10, s14, v14
  v_add_u32 v11, s14, v15
  ds_read_b64_tr_b16 v[128:129], v12 offset:6144
  ds_read_b64_tr_b16 v[130:131], v12 offset:7168
  v_mfma_f32_32x32x16_bf16 v[40:55], v[108:111], v[136:139], v[40:55]
  ds_read_b64_tr_b16 v[132:133], v13 offset:6144
  ds_read_b64_tr_b16 v[134:135], v13 offset:7168
  s_waitcnt lgkmcnt(8)
  v_mfma_f32_32x32x16_bf16 v[24:39], v[112:115], v[140:143], v[24:39]
  ds_read_b64_tr_b16 v[104:105], v10 offset:0
  ds_read_b64_tr_b16 v[106:107], v10 offset:1024
  v_mfma_f32_32x32x16_bf16 v[40:55], v[116:119], v[140:143], v[40:55]
  ds_read_b64_tr_b16 v[108:109], v11 offset:0
  ds_read_b64_tr_b16 v[110:111], v11 offset:1024
  s_waitcnt lgkmcnt(8)
  v_mfma_f32_32x32x16_bf16 v[24:39], v[120:123], v[144:147], v[24:39]
  ds_read_b64_tr_b16 v[112:113], v10 offset:2048
  ds_read_b64_tr_b16 v[114:115], v10 offset:3072
  v_mfma_f32_32x32x16_bf16 v[40:55], v[124:127], v[144:147], v[40:55]
  ds_read_b64_tr_b16 v[116:117], v11 offset:2048
  ds_read_b64_tr_b16 v[118:119], v11 offset:3072
  s_waitcnt lgkmcnt(8)
  v_mfma_f32_32x32x16_bf16 v[24:39], v[128:131], v[148:151], v[24:39]
  ds_read_b64_tr_b16 v[120:121], v10 offset:4096
  ds_read_b64_tr_b16 v[122:123], v10 offset:5120
  s_waitcnt vmcnt(4)
  v_min3_u32 v6, v152, v154, v156
  v_min3_u32 v7, v158, v160, v162
  v_min3_u32 v6, v6, v164, v166
  v_min_u32 v6, v6, v7
  v_cmp_eq_u32 vcc, 0, v6
  v_mfma_f32_32x32x16_bf16 v[40:55], v[132:135], v[148:151], v[40:55]
  ds_read_b64_tr_b16 v[124:125], v11 offset:4096
  ds_read_b64_tr_b16 v[126:127], v11 offset:5120
  s_cbranch_vccnz .g2_kernel_w_v14
.g2_kernel_w_vb14:
  s_waitcnt lgkmcnt(8)
  v_mfma_f32_32x32x16_bf16 v[24:39], v[104:107], v[152:155], v[24:39]
  v_add_u32 v12, s15, v14
  v_add_u32 v13, s15, v15
  ds_read_b64_tr_b16 v[128:129], v10 offset:6144
  ds_read_b64_tr_b16 v[130:131], v10 offset:7168
  v_mfma_f32_32x32x16_bf16 v[40:55], v[108:111], v[152:155], v[40:55]
  ds_read_b64_tr_b16 v[132:133], v11 offset:6144
  ds_read_b64_tr_b16 v[134:135], v11 offset:7168
  s_waitcnt lgkmcnt(8)
  v_mfma_f32_32x32x16_bf16 v[24:39], v[112:115], v[156:159], v[24:39]
  ds_read_b64_tr_b16 v[104:105], v12 offset:0
  ds_read_b64_tr_b16 v[106:107], v12 offset:1024
  v_mfma_f32_32x32x16_bf16 v[40:55], v[116:119], v[156:159], v[40:55]
  ds_read_b64_tr_b16 v[108:109], v13 offset:0
  ds_read_b64_tr_b16 v[110:111], v13 offset:1024
  s_waitcnt lgkmcnt(8)
  v_mfma_f32_32x32x16_bf16 v[24:39], v[120:123], v[160:163], v[24:39]
  ds_read_b64_tr_b16 v[112:113], v12 offset:2048
  ds_read_b64_tr_b16 v[114:115], v12 offset:3072
  v_mfma_f32_32x32x16_bf16 v[40:55], v[124:127], v[160:163], v[40:55]
  ds_read_b64_tr_b16 v[116:117], v13 offset:2048
  ds_read_b64_tr_b16 v[118:119], v13 offset:3072
  s_waitcnt lgkmcnt(8)
  v_mfma_f32_32x32x16_bf16 v[24:39], v[128:131], v[164:167], v[24:39]
  ds_read_b64_tr_b16 v[120:121], v12 offset:4096
  ds_read_b64_tr_b16 v[122:123], v12 offset:5120
  s_waitcnt vmcnt(0)
  v_min3_u32 v6, v56, v58, v60
  v_min3_u32 v7, v62, v64, v66
  v_min3_u32 v6, v6, v68, v70
  v_min_u32 v6, v6, v7
  v_cmp_eq_u32 vcc, 0, v6
  v_mfma_f32_32x32x16_bf16 v[40:55], v[132:135], v[164:167], v[40:55]
  ds_read_b64_tr_b16 v[124:125], v13 offset:4096
  ds_read_b64_tr_b16 v[126:127], v13 offset:5120
  s_cbranch_vccnz .g2_kernel_w_v15
.g2_kernel_w_vb15:
  s_waitcnt lgkmcnt(8)
  v_mfma_f32_32x32x16_bf16 v[24:39], v[104:107], v[56:59], v[24:39]
  ds_read_b64_tr_b16 v[128:129], v12 offset:6144
  ds_read_b64_tr_b16 v[130:131], v12 offset:7168
  v_mfma_f32_32x32x16_bf16 v[40:55], v[108:111], v[56:59], v[40:55]
  ds_read_b64_tr_b16 v[132:133], v13 offset:6144
  ds_read_b64_tr_b16 v[134:135], v13 offset:7168
  s_waitcnt lgkmcnt(8)
  v_mfma_f32_32x32x16_bf16 v[24:39], v[112:115], v[60:63], v[24:39]
  v_mfma_f32_32x32x16_bf16 v[40:55], v[116:119], v[60:63], v[40:55]
  s_waitcnt lgkmcnt(4)
  v_mfma_f32_32x32x16_bf16 v[24:39], v[120:123], v[64:67], v[24:39]
  v_mfma_f32_32x32x16_bf16 v[40:55], v[124:127], v[64:67], v[40:55]
  s_waitcnt lgkmcnt(0)
  v_mfma_f32_32x32x16_bf16 v[24:39], v[128:131], v[68:71], v[24:39]
  v_mfma_f32_32x32x16_bf16 v[40:55], v[132:135], v[68:71], v[40:55]
  s_lshl_b32 s28, s17, 4
  s_add_u32 s28, s28, s18
  s_lshl_b32 s28, s28, 2
  s_add_u32 s28, s28, s16
  s_lshl_b32 s28, s28, 12
  s_add_u32 s28, s28, s63
  s_add_u32 s28, s28, 0xc00000
  s_lshl_b32 s29, s16, 12
  v_add_u32 v6, s29, v22
  s_mov_b32 s36, 0x3f803f80
  v_mov_b32 v8, 0
  v_mov_b32 v9, 0
  v_mov_b32 v10, 0
  v_and_b32 v7, 24, v18
  v_lshlrev_b32 v7, 8, v7
  v_and_b32 v11, 7, v18
  v_lshl_add_u32 v7, v11, 4, v7
  v_cvt_pk_bf16_f32 v56, v24, v25
  v_cvt_pk_bf16_f32 v57, v26, v27
  v_cvt_pk_bf16_f32 v58, v28, v29
  v_cvt_pk_bf16_f32 v59, v30, v31
  buffer_store_dwordx4 v[56:59], v22, s[4:7], s28 offen offset:0 sc1
  v_cvt_pk_bf16_f32 v60, v32, v33
  v_cvt_pk_bf16_f32 v61, v34, v35
  v_cvt_pk_bf16_f32 v62, v36, v37
  v_cvt_pk_bf16_f32 v63, v38, v39
  buffer_store_dwordx4 v[60:63], v22, s[4:7], s28 offen offset:512 sc1
  v_cvt_pk_bf16_f32 v64, v40, v41
  v_cvt_pk_bf16_f32 v65, v42, v43
  v_cvt_pk_bf16_f32 v66, v44, v45
  v_cvt_pk_bf16_f32 v67, v46, v47
  buffer_store_dwordx4 v[64:67], v22, s[4:7], s28 offen offset:1024 sc1
  v_cvt_pk_bf16_f32 v68, v48, v49
  v_cvt_pk_bf16_f32 v69, v50, v51
  v_cvt_pk_bf16_f32 v70, v52, v53
  v_cvt_pk_bf16_f32 v71, v54, v55
  buffer_store_dwordx4 v[68:71], v22, s[4:7], s28 offen offset:1536 sc1
  ds_write_b128 v6, v[56:59] offset:0
  ds_write_b128 v6, v[60:63] offset:512
  ds_write_b128 v6, v[64:67] offset:1024
  ds_write_b128 v6, v[68:71] offset:1536
  s_mov_b64 exec, 1
  ds_add_u32 v20, v5 offset:20
  s_mov_b64 exec, -1
  s_lshl_b32 s28, s17, 2
  s_add_u32 s28, s28, s16
  s_lshl_b32 s28, s28, 13
  s_lshl_b32 s29, s18, 7
  s_add_u32 s28, s28, s29
  s_add_u32 s28, s28, s63
  s_add_u32 s28, s28, 0x1000000
  v_dot2c_f32_bf16 v8, s36, v56
  v_dot2c_f32_bf16 v9, v56, v56
  v_dot2c_f32_bf16 v10, v56, v240
  v_dot2c_f32_bf16 v8, s36, v57
  v_dot2c_f32_bf16 v9, v57, v57
  v_dot2c_f32_bf16 v10, v57, v241
  v_dot2c_f32_bf16 v8, s36, v58
  v_dot2c_f32_bf16 v9, v58, v58
  v_dot2c_f32_bf16 v10, v58, v242
  v_dot2c_f32_bf16 v8, s36, v59
  v_dot2c_f32_bf16 v9, v59, v59
  v_dot2c_f32_bf16 v10, v59, v243
  v_dot2c_f32_bf16 v8, s36, v60
  v_dot2c_f32_bf16 v9, v60, v60
  v_dot2c_f32_bf16 v10, v60, v244
  v_dot2c_f32_bf16 v8, s36, v61
  v_dot2c_f32_bf16 v9, v61, v61
  v_dot2c_f32_bf16 v10, v61, v245
  v_dot2c_f32_bf16 v8, s36, v62
  v_dot2c_f32_bf16 v9, v62, v62
  v_dot2c_f32_bf16 v10, v62, v246
  v_dot2c_f32_bf16 v8, s36, v63
  v_dot2c_f32_bf16 v9, v63, v63
  v_dot2c_f32_bf16 v10, v63, v247
  v_dot2c_f32_bf16 v8, s36, v64
  v_dot2c_f32_bf16 v9, v64, v64
  v_dot2c_f32_bf16 v10, v64, v248
  v_dot2c_f32_bf16 v8, s36, v65
  v_dot2c_f32_bf16 v9, v65, v65
  v_dot2c_f32_bf16 v10, v65, v249
  v_dot2c_f32_bf16 v8, s36, v66
  v_dot2c_f32_bf16 v9, v66, v66
  v_dot2c_f32_bf16 v10, v66, v250
  v_dot2c_f32_bf16 v8, s36, v67
  v_dot2c_f32_bf16 v9, v67, v67
  v_dot2c_f32_bf16 v10, v67, v251
  v_dot2c_f32_bf16 v8, s36, v68
  v_dot2c_f32_bf16 v9, v68, v68
  v_dot2c_f32_bf16 v10, v68, v252
  v_dot2c_f32_bf16 v8, s36, v69
  v_dot2c_f32_bf16 v9, v69, v69
  v_dot2c_f32_bf16 v10, v69, v253
  v_dot2c_f32_bf16 v8, s36, v70
  v_dot2c_f32_bf16 v9, v70, v70
  v_dot2c_f32_bf16 v10, v70, v254
  v_dot2c_f32_bf16 v8, s36, v71
  v_dot2c_f32_bf16 v9, v71, v71
  v_dot2c_f32_bf16 v10, v71, v255
  s_lshl_b32 s29, s16, 7
  s_add_u32 s37, s19, s29
  v_mov_b32 v24, v8
  v_mov_b32 v25, v9
  v_mov_b32 v26, v10
  v_mov_b32 v11, 1
  v_permlane32_swap_b32 v8, v24
  v_permlane32_swap_b32 v9, v25
  v_permlane32_swap_b32 v10, v26
  v_add_f32 v8, v8, v24
  v_add_f32 v9, v9, v25
  v_add_f32 v10, v10, v26
  v_or_b32 v8, 1, v8
  v_mov_b32 v16, s70
  s_mov_b32 exec_hi, 0
  s_waitcnt vmcnt(0)
  buffer_store_dwordx4 v[8:11], v7, s[4:7], s28 offen sc1
  s_mov_b64 exec, 1
  buffer_store_dword v16, v4, s[4:7], s37 offen offset:8 sc1
  s_mov_b64 exec, -1
  s_cmp_lg_u32 s62, 0
  s_cbranch_scc1 .g2_kernel_tail
  s_mov_b32 s62, 1
  s_mov_b32 s63, 0x1800000
  s_mov_b32 s70, 2
  s_mov_b32 s71, 155776
  s_branch .g2_kernel_q_cons2
.g2_kernel_tail:
  s_mov_b32 s28, s56
  s_mov_b32 s29, s57
  s_mov_b32 s30, 0x400000
  s_mov_b32 s31, 0x00020000
  v_lshlrev_b32 v24, 16, v56
  v_and_b32 v25, 0xffff0000, v56
  v_lshlrev_b32 v26, 16, v57
  v_and_b32 v27, 0xffff0000, v57
  v_lshlrev_b32 v28, 16, v58
  v_and_b32 v29, 0xffff0000, v58
  v_lshlrev_b32 v30, 16, v59
  v_and_b32 v31, 0xffff0000, v59
  v_lshlrev_b32 v32, 16, v60
  v_and_b32 v33, 0xffff0000, v60
  v_lshlrev_b32 v34, 16, v61
  v_and_b32 v35, 0xffff0000, v61
  v_lshlrev_b32 v36, 16, v62
  v_and_b32 v37, 0xffff0000, v62
  v_lshlrev_b32 v38, 16, v63
  v_and_b32 v39, 0xffff0000, v63
  v_lshlrev_b32 v40, 16, v64
  v_and_b32 v41, 0xffff0000, v64
  v_lshlrev_b32 v42, 16, v65
  v_and_b32 v43, 0xffff0000, v65
  v_lshlrev_b32 v44, 16, v66
  v_and_b32 v45, 0xffff0000, v66
  v_lshlrev_b32 v46, 16, v67
  v_and_b32 v47, 0xffff0000, v67
  v_lshlrev_b32 v48, 16, v68
  v_and_b32 v49, 0xffff0000, v68
  v_lshlrev_b32 v50, 16, v69
  v_and_b32 v51, 0xffff0000, v69
  v_lshlrev_b32 v52, 16, v70
  v_and_b32 v53, 0xffff0000, v70
  v_lshlrev_b32 v54, 16, v71
  v_and_b32 v55, 0xffff0000, v71
  v_lshlrev_b32 v10, 2, v19
  v_add_u32 v10, 155644, v10
  s_lshl_b32 s32, s17, 2
  s_add_u32 s32, s32, s16
  s_lshl_b32 s32, s32, 16
  s_lshl_b32 s33, s18, 7
  s_add_u32 s32, s32, s33
  v_mov_b32 v6, s71
  s_mov_b32 s38, 0
.g2_kernel_wg5:
  ds_read_b32 v7, v6 offset:28
  s_add_u32 s38, s38, 1
  s_waitcnt lgkmcnt(0)
  v_cmp_le_u32 vcc, 1, v7
  s_cbranch_vccnz .g2_kernel_wg5d
  s_sleep 2
  s_cmp_lt_u32 s38, 524288
  s_cbranch_scc1 .g2_kernel_wg5
.g2_kernel_wg5d:
  ds_read_b32 v8, v10 offset:3840
  ds_read_b32 v9, v10 offset:4352
  ds_read_b32 v16, v20 offset:32
  s_waitcnt lgkmcnt(0)
  v_cmp_ne_u32 vcc, v16, v19
  v_pk_fma_f32 v[24:25], v[24:25], v[8:9], v[8:9] op_sel:[0,0,1] op_sel_hi:[1,0,1]
  v_pk_fma_f32 v[26:27], v[26:27], v[8:9], v[8:9] op_sel:[0,0,1] op_sel_hi:[1,0,1]
  v_pk_fma_f32 v[28:29], v[28:29], v[8:9], v[8:9] op_sel:[0,0,1] op_sel_hi:[1,0,1]
  v_pk_fma_f32 v[30:31], v[30:31], v[8:9], v[8:9] op_sel:[0,0,1] op_sel_hi:[1,0,1]
  v_pk_fma_f32 v[32:33], v[32:33], v[8:9], v[8:9] op_sel:[0,0,1] op_sel_hi:[1,0,1]
  v_pk_fma_f32 v[34:35], v[34:35], v[8:9], v[8:9] op_sel:[0,0,1] op_sel_hi:[1,0,1]
  v_pk_fma_f32 v[36:37], v[36:37], v[8:9], v[8:9] op_sel:[0,0,1] op_sel_hi:[1,0,1]
  v_pk_fma_f32 v[38:39], v[38:39], v[8:9], v[8:9] op_sel:[0,0,1] op_sel_hi:[1,0,1]
  v_pk_fma_f32 v[40:41], v[40:41], v[8:9], v[8:9] op_sel:[0,0,1] op_sel_hi:[1,0,1]
  v_pk_fma_f32 v[42:43], v[42:43], v[8:9], v[8:9] op_sel:[0,0,1] op_sel_hi:[1,0,1]
  v_pk_fma_f32 v[44:45], v[44:45], v[8:9], v[8:9] op_sel:[0,0,1] op_sel_hi:[1,0,1]
  v_pk_fma_f32 v[46:47], v[46:47], v[8:9], v[8:9] op_sel:[0,0,1] op_sel_hi:[1,0,1]
  v_pk_fma_f32 v[48:49], v[48:49], v[8:9], v[8:9] op_sel:[0,0,1] op_sel_hi:[1,0,1]
  v_pk_fma_f32 v[50:51], v[50:51], v[8:9], v[8:9] op_sel:[0,0,1] op_sel_hi:[1,0,1]
  v_pk_fma_f32 v[52:53], v[52:53], v[8:9], v[8:9] op_sel:[0,0,1] op_sel_hi:[1,0,1]
  v_pk_fma_f32 v[54:55], v[54:55], v[8:9], v[8:9] op_sel:[0,0,1] op_sel_hi:[1,0,1]
  v_cvt_pk_bf16_f32 v56, v24, v25
  v_cvt_pk_bf16_f32 v57, v26, v27
  v_cvt_pk_bf16_f32 v58, v28, v29
  v_cvt_pk_bf16_f32 v59, v30, v31
  v_cvt_pk_bf16_f32 v60, v32, v33
  v_cvt_pk_bf16_f32 v61, v34, v35
  v_cvt_pk_bf16_f32 v62, v36, v37
  v_cvt_pk_bf16_f32 v63, v38, v39
  v_cvt_pk_bf16_f32 v64, v40, v41
  v_cvt_pk_bf16_f32 v65, v42, v43
  v_cvt_pk_bf16_f32 v66, v44, v45
  v_cvt_pk_bf16_f32 v67, v46, v47
  v_cvt_pk_bf16_f32 v68, v48, v49
  v_cvt_pk_bf16_f32 v69, v50, v51
  v_cvt_pk_bf16_f32 v70, v52, v53
  v_cvt_pk_bf16_f32 v71, v54, v55
  s_mov_b64 exec, vcc
  buffer_store_dwordx4 v[56:59], v23, s[28:31], s32 offen offset:0
  buffer_store_dwordx4 v[60:63], v23, s[28:31], s32 offen offset:32
  buffer_store_dwordx4 v[64:67], v23, s[28:31], s32 offen offset:64
  buffer_store_dwordx4 v[68:71], v23, s[28:31], s32 offen offset:96
  s_mov_b64 exec, -1
  s_branch .g2_kernel_fin
.g2_kernel_svc:
  s_cmp_eq_u32 s16, 5
  s_cbranch_scc1 .g2_kernel_s1
  s_cmp_eq_u32 s16, 6
  s_cbranch_scc1 .g2_kernel_s2
  s_cmp_eq_u32 s16, 7
  s_cbranch_scc1 .g2_kernel_s3
  s_mov_b32 s8, s40
  s_mov_b32 s9, s41
  s_mov_b32 s10, 0x400000
  s_mov_b32 s11, 0x00020000
  s_setprio 3
  v_lshrrev_b32 v20, 3, v2
  v_and_b32 v21, 7, v2
  v_lshrrev_b32 v22, 4, v2
  v_xor_b32 v23, v21, v22
  v_lshlrev_b32 v23, 4, v23
  v_lshl_add_u32 v24, v20, 11, v23
  v_xor_b32 v25, 64, v24
  s_lshl_b32 s32, s17, 18
  v_add_u32 v32, 0, v24
  v_add_u32 v33, 15360, v25
  v_add_u32 v34, 30720, v24
  v_add_u32 v35, 46080, v25
  v_add_u32 v36, 65536, v24
  v_add_u32 v37, 80896, v25
  v_add_u32 v38, 96256, v24
  v_add_u32 v39, 111616, v25
  v_add_u32 v40, 131072, v24
  v_add_u32 v41, 146432, v25
  v_add_u32 v42, 161792, v24
  v_add_u32 v43, 177152, v25
  v_add_u32 v44, 196608, v24
  v_add_u32 v45, 211968, v25
  v_add_u32 v46, 227328, v24
  v_add_u32 v47, 242688, v25
  s_mov_b32 s29, 0
  s_add_u32 m0, s29, 0
  s_waitcnt vmcnt(63)
  buffer_load_dwordx4 v32, s[8:11], s32 offen offset:0 lds
  buffer_load_dwordx4 v33, s[8:11], s32 offen offset:1024 lds
  buffer_load_dwordx4 v34, s[8:11], s32 offen offset:2048 lds
  buffer_load_dwordx4 v35, s[8:11], s32 offen offset:3072 lds
  s_add_u32 m0, s29, 4096
  s_waitcnt vmcnt(63)
  buffer_load_dwordx4 v36, s[8:11], s32 offen offset:0 lds
  buffer_load_dwordx4 v37, s[8:11], s32 offen offset:1024 lds
  buffer_load_dwordx4 v38, s[8:11], s32 offen offset:2048 lds
  buffer_load_dwordx4 v39, s[8:11], s32 offen offset:3072 lds
  s_add_u32 m0, s29, 8192
  s_waitcnt vmcnt(63)
  buffer_load_dwordx4 v40, s[8:11], s32 offen offset:0 lds
  buffer_load_dwordx4 v41, s[8:11], s32 offen offset:1024 lds
  buffer_load_dwordx4 v42, s[8:11], s32 offen offset:2048 lds
  buffer_load_dwordx4 v43, s[8:11], s32 offen offset:3072 lds
  s_add_u32 m0, s29, 12288
  s_waitcnt vmcnt(63)
  buffer_load_dwordx4 v44, s[8:11], s32 offen offset:0 lds
  buffer_load_dwordx4 v45, s[8:11], s32 offen offset:1024 lds
  buffer_load_dwordx4 v46, s[8:11], s32 offen offset:2048 lds
  buffer_load_dwordx4 v47, s[8:11], s32 offen offset:3072 lds
  s_add_u32 s32, s32, 128
  s_mov_b32 s12, s42
  s_mov_b32 s13, s43
  s_mov_b32 s14, 0x600000
  s_mov_b32 s15, 0x00020000
  v_lshrrev_b32 v28, 3, v2
  v_and_b32 v29, 7, v2
  v_bfe_u32 v30, v2, 4, 1
  v_lshlrev_b32 v30, 1, v30
  v_xor_b32 v31, v29, v30
  v_lshlrev_b32 v31, 4, v31
  v_mul_u32_u24 v28, 6144, v28
  v_add_u32 v28, v28, v31
  v_xor_b32 v29, 64, v28
  v_lshlrev_b32 v9, 8, v2
  v_and_b32 v9, 0x300, v9
  v_add_u32 v9, 156416, v9
  v_add_u32 v48, 0, v28
  v_add_u32 v49, 48128, v29
  v_add_u32 v50, 96256, v28
  v_add_u32 v51, 144384, v29
  v_add_u32 v52, 2048, v28
  v_add_u32 v53, 50176, v29
  v_add_u32 v54, 98304, v28
  v_add_u32 v55, 146432, v29
  v_add_u32 v56, 4096, v28
  v_add_u32 v57, 52224, v29
  v_add_u32 v58, 100352, v28
  v_add_u32 v59, 148480, v29
  s_lshl_b32 s36, s18, 7
  s_mov_b32 s30, 0
  s_add_u32 m0, s30, 65536
  s_waitcnt vmcnt(63)
  buffer_load_dwordx4 v48, s[12:15], s36 offen offset:0 lds
  buffer_load_dwordx4 v49, s[12:15], s36 offen offset:1024 lds
  buffer_load_dwordx4 v50, s[12:15], s36 offen offset:2048 lds
  buffer_load_dwordx4 v51, s[12:15], s36 offen offset:3072 lds
  s_add_u32 m0, s30, 69632
  s_waitcnt vmcnt(63)
  buffer_load_dwordx4 v52, s[12:15], s36 offen offset:0 lds
  buffer_load_dwordx4 v53, s[12:15], s36 offen offset:1024 lds
  buffer_load_dwordx4 v54, s[12:15], s36 offen offset:2048 lds
  buffer_load_dwordx4 v55, s[12:15], s36 offen offset:3072 lds
  s_add_u32 m0, s30, 73728
  s_waitcnt vmcnt(63)
  buffer_load_dwordx4 v56, s[12:15], s36 offen offset:0 lds
  buffer_load_dwordx4 v57, s[12:15], s36 offen offset:1024 lds
  buffer_load_dwordx4 v58, s[12:15], s36 offen offset:2048 lds
  buffer_load_dwordx4 v59, s[12:15], s36 offen offset:3072 lds
  s_add_u32 s30, s30, 12288
  s_cmp_eq_u32 s30, 86016
  s_cselect_b32 s30, 0, s30
  s_barrier
  s_mov_b32 s35, .g2_kernel_tab-.g2_kernel_pc+4
  s_mov_b32 s34, -5
  v_mov_b32 v10, 0
  s_mov_b32 m0, 156160
  s_add_u32 s36, s36, 196608
  buffer_load_dword off, s[64:67], s35 lds
  s_add_u32 s35, s35, 4
  s_branch .g2_kernel_p1_o
  .p2align 6
.g2_kernel_p1_l:
  s_waitcnt lgkmcnt(0)
  v_cmp_gt_i32 vcc, s34, v10
  s_cbranch_vccnz .g2_kernel_p1_aw
.g2_kernel_p1_ai:
  s_add_u32 s29, s29, 16384
  s_and_b32 s29, s29, 0xffff
  s_add_u32 m0, s29, 0
  s_waitcnt vmcnt(63)
  buffer_load_dwordx4 v32, s[8:11], s32 offen offset:0 lds
  buffer_load_dwordx4 v33, s[8:11], s32 offen offset:1024 lds
  buffer_load_dwordx4 v34, s[8:11], s32 offen offset:2048 lds
  buffer_load_dwordx4 v35, s[8:11], s32 offen offset:3072 lds
  s_add_u32 m0, s29, 4096
  s_waitcnt vmcnt(63)
  buffer_load_dwordx4 v36, s[8:11], s32 offen offset:0 lds
  buffer_load_dwordx4 v37, s[8:11], s32 offen offset:1024 lds
  buffer_load_dwordx4 v38, s[8:11], s32 offen offset:2048 lds
  buffer_load_dwordx4 v39, s[8:11], s32 offen offset:3072 lds
  s_add_u32 m0, s29, 8192
  s_waitcnt vmcnt(63)
  buffer_load_dwordx4 v40, s[8:11], s32 offen offset:0 lds
  buffer_load_dwordx4 v41, s[8:11], s32 offen offset:1024 lds
  buffer_load_dwordx4 v42, s[8:11], s32 offen offset:2048 lds
  buffer_load_dwordx4 v43, s[8:11], s32 offen offset:3072 lds
  s_add_u32 m0, s29, 12288
  s_waitcnt vmcnt(63)
  buffer_load_dwordx4 v44, s[8:11], s32 offen offset:0 lds
  buffer_load_dwordx4 v45, s[8:11], s32 offen offset:1024 lds
  buffer_load_dwordx4 v46, s[8:11], s32 offen offset:2048 lds
  buffer_load_dwordx4 v47, s[8:11], s32 offen offset:3072 lds
  s_add_u32 s32, s32, 128
  s_add_u32 m0, s30, 65536
  s_waitcnt vmcnt(63)
  buffer_load_dwordx4 v48, s[12:15], s36 offen offset:0 lds
  buffer_load_dwordx4 v49, s[12:15], s36 offen offset:1024 lds
  buffer_load_dwordx4 v50, s[12:15], s36 offen offset:2048 lds
  buffer_load_dwordx4 v51, s[12:15], s36 offen offset:3072 lds
  s_add_u32 m0, s30, 69632
  s_waitcnt vmcnt(63)
  buffer_load_dwordx4 v52, s[12:15], s36 offen offset:0 lds
  buffer_load_dwordx4 v53, s[12:15], s36 offen offset:1024 lds
  buffer_load_dwordx4 v54, s[12:15], s36 offen offset:2048 lds
  buffer_load_dwordx4 v55, s[12:15], s36 offen offset:3072 lds
  s_add_u32 m0, s30, 73728
  s_waitcnt vmcnt(63)
  buffer_load_dwordx4 v56, s[12:15], s36 offen offset:0 lds
  buffer_load_dwordx4 v57, s[12:15], s36 offen offset:1024 lds
  buffer_load_dwordx4 v58, s[12:15], s36 offen offset:2048 lds
  buffer_load_dwordx4 v59, s[12:15], s36 offen offset:3072 lds
  s_add_u32 s30, s30, 12288
  s_cmp_eq_u32 s30, 86016
  s_cselect_b32 s30, 0, s30
  ds_read_b32 v10, v9
  s_mov_b32 m0, 156160
  s_add_u32 s34, s34, 1
  buffer_load_dword off, s[64:67], s35 lds
  s_add_u32 s35, s35, 4
  s_add_u32 s36, s36, 196608
.g2_kernel_p1_o:
  s_waitcnt lgkmcnt(0)
  v_cmp_gt_i32 vcc, s34, v10
  s_cbranch_vccnz .g2_kernel_p1_bw
.g2_kernel_p1_bi:
  s_add_u32 m0, s30, 65536
  s_waitcnt vmcnt(63)
  buffer_load_dwordx4 v48, s[12:15], s36 offen offset:0 lds
  buffer_load_dwordx4 v49, s[12:15], s36 offen offset:1024 lds
  buffer_load_dwordx4 v50, s[12:15], s36 offen offset:2048 lds
  buffer_load_dwordx4 v51, s[12:15], s36 offen offset:3072 lds
  s_add_u32 m0, s30, 69632
  s_waitcnt vmcnt(63)
  buffer_load_dwordx4 v52, s[12:15], s36 offen offset:0 lds
  buffer_load_dwordx4 v53, s[12:15], s36 offen offset:1024 lds
  buffer_load_dwordx4 v54, s[12:15], s36 offen offset:2048 lds
  buffer_load_dwordx4 v55, s[12:15], s36 offen offset:3072 lds
  s_add_u32 m0, s30, 73728
  s_waitcnt vmcnt(63)
  buffer_load_dwordx4 v56, s[12:15], s36 offen offset:0 lds
  buffer_load_dwordx4 v57, s[12:15], s36 offen offset:1024 lds
  buffer_load_dwordx4 v58, s[12:15], s36 offen offset:2048 lds
  buffer_load_dwordx4 v59, s[12:15], s36 offen offset:3072 lds
  s_add_u32 s30, s30, 12288
  s_cmp_eq_u32 s30, 86016
  s_cselect_b32 s30, 0, s30
  ds_read_b32 v10, v9
  s_mov_b32 m0, 156160
  s_add_u32 s34, s34, 1
  buffer_load_dword off, s[64:67], s35 lds
  s_add_u32 s35, s35, 4
  s_add_u32 s36, s36, 196608
  s_cmp_lt_i32 s34, 26
  s_cbranch_scc1 .g2_kernel_p1_l
  s_branch .g2_kernel_v
.g2_kernel_s1:
  s_mov_b32 s8, s40
  s_mov_b32 s9, s41
  s_mov_b32 s10, 0x400000
  s_mov_b32 s11, 0x00020000
  v_lshrrev_b32 v20, 3, v2
  v_and_b32 v21, 7, v2
  v_lshlrev_b32 v21, 4, v21
  v_lshl_add_u32 v21, v20, 11, v21
  s_lshl_b32 s30, s17, 4
  s_add_u32 s30, s30, s18
  s_lshl_b32 s33, s30, 5
  s_lshl_b32 s30, s30, 14
  s_barrier
  s_sleep 30
  buffer_load_dwordx4 v[64:67], v21, s[8:11], s30 offen offset:0
  buffer_load_dwordx4 v[68:71], v21, s[8:11], s30 offen offset:128
  buffer_load_dwordx4 v[72:75], v21, s[8:11], s30 offen offset:256
  buffer_load_dwordx4 v[76:79], v21, s[8:11], s30 offen offset:384
  buffer_load_dwordx4 v[80:83], v21, s[8:11], s30 offen offset:512
  buffer_load_dwordx4 v[84:87], v21, s[8:11], s30 offen offset:640
  buffer_load_dwordx4 v[88:91], v21, s[8:11], s30 offen offset:768
  buffer_load_dwordx4 v[92:95], v21, s[8:11], s30 offen offset:896
  buffer_load_dwordx4 v[96:99], v21, s[8:11], s30 offen offset:1024
  buffer_load_dwordx4 v[100:103], v21, s[8:11], s30 offen offset:1152
  buffer_load_dwordx4 v[104:107], v21, s[8:11], s30 offen offset:1280
  buffer_load_dwordx4 v[108:111], v21, s[8:11], s30 offen offset:1408
  buffer_load_dwordx4 v[112:115], v21, s[8:11], s30 offen offset:1536
  buffer_load_dwordx4 v[116:119], v21, s[8:11], s30 offen offset:1664
  buffer_load_dwordx4 v[120:123], v21, s[8:11], s30 offen offset:1792
  buffer_load_dwordx4 v[124:127], v21, s[8:11], s30 offen offset:1920
  v_mov_b32 v24, 0
  v_mov_b32 v25, 0
  v_mov_b32 v26, 0
  v_mov_b32 v27, 0
  s_waitcnt vmcnt(15)
  v_lshlrev_b32 v22, 16, v64
  v_and_b32 v64, 0xffff0000, v64
  v_add_f32 v24, v24, v22
  v_fmac_f32 v25, v22, v22
  v_add_f32 v26, v26, v64
  v_fmac_f32 v27, v64, v64
  v_lshlrev_b32 v22, 16, v65
  v_and_b32 v65, 0xffff0000, v65
  v_add_f32 v24, v24, v22
  v_fmac_f32 v25, v22, v22
  v_add_f32 v26, v26, v65
  v_fmac_f32 v27, v65, v65
  v_lshlrev_b32 v22, 16, v66
  v_and_b32 v66, 0xffff0000, v66
  v_add_f32 v24, v24, v22
  v_fmac_f32 v25, v22, v22
  v_add_f32 v26, v26, v66
  v_fmac_f32 v27, v66, v66
  v_lshlrev_b32 v22, 16, v67
  v_and_b32 v67, 0xffff0000, v67
  v_add_f32 v24, v24, v22
  v_fmac_f32 v25, v22, v22
  v_add_f32 v26, v26, v67
  v_fmac_f32 v27, v67, v67
  s_waitcnt vmcnt(14)
  v_lshlrev_b32 v22, 16, v68
  v_and_b32 v68, 0xffff0000, v68
  v_add_f32 v24, v24, v22
  v_fmac_f32 v25, v22, v22
  v_add_f32 v26, v26, v68
  v_fmac_f32 v27, v68, v68
  v_lshlrev_b32 v22, 16, v69
  v_and_b32 v69, 0xffff0000, v69
  v_add_f32 v24, v24, v22
  v_fmac_f32 v25, v22, v22
  v_add_f32 v26, v26, v69
  v_fmac_f32 v27, v69, v69
  v_lshlrev_b32 v22, 16, v70
  v_and_b32 v70, 0xffff0000, v70
  v_add_f32 v24, v24, v22
  v_fmac_f32 v25, v22, v22
  v_add_f32 v26, v26, v70
  v_fmac_f32 v27, v70, v70
  v_lshlrev_b32 v22, 16, v71
  v_and_b32 v71, 0xffff0000, v71
  v_add_f32 v24, v24, v22
  v_fmac_f32 v25, v22, v22
  v_add_f32 v26, v26, v71
  v_fmac_f32 v27, v71, v71
  s_waitcnt vmcnt(13)
  v_lshlrev_b32 v22, 16, v72
  v_and_b32 v72, 0xffff0000, v72
  v_add_f32 v24, v24, v22
  v_fmac_f32 v25, v22, v22
  v_add_f32 v26, v26, v72
  v_fmac_f32 v27, v72, v72
  v_lshlrev_b32 v22, 16, v73
  v_and_b32 v73, 0xffff0000, v73
  v_add_f32 v24, v24, v22
  v_fmac_f32 v25, v22, v22
  v_add_f32 v26, v26, v73
  v_fmac_f32 v27, v73, v73
  v_lshlrev_b32 v22, 16, v74
  v_and_b32 v74, 0xffff0000, v74
  v_add_f32 v24, v24, v22
  v_fmac_f32 v25, v22, v22
  v_add_f32 v26, v26, v74
  v_fmac_f32 v27, v74, v74
  v_lshlrev_b32 v22, 16, v75
  v_and_b32 v75, 0xffff0000, v75
  v_add_f32 v24, v24, v22
  v_fmac_f32 v25, v22, v22
  v_add_f32 v26, v26, v75
  v_fmac_f32 v27, v75, v75
  s_waitcnt vmcnt(12)
  v_lshlrev_b32 v22, 16, v76
  v_and_b32 v76, 0xffff0000, v76
  v_add_f32 v24, v24, v22
  v_fmac_f32 v25, v22, v22
  v_add_f32 v26, v26, v76
  v_fmac_f32 v27, v76, v76
  v_lshlrev_b32 v22, 16, v77
  v_and_b32 v77, 0xffff0000, v77
  v_add_f32 v24, v24, v22
  v_fmac_f32 v25, v22, v22
  v_add_f32 v26, v26, v77
  v_fmac_f32 v27, v77, v77
  v_lshlrev_b32 v22, 16, v78
  v_and_b32 v78, 0xffff0000, v78
  v_add_f32 v24, v24, v22
  v_fmac_f32 v25, v22, v22
  v_add_f32 v26, v26, v78
  v_fmac_f32 v27, v78, v78
  v_lshlrev_b32 v22, 16, v79
  v_and_b32 v79, 0xffff0000, v79
  v_add_f32 v24, v24, v22
  v_fmac_f32 v25, v22, v22
  v_add_f32 v26, v26, v79
  v_fmac_f32 v27, v79, v79
  s_waitcnt vmcnt(11)
  v_lshlrev_b32 v22, 16, v80
  v_and_b32 v80, 0xffff0000, v80
  v_add_f32 v24, v24, v22
  v_fmac_f32 v25, v22, v22
  v_add_f32 v26, v26, v80
  v_fmac_f32 v27, v80, v80
  v_lshlrev_b32 v22, 16, v81
  v_and_b32 v81, 0xffff0000, v81
  v_add_f32 v24, v24, v22
  v_fmac_f32 v25, v22, v22
  v_add_f32 v26, v26, v81
  v_fmac_f32 v27, v81, v81
  v_lshlrev_b32 v22, 16, v82
  v_and_b32 v82, 0xffff0000, v82
  v_add_f32 v24, v24, v22
  v_fmac_f32 v25, v22, v22
  v_add_f32 v26, v26, v82
  v_fmac_f32 v27, v82, v82
  v_lshlrev_b32 v22, 16, v83
  v_and_b32 v83, 0xffff0000, v83
  v_add_f32 v24, v24, v22
  v_fmac_f32 v25, v22, v22
  v_add_f32 v26, v26, v83
  v_fmac_f32 v27, v83, v83
  s_waitcnt vmcnt(10)
  v_lshlrev_b32 v22, 16, v84
  v_and_b32 v84, 0xffff0000, v84
  v_add_f32 v24, v24, v22
  v_fmac_f32 v25, v22, v22
  v_add_f32 v26, v26, v84
  v_fmac_f32 v27, v84, v84
  v_lshlrev_b32 v22, 16, v85
  v_and_b32 v85, 0xffff0000, v85
  v_add_f32 v24, v24, v22
  v_fmac_f32 v25, v22, v22
  v_add_f32 v26, v26, v85
  v_fmac_f32 v27, v85, v85
  v_lshlrev_b32 v22, 16, v86
  v_and_b32 v86, 0xffff0000, v86
  v_add_f32 v24, v24, v22
  v_fmac_f32 v25, v22, v22
  v_add_f32 v26, v26, v86
  v_fmac_f32 v27, v86, v86
  v_lshlrev_b32 v22, 16, v87
  v_and_b32 v87, 0xffff0000, v87
  v_add_f32 v24, v24, v22
  v_fmac_f32 v25, v22, v22
  v_add_f32 v26, v26, v87
  v_fmac_f32 v27, v87, v87
  s_waitcnt vmcnt(9)
  v_lshlrev_b32 v22, 16, v88
  v_and_b32 v88, 0xffff0000, v88
  v_add_f32 v24, v24, v22
  v_fmac_f32 v25, v22, v22
  v_add_f32 v26, v26, v88
  v_fmac_f32 v27, v88, v88
  v_lshlrev_b32 v22, 16, v89
  v_and_b32 v89, 0xffff0000, v89
  v_add_f32 v24, v24, v22
  v_fmac_f32 v25, v22, v22
  v_add_f32 v26, v26, v89
  v_fmac_f32 v27, v89, v89
  v_lshlrev_b32 v22, 16, v90
  v_and_b32 v90, 0xffff0000, v90
  v_add_f32 v24, v24, v22
  v_fmac_f32 v25, v22, v22
  v_add_f32 v26, v26, v90
  v_fmac_f32 v27, v90, v90
  v_lshlrev_b32 v22, 16, v91
  v_and_b32 v91, 0xffff0000, v91
  v_add_f32 v24, v24, v22
  v_fmac_f32 v25, v22, v22
  v_add_f32 v26, v26, v91
  v_fmac_f32 v27, v91, v91
  s_waitcnt vmcnt(8)
  v_lshlrev_b32 v22, 16, v92
  v_and_b32 v92, 0xffff0000, v92
  v_add_f32 v24, v24, v22
  v_fmac_f32 v25, v22, v22
  v_add_f32 v26, v26, v92
  v_fmac_f32 v27, v92, v92
  v_lshlrev_b32 v22, 16, v93
  v_and_b32 v93, 0xffff0000, v93
  v_add_f32 v24, v24, v22
  v_fmac_f32 v25, v22, v22
  v_add_f32 v26, v26, v93
  v_fmac_f32 v27, v93, v93
  v_lshlrev_b32 v22, 16, v94
  v_and_b32 v94, 0xffff0000, v94
  v_add_f32 v24, v24, v22
  v_fmac_f32 v25, v22, v22
  v_add_f32 v26, v26, v94
  v_fmac_f32 v27, v94, v94
  v_lshlrev_b32 v22, 16, v95
  v_and_b32 v95, 0xffff0000, v95
  v_add_f32 v24, v24, v22
  v_fmac_f32 v25, v22, v22
  v_add_f32 v26, v26, v95
  v_fmac_f32 v27, v95, v95
  s_waitcnt vmcnt(7)
  v_lshlrev_b32 v22, 16, v96
  v_and_b32 v96, 0xffff0000, v96
  v_add_f32 v24, v24, v22
  v_fmac_f32 v25, v22, v22
  v_add_f32 v26, v26, v96
  v_fmac_f32 v27, v96, v96
  v_lshlrev_b32 v22, 16, v97
  v_and_b32 v97, 0xffff0000, v97
  v_add_f32 v24, v24, v22
  v_fmac_f32 v25, v22, v22
  v_add_f32 v26, v26, v97
  v_fmac_f32 v27, v97, v97
  v_lshlrev_b32 v22, 16, v98
  v_and_b32 v98, 0xffff0000, v98
  v_add_f32 v24, v24, v22
  v_fmac_f32 v25, v22, v22
  v_add_f32 v26, v26, v98
  v_fmac_f32 v27, v98, v98
  v_lshlrev_b32 v22, 16, v99
  v_and_b32 v99, 0xffff0000, v99
  v_add_f32 v24, v24, v22
  v_fmac_f32 v25, v22, v22
  v_add_f32 v26, v26, v99
  v_fmac_f32 v27, v99, v99
  s_waitcnt vmcnt(6)
  v_lshlrev_b32 v22, 16, v100
  v_and_b32 v100, 0xffff0000, v100
  v_add_f32 v24, v24, v22
  v_fmac_f32 v25, v22, v22
  v_add_f32 v26, v26, v100
  v_fmac_f32 v27, v100, v100
  v_lshlrev_b32 v22, 16, v101
  v_and_b32 v101, 0xffff0000, v101
  v_add_f32 v24, v24, v22
  v_fmac_f32 v25, v22, v22
  v_add_f32 v26, v26, v101
  v_fmac_f32 v27, v101, v101
  v_lshlrev_b32 v22, 16, v102
  v_and_b32 v102, 0xffff0000, v102
  v_add_f32 v24, v24, v22
  v_fmac_f32 v25, v22, v22
  v_add_f32 v26, v26, v102
  v_fmac_f32 v27, v102, v102
  v_lshlrev_b32 v22, 16, v103
  v_and_b32 v103, 0xffff0000, v103
  v_add_f32 v24, v24, v22
  v_fmac_f32 v25, v22, v22
  v_add_f32 v26, v26, v103
  v_fmac_f32 v27, v103, v103
  s_waitcnt vmcnt(5)
  v_lshlrev_b32 v22, 16, v104
  v_and_b32 v104, 0xffff0000, v104
  v_add_f32 v24, v24, v22
  v_fmac_f32 v25, v22, v22
  v_add_f32 v26, v26, v104
  v_fmac_f32 v27, v104, v104
  v_lshlrev_b32 v22, 16, v105
  v_and_b32 v105, 0xffff0000, v105
  v_add_f32 v24, v24, v22
  v_fmac_f32 v25, v22, v22
  v_add_f32 v26, v26, v105
  v_fmac_f32 v27, v105, v105
  v_lshlrev_b32 v22, 16, v106
  v_and_b32 v106, 0xffff0000, v106
  v_add_f32 v24, v24, v22
  v_fmac_f32 v25, v22, v22
  v_add_f32 v26, v26, v106
  v_fmac_f32 v27, v106, v106
  v_lshlrev_b32 v22, 16, v107
  v_and_b32 v107, 0xffff0000, v107
  v_add_f32 v24, v24, v22
  v_fmac_f32 v25, v22, v22
  v_add_f32 v26, v26, v107
  v_fmac_f32 v27, v107, v107
  s_waitcnt vmcnt(4)
  v_lshlrev_b32 v22, 16, v108
  v_and_b32 v108, 0xffff0000, v108
  v_add_f32 v24, v24, v22
  v_fmac_f32 v25, v22, v22
  v_add_f32 v26, v26, v108
  v_fmac_f32 v27, v108, v108
  v_lshlrev_b32 v22, 16, v109
  v_and_b32 v109, 0xffff0000, v109
  v_add_f32 v24, v24, v22
  v_fmac_f32 v25, v22, v22
  v_add_f32 v26, v26, v109
  v_fmac_f32 v27, v109, v109
  v_lshlrev_b32 v22, 16, v110
  v_and_b32 v110, 0xffff0000, v110
  v_add_f32 v24, v24, v22
  v_fmac_f32 v25, v22, v22
  v_add_f32 v26, v26, v110
  v_fmac_f32 v27, v110, v110
  v_lshlrev_b32 v22, 16, v111
  v_and_b32 v111, 0xffff0000, v111
  v_add_f32 v24, v24, v22
  v_fmac_f32 v25, v22, v22
  v_add_f32 v26, v26, v111
  v_fmac_f32 v27, v111, v111
  s_waitcnt vmcnt(3)
  v_lshlrev_b32 v22, 16, v112
  v_and_b32 v112, 0xffff0000, v112
  v_add_f32 v24, v24, v22
  v_fmac_f32 v25, v22, v22
  v_add_f32 v26, v26, v112
  v_fmac_f32 v27, v112, v112
  v_lshlrev_b32 v22, 16, v113
  v_and_b32 v113, 0xffff0000, v113
  v_add_f32 v24, v24, v22
  v_fmac_f32 v25, v22, v22
  v_add_f32 v26, v26, v113
  v_fmac_f32 v27, v113, v113
  v_lshlrev_b32 v22, 16, v114
  v_and_b32 v114, 0xffff0000, v114
  v_add_f32 v24, v24, v22
  v_fmac_f32 v25, v22, v22
  v_add_f32 v26, v26, v114
  v_fmac_f32 v27, v114, v114
  v_lshlrev_b32 v22, 16, v115
  v_and_b32 v115, 0xffff0000, v115
  v_add_f32 v24, v24, v22
  v_fmac_f32 v25, v22, v22
  v_add_f32 v26, v26, v115
  v_fmac_f32 v27, v115, v115
  s_waitcnt vmcnt(2)
  v_lshlrev_b32 v22, 16, v116
  v_and_b32 v116, 0xffff0000, v116
  v_add_f32 v24, v24, v22
  v_fmac_f32 v25, v22, v22
  v_add_f32 v26, v26, v116
  v_fmac_f32 v27, v116, v116
  v_lshlrev_b32 v22, 16, v117
  v_and_b32 v117, 0xffff0000, v117
  v_add_f32 v24, v24, v22
  v_fmac_f32 v25, v22, v22
  v_add_f32 v26, v26, v117
  v_fmac_f32 v27, v117, v117
  v_lshlrev_b32 v22, 16, v118
  v_and_b32 v118, 0xffff0000, v118
  v_add_f32 v24, v24, v22
  v_fmac_f32 v25, v22, v22
  v_add_f32 v26, v26, v118
  v_fmac_f32 v27, v118, v118
  v_lshlrev_b32 v22, 16, v119
  v_and_b32 v119, 0xffff0000, v119
  v_add_f32 v24, v24, v22
  v_fmac_f32 v25, v22, v22
  v_add_f32 v26, v26, v119
  v_fmac_f32 v27, v119, v119
  s_waitcnt vmcnt(1)
  v_lshlrev_b32 v22, 16, v120
  v_and_b32 v120, 0xffff0000, v120
  v_add_f32 v24, v24, v22
  v_fmac_f32 v25, v22, v22
  v_add_f32 v26, v26, v120
  v_fmac_f32 v27, v120, v120
  v_lshlrev_b32 v22, 16, v121
  v_and_b32 v121, 0xffff0000, v121
  v_add_f32 v24, v24, v22
  v_fmac_f32 v25, v22, v22
  v_add_f32 v26, v26, v121
  v_fmac_f32 v27, v121, v121
  v_lshlrev_b32 v22, 16, v122
  v_and_b32 v122, 0xffff0000, v122
  v_add_f32 v24, v24, v22
  v_fmac_f32 v25, v22, v22
  v_add_f32 v26, v26, v122
  v_fmac_f32 v27, v122, v122
  v_lshlrev_b32 v22, 16, v123
  v_and_b32 v123, 0xffff0000, v123
  v_add_f32 v24, v24, v22
  v_fmac_f32 v25, v22, v22
  v_add_f32 v26, v26, v123
  v_fmac_f32 v27, v123, v123
  s_waitcnt vmcnt(0)
  v_lshlrev_b32 v22, 16, v124
  v_and_b32 v124, 0xffff0000, v124
  v_add_f32 v24, v24, v22
  v_fmac_f32 v25, v22, v22
  v_add_f32 v26, v26, v124
  v_fmac_f32 v27, v124, v124
  v_lshlrev_b32 v22, 16, v125
  v_and_b32 v125, 0xffff0000, v125
  v_add_f32 v24, v24, v22
  v_fmac_f32 v25, v22, v22
  v_add_f32 v26, v26, v125
  v_fmac_f32 v27, v125, v125
  v_lshlrev_b32 v22, 16, v126
  v_and_b32 v126, 0xffff0000, v126
  v_add_f32 v24, v24, v22
  v_fmac_f32 v25, v22, v22
  v_add_f32 v26, v26, v126
  v_fmac_f32 v27, v126, v126
  v_lshlrev_b32 v22, 16, v127
  v_and_b32 v127, 0xffff0000, v127
  v_add_f32 v24, v24, v22
  v_fmac_f32 v25, v22, v22
  v_add_f32 v26, v26, v127
  v_fmac_f32 v27, v127, v127
  v_add_f32 v24, v24, v26
  v_add_f32 v25, v25, v27
  s_nop 0
  v_add_f32 v24, v24, v24 quad_perm:[1,0,3,2] row_mask:0xf bank_mask:0xf
  v_add_f32 v25, v25, v25 quad_perm:[1,0,3,2] row_mask:0xf bank_mask:0xf
  s_nop 0
  v_add_f32 v24, v24, v24 quad_perm:[2,3,0,1] row_mask:0xf bank_mask:0xf
  v_add_f32 v25, v25, v25 quad_perm:[2,3,0,1] row_mask:0xf bank_mask:0xf
  s_nop 0
  v_add_f32 v24, v24, v24 row_half_mirror row_mask:0xf bank_mask:0xf
  v_add_f32 v25, v25, v25 row_half_mirror row_mask:0xf bank_mask:0xf
  v_mov_b32 v26, 0.0009765625
  v_mul_f32 v24, v26, v24
  v_mul_f32 v27, v24, v24
  v_fma_f32 v25, v25, v26, -v27
  v_max_f32 v25, 0, v25
  v_add_f32 v25, 1e-05, v25
  v_rsq_f32 v25, v25
  v_lshlrev_b32 v20, 2, v20
  v_mul_f32 v24, v24, v25
  v_sub_f32 v24, 0, v24
  s_add_u32 s33, s33, 0x3070000
  s_add_u32 s34, s33, 0x2000
  s_mov_b32 exec_lo, 0x01010101
  s_mov_b32 exec_hi, 0x01010101
  buffer_store_dword v25, v20, s[4:7], s33 offen sc1
  buffer_store_dword v24, v20, s[4:7], s34 offen sc1
  s_mov_b64 exec, -1
  s_mov_b32 s12, s58
  s_mov_b32 s13, s59
  s_mov_b32 s14, 0x100
  s_mov_b32 s15, 0x00020000
  s_mov_b32 s38, 0
  s_mov_b64 exec, 1
.g2_kernel_gt6:
  buffer_load_dword v6, v4, s[12:15], 0 offen sc1
  s_add_u32 s38, s38, 1
  s_waitcnt vmcnt(0)
  v_cmp_eq_u32 vcc, 0x60, v6
  s_cbranch_vccnz .g2_kernel_gt6d
  s_sleep 8
  s_cmp_lt_u32 s38, 131072
  s_cbranch_scc1 .g2_kernel_gt6
.g2_kernel_gt6d:
  s_mov_b64 exec, -1
  v_mov_b32 v6, s70
  s_mov_b64 exec, 1
  buffer_store_dword v6, v4, s[4:7], s19 offen offset:12 sc1
  s_mov_b64 exec, -1
  v_mov_b32 v6, 155648
  s_mov_b32 s38, 0
.g2_kernel_wg7:
  ds_read_b32 v7, v6 offset:512
  s_add_u32 s38, s38, 1
  s_waitcnt lgkmcnt(0)
  v_cmp_le_u32 vcc, 27, v7
  s_cbranch_vccnz .g2_kernel_wg7d
  s_sleep 4
  s_cmp_lt_u32 s38, 524288
  s_cbranch_scc1 .g2_kernel_wg7
.g2_kernel_wg7d:
  s_and_b32 s31, s19, 0xffffe000
  s_add_u32 s31, s31, 12
  v_and_b32 v6, 15, v2
  v_lshlrev_b32 v6, 9, v6
  v_lshrrev_b32 v7, 4, v2
  v_lshl_add_u32 v6, v7, 7, v6
  v_lshlrev_b32 v7, 2, v2
  v_add_u32 v7, 157952, v7
  s_mov_b32 m0, 157952
  s_mov_b32 s38, 0
  s_bfm_b64 exec, 16, 0
.g2_kernel_pa8:
  buffer_load_dword v6, s[4:7], s31 offen sc1 lds
  s_add_u32 s38, s38, 1
  s_waitcnt vmcnt(0)
  ds_read_b32 v8, v7
  s_waitcnt lgkmcnt(0)
  v_cmp_ge_u32 vcc, s62, v8
  s_cbranch_vccz .g2_kernel_pa8d
  s_mov_b64 exec, vcc
  s_sleep 16
  s_cmp_lt_u32 s38, 131072
  s_cbranch_scc1 .g2_kernel_pa8
.g2_kernel_pa8d:
  s_mov_b64 exec, -1
  s_lshl_b32 s33, s17, 9
  s_add_u32 s33, s33, 0x3070000
  s_add_u32 s34, s33, 0x2000
  s_mov_b32 exec_hi, 0
  s_mov_b32 m0, 158464
  s_nop 0
  buffer_load_dwordx4 v3, s[4:7], s33 offen sc1 lds
  s_mov_b32 m0, 158976
  s_nop 0
  buffer_load_dwordx4 v3, s[4:7], s34 offen sc1 lds
  s_mov_b64 exec, -1
  v_mov_b32 v20, 1.0
  v_mov_b32 v21, 1.0
  v_mov_b32 v22, 0
  v_mov_b32 v23, 0
  v_lshlrev_b32 v24, 3, v2
  v_add_u32 v24, 155648, v24
  v_mov_b32 v6, 155648
  s_mov_b32 s38, 0
.g2_kernel_wg9:
  ds_read_b32 v7, v6 offset:512
  s_add_u32 s38, s38, 1
  s_waitcnt lgkmcnt(0)
  v_cmp_le_u32 vcc, 32, v7
  s_cbranch_vccnz .g2_kernel_wg9d
  s_sleep 2
  s_cmp_lt_u32 s38, 524288
  s_cbranch_scc1 .g2_kernel_wg9
.g2_kernel_wg9d:
  ds_write_b64 v24, v[20:21] offset:3840
  ds_write_b64 v24, v[22:23] offset:4352
  v_lshlrev_b32 v24, 2, v2
  v_add_u32 v24, 155648, v24
  ds_write_b32 v24, v4 offset:2304
  s_waitcnt vmcnt(0)
  v_mov_b32 v6, s71
  s_mov_b64 exec, 1
  ds_add_u32 v6, v5 offset:0
  s_mov_b64 exec, -1
  s_branch .g2_kernel_v
.g2_kernel_s2:
  s_mov_b32 s8, s42
  s_mov_b32 s9, s43
  s_mov_b32 s10, 0x600000
  s_mov_b32 s11, 0x00020000
  v_lshrrev_b32 v20, 3, v2
  v_and_b32 v21, 7, v2
  v_mul_u32_u24 v20, 6144, v20
  v_lshl_add_u32 v20, v21, 4, v20
  s_mul_i32 s30, s17, 393216
  s_lshl_b32 s31, s18, 7
  s_add_u32 s30, s30, s31
  s_add_u32 s31, s30, 4096
  s_barrier
  s_sleep 30
  buffer_load_dwordx4 v[64:67], v20, s[8:11], s30 offen
  buffer_load_dwordx4 v[68:71], v20, s[8:11], s30 offen offset:2048
  buffer_load_dwordx4 v[72:75], v20, s[8:11], s31 offen
  s_add_u32 s30, s30, 49152
  s_add_u32 s31, s31, 49152
  buffer_load_dwordx4 v[76:79], v20, s[8:11], s30 offen
  buffer_load_dwordx4 v[80:83], v20, s[8:11], s30 offen offset:2048
  buffer_load_dwordx4 v[84:87], v20, s[8:11], s31 offen
  s_add_u32 s30, s30, 49152
  s_add_u32 s31, s31, 49152
  buffer_load_dwordx4 v[88:91], v20, s[8:11], s30 offen
  buffer_load_dwordx4 v[92:95], v20, s[8:11], s30 offen offset:2048
  buffer_load_dwordx4 v[96:99], v20, s[8:11], s31 offen
  s_add_u32 s30, s30, 49152
  s_add_u32 s31, s31, 49152
  buffer_load_dwordx4 v[100:103], v20, s[8:11], s30 offen
  buffer_load_dwordx4 v[104:107], v20, s[8:11], s30 offen offset:2048
  buffer_load_dwordx4 v[108:111], v20, s[8:11], s31 offen
  s_add_u32 s30, s30, 49152
  s_add_u32 s31, s31, 49152
  buffer_load_dwordx4 v[112:115], v20, s[8:11], s30 offen
  buffer_load_dwordx4 v[116:119], v20, s[8:11], s30 offen offset:2048
  buffer_load_dwordx4 v[120:123], v20, s[8:11], s31 offen
  s_add_u32 s30, s30, 49152
  s_add_u32 s31, s31, 49152
  buffer_load_dwordx4 v[124:127], v20, s[8:11], s30 offen
  buffer_load_dwordx4 v[128:131], v20, s[8:11], s30 offen offset:2048
  buffer_load_dwordx4 v[132:135], v20, s[8:11], s31 offen
  s_add_u32 s30, s30, 49152
  s_add_u32 s31, s31, 49152
  buffer_load_dwordx4 v[136:139], v20, s[8:11], s30 offen
  buffer_load_dwordx4 v[140:143], v20, s[8:11], s30 offen offset:2048
  buffer_load_dwordx4 v[144:147], v20, s[8:11], s31 offen
  s_add_u32 s30, s30, 49152
  s_add_u32 s31, s31, 49152
  buffer_load_dwordx4 v[148:151], v20, s[8:11], s30 offen
  buffer_load_dwordx4 v[152:155], v20, s[8:11], s30 offen offset:2048
  buffer_load_dwordx4 v[156:159], v20, s[8:11], s31 offen
  s_add_u32 s30, s30, 49152
  s_add_u32 s31, s31, 49152
  v_lshlrev_b32 v21, 5, v21
  v_lshrrev_b32 v22, 5, v2
  v_lshl_add_u32 v21, v22, 4, v21
  v_bfe_u32 v22, v2, 4, 1
  v_lshl_add_u32 v21, v22, 3, v21
  s_lshl_b32 s30, s18, 4
  s_add_u32 s30, s30, s17
  s_mul_i32 s30, s30, 768
  s_add_u32 s30, s30, 0x3080000
  s_waitcnt vmcnt(23)
  v_lshlrev_b32 v160, 16, v64
  v_and_b32 v161, 0xffff0000, v64
  v_lshlrev_b32 v162, 16, v65
  v_and_b32 v163, 0xffff0000, v65
  v_lshlrev_b32 v164, 16, v66
  v_and_b32 v165, 0xffff0000, v66
  v_lshlrev_b32 v166, 16, v67
  v_and_b32 v167, 0xffff0000, v67
  s_waitcnt vmcnt(22)
  v_lshlrev_b32 v168, 16, v68
  v_and_b32 v169, 0xffff0000, v68
  v_lshlrev_b32 v170, 16, v69
  v_and_b32 v171, 0xffff0000, v69
  v_lshlrev_b32 v172, 16, v70
  v_and_b32 v173, 0xffff0000, v70
  v_lshlrev_b32 v174, 16, v71
  v_and_b32 v175, 0xffff0000, v71
  s_waitcnt vmcnt(21)
  v_lshlrev_b32 v176, 16, v72
  v_and_b32 v177, 0xffff0000, v72
  v_lshlrev_b32 v178, 16, v73
  v_and_b32 v179, 0xffff0000, v73
  v_lshlrev_b32 v180, 16, v74
  v_and_b32 v181, 0xffff0000, v74
  v_lshlrev_b32 v182, 16, v75
  v_and_b32 v183, 0xffff0000, v75
  s_waitcnt vmcnt(20)
  v_lshlrev_b32 v184, 16, v76
  v_and_b32 v185, 0xffff0000, v76
  v_lshlrev_b32 v186, 16, v77
  v_and_b32 v187, 0xffff0000, v77
  v_lshlrev_b32 v188, 16, v78
  v_and_b32 v189, 0xffff0000, v78
  v_lshlrev_b32 v190, 16, v79
  v_and_b32 v191, 0xffff0000, v79
  v_add_f32 v160, v160, v184
  v_add_f32 v161, v161, v185
  v_add_f32 v162, v162, v186
  v_add_f32 v163, v163, v187
  v_add_f32 v164, v164, v188
  v_add_f32 v165, v165, v189
  v_add_f32 v166, v166, v190
  v_add_f32 v167, v167, v191
  s_waitcnt vmcnt(19)
  v_lshlrev_b32 v184, 16, v80
  v_and_b32 v185, 0xffff0000, v80
  v_lshlrev_b32 v186, 16, v81
  v_and_b32 v187, 0xffff0000, v81
  v_lshlrev_b32 v188, 16, v82
  v_and_b32 v189, 0xffff0000, v82
  v_lshlrev_b32 v190, 16, v83
  v_and_b32 v191, 0xffff0000, v83
  v_add_f32 v168, v168, v184
  v_add_f32 v169, v169, v185
  v_add_f32 v170, v170, v186
  v_add_f32 v171, v171, v187
  v_add_f32 v172, v172, v188
  v_add_f32 v173, v173, v189
  v_add_f32 v174, v174, v190
  v_add_f32 v175, v175, v191
  s_waitcnt vmcnt(18)
  v_lshlrev_b32 v184, 16, v84
  v_and_b32 v185, 0xffff0000, v84
  v_lshlrev_b32 v186, 16, v85
  v_and_b32 v187, 0xffff0000, v85
  v_lshlrev_b32 v188, 16, v86
  v_and_b32 v189, 0xffff0000, v86
  v_lshlrev_b32 v190, 16, v87
  v_and_b32 v191, 0xffff0000, v87
  v_add_f32 v176, v176, v184
  v_add_f32 v177, v177, v185
  v_add_f32 v178, v178, v186
  v_add_f32 v179, v179, v187
  v_add_f32 v180, v180, v188
  v_add_f32 v181, v181, v189
  v_add_f32 v182, v182, v190
  v_add_f32 v183, v183, v191
  s_waitcnt vmcnt(17)
  v_lshlrev_b32 v184, 16, v88
  v_and_b32 v185, 0xffff0000, v88
  v_lshlrev_b32 v186, 16, v89
  v_and_b32 v187, 0xffff0000, v89
  v_lshlrev_b32 v188, 16, v90
  v_and_b32 v189, 0xffff0000, v90
  v_lshlrev_b32 v190, 16, v91
  v_and_b32 v191, 0xffff0000, v91
  v_add_f32 v160, v160, v184
  v_add_f32 v161, v161, v185
  v_add_f32 v162, v162, v186
  v_add_f32 v163, v163, v187
  v_add_f32 v164, v164, v188
  v_add_f32 v165, v165, v189
  v_add_f32 v166, v166, v190
  v_add_f32 v167, v167, v191
  s_waitcnt vmcnt(16)
  v_lshlrev_b32 v184, 16, v92
  v_and_b32 v185, 0xffff0000, v92
  v_lshlrev_b32 v186, 16, v93
  v_and_b32 v187, 0xffff0000, v93
  v_lshlrev_b32 v188, 16, v94
  v_and_b32 v189, 0xffff0000, v94
  v_lshlrev_b32 v190, 16, v95
  v_and_b32 v191, 0xffff0000, v95
  v_add_f32 v168, v168, v184
  v_add_f32 v169, v169, v185
  v_add_f32 v170, v170, v186
  v_add_f32 v171, v171, v187
  v_add_f32 v172, v172, v188
  v_add_f32 v173, v173, v189
  v_add_f32 v174, v174, v190
  v_add_f32 v175, v175, v191
  s_waitcnt vmcnt(15)
  v_lshlrev_b32 v184, 16, v96
  v_and_b32 v185, 0xffff0000, v96
  v_lshlrev_b32 v186, 16, v97
  v_and_b32 v187, 0xffff0000, v97
  v_lshlrev_b32 v188, 16, v98
  v_and_b32 v189, 0xffff0000, v98
  v_lshlrev_b32 v190, 16, v99
  v_and_b32 v191, 0xffff0000, v99
  v_add_f32 v176, v176, v184
  v_add_f32 v177, v177, v185
  v_add_f32 v178, v178, v186
  v_add_f32 v179, v179, v187
  v_add_f32 v180, v180, v188
  v_add_f32 v181, v181, v189
  v_add_f32 v182, v182, v190
  v_add_f32 v183, v183, v191
  s_waitcnt vmcnt(14)
  v_lshlrev_b32 v184, 16, v100
  v_and_b32 v185, 0xffff0000, v100
  v_lshlrev_b32 v186, 16, v101
  v_and_b32 v187, 0xffff0000, v101
  v_lshlrev_b32 v188, 16, v102
  v_and_b32 v189, 0xffff0000, v102
  v_lshlrev_b32 v190, 16, v103
  v_and_b32 v191, 0xffff0000, v103
  v_add_f32 v160, v160, v184
  v_add_f32 v161, v161, v185
  v_add_f32 v162, v162, v186
  v_add_f32 v163, v163, v187
  v_add_f32 v164, v164, v188
  v_add_f32 v165, v165, v189
  v_add_f32 v166, v166, v190
  v_add_f32 v167, v167, v191
  s_waitcnt vmcnt(13)
  v_lshlrev_b32 v184, 16, v104
  v_and_b32 v185, 0xffff0000, v104
  v_lshlrev_b32 v186, 16, v105
  v_and_b32 v187, 0xffff0000, v105
  v_lshlrev_b32 v188, 16, v106
  v_and_b32 v189, 0xffff0000, v106
  v_lshlrev_b32 v190, 16, v107
  v_and_b32 v191, 0xffff0000, v107
  v_add_f32 v168, v168, v184
  v_add_f32 v169, v169, v185
  v_add_f32 v170, v170, v186
  v_add_f32 v171, v171, v187
  v_add_f32 v172, v172, v188
  v_add_f32 v173, v173, v189
  v_add_f32 v174, v174, v190
  v_add_f32 v175, v175, v191
  s_waitcnt vmcnt(12)
  v_lshlrev_b32 v184, 16, v108
  v_and_b32 v185, 0xffff0000, v108
  v_lshlrev_b32 v186, 16, v109
  v_and_b32 v187, 0xffff0000, v109
  v_lshlrev_b32 v188, 16, v110
  v_and_b32 v189, 0xffff0000, v110
  v_lshlrev_b32 v190, 16, v111
  v_and_b32 v191, 0xffff0000, v111
  v_add_f32 v176, v176, v184
  v_add_f32 v177, v177, v185
  v_add_f32 v178, v178, v186
  v_add_f32 v179, v179, v187
  v_add_f32 v180, v180, v188
  v_add_f32 v181, v181, v189
  v_add_f32 v182, v182, v190
  v_add_f32 v183, v183, v191
  s_waitcnt vmcnt(11)
  v_lshlrev_b32 v184, 16, v112
  v_and_b32 v185, 0xffff0000, v112
  v_lshlrev_b32 v186, 16, v113
  v_and_b32 v187, 0xffff0000, v113
  v_lshlrev_b32 v188, 16, v114
  v_and_b32 v189, 0xffff0000, v114
  v_lshlrev_b32 v190, 16, v115
  v_and_b32 v191, 0xffff0000, v115
  v_add_f32 v160, v160, v184
  v_add_f32 v161, v161, v185
  v_add_f32 v162, v162, v186
  v_add_f32 v163, v163, v187
  v_add_f32 v164, v164, v188
  v_add_f32 v165, v165, v189
  v_add_f32 v166, v166, v190
  v_add_f32 v167, v167, v191
  s_waitcnt vmcnt(10)
  v_lshlrev_b32 v184, 16, v116
  v_and_b32 v185, 0xffff0000, v116
  v_lshlrev_b32 v186, 16, v117
  v_and_b32 v187, 0xffff0000, v117
  v_lshlrev_b32 v188, 16, v118
  v_and_b32 v189, 0xffff0000, v118
  v_lshlrev_b32 v190, 16, v119
  v_and_b32 v191, 0xffff0000, v119
  v_add_f32 v168, v168, v184
  v_add_f32 v169, v169, v185
  v_add_f32 v170, v170, v186
  v_add_f32 v171, v171, v187
  v_add_f32 v172, v172, v188
  v_add_f32 v173, v173, v189
  v_add_f32 v174, v174, v190
  v_add_f32 v175, v175, v191
  s_waitcnt vmcnt(9)
  v_lshlrev_b32 v184, 16, v120
  v_and_b32 v185, 0xffff0000, v120
  v_lshlrev_b32 v186, 16, v121
  v_and_b32 v187, 0xffff0000, v121
  v_lshlrev_b32 v188, 16, v122
  v_and_b32 v189, 0xffff0000, v122
  v_lshlrev_b32 v190, 16, v123
  v_and_b32 v191, 0xffff0000, v123
  v_add_f32 v176, v176, v184
  v_add_f32 v177, v177, v185
  v_add_f32 v178, v178, v186
  v_add_f32 v179, v179, v187
  v_add_f32 v180, v180, v188
  v_add_f32 v181, v181, v189
  v_add_f32 v182, v182, v190
  v_add_f32 v183, v183, v191
  s_waitcnt vmcnt(8)
  v_lshlrev_b32 v184, 16, v124
  v_and_b32 v185, 0xffff0000, v124
  v_lshlrev_b32 v186, 16, v125
  v_and_b32 v187, 0xffff0000, v125
  v_lshlrev_b32 v188, 16, v126
  v_and_b32 v189, 0xffff0000, v126
  v_lshlrev_b32 v190, 16, v127
  v_and_b32 v191, 0xffff0000, v127
  v_add_f32 v160, v160, v184
  v_add_f32 v161, v161, v185
  v_add_f32 v162, v162, v186
  v_add_f32 v163, v163, v187
  v_add_f32 v164, v164, v188
  v_add_f32 v165, v165, v189
  v_add_f32 v166, v166, v190
  v_add_f32 v167, v167, v191
  s_waitcnt vmcnt(7)
  v_lshlrev_b32 v184, 16, v128
  v_and_b32 v185, 0xffff0000, v128
  v_lshlrev_b32 v186, 16, v129
  v_and_b32 v187, 0xffff0000, v129
  v_lshlrev_b32 v188, 16, v130
  v_and_b32 v189, 0xffff0000, v130
  v_lshlrev_b32 v190, 16, v131
  v_and_b32 v191, 0xffff0000, v131
  v_add_f32 v168, v168, v184
  v_add_f32 v169, v169, v185
  v_add_f32 v170, v170, v186
  v_add_f32 v171, v171, v187
  v_add_f32 v172, v172, v188
  v_add_f32 v173, v173, v189
  v_add_f32 v174, v174, v190
  v_add_f32 v175, v175, v191
  s_waitcnt vmcnt(6)
  v_lshlrev_b32 v184, 16, v132
  v_and_b32 v185, 0xffff0000, v132
  v_lshlrev_b32 v186, 16, v133
  v_and_b32 v187, 0xffff0000, v133
  v_lshlrev_b32 v188, 16, v134
  v_and_b32 v189, 0xffff0000, v134
  v_lshlrev_b32 v190, 16, v135
  v_and_b32 v191, 0xffff0000, v135
  v_add_f32 v176, v176, v184
  v_add_f32 v177, v177, v185
  v_add_f32 v178, v178, v186
  v_add_f32 v179, v179, v187
  v_add_f32 v180, v180, v188
  v_add_f32 v181, v181, v189
  v_add_f32 v182, v182, v190
  v_add_f32 v183, v183, v191
  s_waitcnt vmcnt(5)
  v_lshlrev_b32 v184, 16, v136
  v_and_b32 v185, 0xffff0000, v136
  v_lshlrev_b32 v186, 16, v137
  v_and_b32 v187, 0xffff0000, v137
  v_lshlrev_b32 v188, 16, v138
  v_and_b32 v189, 0xffff0000, v138
  v_lshlrev_b32 v190, 16, v139
  v_and_b32 v191, 0xffff0000, v139
  v_add_f32 v160, v160, v184
  v_add_f32 v161, v161, v185
  v_add_f32 v162, v162, v186
  v_add_f32 v163, v163, v187
  v_add_f32 v164, v164, v188
  v_add_f32 v165, v165, v189
  v_add_f32 v166, v166, v190
  v_add_f32 v167, v167, v191
  s_waitcnt vmcnt(4)
  v_lshlrev_b32 v184, 16, v140
  v_and_b32 v185, 0xffff0000, v140
  v_lshlrev_b32 v186, 16, v141
  v_and_b32 v187, 0xffff0000, v141
  v_lshlrev_b32 v188, 16, v142
  v_and_b32 v189, 0xffff0000, v142
  v_lshlrev_b32 v190, 16, v143
  v_and_b32 v191, 0xffff0000, v143
  v_add_f32 v168, v168, v184
  v_add_f32 v169, v169, v185
  v_add_f32 v170, v170, v186
  v_add_f32 v171, v171, v187
  v_add_f32 v172, v172, v188
  v_add_f32 v173, v173, v189
  v_add_f32 v174, v174, v190
  v_add_f32 v175, v175, v191
  s_waitcnt vmcnt(3)
  v_lshlrev_b32 v184, 16, v144
  v_and_b32 v185, 0xffff0000, v144
  v_lshlrev_b32 v186, 16, v145
  v_and_b32 v187, 0xffff0000, v145
  v_lshlrev_b32 v188, 16, v146
  v_and_b32 v189, 0xffff0000, v146
  v_lshlrev_b32 v190, 16, v147
  v_and_b32 v191, 0xffff0000, v147
  v_add_f32 v176, v176, v184
  v_add_f32 v177, v177, v185
  v_add_f32 v178, v178, v186
  v_add_f32 v179, v179, v187
  v_add_f32 v180, v180, v188
  v_add_f32 v181, v181, v189
  v_add_f32 v182, v182, v190
  v_add_f32 v183, v183, v191
  s_waitcnt vmcnt(2)
  v_lshlrev_b32 v184, 16, v148
  v_and_b32 v185, 0xffff0000, v148
  v_lshlrev_b32 v186, 16, v149
  v_and_b32 v187, 0xffff0000, v149
  v_lshlrev_b32 v188, 16, v150
  v_and_b32 v189, 0xffff0000, v150
  v_lshlrev_b32 v190, 16, v151
  v_and_b32 v191, 0xffff0000, v151
  v_add_f32 v160, v160, v184
  v_add_f32 v161, v161, v185
  v_add_f32 v162, v162, v186
  v_add_f32 v163, v163, v187
  v_add_f32 v164, v164, v188
  v_add_f32 v165, v165, v189
  v_add_f32 v166, v166, v190
  v_add_f32 v167, v167, v191
  s_waitcnt vmcnt(1)
  v_lshlrev_b32 v184, 16, v152
  v_and_b32 v185, 0xffff0000, v152
  v_lshlrev_b32 v186, 16, v153
  v_and_b32 v187, 0xffff0000, v153
  v_lshlrev_b32 v188, 16, v154
  v_and_b32 v189, 0xffff0000, v154
  v_lshlrev_b32 v190, 16, v155
  v_and_b32 v191, 0xffff0000, v155
  v_add_f32 v168, v168, v184
  v_add_f32 v169, v169, v185
  v_add_f32 v170, v170, v186
  v_add_f32 v171, v171, v187
  v_add_f32 v172, v172, v188
  v_add_f32 v173, v173, v189
  v_add_f32 v174, v174, v190
  v_add_f32 v175, v175, v191
  s_waitcnt vmcnt(0)
  v_lshlrev_b32 v184, 16, v156
  v_and_b32 v185, 0xffff0000, v156
  v_lshlrev_b32 v186, 16, v157
  v_and_b32 v187, 0xffff0000, v157
  v_lshlrev_b32 v188, 16, v158
  v_and_b32 v189, 0xffff0000, v158
  v_lshlrev_b32 v190, 16, v159
  v_and_b32 v191, 0xffff0000, v159
  v_add_f32 v176, v176, v184
  v_add_f32 v177, v177, v185
  v_add_f32 v178, v178, v186
  v_add_f32 v179, v179, v187
  v_add_f32 v180, v180, v188
  v_add_f32 v181, v181, v189
  v_add_f32 v182, v182, v190
  v_add_f32 v183, v183, v191
  v_permlane32_swap_b32 v160, v164
  v_permlane32_swap_b32 v161, v165
  v_permlane32_swap_b32 v162, v166
  v_permlane32_swap_b32 v163, v167
  v_add_f32 v160, v160, v164
  v_add_f32 v161, v161, v165
  v_add_f32 v162, v162, v166
  v_add_f32 v163, v163, v167
  s_nop 0
  v_permlane16_swap_b32 v160, v162
  v_permlane16_swap_b32 v161, v163
  v_add_f32 v160, v160, v162
  v_add_f32 v161, v161, v163
  s_nop 0
  v_add_f32 v160, v160, v160 row_ror:8 row_mask:0xf bank_mask:0xf
  v_add_f32 v161, v161, v161 row_ror:8 row_mask:0xf bank_mask:0xf
  v_permlane32_swap_b32 v168, v172
  v_permlane32_swap_b32 v169, v173
  v_permlane32_swap_b32 v170, v174
  v_permlane32_swap_b32 v171, v175
  v_add_f32 v168, v168, v172
  v_add_f32 v169, v169, v173
  v_add_f32 v170, v170, v174
  v_add_f32 v171, v171, v175
  s_nop 0
  v_permlane16_swap_b32 v168, v170
  v_permlane16_swap_b32 v169, v171
  v_add_f32 v168, v168, v170
  v_add_f32 v169, v169, v171
  s_nop 0
  v_add_f32 v168, v168, v168 row_ror:8 row_mask:0xf bank_mask:0xf
  v_add_f32 v169, v169, v169 row_ror:8 row_mask:0xf bank_mask:0xf
  v_permlane32_swap_b32 v176, v180
  v_permlane32_swap_b32 v177, v181
  v_permlane32_swap_b32 v178, v182
  v_permlane32_swap_b32 v179, v183
  v_add_f32 v176, v176, v180
  v_add_f32 v177, v177, v181
  v_add_f32 v178, v178, v182
  v_add_f32 v179, v179, v183
  s_nop 0
  v_permlane16_swap_b32 v176, v178
  v_permlane16_swap_b32 v177, v179
  v_add_f32 v176, v176, v178
  v_add_f32 v177, v177, v179
  s_nop 0
  v_add_f32 v176, v176, v176 row_ror:8 row_mask:0xf bank_mask:0xf
  v_add_f32 v177, v177, v177 row_ror:8 row_mask:0xf bank_mask:0xf
  s_mov_b32 exec_lo, 0x00ff00ff
  s_mov_b32 exec_hi, 0x00ff00ff
  buffer_store_dwordx2 v[160:161], v21, s[4:7], s30 offen offset:0 sc1
  buffer_store_dwordx2 v[168:169], v21, s[4:7], s30 offen offset:256 sc1
  buffer_store_dwordx2 v[176:177], v21, s[4:7], s30 offen offset:512 sc1
  s_mov_b64 exec, -1
  s_mov_b32 s12, s58
  s_mov_b32 s13, s59
  s_mov_b32 s14, 0x100
  s_mov_b32 s15, 0x00020000
  s_mov_b32 s38, 0
  s_mov_b64 exec, 1
.g2_kernel_gt10:
  buffer_load_dword v6, v4, s[12:15], 0 offen sc1
  s_add_u32 s38, s38, 1
  s_waitcnt vmcnt(0)
  v_cmp_eq_u32 vcc, 0x60, v6
  s_cbranch_vccnz .g2_kernel_gt10d
  s_sleep 8
  s_cmp_lt_u32 s38, 131072
  s_cbranch_scc1 .g2_kernel_gt10
.g2_kernel_gt10d:
  s_mov_b64 exec, -1
  v_mov_b32 v6, s70
  s_mov_b64 exec, 1
  buffer_store_dword v6, v4, s[4:7], s76 offen offset:4 sc1
  s_mov_b64 exec, -1
  v_mov_b32 v6, 155648
  s_mov_b32 s38, 0
.g2_kernel_wg11:
  ds_read_b32 v7, v6 offset:512
  s_add_u32 s38, s38, 1
  s_waitcnt lgkmcnt(0)
  v_cmp_le_u32 vcc, 27, v7
  s_cbranch_vccnz .g2_kernel_wg11d
  s_sleep 4
  s_cmp_lt_u32 s38, 524288
  s_cbranch_scc1 .g2_kernel_wg11
.g2_kernel_wg11d:
  s_and_b32 s31, s76, 0xffffe000
  s_add_u32 s31, s31, 4
  v_and_b32 v6, 15, v2
  v_lshlrev_b32 v6, 9, v6
  v_lshrrev_b32 v7, 4, v2
  v_lshl_add_u32 v6, v7, 7, v6
  v_lshlrev_b32 v7, 2, v2
  v_add_u32 v7, 157696, v7
  s_mov_b32 m0, 157696
  s_mov_b32 s38, 0
  s_bfm_b64 exec, 16, 0
.g2_kernel_pa12:
  buffer_load_dword v6, s[4:7], s31 offen sc1 lds
  s_add_u32 s38, s38, 1
  s_waitcnt vmcnt(0)
  ds_read_b32 v8, v7
  s_waitcnt lgkmcnt(0)
  v_cmp_ge_u32 vcc, s62, v8
  s_cbranch_vccz .g2_kernel_pa12d
  s_mov_b64 exec, vcc
  s_sleep 16
  s_cmp_lt_u32 s38, 131072
  s_cbranch_scc1 .g2_kernel_pa12
.g2_kernel_pa12d:
  s_mov_b64 exec, -1
  s_mul_i32 s30, s18, 12288
  s_add_u32 s30, s30, 0x3080000
  s_mov_b32 exec_hi, 0xffff
  buffer_load_dwordx4 v[64:67], v3, s[4:7], s30 offen offset:0 sc1
  buffer_load_dwordx4 v[68:71], v3, s[4:7], s30 offen offset:768 sc1
  buffer_load_dwordx4 v[72:75], v3, s[4:7], s30 offen offset:1536 sc1
  buffer_load_dwordx4 v[76:79], v3, s[4:7], s30 offen offset:2304 sc1
  s_add_u32 s30, s30, 3072
  buffer_load_dwordx4 v[80:83], v3, s[4:7], s30 offen offset:0 sc1
  buffer_load_dwordx4 v[84:87], v3, s[4:7], s30 offen offset:768 sc1
  buffer_load_dwordx4 v[88:91], v3, s[4:7], s30 offen offset:1536 sc1
  buffer_load_dwordx4 v[92:95], v3, s[4:7], s30 offen offset:2304 sc1
  s_add_u32 s30, s30, 3072
  buffer_load_dwordx4 v[96:99], v3, s[4:7], s30 offen offset:0 sc1
  buffer_load_dwordx4 v[100:103], v3, s[4:7], s30 offen offset:768 sc1
  buffer_load_dwordx4 v[104:107], v3, s[4:7], s30 offen offset:1536 sc1
  buffer_load_dwordx4 v[108:111], v3, s[4:7], s30 offen offset:2304 sc1
  s_add_u32 s30, s30, 3072
  buffer_load_dwordx4 v[112:115], v3, s[4:7], s30 offen offset:0 sc1
  buffer_load_dwordx4 v[116:119], v3, s[4:7], s30 offen offset:768 sc1
  buffer_load_dwordx4 v[120:123], v3, s[4:7], s30 offen offset:1536 sc1
  buffer_load_dwordx4 v[124:127], v3, s[4:7], s30 offen offset:2304 sc1
  s_add_u32 s30, s30, 3072
  s_waitcnt vmcnt(14)
  v_add_f32 v64, v64, v68
  v_add_f32 v65, v65, v69
  v_add_f32 v66, v66, v70
  v_add_f32 v67, v67, v71
  s_waitcnt vmcnt(13)
  v_add_f32 v64, v64, v72
  v_add_f32 v65, v65, v73
  v_add_f32 v66, v66, v74
  v_add_f32 v67, v67, v75
  s_waitcnt vmcnt(12)
  v_add_f32 v64, v64, v76
  v_add_f32 v65, v65, v77
  v_add_f32 v66, v66, v78
  v_add_f32 v67, v67, v79
  s_waitcnt vmcnt(11)
  v_add_f32 v64, v64, v80
  v_add_f32 v65, v65, v81
  v_add_f32 v66, v66, v82
  v_add_f32 v67, v67, v83
  s_waitcnt vmcnt(10)
  v_add_f32 v64, v64, v84
  v_add_f32 v65, v65, v85
  v_add_f32 v66, v66, v86
  v_add_f32 v67, v67, v87
  s_waitcnt vmcnt(9)
  v_add_f32 v64, v64, v88
  v_add_f32 v65, v65, v89
  v_add_f32 v66, v66, v90
  v_add_f32 v67, v67, v91
  s_waitcnt vmcnt(8)
  v_add_f32 v64, v64, v92
  v_add_f32 v65, v65, v93
  v_add_f32 v66, v66, v94
  v_add_f32 v67, v67, v95
  s_waitcnt vmcnt(7)
  v_add_f32 v64, v64, v96
  v_add_f32 v65, v65, v97
  v_add_f32 v66, v66, v98
  v_add_f32 v67, v67, v99
  s_waitcnt vmcnt(6)
  v_add_f32 v64, v64, v100
  v_add_f32 v65, v65, v101
  v_add_f32 v66, v66, v102
  v_add_f32 v67, v67, v103
  s_waitcnt vmcnt(5)
  v_add_f32 v64, v64, v104
  v_add_f32 v65, v65, v105
  v_add_f32 v66, v66, v106
  v_add_f32 v67, v67, v107
  s_waitcnt vmcnt(4)
  v_add_f32 v64, v64, v108
  v_add_f32 v65, v65, v109
  v_add_f32 v66, v66, v110
  v_add_f32 v67, v67, v111
  s_waitcnt vmcnt(3)
  v_add_f32 v64, v64, v112
  v_add_f32 v65, v65, v113
  v_add_f32 v66, v66, v114
  v_add_f32 v67, v67, v115
  s_waitcnt vmcnt(2)
  v_add_f32 v64, v64, v116
  v_add_f32 v65, v65, v117
  v_add_f32 v66, v66, v118
  v_add_f32 v67, v67, v119
  s_waitcnt vmcnt(1)
  v_add_f32 v64, v64, v120
  v_add_f32 v65, v65, v121
  v_add_f32 v66, v66, v122
  v_add_f32 v67, v67, v123
  s_waitcnt vmcnt(0)
  v_add_f32 v64, v64, v124
  v_add_f32 v65, v65, v125
  v_add_f32 v66, v66, v126
  v_add_f32 v67, v67, v127
  s_mov_b64 exec, -1
  v_mov_b32 v6, 155648
  s_mov_b32 s38, 0
.g2_kernel_wg13:
  ds_read_b32 v7, v6 offset:512
  s_add_u32 s38, s38, 1
  s_waitcnt lgkmcnt(0)
  v_cmp_le_u32 vcc, 32, v7
  s_cbranch_vccnz .g2_kernel_wg13d
  s_sleep 2
  s_cmp_lt_u32 s38, 524288
  s_cbranch_scc1 .g2_kernel_wg13
.g2_kernel_wg13d:
  v_lshlrev_b32 v24, 2, v2
  v_add_u32 v24, 155648, v24
  ds_write_b32 v24, v4 offset:2048
  v_add_u32 v24, 155648, v3
  s_mov_b32 exec_hi, 0xffff
  ds_write_b128 v24, v[64:67] offset:4864
  s_mov_b64 exec, -1
  v_mov_b32 v6, s71
  s_mov_b64 exec, 1
  ds_add_u32 v6, v5 offset:0
  s_mov_b64 exec, -1
  s_branch .g2_kernel_v
.g2_kernel_s3:
  s_mov_b32 s12, s58
  s_mov_b32 s13, s59
  s_mov_b32 s14, 0x100
  s_mov_b32 s15, 0x00020000
  s_mov_b32 s20, s48
  s_mov_b32 s21, s49
  s_mov_b32 s22, 0x800
  s_mov_b32 s23, 0x00020000
  v_mov_b32 v12, 0
  v_mov_b32 v13, 0
  v_mov_b32 v14, 0
  v_mov_b32 v15, 0
  s_cmp_ge_u32 s2, 96
  s_cbranch_scc1 .g2_kernel_zm14
  s_lshl_b32 s36, s2, 12
  s_add_u32 s36, s36, 0x3000000
  buffer_store_dwordx4 v[12:15], v3, s[4:7], s36 offen sc1
  buffer_store_dwordx4 v[12:15], v3, s[4:7], s36 offen offset:1024 sc1
  buffer_store_dwordx4 v[12:15], v3, s[4:7], s36 offen offset:2048 sc1
  buffer_store_dwordx4 v[12:15], v3, s[4:7], s36 offen offset:3072 sc1
.g2_kernel_zm14:
  s_barrier
  s_cbranch_scc1 .g2_kernel_zm14b
  s_mov_b64 exec, 1
  s_waitcnt vmcnt(0)
  buffer_atomic_add v5, v4, s[12:15], 0 offen sc1
  s_mov_b64 exec, -1
.g2_kernel_zm14b:
  s_and_b32 s36, s18, 7
  s_cmp_ge_u32 s36, 3
  s_cbranch_scc1 .g2_kernel_c315
  s_mov_b32 s24, s42
  s_mov_b32 s25, s43
  s_mov_b32 s26, 0x600000
  s_mov_b32 s27, 0x00020000
  v_mul_u32_u24 v7, 6144, v2
  s_lshl_b32 s36, s36, 11
  s_or_b32 s37, s18, 3
  s_lshl_b32 s37, s37, 7
  s_add_u32 s36, s36, s37
  s_and_b32 s37, s17, 7
  s_mul_i32 s37, s37, 393216
  s_add_u32 s36, s36, s37
  s_add_u32 s37, s36, 3145728
  s_sleep 0
  buffer_load_dword v1, v7, s[24:27], s36 offen
  s_sleep 30
  buffer_load_dword v1, v7, s[24:27], s37 offen
.g2_kernel_c315:
  v_lshlrev_b32 v20, 5, v2
  buffer_load_dwordx4 v[24:27], v20, s[20:23], 0 offen
  buffer_load_dwordx4 v[28:31], v20, s[20:23], 0 offen offset:16
  v_mov_b32 v20, 0
  s_waitcnt vmcnt(0)
  v_lshlrev_b32 v21, 16, v24
  v_and_b32 v22, 0xffff0000, v24
  v_add_f32 v20, v20, v21
  v_add_f32 v20, v20, v22
  v_lshlrev_b32 v21, 16, v25
  v_and_b32 v22, 0xffff0000, v25
  v_add_f32 v20, v20, v21
  v_add_f32 v20, v20, v22
  v_lshlrev_b32 v21, 16, v26
  v_and_b32 v22, 0xffff0000, v26
  v_add_f32 v20, v20, v21
  v_add_f32 v20, v20, v22
  v_lshlrev_b32 v21, 16, v27
  v_and_b32 v22, 0xffff0000, v27
  v_add_f32 v20, v20, v21
  v_add_f32 v20, v20, v22
  v_lshlrev_b32 v21, 16, v28
  v_and_b32 v22, 0xffff0000, v28
  v_add_f32 v20, v20, v21
  v_add_f32 v20, v20, v22
  v_lshlrev_b32 v21, 16, v29
  v_and_b32 v22, 0xffff0000, v29
  v_add_f32 v20, v20, v21
  v_add_f32 v20, v20, v22
  v_lshlrev_b32 v21, 16, v30
  v_and_b32 v22, 0xffff0000, v30
  v_add_f32 v20, v20, v21
  v_add_f32 v20, v20, v22
  v_lshlrev_b32 v21, 16, v31
  v_and_b32 v22, 0xffff0000, v31
  v_add_f32 v20, v20, v21
  v_add_f32 v20, v20, v22
  s_nop 1
  v_add_f32 v20, v20, v20 quad_perm:[1,0,3,2] row_mask:0xf bank_mask:0xf
  s_nop 1
  v_add_f32 v20, v20, v20 quad_perm:[2,3,0,1] row_mask:0xf bank_mask:0xf
  s_nop 1
  v_add_f32 v20, v20, v20 row_half_mirror row_mask:0xf bank_mask:0xf
  s_nop 1
  v_add_f32 v20, v20, v20 row_mirror row_mask:0xf bank_mask:0xf
  s_nop 0
  v_readlane_b32 s20, v20, 16
  v_readlane_b32 s21, v20, 32
  v_readlane_b32 s22, v20, 48
  v_add_f32 v20, s20, v20
  v_add_f32 v20, s21, v20
  v_add_f32 v20, s22, v20
  v_mul_f32 v20, 0x3a800000, v20
  v_mov_b32 v6, 155648
  s_mov_b32 s38, 0
.g2_kernel_wg16:
  ds_read_b32 v7, v6 offset:512
  s_add_u32 s38, s38, 1
  s_waitcnt lgkmcnt(0)
  v_cmp_le_u32 vcc, 32, v7
  s_cbranch_vccnz .g2_kernel_wg16d
  s_sleep 2
  s_cmp_lt_u32 s38, 524288
  s_cbranch_scc1 .g2_kernel_wg16
.g2_kernel_wg16d:
  v_mov_b32 v21, 155648
  s_mov_b64 exec, 1
  ds_write_b32 v21, v20 offset:256
  s_mov_b64 exec, -1
.g2_kernel_v:
  s_setprio 3
  s_cmp_lg_u32 s16, 4
  s_cbranch_scc1 .g2_kernel_v_1
  v_mov_b32 v6, s71
  s_mov_b32 s38, 0
.g2_kernel_wg17:
  ds_read_b32 v7, v6 offset:4
  s_add_u32 s38, s38, 1
  s_waitcnt lgkmcnt(0)
  v_cmp_le_u32 vcc, 4, v7
  s_cbranch_vccnz .g2_kernel_wg17d
  s_sleep 1
  s_cmp_lt_u32 s38, 524288
  s_cbranch_scc1 .g2_kernel_wg17
.g2_kernel_wg17d:
  s_sleep 2
  s_and_b32 s31, s76, 0xffffe000
  s_add_u32 s31, s31, 0
  v_and_b32 v6, 15, v2
  v_lshlrev_b32 v6, 9, v6
  v_lshrrev_b32 v7, 4, v2
  v_lshl_add_u32 v6, v7, 7, v6
  v_lshlrev_b32 v7, 2, v2
  v_add_u32 v7, 157440, v7
  s_mov_b32 m0, 157440
  s_mov_b32 s38, 0
  s_mov_b32 exec_lo, 0xffff
  s_mov_b32 exec_hi, 0xffff
.g2_kernel_pa18:
  buffer_load_dword v6, s[4:7], s31 offen sc1 lds
  s_add_u32 s38, s38, 1
  s_waitcnt vmcnt(0)
  ds_read_b32 v8, v7
  s_waitcnt lgkmcnt(0)
  v_cmp_ge_u32 vcc, s62, v8
  s_cbranch_vccz .g2_kernel_pa18d
  s_mov_b64 exec, vcc
  s_sleep 2
  s_cmp_lt_u32 s38, 131072
  s_cbranch_scc1 .g2_kernel_pa18
.g2_kernel_pa18d:
  s_mov_b64 exec, -1
  v_mov_b32 v6, s71
  s_mov_b64 exec, 1
  ds_add_u32 v6, v5 offset:80
  s_mov_b64 exec, -1
.g2_kernel_v_1:
  s_cmp_lt_u32 s16, 6
  s_cbranch_scc1 .g2_kernel_v_2
  v_mov_b32 v6, s71
  s_mov_b32 s38, 0
.g2_kernel_wg19:
  ds_read_b32 v7, v6 offset:4
  s_add_u32 s38, s38, 1
  s_waitcnt lgkmcnt(0)
  v_cmp_le_u32 vcc, 4, v7
  s_cbranch_vccnz .g2_kernel_wg19d
  s_sleep 4
  s_cmp_lt_u32 s38, 524288
  s_cbranch_scc1 .g2_kernel_wg19
.g2_kernel_wg19d:
  s_and_b32 s28, s16, 1
  s_lshl_b32 s30, s28, 13
  s_add_u32 s31, s30, 16384
  v_add_u32 v8, s31, v3
  ds_read_b32 v9, v6 offset:24
  ds_read_b128 v[16:19], v8 offset:0
  ds_read_b128 v[20:23], v8 offset:1024
  ds_read_b128 v[24:27], v8 offset:2048
  ds_read_b128 v[28:31], v8 offset:3072
  ds_read_b128 v[32:35], v8 offset:4096
  ds_read_b128 v[36:39], v8 offset:5120
  ds_read_b128 v[40:43], v8 offset:6144
  ds_read_b128 v[44:47], v8 offset:7168
  s_lshl_b32 s31, s18, 5
  s_add_u32 s31, s31, s17
  s_add_u32 s31, s31, 16
  s_lshl_b32 s31, s31, 14
  s_add_u32 s30, s30, s31
  s_add_u32 s30, s30, s63
  s_add_u32 s31, s30, 4096
  s_lshl_b32 s33, s28, 8
  s_add_u32 s33, s33, 128
  s_waitcnt lgkmcnt(0)
  v_readfirstlane_b32 s29, v9
  v_mov_b32 v6, s71
  s_mov_b64 exec, 1
  ds_add_u32 v6, v5 offset:8
  s_mov_b64 exec, -1
  s_sleep 40
  buffer_store_dwordx4 v[16:19], v3, s[4:7], s30 offen offset:0 sc1
  s_sleep 4
  buffer_store_dwordx4 v[20:23], v3, s[4:7], s30 offen offset:1024 sc1
  s_sleep 4
  buffer_store_dwordx4 v[24:27], v3, s[4:7], s30 offen offset:2048 sc1
  s_sleep 4
  buffer_store_dwordx4 v[28:31], v3, s[4:7], s30 offen offset:3072 sc1
  s_sleep 4
  buffer_store_dwordx4 v[32:35], v3, s[4:7], s31 offen offset:0 sc1
  s_sleep 4
  buffer_store_dwordx4 v[36:39], v3, s[4:7], s31 offen offset:1024 sc1
  s_sleep 4
  buffer_store_dwordx4 v[40:43], v3, s[4:7], s31 offen offset:2048 sc1
  s_sleep 4
  buffer_store_dwordx4 v[44:47], v3, s[4:7], s31 offen offset:3072 sc1
  s_sleep 4
  s_sub_u32 s29, s29, 1
  s_lshr_b32 s29, s29, 6
  s_waitcnt vmcnt(0)
  s_cmp_eq_u32 s29, s28
  s_cbranch_scc1 .g2_kernel_v_1h
  s_add_u32 s31, s76, s33
  v_mov_b32 v6, s70
  s_mov_b64 exec, 1
  buffer_store_dword v6, v4, s[4:7], s31 offen offset:0 sc1
  s_mov_b64 exec, -1
  s_branch .g2_kernel_v_2
.g2_kernel_v_1h:
  v_mov_b32 v6, s71
  s_mov_b64 exec, 1
  ds_add_u32 v6, v5 offset:56
  s_mov_b64 exec, -1
.g2_kernel_v_2:
  v_mov_b32 v6, s71
  s_mov_b32 s38, 0
.g2_kernel_wg20:
  ds_read_b32 v7, v6 offset:80
  s_add_u32 s38, s38, 1
  s_waitcnt lgkmcnt(0)
  v_cmp_le_u32 vcc, 1, v7
  s_cbranch_vccnz .g2_kernel_wg20d
  s_sleep 8
  s_cmp_lt_u32 s38, 524288
  s_cbranch_scc1 .g2_kernel_wg20
.g2_kernel_wg20d:
  s_sleep 20
  s_mov_b32 s39, 0
  v_mov_b32 v12, 0
  v_mov_b32 v13, 0
  v_mov_b32 v14, 0
  v_mov_b32 v15, 0
  s_lshl_b32 s30, s17, 2
  s_and_b32 s31, s16, 3
  s_add_u32 s30, s30, s31
  s_lshl_b32 s30, s30, 4
  s_add_u32 s30, s30, s18
  s_lshl_b32 s30, s30, 9
  s_add_u32 s30, s30, s63
  s_add_u32 s30, s30, 0x1000000
  s_mov_b32 exec_hi, 0
  s_sleep 6
  buffer_store_dwordx4 v[12:15], v3, s[4:7], s30 offen sc1
  s_mov_b64 exec, -1
  s_lshl_b32 s30, s17, 2
  s_add_u32 s30, s30, s31
  s_lshl_b32 s30, s30, 5
  s_add_u32 s30, s30, s18
  s_lshl_b32 s30, s30, 11
  s_add_u32 s30, s30, s63
  s_add_u32 s30, s30, 0x808000
  s_sleep 6
  buffer_store_dwordx4 v[12:15], v3, s[4:7], s30 offen sc1
  s_sleep 6
  buffer_store_dwordx4 v[12:15], v3, s[4:7], s30 offen offset:1024 sc1
  s_cmp_lg_u32 s62, 5
  s_cbranch_scc1 .g2_kernel_zs21k
  s_lshl_b32 s30, s18, 4
  s_add_u32 s30, s30, s17
  s_lshl_b32 s30, s30, 2
  s_add_u32 s30, s30, s31
  s_lshl_b32 s30, s30, 12
  s_add_u32 s30, s30, 0x2c00000
  s_sleep 6
  buffer_store_dwordx4 v[12:15], v3, s[4:7], s30 offen sc1
  s_sleep 6
  buffer_store_dwordx4 v[12:15], v3, s[4:7], s30 offen offset:1024 sc1
  s_sleep 6
  buffer_store_dwordx4 v[12:15], v3, s[4:7], s30 offen offset:2048 sc1
  s_sleep 6
  buffer_store_dwordx4 v[12:15], v3, s[4:7], s30 offen offset:3072 sc1
.g2_kernel_zs21k:
  s_lshl_b32 s30, s17, 4
  s_add_u32 s30, s30, s18
  s_cmp_gt_u32 s16, 5
  s_cbranch_scc1 .g2_kernel_zs21
  s_cmp_eq_u32 s16, 5
  s_cbranch_scc1 .g2_kernel_zs21a
  s_cmp_lg_u32 s62, 0
  s_cbranch_scc1 .g2_kernel_zs21
  s_lshl_b32 s30, s30, 12
  s_add_u32 s31, s30, 0x1090000
  s_sleep 6
  buffer_store_dwordx4 v[12:15], v3, s[4:7], s31 offen offset:0 sc1
  s_sleep 6
  buffer_store_dwordx4 v[12:15], v3, s[4:7], s31 offen offset:1024 sc1
  s_sleep 6
  buffer_store_dwordx4 v[12:15], v3, s[4:7], s31 offen offset:2048 sc1
  s_sleep 6
  buffer_store_dwordx4 v[12:15], v3, s[4:7], s31 offen offset:3072 sc1
  s_add_u32 s31, s30, 0x2890000
  s_sleep 6
  buffer_store_dwordx4 v[12:15], v3, s[4:7], s31 offen offset:0 sc1
  s_sleep 6
  buffer_store_dwordx4 v[12:15], v3, s[4:7], s31 offen offset:1024 sc1
  s_sleep 6
  buffer_store_dwordx4 v[12:15], v3, s[4:7], s31 offen offset:2048 sc1
  s_sleep 6
  buffer_store_dwordx4 v[12:15], v3, s[4:7], s31 offen offset:3072 sc1
  s_add_u32 s31, s30, 0x2b00000
  s_sleep 6
  buffer_store_dwordx4 v[12:15], v3, s[4:7], s31 offen offset:0 sc1
  s_sleep 6
  buffer_store_dwordx4 v[12:15], v3, s[4:7], s31 offen offset:1024 sc1
  s_sleep 6
  buffer_store_dwordx4 v[12:15], v3, s[4:7], s31 offen offset:2048 sc1
  s_sleep 6
  buffer_store_dwordx4 v[12:15], v3, s[4:7], s31 offen offset:3072 sc1
  s_branch .g2_kernel_zs21
.g2_kernel_zs21a:
  s_lshl_b32 s30, s30, 6
  s_add_u32 s30, s30, s63
  s_add_u32 s30, s30, 0x1080000
  s_mov_b64 exec, 15
  s_sleep 6
  buffer_store_dwordx4 v[12:15], v3, s[4:7], s30 offen sc1
  s_mov_b64 exec, -1
  s_and_b32 s30, s18, 14
  s_lshl_b32 s30, s30, 4
  s_add_u32 s30, s30, s17
  s_lshl_b32 s30, s30, 1
  s_and_b32 s31, s18, 1
  s_add_u32 s30, s30, s31
  s_lshl_b32 s30, s30, 10
  s_add_u32 s30, s30, s63
  s_add_u32 s30, s30, 0x1190000
  s_add_u32 s31, s30, 32768
  s_sleep 6
  buffer_store_dwordx4 v[12:15], v3, s[4:7], s30 offen sc1
  s_sleep 6
  buffer_store_dwordx4 v[12:15], v3, s[4:7], s31 offen sc1
.g2_kernel_zs21:
  s_cmp_eq_u32 s16, 4
  s_cbranch_scc1 .g2_kernel_v_3a
  s_cmp_lg_u32 s62, 0
  s_cbranch_scc1 .g2_kernel_g_e
  s_and_b32 s22, s16, 3
  s_lshl_b32 s22, s22, 14
  s_add_u32 s22, s22, 65536
  v_bfe_u32 v8, v2, 2, 2
  v_lshrrev_b32 v9, 4, v2
  v_and_b32 v10, 3, v2
  v_lshlrev_b32 v10, 3, v10
  v_add_u32 v10, s22, v10
  s_cmp_eq_u32 s16, 5
  s_cbranch_scc1 .g2_kernel_g_p
  s_cmp_ge_u32 s17, 14
  s_cbranch_scc1 .g2_kernel_g_e
  v_lshrrev_b32 v6, 1, v2
  v_mul_u32_u24 v6, 7168, v6
  v_and_b32 v7, 1, v2
  v_lshl_add_u32 v250, v7, 4, v6
  v_lshl_add_u32 v11, v9, 3, v8
  v_lshl_add_u32 v251, v11, 5, v10
  v_and_b32 v11, 1, v9
  v_lshl_add_u32 v11, v11, 3, v8
  v_lshl_add_u32 v11, v11, 10, v10
  v_lshrrev_b32 v7, 1, v9
  v_lshl_add_u32 v252, v7, 7, v11
  s_lshl_b32 s24, s17, 4
  s_add_u32 s24, s24, s18
  s_and_b32 s25, s16, 1
  s_mov_b32 s12, s50
  s_mov_b32 s13, s51
  s_mov_b32 s14, 0x700000
  s_mov_b32 s15, 0x00020000
  s_mul_i32 s20, s25, 3670016
  s_lshl_b32 s31, s24, 5
  s_add_u32 s20, s20, s31
  s_lshl_b32 s31, s18, 2
  s_mov_b32 s23, s31
  s_mov_b32 s21, 16
.g2_kernel_gl23:
  s_and_b32 s30, s21, 3
  s_cbranch_scc1 .g2_kernel_gl23m
  s_call_b64 s[26:27], .g2_kernel_v_may
.g2_kernel_gl23m:
  s_and_b32 s23, s23, 15
  s_lshl_b32 s30, s23, 10
  s_add_u32 s30, s30, 0
  s_add_u32 m0, s30, s22
  s_mul_i32 s30, s23, 229376
  s_add_u32 s30, s30, s20
  buffer_load_dwordx4 v250, s[12:15], s30 offen lds
  s_add_u32 s23, s23, 1
  s_sub_u32 s21, s21, 1
  s_sleep 3
  s_waitcnt vmcnt(2)
  s_cmp_lg_u32 s21, 0
  s_cbranch_scc1 .g2_kernel_gl23
  s_waitcnt vmcnt(0)
  ds_read_b64_tr_b16 v[64:65], v251 offset:0
  ds_read_b64_tr_b16 v[66:67], v251 offset:128
  ds_read_b64_tr_b16 v[68:69], v251 offset:1024
  ds_read_b64_tr_b16 v[70:71], v251 offset:1152
  ds_read_b64_tr_b16 v[72:73], v251 offset:2048
  ds_read_b64_tr_b16 v[74:75], v251 offset:2176
  ds_read_b64_tr_b16 v[76:77], v251 offset:3072
  ds_read_b64_tr_b16 v[78:79], v251 offset:3200
  ds_read_b64_tr_b16 v[80:81], v251 offset:4096
  ds_read_b64_tr_b16 v[82:83], v251 offset:4224
  ds_read_b64_tr_b16 v[84:85], v251 offset:5120
  ds_read_b64_tr_b16 v[86:87], v251 offset:5248
  ds_read_b64_tr_b16 v[88:89], v251 offset:6144
  ds_read_b64_tr_b16 v[90:91], v251 offset:6272
  ds_read_b64_tr_b16 v[92:93], v251 offset:7168
  ds_read_b64_tr_b16 v[94:95], v251 offset:7296
  ds_read_b64_tr_b16 v[96:97], v251 offset:8192
  ds_read_b64_tr_b16 v[98:99], v251 offset:8320
  ds_read_b64_tr_b16 v[100:101], v251 offset:9216
  ds_read_b64_tr_b16 v[102:103], v251 offset:9344
  ds_read_b64_tr_b16 v[104:105], v251 offset:10240
  ds_read_b64_tr_b16 v[106:107], v251 offset:10368
  ds_read_b64_tr_b16 v[108:109], v251 offset:11264
  ds_read_b64_tr_b16 v[110:111], v251 offset:11392
  ds_read_b64_tr_b16 v[112:113], v251 offset:12288
  ds_read_b64_tr_b16 v[114:115], v251 offset:12416
  ds_read_b64_tr_b16 v[116:117], v251 offset:13312
  ds_read_b64_tr_b16 v[118:119], v251 offset:13440
  ds_read_b64_tr_b16 v[120:121], v251 offset:14336
  ds_read_b64_tr_b16 v[122:123], v251 offset:14464
  ds_read_b64_tr_b16 v[124:125], v251 offset:15360
  ds_read_b64_tr_b16 v[126:127], v251 offset:15488
  s_waitcnt lgkmcnt(0)
  s_mov_b32 s12, s52
  s_mov_b32 s13, s53
  s_mov_b32 s14, 0x700000
  s_mov_b32 s15, 0x00020000
  s_mul_i32 s20, s25, 3670016
  s_lshl_b32 s31, s24, 5
  s_add_u32 s20, s20, s31
  s_lshl_b32 s31, s18, 2
  s_mov_b32 s23, s31
  s_mov_b32 s21, 16
.g2_kernel_gl24:
  s_and_b32 s30, s21, 3
  s_cbranch_scc1 .g2_kernel_gl24m
  s_call_b64 s[26:27], .g2_kernel_v_may
.g2_kernel_gl24m:
  s_and_b32 s23, s23, 15
  s_lshl_b32 s30, s23, 10
  s_add_u32 s30, s30, 0
  s_add_u32 m0, s30, s22
  s_mul_i32 s30, s23, 229376
  s_add_u32 s30, s30, s20
  buffer_load_dwordx4 v250, s[12:15], s30 offen lds
  s_add_u32 s23, s23, 1
  s_sub_u32 s21, s21, 1
  s_sleep 3
  s_waitcnt vmcnt(2)
  s_cmp_lg_u32 s21, 0
  s_cbranch_scc1 .g2_kernel_gl24
  s_waitcnt vmcnt(0)
  ds_read_b64_tr_b16 v[128:129], v251 offset:0
  ds_read_b64_tr_b16 v[130:131], v251 offset:128
  ds_read_b64_tr_b16 v[132:133], v251 offset:1024
  ds_read_b64_tr_b16 v[134:135], v251 offset:1152
  ds_read_b64_tr_b16 v[136:137], v251 offset:2048
  ds_read_b64_tr_b16 v[138:139], v251 offset:2176
  ds_read_b64_tr_b16 v[140:141], v251 offset:3072
  ds_read_b64_tr_b16 v[142:143], v251 offset:3200
  ds_read_b64_tr_b16 v[144:145], v251 offset:4096
  ds_read_b64_tr_b16 v[146:147], v251 offset:4224
  ds_read_b64_tr_b16 v[148:149], v251 offset:5120
  ds_read_b64_tr_b16 v[150:151], v251 offset:5248
  ds_read_b64_tr_b16 v[152:153], v251 offset:6144
  ds_read_b64_tr_b16 v[154:155], v251 offset:6272
  ds_read_b64_tr_b16 v[156:157], v251 offset:7168
  ds_read_b64_tr_b16 v[158:159], v251 offset:7296
  ds_read_b64_tr_b16 v[160:161], v251 offset:8192
  ds_read_b64_tr_b16 v[162:163], v251 offset:8320
  ds_read_b64_tr_b16 v[164:165], v251 offset:9216
  ds_read_b64_tr_b16 v[166:167], v251 offset:9344
  ds_read_b64_tr_b16 v[168:169], v251 offset:10240
  ds_read_b64_tr_b16 v[170:171], v251 offset:10368
  ds_read_b64_tr_b16 v[172:173], v251 offset:11264
  ds_read_b64_tr_b16 v[174:175], v251 offset:11392
  ds_read_b64_tr_b16 v[176:177], v251 offset:12288
  ds_read_b64_tr_b16 v[178:179], v251 offset:12416
  ds_read_b64_tr_b16 v[180:181], v251 offset:13312
  ds_read_b64_tr_b16 v[182:183], v251 offset:13440
  ds_read_b64_tr_b16 v[184:185], v251 offset:14336
  ds_read_b64_tr_b16 v[186:187], v251 offset:14464
  ds_read_b64_tr_b16 v[188:189], v251 offset:15360
  ds_read_b64_tr_b16 v[190:191], v251 offset:15488
  s_waitcnt lgkmcnt(0)
  s_mov_b32 s12, s54
  s_mov_b32 s13, s55
  s_mov_b32 s14, 0x700000
  s_mov_b32 s15, 0x00020000
  s_lshl_b32 s20, s24, 15
  s_lshl_b32 s31, s25, 10
  s_add_u32 s20, s20, s31
  s_mov_b32 s23, 0
  s_mov_b32 s21, 16
.g2_kernel_gl25:
  s_and_b32 s30, s21, 3
  s_cbranch_scc1 .g2_kernel_gl25m
  s_call_b64 s[26:27], .g2_kernel_v_may
.g2_kernel_gl25m:
  s_and_b32 s23, s23, 15
  s_lshl_b32 s30, s23, 10
  s_add_u32 s30, s30, 0
  s_add_u32 m0, s30, s22
  s_mul_i32 s30, s23, 2048
  s_add_u32 s30, s30, s20
  buffer_load_dwordx4 v3, s[12:15], s30 offen lds
  s_add_u32 s23, s23, 1
  s_sub_u32 s21, s21, 1
  s_sleep 2
  s_waitcnt vmcnt(2)
  s_cmp_lg_u32 s21, 0
  s_cbranch_scc1 .g2_kernel_gl25
  v_mov_b32 v11, v252
  s_waitcnt vmcnt(0)
  ds_read_b64_tr_b16 v[192:193], v11 offset:0
  ds_read_b64_tr_b16 v[194:195], v11 offset:4096
  ds_read_b64_tr_b16 v[196:197], v11 offset:32
  ds_read_b64_tr_b16 v[198:199], v11 offset:4128
  ds_read_b64_tr_b16 v[200:201], v11 offset:64
  ds_read_b64_tr_b16 v[202:203], v11 offset:4160
  ds_read_b64_tr_b16 v[204:205], v11 offset:96
  ds_read_b64_tr_b16 v[206:207], v11 offset:4192
  ds_read_b64_tr_b16 v[208:209], v11 offset:256
  ds_read_b64_tr_b16 v[210:211], v11 offset:4352
  ds_read_b64_tr_b16 v[212:213], v11 offset:288
  ds_read_b64_tr_b16 v[214:215], v11 offset:4384
  ds_read_b64_tr_b16 v[216:217], v11 offset:320
  ds_read_b64_tr_b16 v[218:219], v11 offset:4416
  ds_read_b64_tr_b16 v[220:221], v11 offset:352
  ds_read_b64_tr_b16 v[222:223], v11 offset:4448
  ds_read_b64_tr_b16 v[224:225], v11 offset:512
  ds_read_b64_tr_b16 v[226:227], v11 offset:4608
  ds_read_b64_tr_b16 v[228:229], v11 offset:544
  ds_read_b64_tr_b16 v[230:231], v11 offset:4640
  ds_read_b64_tr_b16 v[232:233], v11 offset:576
  ds_read_b64_tr_b16 v[234:235], v11 offset:4672
  ds_read_b64_tr_b16 v[236:237], v11 offset:608
  ds_read_b64_tr_b16 v[238:239], v11 offset:4704
  ds_read_b64_tr_b16 v[240:241], v11 offset:768
  ds_read_b64_tr_b16 v[242:243], v11 offset:4864
  ds_read_b64_tr_b16 v[244:245], v11 offset:800
  ds_read_b64_tr_b16 v[246:247], v11 offset:4896
  ds_read_b64_tr_b16 v[248:249], v11 offset:832
  ds_read_b64_tr_b16 v[250:251], v11 offset:4928
  ds_read_b64_tr_b16 v[252:253], v11 offset:864
  ds_read_b64_tr_b16 v[254:255], v11 offset:4960
  s_waitcnt lgkmcnt(0)
  s_branch .g2_kernel_g_e
.g2_kernel_g_p:
  s_mov_b32 s12, s42
  s_mov_b32 s13, s43
  s_mov_b32 s14, 0x600000
  s_mov_b32 s15, 0x00020000
  v_mul_u32_u24 v6, 6144, v9
  v_and_b32 v7, 15, v2
  v_lshl_add_u32 v250, v7, 4, v6
  v_lshl_add_u32 v11, v8, 2, v9
  v_lshl_add_u32 v251, v11, 9, v10
  s_lshl_b32 s20, s17, 3
  s_and_b32 s31, s18, 1
  s_add_u32 s20, s20, s31
  s_mul_i32 s20, s20, 49152
  s_and_b32 s31, s18, 14
  s_lshl_b32 s31, s31, 7
  s_add_u32 s20, s20, s31
  s_mov_b32 s23, 0
  s_mov_b32 s21, 8
.g2_kernel_gl26:
  s_and_b32 s30, s21, 3
  s_cbranch_scc1 .g2_kernel_gl26m
  s_call_b64 s[26:27], .g2_kernel_v_may
.g2_kernel_gl26m:
  s_and_b32 s23, s23, 7
  s_lshl_b32 s30, s23, 10
  s_add_u32 s30, s30, 0
  s_add_u32 m0, s30, s22
  s_mul_i32 s30, s23, 49152
  s_add_u32 s30, s30, s20
  s_and_b32 s31, s23, 1
  s_mul_i32 s31, s31, -24576
  s_add_u32 s30, s30, s31
  buffer_load_dwordx4 v250, s[12:15], s30 offen lds
  s_add_u32 s23, s23, 1
  s_sub_u32 s21, s21, 1
  s_sleep 3
  s_waitcnt vmcnt(2)
  s_cmp_lg_u32 s21, 0
  s_cbranch_scc1 .g2_kernel_gl26
  s_add_u32 s20, s20, 2048
  s_mov_b32 s23, 0
  s_mov_b32 s21, 8
.g2_kernel_gl27:
  s_and_b32 s30, s21, 3
  s_cbranch_scc1 .g2_kernel_gl27m
  s_call_b64 s[26:27], .g2_kernel_v_may
.g2_kernel_gl27m:
  s_and_b32 s23, s23, 7
  s_lshl_b32 s30, s23, 10
  s_add_u32 s30, s30, 8192
  s_add_u32 m0, s30, s22
  s_mul_i32 s30, s23, 49152
  s_add_u32 s30, s30, s20
  s_and_b32 s31, s23, 1
  s_mul_i32 s31, s31, -24576
  s_add_u32 s30, s30, s31
  buffer_load_dwordx4 v250, s[12:15], s30 offen lds
  s_add_u32 s23, s23, 1
  s_sub_u32 s21, s21, 1
  s_sleep 3
  s_waitcnt vmcnt(2)
  s_cmp_lg_u32 s21, 0
  s_cbranch_scc1 .g2_kernel_gl27
  s_add_u32 s20, s20, 2048
  s_waitcnt vmcnt(0)
  ds_read_b64_tr_b16 v[64:65], v251 offset:0
  ds_read_b64_tr_b16 v[66:67], v251 offset:256
  ds_read_b64_tr_b16 v[68:69], v251 offset:32
  ds_read_b64_tr_b16 v[70:71], v251 offset:288
  ds_read_b64_tr_b16 v[72:73], v251 offset:64
  ds_read_b64_tr_b16 v[74:75], v251 offset:320
  ds_read_b64_tr_b16 v[76:77], v251 offset:96
  ds_read_b64_tr_b16 v[78:79], v251 offset:352
  ds_read_b64_tr_b16 v[80:81], v251 offset:128
  ds_read_b64_tr_b16 v[82:83], v251 offset:384
  ds_read_b64_tr_b16 v[84:85], v251 offset:160
  ds_read_b64_tr_b16 v[86:87], v251 offset:416
  ds_read_b64_tr_b16 v[88:89], v251 offset:192
  ds_read_b64_tr_b16 v[90:91], v251 offset:448
  ds_read_b64_tr_b16 v[92:93], v251 offset:224
  ds_read_b64_tr_b16 v[94:95], v251 offset:480
  ds_read_b64_tr_b16 v[96:97], v251 offset:8192
  ds_read_b64_tr_b16 v[98:99], v251 offset:8448
  ds_read_b64_tr_b16 v[100:101], v251 offset:8224
  ds_read_b64_tr_b16 v[102:103], v251 offset:8480
  ds_read_b64_tr_b16 v[104:105], v251 offset:8256
  ds_read_b64_tr_b16 v[106:107], v251 offset:8512
  ds_read_b64_tr_b16 v[108:109], v251 offset:8288
  ds_read_b64_tr_b16 v[110:111], v251 offset:8544
  ds_read_b64_tr_b16 v[112:113], v251 offset:8320
  ds_read_b64_tr_b16 v[114:115], v251 offset:8576
  ds_read_b64_tr_b16 v[116:117], v251 offset:8352
  ds_read_b64_tr_b16 v[118:119], v251 offset:8608
  ds_read_b64_tr_b16 v[120:121], v251 offset:8384
  ds_read_b64_tr_b16 v[122:123], v251 offset:8640
  ds_read_b64_tr_b16 v[124:125], v251 offset:8416
  ds_read_b64_tr_b16 v[126:127], v251 offset:8672
  s_waitcnt lgkmcnt(0)
  s_mov_b32 s23, 0
  s_mov_b32 s21, 8
.g2_kernel_gl28:
  s_and_b32 s30, s21, 3
  s_cbranch_scc1 .g2_kernel_gl28m
  s_call_b64 s[26:27], .g2_kernel_v_may
.g2_kernel_gl28m:
  s_and_b32 s23, s23, 7
  s_lshl_b32 s30, s23, 10
  s_add_u32 s30, s30, 0
  s_add_u32 m0, s30, s22
  s_mul_i32 s30, s23, 49152
  s_add_u32 s30, s30, s20
  s_and_b32 s31, s23, 1
  s_mul_i32 s31, s31, -24576
  s_add_u32 s30, s30, s31
  buffer_load_dwordx4 v250, s[12:15], s30 offen lds
  s_add_u32 s23, s23, 1
  s_sub_u32 s21, s21, 1
  s_sleep 3
  s_waitcnt vmcnt(2)
  s_cmp_lg_u32 s21, 0
  s_cbranch_scc1 .g2_kernel_gl28
  s_add_u32 s20, s20, 2048
  s_waitcnt vmcnt(0)
  ds_read_b64_tr_b16 v[128:129], v251 offset:0
  ds_read_b64_tr_b16 v[130:131], v251 offset:256
  ds_read_b64_tr_b16 v[132:133], v251 offset:32
  ds_read_b64_tr_b16 v[134:135], v251 offset:288
  ds_read_b64_tr_b16 v[136:137], v251 offset:64
  ds_read_b64_tr_b16 v[138:139], v251 offset:320
  ds_read_b64_tr_b16 v[140:141], v251 offset:96
  ds_read_b64_tr_b16 v[142:143], v251 offset:352
  ds_read_b64_tr_b16 v[144:145], v251 offset:128
  ds_read_b64_tr_b16 v[146:147], v251 offset:384
  ds_read_b64_tr_b16 v[148:149], v251 offset:160
  ds_read_b64_tr_b16 v[150:151], v251 offset:416
  ds_read_b64_tr_b16 v[152:153], v251 offset:192
  ds_read_b64_tr_b16 v[154:155], v251 offset:448
  ds_read_b64_tr_b16 v[156:157], v251 offset:224
  ds_read_b64_tr_b16 v[158:159], v251 offset:480
  s_waitcnt lgkmcnt(0)
.g2_kernel_g_e:
.g2_kernel_v_3:
  s_mov_b32 s29, 0
  s_and_b32 s30, s16, 3
  s_lshl_b32 s30, s30, 14
  s_add_u32 s30, s30, 65536
  s_call_b64 s[68:69], .g2_kernel_v_wo
  s_waitcnt vmcnt(0)
  v_mov_b32 v6, s71
  s_mov_b64 exec, 1
  ds_add_u32 v6, v5 offset:52
  s_mov_b64 exec, -1
  s_cmp_lg_u32 s39, 0
  s_cbranch_scc1 .g2_kernel_v_3b
  s_call_b64 s[26:27], .g2_kernel_v_do
.g2_kernel_v_3b:
  s_cmp_lg_u32 s16, 4
  s_cbranch_scc1 .g2_kernel_v_4
  v_mov_b32 v6, s71
  s_mov_b32 s38, 0
.g2_kernel_wg29:
  ds_read_b32 v7, v6 offset:8
  s_add_u32 s38, s38, 1
  s_waitcnt lgkmcnt(0)
  v_cmp_le_u32 vcc, 10, v7
  s_cbranch_vccnz .g2_kernel_wg29d
  s_sleep 8
  s_cmp_lt_u32 s38, 524288
  s_cbranch_scc1 .g2_kernel_wg29
.g2_kernel_wg29d:
  s_mov_b32 s29, 1
  s_mov_b32 s30, 139264
  s_call_b64 s[68:69], .g2_kernel_v_wo
  s_add_u32 s31, s31, 81920
  s_sleep 6
  s_waitcnt vmcnt(4)
  buffer_load_dwordx4 v[64:67], v6, s[8:11], s31 offen
  s_add_u32 s31, s31, 16384
  buffer_load_dwordx4 v[68:71], v6, s[8:11], s31 offen
  s_add_u32 s31, s31, 16384
  buffer_load_dwordx4 v[72:75], v6, s[8:11], s31 offen
  s_add_u32 s31, s31, 16384
  buffer_load_dwordx4 v[76:79], v6, s[8:11], s31 offen
  s_add_u32 s31, s31, 81920
  s_sleep 6
  s_waitcnt vmcnt(4)
  buffer_load_dwordx4 v[80:83], v6, s[8:11], s31 offen
  s_add_u32 s31, s31, 16384
  buffer_load_dwordx4 v[84:87], v6, s[8:11], s31 offen
  s_add_u32 s31, s31, 16384
  buffer_load_dwordx4 v[88:91], v6, s[8:11], s31 offen
  s_add_u32 s31, s31, 16384
  buffer_load_dwordx4 v[92:95], v6, s[8:11], s31 offen
  s_add_u32 s31, s31, 81920
  s_sleep 6
  s_waitcnt vmcnt(4)
  buffer_load_dwordx4 v[96:99], v6, s[8:11], s31 offen
  s_add_u32 s31, s31, 16384
  buffer_load_dwordx4 v[100:103], v6, s[8:11], s31 offen
  s_add_u32 s31, s31, 16384
  buffer_load_dwordx4 v[104:107], v6, s[8:11], s31 offen
  s_add_u32 s31, s31, 16384
  buffer_load_dwordx4 v[108:111], v6, s[8:11], s31 offen
  s_add_u32 s31, s31, 81920
  s_sleep 6
  s_waitcnt vmcnt(4)
  buffer_load_dwordx4 v[112:115], v6, s[8:11], s31 offen
  s_add_u32 s31, s31, 16384
  buffer_load_dwordx4 v[116:119], v6, s[8:11], s31 offen
  s_add_u32 s31, s31, 16384
  buffer_load_dwordx4 v[120:123], v6, s[8:11], s31 offen
  s_add_u32 s31, s31, 16384
  buffer_load_dwordx4 v[124:127], v6, s[8:11], s31 offen
  s_add_u32 s31, s31, 81920
  s_sleep 6
  s_waitcnt vmcnt(4)
  s_mov_b32 m0, 32768
  s_nop 0
  buffer_load_dwordx4 v6, s[8:11], s31 offen lds
  s_add_u32 s31, s31, 16384
  s_mov_b32 m0, 33792
  s_nop 0
  buffer_load_dwordx4 v6, s[8:11], s31 offen lds
  s_add_u32 s31, s31, 16384
  s_mov_b32 m0, 34816
  s_nop 0
  buffer_load_dwordx4 v6, s[8:11], s31 offen lds
  s_add_u32 s31, s31, 16384
  s_mov_b32 m0, 35840
  s_nop 0
  buffer_load_dwordx4 v6, s[8:11], s31 offen lds
  s_add_u32 s31, s31, 81920
  s_sleep 6
  s_waitcnt vmcnt(4)
  s_mov_b32 m0, 36864
  s_nop 0
  buffer_load_dwordx4 v6, s[8:11], s31 offen lds
  s_add_u32 s31, s31, 16384
  s_mov_b32 m0, 37888
  s_nop 0
  buffer_load_dwordx4 v6, s[8:11], s31 offen lds
  s_add_u32 s31, s31, 16384
  s_mov_b32 m0, 38912
  s_nop 0
  buffer_load_dwordx4 v6, s[8:11], s31 offen lds
  s_add_u32 s31, s31, 16384
  s_mov_b32 m0, 39936
  s_nop 0
  buffer_load_dwordx4 v6, s[8:11], s31 offen lds
  s_add_u32 s31, s31, 81920
  s_sleep 6
  s_waitcnt vmcnt(4)
  s_mov_b32 m0, 40960
  s_nop 0
  buffer_load_dwordx4 v6, s[8:11], s31 offen lds
  s_add_u32 s31, s31, 16384
  s_mov_b32 m0, 41984
  s_nop 0
  buffer_load_dwordx4 v6, s[8:11], s31 offen lds
  s_add_u32 s31, s31, 16384
  s_mov_b32 m0, 43008
  s_nop 0
  buffer_load_dwordx4 v6, s[8:11], s31 offen lds
  s_add_u32 s31, s31, 16384
  s_mov_b32 m0, 44032
  s_nop 0
  buffer_load_dwordx4 v6, s[8:11], s31 offen lds
  s_add_u32 s31, s31, 81920
  s_sleep 6
  s_waitcnt vmcnt(4)
  s_mov_b32 m0, 45056
  s_nop 0
  buffer_load_dwordx4 v6, s[8:11], s31 offen lds
  s_add_u32 s31, s31, 16384
  s_mov_b32 m0, 46080
  s_nop 0
  buffer_load_dwordx4 v6, s[8:11], s31 offen lds
  s_add_u32 s31, s31, 16384
  s_mov_b32 m0, 47104
  s_nop 0
  buffer_load_dwordx4 v6, s[8:11], s31 offen lds
  s_add_u32 s31, s31, 16384
  s_mov_b32 m0, 48128
  s_nop 0
  buffer_load_dwordx4 v6, s[8:11], s31 offen lds
  s_add_u32 s31, s31, 81920
  s_sleep 6
  s_waitcnt vmcnt(4)
  s_mov_b32 m0, 49152
  s_nop 0
  buffer_load_dwordx4 v6, s[8:11], s31 offen lds
  s_add_u32 s31, s31, 16384
  s_mov_b32 m0, 50176
  s_nop 0
  buffer_load_dwordx4 v6, s[8:11], s31 offen lds
  s_add_u32 s31, s31, 16384
  s_mov_b32 m0, 51200
  s_nop 0
  buffer_load_dwordx4 v6, s[8:11], s31 offen lds
  s_add_u32 s31, s31, 16384
  s_mov_b32 m0, 52224
  s_nop 0
  buffer_load_dwordx4 v6, s[8:11], s31 offen lds
  s_add_u32 s31, s31, 81920
  s_sleep 6
  s_waitcnt vmcnt(4)
  s_mov_b32 m0, 53248
  s_nop 0
  buffer_load_dwordx4 v6, s[8:11], s31 offen lds
  s_add_u32 s31, s31, 16384
  s_mov_b32 m0, 54272
  s_nop 0
  buffer_load_dwordx4 v6, s[8:11], s31 offen lds
  s_add_u32 s31, s31, 16384
  s_mov_b32 m0, 55296
  s_nop 0
  buffer_load_dwordx4 v6, s[8:11], s31 offen lds
  s_add_u32 s31, s31, 16384
  s_mov_b32 m0, 56320
  s_nop 0
  buffer_load_dwordx4 v6, s[8:11], s31 offen lds
  s_add_u32 s31, s31, 81920
  s_sleep 6
  s_waitcnt vmcnt(4)
  s_mov_b32 m0, 57344
  s_nop 0
  buffer_load_dwordx4 v6, s[8:11], s31 offen lds
  s_add_u32 s31, s31, 16384
  s_mov_b32 m0, 58368
  s_nop 0
  buffer_load_dwordx4 v6, s[8:11], s31 offen lds
  s_add_u32 s31, s31, 16384
  s_mov_b32 m0, 59392
  s_nop 0
  buffer_load_dwordx4 v6, s[8:11], s31 offen lds
  s_add_u32 s31, s31, 16384
  s_mov_b32 m0, 60416
  s_nop 0
  buffer_load_dwordx4 v6, s[8:11], s31 offen lds
  s_add_u32 s31, s31, 81920
  s_sleep 6
  s_waitcnt vmcnt(4)
  s_mov_b32 m0, 61440
  s_nop 0
  buffer_load_dwordx4 v6, s[8:11], s31 offen lds
  s_add_u32 s31, s31, 16384
  s_mov_b32 m0, 62464
  s_nop 0
  buffer_load_dwordx4 v6, s[8:11], s31 offen lds
  s_add_u32 s31, s31, 16384
  s_mov_b32 m0, 63488
  s_nop 0
  buffer_load_dwordx4 v6, s[8:11], s31 offen lds
  s_add_u32 s31, s31, 16384
  s_mov_b32 m0, 64512
  s_nop 0
  buffer_load_dwordx4 v6, s[8:11], s31 offen lds
.g2_kernel_v_4:
  s_cmp_lg_u32 s16, 5
  s_cbranch_scc1 .g2_kernel_v_5
  s_sleep 64
  s_and_b32 s31, s19, 0xffffe000
  s_add_u32 s31, s31, 0
  v_and_b32 v6, 15, v2
  v_lshlrev_b32 v6, 9, v6
  v_lshrrev_b32 v7, 4, v2
  v_lshl_add_u32 v6, v7, 7, v6
  v_lshlrev_b32 v7, 2, v2
  v_add_u32 v7, 157696, v7
  s_mov_b32 m0, 157696
  s_mov_b32 s38, 0
.g2_kernel_pa30:
  buffer_load_dword v6, s[4:7], s31 offen sc1 lds
  s_add_u32 s38, s38, 1
  s_waitcnt vmcnt(0)
  ds_read_b32 v8, v7
  s_waitcnt lgkmcnt(0)
  v_cmp_ge_u32 vcc, s62, v8
  s_cbranch_vccz .g2_kernel_pa30d
  s_mov_b64 exec, vcc
  s_sleep 32
  s_cmp_lt_u32 s38, 131072
  s_cbranch_scc1 .g2_kernel_pa30
.g2_kernel_pa30d:
  s_mov_b64 exec, -1
  v_lshlrev_b32 v6, 7, v2
  s_lshl_b32 s30, s17, 2
  s_and_b32 s31, s18, 3
  s_add_u32 s30, s30, s31
  s_lshl_b32 s30, s30, 16
  s_add_u32 s30, s30, s63
  s_add_u32 s30, s30, 0x800000
  s_sleep 8
  buffer_load_dword v1, v6, s[4:7], s30 offen
  s_add_u32 s30, s30, 8192
  s_sleep 8
  buffer_load_dword v1, v6, s[4:7], s30 offen
  s_add_u32 s30, s30, 8192
  s_sleep 8
  buffer_load_dword v1, v6, s[4:7], s30 offen
  s_add_u32 s30, s30, 8192
  s_sleep 8
  buffer_load_dword v1, v6, s[4:7], s30 offen
  s_add_u32 s30, s30, 8192
  s_lshl_b32 s28, s2, 10
  s_and_b32 s28, s28, 0xe000
  v_lshlrev_b32 v7, 7, v2
  buffer_load_dword v1, v7, s[64:67], s28 offen
  s_and_b32 s31, s19, 0xffffe000
  s_add_u32 s31, s31, 4
  v_and_b32 v7, 15, v2
  v_lshlrev_b32 v7, 9, v7
  v_lshrrev_b32 v9, 4, v2
  v_lshl_add_u32 v7, v9, 7, v7
  s_and_b32 s33, s18, 3
  s_lshl_b32 s33, s33, 6
  s_add_u32 s33, s33, 157952
  v_lshl_add_u32 v9, v9, 2, s33
  v_lshlrev_b32 v10, 2, v2
  v_add_u32 v10, 157952, v10
  v_mov_b32 v11, 155968
  s_lshl_b32 s33, s62, 1
  s_add_u32 s33, s33, 1
  s_mov_b32 m0, 157952
  s_mov_b64 s[8:9], -1
  s_mov_b64 s[10:11], -1
  s_mov_b64 s[12:13], -1
  s_mov_b64 s[14:15], -1
  s_mov_b64 s[20:21], -1
  s_add_u32 s34, s30, 8192
  s_add_u32 s35, s30, 16384
  s_add_u32 s36, s30, 24576
  s_mov_b32 s38, 0
  s_sleep 8
.g2_kernel_bp31:
  s_mov_b64 exec, s[20:21]
  buffer_load_dword v7, s[4:7], s31 offen sc1 lds
  s_mov_b64 exec, -1
  s_add_u32 s38, s38, 1
  s_waitcnt vmcnt(0)
  ds_read_b32 v12, v10
  ds_read_b32 v13, v9
  ds_read_b32 v14, v9 offset:16
  ds_read_b32 v15, v9 offset:32
  ds_read_b32 v16, v9 offset:48
  s_waitcnt lgkmcnt(0)
  v_cmp_ge_u32 s[20:21], s62, v12
  v_cmp_lt_u32 vcc, s62, v13
  s_and_b64 exec, vcc, s[8:9]
  s_cbranch_scc0 .g2_kernel_bp31n0
  s_andn2_b64 s[8:9], s[8:9], vcc
  buffer_load_dword v1, v6, s[4:7], s30 offen
.g2_kernel_bp31n0:
  s_mov_b64 exec, -1
  v_cmp_lt_u32 vcc, s62, v14
  s_and_b64 exec, vcc, s[10:11]
  s_cbranch_scc0 .g2_kernel_bp31n1
  s_andn2_b64 s[10:11], s[10:11], vcc
  buffer_load_dword v1, v6, s[4:7], s34 offen
.g2_kernel_bp31n1:
  s_mov_b64 exec, -1
  v_cmp_lt_u32 vcc, s62, v15
  s_and_b64 exec, vcc, s[12:13]
  s_cbranch_scc0 .g2_kernel_bp31n2
  s_andn2_b64 s[12:13], s[12:13], vcc
  buffer_load_dword v1, v6, s[4:7], s35 offen
.g2_kernel_bp31n2:
  s_mov_b64 exec, -1
  v_cmp_lt_u32 vcc, s62, v16
  s_and_b64 exec, vcc, s[14:15]
  s_cbranch_scc0 .g2_kernel_bp31n3
  s_andn2_b64 s[14:15], s[14:15], vcc
  buffer_load_dword v1, v6, s[4:7], s36 offen
.g2_kernel_bp31n3:
  s_mov_b64 exec, -1
  s_sleep 10
  ds_read_b32 v12, v11
  s_waitcnt lgkmcnt(0)
  v_cmp_lt_u32 vcc, s33, v12
  s_cbranch_vccnz .g2_kernel_bp31d
  s_cmp_lt_u32 s38, 131072
  s_cbranch_scc1 .g2_kernel_bp31
.g2_kernel_bp31d:
.g2_kernel_v_5:
  s_mov_b32 s29, 1
  s_call_b64 s[68:69], .g2_kernel_v_cmb
  s_and_b32 s33, s16, 3
  s_lshl_b32 s33, s33, 7
  s_lshl_b32 s28, s29, 2
  s_add_u32 s33, s33, s28
  s_add_u32 s31, s19, s33
  v_mov_b32 v6, s70
  s_mov_b64 exec, 1
  buffer_store_dword v6, v4, s[4:7], s31 offen offset:0 sc1
  s_mov_b64 exec, -1
  s_cmp_lg_u32 s16, 4
  s_cbranch_scc1 .g2_kernel_v_8
  s_waitcnt vmcnt(3)
  v_mov_b32 v6, s71
  s_mov_b32 s38, 0
.g2_kernel_wg32:
  ds_read_b32 v7, v6 offset:76
  s_add_u32 s38, s38, 1
  s_waitcnt lgkmcnt(0)
  v_cmp_le_u32 vcc, 1, v7
  s_cbranch_vccnz .g2_kernel_wg32d
  s_sleep 1
  s_cmp_lt_u32 s38, 524288
  s_cbranch_scc1 .g2_kernel_wg32
.g2_kernel_wg32d:
  v_mov_b32 v6, s71
  s_mov_b32 s38, 0
.g2_kernel_wg33:
  ds_read_b32 v7, v6 offset:72
  s_add_u32 s38, s38, 1
  s_waitcnt lgkmcnt(0)
  v_cmp_le_u32 vcc, 1, v7
  s_cbranch_vccnz .g2_kernel_wg33d
  s_sleep 1
  s_cmp_lt_u32 s38, 524288
  s_cbranch_scc1 .g2_kernel_wg33
.g2_kernel_wg33d:
  v_mov_b32 v6, s71
  s_mov_b32 s38, 0
.g2_kernel_wg34:
  ds_read_b32 v7, v6 offset:68
  s_add_u32 s38, s38, 1
  s_waitcnt lgkmcnt(0)
  v_cmp_le_u32 vcc, 1, v7
  s_cbranch_vccnz .g2_kernel_wg34d
  s_sleep 1
  s_cmp_lt_u32 s38, 524288
  s_cbranch_scc1 .g2_kernel_wg34
.g2_kernel_wg34d:
  ds_write_b128 v3, v[64:67] offset:16384
  ds_write_b128 v3, v[68:71] offset:17408
  ds_write_b128 v3, v[72:75] offset:18432
  ds_write_b128 v3, v[76:79] offset:19456
  ds_write_b128 v3, v[80:83] offset:20480
  ds_write_b128 v3, v[84:87] offset:21504
  ds_write_b128 v3, v[88:91] offset:22528
  ds_write_b128 v3, v[92:95] offset:23552
  ds_write_b128 v3, v[96:99] offset:24576
  ds_write_b128 v3, v[100:103] offset:25600
  ds_write_b128 v3, v[104:107] offset:26624
  ds_write_b128 v3, v[108:111] offset:27648
  ds_write_b128 v3, v[112:115] offset:28672
  ds_write_b128 v3, v[116:119] offset:29696
  ds_write_b128 v3, v[120:123] offset:30720
  ds_write_b128 v3, v[124:127] offset:31744
  v_mov_b32 v8, 4
  ds_write_b32 v6, v8 offset:12
.g2_kernel_v_8:
  s_cmp_eq_u32 s16, 5
  s_cbranch_scc1 .g2_kernel_c1
  s_cmp_lg_u32 s16, 4
  s_cbranch_scc1 .g2_kernel_c2
  s_cmp_lg_u32 s62, 0
  s_cbranch_scc1 .g2_kernel_fin1
  s_setprio 3
  s_mov_b32 s12, s42
  s_mov_b32 s13, s43
  s_mov_b32 s14, 0x600000
  s_mov_b32 s15, 0x00020000
  v_lshrrev_b32 v28, 3, v2
  v_and_b32 v29, 7, v2
  v_bfe_u32 v30, v2, 4, 1
  v_lshlrev_b32 v30, 1, v30
  v_xor_b32 v31, v29, v30
  v_lshlrev_b32 v31, 4, v31
  v_mul_u32_u24 v28, 6144, v28
  v_add_u32 v28, v28, v31
  v_xor_b32 v29, 64, v28
  v_lshlrev_b32 v9, 8, v2
  v_and_b32 v9, 0x300, v9
  v_add_u32 v9, 156416, v9
  v_add_u32 v48, 0, v28
  v_add_u32 v49, 48128, v29
  v_add_u32 v50, 96256, v28
  v_add_u32 v51, 144384, v29
  v_add_u32 v52, 2048, v28
  v_add_u32 v53, 50176, v29
  v_add_u32 v54, 98304, v28
  v_add_u32 v55, 146432, v29
  v_add_u32 v56, 4096, v28
  v_add_u32 v57, 52224, v29
  v_add_u32 v58, 100352, v28
  v_add_u32 v59, 148480, v29
  v_and_b32 v11, 15, v2
  v_xor_b32 v11, s18, v11
  v_and_b32 v12, 48, v2
  v_add_u32 v11, v11, v12
  v_lshlrev_b32 v11, 2, v11
  v_add_u32 v11, 158208, v11
  s_lshl_b32 s39, s18, 7
  s_lshl_b32 s32, s17, 18
  s_add_u32 s32, s32, 0xc00000
  s_mov_b32 s30, 0
  s_mov_b32 s29, 0
  s_mov_b32 s37, 0
  v_mov_b32 v6, s71
  s_mov_b32 s38, 0
.g2_kernel_wg35:
  ds_read_b32 v7, v6 offset:16
  s_add_u32 s38, s38, 1
  s_waitcnt lgkmcnt(0)
  v_cmp_le_u32 vcc, 4, v7
  s_cbranch_vccnz .g2_kernel_wg35d
  s_sleep 2
  s_cmp_lt_u32 s38, 524288
  s_cbranch_scc1 .g2_kernel_wg35
.g2_kernel_wg35d:
  s_xor_b32 s36, s18, 0
  s_mul_i32 s36, s36, 393216
  s_add_u32 s36, s36, s39
  s_add_u32 m0, s30, 65536
  s_waitcnt vmcnt(63)
  buffer_load_dwordx4 v48, s[12:15], s36 offen offset:0 lds
  buffer_load_dwordx4 v49, s[12:15], s36 offen offset:1024 lds
  buffer_load_dwordx4 v50, s[12:15], s36 offen offset:2048 lds
  buffer_load_dwordx4 v51, s[12:15], s36 offen offset:3072 lds
  s_add_u32 m0, s30, 69632
  s_waitcnt vmcnt(63)
  buffer_load_dwordx4 v52, s[12:15], s36 offen offset:0 lds
  buffer_load_dwordx4 v53, s[12:15], s36 offen offset:1024 lds
  buffer_load_dwordx4 v54, s[12:15], s36 offen offset:2048 lds
  buffer_load_dwordx4 v55, s[12:15], s36 offen offset:3072 lds
  s_add_u32 m0, s30, 73728
  s_waitcnt vmcnt(63)
  buffer_load_dwordx4 v56, s[12:15], s36 offen offset:0 lds
  buffer_load_dwordx4 v57, s[12:15], s36 offen offset:1024 lds
  buffer_load_dwordx4 v58, s[12:15], s36 offen offset:2048 lds
  buffer_load_dwordx4 v59, s[12:15], s36 offen offset:3072 lds
  s_add_u32 s30, s30, 12288
  s_cmp_eq_u32 s30, 86016
  s_cselect_b32 s30, 0, s30
  s_xor_b32 s36, s18, 0
  s_mul_i32 s36, s36, 393216
  s_add_u32 s36, s36, s39
  s_add_u32 s36, s36, 196608
  s_add_u32 m0, s30, 65536
  s_waitcnt vmcnt(63)
  buffer_load_dwordx4 v48, s[12:15], s36 offen offset:0 lds
  buffer_load_dwordx4 v49, s[12:15], s36 offen offset:1024 lds
  buffer_load_dwordx4 v50, s[12:15], s36 offen offset:2048 lds
  buffer_load_dwordx4 v51, s[12:15], s36 offen offset:3072 lds
  s_add_u32 m0, s30, 69632
  s_waitcnt vmcnt(63)
  buffer_load_dwordx4 v52, s[12:15], s36 offen offset:0 lds
  buffer_load_dwordx4 v53, s[12:15], s36 offen offset:1024 lds
  buffer_load_dwordx4 v54, s[12:15], s36 offen offset:2048 lds
  buffer_load_dwordx4 v55, s[12:15], s36 offen offset:3072 lds
  s_add_u32 m0, s30, 73728
  s_waitcnt vmcnt(63)
  buffer_load_dwordx4 v56, s[12:15], s36 offen offset:0 lds
  buffer_load_dwordx4 v57, s[12:15], s36 offen offset:1024 lds
  buffer_load_dwordx4 v58, s[12:15], s36 offen offset:2048 lds
  buffer_load_dwordx4 v59, s[12:15], s36 offen offset:3072 lds
  s_add_u32 s30, s30, 12288
  s_cmp_eq_u32 s30, 86016
  s_cselect_b32 s30, 0, s30
  s_mov_b32 m0, 156160
  s_mov_b32 s35, .g2_kernel_tab-.g2_kernel_pc+136
  buffer_load_dword off, s[64:67], s35 lds
  s_xor_b32 s36, s18, 1
  s_mul_i32 s36, s36, 393216
  s_add_u32 s36, s36, s39
  s_add_u32 m0, s30, 65536
  s_waitcnt vmcnt(63)
  buffer_load_dwordx4 v48, s[12:15], s36 offen offset:0 lds
  buffer_load_dwordx4 v49, s[12:15], s36 offen offset:1024 lds
  buffer_load_dwordx4 v50, s[12:15], s36 offen offset:2048 lds
  buffer_load_dwordx4 v51, s[12:15], s36 offen offset:3072 lds
  s_add_u32 m0, s30, 69632
  s_waitcnt vmcnt(63)
  buffer_load_dwordx4 v52, s[12:15], s36 offen offset:0 lds
  buffer_load_dwordx4 v53, s[12:15], s36 offen offset:1024 lds
  buffer_load_dwordx4 v54, s[12:15], s36 offen offset:2048 lds
  buffer_load_dwordx4 v55, s[12:15], s36 offen offset:3072 lds
  s_add_u32 m0, s30, 73728
  s_waitcnt vmcnt(63)
  buffer_load_dwordx4 v56, s[12:15], s36 offen offset:0 lds
  buffer_load_dwordx4 v57, s[12:15], s36 offen offset:1024 lds
  buffer_load_dwordx4 v58, s[12:15], s36 offen offset:2048 lds
  buffer_load_dwordx4 v59, s[12:15], s36 offen offset:3072 lds
  s_add_u32 s30, s30, 12288
  s_cmp_eq_u32 s30, 86016
  s_cselect_b32 s30, 0, s30
  s_xor_b32 s36, s18, 1
  s_mul_i32 s36, s36, 393216
  s_add_u32 s36, s36, s39
  s_add_u32 s36, s36, 196608
  s_add_u32 m0, s30, 65536
  s_waitcnt vmcnt(63)
  buffer_load_dwordx4 v48, s[12:15], s36 offen offset:0 lds
  buffer_load_dwordx4 v49, s[12:15], s36 offen offset:1024 lds
  buffer_load_dwordx4 v50, s[12:15], s36 offen offset:2048 lds
  buffer_load_dwordx4 v51, s[12:15], s36 offen offset:3072 lds
  s_add_u32 m0, s30, 69632
  s_waitcnt vmcnt(63)
  buffer_load_dwordx4 v52, s[12:15], s36 offen offset:0 lds
  buffer_load_dwordx4 v53, s[12:15], s36 offen offset:1024 lds
  buffer_load_dwordx4 v54, s[12:15], s36 offen offset:2048 lds
  buffer_load_dwordx4 v55, s[12:15], s36 offen offset:3072 lds
  s_add_u32 m0, s30, 73728
  s_waitcnt vmcnt(63)
  buffer_load_dwordx4 v56, s[12:15], s36 offen offset:0 lds
  buffer_load_dwordx4 v57, s[12:15], s36 offen offset:1024 lds
  buffer_load_dwordx4 v58, s[12:15], s36 offen offset:2048 lds
  buffer_load_dwordx4 v59, s[12:15], s36 offen offset:3072 lds
  s_add_u32 s30, s30, 12288
  s_cmp_eq_u32 s30, 86016
  s_cselect_b32 s30, 0, s30
  s_xor_b32 s36, s18, 2
  s_mul_i32 s36, s36, 393216
  s_add_u32 s36, s36, s39
  s_add_u32 m0, s30, 65536
  s_waitcnt vmcnt(63)
  buffer_load_dwordx4 v48, s[12:15], s36 offen offset:0 lds
  buffer_load_dwordx4 v49, s[12:15], s36 offen offset:1024 lds
  buffer_load_dwordx4 v50, s[12:15], s36 offen offset:2048 lds
  buffer_load_dwordx4 v51, s[12:15], s36 offen offset:3072 lds
  s_add_u32 m0, s30, 69632
  s_waitcnt vmcnt(63)
  buffer_load_dwordx4 v52, s[12:15], s36 offen offset:0 lds
  buffer_load_dwordx4 v53, s[12:15], s36 offen offset:1024 lds
  buffer_load_dwordx4 v54, s[12:15], s36 offen offset:2048 lds
  buffer_load_dwordx4 v55, s[12:15], s36 offen offset:3072 lds
  s_add_u32 m0, s30, 73728
  s_waitcnt vmcnt(63)
  buffer_load_dwordx4 v56, s[12:15], s36 offen offset:0 lds
  buffer_load_dwordx4 v57, s[12:15], s36 offen offset:1024 lds
  buffer_load_dwordx4 v58, s[12:15], s36 offen offset:2048 lds
  buffer_load_dwordx4 v59, s[12:15], s36 offen offset:3072 lds
  s_add_u32 s30, s30, 12288
  s_cmp_eq_u32 s30, 86016
  s_cselect_b32 s30, 0, s30
  v_mov_b32 v6, s71
  s_mov_b32 s38, 0
.g2_kernel_wg36:
  ds_read_b32 v7, v6 offset:20
  s_add_u32 s38, s38, 1
  s_waitcnt lgkmcnt(0)
  v_cmp_le_u32 vcc, 4, v7
  s_cbranch_vccnz .g2_kernel_wg36d
  s_sleep 1
  s_cmp_lt_u32 s38, 524288
  s_cbranch_scc1 .g2_kernel_wg36
.g2_kernel_wg36d:
  s_mov_b32 s62, 1
  s_mov_b32 s63, 0x1800000
  s_mov_b32 s70, 2
  s_mov_b32 s71, 155776
  s_xor_b32 s36, s18, 2
  s_mul_i32 s36, s36, 393216
  s_add_u32 s36, s36, s39
  s_add_u32 s36, s36, 196608
  s_add_u32 m0, s30, 65536
  s_waitcnt vmcnt(63)
  buffer_load_dwordx4 v48, s[12:15], s36 offen offset:0 lds
  buffer_load_dwordx4 v49, s[12:15], s36 offen offset:1024 lds
  buffer_load_dwordx4 v50, s[12:15], s36 offen offset:2048 lds
  buffer_load_dwordx4 v51, s[12:15], s36 offen offset:3072 lds
  s_add_u32 m0, s30, 69632
  s_waitcnt vmcnt(63)
  buffer_load_dwordx4 v52, s[12:15], s36 offen offset:0 lds
  buffer_load_dwordx4 v53, s[12:15], s36 offen offset:1024 lds
  buffer_load_dwordx4 v54, s[12:15], s36 offen offset:2048 lds
  buffer_load_dwordx4 v55, s[12:15], s36 offen offset:3072 lds
  s_add_u32 m0, s30, 73728
  s_waitcnt vmcnt(63)
  buffer_load_dwordx4 v56, s[12:15], s36 offen offset:0 lds
  buffer_load_dwordx4 v57, s[12:15], s36 offen offset:1024 lds
  buffer_load_dwordx4 v58, s[12:15], s36 offen offset:2048 lds
  buffer_load_dwordx4 v59, s[12:15], s36 offen offset:3072 lds
  s_add_u32 s30, s30, 12288
  s_cmp_eq_u32 s30, 86016
  s_cselect_b32 s30, 0, s30
  s_xor_b32 s36, s18, 3
  s_mul_i32 s36, s36, 393216
  s_add_u32 s36, s36, s39
  s_add_u32 m0, s30, 65536
  s_waitcnt vmcnt(63)
  buffer_load_dwordx4 v48, s[12:15], s36 offen offset:0 lds
  buffer_load_dwordx4 v49, s[12:15], s36 offen offset:1024 lds
  buffer_load_dwordx4 v50, s[12:15], s36 offen offset:2048 lds
  buffer_load_dwordx4 v51, s[12:15], s36 offen offset:3072 lds
  s_add_u32 m0, s30, 69632
  s_waitcnt vmcnt(63)
  buffer_load_dwordx4 v52, s[12:15], s36 offen offset:0 lds
  buffer_load_dwordx4 v53, s[12:15], s36 offen offset:1024 lds
  buffer_load_dwordx4 v54, s[12:15], s36 offen offset:2048 lds
  buffer_load_dwordx4 v55, s[12:15], s36 offen offset:3072 lds
  s_add_u32 m0, s30, 73728
  s_waitcnt vmcnt(63)
  buffer_load_dwordx4 v56, s[12:15], s36 offen offset:0 lds
  buffer_load_dwordx4 v57, s[12:15], s36 offen offset:1024 lds
  buffer_load_dwordx4 v58, s[12:15], s36 offen offset:2048 lds
  buffer_load_dwordx4 v59, s[12:15], s36 offen offset:3072 lds
  s_add_u32 s30, s30, 12288
  s_cmp_eq_u32 s30, 86016
  s_cselect_b32 s30, 0, s30
  s_mov_b32 s28, 1
  s_mov_b32 s29, 16384
  s_bitcmp1_b32 s37, s28
  s_cbranch_scc0 .g2_kernel_p2_x0w
.g2_kernel_p2_x0b:
  s_xor_b32 s33, s28, s18
  s_lshl_b32 s33, s33, 14
  s_add_u32 s33, s33, s32
  s_add_u32 m0, s29, 0
  s_waitcnt vmcnt(63)
  buffer_load_dwordx4 v3, s[4:7], s33 offen offset:0 lds
  buffer_load_dwordx4 v3, s[4:7], s33 offen offset:1024 lds
  buffer_load_dwordx4 v3, s[4:7], s33 offen offset:2048 lds
  buffer_load_dwordx4 v3, s[4:7], s33 offen offset:3072 lds
  s_add_u32 m0, s29, 4096
  s_waitcnt vmcnt(63)
  s_add_u32 s33, s33, 4096
  buffer_load_dwordx4 v3, s[4:7], s33 offen offset:0 lds
  buffer_load_dwordx4 v3, s[4:7], s33 offen offset:1024 lds
  buffer_load_dwordx4 v3, s[4:7], s33 offen offset:2048 lds
  buffer_load_dwordx4 v3, s[4:7], s33 offen offset:3072 lds
  s_add_u32 m0, s29, 8192
  s_waitcnt vmcnt(63)
  s_add_u32 s33, s33, 4096
  buffer_load_dwordx4 v3, s[4:7], s33 offen offset:0 lds
  buffer_load_dwordx4 v3, s[4:7], s33 offen offset:1024 lds
  buffer_load_dwordx4 v3, s[4:7], s33 offen offset:2048 lds
  buffer_load_dwordx4 v3, s[4:7], s33 offen offset:3072 lds
  s_add_u32 m0, s29, 12288
  s_waitcnt vmcnt(63)
  s_add_u32 s33, s33, 4096
  buffer_load_dwordx4 v3, s[4:7], s33 offen offset:0 lds
  buffer_load_dwordx4 v3, s[4:7], s33 offen offset:1024 lds
  buffer_load_dwordx4 v3, s[4:7], s33 offen offset:2048 lds
  buffer_load_dwordx4 v3, s[4:7], s33 offen offset:3072 lds
  s_mov_b32 m0, 156160
  s_mov_b32 s35, .g2_kernel_tab-.g2_kernel_pc+144
  buffer_load_dword off, s[64:67], s35 lds
  s_mov_b32 s28, 2
  s_mov_b32 s29, 32768
  s_bitcmp1_b32 s37, s28
  s_cbranch_scc0 .g2_kernel_p2_x1w
.g2_kernel_p2_x1b:
  s_xor_b32 s33, s28, s18
  s_lshl_b32 s33, s33, 14
  s_add_u32 s33, s33, s32
  s_add_u32 m0, s29, 0
  s_waitcnt vmcnt(63)
  buffer_load_dwordx4 v3, s[4:7], s33 offen offset:0 lds
  buffer_load_dwordx4 v3, s[4:7], s33 offen offset:1024 lds
  buffer_load_dwordx4 v3, s[4:7], s33 offen offset:2048 lds
  buffer_load_dwordx4 v3, s[4:7], s33 offen offset:3072 lds
  s_add_u32 m0, s29, 4096
  s_waitcnt vmcnt(63)
  s_add_u32 s33, s33, 4096
  buffer_load_dwordx4 v3, s[4:7], s33 offen offset:0 lds
  buffer_load_dwordx4 v3, s[4:7], s33 offen offset:1024 lds
  buffer_load_dwordx4 v3, s[4:7], s33 offen offset:2048 lds
  buffer_load_dwordx4 v3, s[4:7], s33 offen offset:3072 lds
  s_add_u32 m0, s29, 8192
  s_waitcnt vmcnt(63)
  s_add_u32 s33, s33, 4096
  buffer_load_dwordx4 v3, s[4:7], s33 offen offset:0 lds
  buffer_load_dwordx4 v3, s[4:7], s33 offen offset:1024 lds
  buffer_load_dwordx4 v3, s[4:7], s33 offen offset:2048 lds
  buffer_load_dwordx4 v3, s[4:7], s33 offen offset:3072 lds
  s_add_u32 m0, s29, 12288
  s_waitcnt vmcnt(63)
  s_add_u32 s33, s33, 4096
  buffer_load_dwordx4 v3, s[4:7], s33 offen offset:0 lds
  buffer_load_dwordx4 v3, s[4:7], s33 offen offset:1024 lds
  buffer_load_dwordx4 v3, s[4:7], s33 offen offset:2048 lds
  buffer_load_dwordx4 v3, s[4:7], s33 offen offset:3072 lds
  s_mov_b32 m0, 156160
  s_mov_b32 s35, .g2_kernel_tab-.g2_kernel_pc+152
  buffer_load_dword off, s[64:67], s35 lds
  s_mov_b32 s28, 3
  s_mov_b32 s29, 49152
  s_bitcmp1_b32 s37, s28
  s_cbranch_scc0 .g2_kernel_p2_x2w
.g2_kernel_p2_x2b:
  s_xor_b32 s33, s28, s18
  s_lshl_b32 s33, s33, 14
  s_add_u32 s33, s33, s32
  s_add_u32 m0, s29, 0
  s_waitcnt vmcnt(63)
  buffer_load_dwordx4 v3, s[4:7], s33 offen offset:0 lds
  buffer_load_dwordx4 v3, s[4:7], s33 offen offset:1024 lds
  buffer_load_dwordx4 v3, s[4:7], s33 offen offset:2048 lds
  buffer_load_dwordx4 v3, s[4:7], s33 offen offset:3072 lds
  s_add_u32 m0, s29, 4096
  s_waitcnt vmcnt(63)
  s_add_u32 s33, s33, 4096
  buffer_load_dwordx4 v3, s[4:7], s33 offen offset:0 lds
  buffer_load_dwordx4 v3, s[4:7], s33 offen offset:1024 lds
  buffer_load_dwordx4 v3, s[4:7], s33 offen offset:2048 lds
  buffer_load_dwordx4 v3, s[4:7], s33 offen offset:3072 lds
  s_add_u32 m0, s29, 8192
  s_waitcnt vmcnt(63)
  s_add_u32 s33, s33, 4096
  buffer_load_dwordx4 v3, s[4:7], s33 offen offset:0 lds
  buffer_load_dwordx4 v3, s[4:7], s33 offen offset:1024 lds
  buffer_load_dwordx4 v3, s[4:7], s33 offen offset:2048 lds
  buffer_load_dwordx4 v3, s[4:7], s33 offen offset:3072 lds
  s_add_u32 m0, s29, 12288
  s_waitcnt vmcnt(63)
  s_add_u32 s33, s33, 4096
  buffer_load_dwordx4 v3, s[4:7], s33 offen offset:0 lds
  buffer_load_dwordx4 v3, s[4:7], s33 offen offset:1024 lds
  buffer_load_dwordx4 v3, s[4:7], s33 offen offset:2048 lds
  buffer_load_dwordx4 v3, s[4:7], s33 offen offset:3072 lds
  s_mov_b32 m0, 156160
  s_mov_b32 s35, .g2_kernel_tab-.g2_kernel_pc+156
  buffer_load_dword off, s[64:67], s35 lds
  s_xor_b32 s36, s18, 3
  s_mul_i32 s36, s36, 393216
  s_add_u32 s36, s36, s39
  s_add_u32 s36, s36, 196608
  ds_read_b32 v10, v9
  s_mov_b32 s34, 33
  s_mov_b32 s35, .g2_kernel_tab-.g2_kernel_pc+160
  s_branch .g2_kernel_p2_o
  .p2align 6
.g2_kernel_p2_l:
  s_waitcnt lgkmcnt(0)
  v_cmp_gt_i32 vcc, s34, v10
  s_cbranch_vccnz .g2_kernel_p2_aw
.g2_kernel_p2_ai:
  s_add_u32 s29, s29, 16384
  s_and_b32 s29, s29, 0xffff
  s_bitcmp1_b32 s37, s28
  s_cbranch_scc0 .g2_kernel_p2_x3w
.g2_kernel_p2_x3b:
  s_xor_b32 s33, s28, s18
  s_lshl_b32 s33, s33, 14
  s_add_u32 s33, s33, s32
  s_add_u32 m0, s29, 0
  s_waitcnt vmcnt(63)
  buffer_load_dwordx4 v3, s[4:7], s33 offen offset:0 lds
  buffer_load_dwordx4 v3, s[4:7], s33 offen offset:1024 lds
  buffer_load_dwordx4 v3, s[4:7], s33 offen offset:2048 lds
  buffer_load_dwordx4 v3, s[4:7], s33 offen offset:3072 lds
  s_add_u32 m0, s29, 4096
  s_waitcnt vmcnt(63)
  s_add_u32 s33, s33, 4096
  buffer_load_dwordx4 v3, s[4:7], s33 offen offset:0 lds
  buffer_load_dwordx4 v3, s[4:7], s33 offen offset:1024 lds
  buffer_load_dwordx4 v3, s[4:7], s33 offen offset:2048 lds
  buffer_load_dwordx4 v3, s[4:7], s33 offen offset:3072 lds
  s_add_u32 m0, s29, 8192
  s_waitcnt vmcnt(63)
  s_add_u32 s33, s33, 4096
  buffer_load_dwordx4 v3, s[4:7], s33 offen offset:0 lds
  buffer_load_dwordx4 v3, s[4:7], s33 offen offset:1024 lds
  buffer_load_dwordx4 v3, s[4:7], s33 offen offset:2048 lds
  buffer_load_dwordx4 v3, s[4:7], s33 offen offset:3072 lds
  s_add_u32 m0, s29, 12288
  s_waitcnt vmcnt(63)
  s_add_u32 s33, s33, 4096
  buffer_load_dwordx4 v3, s[4:7], s33 offen offset:0 lds
  buffer_load_dwordx4 v3, s[4:7], s33 offen offset:1024 lds
  buffer_load_dwordx4 v3, s[4:7], s33 offen offset:2048 lds
  buffer_load_dwordx4 v3, s[4:7], s33 offen offset:3072 lds
  s_add_u32 m0, s30, 65536
  s_waitcnt vmcnt(63)
  buffer_load_dwordx4 v48, s[12:15], s36 offen offset:0 lds
  buffer_load_dwordx4 v49, s[12:15], s36 offen offset:1024 lds
  buffer_load_dwordx4 v50, s[12:15], s36 offen offset:2048 lds
  buffer_load_dwordx4 v51, s[12:15], s36 offen offset:3072 lds
  s_add_u32 m0, s30, 69632
  s_waitcnt vmcnt(63)
  buffer_load_dwordx4 v52, s[12:15], s36 offen offset:0 lds
  buffer_load_dwordx4 v53, s[12:15], s36 offen offset:1024 lds
  buffer_load_dwordx4 v54, s[12:15], s36 offen offset:2048 lds
  buffer_load_dwordx4 v55, s[12:15], s36 offen offset:3072 lds
  s_add_u32 m0, s30, 73728
  s_waitcnt vmcnt(63)
  buffer_load_dwordx4 v56, s[12:15], s36 offen offset:0 lds
  buffer_load_dwordx4 v57, s[12:15], s36 offen offset:1024 lds
  buffer_load_dwordx4 v58, s[12:15], s36 offen offset:2048 lds
  buffer_load_dwordx4 v59, s[12:15], s36 offen offset:3072 lds
  s_add_u32 s30, s30, 12288
  s_cmp_eq_u32 s30, 86016
  s_cselect_b32 s30, 0, s30
  ds_read_b32 v10, v9
  s_mov_b32 m0, 156160
  s_add_u32 s34, s34, 1
  buffer_load_dword off, s[64:67], s35 lds
  s_add_u32 s35, s35, 4
  s_add_u32 s36, s36, 196608
.g2_kernel_p2_o:
  s_waitcnt lgkmcnt(0)
  v_cmp_gt_i32 vcc, s34, v10
  s_cbranch_vccnz .g2_kernel_p2_bw
.g2_kernel_p2_bi:
  s_add_u32 m0, s30, 65536
  s_waitcnt vmcnt(63)
  buffer_load_dwordx4 v48, s[12:15], s36 offen offset:0 lds
  buffer_load_dwordx4 v49, s[12:15], s36 offen offset:1024 lds
  buffer_load_dwordx4 v50, s[12:15], s36 offen offset:2048 lds
  buffer_load_dwordx4 v51, s[12:15], s36 offen offset:3072 lds
  s_add_u32 m0, s30, 69632
  s_waitcnt vmcnt(63)
  buffer_load_dwordx4 v52, s[12:15], s36 offen offset:0 lds
  buffer_load_dwordx4 v53, s[12:15], s36 offen offset:1024 lds
  buffer_load_dwordx4 v54, s[12:15], s36 offen offset:2048 lds
  buffer_load_dwordx4 v55, s[12:15], s36 offen offset:3072 lds
  s_add_u32 m0, s30, 73728
  s_waitcnt vmcnt(63)
  buffer_load_dwordx4 v56, s[12:15], s36 offen offset:0 lds
  buffer_load_dwordx4 v57, s[12:15], s36 offen offset:1024 lds
  buffer_load_dwordx4 v58, s[12:15], s36 offen offset:2048 lds
  buffer_load_dwordx4 v59, s[12:15], s36 offen offset:3072 lds
  s_add_u32 s30, s30, 12288
  s_cmp_eq_u32 s30, 86016
  s_cselect_b32 s30, 0, s30
  ds_read_b32 v10, v9
  s_mov_b32 m0, 156160
  s_add_u32 s34, s34, 1
  buffer_load_dword off, s[64:67], s35 lds
  s_add_u32 s35, s35, 4
  s_add_u32 s28, s28, 1
  s_xor_b32 s36, s18, s28
  s_mul_i32 s36, s36, 393216
  s_add_u32 s36, s36, s39
  s_cmp_lt_i32 s34, 58
  s_cbranch_scc1 .g2_kernel_p2_l
  s_branch .g2_kernel_v
.g2_kernel_c1:
  v_mov_b32 v6, s71
  s_mov_b32 s38, 0
.g2_kernel_wg37:
  ds_read_b32 v7, v6 offset:76
  s_add_u32 s38, s38, 1
  s_waitcnt lgkmcnt(0)
  v_cmp_le_u32 vcc, 1, v7
  s_cbranch_vccnz .g2_kernel_wg37d
  s_sleep 1
  s_cmp_lt_u32 s38, 524288
  s_cbranch_scc1 .g2_kernel_wg37
.g2_kernel_wg37d:
  s_sleep 4
  s_and_b32 s31, s19, 0xffffe000
  s_add_u32 s31, s31, 4
  v_and_b32 v6, 15, v2
  v_lshlrev_b32 v6, 9, v6
  v_lshrrev_b32 v7, 4, v2
  v_lshl_add_u32 v6, v7, 7, v6
  v_lshlrev_b32 v7, 2, v2
  v_add_u32 v7, 157952, v7
  s_mov_b32 m0, 157952
  s_mov_b32 s38, 0
.g2_kernel_pa38:
  buffer_load_dword v6, s[4:7], s31 offen sc1 lds
  s_add_u32 s38, s38, 1
  s_waitcnt vmcnt(0)
  ds_read_b32 v8, v7
  s_waitcnt lgkmcnt(0)
  v_cmp_ge_u32 vcc, s62, v8
  s_cbranch_vccz .g2_kernel_pa38d
  s_mov_b64 exec, vcc
  s_sleep 4
  s_cmp_lt_u32 s38, 131072
  s_cbranch_scc1 .g2_kernel_pa38
.g2_kernel_pa38d:
  s_mov_b64 exec, -1
  s_setprio 2
  s_mov_b32 s39, 0
  s_lshl_b32 s30, s17, 4
  s_add_u32 s30, s30, s18
  s_lshl_b32 s20, s30, 11
  s_add_u32 s20, s20, s63
  s_add_u32 s20, s20, 0x1000000
  s_lshl_b32 s21, s30, 6
  s_add_u32 s21, s21, s63
  s_add_u32 s21, s21, 0x1080000
  s_lshl_b32 s23, s62, 16
  s_add_u32 s23, s23, 0x3040000
  s_lshl_b32 s22, s30, 5
  s_add_u32 s22, s22, s23
  s_and_b32 s28, s2, 7
  s_lshl_b32 s28, s28, 13
  s_add_u32 s23, s23, s28
  v_mov_b32 v9, 155648
  ds_read_b32 v26, v9 offset:256
  v_lshrrev_b32 v24, 4, v2
  v_lshlrev_b32 v25, 3, v24
  v_lshlrev_b32 v27, 13, v2
  v_and_b32 v31, 15, v2
  v_lshlrev_b32 v31, 7, v31
  v_lshl_add_u32 v31, v24, 4, v31
  v_mov_b32 v28, 0.0009765625
  v_mov_b32 v30, 1e-05
  v_mov_b32 v6, s71
  s_mov_b32 s38, 0
.g2_kernel_wg40:
  ds_read_b32 v7, v6 offset:20
  s_add_u32 s38, s38, 1
  s_waitcnt lgkmcnt(0)
  v_cmp_le_u32 vcc, 4, v7
  s_cbranch_vccnz .g2_kernel_wg40d
  s_sleep 1
  s_cmp_lt_u32 s38, 524288
  s_cbranch_scc1 .g2_kernel_wg40
.g2_kernel_wg40d:
  s_sleep 12
  s_cmp_lg_u32 s62, 0
  s_cbranch_scc1 .g2_kernel_nap41
  s_sleep 24
.g2_kernel_nap41:
  s_mov_b32 s38, 0
.g2_kernel_gx42:
  buffer_load_dwordx4 v[16:19], v31, s[4:7], s20 offen offset:0 sc1
  buffer_load_dwordx4 v[20:23], v31, s[4:7], s20 offen offset:64 sc1
  s_add_u32 s38, s38, 1
  s_waitcnt vmcnt(0)
  v_min3_u32 v6, v16, v19, v20
  v_min_u32 v6, v6, v23
  v_cmp_eq_u32 vcc, 0, v6
  s_cbranch_vccz .g2_kernel_gx42d
  s_mov_b64 exec, vcc
  s_sleep 1
  s_cmp_lg_u32 s62, 0
  s_cbranch_scc1 .g2_kernel_nap43
  s_sleep 23
.g2_kernel_nap43:
  s_cmp_lt_u32 s38, 131072
  s_cbranch_scc1 .g2_kernel_gx42
.g2_kernel_gx42d:
  s_mov_b64 exec, -1
  v_add_f32 v16, v16, v16 row_ror:8 row_mask:0xf bank_mask:0xf
  v_add_f32 v17, v17, v17 row_ror:8 row_mask:0xf bank_mask:0xf
  v_add_f32 v18, v18, v18 row_ror:8 row_mask:0xf bank_mask:0xf
  v_add_f32 v20, v20, v20 row_ror:8 row_mask:0xf bank_mask:0xf
  v_add_f32 v21, v21, v21 row_ror:8 row_mask:0xf bank_mask:0xf
  v_add_f32 v22, v22, v22 row_ror:8 row_mask:0xf bank_mask:0xf
  v_add_f32 v16, v16, v16 row_ror:4 row_mask:0xf bank_mask:0xf
  v_add_f32 v17, v17, v17 row_ror:4 row_mask:0xf bank_mask:0xf
  v_add_f32 v18, v18, v18 row_ror:4 row_mask:0xf bank_mask:0xf
  v_add_f32 v20, v20, v20 row_ror:4 row_mask:0xf bank_mask:0xf
  v_add_f32 v21, v21, v21 row_ror:4 row_mask:0xf bank_mask:0xf
  v_add_f32 v22, v22, v22 row_ror:4 row_mask:0xf bank_mask:0xf
  v_add_f32 v16, v16, v16 row_ror:2 row_mask:0xf bank_mask:0xf
  v_add_f32 v17, v17, v17 row_ror:2 row_mask:0xf bank_mask:0xf
  v_add_f32 v18, v18, v18 row_ror:2 row_mask:0xf bank_mask:0xf
  v_add_f32 v20, v20, v20 row_ror:2 row_mask:0xf bank_mask:0xf
  v_add_f32 v21, v21, v21 row_ror:2 row_mask:0xf bank_mask:0xf
  v_add_f32 v22, v22, v22 row_ror:2 row_mask:0xf bank_mask:0xf
  v_add_f32 v16, v16, v16 row_ror:1 row_mask:0xf bank_mask:0xf
  v_add_f32 v17, v17, v17 row_ror:1 row_mask:0xf bank_mask:0xf
  v_add_f32 v18, v18, v18 row_ror:1 row_mask:0xf bank_mask:0xf
  v_add_f32 v20, v20, v20 row_ror:1 row_mask:0xf bank_mask:0xf
  v_add_f32 v21, v21, v21 row_ror:1 row_mask:0xf bank_mask:0xf
  v_add_f32 v22, v22, v22 row_ror:1 row_mask:0xf bank_mask:0xf
  v_fma_f32 v18, -v16, v26, v18
  v_mul_f32 v16, v28, v16
  v_mul_f32 v19, v16, v16
  v_fma_f32 v17, v17, v28, -v19
  v_max_f32 v17, 0, v17
  v_add_f32 v17, v30, v17
  v_rsq_f32 v19, v17
  v_fma_f32 v22, -v20, v26, v22
  v_mul_f32 v20, v28, v20
  v_mul_f32 v23, v20, v20
  v_fma_f32 v21, v21, v28, -v23
  v_max_f32 v21, 0, v21
  v_add_f32 v21, v30, v21
  v_rsq_f32 v23, v21
  v_mul_f32 v18, v18, v19
  v_mul_f32 v22, v22, v23
  v_and_or_b32 v18, v18, -8, v24
  v_or_b32 v29, 4, v24
  v_and_or_b32 v22, v22, -8, v29
  v_max_f32 v10, v18, v22
  v_mov_b32 v11, 1
  s_nop 0
  v_max_f32 v10, v10, v10 row_bcast:15 row_mask:0xa bank_mask:0xf
  s_nop 1
  v_max_f32 v10, v10, v10 row_bcast:31 row_mask:0xc bank_mask:0xf
  s_nop 0
  v_readlane_b32 s28, v10, 63
  s_nop 1
  v_mov_b32 v10, s28
  s_mov_b64 exec, 0xff
  buffer_store_dwordx2 v[10:11], v27, s[4:7], s22 offen sc1
  s_mov_b32 exec_lo, 0x00010001
  s_mov_b32 exec_hi, 0x00010001
  buffer_store_dwordx2 v[16:17], v25, s[4:7], s21 offen sc1
  buffer_store_dwordx2 v[20:21], v25, s[4:7], s21 offen offset:32 sc1
  s_mov_b64 exec, -1
  s_cmp_lg_u32 s62, 0
  s_cbranch_scc1 .g2_kernel_c_t3
  s_sleep 30
  s_mov_b64 s[8:9], -1
  s_mov_b64 s[10:11], -1
  s_mov_b64 s[12:13], -1
  s_mov_b64 s[14:15], -1
  s_call_b64 s[68:69], .g2_kernel_amax
  s_add_u32 s28, s77, 1
  v_mov_b32 v10, s28
  v_mov_b32 v9, s71
  ds_write_b32 v9, v10 offset:36
  s_lshr_b32 s24, s77, 7
  s_lshl_b32 s24, s24, 18
  s_bfe_u32 s28, s77, 0x30004
  s_lshl_b32 s28, s28, 11
  s_add_u32 s24, s24, s28
  s_and_b32 s28, s77, 15
  s_lshl_b32 s28, s28, 4
  s_add_u32 s24, s24, s28
  s_add_u32 s24, s24, s63
  s_add_u32 s24, s24, 0xc00000
  s_lshl_b32 s28, s17, 14
  s_add_u32 s24, s24, s28
  s_and_b32 s28, s18, 1
  s_lshl_b32 s28, s28, 8
  s_add_u32 s24, s24, s28
  v_lshrrev_b32 v12, 3, v2
  v_lshlrev_b32 v13, 1, v12
  s_waitcnt lgkmcnt(0)
  s_wakeup
  buffer_load_ushort v56, v13, s[4:7], s24 offen offset:0
  buffer_load_ushort v57, v13, s[4:7], s24 offen offset:512
  buffer_load_ushort v58, v13, s[4:7], s24 offen offset:1024
  buffer_load_ushort v59, v13, s[4:7], s24 offen offset:1536
  s_lshl_b32 s25, s77, 3
  s_add_u32 s25, s25, s63
  s_add_u32 s25, s25, 0x1080000
  s_lshl_b32 s21, s17, 10
  s_add_u32 s21, s21, s63
  s_add_u32 s21, s21, 0x1080000
  s_mov_b32 s38, 0
.g2_kernel_gx44:
  buffer_load_dwordx4 v[16:19], v3, s[4:7], s21 offen sc1
  buffer_load_dwordx2 v[20:21], v4, s[4:7], s25 offen sc1
  s_add_u32 s38, s38, 1
  s_waitcnt vmcnt(0)
  v_min3_u32 v6, v17, v19, v21
  v_cmp_eq_u32 vcc, 0, v6
  s_cbranch_vccz .g2_kernel_gx44d
  s_mov_b64 exec, vcc
  s_sleep 1
  s_cmp_lt_u32 s38, 131072
  s_cbranch_scc1 .g2_kernel_gx44
.g2_kernel_gx44d:
  s_mov_b64 exec, -1
  s_lshr_b32 s28, s77, 7
  s_and_b32 s79, s77, 127
  s_add_u32 s79, s79, 1
  s_cmp_eq_u32 s28, s17
  s_cselect_b32 s79, s79, 0
  v_rsq_f32 v22, v17
  v_rsq_f32 v23, v19
  v_rsq_f32 v21, v21
  v_mov_b32 v62, -1.4426950408889634
  v_mul_f32 v62, s27, v62
  v_exp_f32 v62, v62
  v_lshlrev_b32 v14, 3, v2
  v_add_u32 v14, 155648, v14
  v_mov_b32 v15, s79
  v_add_f32 v52, 1.0, v22
  v_mul_f32 v54, v16, v22
  v_sub_f32 v54, 0, v54
  v_add_f32 v53, 1.0, v23
  v_mul_f32 v55, v18, v23
  v_sub_f32 v55, 0, v55
  v_add_f32 v62, 1.0, v62
  v_rcp_f32 v62, v62
  v_add_f32 v60, 1.0, v21
  v_mul_f32 v61, v20, v21
  v_sub_f32 v61, 0, v61
  v_sub_f32 v17, v17, v30
  v_mul_f32 v48, v52, v52
  v_fma_f32 v48, v48, v17, v30
  v_rsq_f32 v48, v48
  s_nop 0
  v_mul_f32 v48, v48, v52
  v_mul_f32 v50, v48, v16
  v_sub_f32 v50, 0, v50
  v_sub_f32 v19, v19, v30
  v_mul_f32 v49, v53, v53
  v_fma_f32 v49, v49, v19, v30
  v_rsq_f32 v49, v49
  s_nop 0
  v_mul_f32 v49, v49, v53
  v_mul_f32 v51, v49, v18
  v_sub_f32 v51, 0, v51
  v_lshlrev_b32 v56, 16, v56
  v_fma_f32 v56, v56, v60, v61
  v_lshlrev_b32 v57, 16, v57
  v_fma_f32 v57, v57, v60, v61
  v_lshlrev_b32 v58, 16, v58
  v_fma_f32 v58, v58, v60, v61
  v_lshlrev_b32 v59, 16, v59
  v_fma_f32 v59, v59, v60, v61
  v_and_b32 v10, 7, v2
  v_lshlrev_b32 v10, 12, v10
  v_lshl_add_u32 v10, v12, 4, v10
  s_lshl_b32 s20, s17, 1
  s_and_b32 s28, s18, 1
  s_add_u32 s20, s20, s28
  s_lshl_b32 s20, s20, 7
  s_add_u32 s20, s20, s63
  s_add_u32 s20, s20, 0x1090000
  s_and_b32 s26, s18, 14
  s_lshl_b32 s26, s26, 4
  s_add_u32 s26, s26, s17
  s_lshl_b32 s26, s26, 1
  s_and_b32 s28, s18, 1
  s_add_u32 s26, s26, s28
  s_lshl_b32 s26, s26, 10
  s_add_u32 s26, s26, s63
  s_add_u32 s26, s26, 0x1190000
  s_add_u32 s25, s26, 32768
  ds_write_b64 v14, v[48:49] offset:2816
  ds_write_b64 v14, v[50:51] offset:3328
  ds_write_b64 v14, v[52:53] offset:3840
  ds_write_b64 v14, v[54:55] offset:4352
  s_lshr_b32 s28, s77, 7
  s_xor_b32 s28, s28, s17
  v_mov_b32 v8, s28
  ds_write_b32 v9, v8 offset:212
  v_mov_b32 v8, 2
  ds_write_b32 v9, v15 offset:152
  ds_write_b32 v9, v8 offset:128
  s_lshl_b32 s28, s2, 10
  s_and_b32 s28, s28, 0xe000
  v_lshlrev_b32 v7, 7, v2
  buffer_load_dword v1, v7, s[64:67], s28 offen
  v_mov_b32 v6, s71
  s_mov_b32 s38, 0
.g2_kernel_wg45:
  ds_read_b32 v7, v6 offset:48
  s_add_u32 s38, s38, 1
  s_waitcnt lgkmcnt(0)
  v_cmp_le_u32 vcc, 2, v7
  s_cbranch_vccnz .g2_kernel_wg45d
  s_sleep 1
  s_cmp_lt_u32 s38, 524288
  s_cbranch_scc1 .g2_kernel_wg45
.g2_kernel_wg45d:
  s_sleep 8
  s_cmp_lg_u32 s62, 0
  s_cbranch_scc1 .g2_kernel_nap46
  s_sleep 22
.g2_kernel_nap46:
  s_mov_b32 s38, 0
.g2_kernel_gx47:
  s_mov_b32 s21, s20
  buffer_load_dwordx4 v[160:163], v10, s[4:7], s21 offen sc1
  s_add_u32 s21, s21, 32768
  buffer_load_dwordx4 v[164:167], v10, s[4:7], s21 offen sc1
  s_add_u32 s21, s21, 32768
  buffer_load_dwordx4 v[168:171], v10, s[4:7], s21 offen sc1
  s_add_u32 s21, s21, 32768
  buffer_load_dwordx4 v[172:175], v10, s[4:7], s21 offen sc1
  s_add_u32 s21, s21, 32768
  buffer_load_dwordx4 v[176:179], v10, s[4:7], s21 offen sc1
  s_add_u32 s21, s21, 32768
  buffer_load_dwordx4 v[180:183], v10, s[4:7], s21 offen sc1
  s_add_u32 s21, s21, 32768
  buffer_load_dwordx4 v[184:187], v10, s[4:7], s21 offen sc1
  s_add_u32 s21, s21, 32768
  buffer_load_dwordx4 v[188:191], v10, s[4:7], s21 offen sc1
  s_add_u32 s21, s21, 32768
  buffer_load_dwordx4 v[192:195], v10, s[4:7], s21 offen sc1
  s_add_u32 s21, s21, 32768
  buffer_load_dwordx4 v[196:199], v10, s[4:7], s21 offen sc1
  s_add_u32 s21, s21, 32768
  buffer_load_dwordx4 v[200:203], v10, s[4:7], s21 offen sc1
  s_add_u32 s21, s21, 32768
  buffer_load_dwordx4 v[204:207], v10, s[4:7], s21 offen sc1
  s_add_u32 s21, s21, 32768
  buffer_load_dwordx4 v[208:211], v10, s[4:7], s21 offen sc1
  s_add_u32 s21, s21, 32768
  buffer_load_dwordx4 v[212:215], v10, s[4:7], s21 offen sc1
  s_add_u32 s21, s21, 32768
  buffer_load_dwordx4 v[216:219], v10, s[4:7], s21 offen sc1
  s_add_u32 s21, s21, 32768
  buffer_load_dwordx4 v[220:223], v10, s[4:7], s21 offen sc1
  s_add_u32 s21, s21, 32768
  buffer_load_dwordx4 v[224:227], v10, s[4:7], s21 offen sc1
  s_add_u32 s21, s21, 32768
  buffer_load_dwordx4 v[228:231], v10, s[4:7], s21 offen sc1
  s_add_u32 s21, s21, 32768
  buffer_load_dwordx4 v[232:235], v10, s[4:7], s21 offen sc1
  s_add_u32 s21, s21, 32768
  buffer_load_dwordx4 v[236:239], v10, s[4:7], s21 offen sc1
  s_add_u32 s21, s21, 32768
  buffer_load_dwordx4 v[240:243], v10, s[4:7], s21 offen sc1
  s_add_u32 s21, s21, 32768
  buffer_load_dwordx4 v[244:247], v10, s[4:7], s21 offen sc1
  s_add_u32 s21, s21, 32768
  buffer_load_dwordx4 v[248:251], v10, s[4:7], s21 offen sc1
  s_add_u32 s21, s21, 32768
  buffer_load_dwordx4 v[252:255], v10, s[4:7], s21 offen sc1
  s_add_u32 s21, s21, 32768
  buffer_load_dwordx4 v[16:19], v10, s[4:7], s21 offen sc1
  s_add_u32 s21, s21, 32768
  buffer_load_dwordx4 v[20:23], v10, s[4:7], s21 offen sc1
  s_add_u32 s21, s21, 32768
  buffer_load_dwordx4 v[24:27], v10, s[4:7], s21 offen sc1
  s_add_u32 s21, s21, 32768
  buffer_load_dwordx4 v[28:31], v10, s[4:7], s21 offen sc1
  s_add_u32 s21, s21, 32768
  s_add_u32 s38, s38, 1
  s_waitcnt vmcnt(0)
  v_min3_u32 v6, v160, v162, v164
  v_min3_u32 v6, v6, v166, v168
  v_min3_u32 v6, v6, v170, v172
  v_min3_u32 v6, v6, v174, v176
  v_min3_u32 v6, v6, v178, v180
  v_min3_u32 v6, v6, v182, v184
  v_min3_u32 v6, v6, v186, v188
  v_min3_u32 v6, v6, v190, v192
  v_min3_u32 v6, v6, v194, v196
  v_min3_u32 v6, v6, v198, v200
  v_min3_u32 v6, v6, v202, v204
  v_min3_u32 v6, v6, v206, v208
  v_min3_u32 v6, v6, v210, v212
  v_min3_u32 v6, v6, v214, v216
  v_min3_u32 v6, v6, v218, v220
  v_min3_u32 v6, v6, v222, v224
  v_min3_u32 v6, v6, v226, v228
  v_min3_u32 v6, v6, v230, v232
  v_min3_u32 v6, v6, v234, v236
  v_min3_u32 v6, v6, v238, v240
  v_min3_u32 v6, v6, v242, v244
  v_min3_u32 v6, v6, v246, v248
  v_min3_u32 v6, v6, v250, v252
  v_min3_u32 v6, v6, v254, v16
  v_min3_u32 v6, v6, v18, v20
  v_min3_u32 v6, v6, v22, v24
  v_min3_u32 v6, v6, v26, v28
  v_min_u32 v6, v6, v30
  v_cmp_eq_u32 vcc, 0, v6
  s_cbranch_vccz .g2_kernel_gx47d
  s_mov_b64 exec, vcc
  s_sleep 1
  s_cmp_lg_u32 s62, 0
  s_cbranch_scc1 .g2_kernel_nap48
  s_sleep 11
.g2_kernel_nap48:
  s_cmp_lt_u32 s38, 131072
  s_cbranch_scc1 .g2_kernel_gx47
.g2_kernel_gx47d:
  s_mov_b64 exec, -1
  v_add_f32 v164, v164, v160
  v_add_f32 v165, v165, v161
  v_add_f32 v166, v166, v162
  v_add_f32 v167, v167, v163
  v_add_f32 v172, v172, v168
  v_add_f32 v173, v173, v169
  v_add_f32 v174, v174, v170
  v_add_f32 v175, v175, v171
  v_add_f32 v180, v180, v176
  v_add_f32 v181, v181, v177
  v_add_f32 v182, v182, v178
  v_add_f32 v183, v183, v179
  v_add_f32 v188, v188, v184
  v_add_f32 v189, v189, v185
  v_add_f32 v190, v190, v186
  v_add_f32 v191, v191, v187
  v_add_f32 v196, v196, v192
  v_add_f32 v197, v197, v193
  v_add_f32 v198, v198, v194
  v_add_f32 v199, v199, v195
  v_add_f32 v204, v204, v200
  v_add_f32 v205, v205, v201
  v_add_f32 v206, v206, v202
  v_add_f32 v207, v207, v203
  v_add_f32 v212, v212, v208
  v_add_f32 v213, v213, v209
  v_add_f32 v214, v214, v210
  v_add_f32 v215, v215, v211
  v_add_f32 v220, v220, v216
  v_add_f32 v221, v221, v217
  v_add_f32 v222, v222, v218
  v_add_f32 v223, v223, v219
  v_add_f32 v228, v228, v224
  v_add_f32 v229, v229, v225
  v_add_f32 v230, v230, v226
  v_add_f32 v231, v231, v227
  v_add_f32 v236, v236, v232
  v_add_f32 v237, v237, v233
  v_add_f32 v238, v238, v234
  v_add_f32 v239, v239, v235
  v_add_f32 v244, v244, v240
  v_add_f32 v245, v245, v241
  v_add_f32 v246, v246, v242
  v_add_f32 v247, v247, v243
  v_add_f32 v252, v252, v248
  v_add_f32 v253, v253, v249
  v_add_f32 v254, v254, v250
  v_add_f32 v255, v255, v251
  v_add_f32 v20, v20, v16
  v_add_f32 v21, v21, v17
  v_add_f32 v22, v22, v18
  v_add_f32 v23, v23, v19
  v_add_f32 v28, v28, v24
  v_add_f32 v29, v29, v25
  v_add_f32 v30, v30, v26
  v_add_f32 v31, v31, v27
  v_add_f32 v172, v172, v164
  v_add_f32 v173, v173, v165
  v_add_f32 v174, v174, v166
  v_add_f32 v175, v175, v167
  v_add_f32 v188, v188, v180
  v_add_f32 v189, v189, v181
  v_add_f32 v190, v190, v182
  v_add_f32 v191, v191, v183
  v_add_f32 v204, v204, v196
  v_add_f32 v205, v205, v197
  v_add_f32 v206, v206, v198
  v_add_f32 v207, v207, v199
  v_add_f32 v220, v220, v212
  v_add_f32 v221, v221, v213
  v_add_f32 v222, v222, v214
  v_add_f32 v223, v223, v215
  v_add_f32 v236, v236, v228
  v_add_f32 v237, v237, v229
  v_add_f32 v238, v238, v230
  v_add_f32 v239, v239, v231
  v_add_f32 v252, v252, v244
  v_add_f32 v253, v253, v245
  v_add_f32 v254, v254, v246
  v_add_f32 v255, v255, v247
  v_add_f32 v28, v28, v20
  v_add_f32 v29, v29, v21
  v_add_f32 v30, v30, v22
  v_add_f32 v31, v31, v23
  v_add_f32 v188, v188, v172
  v_add_f32 v189, v189, v173
  v_add_f32 v190, v190, v174
  v_add_f32 v191, v191, v175
  v_add_f32 v220, v220, v204
  v_add_f32 v221, v221, v205
  v_add_f32 v222, v222, v206
  v_add_f32 v223, v223, v207
  v_add_f32 v252, v252, v236
  v_add_f32 v253, v253, v237
  v_add_f32 v254, v254, v238
  v_add_f32 v255, v255, v239
  v_add_f32 v220, v220, v188
  v_add_f32 v221, v221, v189
  v_add_f32 v222, v222, v190
  v_add_f32 v223, v223, v191
  v_add_f32 v28, v28, v252
  v_add_f32 v29, v29, v253
  v_add_f32 v30, v30, v254
  v_add_f32 v31, v31, v255
  v_add_f32 v28, v28, v220
  v_add_f32 v29, v29, v221
  v_add_f32 v30, v30, v222
  v_add_f32 v31, v31, v223
  v_add_f32 v28, v28, v28 quad_perm:[1,0,3,2] row_mask:0xf bank_mask:0xf
  v_add_f32 v29, v29, v29 quad_perm:[1,0,3,2] row_mask:0xf bank_mask:0xf
  v_add_f32 v30, v30, v30 quad_perm:[1,0,3,2] row_mask:0xf bank_mask:0xf
  v_add_f32 v31, v31, v31 quad_perm:[1,0,3,2] row_mask:0xf bank_mask:0xf
  v_add_f32 v28, v28, v28 quad_perm:[2,3,0,1] row_mask:0xf bank_mask:0xf
  v_add_f32 v29, v29, v29 quad_perm:[2,3,0,1] row_mask:0xf bank_mask:0xf
  v_add_f32 v30, v30, v30 quad_perm:[2,3,0,1] row_mask:0xf bank_mask:0xf
  v_add_f32 v31, v31, v31 quad_perm:[2,3,0,1] row_mask:0xf bank_mask:0xf
  v_add_f32 v28, v28, v28 row_half_mirror row_mask:0xf bank_mask:0xf
  v_add_f32 v29, v29, v29 row_half_mirror row_mask:0xf bank_mask:0xf
  v_add_f32 v30, v30, v30 row_half_mirror row_mask:0xf bank_mask:0xf
  v_add_f32 v31, v31, v31 row_half_mirror row_mask:0xf bank_mask:0xf
  v_mul_f32 v28, v28, v62
  v_mul_f32 v29, v29, v62
  v_mul_f32 v30, v30, v62
  v_mul_f32 v31, v31, v62
  v_cvt_pk_bf16_f32 v16, v28, v29
  v_cvt_pk_bf16_f32 v17, v30, v31
  s_mov_b32 s28, 0x00010001
  s_mov_b32 s29, 0x00010001
  v_mov_b32 v18, v16 row_ror:8 row_mask:0xf bank_mask:0xf
  v_mov_b32 v19, v17 row_ror:8 row_mask:0xf bank_mask:0xf
  v_lshlrev_b32 v28, 16, v16
  v_and_b32 v29, 0xffff0000, v16
  v_lshlrev_b32 v30, 16, v17
  v_and_b32 v31, 0xffff0000, v17
  v_cndmask_b32 v32, 0, v16, s[28:29]
  v_cndmask_b32 v33, 0, v17, s[28:29]
  v_cndmask_b32 v34, 0, v18, s[28:29]
  v_cndmask_b32 v35, 0, v19, s[28:29]
  s_lshl_b64 s[28:29], s[28:29], 1
  s_nop 0
  v_mfma_f32_16x16x32_bf16 v[160:163], v[32:35], v[64:67], 0
  v_mfma_f32_16x16x32_bf16 v[164:167], v[32:35], v[80:83], 0
  v_mfma_f32_16x16x32_bf16 v[168:171], v[32:35], v[96:99], 0
  v_mfma_f32_16x16x32_bf16 v[172:175], v[32:35], v[112:115], 0
  v_mfma_f32_16x16x32_bf16 v[176:179], v[32:35], v[128:131], 0
  v_mfma_f32_16x16x32_bf16 v[180:183], v[32:35], v[144:147], 0
  v_cndmask_b32 v36, 0, v16, s[28:29]
  v_cndmask_b32 v37, 0, v17, s[28:29]
  v_cndmask_b32 v38, 0, v18, s[28:29]
  v_cndmask_b32 v39, 0, v19, s[28:29]
  s_lshl_b64 s[28:29], s[28:29], 1
  s_nop 0
  v_mfma_f32_16x16x32_bf16 v[160:163], v[36:39], v[68:71], v[160:163]
  v_mfma_f32_16x16x32_bf16 v[164:167], v[36:39], v[84:87], v[164:167]
  v_mfma_f32_16x16x32_bf16 v[168:171], v[36:39], v[100:103], v[168:171]
  v_mfma_f32_16x16x32_bf16 v[172:175], v[36:39], v[116:119], v[172:175]
  v_mfma_f32_16x16x32_bf16 v[176:179], v[36:39], v[132:135], v[176:179]
  v_mfma_f32_16x16x32_bf16 v[180:183], v[36:39], v[148:151], v[180:183]
  v_cndmask_b32 v40, 0, v16, s[28:29]
  v_cndmask_b32 v41, 0, v17, s[28:29]
  v_cndmask_b32 v42, 0, v18, s[28:29]
  v_cndmask_b32 v43, 0, v19, s[28:29]
  s_lshl_b64 s[28:29], s[28:29], 1
  s_nop 0
  v_mfma_f32_16x16x32_bf16 v[160:163], v[40:43], v[72:75], v[160:163]
  v_mfma_f32_16x16x32_bf16 v[164:167], v[40:43], v[88:91], v[164:167]
  v_mfma_f32_16x16x32_bf16 v[168:171], v[40:43], v[104:107], v[168:171]
  v_mfma_f32_16x16x32_bf16 v[172:175], v[40:43], v[120:123], v[172:175]
  v_mfma_f32_16x16x32_bf16 v[176:179], v[40:43], v[136:139], v[176:179]
  v_mfma_f32_16x16x32_bf16 v[180:183], v[40:43], v[152:155], v[180:183]
  v_cndmask_b32 v44, 0, v16, s[28:29]
  v_cndmask_b32 v45, 0, v17, s[28:29]
  v_cndmask_b32 v46, 0, v18, s[28:29]
  v_cndmask_b32 v47, 0, v19, s[28:29]
  s_lshl_b64 s[28:29], s[28:29], 1
  s_nop 0
  v_mfma_f32_16x16x32_bf16 v[160:163], v[44:47], v[76:79], v[160:163]
  v_mfma_f32_16x16x32_bf16 v[164:167], v[44:47], v[92:95], v[164:167]
  v_mfma_f32_16x16x32_bf16 v[168:171], v[44:47], v[108:111], v[168:171]
  v_mfma_f32_16x16x32_bf16 v[172:175], v[44:47], v[124:127], v[172:175]
  v_mfma_f32_16x16x32_bf16 v[176:179], v[44:47], v[140:143], v[176:179]
  v_mfma_f32_16x16x32_bf16 v[180:183], v[44:47], v[156:159], v[180:183]
  v_add_f32 v56, v56, v28
  v_add_f32 v57, v57, v29
  v_add_f32 v58, v58, v30
  v_add_f32 v59, v59, v31
  v_add_f32 v20, v56, v57
  v_mul_f32 v22, v56, v56
  v_add_f32 v21, v58, v59
  v_fmac_f32 v22, v57, v57
  v_add_f32 v20, v20, v21
  v_fmac_f32 v22, v58, v58
  v_fmac_f32 v22, v59, v59
  v_or_b32 v28, 1, v28
  v_or_b32 v30, 1, v30
  v_add_f32 v20, v20, v20 row_ror:8 row_mask:0xf bank_mask:0xf
  v_add_f32 v22, v22, v22 row_ror:8 row_mask:0xf bank_mask:0xf
  v_lshlrev_b32 v11, 4, v12
  v_add_f32 v20, v20, v20 row_bcast:15 row_mask:0xa bank_mask:0xf
  v_add_f32 v22, v22, v22 row_bcast:15 row_mask:0xa bank_mask:0xf
  s_mov_b32 exec_lo, 0x01010101
  s_mov_b32 exec_hi, 0x01010101
  buffer_store_dwordx4 v[28:31], v11, s[4:7], s26 offen offset:768 sc1
  buffer_store_dwordx4 v[28:31], v11, s[4:7], s25 offen offset:768 sc1
  s_mov_b64 exec, -1
  v_add_f32 v20, v20, v20 row_bcast:31 row_mask:0xc bank_mask:0xf
  v_add_f32 v22, v22, v22 row_bcast:31 row_mask:0xc bank_mask:0xf
  v_or_b32 v20, 1, v20
  v_or_b32 v22, 1, v22
  s_mov_b32 exec_lo, 0
  s_mov_b32 exec_hi, 0x80000000
  buffer_store_dwordx4 v[20:23], v4, s[4:7], s26 offen offset:896 sc1
  buffer_store_dwordx4 v[20:23], v4, s[4:7], s25 offen offset:896 sc1
  s_mov_b64 exec, 0xffff
  v_or_b32 v160, 1, v160
  v_or_b32 v162, 1, v162
  buffer_store_dwordx4 v[160:163], v3, s[4:7], s26 offen offset:0 sc1
  v_or_b32 v164, 1, v164
  v_or_b32 v166, 1, v166
  buffer_store_dwordx4 v[164:167], v3, s[4:7], s25 offen offset:0 sc1
  v_or_b32 v168, 1, v168
  v_or_b32 v170, 1, v170
  buffer_store_dwordx4 v[168:171], v3, s[4:7], s26 offen offset:256 sc1
  v_or_b32 v172, 1, v172
  v_or_b32 v174, 1, v174
  buffer_store_dwordx4 v[172:175], v3, s[4:7], s25 offen offset:256 sc1
  v_or_b32 v176, 1, v176
  v_or_b32 v178, 1, v178
  buffer_store_dwordx4 v[176:179], v3, s[4:7], s26 offen offset:512 sc1
  v_or_b32 v180, 1, v180
  v_or_b32 v182, 1, v182
  buffer_store_dwordx4 v[180:183], v3, s[4:7], s25 offen offset:512 sc1
  s_mov_b64 exec, -1
  s_cmp_eq_u32 s79, 0
  s_cbranch_scc1 .g2_kernel_c_no
  s_lshl_b32 s20, s18, 15
  s_add_u32 s20, s20, 0x1190000
  s_lshl_b32 s22, s18, 11
  s_add_u32 s22, s22, s20
  v_lshlrev_b32 v16, 10, v2
  s_sleep 16
  s_mov_b32 s38, 0
  s_mov_b32 exec_hi, 0
.g2_kernel_gx49:
  buffer_load_dword v17, v16, s[4:7], s20 offen offset:752 sc1
  s_add_u32 s38, s38, 1
  s_waitcnt vmcnt(0)
  v_min_u32 v6, v17, v17
  v_cmp_eq_u32 vcc, 0, v6
  s_cbranch_vccz .g2_kernel_gx49d
  s_mov_b64 exec, vcc
  s_sleep 6
  s_cmp_lt_u32 s38, 131072
  s_cbranch_scc1 .g2_kernel_gx49
.g2_kernel_gx49d:
  s_mov_b64 exec, -1
  s_mov_b32 s38, 0
  s_bfm_b64 exec, 57, 0
.g2_kernel_gx50:
  s_mov_b32 s21, s20
  buffer_load_dwordx4 v[64:67], v3, s[4:7], s21 offen offset:0 sc1
  buffer_load_dwordx4 v[68:71], v3, s[4:7], s21 offen offset:1024 sc1
  buffer_load_dwordx4 v[72:75], v3, s[4:7], s21 offen offset:2048 sc1
  buffer_load_dwordx4 v[76:79], v3, s[4:7], s21 offen offset:3072 sc1
  s_add_u32 s21, s21, 4096
  buffer_load_dwordx4 v[80:83], v3, s[4:7], s21 offen offset:0 sc1
  buffer_load_dwordx4 v[84:87], v3, s[4:7], s21 offen offset:1024 sc1
  buffer_load_dwordx4 v[88:91], v3, s[4:7], s21 offen offset:2048 sc1
  buffer_load_dwordx4 v[92:95], v3, s[4:7], s21 offen offset:3072 sc1
  s_add_u32 s21, s21, 4096
  buffer_load_dwordx4 v[96:99], v3, s[4:7], s21 offen offset:0 sc1
  buffer_load_dwordx4 v[100:103], v3, s[4:7], s21 offen offset:1024 sc1
  buffer_load_dwordx4 v[104:107], v3, s[4:7], s21 offen offset:2048 sc1
  buffer_load_dwordx4 v[108:111], v3, s[4:7], s21 offen offset:3072 sc1
  s_add_u32 s21, s21, 4096
  buffer_load_dwordx4 v[112:115], v3, s[4:7], s21 offen offset:0 sc1
  buffer_load_dwordx4 v[116:119], v3, s[4:7], s21 offen offset:1024 sc1
  buffer_load_dwordx4 v[120:123], v3, s[4:7], s21 offen offset:2048 sc1
  buffer_load_dwordx4 v[124:127], v3, s[4:7], s21 offen offset:3072 sc1
  s_add_u32 s21, s21, 4096
  buffer_load_dwordx4 v[128:131], v3, s[4:7], s21 offen offset:0 sc1
  buffer_load_dwordx4 v[132:135], v3, s[4:7], s21 offen offset:1024 sc1
  buffer_load_dwordx4 v[136:139], v3, s[4:7], s21 offen offset:2048 sc1
  buffer_load_dwordx4 v[140:143], v3, s[4:7], s21 offen offset:3072 sc1
  s_add_u32 s21, s21, 4096
  buffer_load_dwordx4 v[144:147], v3, s[4:7], s21 offen offset:0 sc1
  buffer_load_dwordx4 v[148:151], v3, s[4:7], s21 offen offset:1024 sc1
  buffer_load_dwordx4 v[152:155], v3, s[4:7], s21 offen offset:2048 sc1
  buffer_load_dwordx4 v[156:159], v3, s[4:7], s21 offen offset:3072 sc1
  s_add_u32 s21, s21, 4096
  buffer_load_dwordx4 v[160:163], v3, s[4:7], s21 offen offset:0 sc1
  buffer_load_dwordx4 v[164:167], v3, s[4:7], s21 offen offset:1024 sc1
  buffer_load_dwordx4 v[168:171], v3, s[4:7], s21 offen offset:2048 sc1
  buffer_load_dwordx4 v[172:175], v3, s[4:7], s21 offen offset:3072 sc1
  s_add_u32 s21, s21, 4096
  buffer_load_dwordx4 v[176:179], v3, s[4:7], s21 offen offset:0 sc1
  buffer_load_dwordx4 v[180:183], v3, s[4:7], s21 offen offset:1024 sc1
  buffer_load_dwordx4 v[184:187], v3, s[4:7], s21 offen offset:2048 sc1
  buffer_load_dwordx4 v[188:191], v3, s[4:7], s21 offen offset:3072 sc1
  s_add_u32 s21, s21, 4096
  buffer_load_dwordx4 v[192:195], v3, s[4:7], s22 offen offset:0 sc1
  buffer_load_dwordx4 v[196:199], v3, s[4:7], s22 offen offset:1024 sc1
  s_add_u32 s38, s38, 1
  s_waitcnt vmcnt(0)
  v_min3_u32 v6, v64, v66, v68
  v_min3_u32 v6, v6, v70, v72
  v_min3_u32 v6, v6, v74, v76
  v_min3_u32 v6, v6, v78, v80
  v_min3_u32 v6, v6, v82, v84
  v_min3_u32 v6, v6, v86, v88
  v_min3_u32 v6, v6, v90, v92
  v_min3_u32 v6, v6, v94, v96
  v_min3_u32 v6, v6, v98, v100
  v_min3_u32 v6, v6, v102, v104
  v_min3_u32 v6, v6, v106, v108
  v_min3_u32 v6, v6, v110, v112
  v_min3_u32 v6, v6, v114, v116
  v_min3_u32 v6, v6, v118, v120
  v_min3_u32 v6, v6, v122, v124
  v_min3_u32 v6, v6, v126, v128
  v_min3_u32 v6, v6, v130, v132
  v_min3_u32 v6, v6, v134, v136
  v_min3_u32 v6, v6, v138, v140
  v_min3_u32 v6, v6, v142, v144
  v_min3_u32 v6, v6, v146, v148
  v_min3_u32 v6, v6, v150, v152
  v_min3_u32 v6, v6, v154, v156
  v_min3_u32 v6, v6, v158, v160
  v_min3_u32 v6, v6, v162, v164
  v_min3_u32 v6, v6, v166, v168
  v_min3_u32 v6, v6, v170, v172
  v_min3_u32 v6, v6, v174, v176
  v_min3_u32 v6, v6, v178, v180
  v_min3_u32 v6, v6, v182, v184
  v_min3_u32 v6, v6, v186, v188
  v_min3_u32 v6, v6, v190, v192
  v_min3_u32 v6, v6, v194, v196
  v_min_u32 v6, v6, v198
  v_cmp_eq_u32 vcc, 0, v6
  s_cbranch_vccz .g2_kernel_gx50d
  s_mov_b64 exec, vcc
  s_sleep 2
  s_cmp_lt_u32 s38, 131072
  s_cbranch_scc1 .g2_kernel_gx50
.g2_kernel_gx50d:
  s_mov_b64 exec, -1
  v_add_f32 v64, v64, v128
  v_add_f32 v65, v65, v129
  v_add_f32 v66, v66, v130
  v_add_f32 v67, v67, v131
  v_add_f32 v68, v68, v132
  v_add_f32 v69, v69, v133
  v_add_f32 v70, v70, v134
  v_add_f32 v71, v71, v135
  v_add_f32 v72, v72, v136
  v_add_f32 v73, v73, v137
  v_add_f32 v74, v74, v138
  v_add_f32 v75, v75, v139
  v_add_f32 v76, v76, v140
  v_add_f32 v77, v77, v141
  v_add_f32 v78, v78, v142
  v_add_f32 v79, v79, v143
  v_add_f32 v80, v80, v144
  v_add_f32 v81, v81, v145
  v_add_f32 v82, v82, v146
  v_add_f32 v83, v83, v147
  v_add_f32 v84, v84, v148
  v_add_f32 v85, v85, v149
  v_add_f32 v86, v86, v150
  v_add_f32 v87, v87, v151
  v_add_f32 v88, v88, v152
  v_add_f32 v89, v89, v153
  v_add_f32 v90, v90, v154
  v_add_f32 v91, v91, v155
  v_add_f32 v92, v92, v156
  v_add_f32 v93, v93, v157
  v_add_f32 v94, v94, v158
  v_add_f32 v95, v95, v159
  v_add_f32 v96, v96, v160
  v_add_f32 v97, v97, v161
  v_add_f32 v98, v98, v162
  v_add_f32 v99, v99, v163
  v_add_f32 v100, v100, v164
  v_add_f32 v101, v101, v165
  v_add_f32 v102, v102, v166
  v_add_f32 v103, v103, v167
  v_add_f32 v104, v104, v168
  v_add_f32 v105, v105, v169
  v_add_f32 v106, v106, v170
  v_add_f32 v107, v107, v171
  v_add_f32 v108, v108, v172
  v_add_f32 v109, v109, v173
  v_add_f32 v110, v110, v174
  v_add_f32 v111, v111, v175
  v_add_f32 v112, v112, v176
  v_add_f32 v113, v113, v177
  v_add_f32 v114, v114, v178
  v_add_f32 v115, v115, v179
  v_add_f32 v116, v116, v180
  v_add_f32 v117, v117, v181
  v_add_f32 v118, v118, v182
  v_add_f32 v119, v119, v183
  v_add_f32 v120, v120, v184
  v_add_f32 v121, v121, v185
  v_add_f32 v122, v122, v186
  v_add_f32 v123, v123, v187
  v_add_f32 v124, v124, v188
  v_add_f32 v125, v125, v189
  v_add_f32 v126, v126, v190
  v_add_f32 v127, v127, v191
  v_add_f32 v64, v64, v96
  v_add_f32 v65, v65, v97
  v_add_f32 v66, v66, v98
  v_add_f32 v67, v67, v99
  v_add_f32 v68, v68, v100
  v_add_f32 v69, v69, v101
  v_add_f32 v70, v70, v102
  v_add_f32 v71, v71, v103
  v_add_f32 v72, v72, v104
  v_add_f32 v73, v73, v105
  v_add_f32 v74, v74, v106
  v_add_f32 v75, v75, v107
  v_add_f32 v76, v76, v108
  v_add_f32 v77, v77, v109
  v_add_f32 v78, v78, v110
  v_add_f32 v79, v79, v111
  v_add_f32 v80, v80, v112
  v_add_f32 v81, v81, v113
  v_add_f32 v82, v82, v114
  v_add_f32 v83, v83, v115
  v_add_f32 v84, v84, v116
  v_add_f32 v85, v85, v117
  v_add_f32 v86, v86, v118
  v_add_f32 v87, v87, v119
  v_add_f32 v88, v88, v120
  v_add_f32 v89, v89, v121
  v_add_f32 v90, v90, v122
  v_add_f32 v91, v91, v123
  v_add_f32 v92, v92, v124
  v_add_f32 v93, v93, v125
  v_add_f32 v94, v94, v126
  v_add_f32 v95, v95, v127
  v_add_f32 v64, v64, v80
  v_add_f32 v65, v65, v81
  v_add_f32 v66, v66, v82
  v_add_f32 v67, v67, v83
  v_add_f32 v68, v68, v84
  v_add_f32 v69, v69, v85
  v_add_f32 v70, v70, v86
  v_add_f32 v71, v71, v87
  v_add_f32 v72, v72, v88
  v_add_f32 v73, v73, v89
  v_add_f32 v74, v74, v90
  v_add_f32 v75, v75, v91
  v_add_f32 v76, v76, v92
  v_add_f32 v77, v77, v93
  v_add_f32 v78, v78, v94
  v_add_f32 v79, v79, v95
  v_add_f32 v64, v64, v72
  v_add_f32 v65, v65, v73
  v_add_f32 v66, v66, v74
  v_add_f32 v67, v67, v75
  v_add_f32 v68, v68, v76
  v_add_f32 v69, v69, v77
  v_add_f32 v70, v70, v78
  v_add_f32 v71, v71, v79
  v_add_f32 v64, v64, v68
  v_add_f32 v65, v65, v69
  v_add_f32 v66, v66, v70
  v_add_f32 v67, v67, v71
  v_mov_b32 v28, 0.0009765625
  v_mov_b32 v30, 1e-05
  v_readlane_b32 s21, v64, 56
  v_readlane_b32 s22, v66, 56
  s_nop 0
  v_mul_f32 v20, s21, v28
  v_fma_f32 v21, s22, v28, v30
  v_fma_f32 v21, -v20, v20, v21
  v_rsq_f32 v21, abs(v21)
  v_sub_f32 v20, v61, v20
  v_mul_f32 v22, v21, v60
  v_mul_f32 v23, v21, v20
  v_and_b32 v10, 15, v2
  v_lshrrev_b32 v11, 4, v2
  v_lshlrev_b32 v16, 2, v10
  v_lshl_add_u32 v16, v11, 8, v16
  v_add_u32 v16, 155648, v16
  s_sub_u32 s20, s79, 1
  s_and_b32 s21, s20, 3
  s_lshl_b32 s21, s21, 2
  s_add_u32 s21, s21, 156160
  v_lshl_add_u32 v17, v10, 4, s21
  v_cmp_eq_u32 vcc, 2, v11
  v_mov_b32 v18, 64
  v_mov_b32 v19, 256
  v_cndmask_b32 v17, v16, v17, vcc
  v_cndmask_b32 v18, v18, v19, vcc
  v_lshrrev_b32 v24, 2, v10
  v_lshlrev_b32 v24, 9, v24
  v_and_b32 v25, 3, v10
  v_lshl_add_u32 v24, v25, 1, v24
  s_and_b32 s21, s20, 31
  s_lshl_b32 s22, s21, 4
  s_lshr_b32 s23, s20, 5
  s_lshl_b32 s24, s23, 11
  s_add_u32 s22, s22, s24
  s_add_u32 s22, s22, 131072
  v_add_u32 v26, s22, v24
  s_and_b32 s22, s21, 7
  s_and_b32 s24, s21, 8
  s_lshl_b32 s24, s24, 1
  s_add_u32 s22, s22, s24
  s_and_b32 s24, s21, 16
  s_lshr_b32 s24, s24, 1
  s_add_u32 s22, s22, s24
  s_lshl_b32 s22, s22, 4
  v_add_u32 v24, s22, v24
  s_bfe_u32 s22, s21, 0x20002
  s_lshl_b32 s22, s22, 9
  s_add_u32 s22, s22, s24
  s_and_b32 s24, s21, 3
  s_lshl_b32 s24, s24, 1
  s_add_u32 s22, s22, s24
  s_add_u32 s22, s22, 2048
  v_lshl_add_u32 v25, v10, 4, s22
  v_cndmask_b32 v24, v24, v25, vcc
  v_cndmask_b32 v19, 8, v19, vcc
  v_add_u32 v25, v24, v19
  s_lshl_b32 s22, s18, 7
  s_lshl_b32 s24, s17, 2
  s_add_u32 s22, s22, s24
  s_add_u32 s22, s22, s23
  s_lshl_b32 s22, s22, 12
  s_add_u32 s22, s22, 0x1800000
  s_add_u32 s23, s22, 262144
  s_lshr_b32 s24, s20, 6
  s_lshl_b32 s24, s24, 8
  s_add_u32 s24, s24, s76
  v_cmp_eq_u32 vcc, 0, v11
  v_mov_b32 v27, 0.25503486164919736
  s_nop 0
  v_cndmask_b32 v27, 1.0, v27, vcc
  v_mul_f32 v21, v21, v27
  v_mul_f32 v22, v22, v27
  v_mul_f32 v23, v23, v27
  s_mov_b32 s62, 1
  s_mov_b32 s63, 0x1800000
  s_mov_b32 s70, 2
  s_mov_b32 s71, 155776
  v_mov_b32 v6, s71
  s_mov_b32 s38, 0
.g2_kernel_wg51:
  ds_read_b32 v7, v6 offset:56
  s_add_u32 s38, s38, 1
  s_waitcnt lgkmcnt(0)
  v_cmp_le_u32 vcc, 2, v7
  s_cbranch_vccnz .g2_kernel_wg51d
  s_sleep 1
  s_cmp_lt_u32 s38, 524288
  s_cbranch_scc1 .g2_kernel_wg51
.g2_kernel_wg51d:
  ds_read_b32 v32, v17 offset:5632
  ds_read_b32 v36, v16 offset:4864
  v_add_u32 v17, v17, v18
  ds_read_b32 v33, v17 offset:5632
  ds_read_b32 v37, v16 offset:4928
  v_add_u32 v17, v17, v18
  ds_read_b32 v34, v17 offset:5632
  ds_read_b32 v38, v16 offset:4992
  v_add_u32 v17, v17, v18
  ds_read_b32 v35, v17 offset:5632
  ds_read_b32 v39, v16 offset:5056
  s_waitcnt lgkmcnt(0)
  v_mul_f32 v32, v32, v22
  v_fmac_f32 v32, v64, v21
  v_fmac_f32 v32, v36, v23
  v_mul_f32 v33, v33, v22
  v_fmac_f32 v33, v65, v21
  v_fmac_f32 v33, v37, v23
  v_mul_f32 v34, v34, v22
  v_fmac_f32 v34, v66, v21
  v_fmac_f32 v34, v38, v23
  v_mul_f32 v35, v35, v22
  v_fmac_f32 v35, v67, v21
  v_fmac_f32 v35, v39, v23
  v_cvt_pk_bf16_f32 v32, v32, v33
  v_cvt_pk_bf16_f32 v34, v34, v35
  v_mov_b32 v9, s71
  v_mov_b32 v8, 2
  s_mov_b32 exec_lo, 0xffff0000
  s_mov_b32 exec_hi, 0xffff
  buffer_store_short v32, v24, s[4:7], s22 offen sc1
  buffer_store_short_d16_hi v32, v25, s[4:7], s22 offen sc1
  buffer_store_short v34, v24, s[4:7], s23 offen sc1
  buffer_store_short_d16_hi v34, v25, s[4:7], s23 offen sc1
  s_mov_b64 exec, 0xffff
  ds_write_b16 v26, v32 offset:8192
  ds_write_b16_d16_hi v26, v32 offset:8200
  ds_write_b16 v26, v34
  ds_write_b16_d16_hi v26, v34 offset:8
  ds_write_b32 v9, v5 offset:60
  s_mov_b32 exec_lo, 0
  s_mov_b32 exec_hi, 0xff0000
  ds_write_b32 v16, v192 offset:6912
  ds_write_b32 v16, v193 offset:6976
  ds_write_b32 v16, v194 offset:7040
  ds_write_b32 v16, v195 offset:7104
  ds_write_b32 v16, v196 offset:6944
  ds_write_b32 v16, v197 offset:7008
  ds_write_b32 v16, v198 offset:7072
  ds_write_b32 v16, v199 offset:7136
  s_mov_b64 exec, 1
  s_waitcnt vmcnt(0)
  buffer_store_dword v8, v4, s[4:7], s24 offen sc1
  buffer_store_dword v8, v4, s[4:7], s24 offen offset:128 sc1
  s_mov_b64 exec, -1
  s_branch .g2_kernel_v
.g2_kernel_c_no:
  s_mov_b32 s62, 1
  s_mov_b32 s63, 0x1800000
  s_mov_b32 s70, 2
  s_mov_b32 s71, 155776
  s_branch .g2_kernel_v
.g2_kernel_c_t3:
  s_lshr_b32 s33, s77, 7
  s_lshl_b32 s28, s33, 4
  s_lshl_b64 s[34:35], 0xffff, s28
  s_lshr_b32 s28, s33, 2
  s_cmp_eq_u32 s28, 0
  s_cselect_b64 s[8:9], s[34:35], 0
  s_cmp_eq_u32 s28, 1
  s_cselect_b64 s[10:11], s[34:35], 0
  s_cmp_eq_u32 s28, 2
  s_cselect_b64 s[12:13], s[34:35], 0
  s_cmp_eq_u32 s28, 3
  s_cselect_b64 s[14:15], s[34:35], 0
  s_lshl_b32 s21, s17, 10
  s_add_u32 s21, s21, 0x2880000
  v_lshlrev_b32 v14, 3, v2
  v_add_u32 v14, 155648, v14
  v_mov_b32 v9, s71
  s_cmp_eq_u32 s33, s17
  s_cbranch_scc0 .g2_kernel_c_u1
  s_sleep 6
  s_call_b64 s[72:73], .g2_kernel_c_ph2
  s_branch .g2_kernel_c_u2
.g2_kernel_c_u1:
  v_mov_b32 v6, s71
  s_mov_b32 s38, 0
.g2_kernel_wg52:
  ds_read_b32 v7, v6 offset:36
  s_add_u32 s38, s38, 1
  s_waitcnt lgkmcnt(0)
  v_cmp_le_u32 vcc, 1, v7
  s_cbranch_vccnz .g2_kernel_wg52d
  s_sleep 1
  s_cmp_lt_u32 s38, 524288
  s_cbranch_scc1 .g2_kernel_wg52
.g2_kernel_wg52d:
  v_readfirstlane_b32 s77, v7
  s_sub_u32 s77, s77, 1
.g2_kernel_c_u2:
  s_mov_b32 s38, 0
.g2_kernel_gx53:
  buffer_load_dwordx4 v[16:19], v3, s[4:7], s21 offen sc1
  s_add_u32 s38, s38, 1
  s_waitcnt vmcnt(0)
  v_min_u32 v6, v17, v19
  v_cmp_eq_u32 vcc, 0, v6
  s_cbranch_vccz .g2_kernel_gx53d
  s_mov_b64 exec, vcc
  s_cmp_lt_u32 s38, 131072
  s_cbranch_scc1 .g2_kernel_gx53
.g2_kernel_gx53d:
  s_mov_b64 exec, -1
  s_lshr_b32 s28, s77, 7
  s_and_b32 s79, s77, 127
  s_add_u32 s79, s79, 1
  s_cmp_eq_u32 s28, s17
  s_cselect_b32 s79, s79, 0
  v_rsq_f32 v22, v17
  v_rsq_f32 v23, v19
  v_mov_b32 v15, s79
  v_add_f32 v52, 1.0, v22
  v_mul_f32 v54, v16, v22
  v_sub_f32 v54, 0, v54
  v_add_f32 v53, 1.0, v23
  v_mul_f32 v55, v18, v23
  v_sub_f32 v55, 0, v55
  ds_write_b64 v14, v[52:53] offset:3840
  ds_write_b64 v14, v[54:55] offset:4352
  ds_write_b32 v9, v15 offset:32
  ds_write_b32 v9, v5 offset:28
  s_cmp_eq_u32 s33, s17
  s_cbranch_scc1 .g2_kernel_fin
  s_sleep 40
  s_mov_b32 s39, 1
  s_call_b64 s[72:73], .g2_kernel_c_ph2
  s_branch .g2_kernel_fin
.g2_kernel_c_ph2:
  s_call_b64 s[68:69], .g2_kernel_amax
  v_mov_b32 v6, s71
  s_mov_b32 s38, 0
.g2_kernel_wg54:
  ds_read_b32 v7, v6 offset:36
  s_add_u32 s38, s38, 1
  s_waitcnt lgkmcnt(0)
  v_cmp_le_u32 vcc, 1, v7
  s_cbranch_vccnz .g2_kernel_wg54d
  s_cmp_lt_u32 s38, 524288
  s_cbranch_scc1 .g2_kernel_wg54
.g2_kernel_wg54d:
  ds_read_b32 v8, v9 offset:96
  v_readfirstlane_b32 s28, v7
  s_sub_u32 s28, s28, 1
  s_add_u32 s29, s77, 2
  s_waitcnt lgkmcnt(0)
  v_cmp_gt_f32 vcc, s27, v8
  s_cmp_lg_u64 vcc, 0
  s_cselect_b32 s77, s77, s28
  s_cselect_b32 s29, s29, 1
  v_mov_b32 v10, s29
  v_mov_b32 v11, s27
  ds_write_b64 v9, v[10:11] offset:88
  s_setpc_b64 s[72:73]
.g2_kernel_c2:
  s_cmp_lg_u32 s62, 0
  s_cbranch_scc1 .g2_kernel_d_a
  s_cmp_lg_u32 s16, 7
  s_cbranch_scc1 .g2_kernel_d_a
  v_mov_b32 v6, s71
  s_mov_b32 s38, 0
.g2_kernel_wg57:
  ds_read_b32 v7, v6 offset:20
  s_add_u32 s38, s38, 1
  s_waitcnt lgkmcnt(0)
  v_cmp_le_u32 vcc, 4, v7
  s_cbranch_vccnz .g2_kernel_wg57d
  s_sleep 2
  s_cmp_lt_u32 s38, 524288
  s_cbranch_scc1 .g2_kernel_wg57
.g2_kernel_wg57d:
  s_sleep 20
  s_and_b32 s31, s19, 0xffffe000
  s_add_u32 s31, s31, 8
  v_and_b32 v6, 15, v2
  v_lshlrev_b32 v6, 9, v6
  v_lshrrev_b32 v7, 4, v2
  v_lshl_add_u32 v6, v7, 7, v6
  v_lshlrev_b32 v7, 2, v2
  v_add_u32 v7, 158208, v7
  s_mov_b32 m0, 158208
  s_mov_b32 s38, 0
.g2_kernel_pa58:
  buffer_load_dword v6, s[4:7], s31 offen sc1 lds
  s_add_u32 s38, s38, 1
  s_waitcnt vmcnt(0)
  ds_read_b32 v8, v7
  s_waitcnt lgkmcnt(0)
  v_cmp_ge_u32 vcc, s62, v8
  s_cbranch_vccz .g2_kernel_pa58d
  s_mov_b64 exec, vcc
  s_sleep 10
  s_cmp_lt_u32 s38, 131072
  s_cbranch_scc1 .g2_kernel_pa58
.g2_kernel_pa58d:
  s_mov_b64 exec, -1
.g2_kernel_d_a:
  s_setprio 2
  s_and_b32 s20, s16, 1
  v_bfe_u32 v8, v2, 1, 3
  v_lshlrev_b32 v8, 14, v8
  v_and_b32 v9, 1, v2
  v_lshl_add_u32 v8, v9, 10, v8
  v_lshrrev_b32 v9, 4, v2
  v_lshl_add_u32 v8, v9, 8, v8
  v_and_b32 v9, 15, v2
  v_lshlrev_b32 v9, 3, v9
  s_lshl_b32 s28, s20, 7
  s_add_u32 s28, s28, 163584
  v_add_u32 v10, s28, v9
  v_xor_b32 v11, 128, v10
  s_lshl_b32 s28, s20, 2
  s_add_u32 s28, s28, s71
  v_mov_b32 v12, s28
  v_xor_b32 v13, 4, v12
  s_lshl_b32 s26, s17, 4
  s_add_u32 s26, s26, s18
  s_lshl_b32 s26, s26, 1
  s_add_u32 s26, s26, s20
  s_lshl_b32 s26, s26, 11
  s_add_u32 s26, s26, s63
  s_add_u32 s26, s26, 0x1090000
  s_mov_b32 s32, 0
  s_mov_b32 s39, 0
  s_lshl_b32 s28, s62, 3
  s_add_u32 s28, s28, s16
  s_cmp_lg_u32 s28, 14
  s_cbranch_scc1 .g2_kernel_d_w
  s_lshr_b32 s33, s77, 7
  s_lshl_b32 s28, s33, 4
  s_lshl_b64 s[34:35], 0xffff, s28
  s_lshr_b32 s28, s33, 2
  s_cmp_eq_u32 s28, 0
  s_cselect_b64 s[8:9], s[34:35], 0
  s_cmp_eq_u32 s28, 1
  s_cselect_b64 s[10:11], s[34:35], 0
  s_cmp_eq_u32 s28, 2
  s_cselect_b64 s[12:13], s[34:35], 0
  s_cmp_eq_u32 s28, 3
  s_cselect_b64 s[14:15], s[34:35], 0
  s_not_b64 s[8:9], s[8:9]
  s_not_b64 s[10:11], s[10:11]
  s_not_b64 s[12:13], s[12:13]
  s_not_b64 s[14:15], s[14:15]
  s_and_b32 s28, s2, 7
  s_lshl_b32 s28, s28, 13
  s_add_u32 s23, s28, 0x3050000
  s_cmp_eq_u32 s33, s17
  s_cbranch_scc1 .g2_kernel_d_v
  v_mov_b32 v6, s71
  s_mov_b32 s38, 0
.g2_kernel_wg59:
  ds_read_b32 v7, v6 offset:20
  s_add_u32 s38, s38, 1
  s_waitcnt lgkmcnt(0)
  v_cmp_le_u32 vcc, 4, v7
  s_cbranch_vccnz .g2_kernel_wg59d
  s_sleep 1
  s_cmp_lt_u32 s38, 524288
  s_cbranch_scc1 .g2_kernel_wg59
.g2_kernel_wg59d:
.g2_kernel_d_v:
  s_sleep 60
  s_call_b64 s[68:69], .g2_kernel_amax
  s_add_u32 s28, s77, 1
  v_mov_b32 v6, s27
  v_mov_b32 v7, s28
  ds_write_b32 v12, v6 offset:96
  ds_write_b32 v12, v7 offset:36
  s_waitcnt lgkmcnt(0)
  s_wakeup
  s_branch .g2_kernel_d_r
.g2_kernel_d_w:
  v_mov_b32 v6, s71
  s_mov_b32 s38, 0
.g2_kernel_wg60:
  ds_read_b32 v7, v6 offset:36
  s_add_u32 s38, s38, 1
  s_waitcnt lgkmcnt(0)
  v_cmp_le_u32 vcc, 1, v7
  s_cbranch_vccnz .g2_kernel_wg60d
  s_sleep 4
  s_cmp_lt_u32 s38, 524288
  s_cbranch_scc1 .g2_kernel_wg60
.g2_kernel_wg60d:
  v_readfirstlane_b32 s77, v7
  s_sub_u32 s77, s77, 1
.g2_kernel_d_r:
  s_and_b32 s77, s77, 2047
  s_lshr_b32 s24, s77, 7
  s_lshl_b32 s24, s24, 18
  s_bfe_u32 s28, s77, 0x30004
  s_lshl_b32 s28, s28, 11
  s_add_u32 s24, s24, s28
  s_and_b32 s28, s77, 15
  s_lshl_b32 s28, s28, 4
  s_add_u32 s24, s24, s28
  s_add_u32 s24, s24, s63
  s_add_u32 s24, s24, 0xc00000
  s_lshl_b32 s28, s17, 14
  s_add_u32 s21, s24, s28
  s_and_b32 s28, s18, 8
  s_lshl_b32 s28, s28, 5
  s_add_u32 s21, s21, s28
  s_and_b32 s28, s18, 7
  s_lshl_b32 s28, s28, 1
  s_add_u32 s21, s21, s28
  s_lshl_b32 s28, s20, 17
  s_add_u32 s24, s24, s28
  buffer_load_dwordx4 v[16:19], v8, s[4:7], s24 offen
  buffer_load_ushort v56, v4, s[4:7], s21 offen
  buffer_load_ushort v57, v4, s[4:7], s21 offen offset:512
  buffer_load_ushort v58, v4, s[4:7], s21 offen offset:1024
  buffer_load_ushort v59, v4, s[4:7], s21 offen offset:1536
  s_lshl_b32 s25, s77, 3
  s_add_u32 s25, s25, s63
  s_add_u32 s25, s25, 0x1080000
  s_mov_b32 s38, 0
.g2_kernel_gx61:
  buffer_load_dwordx2 v[20:21], v4, s[4:7], s25 offen sc1
  s_add_u32 s38, s38, 1
  s_waitcnt vmcnt(0)
  v_min_u32 v6, v21, v21
  v_cmp_eq_u32 vcc, 0, v6
  s_cbranch_vccz .g2_kernel_gx61d
  s_mov_b64 exec, vcc
  s_sleep 1
  s_cmp_lt_u32 s38, 131072
  s_cbranch_scc1 .g2_kernel_gx61
.g2_kernel_gx61d:
  s_mov_b64 exec, -1
  v_rsq_f32 v21, v21
  v_lshlrev_b32 v24, 16, v16
  v_and_b32 v25, 0xffff0000, v16
  v_lshlrev_b32 v26, 16, v17
  v_and_b32 v27, 0xffff0000, v17
  v_lshlrev_b32 v28, 16, v18
  v_and_b32 v29, 0xffff0000, v18
  v_lshlrev_b32 v30, 16, v19
  v_and_b32 v31, 0xffff0000, v19
  v_mul_f32 v20, v20, v21
  v_mov_b32 v60, v20
  v_add_f32 v61, 1.0, v21
  s_cmp_ge_u32 s17, 14
  s_cbranch_scc1 .g2_kernel_d_none
  v_fma_f32 v24, v24, v21, -v20
  v_fma_f32 v25, v25, v21, -v20
  v_fma_f32 v26, v26, v21, -v20
  v_fma_f32 v27, v27, v21, -v20
  v_fma_f32 v28, v28, v21, -v20
  v_fma_f32 v29, v29, v21, -v20
  v_fma_f32 v30, v30, v21, -v20
  v_fma_f32 v31, v31, v21, -v20
  v_cvt_pk_bf16_f32 v16, v24, v25
  v_cvt_pk_bf16_f32 v17, v26, v27
  v_cvt_pk_bf16_f32 v18, v28, v29
  v_cvt_pk_bf16_f32 v19, v30, v31
  v_mov_b32 v24, v16 row_newbcast:0 row_mask:0xf bank_mask:0xf
  v_mov_b32 v25, v17 row_newbcast:0 row_mask:0xf bank_mask:0xf
  v_mov_b32 v26, v18 row_newbcast:0 row_mask:0xf bank_mask:0xf
  v_mov_b32 v27, v19 row_newbcast:0 row_mask:0xf bank_mask:0xf
  v_mov_b32 v28, v16 row_newbcast:1 row_mask:0xf bank_mask:0xf
  v_mov_b32 v29, v17 row_newbcast:1 row_mask:0xf bank_mask:0xf
  v_mov_b32 v30, v18 row_newbcast:1 row_mask:0xf bank_mask:0xf
  v_mov_b32 v31, v19 row_newbcast:1 row_mask:0xf bank_mask:0xf
  v_mfma_f32_16x16x32_bf16 v[32:35], v[24:27], v[64:67], 0
  v_mfma_f32_16x16x32_bf16 v[36:39], v[24:27], v[128:131], 0
  v_mov_b32 v24, v16 row_newbcast:2 row_mask:0xf bank_mask:0xf
  v_mov_b32 v25, v17 row_newbcast:2 row_mask:0xf bank_mask:0xf
  v_mov_b32 v26, v18 row_newbcast:2 row_mask:0xf bank_mask:0xf
  v_mov_b32 v27, v19 row_newbcast:2 row_mask:0xf bank_mask:0xf
  v_mfma_f32_16x16x32_bf16 v[32:35], v[28:31], v[68:71], v[32:35]
  v_mfma_f32_16x16x32_bf16 v[36:39], v[28:31], v[132:135], v[36:39]
  v_mov_b32 v28, v16 row_newbcast:3 row_mask:0xf bank_mask:0xf
  v_mov_b32 v29, v17 row_newbcast:3 row_mask:0xf bank_mask:0xf
  v_mov_b32 v30, v18 row_newbcast:3 row_mask:0xf bank_mask:0xf
  v_mov_b32 v31, v19 row_newbcast:3 row_mask:0xf bank_mask:0xf
  v_mfma_f32_16x16x32_bf16 v[32:35], v[24:27], v[72:75], v[32:35]
  v_mfma_f32_16x16x32_bf16 v[36:39], v[24:27], v[136:139], v[36:39]
  v_mov_b32 v24, v16 row_newbcast:4 row_mask:0xf bank_mask:0xf
  v_mov_b32 v25, v17 row_newbcast:4 row_mask:0xf bank_mask:0xf
  v_mov_b32 v26, v18 row_newbcast:4 row_mask:0xf bank_mask:0xf
  v_mov_b32 v27, v19 row_newbcast:4 row_mask:0xf bank_mask:0xf
  v_mfma_f32_16x16x32_bf16 v[32:35], v[28:31], v[76:79], v[32:35]
  v_mfma_f32_16x16x32_bf16 v[36:39], v[28:31], v[140:143], v[36:39]
  v_mov_b32 v28, v16 row_newbcast:5 row_mask:0xf bank_mask:0xf
  v_mov_b32 v29, v17 row_newbcast:5 row_mask:0xf bank_mask:0xf
  v_mov_b32 v30, v18 row_newbcast:5 row_mask:0xf bank_mask:0xf
  v_mov_b32 v31, v19 row_newbcast:5 row_mask:0xf bank_mask:0xf
  v_mfma_f32_16x16x32_bf16 v[32:35], v[24:27], v[80:83], v[32:35]
  v_mfma_f32_16x16x32_bf16 v[36:39], v[24:27], v[144:147], v[36:39]
  v_mov_b32 v24, v16 row_newbcast:6 row_mask:0xf bank_mask:0xf
  v_mov_b32 v25, v17 row_newbcast:6 row_mask:0xf bank_mask:0xf
  v_mov_b32 v26, v18 row_newbcast:6 row_mask:0xf bank_mask:0xf
  v_mov_b32 v27, v19 row_newbcast:6 row_mask:0xf bank_mask:0xf
  v_mfma_f32_16x16x32_bf16 v[32:35], v[28:31], v[84:87], v[32:35]
  v_mfma_f32_16x16x32_bf16 v[36:39], v[28:31], v[148:151], v[36:39]
  v_mov_b32 v28, v16 row_newbcast:7 row_mask:0xf bank_mask:0xf
  v_mov_b32 v29, v17 row_newbcast:7 row_mask:0xf bank_mask:0xf
  v_mov_b32 v30, v18 row_newbcast:7 row_mask:0xf bank_mask:0xf
  v_mov_b32 v31, v19 row_newbcast:7 row_mask:0xf bank_mask:0xf
  v_mfma_f32_16x16x32_bf16 v[32:35], v[24:27], v[88:91], v[32:35]
  v_mfma_f32_16x16x32_bf16 v[36:39], v[24:27], v[152:155], v[36:39]
  v_mov_b32 v24, v16 row_newbcast:8 row_mask:0xf bank_mask:0xf
  v_mov_b32 v25, v17 row_newbcast:8 row_mask:0xf bank_mask:0xf
  v_mov_b32 v26, v18 row_newbcast:8 row_mask:0xf bank_mask:0xf
  v_mov_b32 v27, v19 row_newbcast:8 row_mask:0xf bank_mask:0xf
  v_mfma_f32_16x16x32_bf16 v[32:35], v[28:31], v[92:95], v[32:35]
  v_mfma_f32_16x16x32_bf16 v[36:39], v[28:31], v[156:159], v[36:39]
  v_mov_b32 v28, v16 row_newbcast:9 row_mask:0xf bank_mask:0xf
  v_mov_b32 v29, v17 row_newbcast:9 row_mask:0xf bank_mask:0xf
  v_mov_b32 v30, v18 row_newbcast:9 row_mask:0xf bank_mask:0xf
  v_mov_b32 v31, v19 row_newbcast:9 row_mask:0xf bank_mask:0xf
  v_mfma_f32_16x16x32_bf16 v[32:35], v[24:27], v[96:99], v[32:35]
  v_mfma_f32_16x16x32_bf16 v[36:39], v[24:27], v[160:163], v[36:39]
  v_mov_b32 v24, v16 row_newbcast:10 row_mask:0xf bank_mask:0xf
  v_mov_b32 v25, v17 row_newbcast:10 row_mask:0xf bank_mask:0xf
  v_mov_b32 v26, v18 row_newbcast:10 row_mask:0xf bank_mask:0xf
  v_mov_b32 v27, v19 row_newbcast:10 row_mask:0xf bank_mask:0xf
  v_mfma_f32_16x16x32_bf16 v[32:35], v[28:31], v[100:103], v[32:35]
  v_mfma_f32_16x16x32_bf16 v[36:39], v[28:31], v[164:167], v[36:39]
  v_mov_b32 v28, v16 row_newbcast:11 row_mask:0xf bank_mask:0xf
  v_mov_b32 v29, v17 row_newbcast:11 row_mask:0xf bank_mask:0xf
  v_mov_b32 v30, v18 row_newbcast:11 row_mask:0xf bank_mask:0xf
  v_mov_b32 v31, v19 row_newbcast:11 row_mask:0xf bank_mask:0xf
  v_mfma_f32_16x16x32_bf16 v[32:35], v[24:27], v[104:107], v[32:35]
  v_mfma_f32_16x16x32_bf16 v[36:39], v[24:27], v[168:171], v[36:39]
  v_mov_b32 v24, v16 row_newbcast:12 row_mask:0xf bank_mask:0xf
  v_mov_b32 v25, v17 row_newbcast:12 row_mask:0xf bank_mask:0xf
  v_mov_b32 v26, v18 row_newbcast:12 row_mask:0xf bank_mask:0xf
  v_mov_b32 v27, v19 row_newbcast:12 row_mask:0xf bank_mask:0xf
  v_mfma_f32_16x16x32_bf16 v[32:35], v[28:31], v[108:111], v[32:35]
  v_mfma_f32_16x16x32_bf16 v[36:39], v[28:31], v[172:175], v[36:39]
  v_mov_b32 v28, v16 row_newbcast:13 row_mask:0xf bank_mask:0xf
  v_mov_b32 v29, v17 row_newbcast:13 row_mask:0xf bank_mask:0xf
  v_mov_b32 v30, v18 row_newbcast:13 row_mask:0xf bank_mask:0xf
  v_mov_b32 v31, v19 row_newbcast:13 row_mask:0xf bank_mask:0xf
  v_mfma_f32_16x16x32_bf16 v[32:35], v[24:27], v[112:115], v[32:35]
  v_mfma_f32_16x16x32_bf16 v[36:39], v[24:27], v[176:179], v[36:39]
  v_mov_b32 v24, v16 row_newbcast:14 row_mask:0xf bank_mask:0xf
  v_mov_b32 v25, v17 row_newbcast:14 row_mask:0xf bank_mask:0xf
  v_mov_b32 v26, v18 row_newbcast:14 row_mask:0xf bank_mask:0xf
  v_mov_b32 v27, v19 row_newbcast:14 row_mask:0xf bank_mask:0xf
  v_mfma_f32_16x16x32_bf16 v[32:35], v[28:31], v[116:119], v[32:35]
  v_mfma_f32_16x16x32_bf16 v[36:39], v[28:31], v[180:183], v[36:39]
  v_mov_b32 v28, v16 row_newbcast:15 row_mask:0xf bank_mask:0xf
  v_mov_b32 v29, v17 row_newbcast:15 row_mask:0xf bank_mask:0xf
  v_mov_b32 v30, v18 row_newbcast:15 row_mask:0xf bank_mask:0xf
  v_mov_b32 v31, v19 row_newbcast:15 row_mask:0xf bank_mask:0xf
  v_mfma_f32_16x16x32_bf16 v[32:35], v[24:27], v[120:123], v[32:35]
  v_mfma_f32_16x16x32_bf16 v[36:39], v[24:27], v[184:187], v[36:39]
  v_mfma_f32_16x16x32_bf16 v[32:35], v[28:31], v[124:127], v[32:35]
  v_mfma_f32_16x16x32_bf16 v[36:39], v[28:31], v[188:191], v[36:39]
  s_mov_b32 s38, 0
  s_add_u32 s28, s32, 1
  v_mov_b32 v14, s28
  s_mov_b32 s28, 0x00010001
  s_mov_b32 s29, 0x00100010
  s_nop 2
  v_mov_b32 v35, v36
  ds_write_b64 v10, v[34:35]
  ds_write_b32 v12, v14 offset:40
.g2_kernel_d_x:
  ds_read_b32 v6, v13 offset:40
  ds_read_b64 v[16:17], v11
  s_add_u32 s38, s38, 1
  s_waitcnt lgkmcnt(0)
  v_cmp_lt_u32 vcc, s32, v6
  s_cbranch_vccnz .g2_kernel_d_xd
  s_cmp_lt_u32 s38, 524288
  s_cbranch_scc1 .g2_kernel_d_x
.g2_kernel_d_xd:
  v_add_f32 v16, v16, v32
  v_add_f32 v17, v17, v36
  v_mul_f32 v18, -1.4426950408889634, v16
  v_exp_f32 v18, v18
  v_mul_f32 v16, v16, v17
  v_add_f32 v18, 1.0, v18
  v_rcp_f32 v18, v18
  s_nop 0
  v_mul_f32 v16, v16, v18
  s_nop 1
  v_mov_b32 v17, v16 quad_perm:[1,0,3,2] row_mask:0xf bank_mask:0xf
  v_cvt_pk_bf16_f32 v16, v16, v17
  s_nop 1
  v_mov_b32 v20, v16 row_newbcast:0 row_mask:0x5 bank_mask:0xf
  v_mov_b32 v21, v16 row_newbcast:2 row_mask:0x5 bank_mask:0xf
  v_mov_b32 v22, v16 row_newbcast:4 row_mask:0x5 bank_mask:0xf
  v_mov_b32 v23, v16 row_newbcast:6 row_mask:0x5 bank_mask:0xf
  v_mov_b32 v20, v16 row_newbcast:8 row_mask:0xa bank_mask:0xf
  v_mov_b32 v21, v16 row_newbcast:10 row_mask:0xa bank_mask:0xf
  v_mov_b32 v22, v16 row_newbcast:12 row_mask:0xa bank_mask:0xf
  v_mov_b32 v23, v16 row_newbcast:14 row_mask:0xa bank_mask:0xf
  v_cndmask_b32 v24, 0, v20, s[28:29]
  v_cndmask_b32 v25, 0, v21, s[28:29]
  v_cndmask_b32 v26, 0, v22, s[28:29]
  v_cndmask_b32 v27, 0, v23, s[28:29]
  s_lshl_b64 s[28:29], s[28:29], 1
  s_nop 0
  v_mfma_f32_16x16x32_bf16 v[40:43], v[24:27], v[192:195], 0
  v_mfma_f32_16x16x32_bf16 v[44:47], v[24:27], v[208:211], 0
  v_mfma_f32_16x16x32_bf16 v[48:51], v[24:27], v[224:227], 0
  v_mfma_f32_16x16x32_bf16 v[52:55], v[24:27], v[240:243], 0
  v_cndmask_b32 v28, 0, v20, s[28:29]
  v_cndmask_b32 v29, 0, v21, s[28:29]
  v_cndmask_b32 v30, 0, v22, s[28:29]
  v_cndmask_b32 v31, 0, v23, s[28:29]
  s_lshl_b64 s[28:29], s[28:29], 1
  s_nop 0
  v_mfma_f32_16x16x32_bf16 v[40:43], v[28:31], v[196:199], v[40:43]
  v_mfma_f32_16x16x32_bf16 v[44:47], v[28:31], v[212:215], v[44:47]
  v_mfma_f32_16x16x32_bf16 v[48:51], v[28:31], v[228:231], v[48:51]
  v_mfma_f32_16x16x32_bf16 v[52:55], v[28:31], v[244:247], v[52:55]
  v_cndmask_b32 v32, 0, v20, s[28:29]
  v_cndmask_b32 v33, 0, v21, s[28:29]
  v_cndmask_b32 v34, 0, v22, s[28:29]
  v_cndmask_b32 v35, 0, v23, s[28:29]
  s_lshl_b64 s[28:29], s[28:29], 1
  s_nop 0
  v_mfma_f32_16x16x32_bf16 v[40:43], v[32:35], v[200:203], v[40:43]
  v_mfma_f32_16x16x32_bf16 v[44:47], v[32:35], v[216:219], v[44:47]
  v_mfma_f32_16x16x32_bf16 v[48:51], v[32:35], v[232:235], v[48:51]
  v_mfma_f32_16x16x32_bf16 v[52:55], v[32:35], v[248:251], v[52:55]
  v_cndmask_b32 v36, 0, v20, s[28:29]
  v_cndmask_b32 v37, 0, v21, s[28:29]
  v_cndmask_b32 v38, 0, v22, s[28:29]
  v_cndmask_b32 v39, 0, v23, s[28:29]
  s_lshl_b64 s[28:29], s[28:29], 1
  s_nop 0
  v_mfma_f32_16x16x32_bf16 v[40:43], v[36:39], v[204:207], v[40:43]
  v_mfma_f32_16x16x32_bf16 v[44:47], v[36:39], v[220:223], v[44:47]
  v_mfma_f32_16x16x32_bf16 v[48:51], v[36:39], v[236:239], v[48:51]
  v_mfma_f32_16x16x32_bf16 v[52:55], v[36:39], v[252:255], v[52:55]
  s_mov_b32 exec_hi, 0
  s_nop 3
  v_or_b32 v40, 1, v40
  v_or_b32 v42, 1, v42
  buffer_store_dwordx4 v[40:43], v3, s[4:7], s26 offen offset:0 sc1
  v_or_b32 v44, 1, v44
  v_or_b32 v46, 1, v46
  buffer_store_dwordx4 v[44:47], v3, s[4:7], s26 offen offset:512 sc1
  v_or_b32 v48, 1, v48
  v_or_b32 v50, 1, v50
  buffer_store_dwordx4 v[48:51], v3, s[4:7], s26 offen offset:1024 sc1
  v_or_b32 v52, 1, v52
  v_or_b32 v54, 1, v54
  buffer_store_dwordx4 v[52:55], v3, s[4:7], s26 offen offset:1536 sc1
  s_mov_b64 exec, -1
  s_branch .g2_kernel_d_e
.g2_kernel_d_none:
  s_sleep 24
.g2_kernel_d_e:
  v_mov_b32 v6, s71
  s_mov_b64 exec, 1
  ds_add_u32 v6, v5 offset:48
  s_mov_b64 exec, -1
  s_cmp_lg_u32 s62, 0
  s_cbranch_scc1 .g2_kernel_d_t
  s_mov_b32 s62, 1
  s_mov_b32 s63, 0x1800000
  s_mov_b32 s70, 2
  s_mov_b32 s71, 155776
  s_branch .g2_kernel_v
.g2_kernel_d_t:
  s_cmp_lg_u32 s20, 0
  s_cbranch_scc1 .g2_kernel_d_t1
  v_mov_b32 v62, -1.4426950408889634
  v_mul_f32 v62, s27, v62
  v_exp_f32 v62, v62
  v_lshlrev_b32 v14, 12, v2
  v_min_u32 v15, 126976, v14
  s_lshl_b32 s21, s17, 4
  s_add_u32 s21, s21, s18
  s_lshl_b32 s21, s21, 4
  s_mul_i32 s22, s32, 0x270000
  s_add_u32 s21, s21, s22
  s_add_u32 s21, s21, 0x2890000
  s_add_u32 s22, s21, 262144
  s_add_u32 s24, s21, 524288
  s_add_u32 s25, s21, 786432
  v_add_f32 v62, 1.0, v62
  v_rcp_f32 v62, v62
  v_lshlrev_b32 v56, 16, v56
  v_fma_f32 v56, v56, v61, -v60
  v_lshlrev_b32 v57, 16, v57
  v_fma_f32 v57, v57, v61, -v60
  v_lshlrev_b32 v58, 16, v58
  v_fma_f32 v58, v58, v61, -v60
  v_lshlrev_b32 v59, 16, v59
  v_fma_f32 v59, v59, v61, -v60
  s_sleep 8
  s_mov_b32 s38, 0
.g2_kernel_gx62:
  buffer_load_dwordx4 v[16:19], v14, s[4:7], s21 offen sc1
  buffer_load_dwordx4 v[20:23], v14, s[4:7], s22 offen sc1
  buffer_load_dwordx4 v[24:27], v14, s[4:7], s24 offen sc1
  buffer_load_dwordx4 v[28:31], v15, s[4:7], s25 offen sc1
  s_add_u32 s38, s38, 1
  s_waitcnt vmcnt(0)
  v_min3_u32 v6, v16, v18, v20
  v_min3_u32 v6, v6, v22, v24
  v_min3_u32 v6, v6, v26, v28
  v_min_u32 v6, v6, v30
  v_cmp_eq_u32 vcc, 0, v6
  s_cbranch_vccz .g2_kernel_gx62d
  s_mov_b64 exec, vcc
  s_cmp_lt_u32 s38, 131072
  s_cbranch_scc1 .g2_kernel_gx62
.g2_kernel_gx62d:
  s_mov_b64 exec, -1
  v_add_f32 v16, v16, v20
  v_add_f32 v17, v17, v21
  v_add_f32 v18, v18, v22
  v_add_f32 v19, v19, v23
  s_mov_b32 exec_hi, 0
  v_add_f32 v24, v24, v28
  v_add_f32 v25, v25, v29
  v_add_f32 v26, v26, v30
  v_add_f32 v27, v27, v31
  s_mov_b64 exec, -1
  v_add_f32 v16, v16, v24
  v_add_f32 v17, v17, v25
  v_add_f32 v18, v18, v26
  v_add_f32 v19, v19, v27
  v_add_f32 v16, v16, v16 row_ror:8 row_mask:0xf bank_mask:0xf
  v_add_f32 v17, v17, v17 row_ror:8 row_mask:0xf bank_mask:0xf
  v_add_f32 v18, v18, v18 row_ror:8 row_mask:0xf bank_mask:0xf
  v_add_f32 v19, v19, v19 row_ror:8 row_mask:0xf bank_mask:0xf
  v_add_f32 v16, v16, v16 row_ror:4 row_mask:0xf bank_mask:0xf
  v_add_f32 v17, v17, v17 row_ror:4 row_mask:0xf bank_mask:0xf
  v_add_f32 v18, v18, v18 row_ror:4 row_mask:0xf bank_mask:0xf
  v_add_f32 v19, v19, v19 row_ror:4 row_mask:0xf bank_mask:0xf
  v_add_f32 v16, v16, v16 row_ror:2 row_mask:0xf bank_mask:0xf
  v_add_f32 v17, v17, v17 row_ror:2 row_mask:0xf bank_mask:0xf
  v_add_f32 v18, v18, v18 row_ror:2 row_mask:0xf bank_mask:0xf
  v_add_f32 v19, v19, v19 row_ror:2 row_mask:0xf bank_mask:0xf
  v_add_f32 v16, v16, v16 row_ror:1 row_mask:0xf bank_mask:0xf
  v_add_f32 v17, v17, v17 row_ror:1 row_mask:0xf bank_mask:0xf
  v_add_f32 v18, v18, v18 row_ror:1 row_mask:0xf bank_mask:0xf
  v_add_f32 v19, v19, v19 row_ror:1 row_mask:0xf bank_mask:0xf
  v_add_f32 v16, v16, v16 row_bcast:15 row_mask:0xa bank_mask:0xf
  v_add_f32 v17, v17, v17 row_bcast:15 row_mask:0xa bank_mask:0xf
  v_add_f32 v18, v18, v18 row_bcast:15 row_mask:0xa bank_mask:0xf
  v_add_f32 v19, v19, v19 row_bcast:15 row_mask:0xa bank_mask:0xf
  v_add_f32 v16, v16, v16 row_bcast:31 row_mask:0xc bank_mask:0xf
  v_add_f32 v17, v17, v17 row_bcast:31 row_mask:0xc bank_mask:0xf
  v_add_f32 v18, v18, v18 row_bcast:31 row_mask:0xc bank_mask:0xf
  v_add_f32 v19, v19, v19 row_bcast:31 row_mask:0xc bank_mask:0xf
  s_lshl_b32 s24, s77, 11
  s_lshl_b32 s25, s17, 7
  s_add_u32 s24, s24, s25
  s_lshl_b32 s25, s18, 1
  s_add_u32 s24, s24, s25
.g2_kernel_d_t1:
  v_mov_b32 v6, s71
  s_mov_b32 s38, 0
.g2_kernel_wg63:
  ds_read_b32 v7, v6 offset:88
  s_add_u32 s38, s38, 1
  s_waitcnt lgkmcnt(0)
  v_cmp_le_u32 vcc, 1, v7
  s_cbranch_vccnz .g2_kernel_wg63d
  s_cmp_lt_u32 s38, 524288
  s_cbranch_scc1 .g2_kernel_wg63
.g2_kernel_wg63d:
  ds_read_b32 v6, v6 offset:92
  v_readfirstlane_b32 s33, v7
  s_cmp_lg_u32 s32, 0
  s_cselect_b32 s33, 1, s33
  s_cmp_lg_u32 s20, 0
  s_cbranch_scc1 .g2_kernel_d_t2
  s_cmp_lg_u32 s33, 1
  s_cbranch_scc1 .g2_kernel_d_t4
  v_fmac_f32 v56, v16, v62
  v_fmac_f32 v57, v17, v62
  v_fmac_f32 v58, v18, v62
  v_fmac_f32 v59, v19, v62
.g2_kernel_d_t4:
  s_mov_b32 s28, s56
  s_mov_b32 s29, s57
  s_mov_b32 s30, 0x400000
  s_mov_b32 s31, 0x00020000
  v_cvt_pk_bf16_f32 v56, v56, v57
  v_cvt_pk_bf16_f32 v58, v58, v59
  s_mov_b32 exec_lo, 0
  s_mov_b32 exec_hi, 0x80000000
  buffer_store_short v56, v4, s[28:31], s24 offen
  buffer_store_short_d16_hi v56, v4, s[28:31], s24 offen offset:32
  buffer_store_short v58, v4, s[28:31], s24 offen offset:64
  buffer_store_short_d16_hi v58, v4, s[28:31], s24 offen offset:96
  s_mov_b64 exec, -1
.g2_kernel_d_t2:
  s_cmp_eq_u32 s33, 1
  s_cbranch_scc1 .g2_kernel_fin
  s_waitcnt vmcnt(0) lgkmcnt(0)
  v_readfirstlane_b32 s27, v6
  s_sub_u32 s77, s33, 2
  s_mov_b32 s32, 1
  s_add_u32 s26, s26, 0x270000
  s_branch .g2_kernel_d_r
.g2_kernel_fin1:
.g2_kernel_fin:
.g2_kernel_end:
  s_endpgm
.g2_kernel_q_i2:
  v_mov_b32 v6, 155648
  s_mov_b32 s38, 0
.g2_kernel_wg1:
  ds_read_b32 v7, v6 offset:20
  s_add_u32 s38, s38, 1
  s_waitcnt lgkmcnt(0)
  v_cmp_le_u32 vcc, 4, v7
  s_cbranch_vccnz .g2_kernel_wg1d
  s_cmp_lt_u32 s38, 524288
  s_cbranch_scc1 .g2_kernel_wg1
.g2_kernel_wg1d:
  s_branch .g2_kernel_q_i3
.g2_kernel_q_spin:
  s_mov_b32 s38, 0
.g2_kernel_q_spinl:
  ds_read_b32 v151, v150
  s_add_u32 s38, s38, 1
  s_waitcnt lgkmcnt(0)
  v_cmp_lt_i32 vcc, s33, v151
  s_cbranch_vccnz .g2_kernel_q_spinr
  s_cmp_lt_u32 s38, 524288
  s_cbranch_scc1 .g2_kernel_q_spinl
.g2_kernel_q_spinr:
  s_setpc_b64 s[68:69]
.g2_kernel_q_wf:
  s_call_b64 s[68:69], .g2_kernel_q_spin
  s_branch .g2_kernel_q_backf
.g2_kernel_q_w7:
  s_call_b64 s[68:69], .g2_kernel_q_spin
  s_branch .g2_kernel_q_back7
.g2_kernel_q_w0:
  s_call_b64 s[68:69], .g2_kernel_q_spin
  s_branch .g2_kernel_q_back0
.g2_kernel_q_w1:
  s_call_b64 s[68:69], .g2_kernel_q_spin
  s_branch .g2_kernel_q_back1
.g2_kernel_q_w2:
  s_call_b64 s[68:69], .g2_kernel_q_spin
  s_branch .g2_kernel_q_back2
.g2_kernel_q_w3:
  s_call_b64 s[68:69], .g2_kernel_q_spin
  s_branch .g2_kernel_q_back3
.g2_kernel_q_w4:
  s_call_b64 s[68:69], .g2_kernel_q_spin
  s_branch .g2_kernel_q_back4
.g2_kernel_q_w5:
  s_call_b64 s[68:69], .g2_kernel_q_spin
  s_branch .g2_kernel_q_back5
.g2_kernel_q_w6:
  s_call_b64 s[68:69], .g2_kernel_q_spin
  s_branch .g2_kernel_q_back6
.g2_kernel_q_cons2:
  s_lshr_b32 s26, s16, 1
  s_lshl_b32 s26, s26, 13
  v_add_u32 v144, s26, v3
  v_add_u32 v145, 1024, v144
  s_branch .g2_kernel_q_cs
.g2_kernel_q_ew:
  s_mov_b32 s38, 0
.g2_kernel_q_ewl:
  ds_read_b32 v62, v13 offset:0
  ds_read_b32 v63, v58
  s_add_u32 s38, s38, 1
  s_waitcnt lgkmcnt(0)
  v_cmp_gt_u32 vcc, 2, v62
  v_cmp_gt_u32 s[14:15], s12, v63
  s_or_b64 vcc, vcc, s[14:15]
  s_cbranch_scc0 .g2_kernel_q_ec
  s_cmp_lt_u32 s38, 524288
  s_cbranch_scc1 .g2_kernel_q_ewl
.g2_kernel_q_ec:
  ds_read_b32 v57, v13 offset:24
  ds_read_b32 v21, v13 offset:84
  ds_read_b128 v[40:43], v52 offset:5120
  ds_read_b128 v[44:47], v52 offset:5184
  ds_read_b32 v24, v50 offset:2816
  ds_read_b32 v25, v50 offset:3328
  ds_read_b32 v26, v50 offset:2880
  ds_read_b32 v27, v50 offset:3392
  ds_read_b32 v28, v50 offset:2944
  ds_read_b32 v29, v50 offset:3456
  ds_read_b32 v30, v50 offset:3008
  ds_read_b32 v31, v50 offset:3520
  ds_read_b128 v[64:67], v51 offset:2816
  ds_read_b128 v[80:83], v51 offset:3328
  ds_read_b128 v[68:71], v51 offset:2880
  ds_read_b128 v[84:87], v51 offset:3392
  ds_read_b128 v[72:75], v51 offset:2944
  ds_read_b128 v[88:91], v51 offset:3456
  ds_read_b128 v[76:79], v51 offset:3008
  ds_read_b128 v[92:95], v51 offset:3520
  ds_read_b32 v48, v53 offset:5376
  ds_read_b32 v49, v53 offset:5440
  ds_read_b128 v[32:35], v52 offset:4864
  ds_read_b128 v[36:39], v52 offset:4928
  s_waitcnt lgkmcnt(0)
  s_branch .g2_kernel_q_eb
.g2_kernel_q_patch:
  v_readfirstlane_b32 s35, v57
  s_sub_u32 s28, s35, 1
  s_lshr_b32 s29, s28, 6
  s_lshr_b32 s30, s16, 1
  s_add_u32 s35, s35, 0x100
  s_cmp_lg_u32 s29, s30
  s_cbranch_scc1 .g2_kernel_q_pback
  s_add_u32 s35, s35, 0x100
  s_mov_b32 s77, 0x40000000
  s_and_b32 s29, s28, 15
  s_mov_b32 s14, 0x00010001
  s_mov_b32 s15, 0x00010001
  s_lshl_b64 s[14:15], s[14:15], s29
  s_and_b32 s29, s28, 12
  s_lshl_b32 s29, s29, 2
  s_lshl_b64 s[30:31], 0xffff, s29
  v_subrev_u32 v96, 155648, v53
  v_lshlrev_b32 v96, 2, v96
  v_add_u32 v96, 155648, v96
  s_bfe_u32 s29, s28, 0x20004
  s_cmp_lg_u32 s29, 0
  s_cbranch_scc1 .g2_kernel_q_pv1
  s_mov_b64 exec, s[14:15]
  ds_write_b128 v52, v[160:163] offset:5632
  ds_write_b128 v52, v[176:179] offset:5696
  ds_write_b128 v52, v[192:195] offset:5888
  ds_write_b128 v52, v[208:211] offset:5952
  s_mov_b64 exec, s[30:31]
  ds_write_b128 v96, v[224:227] offset:6144
  ds_write_b128 v96, v[240:243] offset:6400
  s_mov_b64 exec, -1
  s_waitcnt lgkmcnt(0)
  s_branch .g2_kernel_q_pback
.g2_kernel_q_pv1:
  s_cmp_lg_u32 s29, 1
  s_cbranch_scc1 .g2_kernel_q_pv2
  s_mov_b64 exec, s[14:15]
  ds_write_b128 v52, v[164:167] offset:5632
  ds_write_b128 v52, v[180:183] offset:5696
  ds_write_b128 v52, v[196:199] offset:5888
  ds_write_b128 v52, v[212:215] offset:5952
  s_mov_b64 exec, s[30:31]
  ds_write_b128 v96, v[228:231] offset:6144
  ds_write_b128 v96, v[244:247] offset:6400
  s_mov_b64 exec, -1
  s_waitcnt lgkmcnt(0)
  s_branch .g2_kernel_q_pback
.g2_kernel_q_pv2:
  s_cmp_lg_u32 s29, 2
  s_cbranch_scc1 .g2_kernel_q_pv3
  s_mov_b64 exec, s[14:15]
  ds_write_b128 v52, v[168:171] offset:5632
  ds_write_b128 v52, v[184:187] offset:5696
  ds_write_b128 v52, v[200:203] offset:5888
  ds_write_b128 v52, v[216:219] offset:5952
  s_mov_b64 exec, s[30:31]
  ds_write_b128 v96, v[232:235] offset:6144
  ds_write_b128 v96, v[248:251] offset:6400
  s_mov_b64 exec, -1
  s_waitcnt lgkmcnt(0)
  s_branch .g2_kernel_q_pback
.g2_kernel_q_pv3:
  s_mov_b64 exec, s[14:15]
  ds_write_b128 v52, v[172:175] offset:5632
  ds_write_b128 v52, v[188:191] offset:5696
  ds_write_b128 v52, v[204:207] offset:5888
  ds_write_b128 v52, v[220:223] offset:5952
  s_mov_b64 exec, s[30:31]
  ds_write_b128 v96, v[236:239] offset:6144
  ds_write_b128 v96, v[252:255] offset:6400
  s_mov_b64 exec, -1
  s_waitcnt lgkmcnt(0)
  s_branch .g2_kernel_q_pback
.g2_kernel_q_nk:
  v_pk_mul_f32 v[152:153], v[40:41], v[24:25] op_sel:[0,1] op_sel_hi:[1,1]
  v_pk_mul_f32 v[154:155], v[42:43], v[24:25] op_sel:[0,1] op_sel_hi:[1,1]
  v_pk_mul_f32 v[156:157], v[44:45], v[24:25] op_sel:[0,1] op_sel_hi:[1,1]
  v_pk_mul_f32 v[158:159], v[46:47], v[24:25] op_sel:[0,1] op_sel_hi:[1,1]
  v_pk_fma_f32 v[192:193], v[192:193], v[24:25], v[152:153] op_sel_hi:[1,0,1]
  v_pk_fma_f32 v[194:195], v[194:195], v[24:25], v[154:155] op_sel_hi:[1,0,1]
  v_pk_fma_f32 v[208:209], v[208:209], v[24:25], v[156:157] op_sel_hi:[1,0,1]
  v_pk_fma_f32 v[210:211], v[210:211], v[24:25], v[158:159] op_sel_hi:[1,0,1]
  v_cvt_pk_bf16_f32 v192, v192, v193
  v_cvt_pk_bf16_f32 v193, v194, v195
  v_cvt_pk_bf16_f32 v194, v208, v209
  v_cvt_pk_bf16_f32 v195, v210, v211
  ds_write_b128 v59, v[192:195] offset:0
  v_pk_mul_f32 v[152:153], v[40:41], v[26:27] op_sel:[0,1] op_sel_hi:[1,1]
  v_pk_mul_f32 v[154:155], v[42:43], v[26:27] op_sel:[0,1] op_sel_hi:[1,1]
  v_pk_mul_f32 v[156:157], v[44:45], v[26:27] op_sel:[0,1] op_sel_hi:[1,1]
  v_pk_mul_f32 v[158:159], v[46:47], v[26:27] op_sel:[0,1] op_sel_hi:[1,1]
  v_pk_fma_f32 v[196:197], v[196:197], v[26:27], v[152:153] op_sel_hi:[1,0,1]
  v_pk_fma_f32 v[198:199], v[198:199], v[26:27], v[154:155] op_sel_hi:[1,0,1]
  v_pk_fma_f32 v[212:213], v[212:213], v[26:27], v[156:157] op_sel_hi:[1,0,1]
  v_pk_fma_f32 v[214:215], v[214:215], v[26:27], v[158:159] op_sel_hi:[1,0,1]
  v_cvt_pk_bf16_f32 v196, v196, v197
  v_cvt_pk_bf16_f32 v197, v198, v199
  v_cvt_pk_bf16_f32 v198, v212, v213
  v_cvt_pk_bf16_f32 v199, v214, v215
  ds_write_b128 v59, v[196:199] offset:128
  v_pk_mul_f32 v[152:153], v[40:41], v[28:29] op_sel:[0,1] op_sel_hi:[1,1]
  v_pk_mul_f32 v[154:155], v[42:43], v[28:29] op_sel:[0,1] op_sel_hi:[1,1]
  v_pk_mul_f32 v[156:157], v[44:45], v[28:29] op_sel:[0,1] op_sel_hi:[1,1]
  v_pk_mul_f32 v[158:159], v[46:47], v[28:29] op_sel:[0,1] op_sel_hi:[1,1]
  v_pk_fma_f32 v[200:201], v[200:201], v[28:29], v[152:153] op_sel_hi:[1,0,1]
  v_pk_fma_f32 v[202:203], v[202:203], v[28:29], v[154:155] op_sel_hi:[1,0,1]
  v_pk_fma_f32 v[216:217], v[216:217], v[28:29], v[156:157] op_sel_hi:[1,0,1]
  v_pk_fma_f32 v[218:219], v[218:219], v[28:29], v[158:159] op_sel_hi:[1,0,1]
  v_cvt_pk_bf16_f32 v200, v200, v201
  v_cvt_pk_bf16_f32 v201, v202, v203
  v_cvt_pk_bf16_f32 v202, v216, v217
  v_cvt_pk_bf16_f32 v203, v218, v219
  ds_write_b128 v59, v[200:203] offset:4096
  v_pk_mul_f32 v[152:153], v[40:41], v[30:31] op_sel:[0,1] op_sel_hi:[1,1]
  v_pk_mul_f32 v[154:155], v[42:43], v[30:31] op_sel:[0,1] op_sel_hi:[1,1]
  v_pk_mul_f32 v[156:157], v[44:45], v[30:31] op_sel:[0,1] op_sel_hi:[1,1]
  v_pk_mul_f32 v[158:159], v[46:47], v[30:31] op_sel:[0,1] op_sel_hi:[1,1]
  v_pk_fma_f32 v[204:205], v[204:205], v[30:31], v[152:153] op_sel_hi:[1,0,1]
  v_pk_fma_f32 v[206:207], v[206:207], v[30:31], v[154:155] op_sel_hi:[1,0,1]
  v_pk_fma_f32 v[220:221], v[220:221], v[30:31], v[156:157] op_sel_hi:[1,0,1]
  v_pk_fma_f32 v[222:223], v[222:223], v[30:31], v[158:159] op_sel_hi:[1,0,1]
  v_cvt_pk_bf16_f32 v204, v204, v205
  v_cvt_pk_bf16_f32 v205, v206, v207
  v_cvt_pk_bf16_f32 v206, v220, v221
  v_cvt_pk_bf16_f32 v207, v222, v223
  ds_write_b128 v59, v[204:207] offset:4224
  v_pk_mul_f32 v[152:153], v[80:81], v[48:49] op_sel:[0,0] op_sel_hi:[1,0]
  v_pk_mul_f32 v[154:155], v[82:83], v[48:49] op_sel:[0,0] op_sel_hi:[1,0]
  v_pk_mul_f32 v[156:157], v[84:85], v[48:49] op_sel:[0,0] op_sel_hi:[1,0]
  v_pk_mul_f32 v[158:159], v[86:87], v[48:49] op_sel:[0,0] op_sel_hi:[1,0]
  v_pk_fma_f32 v[224:225], v[224:225], v[64:65], v[152:153]
  v_pk_fma_f32 v[226:227], v[226:227], v[66:67], v[154:155]
  v_pk_fma_f32 v[228:229], v[228:229], v[68:69], v[156:157]
  v_pk_fma_f32 v[230:231], v[230:231], v[70:71], v[158:159]
  v_cvt_pk_bf16_f32 v224, v224, v225
  v_cvt_pk_bf16_f32 v225, v226, v227
  v_cvt_pk_bf16_f32 v226, v228, v229
  v_cvt_pk_bf16_f32 v227, v230, v231
  ds_write_b128 v60, v[224:227] offset:2048
  v_pk_mul_f32 v[152:153], v[80:81], v[48:49] op_sel:[0,1] op_sel_hi:[1,1]
  v_pk_mul_f32 v[154:155], v[82:83], v[48:49] op_sel:[0,1] op_sel_hi:[1,1]
  v_pk_mul_f32 v[156:157], v[84:85], v[48:49] op_sel:[0,1] op_sel_hi:[1,1]
  v_pk_mul_f32 v[158:159], v[86:87], v[48:49] op_sel:[0,1] op_sel_hi:[1,1]
  v_pk_fma_f32 v[240:241], v[240:241], v[64:65], v[152:153]
  v_pk_fma_f32 v[242:243], v[242:243], v[66:67], v[154:155]
  v_pk_fma_f32 v[244:245], v[244:245], v[68:69], v[156:157]
  v_pk_fma_f32 v[246:247], v[246:247], v[70:71], v[158:159]
  v_cvt_pk_bf16_f32 v240, v240, v241
  v_cvt_pk_bf16_f32 v241, v242, v243
  v_cvt_pk_bf16_f32 v242, v244, v245
  v_cvt_pk_bf16_f32 v243, v246, v247
  ds_write_b128 v60, v[240:243] offset:2304
  v_pk_mul_f32 v[152:153], v[88:89], v[48:49] op_sel:[0,0] op_sel_hi:[1,0]
  v_pk_mul_f32 v[154:155], v[90:91], v[48:49] op_sel:[0,0] op_sel_hi:[1,0]
  v_pk_mul_f32 v[156:157], v[92:93], v[48:49] op_sel:[0,0] op_sel_hi:[1,0]
  v_pk_mul_f32 v[158:159], v[94:95], v[48:49] op_sel:[0,0] op_sel_hi:[1,0]
  v_pk_fma_f32 v[232:233], v[232:233], v[72:73], v[152:153]
  v_pk_fma_f32 v[234:235], v[234:235], v[74:75], v[154:155]
  v_pk_fma_f32 v[236:237], v[236:237], v[76:77], v[156:157]
  v_pk_fma_f32 v[238:239], v[238:239], v[78:79], v[158:159]
  v_cvt_pk_bf16_f32 v232, v232, v233
  v_cvt_pk_bf16_f32 v233, v234, v235
  v_cvt_pk_bf16_f32 v234, v236, v237
  v_cvt_pk_bf16_f32 v235, v238, v239
  ds_write_b128 v60, v[232:235] offset:6144
  v_pk_mul_f32 v[152:153], v[88:89], v[48:49] op_sel:[0,1] op_sel_hi:[1,1]
  v_pk_mul_f32 v[154:155], v[90:91], v[48:49] op_sel:[0,1] op_sel_hi:[1,1]
  v_pk_mul_f32 v[156:157], v[92:93], v[48:49] op_sel:[0,1] op_sel_hi:[1,1]
  v_pk_mul_f32 v[158:159], v[94:95], v[48:49] op_sel:[0,1] op_sel_hi:[1,1]
  v_pk_fma_f32 v[248:249], v[248:249], v[72:73], v[152:153]
  v_pk_fma_f32 v[250:251], v[250:251], v[74:75], v[154:155]
  v_pk_fma_f32 v[252:253], v[252:253], v[76:77], v[156:157]
  v_pk_fma_f32 v[254:255], v[254:255], v[78:79], v[158:159]
  v_cvt_pk_bf16_f32 v248, v248, v249
  v_cvt_pk_bf16_f32 v249, v250, v251
  v_cvt_pk_bf16_f32 v250, v252, v253
  v_cvt_pk_bf16_f32 v251, v254, v255
  ds_write_b128 v60, v[248:251] offset:6400
  v_pk_mul_f32 v[24:25], v[24:25], v[56:57] op_sel_hi:[1,0]
  v_pk_mul_f32 v[26:27], v[26:27], v[56:57] op_sel_hi:[1,0]
  v_pk_mul_f32 v[28:29], v[28:29], v[56:57] op_sel_hi:[1,0]
  v_pk_mul_f32 v[30:31], v[30:31], v[56:57] op_sel_hi:[1,0]
  v_pk_mul_f32 v[152:153], v[32:33], v[24:25] op_sel:[0,1] op_sel_hi:[1,1]
  v_pk_mul_f32 v[154:155], v[34:35], v[24:25] op_sel:[0,1] op_sel_hi:[1,1]
  v_pk_mul_f32 v[156:157], v[36:37], v[24:25] op_sel:[0,1] op_sel_hi:[1,1]
  v_pk_mul_f32 v[158:159], v[38:39], v[24:25] op_sel:[0,1] op_sel_hi:[1,1]
  v_pk_fma_f32 v[160:161], v[160:161], v[24:25], v[152:153] op_sel_hi:[1,0,1]
  v_pk_fma_f32 v[162:163], v[162:163], v[24:25], v[154:155] op_sel_hi:[1,0,1]
  v_pk_fma_f32 v[176:177], v[176:177], v[24:25], v[156:157] op_sel_hi:[1,0,1]
  v_pk_fma_f32 v[178:179], v[178:179], v[24:25], v[158:159] op_sel_hi:[1,0,1]
  v_cvt_pk_bf16_f32 v160, v160, v161
  v_cvt_pk_bf16_f32 v161, v162, v163
  v_cvt_pk_bf16_f32 v162, v176, v177
  v_cvt_pk_bf16_f32 v163, v178, v179
  ds_write_b128 v61, v[160:163] offset:0
  v_pk_mul_f32 v[152:153], v[32:33], v[26:27] op_sel:[0,1] op_sel_hi:[1,1]
  v_pk_mul_f32 v[154:155], v[34:35], v[26:27] op_sel:[0,1] op_sel_hi:[1,1]
  v_pk_mul_f32 v[156:157], v[36:37], v[26:27] op_sel:[0,1] op_sel_hi:[1,1]
  v_pk_mul_f32 v[158:159], v[38:39], v[26:27] op_sel:[0,1] op_sel_hi:[1,1]
  v_pk_fma_f32 v[164:165], v[164:165], v[26:27], v[152:153] op_sel_hi:[1,0,1]
  v_pk_fma_f32 v[166:167], v[166:167], v[26:27], v[154:155] op_sel_hi:[1,0,1]
  v_pk_fma_f32 v[180:181], v[180:181], v[26:27], v[156:157] op_sel_hi:[1,0,1]
  v_pk_fma_f32 v[182:183], v[182:183], v[26:27], v[158:159] op_sel_hi:[1,0,1]
  v_cvt_pk_bf16_f32 v164, v164, v165
  v_cvt_pk_bf16_f32 v165, v166, v167
  v_cvt_pk_bf16_f32 v166, v180, v181
  v_cvt_pk_bf16_f32 v167, v182, v183
  ds_write_b128 v61, v[164:167] offset:256
  v_pk_mul_f32 v[152:153], v[32:33], v[28:29] op_sel:[0,1] op_sel_hi:[1,1]
  v_pk_mul_f32 v[154:155], v[34:35], v[28:29] op_sel:[0,1] op_sel_hi:[1,1]
  v_pk_mul_f32 v[156:157], v[36:37], v[28:29] op_sel:[0,1] op_sel_hi:[1,1]
  v_pk_mul_f32 v[158:159], v[38:39], v[28:29] op_sel:[0,1] op_sel_hi:[1,1]
  v_pk_fma_f32 v[168:169], v[168:169], v[28:29], v[152:153] op_sel_hi:[1,0,1]
  v_pk_fma_f32 v[170:171], v[170:171], v[28:29], v[154:155] op_sel_hi:[1,0,1]
  v_pk_fma_f32 v[184:185], v[184:185], v[28:29], v[156:157] op_sel_hi:[1,0,1]
  v_pk_fma_f32 v[186:187], v[186:187], v[28:29], v[158:159] op_sel_hi:[1,0,1]
  v_cvt_pk_bf16_f32 v168, v168, v169
  v_cvt_pk_bf16_f32 v169, v170, v171
  v_cvt_pk_bf16_f32 v170, v184, v185
  v_cvt_pk_bf16_f32 v171, v186, v187
  ds_write_b128 v61, v[168:171] offset:2048
  v_pk_mul_f32 v[152:153], v[32:33], v[30:31] op_sel:[0,1] op_sel_hi:[1,1]
  v_pk_mul_f32 v[154:155], v[34:35], v[30:31] op_sel:[0,1] op_sel_hi:[1,1]
  v_pk_mul_f32 v[156:157], v[36:37], v[30:31] op_sel:[0,1] op_sel_hi:[1,1]
  v_pk_mul_f32 v[158:159], v[38:39], v[30:31] op_sel:[0,1] op_sel_hi:[1,1]
  v_pk_fma_f32 v[172:173], v[172:173], v[30:31], v[152:153] op_sel_hi:[1,0,1]
  v_pk_fma_f32 v[174:175], v[174:175], v[30:31], v[154:155] op_sel_hi:[1,0,1]
  v_pk_fma_f32 v[188:189], v[188:189], v[30:31], v[156:157] op_sel_hi:[1,0,1]
  v_pk_fma_f32 v[190:191], v[190:191], v[30:31], v[158:159] op_sel_hi:[1,0,1]
  v_cvt_pk_bf16_f32 v172, v172, v173
  v_cvt_pk_bf16_f32 v173, v174, v175
  v_cvt_pk_bf16_f32 v174, v188, v189
  v_cvt_pk_bf16_f32 v175, v190, v191
  ds_write_b128 v61, v[172:175] offset:2304
  s_add_u32 s37, s37, 32
  s_and_b32 s35, s35, 0x1ff
  s_cmp_lg_u32 s35, 0
  s_cselect_b32 s28, 0x100, 0
  s_or_b32 s35, s35, s28
  s_branch .g2_kernel_q_kd
.g2_kernel_r2:
  buffer_load_dwordx4 v[240:243], v22, s[4:7], s13 offen offset:0
  buffer_load_dwordx4 v[244:247], v22, s[4:7], s13 offen offset:512
  buffer_load_dwordx4 v[248:251], v22, s[4:7], s13 offen offset:1024
  buffer_load_dwordx4 v[252:255], v22, s[4:7], s13 offen offset:1536
  s_branch .g2_kernel_r3
.g2_kernel_a_t1c:
  s_call_b64 s[68:69], .g2_kernel_a_pick
  s_branch .g2_kernel_a_t1b
.g2_kernel_a_t2c:
  s_call_b64 s[68:69], .g2_kernel_a_pick
  s_branch .g2_kernel_a_t2b
.g2_kernel_a_t3c:
  s_call_b64 s[68:69], .g2_kernel_a_pick
  s_branch .g2_kernel_a_t3b
.g2_kernel_a_three:
  s_andn2_b32 s33, s36, s34
  s_cbranch_scc0 .g2_kernel_a_t1c
.g2_kernel_a_t1b:
  s_ff1_i32_b32 s33, s33
  s_bitset1_b32 s34, s33
  s_xor_b32 s33, s33, s24
  s_lshl_b32 s33, s33, s25
  s_add_u32 s22, s20, s33
  s_addc_u32 s23, s21, 0
  global_load_dwordx4 v[192:195], v3, s[22:23] offset:0
  global_load_dwordx4 v[196:199], v3, s[22:23] offset:1024
  global_load_dwordx4 v[200:203], v3, s[22:23] offset:2048
  global_load_dwordx4 v[204:207], v3, s[22:23] offset:3072
  s_andn2_b32 s33, s36, s34
  s_cbranch_scc0 .g2_kernel_a_t2c
.g2_kernel_a_t2b:
  s_ff1_i32_b32 s33, s33
  s_bitset1_b32 s34, s33
  s_xor_b32 s33, s33, s24
  s_lshl_b32 s33, s33, s25
  s_add_u32 s22, s20, s33
  s_addc_u32 s23, s21, 0
  global_load_dwordx4 v[208:211], v3, s[22:23] offset:0
  global_load_dwordx4 v[212:215], v3, s[22:23] offset:1024
  global_load_dwordx4 v[216:219], v3, s[22:23] offset:2048
  global_load_dwordx4 v[220:223], v3, s[22:23] offset:3072
  s_andn2_b32 s33, s36, s34
  s_cbranch_scc0 .g2_kernel_a_t3c
.g2_kernel_a_t3b:
  s_ff1_i32_b32 s33, s33
  s_bitset1_b32 s34, s33
  s_xor_b32 s33, s33, s24
  s_lshl_b32 s33, s33, s25
  s_add_u32 s22, s20, s33
  s_addc_u32 s23, s21, 0
  global_load_dwordx4 v[224:227], v3, s[22:23] offset:0
  global_load_dwordx4 v[228:231], v3, s[22:23] offset:1024
  global_load_dwordx4 v[232:235], v3, s[22:23] offset:2048
  global_load_dwordx4 v[236:239], v3, s[22:23] offset:3072
  s_setpc_b64 s[72:73]
.g2_kernel_a_o0c:
  s_call_b64 s[68:69], .g2_kernel_a_pick
  s_branch .g2_kernel_a_o0b
.g2_kernel_a_o1c:
  s_call_b64 s[68:69], .g2_kernel_a_pick
  s_branch .g2_kernel_a_o1b
.g2_kernel_a_o2c:
  s_call_b64 s[68:69], .g2_kernel_a_pick
  s_branch .g2_kernel_a_o2b
.g2_kernel_a_o3c:
  s_call_b64 s[68:69], .g2_kernel_a_pick
  s_branch .g2_kernel_a_o3b
.g2_kernel_a_r0c:
  s_call_b64 s[68:69], .g2_kernel_a_pick
  s_branch .g2_kernel_a_r0b
.g2_kernel_a_r1c:
  s_call_b64 s[68:69], .g2_kernel_a_pick
  s_branch .g2_kernel_a_r1b
.g2_kernel_a_r2c:
  s_call_b64 s[68:69], .g2_kernel_a_pick
  s_branch .g2_kernel_a_r2b
.g2_kernel_a_own:
  s_waitcnt vmcnt(0) lgkmcnt(0)
  s_mov_b64 exec, 1
  s_cmp_ge_u32 s35, 0x200
  s_cbranch_scc1 .g2_kernel_a_ow1
  buffer_store_dword v15, v4, s[4:7], s37 offen sc1
  s_branch .g2_kernel_a_ow2
.g2_kernel_a_ow1:
  ds_add_u32 v13, v5 offset:56
.g2_kernel_a_ow2:
  s_mov_b64 exec, -1
  s_add_u32 s37, s37, 64
  s_mov_b32 s14, 0
  s_andn2_b32 s33, s36, s34
  s_cbranch_scc0 .g2_kernel_a_o0c
.g2_kernel_a_o0b:
  s_ff1_i32_b32 s33, s33
  s_bitset1_b32 s34, s33
  s_lshl_b32 s28, s33, 0
  s_or_b32 s14, s14, s28
  s_xor_b32 s33, s33, s24
  s_lshl_b32 s33, s33, s25
  s_add_u32 s22, s20, s33
  s_addc_u32 s23, s21, 0
  global_load_dwordx4 v[176:179], v3, s[22:23] offset:0
  global_load_dwordx4 v[180:183], v3, s[22:23] offset:1024
  global_load_dwordx4 v[184:187], v3, s[22:23] offset:2048
  global_load_dwordx4 v[188:191], v3, s[22:23] offset:3072
  s_andn2_b32 s33, s36, s34
  s_cbranch_scc0 .g2_kernel_a_o1c
.g2_kernel_a_o1b:
  s_ff1_i32_b32 s33, s33
  s_bitset1_b32 s34, s33
  s_lshl_b32 s28, s33, 8
  s_or_b32 s14, s14, s28
  s_xor_b32 s33, s33, s24
  s_lshl_b32 s33, s33, s25
  s_add_u32 s22, s20, s33
  s_addc_u32 s23, s21, 0
  global_load_dwordx4 v[192:195], v3, s[22:23] offset:0
  global_load_dwordx4 v[196:199], v3, s[22:23] offset:1024
  global_load_dwordx4 v[200:203], v3, s[22:23] offset:2048
  global_load_dwordx4 v[204:207], v3, s[22:23] offset:3072
  s_andn2_b32 s33, s36, s34
  s_cbranch_scc0 .g2_kernel_a_o2c
.g2_kernel_a_o2b:
  s_ff1_i32_b32 s33, s33
  s_bitset1_b32 s34, s33
  s_lshl_b32 s28, s33, 16
  s_or_b32 s14, s14, s28
  s_xor_b32 s33, s33, s24
  s_lshl_b32 s33, s33, s25
  s_add_u32 s22, s20, s33
  s_addc_u32 s23, s21, 0
  global_load_dwordx4 v[208:211], v3, s[22:23] offset:0
  global_load_dwordx4 v[212:215], v3, s[22:23] offset:1024
  global_load_dwordx4 v[216:219], v3, s[22:23] offset:2048
  global_load_dwordx4 v[220:223], v3, s[22:23] offset:3072
  s_andn2_b32 s33, s36, s34
  s_cbranch_scc0 .g2_kernel_a_o3c
.g2_kernel_a_o3b:
  s_ff1_i32_b32 s33, s33
  s_bitset1_b32 s34, s33
  s_lshl_b32 s28, s33, 24
  s_or_b32 s14, s14, s28
  s_xor_b32 s33, s33, s24
  s_lshl_b32 s33, s33, s25
  s_add_u32 s22, s20, s33
  s_addc_u32 s23, s21, 0
  global_load_dwordx4 v[224:227], v3, s[22:23] offset:0
  global_load_dwordx4 v[228:231], v3, s[22:23] offset:1024
  global_load_dwordx4 v[232:235], v3, s[22:23] offset:2048
  global_load_dwordx4 v[236:239], v3, s[22:23] offset:3072
  s_and_b32 s15, s34, -2
  s_mov_b32 s34, -1
  s_mov_b32 s26, -1
  s_waitcnt vmcnt(12)
  s_branch .g2_kernel_a_ob
.g2_kernel_a_redo:
  v_mfma_f32_32x32x16_bf16 v[104:119], v[236:239], v[172:175], v[104:119]
  v_smfmac_f32_16x16x64_bf16 v[132:135], v[16:19], v[168:175], v20
  v_mov_b32 v6, s71
  s_mov_b32 s38, 0
.g2_kernel_wg3:
  ds_read_b32 v7, v6 offset:60
  s_add_u32 s38, s38, 1
  s_waitcnt lgkmcnt(0)
  v_cmp_le_u32 vcc, 1, v7
  s_cbranch_vccnz .g2_kernel_wg3d
  s_sleep 1
  s_cmp_lt_u32 s38, 524288
  s_cbranch_scc1 .g2_kernel_wg3
.g2_kernel_wg3d:
  ds_read_b32 v7, v8
  s_mov_b32 s34, s15
  s_mov_b32 s26, 0
  s_waitcnt lgkmcnt(0)
  v_cmp_lt_u32 vcc, s62, v7
  s_mov_b32 s36, vcc_lo
  s_sub_u32 s28, s35, 1
  s_bfe_u32 s28, s28, 0x20005
  s_mov_b32 s35, 0
  s_waitcnt vmcnt(0)
  s_cmp_lg_u32 s28, 0
  s_cbranch_scc1 .g2_kernel_a_rd1
  ds_read_b128 v[24:27], v14 offset:8192
  ds_read_b128 v[28:31], v14 offset:9216
  v_mov_b32 v120, 0
  v_mov_b32 v121, 0
  s_waitcnt lgkmcnt(0)
  v_mfma_f32_32x32x16_bf16 v[136:151], v[176:179], v[24:27], 0
  v_mfma_f32_32x32x16_bf16 v[136:151], v[180:183], v[28:31], v[136:151]
  v_mfma_f32_32x32x16_bf16 v[152:167], v[192:195], v[24:27], 0
  s_nop 10
  v_exp_f32 v136, v136
  v_exp_f32 v137, v137
  v_exp_f32 v138, v138
  v_exp_f32 v139, v139
  v_exp_f32 v140, v140
  v_exp_f32 v141, v141
  v_exp_f32 v142, v142
  v_exp_f32 v143, v143
  v_mfma_f32_32x32x16_bf16 v[152:167], v[196:199], v[28:31], v[152:167]
  v_cvt_pk_bf16_f32 v168, v136, v137
  v_cvt_pk_bf16_f32 v169, v138, v139
  v_cvt_pk_bf16_f32 v170, v140, v141
  v_cvt_pk_bf16_f32 v171, v142, v143
  v_exp_f32 v144, v144
  v_exp_f32 v145, v145
  v_exp_f32 v146, v146
  v_exp_f32 v147, v147
  v_mfma_f32_32x32x16_bf16 v[56:71], v[184:187], v[168:171], 0
  v_exp_f32 v148, v148
  v_exp_f32 v149, v149
  v_exp_f32 v150, v150
  v_exp_f32 v151, v151
  v_cvt_pk_bf16_f32 v172, v144, v145
  v_cvt_pk_bf16_f32 v173, v146, v147
  v_cvt_pk_bf16_f32 v174, v148, v149
  v_cvt_pk_bf16_f32 v175, v150, v151
  v_mfma_f32_32x32x16_bf16 v[136:151], v[208:211], v[24:27], 0
  v_exp_f32 v152, v152
  v_exp_f32 v153, v153
  v_exp_f32 v154, v154
  v_mfma_f32_32x32x16_bf16 v[56:71], v[188:191], v[172:175], v[56:71]
  s_call_b64 s[72:73], .g2_kernel_a_ld0
  v_exp_f32 v155, v155
  v_exp_f32 v156, v156
  v_exp_f32 v157, v157
  v_smfmac_f32_16x16x64_bf16 v[120:123], v[16:19], v[168:175], v20
  v_exp_f32 v158, v158
  v_exp_f32 v159, v159
  v_mfma_f32_32x32x16_bf16 v[136:151], v[212:215], v[28:31], v[136:151]
  v_cvt_pk_bf16_f32 v168, v152, v153
  v_cvt_pk_bf16_f32 v169, v154, v155
  v_cvt_pk_bf16_f32 v170, v156, v157
  v_cvt_pk_bf16_f32 v171, v158, v159
  v_exp_f32 v160, v160
  v_exp_f32 v161, v161
  v_exp_f32 v162, v162
  v_exp_f32 v163, v163
  v_mfma_f32_32x32x16_bf16 v[56:71], v[200:203], v[168:171], v[56:71]
  v_exp_f32 v164, v164
  v_exp_f32 v165, v165
  v_exp_f32 v166, v166
  v_exp_f32 v167, v167
  v_cvt_pk_bf16_f32 v172, v160, v161
  v_cvt_pk_bf16_f32 v173, v162, v163
  v_cvt_pk_bf16_f32 v174, v164, v165
  v_cvt_pk_bf16_f32 v175, v166, v167
  v_mfma_f32_32x32x16_bf16 v[152:167], v[224:227], v[24:27], 0
  v_exp_f32 v136, v136
  v_exp_f32 v137, v137
  v_exp_f32 v138, v138
  v_mfma_f32_32x32x16_bf16 v[56:71], v[204:207], v[172:175], v[56:71]
  s_call_b64 s[72:73], .g2_kernel_a_ld1
  v_exp_f32 v139, v139
  v_exp_f32 v140, v140
  v_exp_f32 v141, v141
  v_smfmac_f32_16x16x64_bf16 v[120:123], v[16:19], v[168:175], v20
  v_exp_f32 v142, v142
  v_exp_f32 v143, v143
  v_mfma_f32_32x32x16_bf16 v[152:167], v[228:231], v[28:31], v[152:167]
  v_cvt_pk_bf16_f32 v168, v136, v137
  v_cvt_pk_bf16_f32 v169, v138, v139
  v_cvt_pk_bf16_f32 v170, v140, v141
  v_cvt_pk_bf16_f32 v171, v142, v143
  v_exp_f32 v144, v144
  v_exp_f32 v145, v145
  v_exp_f32 v146, v146
  v_exp_f32 v147, v147
  v_mfma_f32_32x32x16_bf16 v[56:71], v[216:219], v[168:171], v[56:71]
  v_exp_f32 v148, v148
  v_exp_f32 v149, v149
  v_exp_f32 v150, v150
  v_exp_f32 v151, v151
  v_cvt_pk_bf16_f32 v172, v144, v145
  v_cvt_pk_bf16_f32 v173, v146, v147
  v_cvt_pk_bf16_f32 v174, v148, v149
  v_cvt_pk_bf16_f32 v175, v150, v151
  v_exp_f32 v152, v152
  v_exp_f32 v153, v153
  v_exp_f32 v154, v154
  v_mfma_f32_32x32x16_bf16 v[56:71], v[220:223], v[172:175], v[56:71]
  s_call_b64 s[72:73], .g2_kernel_a_ld2
  v_exp_f32 v155, v155
  v_exp_f32 v156, v156
  v_exp_f32 v157, v157
  v_smfmac_f32_16x16x64_bf16 v[120:123], v[16:19], v[168:175], v20
  v_exp_f32 v158, v158
  v_exp_f32 v159, v159
  v_cvt_pk_bf16_f32 v168, v152, v153
  v_cvt_pk_bf16_f32 v169, v154, v155
  v_cvt_pk_bf16_f32 v170, v156, v157
  v_cvt_pk_bf16_f32 v171, v158, v159
  v_exp_f32 v160, v160
  v_exp_f32 v161, v161
  v_exp_f32 v162, v162
  v_exp_f32 v163, v163
  v_mfma_f32_32x32x16_bf16 v[56:71], v[232:235], v[168:171], v[56:71]
  v_exp_f32 v164, v164
  v_exp_f32 v165, v165
  v_exp_f32 v166, v166
  v_exp_f32 v167, v167
  v_cvt_pk_bf16_f32 v172, v160, v161
  v_cvt_pk_bf16_f32 v173, v162, v163
  v_cvt_pk_bf16_f32 v174, v164, v165
  v_cvt_pk_bf16_f32 v175, v166, v167
  s_nop 1
  v_mfma_f32_32x32x16_bf16 v[56:71], v[236:239], v[172:175], v[56:71]
  v_smfmac_f32_16x16x64_bf16 v[120:123], v[16:19], v[168:175], v20
  s_branch .g2_kernel_a_rde
.g2_kernel_a_rd1:
  s_cmp_lg_u32 s28, 1
  s_cbranch_scc1 .g2_kernel_a_rd2
  ds_read_b128 v[32:35], v14 offset:10240
  ds_read_b128 v[36:39], v14 offset:11264
  v_mov_b32 v124, 0
  v_mov_b32 v125, 0
  s_waitcnt lgkmcnt(0)
  v_mfma_f32_32x32x16_bf16 v[136:151], v[176:179], v[32:35], 0
  v_mfma_f32_32x32x16_bf16 v[136:151], v[180:183], v[36:39], v[136:151]
  v_mfma_f32_32x32x16_bf16 v[152:167], v[192:195], v[32:35], 0
  s_nop 10
  v_exp_f32 v136, v136
  v_exp_f32 v137, v137
  v_exp_f32 v138, v138
  v_exp_f32 v139, v139
  v_exp_f32 v140, v140
  v_exp_f32 v141, v141
  v_exp_f32 v142, v142
  v_exp_f32 v143, v143
  v_mfma_f32_32x32x16_bf16 v[152:167], v[196:199], v[36:39], v[152:167]
  v_cvt_pk_bf16_f32 v168, v136, v137
  v_cvt_pk_bf16_f32 v169, v138, v139
  v_cvt_pk_bf16_f32 v170, v140, v141
  v_cvt_pk_bf16_f32 v171, v142, v143
  v_exp_f32 v144, v144
  v_exp_f32 v145, v145
  v_exp_f32 v146, v146
  v_exp_f32 v147, v147
  v_mfma_f32_32x32x16_bf16 v[72:87], v[184:187], v[168:171], 0
  v_exp_f32 v148, v148
  v_exp_f32 v149, v149
  v_exp_f32 v150, v150
  v_exp_f32 v151, v151
  v_cvt_pk_bf16_f32 v172, v144, v145
  v_cvt_pk_bf16_f32 v173, v146, v147
  v_cvt_pk_bf16_f32 v174, v148, v149
  v_cvt_pk_bf16_f32 v175, v150, v151
  v_mfma_f32_32x32x16_bf16 v[136:151], v[208:211], v[32:35], 0
  v_exp_f32 v152, v152
  v_exp_f32 v153, v153
  v_exp_f32 v154, v154
  v_mfma_f32_32x32x16_bf16 v[72:87], v[188:191], v[172:175], v[72:87]
  s_call_b64 s[72:73], .g2_kernel_a_ld0
  v_exp_f32 v155, v155
  v_exp_f32 v156, v156
  v_exp_f32 v157, v157
  v_smfmac_f32_16x16x64_bf16 v[124:127], v[16:19], v[168:175], v20
  v_exp_f32 v158, v158
  v_exp_f32 v159, v159
  v_mfma_f32_32x32x16_bf16 v[136:151], v[212:215], v[36:39], v[136:151]
  v_cvt_pk_bf16_f32 v168, v152, v153
  v_cvt_pk_bf16_f32 v169, v154, v155
  v_cvt_pk_bf16_f32 v170, v156, v157
  v_cvt_pk_bf16_f32 v171, v158, v159
  v_exp_f32 v160, v160
  v_exp_f32 v161, v161
  v_exp_f32 v162, v162
  v_exp_f32 v163, v163
  v_mfma_f32_32x32x16_bf16 v[72:87], v[200:203], v[168:171], v[72:87]
  v_exp_f32 v164, v164
  v_exp_f32 v165, v165
  v_exp_f32 v166, v166
  v_exp_f32 v167, v167
  v_cvt_pk_bf16_f32 v172, v160, v161
  v_cvt_pk_bf16_f32 v173, v162, v163
  v_cvt_pk_bf16_f32 v174, v164, v165
  v_cvt_pk_bf16_f32 v175, v166, v167
  v_mfma_f32_32x32x16_bf16 v[152:167], v[224:227], v[32:35], 0
  v_exp_f32 v136, v136
  v_exp_f32 v137, v137
  v_exp_f32 v138, v138
  v_mfma_f32_32x32x16_bf16 v[72:87], v[204:207], v[172:175], v[72:87]
  s_call_b64 s[72:73], .g2_kernel_a_ld1
  v_exp_f32 v139, v139
  v_exp_f32 v140, v140
  v_exp_f32 v141, v141
  v_smfmac_f32_16x16x64_bf16 v[124:127], v[16:19], v[168:175], v20
  v_exp_f32 v142, v142
  v_exp_f32 v143, v143
  v_mfma_f32_32x32x16_bf16 v[152:167], v[228:231], v[36:39], v[152:167]
  v_cvt_pk_bf16_f32 v168, v136, v137
  v_cvt_pk_bf16_f32 v169, v138, v139
  v_cvt_pk_bf16_f32 v170, v140, v141
  v_cvt_pk_bf16_f32 v171, v142, v143
  v_exp_f32 v144, v144
  v_exp_f32 v145, v145
  v_exp_f32 v146, v146
  v_exp_f32 v147, v147
  v_mfma_f32_32x32x16_bf16 v[72:87], v[216:219], v[168:171], v[72:87]
  v_exp_f32 v148, v148
  v_exp_f32 v149, v149
  v_exp_f32 v150, v150
  v_exp_f32 v151, v151
  v_cvt_pk_bf16_f32 v172, v144, v145
  v_cvt_pk_bf16_f32 v173, v146, v147
  v_cvt_pk_bf16_f32 v174, v148, v149
  v_cvt_pk_bf16_f32 v175, v150, v151
  v_exp_f32 v152, v152
  v_exp_f32 v153, v153
  v_exp_f32 v154, v154
  v_mfma_f32_32x32x16_bf16 v[72:87], v[220:223], v[172:175], v[72:87]
  s_call_b64 s[72:73], .g2_kernel_a_ld2
  v_exp_f32 v155, v155
  v_exp_f32 v156, v156
  v_exp_f32 v157, v157
  v_smfmac_f32_16x16x64_bf16 v[124:127], v[16:19], v[168:175], v20
  v_exp_f32 v158, v158
  v_exp_f32 v159, v159
  v_cvt_pk_bf16_f32 v168, v152, v153
  v_cvt_pk_bf16_f32 v169, v154, v155
  v_cvt_pk_bf16_f32 v170, v156, v157
  v_cvt_pk_bf16_f32 v171, v158, v159
  v_exp_f32 v160, v160
  v_exp_f32 v161, v161
  v_exp_f32 v162, v162
  v_exp_f32 v163, v163
  v_mfma_f32_32x32x16_bf16 v[72:87], v[232:235], v[168:171], v[72:87]
  v_exp_f32 v164, v164
  v_exp_f32 v165, v165
  v_exp_f32 v166, v166
  v_exp_f32 v167, v167
  v_cvt_pk_bf16_f32 v172, v160, v161
  v_cvt_pk_bf16_f32 v173, v162, v163
  v_cvt_pk_bf16_f32 v174, v164, v165
  v_cvt_pk_bf16_f32 v175, v166, v167
  s_nop 1
  v_mfma_f32_32x32x16_bf16 v[72:87], v[236:239], v[172:175], v[72:87]
  v_smfmac_f32_16x16x64_bf16 v[124:127], v[16:19], v[168:175], v20
  s_branch .g2_kernel_a_rde
.g2_kernel_a_rd2:
  s_cmp_lg_u32 s28, 2
  s_cbranch_scc1 .g2_kernel_a_rd3
  ds_read_b128 v[40:43], v14 offset:12288
  ds_read_b128 v[44:47], v14 offset:13312
  v_mov_b32 v128, 0
  v_mov_b32 v129, 0
  s_waitcnt lgkmcnt(0)
  v_mfma_f32_32x32x16_bf16 v[136:151], v[176:179], v[40:43], 0
  v_mfma_f32_32x32x16_bf16 v[136:151], v[180:183], v[44:47], v[136:151]
  v_mfma_f32_32x32x16_bf16 v[152:167], v[192:195], v[40:43], 0
  s_nop 10
  v_exp_f32 v136, v136
  v_exp_f32 v137, v137
  v_exp_f32 v138, v138
  v_exp_f32 v139, v139
  v_exp_f32 v140, v140
  v_exp_f32 v141, v141
  v_exp_f32 v142, v142
  v_exp_f32 v143, v143
  v_mfma_f32_32x32x16_bf16 v[152:167], v[196:199], v[44:47], v[152:167]
  v_cvt_pk_bf16_f32 v168, v136, v137
  v_cvt_pk_bf16_f32 v169, v138, v139
  v_cvt_pk_bf16_f32 v170, v140, v141
  v_cvt_pk_bf16_f32 v171, v142, v143
  v_exp_f32 v144, v144
  v_exp_f32 v145, v145
  v_exp_f32 v146, v146
  v_exp_f32 v147, v147
  v_mfma_f32_32x32x16_bf16 v[88:103], v[184:187], v[168:171], 0
  v_exp_f32 v148, v148
  v_exp_f32 v149, v149
  v_exp_f32 v150, v150
  v_exp_f32 v151, v151
  v_cvt_pk_bf16_f32 v172, v144, v145
  v_cvt_pk_bf16_f32 v173, v146, v147
  v_cvt_pk_bf16_f32 v174, v148, v149
  v_cvt_pk_bf16_f32 v175, v150, v151
  v_mfma_f32_32x32x16_bf16 v[136:151], v[208:211], v[40:43], 0
  v_exp_f32 v152, v152
  v_exp_f32 v153, v153
  v_exp_f32 v154, v154
  v_mfma_f32_32x32x16_bf16 v[88:103], v[188:191], v[172:175], v[88:103]
  s_call_b64 s[72:73], .g2_kernel_a_ld0
  v_exp_f32 v155, v155
  v_exp_f32 v156, v156
  v_exp_f32 v157, v157
  v_smfmac_f32_16x16x64_bf16 v[128:131], v[16:19], v[168:175], v20
  v_exp_f32 v158, v158
  v_exp_f32 v159, v159
  v_mfma_f32_32x32x16_bf16 v[136:151], v[212:215], v[44:47], v[136:151]
  v_cvt_pk_bf16_f32 v168, v152, v153
  v_cvt_pk_bf16_f32 v169, v154, v155
  v_cvt_pk_bf16_f32 v170, v156, v157
  v_cvt_pk_bf16_f32 v171, v158, v159
  v_exp_f32 v160, v160
  v_exp_f32 v161, v161
  v_exp_f32 v162, v162
  v_exp_f32 v163, v163
  v_mfma_f32_32x32x16_bf16 v[88:103], v[200:203], v[168:171], v[88:103]
  v_exp_f32 v164, v164
  v_exp_f32 v165, v165
  v_exp_f32 v166, v166
  v_exp_f32 v167, v167
  v_cvt_pk_bf16_f32 v172, v160, v161
  v_cvt_pk_bf16_f32 v173, v162, v163
  v_cvt_pk_bf16_f32 v174, v164, v165
  v_cvt_pk_bf16_f32 v175, v166, v167
  v_mfma_f32_32x32x16_bf16 v[152:167], v[224:227], v[40:43], 0
  v_exp_f32 v136, v136
  v_exp_f32 v137, v137
  v_exp_f32 v138, v138
  v_mfma_f32_32x32x16_bf16 v[88:103], v[204:207], v[172:175], v[88:103]
  s_call_b64 s[72:73], .g2_kernel_a_ld1
  v_exp_f32 v139, v139
  v_exp_f32 v140, v140
  v_exp_f32 v141, v141
  v_smfmac_f32_16x16x64_bf16 v[128:131], v[16:19], v[168:175], v20
  v_exp_f32 v142, v142
  v_exp_f32 v143, v143
  v_mfma_f32_32x32x16_bf16 v[152:167], v[228:231], v[44:47], v[152:167]
  v_cvt_pk_bf16_f32 v168, v136, v137
  v_cvt_pk_bf16_f32 v169, v138, v139
  v_cvt_pk_bf16_f32 v170, v140, v141
  v_cvt_pk_bf16_f32 v171, v142, v143
  v_exp_f32 v144, v144
  v_exp_f32 v145, v145
  v_exp_f32 v146, v146
  v_exp_f32 v147, v147
  v_mfma_f32_32x32x16_bf16 v[88:103], v[216:219], v[168:171], v[88:103]
  v_exp_f32 v148, v148
  v_exp_f32 v149, v149
  v_exp_f32 v150, v150
  v_exp_f32 v151, v151
  v_cvt_pk_bf16_f32 v172, v144, v145
  v_cvt_pk_bf16_f32 v173, v146, v147
  v_cvt_pk_bf16_f32 v174, v148, v149
  v_cvt_pk_bf16_f32 v175, v150, v151
  v_exp_f32 v152, v152
  v_exp_f32 v153, v153
  v_exp_f32 v154, v154
  v_mfma_f32_32x32x16_bf16 v[88:103], v[220:223], v[172:175], v[88:103]
  s_call_b64 s[72:73], .g2_kernel_a_ld2
  v_exp_f32 v155, v155
  v_exp_f32 v156, v156
  v_exp_f32 v157, v157
  v_smfmac_f32_16x16x64_bf16 v[128:131], v[16:19], v[168:175], v20
  v_exp_f32 v158, v158
  v_exp_f32 v159, v159
  v_cvt_pk_bf16_f32 v168, v152, v153
  v_cvt_pk_bf16_f32 v169, v154, v155
  v_cvt_pk_bf16_f32 v170, v156, v157
  v_cvt_pk_bf16_f32 v171, v158, v159
  v_exp_f32 v160, v160
  v_exp_f32 v161, v161
  v_exp_f32 v162, v162
  v_exp_f32 v163, v163
  v_mfma_f32_32x32x16_bf16 v[88:103], v[232:235], v[168:171], v[88:103]
  v_exp_f32 v164, v164
  v_exp_f32 v165, v165
  v_exp_f32 v166, v166
  v_exp_f32 v167, v167
  v_cvt_pk_bf16_f32 v172, v160, v161
  v_cvt_pk_bf16_f32 v173, v162, v163
  v_cvt_pk_bf16_f32 v174, v164, v165
  v_cvt_pk_bf16_f32 v175, v166, v167
  s_nop 1
  v_mfma_f32_32x32x16_bf16 v[88:103], v[236:239], v[172:175], v[88:103]
  v_smfmac_f32_16x16x64_bf16 v[128:131], v[16:19], v[168:175], v20
  s_branch .g2_kernel_a_rde
.g2_kernel_a_rd3:
  ds_read_b128 v[48:51], v14 offset:14336
  ds_read_b128 v[52:55], v14 offset:15360
  v_mov_b32 v132, 0
  v_mov_b32 v133, 0
  s_waitcnt lgkmcnt(0)
  v_mfma_f32_32x32x16_bf16 v[136:151], v[176:179], v[48:51], 0
  v_mfma_f32_32x32x16_bf16 v[136:151], v[180:183], v[52:55], v[136:151]
  v_mfma_f32_32x32x16_bf16 v[152:167], v[192:195], v[48:51], 0
  s_nop 10
  v_exp_f32 v136, v136
  v_exp_f32 v137, v137
  v_exp_f32 v138, v138
  v_exp_f32 v139, v139
  v_exp_f32 v140, v140
  v_exp_f32 v141, v141
  v_exp_f32 v142, v142
  v_exp_f32 v143, v143
  v_mfma_f32_32x32x16_bf16 v[152:167], v[196:199], v[52:55], v[152:167]
  v_cvt_pk_bf16_f32 v168, v136, v137
  v_cvt_pk_bf16_f32 v169, v138, v139
  v_cvt_pk_bf16_f32 v170, v140, v141
  v_cvt_pk_bf16_f32 v171, v142, v143
  v_exp_f32 v144, v144
  v_exp_f32 v145, v145
  v_exp_f32 v146, v146
  v_exp_f32 v147, v147
  v_mfma_f32_32x32x16_bf16 v[104:119], v[184:187], v[168:171], 0
  v_exp_f32 v148, v148
  v_exp_f32 v149, v149
  v_exp_f32 v150, v150
  v_exp_f32 v151, v151
  v_cvt_pk_bf16_f32 v172, v144, v145
  v_cvt_pk_bf16_f32 v173, v146, v147
  v_cvt_pk_bf16_f32 v174, v148, v149
  v_cvt_pk_bf16_f32 v175, v150, v151
  v_mfma_f32_32x32x16_bf16 v[136:151], v[208:211], v[48:51], 0
  v_exp_f32 v152, v152
  v_exp_f32 v153, v153
  v_exp_f32 v154, v154
  v_mfma_f32_32x32x16_bf16 v[104:119], v[188:191], v[172:175], v[104:119]
  s_call_b64 s[72:73], .g2_kernel_a_ld0
  v_exp_f32 v155, v155
  v_exp_f32 v156, v156
  v_exp_f32 v157, v157
  v_smfmac_f32_16x16x64_bf16 v[132:135], v[16:19], v[168:175], v20
  v_exp_f32 v158, v158
  v_exp_f32 v159, v159
  v_mfma_f32_32x32x16_bf16 v[136:151], v[212:215], v[52:55], v[136:151]
  v_cvt_pk_bf16_f32 v168, v152, v153
  v_cvt_pk_bf16_f32 v169, v154, v155
  v_cvt_pk_bf16_f32 v170, v156, v157
  v_cvt_pk_bf16_f32 v171, v158, v159
  v_exp_f32 v160, v160
  v_exp_f32 v161, v161
  v_exp_f32 v162, v162
  v_exp_f32 v163, v163
  v_mfma_f32_32x32x16_bf16 v[104:119], v[200:203], v[168:171], v[104:119]
  v_exp_f32 v164, v164
  v_exp_f32 v165, v165
  v_exp_f32 v166, v166
  v_exp_f32 v167, v167
  v_cvt_pk_bf16_f32 v172, v160, v161
  v_cvt_pk_bf16_f32 v173, v162, v163
  v_cvt_pk_bf16_f32 v174, v164, v165
  v_cvt_pk_bf16_f32 v175, v166, v167
  v_mfma_f32_32x32x16_bf16 v[152:167], v[224:227], v[48:51], 0
  v_exp_f32 v136, v136
  v_exp_f32 v137, v137
  v_exp_f32 v138, v138
  v_mfma_f32_32x32x16_bf16 v[104:119], v[204:207], v[172:175], v[104:119]
  s_call_b64 s[72:73], .g2_kernel_a_ld1
  v_exp_f32 v139, v139
  v_exp_f32 v140, v140
  v_exp_f32 v141, v141
  v_smfmac_f32_16x16x64_bf16 v[132:135], v[16:19], v[168:175], v20
  v_exp_f32 v142, v142
  v_exp_f32 v143, v143
  v_mfma_f32_32x32x16_bf16 v[152:167], v[228:231], v[52:55], v[152:167]
  v_cvt_pk_bf16_f32 v168, v136, v137
  v_cvt_pk_bf16_f32 v169, v138, v139
  v_cvt_pk_bf16_f32 v170, v140, v141
  v_cvt_pk_bf16_f32 v171, v142, v143
  v_exp_f32 v144, v144
  v_exp_f32 v145, v145
  v_exp_f32 v146, v146
  v_exp_f32 v147, v147
  v_mfma_f32_32x32x16_bf16 v[104:119], v[216:219], v[168:171], v[104:119]
  v_exp_f32 v148, v148
  v_exp_f32 v149, v149
  v_exp_f32 v150, v150
  v_exp_f32 v151, v151
  v_cvt_pk_bf16_f32 v172, v144, v145
  v_cvt_pk_bf16_f32 v173, v146, v147
  v_cvt_pk_bf16_f32 v174, v148, v149
  v_cvt_pk_bf16_f32 v175, v150, v151
  v_exp_f32 v152, v152
  v_exp_f32 v153, v153
  v_exp_f32 v154, v154
  v_mfma_f32_32x32x16_bf16 v[104:119], v[220:223], v[172:175], v[104:119]
  s_call_b64 s[72:73], .g2_kernel_a_ld2
  v_exp_f32 v155, v155
  v_exp_f32 v156, v156
  v_exp_f32 v157, v157
  v_smfmac_f32_16x16x64_bf16 v[132:135], v[16:19], v[168:175], v20
  v_exp_f32 v158, v158
  v_exp_f32 v159, v159
  v_cvt_pk_bf16_f32 v168, v152, v153
  v_cvt_pk_bf16_f32 v169, v154, v155
  v_cvt_pk_bf16_f32 v170, v156, v157
  v_cvt_pk_bf16_f32 v171, v158, v159
  v_exp_f32 v160, v160
  v_exp_f32 v161, v161
  v_exp_f32 v162, v162
  v_exp_f32 v163, v163
  v_mfma_f32_32x32x16_bf16 v[104:119], v[232:235], v[168:171], v[104:119]
  v_exp_f32 v164, v164
  v_exp_f32 v165, v165
  v_exp_f32 v166, v166
  v_exp_f32 v167, v167
  v_cvt_pk_bf16_f32 v172, v160, v161
  v_cvt_pk_bf16_f32 v173, v162, v163
  v_cvt_pk_bf16_f32 v174, v164, v165
  v_cvt_pk_bf16_f32 v175, v166, v167
  s_nop 1
  v_mfma_f32_32x32x16_bf16 v[104:119], v[236:239], v[172:175], v[104:119]
  v_smfmac_f32_16x16x64_bf16 v[132:135], v[16:19], v[168:175], v20
  s_branch .g2_kernel_a_rde
.g2_kernel_a_rd4:
.g2_kernel_a_rde:
  v_mov_b32 v168, 0
  v_mov_b32 v169, 0
  v_mov_b32 v170, 0
  v_mov_b32 v171, 0
  v_mov_b32 v172, 0
  v_mov_b32 v173, 0
  v_mov_b32 v174, 0
  v_mov_b32 v175, 0
  s_waitcnt vmcnt(8)
  v_mfma_f32_32x32x16_bf16 v[136:151], v[176:179], v[24:27], 0
  v_mfma_f32_32x32x16_bf16 v[136:151], v[180:183], v[28:31], v[136:151]
  s_nop 10
  s_branch .g2_kernel_a_loop
.g2_kernel_a_ld0:
  s_andn2_b32 s33, s36, s34
  s_cbranch_scc0 .g2_kernel_a_r0c
.g2_kernel_a_r0b:
  s_ff1_i32_b32 s33, s33
  s_bitset1_b32 s34, s33
  s_xor_b32 s33, s33, s24
  s_lshl_b32 s33, s33, s25
  s_add_u32 s22, s20, s33
  s_addc_u32 s23, s21, 0
  global_load_dwordx4 v[176:179], v3, s[22:23] offset:0
  global_load_dwordx4 v[180:183], v3, s[22:23] offset:1024
  global_load_dwordx4 v[184:187], v3, s[22:23] offset:2048
  global_load_dwordx4 v[188:191], v3, s[22:23] offset:3072
  s_setpc_b64 s[72:73]
.g2_kernel_a_ld1:
  s_andn2_b32 s33, s36, s34
  s_cbranch_scc0 .g2_kernel_a_r1c
.g2_kernel_a_r1b:
  s_ff1_i32_b32 s33, s33
  s_bitset1_b32 s34, s33
  s_xor_b32 s33, s33, s24
  s_lshl_b32 s33, s33, s25
  s_add_u32 s22, s20, s33
  s_addc_u32 s23, s21, 0
  global_load_dwordx4 v[192:195], v3, s[22:23] offset:0
  global_load_dwordx4 v[196:199], v3, s[22:23] offset:1024
  global_load_dwordx4 v[200:203], v3, s[22:23] offset:2048
  global_load_dwordx4 v[204:207], v3, s[22:23] offset:3072
  s_setpc_b64 s[72:73]
.g2_kernel_a_ld2:
  s_andn2_b32 s33, s36, s34
  s_cbranch_scc0 .g2_kernel_a_r2c
.g2_kernel_a_r2b:
  s_ff1_i32_b32 s33, s33
  s_bitset1_b32 s34, s33
  s_xor_b32 s33, s33, s24
  s_lshl_b32 s33, s33, s25
  s_add_u32 s22, s20, s33
  s_addc_u32 s23, s21, 0
  global_load_dwordx4 v[208:211], v3, s[22:23] offset:0
  global_load_dwordx4 v[212:215], v3, s[22:23] offset:1024
  global_load_dwordx4 v[216:219], v3, s[22:23] offset:2048
  global_load_dwordx4 v[220:223], v3, s[22:23] offset:3072
  s_setpc_b64 s[72:73]
.g2_kernel_a_N0c:
  s_call_b64 s[68:69], .g2_kernel_a_pick
  s_branch .g2_kernel_a_N0b
.g2_kernel_a_N1c:
  s_call_b64 s[68:69], .g2_kernel_a_pick
  s_branch .g2_kernel_a_N1b
.g2_kernel_a_N2c:
  s_call_b64 s[68:69], .g2_kernel_a_pick
  s_branch .g2_kernel_a_N2b
.g2_kernel_a_N3c:
  s_call_b64 s[68:69], .g2_kernel_a_pick
  s_branch .g2_kernel_a_N3b
.g2_kernel_a_L3c:
  s_call_b64 s[68:69], .g2_kernel_a_pick
  s_branch .g2_kernel_a_L3b
.g2_kernel_a_G0c:
  s_call_b64 s[68:69], .g2_kernel_a_pick
  s_branch .g2_kernel_a_G0b
.g2_kernel_a_L3g:
  s_mov_b32 s38, 0
.g2_kernel_a_L3gl:
  ds_read_b32 v7, v13 offset:8
  s_add_u32 s38, s38, 1
  s_waitcnt lgkmcnt(0)
  v_cmp_gt_u32 vcc, s27, v7
  s_cbranch_vccz .g2_kernel_a_L3h
  s_cmp_lt_u32 s38, 524288
  s_cbranch_scc1 .g2_kernel_a_L3gl
  s_branch .g2_kernel_a_L3h
.g2_kernel_a_hold:
  s_lshl_b32 s33, 1, s14
  s_lshr_b32 s14, s14, 8
  s_setpc_b64 s[68:69]
.g2_kernel_a_pick:
  s_cmp_lg_u32 s34, -1
  s_cbranch_scc1 .g2_kernel_a_pk1
  s_cmp_eq_u32 s26, -1
  s_cbranch_scc1 .g2_kernel_a_hold
  s_add_u32 s26, s26, 1
  s_mov_b32 s34, 0xffff
  s_cmp_eq_u32 s26, 1
  s_cbranch_scc1 .g2_kernel_a_pk1
  v_and_b32 v8, 15, v2
  s_lshl_b32 s28, s16, 6
  s_add_u32 s28, s28, 157696
  v_lshl_add_u32 v8, v8, 2, s28
  s_lshl_b32 s28, s17, 2
  s_add_u32 s28, s28, s16
  s_lshl_b32 s28, s28, 16
  s_add_u32 s28, s28, s63
  s_add_u32 s28, s28, 0x800000
  s_add_u32 s20, s60, s28
  s_addc_u32 s21, s61, 0
  s_lshl_b32 s24, s18, 1
  s_and_b32 s24, s24, 6
  s_mov_b32 s25, 12
  s_mov_b32 s34, 0
  s_mov_b32 s36, 0xff
  s_mov_b32 s33, 0xff
  s_mov_b32 s38, 0
.g2_kernel_a_pk2:
  ds_read_b32 v7, v8
  s_add_u32 s38, s38, 1
  s_waitcnt lgkmcnt(0)
  v_cmp_ge_u32 vcc, s62, v7
  s_cbranch_vccz .g2_kernel_a_pkr
  s_cmp_lt_u32 s38, 524288
  s_cbranch_scc1 .g2_kernel_a_pk2
  s_branch .g2_kernel_a_pkr
.g2_kernel_a_pk1:
  s_mov_b32 s38, 0
.g2_kernel_a_pkl:
  ds_read_b32 v7, v8
  s_add_u32 s38, s38, 1
  s_waitcnt lgkmcnt(0)
  v_cmp_lt_u32 vcc, s62, v7
  s_mov_b32 s36, vcc_lo
  s_andn2_b32 s33, s36, s34
  s_cbranch_scc1 .g2_kernel_a_pkr
  s_cmp_lt_u32 s38, 524288
  s_cbranch_scc1 .g2_kernel_a_pkl
  s_not_b32 s33, s34
.g2_kernel_a_pkr:
  s_setpc_b64 s[68:69]
.g2_kernel_w_aw:
  v_mov_b32 v6, s71
  s_mov_b32 s38, 0
.g2_kernel_wg4:
  ds_read_b32 v7, v6 offset:52
  s_add_u32 s38, s38, 1
  s_waitcnt lgkmcnt(0)
  v_cmp_le_u32 vcc, 4, v7
  s_cbranch_vccnz .g2_kernel_wg4d
  s_sleep 1
  s_cmp_lt_u32 s38, 524288
  s_cbranch_scc1 .g2_kernel_wg4
.g2_kernel_wg4d:
  s_branch .g2_kernel_w_ab
.g2_kernel_w_pt:
  v_lshlrev_b32 v7, 5, v17
  v_add_u32 v7, 155648, v7
  s_mov_b64 exec, vcc
  ds_read_b128 v[240:243], v7 offset:7680
  ds_read_b128 v[244:247], v7 offset:7696
  ds_read_b128 v[248:251], v7 offset:7744
  ds_read_b128 v[252:255], v7 offset:7760
  s_waitcnt lgkmcnt(0)
  v_pk_add_f32 v[24:25], v[24:25], v[240:241]
  v_pk_add_f32 v[26:27], v[26:27], v[242:243]
  v_pk_add_f32 v[28:29], v[28:29], v[244:245]
  v_pk_add_f32 v[30:31], v[30:31], v[246:247]
  v_pk_add_f32 v[32:33], v[32:33], v[248:249]
  v_pk_add_f32 v[34:35], v[34:35], v[250:251]
  v_pk_add_f32 v[36:37], v[36:37], v[252:253]
  v_pk_add_f32 v[38:39], v[38:39], v[254:255]
  ds_read_b128 v[240:243], v7 offset:7808
  ds_read_b128 v[244:247], v7 offset:7824
  ds_read_b128 v[248:251], v7 offset:7872
  ds_read_b128 v[252:255], v7 offset:7888
  s_waitcnt lgkmcnt(0)
  v_pk_add_f32 v[40:41], v[40:41], v[240:241]
  v_pk_add_f32 v[42:43], v[42:43], v[242:243]
  v_pk_add_f32 v[44:45], v[44:45], v[244:245]
  v_pk_add_f32 v[46:47], v[46:47], v[246:247]
  v_pk_add_f32 v[48:49], v[48:49], v[248:249]
  v_pk_add_f32 v[50:51], v[50:51], v[250:251]
  v_pk_add_f32 v[52:53], v[52:53], v[252:253]
  v_pk_add_f32 v[54:55], v[54:55], v[254:255]
  s_mov_b64 exec, -1
  s_branch .g2_kernel_w_pb
.g2_kernel_w_i8c:
  s_mov_b32 s38, 0
  s_call_b64 s[68:69], .g2_kernel_w_pkl
  s_branch .g2_kernel_w_i8b
.g2_kernel_w_i9c:
  s_mov_b32 s38, 0
  s_call_b64 s[68:69], .g2_kernel_w_pkl
  s_branch .g2_kernel_w_i9b
.g2_kernel_w_i10c:
  s_mov_b32 s38, 0
  s_call_b64 s[68:69], .g2_kernel_w_pkl
  s_branch .g2_kernel_w_i10b
.g2_kernel_w_i11c:
  s_mov_b32 s38, 0
  s_call_b64 s[68:69], .g2_kernel_w_pkl
  s_branch .g2_kernel_w_i11b
.g2_kernel_w_v8:
  s_cmp_ge_u32 s8, 139264
  s_cselect_b32 s28, 139264, 0
  s_sub_u32 s28, s8, s28
  s_lshr_b32 s28, s28, 1
  s_add_u32 s28, s28, 32768
  s_add_u32 s22, s20, s28
  s_addc_u32 s23, s21, 0
  s_mov_b32 s38, 0
.g2_kernel_w_vl8:
  global_load_dwordx4 v[88:91], v3, s[22:23] offset:0 sc1
  global_load_dwordx4 v[92:95], v3, s[22:23] offset:1024 sc1
  global_load_dwordx4 v[96:99], v3, s[22:23] offset:2048 sc1
  global_load_dwordx4 v[100:103], v3, s[22:23] offset:3072 sc1
  s_add_u32 s38, s38, 1
  s_waitcnt vmcnt(0)
  v_min3_u32 v6, v88, v90, v92
  v_min3_u32 v7, v94, v96, v98
  v_min3_u32 v6, v6, v100, v102
  v_min_u32 v6, v6, v7
  v_cmp_eq_u32 vcc, 0, v6
  s_cbranch_vccz .g2_kernel_w_vb8
  s_cmp_lt_u32 s38, 131072
  s_cbranch_scc1 .g2_kernel_w_vl8
  s_branch .g2_kernel_w_vb8
.g2_kernel_w_i12c:
  s_mov_b32 s38, 0
  s_call_b64 s[68:69], .g2_kernel_w_pkl
  s_branch .g2_kernel_w_i12b
.g2_kernel_w_v9:
  s_cmp_ge_u32 s9, 139264
  s_cselect_b32 s28, 139264, 0
  s_sub_u32 s28, s9, s28
  s_lshr_b32 s28, s28, 1
  s_add_u32 s28, s28, 32768
  s_add_u32 s22, s20, s28
  s_addc_u32 s23, s21, 0
  s_mov_b32 s38, 0
.g2_kernel_w_vl9:
  global_load_dwordx4 v[176:179], v3, s[22:23] offset:0 sc1
  global_load_dwordx4 v[180:183], v3, s[22:23] offset:1024 sc1
  global_load_dwordx4 v[184:187], v3, s[22:23] offset:2048 sc1
  global_load_dwordx4 v[188:191], v3, s[22:23] offset:3072 sc1
  s_add_u32 s38, s38, 1
  s_waitcnt vmcnt(0)
  v_min3_u32 v6, v176, v178, v180
  v_min3_u32 v7, v182, v184, v186
  v_min3_u32 v6, v6, v188, v190
  v_min_u32 v6, v6, v7
  v_cmp_eq_u32 vcc, 0, v6
  s_cbranch_vccz .g2_kernel_w_vb9
  s_cmp_lt_u32 s38, 131072
  s_cbranch_scc1 .g2_kernel_w_vl9
  s_branch .g2_kernel_w_vb9
.g2_kernel_w_i13c:
  s_mov_b32 s38, 0
  s_call_b64 s[68:69], .g2_kernel_w_pkl
  s_branch .g2_kernel_w_i13b
.g2_kernel_w_v10:
  s_cmp_ge_u32 s10, 139264
  s_cselect_b32 s28, 139264, 0
  s_sub_u32 s28, s10, s28
  s_lshr_b32 s28, s28, 1
  s_add_u32 s28, s28, 32768
  s_add_u32 s22, s20, s28
  s_addc_u32 s23, s21, 0
  s_mov_b32 s38, 0
.g2_kernel_w_vl10:
  global_load_dwordx4 v[192:195], v3, s[22:23] offset:0 sc1
  global_load_dwordx4 v[196:199], v3, s[22:23] offset:1024 sc1
  global_load_dwordx4 v[200:203], v3, s[22:23] offset:2048 sc1
  global_load_dwordx4 v[204:207], v3, s[22:23] offset:3072 sc1
  s_add_u32 s38, s38, 1
  s_waitcnt vmcnt(0)
  v_min3_u32 v6, v192, v194, v196
  v_min3_u32 v7, v198, v200, v202
  v_min3_u32 v6, v6, v204, v206
  v_min_u32 v6, v6, v7
  v_cmp_eq_u32 vcc, 0, v6
  s_cbranch_vccz .g2_kernel_w_vb10
  s_cmp_lt_u32 s38, 131072
  s_cbranch_scc1 .g2_kernel_w_vl10
  s_branch .g2_kernel_w_vb10
.g2_kernel_w_i14c:
  s_mov_b32 s38, 524288
  s_call_b64 s[68:69], .g2_kernel_w_pkl
  s_branch .g2_kernel_w_i14b
.g2_kernel_w_v11:
  s_cmp_ge_u32 s11, 139264
  s_cselect_b32 s28, 139264, 0
  s_sub_u32 s28, s11, s28
  s_lshr_b32 s28, s28, 1
  s_add_u32 s28, s28, 32768
  s_add_u32 s22, s20, s28
  s_addc_u32 s23, s21, 0
  s_mov_b32 s38, 0
.g2_kernel_w_vl11:
  global_load_dwordx4 v[208:211], v3, s[22:23] offset:0 sc1
  global_load_dwordx4 v[212:215], v3, s[22:23] offset:1024 sc1
  global_load_dwordx4 v[216:219], v3, s[22:23] offset:2048 sc1
  global_load_dwordx4 v[220:223], v3, s[22:23] offset:3072 sc1
  s_add_u32 s38, s38, 1
  s_waitcnt vmcnt(0)
  v_min3_u32 v6, v208, v210, v212
  v_min3_u32 v7, v214, v216, v218
  v_min3_u32 v6, v6, v220, v222
  v_min_u32 v6, v6, v7
  v_cmp_eq_u32 vcc, 0, v6
  s_cbranch_vccz .g2_kernel_w_vb11
  s_cmp_lt_u32 s38, 131072
  s_cbranch_scc1 .g2_kernel_w_vl11
  s_branch .g2_kernel_w_vb11
.g2_kernel_w_i15c:
  s_mov_b32 s38, 524288
  s_call_b64 s[68:69], .g2_kernel_w_pkl
  s_branch .g2_kernel_w_i15b
.g2_kernel_w_v12:
  s_cmp_ge_u32 s12, 139264
  s_cselect_b32 s28, 139264, 0
  s_sub_u32 s28, s12, s28
  s_lshr_b32 s28, s28, 1
  s_add_u32 s28, s28, 32768
  s_add_u32 s22, s20, s28
  s_addc_u32 s23, s21, 0
  s_mov_b32 s38, 0
.g2_kernel_w_vl12:
  global_load_dwordx4 v[224:227], v3, s[22:23] offset:0 sc1
  global_load_dwordx4 v[228:231], v3, s[22:23] offset:1024 sc1
  global_load_dwordx4 v[232:235], v3, s[22:23] offset:2048 sc1
  global_load_dwordx4 v[236:239], v3, s[22:23] offset:3072 sc1
  s_add_u32 s38, s38, 1
  s_waitcnt vmcnt(0)
  v_min3_u32 v6, v224, v226, v228
  v_min3_u32 v7, v230, v232, v234
  v_min3_u32 v6, v6, v236, v238
  v_min_u32 v6, v6, v7
  v_cmp_eq_u32 vcc, 0, v6
  s_cbranch_vccz .g2_kernel_w_vb12
  s_cmp_lt_u32 s38, 131072
  s_cbranch_scc1 .g2_kernel_w_vl12
  s_branch .g2_kernel_w_vb12
.g2_kernel_w_v13:
  s_cmp_ge_u32 s13, 139264
  s_cselect_b32 s28, 139264, 0
  s_sub_u32 s28, s13, s28
  s_lshr_b32 s28, s28, 1
  s_add_u32 s28, s28, 32768
  s_add_u32 s22, s20, s28
  s_addc_u32 s23, s21, 0
  s_mov_b32 s38, 0
.g2_kernel_w_vl13:
  global_load_dwordx4 v[136:139], v3, s[22:23] offset:0 sc1
  global_load_dwordx4 v[140:143], v3, s[22:23] offset:1024 sc1
  global_load_dwordx4 v[144:147], v3, s[22:23] offset:2048 sc1
  global_load_dwordx4 v[148:151], v3, s[22:23] offset:3072 sc1
  s_add_u32 s38, s38, 1
  s_waitcnt vmcnt(0)
  v_min3_u32 v6, v136, v138, v140
  v_min3_u32 v7, v142, v144, v146
  v_min3_u32 v6, v6, v148, v150
  v_min_u32 v6, v6, v7
  v_cmp_eq_u32 vcc, 0, v6
  s_cbranch_vccz .g2_kernel_w_vb13
  s_cmp_lt_u32 s38, 131072
  s_cbranch_scc1 .g2_kernel_w_vl13
  s_branch .g2_kernel_w_vb13
.g2_kernel_w_v14:
  s_cmp_ge_u32 s14, 139264
  s_cselect_b32 s28, 139264, 0
  s_sub_u32 s28, s14, s28
  s_lshr_b32 s28, s28, 1
  s_add_u32 s28, s28, 32768
  s_add_u32 s22, s20, s28
  s_addc_u32 s23, s21, 0
  s_mov_b32 s38, 0
.g2_kernel_w_vl14:
  global_load_dwordx4 v[152:155], v3, s[22:23] offset:0 sc1
  global_load_dwordx4 v[156:159], v3, s[22:23] offset:1024 sc1
  global_load_dwordx4 v[160:163], v3, s[22:23] offset:2048 sc1
  global_load_dwordx4 v[164:167], v3, s[22:23] offset:3072 sc1
  s_add_u32 s38, s38, 1
  s_waitcnt vmcnt(0)
  v_min3_u32 v6, v152, v154, v156
  v_min3_u32 v7, v158, v160, v162
  v_min3_u32 v6, v6, v164, v166
  v_min_u32 v6, v6, v7
  v_cmp_eq_u32 vcc, 0, v6
  s_cbranch_vccz .g2_kernel_w_vb14
  s_cmp_lt_u32 s38, 131072
  s_cbranch_scc1 .g2_kernel_w_vl14
  s_branch .g2_kernel_w_vb14
.g2_kernel_w_v15:
  s_cmp_ge_u32 s15, 139264
  s_cselect_b32 s28, 139264, 0
  s_sub_u32 s28, s15, s28
  s_lshr_b32 s28, s28, 1
  s_add_u32 s28, s28, 32768
  s_add_u32 s22, s20, s28
  s_addc_u32 s23, s21, 0
  s_mov_b32 s38, 0
.g2_kernel_w_vl15:
  global_load_dwordx4 v[56:59], v3, s[22:23] offset:0 sc1
  global_load_dwordx4 v[60:63], v3, s[22:23] offset:1024 sc1
  global_load_dwordx4 v[64:67], v3, s[22:23] offset:2048 sc1
  global_load_dwordx4 v[68:71], v3, s[22:23] offset:3072 sc1
  s_add_u32 s38, s38, 1
  s_waitcnt vmcnt(0)
  v_min3_u32 v6, v56, v58, v60
  v_min3_u32 v7, v62, v64, v66
  v_min3_u32 v6, v6, v68, v70
  v_min_u32 v6, v6, v7
  v_cmp_eq_u32 vcc, 0, v6
  s_cbranch_vccz .g2_kernel_w_vb15
  s_cmp_lt_u32 s38, 131072
  s_cbranch_scc1 .g2_kernel_w_vl15
  s_branch .g2_kernel_w_vb15
.g2_kernel_w_bw:
  s_mov_b32 s38, 0
.g2_kernel_w_bwl:
  ds_read_b32 v16, v20 offset:12
  s_add_u32 s38, s38, 1
  s_waitcnt lgkmcnt(0)
  v_cmp_gt_u32 vcc, 4, v16
  s_cbranch_vccz .g2_kernel_w_bb
  s_cmp_lt_u32 s38, 524288
  s_cbranch_scc1 .g2_kernel_w_bwl
  s_branch .g2_kernel_w_bb
.g2_kernel_w_pick:
  s_mov_b32 s38, 0
.g2_kernel_w_pkl:
  ds_read_b64 v[6:7], v21
  s_add_u32 s38, s38, 1
  s_waitcnt lgkmcnt(0)
  v_min_u32 v6, v6, v7
  v_cmp_lt_u32 vcc, s62, v6
  s_and_b32 s36, vcc_lo, 0xff00
  s_andn2_b32 s33, s36, s34
  s_cbranch_scc1 .g2_kernel_w_pkr
  s_cmp_lt_u32 s38, 524288
  s_cbranch_scc1 .g2_kernel_w_pkl
  s_andn2_b32 s33, 0xff00, s34
.g2_kernel_w_pkr:
  s_setpc_b64 s[68:69]
.g2_kernel_p_spin:
  s_mov_b32 s38, 0
.g2_kernel_p_spinl:
  ds_read_b32 v10, v9
  s_add_u32 s38, s38, 1
  s_waitcnt lgkmcnt(0)
  v_cmp_gt_i32 vcc, s34, v10
  s_cbranch_vccz .g2_kernel_p_spinr
  s_sleep 1
  s_cmp_lt_u32 s38, 524288
  s_cbranch_scc1 .g2_kernel_p_spinl
.g2_kernel_p_spinr:
  s_setpc_b64 s[68:69]
.g2_kernel_p1_aw:
  s_call_b64 s[68:69], .g2_kernel_p_spin
  s_branch .g2_kernel_p1_ai
.g2_kernel_p1_bw:
  s_call_b64 s[68:69], .g2_kernel_p_spin
  s_branch .g2_kernel_p1_bi
.g2_kernel_v_3a:
  s_and_b32 s31, s76, 0xffffe000
  s_add_u32 s31, s31, 0
  v_and_b32 v6, 15, v2
  v_lshlrev_b32 v6, 9, v6
  v_lshrrev_b32 v7, 4, v2
  v_lshl_add_u32 v6, v7, 7, v6
  v_lshlrev_b32 v7, 2, v2
  v_add_u32 v7, 157440, v7
  s_mov_b32 m0, 157440
  s_mov_b32 s38, 0
  s_mov_b32 exec_lo, 0xffff0000
  s_mov_b32 exec_hi, 0xffff0000
.g2_kernel_pa22:
  buffer_load_dword v6, s[4:7], s31 offen sc1 lds
  s_add_u32 s38, s38, 1
  s_waitcnt vmcnt(0)
  ds_read_b32 v8, v7
  s_waitcnt lgkmcnt(0)
  v_cmp_ge_u32 vcc, s62, v8
  s_cbranch_vccz .g2_kernel_pa22d
  s_mov_b64 exec, vcc
  s_sleep 16
  s_cmp_lt_u32 s38, 131072
  s_cbranch_scc1 .g2_kernel_pa22
.g2_kernel_pa22d:
  s_mov_b64 exec, -1
  s_branch .g2_kernel_v_3
.g2_kernel_v_may:
  s_cmp_lg_u32 s39, 0
  s_cbranch_scc1 .g2_kernel_v_mr
  s_and_b32 s28, s16, 3
  s_lshl_b32 s28, s28, 4
  s_add_u32 s28, s28, 155968
  v_mov_b32 v6, s28
  ds_read_b32 v7, v6
  s_waitcnt lgkmcnt(0)
  v_cmp_ne_u32 vcc, 0, v7
  s_cbranch_vccz .g2_kernel_v_mr
.g2_kernel_v_do:
  s_mov_b32 s39, 1
  s_mov_b32 s29, 0
  s_call_b64 s[68:69], .g2_kernel_v_cmb
  s_waitcnt vmcnt(0)
  v_mov_b32 v6, s71
  s_mov_b64 exec, 1
  ds_add_u32 v6, v5 offset:8
  s_mov_b64 exec, -1
  s_and_b32 s33, s16, 3
  s_lshl_b32 s33, s33, 7
  s_lshl_b32 s28, s29, 2
  s_add_u32 s33, s33, s28
  s_add_u32 s31, s19, s33
  v_mov_b32 v6, s70
  s_mov_b64 exec, 1
  buffer_store_dword v6, v4, s[4:7], s31 offen offset:0 sc1
  s_mov_b64 exec, -1
.g2_kernel_v_mr:
  s_setpc_b64 s[26:27]
.g2_kernel_v_wo:
  s_mov_b32 s8, s44
  s_mov_b32 s9, s45
  s_mov_b32 s10, 0x200000
  s_mov_b32 s11, 0x00020000
  v_lshrrev_b32 v6, 3, v2
  v_and_b32 v7, 7, v2
  v_bfe_u32 v8, v2, 4, 1
  v_lshlrev_b32 v8, 2, v8
  v_xor_b32 v7, v7, v8
  v_lshlrev_b32 v7, 4, v7
  v_lshl_add_u32 v6, v6, 11, v7
  s_and_b32 s31, s16, 3
  s_lshl_b32 s31, s31, 3
  s_add_u32 s31, s31, s29
  s_lshl_b32 s31, s31, 16
  s_lshl_b32 s33, s18, 7
  s_add_u32 s31, s31, s33
  s_mov_b32 m0, s30
  s_nop 0
  buffer_load_dwordx4 v6, s[8:11], s31 offen lds
  s_add_u32 m0, m0, 1024
  s_add_u32 s31, s31, 16384
  s_sleep 1
  buffer_load_dwordx4 v6, s[8:11], s31 offen lds
  s_add_u32 m0, m0, 1024
  s_add_u32 s31, s31, 16384
  s_sleep 1
  buffer_load_dwordx4 v6, s[8:11], s31 offen lds
  s_add_u32 m0, m0, 1024
  s_add_u32 s31, s31, 16384
  s_sleep 1
  buffer_load_dwordx4 v6, s[8:11], s31 offen lds
  s_add_u32 m0, m0, 1024
  s_add_u32 s31, s31, 81920
  s_sleep 1
  buffer_load_dwordx4 v6, s[8:11], s31 offen lds
  s_add_u32 m0, m0, 1024
  s_add_u32 s31, s31, 16384
  s_sleep 1
  buffer_load_dwordx4 v6, s[8:11], s31 offen lds
  s_add_u32 m0, m0, 1024
  s_add_u32 s31, s31, 16384
  s_sleep 1
  buffer_load_dwordx4 v6, s[8:11], s31 offen lds
  s_add_u32 m0, m0, 1024
  s_add_u32 s31, s31, 16384
  s_sleep 1
  buffer_load_dwordx4 v6, s[8:11], s31 offen lds
  s_add_u32 m0, m0, 1024
  s_add_u32 s31, s31, 81920
  s_sleep 1
  buffer_load_dwordx4 v6, s[8:11], s31 offen lds
  s_add_u32 m0, m0, 1024
  s_add_u32 s31, s31, 16384
  s_sleep 1
  buffer_load_dwordx4 v6, s[8:11], s31 offen lds
  s_add_u32 m0, m0, 1024
  s_add_u32 s31, s31, 16384
  s_sleep 1
  buffer_load_dwordx4 v6, s[8:11], s31 offen lds
  s_add_u32 m0, m0, 1024
  s_add_u32 s31, s31, 16384
  s_sleep 1
  buffer_load_dwordx4 v6, s[8:11], s31 offen lds
  s_add_u32 m0, m0, 1024
  s_add_u32 s31, s31, 81920
  s_sleep 1
  buffer_load_dwordx4 v6, s[8:11], s31 offen lds
  s_add_u32 m0, m0, 1024
  s_add_u32 s31, s31, 16384
  s_sleep 1
  buffer_load_dwordx4 v6, s[8:11], s31 offen lds
  s_add_u32 m0, m0, 1024
  s_add_u32 s31, s31, 16384
  s_sleep 1
  buffer_load_dwordx4 v6, s[8:11], s31 offen lds
  s_add_u32 m0, m0, 1024
  s_add_u32 s31, s31, 16384
  s_sleep 1
  buffer_load_dwordx4 v6, s[8:11], s31 offen lds
  s_setpc_b64 s[68:69]
.g2_kernel_v_cmb:
  s_and_b32 s28, s16, 3
  s_lshl_b32 s30, s28, 2
  s_lshl_b32 s34, 15, s30
  s_lshr_b32 s32, s34, 4
  s_or_b32 s32, s32, s34
  s_mul_i32 s32, s32, s29
  v_and_b32 v6, 15, v2
  v_lshlrev_b32 v6, 2, v6
  v_add_u32 v6, 155968, v6
  s_mov_b32 s30, .g2_kernel_sel-.g2_kernel_pc
  buffer_load_dwordx4 v[8:11], v3, s[64:67], s30 offen
  buffer_load_dwordx4 v[12:15], v3, s[64:67], s30 offen offset:1024
  s_lshl_b32 s30, s28, 13
  v_add_u32 v0, s30, v3
  v_and_b32 v4, 31, v2
  s_lshl_b32 s31, s28, 9
  s_add_u32 s31, s31, 161280
  v_lshl_add_u32 v4, v4, 2, s31
  s_lshl_b32 s33, s62, 1
  s_add_u32 s33, s33, s29
  s_lshl_b32 s31, s17, 2
  s_add_u32 s31, s31, s28
  s_lshl_b32 s31, s31, 1
  s_add_u32 s31, s31, s29
  s_lshl_b32 s31, s31, 4
  s_add_u32 s31, s31, s18
  s_lshl_b32 s31, s31, 11
  s_add_u32 s31, s31, s63
  s_add_u32 s35, s31, 0x800000
  s_mov_b32 s38, 0
  s_waitcnt vmcnt(0)
.g2_kernel_v_cmbw:
  ds_read_b32 v7, v6
  s_add_u32 s38, s38, 1
  s_waitcnt lgkmcnt(0)
  v_cmp_ge_u32 vcc, s33, v7
  s_and_b32 s30, vcc_lo, s34
  s_cbranch_scc0 .g2_kernel_v_cmbd
  s_orn2_b32 s30, vcc_lo, s32
  s_cmp_lg_u32 s30, -1
  s_cbranch_scc1 .g2_kernel_v_cmbq
  s_sleep 6
.g2_kernel_v_cmbq:
  s_sleep 1
  s_cmp_lt_u32 s38, 524288
  s_cbranch_scc1 .g2_kernel_v_cmbw
.g2_kernel_v_cmbd:
  s_setprio 3
  ds_read_b128 v[32:35], v0 offset:0
  ds_read_b128 v[36:39], v0 offset:1024
  ds_read_b128 v[40:43], v0 offset:2048
  ds_read_b128 v[44:47], v0 offset:3072
  ds_read_b128 v[48:51], v0 offset:4096
  ds_read_b128 v[52:55], v0 offset:5120
  ds_read_b128 v[56:59], v0 offset:6144
  ds_read_b128 v[60:63], v0 offset:7168
  ds_read2_b32 v[6:7], v4 offset0:64 offset1:96
  ds_read2_b32 v[4:5], v4 offset0:0 offset1:32
  s_lshl_b32 s30, s28, 2
  s_add_u32 s30, s30, s71
  s_waitcnt lgkmcnt(9)
  v_mfma_f32_32x32x16_bf16 v[16:31], v[8:11], v[32:35], 0
  s_waitcnt lgkmcnt(8)
  v_mfma_f32_32x32x16_bf16 v[16:31], v[12:15], v[36:39], v[16:31]
  s_waitcnt lgkmcnt(7)
  v_mfma_f32_32x32x16_bf16 v[16:31], v[8:11], v[40:43], v[16:31]
  s_waitcnt lgkmcnt(6)
  v_mfma_f32_32x32x16_bf16 v[16:31], v[12:15], v[44:47], v[16:31]
  s_waitcnt lgkmcnt(5)
  v_mfma_f32_32x32x16_bf16 v[16:31], v[8:11], v[48:51], v[16:31]
  s_waitcnt lgkmcnt(4)
  v_mfma_f32_32x32x16_bf16 v[16:31], v[12:15], v[52:55], v[16:31]
  s_waitcnt lgkmcnt(3)
  v_mfma_f32_32x32x16_bf16 v[16:31], v[8:11], v[56:59], v[16:31]
  s_waitcnt lgkmcnt(2)
  v_mfma_f32_32x32x16_bf16 v[16:31], v[12:15], v[60:63], v[16:31]
  v_mov_b32 v0, s30
  s_waitcnt lgkmcnt(0)
  v_add_f32 v6, v6, v4
  v_add_f32 v7, v7, v5
  v_mov_b32 v4, 0
  v_mov_b32 v5, s29
  ds_write_b32 v0, v5 offset:64
  v_add_f32 v9, v6, v7
  s_mov_b32 s30, 8.673617379884035e-19
  s_mov_b32 s31, 1.152921504606847e+18
  v_rcp_f32 v10, v9
  v_cmp_le_f32 vcc, s30, v9
  v_cmp_ge_f32 s[36:37], s31, v9
  v_mov_b32 v5, 1
  v_mul_f32 v10, 4.0, v10
  s_and_b64 s[36:37], s[36:37], vcc
  v_cmp_o_f32 vcc, v16, v16
  s_and_b64 vcc, vcc, s[36:37]
  s_cmp_eq_u64 vcc, -1
  s_cbranch_scc0 .g2_kernel_v_cmbslow
.g2_kernel_v_cmbfin:
  v_mul_f32 v16, v16, v10
  v_mul_f32 v17, v17, v10
  v_mul_f32 v18, v18, v10
  v_mul_f32 v19, v19, v10
  v_mul_f32 v20, v20, v10
  v_mul_f32 v21, v21, v10
  v_mul_f32 v22, v22, v10
  v_mul_f32 v23, v23, v10
  v_cvt_pk_bf16_f32 v32, v16, v17
  v_cvt_pk_bf16_f32 v33, v18, v19
  v_cvt_pk_bf16_f32 v34, v20, v21
  v_cvt_pk_bf16_f32 v35, v22, v23
  v_max_u32 v32, 1, v32
  v_max_u32 v34, 1, v34
  buffer_store_dwordx4 v[32:35], v3, s[4:7], s35 offen offset:0 sc1
  v_mul_f32 v24, v24, v10
  v_mul_f32 v25, v25, v10
  v_mul_f32 v26, v26, v10
  v_mul_f32 v27, v27, v10
  v_mul_f32 v28, v28, v10
  v_mul_f32 v29, v29, v10
  v_mul_f32 v30, v30, v10
  v_mul_f32 v31, v31, v10
  v_cvt_pk_bf16_f32 v36, v24, v25
  v_cvt_pk_bf16_f32 v37, v26, v27
  v_cvt_pk_bf16_f32 v38, v28, v29
  v_cvt_pk_bf16_f32 v39, v30, v31
  v_max_u32 v36, 1, v36
  v_max_u32 v38, 1, v38
  buffer_store_dwordx4 v[36:39], v3, s[4:7], s35 offen offset:1024 sc1
  s_setprio 3
  s_setpc_b64 s[68:69]
.g2_kernel_v_cmbslow:
  s_setprio 0
  s_lshl_b32 s30, s28, 11
  s_mul_i32 s31, s29, -8192
  s_add_u32 s30, s30, s31
  s_add_u32 s30, s30, 139264
  v_add_u32 v6, s30, v3
  ds_read_b128 v[48:51], v6
  ds_read_b128 v[52:55], v6 offset:1024
  s_lshl_b32 s36, s18, 1
  s_add_u32 s36, s36, s29
  s_lshl_b32 s36, s36, 18
  s_add_u32 s36, s36, s63
  s_mov_b32 s30, s36
  s_mov_b32 s33, 64
  v_mov_b32 v10, 0xff800000
  s_waitcnt lgkmcnt(0)
.g2_kernel_v_cmbs1:
  buffer_load_dwordx4 v[56:59], v3, s[4:7], s30 offen offset:0
  buffer_load_dwordx4 v[60:63], v3, s[4:7], s30 offen offset:1024
  s_waitcnt vmcnt(0)
  v_mfma_f32_32x32x16_bf16 v[32:47], v[56:59], v[48:51], 0
  v_mfma_f32_32x32x16_bf16 v[32:47], v[60:63], v[52:55], v[32:47]
  s_nop 11
  v_max3_f32 v10, v10, v32, v33
  v_max3_f32 v10, v10, v34, v35
  v_max3_f32 v10, v10, v36, v37
  v_max3_f32 v10, v10, v38, v39
  v_max3_f32 v10, v10, v40, v41
  v_max3_f32 v10, v10, v42, v43
  v_max3_f32 v10, v10, v44, v45
  v_max3_f32 v10, v10, v46, v47
  s_add_u32 s30, s30, 4096
  s_sub_u32 s33, s33, 1
  s_cmp_lg_u32 s33, 0
  s_cbranch_scc1 .g2_kernel_v_cmbs1
  v_mov_b32 v11, v10
  s_nop 1
  v_permlane32_swap_b32 v11, v10
  v_max_f32 v10, v10, v11
  v_mov_b32 v9, 0
  v_mov_b32 v16, 0
  v_mov_b32 v17, 0
  v_mov_b32 v18, 0
  v_mov_b32 v19, 0
  v_mov_b32 v20, 0
  v_mov_b32 v21, 0
  v_mov_b32 v22, 0
  v_mov_b32 v23, 0
  v_mov_b32 v24, 0
  v_mov_b32 v25, 0
  v_mov_b32 v26, 0
  v_mov_b32 v27, 0
  v_mov_b32 v28, 0
  v_mov_b32 v29, 0
  v_mov_b32 v30, 0
  v_mov_b32 v31, 0
  s_mov_b32 s30, s36
  s_mov_b32 s33, 64
.g2_kernel_v_cmbs2:
  buffer_load_dwordx4 v[56:59], v3, s[4:7], s30 offen offset:0
  buffer_load_dwordx4 v[60:63], v3, s[4:7], s30 offen offset:1024
  s_waitcnt vmcnt(0)
  v_mfma_f32_32x32x16_bf16 v[32:47], v[56:59], v[48:51], 0
  v_mfma_f32_32x32x16_bf16 v[32:47], v[60:63], v[52:55], v[32:47]
  s_nop 11
  v_sub_f32 v32, v32, v10
  v_sub_f32 v33, v33, v10
  v_sub_f32 v34, v34, v10
  v_sub_f32 v35, v35, v10
  v_sub_f32 v36, v36, v10
  v_sub_f32 v37, v37, v10
  v_sub_f32 v38, v38, v10
  v_sub_f32 v39, v39, v10
  v_sub_f32 v40, v40, v10
  v_sub_f32 v41, v41, v10
  v_sub_f32 v42, v42, v10
  v_sub_f32 v43, v43, v10
  v_sub_f32 v44, v44, v10
  v_sub_f32 v45, v45, v10
  v_sub_f32 v46, v46, v10
  v_sub_f32 v47, v47, v10
  buffer_load_dwordx4 v[56:59], v3, s[4:7], s30 offen offset:2048
  buffer_load_dwordx4 v[60:63], v3, s[4:7], s30 offen offset:3072
  v_exp_f32 v32, v32
  v_exp_f32 v33, v33
  v_exp_f32 v34, v34
  v_exp_f32 v35, v35
  v_exp_f32 v36, v36
  v_exp_f32 v37, v37
  v_exp_f32 v38, v38
  v_exp_f32 v39, v39
  v_exp_f32 v40, v40
  v_exp_f32 v41, v41
  v_exp_f32 v42, v42
  v_exp_f32 v43, v43
  v_exp_f32 v44, v44
  v_exp_f32 v45, v45
  v_exp_f32 v46, v46
  v_exp_f32 v47, v47
  v_add_f32 v9, v9, v32
  v_add_f32 v9, v9, v33
  v_add_f32 v9, v9, v34
  v_add_f32 v9, v9, v35
  v_add_f32 v9, v9, v36
  v_add_f32 v9, v9, v37
  v_add_f32 v9, v9, v38
  v_add_f32 v9, v9, v39
  v_add_f32 v9, v9, v40
  v_add_f32 v9, v9, v41
  v_add_f32 v9, v9, v42
  v_add_f32 v9, v9, v43
  v_add_f32 v9, v9, v44
  v_add_f32 v9, v9, v45
  v_add_f32 v9, v9, v46
  v_add_f32 v9, v9, v47
  v_cvt_pk_bf16_f32 v32, v32, v33
  v_cvt_pk_bf16_f32 v33, v34, v35
  v_cvt_pk_bf16_f32 v34, v36, v37
  v_cvt_pk_bf16_f32 v35, v38, v39
  v_cvt_pk_bf16_f32 v36, v40, v41
  v_cvt_pk_bf16_f32 v37, v42, v43
  v_cvt_pk_bf16_f32 v38, v44, v45
  v_cvt_pk_bf16_f32 v39, v46, v47
  s_waitcnt vmcnt(0)
  v_mfma_f32_32x32x16_bf16 v[16:31], v[56:59], v[32:35], v[16:31]
  v_mfma_f32_32x32x16_bf16 v[16:31], v[60:63], v[36:39], v[16:31]
  s_nop 15
  s_add_u32 s30, s30, 4096
  s_sub_u32 s33, s33, 1
  s_cmp_lg_u32 s33, 0
  s_cbranch_scc1 .g2_kernel_v_cmbs2
  v_mov_b32 v11, v9
  s_nop 1
  v_permlane32_swap_b32 v11, v9
  v_add_f32 v9, v9, v11
  v_rcp_f32 v10, v9
  s_branch .g2_kernel_v_cmbfin
.g2_kernel_p2_xw:
  s_mov_b32 s38, 0
.g2_kernel_p2_xwl:
  ds_read_b32 v12, v11
  s_add_u32 s38, s38, 1
  s_waitcnt lgkmcnt(0)
  v_cmp_ne_u32 vcc, 0, v12
  s_and_b32 s37, vcc_lo, vcc_hi
  s_lshr_b32 s33, s37, 16
  s_and_b32 s37, s37, s33
  s_bitcmp1_b32 s37, s28
  s_cbranch_scc1 .g2_kernel_p2_xwr
  s_sleep 1
  s_cmp_lt_u32 s38, 524288
  s_cbranch_scc1 .g2_kernel_p2_xwl
.g2_kernel_p2_xwr:
  s_setpc_b64 s[68:69]
.g2_kernel_p2_x0w:
  s_call_b64 s[68:69], .g2_kernel_p2_xw
  s_branch .g2_kernel_p2_x0b
.g2_kernel_p2_x1w:
  s_call_b64 s[68:69], .g2_kernel_p2_xw
  s_branch .g2_kernel_p2_x1b
.g2_kernel_p2_x2w:
  s_call_b64 s[68:69], .g2_kernel_p2_xw
  s_branch .g2_kernel_p2_x2b
.g2_kernel_p2_aw:
  s_call_b64 s[68:69], .g2_kernel_p_spin
  s_branch .g2_kernel_p2_ai
.g2_kernel_p2_x3w:
  s_call_b64 s[68:69], .g2_kernel_p2_xw
  s_branch .g2_kernel_p2_x3b
.g2_kernel_p2_bw:
  s_call_b64 s[68:69], .g2_kernel_p_spin
  s_branch .g2_kernel_p2_bi
.g2_kernel_amax:
  v_mov_b32 v16, 0xff7fffff
  v_mov_b32 v17, 1
  v_mov_b32 v18, 0xff7fffff
  v_mov_b32 v19, 1
  v_mov_b32 v20, 0xff7fffff
  v_mov_b32 v21, 1
  v_mov_b32 v22, 0xff7fffff
  v_mov_b32 v23, 1
  s_mov_b32 s38, 0
  s_mov_b64 vcc, -1
  v_lshlrev_b32 v7, 5, v2
  s_add_u32 s28, s23, 4096
.g2_kernel_amaxl:
  s_and_b64 exec, vcc, s[8:9]
  s_cbranch_scc0 .g2_kernel_amaxn0
  buffer_load_dwordx2 v[16:17], v7, s[4:7], s23 offen offset:0 sc1
.g2_kernel_amaxn0:
  s_and_b64 exec, vcc, s[10:11]
  s_cbranch_scc0 .g2_kernel_amaxn1
  buffer_load_dwordx2 v[18:19], v7, s[4:7], s23 offen offset:2048 sc1
.g2_kernel_amaxn1:
  s_and_b64 exec, vcc, s[12:13]
  s_cbranch_scc0 .g2_kernel_amaxn2
  buffer_load_dwordx2 v[20:21], v7, s[4:7], s28 offen offset:0 sc1
.g2_kernel_amaxn2:
  s_and_b64 exec, vcc, s[14:15]
  s_cbranch_scc0 .g2_kernel_amaxn3
  buffer_load_dwordx2 v[22:23], v7, s[4:7], s28 offen offset:2048 sc1
.g2_kernel_amaxn3:
  s_mov_b64 exec, -1
  s_add_u32 s38, s38, 1
  s_waitcnt vmcnt(0)
  v_min3_u32 v6, v17, v19, v21
  v_min_u32 v6, v6, v23
  v_cmp_eq_u32 vcc, 0, v6
  s_cbranch_vccz .g2_kernel_amaxd
  s_sleep 4
  s_cmp_lg_u32 s62, 0
  s_cbranch_scc1 .g2_kernel_nap55
  s_sleep 20
.g2_kernel_nap55:
  s_cmp_eq_u32 s39, 1
  s_cbranch_scc0 .g2_kernel_amaxz
  s_sleep 8
.g2_kernel_amaxz:
  s_cmp_lt_u32 s38, 131072
  s_cbranch_scc1 .g2_kernel_amaxl
.g2_kernel_amaxd:
  s_mov_b32 s28, 0xffffffe7
  v_and_or_b32 v16, v16, s28, 0
  v_and_or_b32 v18, v18, s28, 8
  v_and_or_b32 v20, v20, s28, 16
  v_and_or_b32 v22, v22, s28, 24
  v_max3_f32 v6, v16, v18, v20
  v_max_f32 v6, v6, v22
  s_nop 1
  v_max_f32 v7, v6, v6 row_ror:8 row_mask:0xf bank_mask:0xf
  s_nop 1
  v_max_f32 v7, v7, v7 row_ror:4 row_mask:0xf bank_mask:0xf
  s_nop 1
  v_max_f32 v7, v7, v7 row_ror:2 row_mask:0xf bank_mask:0xf
  s_nop 1
  v_max_f32 v7, v7, v7 row_ror:1 row_mask:0xf bank_mask:0xf
  s_nop 1
  v_max_f32 v7, v7, v7 row_bcast:15 row_mask:0xa bank_mask:0xf
  s_nop 1
  v_max_f32 v7, v7, v7 row_bcast:31 row_mask:0xc bank_mask:0xf
  s_nop 0
  v_readlane_b32 s27, v7, 63
  s_nop 1
  v_cmp_eq_u32 vcc, s27, v6
  s_ff1_i32_b64 s77, vcc
  s_lshl_b32 s77, s77, 3
  s_and_b32 s28, s27, 7
  s_add_u32 s77, s77, s28
  s_and_b32 s28, s27, 24
  s_lshl_b32 s28, s28, 6
  s_add_u32 s77, s77, s28
  s_and_b32 s77, s77, 2047
  s_setpc_b64 s[68:69]
  .p2align 8
.g2_kernel_tab:
  .long 0, 1, 2, 3, 4, 5, 6, 7
  .long 8, 9, 10, 11, 12, 13, 14, 15
  .long 16, 17, 18, 19, 20, 21, 22, 23
  .long 24, 25, 26, 27, 28, 29, 30, 31
  .long 32, 33, 34, 35, 36, 37, 38, 39
  .long 40, 41, 42, 43, 44, 45, 46, 47
  .long 48, 49, 50, 51, 52, 53, 54, 55
  .long 56, 57, 58, 59, 60, 61, 62, 63
  .long 64, 65, 66, 67, 68, 69, 70, 71
  .p2align 4
.g2_kernel_sel:
  .long 0x3e80, 0x0, 0x0, 0x0
  .long 0x3e800000, 0x0, 0x0, 0x0
  .long 0x0, 0x3e80, 0x0, 0x0
  .long 0x0, 0x3e800000, 0x0, 0x0
  .long 0x0, 0x0, 0x0, 0x0
  .long 0x0, 0x0, 0x0, 0x0
  .long 0x0, 0x0, 0x0, 0x0
  .long 0x0, 0x0, 0x0, 0x0
  .long 0x0, 0x0, 0x3e80, 0x0
  .long 0x0, 0x0, 0x3e800000, 0x0
  .long 0x0, 0x0, 0x0, 0x3e80
  .long 0x0, 0x0, 0x0, 0x3e800000
  .long 0x0, 0x0, 0x0, 0x0
  .long 0x0, 0x0, 0x0, 0x0
  .long 0x0, 0x0, 0x0, 0x0
  .long 0x0, 0x0, 0x0, 0x0
  .long 0x0, 0x0, 0x0, 0x0
  .long 0x0, 0x0, 0x0, 0x0
  .long 0x0, 0x0, 0x0, 0x0
  .long 0x0, 0x0, 0x0, 0x0
  .long 0x0, 0x0, 0x0, 0x0
  .long 0x0, 0x0, 0x0, 0x0
  .long 0x0, 0x0, 0x0, 0x0
  .long 0x0, 0x0, 0x0, 0x0
  .long 0x0, 0x0, 0x0, 0x0
  .long 0x0, 0x0, 0x0, 0x0
  .long 0x0, 0x0, 0x0, 0x0
  .long 0x0, 0x0, 0x0, 0x0
  .long 0x0, 0x0, 0x0, 0x0
  .long 0x0, 0x0, 0x0, 0x0
  .long 0x0, 0x0, 0x0, 0x0
  .long 0x0, 0x0, 0x0, 0x0
  .long 0x0, 0x0, 0x0, 0x0
  .long 0x0, 0x0, 0x0, 0x0
  .long 0x0, 0x0, 0x0, 0x0
  .long 0x0, 0x0, 0x0, 0x0
  .long 0x3e80, 0x0, 0x0, 0x0
  .long 0x3e800000, 0x0, 0x0, 0x0
  .long 0x0, 0x3e80, 0x0, 0x0
  .long 0x0, 0x3e800000, 0x0, 0x0
  .long 0x0, 0x0, 0x0, 0x0
  .long 0x0, 0x0, 0x0, 0x0
  .long 0x0, 0x0, 0x0, 0x0
  .long 0x0, 0x0, 0x0, 0x0
  .long 0x0, 0x0, 0x3e80, 0x0
  .long 0x0, 0x0, 0x3e800000, 0x0
  .long 0x0, 0x0, 0x0, 0x3e80
  .long 0x0, 0x0, 0x0, 0x3e800000
  .long 0x0, 0x0, 0x0, 0x0
  .long 0x0, 0x0, 0x0, 0x0
  .long 0x0, 0x0, 0x0, 0x0
  .long 0x0, 0x0, 0x0, 0x0
  .long 0x0, 0x0, 0x0, 0x0
  .long 0x0, 0x0, 0x0, 0x0
  .long 0x0, 0x0, 0x0, 0x0
  .long 0x0, 0x0, 0x0, 0x0
  .long 0x0, 0x0, 0x0, 0x0
  .long 0x0, 0x0, 0x0, 0x0
  .long 0x0, 0x0, 0x0, 0x0
  .long 0x0, 0x0, 0x0, 0x0
  .long 0x0, 0x0, 0x0, 0x0
  .long 0x0, 0x0, 0x0, 0x0
  .long 0x0, 0x0, 0x0, 0x0
  .long 0x0, 0x0, 0x0, 0x0
  .long 0x0, 0x0, 0x0, 0x0
  .long 0x0, 0x0, 0x0, 0x0
  .long 0x0, 0x0, 0x0, 0x0
  .long 0x0, 0x0, 0x0, 0x0
  .long 0x0, 0x0, 0x0, 0x0
  .long 0x0, 0x0, 0x0, 0x0
  .long 0x0, 0x0, 0x0, 0x0
  .long 0x0, 0x0, 0x0, 0x0
  .long 0x0, 0x0, 0x0, 0x0
  .long 0x0, 0x0, 0x0, 0x0
  .long 0x0, 0x0, 0x0, 0x0
  .long 0x0, 0x0, 0x0, 0x0
  .long 0x0, 0x0, 0x0, 0x0
  .long 0x0, 0x0, 0x0, 0x0
  .long 0x0, 0x0, 0x0, 0x0
  .long 0x0, 0x0, 0x0, 0x0
  .long 0x3e80, 0x0, 0x0, 0x0
  .long 0x3e800000, 0x0, 0x0, 0x0
  .long 0x0, 0x3e80, 0x0, 0x0
  .long 0x0, 0x3e800000, 0x0, 0x0
  .long 0x0, 0x0, 0x0, 0x0
  .long 0x0, 0x0, 0x0, 0x0
  .long 0x0, 0x0, 0x0, 0x0
  .long 0x0, 0x0, 0x0, 0x0
  .long 0x0, 0x0, 0x3e80, 0x0
  .long 0x0, 0x0, 0x3e800000, 0x0
  .long 0x0, 0x0, 0x0, 0x3e80
  .long 0x0, 0x0, 0x0, 0x3e800000
  .long 0x0, 0x0, 0x0, 0x0
  .long 0x0, 0x0, 0x0, 0x0
  .long 0x0, 0x0, 0x0, 0x0
  .long 0x0, 0x0, 0x0, 0x0
  .long 0x0, 0x0, 0x0, 0x0
  .long 0x0, 0x0, 0x0, 0x0
  .long 0x0, 0x0, 0x0, 0x0
  .long 0x0, 0x0, 0x0, 0x0
  .long 0x0, 0x0, 0x0, 0x0
  .long 0x0, 0x0, 0x0, 0x0
  .long 0x0, 0x0, 0x0, 0x0
  .long 0x0, 0x0, 0x0, 0x0
  .long 0x0, 0x0, 0x0, 0x0
  .long 0x0, 0x0, 0x0, 0x0
  .long 0x0, 0x0, 0x0, 0x0
  .long 0x0, 0x0, 0x0, 0x0
  .long 0x0, 0x0, 0x0, 0x0
  .long 0x0, 0x0, 0x0, 0x0
  .long 0x0, 0x0, 0x0, 0x0
  .long 0x0, 0x0, 0x0, 0x0
  .long 0x0, 0x0, 0x0, 0x0
  .long 0x0, 0x0, 0x0, 0x0
  .long 0x0, 0x0, 0x0, 0x0
  .long 0x0, 0x0, 0x0, 0x0
  .long 0x3e80, 0x0, 0x0, 0x0
  .long 0x3e800000, 0x0, 0x0, 0x0
  .long 0x0, 0x3e80, 0x0, 0x0
  .long 0x0, 0x3e800000, 0x0, 0x0
  .long 0x0, 0x0, 0x0, 0x0
  .long 0x0, 0x0, 0x0, 0x0
  .long 0x0, 0x0, 0x0, 0x0
  .long 0x0, 0x0, 0x0, 0x0
  .long 0x0, 0x0, 0x3e80, 0x0
  .long 0x0, 0x0, 0x3e800000, 0x0
  .long 0x0, 0x0, 0x0, 0x3e80
  .long 0x0, 0x0, 0x0, 0x3e800000
.g2_kernel_cend:

.section .rodata,"a"
.p2align 6
.amdhsa_kernel g2_kernel
  .amdhsa_next_free_vgpr 256
  .amdhsa_next_free_sgpr 102
  .amdhsa_accum_offset 256
  .amdhsa_group_segment_fixed_size 0
  .amdhsa_kernarg_size 88
  .amdhsa_user_sgpr_count 2
  .amdhsa_user_sgpr_kernarg_segment_ptr 1
  .amdhsa_system_sgpr_workgroup_id_x 1
.end_amdhsa_kernel
```

```asm
; @launch kernel=g2_kernel grid=(256,1,1) block=(512,1,1) lds=163840
.amdgcn_target "amdgcn-amd-amdhsa--gfx950"
.text
.globl g2_kernel
.p2align 8
.type g2_kernel,@function
g2_kernel:
  s_cmp_ge_u32 s2, 256
  s_cbranch_scc1 .g2_kernel_end
  s_load_dwordx16 s[40:55], s[0:1], 0
  s_load_dwordx4 s[56:59], s[0:1], 64
  s_load_dwordx2 s[60:61], s[0:1], 80
  s_getpc_b64 s[64:65]
.g2_kernel_pc:
  s_mov_b32 s66, .g2_kernel_cend-.g2_kernel_pc
  s_mov_b32 s67, 0x00020000
  s_lshl_b32 s12, s2, 10
  s_and_b32 s12, s12, 0xe000
  v_lshrrev_b32 v3, 3, v0
  v_and_b32 v2, 7, v0
  v_and_b32 v3, 0x38, v3
  v_add_lshl_u32 v3, v3, v2, 7
  s_mov_b64 exec, 0xff
  buffer_load_dword v1, v3, s[64:67], s12 offen
  s_mov_b64 exec, -1
  v_lshrrev_b32 v3, 6, v0
  v_and_b32 v2, 63, v0
  v_readfirstlane_b32 s16, v3
  s_and_b32 s21, s2, 7
  s_lshr_b32 s22, s2, 3
  s_and_b32 s23, s21, 3
  s_lshl_b32 s23, s23, 2
  s_and_b32 s24, s22, 3
  s_add_u32 s18, s23, s24
  s_lshr_b32 s24, s21, 2
  s_lshl_b32 s24, s24, 3
  s_lshr_b32 s25, s22, 2
  s_add_u32 s17, s24, s25
  s_lshl_b32 s19, s17, 4
  s_add_u32 s19, s19, s18
  s_lshl_b32 s19, s19, 9
  s_add_u32 s19, s19, 0x3000000
  s_lshl_b32 s76, s18, 4
  s_add_u32 s76, s76, s17
  s_lshl_b32 s76, s76, 9
  s_add_u32 s76, s76, 0x3020000
  v_lshlrev_b32 v3, 4, v2
  v_mov_b32 v4, 0
  v_mov_b32 v5, 1
  s_mov_b32 s62, 0
  s_mov_b32 s63, 0
  s_mov_b32 s70, 1
  s_mov_b32 s71, 155648
  s_waitcnt lgkmcnt(0)
  s_mov_b32 s4, s60
  s_mov_b32 s5, s61
  s_mov_b32 s6, 0x3200000
  s_mov_b32 s7, 0x00020000
  s_cmp_ge_u32 s16, 4
  s_cbranch_scc1 .g2_kernel_svc
  v_mov_b32 v20, 0
  v_mov_b32 v21, 0
  v_mov_b32 v22, 0
  v_mov_b32 v23, 0
  v_lshlrev_b32 v24, 4, v0
  v_cmp_gt_u32 vcc, 2816, v24
  v_add_u32 v24, 155648, v24
  s_and_saveexec_b64 s[20:21], vcc
  s_cbranch_execz .g2_kernel_q_nz
  ds_write_b128 v24, v[20:23]
.g2_kernel_q_nz:
  s_mov_b64 exec, -1
  v_and_b32 v20, 15, v2
  v_lshrrev_b32 v21, 4, v2
  v_lshrrev_b32 v22, 1, v20
  v_xor_b32 v22, v22, v21
  v_lshlrev_b32 v22, 4, v22
  v_lshl_add_u32 v22, v20, 7, v22
  s_lshr_b32 s26, s16, 1
  s_lshl_b32 s26, s26, 13
  v_add_u32 v144, s26, v22
  v_xor_b32 v145, 64, v144
.g2_kernel_q_cs:
  s_and_b32 s27, s16, 1
  s_lshr_b32 s26, s16, 1
  v_bfe_u32 v20, v2, 2, 2
  v_lshrrev_b32 v49, 4, v2
  v_lshl_add_u32 v22, v49, 3, v20
  v_lshlrev_b32 v22, 7, v22
  v_lshrrev_b32 v23, 1, v20
  v_and_b32 v21, 1, v49
  v_xor_b32 v21, s27, v21
  v_lshl_add_u32 v23, v21, 1, v23
  v_lshl_add_u32 v22, v23, 5, v22
  v_and_b32 v23, 3, v2
  v_lshl_add_u32 v22, v23, 3, v22
  v_add_u32 v148, 65536, v22
  v_xor_b32 v149, 32, v148
  v_mov_b32 v146, v148
  v_mov_b32 v147, v149
  v_mov_b32 v150, 156160
  v_and_b32 v48, 15, v2
  s_lshl_b32 s28, s26, 8
  s_add_u32 s28, s28, 155648
  v_lshl_add_u32 v50, v48, 2, s28
  v_lshl_add_u32 v51, v49, 4, s28
  s_lshl_b32 s28, s27, 7
  s_add_u32 s28, s28, 155648
  v_lshl_add_u32 v52, v49, 4, s28
  v_lshl_add_u32 v53, v48, 2, s28
  v_lshlrev_b32 v54, 9, v49
  v_lshl_add_u32 v55, v48, 4, v54
  v_and_b32 v56, 8, v48
  v_lshl_add_u32 v54, v56, 4, v55
  v_mov_b32 v56, 0.25503486164919736
  v_lshlrev_b32 v58, 8, v2
  v_and_b32 v58, 0x300, v58
  v_add_u32 v58, 156416, v58
  s_lshl_b32 s8, s18, 1
  s_add_u32 s8, s8, s27
  s_lshl_b32 s8, s8, 6
  s_lshl_b32 s9, s17, 2
  s_add_u32 s8, s8, s9
  s_lshl_b32 s9, s26, 1
  s_add_u32 s8, s8, s9
  s_lshl_b32 s8, s8, 12
  s_add_u32 s8, s8, s63
  s_add_u32 s9, s8, 4096
  s_lshl_b32 s28, s26, 13
  s_lshl_b32 s10, s27, 14
  s_add_u32 s28, s28, s10
  v_add_u32 v59, s28, v54
  v_add_u32 v60, s28, v55
  s_lshl_b32 s28, s26, 12
  s_mul_i32 s10, s27, -8192
  s_add_u32 s28, s28, s10
  s_add_u32 s28, s28, 139264
  v_add_u32 v61, s28, v55
  s_mov_b32 s10, s27
  s_lshl_b32 s77, s18, 4
  s_add_u32 s77, s77, s17
  s_lshl_b32 s77, s77, 1
  s_add_u32 s77, s77, s26
  s_lshl_b32 s77, s77, 13
  s_add_u32 s77, s77, s63
  s_add_u32 s77, s77, 0x1400000
  s_lshl_b32 s28, s27, 30
  s_add_u32 s77, s77, s28
  s_lshl_b32 s12, s62, 5
  s_add_u32 s12, s12, 28
  v_and_b32 v6, 15, v2
  v_xor_b32 v6, s17, v6
  v_and_b32 v7, 16, v2
  v_add_u32 v6, v6, v7
  s_lshr_b32 s28, s16, 1
  s_lshl_b32 s28, s28, 7
  s_add_u32 s28, s28, 157440
  v_lshl_add_u32 v8, v6, 2, s28
  s_lshl_b32 s28, s16, 12
  v_add_u32 v9, s28, v3
  v_and_b32 v6, 31, v2
  s_lshl_b32 s28, s16, 7
  s_add_u32 s28, s28, 161280
  v_lshl_add_u32 v10, v6, 2, s28
  s_lshl_b32 s28, s16, 2
  s_add_u32 s28, s28, 155968
  v_mov_b32 v11, s28
  s_lshl_b32 s28, s62, 1
  s_add_u32 s28, s28, 1
  v_mov_b32 v12, s28
  v_mov_b32 v13, s71
  v_add_u32 v14, 131072, v3
  v_and_b32 v6, 4, v2
  v_cmp_eq_u32 vcc, 0, v6
  v_mov_b32 v7, 0x3f803f80
  v_and_b32 v6, 1, v2
  v_cndmask_b32 v16, 0, v7, vcc
  v_cndmask_b32 v17, 0, v7, vcc
  v_cndmask_b32 v18, v7, 0, vcc
  v_cndmask_b32 v19, v7, 0, vcc
  v_mul_u32_u24 v20, 0xaaaa, v6
  v_add_u32 v20, 0x4444, v20
  s_lshl_b32 s28, s18, 7
  s_add_u32 s28, s28, s16
  s_lshl_b32 s28, s28, 12
  s_add_u32 s28, s28, s63
  s_add_u32 s20, s60, s28
  s_addc_u32 s21, s61, 0
  s_mov_b32 s24, s17
  s_mov_b32 s25, 14
  s_mov_b32 s26, 0
  s_mov_b32 s27, 6
  s_mov_b32 s34, 0xffff0001
  s_mov_b32 s35, 0
  s_mov_b32 s36, 0
  s_mov_b32 s39, 0
  s_lshl_b32 s28, s16, 7
  s_add_u32 s37, s76, s28
  v_mov_b32 v15, s70
  v_lshrrev_b32 v6, 5, v2
  v_and_b32 v7, 15, v2
  v_lshlrev_b32 v22, 4, v7
  v_lshl_add_u32 v22, v6, 8, v22
  v_and_b32 v7, 16, v2
  v_lshl_add_u32 v22, v7, 7, v22
  v_and_b32 v7, 31, v2
  v_lshlrev_b32 v23, 4, v6
  v_lshl_add_u32 v23, v7, 11, v23
  s_lshl_b32 s28, s17, 2
  s_add_u32 s28, s28, s16
  s_lshl_b32 s28, s28, 16
  s_lshl_b32 s29, s18, 7
  s_add_u32 s28, s28, s29
  s_add_u32 s74, s40, s28
  s_addc_u32 s75, s41, 0
  s_lshl_b32 s13, s17, 4
  s_add_u32 s13, s13, s18
  s_lshl_b32 s13, s13, 2
  s_add_u32 s13, s13, s16
  s_lshl_b32 s13, s13, 12
  s_add_u32 s13, s13, 0xc00000
  s_lshl_b32 s28, s16, 8
  s_add_u32 m0, s28, 156416
  s_lshl_b32 s33, s62, 5
  s_lshl_b32 s31, s33, 2
  s_add_u32 s31, s31, .g2_kernel_tab-.g2_kernel_pc+4
  s_mov_b32 s29, 0
  s_cmp_lg_u32 s62, 0
  s_cbranch_scc1 .g2_kernel_q_i2
  s_waitcnt lgkmcnt(0)
  s_barrier
.g2_kernel_q_i3:
  s_call_b64 s[68:69], .g2_kernel_q_spin
  ds_read_b64_tr_b16 v[80:81], v146 offset:0
  ds_read_b64_tr_b16 v[82:83], v146 offset:512
  ds_read_b128 v[64:67], v144 offset:0
  ds_read_b128 v[68:71], v144 offset:2048
  ds_read_b128 v[72:75], v144 offset:4096
  ds_read_b128 v[76:79], v144 offset:6144
  ds_read_b64_tr_b16 v[84:85], v147 offset:0
  ds_read_b64_tr_b16 v[86:87], v147 offset:512
  ds_read_b64_tr_b16 v[88:89], v146 offset:4096
  ds_read_b64_tr_b16 v[90:91], v146 offset:4608
  ds_read_b64_tr_b16 v[92:93], v147 offset:4096
  ds_read_b64_tr_b16 v[94:95], v147 offset:4608
  ds_read_b64_tr_b16 v[96:97], v146 offset:8192
  ds_read_b64_tr_b16 v[98:99], v146 offset:8704
  ds_read_b64_tr_b16 v[100:101], v147 offset:8192
  ds_read_b64_tr_b16 v[102:103], v147 offset:8704
  s_mov_b32 s30, 12288
  s_add_u32 s33, s33, 1
  v_add_u32 v146, s30, v148
  v_add_u32 v147, s30, v149
  s_waitcnt lgkmcnt(0)
  v_mfma_f32_16x16x32_bf16 v[160:163], v[80:83], v[64:67], 0
  v_cmp_lt_i32 vcc, s33, v151
  v_mfma_f32_16x16x32_bf16 v[164:167], v[80:83], v[68:71], 0
  s_cbranch_vccz .g2_kernel_q_wf
.g2_kernel_q_backf:
  v_mfma_f32_16x16x32_bf16 v[168:171], v[80:83], v[72:75], 0
  ds_read_b64_tr_b16 v[120:121], v146 offset:0
  v_mfma_f32_16x16x32_bf16 v[172:175], v[80:83], v[76:79], 0
  ds_read_b64_tr_b16 v[122:123], v146 offset:512
  v_mfma_f32_16x16x32_bf16 v[188:191], v[84:87], v[76:79], 0
  ds_read_b128 v[104:107], v145 offset:0
  v_mfma_f32_16x16x32_bf16 v[184:187], v[84:87], v[72:75], 0
  ds_read_b128 v[108:111], v145 offset:2048
  v_mfma_f32_16x16x32_bf16 v[180:183], v[84:87], v[68:71], 0
  ds_read_b128 v[112:115], v145 offset:4096
  v_mfma_f32_16x16x32_bf16 v[176:179], v[84:87], v[64:67], 0
  ds_read_b128 v[116:119], v145 offset:6144
  v_mfma_f32_16x16x32_bf16 v[192:195], v[88:91], v[64:67], 0
  ds_read_b64_tr_b16 v[124:125], v147 offset:0
  v_mfma_f32_16x16x32_bf16 v[196:199], v[88:91], v[68:71], 0
  ds_read_b64_tr_b16 v[126:127], v147 offset:512
  v_mfma_f32_16x16x32_bf16 v[200:203], v[88:91], v[72:75], 0
  ds_read_b64_tr_b16 v[128:129], v146 offset:4096
  v_mfma_f32_16x16x32_bf16 v[204:207], v[88:91], v[76:79], 0
  ds_read_b64_tr_b16 v[130:131], v146 offset:4608
  v_mfma_f32_16x16x32_bf16 v[220:223], v[92:95], v[76:79], 0
  ds_read_b64_tr_b16 v[132:133], v147 offset:4096
  v_mfma_f32_16x16x32_bf16 v[216:219], v[92:95], v[72:75], 0
  ds_read_b64_tr_b16 v[134:135], v147 offset:4608
  v_mfma_f32_16x16x32_bf16 v[212:215], v[92:95], v[68:71], 0
  ds_read_b64_tr_b16 v[136:137], v146 offset:8192
  v_mfma_f32_16x16x32_bf16 v[208:211], v[92:95], v[64:67], 0
  ds_read_b64_tr_b16 v[138:139], v146 offset:8704
  v_mfma_f32_16x16x32_bf16 v[224:227], v[64:67], v[96:99], 0
  ds_read_b64_tr_b16 v[140:141], v147 offset:8192
  v_mfma_f32_16x16x32_bf16 v[228:231], v[68:71], v[96:99], 0
  ds_read_b64_tr_b16 v[142:143], v147 offset:8704
  v_mfma_f32_16x16x32_bf16 v[232:235], v[72:75], v[96:99], 0
  ds_read_b32 v151, v150
  s_add_u32 s30, s30, 12288
  v_mfma_f32_16x16x32_bf16 v[236:239], v[76:79], v[96:99], 0
  buffer_load_dword off, s[64:67], s31 lds
  s_cmp_eq_u32 s30, 86016
  v_mfma_f32_16x16x32_bf16 v[252:255], v[76:79], v[100:103], 0
  s_cselect_b32 s30, 0, s30
  s_add_u32 s31, s31, 4
  v_mfma_f32_16x16x32_bf16 v[248:251], v[72:75], v[100:103], 0
  v_add_u32 v146, s30, v148
  s_add_u32 s33, s33, 1
  v_mfma_f32_16x16x32_bf16 v[244:247], v[68:71], v[100:103], 0
  v_add_u32 v147, s30, v149
  v_mfma_f32_16x16x32_bf16 v[240:243], v[64:67], v[100:103], 0
  s_branch .g2_kernel_q_s1
  .p2align 6
.g2_kernel_q_loop:
  s_waitcnt lgkmcnt(0)
  v_mfma_f32_16x16x32_bf16 v[160:163], v[120:123], v[104:107], v[160:163]
  v_cmp_lt_i32 vcc, s33, v151
  v_mfma_f32_16x16x32_bf16 v[164:167], v[120:123], v[108:111], v[164:167]
  s_cbranch_vccz .g2_kernel_q_w7
.g2_kernel_q_back7:
  v_mfma_f32_16x16x32_bf16 v[168:171], v[120:123], v[112:115], v[168:171]
  ds_read_b64_tr_b16 v[80:81], v146 offset:0
  v_mfma_f32_16x16x32_bf16 v[172:175], v[120:123], v[116:119], v[172:175]
  ds_read_b64_tr_b16 v[82:83], v146 offset:512
  v_mfma_f32_16x16x32_bf16 v[188:191], v[124:127], v[116:119], v[188:191]
  ds_read_b128 v[64:67], v144 offset:0
  v_mfma_f32_16x16x32_bf16 v[184:187], v[124:127], v[112:115], v[184:187]
  ds_read_b128 v[68:71], v144 offset:2048
  v_mfma_f32_16x16x32_bf16 v[180:183], v[124:127], v[108:111], v[180:183]
  ds_read_b128 v[72:75], v144 offset:4096
  v_mfma_f32_16x16x32_bf16 v[176:179], v[124:127], v[104:107], v[176:179]
  ds_read_b128 v[76:79], v144 offset:6144
  v_mfma_f32_16x16x32_bf16 v[192:195], v[128:131], v[104:107], v[192:195]
  ds_read_b64_tr_b16 v[84:85], v147 offset:0
  v_mfma_f32_16x16x32_bf16 v[196:199], v[128:131], v[108:111], v[196:199]
  ds_read_b64_tr_b16 v[86:87], v147 offset:512
  v_mfma_f32_16x16x32_bf16 v[200:203], v[128:131], v[112:115], v[200:203]
  ds_read_b64_tr_b16 v[88:89], v146 offset:4096
  v_mfma_f32_16x16x32_bf16 v[204:207], v[128:131], v[116:119], v[204:207]
  ds_read_b64_tr_b16 v[90:91], v146 offset:4608
  v_mfma_f32_16x16x32_bf16 v[220:223], v[132:135], v[116:119], v[220:223]
  ds_read_b64_tr_b16 v[92:93], v147 offset:4096
  v_mfma_f32_16x16x32_bf16 v[216:219], v[132:135], v[112:115], v[216:219]
  ds_read_b64_tr_b16 v[94:95], v147 offset:4608
  v_mfma_f32_16x16x32_bf16 v[212:215], v[132:135], v[108:111], v[212:215]
  ds_read_b64_tr_b16 v[96:97], v146 offset:8192
  v_mfma_f32_16x16x32_bf16 v[208:211], v[132:135], v[104:107], v[208:211]
  ds_read_b64_tr_b16 v[98:99], v146 offset:8704
  v_mfma_f32_16x16x32_bf16 v[224:227], v[104:107], v[136:139], v[224:227]
  ds_read_b64_tr_b16 v[100:101], v147 offset:8192
  v_mfma_f32_16x16x32_bf16 v[228:231], v[108:111], v[136:139], v[228:231]
  ds_read_b64_tr_b16 v[102:103], v147 offset:8704
  v_mfma_f32_16x16x32_bf16 v[232:235], v[112:115], v[136:139], v[232:235]
  ds_read_b32 v151, v150
  s_add_u32 s30, s30, 12288
  v_mfma_f32_16x16x32_bf16 v[236:239], v[116:119], v[136:139], v[236:239]
  buffer_load_dword off, s[64:67], s31 lds
  s_cmp_eq_u32 s30, 86016
  v_mfma_f32_16x16x32_bf16 v[252:255], v[116:119], v[140:143], v[252:255]
  s_cselect_b32 s30, 0, s30
  s_add_u32 s31, s31, 4
  v_mfma_f32_16x16x32_bf16 v[248:251], v[112:115], v[140:143], v[248:251]
  v_add_u32 v146, s30, v148
  s_add_u32 s33, s33, 1
  v_mfma_f32_16x16x32_bf16 v[244:247], v[108:111], v[140:143], v[244:247]
  v_add_u32 v147, s30, v149
  v_mfma_f32_16x16x32_bf16 v[240:243], v[104:107], v[140:143], v[240:243]
  s_waitcnt lgkmcnt(0)
  v_mfma_f32_16x16x32_bf16 v[160:163], v[80:83], v[64:67], v[160:163]
  v_cmp_lt_i32 vcc, s33, v151
  v_mfma_f32_16x16x32_bf16 v[164:167], v[80:83], v[68:71], v[164:167]
  s_cbranch_vccz .g2_kernel_q_w0
.g2_kernel_q_back0:
  v_mfma_f32_16x16x32_bf16 v[168:171], v[80:83], v[72:75], v[168:171]
  ds_read_b64_tr_b16 v[120:121], v146 offset:0
  v_mfma_f32_16x16x32_bf16 v[172:175], v[80:83], v[76:79], v[172:175]
  ds_read_b64_tr_b16 v[122:123], v146 offset:512
  v_mfma_f32_16x16x32_bf16 v[188:191], v[84:87], v[76:79], v[188:191]
  ds_read_b128 v[104:107], v145 offset:0
  v_mfma_f32_16x16x32_bf16 v[184:187], v[84:87], v[72:75], v[184:187]
  ds_read_b128 v[108:111], v145 offset:2048
  v_mfma_f32_16x16x32_bf16 v[180:183], v[84:87], v[68:71], v[180:183]
  ds_read_b128 v[112:115], v145 offset:4096
  v_mfma_f32_16x16x32_bf16 v[176:179], v[84:87], v[64:67], v[176:179]
  ds_read_b128 v[116:119], v145 offset:6144
  v_mfma_f32_16x16x32_bf16 v[192:195], v[88:91], v[64:67], v[192:195]
  ds_read_b64_tr_b16 v[124:125], v147 offset:0
  v_mfma_f32_16x16x32_bf16 v[196:199], v[88:91], v[68:71], v[196:199]
  ds_read_b64_tr_b16 v[126:127], v147 offset:512
  v_mfma_f32_16x16x32_bf16 v[200:203], v[88:91], v[72:75], v[200:203]
  ds_read_b64_tr_b16 v[128:129], v146 offset:4096
  v_mfma_f32_16x16x32_bf16 v[204:207], v[88:91], v[76:79], v[204:207]
  ds_read_b64_tr_b16 v[130:131], v146 offset:4608
  v_mfma_f32_16x16x32_bf16 v[220:223], v[92:95], v[76:79], v[220:223]
  ds_read_b64_tr_b16 v[132:133], v147 offset:4096
  v_mfma_f32_16x16x32_bf16 v[216:219], v[92:95], v[72:75], v[216:219]
  ds_read_b64_tr_b16 v[134:135], v147 offset:4608
  v_mfma_f32_16x16x32_bf16 v[212:215], v[92:95], v[68:71], v[212:215]
  ds_read_b64_tr_b16 v[136:137], v146 offset:8192
  v_mfma_f32_16x16x32_bf16 v[208:211], v[92:95], v[64:67], v[208:211]
  ds_read_b64_tr_b16 v[138:139], v146 offset:8704
  v_mfma_f32_16x16x32_bf16 v[224:227], v[64:67], v[96:99], v[224:227]
  ds_read_b64_tr_b16 v[140:141], v147 offset:8192
  v_mfma_f32_16x16x32_bf16 v[228:231], v[68:71], v[96:99], v[228:231]
  ds_read_b64_tr_b16 v[142:143], v147 offset:8704
  v_mfma_f32_16x16x32_bf16 v[232:235], v[72:75], v[96:99], v[232:235]
  ds_read_b32 v151, v150
  s_add_u32 s30, s30, 12288
  v_mfma_f32_16x16x32_bf16 v[236:239], v[76:79], v[96:99], v[236:239]
  buffer_load_dword off, s[64:67], s31 lds
  s_cmp_eq_u32 s30, 86016
  v_mfma_f32_16x16x32_bf16 v[252:255], v[76:79], v[100:103], v[252:255]
  s_cselect_b32 s30, 0, s30
  s_add_u32 s31, s31, 4
  v_mfma_f32_16x16x32_bf16 v[248:251], v[72:75], v[100:103], v[248:251]
  v_add_u32 v146, s30, v148
  s_add_u32 s33, s33, 1
  v_mfma_f32_16x16x32_bf16 v[244:247], v[68:71], v[100:103], v[244:247]
  v_add_u32 v147, s30, v149
  v_mfma_f32_16x16x32_bf16 v[240:243], v[64:67], v[100:103], v[240:243]
.g2_kernel_q_s1:
  s_waitcnt lgkmcnt(0)
  v_mfma_f32_16x16x32_bf16 v[160:163], v[120:123], v[104:107], v[160:163]
  v_cmp_lt_i32 vcc, s33, v151
  v_mfma_f32_16x16x32_bf16 v[164:167], v[120:123], v[108:111], v[164:167]
  s_cbranch_vccz .g2_kernel_q_w1
.g2_kernel_q_back1:
  v_mfma_f32_16x16x32_bf16 v[168:171], v[120:123], v[112:115], v[168:171]
  ds_read_b64_tr_b16 v[80:81], v146 offset:0
  v_mfma_f32_16x16x32_bf16 v[172:175], v[120:123], v[116:119], v[172:175]
  ds_read_b64_tr_b16 v[82:83], v146 offset:512
  v_mfma_f32_16x16x32_bf16 v[188:191], v[124:127], v[116:119], v[188:191]
  ds_read_b128 v[64:67], v144 offset:16384
  v_mfma_f32_16x16x32_bf16 v[184:187], v[124:127], v[112:115], v[184:187]
  ds_read_b128 v[68:71], v144 offset:18432
  v_mfma_f32_16x16x32_bf16 v[180:183], v[124:127], v[108:111], v[180:183]
  ds_read_b128 v[72:75], v144 offset:20480
  v_mfma_f32_16x16x32_bf16 v[176:179], v[124:127], v[104:107], v[176:179]
  ds_read_b128 v[76:79], v144 offset:22528
  v_mfma_f32_16x16x32_bf16 v[192:195], v[128:131], v[104:107], v[192:195]
  ds_read_b64_tr_b16 v[84:85], v147 offset:0
  v_mfma_f32_16x16x32_bf16 v[196:199], v[128:131], v[108:111], v[196:199]
  ds_read_b64_tr_b16 v[86:87], v147 offset:512
  v_mfma_f32_16x16x32_bf16 v[200:203], v[128:131], v[112:115], v[200:203]
  ds_read_b64_tr_b16 v[88:89], v146 offset:4096
  v_mfma_f32_16x16x32_bf16 v[204:207], v[128:131], v[116:119], v[204:207]
  ds_read_b64_tr_b16 v[90:91], v146 offset:4608
  v_mfma_f32_16x16x32_bf16 v[220:223], v[132:135], v[116:119], v[220:223]
  ds_read_b64_tr_b16 v[92:93], v147 offset:4096
  v_mfma_f32_16x16x32_bf16 v[216:219], v[132:135], v[112:115], v[216:219]
  ds_read_b64_tr_b16 v[94:95], v147 offset:4608
  v_mfma_f32_16x16x32_bf16 v[212:215], v[132:135], v[108:111], v[212:215]
  ds_read_b64_tr_b16 v[96:97], v146 offset:8192
  v_mfma_f32_16x16x32_bf16 v[208:211], v[132:135], v[104:107], v[208:211]
  ds_read_b64_tr_b16 v[98:99], v146 offset:8704
  v_mfma_f32_16x16x32_bf16 v[224:227], v[104:107], v[136:139], v[224:227]
  ds_read_b64_tr_b16 v[100:101], v147 offset:8192
  v_mfma_f32_16x16x32_bf16 v[228:231], v[108:111], v[136:139], v[228:231]
  ds_read_b64_tr_b16 v[102:103], v147 offset:8704
  v_mfma_f32_16x16x32_bf16 v[232:235], v[112:115], v[136:139], v[232:235]
  ds_read_b32 v151, v150
  s_add_u32 s30, s30, 12288
  v_mfma_f32_16x16x32_bf16 v[236:239], v[116:119], v[136:139], v[236:239]
  buffer_load_dword off, s[64:67], s31 lds
  s_cmp_eq_u32 s30, 86016
  v_mfma_f32_16x16x32_bf16 v[252:255], v[116:119], v[140:143], v[252:255]
  s_cselect_b32 s30, 0, s30
  s_add_u32 s31, s31, 4
  v_mfma_f32_16x16x32_bf16 v[248:251], v[112:115], v[140:143], v[248:251]
  v_add_u32 v146, s30, v148
  s_add_u32 s33, s33, 1
  v_mfma_f32_16x16x32_bf16 v[244:247], v[108:111], v[140:143], v[244:247]
  v_add_u32 v147, s30, v149
  v_mfma_f32_16x16x32_bf16 v[240:243], v[104:107], v[140:143], v[240:243]
  s_waitcnt lgkmcnt(0)
  v_mfma_f32_16x16x32_bf16 v[160:163], v[80:83], v[64:67], v[160:163]
  v_cmp_lt_i32 vcc, s33, v151
  v_mfma_f32_16x16x32_bf16 v[164:167], v[80:83], v[68:71], v[164:167]
  s_cbranch_vccz .g2_kernel_q_w2
.g2_kernel_q_back2:
  v_mfma_f32_16x16x32_bf16 v[168:171], v[80:83], v[72:75], v[168:171]
  ds_read_b64_tr_b16 v[120:121], v146 offset:0
  v_mfma_f32_16x16x32_bf16 v[172:175], v[80:83], v[76:79], v[172:175]
  ds_read_b64_tr_b16 v[122:123], v146 offset:512
  v_mfma_f32_16x16x32_bf16 v[188:191], v[84:87], v[76:79], v[188:191]
  ds_read_b128 v[104:107], v145 offset:16384
  v_mfma_f32_16x16x32_bf16 v[184:187], v[84:87], v[72:75], v[184:187]
  ds_read_b128 v[108:111], v145 offset:18432
  v_mfma_f32_16x16x32_bf16 v[180:183], v[84:87], v[68:71], v[180:183]
  ds_read_b128 v[112:115], v145 offset:20480
  v_mfma_f32_16x16x32_bf16 v[176:179], v[84:87], v[64:67], v[176:179]
  ds_read_b128 v[116:119], v145 offset:22528
  v_mfma_f32_16x16x32_bf16 v[192:195], v[88:91], v[64:67], v[192:195]
  ds_read_b64_tr_b16 v[124:125], v147 offset:0
  v_mfma_f32_16x16x32_bf16 v[196:199], v[88:91], v[68:71], v[196:199]
  ds_read_b64_tr_b16 v[126:127], v147 offset:512
  v_mfma_f32_16x16x32_bf16 v[200:203], v[88:91], v[72:75], v[200:203]
  ds_read_b64_tr_b16 v[128:129], v146 offset:4096
  v_mfma_f32_16x16x32_bf16 v[204:207], v[88:91], v[76:79], v[204:207]
  ds_read_b64_tr_b16 v[130:131], v146 offset:4608
  v_mfma_f32_16x16x32_bf16 v[220:223], v[92:95], v[76:79], v[220:223]
  ds_read_b64_tr_b16 v[132:133], v147 offset:4096
  v_mfma_f32_16x16x32_bf16 v[216:219], v[92:95], v[72:75], v[216:219]
  ds_read_b64_tr_b16 v[134:135], v147 offset:4608
  v_mfma_f32_16x16x32_bf16 v[212:215], v[92:95], v[68:71], v[212:215]
  ds_read_b64_tr_b16 v[136:137], v146 offset:8192
  v_mfma_f32_16x16x32_bf16 v[208:211], v[92:95], v[64:67], v[208:211]
  ds_read_b64_tr_b16 v[138:139], v146 offset:8704
  v_mfma_f32_16x16x32_bf16 v[224:227], v[64:67], v[96:99], v[224:227]
  ds_read_b64_tr_b16 v[140:141], v147 offset:8192
  v_mfma_f32_16x16x32_bf16 v[228:231], v[68:71], v[96:99], v[228:231]
  ds_read_b64_tr_b16 v[142:143], v147 offset:8704
  v_mfma_f32_16x16x32_bf16 v[232:235], v[72:75], v[96:99], v[232:235]
  ds_read_b32 v151, v150
  s_add_u32 s30, s30, 12288
  v_mfma_f32_16x16x32_bf16 v[236:239], v[76:79], v[96:99], v[236:239]
  buffer_load_dword off, s[64:67], s31 lds
  s_cmp_eq_u32 s30, 86016
  v_mfma_f32_16x16x32_bf16 v[252:255], v[76:79], v[100:103], v[252:255]
  s_cselect_b32 s30, 0, s30
  s_add_u32 s31, s31, 4
  v_mfma_f32_16x16x32_bf16 v[248:251], v[72:75], v[100:103], v[248:251]
  v_add_u32 v146, s30, v148
  s_add_u32 s33, s33, 1
  v_mfma_f32_16x16x32_bf16 v[244:247], v[68:71], v[100:103], v[244:247]
  v_add_u32 v147, s30, v149
  v_mfma_f32_16x16x32_bf16 v[240:243], v[64:67], v[100:103], v[240:243]
  s_waitcnt lgkmcnt(0)
  v_mfma_f32_16x16x32_bf16 v[160:163], v[120:123], v[104:107], v[160:163]
  v_cmp_lt_i32 vcc, s33, v151
  v_mfma_f32_16x16x32_bf16 v[164:167], v[120:123], v[108:111], v[164:167]
  s_cbranch_vccz .g2_kernel_q_w3
.g2_kernel_q_back3:
  v_mfma_f32_16x16x32_bf16 v[168:171], v[120:123], v[112:115], v[168:171]
  ds_read_b64_tr_b16 v[80:81], v146 offset:0
  v_mfma_f32_16x16x32_bf16 v[172:175], v[120:123], v[116:119], v[172:175]
  ds_read_b64_tr_b16 v[82:83], v146 offset:512
  v_mfma_f32_16x16x32_bf16 v[188:191], v[124:127], v[116:119], v[188:191]
  ds_read_b128 v[64:67], v144 offset:32768
  v_mfma_f32_16x16x32_bf16 v[184:187], v[124:127], v[112:115], v[184:187]
  ds_read_b128 v[68:71], v144 offset:34816
  v_mfma_f32_16x16x32_bf16 v[180:183], v[124:127], v[108:111], v[180:183]
  ds_read_b128 v[72:75], v144 offset:36864
  v_mfma_f32_16x16x32_bf16 v[176:179], v[124:127], v[104:107], v[176:179]
  ds_read_b128 v[76:79], v144 offset:38912
  v_mfma_f32_16x16x32_bf16 v[192:195], v[128:131], v[104:107], v[192:195]
  ds_read_b64_tr_b16 v[84:85], v147 offset:0
  v_mfma_f32_16x16x32_bf16 v[196:199], v[128:131], v[108:111], v[196:199]
  ds_read_b64_tr_b16 v[86:87], v147 offset:512
  v_mfma_f32_16x16x32_bf16 v[200:203], v[128:131], v[112:115], v[200:203]
  ds_read_b64_tr_b16 v[88:89], v146 offset:4096
  v_mfma_f32_16x16x32_bf16 v[204:207], v[128:131], v[116:119], v[204:207]
  ds_read_b64_tr_b16 v[90:91], v146 offset:4608
  v_mfma_f32_16x16x32_bf16 v[220:223], v[132:135], v[116:119], v[220:223]
  ds_read_b64_tr_b16 v[92:93], v147 offset:4096
  v_mfma_f32_16x16x32_bf16 v[216:219], v[132:135], v[112:115], v[216:219]
  ds_read_b64_tr_b16 v[94:95], v147 offset:4608
  v_mfma_f32_16x16x32_bf16 v[212:215], v[132:135], v[108:111], v[212:215]
  ds_read_b64_tr_b16 v[96:97], v146 offset:8192
  v_mfma_f32_16x16x32_bf16 v[208:211], v[132:135], v[104:107], v[208:211]
  ds_read_b64_tr_b16 v[98:99], v146 offset:8704
  v_mfma_f32_16x16x32_bf16 v[224:227], v[104:107], v[136:139], v[224:227]
  ds_read_b64_tr_b16 v[100:101], v147 offset:8192
  v_mfma_f32_16x16x32_bf16 v[228:231], v[108:111], v[136:139], v[228:231]
  ds_read_b64_tr_b16 v[102:103], v147 offset:8704
  v_mfma_f32_16x16x32_bf16 v[232:235], v[112:115], v[136:139], v[232:235]
  ds_read_b32 v151, v150
  s_add_u32 s30, s30, 12288
  v_mfma_f32_16x16x32_bf16 v[236:239], v[116:119], v[136:139], v[236:239]
  buffer_load_dword off, s[64:67], s31 lds
  s_cmp_eq_u32 s30, 86016
  v_mfma_f32_16x16x32_bf16 v[252:255], v[116:119], v[140:143], v[252:255]
  s_cselect_b32 s30, 0, s30
  s_add_u32 s31, s31, 4
  v_mfma_f32_16x16x32_bf16 v[248:251], v[112:115], v[140:143], v[248:251]
  v_add_u32 v146, s30, v148
  s_add_u32 s33, s33, 1
  v_mfma_f32_16x16x32_bf16 v[244:247], v[108:111], v[140:143], v[244:247]
  v_add_u32 v147, s30, v149
  v_mfma_f32_16x16x32_bf16 v[240:243], v[104:107], v[140:143], v[240:243]
  s_waitcnt lgkmcnt(0)
  v_mfma_f32_16x16x32_bf16 v[160:163], v[80:83], v[64:67], v[160:163]
  v_cmp_lt_i32 vcc, s33, v151
  v_mfma_f32_16x16x32_bf16 v[164:167], v[80:83], v[68:71], v[164:167]
  s_cbranch_vccz .g2_kernel_q_w4
.g2_kernel_q_back4:
  v_mfma_f32_16x16x32_bf16 v[168:171], v[80:83], v[72:75], v[168:171]
  ds_read_b64_tr_b16 v[120:121], v146 offset:0
  v_mfma_f32_16x16x32_bf16 v[172:175], v[80:83], v[76:79], v[172:175]
  ds_read_b64_tr_b16 v[122:123], v146 offset:512
  v_mfma_f32_16x16x32_bf16 v[188:191], v[84:87], v[76:79], v[188:191]
  ds_read_b128 v[104:107], v145 offset:32768
  v_mfma_f32_16x16x32_bf16 v[184:187], v[84:87], v[72:75], v[184:187]
  ds_read_b128 v[108:111], v145 offset:34816
  v_mfma_f32_16x16x32_bf16 v[180:183], v[84:87], v[68:71], v[180:183]
  ds_read_b128 v[112:115], v145 offset:36864
  v_mfma_f32_16x16x32_bf16 v[176:179], v[84:87], v[64:67], v[176:179]
  ds_read_b128 v[116:119], v145 offset:38912
  v_mfma_f32_16x16x32_bf16 v[192:195], v[88:91], v[64:67], v[192:195]
  ds_read_b64_tr_b16 v[124:125], v147 offset:0
  v_mfma_f32_16x16x32_bf16 v[196:199], v[88:91], v[68:71], v[196:199]
  ds_read_b64_tr_b16 v[126:127], v147 offset:512
  v_mfma_f32_16x16x32_bf16 v[200:203], v[88:91], v[72:75], v[200:203]
  ds_read_b64_tr_b16 v[128:129], v146 offset:4096
  v_mfma_f32_16x16x32_bf16 v[204:207], v[88:91], v[76:79], v[204:207]
  ds_read_b64_tr_b16 v[130:131], v146 offset:4608
  v_mfma_f32_16x16x32_bf16 v[220:223], v[92:95], v[76:79], v[220:223]
  ds_read_b64_tr_b16 v[132:133], v147 offset:4096
  v_mfma_f32_16x16x32_bf16 v[216:219], v[92:95], v[72:75], v[216:219]
  ds_read_b64_tr_b16 v[134:135], v147 offset:4608
  v_mfma_f32_16x16x32_bf16 v[212:215], v[92:95], v[68:71], v[212:215]
  ds_read_b64_tr_b16 v[136:137], v146 offset:8192
  v_mfma_f32_16x16x32_bf16 v[208:211], v[92:95], v[64:67], v[208:211]
  ds_read_b64_tr_b16 v[138:139], v146 offset:8704
  v_mfma_f32_16x16x32_bf16 v[224:227], v[64:67], v[96:99], v[224:227]
  ds_read_b64_tr_b16 v[140:141], v147 offset:8192
  v_mfma_f32_16x16x32_bf16 v[228:231], v[68:71], v[96:99], v[228:231]
  ds_read_b64_tr_b16 v[142:143], v147 offset:8704
  v_mfma_f32_16x16x32_bf16 v[232:235], v[72:75], v[96:99], v[232:235]
  ds_read_b32 v151, v150
  s_add_u32 s30, s30, 12288
  v_mfma_f32_16x16x32_bf16 v[236:239], v[76:79], v[96:99], v[236:239]
  buffer_load_dword off, s[64:67], s31 lds
  s_cmp_eq_u32 s30, 86016
  v_mfma_f32_16x16x32_bf16 v[252:255], v[76:79], v[100:103], v[252:255]
  s_cselect_b32 s30, 0, s30
  s_add_u32 s31, s31, 4
  v_mfma_f32_16x16x32_bf16 v[248:251], v[72:75], v[100:103], v[248:251]
  v_add_u32 v146, s30, v148
  s_add_u32 s33, s33, 1
  v_mfma_f32_16x16x32_bf16 v[244:247], v[68:71], v[100:103], v[244:247]
  v_add_u32 v147, s30, v149
  v_mfma_f32_16x16x32_bf16 v[240:243], v[64:67], v[100:103], v[240:243]
  s_waitcnt lgkmcnt(0)
  v_mfma_f32_16x16x32_bf16 v[160:163], v[120:123], v[104:107], v[160:163]
  v_cmp_lt_i32 vcc, s33, v151
  v_mfma_f32_16x16x32_bf16 v[164:167], v[120:123], v[108:111], v[164:167]
  s_cbranch_vccz .g2_kernel_q_w5
.g2_kernel_q_back5:
  v_mfma_f32_16x16x32_bf16 v[168:171], v[120:123], v[112:115], v[168:171]
  ds_read_b64_tr_b16 v[80:81], v146 offset:0
  v_mfma_f32_16x16x32_bf16 v[172:175], v[120:123], v[116:119], v[172:175]
  ds_read_b64_tr_b16 v[82:83], v146 offset:512
  v_mfma_f32_16x16x32_bf16 v[188:191], v[124:127], v[116:119], v[188:191]
  ds_read_b128 v[64:67], v144 offset:49152
  v_mfma_f32_16x16x32_bf16 v[184:187], v[124:127], v[112:115], v[184:187]
  ds_read_b128 v[68:71], v144 offset:51200
  v_mfma_f32_16x16x32_bf16 v[180:183], v[124:127], v[108:111], v[180:183]
  ds_read_b128 v[72:75], v144 offset:53248
  v_mfma_f32_16x16x32_bf16 v[176:179], v[124:127], v[104:107], v[176:179]
  ds_read_b128 v[76:79], v144 offset:55296
  v_mfma_f32_16x16x32_bf16 v[192:195], v[128:131], v[104:107], v[192:195]
  ds_read_b64_tr_b16 v[84:85], v147 offset:0
  v_mfma_f32_16x16x32_bf16 v[196:199], v[128:131], v[108:111], v[196:199]
  ds_read_b64_tr_b16 v[86:87], v147 offset:512
  v_mfma_f32_16x16x32_bf16 v[200:203], v[128:131], v[112:115], v[200:203]
  ds_read_b64_tr_b16 v[88:89], v146 offset:4096
  v_mfma_f32_16x16x32_bf16 v[204:207], v[128:131], v[116:119], v[204:207]
  ds_read_b64_tr_b16 v[90:91], v146 offset:4608
  v_mfma_f32_16x16x32_bf16 v[220:223], v[132:135], v[116:119], v[220:223]
  ds_read_b64_tr_b16 v[92:93], v147 offset:4096
  v_mfma_f32_16x16x32_bf16 v[216:219], v[132:135], v[112:115], v[216:219]
  ds_read_b64_tr_b16 v[94:95], v147 offset:4608
  v_mfma_f32_16x16x32_bf16 v[212:215], v[132:135], v[108:111], v[212:215]
  ds_read_b64_tr_b16 v[96:97], v146 offset:8192
  v_mfma_f32_16x16x32_bf16 v[208:211], v[132:135], v[104:107], v[208:211]
  ds_read_b64_tr_b16 v[98:99], v146 offset:8704
  v_mfma_f32_16x16x32_bf16 v[224:227], v[104:107], v[136:139], v[224:227]
  ds_read_b64_tr_b16 v[100:101], v147 offset:8192
  v_mfma_f32_16x16x32_bf16 v[228:231], v[108:111], v[136:139], v[228:231]
  ds_read_b64_tr_b16 v[102:103], v147 offset:8704
  v_mfma_f32_16x16x32_bf16 v[232:235], v[112:115], v[136:139], v[232:235]
  ds_read_b32 v151, v150
  s_add_u32 s30, s30, 12288
  v_mfma_f32_16x16x32_bf16 v[236:239], v[116:119], v[136:139], v[236:239]
  buffer_load_dword off, s[64:67], s31 lds
  s_cmp_eq_u32 s30, 86016
  v_mfma_f32_16x16x32_bf16 v[252:255], v[116:119], v[140:143], v[252:255]
  s_cselect_b32 s30, 0, s30
  s_add_u32 s31, s31, 4
  v_mfma_f32_16x16x32_bf16 v[248:251], v[112:115], v[140:143], v[248:251]
  v_add_u32 v146, s30, v148
  s_add_u32 s33, s33, 1
  v_mfma_f32_16x16x32_bf16 v[244:247], v[108:111], v[140:143], v[244:247]
  v_add_u32 v147, s30, v149
  v_mfma_f32_16x16x32_bf16 v[240:243], v[104:107], v[140:143], v[240:243]
  s_waitcnt lgkmcnt(0)
  v_mfma_f32_16x16x32_bf16 v[160:163], v[80:83], v[64:67], v[160:163]
  v_cmp_lt_i32 vcc, s33, v151
  v_mfma_f32_16x16x32_bf16 v[164:167], v[80:83], v[68:71], v[164:167]
  s_cbranch_vccz .g2_kernel_q_w6
.g2_kernel_q_back6:
  v_mfma_f32_16x16x32_bf16 v[168:171], v[80:83], v[72:75], v[168:171]
  ds_read_b64_tr_b16 v[120:121], v146 offset:0
  v_mfma_f32_16x16x32_bf16 v[172:175], v[80:83], v[76:79], v[172:175]
  ds_read_b64_tr_b16 v[122:123], v146 offset:512
  v_mfma_f32_16x16x32_bf16 v[188:191], v[84:87], v[76:79], v[188:191]
  ds_read_b128 v[104:107], v145 offset:49152
  v_mfma_f32_16x16x32_bf16 v[184:187], v[84:87], v[72:75], v[184:187]
  ds_read_b128 v[108:111], v145 offset:51200
  v_mfma_f32_16x16x32_bf16 v[180:183], v[84:87], v[68:71], v[180:183]
  ds_read_b128 v[112:115], v145 offset:53248
  v_mfma_f32_16x16x32_bf16 v[176:179], v[84:87], v[64:67], v[176:179]
  ds_read_b128 v[116:119], v145 offset:55296
  v_mfma_f32_16x16x32_bf16 v[192:195], v[88:91], v[64:67], v[192:195]
  ds_read_b64_tr_b16 v[124:125], v147 offset:0
  v_mfma_f32_16x16x32_bf16 v[196:199], v[88:91], v[68:71], v[196:199]
  ds_read_b64_tr_b16 v[126:127], v147 offset:512
  v_mfma_f32_16x16x32_bf16 v[200:203], v[88:91], v[72:75], v[200:203]
  ds_read_b64_tr_b16 v[128:129], v146 offset:4096
  v_mfma_f32_16x16x32_bf16 v[204:207], v[88:91], v[76:79], v[204:207]
  ds_read_b64_tr_b16 v[130:131], v146 offset:4608
  v_mfma_f32_16x16x32_bf16 v[220:223], v[92:95], v[76:79], v[220:223]
  ds_read_b64_tr_b16 v[132:133], v147 offset:4096
  v_mfma_f32_16x16x32_bf16 v[216:219], v[92:95], v[72:75], v[216:219]
  ds_read_b64_tr_b16 v[134:135], v147 offset:4608
  v_mfma_f32_16x16x32_bf16 v[212:215], v[92:95], v[68:71], v[212:215]
  ds_read_b64_tr_b16 v[136:137], v146 offset:8192
  v_mfma_f32_16x16x32_bf16 v[208:211], v[92:95], v[64:67], v[208:211]
  ds_read_b64_tr_b16 v[138:139], v146 offset:8704
  v_mfma_f32_16x16x32_bf16 v[224:227], v[64:67], v[96:99], v[224:227]
  ds_read_b64_tr_b16 v[140:141], v147 offset:8192
  v_mfma_f32_16x16x32_bf16 v[228:231], v[68:71], v[96:99], v[228:231]
  ds_read_b64_tr_b16 v[142:143], v147 offset:8704
  v_mfma_f32_16x16x32_bf16 v[232:235], v[72:75], v[96:99], v[232:235]
  ds_read_b32 v151, v150
  s_add_u32 s30, s30, 12288
  v_mfma_f32_16x16x32_bf16 v[236:239], v[76:79], v[96:99], v[236:239]
  buffer_load_dword off, s[64:67], s31 lds
  s_cmp_eq_u32 s30, 86016
  v_mfma_f32_16x16x32_bf16 v[252:255], v[76:79], v[100:103], v[252:255]
  s_cselect_b32 s30, 0, s30
  s_add_u32 s31, s31, 4
  v_mfma_f32_16x16x32_bf16 v[248:251], v[72:75], v[100:103], v[248:251]
  v_add_u32 v146, s30, v148
  s_add_u32 s33, s33, 1
  v_mfma_f32_16x16x32_bf16 v[244:247], v[68:71], v[100:103], v[244:247]
  v_add_u32 v147, s30, v149
  s_add_u32 s29, s29, 1
  v_mfma_f32_16x16x32_bf16 v[240:243], v[64:67], v[100:103], v[240:243]
  s_cmp_lg_u32 s29, 4
  s_cbranch_scc1 .g2_kernel_q_loop
  s_waitcnt lgkmcnt(0)
  v_mfma_f32_16x16x32_bf16 v[192:195], v[128:131], v[104:107], v[192:195]
  ds_read_b32 v62, v13 offset:0
  ds_read_b32 v63, v58
  v_mfma_f32_16x16x32_bf16 v[196:199], v[128:131], v[108:111], v[196:199]
  ds_read_b32 v57, v13 offset:24
  ds_read_b32 v21, v13 offset:84
  v_mfma_f32_16x16x32_bf16 v[200:203], v[128:131], v[112:115], v[200:203]
  ds_read_b128 v[40:43], v52 offset:5120
  ds_read_b128 v[44:47], v52 offset:5184
  v_mfma_f32_16x16x32_bf16 v[204:207], v[128:131], v[116:119], v[204:207]
  ds_read_b32 v24, v50 offset:2816
  ds_read_b32 v25, v50 offset:3328
  v_mfma_f32_16x16x32_bf16 v[220:223], v[132:135], v[116:119], v[220:223]
  ds_read_b32 v26, v50 offset:2880
  ds_read_b32 v27, v50 offset:3392
  v_mfma_f32_16x16x32_bf16 v[216:219], v[132:135], v[112:115], v[216:219]
  ds_read_b32 v28, v50 offset:2944
  ds_read_b32 v29, v50 offset:3456
  v_mfma_f32_16x16x32_bf16 v[212:215], v[132:135], v[108:111], v[212:215]
  ds_read_b32 v30, v50 offset:3008
  ds_read_b32 v31, v50 offset:3520
  v_mfma_f32_16x16x32_bf16 v[208:211], v[132:135], v[104:107], v[208:211]
  ds_read_b128 v[64:67], v51 offset:2816
  ds_read_b128 v[80:83], v51 offset:3328
  v_mfma_f32_16x16x32_bf16 v[224:227], v[104:107], v[136:139], v[224:227]
  ds_read_b128 v[68:71], v51 offset:2880
  v_mfma_f32_16x16x32_bf16 v[228:231], v[108:111], v[136:139], v[228:231]
  ds_read_b128 v[84:87], v51 offset:3392
  v_mfma_f32_16x16x32_bf16 v[232:235], v[112:115], v[136:139], v[232:235]
  ds_read_b128 v[72:75], v51 offset:2944
  v_mfma_f32_16x16x32_bf16 v[236:239], v[116:119], v[136:139], v[236:239]
  ds_read_b128 v[88:91], v51 offset:3456
  v_mfma_f32_16x16x32_bf16 v[252:255], v[116:119], v[140:143], v[252:255]
  ds_read_b128 v[76:79], v51 offset:3008
  v_mfma_f32_16x16x32_bf16 v[248:251], v[112:115], v[140:143], v[248:251]
  ds_read_b128 v[92:95], v51 offset:3520
  v_mfma_f32_16x16x32_bf16 v[244:247], v[108:111], v[140:143], v[244:247]
  ds_read_b32 v48, v53 offset:5376
  v_mfma_f32_16x16x32_bf16 v[240:243], v[104:107], v[140:143], v[240:243]
  ds_read_b32 v49, v53 offset:5440
  v_mfma_f32_16x16x32_bf16 v[160:163], v[120:123], v[104:107], v[160:163]
  ds_read_b128 v[32:35], v52 offset:4864
  v_mfma_f32_16x16x32_bf16 v[164:167], v[120:123], v[108:111], v[164:167]
  ds_read_b128 v[36:39], v52 offset:4928
  v_mfma_f32_16x16x32_bf16 v[168:171], v[120:123], v[112:115], v[168:171]
  v_mfma_f32_16x16x32_bf16 v[172:175], v[120:123], v[116:119], v[172:175]
  v_mfma_f32_16x16x32_bf16 v[188:191], v[124:127], v[116:119], v[188:191]
  buffer_load_dword off, s[64:67], s31 lds
  v_mfma_f32_16x16x32_bf16 v[184:187], v[124:127], v[112:115], v[184:187]
  v_mfma_f32_16x16x32_bf16 v[180:183], v[124:127], v[108:111], v[180:183]
  v_mfma_f32_16x16x32_bf16 v[176:179], v[124:127], v[104:107], v[176:179]
  s_waitcnt lgkmcnt(0)
  v_cmp_gt_u32 vcc, 2, v62
  v_cmp_gt_u32 s[14:15], s12, v63
  s_or_b64 vcc, vcc, s[14:15]
  s_cbranch_scc1 .g2_kernel_q_ew
.g2_kernel_q_eb:
  v_cmp_ne_u32 vcc, 0, v57
  s_cbranch_vccnz .g2_kernel_q_patch
.g2_kernel_q_pback:
  s_add_u32 s79, s77, 4096
  s_cmp_lg_u32 s10, 0
  s_cbranch_scc1 .g2_kernel_q_nk
  v_pk_mul_f32 v[152:153], v[40:41], v[24:25] op_sel:[0,1] op_sel_hi:[1,1]
  v_pk_mul_f32 v[154:155], v[42:43], v[24:25] op_sel:[0,1] op_sel_hi:[1,1]
  v_pk_mul_f32 v[156:157], v[44:45], v[24:25] op_sel:[0,1] op_sel_hi:[1,1]
  v_pk_mul_f32 v[158:159], v[46:47], v[24:25] op_sel:[0,1] op_sel_hi:[1,1]
  v_pk_fma_f32 v[192:193], v[192:193], v[24:25], v[152:153] op_sel_hi:[1,0,1]
  v_pk_fma_f32 v[194:195], v[194:195], v[24:25], v[154:155] op_sel_hi:[1,0,1]
  v_pk_fma_f32 v[208:209], v[208:209], v[24:25], v[156:157] op_sel_hi:[1,0,1]
  v_pk_fma_f32 v[210:211], v[210:211], v[24:25], v[158:159] op_sel_hi:[1,0,1]
  v_cvt_pk_bf16_f32 v192, v192, v193
  v_cvt_pk_bf16_f32 v193, v194, v195
  v_cvt_pk_bf16_f32 v194, v208, v209
  v_cvt_pk_bf16_f32 v195, v210, v211
  buffer_store_dwordx4 v[192:195], v54, s[4:7], s8 offen offset:0 sc1
  v_pk_mul_f32 v[152:153], v[40:41], v[26:27] op_sel:[0,1] op_sel_hi:[1,1]
  v_pk_mul_f32 v[154:155], v[42:43], v[26:27] op_sel:[0,1] op_sel_hi:[1,1]
  v_pk_mul_f32 v[156:157], v[44:45], v[26:27] op_sel:[0,1] op_sel_hi:[1,1]
  v_pk_mul_f32 v[158:159], v[46:47], v[26:27] op_sel:[0,1] op_sel_hi:[1,1]
  v_pk_fma_f32 v[196:197], v[196:197], v[26:27], v[152:153] op_sel_hi:[1,0,1]
  v_pk_fma_f32 v[198:199], v[198:199], v[26:27], v[154:155] op_sel_hi:[1,0,1]
  v_pk_fma_f32 v[212:213], v[212:213], v[26:27], v[156:157] op_sel_hi:[1,0,1]
  v_pk_fma_f32 v[214:215], v[214:215], v[26:27], v[158:159] op_sel_hi:[1,0,1]
  v_cvt_pk_bf16_f32 v196, v196, v197
  v_cvt_pk_bf16_f32 v197, v198, v199
  v_cvt_pk_bf16_f32 v198, v212, v213
  v_cvt_pk_bf16_f32 v199, v214, v215
  buffer_store_dwordx4 v[196:199], v54, s[4:7], s8 offen offset:128 sc1
  v_pk_mul_f32 v[152:153], v[40:41], v[28:29] op_sel:[0,1] op_sel_hi:[1,1]
  v_pk_mul_f32 v[154:155], v[42:43], v[28:29] op_sel:[0,1] op_sel_hi:[1,1]
  v_pk_mul_f32 v[156:157], v[44:45], v[28:29] op_sel:[0,1] op_sel_hi:[1,1]
  v_pk_mul_f32 v[158:159], v[46:47], v[28:29] op_sel:[0,1] op_sel_hi:[1,1]
  v_pk_fma_f32 v[200:201], v[200:201], v[28:29], v[152:153] op_sel_hi:[1,0,1]
  v_pk_fma_f32 v[202:203], v[202:203], v[28:29], v[154:155] op_sel_hi:[1,0,1]
  v_pk_fma_f32 v[216:217], v[216:217], v[28:29], v[156:157] op_sel_hi:[1,0,1]
  v_pk_fma_f32 v[218:219], v[218:219], v[28:29], v[158:159] op_sel_hi:[1,0,1]
  v_cvt_pk_bf16_f32 v200, v200, v201
  v_cvt_pk_bf16_f32 v201, v202, v203
  v_cvt_pk_bf16_f32 v202, v216, v217
  v_cvt_pk_bf16_f32 v203, v218, v219
  buffer_store_dwordx4 v[200:203], v54, s[4:7], s9 offen offset:0 sc1
  v_pk_mul_f32 v[152:153], v[40:41], v[30:31] op_sel:[0,1] op_sel_hi:[1,1]
  v_pk_mul_f32 v[154:155], v[42:43], v[30:31] op_sel:[0,1] op_sel_hi:[1,1]
  v_pk_mul_f32 v[156:157], v[44:45], v[30:31] op_sel:[0,1] op_sel_hi:[1,1]
  v_pk_mul_f32 v[158:159], v[46:47], v[30:31] op_sel:[0,1] op_sel_hi:[1,1]
  v_pk_fma_f32 v[204:205], v[204:205], v[30:31], v[152:153] op_sel_hi:[1,0,1]
  v_pk_fma_f32 v[206:207], v[206:207], v[30:31], v[154:155] op_sel_hi:[1,0,1]
  v_pk_fma_f32 v[220:221], v[220:221], v[30:31], v[156:157] op_sel_hi:[1,0,1]
  v_pk_fma_f32 v[222:223], v[222:223], v[30:31], v[158:159] op_sel_hi:[1,0,1]
  v_cvt_pk_bf16_f32 v204, v204, v205
  v_cvt_pk_bf16_f32 v205, v206, v207
  v_cvt_pk_bf16_f32 v206, v220, v221
  v_cvt_pk_bf16_f32 v207, v222, v223
  buffer_store_dwordx4 v[204:207], v54, s[4:7], s9 offen offset:128 sc1
  v_pk_mul_f32 v[152:153], v[80:81], v[48:49] op_sel:[0,0] op_sel_hi:[1,0]
  v_pk_mul_f32 v[154:155], v[82:83], v[48:49] op_sel:[0,0] op_sel_hi:[1,0]
  v_pk_mul_f32 v[156:157], v[84:85], v[48:49] op_sel:[0,0] op_sel_hi:[1,0]
  v_pk_mul_f32 v[158:159], v[86:87], v[48:49] op_sel:[0,0] op_sel_hi:[1,0]
  v_pk_fma_f32 v[224:225], v[224:225], v[64:65], v[152:153]
  v_pk_fma_f32 v[226:227], v[226:227], v[66:67], v[154:155]
  v_pk_fma_f32 v[228:229], v[228:229], v[68:69], v[156:157]
  v_pk_fma_f32 v[230:231], v[230:231], v[70:71], v[158:159]
  v_cvt_pk_bf16_f32 v224, v224, v225
  v_cvt_pk_bf16_f32 v225, v226, v227
  v_cvt_pk_bf16_f32 v226, v228, v229
  v_cvt_pk_bf16_f32 v227, v230, v231
  buffer_store_dwordx4 v[224:227], v55, s[4:7], s8 offen offset:2048 sc1
  v_pk_mul_f32 v[152:153], v[80:81], v[48:49] op_sel:[0,1] op_sel_hi:[1,1]
  v_pk_mul_f32 v[154:155], v[82:83], v[48:49] op_sel:[0,1] op_sel_hi:[1,1]
  v_pk_mul_f32 v[156:157], v[84:85], v[48:49] op_sel:[0,1] op_sel_hi:[1,1]
  v_pk_mul_f32 v[158:159], v[86:87], v[48:49] op_sel:[0,1] op_sel_hi:[1,1]
  v_pk_fma_f32 v[240:241], v[240:241], v[64:65], v[152:153]
  v_pk_fma_f32 v[242:243], v[242:243], v[66:67], v[154:155]
  v_pk_fma_f32 v[244:245], v[244:245], v[68:69], v[156:157]
  v_pk_fma_f32 v[246:247], v[246:247], v[70:71], v[158:159]
  v_cvt_pk_bf16_f32 v240, v240, v241
  v_cvt_pk_bf16_f32 v241, v242, v243
  v_cvt_pk_bf16_f32 v242, v244, v245
  v_cvt_pk_bf16_f32 v243, v246, v247
  buffer_store_dwordx4 v[240:243], v55, s[4:7], s8 offen offset:2304 sc1
  v_pk_mul_f32 v[152:153], v[88:89], v[48:49] op_sel:[0,0] op_sel_hi:[1,0]
  v_pk_mul_f32 v[154:155], v[90:91], v[48:49] op_sel:[0,0] op_sel_hi:[1,0]
  v_pk_mul_f32 v[156:157], v[92:93], v[48:49] op_sel:[0,0] op_sel_hi:[1,0]
  v_pk_mul_f32 v[158:159], v[94:95], v[48:49] op_sel:[0,0] op_sel_hi:[1,0]
  v_pk_fma_f32 v[232:233], v[232:233], v[72:73], v[152:153]
  v_pk_fma_f32 v[234:235], v[234:235], v[74:75], v[154:155]
  v_pk_fma_f32 v[236:237], v[236:237], v[76:77], v[156:157]
  v_pk_fma_f32 v[238:239], v[238:239], v[78:79], v[158:159]
  v_cvt_pk_bf16_f32 v232, v232, v233
  v_cvt_pk_bf16_f32 v233, v234, v235
  v_cvt_pk_bf16_f32 v234, v236, v237
  v_cvt_pk_bf16_f32 v235, v238, v239
  buffer_store_dwordx4 v[232:235], v55, s[4:7], s9 offen offset:2048 sc1
  v_pk_mul_f32 v[152:153], v[88:89], v[48:49] op_sel:[0,1] op_sel_hi:[1,1]
  v_pk_mul_f32 v[154:155], v[90:91], v[48:49] op_sel:[0,1] op_sel_hi:[1,1]
  v_pk_mul_f32 v[156:157], v[92:93], v[48:49] op_sel:[0,1] op_sel_hi:[1,1]
  v_pk_mul_f32 v[158:159], v[94:95], v[48:49] op_sel:[0,1] op_sel_hi:[1,1]
  v_pk_fma_f32 v[248:249], v[248:249], v[72:73], v[152:153]
  v_pk_fma_f32 v[250:251], v[250:251], v[74:75], v[154:155]
  v_pk_fma_f32 v[252:253], v[252:253], v[76:77], v[156:157]
  v_pk_fma_f32 v[254:255], v[254:255], v[78:79], v[158:159]
  v_cvt_pk_bf16_f32 v248, v248, v249
  v_cvt_pk_bf16_f32 v249, v250, v251
  v_cvt_pk_bf16_f32 v250, v252, v253
  v_cvt_pk_bf16_f32 v251, v254, v255
  buffer_store_dwordx4 v[248:251], v55, s[4:7], s9 offen offset:2304 sc1
  v_pk_mul_f32 v[24:25], v[24:25], v[56:57] op_sel_hi:[1,0]
  v_pk_mul_f32 v[26:27], v[26:27], v[56:57] op_sel_hi:[1,0]
  v_pk_mul_f32 v[28:29], v[28:29], v[56:57] op_sel_hi:[1,0]
  v_pk_mul_f32 v[30:31], v[30:31], v[56:57] op_sel_hi:[1,0]
  ds_write_b128 v59, v[192:195] offset:0
  ds_write_b128 v59, v[196:199] offset:128
  v_pk_mul_f32 v[152:153], v[32:33], v[24:25] op_sel:[0,1] op_sel_hi:[1,1]
  v_pk_mul_f32 v[154:155], v[34:35], v[24:25] op_sel:[0,1] op_sel_hi:[1,1]
  v_pk_mul_f32 v[156:157], v[36:37], v[24:25] op_sel:[0,1] op_sel_hi:[1,1]
  v_pk_mul_f32 v[158:159], v[38:39], v[24:25] op_sel:[0,1] op_sel_hi:[1,1]
  v_pk_fma_f32 v[160:161], v[160:161], v[24:25], v[152:153] op_sel_hi:[1,0,1]
  v_pk_fma_f32 v[162:163], v[162:163], v[24:25], v[154:155] op_sel_hi:[1,0,1]
  v_pk_fma_f32 v[176:177], v[176:177], v[24:25], v[156:157] op_sel_hi:[1,0,1]
  v_pk_fma_f32 v[178:179], v[178:179], v[24:25], v[158:159] op_sel_hi:[1,0,1]
  v_cvt_pk_bf16_f32 v160, v160, v161
  v_cvt_pk_bf16_f32 v161, v162, v163
  v_cvt_pk_bf16_f32 v162, v176, v177
  v_cvt_pk_bf16_f32 v163, v178, v179
  ds_write_b128 v61, v[160:163] offset:0
  ds_write_b128 v59, v[200:203] offset:4096
  ds_write_b128 v59, v[204:207] offset:4224
  v_pk_mul_f32 v[152:153], v[32:33], v[26:27] op_sel:[0,1] op_sel_hi:[1,1]
  v_pk_mul_f32 v[154:155], v[34:35], v[26:27] op_sel:[0,1] op_sel_hi:[1,1]
  v_pk_mul_f32 v[156:157], v[36:37], v[26:27] op_sel:[0,1] op_sel_hi:[1,1]
  v_pk_mul_f32 v[158:159], v[38:39], v[26:27] op_sel:[0,1] op_sel_hi:[1,1]
  v_pk_fma_f32 v[164:165], v[164:165], v[26:27], v[152:153] op_sel_hi:[1,0,1]
  v_pk_fma_f32 v[166:167], v[166:167], v[26:27], v[154:155] op_sel_hi:[1,0,1]
  v_pk_fma_f32 v[180:181], v[180:181], v[26:27], v[156:157] op_sel_hi:[1,0,1]
  v_pk_fma_f32 v[182:183], v[182:183], v[26:27], v[158:159] op_sel_hi:[1,0,1]
  v_cvt_pk_bf16_f32 v164, v164, v165
  v_cvt_pk_bf16_f32 v165, v166, v167
  v_cvt_pk_bf16_f32 v166, v180, v181
  v_cvt_pk_bf16_f32 v167, v182, v183
  ds_write_b128 v61, v[164:167] offset:256
  ds_write_b128 v60, v[224:227] offset:2048
  ds_write_b128 v60, v[240:243] offset:2304
  v_pk_mul_f32 v[152:153], v[32:33], v[28:29] op_sel:[0,1] op_sel_hi:[1,1]
  v_pk_mul_f32 v[154:155], v[34:35], v[28:29] op_sel:[0,1] op_sel_hi:[1,1]
  v_pk_mul_f32 v[156:157], v[36:37], v[28:29] op_sel:[0,1] op_sel_hi:[1,1]
  v_pk_mul_f32 v[158:159], v[38:39], v[28:29] op_sel:[0,1] op_sel_hi:[1,1]
  v_pk_fma_f32 v[168:169], v[168:169], v[28:29], v[152:153] op_sel_hi:[1,0,1]
  v_pk_fma_f32 v[170:171], v[170:171], v[28:29], v[154:155] op_sel_hi:[1,0,1]
  v_pk_fma_f32 v[184:185], v[184:185], v[28:29], v[156:157] op_sel_hi:[1,0,1]
  v_pk_fma_f32 v[186:187], v[186:187], v[28:29], v[158:159] op_sel_hi:[1,0,1]
  v_cvt_pk_bf16_f32 v168, v168, v169
  v_cvt_pk_bf16_f32 v169, v170, v171
  v_cvt_pk_bf16_f32 v170, v184, v185
  v_cvt_pk_bf16_f32 v171, v186, v187
  ds_write_b128 v61, v[168:171] offset:2048
  ds_write_b128 v60, v[232:235] offset:6144
  ds_write_b128 v60, v[248:251] offset:6400
  v_pk_mul_f32 v[152:153], v[32:33], v[30:31] op_sel:[0,1] op_sel_hi:[1,1]
  v_pk_mul_f32 v[154:155], v[34:35], v[30:31] op_sel:[0,1] op_sel_hi:[1,1]
  v_pk_mul_f32 v[156:157], v[36:37], v[30:31] op_sel:[0,1] op_sel_hi:[1,1]
  v_pk_mul_f32 v[158:159], v[38:39], v[30:31] op_sel:[0,1] op_sel_hi:[1,1]
  v_pk_fma_f32 v[172:173], v[172:173], v[30:31], v[152:153] op_sel_hi:[1,0,1]
  v_pk_fma_f32 v[174:175], v[174:175], v[30:31], v[154:155] op_sel_hi:[1,0,1]
  v_pk_fma_f32 v[188:189], v[188:189], v[30:31], v[156:157] op_sel_hi:[1,0,1]
  v_pk_fma_f32 v[190:191], v[190:191], v[30:31], v[158:159] op_sel_hi:[1,0,1]
  v_cvt_pk_bf16_f32 v172, v172, v173
  v_cvt_pk_bf16_f32 v173, v174, v175
  v_cvt_pk_bf16_f32 v174, v188, v189
  v_cvt_pk_bf16_f32 v175, v190, v191
  ds_write_b128 v61, v[172:175] offset:2304
.g2_kernel_q_kd:
  s_mov_b64 exec, 1
  ds_add_u32 v13, v5 offset:4
  s_mov_b64 exec, -1
  v_mov_b32 v120, 0
  v_mov_b32 v121, 0
  v_mov_b32 v124, 0
  v_mov_b32 v125, 0
  v_mov_b32 v128, 0
  v_mov_b32 v129, 0
  v_mov_b32 v132, 0
  v_mov_b32 v133, 0
  s_cmp_lg_u32 s62, 0
  s_cbranch_scc1 .g2_kernel_r2
  global_load_dwordx4 v[240:243], v23, s[74:75] offset:0
  global_load_dwordx4 v[244:247], v23, s[74:75] offset:32
  global_load_dwordx4 v[248:251], v23, s[74:75] offset:64
  global_load_dwordx4 v[252:255], v23, s[74:75] offset:96
.g2_kernel_r3:
  v_mov_b32 v6, s71
  s_mov_b32 s38, 0
.g2_kernel_wg2:
  ds_read_b32 v7, v6 offset:4
  s_add_u32 s38, s38, 1
  s_waitcnt lgkmcnt(0)
  v_cmp_le_u32 vcc, 4, v7
  s_cbranch_vccnz .g2_kernel_wg2d
  s_cmp_lt_u32 s38, 524288
  s_cbranch_scc1 .g2_kernel_wg2
.g2_kernel_wg2d:
  ds_read_b128 v[176:179], v9 offset:0
  ds_read_b128 v[180:183], v9 offset:1024
  ds_read_b128 v[24:27], v14 offset:8192
  ds_read_b128 v[28:31], v14 offset:9216
  ds_read_b128 v[184:187], v9 offset:2048
  ds_read_b128 v[188:191], v9 offset:3072
  ds_read_b128 v[32:35], v14 offset:10240
  ds_read_b128 v[36:39], v14 offset:11264
  ds_read_b128 v[40:43], v14 offset:12288
  ds_read_b128 v[44:47], v14 offset:13312
  ds_read_b128 v[48:51], v14 offset:14336
  ds_read_b128 v[52:55], v14 offset:15360
  s_cmp_lg_u32 s35, 0
  s_cbranch_scc1 .g2_kernel_a_own
  s_waitcnt lgkmcnt(8)
.g2_kernel_a_ob:
  v_mfma_f32_32x32x16_bf16 v[136:151], v[176:179], v[24:27], 0
  v_mfma_f32_32x32x16_bf16 v[136:151], v[180:183], v[28:31], v[136:151]
  s_waitcnt lgkmcnt(0)
  s_nop 7
  v_mfma_f32_32x32x16_bf16 v[152:167], v[176:179], v[32:35], 0
  s_waitcnt vmcnt(4)
  s_mov_b64 exec, 1
  buffer_store_dword v15, v4, s[4:7], s37 offen sc1
  s_mov_b64 exec, -1
  v_exp_f32 v136, v136
  v_exp_f32 v137, v137
  v_exp_f32 v138, v138
  v_exp_f32 v139, v139
  v_exp_f32 v140, v140
  v_exp_f32 v141, v141
  v_exp_f32 v142, v142
  v_exp_f32 v143, v143
  v_mfma_f32_32x32x16_bf16 v[152:167], v[180:183], v[36:39], v[152:167]
  s_mov_b64 exec, 1
  ds_add_u32 v13, v5 offset:8
  s_mov_b64 exec, -1
  v_cvt_pk_bf16_f32 v168, v136, v137
  v_cvt_pk_bf16_f32 v169, v138, v139
  v_cvt_pk_bf16_f32 v170, v140, v141
  v_cvt_pk_bf16_f32 v171, v142, v143
  v_exp_f32 v144, v144
  v_exp_f32 v145, v145
  v_exp_f32 v146, v146
  v_exp_f32 v147, v147
  v_mfma_f32_32x32x16_bf16 v[56:71], v[184:187], v[168:171], 0
  v_exp_f32 v148, v148
  v_exp_f32 v149, v149
  v_exp_f32 v150, v150
  v_exp_f32 v151, v151
  v_cvt_pk_bf16_f32 v172, v144, v145
  v_cvt_pk_bf16_f32 v173, v146, v147
  v_cvt_pk_bf16_f32 v174, v148, v149
  v_cvt_pk_bf16_f32 v175, v150, v151
  v_mfma_f32_32x32x16_bf16 v[136:151], v[176:179], v[40:43], 0
  v_exp_f32 v152, v152
  v_exp_f32 v153, v153
  v_exp_f32 v154, v154
  v_mfma_f32_32x32x16_bf16 v[56:71], v[188:191], v[172:175], v[56:71]
  v_exp_f32 v155, v155
  v_exp_f32 v156, v156
  v_exp_f32 v157, v157
  v_smfmac_f32_16x16x64_bf16 v[120:123], v[16:19], v[168:175], v20
  v_exp_f32 v158, v158
  v_exp_f32 v159, v159
  v_mfma_f32_32x32x16_bf16 v[136:151], v[180:183], v[44:47], v[136:151]
  v_cvt_pk_bf16_f32 v168, v152, v153
  v_cvt_pk_bf16_f32 v169, v154, v155
  v_cvt_pk_bf16_f32 v170, v156, v157
  v_cvt_pk_bf16_f32 v171, v158, v159
  v_exp_f32 v160, v160
  v_exp_f32 v161, v161
  v_exp_f32 v162, v162
  v_exp_f32 v163, v163
  v_mfma_f32_32x32x16_bf16 v[72:87], v[184:187], v[168:171], 0
  v_exp_f32 v164, v164
  v_exp_f32 v165, v165
  v_exp_f32 v166, v166
  v_exp_f32 v167, v167
  v_cvt_pk_bf16_f32 v172, v160, v161
  v_cvt_pk_bf16_f32 v173, v162, v163
  v_cvt_pk_bf16_f32 v174, v164, v165
  v_cvt_pk_bf16_f32 v175, v166, v167
  v_mfma_f32_32x32x16_bf16 v[152:167], v[176:179], v[48:51], 0
  ds_read_b32 v7, v8
  v_exp_f32 v136, v136
  v_exp_f32 v137, v137
  v_exp_f32 v138, v138
  v_mfma_f32_32x32x16_bf16 v[72:87], v[188:191], v[172:175], v[72:87]
  s_lshl_b32 s28, s16, 11
  v_exp_f32 v139, v139
  v_exp_f32 v140, v140
  v_exp_f32 v141, v141
  v_smfmac_f32_16x16x64_bf16 v[124:127], v[16:19], v[168:175], v20
  v_add_u32 v9, s28, v3
  v_exp_f32 v142, v142
  v_exp_f32 v143, v143
  v_mfma_f32_32x32x16_bf16 v[152:167], v[180:183], v[52:55], v[152:167]
  s_waitcnt lgkmcnt(0)
  v_cmp_lt_u32 vcc, s62, v7
  v_cvt_pk_bf16_f32 v168, v136, v137
  v_cvt_pk_bf16_f32 v169, v138, v139
  v_cvt_pk_bf16_f32 v170, v140, v141
  v_cvt_pk_bf16_f32 v171, v142, v143
  v_exp_f32 v144, v144
  v_exp_f32 v145, v145
  v_exp_f32 v146, v146
  v_exp_f32 v147, v147
  v_mfma_f32_32x32x16_bf16 v[88:103], v[184:187], v[168:171], 0
  s_mov_b32 s36, vcc_lo
  s_andn2_b32 s33, s36, s34
  v_exp_f32 v148, v148
  v_exp_f32 v149, v149
  v_exp_f32 v150, v150
  v_exp_f32 v151, v151
  v_cvt_pk_bf16_f32 v172, v144, v145
  v_cvt_pk_bf16_f32 v173, v146, v147
  v_cvt_pk_bf16_f32 v174, v148, v149
  v_cvt_pk_bf16_f32 v175, v150, v151
  v_exp_f32 v152, v152
  v_exp_f32 v153, v153
  v_exp_f32 v154, v154
  v_mfma_f32_32x32x16_bf16 v[88:103], v[188:191], v[172:175], v[88:103]
  s_bcnt1_i32_b32 s39, s33
  s_cmp_lt_u32 s39, 3
  v_exp_f32 v155, v155
  v_exp_f32 v156, v156
  v_exp_f32 v157, v157
  v_smfmac_f32_16x16x64_bf16 v[128:131], v[16:19], v[168:175], v20
  s_cbranch_scc1 .g2_kernel_a_F0n
  s_call_b64 s[72:73], .g2_kernel_a_three
.g2_kernel_a_F0n:
  v_exp_f32 v158, v158
  v_exp_f32 v159, v159
  v_cvt_pk_bf16_f32 v168, v152, v153
  v_cvt_pk_bf16_f32 v169, v154, v155
  v_cvt_pk_bf16_f32 v170, v156, v157
  v_cvt_pk_bf16_f32 v171, v158, v159
  v_exp_f32 v160, v160
  v_exp_f32 v161, v161
  v_exp_f32 v162, v162
  v_exp_f32 v163, v163
  v_mfma_f32_32x32x16_bf16 v[104:119], v[184:187], v[168:171], 0
  v_exp_f32 v164, v164
  v_exp_f32 v165, v165
  v_exp_f32 v166, v166
  v_exp_f32 v167, v167
  v_cvt_pk_bf16_f32 v172, v160, v161
  v_cvt_pk_bf16_f32 v173, v162, v163
  v_cvt_pk_bf16_f32 v174, v164, v165
  v_cvt_pk_bf16_f32 v175, v166, v167
  s_add_u32 s39, s39, s35
  s_cmp_ge_u32 s39, 3
  s_cbranch_scc1 .g2_kernel_a_p1
  s_call_b64 s[72:73], .g2_kernel_a_three
.g2_kernel_a_p1:
  s_waitcnt vmcnt(10)
  v_mfma_f32_32x32x16_bf16 v[136:151], v[192:195], v[24:27], 0
  v_mfma_f32_32x32x16_bf16 v[136:151], v[196:199], v[28:31], v[136:151]
  s_waitcnt vmcnt(8)
  s_mov_b32 s32, 0
  s_nop 8
  s_branch .g2_kernel_a_n1
  .p2align 6
.g2_kernel_a_loop:
  v_mfma_f32_32x32x16_bf16 v[152:167], v[176:179], v[32:35], 0
  s_andn2_b32 s33, s36, s34
  v_exp_f32 v136, v136
  v_exp_f32 v137, v137
  v_exp_f32 v138, v138
  v_mfma_f32_32x32x16_bf16 v[104:119], v[236:239], v[172:175], v[104:119]
  s_cbranch_scc0 .g2_kernel_a_N0c
.g2_kernel_a_N0b:
  v_exp_f32 v139, v139
  v_exp_f32 v140, v140
  v_exp_f32 v141, v141
  v_smfmac_f32_16x16x64_bf16 v[132:135], v[16:19], v[168:175], v20
  s_ff1_i32_b32 s33, s33
  v_exp_f32 v142, v142
  v_exp_f32 v143, v143
  v_mfma_f32_32x32x16_bf16 v[152:167], v[180:183], v[36:39], v[152:167]
  s_bitset1_b32 s34, s33
  v_cvt_pk_bf16_f32 v168, v136, v137
  v_cvt_pk_bf16_f32 v169, v138, v139
  v_cvt_pk_bf16_f32 v170, v140, v141
  v_cvt_pk_bf16_f32 v171, v142, v143
  v_exp_f32 v144, v144
  v_exp_f32 v145, v145
  v_exp_f32 v146, v146
  v_exp_f32 v147, v147
  v_mfma_f32_32x32x16_bf16 v[56:71], v[184:187], v[168:171], v[56:71]
  s_xor_b32 s33, s33, s24
  v_exp_f32 v148, v148
  v_exp_f32 v149, v149
  v_exp_f32 v150, v150
  v_exp_f32 v151, v151
  v_cvt_pk_bf16_f32 v172, v144, v145
  v_cvt_pk_bf16_f32 v173, v146, v147
  v_cvt_pk_bf16_f32 v174, v148, v149
  v_cvt_pk_bf16_f32 v175, v150, v151
  v_mfma_f32_32x32x16_bf16 v[136:151], v[176:179], v[40:43], 0
  s_lshl_b32 s33, s33, s25
  v_exp_f32 v152, v152
  v_exp_f32 v153, v153
  v_exp_f32 v154, v154
  v_mfma_f32_32x32x16_bf16 v[56:71], v[188:191], v[172:175], v[56:71]
  s_add_u32 s22, s20, s33
  v_exp_f32 v155, v155
  v_exp_f32 v156, v156
  v_exp_f32 v157, v157
  v_smfmac_f32_16x16x64_bf16 v[120:123], v[16:19], v[168:175], v20
  s_addc_u32 s23, s21, 0
  v_exp_f32 v158, v158
  v_exp_f32 v159, v159
  v_mfma_f32_32x32x16_bf16 v[136:151], v[180:183], v[44:47], v[136:151]
  v_cvt_pk_bf16_f32 v168, v152, v153
  v_cvt_pk_bf16_f32 v169, v154, v155
  v_cvt_pk_bf16_f32 v170, v156, v157
  v_cvt_pk_bf16_f32 v171, v158, v159
  v_exp_f32 v160, v160
  v_exp_f32 v161, v161
  v_exp_f32 v162, v162
  v_exp_f32 v163, v163
  v_mfma_f32_32x32x16_bf16 v[72:87], v[184:187], v[168:171], v[72:87]
  v_exp_f32 v164, v164
  v_exp_f32 v165, v165
  v_exp_f32 v166, v166
  v_exp_f32 v167, v167
  v_cvt_pk_bf16_f32 v172, v160, v161
  v_cvt_pk_bf16_f32 v173, v162, v163
  v_cvt_pk_bf16_f32 v174, v164, v165
  v_cvt_pk_bf16_f32 v175, v166, v167
  v_mfma_f32_32x32x16_bf16 v[152:167], v[176:179], v[48:51], 0
  v_exp_f32 v136, v136
  v_exp_f32 v137, v137
  v_exp_f32 v138, v138
  v_mfma_f32_32x32x16_bf16 v[72:87], v[188:191], v[172:175], v[72:87]
  v_exp_f32 v139, v139
  v_exp_f32 v140, v140
  v_exp_f32 v141, v141
  v_smfmac_f32_16x16x64_bf16 v[124:127], v[16:19], v[168:175], v20
  global_load_dwordx4 v[224:227], v3, s[22:23] offset:0
  global_load_dwordx4 v[228:231], v3, s[22:23] offset:1024
  global_load_dwordx4 v[232:235], v3, s[22:23] offset:2048
  global_load_dwordx4 v[236:239], v3, s[22:23] offset:3072
  v_exp_f32 v142, v142
  v_exp_f32 v143, v143
  v_mfma_f32_32x32x16_bf16 v[152:167], v[180:183], v[52:55], v[152:167]
  v_cvt_pk_bf16_f32 v168, v136, v137
  v_cvt_pk_bf16_f32 v169, v138, v139
  v_cvt_pk_bf16_f32 v170, v140, v141
  v_cvt_pk_bf16_f32 v171, v142, v143
  v_exp_f32 v144, v144
  v_exp_f32 v145, v145
  v_exp_f32 v146, v146
  v_exp_f32 v147, v147
  v_mfma_f32_32x32x16_bf16 v[88:103], v[184:187], v[168:171], v[88:103]
  s_waitcnt vmcnt(8)
  v_exp_f32 v148, v148
  v_exp_f32 v149, v149
  v_exp_f32 v150, v150
  v_exp_f32 v151, v151
  v_cvt_pk_bf16_f32 v172, v144, v145
  v_cvt_pk_bf16_f32 v173, v146, v147
  v_cvt_pk_bf16_f32 v174, v148, v149
  v_cvt_pk_bf16_f32 v175, v150, v151
  v_mfma_f32_32x32x16_bf16 v[136:151], v[192:195], v[24:27], 0
  v_exp_f32 v152, v152
  v_exp_f32 v153, v153
  v_exp_f32 v154, v154
  v_mfma_f32_32x32x16_bf16 v[88:103], v[188:191], v[172:175], v[88:103]
  v_exp_f32 v155, v155
  v_exp_f32 v156, v156
  v_exp_f32 v157, v157
  v_smfmac_f32_16x16x64_bf16 v[128:131], v[16:19], v[168:175], v20
  v_exp_f32 v158, v158
  v_exp_f32 v159, v159
  v_mfma_f32_32x32x16_bf16 v[136:151], v[196:199], v[28:31], v[136:151]
  v_cvt_pk_bf16_f32 v168, v152, v153
  v_cvt_pk_bf16_f32 v169, v154, v155
  v_cvt_pk_bf16_f32 v170, v156, v157
  v_cvt_pk_bf16_f32 v171, v158, v159
  v_exp_f32 v160, v160
  v_exp_f32 v161, v161
  v_exp_f32 v162, v162
  v_exp_f32 v163, v163
  v_mfma_f32_32x32x16_bf16 v[104:119], v[184:187], v[168:171], v[104:119]
  v_exp_f32 v164, v164
  v_exp_f32 v165, v165
  v_exp_f32 v166, v166
  v_exp_f32 v167, v167
  v_cvt_pk_bf16_f32 v172, v160, v161
  v_cvt_pk_bf16_f32 v173, v162, v163
  v_cvt_pk_bf16_f32 v174, v164, v165
  v_cvt_pk_bf16_f32 v175, v166, v167
.g2_kernel_a_n1:
  v_mfma_f32_32x32x16_bf16 v[152:167], v[192:195], v[32:35], 0
  s_andn2_b32 s33, s36, s34
  v_exp_f32 v136, v136
  v_exp_f32 v137, v137
  v_exp_f32 v138, v138
  v_mfma_f32_32x32x16_bf16 v[104:119], v[188:191], v[172:175], v[104:119]
  s_cbranch_scc0 .g2_kernel_a_N1c
.g2_kernel_a_N1b:
  v_exp_f32 v139, v139
  v_exp_f32 v140, v140
  v_exp_f32 v141, v141
  v_smfmac_f32_16x16x64_bf16 v[132:135], v[16:19], v[168:175], v20
  s_ff1_i32_b32 s33, s33
  v_exp_f32 v142, v142
  v_exp_f32 v143, v143
  v_mfma_f32_32x32x16_bf16 v[152:167], v[196:199], v[36:39], v[152:167]
  s_bitset1_b32 s34, s33
  v_cvt_pk_bf16_f32 v168, v136, v137
  v_cvt_pk_bf16_f32 v169, v138, v139
  v_cvt_pk_bf16_f32 v170, v140, v141
  v_cvt_pk_bf16_f32 v171, v142, v143
  v_exp_f32 v144, v144
  v_exp_f32 v145, v145
  v_exp_f32 v146, v146
  v_exp_f32 v147, v147
  v_mfma_f32_32x32x16_bf16 v[56:71], v[200:203], v[168:171], v[56:71]
  s_xor_b32 s33, s33, s24
  v_exp_f32 v148, v148
  v_exp_f32 v149, v149
  v_exp_f32 v150, v150
  v_exp_f32 v151, v151
  v_cvt_pk_bf16_f32 v172, v144, v145
  v_cvt_pk_bf16_f32 v173, v146, v147
  v_cvt_pk_bf16_f32 v174, v148, v149
  v_cvt_pk_bf16_f32 v175, v150, v151
  v_mfma_f32_32x32x16_bf16 v[136:151], v[192:195], v[40:43], 0
  s_lshl_b32 s33, s33, s25
  v_exp_f32 v152, v152
  v_exp_f32 v153, v153
  v_exp_f32 v154, v154
  v_mfma_f32_32x32x16_bf16 v[56:71], v[204:207], v[172:175], v[56:71]
  s_add_u32 s22, s20, s33
  v_exp_f32 v155, v155
  v_exp_f32 v156, v156
  v_exp_f32 v157, v157
  v_smfmac_f32_16x16x64_bf16 v[120:123], v[16:19], v[168:175], v20
  s_addc_u32 s23, s21, 0
  v_exp_f32 v158, v158
  v_exp_f32 v159, v159
  v_mfma_f32_32x32x16_bf16 v[136:151], v[196:199], v[44:47], v[136:151]
  v_cvt_pk_bf16_f32 v168, v152, v153
  v_cvt_pk_bf16_f32 v169, v154, v155
  v_cvt_pk_bf16_f32 v170, v156, v157
  v_cvt_pk_bf16_f32 v171, v158, v159
  v_exp_f32 v160, v160
  v_exp_f32 v161, v161
  v_exp_f32 v162, v162
  v_exp_f32 v163, v163
  v_mfma_f32_32x32x16_bf16 v[72:87], v[200:203], v[168:171], v[72:87]
  v_exp_f32 v164, v164
  v_exp_f32 v165, v165
  v_exp_f32 v166, v166
  v_exp_f32 v167, v167
  v_cvt_pk_bf16_f32 v172, v160, v161
  v_cvt_pk_bf16_f32 v173, v162, v163
  v_cvt_pk_bf16_f32 v174, v164, v165
  v_cvt_pk_bf16_f32 v175, v166, v167
  v_mfma_f32_32x32x16_bf16 v[152:167], v[192:195], v[48:51], 0
  v_exp_f32 v136, v136
  v_exp_f32 v137, v137
  v_exp_f32 v138, v138
  v_mfma_f32_32x32x16_bf16 v[72:87], v[204:207], v[172:175], v[72:87]
  v_exp_f32 v139, v139
  v_exp_f32 v140, v140
  v_exp_f32 v141, v141
  v_smfmac_f32_16x16x64_bf16 v[124:127], v[16:19], v[168:175], v20
  global_load_dwordx4 v[176:179], v3, s[22:23] offset:0
  global_load_dwordx4 v[180:183], v3, s[22:23] offset:1024
  global_load_dwordx4 v[184:187], v3, s[22:23] offset:2048
  global_load_dwordx4 v[188:191], v3, s[22:23] offset:3072
  v_exp_f32 v142, v142
  v_exp_f32 v143, v143
  v_mfma_f32_32x32x16_bf16 v[152:167], v[196:199], v[52:55], v[152:167]
  v_cvt_pk_bf16_f32 v168, v136, v137
  v_cvt_pk_bf16_f32 v169, v138, v139
  v_cvt_pk_bf16_f32 v170, v140, v141
  v_cvt_pk_bf16_f32 v171, v142, v143
  v_exp_f32 v144, v144
  v_exp_f32 v145, v145
  v_exp_f32 v146, v146
  v_exp_f32 v147, v147
  v_mfma_f32_32x32x16_bf16 v[88:103], v[200:203], v[168:171], v[88:103]
  s_waitcnt vmcnt(8)
  v_exp_f32 v148, v148
  v_exp_f32 v149, v149
  v_exp_f32 v150, v150
  v_exp_f32 v151, v151
  v_cvt_pk_bf16_f32 v172, v144, v145
  v_cvt_pk_bf16_f32 v173, v146, v147
  v_cvt_pk_bf16_f32 v174, v148, v149
  v_cvt_pk_bf16_f32 v175, v150, v151
  v_mfma_f32_32x32x16_bf16 v[136:151], v[208:211], v[24:27], 0
  v_exp_f32 v152, v152
  v_exp_f32 v153, v153
  v_exp_f32 v154, v154
  v_mfma_f32_32x32x16_bf16 v[88:103], v[204:207], v[172:175], v[88:103]
  v_exp_f32 v155, v155
  v_exp_f32 v156, v156
  v_exp_f32 v157, v157
  v_smfmac_f32_16x16x64_bf16 v[128:131], v[16:19], v[168:175], v20
  v_exp_f32 v158, v158
  v_exp_f32 v159, v159
  v_mfma_f32_32x32x16_bf16 v[136:151], v[212:215], v[28:31], v[136:151]
  v_cvt_pk_bf16_f32 v168, v152, v153
  v_cvt_pk_bf16_f32 v169, v154, v155
  v_cvt_pk_bf16_f32 v170, v156, v157
  v_cvt_pk_bf16_f32 v171, v158, v159
  v_exp_f32 v160, v160
  v_exp_f32 v161, v161
  v_exp_f32 v162, v162
  v_exp_f32 v163, v163
  v_mfma_f32_32x32x16_bf16 v[104:119], v[200:203], v[168:171], v[104:119]
  v_exp_f32 v164, v164
  v_exp_f32 v165, v165
  v_exp_f32 v166, v166
  v_exp_f32 v167, v167
  v_cvt_pk_bf16_f32 v172, v160, v161
  v_cvt_pk_bf16_f32 v173, v162, v163
  v_cvt_pk_bf16_f32 v174, v164, v165
  v_cvt_pk_bf16_f32 v175, v166, v167
  v_mfma_f32_32x32x16_bf16 v[152:167], v[208:211], v[32:35], 0
  s_andn2_b32 s33, s36, s34
  v_exp_f32 v136, v136
  v_exp_f32 v137, v137
  v_exp_f32 v138, v138
  v_mfma_f32_32x32x16_bf16 v[104:119], v[204:207], v[172:175], v[104:119]
  s_cbranch_scc0 .g2_kernel_a_N2c
.g2_kernel_a_N2b:
  v_exp_f32 v139, v139
  v_exp_f32 v140, v140
  v_exp_f32 v141, v141
  v_smfmac_f32_16x16x64_bf16 v[132:135], v[16:19], v[168:175], v20
  s_ff1_i32_b32 s33, s33
  v_exp_f32 v142, v142
  v_exp_f32 v143, v143
  v_mfma_f32_32x32x16_bf16 v[152:167], v[212:215], v[36:39], v[152:167]
  s_bitset1_b32 s34, s33
  v_cvt_pk_bf16_f32 v168, v136, v137
  v_cvt_pk_bf16_f32 v169, v138, v139
  v_cvt_pk_bf16_f32 v170, v140, v141
  v_cvt_pk_bf16_f32 v171, v142, v143
  v_exp_f32 v144, v144
  v_exp_f32 v145, v145
  v_exp_f32 v146, v146
  v_exp_f32 v147, v147
  v_mfma_f32_32x32x16_bf16 v[56:71], v[216:219], v[168:171], v[56:71]
  s_xor_b32 s33, s33, s24
  v_exp_f32 v148, v148
  v_exp_f32 v149, v149
  v_exp_f32 v150, v150
  v_exp_f32 v151, v151
  v_cvt_pk_bf16_f32 v172, v144, v145
  v_cvt_pk_bf16_f32 v173, v146, v147
  v_cvt_pk_bf16_f32 v174, v148, v149
  v_cvt_pk_bf16_f32 v175, v150, v151
  v_mfma_f32_32x32x16_bf16 v[136:151], v[208:211], v[40:43], 0
  s_lshl_b32 s33, s33, s25
  v_exp_f32 v152, v152
  v_exp_f32 v153, v153
  v_exp_f32 v154, v154
  v_mfma_f32_32x32x16_bf16 v[56:71], v[220:223], v[172:175], v[56:71]
  s_add_u32 s22, s20, s33
  v_exp_f32 v155, v155
  v_exp_f32 v156, v156
  v_exp_f32 v157, v157
  v_smfmac_f32_16x16x64_bf16 v[120:123], v[16:19], v[168:175], v20
  s_addc_u32 s23, s21, 0
  v_exp_f32 v158, v158
  v_exp_f32 v159, v159
  v_mfma_f32_32x32x16_bf16 v[136:151], v[212:215], v[44:47], v[136:151]
  v_cvt_pk_bf16_f32 v168, v152, v153
  v_cvt_pk_bf16_f32 v169, v154, v155
  v_cvt_pk_bf16_f32 v170, v156, v157
  v_cvt_pk_bf16_f32 v171, v158, v159
  v_exp_f32 v160, v160
  v_exp_f32 v161, v161
  v_exp_f32 v162, v162
  v_exp_f32 v163, v163
  v_mfma_f32_32x32x16_bf16 v[72:87], v[216:219], v[168:171], v[72:87]
  v_exp_f32 v164, v164
  v_exp_f32 v165, v165
  v_exp_f32 v166, v166
  v_exp_f32 v167, v167
  v_cvt_pk_bf16_f32 v172, v160, v161
  v_cvt_pk_bf16_f32 v173, v162, v163
  v_cvt_pk_bf16_f32 v174, v164, v165
  v_cvt_pk_bf16_f32 v175, v166, v167
  v_mfma_f32_32x32x16_bf16 v[152:167], v[208:211], v[48:51], 0
  v_exp_f32 v136, v136
  v_exp_f32 v137, v137
  v_exp_f32 v138, v138
  v_mfma_f32_32x32x16_bf16 v[72:87], v[220:223], v[172:175], v[72:87]
  v_exp_f32 v139, v139
  v_exp_f32 v140, v140
  v_exp_f32 v141, v141
  v_smfmac_f32_16x16x64_bf16 v[124:127], v[16:19], v[168:175], v20
  global_load_dwordx4 v[192:195], v3, s[22:23] offset:0
  global_load_dwordx4 v[196:199], v3, s[22:23] offset:1024
  global_load_dwordx4 v[200:203], v3, s[22:23] offset:2048
  global_load_dwordx4 v[204:207], v3, s[22:23] offset:3072
  v_exp_f32 v142, v142
  v_exp_f32 v143, v143
  v_mfma_f32_32x32x16_bf16 v[152:167], v[212:215], v[52:55], v[152:167]
  v_cvt_pk_bf16_f32 v168, v136, v137
  v_cvt_pk_bf16_f32 v169, v138, v139
  v_cvt_pk_bf16_f32 v170, v140, v141
  v_cvt_pk_bf16_f32 v171, v142, v143
  v_exp_f32 v144, v144
  v_exp_f32 v145, v145
  v_exp_f32 v146, v146
  v_exp_f32 v147, v147
  v_mfma_f32_32x32x16_bf16 v[88:103], v[216:219], v[168:171], v[88:103]
  s_waitcnt vmcnt(8)
  v_exp_f32 v148, v148
  v_exp_f32 v149, v149
  v_exp_f32 v150, v150
  v_exp_f32 v151, v151
  v_cvt_pk_bf16_f32 v172, v144, v145
  v_cvt_pk_bf16_f32 v173, v146, v147
  v_cvt_pk_bf16_f32 v174, v148, v149
  v_cvt_pk_bf16_f32 v175, v150, v151
  v_mfma_f32_32x32x16_bf16 v[136:151], v[224:227], v[24:27], 0
  v_exp_f32 v152, v152
  v_exp_f32 v153, v153
  v_exp_f32 v154, v154
  v_mfma_f32_32x32x16_bf16 v[88:103], v[220:223], v[172:175], v[88:103]
  v_exp_f32 v155, v155
  v_exp_f32 v156, v156
  v_exp_f32 v157, v157
  v_smfmac_f32_16x16x64_bf16 v[128:131], v[16:19], v[168:175], v20
  v_exp_f32 v158, v158
  v_exp_f32 v159, v159
  v_mfma_f32_32x32x16_bf16 v[136:151], v[228:231], v[28:31], v[136:151]
  s_and_b32 s28, s32, 3
  v_cvt_pk_bf16_f32 v168, v152, v153
  v_cvt_pk_bf16_f32 v169, v154, v155
  v_cvt_pk_bf16_f32 v170, v156, v157
  v_cvt_pk_bf16_f32 v171, v158, v159
  v_exp_f32 v160, v160
  v_exp_f32 v161, v161
  v_exp_f32 v162, v162
  v_exp_f32 v163, v163
  v_mfma_f32_32x32x16_bf16 v[104:119], v[216:219], v[168:171], v[104:119]
  s_cmp_eq_u32 s28, 3
  v_exp_f32 v164, v164
  v_exp_f32 v165, v165
  v_exp_f32 v166, v166
  v_exp_f32 v167, v167
  v_cvt_pk_bf16_f32 v172, v160, v161
  v_cvt_pk_bf16_f32 v173, v162, v163
  v_cvt_pk_bf16_f32 v174, v164, v165
  v_cvt_pk_bf16_f32 v175, v166, v167
  s_cbranch_scc1 .g2_kernel_a_last
  v_mfma_f32_32x32x16_bf16 v[152:167], v[224:227], v[32:35], 0
  s_andn2_b32 s33, s36, s34
  v_exp_f32 v136, v136
  v_exp_f32 v137, v137
  v_exp_f32 v138, v138
  v_mfma_f32_32x32x16_bf16 v[104:119], v[220:223], v[172:175], v[104:119]
  s_cbranch_scc0 .g2_kernel_a_N3c
.g2_kernel_a_N3b:
  v_exp_f32 v139, v139
  v_exp_f32 v140, v140
  v_exp_f32 v141, v141
  v_smfmac_f32_16x16x64_bf16 v[132:135], v[16:19], v[168:175], v20
  s_ff1_i32_b32 s33, s33
  v_exp_f32 v142, v142
  v_exp_f32 v143, v143
  v_mfma_f32_32x32x16_bf16 v[152:167], v[228:231], v[36:39], v[152:167]
  s_bitset1_b32 s34, s33
  v_cvt_pk_bf16_f32 v168, v136, v137
  v_cvt_pk_bf16_f32 v169, v138, v139
  v_cvt_pk_bf16_f32 v170, v140, v141
  v_cvt_pk_bf16_f32 v171, v142, v143
  v_exp_f32 v144, v144
  v_exp_f32 v145, v145
  v_exp_f32 v146, v146
  v_exp_f32 v147, v147
  v_mfma_f32_32x32x16_bf16 v[56:71], v[232:235], v[168:171], v[56:71]
  s_xor_b32 s33, s33, s24
  v_exp_f32 v148, v148
  v_exp_f32 v149, v149
  v_exp_f32 v150, v150
  v_exp_f32 v151, v151
  v_cvt_pk_bf16_f32 v172, v144, v145
  v_cvt_pk_bf16_f32 v173, v146, v147
  v_cvt_pk_bf16_f32 v174, v148, v149
  v_cvt_pk_bf16_f32 v175, v150, v151
  v_mfma_f32_32x32x16_bf16 v[136:151], v[224:227], v[40:43], 0
  s_lshl_b32 s33, s33, s25
  v_exp_f32 v152, v152
  v_exp_f32 v153, v153
  v_exp_f32 v154, v154
  v_mfma_f32_32x32x16_bf16 v[56:71], v[236:239], v[172:175], v[56:71]
  s_add_u32 s22, s20, s33
  v_exp_f32 v155, v155
  v_exp_f32 v156, v156
  v_exp_f32 v157, v157
  v_smfmac_f32_16x16x64_bf16 v[120:123], v[16:19], v[168:175], v20
  s_addc_u32 s23, s21, 0
  v_exp_f32 v158, v158
  v_exp_f32 v159, v159
  v_mfma_f32_32x32x16_bf16 v[136:151], v[228:231], v[44:47], v[136:151]
  v_cvt_pk_bf16_f32 v168, v152, v153
  v_cvt_pk_bf16_f32 v169, v154, v155
  v_cvt_pk_bf16_f32 v170, v156, v157
  v_cvt_pk_bf16_f32 v171, v158, v159
  v_exp_f32 v160, v160
  v_exp_f32 v161, v161
  v_exp_f32 v162, v162
  v_exp_f32 v163, v163
  v_mfma_f32_32x32x16_bf16 v[72:87], v[232:235], v[168:171], v[72:87]
  v_exp_f32 v164, v164
  v_exp_f32 v165, v165
  v_exp_f32 v166, v166
  v_exp_f32 v167, v167
  v_cvt_pk_bf16_f32 v172, v160, v161
  v_cvt_pk_bf16_f32 v173, v162, v163
  v_cvt_pk_bf16_f32 v174, v164, v165
  v_cvt_pk_bf16_f32 v175, v166, v167
  v_mfma_f32_32x32x16_bf16 v[152:167], v[224:227], v[48:51], 0
  v_exp_f32 v136, v136
  v_exp_f32 v137, v137
  v_exp_f32 v138, v138
  v_mfma_f32_32x32x16_bf16 v[72:87], v[236:239], v[172:175], v[72:87]
  v_exp_f32 v139, v139
  v_exp_f32 v140, v140
  v_exp_f32 v141, v141
  v_smfmac_f32_16x16x64_bf16 v[124:127], v[16:19], v[168:175], v20
  global_load_dwordx4 v[208:211], v3, s[22:23] offset:0
  global_load_dwordx4 v[212:215], v3, s[22:23] offset:1024
  global_load_dwordx4 v[216:219], v3, s[22:23] offset:2048
  global_load_dwordx4 v[220:223], v3, s[22:23] offset:3072
  v_exp_f32 v142, v142
  v_exp_f32 v143, v143
  v_mfma_f32_32x32x16_bf16 v[152:167], v[228:231], v[52:55], v[152:167]
  v_cvt_pk_bf16_f32 v168, v136, v137
  v_cvt_pk_bf16_f32 v169, v138, v139
  v_cvt_pk_bf16_f32 v170, v140, v141
  v_cvt_pk_bf16_f32 v171, v142, v143
  v_exp_f32 v144, v144
  v_exp_f32 v145, v145
  v_exp_f32 v146, v146
  v_exp_f32 v147, v147
  v_mfma_f32_32x32x16_bf16 v[88:103], v[232:235], v[168:171], v[88:103]
  s_waitcnt vmcnt(8)
  v_exp_f32 v148, v148
  v_exp_f32 v149, v149
  v_exp_f32 v150, v150
  v_exp_f32 v151, v151
  v_cvt_pk_bf16_f32 v172, v144, v145
  v_cvt_pk_bf16_f32 v173, v146, v147
  v_cvt_pk_bf16_f32 v174, v148, v149
  v_cvt_pk_bf16_f32 v175, v150, v151
  v_mfma_f32_32x32x16_bf16 v[136:151], v[176:179], v[24:27], 0
  v_exp_f32 v152, v152
  v_exp_f32 v153, v153
  v_exp_f32 v154, v154
  v_mfma_f32_32x32x16_bf16 v[88:103], v[236:239], v[172:175], v[88:103]
  v_exp_f32 v155, v155
  v_exp_f32 v156, v156
  v_exp_f32 v157, v157
  v_smfmac_f32_16x16x64_bf16 v[128:131], v[16:19], v[168:175], v20
  v_exp_f32 v158, v158
  v_exp_f32 v159, v159
  v_mfma_f32_32x32x16_bf16 v[136:151], v[180:183], v[28:31], v[136:151]
  s_add_u32 s32, s32, 1
  v_cvt_pk_bf16_f32 v168, v152, v153
  v_cvt_pk_bf16_f32 v169, v154, v155
  v_cvt_pk_bf16_f32 v170, v156, v157
  v_cvt_pk_bf16_f32 v171, v158, v159
  v_exp_f32 v160, v160
  v_exp_f32 v161, v161
  v_exp_f32 v162, v162
  v_exp_f32 v163, v163
  v_mfma_f32_32x32x16_bf16 v[104:119], v[232:235], v[168:171], v[104:119]
  s_cmp_eq_u32 s35, 0
  v_exp_f32 v164, v164
  v_exp_f32 v165, v165
  v_exp_f32 v166, v166
  v_exp_f32 v167, v167
  v_cvt_pk_bf16_f32 v172, v160, v161
  v_cvt_pk_bf16_f32 v173, v162, v163
  v_cvt_pk_bf16_f32 v174, v164, v165
  v_cvt_pk_bf16_f32 v175, v166, v167
  s_cbranch_scc1 .g2_kernel_a_loop
  s_branch .g2_kernel_a_redo
.g2_kernel_a_last:
  v_mfma_f32_32x32x16_bf16 v[152:167], v[224:227], v[32:35], 0
  ds_read_b32 v21, v13 offset:8
  s_andn2_b32 s33, s36, s34
  v_exp_f32 v136, v136
  v_exp_f32 v137, v137
  v_exp_f32 v138, v138
  v_mfma_f32_32x32x16_bf16 v[104:119], v[220:223], v[172:175], v[104:119]
  s_cbranch_scc0 .g2_kernel_a_L3c
.g2_kernel_a_L3b:
  v_exp_f32 v139, v139
  v_exp_f32 v140, v140
  v_exp_f32 v141, v141
  v_smfmac_f32_16x16x64_bf16 v[132:135], v[16:19], v[168:175], v20
  s_ff1_i32_b32 s33, s33
  v_exp_f32 v142, v142
  v_exp_f32 v143, v143
  v_mfma_f32_32x32x16_bf16 v[152:167], v[228:231], v[36:39], v[152:167]
  s_bitset1_b32 s34, s33
  ds_read_b128 v[24:27], v14 offset:0
  v_cvt_pk_bf16_f32 v168, v136, v137
  v_cvt_pk_bf16_f32 v169, v138, v139
  v_cvt_pk_bf16_f32 v170, v140, v141
  v_cvt_pk_bf16_f32 v171, v142, v143
  v_exp_f32 v144, v144
  v_exp_f32 v145, v145
  v_exp_f32 v146, v146
  v_exp_f32 v147, v147
  v_mfma_f32_32x32x16_bf16 v[56:71], v[232:235], v[168:171], v[56:71]
  s_xor_b32 s33, s33, s24
  ds_read_b128 v[28:31], v14 offset:1024
  v_exp_f32 v148, v148
  v_exp_f32 v149, v149
  v_exp_f32 v150, v150
  v_exp_f32 v151, v151
  v_cvt_pk_bf16_f32 v172, v144, v145
  v_cvt_pk_bf16_f32 v173, v146, v147
  v_cvt_pk_bf16_f32 v174, v148, v149
  v_cvt_pk_bf16_f32 v175, v150, v151
  v_mfma_f32_32x32x16_bf16 v[136:151], v[224:227], v[40:43], 0
  s_waitcnt lgkmcnt(2)
  s_lshl_b32 s33, s33, s25
  v_exp_f32 v152, v152
  v_exp_f32 v153, v153
  v_exp_f32 v154, v154
  v_mfma_f32_32x32x16_bf16 v[56:71], v[236:239], v[172:175], v[56:71]
  v_cmp_gt_u32 vcc, s27, v21
  s_add_u32 s22, s20, s33
  v_exp_f32 v155, v155
  v_exp_f32 v156, v156
  v_exp_f32 v157, v157
  v_smfmac_f32_16x16x64_bf16 v[120:123], v[16:19], v[168:175], v20
  s_addc_u32 s23, s21, 0
  v_exp_f32 v158, v158
  v_exp_f32 v159, v159
  v_mfma_f32_32x32x16_bf16 v[136:151], v[228:231], v[44:47], v[136:151]
  v_cvt_pk_bf16_f32 v168, v152, v153
  v_cvt_pk_bf16_f32 v169, v154, v155
  v_cvt_pk_bf16_f32 v170, v156, v157
  v_cvt_pk_bf16_f32 v171, v158, v159
  v_exp_f32 v160, v160
  v_exp_f32 v161, v161
  v_exp_f32 v162, v162
  v_exp_f32 v163, v163
  v_mfma_f32_32x32x16_bf16 v[72:87], v[232:235], v[168:171], v[72:87]
  s_cbranch_vccnz .g2_kernel_a_L3g
.g2_kernel_a_L3h:
  ds_read_b128 v[32:35], v14 offset:2048
  ds_read_b128 v[36:39], v14 offset:3072
  v_cvt_pk_bf16_f32 v56, v56, v57
  v_cvt_pk_bf16_f32 v57, v58, v59
  v_cvt_pk_bf16_f32 v58, v60, v61
  v_cvt_pk_bf16_f32 v59, v62, v63
  v_add_f32 v6, v120, v121
  v_exp_f32 v164, v164
  v_exp_f32 v165, v165
  v_exp_f32 v166, v166
  v_exp_f32 v167, v167
  v_cvt_pk_bf16_f32 v172, v160, v161
  v_cvt_pk_bf16_f32 v173, v162, v163
  v_cvt_pk_bf16_f32 v174, v164, v165
  v_cvt_pk_bf16_f32 v175, v166, v167
  v_mfma_f32_32x32x16_bf16 v[152:167], v[224:227], v[48:51], 0
  ds_write_b128 v9, v[56:59] offset:0
  v_cvt_pk_bf16_f32 v60, v64, v65
  v_cvt_pk_bf16_f32 v61, v66, v67
  v_cvt_pk_bf16_f32 v62, v68, v69
  v_cvt_pk_bf16_f32 v63, v70, v71
  v_exp_f32 v136, v136
  v_exp_f32 v137, v137
  v_exp_f32 v138, v138
  v_mfma_f32_32x32x16_bf16 v[72:87], v[236:239], v[172:175], v[72:87]
  ds_write_b128 v9, v[60:63] offset:1024
  v_mov_b32 v120, 0
  v_mov_b32 v121, 0
  v_exp_f32 v139, v139
  v_exp_f32 v140, v140
  v_exp_f32 v141, v141
  v_smfmac_f32_16x16x64_bf16 v[124:127], v[16:19], v[168:175], v20
  global_load_dwordx4 v[208:211], v3, s[22:23] offset:0
  global_load_dwordx4 v[212:215], v3, s[22:23] offset:1024
  global_load_dwordx4 v[216:219], v3, s[22:23] offset:2048
  global_load_dwordx4 v[220:223], v3, s[22:23] offset:3072
  ds_write_b32 v10, v6 offset:0
  ds_write_b32 v11, v12 offset:0
  v_exp_f32 v142, v142
  v_exp_f32 v143, v143
  v_mfma_f32_32x32x16_bf16 v[152:167], v[228:231], v[52:55], v[152:167]
  ds_read_b128 v[40:43], v14 offset:4096
  s_wakeup
  v_cvt_pk_bf16_f32 v168, v136, v137
  v_cvt_pk_bf16_f32 v169, v138, v139
  v_cvt_pk_bf16_f32 v170, v140, v141
  v_cvt_pk_bf16_f32 v171, v142, v143
  v_exp_f32 v144, v144
  v_exp_f32 v145, v145
  v_exp_f32 v146, v146
  v_exp_f32 v147, v147
  v_mfma_f32_32x32x16_bf16 v[88:103], v[232:235], v[168:171], v[88:103]
  s_waitcnt vmcnt(8)
  ds_read_b128 v[44:47], v14 offset:5120
  v_cvt_pk_bf16_f32 v72, v72, v73
  v_cvt_pk_bf16_f32 v73, v74, v75
  v_cvt_pk_bf16_f32 v74, v76, v77
  v_cvt_pk_bf16_f32 v75, v78, v79
  v_add_f32 v6, v124, v125
  v_exp_f32 v148, v148
  v_exp_f32 v149, v149
  v_exp_f32 v150, v150
  v_exp_f32 v151, v151
  v_cvt_pk_bf16_f32 v172, v144, v145
  v_cvt_pk_bf16_f32 v173, v146, v147
  v_cvt_pk_bf16_f32 v174, v148, v149
  v_cvt_pk_bf16_f32 v175, v150, v151
  s_waitcnt lgkmcnt(8)
  v_mfma_f32_32x32x16_bf16 v[136:151], v[176:179], v[24:27], 0
  ds_write_b128 v9, v[72:75] offset:8192
  v_cvt_pk_bf16_f32 v76, v80, v81
  v_cvt_pk_bf16_f32 v77, v82, v83
  v_cvt_pk_bf16_f32 v78, v84, v85
  v_cvt_pk_bf16_f32 v79, v86, v87
  v_exp_f32 v152, v152
  v_exp_f32 v153, v153
  v_exp_f32 v154, v154
  v_mfma_f32_32x32x16_bf16 v[88:103], v[236:239], v[172:175], v[88:103]
  ds_write_b128 v9, v[76:79] offset:9216
  v_mov_b32 v124, 0
  v_mov_b32 v125, 0
  v_exp_f32 v155, v155
  v_exp_f32 v156, v156
  v_exp_f32 v157, v157
  v_smfmac_f32_16x16x64_bf16 v[128:131], v[16:19], v[168:175], v20
  ds_write_b32 v10, v6 offset:512
  ds_write_b32 v11, v12 offset:16
  v_exp_f32 v158, v158
  v_exp_f32 v159, v159
  v_mfma_f32_32x32x16_bf16 v[136:151], v[180:183], v[28:31], v[136:151]
  ds_read_b128 v[48:51], v14 offset:6144
  s_wakeup
  v_cvt_pk_bf16_f32 v168, v152, v153
  v_cvt_pk_bf16_f32 v169, v154, v155
  v_cvt_pk_bf16_f32 v170, v156, v157
  v_cvt_pk_bf16_f32 v171, v158, v159
  v_exp_f32 v160, v160
  v_exp_f32 v161, v161
  v_exp_f32 v162, v162
  v_exp_f32 v163, v163
  v_mfma_f32_32x32x16_bf16 v[104:119], v[232:235], v[168:171], v[104:119]
  ds_read_b128 v[52:55], v14 offset:7168
  v_cvt_pk_bf16_f32 v88, v88, v89
  v_cvt_pk_bf16_f32 v89, v90, v91
  v_cvt_pk_bf16_f32 v90, v92, v93
  v_cvt_pk_bf16_f32 v91, v94, v95
  v_add_f32 v6, v128, v129
  ds_write_b128 v9, v[88:91] offset:16384
  v_cvt_pk_bf16_f32 v92, v96, v97
  v_cvt_pk_bf16_f32 v93, v98, v99
  v_cvt_pk_bf16_f32 v94, v100, v101
  v_cvt_pk_bf16_f32 v95, v102, v103
  ds_write_b128 v9, v[92:95] offset:17408
  v_mov_b32 v128, 0
  v_mov_b32 v129, 0
  ds_write_b32 v10, v6 offset:1024
  ds_write_b32 v11, v12 offset:32
  s_add_u32 s32, s32, 1
  v_exp_f32 v164, v164
  v_exp_f32 v165, v165
  v_exp_f32 v166, v166
  v_exp_f32 v167, v167
  v_cvt_pk_bf16_f32 v172, v160, v161
  v_cvt_pk_bf16_f32 v173, v162, v163
  v_cvt_pk_bf16_f32 v174, v164, v165
  v_cvt_pk_bf16_f32 v175, v166, v167
  s_cmp_eq_u32 s32, 8
  s_cbranch_scc1 .g2_kernel_a_end
  s_waitcnt lgkmcnt(15)
  v_mfma_f32_32x32x16_bf16 v[152:167], v[176:179], v[32:35], 0
  s_andn2_b32 s33, s36, s34
  v_exp_f32 v136, v136
  v_exp_f32 v137, v137
  v_exp_f32 v138, v138
  v_mfma_f32_32x32x16_bf16 v[104:119], v[236:239], v[172:175], v[104:119]
  s_cbranch_scc0 .g2_kernel_a_G0c
.g2_kernel_a_G0b:
  v_exp_f32 v139, v139
  v_exp_f32 v140, v140
  v_exp_f32 v141, v141
  v_smfmac_f32_16x16x64_bf16 v[132:135], v[16:19], v[168:175], v20
  s_ff1_i32_b32 s33, s33
  v_exp_f32 v142, v142
  v_exp_f32 v143, v143
  v_mfma_f32_32x32x16_bf16 v[152:167], v[180:183], v[36:39], v[152:167]
  s_bitset1_b32 s34, s33
  v_cvt_pk_bf16_f32 v168, v136, v137
  v_cvt_pk_bf16_f32 v169, v138, v139
  v_cvt_pk_bf16_f32 v170, v140, v141
  v_cvt_pk_bf16_f32 v171, v142, v143
  v_exp_f32 v144, v144
  v_exp_f32 v145, v145
  v_exp_f32 v146, v146
  v_exp_f32 v147, v147
  s_waitcnt lgkmcnt(14)
  v_mfma_f32_32x32x16_bf16 v[56:71], v[184:187], v[168:171], 0
  s_xor_b32 s33, s33, s24
  v_cvt_pk_bf16_f32 v104, v104, v105
  v_cvt_pk_bf16_f32 v105, v106, v107
  v_cvt_pk_bf16_f32 v106, v108, v109
  v_cvt_pk_bf16_f32 v107, v110, v111
  v_add_f32 v6, v132, v133
  v_exp_f32 v148, v148
  v_exp_f32 v149, v149
  v_exp_f32 v150, v150
  v_exp_f32 v151, v151
  v_cvt_pk_bf16_f32 v172, v144, v145
  v_cvt_pk_bf16_f32 v173, v146, v147
  v_cvt_pk_bf16_f32 v174, v148, v149
  v_cvt_pk_bf16_f32 v175, v150, v151
  s_waitcnt lgkmcnt(10)
  v_mfma_f32_32x32x16_bf16 v[136:151], v[176:179], v[40:43], 0
  s_lshl_b32 s33, s33, s25
  ds_write_b128 v9, v[104:107] offset:24576
  v_cvt_pk_bf16_f32 v108, v112, v113
  v_cvt_pk_bf16_f32 v109, v114, v115
  v_cvt_pk_bf16_f32 v110, v116, v117
  v_cvt_pk_bf16_f32 v111, v118, v119
  v_exp_f32 v152, v152
  v_exp_f32 v153, v153
  v_exp_f32 v154, v154
  v_mfma_f32_32x32x16_bf16 v[56:71], v[188:191], v[172:175], v[56:71]
  s_add_u32 s22, s20, s33
  ds_write_b128 v9, v[108:111] offset:25600
  v_mov_b32 v132, 0
  v_mov_b32 v133, 0
  v_exp_f32 v155, v155
  v_exp_f32 v156, v156
  v_exp_f32 v157, v157
  v_smfmac_f32_16x16x64_bf16 v[120:123], v[16:19], v[168:175], v20
  s_addc_u32 s23, s21, 0
  ds_write_b32 v10, v6 offset:1536
  v_exp_f32 v158, v158
  v_exp_f32 v159, v159
  v_mfma_f32_32x32x16_bf16 v[136:151], v[180:183], v[44:47], v[136:151]
  v_cvt_pk_bf16_f32 v168, v152, v153
  v_cvt_pk_bf16_f32 v169, v154, v155
  v_cvt_pk_bf16_f32 v170, v156, v157
  v_cvt_pk_bf16_f32 v171, v158, v159
  v_exp_f32 v160, v160
  v_exp_f32 v161, v161
  v_exp_f32 v162, v162
  v_exp_f32 v163, v163
  s_waitcnt lgkmcnt(11)
  v_mfma_f32_32x32x16_bf16 v[72:87], v[184:187], v[168:171], 0
  ds_write_b32 v11, v12 offset:48
  v_exp_f32 v164, v164
  v_exp_f32 v165, v165
  v_exp_f32 v166, v166
  v_exp_f32 v167, v167
  v_cvt_pk_bf16_f32 v172, v160, v161
  v_cvt_pk_bf16_f32 v173, v162, v163
  v_cvt_pk_bf16_f32 v174, v164, v165
  v_cvt_pk_bf16_f32 v175, v166, v167
  s_waitcnt lgkmcnt(8)
  v_mfma_f32_32x32x16_bf16 v[152:167], v[176:179], v[48:51], 0
  v_add_u32 v12, 1, v12
  v_exp_f32 v136, v136
  v_exp_f32 v137, v137
  v_exp_f32 v138, v138
  v_mfma_f32_32x32x16_bf16 v[72:87], v[188:191], v[172:175], v[72:87]
  v_exp_f32 v139, v139
  v_exp_f32 v140, v140
  v_exp_f32 v141, v141
  v_smfmac_f32_16x16x64_bf16 v[124:127], v[16:19], v[168:175], v20
  global_load_dwordx4 v[224:227], v3, s[22:23] offset:0
  global_load_dwordx4 v[228:231], v3, s[22:23] offset:1024
  global_load_dwordx4 v[232:235], v3, s[22:23] offset:2048
  global_load_dwordx4 v[236:239], v3, s[22:23] offset:3072
  s_add_u32 s27, s27, 4
  v_exp_f32 v142, v142
  v_exp_f32 v143, v143
  v_mfma_f32_32x32x16_bf16 v[152:167], v[180:183], v[52:55], v[152:167]
  v_cvt_pk_bf16_f32 v168, v136, v137
  v_cvt_pk_bf16_f32 v169, v138, v139
  v_cvt_pk_bf16_f32 v170, v140, v141
  v_cvt_pk_bf16_f32 v171, v142, v143
  v_exp_f32 v144, v144
  v_exp_f32 v145, v145
  v_exp_f32 v146, v146
  v_exp_f32 v147, v147
  s_waitcnt lgkmcnt(6)
  v_mfma_f32_32x32x16_bf16 v[88:103], v[184:187], v[168:171], 0
  s_waitcnt vmcnt(8)
  v_exp_f32 v148, v148
  v_exp_f32 v149, v149
  v_exp_f32 v150, v150
  v_exp_f32 v151, v151
  v_cvt_pk_bf16_f32 v172, v144, v145
  v_cvt_pk_bf16_f32 v173, v146, v147
  v_cvt_pk_bf16_f32 v174, v148, v149
  v_cvt_pk_bf16_f32 v175, v150, v151
  v_mfma_f32_32x32x16_bf16 v[136:151], v[192:195], v[24:27], 0
  v_exp_f32 v152, v152
  v_exp_f32 v153, v153
  v_exp_f32 v154, v154
  v_mfma_f32_32x32x16_bf16 v[88:103], v[188:191], v[172:175], v[88:103]
  v_exp_f32 v155, v155
  v_exp_f32 v156, v156
  v_exp_f32 v157, v157
  v_smfmac_f32_16x16x64_bf16 v[128:131], v[16:19], v[168:175], v20
  v_exp_f32 v158, v158
  v_exp_f32 v159, v159
  v_mfma_f32_32x32x16_bf16 v[136:151], v[196:199], v[28:31], v[136:151]
  v_cvt_pk_bf16_f32 v168, v152, v153
  v_cvt_pk_bf16_f32 v169, v154, v155
  v_cvt_pk_bf16_f32 v170, v156, v157
  v_cvt_pk_bf16_f32 v171, v158, v159
  v_exp_f32 v160, v160
  v_exp_f32 v161, v161
  v_exp_f32 v162, v162
  v_exp_f32 v163, v163
  s_waitcnt lgkmcnt(2)
  v_mfma_f32_32x32x16_bf16 v[104:119], v[184:187], v[168:171], 0
  v_exp_f32 v164, v164
  v_exp_f32 v165, v165
  v_exp_f32 v166, v166
  v_exp_f32 v167, v167
  v_cvt_pk_bf16_f32 v172, v160, v161
  v_cvt_pk_bf16_f32 v173, v162, v163
  v_cvt_pk_bf16_f32 v174, v164, v165
  v_cvt_pk_bf16_f32 v175, v166, v167
  s_branch .g2_kernel_a_n1
.g2_kernel_a_end:
  v_mfma_f32_32x32x16_bf16 v[104:119], v[236:239], v[172:175], v[104:119]
  v_smfmac_f32_16x16x64_bf16 v[132:135], v[16:19], v[168:175], v20
  s_wakeup
  s_nop 9
  v_cvt_pk_bf16_f32 v104, v104, v105
  v_cvt_pk_bf16_f32 v105, v106, v107
  v_cvt_pk_bf16_f32 v106, v108, v109
  v_cvt_pk_bf16_f32 v107, v110, v111
  v_add_f32 v6, v132, v133
  ds_write_b128 v9, v[104:107] offset:24576
  v_cvt_pk_bf16_f32 v108, v112, v113
  v_cvt_pk_bf16_f32 v109, v114, v115
  v_cvt_pk_bf16_f32 v110, v116, v117
  v_cvt_pk_bf16_f32 v111, v118, v119
  ds_write_b128 v9, v[108:111] offset:25600
  v_mov_b32 v132, 0
  v_mov_b32 v133, 0
  ds_write_b32 v10, v6 offset:1536
  ds_write_b32 v11, v12 offset:48
  s_waitcnt lgkmcnt(4)
  v_mov_b32 v20, s71
  v_lshrrev_b32 v17, 5, v2
  v_and_b32 v18, 31, v2
  s_lshl_b32 s28, s16, 5
  v_add_u32 v19, s28, v18
  v_lshlrev_b32 v7, 2, v19
  v_add_u32 v7, 155648, v7
  ds_read_b32 v8, v7 offset:3840
  ds_read_b32 v9, v7 offset:4352
  ds_read_b32 v16, v20 offset:24
  ds_read_b32 v6, v20 offset:52
  v_add_u32 v19, 1, v19
  v_bfe_u32 v7, v2, 2, 2
  v_lshl_add_u32 v14, v17, 2, v7
  v_lshlrev_b32 v14, 7, v14
  v_lshrrev_b32 v7, 1, v7
  v_lshl_add_u32 v14, v7, 6, v14
  v_bfe_u32 v7, v2, 4, 1
  v_lshl_add_u32 v14, v7, 5, v14
  v_and_b32 v7, 1, v2
  v_lshl_add_u32 v14, v7, 4, v14
  v_bfe_u32 v7, v2, 1, 1
  v_lshl_add_u32 v14, v7, 3, v14
  v_xor_b32 v15, 64, v14
  v_and_b32 v7, 7, v2
  v_xor_b32 v7, s24, v7
  s_lshl_b32 s28, s16, 6
  s_add_u32 s28, s28, 157952
  v_lshl_add_u32 v21, v7, 3, s28
  v_lshlrev_b32 v24, 16, v240
  v_and_b32 v25, 0xffff0000, v240
  v_lshlrev_b32 v26, 16, v241
  v_and_b32 v27, 0xffff0000, v241
  v_lshlrev_b32 v28, 16, v242
  v_and_b32 v29, 0xffff0000, v242
  v_lshlrev_b32 v30, 16, v243
  v_and_b32 v31, 0xffff0000, v243
  v_lshlrev_b32 v32, 16, v244
  v_and_b32 v33, 0xffff0000, v244
  v_lshlrev_b32 v34, 16, v245
  v_and_b32 v35, 0xffff0000, v245
  v_lshlrev_b32 v36, 16, v246
  v_and_b32 v37, 0xffff0000, v246
  v_lshlrev_b32 v38, 16, v247
  v_and_b32 v39, 0xffff0000, v247
  v_lshlrev_b32 v40, 16, v248
  v_and_b32 v41, 0xffff0000, v248
  v_lshlrev_b32 v42, 16, v249
  v_and_b32 v43, 0xffff0000, v249
  v_lshlrev_b32 v44, 16, v250
  v_and_b32 v45, 0xffff0000, v250
  v_lshlrev_b32 v46, 16, v251
  v_and_b32 v47, 0xffff0000, v251
  v_lshlrev_b32 v48, 16, v252
  v_and_b32 v49, 0xffff0000, v252
  v_lshlrev_b32 v50, 16, v253
  v_and_b32 v51, 0xffff0000, v253
  v_lshlrev_b32 v52, 16, v254
  v_and_b32 v53, 0xffff0000, v254
  v_lshlrev_b32 v54, 16, v255
  v_and_b32 v55, 0xffff0000, v255
  s_waitcnt lgkmcnt(0)
  v_cmp_gt_u32 vcc, 4, v6
  s_cbranch_vccnz .g2_kernel_w_aw
.g2_kernel_w_ab:
  s_xor_b32 s28, s24, 0
  s_lshl_b32 s28, s28, 13
  s_add_u32 s28, s28, 65536
  v_add_u32 v10, s28, v14
  v_add_u32 v11, s28, v15
  ds_read_b64_tr_b16 v[104:105], v10 offset:0
  ds_read_b64_tr_b16 v[106:107], v10 offset:1024
  ds_read_b64_tr_b16 v[108:109], v11 offset:0
  ds_read_b64_tr_b16 v[110:111], v11 offset:1024
  ds_read_b64_tr_b16 v[112:113], v10 offset:2048
  ds_read_b64_tr_b16 v[114:115], v10 offset:3072
  ds_read_b64_tr_b16 v[116:117], v11 offset:2048
  ds_read_b64_tr_b16 v[118:119], v11 offset:3072
  ds_read_b64_tr_b16 v[120:121], v10 offset:4096
  ds_read_b64_tr_b16 v[122:123], v10 offset:5120
  ds_read_b64_tr_b16 v[124:125], v11 offset:4096
  ds_read_b64_tr_b16 v[126:127], v11 offset:5120
  s_andn2_b32 s33, s36, s34
  s_ff1_i32_b32 s33, s33
  s_bitset1_b32 s34, s33
  s_xor_b32 s33, s33, s24
  s_lshl_b32 s33, s33, 12
  s_add_u32 s22, s20, s33
  s_addc_u32 s23, s21, 0
  global_load_dwordx4 v[224:227], v3, s[22:23] offset:0
  global_load_dwordx4 v[228:231], v3, s[22:23] offset:1024
  global_load_dwordx4 v[232:235], v3, s[22:23] offset:2048
  global_load_dwordx4 v[236:239], v3, s[22:23] offset:3072
  v_pk_fma_f32 v[24:25], v[24:25], v[8:9], v[8:9] op_sel:[0,0,1] op_sel_hi:[1,0,1]
  v_pk_fma_f32 v[26:27], v[26:27], v[8:9], v[8:9] op_sel:[0,0,1] op_sel_hi:[1,0,1]
  v_pk_fma_f32 v[28:29], v[28:29], v[8:9], v[8:9] op_sel:[0,0,1] op_sel_hi:[1,0,1]
  v_pk_fma_f32 v[30:31], v[30:31], v[8:9], v[8:9] op_sel:[0,0,1] op_sel_hi:[1,0,1]
  v_pk_fma_f32 v[32:33], v[32:33], v[8:9], v[8:9] op_sel:[0,0,1] op_sel_hi:[1,0,1]
  v_pk_fma_f32 v[34:35], v[34:35], v[8:9], v[8:9] op_sel:[0,0,1] op_sel_hi:[1,0,1]
  v_pk_fma_f32 v[36:37], v[36:37], v[8:9], v[8:9] op_sel:[0,0,1] op_sel_hi:[1,0,1]
  v_pk_fma_f32 v[38:39], v[38:39], v[8:9], v[8:9] op_sel:[0,0,1] op_sel_hi:[1,0,1]
  v_pk_fma_f32 v[40:41], v[40:41], v[8:9], v[8:9] op_sel:[0,0,1] op_sel_hi:[1,0,1]
  v_pk_fma_f32 v[42:43], v[42:43], v[8:9], v[8:9] op_sel:[0,0,1] op_sel_hi:[1,0,1]
  v_pk_fma_f32 v[44:45], v[44:45], v[8:9], v[8:9] op_sel:[0,0,1] op_sel_hi:[1,0,1]
  v_pk_fma_f32 v[46:47], v[46:47], v[8:9], v[8:9] op_sel:[0,0,1] op_sel_hi:[1,0,1]
  v_pk_fma_f32 v[48:49], v[48:49], v[8:9], v[8:9] op_sel:[0,0,1] op_sel_hi:[1,0,1]
  v_pk_fma_f32 v[50:51], v[50:51], v[8:9], v[8:9] op_sel:[0,0,1] op_sel_hi:[1,0,1]
  v_pk_fma_f32 v[52:53], v[52:53], v[8:9], v[8:9] op_sel:[0,0,1] op_sel_hi:[1,0,1]
  v_pk_fma_f32 v[54:55], v[54:55], v[8:9], v[8:9] op_sel:[0,0,1] op_sel_hi:[1,0,1]
  v_cmp_eq_u32 vcc, v16, v19
  s_cbranch_vccnz .g2_kernel_w_pt
.g2_kernel_w_pb:
  s_mov_b32 s72, s48
  s_mov_b32 s73, s49
  s_mov_b32 s74, 0x800
  s_mov_b32 s75, 0x00020000
  s_waitcnt vmcnt(15) lgkmcnt(8)
  v_mfma_f32_32x32x16_bf16 v[24:39], v[104:107], v[176:179], v[24:39]
  s_xor_b32 s28, s24, 1
  s_lshl_b32 s28, s28, 13
  s_add_u32 s28, s28, 65536
  ds_read_b64_tr_b16 v[128:129], v10 offset:6144
  ds_read_b64_tr_b16 v[130:131], v10 offset:7168
  v_mfma_f32_32x32x16_bf16 v[40:55], v[108:111], v[176:179], v[40:55]
  v_add_u32 v12, s28, v14
  v_add_u32 v13, s28, v15
  s_andn2_b32 s33, s36, s34
  ds_read_b64_tr_b16 v[132:133], v11 offset:6144
  ds_read_b64_tr_b16 v[134:135], v11 offset:7168
  s_waitcnt vmcnt(14) lgkmcnt(8)
  v_mfma_f32_32x32x16_bf16 v[24:39], v[112:115], v[180:183], v[24:39]
  s_ff1_i32_b32 s33, s33
  s_bitset1_b32 s34, s33
  s_xor_b32 s33, s33, s24
  ds_read_b64_tr_b16 v[104:105], v12 offset:0
  ds_read_b64_tr_b16 v[106:107], v12 offset:1024
  v_mfma_f32_32x32x16_bf16 v[40:55], v[116:119], v[180:183], v[40:55]
  s_lshl_b32 s33, s33, 12
  s_add_u32 s22, s20, s33
  s_addc_u32 s23, s21, 0
  ds_read_b64_tr_b16 v[108:109], v13 offset:0
  ds_read_b64_tr_b16 v[110:111], v13 offset:1024
  s_waitcnt vmcnt(13) lgkmcnt(8)
  v_mfma_f32_32x32x16_bf16 v[24:39], v[120:123], v[184:187], v[24:39]
  global_load_dwordx4 v[136:139], v3, s[22:23] offset:0
  global_load_dwordx4 v[140:143], v3, s[22:23] offset:1024
  global_load_dwordx4 v[144:147], v3, s[22:23] offset:2048
  ds_read_b64_tr_b16 v[112:113], v12 offset:2048
  ds_read_b64_tr_b16 v[114:115], v12 offset:3072
  v_mfma_f32_32x32x16_bf16 v[40:55], v[124:127], v[184:187], v[40:55]
  global_load_dwordx4 v[148:151], v3, s[22:23] offset:3072
  ds_read_b64_tr_b16 v[116:117], v13 offset:2048
  ds_read_b64_tr_b16 v[118:119], v13 offset:3072
  s_waitcnt vmcnt(16) lgkmcnt(8)
  v_mfma_f32_32x32x16_bf16 v[24:39], v[128:131], v[188:191], v[24:39]
  ds_read_b64_tr_b16 v[120:121], v12 offset:4096
  ds_read_b64_tr_b16 v[122:123], v12 offset:5120
  v_mfma_f32_32x32x16_bf16 v[40:55], v[132:135], v[188:191], v[40:55]
  ds_read_b64_tr_b16 v[124:125], v13 offset:4096
  ds_read_b64_tr_b16 v[126:127], v13 offset:5120
  s_waitcnt vmcnt(15) lgkmcnt(8)
  v_mfma_f32_32x32x16_bf16 v[24:39], v[104:107], v[192:195], v[24:39]
  s_xor_b32 s28, s24, 2
  s_lshl_b32 s28, s28, 13
  s_add_u32 s28, s28, 65536
  ds_read_b64_tr_b16 v[128:129], v12 offset:6144
  ds_read_b64_tr_b16 v[130:131], v12 offset:7168
  v_mfma_f32_32x32x16_bf16 v[40:55], v[108:111], v[192:195], v[40:55]
  v_add_u32 v10, s28, v14
  v_add_u32 v11, s28, v15
  s_andn2_b32 s33, s36, s34
  ds_read_b64_tr_b16 v[132:133], v13 offset:6144
  ds_read_b64_tr_b16 v[134:135], v13 offset:7168
  s_waitcnt vmcnt(14) lgkmcnt(8)
  v_mfma_f32_32x32x16_bf16 v[24:39], v[112:115], v[196:199], v[24:39]
  s_ff1_i32_b32 s33, s33
  s_bitset1_b32 s34, s33
  s_xor_b32 s33, s33, s24
  ds_read_b64_tr_b16 v[104:105], v10 offset:0
  ds_read_b64_tr_b16 v[106:107], v10 offset:1024
  v_mfma_f32_32x32x16_bf16 v[40:55], v[116:119], v[196:199], v[40:55]
  s_lshl_b32 s33, s33, 12
  s_add_u32 s22, s20, s33
  s_addc_u32 s23, s21, 0
  ds_read_b64_tr_b16 v[108:109], v11 offset:0
  ds_read_b64_tr_b16 v[110:111], v11 offset:1024
  s_waitcnt vmcnt(13) lgkmcnt(8)
  v_mfma_f32_32x32x16_bf16 v[24:39], v[120:123], v[200:203], v[24:39]
  global_load_dwordx4 v[152:155], v3, s[22:23] offset:0
  global_load_dwordx4 v[156:159], v3, s[22:23] offset:1024
  global_load_dwordx4 v[160:163], v3, s[22:23] offset:2048
  ds_read_b64_tr_b16 v[112:113], v10 offset:2048
  ds_read_b64_tr_b16 v[114:115], v10 offset:3072
  v_mfma_f32_32x32x16_bf16 v[40:55], v[124:127], v[200:203], v[40:55]
  global_load_dwordx4 v[164:167], v3, s[22:23] offset:3072
  ds_read_b64_tr_b16 v[116:117], v11 offset:2048
  ds_read_b64_tr_b16 v[118:119], v11 offset:3072
  s_waitcnt vmcnt(16) lgkmcnt(8)
  v_mfma_f32_32x32x16_bf16 v[24:39], v[128:131], v[204:207], v[24:39]
  ds_read_b64_tr_b16 v[120:121], v10 offset:4096
  ds_read_b64_tr_b16 v[122:123], v10 offset:5120
  v_mfma_f32_32x32x16_bf16 v[40:55], v[132:135], v[204:207], v[40:55]
  ds_read_b64_tr_b16 v[124:125], v11 offset:4096
  ds_read_b64_tr_b16 v[126:127], v11 offset:5120
  s_waitcnt vmcnt(15) lgkmcnt(8)
  v_mfma_f32_32x32x16_bf16 v[24:39], v[104:107], v[208:211], v[24:39]
  s_xor_b32 s28, s24, 3
  s_lshl_b32 s28, s28, 13
  s_add_u32 s28, s28, 65536
  ds_read_b64_tr_b16 v[128:129], v10 offset:6144
  ds_read_b64_tr_b16 v[130:131], v10 offset:7168
  v_mfma_f32_32x32x16_bf16 v[40:55], v[108:111], v[208:211], v[40:55]
  v_add_u32 v12, s28, v14
  v_add_u32 v13, s28, v15
  s_andn2_b32 s33, s36, s34
  ds_read_b64_tr_b16 v[132:133], v11 offset:6144
  ds_read_b64_tr_b16 v[134:135], v11 offset:7168
  s_waitcnt vmcnt(14) lgkmcnt(8)
  v_mfma_f32_32x32x16_bf16 v[24:39], v[112:115], v[212:215], v[24:39]
  s_ff1_i32_b32 s33, s33
  s_bitset1_b32 s34, s33
  s_xor_b32 s33, s33, s24
  ds_read_b64_tr_b16 v[104:105], v12 offset:0
  ds_read_b64_tr_b16 v[106:107], v12 offset:1024
  v_mfma_f32_32x32x16_bf16 v[40:55], v[116:119], v[212:215], v[40:55]
  s_lshl_b32 s33, s33, 12
  s_add_u32 s22, s20, s33
  s_addc_u32 s23, s21, 0
  ds_read_b64_tr_b16 v[108:109], v13 offset:0
  ds_read_b64_tr_b16 v[110:111], v13 offset:1024
  s_waitcnt vmcnt(13) lgkmcnt(8)
  v_mfma_f32_32x32x16_bf16 v[24:39], v[120:123], v[216:219], v[24:39]
  global_load_dwordx4 v[56:59], v3, s[22:23] offset:0
  global_load_dwordx4 v[60:63], v3, s[22:23] offset:1024
  global_load_dwordx4 v[64:67], v3, s[22:23] offset:2048
  ds_read_b64_tr_b16 v[112:113], v12 offset:2048
  ds_read_b64_tr_b16 v[114:115], v12 offset:3072
  v_mfma_f32_32x32x16_bf16 v[40:55], v[124:127], v[216:219], v[40:55]
  global_load_dwordx4 v[68:71], v3, s[22:23] offset:3072
  ds_read_b64_tr_b16 v[116:117], v13 offset:2048
  ds_read_b64_tr_b16 v[118:119], v13 offset:3072
  s_waitcnt vmcnt(16) lgkmcnt(8)
  v_mfma_f32_32x32x16_bf16 v[24:39], v[128:131], v[220:223], v[24:39]
  ds_read_b64_tr_b16 v[120:121], v12 offset:4096
  ds_read_b64_tr_b16 v[122:123], v12 offset:5120
  v_mfma_f32_32x32x16_bf16 v[40:55], v[132:135], v[220:223], v[40:55]
  ds_read_b64_tr_b16 v[124:125], v13 offset:4096
  ds_read_b64_tr_b16 v[126:127], v13 offset:5120
  s_waitcnt vmcnt(15) lgkmcnt(8)
  v_mfma_f32_32x32x16_bf16 v[24:39], v[104:107], v[224:227], v[24:39]
  s_xor_b32 s28, s24, 4
  s_lshl_b32 s28, s28, 13
  s_add_u32 s28, s28, 65536
  ds_read_b64_tr_b16 v[128:129], v12 offset:6144
  ds_read_b64_tr_b16 v[130:131], v12 offset:7168
  v_mfma_f32_32x32x16_bf16 v[40:55], v[108:111], v[224:227], v[40:55]
  v_add_u32 v10, s28, v14
  v_add_u32 v11, s28, v15
  s_andn2_b32 s33, s36, s34
  ds_read_b64_tr_b16 v[132:133], v13 offset:6144
  ds_read_b64_tr_b16 v[134:135], v13 offset:7168
  s_waitcnt vmcnt(14) lgkmcnt(8)
  v_mfma_f32_32x32x16_bf16 v[24:39], v[112:115], v[228:231], v[24:39]
  s_ff1_i32_b32 s33, s33
  s_bitset1_b32 s34, s33
  s_xor_b32 s33, s33, s24
  ds_read_b64_tr_b16 v[104:105], v10 offset:0
  ds_read_b64_tr_b16 v[106:107], v10 offset:1024
  v_mfma_f32_32x32x16_bf16 v[40:55], v[116:119], v[228:231], v[40:55]
  s_lshl_b32 s33, s33, 12
  s_add_u32 s22, s20, s33
  s_addc_u32 s23, s21, 0
  ds_read_b64_tr_b16 v[108:109], v11 offset:0
  ds_read_b64_tr_b16 v[110:111], v11 offset:1024
  s_waitcnt vmcnt(13) lgkmcnt(8)
  v_mfma_f32_32x32x16_bf16 v[24:39], v[120:123], v[232:235], v[24:39]
  global_load_dwordx4 v[72:75], v3, s[22:23] offset:0
  global_load_dwordx4 v[76:79], v3, s[22:23] offset:1024
  global_load_dwordx4 v[80:83], v3, s[22:23] offset:2048
  ds_read_b64_tr_b16 v[112:113], v10 offset:2048
  ds_read_b64_tr_b16 v[114:115], v10 offset:3072
  v_mfma_f32_32x32x16_bf16 v[40:55], v[124:127], v[232:235], v[40:55]
  global_load_dwordx4 v[84:87], v3, s[22:23] offset:3072
  ds_read_b64_tr_b16 v[116:117], v11 offset:2048
  ds_read_b64_tr_b16 v[118:119], v11 offset:3072
  s_waitcnt vmcnt(16) lgkmcnt(8)
  v_mfma_f32_32x32x16_bf16 v[24:39], v[128:131], v[236:239], v[24:39]
  ds_read_b64_tr_b16 v[120:121], v10 offset:4096
  ds_read_b64_tr_b16 v[122:123], v10 offset:5120
  v_mfma_f32_32x32x16_bf16 v[40:55], v[132:135], v[236:239], v[40:55]
  ds_read_b64_tr_b16 v[124:125], v11 offset:4096
  ds_read_b64_tr_b16 v[126:127], v11 offset:5120
  s_waitcnt vmcnt(15) lgkmcnt(8)
  v_mfma_f32_32x32x16_bf16 v[24:39], v[104:107], v[136:139], v[24:39]
  s_xor_b32 s28, s24, 5
  s_lshl_b32 s28, s28, 13
  s_add_u32 s28, s28, 65536
  v_add_u32 v12, s28, v14
  ds_read_b64_tr_b16 v[128:129], v10 offset:6144
  ds_read_b64_tr_b16 v[130:131], v10 offset:7168
  v_mfma_f32_32x32x16_bf16 v[40:55], v[108:111], v[136:139], v[40:55]
  v_add_u32 v13, s28, v15
  s_andn2_b32 s33, s36, s34
  s_cbranch_scc0 .g2_kernel_w_i8c
.g2_kernel_w_i8b:
  s_ff1_i32_b32 s33, s33
  ds_read_b64_tr_b16 v[132:133], v11 offset:6144
  ds_read_b64_tr_b16 v[134:135], v11 offset:7168
  s_waitcnt vmcnt(14) lgkmcnt(8)
  v_mfma_f32_32x32x16_bf16 v[24:39], v[112:115], v[140:143], v[24:39]
  s_bitset1_b32 s34, s33
  s_xor_b32 s33, s33, s24
  s_and_b32 s8, s33, 7
  s_cmp_lt_u32 s8, 2
  ds_read_b64_tr_b16 v[104:105], v12 offset:0
  ds_read_b64_tr_b16 v[106:107], v12 offset:1024
  v_mfma_f32_32x32x16_bf16 v[40:55], v[116:119], v[140:143], v[40:55]
  s_cselect_b32 s28, 139264, 0
  s_lshl_b32 s8, s8, 13
  s_add_u32 s8, s8, s28
  s_lshl_b32 s33, s33, 12
  ds_read_b64_tr_b16 v[108:109], v13 offset:0
  ds_read_b64_tr_b16 v[110:111], v13 offset:1024
  s_waitcnt vmcnt(13) lgkmcnt(8)
  v_mfma_f32_32x32x16_bf16 v[24:39], v[120:123], v[144:147], v[24:39]
  s_add_u32 s22, s20, s33
  s_addc_u32 s23, s21, 0
  global_load_dwordx4 v[88:91], v3, s[22:23] offset:0
  global_load_dwordx4 v[92:95], v3, s[22:23] offset:1024
  ds_read_b64_tr_b16 v[112:113], v12 offset:2048
  ds_read_b64_tr_b16 v[114:115], v12 offset:3072
  v_mfma_f32_32x32x16_bf16 v[40:55], v[124:127], v[144:147], v[40:55]
  global_load_dwordx4 v[96:99], v3, s[22:23] offset:2048
  global_load_dwordx4 v[100:103], v3, s[22:23] offset:3072
  ds_read_b64_tr_b16 v[116:117], v13 offset:2048
  ds_read_b64_tr_b16 v[118:119], v13 offset:3072
  s_waitcnt vmcnt(16) lgkmcnt(8)
  v_mfma_f32_32x32x16_bf16 v[24:39], v[128:131], v[148:151], v[24:39]
  ds_read_b64_tr_b16 v[120:121], v12 offset:4096
  ds_read_b64_tr_b16 v[122:123], v12 offset:5120
  v_mfma_f32_32x32x16_bf16 v[40:55], v[132:135], v[148:151], v[40:55]
  ds_read_b64_tr_b16 v[124:125], v13 offset:4096
  ds_read_b64_tr_b16 v[126:127], v13 offset:5120
  s_waitcnt vmcnt(15) lgkmcnt(8)
  v_mfma_f32_32x32x16_bf16 v[24:39], v[104:107], v[152:155], v[24:39]
  s_xor_b32 s28, s24, 6
  s_lshl_b32 s28, s28, 13
  s_add_u32 s28, s28, 65536
  v_add_u32 v10, s28, v14
  v_add_u32 v11, s28, v15
  ds_read_b64_tr_b16 v[128:129], v12 offset:6144
  ds_read_b64_tr_b16 v[130:131], v12 offset:7168
  v_mfma_f32_32x32x16_bf16 v[40:55], v[108:111], v[152:155], v[40:55]
  s_andn2_b32 s33, s36, s34
  s_cbranch_scc0 .g2_kernel_w_i9c
.g2_kernel_w_i9b:
  s_ff1_i32_b32 s33, s33
  s_bitset1_b32 s34, s33
  s_xor_b32 s33, s33, s24
  ds_read_b64_tr_b16 v[132:133], v13 offset:6144
  ds_read_b64_tr_b16 v[134:135], v13 offset:7168
  s_waitcnt vmcnt(14) lgkmcnt(8)
  v_mfma_f32_32x32x16_bf16 v[24:39], v[112:115], v[156:159], v[24:39]
  s_and_b32 s9, s33, 7
  s_cmp_lt_u32 s9, 2
  s_cselect_b32 s28, 139264, 0
  s_lshl_b32 s9, s9, 13
  s_add_u32 s9, s9, s28
  ds_read_b64_tr_b16 v[104:105], v10 offset:0
  ds_read_b64_tr_b16 v[106:107], v10 offset:1024
  v_mfma_f32_32x32x16_bf16 v[40:55], v[116:119], v[156:159], v[40:55]
  s_lshl_b32 s33, s33, 12
  s_add_u32 s22, s20, s33
  s_addc_u32 s23, s21, 0
  global_load_dwordx4 v[176:179], v3, s[22:23] offset:0
  global_load_dwordx4 v[180:183], v3, s[22:23] offset:1024
  ds_read_b64_tr_b16 v[108:109], v11 offset:0
  ds_read_b64_tr_b16 v[110:111], v11 offset:1024
  s_waitcnt vmcnt(15) lgkmcnt(8)
  v_mfma_f32_32x32x16_bf16 v[24:39], v[120:123], v[160:163], v[24:39]
  global_load_dwordx4 v[184:187], v3, s[22:23] offset:2048
  global_load_dwordx4 v[188:191], v3, s[22:23] offset:3072
  v_lshlrev_b32 v16, 4, v17
  s_lshl_b32 s29, s18, 7
  buffer_load_dwordx4 v[240:243], v16, s[72:75], s29 offen offset:0
  ds_read_b64_tr_b16 v[112:113], v10 offset:2048
  ds_read_b64_tr_b16 v[114:115], v10 offset:3072
  v_mfma_f32_32x32x16_bf16 v[40:55], v[124:127], v[160:163], v[40:55]
  buffer_load_dwordx4 v[244:247], v16, s[72:75], s29 offen offset:32
  buffer_load_dwordx4 v[248:251], v16, s[72:75], s29 offen offset:64
  buffer_load_dwordx4 v[252:255], v16, s[72:75], s29 offen offset:96
  ds_read_b64_tr_b16 v[116:117], v11 offset:2048
  ds_read_b64_tr_b16 v[118:119], v11 offset:3072
  s_waitcnt vmcnt(20) lgkmcnt(8)
  v_mfma_f32_32x32x16_bf16 v[24:39], v[128:131], v[164:167], v[24:39]
  ds_read_b64_tr_b16 v[120:121], v10 offset:4096
  ds_read_b64_tr_b16 v[122:123], v10 offset:5120
  v_mfma_f32_32x32x16_bf16 v[40:55], v[132:135], v[164:167], v[40:55]
  ds_read_b64_tr_b16 v[124:125], v11 offset:4096
  ds_read_b64_tr_b16 v[126:127], v11 offset:5120
  s_waitcnt vmcnt(19) lgkmcnt(8)
  v_mfma_f32_32x32x16_bf16 v[24:39], v[104:107], v[56:59], v[24:39]
  s_xor_b32 s28, s24, 7
  s_lshl_b32 s28, s28, 13
  s_add_u32 s28, s28, 65536
  v_add_u32 v12, s28, v14
  ds_read_b64_tr_b16 v[128:129], v10 offset:6144
  ds_read_b64_tr_b16 v[130:131], v10 offset:7168
  v_mfma_f32_32x32x16_bf16 v[40:55], v[108:111], v[56:59], v[40:55]
  v_add_u32 v13, s28, v15
  s_andn2_b32 s33, s36, s34
  s_cbranch_scc0 .g2_kernel_w_i10c
.g2_kernel_w_i10b:
  s_ff1_i32_b32 s33, s33
  ds_read_b64_tr_b16 v[132:133], v11 offset:6144
  ds_read_b64_tr_b16 v[134:135], v11 offset:7168
  s_waitcnt vmcnt(18) lgkmcnt(8)
  v_mfma_f32_32x32x16_bf16 v[24:39], v[112:115], v[60:63], v[24:39]
  s_bitset1_b32 s34, s33
  s_xor_b32 s33, s33, s24
  s_and_b32 s10, s33, 7
  s_cmp_lt_u32 s10, 2
  ds_read_b64_tr_b16 v[104:105], v12 offset:0
  ds_read_b64_tr_b16 v[106:107], v12 offset:1024
  v_mfma_f32_32x32x16_bf16 v[40:55], v[116:119], v[60:63], v[40:55]
  s_cselect_b32 s28, 139264, 0
  s_lshl_b32 s10, s10, 13
  s_add_u32 s10, s10, s28
  s_lshl_b32 s33, s33, 12
  ds_read_b64_tr_b16 v[108:109], v13 offset:0
  ds_read_b64_tr_b16 v[110:111], v13 offset:1024
  s_waitcnt vmcnt(17) lgkmcnt(8)
  v_mfma_f32_32x32x16_bf16 v[24:39], v[120:123], v[64:67], v[24:39]
  s_add_u32 s22, s20, s33
  s_addc_u32 s23, s21, 0
  global_load_dwordx4 v[192:195], v3, s[22:23] offset:0
  global_load_dwordx4 v[196:199], v3, s[22:23] offset:1024
  ds_read_b64_tr_b16 v[112:113], v12 offset:2048
  ds_read_b64_tr_b16 v[114:115], v12 offset:3072
  v_mfma_f32_32x32x16_bf16 v[40:55], v[124:127], v[64:67], v[40:55]
  global_load_dwordx4 v[200:203], v3, s[22:23] offset:2048
  global_load_dwordx4 v[204:207], v3, s[22:23] offset:3072
  ds_read_b64_tr_b16 v[116:117], v13 offset:2048
  ds_read_b64_tr_b16 v[118:119], v13 offset:3072
  s_waitcnt vmcnt(20) lgkmcnt(8)
  v_mfma_f32_32x32x16_bf16 v[24:39], v[128:131], v[68:71], v[24:39]
  ds_read_b64_tr_b16 v[120:121], v12 offset:4096
  ds_read_b64_tr_b16 v[122:123], v12 offset:5120
  v_mfma_f32_32x32x16_bf16 v[40:55], v[132:135], v[68:71], v[40:55]
  ds_read_b64_tr_b16 v[124:125], v13 offset:4096
  ds_read_b64_tr_b16 v[126:127], v13 offset:5120
  s_waitcnt vmcnt(19) lgkmcnt(8)
  v_mfma_f32_32x32x16_bf16 v[24:39], v[104:107], v[72:75], v[24:39]
  s_andn2_b32 s33, s36, s34
  s_cbranch_scc0 .g2_kernel_w_i11c
.g2_kernel_w_i11b:
  s_ff1_i32_b32 s33, s33
  ds_read_b64_tr_b16 v[128:129], v12 offset:6144
  ds_read_b64_tr_b16 v[130:131], v12 offset:7168
  v_mfma_f32_32x32x16_bf16 v[40:55], v[108:111], v[72:75], v[40:55]
  s_bitset1_b32 s34, s33
  s_xor_b32 s33, s33, s24
  s_and_b32 s11, s33, 7
  ds_read_b64_tr_b16 v[132:133], v13 offset:6144
  ds_read_b64_tr_b16 v[134:135], v13 offset:7168
  s_waitcnt vmcnt(18) lgkmcnt(8)
  v_mfma_f32_32x32x16_bf16 v[24:39], v[112:115], v[76:79], v[24:39]
  s_cmp_lt_u32 s11, 2
  s_cselect_b32 s28, 139264, 0
  s_lshl_b32 s11, s11, 13
  v_mfma_f32_32x32x16_bf16 v[40:55], v[116:119], v[76:79], v[40:55]
  s_add_u32 s11, s11, s28
  s_lshl_b32 s33, s33, 12
  s_add_u32 s22, s20, s33
  s_waitcnt vmcnt(17) lgkmcnt(4)
  v_mfma_f32_32x32x16_bf16 v[24:39], v[120:123], v[80:83], v[24:39]
  s_addc_u32 s23, s21, 0
  global_load_dwordx4 v[208:211], v3, s[22:23] offset:0
  global_load_dwordx4 v[212:215], v3, s[22:23] offset:1024
  v_mfma_f32_32x32x16_bf16 v[40:55], v[124:127], v[80:83], v[40:55]
  global_load_dwordx4 v[216:219], v3, s[22:23] offset:2048
  global_load_dwordx4 v[220:223], v3, s[22:23] offset:3072
  s_waitcnt vmcnt(20) lgkmcnt(0)
  v_mfma_f32_32x32x16_bf16 v[24:39], v[128:131], v[84:87], v[24:39]
  v_mfma_f32_32x32x16_bf16 v[40:55], v[132:135], v[84:87], v[40:55]
  ds_read_b32 v16, v20 offset:12
  v_add_u32 v10, s8, v14
  v_add_u32 v11, s8, v15
  s_waitcnt lgkmcnt(0)
  v_cmp_gt_u32 vcc, 4, v16
  s_cbranch_vccnz .g2_kernel_w_bw
.g2_kernel_w_bb:
  ds_read_b64_tr_b16 v[104:105], v10 offset:0
  ds_read_b64_tr_b16 v[106:107], v10 offset:1024
  ds_read_b64_tr_b16 v[108:109], v11 offset:0
  ds_read_b64_tr_b16 v[110:111], v11 offset:1024
  ds_read_b64_tr_b16 v[112:113], v10 offset:2048
  ds_read_b64_tr_b16 v[114:115], v10 offset:3072
  ds_read_b64_tr_b16 v[116:117], v11 offset:2048
  ds_read_b64_tr_b16 v[118:119], v11 offset:3072
  ds_read_b64_tr_b16 v[120:121], v10 offset:4096
  ds_read_b64_tr_b16 v[122:123], v10 offset:5120
  ds_read_b64_tr_b16 v[124:125], v11 offset:4096
  ds_read_b64_tr_b16 v[126:127], v11 offset:5120
  s_waitcnt vmcnt(16)
  v_min3_u32 v6, v88, v90, v92
  v_min3_u32 v7, v94, v96, v98
  v_min3_u32 v6, v6, v100, v102
  v_min_u32 v6, v6, v7
  v_cmp_eq_u32 vcc, 0, v6
  s_cbranch_vccnz .g2_kernel_w_v8
.g2_kernel_w_vb8:
  s_waitcnt lgkmcnt(8)
  v_mfma_f32_32x32x16_bf16 v[24:39], v[104:107], v[88:91], v[24:39]
  v_add_u32 v12, s9, v14
  v_add_u32 v13, s9, v15
  s_andn2_b32 s33, s36, s34
  s_cbranch_scc0 .g2_kernel_w_i12c
.g2_kernel_w_i12b:
  ds_read_b64_tr_b16 v[128:129], v10 offset:6144
  ds_read_b64_tr_b16 v[130:131], v10 offset:7168
  v_mfma_f32_32x32x16_bf16 v[40:55], v[108:111], v[88:91], v[40:55]
  s_ff1_i32_b32 s33, s33
  s_bitset1_b32 s34, s33
  s_xor_b32 s33, s33, s24
  s_and_b32 s12, s33, 7
  ds_read_b64_tr_b16 v[132:133], v11 offset:6144
  ds_read_b64_tr_b16 v[134:135], v11 offset:7168
  s_waitcnt lgkmcnt(8)
  v_mfma_f32_32x32x16_bf16 v[24:39], v[112:115], v[92:95], v[24:39]
  s_cmp_lt_u32 s12, 2
  s_cselect_b32 s28, 139264, 0
  s_lshl_b32 s12, s12, 13
  s_add_u32 s12, s12, s28
  ds_read_b64_tr_b16 v[104:105], v12 offset:0
  ds_read_b64_tr_b16 v[106:107], v12 offset:1024
  v_mfma_f32_32x32x16_bf16 v[40:55], v[116:119], v[92:95], v[40:55]
  s_lshl_b32 s33, s33, 12
  s_add_u32 s22, s20, s33
  s_addc_u32 s23, s21, 0
  global_load_dwordx4 v[224:227], v3, s[22:23] offset:0
  ds_read_b64_tr_b16 v[108:109], v13 offset:0
  ds_read_b64_tr_b16 v[110:111], v13 offset:1024
  s_waitcnt lgkmcnt(8)
  v_mfma_f32_32x32x16_bf16 v[24:39], v[120:123], v[96:99], v[24:39]
  global_load_dwordx4 v[228:231], v3, s[22:23] offset:1024
  global_load_dwordx4 v[232:235], v3, s[22:23] offset:2048
  global_load_dwordx4 v[236:239], v3, s[22:23] offset:3072
  ds_read_b64_tr_b16 v[112:113], v12 offset:2048
  ds_read_b64_tr_b16 v[114:115], v12 offset:3072
  v_mfma_f32_32x32x16_bf16 v[40:55], v[124:127], v[96:99], v[40:55]
  ds_read_b64_tr_b16 v[116:117], v13 offset:2048
  ds_read_b64_tr_b16 v[118:119], v13 offset:3072
  s_waitcnt lgkmcnt(8)
  v_mfma_f32_32x32x16_bf16 v[24:39], v[128:131], v[100:103], v[24:39]
  ds_read_b64_tr_b16 v[120:121], v12 offset:4096
  ds_read_b64_tr_b16 v[122:123], v12 offset:5120
  s_waitcnt vmcnt(16)
  v_min3_u32 v6, v176, v178, v180
  v_min3_u32 v7, v182, v184, v186
  v_min3_u32 v6, v6, v188, v190
  v_min_u32 v6, v6, v7
  v_cmp_eq_u32 vcc, 0, v6
  v_mfma_f32_32x32x16_bf16 v[40:55], v[132:135], v[100:103], v[40:55]
  ds_read_b64_tr_b16 v[124:125], v13 offset:4096
  ds_read_b64_tr_b16 v[126:127], v13 offset:5120
  s_cbranch_vccnz .g2_kernel_w_v9
.g2_kernel_w_vb9:
  s_waitcnt lgkmcnt(8)
  v_mfma_f32_32x32x16_bf16 v[24:39], v[104:107], v[176:179], v[24:39]
  v_add_u32 v10, s10, v14
  v_add_u32 v11, s10, v15
  s_andn2_b32 s33, s36, s34
  s_cbranch_scc0 .g2_kernel_w_i13c
.g2_kernel_w_i13b:
  ds_read_b64_tr_b16 v[128:129], v12 offset:6144
  ds_read_b64_tr_b16 v[130:131], v12 offset:7168
  v_mfma_f32_32x32x16_bf16 v[40:55], v[108:111], v[176:179], v[40:55]
  s_ff1_i32_b32 s33, s33
  s_bitset1_b32 s34, s33
  s_xor_b32 s33, s33, s24
  s_and_b32 s13, s33, 7
  ds_read_b64_tr_b16 v[132:133], v13 offset:6144
  ds_read_b64_tr_b16 v[134:135], v13 offset:7168
  s_waitcnt lgkmcnt(8)
  v_mfma_f32_32x32x16_bf16 v[24:39], v[112:115], v[180:183], v[24:39]
  s_cmp_lt_u32 s13, 2
  s_cselect_b32 s28, 139264, 0
  s_lshl_b32 s13, s13, 13
  s_add_u32 s13, s13, s28
  ds_read_b64_tr_b16 v[104:105], v10 offset:0
  ds_read_b64_tr_b16 v[106:107], v10 offset:1024
  v_mfma_f32_32x32x16_bf16 v[40:55], v[116:119], v[180:183], v[40:55]
  s_lshl_b32 s33, s33, 12
  s_add_u32 s22, s20, s33
  s_addc_u32 s23, s21, 0
  global_load_dwordx4 v[136:139], v3, s[22:23] offset:0
  ds_read_b64_tr_b16 v[108:109], v11 offset:0
  ds_read_b64_tr_b16 v[110:111], v11 offset:1024
  s_waitcnt lgkmcnt(8)
  v_mfma_f32_32x32x16_bf16 v[24:39], v[120:123], v[184:187], v[24:39]
  global_load_dwordx4 v[140:143], v3, s[22:23] offset:1024
  global_load_dwordx4 v[144:147], v3, s[22:23] offset:2048
  global_load_dwordx4 v[148:151], v3, s[22:23] offset:3072
  ds_read_b64_tr_b16 v[112:113], v10 offset:2048
  ds_read_b64_tr_b16 v[114:115], v10 offset:3072
  v_mfma_f32_32x32x16_bf16 v[40:55], v[124:127], v[184:187], v[40:55]
  ds_read_b64_tr_b16 v[116:117], v11 offset:2048
  ds_read_b64_tr_b16 v[118:119], v11 offset:3072
  s_waitcnt lgkmcnt(8)
  v_mfma_f32_32x32x16_bf16 v[24:39], v[128:131], v[188:191], v[24:39]
  ds_read_b64_tr_b16 v[120:121], v10 offset:4096
  ds_read_b64_tr_b16 v[122:123], v10 offset:5120
  s_waitcnt vmcnt(12)
  v_min3_u32 v6, v192, v194, v196
  v_min3_u32 v7, v198, v200, v202
  v_min3_u32 v6, v6, v204, v206
  v_min_u32 v6, v6, v7
  v_cmp_eq_u32 vcc, 0, v6
  v_mfma_f32_32x32x16_bf16 v[40:55], v[132:135], v[188:191], v[40:55]
  ds_read_b64_tr_b16 v[124:125], v11 offset:4096
  ds_read_b64_tr_b16 v[126:127], v11 offset:5120
  s_cbranch_vccnz .g2_kernel_w_v10
.g2_kernel_w_vb10:
  s_waitcnt lgkmcnt(8)
  v_mfma_f32_32x32x16_bf16 v[24:39], v[104:107], v[192:195], v[24:39]
  v_add_u32 v12, s11, v14
  v_add_u32 v13, s11, v15
  s_andn2_b32 s33, s36, s34
  s_cbranch_scc0 .g2_kernel_w_i14c
.g2_kernel_w_i14b:
  ds_read_b64_tr_b16 v[128:129], v10 offset:6144
  ds_read_b64_tr_b16 v[130:131], v10 offset:7168
  v_mfma_f32_32x32x16_bf16 v[40:55], v[108:111], v[192:195], v[40:55]
  s_ff1_i32_b32 s33, s33
  s_bitset1_b32 s34, s33
  s_xor_b32 s33, s33, s24
  s_and_b32 s14, s33, 7
  ds_read_b64_tr_b16 v[132:133], v11 offset:6144
  ds_read_b64_tr_b16 v[134:135], v11 offset:7168
  s_waitcnt lgkmcnt(8)
  v_mfma_f32_32x32x16_bf16 v[24:39], v[112:115], v[196:199], v[24:39]
  s_cmp_lt_u32 s14, 2
  s_cselect_b32 s28, 139264, 0
  s_lshl_b32 s14, s14, 13
  s_add_u32 s14, s14, s28
  ds_read_b64_tr_b16 v[104:105], v12 offset:0
  ds_read_b64_tr_b16 v[106:107], v12 offset:1024
  v_mfma_f32_32x32x16_bf16 v[40:55], v[116:119], v[196:199], v[40:55]
  s_lshl_b32 s33, s33, 12
  s_add_u32 s22, s20, s33
  s_addc_u32 s23, s21, 0
  global_load_dwordx4 v[152:155], v3, s[22:23] offset:0 sc1
  ds_read_b64_tr_b16 v[108:109], v13 offset:0
  ds_read_b64_tr_b16 v[110:111], v13 offset:1024
  s_waitcnt lgkmcnt(8)
  v_mfma_f32_32x32x16_bf16 v[24:39], v[120:123], v[200:203], v[24:39]
  global_load_dwordx4 v[156:159], v3, s[22:23] offset:1024 sc1
  global_load_dwordx4 v[160:163], v3, s[22:23] offset:2048 sc1
  global_load_dwordx4 v[164:167], v3, s[22:23] offset:3072 sc1
  ds_read_b64_tr_b16 v[112:113], v12 offset:2048
  ds_read_b64_tr_b16 v[114:115], v12 offset:3072
  v_mfma_f32_32x32x16_bf16 v[40:55], v[124:127], v[200:203], v[40:55]
  ds_read_b64_tr_b16 v[116:117], v13 offset:2048
  ds_read_b64_tr_b16 v[118:119], v13 offset:3072
  s_waitcnt lgkmcnt(8)
  v_mfma_f32_32x32x16_bf16 v[24:39], v[128:131], v[204:207], v[24:39]
  ds_read_b64_tr_b16 v[120:121], v12 offset:4096
  ds_read_b64_tr_b16 v[122:123], v12 offset:5120
  s_waitcnt vmcnt(12)
  v_min3_u32 v6, v208, v210, v212
  v_min3_u32 v7, v214, v216, v218
  v_min3_u32 v6, v6, v220, v222
  v_min_u32 v6, v6, v7
  v_cmp_eq_u32 vcc, 0, v6
  v_mfma_f32_32x32x16_bf16 v[40:55], v[132:135], v[204:207], v[40:55]
  ds_read_b64_tr_b16 v[124:125], v13 offset:4096
  ds_read_b64_tr_b16 v[126:127], v13 offset:5120
  s_cbranch_vccnz .g2_kernel_w_v11
.g2_kernel_w_vb11:
  s_mov_b64 exec, 1
  ds_add_u32 v20, v5 offset:16
  s_mov_b64 exec, -1
  s_waitcnt lgkmcnt(8)
  v_mfma_f32_32x32x16_bf16 v[24:39], v[104:107], v[208:211], v[24:39]
  v_add_u32 v10, s12, v14
  v_add_u32 v11, s12, v15
  s_andn2_b32 s33, s36, s34
  s_cbranch_scc0 .g2_kernel_w_i15c
.g2_kernel_w_i15b:
  ds_read_b64_tr_b16 v[128:129], v12 offset:6144
  ds_read_b64_tr_b16 v[130:131], v12 offset:7168
  v_mfma_f32_32x32x16_bf16 v[40:55], v[108:111], v[208:211], v[40:55]
  s_ff1_i32_b32 s33, s33
  s_bitset1_b32 s34, s33
  s_xor_b32 s33, s33, s24
  s_and_b32 s15, s33, 7
  ds_read_b64_tr_b16 v[132:133], v13 offset:6144
  ds_read_b64_tr_b16 v[134:135], v13 offset:7168
  s_waitcnt lgkmcnt(8)
  v_mfma_f32_32x32x16_bf16 v[24:39], v[112:115], v[212:215], v[24:39]
  s_cmp_lt_u32 s15, 2
  s_cselect_b32 s28, 139264, 0
  s_lshl_b32 s15, s15, 13
  s_add_u32 s15, s15, s28
  ds_read_b64_tr_b16 v[104:105], v10 offset:0
  ds_read_b64_tr_b16 v[106:107], v10 offset:1024
  v_mfma_f32_32x32x16_bf16 v[40:55], v[116:119], v[212:215], v[40:55]
  s_lshl_b32 s33, s33, 12
  s_add_u32 s22, s20, s33
  s_addc_u32 s23, s21, 0
  global_load_dwordx4 v[56:59], v3, s[22:23] offset:0 sc1
  ds_read_b64_tr_b16 v[108:109], v11 offset:0
  ds_read_b64_tr_b16 v[110:111], v11 offset:1024
  s_waitcnt lgkmcnt(8)
  v_mfma_f32_32x32x16_bf16 v[24:39], v[120:123], v[216:219], v[24:39]
  global_load_dwordx4 v[60:63], v3, s[22:23] offset:1024 sc1
  global_load_dwordx4 v[64:67], v3, s[22:23] offset:2048 sc1
  global_load_dwordx4 v[68:71], v3, s[22:23] offset:3072 sc1
  ds_read_b64_tr_b16 v[112:113], v10 offset:2048
  ds_read_b64_tr_b16 v[114:115], v10 offset:3072
  v_mfma_f32_32x32x16_bf16 v[40:55], v[124:127], v[216:219], v[40:55]
  ds_read_b64_tr_b16 v[116:117], v11 offset:2048
  ds_read_b64_tr_b16 v[118:119], v11 offset:3072
  s_waitcnt lgkmcnt(8)
  v_mfma_f32_32x32x16_bf16 v[24:39], v[128:131], v[220:223], v[24:39]
  ds_read_b64_tr_b16 v[120:121], v10 offset:4096
  ds_read_b64_tr_b16 v[122:123], v10 offset:5120
  s_waitcnt vmcnt(12)
  v_min3_u32 v6, v224, v226, v228
  v_min3_u32 v7, v230, v232, v234
  v_min3_u32 v6, v6, v236, v238
  v_min_u32 v6, v6, v7
  v_cmp_eq_u32 vcc, 0, v6
  v_mfma_f32_32x32x16_bf16 v[40:55], v[132:135], v[220:223], v[40:55]
  ds_read_b64_tr_b16 v[124:125], v11 offset:4096
  ds_read_b64_tr_b16 v[126:127], v11 offset:5120
  s_cbranch_vccnz .g2_kernel_w_v12
.g2_kernel_w_vb12:
  s_waitcnt lgkmcnt(8)
  v_mfma_f32_32x32x16_bf16 v[24:39], v[104:107], v[224:227], v[24:39]
  v_add_u32 v12, s13, v14
  v_add_u32 v13, s13, v15
  ds_read_b64_tr_b16 v[128:129], v10 offset:6144
  ds_read_b64_tr_b16 v[130:131], v10 offset:7168
  v_mfma_f32_32x32x16_bf16 v[40:55], v[108:111], v[224:227], v[40:55]
  ds_read_b64_tr_b16 v[132:133], v11 offset:6144
  ds_read_b64_tr_b16 v[134:135], v11 offset:7168
  s_waitcnt lgkmcnt(8)
  v_mfma_f32_32x32x16_bf16 v[24:39], v[112:115], v[228:231], v[24:39]
  ds_read_b64_tr_b16 v[104:105], v12 offset:0
  ds_read_b64_tr_b16 v[106:107], v12 offset:1024
  v_mfma_f32_32x32x16_bf16 v[40:55], v[116:119], v[228:231], v[40:55]
  ds_read_b64_tr_b16 v[108:109], v13 offset:0
  ds_read_b64_tr_b16 v[110:111], v13 offset:1024
  s_waitcnt lgkmcnt(8)
  v_mfma_f32_32x32x16_bf16 v[24:39], v[120:123], v[232:235], v[24:39]
  ds_read_b64_tr_b16 v[112:113], v12 offset:2048
  ds_read_b64_tr_b16 v[114:115], v12 offset:3072
  v_mfma_f32_32x32x16_bf16 v[40:55], v[124:127], v[232:235], v[40:55]
  ds_read_b64_tr_b16 v[116:117], v13 offset:2048
  ds_read_b64_tr_b16 v[118:119], v13 offset:3072
  s_waitcnt lgkmcnt(8)
  v_mfma_f32_32x32x16_bf16 v[24:39], v[128:131], v[236:239], v[24:39]
  ds_read_b64_tr_b16 v[120:121], v12 offset:4096
  ds_read_b64_tr_b16 v[122:123], v12 offset:5120
  s_waitcnt vmcnt(8)
  v_min3_u32 v6, v136, v138, v140
  v_min3_u32 v7, v142, v144, v146
  v_min3_u32 v6, v6, v148, v150
  v_min_u32 v6, v6, v7
  v_cmp_eq_u32 vcc, 0, v6
  v_mfma_f32_32x32x16_bf16 v[40:55], v[132:135], v[236:239], v[40:55]
  ds_read_b64_tr_b16 v[124:125], v13 offset:4096
  ds_read_b64_tr_b16 v[126:127], v13 offset:5120
  s_cbranch_vccnz .g2_kernel_w_v13
.g2_kernel_w_vb13:
  s_waitcnt lgkmcnt(8)
  v_mfma_f32_32x32x16_bf16 v[24:39], v[104:107], v[136:139], v[24:39]
  v_add_u32 v10, s14, v14
  v_add_u32 v11, s14, v15
  ds_read_b64_tr_b16 v[128:129], v12 offset:6144
  ds_read_b64_tr_b16 v[130:131], v12 offset:7168
  v_mfma_f32_32x32x16_bf16 v[40:55], v[108:111], v[136:139], v[40:55]
  ds_read_b64_tr_b16 v[132:133], v13 offset:6144
  ds_read_b64_tr_b16 v[134:135], v13 offset:7168
  s_waitcnt lgkmcnt(8)
  v_mfma_f32_32x32x16_bf16 v[24:39], v[112:115], v[140:143], v[24:39]
  ds_read_b64_tr_b16 v[104:105], v10 offset:0
  ds_read_b64_tr_b16 v[106:107], v10 offset:1024
  v_mfma_f32_32x32x16_bf16 v[40:55], v[116:119], v[140:143], v[40:55]
  ds_read_b64_tr_b16 v[108:109], v11 offset:0
  ds_read_b64_tr_b16 v[110:111], v11 offset:1024
  s_waitcnt lgkmcnt(8)
  v_mfma_f32_32x32x16_bf16 v[24:39], v[120:123], v[144:147], v[24:39]
  ds_read_b64_tr_b16 v[112:113], v10 offset:2048
  ds_read_b64_tr_b16 v[114:115], v10 offset:3072
  v_mfma_f32_32x32x16_bf16 v[40:55], v[124:127], v[144:147], v[40:55]
  ds_read_b64_tr_b16 v[116:117], v11 offset:2048
  ds_read_b64_tr_b16 v[118:119], v11 offset:3072
  s_waitcnt lgkmcnt(8)
  v_mfma_f32_32x32x16_bf16 v[24:39], v[128:131], v[148:151], v[24:39]
  ds_read_b64_tr_b16 v[120:121], v10 offset:4096
  ds_read_b64_tr_b16 v[122:123], v10 offset:5120
  s_waitcnt vmcnt(4)
  v_min3_u32 v6, v152, v154, v156
  v_min3_u32 v7, v158, v160, v162
  v_min3_u32 v6, v6, v164, v166
  v_min_u32 v6, v6, v7
  v_cmp_eq_u32 vcc, 0, v6
  v_mfma_f32_32x32x16_bf16 v[40:55], v[132:135], v[148:151], v[40:55]
  ds_read_b64_tr_b16 v[124:125], v11 offset:4096
  ds_read_b64_tr_b16 v[126:127], v11 offset:5120
  s_cbranch_vccnz .g2_kernel_w_v14
.g2_kernel_w_vb14:
  s_waitcnt lgkmcnt(8)
  v_mfma_f32_32x32x16_bf16 v[24:39], v[104:107], v[152:155], v[24:39]
  v_add_u32 v12, s15, v14
  v_add_u32 v13, s15, v15
  ds_read_b64_tr_b16 v[128:129], v10 offset:6144
  ds_read_b64_tr_b16 v[130:131], v10 offset:7168
  v_mfma_f32_32x32x16_bf16 v[40:55], v[108:111], v[152:155], v[40:55]
  ds_read_b64_tr_b16 v[132:133], v11 offset:6144
  ds_read_b64_tr_b16 v[134:135], v11 offset:7168
  s_waitcnt lgkmcnt(8)
  v_mfma_f32_32x32x16_bf16 v[24:39], v[112:115], v[156:159], v[24:39]
  ds_read_b64_tr_b16 v[104:105], v12 offset:0
  ds_read_b64_tr_b16 v[106:107], v12 offset:1024
  v_mfma_f32_32x32x16_bf16 v[40:55], v[116:119], v[156:159], v[40:55]
  ds_read_b64_tr_b16 v[108:109], v13 offset:0
  ds_read_b64_tr_b16 v[110:111], v13 offset:1024
  s_waitcnt lgkmcnt(8)
  v_mfma_f32_32x32x16_bf16 v[24:39], v[120:123], v[160:163], v[24:39]
  ds_read_b64_tr_b16 v[112:113], v12 offset:2048
  ds_read_b64_tr_b16 v[114:115], v12 offset:3072
  v_mfma_f32_32x32x16_bf16 v[40:55], v[124:127], v[160:163], v[40:55]
  ds_read_b64_tr_b16 v[116:117], v13 offset:2048
  ds_read_b64_tr_b16 v[118:119], v13 offset:3072
  s_waitcnt lgkmcnt(8)
  v_mfma_f32_32x32x16_bf16 v[24:39], v[128:131], v[164:167], v[24:39]
  ds_read_b64_tr_b16 v[120:121], v12 offset:4096
  ds_read_b64_tr_b16 v[122:123], v12 offset:5120
  s_waitcnt vmcnt(0)
  v_min3_u32 v6, v56, v58, v60
  v_min3_u32 v7, v62, v64, v66
  v_min3_u32 v6, v6, v68, v70
  v_min_u32 v6, v6, v7
  v_cmp_eq_u32 vcc, 0, v6
  v_mfma_f32_32x32x16_bf16 v[40:55], v[132:135], v[164:167], v[40:55]
  ds_read_b64_tr_b16 v[124:125], v13 offset:4096
  ds_read_b64_tr_b16 v[126:127], v13 offset:5120
  s_cbranch_vccnz .g2_kernel_w_v15
.g2_kernel_w_vb15:
  s_waitcnt lgkmcnt(8)
  v_mfma_f32_32x32x16_bf16 v[24:39], v[104:107], v[56:59], v[24:39]
  ds_read_b64_tr_b16 v[128:129], v12 offset:6144
  ds_read_b64_tr_b16 v[130:131], v12 offset:7168
  v_mfma_f32_32x32x16_bf16 v[40:55], v[108:111], v[56:59], v[40:55]
  ds_read_b64_tr_b16 v[132:133], v13 offset:6144
  ds_read_b64_tr_b16 v[134:135], v13 offset:7168
  s_waitcnt lgkmcnt(8)
  v_mfma_f32_32x32x16_bf16 v[24:39], v[112:115], v[60:63], v[24:39]
  v_mfma_f32_32x32x16_bf16 v[40:55], v[116:119], v[60:63], v[40:55]
  s_waitcnt lgkmcnt(4)
  v_mfma_f32_32x32x16_bf16 v[24:39], v[120:123], v[64:67], v[24:39]
  v_mfma_f32_32x32x16_bf16 v[40:55], v[124:127], v[64:67], v[40:55]
  s_waitcnt lgkmcnt(0)
  v_mfma_f32_32x32x16_bf16 v[24:39], v[128:131], v[68:71], v[24:39]
  v_mfma_f32_32x32x16_bf16 v[40:55], v[132:135], v[68:71], v[40:55]
  s_lshl_b32 s28, s17, 4
  s_add_u32 s28, s28, s18
  s_lshl_b32 s28, s28, 2
  s_add_u32 s28, s28, s16
  s_lshl_b32 s28, s28, 12
  s_add_u32 s28, s28, s63
  s_add_u32 s28, s28, 0xc00000
  s_lshl_b32 s29, s16, 12
  v_add_u32 v6, s29, v22
  s_mov_b32 s36, 0x3f803f80
  v_mov_b32 v8, 0
  v_mov_b32 v9, 0
  v_mov_b32 v10, 0
  v_and_b32 v7, 24, v18
  v_lshlrev_b32 v7, 8, v7
  v_and_b32 v11, 7, v18
  v_lshl_add_u32 v7, v11, 4, v7
  v_cvt_pk_bf16_f32 v56, v24, v25
  v_cvt_pk_bf16_f32 v57, v26, v27
  v_cvt_pk_bf16_f32 v58, v28, v29
  v_cvt_pk_bf16_f32 v59, v30, v31
  buffer_store_dwordx4 v[56:59], v22, s[4:7], s28 offen offset:0 sc1
  v_cvt_pk_bf16_f32 v60, v32, v33
  v_cvt_pk_bf16_f32 v61, v34, v35
  v_cvt_pk_bf16_f32 v62, v36, v37
  v_cvt_pk_bf16_f32 v63, v38, v39
  buffer_store_dwordx4 v[60:63], v22, s[4:7], s28 offen offset:512 sc1
  v_cvt_pk_bf16_f32 v64, v40, v41
  v_cvt_pk_bf16_f32 v65, v42, v43
  v_cvt_pk_bf16_f32 v66, v44, v45
  v_cvt_pk_bf16_f32 v67, v46, v47
  buffer_store_dwordx4 v[64:67], v22, s[4:7], s28 offen offset:1024 sc1
  v_cvt_pk_bf16_f32 v68, v48, v49
  v_cvt_pk_bf16_f32 v69, v50, v51
  v_cvt_pk_bf16_f32 v70, v52, v53
  v_cvt_pk_bf16_f32 v71, v54, v55
  buffer_store_dwordx4 v[68:71], v22, s[4:7], s28 offen offset:1536 sc1
  ds_write_b128 v6, v[56:59] offset:0
  ds_write_b128 v6, v[60:63] offset:512
  ds_write_b128 v6, v[64:67] offset:1024
  ds_write_b128 v6, v[68:71] offset:1536
  s_mov_b64 exec, 1
  ds_add_u32 v20, v5 offset:20
  s_mov_b64 exec, -1
  s_lshl_b32 s28, s17, 2
  s_add_u32 s28, s28, s16
  s_lshl_b32 s28, s28, 13
  s_lshl_b32 s29, s18, 7
  s_add_u32 s28, s28, s29
  s_add_u32 s28, s28, s63
  s_add_u32 s28, s28, 0x1000000
  v_dot2c_f32_bf16 v8, s36, v56
  v_dot2c_f32_bf16 v9, v56, v56
  v_dot2c_f32_bf16 v10, v56, v240
  v_dot2c_f32_bf16 v8, s36, v57
  v_dot2c_f32_bf16 v9, v57, v57
  v_dot2c_f32_bf16 v10, v57, v241
  v_dot2c_f32_bf16 v8, s36, v58
  v_dot2c_f32_bf16 v9, v58, v58
  v_dot2c_f32_bf16 v10, v58, v242
  v_dot2c_f32_bf16 v8, s36, v59
  v_dot2c_f32_bf16 v9, v59, v59
  v_dot2c_f32_bf16 v10, v59, v243
  v_dot2c_f32_bf16 v8, s36, v60
  v_dot2c_f32_bf16 v9, v60, v60
  v_dot2c_f32_bf16 v10, v60, v244
  v_dot2c_f32_bf16 v8, s36, v61
  v_dot2c_f32_bf16 v9, v61, v61
  v_dot2c_f32_bf16 v10, v61, v245
  v_dot2c_f32_bf16 v8, s36, v62
  v_dot2c_f32_bf16 v9, v62, v62
  v_dot2c_f32_bf16 v10, v62, v246
  v_dot2c_f32_bf16 v8, s36, v63
  v_dot2c_f32_bf16 v9, v63, v63
  v_dot2c_f32_bf16 v10, v63, v247
  v_dot2c_f32_bf16 v8, s36, v64
  v_dot2c_f32_bf16 v9, v64, v64
  v_dot2c_f32_bf16 v10, v64, v248
  v_dot2c_f32_bf16 v8, s36, v65
  v_dot2c_f32_bf16 v9, v65, v65
  v_dot2c_f32_bf16 v10, v65, v249
  v_dot2c_f32_bf16 v8, s36, v66
  v_dot2c_f32_bf16 v9, v66, v66
  v_dot2c_f32_bf16 v10, v66, v250
  v_dot2c_f32_bf16 v8, s36, v67
  v_dot2c_f32_bf16 v9, v67, v67
  v_dot2c_f32_bf16 v10, v67, v251
  v_dot2c_f32_bf16 v8, s36, v68
  v_dot2c_f32_bf16 v9, v68, v68
  v_dot2c_f32_bf16 v10, v68, v252
  v_dot2c_f32_bf16 v8, s36, v69
  v_dot2c_f32_bf16 v9, v69, v69
  v_dot2c_f32_bf16 v10, v69, v253
  v_dot2c_f32_bf16 v8, s36, v70
  v_dot2c_f32_bf16 v9, v70, v70
  v_dot2c_f32_bf16 v10, v70, v254
  v_dot2c_f32_bf16 v8, s36, v71
  v_dot2c_f32_bf16 v9, v71, v71
  v_dot2c_f32_bf16 v10, v71, v255
  s_lshl_b32 s29, s16, 7
  s_add_u32 s37, s19, s29
  v_mov_b32 v24, v8
  v_mov_b32 v25, v9
  v_mov_b32 v26, v10
  v_mov_b32 v11, 1
  v_permlane32_swap_b32 v8, v24
  v_permlane32_swap_b32 v9, v25
  v_permlane32_swap_b32 v10, v26
  v_add_f32 v8, v8, v24
  v_add_f32 v9, v9, v25
  v_add_f32 v10, v10, v26
  v_or_b32 v8, 1, v8
  v_mov_b32 v16, s70
  s_mov_b32 exec_hi, 0
  s_waitcnt vmcnt(0)
  buffer_store_dwordx4 v[8:11], v7, s[4:7], s28 offen sc1
  s_mov_b64 exec, 1
  buffer_store_dword v16, v4, s[4:7], s37 offen offset:8 sc1
  s_mov_b64 exec, -1
  s_cmp_lg_u32 s62, 0
  s_cbranch_scc1 .g2_kernel_tail
  s_mov_b32 s62, 1
  s_mov_b32 s63, 0x1800000
  s_mov_b32 s70, 2
  s_mov_b32 s71, 155776
  s_branch .g2_kernel_q_cons2
.g2_kernel_tail:
  s_mov_b32 s28, s56
  s_mov_b32 s29, s57
  s_mov_b32 s30, 0x400000
  s_mov_b32 s31, 0x00020000
  v_lshrrev_b32 v8, 3, v2
  v_and_b32 v9, 7, v2
  v_lshlrev_b32 v10, 8, v9
  v_lshl_add_u32 v10, v8, 4, v10
  s_lshl_b32 s32, s16, 12
  v_add_u32 v10, s32, v10
  ds_read_b128 v[56:59], v10 offset:0
  ds_read_b128 v[60:63], v10 offset:128
  ds_read_b128 v[64:67], v10 offset:2048
  ds_read_b128 v[68:71], v10 offset:2176
  v_lshlrev_b32 v23, 11, v8
  v_lshl_add_u32 v23, v9, 4, v23
  s_lshl_b32 s32, s16, 5
  v_add_u32 v19, s32, v8
  v_lshlrev_b32 v10, 2, v19
  v_add_u32 v10, 155648, v10
  s_lshl_b32 s32, s17, 2
  s_add_u32 s32, s32, s16
  s_lshl_b32 s32, s32, 16
  s_lshl_b32 s33, s18, 7
  s_add_u32 s32, s32, s33
  s_waitcnt lgkmcnt(0)
  v_lshlrev_b32 v24, 16, v56
  v_and_b32 v25, 0xffff0000, v56
  v_lshlrev_b32 v26, 16, v57
  v_and_b32 v27, 0xffff0000, v57
  v_lshlrev_b32 v28, 16, v58
  v_and_b32 v29, 0xffff0000, v58
  v_lshlrev_b32 v30, 16, v59
  v_and_b32 v31, 0xffff0000, v59
  v_lshlrev_b32 v32, 16, v60
  v_and_b32 v33, 0xffff0000, v60
  v_lshlrev_b32 v34, 16, v61
  v_and_b32 v35, 0xffff0000, v61
  v_lshlrev_b32 v36, 16, v62
  v_and_b32 v37, 0xffff0000, v62
  v_lshlrev_b32 v38, 16, v63
  v_and_b32 v39, 0xffff0000, v63
  v_lshlrev_b32 v40, 16, v64
  v_and_b32 v41, 0xffff0000, v64
  v_lshlrev_b32 v42, 16, v65
  v_and_b32 v43, 0xffff0000, v65
  v_lshlrev_b32 v44, 16, v66
  v_and_b32 v45, 0xffff0000, v66
  v_lshlrev_b32 v46, 16, v67
  v_and_b32 v47, 0xffff0000, v67
  v_lshlrev_b32 v48, 16, v68
  v_and_b32 v49, 0xffff0000, v68
  v_lshlrev_b32 v50, 16, v69
  v_and_b32 v51, 0xffff0000, v69
  v_lshlrev_b32 v52, 16, v70
  v_and_b32 v53, 0xffff0000, v70
  v_lshlrev_b32 v54, 16, v71
  v_and_b32 v55, 0xffff0000, v71
  v_mov_b32 v6, s71
  s_mov_b32 s38, 0
.g2_kernel_wg5:
  ds_read_b32 v7, v6 offset:28
  s_add_u32 s38, s38, 1
  s_waitcnt lgkmcnt(0)
  v_cmp_le_u32 vcc, 1, v7
  s_cbranch_vccnz .g2_kernel_wg5d
  s_sleep 2
  s_cmp_lt_u32 s38, 524288
  s_cbranch_scc1 .g2_kernel_wg5
.g2_kernel_wg5d:
  ds_read_b32 v16, v20 offset:32
  ds_read_b32 v72, v10 offset:3840
  ds_read_b32 v73, v10 offset:4352
  ds_read_b32 v74, v10 offset:3872
  ds_read_b32 v75, v10 offset:4384
  ds_read_b32 v76, v10 offset:3904
  ds_read_b32 v77, v10 offset:4416
  ds_read_b32 v78, v10 offset:3936
  ds_read_b32 v79, v10 offset:4448
  s_waitcnt lgkmcnt(0)
  v_sub_u32 v16, v16, v19
  v_pk_fma_f32 v[24:25], v[24:25], v[72:73], v[72:73] op_sel:[0,0,1] op_sel_hi:[1,0,1]
  v_pk_fma_f32 v[26:27], v[26:27], v[72:73], v[72:73] op_sel:[0,0,1] op_sel_hi:[1,0,1]
  v_pk_fma_f32 v[28:29], v[28:29], v[72:73], v[72:73] op_sel:[0,0,1] op_sel_hi:[1,0,1]
  v_pk_fma_f32 v[30:31], v[30:31], v[72:73], v[72:73] op_sel:[0,0,1] op_sel_hi:[1,0,1]
  v_cvt_pk_bf16_f32 v56, v24, v25
  v_cvt_pk_bf16_f32 v57, v26, v27
  v_cvt_pk_bf16_f32 v58, v28, v29
  v_cvt_pk_bf16_f32 v59, v30, v31
  v_cmp_ne_u32 vcc, 1, v16
  s_mov_b64 exec, vcc
  buffer_store_dwordx4 v[56:59], v23, s[28:31], s32 offen sc1
  s_mov_b64 exec, -1
  s_add_u32 s32, s32, 16384
  v_pk_fma_f32 v[32:33], v[32:33], v[74:75], v[74:75] op_sel:[0,0,1] op_sel_hi:[1,0,1]
  v_pk_fma_f32 v[34:35], v[34:35], v[74:75], v[74:75] op_sel:[0,0,1] op_sel_hi:[1,0,1]
  v_pk_fma_f32 v[36:37], v[36:37], v[74:75], v[74:75] op_sel:[0,0,1] op_sel_hi:[1,0,1]
  v_pk_fma_f32 v[38:39], v[38:39], v[74:75], v[74:75] op_sel:[0,0,1] op_sel_hi:[1,0,1]
  v_cvt_pk_bf16_f32 v60, v32, v33
  v_cvt_pk_bf16_f32 v61, v34, v35
  v_cvt_pk_bf16_f32 v62, v36, v37
  v_cvt_pk_bf16_f32 v63, v38, v39
  v_cmp_ne_u32 vcc, 9, v16
  s_mov_b64 exec, vcc
  buffer_store_dwordx4 v[60:63], v23, s[28:31], s32 offen sc1
  s_mov_b64 exec, -1
  s_add_u32 s32, s32, 16384
  v_pk_fma_f32 v[40:41], v[40:41], v[76:77], v[76:77] op_sel:[0,0,1] op_sel_hi:[1,0,1]
  v_pk_fma_f32 v[42:43], v[42:43], v[76:77], v[76:77] op_sel:[0,0,1] op_sel_hi:[1,0,1]
  v_pk_fma_f32 v[44:45], v[44:45], v[76:77], v[76:77] op_sel:[0,0,1] op_sel_hi:[1,0,1]
  v_pk_fma_f32 v[46:47], v[46:47], v[76:77], v[76:77] op_sel:[0,0,1] op_sel_hi:[1,0,1]
  v_cvt_pk_bf16_f32 v64, v40, v41
  v_cvt_pk_bf16_f32 v65, v42, v43
  v_cvt_pk_bf16_f32 v66, v44, v45
  v_cvt_pk_bf16_f32 v67, v46, v47
  v_cmp_ne_u32 vcc, 17, v16
  s_mov_b64 exec, vcc
  buffer_store_dwordx4 v[64:67], v23, s[28:31], s32 offen sc1
  s_mov_b64 exec, -1
  s_add_u32 s32, s32, 16384
  v_pk_fma_f32 v[48:49], v[48:49], v[78:79], v[78:79] op_sel:[0,0,1] op_sel_hi:[1,0,1]
  v_pk_fma_f32 v[50:51], v[50:51], v[78:79], v[78:79] op_sel:[0,0,1] op_sel_hi:[1,0,1]
  v_pk_fma_f32 v[52:53], v[52:53], v[78:79], v[78:79] op_sel:[0,0,1] op_sel_hi:[1,0,1]
  v_pk_fma_f32 v[54:55], v[54:55], v[78:79], v[78:79] op_sel:[0,0,1] op_sel_hi:[1,0,1]
  v_cvt_pk_bf16_f32 v68, v48, v49
  v_cvt_pk_bf16_f32 v69, v50, v51
  v_cvt_pk_bf16_f32 v70, v52, v53
  v_cvt_pk_bf16_f32 v71, v54, v55
  v_cmp_ne_u32 vcc, 25, v16
  s_mov_b64 exec, vcc
  buffer_store_dwordx4 v[68:71], v23, s[28:31], s32 offen sc1
  s_mov_b64 exec, -1
  s_add_u32 s32, s32, 16384
  s_branch .g2_kernel_fin
.g2_kernel_svc:
  s_cmp_eq_u32 s16, 5
  s_cbranch_scc1 .g2_kernel_s1
  s_cmp_eq_u32 s16, 6
  s_cbranch_scc1 .g2_kernel_s2
  s_cmp_eq_u32 s16, 7
  s_cbranch_scc1 .g2_kernel_s3
  s_mov_b32 s8, s40
  s_mov_b32 s9, s41
  s_mov_b32 s10, 0x400000
  s_mov_b32 s11, 0x00020000
  s_setprio 3
  v_lshrrev_b32 v20, 3, v2
  v_and_b32 v21, 7, v2
  v_lshrrev_b32 v22, 4, v2
  v_xor_b32 v23, v21, v22
  v_lshlrev_b32 v23, 4, v23
  v_lshl_add_u32 v24, v20, 11, v23
  v_xor_b32 v25, 64, v24
  s_lshl_b32 s32, s17, 18
  v_add_u32 v32, 0, v24
  v_add_u32 v33, 15360, v25
  v_add_u32 v34, 30720, v24
  v_add_u32 v35, 46080, v25
  v_add_u32 v36, 65536, v24
  v_add_u32 v37, 80896, v25
  v_add_u32 v38, 96256, v24
  v_add_u32 v39, 111616, v25
  v_add_u32 v40, 131072, v24
  v_add_u32 v41, 146432, v25
  v_add_u32 v42, 161792, v24
  v_add_u32 v43, 177152, v25
  v_add_u32 v44, 196608, v24
  v_add_u32 v45, 211968, v25
  v_add_u32 v46, 227328, v24
  v_add_u32 v47, 242688, v25
  s_mov_b32 s29, 0
  s_add_u32 m0, s29, 0
  s_waitcnt vmcnt(63)
  buffer_load_dwordx4 v32, s[8:11], s32 offen offset:0 lds
  buffer_load_dwordx4 v33, s[8:11], s32 offen offset:1024 lds
  buffer_load_dwordx4 v34, s[8:11], s32 offen offset:2048 lds
  buffer_load_dwordx4 v35, s[8:11], s32 offen offset:3072 lds
  s_add_u32 m0, s29, 4096
  s_waitcnt vmcnt(63)
  buffer_load_dwordx4 v36, s[8:11], s32 offen offset:0 lds
  buffer_load_dwordx4 v37, s[8:11], s32 offen offset:1024 lds
  buffer_load_dwordx4 v38, s[8:11], s32 offen offset:2048 lds
  buffer_load_dwordx4 v39, s[8:11], s32 offen offset:3072 lds
  s_add_u32 m0, s29, 8192
  s_waitcnt vmcnt(63)
  buffer_load_dwordx4 v40, s[8:11], s32 offen offset:0 lds
  buffer_load_dwordx4 v41, s[8:11], s32 offen offset:1024 lds
  buffer_load_dwordx4 v42, s[8:11], s32 offen offset:2048 lds
  buffer_load_dwordx4 v43, s[8:11], s32 offen offset:3072 lds
  s_add_u32 m0, s29, 12288
  s_waitcnt vmcnt(63)
  buffer_load_dwordx4 v44, s[8:11], s32 offen offset:0 lds
  buffer_load_dwordx4 v45, s[8:11], s32 offen offset:1024 lds
  buffer_load_dwordx4 v46, s[8:11], s32 offen offset:2048 lds
  buffer_load_dwordx4 v47, s[8:11], s32 offen offset:3072 lds
  s_add_u32 s32, s32, 128
  s_mov_b32 s12, s42
  s_mov_b32 s13, s43
  s_mov_b32 s14, 0x600000
  s_mov_b32 s15, 0x00020000
  v_lshrrev_b32 v28, 3, v2
  v_and_b32 v29, 7, v2
  v_bfe_u32 v30, v2, 4, 1
  v_lshlrev_b32 v30, 1, v30
  v_xor_b32 v31, v29, v30
  v_lshlrev_b32 v31, 4, v31
  v_mul_u32_u24 v28, 6144, v28
  v_add_u32 v28, v28, v31
  v_xor_b32 v29, 64, v28
  v_lshlrev_b32 v9, 8, v2
  v_and_b32 v9, 0x300, v9
  v_add_u32 v9, 156416, v9
  v_add_u32 v48, 0, v28
  v_add_u32 v49, 48128, v29
  v_add_u32 v50, 96256, v28
  v_add_u32 v51, 144384, v29
  v_add_u32 v52, 2048, v28
  v_add_u32 v53, 50176, v29
  v_add_u32 v54, 98304, v28
  v_add_u32 v55, 146432, v29
  v_add_u32 v56, 4096, v28
  v_add_u32 v57, 52224, v29
  v_add_u32 v58, 100352, v28
  v_add_u32 v59, 148480, v29
  s_lshl_b32 s36, s18, 7
  s_mov_b32 s30, 0
  s_add_u32 m0, s30, 65536
  s_waitcnt vmcnt(63)
  buffer_load_dwordx4 v48, s[12:15], s36 offen offset:0 lds
  buffer_load_dwordx4 v49, s[12:15], s36 offen offset:1024 lds
  buffer_load_dwordx4 v50, s[12:15], s36 offen offset:2048 lds
  buffer_load_dwordx4 v51, s[12:15], s36 offen offset:3072 lds
  s_add_u32 m0, s30, 69632
  s_waitcnt vmcnt(63)
  buffer_load_dwordx4 v52, s[12:15], s36 offen offset:0 lds
  buffer_load_dwordx4 v53, s[12:15], s36 offen offset:1024 lds
  buffer_load_dwordx4 v54, s[12:15], s36 offen offset:2048 lds
  buffer_load_dwordx4 v55, s[12:15], s36 offen offset:3072 lds
  s_add_u32 m0, s30, 73728
  s_waitcnt vmcnt(63)
  buffer_load_dwordx4 v56, s[12:15], s36 offen offset:0 lds
  buffer_load_dwordx4 v57, s[12:15], s36 offen offset:1024 lds
  buffer_load_dwordx4 v58, s[12:15], s36 offen offset:2048 lds
  buffer_load_dwordx4 v59, s[12:15], s36 offen offset:3072 lds
  s_add_u32 s30, s30, 12288
  s_cmp_eq_u32 s30, 86016
  s_cselect_b32 s30, 0, s30
  s_barrier
  s_mov_b32 s35, .g2_kernel_tab-.g2_kernel_pc+4
  s_mov_b32 s34, -5
  v_mov_b32 v10, 0
  s_mov_b32 m0, 156160
  s_add_u32 s36, s36, 196608
  buffer_load_dword off, s[64:67], s35 lds
  s_add_u32 s35, s35, 4
  s_branch .g2_kernel_p1_o
  .p2align 6
.g2_kernel_p1_l:
  s_waitcnt lgkmcnt(0)
  v_cmp_gt_i32 vcc, s34, v10
  s_cbranch_vccnz .g2_kernel_p1_aw
.g2_kernel_p1_ai:
  s_add_u32 s29, s29, 16384
  s_and_b32 s29, s29, 0xffff
  s_add_u32 m0, s29, 0
  s_waitcnt vmcnt(63)
  buffer_load_dwordx4 v32, s[8:11], s32 offen offset:0 lds
  buffer_load_dwordx4 v33, s[8:11], s32 offen offset:1024 lds
  buffer_load_dwordx4 v34, s[8:11], s32 offen offset:2048 lds
  buffer_load_dwordx4 v35, s[8:11], s32 offen offset:3072 lds
  s_add_u32 m0, s29, 4096
  s_waitcnt vmcnt(63)
  buffer_load_dwordx4 v36, s[8:11], s32 offen offset:0 lds
  buffer_load_dwordx4 v37, s[8:11], s32 offen offset:1024 lds
  buffer_load_dwordx4 v38, s[8:11], s32 offen offset:2048 lds
  buffer_load_dwordx4 v39, s[8:11], s32 offen offset:3072 lds
  s_add_u32 m0, s29, 8192
  s_waitcnt vmcnt(63)
  buffer_load_dwordx4 v40, s[8:11], s32 offen offset:0 lds
  buffer_load_dwordx4 v41, s[8:11], s32 offen offset:1024 lds
  buffer_load_dwordx4 v42, s[8:11], s32 offen offset:2048 lds
  buffer_load_dwordx4 v43, s[8:11], s32 offen offset:3072 lds
  s_add_u32 m0, s29, 12288
  s_waitcnt vmcnt(63)
  buffer_load_dwordx4 v44, s[8:11], s32 offen offset:0 lds
  buffer_load_dwordx4 v45, s[8:11], s32 offen offset:1024 lds
  buffer_load_dwordx4 v46, s[8:11], s32 offen offset:2048 lds
  buffer_load_dwordx4 v47, s[8:11], s32 offen offset:3072 lds
  s_add_u32 s32, s32, 128
  s_add_u32 m0, s30, 65536
  s_waitcnt vmcnt(63)
  buffer_load_dwordx4 v48, s[12:15], s36 offen offset:0 lds
  buffer_load_dwordx4 v49, s[12:15], s36 offen offset:1024 lds
  buffer_load_dwordx4 v50, s[12:15], s36 offen offset:2048 lds
  buffer_load_dwordx4 v51, s[12:15], s36 offen offset:3072 lds
  s_add_u32 m0, s30, 69632
  s_waitcnt vmcnt(63)
  buffer_load_dwordx4 v52, s[12:15], s36 offen offset:0 lds
  buffer_load_dwordx4 v53, s[12:15], s36 offen offset:1024 lds
  buffer_load_dwordx4 v54, s[12:15], s36 offen offset:2048 lds
  buffer_load_dwordx4 v55, s[12:15], s36 offen offset:3072 lds
  s_add_u32 m0, s30, 73728
  s_waitcnt vmcnt(63)
  buffer_load_dwordx4 v56, s[12:15], s36 offen offset:0 lds
  buffer_load_dwordx4 v57, s[12:15], s36 offen offset:1024 lds
  buffer_load_dwordx4 v58, s[12:15], s36 offen offset:2048 lds
  buffer_load_dwordx4 v59, s[12:15], s36 offen offset:3072 lds
  s_add_u32 s30, s30, 12288
  s_cmp_eq_u32 s30, 86016
  s_cselect_b32 s30, 0, s30
  ds_read_b32 v10, v9
  s_mov_b32 m0, 156160
  s_add_u32 s34, s34, 1
  buffer_load_dword off, s[64:67], s35 lds
  s_add_u32 s35, s35, 4
  s_add_u32 s36, s36, 196608
.g2_kernel_p1_o:
  s_waitcnt lgkmcnt(0)
  v_cmp_gt_i32 vcc, s34, v10
  s_cbranch_vccnz .g2_kernel_p1_bw
.g2_kernel_p1_bi:
  s_add_u32 m0, s30, 65536
  s_waitcnt vmcnt(63)
  buffer_load_dwordx4 v48, s[12:15], s36 offen offset:0 lds
  buffer_load_dwordx4 v49, s[12:15], s36 offen offset:1024 lds
  buffer_load_dwordx4 v50, s[12:15], s36 offen offset:2048 lds
  buffer_load_dwordx4 v51, s[12:15], s36 offen offset:3072 lds
  s_add_u32 m0, s30, 69632
  s_waitcnt vmcnt(63)
  buffer_load_dwordx4 v52, s[12:15], s36 offen offset:0 lds
  buffer_load_dwordx4 v53, s[12:15], s36 offen offset:1024 lds
  buffer_load_dwordx4 v54, s[12:15], s36 offen offset:2048 lds
  buffer_load_dwordx4 v55, s[12:15], s36 offen offset:3072 lds
  s_add_u32 m0, s30, 73728
  s_waitcnt vmcnt(63)
  buffer_load_dwordx4 v56, s[12:15], s36 offen offset:0 lds
  buffer_load_dwordx4 v57, s[12:15], s36 offen offset:1024 lds
  buffer_load_dwordx4 v58, s[12:15], s36 offen offset:2048 lds
  buffer_load_dwordx4 v59, s[12:15], s36 offen offset:3072 lds
  s_add_u32 s30, s30, 12288
  s_cmp_eq_u32 s30, 86016
  s_cselect_b32 s30, 0, s30
  ds_read_b32 v10, v9
  s_mov_b32 m0, 156160
  s_add_u32 s34, s34, 1
  buffer_load_dword off, s[64:67], s35 lds
  s_add_u32 s35, s35, 4
  s_add_u32 s36, s36, 196608
  s_cmp_lt_i32 s34, 26
  s_cbranch_scc1 .g2_kernel_p1_l
  s_branch .g2_kernel_v
.g2_kernel_s1:
  s_mov_b32 s8, s40
  s_mov_b32 s9, s41
  s_mov_b32 s10, 0x400000
  s_mov_b32 s11, 0x00020000
  v_lshrrev_b32 v20, 3, v2
  v_and_b32 v21, 7, v2
  v_lshlrev_b32 v21, 4, v21
  v_lshl_add_u32 v21, v20, 11, v21
  s_lshl_b32 s30, s17, 4
  s_add_u32 s30, s30, s18
  s_lshl_b32 s33, s30, 5
  s_lshl_b32 s30, s30, 14
  s_barrier
  s_sleep 30
  buffer_load_dwordx4 v[64:67], v21, s[8:11], s30 offen offset:0
  buffer_load_dwordx4 v[68:71], v21, s[8:11], s30 offen offset:128
  buffer_load_dwordx4 v[72:75], v21, s[8:11], s30 offen offset:256
  buffer_load_dwordx4 v[76:79], v21, s[8:11], s30 offen offset:384
  buffer_load_dwordx4 v[80:83], v21, s[8:11], s30 offen offset:512
  buffer_load_dwordx4 v[84:87], v21, s[8:11], s30 offen offset:640
  buffer_load_dwordx4 v[88:91], v21, s[8:11], s30 offen offset:768
  buffer_load_dwordx4 v[92:95], v21, s[8:11], s30 offen offset:896
  buffer_load_dwordx4 v[96:99], v21, s[8:11], s30 offen offset:1024
  buffer_load_dwordx4 v[100:103], v21, s[8:11], s30 offen offset:1152
  buffer_load_dwordx4 v[104:107], v21, s[8:11], s30 offen offset:1280
  buffer_load_dwordx4 v[108:111], v21, s[8:11], s30 offen offset:1408
  buffer_load_dwordx4 v[112:115], v21, s[8:11], s30 offen offset:1536
  buffer_load_dwordx4 v[116:119], v21, s[8:11], s30 offen offset:1664
  buffer_load_dwordx4 v[120:123], v21, s[8:11], s30 offen offset:1792
  buffer_load_dwordx4 v[124:127], v21, s[8:11], s30 offen offset:1920
  v_mov_b32 v24, 0
  v_mov_b32 v25, 0
  v_mov_b32 v26, 0
  v_mov_b32 v27, 0
  s_waitcnt vmcnt(15)
  v_lshlrev_b32 v22, 16, v64
  v_and_b32 v64, 0xffff0000, v64
  v_add_f32 v24, v24, v22
  v_fmac_f32 v25, v22, v22
  v_add_f32 v26, v26, v64
  v_fmac_f32 v27, v64, v64
  v_lshlrev_b32 v22, 16, v65
  v_and_b32 v65, 0xffff0000, v65
  v_add_f32 v24, v24, v22
  v_fmac_f32 v25, v22, v22
  v_add_f32 v26, v26, v65
  v_fmac_f32 v27, v65, v65
  v_lshlrev_b32 v22, 16, v66
  v_and_b32 v66, 0xffff0000, v66
  v_add_f32 v24, v24, v22
  v_fmac_f32 v25, v22, v22
  v_add_f32 v26, v26, v66
  v_fmac_f32 v27, v66, v66
  v_lshlrev_b32 v22, 16, v67
  v_and_b32 v67, 0xffff0000, v67
  v_add_f32 v24, v24, v22
  v_fmac_f32 v25, v22, v22
  v_add_f32 v26, v26, v67
  v_fmac_f32 v27, v67, v67
  s_waitcnt vmcnt(14)
  v_lshlrev_b32 v22, 16, v68
  v_and_b32 v68, 0xffff0000, v68
  v_add_f32 v24, v24, v22
  v_fmac_f32 v25, v22, v22
  v_add_f32 v26, v26, v68
  v_fmac_f32 v27, v68, v68
  v_lshlrev_b32 v22, 16, v69
  v_and_b32 v69, 0xffff0000, v69
  v_add_f32 v24, v24, v22
  v_fmac_f32 v25, v22, v22
  v_add_f32 v26, v26, v69
  v_fmac_f32 v27, v69, v69
  v_lshlrev_b32 v22, 16, v70
  v_and_b32 v70, 0xffff0000, v70
  v_add_f32 v24, v24, v22
  v_fmac_f32 v25, v22, v22
  v_add_f32 v26, v26, v70
  v_fmac_f32 v27, v70, v70
  v_lshlrev_b32 v22, 16, v71
  v_and_b32 v71, 0xffff0000, v71
  v_add_f32 v24, v24, v22
  v_fmac_f32 v25, v22, v22
  v_add_f32 v26, v26, v71
  v_fmac_f32 v27, v71, v71
  s_waitcnt vmcnt(13)
  v_lshlrev_b32 v22, 16, v72
  v_and_b32 v72, 0xffff0000, v72
  v_add_f32 v24, v24, v22
  v_fmac_f32 v25, v22, v22
  v_add_f32 v26, v26, v72
  v_fmac_f32 v27, v72, v72
  v_lshlrev_b32 v22, 16, v73
  v_and_b32 v73, 0xffff0000, v73
  v_add_f32 v24, v24, v22
  v_fmac_f32 v25, v22, v22
  v_add_f32 v26, v26, v73
  v_fmac_f32 v27, v73, v73
  v_lshlrev_b32 v22, 16, v74
  v_and_b32 v74, 0xffff0000, v74
  v_add_f32 v24, v24, v22
  v_fmac_f32 v25, v22, v22
  v_add_f32 v26, v26, v74
  v_fmac_f32 v27, v74, v74
  v_lshlrev_b32 v22, 16, v75
  v_and_b32 v75, 0xffff0000, v75
  v_add_f32 v24, v24, v22
  v_fmac_f32 v25, v22, v22
  v_add_f32 v26, v26, v75
  v_fmac_f32 v27, v75, v75
  s_waitcnt vmcnt(12)
  v_lshlrev_b32 v22, 16, v76
  v_and_b32 v76, 0xffff0000, v76
  v_add_f32 v24, v24, v22
  v_fmac_f32 v25, v22, v22
  v_add_f32 v26, v26, v76
  v_fmac_f32 v27, v76, v76
  v_lshlrev_b32 v22, 16, v77
  v_and_b32 v77, 0xffff0000, v77
  v_add_f32 v24, v24, v22
  v_fmac_f32 v25, v22, v22
  v_add_f32 v26, v26, v77
  v_fmac_f32 v27, v77, v77
  v_lshlrev_b32 v22, 16, v78
  v_and_b32 v78, 0xffff0000, v78
  v_add_f32 v24, v24, v22
  v_fmac_f32 v25, v22, v22
  v_add_f32 v26, v26, v78
  v_fmac_f32 v27, v78, v78
  v_lshlrev_b32 v22, 16, v79
  v_and_b32 v79, 0xffff0000, v79
  v_add_f32 v24, v24, v22
  v_fmac_f32 v25, v22, v22
  v_add_f32 v26, v26, v79
  v_fmac_f32 v27, v79, v79
  s_waitcnt vmcnt(11)
  v_lshlrev_b32 v22, 16, v80
  v_and_b32 v80, 0xffff0000, v80
  v_add_f32 v24, v24, v22
  v_fmac_f32 v25, v22, v22
  v_add_f32 v26, v26, v80
  v_fmac_f32 v27, v80, v80
  v_lshlrev_b32 v22, 16, v81
  v_and_b32 v81, 0xffff0000, v81
  v_add_f32 v24, v24, v22
  v_fmac_f32 v25, v22, v22
  v_add_f32 v26, v26, v81
  v_fmac_f32 v27, v81, v81
  v_lshlrev_b32 v22, 16, v82
  v_and_b32 v82, 0xffff0000, v82
  v_add_f32 v24, v24, v22
  v_fmac_f32 v25, v22, v22
  v_add_f32 v26, v26, v82
  v_fmac_f32 v27, v82, v82
  v_lshlrev_b32 v22, 16, v83
  v_and_b32 v83, 0xffff0000, v83
  v_add_f32 v24, v24, v22
  v_fmac_f32 v25, v22, v22
  v_add_f32 v26, v26, v83
  v_fmac_f32 v27, v83, v83
  s_waitcnt vmcnt(10)
  v_lshlrev_b32 v22, 16, v84
  v_and_b32 v84, 0xffff0000, v84
  v_add_f32 v24, v24, v22
  v_fmac_f32 v25, v22, v22
  v_add_f32 v26, v26, v84
  v_fmac_f32 v27, v84, v84
  v_lshlrev_b32 v22, 16, v85
  v_and_b32 v85, 0xffff0000, v85
  v_add_f32 v24, v24, v22
  v_fmac_f32 v25, v22, v22
  v_add_f32 v26, v26, v85
  v_fmac_f32 v27, v85, v85
  v_lshlrev_b32 v22, 16, v86
  v_and_b32 v86, 0xffff0000, v86
  v_add_f32 v24, v24, v22
  v_fmac_f32 v25, v22, v22
  v_add_f32 v26, v26, v86
  v_fmac_f32 v27, v86, v86
  v_lshlrev_b32 v22, 16, v87
  v_and_b32 v87, 0xffff0000, v87
  v_add_f32 v24, v24, v22
  v_fmac_f32 v25, v22, v22
  v_add_f32 v26, v26, v87
  v_fmac_f32 v27, v87, v87
  s_waitcnt vmcnt(9)
  v_lshlrev_b32 v22, 16, v88
  v_and_b32 v88, 0xffff0000, v88
  v_add_f32 v24, v24, v22
  v_fmac_f32 v25, v22, v22
  v_add_f32 v26, v26, v88
  v_fmac_f32 v27, v88, v88
  v_lshlrev_b32 v22, 16, v89
  v_and_b32 v89, 0xffff0000, v89
  v_add_f32 v24, v24, v22
  v_fmac_f32 v25, v22, v22
  v_add_f32 v26, v26, v89
  v_fmac_f32 v27, v89, v89
  v_lshlrev_b32 v22, 16, v90
  v_and_b32 v90, 0xffff0000, v90
  v_add_f32 v24, v24, v22
  v_fmac_f32 v25, v22, v22
  v_add_f32 v26, v26, v90
  v_fmac_f32 v27, v90, v90
  v_lshlrev_b32 v22, 16, v91
  v_and_b32 v91, 0xffff0000, v91
  v_add_f32 v24, v24, v22
  v_fmac_f32 v25, v22, v22
  v_add_f32 v26, v26, v91
  v_fmac_f32 v27, v91, v91
  s_waitcnt vmcnt(8)
  v_lshlrev_b32 v22, 16, v92
  v_and_b32 v92, 0xffff0000, v92
  v_add_f32 v24, v24, v22
  v_fmac_f32 v25, v22, v22
  v_add_f32 v26, v26, v92
  v_fmac_f32 v27, v92, v92
  v_lshlrev_b32 v22, 16, v93
  v_and_b32 v93, 0xffff0000, v93
  v_add_f32 v24, v24, v22
  v_fmac_f32 v25, v22, v22
  v_add_f32 v26, v26, v93
  v_fmac_f32 v27, v93, v93
  v_lshlrev_b32 v22, 16, v94
  v_and_b32 v94, 0xffff0000, v94
  v_add_f32 v24, v24, v22
  v_fmac_f32 v25, v22, v22
  v_add_f32 v26, v26, v94
  v_fmac_f32 v27, v94, v94
  v_lshlrev_b32 v22, 16, v95
  v_and_b32 v95, 0xffff0000, v95
  v_add_f32 v24, v24, v22
  v_fmac_f32 v25, v22, v22
  v_add_f32 v26, v26, v95
  v_fmac_f32 v27, v95, v95
  s_waitcnt vmcnt(7)
  v_lshlrev_b32 v22, 16, v96
  v_and_b32 v96, 0xffff0000, v96
  v_add_f32 v24, v24, v22
  v_fmac_f32 v25, v22, v22
  v_add_f32 v26, v26, v96
  v_fmac_f32 v27, v96, v96
  v_lshlrev_b32 v22, 16, v97
  v_and_b32 v97, 0xffff0000, v97
  v_add_f32 v24, v24, v22
  v_fmac_f32 v25, v22, v22
  v_add_f32 v26, v26, v97
  v_fmac_f32 v27, v97, v97
  v_lshlrev_b32 v22, 16, v98
  v_and_b32 v98, 0xffff0000, v98
  v_add_f32 v24, v24, v22
  v_fmac_f32 v25, v22, v22
  v_add_f32 v26, v26, v98
  v_fmac_f32 v27, v98, v98
  v_lshlrev_b32 v22, 16, v99
  v_and_b32 v99, 0xffff0000, v99
  v_add_f32 v24, v24, v22
  v_fmac_f32 v25, v22, v22
  v_add_f32 v26, v26, v99
  v_fmac_f32 v27, v99, v99
  s_waitcnt vmcnt(6)
  v_lshlrev_b32 v22, 16, v100
  v_and_b32 v100, 0xffff0000, v100
  v_add_f32 v24, v24, v22
  v_fmac_f32 v25, v22, v22
  v_add_f32 v26, v26, v100
  v_fmac_f32 v27, v100, v100
  v_lshlrev_b32 v22, 16, v101
  v_and_b32 v101, 0xffff0000, v101
  v_add_f32 v24, v24, v22
  v_fmac_f32 v25, v22, v22
  v_add_f32 v26, v26, v101
  v_fmac_f32 v27, v101, v101
  v_lshlrev_b32 v22, 16, v102
  v_and_b32 v102, 0xffff0000, v102
  v_add_f32 v24, v24, v22
  v_fmac_f32 v25, v22, v22
  v_add_f32 v26, v26, v102
  v_fmac_f32 v27, v102, v102
  v_lshlrev_b32 v22, 16, v103
  v_and_b32 v103, 0xffff0000, v103
  v_add_f32 v24, v24, v22
  v_fmac_f32 v25, v22, v22
  v_add_f32 v26, v26, v103
  v_fmac_f32 v27, v103, v103
  s_waitcnt vmcnt(5)
  v_lshlrev_b32 v22, 16, v104
  v_and_b32 v104, 0xffff0000, v104
  v_add_f32 v24, v24, v22
  v_fmac_f32 v25, v22, v22
  v_add_f32 v26, v26, v104
  v_fmac_f32 v27, v104, v104
  v_lshlrev_b32 v22, 16, v105
  v_and_b32 v105, 0xffff0000, v105
  v_add_f32 v24, v24, v22
  v_fmac_f32 v25, v22, v22
  v_add_f32 v26, v26, v105
  v_fmac_f32 v27, v105, v105
  v_lshlrev_b32 v22, 16, v106
  v_and_b32 v106, 0xffff0000, v106
  v_add_f32 v24, v24, v22
  v_fmac_f32 v25, v22, v22
  v_add_f32 v26, v26, v106
  v_fmac_f32 v27, v106, v106
  v_lshlrev_b32 v22, 16, v107
  v_and_b32 v107, 0xffff0000, v107
  v_add_f32 v24, v24, v22
  v_fmac_f32 v25, v22, v22
  v_add_f32 v26, v26, v107
  v_fmac_f32 v27, v107, v107
  s_waitcnt vmcnt(4)
  v_lshlrev_b32 v22, 16, v108
  v_and_b32 v108, 0xffff0000, v108
  v_add_f32 v24, v24, v22
  v_fmac_f32 v25, v22, v22
  v_add_f32 v26, v26, v108
  v_fmac_f32 v27, v108, v108
  v_lshlrev_b32 v22, 16, v109
  v_and_b32 v109, 0xffff0000, v109
  v_add_f32 v24, v24, v22
  v_fmac_f32 v25, v22, v22
  v_add_f32 v26, v26, v109
  v_fmac_f32 v27, v109, v109
  v_lshlrev_b32 v22, 16, v110
  v_and_b32 v110, 0xffff0000, v110
  v_add_f32 v24, v24, v22
  v_fmac_f32 v25, v22, v22
  v_add_f32 v26, v26, v110
  v_fmac_f32 v27, v110, v110
  v_lshlrev_b32 v22, 16, v111
  v_and_b32 v111, 0xffff0000, v111
  v_add_f32 v24, v24, v22
  v_fmac_f32 v25, v22, v22
  v_add_f32 v26, v26, v111
  v_fmac_f32 v27, v111, v111
  s_waitcnt vmcnt(3)
  v_lshlrev_b32 v22, 16, v112
  v_and_b32 v112, 0xffff0000, v112
  v_add_f32 v24, v24, v22
  v_fmac_f32 v25, v22, v22
  v_add_f32 v26, v26, v112
  v_fmac_f32 v27, v112, v112
  v_lshlrev_b32 v22, 16, v113
  v_and_b32 v113, 0xffff0000, v113
  v_add_f32 v24, v24, v22
  v_fmac_f32 v25, v22, v22
  v_add_f32 v26, v26, v113
  v_fmac_f32 v27, v113, v113
  v_lshlrev_b32 v22, 16, v114
  v_and_b32 v114, 0xffff0000, v114
  v_add_f32 v24, v24, v22
  v_fmac_f32 v25, v22, v22
  v_add_f32 v26, v26, v114
  v_fmac_f32 v27, v114, v114
  v_lshlrev_b32 v22, 16, v115
  v_and_b32 v115, 0xffff0000, v115
  v_add_f32 v24, v24, v22
  v_fmac_f32 v25, v22, v22
  v_add_f32 v26, v26, v115
  v_fmac_f32 v27, v115, v115
  s_waitcnt vmcnt(2)
  v_lshlrev_b32 v22, 16, v116
  v_and_b32 v116, 0xffff0000, v116
  v_add_f32 v24, v24, v22
  v_fmac_f32 v25, v22, v22
  v_add_f32 v26, v26, v116
  v_fmac_f32 v27, v116, v116
  v_lshlrev_b32 v22, 16, v117
  v_and_b32 v117, 0xffff0000, v117
  v_add_f32 v24, v24, v22
  v_fmac_f32 v25, v22, v22
  v_add_f32 v26, v26, v117
  v_fmac_f32 v27, v117, v117
  v_lshlrev_b32 v22, 16, v118
  v_and_b32 v118, 0xffff0000, v118
  v_add_f32 v24, v24, v22
  v_fmac_f32 v25, v22, v22
  v_add_f32 v26, v26, v118
  v_fmac_f32 v27, v118, v118
  v_lshlrev_b32 v22, 16, v119
  v_and_b32 v119, 0xffff0000, v119
  v_add_f32 v24, v24, v22
  v_fmac_f32 v25, v22, v22
  v_add_f32 v26, v26, v119
  v_fmac_f32 v27, v119, v119
  s_waitcnt vmcnt(1)
  v_lshlrev_b32 v22, 16, v120
  v_and_b32 v120, 0xffff0000, v120
  v_add_f32 v24, v24, v22
  v_fmac_f32 v25, v22, v22
  v_add_f32 v26, v26, v120
  v_fmac_f32 v27, v120, v120
  v_lshlrev_b32 v22, 16, v121
  v_and_b32 v121, 0xffff0000, v121
  v_add_f32 v24, v24, v22
  v_fmac_f32 v25, v22, v22
  v_add_f32 v26, v26, v121
  v_fmac_f32 v27, v121, v121
  v_lshlrev_b32 v22, 16, v122
  v_and_b32 v122, 0xffff0000, v122
  v_add_f32 v24, v24, v22
  v_fmac_f32 v25, v22, v22
  v_add_f32 v26, v26, v122
  v_fmac_f32 v27, v122, v122
  v_lshlrev_b32 v22, 16, v123
  v_and_b32 v123, 0xffff0000, v123
  v_add_f32 v24, v24, v22
  v_fmac_f32 v25, v22, v22
  v_add_f32 v26, v26, v123
  v_fmac_f32 v27, v123, v123
  s_waitcnt vmcnt(0)
  v_lshlrev_b32 v22, 16, v124
  v_and_b32 v124, 0xffff0000, v124
  v_add_f32 v24, v24, v22
  v_fmac_f32 v25, v22, v22
  v_add_f32 v26, v26, v124
  v_fmac_f32 v27, v124, v124
  v_lshlrev_b32 v22, 16, v125
  v_and_b32 v125, 0xffff0000, v125
  v_add_f32 v24, v24, v22
  v_fmac_f32 v25, v22, v22
  v_add_f32 v26, v26, v125
  v_fmac_f32 v27, v125, v125
  v_lshlrev_b32 v22, 16, v126
  v_and_b32 v126, 0xffff0000, v126
  v_add_f32 v24, v24, v22
  v_fmac_f32 v25, v22, v22
  v_add_f32 v26, v26, v126
  v_fmac_f32 v27, v126, v126
  v_lshlrev_b32 v22, 16, v127
  v_and_b32 v127, 0xffff0000, v127
  v_add_f32 v24, v24, v22
  v_fmac_f32 v25, v22, v22
  v_add_f32 v26, v26, v127
  v_fmac_f32 v27, v127, v127
  v_add_f32 v24, v24, v26
  v_add_f32 v25, v25, v27
  s_nop 0
  v_add_f32 v24, v24, v24 quad_perm:[1,0,3,2] row_mask:0xf bank_mask:0xf
  v_add_f32 v25, v25, v25 quad_perm:[1,0,3,2] row_mask:0xf bank_mask:0xf
  s_nop 0
  v_add_f32 v24, v24, v24 quad_perm:[2,3,0,1] row_mask:0xf bank_mask:0xf
  v_add_f32 v25, v25, v25 quad_perm:[2,3,0,1] row_mask:0xf bank_mask:0xf
  s_nop 0
  v_add_f32 v24, v24, v24 row_half_mirror row_mask:0xf bank_mask:0xf
  v_add_f32 v25, v25, v25 row_half_mirror row_mask:0xf bank_mask:0xf
  v_mov_b32 v26, 0.0009765625
  v_mul_f32 v24, v26, v24
  v_mul_f32 v27, v24, v24
  v_fma_f32 v25, v25, v26, -v27
  v_max_f32 v25, 0, v25
  v_add_f32 v25, 1e-05, v25
  v_rsq_f32 v25, v25
  v_lshlrev_b32 v20, 2, v20
  v_mul_f32 v24, v24, v25
  v_sub_f32 v24, 0, v24
  s_add_u32 s33, s33, 0x3070000
  s_add_u32 s34, s33, 0x2000
  s_mov_b32 exec_lo, 0x01010101
  s_mov_b32 exec_hi, 0x01010101
  buffer_store_dword v25, v20, s[4:7], s33 offen sc1
  buffer_store_dword v24, v20, s[4:7], s34 offen sc1
  s_mov_b64 exec, -1
  s_mov_b32 s12, s58
  s_mov_b32 s13, s59
  s_mov_b32 s14, 0x100
  s_mov_b32 s15, 0x00020000
  s_mov_b32 s38, 0
  s_mov_b64 exec, 1
.g2_kernel_gt6:
  buffer_load_dword v6, v4, s[12:15], 0 offen sc1
  s_add_u32 s38, s38, 1
  s_waitcnt vmcnt(0)
  v_cmp_eq_u32 vcc, 0x60, v6
  s_cbranch_vccnz .g2_kernel_gt6d
  s_sleep 8
  s_cmp_lt_u32 s38, 131072
  s_cbranch_scc1 .g2_kernel_gt6
.g2_kernel_gt6d:
  s_mov_b64 exec, -1
  v_mov_b32 v6, s70
  s_mov_b64 exec, 1
  buffer_store_dword v6, v4, s[4:7], s19 offen offset:12 sc1
  s_mov_b64 exec, -1
  v_mov_b32 v6, 155648
  s_mov_b32 s38, 0
.g2_kernel_wg7:
  ds_read_b32 v7, v6 offset:512
  s_add_u32 s38, s38, 1
  s_waitcnt lgkmcnt(0)
  v_cmp_le_u32 vcc, 27, v7
  s_cbranch_vccnz .g2_kernel_wg7d
  s_sleep 4
  s_cmp_lt_u32 s38, 524288
  s_cbranch_scc1 .g2_kernel_wg7
.g2_kernel_wg7d:
  s_and_b32 s31, s19, 0xffffe000
  s_add_u32 s31, s31, 12
  v_and_b32 v6, 15, v2
  v_lshlrev_b32 v6, 9, v6
  v_lshrrev_b32 v7, 4, v2
  v_lshl_add_u32 v6, v7, 7, v6
  v_lshlrev_b32 v7, 2, v2
  v_add_u32 v7, 157952, v7
  s_mov_b32 m0, 157952
  s_mov_b32 s38, 0
  s_bfm_b64 exec, 16, 0
.g2_kernel_pa8:
  buffer_load_dword v6, s[4:7], s31 offen sc1 lds
  s_add_u32 s38, s38, 1
  s_waitcnt vmcnt(0)
  ds_read_b32 v8, v7
  s_waitcnt lgkmcnt(0)
  v_cmp_ge_u32 vcc, s62, v8
  s_cbranch_vccz .g2_kernel_pa8d
  s_mov_b64 exec, vcc
  s_sleep 16
  s_cmp_lt_u32 s38, 131072
  s_cbranch_scc1 .g2_kernel_pa8
.g2_kernel_pa8d:
  s_mov_b64 exec, -1
  s_lshl_b32 s33, s17, 9
  s_add_u32 s33, s33, 0x3070000
  s_add_u32 s34, s33, 0x2000
  s_mov_b32 exec_hi, 0
  s_mov_b32 m0, 158464
  s_nop 0
  buffer_load_dwordx4 v3, s[4:7], s33 offen sc1 lds
  s_mov_b32 m0, 158976
  s_nop 0
  buffer_load_dwordx4 v3, s[4:7], s34 offen sc1 lds
  s_mov_b64 exec, -1
  v_mov_b32 v20, 1.0
  v_mov_b32 v21, 1.0
  v_mov_b32 v22, 0
  v_mov_b32 v23, 0
  v_lshlrev_b32 v24, 3, v2
  v_add_u32 v24, 155648, v24
  v_mov_b32 v6, 155648
  s_mov_b32 s38, 0
.g2_kernel_wg9:
  ds_read_b32 v7, v6 offset:512
  s_add_u32 s38, s38, 1
  s_waitcnt lgkmcnt(0)
  v_cmp_le_u32 vcc, 32, v7
  s_cbranch_vccnz .g2_kernel_wg9d
  s_sleep 2
  s_cmp_lt_u32 s38, 524288
  s_cbranch_scc1 .g2_kernel_wg9
.g2_kernel_wg9d:
  ds_write_b64 v24, v[20:21] offset:3840
  ds_write_b64 v24, v[22:23] offset:4352
  v_lshlrev_b32 v24, 2, v2
  v_add_u32 v24, 155648, v24
  ds_write_b32 v24, v4 offset:2304
  s_waitcnt vmcnt(0)
  v_mov_b32 v6, s71
  s_mov_b64 exec, 1
  ds_add_u32 v6, v5 offset:0
  s_mov_b64 exec, -1
  s_branch .g2_kernel_v
.g2_kernel_s2:
  s_mov_b32 s8, s42
  s_mov_b32 s9, s43
  s_mov_b32 s10, 0x600000
  s_mov_b32 s11, 0x00020000
  v_lshrrev_b32 v20, 3, v2
  v_and_b32 v21, 7, v2
  v_mul_u32_u24 v20, 6144, v20
  v_lshl_add_u32 v20, v21, 4, v20
  s_mul_i32 s30, s17, 393216
  s_lshl_b32 s31, s18, 7
  s_add_u32 s30, s30, s31
  s_add_u32 s31, s30, 4096
  s_barrier
  s_sleep 30
  buffer_load_dwordx4 v[64:67], v20, s[8:11], s30 offen
  buffer_load_dwordx4 v[68:71], v20, s[8:11], s30 offen offset:2048
  buffer_load_dwordx4 v[72:75], v20, s[8:11], s31 offen
  s_add_u32 s30, s30, 49152
  s_add_u32 s31, s31, 49152
  buffer_load_dwordx4 v[76:79], v20, s[8:11], s30 offen
  buffer_load_dwordx4 v[80:83], v20, s[8:11], s30 offen offset:2048
  buffer_load_dwordx4 v[84:87], v20, s[8:11], s31 offen
  s_add_u32 s30, s30, 49152
  s_add_u32 s31, s31, 49152
  buffer_load_dwordx4 v[88:91], v20, s[8:11], s30 offen
  buffer_load_dwordx4 v[92:95], v20, s[8:11], s30 offen offset:2048
  buffer_load_dwordx4 v[96:99], v20, s[8:11], s31 offen
  s_add_u32 s30, s30, 49152
  s_add_u32 s31, s31, 49152
  buffer_load_dwordx4 v[100:103], v20, s[8:11], s30 offen
  buffer_load_dwordx4 v[104:107], v20, s[8:11], s30 offen offset:2048
  buffer_load_dwordx4 v[108:111], v20, s[8:11], s31 offen
  s_add_u32 s30, s30, 49152
  s_add_u32 s31, s31, 49152
  buffer_load_dwordx4 v[112:115], v20, s[8:11], s30 offen
  buffer_load_dwordx4 v[116:119], v20, s[8:11], s30 offen offset:2048
  buffer_load_dwordx4 v[120:123], v20, s[8:11], s31 offen
  s_add_u32 s30, s30, 49152
  s_add_u32 s31, s31, 49152
  buffer_load_dwordx4 v[124:127], v20, s[8:11], s30 offen
  buffer_load_dwordx4 v[128:131], v20, s[8:11], s30 offen offset:2048
  buffer_load_dwordx4 v[132:135], v20, s[8:11], s31 offen
  s_add_u32 s30, s30, 49152
  s_add_u32 s31, s31, 49152
  buffer_load_dwordx4 v[136:139], v20, s[8:11], s30 offen
  buffer_load_dwordx4 v[140:143], v20, s[8:11], s30 offen offset:2048
  buffer_load_dwordx4 v[144:147], v20, s[8:11], s31 offen
  s_add_u32 s30, s30, 49152
  s_add_u32 s31, s31, 49152
  buffer_load_dwordx4 v[148:151], v20, s[8:11], s30 offen
  buffer_load_dwordx4 v[152:155], v20, s[8:11], s30 offen offset:2048
  buffer_load_dwordx4 v[156:159], v20, s[8:11], s31 offen
  s_add_u32 s30, s30, 49152
  s_add_u32 s31, s31, 49152
  v_lshlrev_b32 v21, 5, v21
  v_lshrrev_b32 v22, 5, v2
  v_lshl_add_u32 v21, v22, 4, v21
  v_bfe_u32 v22, v2, 4, 1
  v_lshl_add_u32 v21, v22, 3, v21
  s_lshl_b32 s30, s18, 4
  s_add_u32 s30, s30, s17
  s_mul_i32 s30, s30, 768
  s_add_u32 s30, s30, 0x3080000
  s_waitcnt vmcnt(23)
  v_lshlrev_b32 v160, 16, v64
  v_and_b32 v161, 0xffff0000, v64
  v_lshlrev_b32 v162, 16, v65
  v_and_b32 v163, 0xffff0000, v65
  v_lshlrev_b32 v164, 16, v66
  v_and_b32 v165, 0xffff0000, v66
  v_lshlrev_b32 v166, 16, v67
  v_and_b32 v167, 0xffff0000, v67
  s_waitcnt vmcnt(22)
  v_lshlrev_b32 v168, 16, v68
  v_and_b32 v169, 0xffff0000, v68
  v_lshlrev_b32 v170, 16, v69
  v_and_b32 v171, 0xffff0000, v69
  v_lshlrev_b32 v172, 16, v70
  v_and_b32 v173, 0xffff0000, v70
  v_lshlrev_b32 v174, 16, v71
  v_and_b32 v175, 0xffff0000, v71
  s_waitcnt vmcnt(21)
  v_lshlrev_b32 v176, 16, v72
  v_and_b32 v177, 0xffff0000, v72
  v_lshlrev_b32 v178, 16, v73
  v_and_b32 v179, 0xffff0000, v73
  v_lshlrev_b32 v180, 16, v74
  v_and_b32 v181, 0xffff0000, v74
  v_lshlrev_b32 v182, 16, v75
  v_and_b32 v183, 0xffff0000, v75
  s_waitcnt vmcnt(20)
  v_lshlrev_b32 v184, 16, v76
  v_and_b32 v185, 0xffff0000, v76
  v_lshlrev_b32 v186, 16, v77
  v_and_b32 v187, 0xffff0000, v77
  v_lshlrev_b32 v188, 16, v78
  v_and_b32 v189, 0xffff0000, v78
  v_lshlrev_b32 v190, 16, v79
  v_and_b32 v191, 0xffff0000, v79
  v_add_f32 v160, v160, v184
  v_add_f32 v161, v161, v185
  v_add_f32 v162, v162, v186
  v_add_f32 v163, v163, v187
  v_add_f32 v164, v164, v188
  v_add_f32 v165, v165, v189
  v_add_f32 v166, v166, v190
  v_add_f32 v167, v167, v191
  s_waitcnt vmcnt(19)
  v_lshlrev_b32 v184, 16, v80
  v_and_b32 v185, 0xffff0000, v80
  v_lshlrev_b32 v186, 16, v81
  v_and_b32 v187, 0xffff0000, v81
  v_lshlrev_b32 v188, 16, v82
  v_and_b32 v189, 0xffff0000, v82
  v_lshlrev_b32 v190, 16, v83
  v_and_b32 v191, 0xffff0000, v83
  v_add_f32 v168, v168, v184
  v_add_f32 v169, v169, v185
  v_add_f32 v170, v170, v186
  v_add_f32 v171, v171, v187
  v_add_f32 v172, v172, v188
  v_add_f32 v173, v173, v189
  v_add_f32 v174, v174, v190
  v_add_f32 v175, v175, v191
  s_waitcnt vmcnt(18)
  v_lshlrev_b32 v184, 16, v84
  v_and_b32 v185, 0xffff0000, v84
  v_lshlrev_b32 v186, 16, v85
  v_and_b32 v187, 0xffff0000, v85
  v_lshlrev_b32 v188, 16, v86
  v_and_b32 v189, 0xffff0000, v86
  v_lshlrev_b32 v190, 16, v87
  v_and_b32 v191, 0xffff0000, v87
  v_add_f32 v176, v176, v184
  v_add_f32 v177, v177, v185
  v_add_f32 v178, v178, v186
  v_add_f32 v179, v179, v187
  v_add_f32 v180, v180, v188
  v_add_f32 v181, v181, v189
  v_add_f32 v182, v182, v190
  v_add_f32 v183, v183, v191
  s_waitcnt vmcnt(17)
  v_lshlrev_b32 v184, 16, v88
  v_and_b32 v185, 0xffff0000, v88
  v_lshlrev_b32 v186, 16, v89
  v_and_b32 v187, 0xffff0000, v89
  v_lshlrev_b32 v188, 16, v90
  v_and_b32 v189, 0xffff0000, v90
  v_lshlrev_b32 v190, 16, v91
  v_and_b32 v191, 0xffff0000, v91
  v_add_f32 v160, v160, v184
  v_add_f32 v161, v161, v185
  v_add_f32 v162, v162, v186
  v_add_f32 v163, v163, v187
  v_add_f32 v164, v164, v188
  v_add_f32 v165, v165, v189
  v_add_f32 v166, v166, v190
  v_add_f32 v167, v167, v191
  s_waitcnt vmcnt(16)
  v_lshlrev_b32 v184, 16, v92
  v_and_b32 v185, 0xffff0000, v92
  v_lshlrev_b32 v186, 16, v93
  v_and_b32 v187, 0xffff0000, v93
  v_lshlrev_b32 v188, 16, v94
  v_and_b32 v189, 0xffff0000, v94
  v_lshlrev_b32 v190, 16, v95
  v_and_b32 v191, 0xffff0000, v95
  v_add_f32 v168, v168, v184
  v_add_f32 v169, v169, v185
  v_add_f32 v170, v170, v186
  v_add_f32 v171, v171, v187
  v_add_f32 v172, v172, v188
  v_add_f32 v173, v173, v189
  v_add_f32 v174, v174, v190
  v_add_f32 v175, v175, v191
  s_waitcnt vmcnt(15)
  v_lshlrev_b32 v184, 16, v96
  v_and_b32 v185, 0xffff0000, v96
  v_lshlrev_b32 v186, 16, v97
  v_and_b32 v187, 0xffff0000, v97
  v_lshlrev_b32 v188, 16, v98
  v_and_b32 v189, 0xffff0000, v98
  v_lshlrev_b32 v190, 16, v99
  v_and_b32 v191, 0xffff0000, v99
  v_add_f32 v176, v176, v184
  v_add_f32 v177, v177, v185
  v_add_f32 v178, v178, v186
  v_add_f32 v179, v179, v187
  v_add_f32 v180, v180, v188
  v_add_f32 v181, v181, v189
  v_add_f32 v182, v182, v190
  v_add_f32 v183, v183, v191
  s_waitcnt vmcnt(14)
  v_lshlrev_b32 v184, 16, v100
  v_and_b32 v185, 0xffff0000, v100
  v_lshlrev_b32 v186, 16, v101
  v_and_b32 v187, 0xffff0000, v101
  v_lshlrev_b32 v188, 16, v102
  v_and_b32 v189, 0xffff0000, v102
  v_lshlrev_b32 v190, 16, v103
  v_and_b32 v191, 0xffff0000, v103
  v_add_f32 v160, v160, v184
  v_add_f32 v161, v161, v185
  v_add_f32 v162, v162, v186
  v_add_f32 v163, v163, v187
  v_add_f32 v164, v164, v188
  v_add_f32 v165, v165, v189
  v_add_f32 v166, v166, v190
  v_add_f32 v167, v167, v191
  s_waitcnt vmcnt(13)
  v_lshlrev_b32 v184, 16, v104
  v_and_b32 v185, 0xffff0000, v104
  v_lshlrev_b32 v186, 16, v105
  v_and_b32 v187, 0xffff0000, v105
  v_lshlrev_b32 v188, 16, v106
  v_and_b32 v189, 0xffff0000, v106
  v_lshlrev_b32 v190, 16, v107
  v_and_b32 v191, 0xffff0000, v107
  v_add_f32 v168, v168, v184
  v_add_f32 v169, v169, v185
  v_add_f32 v170, v170, v186
  v_add_f32 v171, v171, v187
  v_add_f32 v172, v172, v188
  v_add_f32 v173, v173, v189
  v_add_f32 v174, v174, v190
  v_add_f32 v175, v175, v191
  s_waitcnt vmcnt(12)
  v_lshlrev_b32 v184, 16, v108
  v_and_b32 v185, 0xffff0000, v108
  v_lshlrev_b32 v186, 16, v109
  v_and_b32 v187, 0xffff0000, v109
  v_lshlrev_b32 v188, 16, v110
  v_and_b32 v189, 0xffff0000, v110
  v_lshlrev_b32 v190, 16, v111
  v_and_b32 v191, 0xffff0000, v111
  v_add_f32 v176, v176, v184
  v_add_f32 v177, v177, v185
  v_add_f32 v178, v178, v186
  v_add_f32 v179, v179, v187
  v_add_f32 v180, v180, v188
  v_add_f32 v181, v181, v189
  v_add_f32 v182, v182, v190
  v_add_f32 v183, v183, v191
  s_waitcnt vmcnt(11)
  v_lshlrev_b32 v184, 16, v112
  v_and_b32 v185, 0xffff0000, v112
  v_lshlrev_b32 v186, 16, v113
  v_and_b32 v187, 0xffff0000, v113
  v_lshlrev_b32 v188, 16, v114
  v_and_b32 v189, 0xffff0000, v114
  v_lshlrev_b32 v190, 16, v115
  v_and_b32 v191, 0xffff0000, v115
  v_add_f32 v160, v160, v184
  v_add_f32 v161, v161, v185
  v_add_f32 v162, v162, v186
  v_add_f32 v163, v163, v187
  v_add_f32 v164, v164, v188
  v_add_f32 v165, v165, v189
  v_add_f32 v166, v166, v190
  v_add_f32 v167, v167, v191
  s_waitcnt vmcnt(10)
  v_lshlrev_b32 v184, 16, v116
  v_and_b32 v185, 0xffff0000, v116
  v_lshlrev_b32 v186, 16, v117
  v_and_b32 v187, 0xffff0000, v117
  v_lshlrev_b32 v188, 16, v118
  v_and_b32 v189, 0xffff0000, v118
  v_lshlrev_b32 v190, 16, v119
  v_and_b32 v191, 0xffff0000, v119
  v_add_f32 v168, v168, v184
  v_add_f32 v169, v169, v185
  v_add_f32 v170, v170, v186
  v_add_f32 v171, v171, v187
  v_add_f32 v172, v172, v188
  v_add_f32 v173, v173, v189
  v_add_f32 v174, v174, v190
  v_add_f32 v175, v175, v191
  s_waitcnt vmcnt(9)
  v_lshlrev_b32 v184, 16, v120
  v_and_b32 v185, 0xffff0000, v120
  v_lshlrev_b32 v186, 16, v121
  v_and_b32 v187, 0xffff0000, v121
  v_lshlrev_b32 v188, 16, v122
  v_and_b32 v189, 0xffff0000, v122
  v_lshlrev_b32 v190, 16, v123
  v_and_b32 v191, 0xffff0000, v123
  v_add_f32 v176, v176, v184
  v_add_f32 v177, v177, v185
  v_add_f32 v178, v178, v186
  v_add_f32 v179, v179, v187
  v_add_f32 v180, v180, v188
  v_add_f32 v181, v181, v189
  v_add_f32 v182, v182, v190
  v_add_f32 v183, v183, v191
  s_waitcnt vmcnt(8)
  v_lshlrev_b32 v184, 16, v124
  v_and_b32 v185, 0xffff0000, v124
  v_lshlrev_b32 v186, 16, v125
  v_and_b32 v187, 0xffff0000, v125
  v_lshlrev_b32 v188, 16, v126
  v_and_b32 v189, 0xffff0000, v126
  v_lshlrev_b32 v190, 16, v127
  v_and_b32 v191, 0xffff0000, v127
  v_add_f32 v160, v160, v184
  v_add_f32 v161, v161, v185
  v_add_f32 v162, v162, v186
  v_add_f32 v163, v163, v187
  v_add_f32 v164, v164, v188
  v_add_f32 v165, v165, v189
  v_add_f32 v166, v166, v190
  v_add_f32 v167, v167, v191
  s_waitcnt vmcnt(7)
  v_lshlrev_b32 v184, 16, v128
  v_and_b32 v185, 0xffff0000, v128
  v_lshlrev_b32 v186, 16, v129
  v_and_b32 v187, 0xffff0000, v129
  v_lshlrev_b32 v188, 16, v130
  v_and_b32 v189, 0xffff0000, v130
  v_lshlrev_b32 v190, 16, v131
  v_and_b32 v191, 0xffff0000, v131
  v_add_f32 v168, v168, v184
  v_add_f32 v169, v169, v185
  v_add_f32 v170, v170, v186
  v_add_f32 v171, v171, v187
  v_add_f32 v172, v172, v188
  v_add_f32 v173, v173, v189
  v_add_f32 v174, v174, v190
  v_add_f32 v175, v175, v191
  s_waitcnt vmcnt(6)
  v_lshlrev_b32 v184, 16, v132
  v_and_b32 v185, 0xffff0000, v132
  v_lshlrev_b32 v186, 16, v133
  v_and_b32 v187, 0xffff0000, v133
  v_lshlrev_b32 v188, 16, v134
  v_and_b32 v189, 0xffff0000, v134
  v_lshlrev_b32 v190, 16, v135
  v_and_b32 v191, 0xffff0000, v135
  v_add_f32 v176, v176, v184
  v_add_f32 v177, v177, v185
  v_add_f32 v178, v178, v186
  v_add_f32 v179, v179, v187
  v_add_f32 v180, v180, v188
  v_add_f32 v181, v181, v189
  v_add_f32 v182, v182, v190
  v_add_f32 v183, v183, v191
  s_waitcnt vmcnt(5)
  v_lshlrev_b32 v184, 16, v136
  v_and_b32 v185, 0xffff0000, v136
  v_lshlrev_b32 v186, 16, v137
  v_and_b32 v187, 0xffff0000, v137
  v_lshlrev_b32 v188, 16, v138
  v_and_b32 v189, 0xffff0000, v138
  v_lshlrev_b32 v190, 16, v139
  v_and_b32 v191, 0xffff0000, v139
  v_add_f32 v160, v160, v184
  v_add_f32 v161, v161, v185
  v_add_f32 v162, v162, v186
  v_add_f32 v163, v163, v187
  v_add_f32 v164, v164, v188
  v_add_f32 v165, v165, v189
  v_add_f32 v166, v166, v190
  v_add_f32 v167, v167, v191
  s_waitcnt vmcnt(4)
  v_lshlrev_b32 v184, 16, v140
  v_and_b32 v185, 0xffff0000, v140
  v_lshlrev_b32 v186, 16, v141
  v_and_b32 v187, 0xffff0000, v141
  v_lshlrev_b32 v188, 16, v142
  v_and_b32 v189, 0xffff0000, v142
  v_lshlrev_b32 v190, 16, v143
  v_and_b32 v191, 0xffff0000, v143
  v_add_f32 v168, v168, v184
  v_add_f32 v169, v169, v185
  v_add_f32 v170, v170, v186
  v_add_f32 v171, v171, v187
  v_add_f32 v172, v172, v188
  v_add_f32 v173, v173, v189
  v_add_f32 v174, v174, v190
  v_add_f32 v175, v175, v191
  s_waitcnt vmcnt(3)
  v_lshlrev_b32 v184, 16, v144
  v_and_b32 v185, 0xffff0000, v144
  v_lshlrev_b32 v186, 16, v145
  v_and_b32 v187, 0xffff0000, v145
  v_lshlrev_b32 v188, 16, v146
  v_and_b32 v189, 0xffff0000, v146
  v_lshlrev_b32 v190, 16, v147
  v_and_b32 v191, 0xffff0000, v147
  v_add_f32 v176, v176, v184
  v_add_f32 v177, v177, v185
  v_add_f32 v178, v178, v186
  v_add_f32 v179, v179, v187
  v_add_f32 v180, v180, v188
  v_add_f32 v181, v181, v189
  v_add_f32 v182, v182, v190
  v_add_f32 v183, v183, v191
  s_waitcnt vmcnt(2)
  v_lshlrev_b32 v184, 16, v148
  v_and_b32 v185, 0xffff0000, v148
  v_lshlrev_b32 v186, 16, v149
  v_and_b32 v187, 0xffff0000, v149
  v_lshlrev_b32 v188, 16, v150
  v_and_b32 v189, 0xffff0000, v150
  v_lshlrev_b32 v190, 16, v151
  v_and_b32 v191, 0xffff0000, v151
  v_add_f32 v160, v160, v184
  v_add_f32 v161, v161, v185
  v_add_f32 v162, v162, v186
  v_add_f32 v163, v163, v187
  v_add_f32 v164, v164, v188
  v_add_f32 v165, v165, v189
  v_add_f32 v166, v166, v190
  v_add_f32 v167, v167, v191
  s_waitcnt vmcnt(1)
  v_lshlrev_b32 v184, 16, v152
  v_and_b32 v185, 0xffff0000, v152
  v_lshlrev_b32 v186, 16, v153
  v_and_b32 v187, 0xffff0000, v153
  v_lshlrev_b32 v188, 16, v154
  v_and_b32 v189, 0xffff0000, v154
  v_lshlrev_b32 v190, 16, v155
  v_and_b32 v191, 0xffff0000, v155
  v_add_f32 v168, v168, v184
  v_add_f32 v169, v169, v185
  v_add_f32 v170, v170, v186
  v_add_f32 v171, v171, v187
  v_add_f32 v172, v172, v188
  v_add_f32 v173, v173, v189
  v_add_f32 v174, v174, v190
  v_add_f32 v175, v175, v191
  s_waitcnt vmcnt(0)
  v_lshlrev_b32 v184, 16, v156
  v_and_b32 v185, 0xffff0000, v156
  v_lshlrev_b32 v186, 16, v157
  v_and_b32 v187, 0xffff0000, v157
  v_lshlrev_b32 v188, 16, v158
  v_and_b32 v189, 0xffff0000, v158
  v_lshlrev_b32 v190, 16, v159
  v_and_b32 v191, 0xffff0000, v159
  v_add_f32 v176, v176, v184
  v_add_f32 v177, v177, v185
  v_add_f32 v178, v178, v186
  v_add_f32 v179, v179, v187
  v_add_f32 v180, v180, v188
  v_add_f32 v181, v181, v189
  v_add_f32 v182, v182, v190
  v_add_f32 v183, v183, v191
  v_permlane32_swap_b32 v160, v164
  v_permlane32_swap_b32 v161, v165
  v_permlane32_swap_b32 v162, v166
  v_permlane32_swap_b32 v163, v167
  v_add_f32 v160, v160, v164
  v_add_f32 v161, v161, v165
  v_add_f32 v162, v162, v166
  v_add_f32 v163, v163, v167
  s_nop 0
  v_permlane16_swap_b32 v160, v162
  v_permlane16_swap_b32 v161, v163
  v_add_f32 v160, v160, v162
  v_add_f32 v161, v161, v163
  s_nop 0
  v_add_f32 v160, v160, v160 row_ror:8 row_mask:0xf bank_mask:0xf
  v_add_f32 v161, v161, v161 row_ror:8 row_mask:0xf bank_mask:0xf
  v_permlane32_swap_b32 v168, v172
  v_permlane32_swap_b32 v169, v173
  v_permlane32_swap_b32 v170, v174
  v_permlane32_swap_b32 v171, v175
  v_add_f32 v168, v168, v172
  v_add_f32 v169, v169, v173
  v_add_f32 v170, v170, v174
  v_add_f32 v171, v171, v175
  s_nop 0
  v_permlane16_swap_b32 v168, v170
  v_permlane16_swap_b32 v169, v171
  v_add_f32 v168, v168, v170
  v_add_f32 v169, v169, v171
  s_nop 0
  v_add_f32 v168, v168, v168 row_ror:8 row_mask:0xf bank_mask:0xf
  v_add_f32 v169, v169, v169 row_ror:8 row_mask:0xf bank_mask:0xf
  v_permlane32_swap_b32 v176, v180
  v_permlane32_swap_b32 v177, v181
  v_permlane32_swap_b32 v178, v182
  v_permlane32_swap_b32 v179, v183
  v_add_f32 v176, v176, v180
  v_add_f32 v177, v177, v181
  v_add_f32 v178, v178, v182
  v_add_f32 v179, v179, v183
  s_nop 0
  v_permlane16_swap_b32 v176, v178
  v_permlane16_swap_b32 v177, v179
  v_add_f32 v176, v176, v178
  v_add_f32 v177, v177, v179
  s_nop 0
  v_add_f32 v176, v176, v176 row_ror:8 row_mask:0xf bank_mask:0xf
  v_add_f32 v177, v177, v177 row_ror:8 row_mask:0xf bank_mask:0xf
  s_mov_b32 exec_lo, 0x00ff00ff
  s_mov_b32 exec_hi, 0x00ff00ff
  buffer_store_dwordx2 v[160:161], v21, s[4:7], s30 offen offset:0 sc1
  buffer_store_dwordx2 v[168:169], v21, s[4:7], s30 offen offset:256 sc1
  buffer_store_dwordx2 v[176:177], v21, s[4:7], s30 offen offset:512 sc1
  s_mov_b64 exec, -1
  s_mov_b32 s12, s58
  s_mov_b32 s13, s59
  s_mov_b32 s14, 0x100
  s_mov_b32 s15, 0x00020000
  s_mov_b32 s38, 0
  s_mov_b64 exec, 1
.g2_kernel_gt10:
  buffer_load_dword v6, v4, s[12:15], 0 offen sc1
  s_add_u32 s38, s38, 1
  s_waitcnt vmcnt(0)
  v_cmp_eq_u32 vcc, 0x60, v6
  s_cbranch_vccnz .g2_kernel_gt10d
  s_sleep 8
  s_cmp_lt_u32 s38, 131072
  s_cbranch_scc1 .g2_kernel_gt10
.g2_kernel_gt10d:
  s_mov_b64 exec, -1
  v_mov_b32 v6, s70
  s_mov_b64 exec, 1
  buffer_store_dword v6, v4, s[4:7], s76 offen offset:4 sc1
  s_mov_b64 exec, -1
  v_mov_b32 v6, 155648
  s_mov_b32 s38, 0
.g2_kernel_wg11:
  ds_read_b32 v7, v6 offset:512
  s_add_u32 s38, s38, 1
  s_waitcnt lgkmcnt(0)
  v_cmp_le_u32 vcc, 27, v7
  s_cbranch_vccnz .g2_kernel_wg11d
  s_sleep 4
  s_cmp_lt_u32 s38, 524288
  s_cbranch_scc1 .g2_kernel_wg11
.g2_kernel_wg11d:
  s_and_b32 s31, s76, 0xffffe000
  s_add_u32 s31, s31, 4
  v_and_b32 v6, 15, v2
  v_lshlrev_b32 v6, 9, v6
  v_lshrrev_b32 v7, 4, v2
  v_lshl_add_u32 v6, v7, 7, v6
  v_lshlrev_b32 v7, 2, v2
  v_add_u32 v7, 157696, v7
  s_mov_b32 m0, 157696
  s_mov_b32 s38, 0
  s_bfm_b64 exec, 16, 0
.g2_kernel_pa12:
  buffer_load_dword v6, s[4:7], s31 offen sc1 lds
  s_add_u32 s38, s38, 1
  s_waitcnt vmcnt(0)
  ds_read_b32 v8, v7
  s_waitcnt lgkmcnt(0)
  v_cmp_ge_u32 vcc, s62, v8
  s_cbranch_vccz .g2_kernel_pa12d
  s_mov_b64 exec, vcc
  s_sleep 16
  s_cmp_lt_u32 s38, 131072
  s_cbranch_scc1 .g2_kernel_pa12
.g2_kernel_pa12d:
  s_mov_b64 exec, -1
  s_mul_i32 s30, s18, 12288
  s_add_u32 s30, s30, 0x3080000
  s_mov_b32 exec_hi, 0xffff
  buffer_load_dwordx4 v[64:67], v3, s[4:7], s30 offen offset:0 sc1
  buffer_load_dwordx4 v[68:71], v3, s[4:7], s30 offen offset:768 sc1
  buffer_load_dwordx4 v[72:75], v3, s[4:7], s30 offen offset:1536 sc1
  buffer_load_dwordx4 v[76:79], v3, s[4:7], s30 offen offset:2304 sc1
  s_add_u32 s30, s30, 3072
  buffer_load_dwordx4 v[80:83], v3, s[4:7], s30 offen offset:0 sc1
  buffer_load_dwordx4 v[84:87], v3, s[4:7], s30 offen offset:768 sc1
  buffer_load_dwordx4 v[88:91], v3, s[4:7], s30 offen offset:1536 sc1
  buffer_load_dwordx4 v[92:95], v3, s[4:7], s30 offen offset:2304 sc1
  s_add_u32 s30, s30, 3072
  buffer_load_dwordx4 v[96:99], v3, s[4:7], s30 offen offset:0 sc1
  buffer_load_dwordx4 v[100:103], v3, s[4:7], s30 offen offset:768 sc1
  buffer_load_dwordx4 v[104:107], v3, s[4:7], s30 offen offset:1536 sc1
  buffer_load_dwordx4 v[108:111], v3, s[4:7], s30 offen offset:2304 sc1
  s_add_u32 s30, s30, 3072
  buffer_load_dwordx4 v[112:115], v3, s[4:7], s30 offen offset:0 sc1
  buffer_load_dwordx4 v[116:119], v3, s[4:7], s30 offen offset:768 sc1
  buffer_load_dwordx4 v[120:123], v3, s[4:7], s30 offen offset:1536 sc1
  buffer_load_dwordx4 v[124:127], v3, s[4:7], s30 offen offset:2304 sc1
  s_add_u32 s30, s30, 3072
  s_waitcnt vmcnt(14)
  v_add_f32 v64, v64, v68
  v_add_f32 v65, v65, v69
  v_add_f32 v66, v66, v70
  v_add_f32 v67, v67, v71
  s_waitcnt vmcnt(13)
  v_add_f32 v64, v64, v72
  v_add_f32 v65, v65, v73
  v_add_f32 v66, v66, v74
  v_add_f32 v67, v67, v75
  s_waitcnt vmcnt(12)
  v_add_f32 v64, v64, v76
  v_add_f32 v65, v65, v77
  v_add_f32 v66, v66, v78
  v_add_f32 v67, v67, v79
  s_waitcnt vmcnt(11)
  v_add_f32 v64, v64, v80
  v_add_f32 v65, v65, v81
  v_add_f32 v66, v66, v82
  v_add_f32 v67, v67, v83
  s_waitcnt vmcnt(10)
  v_add_f32 v64, v64, v84
  v_add_f32 v65, v65, v85
  v_add_f32 v66, v66, v86
  v_add_f32 v67, v67, v87
  s_waitcnt vmcnt(9)
  v_add_f32 v64, v64, v88
  v_add_f32 v65, v65, v89
  v_add_f32 v66, v66, v90
  v_add_f32 v67, v67, v91
  s_waitcnt vmcnt(8)
  v_add_f32 v64, v64, v92
  v_add_f32 v65, v65, v93
  v_add_f32 v66, v66, v94
  v_add_f32 v67, v67, v95
  s_waitcnt vmcnt(7)
  v_add_f32 v64, v64, v96
  v_add_f32 v65, v65, v97
  v_add_f32 v66, v66, v98
  v_add_f32 v67, v67, v99
  s_waitcnt vmcnt(6)
  v_add_f32 v64, v64, v100
  v_add_f32 v65, v65, v101
  v_add_f32 v66, v66, v102
  v_add_f32 v67, v67, v103
  s_waitcnt vmcnt(5)
  v_add_f32 v64, v64, v104
  v_add_f32 v65, v65, v105
  v_add_f32 v66, v66, v106
  v_add_f32 v67, v67, v107
  s_waitcnt vmcnt(4)
  v_add_f32 v64, v64, v108
  v_add_f32 v65, v65, v109
  v_add_f32 v66, v66, v110
  v_add_f32 v67, v67, v111
  s_waitcnt vmcnt(3)
  v_add_f32 v64, v64, v112
  v_add_f32 v65, v65, v113
  v_add_f32 v66, v66, v114
  v_add_f32 v67, v67, v115
  s_waitcnt vmcnt(2)
  v_add_f32 v64, v64, v116
  v_add_f32 v65, v65, v117
  v_add_f32 v66, v66, v118
  v_add_f32 v67, v67, v119
  s_waitcnt vmcnt(1)
  v_add_f32 v64, v64, v120
  v_add_f32 v65, v65, v121
  v_add_f32 v66, v66, v122
  v_add_f32 v67, v67, v123
  s_waitcnt vmcnt(0)
  v_add_f32 v64, v64, v124
  v_add_f32 v65, v65, v125
  v_add_f32 v66, v66, v126
  v_add_f32 v67, v67, v127
  s_mov_b64 exec, -1
  v_mov_b32 v6, 155648
  s_mov_b32 s38, 0
.g2_kernel_wg13:
  ds_read_b32 v7, v6 offset:512
  s_add_u32 s38, s38, 1
  s_waitcnt lgkmcnt(0)
  v_cmp_le_u32 vcc, 32, v7
  s_cbranch_vccnz .g2_kernel_wg13d
  s_sleep 2
  s_cmp_lt_u32 s38, 524288
  s_cbranch_scc1 .g2_kernel_wg13
.g2_kernel_wg13d:
  v_lshlrev_b32 v24, 2, v2
  v_add_u32 v24, 155648, v24
  ds_write_b32 v24, v4 offset:2048
  v_add_u32 v24, 155648, v3
  s_mov_b32 exec_hi, 0xffff
  ds_write_b128 v24, v[64:67] offset:4864
  s_mov_b64 exec, -1
  v_mov_b32 v6, s71
  s_mov_b64 exec, 1
  ds_add_u32 v6, v5 offset:0
  s_mov_b64 exec, -1
  s_branch .g2_kernel_v
.g2_kernel_s3:
  s_mov_b32 s12, s58
  s_mov_b32 s13, s59
  s_mov_b32 s14, 0x100
  s_mov_b32 s15, 0x00020000
  s_mov_b32 s20, s48
  s_mov_b32 s21, s49
  s_mov_b32 s22, 0x800
  s_mov_b32 s23, 0x00020000
  v_mov_b32 v12, 0
  v_mov_b32 v13, 0
  v_mov_b32 v14, 0
  v_mov_b32 v15, 0
  s_cmp_ge_u32 s2, 96
  s_cbranch_scc1 .g2_kernel_zm14
  s_lshl_b32 s36, s2, 12
  s_add_u32 s36, s36, 0x3000000
  buffer_store_dwordx4 v[12:15], v3, s[4:7], s36 offen sc1
  buffer_store_dwordx4 v[12:15], v3, s[4:7], s36 offen offset:1024 sc1
  buffer_store_dwordx4 v[12:15], v3, s[4:7], s36 offen offset:2048 sc1
  buffer_store_dwordx4 v[12:15], v3, s[4:7], s36 offen offset:3072 sc1
.g2_kernel_zm14:
  s_barrier
  s_cbranch_scc1 .g2_kernel_zm14b
  s_mov_b64 exec, 1
  s_waitcnt vmcnt(0)
  buffer_atomic_add v5, v4, s[12:15], 0 offen sc1
  s_mov_b64 exec, -1
.g2_kernel_zm14b:
  s_and_b32 s36, s18, 7
  s_cmp_ge_u32 s36, 3
  s_cbranch_scc1 .g2_kernel_c315
  s_mov_b32 s24, s42
  s_mov_b32 s25, s43
  s_mov_b32 s26, 0x600000
  s_mov_b32 s27, 0x00020000
  v_mul_u32_u24 v7, 6144, v2
  s_lshl_b32 s36, s36, 11
  s_or_b32 s37, s18, 3
  s_lshl_b32 s37, s37, 7
  s_add_u32 s36, s36, s37
  s_and_b32 s37, s17, 7
  s_mul_i32 s37, s37, 393216
  s_add_u32 s36, s36, s37
  s_add_u32 s37, s36, 3145728
  s_sleep 0
  buffer_load_dword v1, v7, s[24:27], s36 offen
  s_sleep 30
  buffer_load_dword v1, v7, s[24:27], s37 offen
.g2_kernel_c315:
  v_lshlrev_b32 v20, 5, v2
  buffer_load_dwordx4 v[24:27], v20, s[20:23], 0 offen
  buffer_load_dwordx4 v[28:31], v20, s[20:23], 0 offen offset:16
  v_mov_b32 v20, 0
  s_waitcnt vmcnt(0)
  v_lshlrev_b32 v21, 16, v24
  v_and_b32 v22, 0xffff0000, v24
  v_add_f32 v20, v20, v21
  v_add_f32 v20, v20, v22
  v_lshlrev_b32 v21, 16, v25
  v_and_b32 v22, 0xffff0000, v25
  v_add_f32 v20, v20, v21
  v_add_f32 v20, v20, v22
  v_lshlrev_b32 v21, 16, v26
  v_and_b32 v22, 0xffff0000, v26
  v_add_f32 v20, v20, v21
  v_add_f32 v20, v20, v22
  v_lshlrev_b32 v21, 16, v27
  v_and_b32 v22, 0xffff0000, v27
  v_add_f32 v20, v20, v21
  v_add_f32 v20, v20, v22
  v_lshlrev_b32 v21, 16, v28
  v_and_b32 v22, 0xffff0000, v28
  v_add_f32 v20, v20, v21
  v_add_f32 v20, v20, v22
  v_lshlrev_b32 v21, 16, v29
  v_and_b32 v22, 0xffff0000, v29
  v_add_f32 v20, v20, v21
  v_add_f32 v20, v20, v22
  v_lshlrev_b32 v21, 16, v30
  v_and_b32 v22, 0xffff0000, v30
  v_add_f32 v20, v20, v21
  v_add_f32 v20, v20, v22
  v_lshlrev_b32 v21, 16, v31
  v_and_b32 v22, 0xffff0000, v31
  v_add_f32 v20, v20, v21
  v_add_f32 v20, v20, v22
  s_nop 1
  v_add_f32 v20, v20, v20 quad_perm:[1,0,3,2] row_mask:0xf bank_mask:0xf
  s_nop 1
  v_add_f32 v20, v20, v20 quad_perm:[2,3,0,1] row_mask:0xf bank_mask:0xf
  s_nop 1
  v_add_f32 v20, v20, v20 row_half_mirror row_mask:0xf bank_mask:0xf
  s_nop 1
  v_add_f32 v20, v20, v20 row_mirror row_mask:0xf bank_mask:0xf
  s_nop 0
  v_readlane_b32 s20, v20, 16
  v_readlane_b32 s21, v20, 32
  v_readlane_b32 s22, v20, 48
  v_add_f32 v20, s20, v20
  v_add_f32 v20, s21, v20
  v_add_f32 v20, s22, v20
  v_mul_f32 v20, 0x3a800000, v20
  v_mov_b32 v6, 155648
  s_mov_b32 s38, 0
.g2_kernel_wg16:
  ds_read_b32 v7, v6 offset:512
  s_add_u32 s38, s38, 1
  s_waitcnt lgkmcnt(0)
  v_cmp_le_u32 vcc, 32, v7
  s_cbranch_vccnz .g2_kernel_wg16d
  s_sleep 2
  s_cmp_lt_u32 s38, 524288
  s_cbranch_scc1 .g2_kernel_wg16
.g2_kernel_wg16d:
  v_mov_b32 v21, 155648
  s_mov_b64 exec, 1
  ds_write_b32 v21, v20 offset:256
  s_mov_b64 exec, -1
.g2_kernel_v:
  s_setprio 3
  s_cmp_lg_u32 s16, 4
  s_cbranch_scc1 .g2_kernel_v_1
  v_mov_b32 v6, s71
  s_mov_b32 s38, 0
.g2_kernel_wg17:
  ds_read_b32 v7, v6 offset:4
  s_add_u32 s38, s38, 1
  s_waitcnt lgkmcnt(0)
  v_cmp_le_u32 vcc, 4, v7
  s_cbranch_vccnz .g2_kernel_wg17d
  s_sleep 1
  s_cmp_lt_u32 s38, 524288
  s_cbranch_scc1 .g2_kernel_wg17
.g2_kernel_wg17d:
  s_sleep 2
  s_and_b32 s31, s76, 0xffffe000
  s_add_u32 s31, s31, 0
  v_and_b32 v6, 15, v2
  v_lshlrev_b32 v6, 9, v6
  v_lshrrev_b32 v7, 4, v2
  v_lshl_add_u32 v6, v7, 7, v6
  v_lshlrev_b32 v7, 2, v2
  v_add_u32 v7, 157440, v7
  s_mov_b32 m0, 157440
  s_mov_b32 s38, 0
  s_mov_b32 exec_lo, 0xffff
  s_mov_b32 exec_hi, 0xffff
.g2_kernel_pa18:
  buffer_load_dword v6, s[4:7], s31 offen sc1 lds
  s_add_u32 s38, s38, 1
  s_waitcnt vmcnt(0)
  ds_read_b32 v8, v7
  s_waitcnt lgkmcnt(0)
  v_cmp_ge_u32 vcc, s62, v8
  s_cbranch_vccz .g2_kernel_pa18d
  s_mov_b64 exec, vcc
  s_sleep 2
  s_cmp_lt_u32 s38, 131072
  s_cbranch_scc1 .g2_kernel_pa18
.g2_kernel_pa18d:
  s_mov_b64 exec, -1
  v_mov_b32 v6, s71
  s_mov_b64 exec, 1
  ds_add_u32 v6, v5 offset:80
  s_mov_b64 exec, -1
.g2_kernel_v_1:
  s_cmp_lt_u32 s16, 6
  s_cbranch_scc1 .g2_kernel_v_2
  v_mov_b32 v6, s71
  s_mov_b32 s38, 0
.g2_kernel_wg19:
  ds_read_b32 v7, v6 offset:4
  s_add_u32 s38, s38, 1
  s_waitcnt lgkmcnt(0)
  v_cmp_le_u32 vcc, 4, v7
  s_cbranch_vccnz .g2_kernel_wg19d
  s_sleep 4
  s_cmp_lt_u32 s38, 524288
  s_cbranch_scc1 .g2_kernel_wg19
.g2_kernel_wg19d:
  s_and_b32 s28, s16, 1
  s_lshl_b32 s30, s28, 13
  s_add_u32 s31, s30, 16384
  v_add_u32 v8, s31, v3
  ds_read_b32 v9, v6 offset:24
  ds_read_b128 v[16:19], v8 offset:0
  ds_read_b128 v[20:23], v8 offset:1024
  ds_read_b128 v[24:27], v8 offset:2048
  ds_read_b128 v[28:31], v8 offset:3072
  ds_read_b128 v[32:35], v8 offset:4096
  ds_read_b128 v[36:39], v8 offset:5120
  ds_read_b128 v[40:43], v8 offset:6144
  ds_read_b128 v[44:47], v8 offset:7168
  s_lshl_b32 s31, s18, 5
  s_add_u32 s31, s31, s17
  s_add_u32 s31, s31, 16
  s_lshl_b32 s31, s31, 14
  s_add_u32 s30, s30, s31
  s_add_u32 s30, s30, s63
  s_add_u32 s31, s30, 4096
  s_lshl_b32 s33, s28, 8
  s_add_u32 s33, s33, 128
  s_waitcnt lgkmcnt(0)
  v_readfirstlane_b32 s29, v9
  v_mov_b32 v6, s71
  s_mov_b64 exec, 1
  ds_add_u32 v6, v5 offset:8
  s_mov_b64 exec, -1
  s_sleep 40
  buffer_store_dwordx4 v[16:19], v3, s[4:7], s30 offen offset:0 sc1
  s_sleep 4
  buffer_store_dwordx4 v[20:23], v3, s[4:7], s30 offen offset:1024 sc1
  s_sleep 4
  buffer_store_dwordx4 v[24:27], v3, s[4:7], s30 offen offset:2048 sc1
  s_sleep 4
  buffer_store_dwordx4 v[28:31], v3, s[4:7], s30 offen offset:3072 sc1
  s_sleep 4
  buffer_store_dwordx4 v[32:35], v3, s[4:7], s31 offen offset:0 sc1
  s_sleep 4
  buffer_store_dwordx4 v[36:39], v3, s[4:7], s31 offen offset:1024 sc1
  s_sleep 4
  buffer_store_dwordx4 v[40:43], v3, s[4:7], s31 offen offset:2048 sc1
  s_sleep 4
  buffer_store_dwordx4 v[44:47], v3, s[4:7], s31 offen offset:3072 sc1
  s_sleep 4
  s_sub_u32 s29, s29, 1
  s_lshr_b32 s29, s29, 6
  s_waitcnt vmcnt(0)
  s_cmp_eq_u32 s29, s28
  s_cbranch_scc1 .g2_kernel_v_1h
  s_add_u32 s31, s76, s33
  v_mov_b32 v6, s70
  s_mov_b64 exec, 1
  buffer_store_dword v6, v4, s[4:7], s31 offen offset:0 sc1
  s_mov_b64 exec, -1
  s_branch .g2_kernel_v_2
.g2_kernel_v_1h:
  v_mov_b32 v6, s71
  s_mov_b64 exec, 1
  ds_add_u32 v6, v5 offset:56
  s_mov_b64 exec, -1
.g2_kernel_v_2:
  v_mov_b32 v6, s71
  s_mov_b32 s38, 0
.g2_kernel_wg20:
  ds_read_b32 v7, v6 offset:80
  s_add_u32 s38, s38, 1
  s_waitcnt lgkmcnt(0)
  v_cmp_le_u32 vcc, 1, v7
  s_cbranch_vccnz .g2_kernel_wg20d
  s_sleep 8
  s_cmp_lt_u32 s38, 524288
  s_cbranch_scc1 .g2_kernel_wg20
.g2_kernel_wg20d:
  s_sleep 20
  s_mov_b32 s39, 0
  v_mov_b32 v12, 0
  v_mov_b32 v13, 0
  v_mov_b32 v14, 0
  v_mov_b32 v15, 0
  s_lshl_b32 s30, s17, 2
  s_and_b32 s31, s16, 3
  s_add_u32 s30, s30, s31
  s_lshl_b32 s30, s30, 4
  s_add_u32 s30, s30, s18
  s_lshl_b32 s30, s30, 9
  s_add_u32 s30, s30, s63
  s_add_u32 s30, s30, 0x1000000
  s_mov_b32 exec_hi, 0
  s_sleep 6
  buffer_store_dwordx4 v[12:15], v3, s[4:7], s30 offen sc1
  s_mov_b64 exec, -1
  s_lshl_b32 s30, s17, 2
  s_add_u32 s30, s30, s31
  s_lshl_b32 s30, s30, 5
  s_add_u32 s30, s30, s18
  s_lshl_b32 s30, s30, 11
  s_add_u32 s30, s30, s63
  s_add_u32 s30, s30, 0x808000
  s_sleep 6
  buffer_store_dwordx4 v[12:15], v3, s[4:7], s30 offen sc1
  s_sleep 6
  buffer_store_dwordx4 v[12:15], v3, s[4:7], s30 offen offset:1024 sc1
  s_cmp_lg_u32 s62, 5
  s_cbranch_scc1 .g2_kernel_zs21k
  s_lshl_b32 s30, s18, 4
  s_add_u32 s30, s30, s17
  s_lshl_b32 s30, s30, 2
  s_add_u32 s30, s30, s31
  s_lshl_b32 s30, s30, 12
  s_add_u32 s30, s30, 0x2c00000
  s_sleep 6
  buffer_store_dwordx4 v[12:15], v3, s[4:7], s30 offen sc1
  s_sleep 6
  buffer_store_dwordx4 v[12:15], v3, s[4:7], s30 offen offset:1024 sc1
  s_sleep 6
  buffer_store_dwordx4 v[12:15], v3, s[4:7], s30 offen offset:2048 sc1
  s_sleep 6
  buffer_store_dwordx4 v[12:15], v3, s[4:7], s30 offen offset:3072 sc1
.g2_kernel_zs21k:
  s_lshl_b32 s30, s17, 4
  s_add_u32 s30, s30, s18
  s_cmp_gt_u32 s16, 5
  s_cbranch_scc1 .g2_kernel_zs21
  s_cmp_eq_u32 s16, 5
  s_cbranch_scc1 .g2_kernel_zs21a
  s_cmp_lg_u32 s62, 0
  s_cbranch_scc1 .g2_kernel_zs21
  s_lshl_b32 s30, s30, 12
  s_add_u32 s31, s30, 0x1090000
  s_sleep 6
  buffer_store_dwordx4 v[12:15], v3, s[4:7], s31 offen offset:0 sc1
  s_sleep 6
  buffer_store_dwordx4 v[12:15], v3, s[4:7], s31 offen offset:1024 sc1
  s_sleep 6
  buffer_store_dwordx4 v[12:15], v3, s[4:7], s31 offen offset:2048 sc1
  s_sleep 6
  buffer_store_dwordx4 v[12:15], v3, s[4:7], s31 offen offset:3072 sc1
  s_add_u32 s31, s30, 0x2890000
  s_sleep 6
  buffer_store_dwordx4 v[12:15], v3, s[4:7], s31 offen offset:0 sc1
  s_sleep 6
  buffer_store_dwordx4 v[12:15], v3, s[4:7], s31 offen offset:1024 sc1
  s_sleep 6
  buffer_store_dwordx4 v[12:15], v3, s[4:7], s31 offen offset:2048 sc1
  s_sleep 6
  buffer_store_dwordx4 v[12:15], v3, s[4:7], s31 offen offset:3072 sc1
  s_add_u32 s31, s30, 0x2b00000
  s_sleep 6
  buffer_store_dwordx4 v[12:15], v3, s[4:7], s31 offen offset:0 sc1
  s_sleep 6
  buffer_store_dwordx4 v[12:15], v3, s[4:7], s31 offen offset:1024 sc1
  s_sleep 6
  buffer_store_dwordx4 v[12:15], v3, s[4:7], s31 offen offset:2048 sc1
  s_sleep 6
  buffer_store_dwordx4 v[12:15], v3, s[4:7], s31 offen offset:3072 sc1
  s_branch .g2_kernel_zs21
.g2_kernel_zs21a:
  s_lshl_b32 s30, s30, 6
  s_add_u32 s30, s30, s63
  s_add_u32 s30, s30, 0x1080000
  s_mov_b64 exec, 15
  s_sleep 6
  buffer_store_dwordx4 v[12:15], v3, s[4:7], s30 offen sc1
  s_mov_b64 exec, -1
  s_and_b32 s30, s18, 14
  s_lshl_b32 s30, s30, 4
  s_add_u32 s30, s30, s17
  s_lshl_b32 s30, s30, 1
  s_and_b32 s31, s18, 1
  s_add_u32 s30, s30, s31
  s_lshl_b32 s30, s30, 10
  s_add_u32 s30, s30, s63
  s_add_u32 s30, s30, 0x1190000
  s_add_u32 s31, s30, 32768
  s_sleep 6
  buffer_store_dwordx4 v[12:15], v3, s[4:7], s30 offen sc1
  s_sleep 6
  buffer_store_dwordx4 v[12:15], v3, s[4:7], s31 offen sc1
.g2_kernel_zs21:
  s_cmp_eq_u32 s16, 4
  s_cbranch_scc1 .g2_kernel_v_3a
  s_cmp_lg_u32 s62, 0
  s_cbranch_scc1 .g2_kernel_g_e
  s_and_b32 s22, s16, 3
  s_lshl_b32 s22, s22, 14
  s_add_u32 s22, s22, 65536
  v_bfe_u32 v8, v2, 2, 2
  v_lshrrev_b32 v9, 4, v2
  v_and_b32 v10, 3, v2
  v_lshlrev_b32 v10, 3, v10
  v_add_u32 v10, s22, v10
  s_cmp_eq_u32 s16, 5
  s_cbranch_scc1 .g2_kernel_g_p
  s_cmp_ge_u32 s17, 14
  s_cbranch_scc1 .g2_kernel_g_e
  v_lshrrev_b32 v6, 1, v2
  v_mul_u32_u24 v6, 7168, v6
  v_and_b32 v7, 1, v2
  v_lshl_add_u32 v250, v7, 4, v6
  v_lshl_add_u32 v11, v9, 3, v8
  v_lshl_add_u32 v251, v11, 5, v10
  v_and_b32 v11, 1, v9
  v_lshl_add_u32 v11, v11, 3, v8
  v_lshl_add_u32 v11, v11, 10, v10
  v_lshrrev_b32 v7, 1, v9
  v_lshl_add_u32 v252, v7, 7, v11
  s_lshl_b32 s24, s17, 4
  s_add_u32 s24, s24, s18
  s_and_b32 s25, s16, 1
  s_mov_b32 s12, s50
  s_mov_b32 s13, s51
  s_mov_b32 s14, 0x700000
  s_mov_b32 s15, 0x00020000
  s_mul_i32 s20, s25, 3670016
  s_lshl_b32 s31, s24, 5
  s_add_u32 s20, s20, s31
  s_lshl_b32 s31, s18, 2
  s_mov_b32 s23, s31
  s_mov_b32 s21, 16
.g2_kernel_gl23:
  s_and_b32 s30, s21, 3
  s_cbranch_scc1 .g2_kernel_gl23m
  s_call_b64 s[26:27], .g2_kernel_v_may
.g2_kernel_gl23m:
  s_and_b32 s23, s23, 15
  s_lshl_b32 s30, s23, 10
  s_add_u32 s30, s30, 0
  s_add_u32 m0, s30, s22
  s_mul_i32 s30, s23, 229376
  s_add_u32 s30, s30, s20
  buffer_load_dwordx4 v250, s[12:15], s30 offen lds
  s_add_u32 s23, s23, 1
  s_sub_u32 s21, s21, 1
  s_sleep 3
  s_waitcnt vmcnt(2)
  s_cmp_lg_u32 s21, 0
  s_cbranch_scc1 .g2_kernel_gl23
  s_waitcnt vmcnt(0)
  ds_read_b64_tr_b16 v[64:65], v251 offset:0
  ds_read_b64_tr_b16 v[66:67], v251 offset:128
  ds_read_b64_tr_b16 v[68:69], v251 offset:1024
  ds_read_b64_tr_b16 v[70:71], v251 offset:1152
  ds_read_b64_tr_b16 v[72:73], v251 offset:2048
  ds_read_b64_tr_b16 v[74:75], v251 offset:2176
  ds_read_b64_tr_b16 v[76:77], v251 offset:3072
  ds_read_b64_tr_b16 v[78:79], v251 offset:3200
  ds_read_b64_tr_b16 v[80:81], v251 offset:4096
  ds_read_b64_tr_b16 v[82:83], v251 offset:4224
  ds_read_b64_tr_b16 v[84:85], v251 offset:5120
  ds_read_b64_tr_b16 v[86:87], v251 offset:5248
  ds_read_b64_tr_b16 v[88:89], v251 offset:6144
  ds_read_b64_tr_b16 v[90:91], v251 offset:6272
  ds_read_b64_tr_b16 v[92:93], v251 offset:7168
  ds_read_b64_tr_b16 v[94:95], v251 offset:7296
  ds_read_b64_tr_b16 v[96:97], v251 offset:8192
  ds_read_b64_tr_b16 v[98:99], v251 offset:8320
  ds_read_b64_tr_b16 v[100:101], v251 offset:9216
  ds_read_b64_tr_b16 v[102:103], v251 offset:9344
  ds_read_b64_tr_b16 v[104:105], v251 offset:10240
  ds_read_b64_tr_b16 v[106:107], v251 offset:10368
  ds_read_b64_tr_b16 v[108:109], v251 offset:11264
  ds_read_b64_tr_b16 v[110:111], v251 offset:11392
  ds_read_b64_tr_b16 v[112:113], v251 offset:12288
  ds_read_b64_tr_b16 v[114:115], v251 offset:12416
  ds_read_b64_tr_b16 v[116:117], v251 offset:13312
  ds_read_b64_tr_b16 v[118:119], v251 offset:13440
  ds_read_b64_tr_b16 v[120:121], v251 offset:14336
  ds_read_b64_tr_b16 v[122:123], v251 offset:14464
  ds_read_b64_tr_b16 v[124:125], v251 offset:15360
  ds_read_b64_tr_b16 v[126:127], v251 offset:15488
  s_waitcnt lgkmcnt(0)
  s_mov_b32 s12, s52
  s_mov_b32 s13, s53
  s_mov_b32 s14, 0x700000
  s_mov_b32 s15, 0x00020000
  s_mul_i32 s20, s25, 3670016
  s_lshl_b32 s31, s24, 5
  s_add_u32 s20, s20, s31
  s_lshl_b32 s31, s18, 2
  s_mov_b32 s23, s31
  s_mov_b32 s21, 16
.g2_kernel_gl24:
  s_and_b32 s30, s21, 3
  s_cbranch_scc1 .g2_kernel_gl24m
  s_call_b64 s[26:27], .g2_kernel_v_may
.g2_kernel_gl24m:
  s_and_b32 s23, s23, 15
  s_lshl_b32 s30, s23, 10
  s_add_u32 s30, s30, 0
  s_add_u32 m0, s30, s22
  s_mul_i32 s30, s23, 229376
  s_add_u32 s30, s30, s20
  buffer_load_dwordx4 v250, s[12:15], s30 offen lds
  s_add_u32 s23, s23, 1
  s_sub_u32 s21, s21, 1
  s_sleep 3
  s_waitcnt vmcnt(2)
  s_cmp_lg_u32 s21, 0
  s_cbranch_scc1 .g2_kernel_gl24
  s_waitcnt vmcnt(0)
  ds_read_b64_tr_b16 v[128:129], v251 offset:0
  ds_read_b64_tr_b16 v[130:131], v251 offset:128
  ds_read_b64_tr_b16 v[132:133], v251 offset:1024
  ds_read_b64_tr_b16 v[134:135], v251 offset:1152
  ds_read_b64_tr_b16 v[136:137], v251 offset:2048
  ds_read_b64_tr_b16 v[138:139], v251 offset:2176
  ds_read_b64_tr_b16 v[140:141], v251 offset:3072
  ds_read_b64_tr_b16 v[142:143], v251 offset:3200
  ds_read_b64_tr_b16 v[144:145], v251 offset:4096
  ds_read_b64_tr_b16 v[146:147], v251 offset:4224
  ds_read_b64_tr_b16 v[148:149], v251 offset:5120
  ds_read_b64_tr_b16 v[150:151], v251 offset:5248
  ds_read_b64_tr_b16 v[152:153], v251 offset:6144
  ds_read_b64_tr_b16 v[154:155], v251 offset:6272
  ds_read_b64_tr_b16 v[156:157], v251 offset:7168
  ds_read_b64_tr_b16 v[158:159], v251 offset:7296
  ds_read_b64_tr_b16 v[160:161], v251 offset:8192
  ds_read_b64_tr_b16 v[162:163], v251 offset:8320
  ds_read_b64_tr_b16 v[164:165], v251 offset:9216
  ds_read_b64_tr_b16 v[166:167], v251 offset:9344
  ds_read_b64_tr_b16 v[168:169], v251 offset:10240
  ds_read_b64_tr_b16 v[170:171], v251 offset:10368
  ds_read_b64_tr_b16 v[172:173], v251 offset:11264
  ds_read_b64_tr_b16 v[174:175], v251 offset:11392
  ds_read_b64_tr_b16 v[176:177], v251 offset:12288
  ds_read_b64_tr_b16 v[178:179], v251 offset:12416
  ds_read_b64_tr_b16 v[180:181], v251 offset:13312
  ds_read_b64_tr_b16 v[182:183], v251 offset:13440
  ds_read_b64_tr_b16 v[184:185], v251 offset:14336
  ds_read_b64_tr_b16 v[186:187], v251 offset:14464
  ds_read_b64_tr_b16 v[188:189], v251 offset:15360
  ds_read_b64_tr_b16 v[190:191], v251 offset:15488
  s_waitcnt lgkmcnt(0)
  s_mov_b32 s12, s54
  s_mov_b32 s13, s55
  s_mov_b32 s14, 0x700000
  s_mov_b32 s15, 0x00020000
  s_lshl_b32 s20, s24, 15
  s_lshl_b32 s31, s25, 10
  s_add_u32 s20, s20, s31
  s_mov_b32 s23, 0
  s_mov_b32 s21, 16
.g2_kernel_gl25:
  s_and_b32 s30, s21, 3
  s_cbranch_scc1 .g2_kernel_gl25m
  s_call_b64 s[26:27], .g2_kernel_v_may
.g2_kernel_gl25m:
  s_and_b32 s23, s23, 15
  s_lshl_b32 s30, s23, 10
  s_add_u32 s30, s30, 0
  s_add_u32 m0, s30, s22
  s_mul_i32 s30, s23, 2048
  s_add_u32 s30, s30, s20
  buffer_load_dwordx4 v3, s[12:15], s30 offen lds
  s_add_u32 s23, s23, 1
  s_sub_u32 s21, s21, 1
  s_sleep 2
  s_waitcnt vmcnt(2)
  s_cmp_lg_u32 s21, 0
  s_cbranch_scc1 .g2_kernel_gl25
  v_mov_b32 v11, v252
  s_waitcnt vmcnt(0)
  ds_read_b64_tr_b16 v[192:193], v11 offset:0
  ds_read_b64_tr_b16 v[194:195], v11 offset:4096
  ds_read_b64_tr_b16 v[196:197], v11 offset:32
  ds_read_b64_tr_b16 v[198:199], v11 offset:4128
  ds_read_b64_tr_b16 v[200:201], v11 offset:64
  ds_read_b64_tr_b16 v[202:203], v11 offset:4160
  ds_read_b64_tr_b16 v[204:205], v11 offset:96
  ds_read_b64_tr_b16 v[206:207], v11 offset:4192
  ds_read_b64_tr_b16 v[208:209], v11 offset:256
  ds_read_b64_tr_b16 v[210:211], v11 offset:4352
  ds_read_b64_tr_b16 v[212:213], v11 offset:288
  ds_read_b64_tr_b16 v[214:215], v11 offset:4384
  ds_read_b64_tr_b16 v[216:217], v11 offset:320
  ds_read_b64_tr_b16 v[218:219], v11 offset:4416
  ds_read_b64_tr_b16 v[220:221], v11 offset:352
  ds_read_b64_tr_b16 v[222:223], v11 offset:4448
  ds_read_b64_tr_b16 v[224:225], v11 offset:512
  ds_read_b64_tr_b16 v[226:227], v11 offset:4608
  ds_read_b64_tr_b16 v[228:229], v11 offset:544
  ds_read_b64_tr_b16 v[230:231], v11 offset:4640
  ds_read_b64_tr_b16 v[232:233], v11 offset:576
  ds_read_b64_tr_b16 v[234:235], v11 offset:4672
  ds_read_b64_tr_b16 v[236:237], v11 offset:608
  ds_read_b64_tr_b16 v[238:239], v11 offset:4704
  ds_read_b64_tr_b16 v[240:241], v11 offset:768
  ds_read_b64_tr_b16 v[242:243], v11 offset:4864
  ds_read_b64_tr_b16 v[244:245], v11 offset:800
  ds_read_b64_tr_b16 v[246:247], v11 offset:4896
  ds_read_b64_tr_b16 v[248:249], v11 offset:832
  ds_read_b64_tr_b16 v[250:251], v11 offset:4928
  ds_read_b64_tr_b16 v[252:253], v11 offset:864
  ds_read_b64_tr_b16 v[254:255], v11 offset:4960
  s_waitcnt lgkmcnt(0)
  s_branch .g2_kernel_g_e
.g2_kernel_g_p:
  s_mov_b32 s12, s42
  s_mov_b32 s13, s43
  s_mov_b32 s14, 0x600000
  s_mov_b32 s15, 0x00020000
  v_mul_u32_u24 v6, 6144, v9
  v_and_b32 v7, 15, v2
  v_lshl_add_u32 v250, v7, 4, v6
  v_lshl_add_u32 v11, v8, 2, v9
  v_lshl_add_u32 v251, v11, 9, v10
  s_lshl_b32 s20, s17, 3
  s_and_b32 s31, s18, 1
  s_add_u32 s20, s20, s31
  s_mul_i32 s20, s20, 49152
  s_and_b32 s31, s18, 14
  s_lshl_b32 s31, s31, 7
  s_add_u32 s20, s20, s31
  s_mov_b32 s23, 0
  s_mov_b32 s21, 8
.g2_kernel_gl26:
  s_and_b32 s30, s21, 3
  s_cbranch_scc1 .g2_kernel_gl26m
  s_call_b64 s[26:27], .g2_kernel_v_may
.g2_kernel_gl26m:
  s_and_b32 s23, s23, 7
  s_lshl_b32 s30, s23, 10
  s_add_u32 s30, s30, 0
  s_add_u32 m0, s30, s22
  s_mul_i32 s30, s23, 49152
  s_add_u32 s30, s30, s20
  s_and_b32 s31, s23, 1
  s_mul_i32 s31, s31, -24576
  s_add_u32 s30, s30, s31
  buffer_load_dwordx4 v250, s[12:15], s30 offen lds
  s_add_u32 s23, s23, 1
  s_sub_u32 s21, s21, 1
  s_sleep 3
  s_waitcnt vmcnt(2)
  s_cmp_lg_u32 s21, 0
  s_cbranch_scc1 .g2_kernel_gl26
  s_add_u32 s20, s20, 2048
  s_mov_b32 s23, 0
  s_mov_b32 s21, 8
.g2_kernel_gl27:
  s_and_b32 s30, s21, 3
  s_cbranch_scc1 .g2_kernel_gl27m
  s_call_b64 s[26:27], .g2_kernel_v_may
.g2_kernel_gl27m:
  s_and_b32 s23, s23, 7
  s_lshl_b32 s30, s23, 10
  s_add_u32 s30, s30, 8192
  s_add_u32 m0, s30, s22
  s_mul_i32 s30, s23, 49152
  s_add_u32 s30, s30, s20
  s_and_b32 s31, s23, 1
  s_mul_i32 s31, s31, -24576
  s_add_u32 s30, s30, s31
  buffer_load_dwordx4 v250, s[12:15], s30 offen lds
  s_add_u32 s23, s23, 1
  s_sub_u32 s21, s21, 1
  s_sleep 3
  s_waitcnt vmcnt(2)
  s_cmp_lg_u32 s21, 0
  s_cbranch_scc1 .g2_kernel_gl27
  s_add_u32 s20, s20, 2048
  s_waitcnt vmcnt(0)
  ds_read_b64_tr_b16 v[64:65], v251 offset:0
  ds_read_b64_tr_b16 v[66:67], v251 offset:256
  ds_read_b64_tr_b16 v[68:69], v251 offset:32
  ds_read_b64_tr_b16 v[70:71], v251 offset:288
  ds_read_b64_tr_b16 v[72:73], v251 offset:64
  ds_read_b64_tr_b16 v[74:75], v251 offset:320
  ds_read_b64_tr_b16 v[76:77], v251 offset:96
  ds_read_b64_tr_b16 v[78:79], v251 offset:352
  ds_read_b64_tr_b16 v[80:81], v251 offset:128
  ds_read_b64_tr_b16 v[82:83], v251 offset:384
  ds_read_b64_tr_b16 v[84:85], v251 offset:160
  ds_read_b64_tr_b16 v[86:87], v251 offset:416
  ds_read_b64_tr_b16 v[88:89], v251 offset:192
  ds_read_b64_tr_b16 v[90:91], v251 offset:448
  ds_read_b64_tr_b16 v[92:93], v251 offset:224
  ds_read_b64_tr_b16 v[94:95], v251 offset:480
  ds_read_b64_tr_b16 v[96:97], v251 offset:8192
  ds_read_b64_tr_b16 v[98:99], v251 offset:8448
  ds_read_b64_tr_b16 v[100:101], v251 offset:8224
  ds_read_b64_tr_b16 v[102:103], v251 offset:8480
  ds_read_b64_tr_b16 v[104:105], v251 offset:8256
  ds_read_b64_tr_b16 v[106:107], v251 offset:8512
  ds_read_b64_tr_b16 v[108:109], v251 offset:8288
  ds_read_b64_tr_b16 v[110:111], v251 offset:8544
  ds_read_b64_tr_b16 v[112:113], v251 offset:8320
  ds_read_b64_tr_b16 v[114:115], v251 offset:8576
  ds_read_b64_tr_b16 v[116:117], v251 offset:8352
  ds_read_b64_tr_b16 v[118:119], v251 offset:8608
  ds_read_b64_tr_b16 v[120:121], v251 offset:8384
  ds_read_b64_tr_b16 v[122:123], v251 offset:8640
  ds_read_b64_tr_b16 v[124:125], v251 offset:8416
  ds_read_b64_tr_b16 v[126:127], v251 offset:8672
  s_waitcnt lgkmcnt(0)
  s_mov_b32 s23, 0
  s_mov_b32 s21, 8
.g2_kernel_gl28:
  s_and_b32 s30, s21, 3
  s_cbranch_scc1 .g2_kernel_gl28m
  s_call_b64 s[26:27], .g2_kernel_v_may
.g2_kernel_gl28m:
  s_and_b32 s23, s23, 7
  s_lshl_b32 s30, s23, 10
  s_add_u32 s30, s30, 0
  s_add_u32 m0, s30, s22
  s_mul_i32 s30, s23, 49152
  s_add_u32 s30, s30, s20
  s_and_b32 s31, s23, 1
  s_mul_i32 s31, s31, -24576
  s_add_u32 s30, s30, s31
  buffer_load_dwordx4 v250, s[12:15], s30 offen lds
  s_add_u32 s23, s23, 1
  s_sub_u32 s21, s21, 1
  s_sleep 3
  s_waitcnt vmcnt(2)
  s_cmp_lg_u32 s21, 0
  s_cbranch_scc1 .g2_kernel_gl28
  s_add_u32 s20, s20, 2048
  s_waitcnt vmcnt(0)
  ds_read_b64_tr_b16 v[128:129], v251 offset:0
  ds_read_b64_tr_b16 v[130:131], v251 offset:256
  ds_read_b64_tr_b16 v[132:133], v251 offset:32
  ds_read_b64_tr_b16 v[134:135], v251 offset:288
  ds_read_b64_tr_b16 v[136:137], v251 offset:64
  ds_read_b64_tr_b16 v[138:139], v251 offset:320
  ds_read_b64_tr_b16 v[140:141], v251 offset:96
  ds_read_b64_tr_b16 v[142:143], v251 offset:352
  ds_read_b64_tr_b16 v[144:145], v251 offset:128
  ds_read_b64_tr_b16 v[146:147], v251 offset:384
  ds_read_b64_tr_b16 v[148:149], v251 offset:160
  ds_read_b64_tr_b16 v[150:151], v251 offset:416
  ds_read_b64_tr_b16 v[152:153], v251 offset:192
  ds_read_b64_tr_b16 v[154:155], v251 offset:448
  ds_read_b64_tr_b16 v[156:157], v251 offset:224
  ds_read_b64_tr_b16 v[158:159], v251 offset:480
  s_waitcnt lgkmcnt(0)
.g2_kernel_g_e:
.g2_kernel_v_3:
  s_mov_b32 s29, 0
  s_and_b32 s30, s16, 3
  s_lshl_b32 s30, s30, 14
  s_add_u32 s30, s30, 65536
  s_call_b64 s[68:69], .g2_kernel_v_wo
  s_waitcnt vmcnt(0)
  v_mov_b32 v6, s71
  s_mov_b64 exec, 1
  ds_add_u32 v6, v5 offset:52
  s_mov_b64 exec, -1
  s_cmp_lg_u32 s39, 0
  s_cbranch_scc1 .g2_kernel_v_3b
  s_call_b64 s[26:27], .g2_kernel_v_do
.g2_kernel_v_3b:
  s_cmp_lg_u32 s16, 4
  s_cbranch_scc1 .g2_kernel_v_4
  v_mov_b32 v6, s71
  s_mov_b32 s38, 0
.g2_kernel_wg29:
  ds_read_b32 v7, v6 offset:8
  s_add_u32 s38, s38, 1
  s_waitcnt lgkmcnt(0)
  v_cmp_le_u32 vcc, 10, v7
  s_cbranch_vccnz .g2_kernel_wg29d
  s_sleep 8
  s_cmp_lt_u32 s38, 524288
  s_cbranch_scc1 .g2_kernel_wg29
.g2_kernel_wg29d:
  s_mov_b32 s29, 1
  s_mov_b32 s30, 139264
  s_call_b64 s[68:69], .g2_kernel_v_wo
  s_add_u32 s31, s31, 81920
  s_sleep 6
  s_waitcnt vmcnt(4)
  buffer_load_dwordx4 v[64:67], v6, s[8:11], s31 offen
  s_add_u32 s31, s31, 16384
  buffer_load_dwordx4 v[68:71], v6, s[8:11], s31 offen
  s_add_u32 s31, s31, 16384
  buffer_load_dwordx4 v[72:75], v6, s[8:11], s31 offen
  s_add_u32 s31, s31, 16384
  buffer_load_dwordx4 v[76:79], v6, s[8:11], s31 offen
  s_add_u32 s31, s31, 81920
  s_sleep 6
  s_waitcnt vmcnt(4)
  buffer_load_dwordx4 v[80:83], v6, s[8:11], s31 offen
  s_add_u32 s31, s31, 16384
  buffer_load_dwordx4 v[84:87], v6, s[8:11], s31 offen
  s_add_u32 s31, s31, 16384
  buffer_load_dwordx4 v[88:91], v6, s[8:11], s31 offen
  s_add_u32 s31, s31, 16384
  buffer_load_dwordx4 v[92:95], v6, s[8:11], s31 offen
  s_add_u32 s31, s31, 81920
  s_sleep 6
  s_waitcnt vmcnt(4)
  buffer_load_dwordx4 v[96:99], v6, s[8:11], s31 offen
  s_add_u32 s31, s31, 16384
  buffer_load_dwordx4 v[100:103], v6, s[8:11], s31 offen
  s_add_u32 s31, s31, 16384
  buffer_load_dwordx4 v[104:107], v6, s[8:11], s31 offen
  s_add_u32 s31, s31, 16384
  buffer_load_dwordx4 v[108:111], v6, s[8:11], s31 offen
  s_add_u32 s31, s31, 81920
  s_sleep 6
  s_waitcnt vmcnt(4)
  buffer_load_dwordx4 v[112:115], v6, s[8:11], s31 offen
  s_add_u32 s31, s31, 16384
  buffer_load_dwordx4 v[116:119], v6, s[8:11], s31 offen
  s_add_u32 s31, s31, 16384
  buffer_load_dwordx4 v[120:123], v6, s[8:11], s31 offen
  s_add_u32 s31, s31, 16384
  buffer_load_dwordx4 v[124:127], v6, s[8:11], s31 offen
  s_add_u32 s31, s31, 81920
  s_sleep 6
  s_waitcnt vmcnt(4)
  s_mov_b32 m0, 32768
  s_nop 0
  buffer_load_dwordx4 v6, s[8:11], s31 offen lds
  s_add_u32 s31, s31, 16384
  s_mov_b32 m0, 33792
  s_nop 0
  buffer_load_dwordx4 v6, s[8:11], s31 offen lds
  s_add_u32 s31, s31, 16384
  s_mov_b32 m0, 34816
  s_nop 0
  buffer_load_dwordx4 v6, s[8:11], s31 offen lds
  s_add_u32 s31, s31, 16384
  s_mov_b32 m0, 35840
  s_nop 0
  buffer_load_dwordx4 v6, s[8:11], s31 offen lds
  s_add_u32 s31, s31, 81920
  s_sleep 6
  s_waitcnt vmcnt(4)
  s_mov_b32 m0, 36864
  s_nop 0
  buffer_load_dwordx4 v6, s[8:11], s31 offen lds
  s_add_u32 s31, s31, 16384
  s_mov_b32 m0, 37888
  s_nop 0
  buffer_load_dwordx4 v6, s[8:11], s31 offen lds
  s_add_u32 s31, s31, 16384
  s_mov_b32 m0, 38912
  s_nop 0
  buffer_load_dwordx4 v6, s[8:11], s31 offen lds
  s_add_u32 s31, s31, 16384
  s_mov_b32 m0, 39936
  s_nop 0
  buffer_load_dwordx4 v6, s[8:11], s31 offen lds
  s_add_u32 s31, s31, 81920
  s_sleep 6
  s_waitcnt vmcnt(4)
  s_mov_b32 m0, 40960
  s_nop 0
  buffer_load_dwordx4 v6, s[8:11], s31 offen lds
  s_add_u32 s31, s31, 16384
  s_mov_b32 m0, 41984
  s_nop 0
  buffer_load_dwordx4 v6, s[8:11], s31 offen lds
  s_add_u32 s31, s31, 16384
  s_mov_b32 m0, 43008
  s_nop 0
  buffer_load_dwordx4 v6, s[8:11], s31 offen lds
  s_add_u32 s31, s31, 16384
  s_mov_b32 m0, 44032
  s_nop 0
  buffer_load_dwordx4 v6, s[8:11], s31 offen lds
  s_add_u32 s31, s31, 81920
  s_sleep 6
  s_waitcnt vmcnt(4)
  s_mov_b32 m0, 45056
  s_nop 0
  buffer_load_dwordx4 v6, s[8:11], s31 offen lds
  s_add_u32 s31, s31, 16384
  s_mov_b32 m0, 46080
  s_nop 0
  buffer_load_dwordx4 v6, s[8:11], s31 offen lds
  s_add_u32 s31, s31, 16384
  s_mov_b32 m0, 47104
  s_nop 0
  buffer_load_dwordx4 v6, s[8:11], s31 offen lds
  s_add_u32 s31, s31, 16384
  s_mov_b32 m0, 48128
  s_nop 0
  buffer_load_dwordx4 v6, s[8:11], s31 offen lds
  s_add_u32 s31, s31, 81920
  s_sleep 6
  s_waitcnt vmcnt(4)
  s_mov_b32 m0, 49152
  s_nop 0
  buffer_load_dwordx4 v6, s[8:11], s31 offen lds
  s_add_u32 s31, s31, 16384
  s_mov_b32 m0, 50176
  s_nop 0
  buffer_load_dwordx4 v6, s[8:11], s31 offen lds
  s_add_u32 s31, s31, 16384
  s_mov_b32 m0, 51200
  s_nop 0
  buffer_load_dwordx4 v6, s[8:11], s31 offen lds
  s_add_u32 s31, s31, 16384
  s_mov_b32 m0, 52224
  s_nop 0
  buffer_load_dwordx4 v6, s[8:11], s31 offen lds
  s_add_u32 s31, s31, 81920
  s_sleep 6
  s_waitcnt vmcnt(4)
  s_mov_b32 m0, 53248
  s_nop 0
  buffer_load_dwordx4 v6, s[8:11], s31 offen lds
  s_add_u32 s31, s31, 16384
  s_mov_b32 m0, 54272
  s_nop 0
  buffer_load_dwordx4 v6, s[8:11], s31 offen lds
  s_add_u32 s31, s31, 16384
  s_mov_b32 m0, 55296
  s_nop 0
  buffer_load_dwordx4 v6, s[8:11], s31 offen lds
  s_add_u32 s31, s31, 16384
  s_mov_b32 m0, 56320
  s_nop 0
  buffer_load_dwordx4 v6, s[8:11], s31 offen lds
  s_add_u32 s31, s31, 81920
  s_sleep 6
  s_waitcnt vmcnt(4)
  s_mov_b32 m0, 57344
  s_nop 0
  buffer_load_dwordx4 v6, s[8:11], s31 offen lds
  s_add_u32 s31, s31, 16384
  s_mov_b32 m0, 58368
  s_nop 0
  buffer_load_dwordx4 v6, s[8:11], s31 offen lds
  s_add_u32 s31, s31, 16384
  s_mov_b32 m0, 59392
  s_nop 0
  buffer_load_dwordx4 v6, s[8:11], s31 offen lds
  s_add_u32 s31, s31, 16384
  s_mov_b32 m0, 60416
  s_nop 0
  buffer_load_dwordx4 v6, s[8:11], s31 offen lds
  s_add_u32 s31, s31, 81920
  s_sleep 6
  s_waitcnt vmcnt(4)
  s_mov_b32 m0, 61440
  s_nop 0
  buffer_load_dwordx4 v6, s[8:11], s31 offen lds
  s_add_u32 s31, s31, 16384
  s_mov_b32 m0, 62464
  s_nop 0
  buffer_load_dwordx4 v6, s[8:11], s31 offen lds
  s_add_u32 s31, s31, 16384
  s_mov_b32 m0, 63488
  s_nop 0
  buffer_load_dwordx4 v6, s[8:11], s31 offen lds
  s_add_u32 s31, s31, 16384
  s_mov_b32 m0, 64512
  s_nop 0
  buffer_load_dwordx4 v6, s[8:11], s31 offen lds
.g2_kernel_v_4:
  s_cmp_lg_u32 s16, 5
  s_cbranch_scc1 .g2_kernel_v_5
  s_sleep 64
  s_and_b32 s31, s19, 0xffffe000
  s_add_u32 s31, s31, 0
  v_and_b32 v6, 15, v2
  v_lshlrev_b32 v6, 9, v6
  v_lshrrev_b32 v7, 4, v2
  v_lshl_add_u32 v6, v7, 7, v6
  v_lshlrev_b32 v7, 2, v2
  v_add_u32 v7, 157696, v7
  s_mov_b32 m0, 157696
  s_mov_b32 s38, 0
.g2_kernel_pa30:
  buffer_load_dword v6, s[4:7], s31 offen sc1 lds
  s_add_u32 s38, s38, 1
  s_waitcnt vmcnt(0)
  ds_read_b32 v8, v7
  s_waitcnt lgkmcnt(0)
  v_cmp_ge_u32 vcc, s62, v8
  s_cbranch_vccz .g2_kernel_pa30d
  s_mov_b64 exec, vcc
  s_sleep 32
  s_cmp_lt_u32 s38, 131072
  s_cbranch_scc1 .g2_kernel_pa30
.g2_kernel_pa30d:
  s_mov_b64 exec, -1
  v_lshlrev_b32 v6, 7, v2
  s_lshl_b32 s30, s17, 2
  s_and_b32 s31, s18, 3
  s_add_u32 s30, s30, s31
  s_lshl_b32 s30, s30, 16
  s_add_u32 s30, s30, s63
  s_add_u32 s30, s30, 0x800000
  s_sleep 8
  buffer_load_dword v1, v6, s[4:7], s30 offen
  s_add_u32 s30, s30, 8192
  s_sleep 8
  buffer_load_dword v1, v6, s[4:7], s30 offen
  s_add_u32 s30, s30, 8192
  s_sleep 8
  buffer_load_dword v1, v6, s[4:7], s30 offen
  s_add_u32 s30, s30, 8192
  s_sleep 8
  buffer_load_dword v1, v6, s[4:7], s30 offen
  s_add_u32 s30, s30, 8192
  s_lshl_b32 s28, s2, 10
  s_and_b32 s28, s28, 0xe000
  v_lshlrev_b32 v7, 7, v2
  buffer_load_dword v1, v7, s[64:67], s28 offen
  s_and_b32 s31, s19, 0xffffe000
  s_add_u32 s31, s31, 4
  v_and_b32 v7, 15, v2
  v_lshlrev_b32 v7, 9, v7
  v_lshrrev_b32 v9, 4, v2
  v_lshl_add_u32 v7, v9, 7, v7
  s_and_b32 s33, s18, 3
  s_lshl_b32 s33, s33, 6
  s_add_u32 s33, s33, 157952
  v_lshl_add_u32 v9, v9, 2, s33
  v_lshlrev_b32 v10, 2, v2
  v_add_u32 v10, 157952, v10
  v_mov_b32 v11, 155968
  s_lshl_b32 s33, s62, 1
  s_add_u32 s33, s33, 1
  s_mov_b32 m0, 157952
  s_mov_b64 s[8:9], -1
  s_mov_b64 s[10:11], -1
  s_mov_b64 s[12:13], -1
  s_mov_b64 s[14:15], -1
  s_mov_b64 s[20:21], -1
  s_add_u32 s34, s30, 8192
  s_add_u32 s35, s30, 16384
  s_add_u32 s36, s30, 24576
  s_mov_b32 s38, 0
  s_sleep 8
.g2_kernel_bp31:
  s_mov_b64 exec, s[20:21]
  buffer_load_dword v7, s[4:7], s31 offen sc1 lds
  s_mov_b64 exec, -1
  s_add_u32 s38, s38, 1
  s_waitcnt vmcnt(0)
  ds_read_b32 v12, v10
  ds_read_b32 v13, v9
  ds_read_b32 v14, v9 offset:16
  ds_read_b32 v15, v9 offset:32
  ds_read_b32 v16, v9 offset:48
  s_waitcnt lgkmcnt(0)
  v_cmp_ge_u32 s[20:21], s62, v12
  v_cmp_lt_u32 vcc, s62, v13
  s_and_b64 exec, vcc, s[8:9]
  s_cbranch_scc0 .g2_kernel_bp31n0
  s_andn2_b64 s[8:9], s[8:9], vcc
  buffer_load_dword v1, v6, s[4:7], s30 offen
.g2_kernel_bp31n0:
  s_mov_b64 exec, -1
  v_cmp_lt_u32 vcc, s62, v14
  s_and_b64 exec, vcc, s[10:11]
  s_cbranch_scc0 .g2_kernel_bp31n1
  s_andn2_b64 s[10:11], s[10:11], vcc
  buffer_load_dword v1, v6, s[4:7], s34 offen
.g2_kernel_bp31n1:
  s_mov_b64 exec, -1
  v_cmp_lt_u32 vcc, s62, v15
  s_and_b64 exec, vcc, s[12:13]
  s_cbranch_scc0 .g2_kernel_bp31n2
  s_andn2_b64 s[12:13], s[12:13], vcc
  buffer_load_dword v1, v6, s[4:7], s35 offen
.g2_kernel_bp31n2:
  s_mov_b64 exec, -1
  v_cmp_lt_u32 vcc, s62, v16
  s_and_b64 exec, vcc, s[14:15]
  s_cbranch_scc0 .g2_kernel_bp31n3
  s_andn2_b64 s[14:15], s[14:15], vcc
  buffer_load_dword v1, v6, s[4:7], s36 offen
.g2_kernel_bp31n3:
  s_mov_b64 exec, -1
  s_sleep 10
  ds_read_b32 v12, v11
  s_waitcnt lgkmcnt(0)
  v_cmp_lt_u32 vcc, s33, v12
  s_cbranch_vccnz .g2_kernel_bp31d
  s_cmp_lt_u32 s38, 131072
  s_cbranch_scc1 .g2_kernel_bp31
.g2_kernel_bp31d:
.g2_kernel_v_5:
  s_mov_b32 s29, 1
  s_call_b64 s[68:69], .g2_kernel_v_cmb
  s_and_b32 s33, s16, 3
  s_lshl_b32 s33, s33, 7
  s_lshl_b32 s28, s29, 2
  s_add_u32 s33, s33, s28
  s_add_u32 s31, s19, s33
  v_mov_b32 v6, s70
  s_mov_b64 exec, 1
  buffer_store_dword v6, v4, s[4:7], s31 offen offset:0 sc1
  s_mov_b64 exec, -1
  s_cmp_lg_u32 s16, 4
  s_cbranch_scc1 .g2_kernel_v_8
  s_waitcnt vmcnt(3)
  v_mov_b32 v6, s71
  s_mov_b32 s38, 0
.g2_kernel_wg32:
  ds_read_b32 v7, v6 offset:76
  s_add_u32 s38, s38, 1
  s_waitcnt lgkmcnt(0)
  v_cmp_le_u32 vcc, 1, v7
  s_cbranch_vccnz .g2_kernel_wg32d
  s_sleep 1
  s_cmp_lt_u32 s38, 524288
  s_cbranch_scc1 .g2_kernel_wg32
.g2_kernel_wg32d:
  v_mov_b32 v6, s71
  s_mov_b32 s38, 0
.g2_kernel_wg33:
  ds_read_b32 v7, v6 offset:72
  s_add_u32 s38, s38, 1
  s_waitcnt lgkmcnt(0)
  v_cmp_le_u32 vcc, 1, v7
  s_cbranch_vccnz .g2_kernel_wg33d
  s_sleep 1
  s_cmp_lt_u32 s38, 524288
  s_cbranch_scc1 .g2_kernel_wg33
.g2_kernel_wg33d:
  v_mov_b32 v6, s71
  s_mov_b32 s38, 0
.g2_kernel_wg34:
  ds_read_b32 v7, v6 offset:68
  s_add_u32 s38, s38, 1
  s_waitcnt lgkmcnt(0)
  v_cmp_le_u32 vcc, 1, v7
  s_cbranch_vccnz .g2_kernel_wg34d
  s_sleep 1
  s_cmp_lt_u32 s38, 524288
  s_cbranch_scc1 .g2_kernel_wg34
.g2_kernel_wg34d:
  ds_write_b128 v3, v[64:67] offset:16384
  ds_write_b128 v3, v[68:71] offset:17408
  ds_write_b128 v3, v[72:75] offset:18432
  ds_write_b128 v3, v[76:79] offset:19456
  ds_write_b128 v3, v[80:83] offset:20480
  ds_write_b128 v3, v[84:87] offset:21504
  ds_write_b128 v3, v[88:91] offset:22528
  ds_write_b128 v3, v[92:95] offset:23552
  ds_write_b128 v3, v[96:99] offset:24576
  ds_write_b128 v3, v[100:103] offset:25600
  ds_write_b128 v3, v[104:107] offset:26624
  ds_write_b128 v3, v[108:111] offset:27648
  ds_write_b128 v3, v[112:115] offset:28672
  ds_write_b128 v3, v[116:119] offset:29696
  ds_write_b128 v3, v[120:123] offset:30720
  ds_write_b128 v3, v[124:127] offset:31744
  v_mov_b32 v8, 4
  ds_write_b32 v6, v8 offset:12
.g2_kernel_v_8:
  s_cmp_eq_u32 s16, 5
  s_cbranch_scc1 .g2_kernel_c1
  s_cmp_lg_u32 s16, 4
  s_cbranch_scc1 .g2_kernel_c2
  s_cmp_lg_u32 s62, 0
  s_cbranch_scc1 .g2_kernel_fin1
  s_setprio 3
  s_mov_b32 s12, s42
  s_mov_b32 s13, s43
  s_mov_b32 s14, 0x600000
  s_mov_b32 s15, 0x00020000
  v_lshrrev_b32 v28, 3, v2
  v_and_b32 v29, 7, v2
  v_bfe_u32 v30, v2, 4, 1
  v_lshlrev_b32 v30, 1, v30
  v_xor_b32 v31, v29, v30
  v_lshlrev_b32 v31, 4, v31
  v_mul_u32_u24 v28, 6144, v28
  v_add_u32 v28, v28, v31
  v_xor_b32 v29, 64, v28
  v_lshlrev_b32 v9, 8, v2
  v_and_b32 v9, 0x300, v9
  v_add_u32 v9, 156416, v9
  v_add_u32 v48, 0, v28
  v_add_u32 v49, 48128, v29
  v_add_u32 v50, 96256, v28
  v_add_u32 v51, 144384, v29
  v_add_u32 v52, 2048, v28
  v_add_u32 v53, 50176, v29
  v_add_u32 v54, 98304, v28
  v_add_u32 v55, 146432, v29
  v_add_u32 v56, 4096, v28
  v_add_u32 v57, 52224, v29
  v_add_u32 v58, 100352, v28
  v_add_u32 v59, 148480, v29
  v_and_b32 v11, 15, v2
  v_xor_b32 v11, s18, v11
  v_and_b32 v12, 48, v2
  v_add_u32 v11, v11, v12
  v_lshlrev_b32 v11, 2, v11
  v_add_u32 v11, 158208, v11
  s_lshl_b32 s39, s18, 7
  s_lshl_b32 s32, s17, 18
  s_add_u32 s32, s32, 0xc00000
  s_mov_b32 s30, 0
  s_mov_b32 s29, 0
  s_mov_b32 s37, 0
  v_mov_b32 v6, s71
  s_mov_b32 s38, 0
.g2_kernel_wg35:
  ds_read_b32 v7, v6 offset:16
  s_add_u32 s38, s38, 1
  s_waitcnt lgkmcnt(0)
  v_cmp_le_u32 vcc, 4, v7
  s_cbranch_vccnz .g2_kernel_wg35d
  s_sleep 2
  s_cmp_lt_u32 s38, 524288
  s_cbranch_scc1 .g2_kernel_wg35
.g2_kernel_wg35d:
  s_xor_b32 s36, s18, 0
  s_mul_i32 s36, s36, 393216
  s_add_u32 s36, s36, s39
  s_add_u32 m0, s30, 65536
  s_waitcnt vmcnt(63)
  buffer_load_dwordx4 v48, s[12:15], s36 offen offset:0 lds
  buffer_load_dwordx4 v49, s[12:15], s36 offen offset:1024 lds
  buffer_load_dwordx4 v50, s[12:15], s36 offen offset:2048 lds
  buffer_load_dwordx4 v51, s[12:15], s36 offen offset:3072 lds
  s_add_u32 m0, s30, 69632
  s_waitcnt vmcnt(63)
  buffer_load_dwordx4 v52, s[12:15], s36 offen offset:0 lds
  buffer_load_dwordx4 v53, s[12:15], s36 offen offset:1024 lds
  buffer_load_dwordx4 v54, s[12:15], s36 offen offset:2048 lds
  buffer_load_dwordx4 v55, s[12:15], s36 offen offset:3072 lds
  s_add_u32 m0, s30, 73728
  s_waitcnt vmcnt(63)
  buffer_load_dwordx4 v56, s[12:15], s36 offen offset:0 lds
  buffer_load_dwordx4 v57, s[12:15], s36 offen offset:1024 lds
  buffer_load_dwordx4 v58, s[12:15], s36 offen offset:2048 lds
  buffer_load_dwordx4 v59, s[12:15], s36 offen offset:3072 lds
  s_add_u32 s30, s30, 12288
  s_cmp_eq_u32 s30, 86016
  s_cselect_b32 s30, 0, s30
  s_xor_b32 s36, s18, 0
  s_mul_i32 s36, s36, 393216
  s_add_u32 s36, s36, s39
  s_add_u32 s36, s36, 196608
  s_add_u32 m0, s30, 65536
  s_waitcnt vmcnt(63)
  buffer_load_dwordx4 v48, s[12:15], s36 offen offset:0 lds
  buffer_load_dwordx4 v49, s[12:15], s36 offen offset:1024 lds
  buffer_load_dwordx4 v50, s[12:15], s36 offen offset:2048 lds
  buffer_load_dwordx4 v51, s[12:15], s36 offen offset:3072 lds
  s_add_u32 m0, s30, 69632
  s_waitcnt vmcnt(63)
  buffer_load_dwordx4 v52, s[12:15], s36 offen offset:0 lds
  buffer_load_dwordx4 v53, s[12:15], s36 offen offset:1024 lds
  buffer_load_dwordx4 v54, s[12:15], s36 offen offset:2048 lds
  buffer_load_dwordx4 v55, s[12:15], s36 offen offset:3072 lds
  s_add_u32 m0, s30, 73728
  s_waitcnt vmcnt(63)
  buffer_load_dwordx4 v56, s[12:15], s36 offen offset:0 lds
  buffer_load_dwordx4 v57, s[12:15], s36 offen offset:1024 lds
  buffer_load_dwordx4 v58, s[12:15], s36 offen offset:2048 lds
  buffer_load_dwordx4 v59, s[12:15], s36 offen offset:3072 lds
  s_add_u32 s30, s30, 12288
  s_cmp_eq_u32 s30, 86016
  s_cselect_b32 s30, 0, s30
  s_mov_b32 m0, 156160
  s_mov_b32 s35, .g2_kernel_tab-.g2_kernel_pc+136
  buffer_load_dword off, s[64:67], s35 lds
  s_xor_b32 s36, s18, 1
  s_mul_i32 s36, s36, 393216
  s_add_u32 s36, s36, s39
  s_add_u32 m0, s30, 65536
  s_waitcnt vmcnt(63)
  buffer_load_dwordx4 v48, s[12:15], s36 offen offset:0 lds
  buffer_load_dwordx4 v49, s[12:15], s36 offen offset:1024 lds
  buffer_load_dwordx4 v50, s[12:15], s36 offen offset:2048 lds
  buffer_load_dwordx4 v51, s[12:15], s36 offen offset:3072 lds
  s_add_u32 m0, s30, 69632
  s_waitcnt vmcnt(63)
  buffer_load_dwordx4 v52, s[12:15], s36 offen offset:0 lds
  buffer_load_dwordx4 v53, s[12:15], s36 offen offset:1024 lds
  buffer_load_dwordx4 v54, s[12:15], s36 offen offset:2048 lds
  buffer_load_dwordx4 v55, s[12:15], s36 offen offset:3072 lds
  s_add_u32 m0, s30, 73728
  s_waitcnt vmcnt(63)
  buffer_load_dwordx4 v56, s[12:15], s36 offen offset:0 lds
  buffer_load_dwordx4 v57, s[12:15], s36 offen offset:1024 lds
  buffer_load_dwordx4 v58, s[12:15], s36 offen offset:2048 lds
  buffer_load_dwordx4 v59, s[12:15], s36 offen offset:3072 lds
  s_add_u32 s30, s30, 12288
  s_cmp_eq_u32 s30, 86016
  s_cselect_b32 s30, 0, s30
  s_xor_b32 s36, s18, 1
  s_mul_i32 s36, s36, 393216
  s_add_u32 s36, s36, s39
  s_add_u32 s36, s36, 196608
  s_add_u32 m0, s30, 65536
  s_waitcnt vmcnt(63)
  buffer_load_dwordx4 v48, s[12:15], s36 offen offset:0 lds
  buffer_load_dwordx4 v49, s[12:15], s36 offen offset:1024 lds
  buffer_load_dwordx4 v50, s[12:15], s36 offen offset:2048 lds
  buffer_load_dwordx4 v51, s[12:15], s36 offen offset:3072 lds
  s_add_u32 m0, s30, 69632
  s_waitcnt vmcnt(63)
  buffer_load_dwordx4 v52, s[12:15], s36 offen offset:0 lds
  buffer_load_dwordx4 v53, s[12:15], s36 offen offset:1024 lds
  buffer_load_dwordx4 v54, s[12:15], s36 offen offset:2048 lds
  buffer_load_dwordx4 v55, s[12:15], s36 offen offset:3072 lds
  s_add_u32 m0, s30, 73728
  s_waitcnt vmcnt(63)
  buffer_load_dwordx4 v56, s[12:15], s36 offen offset:0 lds
  buffer_load_dwordx4 v57, s[12:15], s36 offen offset:1024 lds
  buffer_load_dwordx4 v58, s[12:15], s36 offen offset:2048 lds
  buffer_load_dwordx4 v59, s[12:15], s36 offen offset:3072 lds
  s_add_u32 s30, s30, 12288
  s_cmp_eq_u32 s30, 86016
  s_cselect_b32 s30, 0, s30
  s_xor_b32 s36, s18, 2
  s_mul_i32 s36, s36, 393216
  s_add_u32 s36, s36, s39
  s_add_u32 m0, s30, 65536
  s_waitcnt vmcnt(63)
  buffer_load_dwordx4 v48, s[12:15], s36 offen offset:0 lds
  buffer_load_dwordx4 v49, s[12:15], s36 offen offset:1024 lds
  buffer_load_dwordx4 v50, s[12:15], s36 offen offset:2048 lds
  buffer_load_dwordx4 v51, s[12:15], s36 offen offset:3072 lds
  s_add_u32 m0, s30, 69632
  s_waitcnt vmcnt(63)
  buffer_load_dwordx4 v52, s[12:15], s36 offen offset:0 lds
  buffer_load_dwordx4 v53, s[12:15], s36 offen offset:1024 lds
  buffer_load_dwordx4 v54, s[12:15], s36 offen offset:2048 lds
  buffer_load_dwordx4 v55, s[12:15], s36 offen offset:3072 lds
  s_add_u32 m0, s30, 73728
  s_waitcnt vmcnt(63)
  buffer_load_dwordx4 v56, s[12:15], s36 offen offset:0 lds
  buffer_load_dwordx4 v57, s[12:15], s36 offen offset:1024 lds
  buffer_load_dwordx4 v58, s[12:15], s36 offen offset:2048 lds
  buffer_load_dwordx4 v59, s[12:15], s36 offen offset:3072 lds
  s_add_u32 s30, s30, 12288
  s_cmp_eq_u32 s30, 86016
  s_cselect_b32 s30, 0, s30
  v_mov_b32 v6, s71
  s_mov_b32 s38, 0
.g2_kernel_wg36:
  ds_read_b32 v7, v6 offset:20
  s_add_u32 s38, s38, 1
  s_waitcnt lgkmcnt(0)
  v_cmp_le_u32 vcc, 4, v7
  s_cbranch_vccnz .g2_kernel_wg36d
  s_sleep 1
  s_cmp_lt_u32 s38, 524288
  s_cbranch_scc1 .g2_kernel_wg36
.g2_kernel_wg36d:
  s_mov_b32 s62, 1
  s_mov_b32 s63, 0x1800000
  s_mov_b32 s70, 2
  s_mov_b32 s71, 155776
  s_xor_b32 s36, s18, 2
  s_mul_i32 s36, s36, 393216
  s_add_u32 s36, s36, s39
  s_add_u32 s36, s36, 196608
  s_add_u32 m0, s30, 65536
  s_waitcnt vmcnt(63)
  buffer_load_dwordx4 v48, s[12:15], s36 offen offset:0 lds
  buffer_load_dwordx4 v49, s[12:15], s36 offen offset:1024 lds
  buffer_load_dwordx4 v50, s[12:15], s36 offen offset:2048 lds
  buffer_load_dwordx4 v51, s[12:15], s36 offen offset:3072 lds
  s_add_u32 m0, s30, 69632
  s_waitcnt vmcnt(63)
  buffer_load_dwordx4 v52, s[12:15], s36 offen offset:0 lds
  buffer_load_dwordx4 v53, s[12:15], s36 offen offset:1024 lds
  buffer_load_dwordx4 v54, s[12:15], s36 offen offset:2048 lds
  buffer_load_dwordx4 v55, s[12:15], s36 offen offset:3072 lds
  s_add_u32 m0, s30, 73728
  s_waitcnt vmcnt(63)
  buffer_load_dwordx4 v56, s[12:15], s36 offen offset:0 lds
  buffer_load_dwordx4 v57, s[12:15], s36 offen offset:1024 lds
  buffer_load_dwordx4 v58, s[12:15], s36 offen offset:2048 lds
  buffer_load_dwordx4 v59, s[12:15], s36 offen offset:3072 lds
  s_add_u32 s30, s30, 12288
  s_cmp_eq_u32 s30, 86016
  s_cselect_b32 s30, 0, s30
  s_xor_b32 s36, s18, 3
  s_mul_i32 s36, s36, 393216
  s_add_u32 s36, s36, s39
  s_add_u32 m0, s30, 65536
  s_waitcnt vmcnt(63)
  buffer_load_dwordx4 v48, s[12:15], s36 offen offset:0 lds
  buffer_load_dwordx4 v49, s[12:15], s36 offen offset:1024 lds
  buffer_load_dwordx4 v50, s[12:15], s36 offen offset:2048 lds
  buffer_load_dwordx4 v51, s[12:15], s36 offen offset:3072 lds
  s_add_u32 m0, s30, 69632
  s_waitcnt vmcnt(63)
  buffer_load_dwordx4 v52, s[12:15], s36 offen offset:0 lds
  buffer_load_dwordx4 v53, s[12:15], s36 offen offset:1024 lds
  buffer_load_dwordx4 v54, s[12:15], s36 offen offset:2048 lds
  buffer_load_dwordx4 v55, s[12:15], s36 offen offset:3072 lds
  s_add_u32 m0, s30, 73728
  s_waitcnt vmcnt(63)
  buffer_load_dwordx4 v56, s[12:15], s36 offen offset:0 lds
  buffer_load_dwordx4 v57, s[12:15], s36 offen offset:1024 lds
  buffer_load_dwordx4 v58, s[12:15], s36 offen offset:2048 lds
  buffer_load_dwordx4 v59, s[12:15], s36 offen offset:3072 lds
  s_add_u32 s30, s30, 12288
  s_cmp_eq_u32 s30, 86016
  s_cselect_b32 s30, 0, s30
  s_mov_b32 s28, 1
  s_mov_b32 s29, 16384
  s_bitcmp1_b32 s37, s28
  s_cbranch_scc0 .g2_kernel_p2_x0w
.g2_kernel_p2_x0b:
  s_xor_b32 s33, s28, s18
  s_lshl_b32 s33, s33, 14
  s_add_u32 s33, s33, s32
  s_add_u32 m0, s29, 0
  s_waitcnt vmcnt(63)
  buffer_load_dwordx4 v3, s[4:7], s33 offen offset:0 lds
  buffer_load_dwordx4 v3, s[4:7], s33 offen offset:1024 lds
  buffer_load_dwordx4 v3, s[4:7], s33 offen offset:2048 lds
  buffer_load_dwordx4 v3, s[4:7], s33 offen offset:3072 lds
  s_add_u32 m0, s29, 4096
  s_waitcnt vmcnt(63)
  s_add_u32 s33, s33, 4096
  buffer_load_dwordx4 v3, s[4:7], s33 offen offset:0 lds
  buffer_load_dwordx4 v3, s[4:7], s33 offen offset:1024 lds
  buffer_load_dwordx4 v3, s[4:7], s33 offen offset:2048 lds
  buffer_load_dwordx4 v3, s[4:7], s33 offen offset:3072 lds
  s_add_u32 m0, s29, 8192
  s_waitcnt vmcnt(63)
  s_add_u32 s33, s33, 4096
  buffer_load_dwordx4 v3, s[4:7], s33 offen offset:0 lds
  buffer_load_dwordx4 v3, s[4:7], s33 offen offset:1024 lds
  buffer_load_dwordx4 v3, s[4:7], s33 offen offset:2048 lds
  buffer_load_dwordx4 v3, s[4:7], s33 offen offset:3072 lds
  s_add_u32 m0, s29, 12288
  s_waitcnt vmcnt(63)
  s_add_u32 s33, s33, 4096
  buffer_load_dwordx4 v3, s[4:7], s33 offen offset:0 lds
  buffer_load_dwordx4 v3, s[4:7], s33 offen offset:1024 lds
  buffer_load_dwordx4 v3, s[4:7], s33 offen offset:2048 lds
  buffer_load_dwordx4 v3, s[4:7], s33 offen offset:3072 lds
  s_mov_b32 m0, 156160
  s_mov_b32 s35, .g2_kernel_tab-.g2_kernel_pc+144
  buffer_load_dword off, s[64:67], s35 lds
  s_mov_b32 s28, 2
  s_mov_b32 s29, 32768
  s_bitcmp1_b32 s37, s28
  s_cbranch_scc0 .g2_kernel_p2_x1w
.g2_kernel_p2_x1b:
  s_xor_b32 s33, s28, s18
  s_lshl_b32 s33, s33, 14
  s_add_u32 s33, s33, s32
  s_add_u32 m0, s29, 0
  s_waitcnt vmcnt(63)
  buffer_load_dwordx4 v3, s[4:7], s33 offen offset:0 lds
  buffer_load_dwordx4 v3, s[4:7], s33 offen offset:1024 lds
  buffer_load_dwordx4 v3, s[4:7], s33 offen offset:2048 lds
  buffer_load_dwordx4 v3, s[4:7], s33 offen offset:3072 lds
  s_add_u32 m0, s29, 4096
  s_waitcnt vmcnt(63)
  s_add_u32 s33, s33, 4096
  buffer_load_dwordx4 v3, s[4:7], s33 offen offset:0 lds
  buffer_load_dwordx4 v3, s[4:7], s33 offen offset:1024 lds
  buffer_load_dwordx4 v3, s[4:7], s33 offen offset:2048 lds
  buffer_load_dwordx4 v3, s[4:7], s33 offen offset:3072 lds
  s_add_u32 m0, s29, 8192
  s_waitcnt vmcnt(63)
  s_add_u32 s33, s33, 4096
  buffer_load_dwordx4 v3, s[4:7], s33 offen offset:0 lds
  buffer_load_dwordx4 v3, s[4:7], s33 offen offset:1024 lds
  buffer_load_dwordx4 v3, s[4:7], s33 offen offset:2048 lds
  buffer_load_dwordx4 v3, s[4:7], s33 offen offset:3072 lds
  s_add_u32 m0, s29, 12288
  s_waitcnt vmcnt(63)
  s_add_u32 s33, s33, 4096
  buffer_load_dwordx4 v3, s[4:7], s33 offen offset:0 lds
  buffer_load_dwordx4 v3, s[4:7], s33 offen offset:1024 lds
  buffer_load_dwordx4 v3, s[4:7], s33 offen offset:2048 lds
  buffer_load_dwordx4 v3, s[4:7], s33 offen offset:3072 lds
  s_mov_b32 m0, 156160
  s_mov_b32 s35, .g2_kernel_tab-.g2_kernel_pc+152
  buffer_load_dword off, s[64:67], s35 lds
  s_mov_b32 s28, 3
  s_mov_b32 s29, 49152
  s_bitcmp1_b32 s37, s28
  s_cbranch_scc0 .g2_kernel_p2_x2w
.g2_kernel_p2_x2b:
  s_xor_b32 s33, s28, s18
  s_lshl_b32 s33, s33, 14
  s_add_u32 s33, s33, s32
  s_add_u32 m0, s29, 0
  s_waitcnt vmcnt(63)
  buffer_load_dwordx4 v3, s[4:7], s33 offen offset:0 lds
  buffer_load_dwordx4 v3, s[4:7], s33 offen offset:1024 lds
  buffer_load_dwordx4 v3, s[4:7], s33 offen offset:2048 lds
  buffer_load_dwordx4 v3, s[4:7], s33 offen offset:3072 lds
  s_add_u32 m0, s29, 4096
  s_waitcnt vmcnt(63)
  s_add_u32 s33, s33, 4096
  buffer_load_dwordx4 v3, s[4:7], s33 offen offset:0 lds
  buffer_load_dwordx4 v3, s[4:7], s33 offen offset:1024 lds
  buffer_load_dwordx4 v3, s[4:7], s33 offen offset:2048 lds
  buffer_load_dwordx4 v3, s[4:7], s33 offen offset:3072 lds
  s_add_u32 m0, s29, 8192
  s_waitcnt vmcnt(63)
  s_add_u32 s33, s33, 4096
  buffer_load_dwordx4 v3, s[4:7], s33 offen offset:0 lds
  buffer_load_dwordx4 v3, s[4:7], s33 offen offset:1024 lds
  buffer_load_dwordx4 v3, s[4:7], s33 offen offset:2048 lds
  buffer_load_dwordx4 v3, s[4:7], s33 offen offset:3072 lds
  s_add_u32 m0, s29, 12288
  s_waitcnt vmcnt(63)
  s_add_u32 s33, s33, 4096
  buffer_load_dwordx4 v3, s[4:7], s33 offen offset:0 lds
  buffer_load_dwordx4 v3, s[4:7], s33 offen offset:1024 lds
  buffer_load_dwordx4 v3, s[4:7], s33 offen offset:2048 lds
  buffer_load_dwordx4 v3, s[4:7], s33 offen offset:3072 lds
  s_mov_b32 m0, 156160
  s_mov_b32 s35, .g2_kernel_tab-.g2_kernel_pc+156
  buffer_load_dword off, s[64:67], s35 lds
  s_xor_b32 s36, s18, 3
  s_mul_i32 s36, s36, 393216
  s_add_u32 s36, s36, s39
  s_add_u32 s36, s36, 196608
  ds_read_b32 v10, v9
  s_mov_b32 s34, 33
  s_mov_b32 s35, .g2_kernel_tab-.g2_kernel_pc+160
  s_branch .g2_kernel_p2_o
  .p2align 6
.g2_kernel_p2_l:
  s_waitcnt lgkmcnt(0)
  v_cmp_gt_i32 vcc, s34, v10
  s_cbranch_vccnz .g2_kernel_p2_aw
.g2_kernel_p2_ai:
  s_add_u32 s29, s29, 16384
  s_and_b32 s29, s29, 0xffff
  s_bitcmp1_b32 s37, s28
  s_cbranch_scc0 .g2_kernel_p2_x3w
.g2_kernel_p2_x3b:
  s_xor_b32 s33, s28, s18
  s_lshl_b32 s33, s33, 14
  s_add_u32 s33, s33, s32
  s_add_u32 m0, s29, 0
  s_waitcnt vmcnt(63)
  buffer_load_dwordx4 v3, s[4:7], s33 offen offset:0 lds
  buffer_load_dwordx4 v3, s[4:7], s33 offen offset:1024 lds
  buffer_load_dwordx4 v3, s[4:7], s33 offen offset:2048 lds
  buffer_load_dwordx4 v3, s[4:7], s33 offen offset:3072 lds
  s_add_u32 m0, s29, 4096
  s_waitcnt vmcnt(63)
  s_add_u32 s33, s33, 4096
  buffer_load_dwordx4 v3, s[4:7], s33 offen offset:0 lds
  buffer_load_dwordx4 v3, s[4:7], s33 offen offset:1024 lds
  buffer_load_dwordx4 v3, s[4:7], s33 offen offset:2048 lds
  buffer_load_dwordx4 v3, s[4:7], s33 offen offset:3072 lds
  s_add_u32 m0, s29, 8192
  s_waitcnt vmcnt(63)
  s_add_u32 s33, s33, 4096
  buffer_load_dwordx4 v3, s[4:7], s33 offen offset:0 lds
  buffer_load_dwordx4 v3, s[4:7], s33 offen offset:1024 lds
  buffer_load_dwordx4 v3, s[4:7], s33 offen offset:2048 lds
  buffer_load_dwordx4 v3, s[4:7], s33 offen offset:3072 lds
  s_add_u32 m0, s29, 12288
  s_waitcnt vmcnt(63)
  s_add_u32 s33, s33, 4096
  buffer_load_dwordx4 v3, s[4:7], s33 offen offset:0 lds
  buffer_load_dwordx4 v3, s[4:7], s33 offen offset:1024 lds
  buffer_load_dwordx4 v3, s[4:7], s33 offen offset:2048 lds
  buffer_load_dwordx4 v3, s[4:7], s33 offen offset:3072 lds
  s_add_u32 m0, s30, 65536
  s_waitcnt vmcnt(63)
  buffer_load_dwordx4 v48, s[12:15], s36 offen offset:0 lds
  buffer_load_dwordx4 v49, s[12:15], s36 offen offset:1024 lds
  buffer_load_dwordx4 v50, s[12:15], s36 offen offset:2048 lds
  buffer_load_dwordx4 v51, s[12:15], s36 offen offset:3072 lds
  s_add_u32 m0, s30, 69632
  s_waitcnt vmcnt(63)
  buffer_load_dwordx4 v52, s[12:15], s36 offen offset:0 lds
  buffer_load_dwordx4 v53, s[12:15], s36 offen offset:1024 lds
  buffer_load_dwordx4 v54, s[12:15], s36 offen offset:2048 lds
  buffer_load_dwordx4 v55, s[12:15], s36 offen offset:3072 lds
  s_add_u32 m0, s30, 73728
  s_waitcnt vmcnt(63)
  buffer_load_dwordx4 v56, s[12:15], s36 offen offset:0 lds
  buffer_load_dwordx4 v57, s[12:15], s36 offen offset:1024 lds
  buffer_load_dwordx4 v58, s[12:15], s36 offen offset:2048 lds
  buffer_load_dwordx4 v59, s[12:15], s36 offen offset:3072 lds
  s_add_u32 s30, s30, 12288
  s_cmp_eq_u32 s30, 86016
  s_cselect_b32 s30, 0, s30
  ds_read_b32 v10, v9
  s_mov_b32 m0, 156160
  s_add_u32 s34, s34, 1
  buffer_load_dword off, s[64:67], s35 lds
  s_add_u32 s35, s35, 4
  s_add_u32 s36, s36, 196608
.g2_kernel_p2_o:
  s_waitcnt lgkmcnt(0)
  v_cmp_gt_i32 vcc, s34, v10
  s_cbranch_vccnz .g2_kernel_p2_bw
.g2_kernel_p2_bi:
  s_add_u32 m0, s30, 65536
  s_waitcnt vmcnt(63)
  buffer_load_dwordx4 v48, s[12:15], s36 offen offset:0 lds
  buffer_load_dwordx4 v49, s[12:15], s36 offen offset:1024 lds
  buffer_load_dwordx4 v50, s[12:15], s36 offen offset:2048 lds
  buffer_load_dwordx4 v51, s[12:15], s36 offen offset:3072 lds
  s_add_u32 m0, s30, 69632
  s_waitcnt vmcnt(63)
  buffer_load_dwordx4 v52, s[12:15], s36 offen offset:0 lds
  buffer_load_dwordx4 v53, s[12:15], s36 offen offset:1024 lds
  buffer_load_dwordx4 v54, s[12:15], s36 offen offset:2048 lds
  buffer_load_dwordx4 v55, s[12:15], s36 offen offset:3072 lds
  s_add_u32 m0, s30, 73728
  s_waitcnt vmcnt(63)
  buffer_load_dwordx4 v56, s[12:15], s36 offen offset:0 lds
  buffer_load_dwordx4 v57, s[12:15], s36 offen offset:1024 lds
  buffer_load_dwordx4 v58, s[12:15], s36 offen offset:2048 lds
  buffer_load_dwordx4 v59, s[12:15], s36 offen offset:3072 lds
  s_add_u32 s30, s30, 12288
  s_cmp_eq_u32 s30, 86016
  s_cselect_b32 s30, 0, s30
  ds_read_b32 v10, v9
  s_mov_b32 m0, 156160
  s_add_u32 s34, s34, 1
  buffer_load_dword off, s[64:67], s35 lds
  s_add_u32 s35, s35, 4
  s_add_u32 s28, s28, 1
  s_xor_b32 s36, s18, s28
  s_mul_i32 s36, s36, 393216
  s_add_u32 s36, s36, s39
  s_cmp_lt_i32 s34, 58
  s_cbranch_scc1 .g2_kernel_p2_l
  s_branch .g2_kernel_v
.g2_kernel_c1:
  v_mov_b32 v6, s71
  s_mov_b32 s38, 0
.g2_kernel_wg37:
  ds_read_b32 v7, v6 offset:76
  s_add_u32 s38, s38, 1
  s_waitcnt lgkmcnt(0)
  v_cmp_le_u32 vcc, 1, v7
  s_cbranch_vccnz .g2_kernel_wg37d
  s_sleep 1
  s_cmp_lt_u32 s38, 524288
  s_cbranch_scc1 .g2_kernel_wg37
.g2_kernel_wg37d:
  s_sleep 4
  s_and_b32 s31, s19, 0xffffe000
  s_add_u32 s31, s31, 4
  v_and_b32 v6, 15, v2
  v_lshlrev_b32 v6, 9, v6
  v_lshrrev_b32 v7, 4, v2
  v_lshl_add_u32 v6, v7, 7, v6
  v_lshlrev_b32 v7, 2, v2
  v_add_u32 v7, 157952, v7
  s_mov_b32 m0, 157952
  s_mov_b32 s38, 0
.g2_kernel_pa38:
  buffer_load_dword v6, s[4:7], s31 offen sc1 lds
  s_add_u32 s38, s38, 1
  s_waitcnt vmcnt(0)
  ds_read_b32 v8, v7
  s_waitcnt lgkmcnt(0)
  v_cmp_ge_u32 vcc, s62, v8
  s_cbranch_vccz .g2_kernel_pa38d
  s_mov_b64 exec, vcc
  s_sleep 4
  s_cmp_lt_u32 s38, 131072
  s_cbranch_scc1 .g2_kernel_pa38
.g2_kernel_pa38d:
  s_mov_b64 exec, -1
  s_setprio 2
  s_mov_b32 s39, 0
  s_lshl_b32 s30, s17, 4
  s_add_u32 s30, s30, s18
  s_lshl_b32 s20, s30, 11
  s_add_u32 s20, s20, s63
  s_add_u32 s20, s20, 0x1000000
  s_lshl_b32 s21, s30, 6
  s_add_u32 s21, s21, s63
  s_add_u32 s21, s21, 0x1080000
  s_lshl_b32 s23, s62, 16
  s_add_u32 s23, s23, 0x3040000
  s_lshl_b32 s22, s30, 5
  s_add_u32 s22, s22, s23
  s_and_b32 s28, s2, 7
  s_lshl_b32 s28, s28, 13
  s_add_u32 s23, s23, s28
  v_mov_b32 v9, 155648
  ds_read_b32 v26, v9 offset:256
  v_lshrrev_b32 v24, 4, v2
  v_lshlrev_b32 v25, 3, v24
  v_lshlrev_b32 v27, 13, v2
  v_and_b32 v31, 15, v2
  v_lshlrev_b32 v31, 7, v31
  v_lshl_add_u32 v31, v24, 4, v31
  v_mov_b32 v28, 0.0009765625
  v_mov_b32 v30, 1e-05
  v_mov_b32 v6, s71
  s_mov_b32 s38, 0
.g2_kernel_wg40:
  ds_read_b32 v7, v6 offset:20
  s_add_u32 s38, s38, 1
  s_waitcnt lgkmcnt(0)
  v_cmp_le_u32 vcc, 4, v7
  s_cbranch_vccnz .g2_kernel_wg40d
  s_sleep 1
  s_cmp_lt_u32 s38, 524288
  s_cbranch_scc1 .g2_kernel_wg40
.g2_kernel_wg40d:
  s_sleep 12
  s_cmp_lg_u32 s62, 0
  s_cbranch_scc1 .g2_kernel_nap41
  s_sleep 24
.g2_kernel_nap41:
  s_mov_b32 s38, 0
.g2_kernel_gx42:
  buffer_load_dwordx4 v[16:19], v31, s[4:7], s20 offen offset:0 sc1
  buffer_load_dwordx4 v[20:23], v31, s[4:7], s20 offen offset:64 sc1
  s_add_u32 s38, s38, 1
  s_waitcnt vmcnt(0)
  v_min3_u32 v6, v16, v19, v20
  v_min_u32 v6, v6, v23
  v_cmp_eq_u32 vcc, 0, v6
  s_cbranch_vccz .g2_kernel_gx42d
  s_mov_b64 exec, vcc
  s_sleep 1
  s_cmp_lg_u32 s62, 0
  s_cbranch_scc1 .g2_kernel_nap43
  s_sleep 23
.g2_kernel_nap43:
  s_cmp_lt_u32 s38, 131072
  s_cbranch_scc1 .g2_kernel_gx42
.g2_kernel_gx42d:
  s_mov_b64 exec, -1
  v_add_f32 v16, v16, v16 row_ror:8 row_mask:0xf bank_mask:0xf
  v_add_f32 v17, v17, v17 row_ror:8 row_mask:0xf bank_mask:0xf
  v_add_f32 v18, v18, v18 row_ror:8 row_mask:0xf bank_mask:0xf
  v_add_f32 v20, v20, v20 row_ror:8 row_mask:0xf bank_mask:0xf
  v_add_f32 v21, v21, v21 row_ror:8 row_mask:0xf bank_mask:0xf
  v_add_f32 v22, v22, v22 row_ror:8 row_mask:0xf bank_mask:0xf
  v_add_f32 v16, v16, v16 row_ror:4 row_mask:0xf bank_mask:0xf
  v_add_f32 v17, v17, v17 row_ror:4 row_mask:0xf bank_mask:0xf
  v_add_f32 v18, v18, v18 row_ror:4 row_mask:0xf bank_mask:0xf
  v_add_f32 v20, v20, v20 row_ror:4 row_mask:0xf bank_mask:0xf
  v_add_f32 v21, v21, v21 row_ror:4 row_mask:0xf bank_mask:0xf
  v_add_f32 v22, v22, v22 row_ror:4 row_mask:0xf bank_mask:0xf
  v_add_f32 v16, v16, v16 row_ror:2 row_mask:0xf bank_mask:0xf
  v_add_f32 v17, v17, v17 row_ror:2 row_mask:0xf bank_mask:0xf
  v_add_f32 v18, v18, v18 row_ror:2 row_mask:0xf bank_mask:0xf
  v_add_f32 v20, v20, v20 row_ror:2 row_mask:0xf bank_mask:0xf
  v_add_f32 v21, v21, v21 row_ror:2 row_mask:0xf bank_mask:0xf
  v_add_f32 v22, v22, v22 row_ror:2 row_mask:0xf bank_mask:0xf
  v_add_f32 v16, v16, v16 row_ror:1 row_mask:0xf bank_mask:0xf
  v_add_f32 v17, v17, v17 row_ror:1 row_mask:0xf bank_mask:0xf
  v_add_f32 v18, v18, v18 row_ror:1 row_mask:0xf bank_mask:0xf
  v_add_f32 v20, v20, v20 row_ror:1 row_mask:0xf bank_mask:0xf
  v_add_f32 v21, v21, v21 row_ror:1 row_mask:0xf bank_mask:0xf
  v_add_f32 v22, v22, v22 row_ror:1 row_mask:0xf bank_mask:0xf
  v_fma_f32 v18, -v16, v26, v18
  v_mul_f32 v16, v28, v16
  v_mul_f32 v19, v16, v16
  v_fma_f32 v17, v17, v28, -v19
  v_max_f32 v17, 0, v17
  v_add_f32 v17, v30, v17
  v_rsq_f32 v19, v17
  v_fma_f32 v22, -v20, v26, v22
  v_mul_f32 v20, v28, v20
  v_mul_f32 v23, v20, v20
  v_fma_f32 v21, v21, v28, -v23
  v_max_f32 v21, 0, v21
  v_add_f32 v21, v30, v21
  v_rsq_f32 v23, v21
  v_mul_f32 v18, v18, v19
  v_mul_f32 v22, v22, v23
  v_and_or_b32 v18, v18, -8, v24
  v_or_b32 v29, 4, v24
  v_and_or_b32 v22, v22, -8, v29
  v_max_f32 v10, v18, v22
  v_mov_b32 v11, 1
  s_nop 0
  v_max_f32 v10, v10, v10 row_bcast:15 row_mask:0xa bank_mask:0xf
  s_nop 1
  v_max_f32 v10, v10, v10 row_bcast:31 row_mask:0xc bank_mask:0xf
  s_nop 0
  v_readlane_b32 s28, v10, 63
  s_nop 1
  v_mov_b32 v10, s28
  s_mov_b64 exec, 0xff
  buffer_store_dwordx2 v[10:11], v27, s[4:7], s22 offen sc1
  s_mov_b32 exec_lo, 0x00010001
  s_mov_b32 exec_hi, 0x00010001
  buffer_store_dwordx2 v[16:17], v25, s[4:7], s21 offen sc1
  buffer_store_dwordx2 v[20:21], v25, s[4:7], s21 offen offset:32 sc1
  s_mov_b64 exec, -1
  s_cmp_lg_u32 s62, 0
  s_cbranch_scc1 .g2_kernel_c_t3
  s_sleep 30
  s_mov_b64 s[8:9], -1
  s_mov_b64 s[10:11], -1
  s_mov_b64 s[12:13], -1
  s_mov_b64 s[14:15], -1
  s_call_b64 s[68:69], .g2_kernel_amax
  s_add_u32 s28, s77, 1
  v_mov_b32 v10, s28
  v_mov_b32 v9, s71
  ds_write_b32 v9, v10 offset:36
  s_lshr_b32 s24, s77, 7
  s_lshl_b32 s24, s24, 18
  s_bfe_u32 s28, s77, 0x30004
  s_lshl_b32 s28, s28, 11
  s_add_u32 s24, s24, s28
  s_and_b32 s28, s77, 15
  s_lshl_b32 s28, s28, 4
  s_add_u32 s24, s24, s28
  s_add_u32 s24, s24, s63
  s_add_u32 s24, s24, 0xc00000
  s_lshl_b32 s28, s17, 14
  s_add_u32 s24, s24, s28
  s_and_b32 s28, s18, 1
  s_lshl_b32 s28, s28, 8
  s_add_u32 s24, s24, s28
  v_lshrrev_b32 v12, 3, v2
  v_lshlrev_b32 v13, 1, v12
  s_waitcnt lgkmcnt(0)
  s_wakeup
  buffer_load_ushort v56, v13, s[4:7], s24 offen offset:0
  buffer_load_ushort v57, v13, s[4:7], s24 offen offset:512
  buffer_load_ushort v58, v13, s[4:7], s24 offen offset:1024
  buffer_load_ushort v59, v13, s[4:7], s24 offen offset:1536
  s_lshl_b32 s25, s77, 3
  s_add_u32 s25, s25, s63
  s_add_u32 s25, s25, 0x1080000
  s_lshl_b32 s21, s17, 10
  s_add_u32 s21, s21, s63
  s_add_u32 s21, s21, 0x1080000
  s_mov_b32 s38, 0
.g2_kernel_gx44:
  buffer_load_dwordx4 v[16:19], v3, s[4:7], s21 offen sc1
  buffer_load_dwordx2 v[20:21], v4, s[4:7], s25 offen sc1
  s_add_u32 s38, s38, 1
  s_waitcnt vmcnt(0)
  v_min3_u32 v6, v17, v19, v21
  v_cmp_eq_u32 vcc, 0, v6
  s_cbranch_vccz .g2_kernel_gx44d
  s_mov_b64 exec, vcc
  s_sleep 1
  s_cmp_lt_u32 s38, 131072
  s_cbranch_scc1 .g2_kernel_gx44
.g2_kernel_gx44d:
  s_mov_b64 exec, -1
  s_lshr_b32 s28, s77, 7
  s_and_b32 s79, s77, 127
  s_add_u32 s79, s79, 1
  s_cmp_eq_u32 s28, s17
  s_cselect_b32 s79, s79, 0
  v_rsq_f32 v22, v17
  v_rsq_f32 v23, v19
  v_rsq_f32 v21, v21
  v_mov_b32 v62, -1.4426950408889634
  v_mul_f32 v62, s27, v62
  v_exp_f32 v62, v62
  v_lshlrev_b32 v14, 3, v2
  v_add_u32 v14, 155648, v14
  v_mov_b32 v15, s79
  v_add_f32 v52, 1.0, v22
  v_mul_f32 v54, v16, v22
  v_sub_f32 v54, 0, v54
  v_add_f32 v53, 1.0, v23
  v_mul_f32 v55, v18, v23
  v_sub_f32 v55, 0, v55
  v_add_f32 v62, 1.0, v62
  v_rcp_f32 v62, v62
  v_add_f32 v60, 1.0, v21
  v_mul_f32 v61, v20, v21
  v_sub_f32 v61, 0, v61
  v_sub_f32 v17, v17, v30
  v_mul_f32 v48, v52, v52
  v_fma_f32 v48, v48, v17, v30
  v_rsq_f32 v48, v48
  s_nop 0
  v_mul_f32 v48, v48, v52
  v_mul_f32 v50, v48, v16
  v_sub_f32 v50, 0, v50
  v_sub_f32 v19, v19, v30
  v_mul_f32 v49, v53, v53
  v_fma_f32 v49, v49, v19, v30
  v_rsq_f32 v49, v49
  s_nop 0
  v_mul_f32 v49, v49, v53
  v_mul_f32 v51, v49, v18
  v_sub_f32 v51, 0, v51
  v_lshlrev_b32 v56, 16, v56
  v_fma_f32 v56, v56, v60, v61
  v_lshlrev_b32 v57, 16, v57
  v_fma_f32 v57, v57, v60, v61
  v_lshlrev_b32 v58, 16, v58
  v_fma_f32 v58, v58, v60, v61
  v_lshlrev_b32 v59, 16, v59
  v_fma_f32 v59, v59, v60, v61
  v_and_b32 v10, 7, v2
  v_lshlrev_b32 v10, 12, v10
  v_lshl_add_u32 v10, v12, 4, v10
  s_lshl_b32 s20, s17, 1
  s_and_b32 s28, s18, 1
  s_add_u32 s20, s20, s28
  s_lshl_b32 s20, s20, 7
  s_add_u32 s20, s20, s63
  s_add_u32 s20, s20, 0x1090000
  s_and_b32 s26, s18, 14
  s_lshl_b32 s26, s26, 4
  s_add_u32 s26, s26, s17
  s_lshl_b32 s26, s26, 1
  s_and_b32 s28, s18, 1
  s_add_u32 s26, s26, s28
  s_lshl_b32 s26, s26, 10
  s_add_u32 s26, s26, s63
  s_add_u32 s26, s26, 0x1190000
  s_add_u32 s25, s26, 32768
  ds_write_b64 v14, v[48:49] offset:2816
  ds_write_b64 v14, v[50:51] offset:3328
  ds_write_b64 v14, v[52:53] offset:3840
  ds_write_b64 v14, v[54:55] offset:4352
  s_lshr_b32 s28, s77, 7
  s_xor_b32 s28, s28, s17
  v_mov_b32 v8, s28
  ds_write_b32 v9, v8 offset:212
  v_mov_b32 v8, 2
  ds_write_b32 v9, v15 offset:152
  ds_write_b32 v9, v8 offset:128
  s_lshl_b32 s28, s2, 10
  s_and_b32 s28, s28, 0xe000
  v_lshlrev_b32 v7, 7, v2
  buffer_load_dword v1, v7, s[64:67], s28 offen
  v_mov_b32 v6, s71
  s_mov_b32 s38, 0
.g2_kernel_wg45:
  ds_read_b32 v7, v6 offset:48
  s_add_u32 s38, s38, 1
  s_waitcnt lgkmcnt(0)
  v_cmp_le_u32 vcc, 2, v7
  s_cbranch_vccnz .g2_kernel_wg45d
  s_sleep 1
  s_cmp_lt_u32 s38, 524288
  s_cbranch_scc1 .g2_kernel_wg45
.g2_kernel_wg45d:
  s_sleep 8
  s_cmp_lg_u32 s62, 0
  s_cbranch_scc1 .g2_kernel_nap46
  s_sleep 22
.g2_kernel_nap46:
  s_mov_b32 s38, 0
.g2_kernel_gx47:
  s_mov_b32 s21, s20
  buffer_load_dwordx4 v[160:163], v10, s[4:7], s21 offen sc1
  s_add_u32 s21, s21, 32768
  buffer_load_dwordx4 v[164:167], v10, s[4:7], s21 offen sc1
  s_add_u32 s21, s21, 32768
  buffer_load_dwordx4 v[168:171], v10, s[4:7], s21 offen sc1
  s_add_u32 s21, s21, 32768
  buffer_load_dwordx4 v[172:175], v10, s[4:7], s21 offen sc1
  s_add_u32 s21, s21, 32768
  buffer_load_dwordx4 v[176:179], v10, s[4:7], s21 offen sc1
  s_add_u32 s21, s21, 32768
  buffer_load_dwordx4 v[180:183], v10, s[4:7], s21 offen sc1
  s_add_u32 s21, s21, 32768
  buffer_load_dwordx4 v[184:187], v10, s[4:7], s21 offen sc1
  s_add_u32 s21, s21, 32768
  buffer_load_dwordx4 v[188:191], v10, s[4:7], s21 offen sc1
  s_add_u32 s21, s21, 32768
  buffer_load_dwordx4 v[192:195], v10, s[4:7], s21 offen sc1
  s_add_u32 s21, s21, 32768
  buffer_load_dwordx4 v[196:199], v10, s[4:7], s21 offen sc1
  s_add_u32 s21, s21, 32768
  buffer_load_dwordx4 v[200:203], v10, s[4:7], s21 offen sc1
  s_add_u32 s21, s21, 32768
  buffer_load_dwordx4 v[204:207], v10, s[4:7], s21 offen sc1
  s_add_u32 s21, s21, 32768
  buffer_load_dwordx4 v[208:211], v10, s[4:7], s21 offen sc1
  s_add_u32 s21, s21, 32768
  buffer_load_dwordx4 v[212:215], v10, s[4:7], s21 offen sc1
  s_add_u32 s21, s21, 32768
  buffer_load_dwordx4 v[216:219], v10, s[4:7], s21 offen sc1
  s_add_u32 s21, s21, 32768
  buffer_load_dwordx4 v[220:223], v10, s[4:7], s21 offen sc1
  s_add_u32 s21, s21, 32768
  buffer_load_dwordx4 v[224:227], v10, s[4:7], s21 offen sc1
  s_add_u32 s21, s21, 32768
  buffer_load_dwordx4 v[228:231], v10, s[4:7], s21 offen sc1
  s_add_u32 s21, s21, 32768
  buffer_load_dwordx4 v[232:235], v10, s[4:7], s21 offen sc1
  s_add_u32 s21, s21, 32768
  buffer_load_dwordx4 v[236:239], v10, s[4:7], s21 offen sc1
  s_add_u32 s21, s21, 32768
  buffer_load_dwordx4 v[240:243], v10, s[4:7], s21 offen sc1
  s_add_u32 s21, s21, 32768
  buffer_load_dwordx4 v[244:247], v10, s[4:7], s21 offen sc1
  s_add_u32 s21, s21, 32768
  buffer_load_dwordx4 v[248:251], v10, s[4:7], s21 offen sc1
  s_add_u32 s21, s21, 32768
  buffer_load_dwordx4 v[252:255], v10, s[4:7], s21 offen sc1
  s_add_u32 s21, s21, 32768
  buffer_load_dwordx4 v[16:19], v10, s[4:7], s21 offen sc1
  s_add_u32 s21, s21, 32768
  buffer_load_dwordx4 v[20:23], v10, s[4:7], s21 offen sc1
  s_add_u32 s21, s21, 32768
  buffer_load_dwordx4 v[24:27], v10, s[4:7], s21 offen sc1
  s_add_u32 s21, s21, 32768
  buffer_load_dwordx4 v[28:31], v10, s[4:7], s21 offen sc1
  s_add_u32 s21, s21, 32768
  s_add_u32 s38, s38, 1
  s_waitcnt vmcnt(0)
  v_min3_u32 v6, v160, v162, v164
  v_min3_u32 v6, v6, v166, v168
  v_min3_u32 v6, v6, v170, v172
  v_min3_u32 v6, v6, v174, v176
  v_min3_u32 v6, v6, v178, v180
  v_min3_u32 v6, v6, v182, v184
  v_min3_u32 v6, v6, v186, v188
  v_min3_u32 v6, v6, v190, v192
  v_min3_u32 v6, v6, v194, v196
  v_min3_u32 v6, v6, v198, v200
  v_min3_u32 v6, v6, v202, v204
  v_min3_u32 v6, v6, v206, v208
  v_min3_u32 v6, v6, v210, v212
  v_min3_u32 v6, v6, v214, v216
  v_min3_u32 v6, v6, v218, v220
  v_min3_u32 v6, v6, v222, v224
  v_min3_u32 v6, v6, v226, v228
  v_min3_u32 v6, v6, v230, v232
  v_min3_u32 v6, v6, v234, v236
  v_min3_u32 v6, v6, v238, v240
  v_min3_u32 v6, v6, v242, v244
  v_min3_u32 v6, v6, v246, v248
  v_min3_u32 v6, v6, v250, v252
  v_min3_u32 v6, v6, v254, v16
  v_min3_u32 v6, v6, v18, v20
  v_min3_u32 v6, v6, v22, v24
  v_min3_u32 v6, v6, v26, v28
  v_min_u32 v6, v6, v30
  v_cmp_eq_u32 vcc, 0, v6
  s_cbranch_vccz .g2_kernel_gx47d
  s_mov_b64 exec, vcc
  s_sleep 1
  s_cmp_lg_u32 s62, 0
  s_cbranch_scc1 .g2_kernel_nap48
  s_sleep 11
.g2_kernel_nap48:
  s_cmp_lt_u32 s38, 131072
  s_cbranch_scc1 .g2_kernel_gx47
.g2_kernel_gx47d:
  s_mov_b64 exec, -1
  v_add_f32 v164, v164, v160
  v_add_f32 v165, v165, v161
  v_add_f32 v166, v166, v162
  v_add_f32 v167, v167, v163
  v_add_f32 v172, v172, v168
  v_add_f32 v173, v173, v169
  v_add_f32 v174, v174, v170
  v_add_f32 v175, v175, v171
  v_add_f32 v180, v180, v176
  v_add_f32 v181, v181, v177
  v_add_f32 v182, v182, v178
  v_add_f32 v183, v183, v179
  v_add_f32 v188, v188, v184
  v_add_f32 v189, v189, v185
  v_add_f32 v190, v190, v186
  v_add_f32 v191, v191, v187
  v_add_f32 v196, v196, v192
  v_add_f32 v197, v197, v193
  v_add_f32 v198, v198, v194
  v_add_f32 v199, v199, v195
  v_add_f32 v204, v204, v200
  v_add_f32 v205, v205, v201
  v_add_f32 v206, v206, v202
  v_add_f32 v207, v207, v203
  v_add_f32 v212, v212, v208
  v_add_f32 v213, v213, v209
  v_add_f32 v214, v214, v210
  v_add_f32 v215, v215, v211
  v_add_f32 v220, v220, v216
  v_add_f32 v221, v221, v217
  v_add_f32 v222, v222, v218
  v_add_f32 v223, v223, v219
  v_add_f32 v228, v228, v224
  v_add_f32 v229, v229, v225
  v_add_f32 v230, v230, v226
  v_add_f32 v231, v231, v227
  v_add_f32 v236, v236, v232
  v_add_f32 v237, v237, v233
  v_add_f32 v238, v238, v234
  v_add_f32 v239, v239, v235
  v_add_f32 v244, v244, v240
  v_add_f32 v245, v245, v241
  v_add_f32 v246, v246, v242
  v_add_f32 v247, v247, v243
  v_add_f32 v252, v252, v248
  v_add_f32 v253, v253, v249
  v_add_f32 v254, v254, v250
  v_add_f32 v255, v255, v251
  v_add_f32 v20, v20, v16
  v_add_f32 v21, v21, v17
  v_add_f32 v22, v22, v18
  v_add_f32 v23, v23, v19
  v_add_f32 v28, v28, v24
  v_add_f32 v29, v29, v25
  v_add_f32 v30, v30, v26
  v_add_f32 v31, v31, v27
  v_add_f32 v172, v172, v164
  v_add_f32 v173, v173, v165
  v_add_f32 v174, v174, v166
  v_add_f32 v175, v175, v167
  v_add_f32 v188, v188, v180
  v_add_f32 v189, v189, v181
  v_add_f32 v190, v190, v182
  v_add_f32 v191, v191, v183
  v_add_f32 v204, v204, v196
  v_add_f32 v205, v205, v197
  v_add_f32 v206, v206, v198
  v_add_f32 v207, v207, v199
  v_add_f32 v220, v220, v212
  v_add_f32 v221, v221, v213
  v_add_f32 v222, v222, v214
  v_add_f32 v223, v223, v215
  v_add_f32 v236, v236, v228
  v_add_f32 v237, v237, v229
  v_add_f32 v238, v238, v230
  v_add_f32 v239, v239, v231
  v_add_f32 v252, v252, v244
  v_add_f32 v253, v253, v245
  v_add_f32 v254, v254, v246
  v_add_f32 v255, v255, v247
  v_add_f32 v28, v28, v20
  v_add_f32 v29, v29, v21
  v_add_f32 v30, v30, v22
  v_add_f32 v31, v31, v23
  v_add_f32 v188, v188, v172
  v_add_f32 v189, v189, v173
  v_add_f32 v190, v190, v174
  v_add_f32 v191, v191, v175
  v_add_f32 v220, v220, v204
  v_add_f32 v221, v221, v205
  v_add_f32 v222, v222, v206
  v_add_f32 v223, v223, v207
  v_add_f32 v252, v252, v236
  v_add_f32 v253, v253, v237
  v_add_f32 v254, v254, v238
  v_add_f32 v255, v255, v239
  v_add_f32 v220, v220, v188
  v_add_f32 v221, v221, v189
  v_add_f32 v222, v222, v190
  v_add_f32 v223, v223, v191
  v_add_f32 v28, v28, v252
  v_add_f32 v29, v29, v253
  v_add_f32 v30, v30, v254
  v_add_f32 v31, v31, v255
  v_add_f32 v28, v28, v220
  v_add_f32 v29, v29, v221
  v_add_f32 v30, v30, v222
  v_add_f32 v31, v31, v223
  v_add_f32 v28, v28, v28 quad_perm:[1,0,3,2] row_mask:0xf bank_mask:0xf
  v_add_f32 v29, v29, v29 quad_perm:[1,0,3,2] row_mask:0xf bank_mask:0xf
  v_add_f32 v30, v30, v30 quad_perm:[1,0,3,2] row_mask:0xf bank_mask:0xf
  v_add_f32 v31, v31, v31 quad_perm:[1,0,3,2] row_mask:0xf bank_mask:0xf
  v_add_f32 v28, v28, v28 quad_perm:[2,3,0,1] row_mask:0xf bank_mask:0xf
  v_add_f32 v29, v29, v29 quad_perm:[2,3,0,1] row_mask:0xf bank_mask:0xf
  v_add_f32 v30, v30, v30 quad_perm:[2,3,0,1] row_mask:0xf bank_mask:0xf
  v_add_f32 v31, v31, v31 quad_perm:[2,3,0,1] row_mask:0xf bank_mask:0xf
  v_add_f32 v28, v28, v28 row_half_mirror row_mask:0xf bank_mask:0xf
  v_add_f32 v29, v29, v29 row_half_mirror row_mask:0xf bank_mask:0xf
  v_add_f32 v30, v30, v30 row_half_mirror row_mask:0xf bank_mask:0xf
  v_add_f32 v31, v31, v31 row_half_mirror row_mask:0xf bank_mask:0xf
  v_mul_f32 v28, v28, v62
  v_mul_f32 v29, v29, v62
  v_mul_f32 v30, v30, v62
  v_mul_f32 v31, v31, v62
  v_cvt_pk_bf16_f32 v16, v28, v29
  v_cvt_pk_bf16_f32 v17, v30, v31
  s_mov_b32 s28, 0x00010001
  s_mov_b32 s29, 0x00010001
  v_mov_b32 v18, v16 row_ror:8 row_mask:0xf bank_mask:0xf
  v_mov_b32 v19, v17 row_ror:8 row_mask:0xf bank_mask:0xf
  v_lshlrev_b32 v28, 16, v16
  v_and_b32 v29, 0xffff0000, v16
  v_lshlrev_b32 v30, 16, v17
  v_and_b32 v31, 0xffff0000, v17
  v_cndmask_b32 v32, 0, v16, s[28:29]
  v_cndmask_b32 v33, 0, v17, s[28:29]
  v_cndmask_b32 v34, 0, v18, s[28:29]
  v_cndmask_b32 v35, 0, v19, s[28:29]
  s_lshl_b64 s[28:29], s[28:29], 1
  s_nop 0
  v_mfma_f32_16x16x32_bf16 v[160:163], v[32:35], v[64:67], 0
  v_mfma_f32_16x16x32_bf16 v[164:167], v[32:35], v[80:83], 0
  v_mfma_f32_16x16x32_bf16 v[168:171], v[32:35], v[96:99], 0
  v_mfma_f32_16x16x32_bf16 v[172:175], v[32:35], v[112:115], 0
  v_mfma_f32_16x16x32_bf16 v[176:179], v[32:35], v[128:131], 0
  v_mfma_f32_16x16x32_bf16 v[180:183], v[32:35], v[144:147], 0
  v_cndmask_b32 v36, 0, v16, s[28:29]
  v_cndmask_b32 v37, 0, v17, s[28:29]
  v_cndmask_b32 v38, 0, v18, s[28:29]
  v_cndmask_b32 v39, 0, v19, s[28:29]
  s_lshl_b64 s[28:29], s[28:29], 1
  s_nop 0
  v_mfma_f32_16x16x32_bf16 v[160:163], v[36:39], v[68:71], v[160:163]
  v_mfma_f32_16x16x32_bf16 v[164:167], v[36:39], v[84:87], v[164:167]
  v_mfma_f32_16x16x32_bf16 v[168:171], v[36:39], v[100:103], v[168:171]
  v_mfma_f32_16x16x32_bf16 v[172:175], v[36:39], v[116:119], v[172:175]
  v_mfma_f32_16x16x32_bf16 v[176:179], v[36:39], v[132:135], v[176:179]
  v_mfma_f32_16x16x32_bf16 v[180:183], v[36:39], v[148:151], v[180:183]
  v_cndmask_b32 v40, 0, v16, s[28:29]
  v_cndmask_b32 v41, 0, v17, s[28:29]
  v_cndmask_b32 v42, 0, v18, s[28:29]
  v_cndmask_b32 v43, 0, v19, s[28:29]
  s_lshl_b64 s[28:29], s[28:29], 1
  s_nop 0
  v_mfma_f32_16x16x32_bf16 v[160:163], v[40:43], v[72:75], v[160:163]
  v_mfma_f32_16x16x32_bf16 v[164:167], v[40:43], v[88:91], v[164:167]
  v_mfma_f32_16x16x32_bf16 v[168:171], v[40:43], v[104:107], v[168:171]
  v_mfma_f32_16x16x32_bf16 v[172:175], v[40:43], v[120:123], v[172:175]
  v_mfma_f32_16x16x32_bf16 v[176:179], v[40:43], v[136:139], v[176:179]
  v_mfma_f32_16x16x32_bf16 v[180:183], v[40:43], v[152:155], v[180:183]
  v_cndmask_b32 v44, 0, v16, s[28:29]
  v_cndmask_b32 v45, 0, v17, s[28:29]
  v_cndmask_b32 v46, 0, v18, s[28:29]
  v_cndmask_b32 v47, 0, v19, s[28:29]
  s_lshl_b64 s[28:29], s[28:29], 1
  s_nop 0
  v_mfma_f32_16x16x32_bf16 v[160:163], v[44:47], v[76:79], v[160:163]
  v_mfma_f32_16x16x32_bf16 v[164:167], v[44:47], v[92:95], v[164:167]
  v_mfma_f32_16x16x32_bf16 v[168:171], v[44:47], v[108:111], v[168:171]
  v_mfma_f32_16x16x32_bf16 v[172:175], v[44:47], v[124:127], v[172:175]
  v_mfma_f32_16x16x32_bf16 v[176:179], v[44:47], v[140:143], v[176:179]
  v_mfma_f32_16x16x32_bf16 v[180:183], v[44:47], v[156:159], v[180:183]
  v_add_f32 v56, v56, v28
  v_add_f32 v57, v57, v29
  v_add_f32 v58, v58, v30
  v_add_f32 v59, v59, v31
  v_add_f32 v20, v56, v57
  v_mul_f32 v22, v56, v56
  v_add_f32 v21, v58, v59
  v_fmac_f32 v22, v57, v57
  v_add_f32 v20, v20, v21
  v_fmac_f32 v22, v58, v58
  v_fmac_f32 v22, v59, v59
  v_or_b32 v28, 1, v28
  v_or_b32 v30, 1, v30
  v_add_f32 v20, v20, v20 row_ror:8 row_mask:0xf bank_mask:0xf
  v_add_f32 v22, v22, v22 row_ror:8 row_mask:0xf bank_mask:0xf
  v_lshlrev_b32 v11, 4, v12
  v_add_f32 v20, v20, v20 row_bcast:15 row_mask:0xa bank_mask:0xf
  v_add_f32 v22, v22, v22 row_bcast:15 row_mask:0xa bank_mask:0xf
  s_mov_b32 exec_lo, 0x01010101
  s_mov_b32 exec_hi, 0x01010101
  buffer_store_dwordx4 v[28:31], v11, s[4:7], s26 offen offset:768 sc1
  buffer_store_dwordx4 v[28:31], v11, s[4:7], s25 offen offset:768 sc1
  s_mov_b64 exec, -1
  v_add_f32 v20, v20, v20 row_bcast:31 row_mask:0xc bank_mask:0xf
  v_add_f32 v22, v22, v22 row_bcast:31 row_mask:0xc bank_mask:0xf
  v_or_b32 v20, 1, v20
  v_or_b32 v22, 1, v22
  s_mov_b32 exec_lo, 0
  s_mov_b32 exec_hi, 0x80000000
  buffer_store_dwordx4 v[20:23], v4, s[4:7], s26 offen offset:896 sc1
  buffer_store_dwordx4 v[20:23], v4, s[4:7], s25 offen offset:896 sc1
  s_mov_b64 exec, 0xffff
  v_or_b32 v160, 1, v160
  v_or_b32 v162, 1, v162
  buffer_store_dwordx4 v[160:163], v3, s[4:7], s26 offen offset:0 sc1
  v_or_b32 v164, 1, v164
  v_or_b32 v166, 1, v166
  buffer_store_dwordx4 v[164:167], v3, s[4:7], s25 offen offset:0 sc1
  v_or_b32 v168, 1, v168
  v_or_b32 v170, 1, v170
  buffer_store_dwordx4 v[168:171], v3, s[4:7], s26 offen offset:256 sc1
  v_or_b32 v172, 1, v172
  v_or_b32 v174, 1, v174
  buffer_store_dwordx4 v[172:175], v3, s[4:7], s25 offen offset:256 sc1
  v_or_b32 v176, 1, v176
  v_or_b32 v178, 1, v178
  buffer_store_dwordx4 v[176:179], v3, s[4:7], s26 offen offset:512 sc1
  v_or_b32 v180, 1, v180
  v_or_b32 v182, 1, v182
  buffer_store_dwordx4 v[180:183], v3, s[4:7], s25 offen offset:512 sc1
  s_mov_b64 exec, -1
  s_cmp_eq_u32 s79, 0
  s_cbranch_scc1 .g2_kernel_c_no
  s_lshl_b32 s20, s18, 15
  s_add_u32 s20, s20, 0x1190000
  s_lshl_b32 s22, s18, 11
  s_add_u32 s22, s22, s20
  v_lshlrev_b32 v16, 10, v2
  s_sleep 16
  s_mov_b32 s38, 0
  s_mov_b32 exec_hi, 0
.g2_kernel_gx49:
  buffer_load_dword v17, v16, s[4:7], s20 offen offset:752 sc1
  s_add_u32 s38, s38, 1
  s_waitcnt vmcnt(0)
  v_min_u32 v6, v17, v17
  v_cmp_eq_u32 vcc, 0, v6
  s_cbranch_vccz .g2_kernel_gx49d
  s_mov_b64 exec, vcc
  s_sleep 6
  s_cmp_lt_u32 s38, 131072
  s_cbranch_scc1 .g2_kernel_gx49
.g2_kernel_gx49d:
  s_mov_b64 exec, -1
  s_mov_b32 s38, 0
  s_bfm_b64 exec, 57, 0
.g2_kernel_gx50:
  s_mov_b32 s21, s20
  buffer_load_dwordx4 v[64:67], v3, s[4:7], s21 offen offset:0 sc1
  buffer_load_dwordx4 v[68:71], v3, s[4:7], s21 offen offset:1024 sc1
  buffer_load_dwordx4 v[72:75], v3, s[4:7], s21 offen offset:2048 sc1
  buffer_load_dwordx4 v[76:79], v3, s[4:7], s21 offen offset:3072 sc1
  s_add_u32 s21, s21, 4096
  buffer_load_dwordx4 v[80:83], v3, s[4:7], s21 offen offset:0 sc1
  buffer_load_dwordx4 v[84:87], v3, s[4:7], s21 offen offset:1024 sc1
  buffer_load_dwordx4 v[88:91], v3, s[4:7], s21 offen offset:2048 sc1
  buffer_load_dwordx4 v[92:95], v3, s[4:7], s21 offen offset:3072 sc1
  s_add_u32 s21, s21, 4096
  buffer_load_dwordx4 v[96:99], v3, s[4:7], s21 offen offset:0 sc1
  buffer_load_dwordx4 v[100:103], v3, s[4:7], s21 offen offset:1024 sc1
  buffer_load_dwordx4 v[104:107], v3, s[4:7], s21 offen offset:2048 sc1
  buffer_load_dwordx4 v[108:111], v3, s[4:7], s21 offen offset:3072 sc1
  s_add_u32 s21, s21, 4096
  buffer_load_dwordx4 v[112:115], v3, s[4:7], s21 offen offset:0 sc1
  buffer_load_dwordx4 v[116:119], v3, s[4:7], s21 offen offset:1024 sc1
  buffer_load_dwordx4 v[120:123], v3, s[4:7], s21 offen offset:2048 sc1
  buffer_load_dwordx4 v[124:127], v3, s[4:7], s21 offen offset:3072 sc1
  s_add_u32 s21, s21, 4096
  buffer_load_dwordx4 v[128:131], v3, s[4:7], s21 offen offset:0 sc1
  buffer_load_dwordx4 v[132:135], v3, s[4:7], s21 offen offset:1024 sc1
  buffer_load_dwordx4 v[136:139], v3, s[4:7], s21 offen offset:2048 sc1
  buffer_load_dwordx4 v[140:143], v3, s[4:7], s21 offen offset:3072 sc1
  s_add_u32 s21, s21, 4096
  buffer_load_dwordx4 v[144:147], v3, s[4:7], s21 offen offset:0 sc1
  buffer_load_dwordx4 v[148:151], v3, s[4:7], s21 offen offset:1024 sc1
  buffer_load_dwordx4 v[152:155], v3, s[4:7], s21 offen offset:2048 sc1
  buffer_load_dwordx4 v[156:159], v3, s[4:7], s21 offen offset:3072 sc1
  s_add_u32 s21, s21, 4096
  buffer_load_dwordx4 v[160:163], v3, s[4:7], s21 offen offset:0 sc1
  buffer_load_dwordx4 v[164:167], v3, s[4:7], s21 offen offset:1024 sc1
  buffer_load_dwordx4 v[168:171], v3, s[4:7], s21 offen offset:2048 sc1
  buffer_load_dwordx4 v[172:175], v3, s[4:7], s21 offen offset:3072 sc1
  s_add_u32 s21, s21, 4096
  buffer_load_dwordx4 v[176:179], v3, s[4:7], s21 offen offset:0 sc1
  buffer_load_dwordx4 v[180:183], v3, s[4:7], s21 offen offset:1024 sc1
  buffer_load_dwordx4 v[184:187], v3, s[4:7], s21 offen offset:2048 sc1
  buffer_load_dwordx4 v[188:191], v3, s[4:7], s21 offen offset:3072 sc1
  s_add_u32 s21, s21, 4096
  buffer_load_dwordx4 v[192:195], v3, s[4:7], s22 offen offset:0 sc1
  buffer_load_dwordx4 v[196:199], v3, s[4:7], s22 offen offset:1024 sc1
  s_add_u32 s38, s38, 1
  s_waitcnt vmcnt(0)
  v_min3_u32 v6, v64, v66, v68
  v_min3_u32 v6, v6, v70, v72
  v_min3_u32 v6, v6, v74, v76
  v_min3_u32 v6, v6, v78, v80
  v_min3_u32 v6, v6, v82, v84
  v_min3_u32 v6, v6, v86, v88
  v_min3_u32 v6, v6, v90, v92
  v_min3_u32 v6, v6, v94, v96
  v_min3_u32 v6, v6, v98, v100
  v_min3_u32 v6, v6, v102, v104
  v_min3_u32 v6, v6, v106, v108
  v_min3_u32 v6, v6, v110, v112
  v_min3_u32 v6, v6, v114, v116
  v_min3_u32 v6, v6, v118, v120
  v_min3_u32 v6, v6, v122, v124
  v_min3_u32 v6, v6, v126, v128
  v_min3_u32 v6, v6, v130, v132
  v_min3_u32 v6, v6, v134, v136
  v_min3_u32 v6, v6, v138, v140
  v_min3_u32 v6, v6, v142, v144
  v_min3_u32 v6, v6, v146, v148
  v_min3_u32 v6, v6, v150, v152
  v_min3_u32 v6, v6, v154, v156
  v_min3_u32 v6, v6, v158, v160
  v_min3_u32 v6, v6, v162, v164
  v_min3_u32 v6, v6, v166, v168
  v_min3_u32 v6, v6, v170, v172
  v_min3_u32 v6, v6, v174, v176
  v_min3_u32 v6, v6, v178, v180
  v_min3_u32 v6, v6, v182, v184
  v_min3_u32 v6, v6, v186, v188
  v_min3_u32 v6, v6, v190, v192
  v_min3_u32 v6, v6, v194, v196
  v_min_u32 v6, v6, v198
  v_cmp_eq_u32 vcc, 0, v6
  s_cbranch_vccz .g2_kernel_gx50d
  s_mov_b64 exec, vcc
  s_sleep 2
  s_cmp_lt_u32 s38, 131072
  s_cbranch_scc1 .g2_kernel_gx50
.g2_kernel_gx50d:
  s_mov_b64 exec, -1
  v_add_f32 v64, v64, v128
  v_add_f32 v65, v65, v129
  v_add_f32 v66, v66, v130
  v_add_f32 v67, v67, v131
  v_add_f32 v68, v68, v132
  v_add_f32 v69, v69, v133
  v_add_f32 v70, v70, v134
  v_add_f32 v71, v71, v135
  v_add_f32 v72, v72, v136
  v_add_f32 v73, v73, v137
  v_add_f32 v74, v74, v138
  v_add_f32 v75, v75, v139
  v_add_f32 v76, v76, v140
  v_add_f32 v77, v77, v141
  v_add_f32 v78, v78, v142
  v_add_f32 v79, v79, v143
  v_add_f32 v80, v80, v144
  v_add_f32 v81, v81, v145
  v_add_f32 v82, v82, v146
  v_add_f32 v83, v83, v147
  v_add_f32 v84, v84, v148
  v_add_f32 v85, v85, v149
  v_add_f32 v86, v86, v150
  v_add_f32 v87, v87, v151
  v_add_f32 v88, v88, v152
  v_add_f32 v89, v89, v153
  v_add_f32 v90, v90, v154
  v_add_f32 v91, v91, v155
  v_add_f32 v92, v92, v156
  v_add_f32 v93, v93, v157
  v_add_f32 v94, v94, v158
  v_add_f32 v95, v95, v159
  v_add_f32 v96, v96, v160
  v_add_f32 v97, v97, v161
  v_add_f32 v98, v98, v162
  v_add_f32 v99, v99, v163
  v_add_f32 v100, v100, v164
  v_add_f32 v101, v101, v165
  v_add_f32 v102, v102, v166
  v_add_f32 v103, v103, v167
  v_add_f32 v104, v104, v168
  v_add_f32 v105, v105, v169
  v_add_f32 v106, v106, v170
  v_add_f32 v107, v107, v171
  v_add_f32 v108, v108, v172
  v_add_f32 v109, v109, v173
  v_add_f32 v110, v110, v174
  v_add_f32 v111, v111, v175
  v_add_f32 v112, v112, v176
  v_add_f32 v113, v113, v177
  v_add_f32 v114, v114, v178
  v_add_f32 v115, v115, v179
  v_add_f32 v116, v116, v180
  v_add_f32 v117, v117, v181
  v_add_f32 v118, v118, v182
  v_add_f32 v119, v119, v183
  v_add_f32 v120, v120, v184
  v_add_f32 v121, v121, v185
  v_add_f32 v122, v122, v186
  v_add_f32 v123, v123, v187
  v_add_f32 v124, v124, v188
  v_add_f32 v125, v125, v189
  v_add_f32 v126, v126, v190
  v_add_f32 v127, v127, v191
  v_add_f32 v64, v64, v96
  v_add_f32 v65, v65, v97
  v_add_f32 v66, v66, v98
  v_add_f32 v67, v67, v99
  v_add_f32 v68, v68, v100
  v_add_f32 v69, v69, v101
  v_add_f32 v70, v70, v102
  v_add_f32 v71, v71, v103
  v_add_f32 v72, v72, v104
  v_add_f32 v73, v73, v105
  v_add_f32 v74, v74, v106
  v_add_f32 v75, v75, v107
  v_add_f32 v76, v76, v108
  v_add_f32 v77, v77, v109
  v_add_f32 v78, v78, v110
  v_add_f32 v79, v79, v111
  v_add_f32 v80, v80, v112
  v_add_f32 v81, v81, v113
  v_add_f32 v82, v82, v114
  v_add_f32 v83, v83, v115
  v_add_f32 v84, v84, v116
  v_add_f32 v85, v85, v117
  v_add_f32 v86, v86, v118
  v_add_f32 v87, v87, v119
  v_add_f32 v88, v88, v120
  v_add_f32 v89, v89, v121
  v_add_f32 v90, v90, v122
  v_add_f32 v91, v91, v123
  v_add_f32 v92, v92, v124
  v_add_f32 v93, v93, v125
  v_add_f32 v94, v94, v126
  v_add_f32 v95, v95, v127
  v_add_f32 v64, v64, v80
  v_add_f32 v65, v65, v81
  v_add_f32 v66, v66, v82
  v_add_f32 v67, v67, v83
  v_add_f32 v68, v68, v84
  v_add_f32 v69, v69, v85
  v_add_f32 v70, v70, v86
  v_add_f32 v71, v71, v87
  v_add_f32 v72, v72, v88
  v_add_f32 v73, v73, v89
  v_add_f32 v74, v74, v90
  v_add_f32 v75, v75, v91
  v_add_f32 v76, v76, v92
  v_add_f32 v77, v77, v93
  v_add_f32 v78, v78, v94
  v_add_f32 v79, v79, v95
  v_add_f32 v64, v64, v72
  v_add_f32 v65, v65, v73
  v_add_f32 v66, v66, v74
  v_add_f32 v67, v67, v75
  v_add_f32 v68, v68, v76
  v_add_f32 v69, v69, v77
  v_add_f32 v70, v70, v78
  v_add_f32 v71, v71, v79
  v_add_f32 v64, v64, v68
  v_add_f32 v65, v65, v69
  v_add_f32 v66, v66, v70
  v_add_f32 v67, v67, v71
  v_mov_b32 v28, 0.0009765625
  v_mov_b32 v30, 1e-05
  v_readlane_b32 s21, v64, 56
  v_readlane_b32 s22, v66, 56
  s_nop 0
  v_mul_f32 v20, s21, v28
  v_fma_f32 v21, s22, v28, v30
  v_fma_f32 v21, -v20, v20, v21
  v_rsq_f32 v21, abs(v21)
  v_sub_f32 v20, v61, v20
  v_mul_f32 v22, v21, v60
  v_mul_f32 v23, v21, v20
  v_and_b32 v10, 15, v2
  v_lshrrev_b32 v11, 4, v2
  v_lshlrev_b32 v16, 2, v10
  v_lshl_add_u32 v16, v11, 8, v16
  v_add_u32 v16, 155648, v16
  s_sub_u32 s20, s79, 1
  s_and_b32 s21, s20, 3
  s_lshl_b32 s21, s21, 2
  s_add_u32 s21, s21, 156160
  v_lshl_add_u32 v17, v10, 4, s21
  v_cmp_eq_u32 vcc, 2, v11
  v_mov_b32 v18, 64
  v_mov_b32 v19, 256
  v_cndmask_b32 v17, v16, v17, vcc
  v_cndmask_b32 v18, v18, v19, vcc
  v_lshrrev_b32 v24, 2, v10
  v_lshlrev_b32 v24, 9, v24
  v_and_b32 v25, 3, v10
  v_lshl_add_u32 v24, v25, 1, v24
  s_and_b32 s21, s20, 31
  s_lshl_b32 s22, s21, 4
  s_lshr_b32 s23, s20, 5
  s_lshl_b32 s24, s23, 11
  s_add_u32 s22, s22, s24
  s_add_u32 s22, s22, 131072
  v_add_u32 v26, s22, v24
  s_and_b32 s22, s21, 7
  s_and_b32 s24, s21, 8
  s_lshl_b32 s24, s24, 1
  s_add_u32 s22, s22, s24
  s_and_b32 s24, s21, 16
  s_lshr_b32 s24, s24, 1
  s_add_u32 s22, s22, s24
  s_lshl_b32 s22, s22, 4
  v_add_u32 v24, s22, v24
  s_bfe_u32 s22, s21, 0x20002
  s_lshl_b32 s22, s22, 9
  s_add_u32 s22, s22, s24
  s_and_b32 s24, s21, 3
  s_lshl_b32 s24, s24, 1
  s_add_u32 s22, s22, s24
  s_add_u32 s22, s22, 2048
  v_lshl_add_u32 v25, v10, 4, s22
  v_cndmask_b32 v24, v24, v25, vcc
  v_cndmask_b32 v19, 8, v19, vcc
  v_add_u32 v25, v24, v19
  s_lshl_b32 s22, s18, 7
  s_lshl_b32 s24, s17, 2
  s_add_u32 s22, s22, s24
  s_add_u32 s22, s22, s23
  s_lshl_b32 s22, s22, 12
  s_add_u32 s22, s22, 0x1800000
  s_add_u32 s23, s22, 262144
  s_lshr_b32 s24, s20, 6
  s_lshl_b32 s24, s24, 8
  s_add_u32 s24, s24, s76
  v_cmp_eq_u32 vcc, 0, v11
  v_mov_b32 v27, 0.25503486164919736
  s_nop 0
  v_cndmask_b32 v27, 1.0, v27, vcc
  v_mul_f32 v21, v21, v27
  v_mul_f32 v22, v22, v27
  v_mul_f32 v23, v23, v27
  s_mov_b32 s62, 1
  s_mov_b32 s63, 0x1800000
  s_mov_b32 s70, 2
  s_mov_b32 s71, 155776
  v_mov_b32 v6, s71
  s_mov_b32 s38, 0
.g2_kernel_wg51:
  ds_read_b32 v7, v6 offset:56
  s_add_u32 s38, s38, 1
  s_waitcnt lgkmcnt(0)
  v_cmp_le_u32 vcc, 2, v7
  s_cbranch_vccnz .g2_kernel_wg51d
  s_sleep 1
  s_cmp_lt_u32 s38, 524288
  s_cbranch_scc1 .g2_kernel_wg51
.g2_kernel_wg51d:
  ds_read_b32 v32, v17 offset:5632
  ds_read_b32 v36, v16 offset:4864
  v_add_u32 v17, v17, v18
  ds_read_b32 v33, v17 offset:5632
  ds_read_b32 v37, v16 offset:4928
  v_add_u32 v17, v17, v18
  ds_read_b32 v34, v17 offset:5632
  ds_read_b32 v38, v16 offset:4992
  v_add_u32 v17, v17, v18
  ds_read_b32 v35, v17 offset:5632
  ds_read_b32 v39, v16 offset:5056
  s_waitcnt lgkmcnt(0)
  v_mul_f32 v32, v32, v22
  v_fmac_f32 v32, v64, v21
  v_fmac_f32 v32, v36, v23
  v_mul_f32 v33, v33, v22
  v_fmac_f32 v33, v65, v21
  v_fmac_f32 v33, v37, v23
  v_mul_f32 v34, v34, v22
  v_fmac_f32 v34, v66, v21
  v_fmac_f32 v34, v38, v23
  v_mul_f32 v35, v35, v22
  v_fmac_f32 v35, v67, v21
  v_fmac_f32 v35, v39, v23
  v_cvt_pk_bf16_f32 v32, v32, v33
  v_cvt_pk_bf16_f32 v34, v34, v35
  v_mov_b32 v9, s71
  v_mov_b32 v8, 2
  s_mov_b32 exec_lo, 0xffff0000
  s_mov_b32 exec_hi, 0xffff
  buffer_store_short v32, v24, s[4:7], s22 offen sc1
  buffer_store_short_d16_hi v32, v25, s[4:7], s22 offen sc1
  buffer_store_short v34, v24, s[4:7], s23 offen sc1
  buffer_store_short_d16_hi v34, v25, s[4:7], s23 offen sc1
  s_mov_b64 exec, 0xffff
  ds_write_b16 v26, v32 offset:8192
  ds_write_b16_d16_hi v26, v32 offset:8200
  ds_write_b16 v26, v34
  ds_write_b16_d16_hi v26, v34 offset:8
  ds_write_b32 v9, v5 offset:60
  s_mov_b32 exec_lo, 0
  s_mov_b32 exec_hi, 0xff0000
  ds_write_b32 v16, v192 offset:6912
  ds_write_b32 v16, v193 offset:6976
  ds_write_b32 v16, v194 offset:7040
  ds_write_b32 v16, v195 offset:7104
  ds_write_b32 v16, v196 offset:6944
  ds_write_b32 v16, v197 offset:7008
  ds_write_b32 v16, v198 offset:7072
  ds_write_b32 v16, v199 offset:7136
  s_mov_b64 exec, 1
  s_waitcnt vmcnt(0)
  buffer_store_dword v8, v4, s[4:7], s24 offen sc1
  buffer_store_dword v8, v4, s[4:7], s24 offen offset:128 sc1
  s_mov_b64 exec, -1
  s_branch .g2_kernel_v
.g2_kernel_c_no:
  s_mov_b32 s62, 1
  s_mov_b32 s63, 0x1800000
  s_mov_b32 s70, 2
  s_mov_b32 s71, 155776
  s_branch .g2_kernel_v
.g2_kernel_c_t3:
  s_lshr_b32 s33, s77, 7
  s_lshl_b32 s28, s33, 4
  s_lshl_b64 s[34:35], 0xffff, s28
  s_lshr_b32 s28, s33, 2
  s_cmp_eq_u32 s28, 0
  s_cselect_b64 s[8:9], s[34:35], 0
  s_cmp_eq_u32 s28, 1
  s_cselect_b64 s[10:11], s[34:35], 0
  s_cmp_eq_u32 s28, 2
  s_cselect_b64 s[12:13], s[34:35], 0
  s_cmp_eq_u32 s28, 3
  s_cselect_b64 s[14:15], s[34:35], 0
  s_lshl_b32 s21, s17, 10
  s_add_u32 s21, s21, 0x2880000
  v_lshlrev_b32 v14, 3, v2
  v_add_u32 v14, 155648, v14
  v_mov_b32 v9, s71
  s_cmp_eq_u32 s33, s17
  s_cbranch_scc0 .g2_kernel_c_u1
  s_sleep 6
  s_call_b64 s[72:73], .g2_kernel_c_ph2
  s_branch .g2_kernel_c_u2
.g2_kernel_c_u1:
  v_mov_b32 v6, s71
  s_mov_b32 s38, 0
.g2_kernel_wg52:
  ds_read_b32 v7, v6 offset:36
  s_add_u32 s38, s38, 1
  s_waitcnt lgkmcnt(0)
  v_cmp_le_u32 vcc, 1, v7
  s_cbranch_vccnz .g2_kernel_wg52d
  s_sleep 1
  s_cmp_lt_u32 s38, 524288
  s_cbranch_scc1 .g2_kernel_wg52
.g2_kernel_wg52d:
  v_readfirstlane_b32 s77, v7
  s_sub_u32 s77, s77, 1
.g2_kernel_c_u2:
  s_mov_b32 s38, 0
.g2_kernel_gx53:
  buffer_load_dwordx4 v[16:19], v3, s[4:7], s21 offen sc1
  s_add_u32 s38, s38, 1
  s_waitcnt vmcnt(0)
  v_min_u32 v6, v17, v19
  v_cmp_eq_u32 vcc, 0, v6
  s_cbranch_vccz .g2_kernel_gx53d
  s_mov_b64 exec, vcc
  s_cmp_lt_u32 s38, 131072
  s_cbranch_scc1 .g2_kernel_gx53
.g2_kernel_gx53d:
  s_mov_b64 exec, -1
  s_lshr_b32 s28, s77, 7
  s_and_b32 s79, s77, 127
  s_add_u32 s79, s79, 1
  s_cmp_eq_u32 s28, s17
  s_cselect_b32 s79, s79, 0
  v_rsq_f32 v22, v17
  v_rsq_f32 v23, v19
  v_mov_b32 v15, s79
  v_add_f32 v52, 1.0, v22
  v_mul_f32 v54, v16, v22
  v_sub_f32 v54, 0, v54
  v_add_f32 v53, 1.0, v23
  v_mul_f32 v55, v18, v23
  v_sub_f32 v55, 0, v55
  ds_write_b64 v14, v[52:53] offset:3840
  ds_write_b64 v14, v[54:55] offset:4352
  ds_write_b32 v9, v15 offset:32
  ds_write_b32 v9, v5 offset:28
  s_cmp_eq_u32 s33, s17
  s_cbranch_scc1 .g2_kernel_fin
  s_sleep 40
  s_mov_b32 s39, 1
  s_call_b64 s[72:73], .g2_kernel_c_ph2
  s_branch .g2_kernel_fin
.g2_kernel_c_ph2:
  s_call_b64 s[68:69], .g2_kernel_amax
  v_mov_b32 v6, s71
  s_mov_b32 s38, 0
.g2_kernel_wg54:
  ds_read_b32 v7, v6 offset:36
  s_add_u32 s38, s38, 1
  s_waitcnt lgkmcnt(0)
  v_cmp_le_u32 vcc, 1, v7
  s_cbranch_vccnz .g2_kernel_wg54d
  s_cmp_lt_u32 s38, 524288
  s_cbranch_scc1 .g2_kernel_wg54
.g2_kernel_wg54d:
  ds_read_b32 v8, v9 offset:96
  v_readfirstlane_b32 s28, v7
  s_sub_u32 s28, s28, 1
  s_add_u32 s29, s77, 2
  s_waitcnt lgkmcnt(0)
  v_cmp_gt_f32 vcc, s27, v8
  s_cmp_lg_u64 vcc, 0
  s_cselect_b32 s77, s77, s28
  s_cselect_b32 s29, s29, 1
  v_mov_b32 v10, s29
  v_mov_b32 v11, s27
  ds_write_b64 v9, v[10:11] offset:88
  s_setpc_b64 s[72:73]
.g2_kernel_c2:
  s_cmp_lg_u32 s62, 0
  s_cbranch_scc1 .g2_kernel_d_a
  s_cmp_lg_u32 s16, 7
  s_cbranch_scc1 .g2_kernel_d_a
  v_mov_b32 v6, s71
  s_mov_b32 s38, 0
.g2_kernel_wg57:
  ds_read_b32 v7, v6 offset:20
  s_add_u32 s38, s38, 1
  s_waitcnt lgkmcnt(0)
  v_cmp_le_u32 vcc, 4, v7
  s_cbranch_vccnz .g2_kernel_wg57d
  s_sleep 2
  s_cmp_lt_u32 s38, 524288
  s_cbranch_scc1 .g2_kernel_wg57
.g2_kernel_wg57d:
  s_sleep 20
  s_and_b32 s31, s19, 0xffffe000
  s_add_u32 s31, s31, 8
  v_and_b32 v6, 15, v2
  v_lshlrev_b32 v6, 9, v6
  v_lshrrev_b32 v7, 4, v2
  v_lshl_add_u32 v6, v7, 7, v6
  v_lshlrev_b32 v7, 2, v2
  v_add_u32 v7, 158208, v7
  s_mov_b32 m0, 158208
  s_mov_b32 s38, 0
.g2_kernel_pa58:
  buffer_load_dword v6, s[4:7], s31 offen sc1 lds
  s_add_u32 s38, s38, 1
  s_waitcnt vmcnt(0)
  ds_read_b32 v8, v7
  s_waitcnt lgkmcnt(0)
  v_cmp_ge_u32 vcc, s62, v8
  s_cbranch_vccz .g2_kernel_pa58d
  s_mov_b64 exec, vcc
  s_sleep 10
  s_cmp_lt_u32 s38, 131072
  s_cbranch_scc1 .g2_kernel_pa58
.g2_kernel_pa58d:
  s_mov_b64 exec, -1
.g2_kernel_d_a:
  s_setprio 2
  s_and_b32 s20, s16, 1
  v_bfe_u32 v8, v2, 1, 3
  v_lshlrev_b32 v8, 14, v8
  v_and_b32 v9, 1, v2
  v_lshl_add_u32 v8, v9, 10, v8
  v_lshrrev_b32 v9, 4, v2
  v_lshl_add_u32 v8, v9, 8, v8
  v_and_b32 v9, 15, v2
  v_lshlrev_b32 v9, 3, v9
  s_lshl_b32 s28, s20, 7
  s_add_u32 s28, s28, 163584
  v_add_u32 v10, s28, v9
  v_xor_b32 v11, 128, v10
  s_lshl_b32 s28, s20, 2
  s_add_u32 s28, s28, s71
  v_mov_b32 v12, s28
  v_xor_b32 v13, 4, v12
  s_lshl_b32 s26, s17, 4
  s_add_u32 s26, s26, s18
  s_lshl_b32 s26, s26, 1
  s_add_u32 s26, s26, s20
  s_lshl_b32 s26, s26, 11
  s_add_u32 s26, s26, s63
  s_add_u32 s26, s26, 0x1090000
  s_mov_b32 s32, 0
  s_mov_b32 s39, 0
  s_lshl_b32 s28, s62, 3
  s_add_u32 s28, s28, s16
  s_cmp_lg_u32 s28, 14
  s_cbranch_scc1 .g2_kernel_d_w
  s_lshr_b32 s33, s77, 7
  s_lshl_b32 s28, s33, 4
  s_lshl_b64 s[34:35], 0xffff, s28
  s_lshr_b32 s28, s33, 2
  s_cmp_eq_u32 s28, 0
  s_cselect_b64 s[8:9], s[34:35], 0
  s_cmp_eq_u32 s28, 1
  s_cselect_b64 s[10:11], s[34:35], 0
  s_cmp_eq_u32 s28, 2
  s_cselect_b64 s[12:13], s[34:35], 0
  s_cmp_eq_u32 s28, 3
  s_cselect_b64 s[14:15], s[34:35], 0
  s_not_b64 s[8:9], s[8:9]
  s_not_b64 s[10:11], s[10:11]
  s_not_b64 s[12:13], s[12:13]
  s_not_b64 s[14:15], s[14:15]
  s_and_b32 s28, s2, 7
  s_lshl_b32 s28, s28, 13
  s_add_u32 s23, s28, 0x3050000
  s_cmp_eq_u32 s33, s17
  s_cbranch_scc1 .g2_kernel_d_v
  v_mov_b32 v6, s71
  s_mov_b32 s38, 0
.g2_kernel_wg59:
  ds_read_b32 v7, v6 offset:20
  s_add_u32 s38, s38, 1
  s_waitcnt lgkmcnt(0)
  v_cmp_le_u32 vcc, 4, v7
  s_cbranch_vccnz .g2_kernel_wg59d
  s_sleep 1
  s_cmp_lt_u32 s38, 524288
  s_cbranch_scc1 .g2_kernel_wg59
.g2_kernel_wg59d:
.g2_kernel_d_v:
  s_sleep 60
  s_call_b64 s[68:69], .g2_kernel_amax
  s_add_u32 s28, s77, 1
  v_mov_b32 v6, s27
  v_mov_b32 v7, s28
  ds_write_b32 v12, v6 offset:96
  ds_write_b32 v12, v7 offset:36
  s_waitcnt lgkmcnt(0)
  s_wakeup
  s_branch .g2_kernel_d_r
.g2_kernel_d_w:
  v_mov_b32 v6, s71
  s_mov_b32 s38, 0
.g2_kernel_wg60:
  ds_read_b32 v7, v6 offset:36
  s_add_u32 s38, s38, 1
  s_waitcnt lgkmcnt(0)
  v_cmp_le_u32 vcc, 1, v7
  s_cbranch_vccnz .g2_kernel_wg60d
  s_sleep 4
  s_cmp_lt_u32 s38, 524288
  s_cbranch_scc1 .g2_kernel_wg60
.g2_kernel_wg60d:
  v_readfirstlane_b32 s77, v7
  s_sub_u32 s77, s77, 1
.g2_kernel_d_r:
  s_and_b32 s77, s77, 2047
  s_lshr_b32 s24, s77, 7
  s_lshl_b32 s24, s24, 18
  s_bfe_u32 s28, s77, 0x30004
  s_lshl_b32 s28, s28, 11
  s_add_u32 s24, s24, s28
  s_and_b32 s28, s77, 15
  s_lshl_b32 s28, s28, 4
  s_add_u32 s24, s24, s28
  s_add_u32 s24, s24, s63
  s_add_u32 s24, s24, 0xc00000
  s_lshl_b32 s28, s17, 14
  s_add_u32 s21, s24, s28
  s_and_b32 s28, s18, 8
  s_lshl_b32 s28, s28, 5
  s_add_u32 s21, s21, s28
  s_and_b32 s28, s18, 7
  s_lshl_b32 s28, s28, 1
  s_add_u32 s21, s21, s28
  s_lshl_b32 s28, s20, 17
  s_add_u32 s24, s24, s28
  buffer_load_dwordx4 v[16:19], v8, s[4:7], s24 offen
  buffer_load_ushort v56, v4, s[4:7], s21 offen
  buffer_load_ushort v57, v4, s[4:7], s21 offen offset:512
  buffer_load_ushort v58, v4, s[4:7], s21 offen offset:1024
  buffer_load_ushort v59, v4, s[4:7], s21 offen offset:1536
  s_lshl_b32 s25, s77, 3
  s_add_u32 s25, s25, s63
  s_add_u32 s25, s25, 0x1080000
  s_mov_b32 s38, 0
.g2_kernel_gx61:
  buffer_load_dwordx2 v[20:21], v4, s[4:7], s25 offen sc1
  s_add_u32 s38, s38, 1
  s_waitcnt vmcnt(0)
  v_min_u32 v6, v21, v21
  v_cmp_eq_u32 vcc, 0, v6
  s_cbranch_vccz .g2_kernel_gx61d
  s_mov_b64 exec, vcc
  s_sleep 1
  s_cmp_lt_u32 s38, 131072
  s_cbranch_scc1 .g2_kernel_gx61
.g2_kernel_gx61d:
  s_mov_b64 exec, -1
  v_rsq_f32 v21, v21
  v_lshlrev_b32 v24, 16, v16
  v_and_b32 v25, 0xffff0000, v16
  v_lshlrev_b32 v26, 16, v17
  v_and_b32 v27, 0xffff0000, v17
  v_lshlrev_b32 v28, 16, v18
  v_and_b32 v29, 0xffff0000, v18
  v_lshlrev_b32 v30, 16, v19
  v_and_b32 v31, 0xffff0000, v19
  v_mul_f32 v20, v20, v21
  v_mov_b32 v60, v20
  v_add_f32 v61, 1.0, v21
  s_cmp_ge_u32 s17, 14
  s_cbranch_scc1 .g2_kernel_d_none
  v_fma_f32 v24, v24, v21, -v20
  v_fma_f32 v25, v25, v21, -v20
  v_fma_f32 v26, v26, v21, -v20
  v_fma_f32 v27, v27, v21, -v20
  v_fma_f32 v28, v28, v21, -v20
  v_fma_f32 v29, v29, v21, -v20
  v_fma_f32 v30, v30, v21, -v20
  v_fma_f32 v31, v31, v21, -v20
  v_cvt_pk_bf16_f32 v16, v24, v25
  v_cvt_pk_bf16_f32 v17, v26, v27
  v_cvt_pk_bf16_f32 v18, v28, v29
  v_cvt_pk_bf16_f32 v19, v30, v31
  v_mov_b32 v24, v16 row_newbcast:0 row_mask:0xf bank_mask:0xf
  v_mov_b32 v25, v17 row_newbcast:0 row_mask:0xf bank_mask:0xf
  v_mov_b32 v26, v18 row_newbcast:0 row_mask:0xf bank_mask:0xf
  v_mov_b32 v27, v19 row_newbcast:0 row_mask:0xf bank_mask:0xf
  v_mov_b32 v28, v16 row_newbcast:1 row_mask:0xf bank_mask:0xf
  v_mov_b32 v29, v17 row_newbcast:1 row_mask:0xf bank_mask:0xf
  v_mov_b32 v30, v18 row_newbcast:1 row_mask:0xf bank_mask:0xf
  v_mov_b32 v31, v19 row_newbcast:1 row_mask:0xf bank_mask:0xf
  v_mfma_f32_16x16x32_bf16 v[32:35], v[24:27], v[64:67], 0
  v_mfma_f32_16x16x32_bf16 v[36:39], v[24:27], v[128:131], 0
  v_mov_b32 v24, v16 row_newbcast:2 row_mask:0xf bank_mask:0xf
  v_mov_b32 v25, v17 row_newbcast:2 row_mask:0xf bank_mask:0xf
  v_mov_b32 v26, v18 row_newbcast:2 row_mask:0xf bank_mask:0xf
  v_mov_b32 v27, v19 row_newbcast:2 row_mask:0xf bank_mask:0xf
  v_mfma_f32_16x16x32_bf16 v[32:35], v[28:31], v[68:71], v[32:35]
  v_mfma_f32_16x16x32_bf16 v[36:39], v[28:31], v[132:135], v[36:39]
  v_mov_b32 v28, v16 row_newbcast:3 row_mask:0xf bank_mask:0xf
  v_mov_b32 v29, v17 row_newbcast:3 row_mask:0xf bank_mask:0xf
  v_mov_b32 v30, v18 row_newbcast:3 row_mask:0xf bank_mask:0xf
  v_mov_b32 v31, v19 row_newbcast:3 row_mask:0xf bank_mask:0xf
  v_mfma_f32_16x16x32_bf16 v[32:35], v[24:27], v[72:75], v[32:35]
  v_mfma_f32_16x16x32_bf16 v[36:39], v[24:27], v[136:139], v[36:39]
  v_mov_b32 v24, v16 row_newbcast:4 row_mask:0xf bank_mask:0xf
  v_mov_b32 v25, v17 row_newbcast:4 row_mask:0xf bank_mask:0xf
  v_mov_b32 v26, v18 row_newbcast:4 row_mask:0xf bank_mask:0xf
  v_mov_b32 v27, v19 row_newbcast:4 row_mask:0xf bank_mask:0xf
  v_mfma_f32_16x16x32_bf16 v[32:35], v[28:31], v[76:79], v[32:35]
  v_mfma_f32_16x16x32_bf16 v[36:39], v[28:31], v[140:143], v[36:39]
  v_mov_b32 v28, v16 row_newbcast:5 row_mask:0xf bank_mask:0xf
  v_mov_b32 v29, v17 row_newbcast:5 row_mask:0xf bank_mask:0xf
  v_mov_b32 v30, v18 row_newbcast:5 row_mask:0xf bank_mask:0xf
  v_mov_b32 v31, v19 row_newbcast:5 row_mask:0xf bank_mask:0xf
  v_mfma_f32_16x16x32_bf16 v[32:35], v[24:27], v[80:83], v[32:35]
  v_mfma_f32_16x16x32_bf16 v[36:39], v[24:27], v[144:147], v[36:39]
  v_mov_b32 v24, v16 row_newbcast:6 row_mask:0xf bank_mask:0xf
  v_mov_b32 v25, v17 row_newbcast:6 row_mask:0xf bank_mask:0xf
  v_mov_b32 v26, v18 row_newbcast:6 row_mask:0xf bank_mask:0xf
  v_mov_b32 v27, v19 row_newbcast:6 row_mask:0xf bank_mask:0xf
  v_mfma_f32_16x16x32_bf16 v[32:35], v[28:31], v[84:87], v[32:35]
  v_mfma_f32_16x16x32_bf16 v[36:39], v[28:31], v[148:151], v[36:39]
  v_mov_b32 v28, v16 row_newbcast:7 row_mask:0xf bank_mask:0xf
  v_mov_b32 v29, v17 row_newbcast:7 row_mask:0xf bank_mask:0xf
  v_mov_b32 v30, v18 row_newbcast:7 row_mask:0xf bank_mask:0xf
  v_mov_b32 v31, v19 row_newbcast:7 row_mask:0xf bank_mask:0xf
  v_mfma_f32_16x16x32_bf16 v[32:35], v[24:27], v[88:91], v[32:35]
  v_mfma_f32_16x16x32_bf16 v[36:39], v[24:27], v[152:155], v[36:39]
  v_mov_b32 v24, v16 row_newbcast:8 row_mask:0xf bank_mask:0xf
  v_mov_b32 v25, v17 row_newbcast:8 row_mask:0xf bank_mask:0xf
  v_mov_b32 v26, v18 row_newbcast:8 row_mask:0xf bank_mask:0xf
  v_mov_b32 v27, v19 row_newbcast:8 row_mask:0xf bank_mask:0xf
  v_mfma_f32_16x16x32_bf16 v[32:35], v[28:31], v[92:95], v[32:35]
  v_mfma_f32_16x16x32_bf16 v[36:39], v[28:31], v[156:159], v[36:39]
  v_mov_b32 v28, v16 row_newbcast:9 row_mask:0xf bank_mask:0xf
  v_mov_b32 v29, v17 row_newbcast:9 row_mask:0xf bank_mask:0xf
  v_mov_b32 v30, v18 row_newbcast:9 row_mask:0xf bank_mask:0xf
  v_mov_b32 v31, v19 row_newbcast:9 row_mask:0xf bank_mask:0xf
  v_mfma_f32_16x16x32_bf16 v[32:35], v[24:27], v[96:99], v[32:35]
  v_mfma_f32_16x16x32_bf16 v[36:39], v[24:27], v[160:163], v[36:39]
  v_mov_b32 v24, v16 row_newbcast:10 row_mask:0xf bank_mask:0xf
  v_mov_b32 v25, v17 row_newbcast:10 row_mask:0xf bank_mask:0xf
  v_mov_b32 v26, v18 row_newbcast:10 row_mask:0xf bank_mask:0xf
  v_mov_b32 v27, v19 row_newbcast:10 row_mask:0xf bank_mask:0xf
  v_mfma_f32_16x16x32_bf16 v[32:35], v[28:31], v[100:103], v[32:35]
  v_mfma_f32_16x16x32_bf16 v[36:39], v[28:31], v[164:167], v[36:39]
  v_mov_b32 v28, v16 row_newbcast:11 row_mask:0xf bank_mask:0xf
  v_mov_b32 v29, v17 row_newbcast:11 row_mask:0xf bank_mask:0xf
  v_mov_b32 v30, v18 row_newbcast:11 row_mask:0xf bank_mask:0xf
  v_mov_b32 v31, v19 row_newbcast:11 row_mask:0xf bank_mask:0xf
  v_mfma_f32_16x16x32_bf16 v[32:35], v[24:27], v[104:107], v[32:35]
  v_mfma_f32_16x16x32_bf16 v[36:39], v[24:27], v[168:171], v[36:39]
  v_mov_b32 v24, v16 row_newbcast:12 row_mask:0xf bank_mask:0xf
  v_mov_b32 v25, v17 row_newbcast:12 row_mask:0xf bank_mask:0xf
  v_mov_b32 v26, v18 row_newbcast:12 row_mask:0xf bank_mask:0xf
  v_mov_b32 v27, v19 row_newbcast:12 row_mask:0xf bank_mask:0xf
  v_mfma_f32_16x16x32_bf16 v[32:35], v[28:31], v[108:111], v[32:35]
  v_mfma_f32_16x16x32_bf16 v[36:39], v[28:31], v[172:175], v[36:39]
  v_mov_b32 v28, v16 row_newbcast:13 row_mask:0xf bank_mask:0xf
  v_mov_b32 v29, v17 row_newbcast:13 row_mask:0xf bank_mask:0xf
  v_mov_b32 v30, v18 row_newbcast:13 row_mask:0xf bank_mask:0xf
  v_mov_b32 v31, v19 row_newbcast:13 row_mask:0xf bank_mask:0xf
  v_mfma_f32_16x16x32_bf16 v[32:35], v[24:27], v[112:115], v[32:35]
  v_mfma_f32_16x16x32_bf16 v[36:39], v[24:27], v[176:179], v[36:39]
  v_mov_b32 v24, v16 row_newbcast:14 row_mask:0xf bank_mask:0xf
  v_mov_b32 v25, v17 row_newbcast:14 row_mask:0xf bank_mask:0xf
  v_mov_b32 v26, v18 row_newbcast:14 row_mask:0xf bank_mask:0xf
  v_mov_b32 v27, v19 row_newbcast:14 row_mask:0xf bank_mask:0xf
  v_mfma_f32_16x16x32_bf16 v[32:35], v[28:31], v[116:119], v[32:35]
  v_mfma_f32_16x16x32_bf16 v[36:39], v[28:31], v[180:183], v[36:39]
  v_mov_b32 v28, v16 row_newbcast:15 row_mask:0xf bank_mask:0xf
  v_mov_b32 v29, v17 row_newbcast:15 row_mask:0xf bank_mask:0xf
  v_mov_b32 v30, v18 row_newbcast:15 row_mask:0xf bank_mask:0xf
  v_mov_b32 v31, v19 row_newbcast:15 row_mask:0xf bank_mask:0xf
  v_mfma_f32_16x16x32_bf16 v[32:35], v[24:27], v[120:123], v[32:35]
  v_mfma_f32_16x16x32_bf16 v[36:39], v[24:27], v[184:187], v[36:39]
  v_mfma_f32_16x16x32_bf16 v[32:35], v[28:31], v[124:127], v[32:35]
  v_mfma_f32_16x16x32_bf16 v[36:39], v[28:31], v[188:191], v[36:39]
  s_mov_b32 s38, 0
  s_add_u32 s28, s32, 1
  v_mov_b32 v14, s28
  s_mov_b32 s28, 0x00010001
  s_mov_b32 s29, 0x00100010
  s_nop 2
  v_mov_b32 v35, v36
  ds_write_b64 v10, v[34:35]
  ds_write_b32 v12, v14 offset:40
.g2_kernel_d_x:
  ds_read_b32 v6, v13 offset:40
  ds_read_b64 v[16:17], v11
  s_add_u32 s38, s38, 1
  s_waitcnt lgkmcnt(0)
  v_cmp_lt_u32 vcc, s32, v6
  s_cbranch_vccnz .g2_kernel_d_xd
  s_cmp_lt_u32 s38, 524288
  s_cbranch_scc1 .g2_kernel_d_x
.g2_kernel_d_xd:
  v_add_f32 v16, v16, v32
  v_add_f32 v17, v17, v36
  v_mul_f32 v18, -1.4426950408889634, v16
  v_exp_f32 v18, v18
  v_mul_f32 v16, v16, v17
  v_add_f32 v18, 1.0, v18
  v_rcp_f32 v18, v18
  s_nop 0
  v_mul_f32 v16, v16, v18
  s_nop 1
  v_mov_b32 v17, v16 quad_perm:[1,0,3,2] row_mask:0xf bank_mask:0xf
  v_cvt_pk_bf16_f32 v16, v16, v17
  s_nop 1
  v_mov_b32 v20, v16 row_newbcast:0 row_mask:0x5 bank_mask:0xf
  v_mov_b32 v21, v16 row_newbcast:2 row_mask:0x5 bank_mask:0xf
  v_mov_b32 v22, v16 row_newbcast:4 row_mask:0x5 bank_mask:0xf
  v_mov_b32 v23, v16 row_newbcast:6 row_mask:0x5 bank_mask:0xf
  v_mov_b32 v20, v16 row_newbcast:8 row_mask:0xa bank_mask:0xf
  v_mov_b32 v21, v16 row_newbcast:10 row_mask:0xa bank_mask:0xf
  v_mov_b32 v22, v16 row_newbcast:12 row_mask:0xa bank_mask:0xf
  v_mov_b32 v23, v16 row_newbcast:14 row_mask:0xa bank_mask:0xf
  v_cndmask_b32 v24, 0, v20, s[28:29]
  v_cndmask_b32 v25, 0, v21, s[28:29]
  v_cndmask_b32 v26, 0, v22, s[28:29]
  v_cndmask_b32 v27, 0, v23, s[28:29]
  s_lshl_b64 s[28:29], s[28:29], 1
  s_nop 0
  v_mfma_f32_16x16x32_bf16 v[40:43], v[24:27], v[192:195], 0
  v_mfma_f32_16x16x32_bf16 v[44:47], v[24:27], v[208:211], 0
  v_mfma_f32_16x16x32_bf16 v[48:51], v[24:27], v[224:227], 0
  v_mfma_f32_16x16x32_bf16 v[52:55], v[24:27], v[240:243], 0
  v_cndmask_b32 v28, 0, v20, s[28:29]
  v_cndmask_b32 v29, 0, v21, s[28:29]
  v_cndmask_b32 v30, 0, v22, s[28:29]
  v_cndmask_b32 v31, 0, v23, s[28:29]
  s_lshl_b64 s[28:29], s[28:29], 1
  s_nop 0
  v_mfma_f32_16x16x32_bf16 v[40:43], v[28:31], v[196:199], v[40:43]
  v_mfma_f32_16x16x32_bf16 v[44:47], v[28:31], v[212:215], v[44:47]
  v_mfma_f32_16x16x32_bf16 v[48:51], v[28:31], v[228:231], v[48:51]
  v_mfma_f32_16x16x32_bf16 v[52:55], v[28:31], v[244:247], v[52:55]
  v_cndmask_b32 v32, 0, v20, s[28:29]
  v_cndmask_b32 v33, 0, v21, s[28:29]
  v_cndmask_b32 v34, 0, v22, s[28:29]
  v_cndmask_b32 v35, 0, v23, s[28:29]
  s_lshl_b64 s[28:29], s[28:29], 1
  s_nop 0
  v_mfma_f32_16x16x32_bf16 v[40:43], v[32:35], v[200:203], v[40:43]
  v_mfma_f32_16x16x32_bf16 v[44:47], v[32:35], v[216:219], v[44:47]
  v_mfma_f32_16x16x32_bf16 v[48:51], v[32:35], v[232:235], v[48:51]
  v_mfma_f32_16x16x32_bf16 v[52:55], v[32:35], v[248:251], v[52:55]
  v_cndmask_b32 v36, 0, v20, s[28:29]
  v_cndmask_b32 v37, 0, v21, s[28:29]
  v_cndmask_b32 v38, 0, v22, s[28:29]
  v_cndmask_b32 v39, 0, v23, s[28:29]
  s_lshl_b64 s[28:29], s[28:29], 1
  s_nop 0
  v_mfma_f32_16x16x32_bf16 v[40:43], v[36:39], v[204:207], v[40:43]
  v_mfma_f32_16x16x32_bf16 v[44:47], v[36:39], v[220:223], v[44:47]
  v_mfma_f32_16x16x32_bf16 v[48:51], v[36:39], v[236:239], v[48:51]
  v_mfma_f32_16x16x32_bf16 v[52:55], v[36:39], v[252:255], v[52:55]
  s_mov_b32 exec_hi, 0
  s_nop 3
  v_or_b32 v40, 1, v40
  v_or_b32 v42, 1, v42
  buffer_store_dwordx4 v[40:43], v3, s[4:7], s26 offen offset:0 sc1
  v_or_b32 v44, 1, v44
  v_or_b32 v46, 1, v46
  buffer_store_dwordx4 v[44:47], v3, s[4:7], s26 offen offset:512 sc1
  v_or_b32 v48, 1, v48
  v_or_b32 v50, 1, v50
  buffer_store_dwordx4 v[48:51], v3, s[4:7], s26 offen offset:1024 sc1
  v_or_b32 v52, 1, v52
  v_or_b32 v54, 1, v54
  buffer_store_dwordx4 v[52:55], v3, s[4:7], s26 offen offset:1536 sc1
  s_mov_b64 exec, -1
  s_branch .g2_kernel_d_e
.g2_kernel_d_none:
  s_sleep 24
.g2_kernel_d_e:
  v_mov_b32 v6, s71
  s_mov_b64 exec, 1
  ds_add_u32 v6, v5 offset:48
  s_mov_b64 exec, -1
  s_cmp_lg_u32 s62, 0
  s_cbranch_scc1 .g2_kernel_d_t
  s_mov_b32 s62, 1
  s_mov_b32 s63, 0x1800000
  s_mov_b32 s70, 2
  s_mov_b32 s71, 155776
  s_branch .g2_kernel_v
.g2_kernel_d_t:
  s_cmp_lg_u32 s20, 0
  s_cbranch_scc1 .g2_kernel_d_t1
  v_mov_b32 v62, -1.4426950408889634
  v_mul_f32 v62, s27, v62
  v_exp_f32 v62, v62
  v_lshlrev_b32 v14, 12, v2
  v_min_u32 v15, 126976, v14
  s_lshl_b32 s21, s17, 4
  s_add_u32 s21, s21, s18
  s_lshl_b32 s21, s21, 4
  s_mul_i32 s22, s32, 0x270000
  s_add_u32 s21, s21, s22
  s_add_u32 s21, s21, 0x2890000
  s_add_u32 s22, s21, 262144
  s_add_u32 s24, s21, 524288
  s_add_u32 s25, s21, 786432
  v_add_f32 v62, 1.0, v62
  v_rcp_f32 v62, v62
  v_lshlrev_b32 v56, 16, v56
  v_fma_f32 v56, v56, v61, -v60
  v_lshlrev_b32 v57, 16, v57
  v_fma_f32 v57, v57, v61, -v60
  v_lshlrev_b32 v58, 16, v58
  v_fma_f32 v58, v58, v61, -v60
  v_lshlrev_b32 v59, 16, v59
  v_fma_f32 v59, v59, v61, -v60
  s_sleep 8
  s_mov_b32 s38, 0
.g2_kernel_gx62:
  buffer_load_dwordx4 v[16:19], v14, s[4:7], s21 offen sc1
  buffer_load_dwordx4 v[20:23], v14, s[4:7], s22 offen sc1
  buffer_load_dwordx4 v[24:27], v14, s[4:7], s24 offen sc1
  buffer_load_dwordx4 v[28:31], v15, s[4:7], s25 offen sc1
  s_add_u32 s38, s38, 1
  s_waitcnt vmcnt(0)
  v_min3_u32 v6, v16, v18, v20
  v_min3_u32 v6, v6, v22, v24
  v_min3_u32 v6, v6, v26, v28
  v_min_u32 v6, v6, v30
  v_cmp_eq_u32 vcc, 0, v6
  s_cbranch_vccz .g2_kernel_gx62d
  s_mov_b64 exec, vcc
  s_cmp_lt_u32 s38, 131072
  s_cbranch_scc1 .g2_kernel_gx62
.g2_kernel_gx62d:
  s_mov_b64 exec, -1
  v_add_f32 v16, v16, v20
  v_add_f32 v17, v17, v21
  v_add_f32 v18, v18, v22
  v_add_f32 v19, v19, v23
  s_mov_b32 exec_hi, 0
  v_add_f32 v24, v24, v28
  v_add_f32 v25, v25, v29
  v_add_f32 v26, v26, v30
  v_add_f32 v27, v27, v31
  s_mov_b64 exec, -1
  v_add_f32 v16, v16, v24
  v_add_f32 v17, v17, v25
  v_add_f32 v18, v18, v26
  v_add_f32 v19, v19, v27
  v_add_f32 v16, v16, v16 row_ror:8 row_mask:0xf bank_mask:0xf
  v_add_f32 v17, v17, v17 row_ror:8 row_mask:0xf bank_mask:0xf
  v_add_f32 v18, v18, v18 row_ror:8 row_mask:0xf bank_mask:0xf
  v_add_f32 v19, v19, v19 row_ror:8 row_mask:0xf bank_mask:0xf
  v_add_f32 v16, v16, v16 row_ror:4 row_mask:0xf bank_mask:0xf
  v_add_f32 v17, v17, v17 row_ror:4 row_mask:0xf bank_mask:0xf
  v_add_f32 v18, v18, v18 row_ror:4 row_mask:0xf bank_mask:0xf
  v_add_f32 v19, v19, v19 row_ror:4 row_mask:0xf bank_mask:0xf
  v_add_f32 v16, v16, v16 row_ror:2 row_mask:0xf bank_mask:0xf
  v_add_f32 v17, v17, v17 row_ror:2 row_mask:0xf bank_mask:0xf
  v_add_f32 v18, v18, v18 row_ror:2 row_mask:0xf bank_mask:0xf
  v_add_f32 v19, v19, v19 row_ror:2 row_mask:0xf bank_mask:0xf
  v_add_f32 v16, v16, v16 row_ror:1 row_mask:0xf bank_mask:0xf
  v_add_f32 v17, v17, v17 row_ror:1 row_mask:0xf bank_mask:0xf
  v_add_f32 v18, v18, v18 row_ror:1 row_mask:0xf bank_mask:0xf
  v_add_f32 v19, v19, v19 row_ror:1 row_mask:0xf bank_mask:0xf
  v_add_f32 v16, v16, v16 row_bcast:15 row_mask:0xa bank_mask:0xf
  v_add_f32 v17, v17, v17 row_bcast:15 row_mask:0xa bank_mask:0xf
  v_add_f32 v18, v18, v18 row_bcast:15 row_mask:0xa bank_mask:0xf
  v_add_f32 v19, v19, v19 row_bcast:15 row_mask:0xa bank_mask:0xf
  v_add_f32 v16, v16, v16 row_bcast:31 row_mask:0xc bank_mask:0xf
  v_add_f32 v17, v17, v17 row_bcast:31 row_mask:0xc bank_mask:0xf
  v_add_f32 v18, v18, v18 row_bcast:31 row_mask:0xc bank_mask:0xf
  v_add_f32 v19, v19, v19 row_bcast:31 row_mask:0xc bank_mask:0xf
  s_lshl_b32 s24, s77, 11
  s_lshl_b32 s25, s17, 7
  s_add_u32 s24, s24, s25
  s_lshl_b32 s25, s18, 1
  s_add_u32 s24, s24, s25
.g2_kernel_d_t1:
  v_mov_b32 v6, s71
  s_mov_b32 s38, 0
.g2_kernel_wg63:
  ds_read_b32 v7, v6 offset:88
  s_add_u32 s38, s38, 1
  s_waitcnt lgkmcnt(0)
  v_cmp_le_u32 vcc, 1, v7
  s_cbranch_vccnz .g2_kernel_wg63d
  s_cmp_lt_u32 s38, 524288
  s_cbranch_scc1 .g2_kernel_wg63
.g2_kernel_wg63d:
  ds_read_b32 v6, v6 offset:92
  v_readfirstlane_b32 s33, v7
  s_cmp_lg_u32 s32, 0
  s_cselect_b32 s33, 1, s33
  s_cmp_lg_u32 s20, 0
  s_cbranch_scc1 .g2_kernel_d_t2
  s_cmp_lg_u32 s33, 1
  s_cbranch_scc1 .g2_kernel_d_t4
  v_fmac_f32 v56, v16, v62
  v_fmac_f32 v57, v17, v62
  v_fmac_f32 v58, v18, v62
  v_fmac_f32 v59, v19, v62
.g2_kernel_d_t4:
  s_mov_b32 s28, s56
  s_mov_b32 s29, s57
  s_mov_b32 s30, 0x400000
  s_mov_b32 s31, 0x00020000
  v_cvt_pk_bf16_f32 v56, v56, v57
  v_cvt_pk_bf16_f32 v58, v58, v59
  s_mov_b32 exec_lo, 0
  s_mov_b32 exec_hi, 0x80000000
  buffer_store_short v56, v4, s[28:31], s24 offen
  buffer_store_short_d16_hi v56, v4, s[28:31], s24 offen offset:32
  buffer_store_short v58, v4, s[28:31], s24 offen offset:64
  buffer_store_short_d16_hi v58, v4, s[28:31], s24 offen offset:96
  s_mov_b64 exec, -1
.g2_kernel_d_t2:
  s_cmp_eq_u32 s33, 1
  s_cbranch_scc1 .g2_kernel_fin
  s_waitcnt vmcnt(0) lgkmcnt(0)
  v_readfirstlane_b32 s27, v6
  s_sub_u32 s77, s33, 2
  s_mov_b32 s32, 1
  s_add_u32 s26, s26, 0x270000
  s_branch .g2_kernel_d_r
.g2_kernel_fin1:
.g2_kernel_fin:
.g2_kernel_end:
  s_endpgm
.g2_kernel_q_i2:
  v_mov_b32 v6, 155648
  s_mov_b32 s38, 0
.g2_kernel_wg1:
  ds_read_b32 v7, v6 offset:20
  s_add_u32 s38, s38, 1
  s_waitcnt lgkmcnt(0)
  v_cmp_le_u32 vcc, 4, v7
  s_cbranch_vccnz .g2_kernel_wg1d
  s_cmp_lt_u32 s38, 524288
  s_cbranch_scc1 .g2_kernel_wg1
.g2_kernel_wg1d:
  s_branch .g2_kernel_q_i3
.g2_kernel_q_spin:
  s_mov_b32 s38, 0
.g2_kernel_q_spinl:
  ds_read_b32 v151, v150
  s_add_u32 s38, s38, 1
  s_waitcnt lgkmcnt(0)
  v_cmp_lt_i32 vcc, s33, v151
  s_cbranch_vccnz .g2_kernel_q_spinr
  s_cmp_lt_u32 s38, 524288
  s_cbranch_scc1 .g2_kernel_q_spinl
.g2_kernel_q_spinr:
  s_setpc_b64 s[68:69]
.g2_kernel_q_wf:
  s_call_b64 s[68:69], .g2_kernel_q_spin
  s_branch .g2_kernel_q_backf
.g2_kernel_q_w7:
  s_call_b64 s[68:69], .g2_kernel_q_spin
  s_branch .g2_kernel_q_back7
.g2_kernel_q_w0:
  s_call_b64 s[68:69], .g2_kernel_q_spin
  s_branch .g2_kernel_q_back0
.g2_kernel_q_w1:
  s_call_b64 s[68:69], .g2_kernel_q_spin
  s_branch .g2_kernel_q_back1
.g2_kernel_q_w2:
  s_call_b64 s[68:69], .g2_kernel_q_spin
  s_branch .g2_kernel_q_back2
.g2_kernel_q_w3:
  s_call_b64 s[68:69], .g2_kernel_q_spin
  s_branch .g2_kernel_q_back3
.g2_kernel_q_w4:
  s_call_b64 s[68:69], .g2_kernel_q_spin
  s_branch .g2_kernel_q_back4
.g2_kernel_q_w5:
  s_call_b64 s[68:69], .g2_kernel_q_spin
  s_branch .g2_kernel_q_back5
.g2_kernel_q_w6:
  s_call_b64 s[68:69], .g2_kernel_q_spin
  s_branch .g2_kernel_q_back6
.g2_kernel_q_cons2:
  s_lshr_b32 s26, s16, 1
  s_lshl_b32 s26, s26, 13
  v_add_u32 v144, s26, v3
  v_add_u32 v145, 1024, v144
  s_branch .g2_kernel_q_cs
.g2_kernel_q_ew:
  s_mov_b32 s38, 0
.g2_kernel_q_ewl:
  ds_read_b32 v62, v13 offset:0
  ds_read_b32 v63, v58
  s_add_u32 s38, s38, 1
  s_waitcnt lgkmcnt(0)
  v_cmp_gt_u32 vcc, 2, v62
  v_cmp_gt_u32 s[14:15], s12, v63
  s_or_b64 vcc, vcc, s[14:15]
  s_cbranch_scc0 .g2_kernel_q_ec
  s_cmp_lt_u32 s38, 524288
  s_cbranch_scc1 .g2_kernel_q_ewl
.g2_kernel_q_ec:
  ds_read_b32 v57, v13 offset:24
  ds_read_b32 v21, v13 offset:84
  ds_read_b128 v[40:43], v52 offset:5120
  ds_read_b128 v[44:47], v52 offset:5184
  ds_read_b32 v24, v50 offset:2816
  ds_read_b32 v25, v50 offset:3328
  ds_read_b32 v26, v50 offset:2880
  ds_read_b32 v27, v50 offset:3392
  ds_read_b32 v28, v50 offset:2944
  ds_read_b32 v29, v50 offset:3456
  ds_read_b32 v30, v50 offset:3008
  ds_read_b32 v31, v50 offset:3520
  ds_read_b128 v[64:67], v51 offset:2816
  ds_read_b128 v[80:83], v51 offset:3328
  ds_read_b128 v[68:71], v51 offset:2880
  ds_read_b128 v[84:87], v51 offset:3392
  ds_read_b128 v[72:75], v51 offset:2944
  ds_read_b128 v[88:91], v51 offset:3456
  ds_read_b128 v[76:79], v51 offset:3008
  ds_read_b128 v[92:95], v51 offset:3520
  ds_read_b32 v48, v53 offset:5376
  ds_read_b32 v49, v53 offset:5440
  ds_read_b128 v[32:35], v52 offset:4864
  ds_read_b128 v[36:39], v52 offset:4928
  s_waitcnt lgkmcnt(0)
  s_branch .g2_kernel_q_eb
.g2_kernel_q_patch:
  v_readfirstlane_b32 s35, v57
  s_sub_u32 s28, s35, 1
  s_lshr_b32 s29, s28, 6
  s_lshr_b32 s30, s16, 1
  s_add_u32 s35, s35, 0x100
  s_cmp_lg_u32 s29, s30
  s_cbranch_scc1 .g2_kernel_q_pback
  s_add_u32 s35, s35, 0x100
  s_mov_b32 s77, 0x40000000
  s_and_b32 s29, s28, 15
  s_mov_b32 s14, 0x00010001
  s_mov_b32 s15, 0x00010001
  s_lshl_b64 s[14:15], s[14:15], s29
  s_and_b32 s29, s28, 12
  s_lshl_b32 s29, s29, 2
  s_lshl_b64 s[30:31], 0xffff, s29
  v_subrev_u32 v96, 155648, v53
  v_lshlrev_b32 v96, 2, v96
  v_add_u32 v96, 155648, v96
  s_bfe_u32 s29, s28, 0x20004
  s_cmp_lg_u32 s29, 0
  s_cbranch_scc1 .g2_kernel_q_pv1
  s_mov_b64 exec, s[14:15]
  ds_write_b128 v52, v[160:163] offset:5632
  ds_write_b128 v52, v[176:179] offset:5696
  ds_write_b128 v52, v[192:195] offset:5888
  ds_write_b128 v52, v[208:211] offset:5952
  s_mov_b64 exec, s[30:31]
  ds_write_b128 v96, v[224:227] offset:6144
  ds_write_b128 v96, v[240:243] offset:6400
  s_mov_b64 exec, -1
  s_waitcnt lgkmcnt(0)
  s_branch .g2_kernel_q_pback
.g2_kernel_q_pv1:
  s_cmp_lg_u32 s29, 1
  s_cbranch_scc1 .g2_kernel_q_pv2
  s_mov_b64 exec, s[14:15]
  ds_write_b128 v52, v[164:167] offset:5632
  ds_write_b128 v52, v[180:183] offset:5696
  ds_write_b128 v52, v[196:199] offset:5888
  ds_write_b128 v52, v[212:215] offset:5952
  s_mov_b64 exec, s[30:31]
  ds_write_b128 v96, v[228:231] offset:6144
  ds_write_b128 v96, v[244:247] offset:6400
  s_mov_b64 exec, -1
  s_waitcnt lgkmcnt(0)
  s_branch .g2_kernel_q_pback
.g2_kernel_q_pv2:
  s_cmp_lg_u32 s29, 2
  s_cbranch_scc1 .g2_kernel_q_pv3
  s_mov_b64 exec, s[14:15]
  ds_write_b128 v52, v[168:171] offset:5632
  ds_write_b128 v52, v[184:187] offset:5696
  ds_write_b128 v52, v[200:203] offset:5888
  ds_write_b128 v52, v[216:219] offset:5952
  s_mov_b64 exec, s[30:31]
  ds_write_b128 v96, v[232:235] offset:6144
  ds_write_b128 v96, v[248:251] offset:6400
  s_mov_b64 exec, -1
  s_waitcnt lgkmcnt(0)
  s_branch .g2_kernel_q_pback
.g2_kernel_q_pv3:
  s_mov_b64 exec, s[14:15]
  ds_write_b128 v52, v[172:175] offset:5632
  ds_write_b128 v52, v[188:191] offset:5696
  ds_write_b128 v52, v[204:207] offset:5888
  ds_write_b128 v52, v[220:223] offset:5952
  s_mov_b64 exec, s[30:31]
  ds_write_b128 v96, v[236:239] offset:6144
  ds_write_b128 v96, v[252:255] offset:6400
  s_mov_b64 exec, -1
  s_waitcnt lgkmcnt(0)
  s_branch .g2_kernel_q_pback
.g2_kernel_q_nk:
  v_pk_mul_f32 v[152:153], v[40:41], v[24:25] op_sel:[0,1] op_sel_hi:[1,1]
  v_pk_mul_f32 v[154:155], v[42:43], v[24:25] op_sel:[0,1] op_sel_hi:[1,1]
  v_pk_mul_f32 v[156:157], v[44:45], v[24:25] op_sel:[0,1] op_sel_hi:[1,1]
  v_pk_mul_f32 v[158:159], v[46:47], v[24:25] op_sel:[0,1] op_sel_hi:[1,1]
  v_pk_fma_f32 v[192:193], v[192:193], v[24:25], v[152:153] op_sel_hi:[1,0,1]
  v_pk_fma_f32 v[194:195], v[194:195], v[24:25], v[154:155] op_sel_hi:[1,0,1]
  v_pk_fma_f32 v[208:209], v[208:209], v[24:25], v[156:157] op_sel_hi:[1,0,1]
  v_pk_fma_f32 v[210:211], v[210:211], v[24:25], v[158:159] op_sel_hi:[1,0,1]
  v_cvt_pk_bf16_f32 v192, v192, v193
  v_cvt_pk_bf16_f32 v193, v194, v195
  v_cvt_pk_bf16_f32 v194, v208, v209
  v_cvt_pk_bf16_f32 v195, v210, v211
  ds_write_b128 v59, v[192:195] offset:0
  v_pk_mul_f32 v[152:153], v[40:41], v[26:27] op_sel:[0,1] op_sel_hi:[1,1]
  v_pk_mul_f32 v[154:155], v[42:43], v[26:27] op_sel:[0,1] op_sel_hi:[1,1]
  v_pk_mul_f32 v[156:157], v[44:45], v[26:27] op_sel:[0,1] op_sel_hi:[1,1]
  v_pk_mul_f32 v[158:159], v[46:47], v[26:27] op_sel:[0,1] op_sel_hi:[1,1]
  v_pk_fma_f32 v[196:197], v[196:197], v[26:27], v[152:153] op_sel_hi:[1,0,1]
  v_pk_fma_f32 v[198:199], v[198:199], v[26:27], v[154:155] op_sel_hi:[1,0,1]
  v_pk_fma_f32 v[212:213], v[212:213], v[26:27], v[156:157] op_sel_hi:[1,0,1]
  v_pk_fma_f32 v[214:215], v[214:215], v[26:27], v[158:159] op_sel_hi:[1,0,1]
  v_cvt_pk_bf16_f32 v196, v196, v197
  v_cvt_pk_bf16_f32 v197, v198, v199
  v_cvt_pk_bf16_f32 v198, v212, v213
  v_cvt_pk_bf16_f32 v199, v214, v215
  ds_write_b128 v59, v[196:199] offset:128
  v_pk_mul_f32 v[152:153], v[40:41], v[28:29] op_sel:[0,1] op_sel_hi:[1,1]
  v_pk_mul_f32 v[154:155], v[42:43], v[28:29] op_sel:[0,1] op_sel_hi:[1,1]
  v_pk_mul_f32 v[156:157], v[44:45], v[28:29] op_sel:[0,1] op_sel_hi:[1,1]
  v_pk_mul_f32 v[158:159], v[46:47], v[28:29] op_sel:[0,1] op_sel_hi:[1,1]
  v_pk_fma_f32 v[200:201], v[200:201], v[28:29], v[152:153] op_sel_hi:[1,0,1]
  v_pk_fma_f32 v[202:203], v[202:203], v[28:29], v[154:155] op_sel_hi:[1,0,1]
  v_pk_fma_f32 v[216:217], v[216:217], v[28:29], v[156:157] op_sel_hi:[1,0,1]
  v_pk_fma_f32 v[218:219], v[218:219], v[28:29], v[158:159] op_sel_hi:[1,0,1]
  v_cvt_pk_bf16_f32 v200, v200, v201
  v_cvt_pk_bf16_f32 v201, v202, v203
  v_cvt_pk_bf16_f32 v202, v216, v217
  v_cvt_pk_bf16_f32 v203, v218, v219
  ds_write_b128 v59, v[200:203] offset:4096
  v_pk_mul_f32 v[152:153], v[40:41], v[30:31] op_sel:[0,1] op_sel_hi:[1,1]
  v_pk_mul_f32 v[154:155], v[42:43], v[30:31] op_sel:[0,1] op_sel_hi:[1,1]
  v_pk_mul_f32 v[156:157], v[44:45], v[30:31] op_sel:[0,1] op_sel_hi:[1,1]
  v_pk_mul_f32 v[158:159], v[46:47], v[30:31] op_sel:[0,1] op_sel_hi:[1,1]
  v_pk_fma_f32 v[204:205], v[204:205], v[30:31], v[152:153] op_sel_hi:[1,0,1]
  v_pk_fma_f32 v[206:207], v[206:207], v[30:31], v[154:155] op_sel_hi:[1,0,1]
  v_pk_fma_f32 v[220:221], v[220:221], v[30:31], v[156:157] op_sel_hi:[1,0,1]
  v_pk_fma_f32 v[222:223], v[222:223], v[30:31], v[158:159] op_sel_hi:[1,0,1]
  v_cvt_pk_bf16_f32 v204, v204, v205
  v_cvt_pk_bf16_f32 v205, v206, v207
  v_cvt_pk_bf16_f32 v206, v220, v221
  v_cvt_pk_bf16_f32 v207, v222, v223
  ds_write_b128 v59, v[204:207] offset:4224
  v_pk_mul_f32 v[152:153], v[80:81], v[48:49] op_sel:[0,0] op_sel_hi:[1,0]
  v_pk_mul_f32 v[154:155], v[82:83], v[48:49] op_sel:[0,0] op_sel_hi:[1,0]
  v_pk_mul_f32 v[156:157], v[84:85], v[48:49] op_sel:[0,0] op_sel_hi:[1,0]
  v_pk_mul_f32 v[158:159], v[86:87], v[48:49] op_sel:[0,0] op_sel_hi:[1,0]
  v_pk_fma_f32 v[224:225], v[224:225], v[64:65], v[152:153]
  v_pk_fma_f32 v[226:227], v[226:227], v[66:67], v[154:155]
  v_pk_fma_f32 v[228:229], v[228:229], v[68:69], v[156:157]
  v_pk_fma_f32 v[230:231], v[230:231], v[70:71], v[158:159]
  v_cvt_pk_bf16_f32 v224, v224, v225
  v_cvt_pk_bf16_f32 v225, v226, v227
  v_cvt_pk_bf16_f32 v226, v228, v229
  v_cvt_pk_bf16_f32 v227, v230, v231
  ds_write_b128 v60, v[224:227] offset:2048
  v_pk_mul_f32 v[152:153], v[80:81], v[48:49] op_sel:[0,1] op_sel_hi:[1,1]
  v_pk_mul_f32 v[154:155], v[82:83], v[48:49] op_sel:[0,1] op_sel_hi:[1,1]
  v_pk_mul_f32 v[156:157], v[84:85], v[48:49] op_sel:[0,1] op_sel_hi:[1,1]
  v_pk_mul_f32 v[158:159], v[86:87], v[48:49] op_sel:[0,1] op_sel_hi:[1,1]
  v_pk_fma_f32 v[240:241], v[240:241], v[64:65], v[152:153]
  v_pk_fma_f32 v[242:243], v[242:243], v[66:67], v[154:155]
  v_pk_fma_f32 v[244:245], v[244:245], v[68:69], v[156:157]
  v_pk_fma_f32 v[246:247], v[246:247], v[70:71], v[158:159]
  v_cvt_pk_bf16_f32 v240, v240, v241
  v_cvt_pk_bf16_f32 v241, v242, v243
  v_cvt_pk_bf16_f32 v242, v244, v245
  v_cvt_pk_bf16_f32 v243, v246, v247
  ds_write_b128 v60, v[240:243] offset:2304
  v_pk_mul_f32 v[152:153], v[88:89], v[48:49] op_sel:[0,0] op_sel_hi:[1,0]
  v_pk_mul_f32 v[154:155], v[90:91], v[48:49] op_sel:[0,0] op_sel_hi:[1,0]
  v_pk_mul_f32 v[156:157], v[92:93], v[48:49] op_sel:[0,0] op_sel_hi:[1,0]
  v_pk_mul_f32 v[158:159], v[94:95], v[48:49] op_sel:[0,0] op_sel_hi:[1,0]
  v_pk_fma_f32 v[232:233], v[232:233], v[72:73], v[152:153]
  v_pk_fma_f32 v[234:235], v[234:235], v[74:75], v[154:155]
  v_pk_fma_f32 v[236:237], v[236:237], v[76:77], v[156:157]
  v_pk_fma_f32 v[238:239], v[238:239], v[78:79], v[158:159]
  v_cvt_pk_bf16_f32 v232, v232, v233
  v_cvt_pk_bf16_f32 v233, v234, v235
  v_cvt_pk_bf16_f32 v234, v236, v237
  v_cvt_pk_bf16_f32 v235, v238, v239
  ds_write_b128 v60, v[232:235] offset:6144
  v_pk_mul_f32 v[152:153], v[88:89], v[48:49] op_sel:[0,1] op_sel_hi:[1,1]
  v_pk_mul_f32 v[154:155], v[90:91], v[48:49] op_sel:[0,1] op_sel_hi:[1,1]
  v_pk_mul_f32 v[156:157], v[92:93], v[48:49] op_sel:[0,1] op_sel_hi:[1,1]
  v_pk_mul_f32 v[158:159], v[94:95], v[48:49] op_sel:[0,1] op_sel_hi:[1,1]
  v_pk_fma_f32 v[248:249], v[248:249], v[72:73], v[152:153]
  v_pk_fma_f32 v[250:251], v[250:251], v[74:75], v[154:155]
  v_pk_fma_f32 v[252:253], v[252:253], v[76:77], v[156:157]
  v_pk_fma_f32 v[254:255], v[254:255], v[78:79], v[158:159]
  v_cvt_pk_bf16_f32 v248, v248, v249
  v_cvt_pk_bf16_f32 v249, v250, v251
  v_cvt_pk_bf16_f32 v250, v252, v253
  v_cvt_pk_bf16_f32 v251, v254, v255
  ds_write_b128 v60, v[248:251] offset:6400
  v_pk_mul_f32 v[24:25], v[24:25], v[56:57] op_sel_hi:[1,0]
  v_pk_mul_f32 v[26:27], v[26:27], v[56:57] op_sel_hi:[1,0]
  v_pk_mul_f32 v[28:29], v[28:29], v[56:57] op_sel_hi:[1,0]
  v_pk_mul_f32 v[30:31], v[30:31], v[56:57] op_sel_hi:[1,0]
  v_pk_mul_f32 v[152:153], v[32:33], v[24:25] op_sel:[0,1] op_sel_hi:[1,1]
  v_pk_mul_f32 v[154:155], v[34:35], v[24:25] op_sel:[0,1] op_sel_hi:[1,1]
  v_pk_mul_f32 v[156:157], v[36:37], v[24:25] op_sel:[0,1] op_sel_hi:[1,1]
  v_pk_mul_f32 v[158:159], v[38:39], v[24:25] op_sel:[0,1] op_sel_hi:[1,1]
  v_pk_fma_f32 v[160:161], v[160:161], v[24:25], v[152:153] op_sel_hi:[1,0,1]
  v_pk_fma_f32 v[162:163], v[162:163], v[24:25], v[154:155] op_sel_hi:[1,0,1]
  v_pk_fma_f32 v[176:177], v[176:177], v[24:25], v[156:157] op_sel_hi:[1,0,1]
  v_pk_fma_f32 v[178:179], v[178:179], v[24:25], v[158:159] op_sel_hi:[1,0,1]
  v_cvt_pk_bf16_f32 v160, v160, v161
  v_cvt_pk_bf16_f32 v161, v162, v163
  v_cvt_pk_bf16_f32 v162, v176, v177
  v_cvt_pk_bf16_f32 v163, v178, v179
  ds_write_b128 v61, v[160:163] offset:0
  v_pk_mul_f32 v[152:153], v[32:33], v[26:27] op_sel:[0,1] op_sel_hi:[1,1]
  v_pk_mul_f32 v[154:155], v[34:35], v[26:27] op_sel:[0,1] op_sel_hi:[1,1]
  v_pk_mul_f32 v[156:157], v[36:37], v[26:27] op_sel:[0,1] op_sel_hi:[1,1]
  v_pk_mul_f32 v[158:159], v[38:39], v[26:27] op_sel:[0,1] op_sel_hi:[1,1]
  v_pk_fma_f32 v[164:165], v[164:165], v[26:27], v[152:153] op_sel_hi:[1,0,1]
  v_pk_fma_f32 v[166:167], v[166:167], v[26:27], v[154:155] op_sel_hi:[1,0,1]
  v_pk_fma_f32 v[180:181], v[180:181], v[26:27], v[156:157] op_sel_hi:[1,0,1]
  v_pk_fma_f32 v[182:183], v[182:183], v[26:27], v[158:159] op_sel_hi:[1,0,1]
  v_cvt_pk_bf16_f32 v164, v164, v165
  v_cvt_pk_bf16_f32 v165, v166, v167
  v_cvt_pk_bf16_f32 v166, v180, v181
  v_cvt_pk_bf16_f32 v167, v182, v183
  ds_write_b128 v61, v[164:167] offset:256
  v_pk_mul_f32 v[152:153], v[32:33], v[28:29] op_sel:[0,1] op_sel_hi:[1,1]
  v_pk_mul_f32 v[154:155], v[34:35], v[28:29] op_sel:[0,1] op_sel_hi:[1,1]
  v_pk_mul_f32 v[156:157], v[36:37], v[28:29] op_sel:[0,1] op_sel_hi:[1,1]
  v_pk_mul_f32 v[158:159], v[38:39], v[28:29] op_sel:[0,1] op_sel_hi:[1,1]
  v_pk_fma_f32 v[168:169], v[168:169], v[28:29], v[152:153] op_sel_hi:[1,0,1]
  v_pk_fma_f32 v[170:171], v[170:171], v[28:29], v[154:155] op_sel_hi:[1,0,1]
  v_pk_fma_f32 v[184:185], v[184:185], v[28:29], v[156:157] op_sel_hi:[1,0,1]
  v_pk_fma_f32 v[186:187], v[186:187], v[28:29], v[158:159] op_sel_hi:[1,0,1]
  v_cvt_pk_bf16_f32 v168, v168, v169
  v_cvt_pk_bf16_f32 v169, v170, v171
  v_cvt_pk_bf16_f32 v170, v184, v185
  v_cvt_pk_bf16_f32 v171, v186, v187
  ds_write_b128 v61, v[168:171] offset:2048
  v_pk_mul_f32 v[152:153], v[32:33], v[30:31] op_sel:[0,1] op_sel_hi:[1,1]
  v_pk_mul_f32 v[154:155], v[34:35], v[30:31] op_sel:[0,1] op_sel_hi:[1,1]
  v_pk_mul_f32 v[156:157], v[36:37], v[30:31] op_sel:[0,1] op_sel_hi:[1,1]
  v_pk_mul_f32 v[158:159], v[38:39], v[30:31] op_sel:[0,1] op_sel_hi:[1,1]
  v_pk_fma_f32 v[172:173], v[172:173], v[30:31], v[152:153] op_sel_hi:[1,0,1]
  v_pk_fma_f32 v[174:175], v[174:175], v[30:31], v[154:155] op_sel_hi:[1,0,1]
  v_pk_fma_f32 v[188:189], v[188:189], v[30:31], v[156:157] op_sel_hi:[1,0,1]
  v_pk_fma_f32 v[190:191], v[190:191], v[30:31], v[158:159] op_sel_hi:[1,0,1]
  v_cvt_pk_bf16_f32 v172, v172, v173
  v_cvt_pk_bf16_f32 v173, v174, v175
  v_cvt_pk_bf16_f32 v174, v188, v189
  v_cvt_pk_bf16_f32 v175, v190, v191
  ds_write_b128 v61, v[172:175] offset:2304
  s_add_u32 s37, s37, 32
  s_and_b32 s35, s35, 0x1ff
  s_cmp_lg_u32 s35, 0
  s_cselect_b32 s28, 0x100, 0
  s_or_b32 s35, s35, s28
  s_branch .g2_kernel_q_kd
.g2_kernel_r2:
  buffer_load_dwordx4 v[240:243], v22, s[4:7], s13 offen offset:0
  buffer_load_dwordx4 v[244:247], v22, s[4:7], s13 offen offset:512
  buffer_load_dwordx4 v[248:251], v22, s[4:7], s13 offen offset:1024
  buffer_load_dwordx4 v[252:255], v22, s[4:7], s13 offen offset:1536
  s_branch .g2_kernel_r3
.g2_kernel_a_t1c:
  s_call_b64 s[68:69], .g2_kernel_a_pick
  s_branch .g2_kernel_a_t1b
.g2_kernel_a_t2c:
  s_call_b64 s[68:69], .g2_kernel_a_pick
  s_branch .g2_kernel_a_t2b
.g2_kernel_a_t3c:
  s_call_b64 s[68:69], .g2_kernel_a_pick
  s_branch .g2_kernel_a_t3b
.g2_kernel_a_three:
  s_andn2_b32 s33, s36, s34
  s_cbranch_scc0 .g2_kernel_a_t1c
.g2_kernel_a_t1b:
  s_ff1_i32_b32 s33, s33
  s_bitset1_b32 s34, s33
  s_xor_b32 s33, s33, s24
  s_lshl_b32 s33, s33, s25
  s_add_u32 s22, s20, s33
  s_addc_u32 s23, s21, 0
  global_load_dwordx4 v[192:195], v3, s[22:23] offset:0
  global_load_dwordx4 v[196:199], v3, s[22:23] offset:1024
  global_load_dwordx4 v[200:203], v3, s[22:23] offset:2048
  global_load_dwordx4 v[204:207], v3, s[22:23] offset:3072
  s_andn2_b32 s33, s36, s34
  s_cbranch_scc0 .g2_kernel_a_t2c
.g2_kernel_a_t2b:
  s_ff1_i32_b32 s33, s33
  s_bitset1_b32 s34, s33
  s_xor_b32 s33, s33, s24
  s_lshl_b32 s33, s33, s25
  s_add_u32 s22, s20, s33
  s_addc_u32 s23, s21, 0
  global_load_dwordx4 v[208:211], v3, s[22:23] offset:0
  global_load_dwordx4 v[212:215], v3, s[22:23] offset:1024
  global_load_dwordx4 v[216:219], v3, s[22:23] offset:2048
  global_load_dwordx4 v[220:223], v3, s[22:23] offset:3072
  s_andn2_b32 s33, s36, s34
  s_cbranch_scc0 .g2_kernel_a_t3c
.g2_kernel_a_t3b:
  s_ff1_i32_b32 s33, s33
  s_bitset1_b32 s34, s33
  s_xor_b32 s33, s33, s24
  s_lshl_b32 s33, s33, s25
  s_add_u32 s22, s20, s33
  s_addc_u32 s23, s21, 0
  global_load_dwordx4 v[224:227], v3, s[22:23] offset:0
  global_load_dwordx4 v[228:231], v3, s[22:23] offset:1024
  global_load_dwordx4 v[232:235], v3, s[22:23] offset:2048
  global_load_dwordx4 v[236:239], v3, s[22:23] offset:3072
  s_setpc_b64 s[72:73]
.g2_kernel_a_o0c:
  s_call_b64 s[68:69], .g2_kernel_a_pick
  s_branch .g2_kernel_a_o0b
.g2_kernel_a_o1c:
  s_call_b64 s[68:69], .g2_kernel_a_pick
  s_branch .g2_kernel_a_o1b
.g2_kernel_a_o2c:
  s_call_b64 s[68:69], .g2_kernel_a_pick
  s_branch .g2_kernel_a_o2b
.g2_kernel_a_o3c:
  s_call_b64 s[68:69], .g2_kernel_a_pick
  s_branch .g2_kernel_a_o3b
.g2_kernel_a_r0c:
  s_call_b64 s[68:69], .g2_kernel_a_pick
  s_branch .g2_kernel_a_r0b
.g2_kernel_a_r1c:
  s_call_b64 s[68:69], .g2_kernel_a_pick
  s_branch .g2_kernel_a_r1b
.g2_kernel_a_r2c:
  s_call_b64 s[68:69], .g2_kernel_a_pick
  s_branch .g2_kernel_a_r2b
.g2_kernel_a_own:
  s_waitcnt vmcnt(0) lgkmcnt(0)
  s_mov_b64 exec, 1
  s_cmp_ge_u32 s35, 0x200
  s_cbranch_scc1 .g2_kernel_a_ow1
  buffer_store_dword v15, v4, s[4:7], s37 offen sc1
  s_branch .g2_kernel_a_ow2
.g2_kernel_a_ow1:
  ds_add_u32 v13, v5 offset:56
.g2_kernel_a_ow2:
  s_mov_b64 exec, -1
  s_add_u32 s37, s37, 64
  s_mov_b32 s14, 0
  s_andn2_b32 s33, s36, s34
  s_cbranch_scc0 .g2_kernel_a_o0c
.g2_kernel_a_o0b:
  s_ff1_i32_b32 s33, s33
  s_bitset1_b32 s34, s33
  s_lshl_b32 s28, s33, 0
  s_or_b32 s14, s14, s28
  s_xor_b32 s33, s33, s24
  s_lshl_b32 s33, s33, s25
  s_add_u32 s22, s20, s33
  s_addc_u32 s23, s21, 0
  global_load_dwordx4 v[176:179], v3, s[22:23] offset:0
  global_load_dwordx4 v[180:183], v3, s[22:23] offset:1024
  global_load_dwordx4 v[184:187], v3, s[22:23] offset:2048
  global_load_dwordx4 v[188:191], v3, s[22:23] offset:3072
  s_andn2_b32 s33, s36, s34
  s_cbranch_scc0 .g2_kernel_a_o1c
.g2_kernel_a_o1b:
  s_ff1_i32_b32 s33, s33
  s_bitset1_b32 s34, s33
  s_lshl_b32 s28, s33, 8
  s_or_b32 s14, s14, s28
  s_xor_b32 s33, s33, s24
  s_lshl_b32 s33, s33, s25
  s_add_u32 s22, s20, s33
  s_addc_u32 s23, s21, 0
  global_load_dwordx4 v[192:195], v3, s[22:23] offset:0
  global_load_dwordx4 v[196:199], v3, s[22:23] offset:1024
  global_load_dwordx4 v[200:203], v3, s[22:23] offset:2048
  global_load_dwordx4 v[204:207], v3, s[22:23] offset:3072
  s_andn2_b32 s33, s36, s34
  s_cbranch_scc0 .g2_kernel_a_o2c
.g2_kernel_a_o2b:
  s_ff1_i32_b32 s33, s33
  s_bitset1_b32 s34, s33
  s_lshl_b32 s28, s33, 16
  s_or_b32 s14, s14, s28
  s_xor_b32 s33, s33, s24
  s_lshl_b32 s33, s33, s25
  s_add_u32 s22, s20, s33
  s_addc_u32 s23, s21, 0
  global_load_dwordx4 v[208:211], v3, s[22:23] offset:0
  global_load_dwordx4 v[212:215], v3, s[22:23] offset:1024
  global_load_dwordx4 v[216:219], v3, s[22:23] offset:2048
  global_load_dwordx4 v[220:223], v3, s[22:23] offset:3072
  s_andn2_b32 s33, s36, s34
  s_cbranch_scc0 .g2_kernel_a_o3c
.g2_kernel_a_o3b:
  s_ff1_i32_b32 s33, s33
  s_bitset1_b32 s34, s33
  s_lshl_b32 s28, s33, 24
  s_or_b32 s14, s14, s28
  s_xor_b32 s33, s33, s24
  s_lshl_b32 s33, s33, s25
  s_add_u32 s22, s20, s33
  s_addc_u32 s23, s21, 0
  global_load_dwordx4 v[224:227], v3, s[22:23] offset:0
  global_load_dwordx4 v[228:231], v3, s[22:23] offset:1024
  global_load_dwordx4 v[232:235], v3, s[22:23] offset:2048
  global_load_dwordx4 v[236:239], v3, s[22:23] offset:3072
  s_and_b32 s15, s34, -2
  s_mov_b32 s34, -1
  s_mov_b32 s26, -1
  s_waitcnt vmcnt(12)
  s_branch .g2_kernel_a_ob
.g2_kernel_a_redo:
  v_mfma_f32_32x32x16_bf16 v[104:119], v[236:239], v[172:175], v[104:119]
  v_smfmac_f32_16x16x64_bf16 v[132:135], v[16:19], v[168:175], v20
  v_mov_b32 v6, s71
  s_mov_b32 s38, 0
.g2_kernel_wg3:
  ds_read_b32 v7, v6 offset:60
  s_add_u32 s38, s38, 1
  s_waitcnt lgkmcnt(0)
  v_cmp_le_u32 vcc, 1, v7
  s_cbranch_vccnz .g2_kernel_wg3d
  s_sleep 1
  s_cmp_lt_u32 s38, 524288
  s_cbranch_scc1 .g2_kernel_wg3
.g2_kernel_wg3d:
  ds_read_b32 v7, v8
  s_mov_b32 s34, s15
  s_mov_b32 s26, 0
  s_waitcnt lgkmcnt(0)
  v_cmp_lt_u32 vcc, s62, v7
  s_mov_b32 s36, vcc_lo
  s_sub_u32 s28, s35, 1
  s_bfe_u32 s28, s28, 0x20005
  s_mov_b32 s35, 0
  s_waitcnt vmcnt(0)
  s_cmp_lg_u32 s28, 0
  s_cbranch_scc1 .g2_kernel_a_rd1
  ds_read_b128 v[24:27], v14 offset:8192
  ds_read_b128 v[28:31], v14 offset:9216
  v_mov_b32 v120, 0
  v_mov_b32 v121, 0
  s_waitcnt lgkmcnt(0)
  v_mfma_f32_32x32x16_bf16 v[136:151], v[176:179], v[24:27], 0
  v_mfma_f32_32x32x16_bf16 v[136:151], v[180:183], v[28:31], v[136:151]
  v_mfma_f32_32x32x16_bf16 v[152:167], v[192:195], v[24:27], 0
  s_nop 10
  v_exp_f32 v136, v136
  v_exp_f32 v137, v137
  v_exp_f32 v138, v138
  v_exp_f32 v139, v139
  v_exp_f32 v140, v140
  v_exp_f32 v141, v141
  v_exp_f32 v142, v142
  v_exp_f32 v143, v143
  v_mfma_f32_32x32x16_bf16 v[152:167], v[196:199], v[28:31], v[152:167]
  v_cvt_pk_bf16_f32 v168, v136, v137
  v_cvt_pk_bf16_f32 v169, v138, v139
  v_cvt_pk_bf16_f32 v170, v140, v141
  v_cvt_pk_bf16_f32 v171, v142, v143
  v_exp_f32 v144, v144
  v_exp_f32 v145, v145
  v_exp_f32 v146, v146
  v_exp_f32 v147, v147
  v_mfma_f32_32x32x16_bf16 v[56:71], v[184:187], v[168:171], 0
  v_exp_f32 v148, v148
  v_exp_f32 v149, v149
  v_exp_f32 v150, v150
  v_exp_f32 v151, v151
  v_cvt_pk_bf16_f32 v172, v144, v145
  v_cvt_pk_bf16_f32 v173, v146, v147
  v_cvt_pk_bf16_f32 v174, v148, v149
  v_cvt_pk_bf16_f32 v175, v150, v151
  v_mfma_f32_32x32x16_bf16 v[136:151], v[208:211], v[24:27], 0
  v_exp_f32 v152, v152
  v_exp_f32 v153, v153
  v_exp_f32 v154, v154
  v_mfma_f32_32x32x16_bf16 v[56:71], v[188:191], v[172:175], v[56:71]
  s_call_b64 s[72:73], .g2_kernel_a_ld0
  v_exp_f32 v155, v155
  v_exp_f32 v156, v156
  v_exp_f32 v157, v157
  v_smfmac_f32_16x16x64_bf16 v[120:123], v[16:19], v[168:175], v20
  v_exp_f32 v158, v158
  v_exp_f32 v159, v159
  v_mfma_f32_32x32x16_bf16 v[136:151], v[212:215], v[28:31], v[136:151]
  v_cvt_pk_bf16_f32 v168, v152, v153
  v_cvt_pk_bf16_f32 v169, v154, v155
  v_cvt_pk_bf16_f32 v170, v156, v157
  v_cvt_pk_bf16_f32 v171, v158, v159
  v_exp_f32 v160, v160
  v_exp_f32 v161, v161
  v_exp_f32 v162, v162
  v_exp_f32 v163, v163
  v_mfma_f32_32x32x16_bf16 v[56:71], v[200:203], v[168:171], v[56:71]
  v_exp_f32 v164, v164
  v_exp_f32 v165, v165
  v_exp_f32 v166, v166
  v_exp_f32 v167, v167
  v_cvt_pk_bf16_f32 v172, v160, v161
  v_cvt_pk_bf16_f32 v173, v162, v163
  v_cvt_pk_bf16_f32 v174, v164, v165
  v_cvt_pk_bf16_f32 v175, v166, v167
  v_mfma_f32_32x32x16_bf16 v[152:167], v[224:227], v[24:27], 0
  v_exp_f32 v136, v136
  v_exp_f32 v137, v137
  v_exp_f32 v138, v138
  v_mfma_f32_32x32x16_bf16 v[56:71], v[204:207], v[172:175], v[56:71]
  s_call_b64 s[72:73], .g2_kernel_a_ld1
  v_exp_f32 v139, v139
  v_exp_f32 v140, v140
  v_exp_f32 v141, v141
  v_smfmac_f32_16x16x64_bf16 v[120:123], v[16:19], v[168:175], v20
  v_exp_f32 v142, v142
  v_exp_f32 v143, v143
  v_mfma_f32_32x32x16_bf16 v[152:167], v[228:231], v[28:31], v[152:167]
  v_cvt_pk_bf16_f32 v168, v136, v137
  v_cvt_pk_bf16_f32 v169, v138, v139
  v_cvt_pk_bf16_f32 v170, v140, v141
  v_cvt_pk_bf16_f32 v171, v142, v143
  v_exp_f32 v144, v144
  v_exp_f32 v145, v145
  v_exp_f32 v146, v146
  v_exp_f32 v147, v147
  v_mfma_f32_32x32x16_bf16 v[56:71], v[216:219], v[168:171], v[56:71]
  v_exp_f32 v148, v148
  v_exp_f32 v149, v149
  v_exp_f32 v150, v150
  v_exp_f32 v151, v151
  v_cvt_pk_bf16_f32 v172, v144, v145
  v_cvt_pk_bf16_f32 v173, v146, v147
  v_cvt_pk_bf16_f32 v174, v148, v149
  v_cvt_pk_bf16_f32 v175, v150, v151
  v_exp_f32 v152, v152
  v_exp_f32 v153, v153
  v_exp_f32 v154, v154
  v_mfma_f32_32x32x16_bf16 v[56:71], v[220:223], v[172:175], v[56:71]
  s_call_b64 s[72:73], .g2_kernel_a_ld2
  v_exp_f32 v155, v155
  v_exp_f32 v156, v156
  v_exp_f32 v157, v157
  v_smfmac_f32_16x16x64_bf16 v[120:123], v[16:19], v[168:175], v20
  v_exp_f32 v158, v158
  v_exp_f32 v159, v159
  v_cvt_pk_bf16_f32 v168, v152, v153
  v_cvt_pk_bf16_f32 v169, v154, v155
  v_cvt_pk_bf16_f32 v170, v156, v157
  v_cvt_pk_bf16_f32 v171, v158, v159
  v_exp_f32 v160, v160
  v_exp_f32 v161, v161
  v_exp_f32 v162, v162
  v_exp_f32 v163, v163
  v_mfma_f32_32x32x16_bf16 v[56:71], v[232:235], v[168:171], v[56:71]
  v_exp_f32 v164, v164
  v_exp_f32 v165, v165
  v_exp_f32 v166, v166
  v_exp_f32 v167, v167
  v_cvt_pk_bf16_f32 v172, v160, v161
  v_cvt_pk_bf16_f32 v173, v162, v163
  v_cvt_pk_bf16_f32 v174, v164, v165
  v_cvt_pk_bf16_f32 v175, v166, v167
  s_nop 1
  v_mfma_f32_32x32x16_bf16 v[56:71], v[236:239], v[172:175], v[56:71]
  v_smfmac_f32_16x16x64_bf16 v[120:123], v[16:19], v[168:175], v20
  s_branch .g2_kernel_a_rde
.g2_kernel_a_rd1:
  s_cmp_lg_u32 s28, 1
  s_cbranch_scc1 .g2_kernel_a_rd2
  ds_read_b128 v[32:35], v14 offset:10240
  ds_read_b128 v[36:39], v14 offset:11264
  v_mov_b32 v124, 0
  v_mov_b32 v125, 0
  s_waitcnt lgkmcnt(0)
  v_mfma_f32_32x32x16_bf16 v[136:151], v[176:179], v[32:35], 0
  v_mfma_f32_32x32x16_bf16 v[136:151], v[180:183], v[36:39], v[136:151]
  v_mfma_f32_32x32x16_bf16 v[152:167], v[192:195], v[32:35], 0
  s_nop 10
  v_exp_f32 v136, v136
  v_exp_f32 v137, v137
  v_exp_f32 v138, v138
  v_exp_f32 v139, v139
  v_exp_f32 v140, v140
  v_exp_f32 v141, v141
  v_exp_f32 v142, v142
  v_exp_f32 v143, v143
  v_mfma_f32_32x32x16_bf16 v[152:167], v[196:199], v[36:39], v[152:167]
  v_cvt_pk_bf16_f32 v168, v136, v137
  v_cvt_pk_bf16_f32 v169, v138, v139
  v_cvt_pk_bf16_f32 v170, v140, v141
  v_cvt_pk_bf16_f32 v171, v142, v143
  v_exp_f32 v144, v144
  v_exp_f32 v145, v145
  v_exp_f32 v146, v146
  v_exp_f32 v147, v147
  v_mfma_f32_32x32x16_bf16 v[72:87], v[184:187], v[168:171], 0
  v_exp_f32 v148, v148
  v_exp_f32 v149, v149
  v_exp_f32 v150, v150
  v_exp_f32 v151, v151
  v_cvt_pk_bf16_f32 v172, v144, v145
  v_cvt_pk_bf16_f32 v173, v146, v147
  v_cvt_pk_bf16_f32 v174, v148, v149
  v_cvt_pk_bf16_f32 v175, v150, v151
  v_mfma_f32_32x32x16_bf16 v[136:151], v[208:211], v[32:35], 0
  v_exp_f32 v152, v152
  v_exp_f32 v153, v153
  v_exp_f32 v154, v154
  v_mfma_f32_32x32x16_bf16 v[72:87], v[188:191], v[172:175], v[72:87]
  s_call_b64 s[72:73], .g2_kernel_a_ld0
  v_exp_f32 v155, v155
  v_exp_f32 v156, v156
  v_exp_f32 v157, v157
  v_smfmac_f32_16x16x64_bf16 v[124:127], v[16:19], v[168:175], v20
  v_exp_f32 v158, v158
  v_exp_f32 v159, v159
  v_mfma_f32_32x32x16_bf16 v[136:151], v[212:215], v[36:39], v[136:151]
  v_cvt_pk_bf16_f32 v168, v152, v153
  v_cvt_pk_bf16_f32 v169, v154, v155
  v_cvt_pk_bf16_f32 v170, v156, v157
  v_cvt_pk_bf16_f32 v171, v158, v159
  v_exp_f32 v160, v160
  v_exp_f32 v161, v161
  v_exp_f32 v162, v162
  v_exp_f32 v163, v163
  v_mfma_f32_32x32x16_bf16 v[72:87], v[200:203], v[168:171], v[72:87]
  v_exp_f32 v164, v164
  v_exp_f32 v165, v165
  v_exp_f32 v166, v166
  v_exp_f32 v167, v167
  v_cvt_pk_bf16_f32 v172, v160, v161
  v_cvt_pk_bf16_f32 v173, v162, v163
  v_cvt_pk_bf16_f32 v174, v164, v165
  v_cvt_pk_bf16_f32 v175, v166, v167
  v_mfma_f32_32x32x16_bf16 v[152:167], v[224:227], v[32:35], 0
  v_exp_f32 v136, v136
  v_exp_f32 v137, v137
  v_exp_f32 v138, v138
  v_mfma_f32_32x32x16_bf16 v[72:87], v[204:207], v[172:175], v[72:87]
  s_call_b64 s[72:73], .g2_kernel_a_ld1
  v_exp_f32 v139, v139
  v_exp_f32 v140, v140
  v_exp_f32 v141, v141
  v_smfmac_f32_16x16x64_bf16 v[124:127], v[16:19], v[168:175], v20
  v_exp_f32 v142, v142
  v_exp_f32 v143, v143
  v_mfma_f32_32x32x16_bf16 v[152:167], v[228:231], v[36:39], v[152:167]
  v_cvt_pk_bf16_f32 v168, v136, v137
  v_cvt_pk_bf16_f32 v169, v138, v139
  v_cvt_pk_bf16_f32 v170, v140, v141
  v_cvt_pk_bf16_f32 v171, v142, v143
  v_exp_f32 v144, v144
  v_exp_f32 v145, v145
  v_exp_f32 v146, v146
  v_exp_f32 v147, v147
  v_mfma_f32_32x32x16_bf16 v[72:87], v[216:219], v[168:171], v[72:87]
  v_exp_f32 v148, v148
  v_exp_f32 v149, v149
  v_exp_f32 v150, v150
  v_exp_f32 v151, v151
  v_cvt_pk_bf16_f32 v172, v144, v145
  v_cvt_pk_bf16_f32 v173, v146, v147
  v_cvt_pk_bf16_f32 v174, v148, v149
  v_cvt_pk_bf16_f32 v175, v150, v151
  v_exp_f32 v152, v152
  v_exp_f32 v153, v153
  v_exp_f32 v154, v154
  v_mfma_f32_32x32x16_bf16 v[72:87], v[220:223], v[172:175], v[72:87]
  s_call_b64 s[72:73], .g2_kernel_a_ld2
  v_exp_f32 v155, v155
  v_exp_f32 v156, v156
  v_exp_f32 v157, v157
  v_smfmac_f32_16x16x64_bf16 v[124:127], v[16:19], v[168:175], v20
  v_exp_f32 v158, v158
  v_exp_f32 v159, v159
  v_cvt_pk_bf16_f32 v168, v152, v153
  v_cvt_pk_bf16_f32 v169, v154, v155
  v_cvt_pk_bf16_f32 v170, v156, v157
  v_cvt_pk_bf16_f32 v171, v158, v159
  v_exp_f32 v160, v160
  v_exp_f32 v161, v161
  v_exp_f32 v162, v162
  v_exp_f32 v163, v163
  v_mfma_f32_32x32x16_bf16 v[72:87], v[232:235], v[168:171], v[72:87]
  v_exp_f32 v164, v164
  v_exp_f32 v165, v165
  v_exp_f32 v166, v166
  v_exp_f32 v167, v167
  v_cvt_pk_bf16_f32 v172, v160, v161
  v_cvt_pk_bf16_f32 v173, v162, v163
  v_cvt_pk_bf16_f32 v174, v164, v165
  v_cvt_pk_bf16_f32 v175, v166, v167
  s_nop 1
  v_mfma_f32_32x32x16_bf16 v[72:87], v[236:239], v[172:175], v[72:87]
  v_smfmac_f32_16x16x64_bf16 v[124:127], v[16:19], v[168:175], v20
  s_branch .g2_kernel_a_rde
.g2_kernel_a_rd2:
  s_cmp_lg_u32 s28, 2
  s_cbranch_scc1 .g2_kernel_a_rd3
  ds_read_b128 v[40:43], v14 offset:12288
  ds_read_b128 v[44:47], v14 offset:13312
  v_mov_b32 v128, 0
  v_mov_b32 v129, 0
  s_waitcnt lgkmcnt(0)
  v_mfma_f32_32x32x16_bf16 v[136:151], v[176:179], v[40:43], 0
  v_mfma_f32_32x32x16_bf16 v[136:151], v[180:183], v[44:47], v[136:151]
  v_mfma_f32_32x32x16_bf16 v[152:167], v[192:195], v[40:43], 0
  s_nop 10
  v_exp_f32 v136, v136
  v_exp_f32 v137, v137
  v_exp_f32 v138, v138
  v_exp_f32 v139, v139
  v_exp_f32 v140, v140
  v_exp_f32 v141, v141
  v_exp_f32 v142, v142
  v_exp_f32 v143, v143
  v_mfma_f32_32x32x16_bf16 v[152:167], v[196:199], v[44:47], v[152:167]
  v_cvt_pk_bf16_f32 v168, v136, v137
  v_cvt_pk_bf16_f32 v169, v138, v139
  v_cvt_pk_bf16_f32 v170, v140, v141
  v_cvt_pk_bf16_f32 v171, v142, v143
  v_exp_f32 v144, v144
  v_exp_f32 v145, v145
  v_exp_f32 v146, v146
  v_exp_f32 v147, v147
  v_mfma_f32_32x32x16_bf16 v[88:103], v[184:187], v[168:171], 0
  v_exp_f32 v148, v148
  v_exp_f32 v149, v149
  v_exp_f32 v150, v150
  v_exp_f32 v151, v151
  v_cvt_pk_bf16_f32 v172, v144, v145
  v_cvt_pk_bf16_f32 v173, v146, v147
  v_cvt_pk_bf16_f32 v174, v148, v149
  v_cvt_pk_bf16_f32 v175, v150, v151
  v_mfma_f32_32x32x16_bf16 v[136:151], v[208:211], v[40:43], 0
  v_exp_f32 v152, v152
  v_exp_f32 v153, v153
  v_exp_f32 v154, v154
  v_mfma_f32_32x32x16_bf16 v[88:103], v[188:191], v[172:175], v[88:103]
  s_call_b64 s[72:73], .g2_kernel_a_ld0
  v_exp_f32 v155, v155
  v_exp_f32 v156, v156
  v_exp_f32 v157, v157
  v_smfmac_f32_16x16x64_bf16 v[128:131], v[16:19], v[168:175], v20
  v_exp_f32 v158, v158
  v_exp_f32 v159, v159
  v_mfma_f32_32x32x16_bf16 v[136:151], v[212:215], v[44:47], v[136:151]
  v_cvt_pk_bf16_f32 v168, v152, v153
  v_cvt_pk_bf16_f32 v169, v154, v155
  v_cvt_pk_bf16_f32 v170, v156, v157
  v_cvt_pk_bf16_f32 v171, v158, v159
  v_exp_f32 v160, v160
  v_exp_f32 v161, v161
  v_exp_f32 v162, v162
  v_exp_f32 v163, v163
  v_mfma_f32_32x32x16_bf16 v[88:103], v[200:203], v[168:171], v[88:103]
  v_exp_f32 v164, v164
  v_exp_f32 v165, v165
  v_exp_f32 v166, v166
  v_exp_f32 v167, v167
  v_cvt_pk_bf16_f32 v172, v160, v161
  v_cvt_pk_bf16_f32 v173, v162, v163
  v_cvt_pk_bf16_f32 v174, v164, v165
  v_cvt_pk_bf16_f32 v175, v166, v167
  v_mfma_f32_32x32x16_bf16 v[152:167], v[224:227], v[40:43], 0
  v_exp_f32 v136, v136
  v_exp_f32 v137, v137
  v_exp_f32 v138, v138
  v_mfma_f32_32x32x16_bf16 v[88:103], v[204:207], v[172:175], v[88:103]
  s_call_b64 s[72:73], .g2_kernel_a_ld1
  v_exp_f32 v139, v139
  v_exp_f32 v140, v140
  v_exp_f32 v141, v141
  v_smfmac_f32_16x16x64_bf16 v[128:131], v[16:19], v[168:175], v20
  v_exp_f32 v142, v142
  v_exp_f32 v143, v143
  v_mfma_f32_32x32x16_bf16 v[152:167], v[228:231], v[44:47], v[152:167]
  v_cvt_pk_bf16_f32 v168, v136, v137
  v_cvt_pk_bf16_f32 v169, v138, v139
  v_cvt_pk_bf16_f32 v170, v140, v141
  v_cvt_pk_bf16_f32 v171, v142, v143
  v_exp_f32 v144, v144
  v_exp_f32 v145, v145
  v_exp_f32 v146, v146
  v_exp_f32 v147, v147
  v_mfma_f32_32x32x16_bf16 v[88:103], v[216:219], v[168:171], v[88:103]
  v_exp_f32 v148, v148
  v_exp_f32 v149, v149
  v_exp_f32 v150, v150
  v_exp_f32 v151, v151
  v_cvt_pk_bf16_f32 v172, v144, v145
  v_cvt_pk_bf16_f32 v173, v146, v147
  v_cvt_pk_bf16_f32 v174, v148, v149
  v_cvt_pk_bf16_f32 v175, v150, v151
  v_exp_f32 v152, v152
  v_exp_f32 v153, v153
  v_exp_f32 v154, v154
  v_mfma_f32_32x32x16_bf16 v[88:103], v[220:223], v[172:175], v[88:103]
  s_call_b64 s[72:73], .g2_kernel_a_ld2
  v_exp_f32 v155, v155
  v_exp_f32 v156, v156
  v_exp_f32 v157, v157
  v_smfmac_f32_16x16x64_bf16 v[128:131], v[16:19], v[168:175], v20
  v_exp_f32 v158, v158
  v_exp_f32 v159, v159
  v_cvt_pk_bf16_f32 v168, v152, v153
  v_cvt_pk_bf16_f32 v169, v154, v155
  v_cvt_pk_bf16_f32 v170, v156, v157
  v_cvt_pk_bf16_f32 v171, v158, v159
  v_exp_f32 v160, v160
  v_exp_f32 v161, v161
  v_exp_f32 v162, v162
  v_exp_f32 v163, v163
  v_mfma_f32_32x32x16_bf16 v[88:103], v[232:235], v[168:171], v[88:103]
  v_exp_f32 v164, v164
  v_exp_f32 v165, v165
  v_exp_f32 v166, v166
  v_exp_f32 v167, v167
  v_cvt_pk_bf16_f32 v172, v160, v161
  v_cvt_pk_bf16_f32 v173, v162, v163
  v_cvt_pk_bf16_f32 v174, v164, v165
  v_cvt_pk_bf16_f32 v175, v166, v167
  s_nop 1
  v_mfma_f32_32x32x16_bf16 v[88:103], v[236:239], v[172:175], v[88:103]
  v_smfmac_f32_16x16x64_bf16 v[128:131], v[16:19], v[168:175], v20
  s_branch .g2_kernel_a_rde
.g2_kernel_a_rd3:
  ds_read_b128 v[48:51], v14 offset:14336
  ds_read_b128 v[52:55], v14 offset:15360
  v_mov_b32 v132, 0
  v_mov_b32 v133, 0
  s_waitcnt lgkmcnt(0)
  v_mfma_f32_32x32x16_bf16 v[136:151], v[176:179], v[48:51], 0
  v_mfma_f32_32x32x16_bf16 v[136:151], v[180:183], v[52:55], v[136:151]
  v_mfma_f32_32x32x16_bf16 v[152:167], v[192:195], v[48:51], 0
  s_nop 10
  v_exp_f32 v136, v136
  v_exp_f32 v137, v137
  v_exp_f32 v138, v138
  v_exp_f32 v139, v139
  v_exp_f32 v140, v140
  v_exp_f32 v141, v141
  v_exp_f32 v142, v142
  v_exp_f32 v143, v143
  v_mfma_f32_32x32x16_bf16 v[152:167], v[196:199], v[52:55], v[152:167]
  v_cvt_pk_bf16_f32 v168, v136, v137
  v_cvt_pk_bf16_f32 v169, v138, v139
  v_cvt_pk_bf16_f32 v170, v140, v141
  v_cvt_pk_bf16_f32 v171, v142, v143
  v_exp_f32 v144, v144
  v_exp_f32 v145, v145
  v_exp_f32 v146, v146
  v_exp_f32 v147, v147
  v_mfma_f32_32x32x16_bf16 v[104:119], v[184:187], v[168:171], 0
  v_exp_f32 v148, v148
  v_exp_f32 v149, v149
  v_exp_f32 v150, v150
  v_exp_f32 v151, v151
  v_cvt_pk_bf16_f32 v172, v144, v145
  v_cvt_pk_bf16_f32 v173, v146, v147
  v_cvt_pk_bf16_f32 v174, v148, v149
  v_cvt_pk_bf16_f32 v175, v150, v151
  v_mfma_f32_32x32x16_bf16 v[136:151], v[208:211], v[48:51], 0
  v_exp_f32 v152, v152
  v_exp_f32 v153, v153
  v_exp_f32 v154, v154
  v_mfma_f32_32x32x16_bf16 v[104:119], v[188:191], v[172:175], v[104:119]
  s_call_b64 s[72:73], .g2_kernel_a_ld0
  v_exp_f32 v155, v155
  v_exp_f32 v156, v156
  v_exp_f32 v157, v157
  v_smfmac_f32_16x16x64_bf16 v[132:135], v[16:19], v[168:175], v20
  v_exp_f32 v158, v158
  v_exp_f32 v159, v159
  v_mfma_f32_32x32x16_bf16 v[136:151], v[212:215], v[52:55], v[136:151]
  v_cvt_pk_bf16_f32 v168, v152, v153
  v_cvt_pk_bf16_f32 v169, v154, v155
  v_cvt_pk_bf16_f32 v170, v156, v157
  v_cvt_pk_bf16_f32 v171, v158, v159
  v_exp_f32 v160, v160
  v_exp_f32 v161, v161
  v_exp_f32 v162, v162
  v_exp_f32 v163, v163
  v_mfma_f32_32x32x16_bf16 v[104:119], v[200:203], v[168:171], v[104:119]
  v_exp_f32 v164, v164
  v_exp_f32 v165, v165
  v_exp_f32 v166, v166
  v_exp_f32 v167, v167
  v_cvt_pk_bf16_f32 v172, v160, v161
  v_cvt_pk_bf16_f32 v173, v162, v163
  v_cvt_pk_bf16_f32 v174, v164, v165
  v_cvt_pk_bf16_f32 v175, v166, v167
  v_mfma_f32_32x32x16_bf16 v[152:167], v[224:227], v[48:51], 0
  v_exp_f32 v136, v136
  v_exp_f32 v137, v137
  v_exp_f32 v138, v138
  v_mfma_f32_32x32x16_bf16 v[104:119], v[204:207], v[172:175], v[104:119]
  s_call_b64 s[72:73], .g2_kernel_a_ld1
  v_exp_f32 v139, v139
  v_exp_f32 v140, v140
  v_exp_f32 v141, v141
  v_smfmac_f32_16x16x64_bf16 v[132:135], v[16:19], v[168:175], v20
  v_exp_f32 v142, v142
  v_exp_f32 v143, v143
  v_mfma_f32_32x32x16_bf16 v[152:167], v[228:231], v[52:55], v[152:167]
  v_cvt_pk_bf16_f32 v168, v136, v137
  v_cvt_pk_bf16_f32 v169, v138, v139
  v_cvt_pk_bf16_f32 v170, v140, v141
  v_cvt_pk_bf16_f32 v171, v142, v143
  v_exp_f32 v144, v144
  v_exp_f32 v145, v145
  v_exp_f32 v146, v146
  v_exp_f32 v147, v147
  v_mfma_f32_32x32x16_bf16 v[104:119], v[216:219], v[168:171], v[104:119]
  v_exp_f32 v148, v148
  v_exp_f32 v149, v149
  v_exp_f32 v150, v150
  v_exp_f32 v151, v151
  v_cvt_pk_bf16_f32 v172, v144, v145
  v_cvt_pk_bf16_f32 v173, v146, v147
  v_cvt_pk_bf16_f32 v174, v148, v149
  v_cvt_pk_bf16_f32 v175, v150, v151
  v_exp_f32 v152, v152
  v_exp_f32 v153, v153
  v_exp_f32 v154, v154
  v_mfma_f32_32x32x16_bf16 v[104:119], v[220:223], v[172:175], v[104:119]
  s_call_b64 s[72:73], .g2_kernel_a_ld2
  v_exp_f32 v155, v155
  v_exp_f32 v156, v156
  v_exp_f32 v157, v157
  v_smfmac_f32_16x16x64_bf16 v[132:135], v[16:19], v[168:175], v20
  v_exp_f32 v158, v158
  v_exp_f32 v159, v159
  v_cvt_pk_bf16_f32 v168, v152, v153
  v_cvt_pk_bf16_f32 v169, v154, v155
  v_cvt_pk_bf16_f32 v170, v156, v157
  v_cvt_pk_bf16_f32 v171, v158, v159
  v_exp_f32 v160, v160
  v_exp_f32 v161, v161
  v_exp_f32 v162, v162
  v_exp_f32 v163, v163
  v_mfma_f32_32x32x16_bf16 v[104:119], v[232:235], v[168:171], v[104:119]
  v_exp_f32 v164, v164
  v_exp_f32 v165, v165
  v_exp_f32 v166, v166
  v_exp_f32 v167, v167
  v_cvt_pk_bf16_f32 v172, v160, v161
  v_cvt_pk_bf16_f32 v173, v162, v163
  v_cvt_pk_bf16_f32 v174, v164, v165
  v_cvt_pk_bf16_f32 v175, v166, v167
  s_nop 1
  v_mfma_f32_32x32x16_bf16 v[104:119], v[236:239], v[172:175], v[104:119]
  v_smfmac_f32_16x16x64_bf16 v[132:135], v[16:19], v[168:175], v20
  s_branch .g2_kernel_a_rde
.g2_kernel_a_rd4:
.g2_kernel_a_rde:
  v_mov_b32 v168, 0
  v_mov_b32 v169, 0
  v_mov_b32 v170, 0
  v_mov_b32 v171, 0
  v_mov_b32 v172, 0
  v_mov_b32 v173, 0
  v_mov_b32 v174, 0
  v_mov_b32 v175, 0
  s_waitcnt vmcnt(8)
  v_mfma_f32_32x32x16_bf16 v[136:151], v[176:179], v[24:27], 0
  v_mfma_f32_32x32x16_bf16 v[136:151], v[180:183], v[28:31], v[136:151]
  s_nop 10
  s_branch .g2_kernel_a_loop
.g2_kernel_a_ld0:
  s_andn2_b32 s33, s36, s34
  s_cbranch_scc0 .g2_kernel_a_r0c
.g2_kernel_a_r0b:
  s_ff1_i32_b32 s33, s33
  s_bitset1_b32 s34, s33
  s_xor_b32 s33, s33, s24
  s_lshl_b32 s33, s33, s25
  s_add_u32 s22, s20, s33
  s_addc_u32 s23, s21, 0
  global_load_dwordx4 v[176:179], v3, s[22:23] offset:0
  global_load_dwordx4 v[180:183], v3, s[22:23] offset:1024
  global_load_dwordx4 v[184:187], v3, s[22:23] offset:2048
  global_load_dwordx4 v[188:191], v3, s[22:23] offset:3072
  s_setpc_b64 s[72:73]
.g2_kernel_a_ld1:
  s_andn2_b32 s33, s36, s34
  s_cbranch_scc0 .g2_kernel_a_r1c
.g2_kernel_a_r1b:
  s_ff1_i32_b32 s33, s33
  s_bitset1_b32 s34, s33
  s_xor_b32 s33, s33, s24
  s_lshl_b32 s33, s33, s25
  s_add_u32 s22, s20, s33
  s_addc_u32 s23, s21, 0
  global_load_dwordx4 v[192:195], v3, s[22:23] offset:0
  global_load_dwordx4 v[196:199], v3, s[22:23] offset:1024
  global_load_dwordx4 v[200:203], v3, s[22:23] offset:2048
  global_load_dwordx4 v[204:207], v3, s[22:23] offset:3072
  s_setpc_b64 s[72:73]
.g2_kernel_a_ld2:
  s_andn2_b32 s33, s36, s34
  s_cbranch_scc0 .g2_kernel_a_r2c
.g2_kernel_a_r2b:
  s_ff1_i32_b32 s33, s33
  s_bitset1_b32 s34, s33
  s_xor_b32 s33, s33, s24
  s_lshl_b32 s33, s33, s25
  s_add_u32 s22, s20, s33
  s_addc_u32 s23, s21, 0
  global_load_dwordx4 v[208:211], v3, s[22:23] offset:0
  global_load_dwordx4 v[212:215], v3, s[22:23] offset:1024
  global_load_dwordx4 v[216:219], v3, s[22:23] offset:2048
  global_load_dwordx4 v[220:223], v3, s[22:23] offset:3072
  s_setpc_b64 s[72:73]
.g2_kernel_a_N0c:
  s_call_b64 s[68:69], .g2_kernel_a_pick
  s_branch .g2_kernel_a_N0b
.g2_kernel_a_N1c:
  s_call_b64 s[68:69], .g2_kernel_a_pick
  s_branch .g2_kernel_a_N1b
.g2_kernel_a_N2c:
  s_call_b64 s[68:69], .g2_kernel_a_pick
  s_branch .g2_kernel_a_N2b
.g2_kernel_a_N3c:
  s_call_b64 s[68:69], .g2_kernel_a_pick
  s_branch .g2_kernel_a_N3b
.g2_kernel_a_L3c:
  s_call_b64 s[68:69], .g2_kernel_a_pick
  s_branch .g2_kernel_a_L3b
.g2_kernel_a_G0c:
  s_call_b64 s[68:69], .g2_kernel_a_pick
  s_branch .g2_kernel_a_G0b
.g2_kernel_a_L3g:
  s_mov_b32 s38, 0
.g2_kernel_a_L3gl:
  ds_read_b32 v7, v13 offset:8
  s_add_u32 s38, s38, 1
  s_waitcnt lgkmcnt(0)
  v_cmp_gt_u32 vcc, s27, v7
  s_cbranch_vccz .g2_kernel_a_L3h
  s_cmp_lt_u32 s38, 524288
  s_cbranch_scc1 .g2_kernel_a_L3gl
  s_branch .g2_kernel_a_L3h
.g2_kernel_a_hold:
  s_lshl_b32 s33, 1, s14
  s_lshr_b32 s14, s14, 8
  s_setpc_b64 s[68:69]
.g2_kernel_a_pick:
  s_cmp_lg_u32 s34, -1
  s_cbranch_scc1 .g2_kernel_a_pk1
  s_cmp_eq_u32 s26, -1
  s_cbranch_scc1 .g2_kernel_a_hold
  s_add_u32 s26, s26, 1
  s_mov_b32 s34, 0xffff
  s_cmp_eq_u32 s26, 1
  s_cbranch_scc1 .g2_kernel_a_pk1
  v_and_b32 v8, 15, v2
  s_lshl_b32 s28, s16, 6
  s_add_u32 s28, s28, 157696
  v_lshl_add_u32 v8, v8, 2, s28
  s_lshl_b32 s28, s17, 2
  s_add_u32 s28, s28, s16
  s_lshl_b32 s28, s28, 16
  s_add_u32 s28, s28, s63
  s_add_u32 s28, s28, 0x800000
  s_add_u32 s20, s60, s28
  s_addc_u32 s21, s61, 0
  s_lshl_b32 s24, s18, 1
  s_and_b32 s24, s24, 6
  s_mov_b32 s25, 12
  s_mov_b32 s34, 0
  s_mov_b32 s36, 0xff
  s_mov_b32 s33, 0xff
  s_mov_b32 s38, 0
.g2_kernel_a_pk2:
  ds_read_b32 v7, v8
  s_add_u32 s38, s38, 1
  s_waitcnt lgkmcnt(0)
  v_cmp_ge_u32 vcc, s62, v7
  s_cbranch_vccz .g2_kernel_a_pkr
  s_cmp_lt_u32 s38, 524288
  s_cbranch_scc1 .g2_kernel_a_pk2
  s_branch .g2_kernel_a_pkr
.g2_kernel_a_pk1:
  s_mov_b32 s38, 0
.g2_kernel_a_pkl:
  ds_read_b32 v7, v8
  s_add_u32 s38, s38, 1
  s_waitcnt lgkmcnt(0)
  v_cmp_lt_u32 vcc, s62, v7
  s_mov_b32 s36, vcc_lo
  s_andn2_b32 s33, s36, s34
  s_cbranch_scc1 .g2_kernel_a_pkr
  s_cmp_lt_u32 s38, 524288
  s_cbranch_scc1 .g2_kernel_a_pkl
  s_not_b32 s33, s34
.g2_kernel_a_pkr:
  s_setpc_b64 s[68:69]
.g2_kernel_w_aw:
  v_mov_b32 v6, s71
  s_mov_b32 s38, 0
.g2_kernel_wg4:
  ds_read_b32 v7, v6 offset:52
  s_add_u32 s38, s38, 1
  s_waitcnt lgkmcnt(0)
  v_cmp_le_u32 vcc, 4, v7
  s_cbranch_vccnz .g2_kernel_wg4d
  s_sleep 1
  s_cmp_lt_u32 s38, 524288
  s_cbranch_scc1 .g2_kernel_wg4
.g2_kernel_wg4d:
  s_branch .g2_kernel_w_ab
.g2_kernel_w_pt:
  v_lshlrev_b32 v7, 5, v17
  v_add_u32 v7, 155648, v7
  s_mov_b64 exec, vcc
  ds_read_b128 v[240:243], v7 offset:7680
  ds_read_b128 v[244:247], v7 offset:7696
  ds_read_b128 v[248:251], v7 offset:7744
  ds_read_b128 v[252:255], v7 offset:7760
  s_waitcnt lgkmcnt(0)
  v_pk_add_f32 v[24:25], v[24:25], v[240:241]
  v_pk_add_f32 v[26:27], v[26:27], v[242:243]
  v_pk_add_f32 v[28:29], v[28:29], v[244:245]
  v_pk_add_f32 v[30:31], v[30:31], v[246:247]
  v_pk_add_f32 v[32:33], v[32:33], v[248:249]
  v_pk_add_f32 v[34:35], v[34:35], v[250:251]
  v_pk_add_f32 v[36:37], v[36:37], v[252:253]
  v_pk_add_f32 v[38:39], v[38:39], v[254:255]
  ds_read_b128 v[240:243], v7 offset:7808
  ds_read_b128 v[244:247], v7 offset:7824
  ds_read_b128 v[248:251], v7 offset:7872
  ds_read_b128 v[252:255], v7 offset:7888
  s_waitcnt lgkmcnt(0)
  v_pk_add_f32 v[40:41], v[40:41], v[240:241]
  v_pk_add_f32 v[42:43], v[42:43], v[242:243]
  v_pk_add_f32 v[44:45], v[44:45], v[244:245]
  v_pk_add_f32 v[46:47], v[46:47], v[246:247]
  v_pk_add_f32 v[48:49], v[48:49], v[248:249]
  v_pk_add_f32 v[50:51], v[50:51], v[250:251]
  v_pk_add_f32 v[52:53], v[52:53], v[252:253]
  v_pk_add_f32 v[54:55], v[54:55], v[254:255]
  s_mov_b64 exec, -1
  s_branch .g2_kernel_w_pb
.g2_kernel_w_i8c:
  s_mov_b32 s38, 0
  s_call_b64 s[68:69], .g2_kernel_w_pkl
  s_branch .g2_kernel_w_i8b
.g2_kernel_w_i9c:
  s_mov_b32 s38, 0
  s_call_b64 s[68:69], .g2_kernel_w_pkl
  s_branch .g2_kernel_w_i9b
.g2_kernel_w_i10c:
  s_mov_b32 s38, 0
  s_call_b64 s[68:69], .g2_kernel_w_pkl
  s_branch .g2_kernel_w_i10b
.g2_kernel_w_i11c:
  s_mov_b32 s38, 0
  s_call_b64 s[68:69], .g2_kernel_w_pkl
  s_branch .g2_kernel_w_i11b
.g2_kernel_w_v8:
  s_cmp_ge_u32 s8, 139264
  s_cselect_b32 s28, 139264, 0
  s_sub_u32 s28, s8, s28
  s_lshr_b32 s28, s28, 1
  s_add_u32 s28, s28, 32768
  s_add_u32 s22, s20, s28
  s_addc_u32 s23, s21, 0
  s_mov_b32 s38, 0
.g2_kernel_w_vl8:
  global_load_dwordx4 v[88:91], v3, s[22:23] offset:0 sc1
  global_load_dwordx4 v[92:95], v3, s[22:23] offset:1024 sc1
  global_load_dwordx4 v[96:99], v3, s[22:23] offset:2048 sc1
  global_load_dwordx4 v[100:103], v3, s[22:23] offset:3072 sc1
  s_add_u32 s38, s38, 1
  s_waitcnt vmcnt(0)
  v_min3_u32 v6, v88, v90, v92
  v_min3_u32 v7, v94, v96, v98
  v_min3_u32 v6, v6, v100, v102
  v_min_u32 v6, v6, v7
  v_cmp_eq_u32 vcc, 0, v6
  s_cbranch_vccz .g2_kernel_w_vb8
  s_cmp_lt_u32 s38, 131072
  s_cbranch_scc1 .g2_kernel_w_vl8
  s_branch .g2_kernel_w_vb8
.g2_kernel_w_i12c:
  s_mov_b32 s38, 0
  s_call_b64 s[68:69], .g2_kernel_w_pkl
  s_branch .g2_kernel_w_i12b
.g2_kernel_w_v9:
  s_cmp_ge_u32 s9, 139264
  s_cselect_b32 s28, 139264, 0
  s_sub_u32 s28, s9, s28
  s_lshr_b32 s28, s28, 1
  s_add_u32 s28, s28, 32768
  s_add_u32 s22, s20, s28
  s_addc_u32 s23, s21, 0
  s_mov_b32 s38, 0
.g2_kernel_w_vl9:
  global_load_dwordx4 v[176:179], v3, s[22:23] offset:0 sc1
  global_load_dwordx4 v[180:183], v3, s[22:23] offset:1024 sc1
  global_load_dwordx4 v[184:187], v3, s[22:23] offset:2048 sc1
  global_load_dwordx4 v[188:191], v3, s[22:23] offset:3072 sc1
  s_add_u32 s38, s38, 1
  s_waitcnt vmcnt(0)
  v_min3_u32 v6, v176, v178, v180
  v_min3_u32 v7, v182, v184, v186
  v_min3_u32 v6, v6, v188, v190
  v_min_u32 v6, v6, v7
  v_cmp_eq_u32 vcc, 0, v6
  s_cbranch_vccz .g2_kernel_w_vb9
  s_cmp_lt_u32 s38, 131072
  s_cbranch_scc1 .g2_kernel_w_vl9
  s_branch .g2_kernel_w_vb9
.g2_kernel_w_i13c:
  s_mov_b32 s38, 0
  s_call_b64 s[68:69], .g2_kernel_w_pkl
  s_branch .g2_kernel_w_i13b
.g2_kernel_w_v10:
  s_cmp_ge_u32 s10, 139264
  s_cselect_b32 s28, 139264, 0
  s_sub_u32 s28, s10, s28
  s_lshr_b32 s28, s28, 1
  s_add_u32 s28, s28, 32768
  s_add_u32 s22, s20, s28
  s_addc_u32 s23, s21, 0
  s_mov_b32 s38, 0
.g2_kernel_w_vl10:
  global_load_dwordx4 v[192:195], v3, s[22:23] offset:0 sc1
  global_load_dwordx4 v[196:199], v3, s[22:23] offset:1024 sc1
  global_load_dwordx4 v[200:203], v3, s[22:23] offset:2048 sc1
  global_load_dwordx4 v[204:207], v3, s[22:23] offset:3072 sc1
  s_add_u32 s38, s38, 1
  s_waitcnt vmcnt(0)
  v_min3_u32 v6, v192, v194, v196
  v_min3_u32 v7, v198, v200, v202
  v_min3_u32 v6, v6, v204, v206
  v_min_u32 v6, v6, v7
  v_cmp_eq_u32 vcc, 0, v6
  s_cbranch_vccz .g2_kernel_w_vb10
  s_cmp_lt_u32 s38, 131072
  s_cbranch_scc1 .g2_kernel_w_vl10
  s_branch .g2_kernel_w_vb10
.g2_kernel_w_i14c:
  s_mov_b32 s38, 524288
  s_call_b64 s[68:69], .g2_kernel_w_pkl
  s_branch .g2_kernel_w_i14b
.g2_kernel_w_v11:
  s_cmp_ge_u32 s11, 139264
  s_cselect_b32 s28, 139264, 0
  s_sub_u32 s28, s11, s28
  s_lshr_b32 s28, s28, 1
  s_add_u32 s28, s28, 32768
  s_add_u32 s22, s20, s28
  s_addc_u32 s23, s21, 0
  s_mov_b32 s38, 0
.g2_kernel_w_vl11:
  global_load_dwordx4 v[208:211], v3, s[22:23] offset:0 sc1
  global_load_dwordx4 v[212:215], v3, s[22:23] offset:1024 sc1
  global_load_dwordx4 v[216:219], v3, s[22:23] offset:2048 sc1
  global_load_dwordx4 v[220:223], v3, s[22:23] offset:3072 sc1
  s_add_u32 s38, s38, 1
  s_waitcnt vmcnt(0)
  v_min3_u32 v6, v208, v210, v212
  v_min3_u32 v7, v214, v216, v218
  v_min3_u32 v6, v6, v220, v222
  v_min_u32 v6, v6, v7
  v_cmp_eq_u32 vcc, 0, v6
  s_cbranch_vccz .g2_kernel_w_vb11
  s_cmp_lt_u32 s38, 131072
  s_cbranch_scc1 .g2_kernel_w_vl11
  s_branch .g2_kernel_w_vb11
.g2_kernel_w_i15c:
  s_mov_b32 s38, 524288
  s_call_b64 s[68:69], .g2_kernel_w_pkl
  s_branch .g2_kernel_w_i15b
.g2_kernel_w_v12:
  s_cmp_ge_u32 s12, 139264
  s_cselect_b32 s28, 139264, 0
  s_sub_u32 s28, s12, s28
  s_lshr_b32 s28, s28, 1
  s_add_u32 s28, s28, 32768
  s_add_u32 s22, s20, s28
  s_addc_u32 s23, s21, 0
  s_mov_b32 s38, 0
.g2_kernel_w_vl12:
  global_load_dwordx4 v[224:227], v3, s[22:23] offset:0 sc1
  global_load_dwordx4 v[228:231], v3, s[22:23] offset:1024 sc1
  global_load_dwordx4 v[232:235], v3, s[22:23] offset:2048 sc1
  global_load_dwordx4 v[236:239], v3, s[22:23] offset:3072 sc1
  s_add_u32 s38, s38, 1
  s_waitcnt vmcnt(0)
  v_min3_u32 v6, v224, v226, v228
  v_min3_u32 v7, v230, v232, v234
  v_min3_u32 v6, v6, v236, v238
  v_min_u32 v6, v6, v7
  v_cmp_eq_u32 vcc, 0, v6
  s_cbranch_vccz .g2_kernel_w_vb12
  s_cmp_lt_u32 s38, 131072
  s_cbranch_scc1 .g2_kernel_w_vl12
  s_branch .g2_kernel_w_vb12
.g2_kernel_w_v13:
  s_cmp_ge_u32 s13, 139264
  s_cselect_b32 s28, 139264, 0
  s_sub_u32 s28, s13, s28
  s_lshr_b32 s28, s28, 1
  s_add_u32 s28, s28, 32768
  s_add_u32 s22, s20, s28
  s_addc_u32 s23, s21, 0
  s_mov_b32 s38, 0
.g2_kernel_w_vl13:
  global_load_dwordx4 v[136:139], v3, s[22:23] offset:0 sc1
  global_load_dwordx4 v[140:143], v3, s[22:23] offset:1024 sc1
  global_load_dwordx4 v[144:147], v3, s[22:23] offset:2048 sc1
  global_load_dwordx4 v[148:151], v3, s[22:23] offset:3072 sc1
  s_add_u32 s38, s38, 1
  s_waitcnt vmcnt(0)
  v_min3_u32 v6, v136, v138, v140
  v_min3_u32 v7, v142, v144, v146
  v_min3_u32 v6, v6, v148, v150
  v_min_u32 v6, v6, v7
  v_cmp_eq_u32 vcc, 0, v6
  s_cbranch_vccz .g2_kernel_w_vb13
  s_cmp_lt_u32 s38, 131072
  s_cbranch_scc1 .g2_kernel_w_vl13
  s_branch .g2_kernel_w_vb13
.g2_kernel_w_v14:
  s_cmp_ge_u32 s14, 139264
  s_cselect_b32 s28, 139264, 0
  s_sub_u32 s28, s14, s28
  s_lshr_b32 s28, s28, 1
  s_add_u32 s28, s28, 32768
  s_add_u32 s22, s20, s28
  s_addc_u32 s23, s21, 0
  s_mov_b32 s38, 0
.g2_kernel_w_vl14:
  global_load_dwordx4 v[152:155], v3, s[22:23] offset:0 sc1
  global_load_dwordx4 v[156:159], v3, s[22:23] offset:1024 sc1
  global_load_dwordx4 v[160:163], v3, s[22:23] offset:2048 sc1
  global_load_dwordx4 v[164:167], v3, s[22:23] offset:3072 sc1
  s_add_u32 s38, s38, 1
  s_waitcnt vmcnt(0)
  v_min3_u32 v6, v152, v154, v156
  v_min3_u32 v7, v158, v160, v162
  v_min3_u32 v6, v6, v164, v166
  v_min_u32 v6, v6, v7
  v_cmp_eq_u32 vcc, 0, v6
  s_cbranch_vccz .g2_kernel_w_vb14
  s_cmp_lt_u32 s38, 131072
  s_cbranch_scc1 .g2_kernel_w_vl14
  s_branch .g2_kernel_w_vb14
.g2_kernel_w_v15:
  s_cmp_ge_u32 s15, 139264
  s_cselect_b32 s28, 139264, 0
  s_sub_u32 s28, s15, s28
  s_lshr_b32 s28, s28, 1
  s_add_u32 s28, s28, 32768
  s_add_u32 s22, s20, s28
  s_addc_u32 s23, s21, 0
  s_mov_b32 s38, 0
.g2_kernel_w_vl15:
  global_load_dwordx4 v[56:59], v3, s[22:23] offset:0 sc1
  global_load_dwordx4 v[60:63], v3, s[22:23] offset:1024 sc1
  global_load_dwordx4 v[64:67], v3, s[22:23] offset:2048 sc1
  global_load_dwordx4 v[68:71], v3, s[22:23] offset:3072 sc1
  s_add_u32 s38, s38, 1
  s_waitcnt vmcnt(0)
  v_min3_u32 v6, v56, v58, v60
  v_min3_u32 v7, v62, v64, v66
  v_min3_u32 v6, v6, v68, v70
  v_min_u32 v6, v6, v7
  v_cmp_eq_u32 vcc, 0, v6
  s_cbranch_vccz .g2_kernel_w_vb15
  s_cmp_lt_u32 s38, 131072
  s_cbranch_scc1 .g2_kernel_w_vl15
  s_branch .g2_kernel_w_vb15
.g2_kernel_w_bw:
  s_mov_b32 s38, 0
.g2_kernel_w_bwl:
  ds_read_b32 v16, v20 offset:12
  s_add_u32 s38, s38, 1
  s_waitcnt lgkmcnt(0)
  v_cmp_gt_u32 vcc, 4, v16
  s_cbranch_vccz .g2_kernel_w_bb
  s_cmp_lt_u32 s38, 524288
  s_cbranch_scc1 .g2_kernel_w_bwl
  s_branch .g2_kernel_w_bb
.g2_kernel_w_pick:
  s_mov_b32 s38, 0
.g2_kernel_w_pkl:
  ds_read_b64 v[6:7], v21
  s_add_u32 s38, s38, 1
  s_waitcnt lgkmcnt(0)
  v_min_u32 v6, v6, v7
  v_cmp_lt_u32 vcc, s62, v6
  s_and_b32 s36, vcc_lo, 0xff00
  s_andn2_b32 s33, s36, s34
  s_cbranch_scc1 .g2_kernel_w_pkr
  s_cmp_lt_u32 s38, 524288
  s_cbranch_scc1 .g2_kernel_w_pkl
  s_andn2_b32 s33, 0xff00, s34
.g2_kernel_w_pkr:
  s_setpc_b64 s[68:69]
.g2_kernel_p_spin:
  s_mov_b32 s38, 0
.g2_kernel_p_spinl:
  ds_read_b32 v10, v9
  s_add_u32 s38, s38, 1
  s_waitcnt lgkmcnt(0)
  v_cmp_gt_i32 vcc, s34, v10
  s_cbranch_vccz .g2_kernel_p_spinr
  s_sleep 1
  s_cmp_lt_u32 s38, 524288
  s_cbranch_scc1 .g2_kernel_p_spinl
.g2_kernel_p_spinr:
  s_setpc_b64 s[68:69]
.g2_kernel_p1_aw:
  s_call_b64 s[68:69], .g2_kernel_p_spin
  s_branch .g2_kernel_p1_ai
.g2_kernel_p1_bw:
  s_call_b64 s[68:69], .g2_kernel_p_spin
  s_branch .g2_kernel_p1_bi
.g2_kernel_v_3a:
  s_and_b32 s31, s76, 0xffffe000
  s_add_u32 s31, s31, 0
  v_and_b32 v6, 15, v2
  v_lshlrev_b32 v6, 9, v6
  v_lshrrev_b32 v7, 4, v2
  v_lshl_add_u32 v6, v7, 7, v6
  v_lshlrev_b32 v7, 2, v2
  v_add_u32 v7, 157440, v7
  s_mov_b32 m0, 157440
  s_mov_b32 s38, 0
  s_mov_b32 exec_lo, 0xffff0000
  s_mov_b32 exec_hi, 0xffff0000
.g2_kernel_pa22:
  buffer_load_dword v6, s[4:7], s31 offen sc1 lds
  s_add_u32 s38, s38, 1
  s_waitcnt vmcnt(0)
  ds_read_b32 v8, v7
  s_waitcnt lgkmcnt(0)
  v_cmp_ge_u32 vcc, s62, v8
  s_cbranch_vccz .g2_kernel_pa22d
  s_mov_b64 exec, vcc
  s_sleep 16
  s_cmp_lt_u32 s38, 131072
  s_cbranch_scc1 .g2_kernel_pa22
.g2_kernel_pa22d:
  s_mov_b64 exec, -1
  s_branch .g2_kernel_v_3
.g2_kernel_v_may:
  s_cmp_lg_u32 s39, 0
  s_cbranch_scc1 .g2_kernel_v_mr
  s_and_b32 s28, s16, 3
  s_lshl_b32 s28, s28, 4
  s_add_u32 s28, s28, 155968
  v_mov_b32 v6, s28
  ds_read_b32 v7, v6
  s_waitcnt lgkmcnt(0)
  v_cmp_ne_u32 vcc, 0, v7
  s_cbranch_vccz .g2_kernel_v_mr
.g2_kernel_v_do:
  s_mov_b32 s39, 1
  s_mov_b32 s29, 0
  s_call_b64 s[68:69], .g2_kernel_v_cmb
  s_waitcnt vmcnt(0)
  v_mov_b32 v6, s71
  s_mov_b64 exec, 1
  ds_add_u32 v6, v5 offset:8
  s_mov_b64 exec, -1
  s_and_b32 s33, s16, 3
  s_lshl_b32 s33, s33, 7
  s_lshl_b32 s28, s29, 2
  s_add_u32 s33, s33, s28
  s_add_u32 s31, s19, s33
  v_mov_b32 v6, s70
  s_mov_b64 exec, 1
  buffer_store_dword v6, v4, s[4:7], s31 offen offset:0 sc1
  s_mov_b64 exec, -1
.g2_kernel_v_mr:
  s_setpc_b64 s[26:27]
.g2_kernel_v_wo:
  s_mov_b32 s8, s44
  s_mov_b32 s9, s45
  s_mov_b32 s10, 0x200000
  s_mov_b32 s11, 0x00020000
  v_lshrrev_b32 v6, 3, v2
  v_and_b32 v7, 7, v2
  v_bfe_u32 v8, v2, 4, 1
  v_lshlrev_b32 v8, 2, v8
  v_xor_b32 v7, v7, v8
  v_lshlrev_b32 v7, 4, v7
  v_lshl_add_u32 v6, v6, 11, v7
  s_and_b32 s31, s16, 3
  s_lshl_b32 s31, s31, 3
  s_add_u32 s31, s31, s29
  s_lshl_b32 s31, s31, 16
  s_lshl_b32 s33, s18, 7
  s_add_u32 s31, s31, s33
  s_mov_b32 m0, s30
  s_nop 0
  buffer_load_dwordx4 v6, s[8:11], s31 offen lds
  s_add_u32 m0, m0, 1024
  s_add_u32 s31, s31, 16384
  s_sleep 1
  buffer_load_dwordx4 v6, s[8:11], s31 offen lds
  s_add_u32 m0, m0, 1024
  s_add_u32 s31, s31, 16384
  s_sleep 1
  buffer_load_dwordx4 v6, s[8:11], s31 offen lds
  s_add_u32 m0, m0, 1024
  s_add_u32 s31, s31, 16384
  s_sleep 1
  buffer_load_dwordx4 v6, s[8:11], s31 offen lds
  s_add_u32 m0, m0, 1024
  s_add_u32 s31, s31, 81920
  s_sleep 1
  buffer_load_dwordx4 v6, s[8:11], s31 offen lds
  s_add_u32 m0, m0, 1024
  s_add_u32 s31, s31, 16384
  s_sleep 1
  buffer_load_dwordx4 v6, s[8:11], s31 offen lds
  s_add_u32 m0, m0, 1024
  s_add_u32 s31, s31, 16384
  s_sleep 1
  buffer_load_dwordx4 v6, s[8:11], s31 offen lds
  s_add_u32 m0, m0, 1024
  s_add_u32 s31, s31, 16384
  s_sleep 1
  buffer_load_dwordx4 v6, s[8:11], s31 offen lds
  s_add_u32 m0, m0, 1024
  s_add_u32 s31, s31, 81920
  s_sleep 1
  buffer_load_dwordx4 v6, s[8:11], s31 offen lds
  s_add_u32 m0, m0, 1024
  s_add_u32 s31, s31, 16384
  s_sleep 1
  buffer_load_dwordx4 v6, s[8:11], s31 offen lds
  s_add_u32 m0, m0, 1024
  s_add_u32 s31, s31, 16384
  s_sleep 1
  buffer_load_dwordx4 v6, s[8:11], s31 offen lds
  s_add_u32 m0, m0, 1024
  s_add_u32 s31, s31, 16384
  s_sleep 1
  buffer_load_dwordx4 v6, s[8:11], s31 offen lds
  s_add_u32 m0, m0, 1024
  s_add_u32 s31, s31, 81920
  s_sleep 1
  buffer_load_dwordx4 v6, s[8:11], s31 offen lds
  s_add_u32 m0, m0, 1024
  s_add_u32 s31, s31, 16384
  s_sleep 1
  buffer_load_dwordx4 v6, s[8:11], s31 offen lds
  s_add_u32 m0, m0, 1024
  s_add_u32 s31, s31, 16384
  s_sleep 1
  buffer_load_dwordx4 v6, s[8:11], s31 offen lds
  s_add_u32 m0, m0, 1024
  s_add_u32 s31, s31, 16384
  s_sleep 1
  buffer_load_dwordx4 v6, s[8:11], s31 offen lds
  s_setpc_b64 s[68:69]
.g2_kernel_v_cmb:
  s_and_b32 s28, s16, 3
  s_lshl_b32 s30, s28, 2
  s_lshl_b32 s34, 15, s30
  s_lshr_b32 s32, s34, 4
  s_or_b32 s32, s32, s34
  s_mul_i32 s32, s32, s29
  v_and_b32 v6, 15, v2
  v_lshlrev_b32 v6, 2, v6
  v_add_u32 v6, 155968, v6
  s_mov_b32 s30, .g2_kernel_sel-.g2_kernel_pc
  buffer_load_dwordx4 v[8:11], v3, s[64:67], s30 offen
  buffer_load_dwordx4 v[12:15], v3, s[64:67], s30 offen offset:1024
  s_lshl_b32 s30, s28, 13
  v_add_u32 v0, s30, v3
  v_and_b32 v4, 31, v2
  s_lshl_b32 s31, s28, 9
  s_add_u32 s31, s31, 161280
  v_lshl_add_u32 v4, v4, 2, s31
  s_lshl_b32 s33, s62, 1
  s_add_u32 s33, s33, s29
  s_lshl_b32 s31, s17, 2
  s_add_u32 s31, s31, s28
  s_lshl_b32 s31, s31, 1
  s_add_u32 s31, s31, s29
  s_lshl_b32 s31, s31, 4
  s_add_u32 s31, s31, s18
  s_lshl_b32 s31, s31, 11
  s_add_u32 s31, s31, s63
  s_add_u32 s35, s31, 0x800000
  s_mov_b32 s38, 0
  s_waitcnt vmcnt(0)
.g2_kernel_v_cmbw:
  ds_read_b32 v7, v6
  s_add_u32 s38, s38, 1
  s_waitcnt lgkmcnt(0)
  v_cmp_ge_u32 vcc, s33, v7
  s_and_b32 s30, vcc_lo, s34
  s_cbranch_scc0 .g2_kernel_v_cmbd
  s_orn2_b32 s30, vcc_lo, s32
  s_cmp_lg_u32 s30, -1
  s_cbranch_scc1 .g2_kernel_v_cmbq
  s_sleep 6
.g2_kernel_v_cmbq:
  s_sleep 1
  s_cmp_lt_u32 s38, 524288
  s_cbranch_scc1 .g2_kernel_v_cmbw
.g2_kernel_v_cmbd:
  s_setprio 3
  ds_read_b128 v[32:35], v0 offset:0
  ds_read_b128 v[36:39], v0 offset:1024
  ds_read_b128 v[40:43], v0 offset:2048
  ds_read_b128 v[44:47], v0 offset:3072
  ds_read_b128 v[48:51], v0 offset:4096
  ds_read_b128 v[52:55], v0 offset:5120
  ds_read_b128 v[56:59], v0 offset:6144
  ds_read_b128 v[60:63], v0 offset:7168
  ds_read2_b32 v[6:7], v4 offset0:64 offset1:96
  ds_read2_b32 v[4:5], v4 offset0:0 offset1:32
  s_lshl_b32 s30, s28, 2
  s_add_u32 s30, s30, s71
  s_waitcnt lgkmcnt(9)
  v_mfma_f32_32x32x16_bf16 v[16:31], v[8:11], v[32:35], 0
  s_waitcnt lgkmcnt(8)
  v_mfma_f32_32x32x16_bf16 v[16:31], v[12:15], v[36:39], v[16:31]
  s_waitcnt lgkmcnt(7)
  v_mfma_f32_32x32x16_bf16 v[16:31], v[8:11], v[40:43], v[16:31]
  s_waitcnt lgkmcnt(6)
  v_mfma_f32_32x32x16_bf16 v[16:31], v[12:15], v[44:47], v[16:31]
  s_waitcnt lgkmcnt(5)
  v_mfma_f32_32x32x16_bf16 v[16:31], v[8:11], v[48:51], v[16:31]
  s_waitcnt lgkmcnt(4)
  v_mfma_f32_32x32x16_bf16 v[16:31], v[12:15], v[52:55], v[16:31]
  s_waitcnt lgkmcnt(3)
  v_mfma_f32_32x32x16_bf16 v[16:31], v[8:11], v[56:59], v[16:31]
  s_waitcnt lgkmcnt(2)
  v_mfma_f32_32x32x16_bf16 v[16:31], v[12:15], v[60:63], v[16:31]
  v_mov_b32 v0, s30
  s_waitcnt lgkmcnt(0)
  v_add_f32 v6, v6, v4
  v_add_f32 v7, v7, v5
  v_mov_b32 v4, 0
  v_mov_b32 v5, s29
  ds_write_b32 v0, v5 offset:64
  v_add_f32 v9, v6, v7
  s_mov_b32 s30, 8.673617379884035e-19
  s_mov_b32 s31, 1.152921504606847e+18
  v_rcp_f32 v10, v9
  v_cmp_le_f32 vcc, s30, v9
  v_cmp_ge_f32 s[36:37], s31, v9
  v_mov_b32 v5, 1
  v_mul_f32 v10, 4.0, v10
  s_and_b64 s[36:37], s[36:37], vcc
  v_cmp_o_f32 vcc, v16, v16
  s_and_b64 vcc, vcc, s[36:37]
  s_cmp_eq_u64 vcc, -1
  s_cbranch_scc0 .g2_kernel_v_cmbslow
.g2_kernel_v_cmbfin:
  v_mul_f32 v16, v16, v10
  v_mul_f32 v17, v17, v10
  v_mul_f32 v18, v18, v10
  v_mul_f32 v19, v19, v10
  v_mul_f32 v20, v20, v10
  v_mul_f32 v21, v21, v10
  v_mul_f32 v22, v22, v10
  v_mul_f32 v23, v23, v10
  v_cvt_pk_bf16_f32 v32, v16, v17
  v_cvt_pk_bf16_f32 v33, v18, v19
  v_cvt_pk_bf16_f32 v34, v20, v21
  v_cvt_pk_bf16_f32 v35, v22, v23
  v_max_u32 v32, 1, v32
  v_max_u32 v34, 1, v34
  buffer_store_dwordx4 v[32:35], v3, s[4:7], s35 offen offset:0 sc1
  v_mul_f32 v24, v24, v10
  v_mul_f32 v25, v25, v10
  v_mul_f32 v26, v26, v10
  v_mul_f32 v27, v27, v10
  v_mul_f32 v28, v28, v10
  v_mul_f32 v29, v29, v10
  v_mul_f32 v30, v30, v10
  v_mul_f32 v31, v31, v10
  v_cvt_pk_bf16_f32 v36, v24, v25
  v_cvt_pk_bf16_f32 v37, v26, v27
  v_cvt_pk_bf16_f32 v38, v28, v29
  v_cvt_pk_bf16_f32 v39, v30, v31
  v_max_u32 v36, 1, v36
  v_max_u32 v38, 1, v38
  buffer_store_dwordx4 v[36:39], v3, s[4:7], s35 offen offset:1024 sc1
  s_setprio 3
  s_setpc_b64 s[68:69]
.g2_kernel_v_cmbslow:
  s_setprio 0
  s_lshl_b32 s30, s28, 11
  s_mul_i32 s31, s29, -8192
  s_add_u32 s30, s30, s31
  s_add_u32 s30, s30, 139264
  v_add_u32 v6, s30, v3
  ds_read_b128 v[48:51], v6
  ds_read_b128 v[52:55], v6 offset:1024
  s_lshl_b32 s36, s18, 1
  s_add_u32 s36, s36, s29
  s_lshl_b32 s36, s36, 18
  s_add_u32 s36, s36, s63
  s_mov_b32 s30, s36
  s_mov_b32 s33, 64
  v_mov_b32 v10, 0xff800000
  s_waitcnt lgkmcnt(0)
.g2_kernel_v_cmbs1:
  buffer_load_dwordx4 v[56:59], v3, s[4:7], s30 offen offset:0
  buffer_load_dwordx4 v[60:63], v3, s[4:7], s30 offen offset:1024
  s_waitcnt vmcnt(0)
  v_mfma_f32_32x32x16_bf16 v[32:47], v[56:59], v[48:51], 0
  v_mfma_f32_32x32x16_bf16 v[32:47], v[60:63], v[52:55], v[32:47]
  s_nop 11
  v_max3_f32 v10, v10, v32, v33
  v_max3_f32 v10, v10, v34, v35
  v_max3_f32 v10, v10, v36, v37
  v_max3_f32 v10, v10, v38, v39
  v_max3_f32 v10, v10, v40, v41
  v_max3_f32 v10, v10, v42, v43
  v_max3_f32 v10, v10, v44, v45
  v_max3_f32 v10, v10, v46, v47
  s_add_u32 s30, s30, 4096
  s_sub_u32 s33, s33, 1
  s_cmp_lg_u32 s33, 0
  s_cbranch_scc1 .g2_kernel_v_cmbs1
  v_mov_b32 v11, v10
  s_nop 1
  v_permlane32_swap_b32 v11, v10
  v_max_f32 v10, v10, v11
  v_mov_b32 v9, 0
  v_mov_b32 v16, 0
  v_mov_b32 v17, 0
  v_mov_b32 v18, 0
  v_mov_b32 v19, 0
  v_mov_b32 v20, 0
  v_mov_b32 v21, 0
  v_mov_b32 v22, 0
  v_mov_b32 v23, 0
  v_mov_b32 v24, 0
  v_mov_b32 v25, 0
  v_mov_b32 v26, 0
  v_mov_b32 v27, 0
  v_mov_b32 v28, 0
  v_mov_b32 v29, 0
  v_mov_b32 v30, 0
  v_mov_b32 v31, 0
  s_mov_b32 s30, s36
  s_mov_b32 s33, 64
.g2_kernel_v_cmbs2:
  buffer_load_dwordx4 v[56:59], v3, s[4:7], s30 offen offset:0
  buffer_load_dwordx4 v[60:63], v3, s[4:7], s30 offen offset:1024
  s_waitcnt vmcnt(0)
  v_mfma_f32_32x32x16_bf16 v[32:47], v[56:59], v[48:51], 0
  v_mfma_f32_32x32x16_bf16 v[32:47], v[60:63], v[52:55], v[32:47]
  s_nop 11
  v_sub_f32 v32, v32, v10
  v_sub_f32 v33, v33, v10
  v_sub_f32 v34, v34, v10
  v_sub_f32 v35, v35, v10
  v_sub_f32 v36, v36, v10
  v_sub_f32 v37, v37, v10
  v_sub_f32 v38, v38, v10
  v_sub_f32 v39, v39, v10
  v_sub_f32 v40, v40, v10
  v_sub_f32 v41, v41, v10
  v_sub_f32 v42, v42, v10
  v_sub_f32 v43, v43, v10
  v_sub_f32 v44, v44, v10
  v_sub_f32 v45, v45, v10
  v_sub_f32 v46, v46, v10
  v_sub_f32 v47, v47, v10
  buffer_load_dwordx4 v[56:59], v3, s[4:7], s30 offen offset:2048
  buffer_load_dwordx4 v[60:63], v3, s[4:7], s30 offen offset:3072
  v_exp_f32 v32, v32
  v_exp_f32 v33, v33
  v_exp_f32 v34, v34
  v_exp_f32 v35, v35
  v_exp_f32 v36, v36
  v_exp_f32 v37, v37
  v_exp_f32 v38, v38
  v_exp_f32 v39, v39
  v_exp_f32 v40, v40
  v_exp_f32 v41, v41
  v_exp_f32 v42, v42
  v_exp_f32 v43, v43
  v_exp_f32 v44, v44
  v_exp_f32 v45, v45
  v_exp_f32 v46, v46
  v_exp_f32 v47, v47
  v_add_f32 v9, v9, v32
  v_add_f32 v9, v9, v33
  v_add_f32 v9, v9, v34
  v_add_f32 v9, v9, v35
  v_add_f32 v9, v9, v36
  v_add_f32 v9, v9, v37
  v_add_f32 v9, v9, v38
  v_add_f32 v9, v9, v39
  v_add_f32 v9, v9, v40
  v_add_f32 v9, v9, v41
  v_add_f32 v9, v9, v42
  v_add_f32 v9, v9, v43
  v_add_f32 v9, v9, v44
  v_add_f32 v9, v9, v45
  v_add_f32 v9, v9, v46
  v_add_f32 v9, v9, v47
  v_cvt_pk_bf16_f32 v32, v32, v33
  v_cvt_pk_bf16_f32 v33, v34, v35
  v_cvt_pk_bf16_f32 v34, v36, v37
  v_cvt_pk_bf16_f32 v35, v38, v39
  v_cvt_pk_bf16_f32 v36, v40, v41
  v_cvt_pk_bf16_f32 v37, v42, v43
  v_cvt_pk_bf16_f32 v38, v44, v45
  v_cvt_pk_bf16_f32 v39, v46, v47
  s_waitcnt vmcnt(0)
  v_mfma_f32_32x32x16_bf16 v[16:31], v[56:59], v[32:35], v[16:31]
  v_mfma_f32_32x32x16_bf16 v[16:31], v[60:63], v[36:39], v[16:31]
  s_nop 15
  s_add_u32 s30, s30, 4096
  s_sub_u32 s33, s33, 1
  s_cmp_lg_u32 s33, 0
  s_cbranch_scc1 .g2_kernel_v_cmbs2
  v_mov_b32 v11, v9
  s_nop 1
  v_permlane32_swap_b32 v11, v9
  v_add_f32 v9, v9, v11
  v_rcp_f32 v10, v9
  s_branch .g2_kernel_v_cmbfin
.g2_kernel_p2_xw:
  s_mov_b32 s38, 0
.g2_kernel_p2_xwl:
  ds_read_b32 v12, v11
  s_add_u32 s38, s38, 1
  s_waitcnt lgkmcnt(0)
  v_cmp_ne_u32 vcc, 0, v12
  s_and_b32 s37, vcc_lo, vcc_hi
  s_lshr_b32 s33, s37, 16
  s_and_b32 s37, s37, s33
  s_bitcmp1_b32 s37, s28
  s_cbranch_scc1 .g2_kernel_p2_xwr
  s_sleep 1
  s_cmp_lt_u32 s38, 524288
  s_cbranch_scc1 .g2_kernel_p2_xwl
.g2_kernel_p2_xwr:
  s_setpc_b64 s[68:69]
.g2_kernel_p2_x0w:
  s_call_b64 s[68:69], .g2_kernel_p2_xw
  s_branch .g2_kernel_p2_x0b
.g2_kernel_p2_x1w:
  s_call_b64 s[68:69], .g2_kernel_p2_xw
  s_branch .g2_kernel_p2_x1b
.g2_kernel_p2_x2w:
  s_call_b64 s[68:69], .g2_kernel_p2_xw
  s_branch .g2_kernel_p2_x2b
.g2_kernel_p2_aw:
  s_call_b64 s[68:69], .g2_kernel_p_spin
  s_branch .g2_kernel_p2_ai
.g2_kernel_p2_x3w:
  s_call_b64 s[68:69], .g2_kernel_p2_xw
  s_branch .g2_kernel_p2_x3b
.g2_kernel_p2_bw:
  s_call_b64 s[68:69], .g2_kernel_p_spin
  s_branch .g2_kernel_p2_bi
.g2_kernel_amax:
  v_mov_b32 v16, 0xff7fffff
  v_mov_b32 v17, 1
  v_mov_b32 v18, 0xff7fffff
  v_mov_b32 v19, 1
  v_mov_b32 v20, 0xff7fffff
  v_mov_b32 v21, 1
  v_mov_b32 v22, 0xff7fffff
  v_mov_b32 v23, 1
  s_mov_b32 s38, 0
  s_mov_b64 vcc, -1
  v_lshlrev_b32 v7, 5, v2
  s_add_u32 s28, s23, 4096
.g2_kernel_amaxl:
  s_and_b64 exec, vcc, s[8:9]
  s_cbranch_scc0 .g2_kernel_amaxn0
  buffer_load_dwordx2 v[16:17], v7, s[4:7], s23 offen offset:0 sc1
.g2_kernel_amaxn0:
  s_and_b64 exec, vcc, s[10:11]
  s_cbranch_scc0 .g2_kernel_amaxn1
  buffer_load_dwordx2 v[18:19], v7, s[4:7], s23 offen offset:2048 sc1
.g2_kernel_amaxn1:
  s_and_b64 exec, vcc, s[12:13]
  s_cbranch_scc0 .g2_kernel_amaxn2
  buffer_load_dwordx2 v[20:21], v7, s[4:7], s28 offen offset:0 sc1
.g2_kernel_amaxn2:
  s_and_b64 exec, vcc, s[14:15]
  s_cbranch_scc0 .g2_kernel_amaxn3
  buffer_load_dwordx2 v[22:23], v7, s[4:7], s28 offen offset:2048 sc1
.g2_kernel_amaxn3:
  s_mov_b64 exec, -1
  s_add_u32 s38, s38, 1
  s_waitcnt vmcnt(0)
  v_min3_u32 v6, v17, v19, v21
  v_min_u32 v6, v6, v23
  v_cmp_eq_u32 vcc, 0, v6
  s_cbranch_vccz .g2_kernel_amaxd
  s_sleep 4
  s_cmp_lg_u32 s62, 0
  s_cbranch_scc1 .g2_kernel_nap55
  s_sleep 20
.g2_kernel_nap55:
  s_cmp_eq_u32 s39, 1
  s_cbranch_scc0 .g2_kernel_amaxz
  s_sleep 8
.g2_kernel_amaxz:
  s_cmp_lt_u32 s38, 131072
  s_cbranch_scc1 .g2_kernel_amaxl
.g2_kernel_amaxd:
  s_mov_b32 s28, 0xffffffe7
  v_and_or_b32 v16, v16, s28, 0
  v_and_or_b32 v18, v18, s28, 8
  v_and_or_b32 v20, v20, s28, 16
  v_and_or_b32 v22, v22, s28, 24
  v_max3_f32 v6, v16, v18, v20
  v_max_f32 v6, v6, v22
  s_nop 1
  v_max_f32 v7, v6, v6 row_ror:8 row_mask:0xf bank_mask:0xf
  s_nop 1
  v_max_f32 v7, v7, v7 row_ror:4 row_mask:0xf bank_mask:0xf
  s_nop 1
  v_max_f32 v7, v7, v7 row_ror:2 row_mask:0xf bank_mask:0xf
  s_nop 1
  v_max_f32 v7, v7, v7 row_ror:1 row_mask:0xf bank_mask:0xf
  s_nop 1
  v_max_f32 v7, v7, v7 row_bcast:15 row_mask:0xa bank_mask:0xf
  s_nop 1
  v_max_f32 v7, v7, v7 row_bcast:31 row_mask:0xc bank_mask:0xf
  s_nop 0
  v_readlane_b32 s27, v7, 63
  s_nop 1
  v_cmp_eq_u32 vcc, s27, v6
  s_ff1_i32_b64 s77, vcc
  s_lshl_b32 s77, s77, 3
  s_and_b32 s28, s27, 7
  s_add_u32 s77, s77, s28
  s_and_b32 s28, s27, 24
  s_lshl_b32 s28, s28, 6
  s_add_u32 s77, s77, s28
  s_and_b32 s77, s77, 2047
  s_setpc_b64 s[68:69]
  .p2align 8
.g2_kernel_tab:
  .long 0, 1, 2, 3, 4, 5, 6, 7
  .long 8, 9, 10, 11, 12, 13, 14, 15
  .long 16, 17, 18, 19, 20, 21, 22, 23
  .long 24, 25, 26, 27, 28, 29, 30, 31
  .long 32, 33, 34, 35, 36, 37, 38, 39
  .long 40, 41, 42, 43, 44, 45, 46, 47
  .long 48, 49, 50, 51, 52, 53, 54, 55
  .long 56, 57, 58, 59, 60, 61, 62, 63
  .long 64, 65, 66, 67, 68, 69, 70, 71
  .p2align 4
.g2_kernel_sel:
  .long 0x3e80, 0x0, 0x0, 0x0
  .long 0x3e800000, 0x0, 0x0, 0x0
  .long 0x0, 0x3e80, 0x0, 0x0
  .long 0x0, 0x3e800000, 0x0, 0x0
  .long 0x0, 0x0, 0x0, 0x0
  .long 0x0, 0x0, 0x0, 0x0
  .long 0x0, 0x0, 0x0, 0x0
  .long 0x0, 0x0, 0x0, 0x0
  .long 0x0, 0x0, 0x3e80, 0x0
  .long 0x0, 0x0, 0x3e800000, 0x0
  .long 0x0, 0x0, 0x0, 0x3e80
  .long 0x0, 0x0, 0x0, 0x3e800000
  .long 0x0, 0x0, 0x0, 0x0
  .long 0x0, 0x0, 0x0, 0x0
  .long 0x0, 0x0, 0x0, 0x0
  .long 0x0, 0x0, 0x0, 0x0
  .long 0x0, 0x0, 0x0, 0x0
  .long 0x0, 0x0, 0x0, 0x0
  .long 0x0, 0x0, 0x0, 0x0
  .long 0x0, 0x0, 0x0, 0x0
  .long 0x0, 0x0, 0x0, 0x0
  .long 0x0, 0x0, 0x0, 0x0
  .long 0x0, 0x0, 0x0, 0x0
  .long 0x0, 0x0, 0x0, 0x0
  .long 0x0, 0x0, 0x0, 0x0
  .long 0x0, 0x0, 0x0, 0x0
  .long 0x0, 0x0, 0x0, 0x0
  .long 0x0, 0x0, 0x0, 0x0
  .long 0x0, 0x0, 0x0, 0x0
  .long 0x0, 0x0, 0x0, 0x0
  .long 0x0, 0x0, 0x0, 0x0
  .long 0x0, 0x0, 0x0, 0x0
  .long 0x0, 0x0, 0x0, 0x0
  .long 0x0, 0x0, 0x0, 0x0
  .long 0x0, 0x0, 0x0, 0x0
  .long 0x0, 0x0, 0x0, 0x0
  .long 0x3e80, 0x0, 0x0, 0x0
  .long 0x3e800000, 0x0, 0x0, 0x0
  .long 0x0, 0x3e80, 0x0, 0x0
  .long 0x0, 0x3e800000, 0x0, 0x0
  .long 0x0, 0x0, 0x0, 0x0
  .long 0x0, 0x0, 0x0, 0x0
  .long 0x0, 0x0, 0x0, 0x0
  .long 0x0, 0x0, 0x0, 0x0
  .long 0x0, 0x0, 0x3e80, 0x0
  .long 0x0, 0x0, 0x3e800000, 0x0
  .long 0x0, 0x0, 0x0, 0x3e80
  .long 0x0, 0x0, 0x0, 0x3e800000
  .long 0x0, 0x0, 0x0, 0x0
  .long 0x0, 0x0, 0x0, 0x0
  .long 0x0, 0x0, 0x0, 0x0
  .long 0x0, 0x0, 0x0, 0x0
  .long 0x0, 0x0, 0x0, 0x0
  .long 0x0, 0x0, 0x0, 0x0
  .long 0x0, 0x0, 0x0, 0x0
  .long 0x0, 0x0, 0x0, 0x0
  .long 0x0, 0x0, 0x0, 0x0
  .long 0x0, 0x0, 0x0, 0x0
  .long 0x0, 0x0, 0x0, 0x0
  .long 0x0, 0x0, 0x0, 0x0
  .long 0x0, 0x0, 0x0, 0x0
  .long 0x0, 0x0, 0x0, 0x0
  .long 0x0, 0x0, 0x0, 0x0
  .long 0x0, 0x0, 0x0, 0x0
  .long 0x0, 0x0, 0x0, 0x0
  .long 0x0, 0x0, 0x0, 0x0
  .long 0x0, 0x0, 0x0, 0x0
  .long 0x0, 0x0, 0x0, 0x0
  .long 0x0, 0x0, 0x0, 0x0
  .long 0x0, 0x0, 0x0, 0x0
  .long 0x0, 0x0, 0x0, 0x0
  .long 0x0, 0x0, 0x0, 0x0
  .long 0x0, 0x0, 0x0, 0x0
  .long 0x0, 0x0, 0x0, 0x0
  .long 0x0, 0x0, 0x0, 0x0
  .long 0x0, 0x0, 0x0, 0x0
  .long 0x0, 0x0, 0x0, 0x0
  .long 0x0, 0x0, 0x0, 0x0
  .long 0x0, 0x0, 0x0, 0x0
  .long 0x0, 0x0, 0x0, 0x0
  .long 0x3e80, 0x0, 0x0, 0x0
  .long 0x3e800000, 0x0, 0x0, 0x0
  .long 0x0, 0x3e80, 0x0, 0x0
  .long 0x0, 0x3e800000, 0x0, 0x0
  .long 0x0, 0x0, 0x0, 0x0
  .long 0x0, 0x0, 0x0, 0x0
  .long 0x0, 0x0, 0x0, 0x0
  .long 0x0, 0x0, 0x0, 0x0
  .long 0x0, 0x0, 0x3e80, 0x0
  .long 0x0, 0x0, 0x3e800000, 0x0
  .long 0x0, 0x0, 0x0, 0x3e80
  .long 0x0, 0x0, 0x0, 0x3e800000
  .long 0x0, 0x0, 0x0, 0x0
  .long 0x0, 0x0, 0x0, 0x0
  .long 0x0, 0x0, 0x0, 0x0
  .long 0x0, 0x0, 0x0, 0x0
  .long 0x0, 0x0, 0x0, 0x0
  .long 0x0, 0x0, 0x0, 0x0
  .long 0x0, 0x0, 0x0, 0x0
  .long 0x0, 0x0, 0x0, 0x0
  .long 0x0, 0x0, 0x0, 0x0
  .long 0x0, 0x0, 0x0, 0x0
  .long 0x0, 0x0, 0x0, 0x0
  .long 0x0, 0x0, 0x0, 0x0
  .long 0x0, 0x0, 0x0, 0x0
  .long 0x0, 0x0, 0x0, 0x0
  .long 0x0, 0x0, 0x0, 0x0
  .long 0x0, 0x0, 0x0, 0x0
  .long 0x0, 0x0, 0x0, 0x0
  .long 0x0, 0x0, 0x0, 0x0
  .long 0x0, 0x0, 0x0, 0x0
  .long 0x0, 0x0, 0x0, 0x0
  .long 0x0, 0x0, 0x0, 0x0
  .long 0x0, 0x0, 0x0, 0x0
  .long 0x0, 0x0, 0x0, 0x0
  .long 0x0, 0x0, 0x0, 0x0
  .long 0x3e80, 0x0, 0x0, 0x0
  .long 0x3e800000, 0x0, 0x0, 0x0
  .long 0x0, 0x3e80, 0x0, 0x0
  .long 0x0, 0x3e800000, 0x0, 0x0
  .long 0x0, 0x0, 0x0, 0x0
  .long 0x0, 0x0, 0x0, 0x0
  .long 0x0, 0x0, 0x0, 0x0
  .long 0x0, 0x0, 0x0, 0x0
  .long 0x0, 0x0, 0x3e80, 0x0
  .long 0x0, 0x0, 0x3e800000, 0x0
  .long 0x0, 0x0, 0x0, 0x3e80
  .long 0x0, 0x0, 0x0, 0x3e800000
.g2_kernel_cend:

.section .rodata,"a"
.p2align 6
.amdhsa_kernel g2_kernel
  .amdhsa_next_free_vgpr 256
  .amdhsa_next_free_sgpr 102
  .amdhsa_accum_offset 256
  .amdhsa_group_segment_fixed_size 0
  .amdhsa_kernarg_size 88
  .amdhsa_user_sgpr_count 2
  .amdhsa_user_sgpr_kernarg_segment_ptr 1
  .amdhsa_system_sgpr_workgroup_id_x 1
.end_amdhsa_kernel
```

```asm
; @launch kernel=g2_kernel grid=(256,1,1) block=(512,1,1) lds=163840
.amdgcn_target "amdgcn-amd-amdhsa--gfx950"
.text
.globl g2_kernel
.p2align 8
.type g2_kernel,@function
g2_kernel:
  s_cmp_ge_u32 s2, 256
  s_cbranch_scc1 .g2_kernel_end
  s_load_dwordx16 s[40:55], s[0:1], 0
  s_load_dwordx4 s[56:59], s[0:1], 64
  s_load_dwordx2 s[60:61], s[0:1], 80
  s_getpc_b64 s[64:65]
.g2_kernel_pc:
  s_mov_b32 s66, .g2_kernel_cend-.g2_kernel_pc
  s_mov_b32 s67, 0x00020000
  s_lshl_b32 s12, s2, 10
  s_and_b32 s12, s12, 0xe000
  v_lshrrev_b32 v3, 3, v0
  v_and_b32 v2, 7, v0
  v_and_b32 v3, 0x38, v3
  v_add_lshl_u32 v3, v3, v2, 7
  s_mov_b64 exec, 0xff
  buffer_load_dword v1, v3, s[64:67], s12 offen
  s_mov_b64 exec, -1
  v_lshrrev_b32 v3, 6, v0
  v_and_b32 v2, 63, v0
  v_readfirstlane_b32 s16, v3
  s_and_b32 s21, s2, 7
  s_lshr_b32 s22, s2, 3
  s_and_b32 s23, s21, 3
  s_lshl_b32 s23, s23, 2
  s_and_b32 s24, s22, 3
  s_add_u32 s18, s23, s24
  s_lshr_b32 s24, s21, 2
  s_lshl_b32 s24, s24, 3
  s_lshr_b32 s25, s22, 2
  s_add_u32 s17, s24, s25
  s_lshl_b32 s19, s17, 4
  s_add_u32 s19, s19, s18
  s_lshl_b32 s19, s19, 9
  s_add_u32 s19, s19, 0x3000000
  s_lshl_b32 s76, s18, 4
  s_add_u32 s76, s76, s17
  s_lshl_b32 s76, s76, 9
  s_add_u32 s76, s76, 0x3020000
  v_lshlrev_b32 v3, 4, v2
  v_mov_b32 v4, 0
  v_mov_b32 v5, 1
  s_mov_b32 s62, 0
  s_mov_b32 s63, 0
  s_mov_b32 s70, 1
  s_mov_b32 s71, 155648
  s_waitcnt lgkmcnt(0)
  s_mov_b32 s4, s60
  s_mov_b32 s5, s61
  s_mov_b32 s6, 0x3200000
  s_mov_b32 s7, 0x00020000
  s_cmp_ge_u32 s16, 4
  s_cbranch_scc1 .g2_kernel_svc
  v_mov_b32 v20, 0
  v_mov_b32 v21, 0
  v_mov_b32 v22, 0
  v_mov_b32 v23, 0
  v_lshlrev_b32 v24, 4, v0
  v_cmp_gt_u32 vcc, 2816, v24
  v_add_u32 v24, 155648, v24
  s_and_saveexec_b64 s[20:21], vcc
  s_cbranch_execz .g2_kernel_q_nz
  ds_write_b128 v24, v[20:23]
.g2_kernel_q_nz:
  s_mov_b64 exec, -1
  v_and_b32 v20, 15, v2
  v_lshrrev_b32 v21, 4, v2
  v_lshrrev_b32 v22, 1, v20
  v_xor_b32 v22, v22, v21
  v_lshlrev_b32 v22, 4, v22
  v_lshl_add_u32 v22, v20, 7, v22
  s_lshr_b32 s26, s16, 1
  s_lshl_b32 s26, s26, 13
  v_add_u32 v144, s26, v22
  v_xor_b32 v145, 64, v144
.g2_kernel_q_cs:
  s_and_b32 s27, s16, 1
  s_lshr_b32 s26, s16, 1
  v_bfe_u32 v20, v2, 2, 2
  v_lshrrev_b32 v49, 4, v2
  v_lshl_add_u32 v22, v49, 3, v20
  v_lshlrev_b32 v22, 7, v22
  v_lshrrev_b32 v23, 1, v20
  v_and_b32 v21, 1, v49
  v_xor_b32 v21, s27, v21
  v_lshl_add_u32 v23, v21, 1, v23
  v_lshl_add_u32 v22, v23, 5, v22
  v_and_b32 v23, 3, v2
  v_lshl_add_u32 v22, v23, 3, v22
  v_add_u32 v148, 65536, v22
  v_xor_b32 v149, 32, v148
  v_mov_b32 v146, v148
  v_mov_b32 v147, v149
  v_mov_b32 v150, 156160
  v_and_b32 v48, 15, v2
  s_lshl_b32 s28, s26, 8
  s_add_u32 s28, s28, 155648
  v_lshl_add_u32 v50, v48, 2, s28
  v_lshl_add_u32 v51, v49, 4, s28
  s_lshl_b32 s28, s27, 7
  s_add_u32 s28, s28, 155648
  v_lshl_add_u32 v52, v49, 4, s28
  v_lshl_add_u32 v53, v48, 2, s28
  v_lshlrev_b32 v54, 9, v49
  v_lshl_add_u32 v55, v48, 4, v54
  v_and_b32 v56, 8, v48
  v_lshl_add_u32 v54, v56, 4, v55
  v_mov_b32 v56, 0.25503486164919736
  v_lshlrev_b32 v58, 8, v2
  v_and_b32 v58, 0x300, v58
  v_add_u32 v58, 156416, v58
  s_lshl_b32 s8, s18, 1
  s_add_u32 s8, s8, s27
  s_lshl_b32 s8, s8, 6
  s_lshl_b32 s9, s17, 2
  s_add_u32 s8, s8, s9
  s_lshl_b32 s9, s26, 1
  s_add_u32 s8, s8, s9
  s_lshl_b32 s8, s8, 12
  s_add_u32 s8, s8, s63
  s_add_u32 s9, s8, 4096
  s_lshl_b32 s28, s26, 13
  s_lshl_b32 s10, s27, 14
  s_add_u32 s28, s28, s10
  v_add_u32 v59, s28, v54
  v_add_u32 v60, s28, v55
  s_lshl_b32 s28, s26, 12
  s_mul_i32 s10, s27, -8192
  s_add_u32 s28, s28, s10
  s_add_u32 s28, s28, 139264
  v_add_u32 v61, s28, v55
  s_mov_b32 s10, s27
  s_lshl_b32 s77, s18, 4
  s_add_u32 s77, s77, s17
  s_lshl_b32 s77, s77, 1
  s_add_u32 s77, s77, s26
  s_lshl_b32 s77, s77, 13
  s_add_u32 s77, s77, s63
  s_add_u32 s77, s77, 0x1400000
  s_lshl_b32 s28, s27, 30
  s_add_u32 s77, s77, s28
  s_lshl_b32 s12, s62, 5
  s_add_u32 s12, s12, 28
  v_and_b32 v6, 15, v2
  v_xor_b32 v6, s17, v6
  v_and_b32 v7, 16, v2
  v_add_u32 v6, v6, v7
  s_lshr_b32 s28, s16, 1
  s_lshl_b32 s28, s28, 7
  s_add_u32 s28, s28, 157440
  v_lshl_add_u32 v8, v6, 2, s28
  s_lshl_b32 s28, s16, 12
  v_add_u32 v9, s28, v3
  v_and_b32 v6, 31, v2
  s_lshl_b32 s28, s16, 7
  s_add_u32 s28, s28, 161280
  v_lshl_add_u32 v10, v6, 2, s28
  s_lshl_b32 s28, s16, 2
  s_add_u32 s28, s28, 155968
  v_mov_b32 v11, s28
  s_lshl_b32 s28, s62, 1
  s_add_u32 s28, s28, 1
  v_mov_b32 v12, s28
  v_mov_b32 v13, s71
  v_add_u32 v14, 131072, v3
  v_and_b32 v6, 4, v2
  v_cmp_eq_u32 vcc, 0, v6
  v_mov_b32 v7, 0x3f803f80
  v_and_b32 v6, 1, v2
  v_cndmask_b32 v16, 0, v7, vcc
  v_cndmask_b32 v17, 0, v7, vcc
  v_cndmask_b32 v18, v7, 0, vcc
  v_cndmask_b32 v19, v7, 0, vcc
  v_mul_u32_u24 v20, 0xaaaa, v6
  v_add_u32 v20, 0x4444, v20
  s_lshl_b32 s28, s18, 7
  s_add_u32 s28, s28, s16
  s_lshl_b32 s28, s28, 12
  s_add_u32 s28, s28, s63
  s_add_u32 s20, s60, s28
  s_addc_u32 s21, s61, 0
  s_mov_b32 s24, s17
  s_mov_b32 s25, 14
  s_mov_b32 s26, 0
  s_mov_b32 s27, 6
  s_mov_b32 s34, 0xffff0001
  s_mov_b32 s35, 0
  s_mov_b32 s36, 0
  s_mov_b32 s39, 0
  s_lshl_b32 s28, s16, 7
  s_add_u32 s37, s76, s28
  v_mov_b32 v15, s70
  v_lshrrev_b32 v6, 5, v2
  v_and_b32 v7, 15, v2
  v_lshlrev_b32 v22, 4, v7
  v_lshl_add_u32 v22, v6, 8, v22
  v_and_b32 v7, 16, v2
  v_lshl_add_u32 v22, v7, 7, v22
  v_and_b32 v7, 31, v2
  v_lshlrev_b32 v23, 4, v6
  v_lshl_add_u32 v23, v7, 11, v23
  s_lshl_b32 s28, s17, 2
  s_add_u32 s28, s28, s16
  s_lshl_b32 s28, s28, 16
  s_lshl_b32 s29, s18, 7
  s_add_u32 s28, s28, s29
  s_add_u32 s74, s40, s28
  s_addc_u32 s75, s41, 0
  s_lshl_b32 s13, s17, 4
  s_add_u32 s13, s13, s18
  s_lshl_b32 s13, s13, 2
  s_add_u32 s13, s13, s16
  s_lshl_b32 s13, s13, 12
  s_add_u32 s13, s13, 0xc00000
  s_lshl_b32 s28, s16, 8
  s_add_u32 m0, s28, 156416
  s_lshl_b32 s33, s62, 5
  s_lshl_b32 s31, s33, 2
  s_add_u32 s31, s31, .g2_kernel_tab-.g2_kernel_pc+4
  s_mov_b32 s29, 0
  s_cmp_lg_u32 s62, 0
  s_cbranch_scc1 .g2_kernel_q_i2
  s_waitcnt lgkmcnt(0)
  s_barrier
.g2_kernel_q_i3:
  s_call_b64 s[68:69], .g2_kernel_q_spin
  ds_read_b64_tr_b16 v[80:81], v146 offset:0
  ds_read_b64_tr_b16 v[82:83], v146 offset:512
  ds_read_b128 v[64:67], v144 offset:0
  ds_read_b128 v[68:71], v144 offset:2048
  ds_read_b128 v[72:75], v144 offset:4096
  ds_read_b128 v[76:79], v144 offset:6144
  ds_read_b64_tr_b16 v[84:85], v147 offset:0
  ds_read_b64_tr_b16 v[86:87], v147 offset:512
  ds_read_b64_tr_b16 v[88:89], v146 offset:4096
  ds_read_b64_tr_b16 v[90:91], v146 offset:4608
  ds_read_b64_tr_b16 v[92:93], v147 offset:4096
  ds_read_b64_tr_b16 v[94:95], v147 offset:4608
  ds_read_b64_tr_b16 v[96:97], v146 offset:8192
  ds_read_b64_tr_b16 v[98:99], v146 offset:8704
  ds_read_b64_tr_b16 v[100:101], v147 offset:8192
  ds_read_b64_tr_b16 v[102:103], v147 offset:8704
  s_mov_b32 s30, 12288
  s_add_u32 s33, s33, 1
  v_add_u32 v146, s30, v148
  v_add_u32 v147, s30, v149
  s_waitcnt lgkmcnt(0)
  v_mfma_f32_16x16x32_bf16 v[160:163], v[80:83], v[64:67], 0
  v_cmp_lt_i32 vcc, s33, v151
  v_mfma_f32_16x16x32_bf16 v[164:167], v[80:83], v[68:71], 0
  s_cbranch_vccz .g2_kernel_q_wf
.g2_kernel_q_backf:
  v_mfma_f32_16x16x32_bf16 v[168:171], v[80:83], v[72:75], 0
  ds_read_b64_tr_b16 v[120:121], v146 offset:0
  v_mfma_f32_16x16x32_bf16 v[172:175], v[80:83], v[76:79], 0
  ds_read_b64_tr_b16 v[122:123], v146 offset:512
  v_mfma_f32_16x16x32_bf16 v[188:191], v[84:87], v[76:79], 0
  ds_read_b128 v[104:107], v145 offset:0
  v_mfma_f32_16x16x32_bf16 v[184:187], v[84:87], v[72:75], 0
  ds_read_b128 v[108:111], v145 offset:2048
  v_mfma_f32_16x16x32_bf16 v[180:183], v[84:87], v[68:71], 0
  ds_read_b128 v[112:115], v145 offset:4096
  v_mfma_f32_16x16x32_bf16 v[176:179], v[84:87], v[64:67], 0
  ds_read_b128 v[116:119], v145 offset:6144
  v_mfma_f32_16x16x32_bf16 v[192:195], v[88:91], v[64:67], 0
  ds_read_b64_tr_b16 v[124:125], v147 offset:0
  v_mfma_f32_16x16x32_bf16 v[196:199], v[88:91], v[68:71], 0
  ds_read_b64_tr_b16 v[126:127], v147 offset:512
  v_mfma_f32_16x16x32_bf16 v[200:203], v[88:91], v[72:75], 0
  ds_read_b64_tr_b16 v[128:129], v146 offset:4096
  v_mfma_f32_16x16x32_bf16 v[204:207], v[88:91], v[76:79], 0
  ds_read_b64_tr_b16 v[130:131], v146 offset:4608
  v_mfma_f32_16x16x32_bf16 v[220:223], v[92:95], v[76:79], 0
  ds_read_b64_tr_b16 v[132:133], v147 offset:4096
  v_mfma_f32_16x16x32_bf16 v[216:219], v[92:95], v[72:75], 0
  ds_read_b64_tr_b16 v[134:135], v147 offset:4608
  v_mfma_f32_16x16x32_bf16 v[212:215], v[92:95], v[68:71], 0
  ds_read_b64_tr_b16 v[136:137], v146 offset:8192
  v_mfma_f32_16x16x32_bf16 v[208:211], v[92:95], v[64:67], 0
  ds_read_b64_tr_b16 v[138:139], v146 offset:8704
  v_mfma_f32_16x16x32_bf16 v[224:227], v[64:67], v[96:99], 0
  ds_read_b64_tr_b16 v[140:141], v147 offset:8192
  v_mfma_f32_16x16x32_bf16 v[228:231], v[68:71], v[96:99], 0
  ds_read_b64_tr_b16 v[142:143], v147 offset:8704
  v_mfma_f32_16x16x32_bf16 v[232:235], v[72:75], v[96:99], 0
  ds_read_b32 v151, v150
  s_add_u32 s30, s30, 12288
  v_mfma_f32_16x16x32_bf16 v[236:239], v[76:79], v[96:99], 0
  buffer_load_dword off, s[64:67], s31 lds
  s_cmp_eq_u32 s30, 86016
  v_mfma_f32_16x16x32_bf16 v[252:255], v[76:79], v[100:103], 0
  s_cselect_b32 s30, 0, s30
  s_add_u32 s31, s31, 4
  v_mfma_f32_16x16x32_bf16 v[248:251], v[72:75], v[100:103], 0
  v_add_u32 v146, s30, v148
  s_add_u32 s33, s33, 1
  v_mfma_f32_16x16x32_bf16 v[244:247], v[68:71], v[100:103], 0
  v_add_u32 v147, s30, v149
  v_mfma_f32_16x16x32_bf16 v[240:243], v[64:67], v[100:103], 0
  s_branch .g2_kernel_q_s1
  .p2align 6
.g2_kernel_q_loop:
  s_waitcnt lgkmcnt(0)
  v_mfma_f32_16x16x32_bf16 v[160:163], v[120:123], v[104:107], v[160:163]
  v_cmp_lt_i32 vcc, s33, v151
  v_mfma_f32_16x16x32_bf16 v[164:167], v[120:123], v[108:111], v[164:167]
  s_cbranch_vccz .g2_kernel_q_w7
.g2_kernel_q_back7:
  v_mfma_f32_16x16x32_bf16 v[168:171], v[120:123], v[112:115], v[168:171]
  ds_read_b64_tr_b16 v[80:81], v146 offset:0
  v_mfma_f32_16x16x32_bf16 v[172:175], v[120:123], v[116:119], v[172:175]
  ds_read_b64_tr_b16 v[82:83], v146 offset:512
  v_mfma_f32_16x16x32_bf16 v[188:191], v[124:127], v[116:119], v[188:191]
  ds_read_b128 v[64:67], v144 offset:0
  v_mfma_f32_16x16x32_bf16 v[184:187], v[124:127], v[112:115], v[184:187]
  ds_read_b128 v[68:71], v144 offset:2048
  v_mfma_f32_16x16x32_bf16 v[180:183], v[124:127], v[108:111], v[180:183]
  ds_read_b128 v[72:75], v144 offset:4096
  v_mfma_f32_16x16x32_bf16 v[176:179], v[124:127], v[104:107], v[176:179]
  ds_read_b128 v[76:79], v144 offset:6144
  v_mfma_f32_16x16x32_bf16 v[192:195], v[128:131], v[104:107], v[192:195]
  ds_read_b64_tr_b16 v[84:85], v147 offset:0
  v_mfma_f32_16x16x32_bf16 v[196:199], v[128:131], v[108:111], v[196:199]
  ds_read_b64_tr_b16 v[86:87], v147 offset:512
  v_mfma_f32_16x16x32_bf16 v[200:203], v[128:131], v[112:115], v[200:203]
  ds_read_b64_tr_b16 v[88:89], v146 offset:4096
  v_mfma_f32_16x16x32_bf16 v[204:207], v[128:131], v[116:119], v[204:207]
  ds_read_b64_tr_b16 v[90:91], v146 offset:4608
  v_mfma_f32_16x16x32_bf16 v[220:223], v[132:135], v[116:119], v[220:223]
  ds_read_b64_tr_b16 v[92:93], v147 offset:4096
  v_mfma_f32_16x16x32_bf16 v[216:219], v[132:135], v[112:115], v[216:219]
  ds_read_b64_tr_b16 v[94:95], v147 offset:4608
  v_mfma_f32_16x16x32_bf16 v[212:215], v[132:135], v[108:111], v[212:215]
  ds_read_b64_tr_b16 v[96:97], v146 offset:8192
  v_mfma_f32_16x16x32_bf16 v[208:211], v[132:135], v[104:107], v[208:211]
  ds_read_b64_tr_b16 v[98:99], v146 offset:8704
  v_mfma_f32_16x16x32_bf16 v[224:227], v[104:107], v[136:139], v[224:227]
  ds_read_b64_tr_b16 v[100:101], v147 offset:8192
  v_mfma_f32_16x16x32_bf16 v[228:231], v[108:111], v[136:139], v[228:231]
  ds_read_b64_tr_b16 v[102:103], v147 offset:8704
  v_mfma_f32_16x16x32_bf16 v[232:235], v[112:115], v[136:139], v[232:235]
  ds_read_b32 v151, v150
  s_add_u32 s30, s30, 12288
  v_mfma_f32_16x16x32_bf16 v[236:239], v[116:119], v[136:139], v[236:239]
  buffer_load_dword off, s[64:67], s31 lds
  s_cmp_eq_u32 s30, 86016
  v_mfma_f32_16x16x32_bf16 v[252:255], v[116:119], v[140:143], v[252:255]
  s_cselect_b32 s30, 0, s30
  s_add_u32 s31, s31, 4
  v_mfma_f32_16x16x32_bf16 v[248:251], v[112:115], v[140:143], v[248:251]
  v_add_u32 v146, s30, v148
  s_add_u32 s33, s33, 1
  v_mfma_f32_16x16x32_bf16 v[244:247], v[108:111], v[140:143], v[244:247]
  v_add_u32 v147, s30, v149
  v_mfma_f32_16x16x32_bf16 v[240:243], v[104:107], v[140:143], v[240:243]
  s_waitcnt lgkmcnt(0)
  v_mfma_f32_16x16x32_bf16 v[160:163], v[80:83], v[64:67], v[160:163]
  v_cmp_lt_i32 vcc, s33, v151
  v_mfma_f32_16x16x32_bf16 v[164:167], v[80:83], v[68:71], v[164:167]
  s_cbranch_vccz .g2_kernel_q_w0
.g2_kernel_q_back0:
  v_mfma_f32_16x16x32_bf16 v[168:171], v[80:83], v[72:75], v[168:171]
  ds_read_b64_tr_b16 v[120:121], v146 offset:0
  v_mfma_f32_16x16x32_bf16 v[172:175], v[80:83], v[76:79], v[172:175]
  ds_read_b64_tr_b16 v[122:123], v146 offset:512
  v_mfma_f32_16x16x32_bf16 v[188:191], v[84:87], v[76:79], v[188:191]
  ds_read_b128 v[104:107], v145 offset:0
  v_mfma_f32_16x16x32_bf16 v[184:187], v[84:87], v[72:75], v[184:187]
  ds_read_b128 v[108:111], v145 offset:2048
  v_mfma_f32_16x16x32_bf16 v[180:183], v[84:87], v[68:71], v[180:183]
  ds_read_b128 v[112:115], v145 offset:4096
  v_mfma_f32_16x16x32_bf16 v[176:179], v[84:87], v[64:67], v[176:179]
  ds_read_b128 v[116:119], v145 offset:6144
  v_mfma_f32_16x16x32_bf16 v[192:195], v[88:91], v[64:67], v[192:195]
  ds_read_b64_tr_b16 v[124:125], v147 offset:0
  v_mfma_f32_16x16x32_bf16 v[196:199], v[88:91], v[68:71], v[196:199]
  ds_read_b64_tr_b16 v[126:127], v147 offset:512
  v_mfma_f32_16x16x32_bf16 v[200:203], v[88:91], v[72:75], v[200:203]
  ds_read_b64_tr_b16 v[128:129], v146 offset:4096
  v_mfma_f32_16x16x32_bf16 v[204:207], v[88:91], v[76:79], v[204:207]
  ds_read_b64_tr_b16 v[130:131], v146 offset:4608
  v_mfma_f32_16x16x32_bf16 v[220:223], v[92:95], v[76:79], v[220:223]
  ds_read_b64_tr_b16 v[132:133], v147 offset:4096
  v_mfma_f32_16x16x32_bf16 v[216:219], v[92:95], v[72:75], v[216:219]
  ds_read_b64_tr_b16 v[134:135], v147 offset:4608
  v_mfma_f32_16x16x32_bf16 v[212:215], v[92:95], v[68:71], v[212:215]
  ds_read_b64_tr_b16 v[136:137], v146 offset:8192
  v_mfma_f32_16x16x32_bf16 v[208:211], v[92:95], v[64:67], v[208:211]
  ds_read_b64_tr_b16 v[138:139], v146 offset:8704
  v_mfma_f32_16x16x32_bf16 v[224:227], v[64:67], v[96:99], v[224:227]
  ds_read_b64_tr_b16 v[140:141], v147 offset:8192
  v_mfma_f32_16x16x32_bf16 v[228:231], v[68:71], v[96:99], v[228:231]
  ds_read_b64_tr_b16 v[142:143], v147 offset:8704
  v_mfma_f32_16x16x32_bf16 v[232:235], v[72:75], v[96:99], v[232:235]
  ds_read_b32 v151, v150
  s_add_u32 s30, s30, 12288
  v_mfma_f32_16x16x32_bf16 v[236:239], v[76:79], v[96:99], v[236:239]
  buffer_load_dword off, s[64:67], s31 lds
  s_cmp_eq_u32 s30, 86016
  v_mfma_f32_16x16x32_bf16 v[252:255], v[76:79], v[100:103], v[252:255]
  s_cselect_b32 s30, 0, s30
  s_add_u32 s31, s31, 4
  v_mfma_f32_16x16x32_bf16 v[248:251], v[72:75], v[100:103], v[248:251]
  v_add_u32 v146, s30, v148
  s_add_u32 s33, s33, 1
  v_mfma_f32_16x16x32_bf16 v[244:247], v[68:71], v[100:103], v[244:247]
  v_add_u32 v147, s30, v149
  v_mfma_f32_16x16x32_bf16 v[240:243], v[64:67], v[100:103], v[240:243]
.g2_kernel_q_s1:
  s_waitcnt lgkmcnt(0)
  v_mfma_f32_16x16x32_bf16 v[160:163], v[120:123], v[104:107], v[160:163]
  v_cmp_lt_i32 vcc, s33, v151
  v_mfma_f32_16x16x32_bf16 v[164:167], v[120:123], v[108:111], v[164:167]
  s_cbranch_vccz .g2_kernel_q_w1
.g2_kernel_q_back1:
  v_mfma_f32_16x16x32_bf16 v[168:171], v[120:123], v[112:115], v[168:171]
  ds_read_b64_tr_b16 v[80:81], v146 offset:0
  v_mfma_f32_16x16x32_bf16 v[172:175], v[120:123], v[116:119], v[172:175]
  ds_read_b64_tr_b16 v[82:83], v146 offset:512
  v_mfma_f32_16x16x32_bf16 v[188:191], v[124:127], v[116:119], v[188:191]
  ds_read_b128 v[64:67], v144 offset:16384
  v_mfma_f32_16x16x32_bf16 v[184:187], v[124:127], v[112:115], v[184:187]
  ds_read_b128 v[68:71], v144 offset:18432
  v_mfma_f32_16x16x32_bf16 v[180:183], v[124:127], v[108:111], v[180:183]
  ds_read_b128 v[72:75], v144 offset:20480
  v_mfma_f32_16x16x32_bf16 v[176:179], v[124:127], v[104:107], v[176:179]
  ds_read_b128 v[76:79], v144 offset:22528
  v_mfma_f32_16x16x32_bf16 v[192:195], v[128:131], v[104:107], v[192:195]
  ds_read_b64_tr_b16 v[84:85], v147 offset:0
  v_mfma_f32_16x16x32_bf16 v[196:199], v[128:131], v[108:111], v[196:199]
  ds_read_b64_tr_b16 v[86:87], v147 offset:512
  v_mfma_f32_16x16x32_bf16 v[200:203], v[128:131], v[112:115], v[200:203]
  ds_read_b64_tr_b16 v[88:89], v146 offset:4096
  v_mfma_f32_16x16x32_bf16 v[204:207], v[128:131], v[116:119], v[204:207]
  ds_read_b64_tr_b16 v[90:91], v146 offset:4608
  v_mfma_f32_16x16x32_bf16 v[220:223], v[132:135], v[116:119], v[220:223]
  ds_read_b64_tr_b16 v[92:93], v147 offset:4096
  v_mfma_f32_16x16x32_bf16 v[216:219], v[132:135], v[112:115], v[216:219]
  ds_read_b64_tr_b16 v[94:95], v147 offset:4608
  v_mfma_f32_16x16x32_bf16 v[212:215], v[132:135], v[108:111], v[212:215]
  ds_read_b64_tr_b16 v[96:97], v146 offset:8192
  v_mfma_f32_16x16x32_bf16 v[208:211], v[132:135], v[104:107], v[208:211]
  ds_read_b64_tr_b16 v[98:99], v146 offset:8704
  v_mfma_f32_16x16x32_bf16 v[224:227], v[104:107], v[136:139], v[224:227]
  ds_read_b64_tr_b16 v[100:101], v147 offset:8192
  v_mfma_f32_16x16x32_bf16 v[228:231], v[108:111], v[136:139], v[228:231]
  ds_read_b64_tr_b16 v[102:103], v147 offset:8704
  v_mfma_f32_16x16x32_bf16 v[232:235], v[112:115], v[136:139], v[232:235]
  ds_read_b32 v151, v150
  s_add_u32 s30, s30, 12288
  v_mfma_f32_16x16x32_bf16 v[236:239], v[116:119], v[136:139], v[236:239]
  buffer_load_dword off, s[64:67], s31 lds
  s_cmp_eq_u32 s30, 86016
  v_mfma_f32_16x16x32_bf16 v[252:255], v[116:119], v[140:143], v[252:255]
  s_cselect_b32 s30, 0, s30
  s_add_u32 s31, s31, 4
  v_mfma_f32_16x16x32_bf16 v[248:251], v[112:115], v[140:143], v[248:251]
  v_add_u32 v146, s30, v148
  s_add_u32 s33, s33, 1
  v_mfma_f32_16x16x32_bf16 v[244:247], v[108:111], v[140:143], v[244:247]
  v_add_u32 v147, s30, v149
  v_mfma_f32_16x16x32_bf16 v[240:243], v[104:107], v[140:143], v[240:243]
  s_waitcnt lgkmcnt(0)
  v_mfma_f32_16x16x32_bf16 v[160:163], v[80:83], v[64:67], v[160:163]
  v_cmp_lt_i32 vcc, s33, v151
  v_mfma_f32_16x16x32_bf16 v[164:167], v[80:83], v[68:71], v[164:167]
  s_cbranch_vccz .g2_kernel_q_w2
.g2_kernel_q_back2:
  v_mfma_f32_16x16x32_bf16 v[168:171], v[80:83], v[72:75], v[168:171]
  ds_read_b64_tr_b16 v[120:121], v146 offset:0
  v_mfma_f32_16x16x32_bf16 v[172:175], v[80:83], v[76:79], v[172:175]
  ds_read_b64_tr_b16 v[122:123], v146 offset:512
  v_mfma_f32_16x16x32_bf16 v[188:191], v[84:87], v[76:79], v[188:191]
  ds_read_b128 v[104:107], v145 offset:16384
  v_mfma_f32_16x16x32_bf16 v[184:187], v[84:87], v[72:75], v[184:187]
  ds_read_b128 v[108:111], v145 offset:18432
  v_mfma_f32_16x16x32_bf16 v[180:183], v[84:87], v[68:71], v[180:183]
  ds_read_b128 v[112:115], v145 offset:20480
  v_mfma_f32_16x16x32_bf16 v[176:179], v[84:87], v[64:67], v[176:179]
  ds_read_b128 v[116:119], v145 offset:22528
  v_mfma_f32_16x16x32_bf16 v[192:195], v[88:91], v[64:67], v[192:195]
  ds_read_b64_tr_b16 v[124:125], v147 offset:0
  v_mfma_f32_16x16x32_bf16 v[196:199], v[88:91], v[68:71], v[196:199]
  ds_read_b64_tr_b16 v[126:127], v147 offset:512
  v_mfma_f32_16x16x32_bf16 v[200:203], v[88:91], v[72:75], v[200:203]
  ds_read_b64_tr_b16 v[128:129], v146 offset:4096
  v_mfma_f32_16x16x32_bf16 v[204:207], v[88:91], v[76:79], v[204:207]
  ds_read_b64_tr_b16 v[130:131], v146 offset:4608
  v_mfma_f32_16x16x32_bf16 v[220:223], v[92:95], v[76:79], v[220:223]
  ds_read_b64_tr_b16 v[132:133], v147 offset:4096
  v_mfma_f32_16x16x32_bf16 v[216:219], v[92:95], v[72:75], v[216:219]
  ds_read_b64_tr_b16 v[134:135], v147 offset:4608
  v_mfma_f32_16x16x32_bf16 v[212:215], v[92:95], v[68:71], v[212:215]
  ds_read_b64_tr_b16 v[136:137], v146 offset:8192
  v_mfma_f32_16x16x32_bf16 v[208:211], v[92:95], v[64:67], v[208:211]
  ds_read_b64_tr_b16 v[138:139], v146 offset:8704
  v_mfma_f32_16x16x32_bf16 v[224:227], v[64:67], v[96:99], v[224:227]
  ds_read_b64_tr_b16 v[140:141], v147 offset:8192
  v_mfma_f32_16x16x32_bf16 v[228:231], v[68:71], v[96:99], v[228:231]
  ds_read_b64_tr_b16 v[142:143], v147 offset:8704
  v_mfma_f32_16x16x32_bf16 v[232:235], v[72:75], v[96:99], v[232:235]
  ds_read_b32 v151, v150
  s_add_u32 s30, s30, 12288
  v_mfma_f32_16x16x32_bf16 v[236:239], v[76:79], v[96:99], v[236:239]
  buffer_load_dword off, s[64:67], s31 lds
  s_cmp_eq_u32 s30, 86016
  v_mfma_f32_16x16x32_bf16 v[252:255], v[76:79], v[100:103], v[252:255]
  s_cselect_b32 s30, 0, s30
  s_add_u32 s31, s31, 4
  v_mfma_f32_16x16x32_bf16 v[248:251], v[72:75], v[100:103], v[248:251]
  v_add_u32 v146, s30, v148
  s_add_u32 s33, s33, 1
  v_mfma_f32_16x16x32_bf16 v[244:247], v[68:71], v[100:103], v[244:247]
  v_add_u32 v147, s30, v149
  v_mfma_f32_16x16x32_bf16 v[240:243], v[64:67], v[100:103], v[240:243]
  s_waitcnt lgkmcnt(0)
  v_mfma_f32_16x16x32_bf16 v[160:163], v[120:123], v[104:107], v[160:163]
  v_cmp_lt_i32 vcc, s33, v151
  v_mfma_f32_16x16x32_bf16 v[164:167], v[120:123], v[108:111], v[164:167]
  s_cbranch_vccz .g2_kernel_q_w3
.g2_kernel_q_back3:
  v_mfma_f32_16x16x32_bf16 v[168:171], v[120:123], v[112:115], v[168:171]
  ds_read_b64_tr_b16 v[80:81], v146 offset:0
  v_mfma_f32_16x16x32_bf16 v[172:175], v[120:123], v[116:119], v[172:175]
  ds_read_b64_tr_b16 v[82:83], v146 offset:512
  v_mfma_f32_16x16x32_bf16 v[188:191], v[124:127], v[116:119], v[188:191]
  ds_read_b128 v[64:67], v144 offset:32768
  v_mfma_f32_16x16x32_bf16 v[184:187], v[124:127], v[112:115], v[184:187]
  ds_read_b128 v[68:71], v144 offset:34816
  v_mfma_f32_16x16x32_bf16 v[180:183], v[124:127], v[108:111], v[180:183]
  ds_read_b128 v[72:75], v144 offset:36864
  v_mfma_f32_16x16x32_bf16 v[176:179], v[124:127], v[104:107], v[176:179]
  ds_read_b128 v[76:79], v144 offset:38912
  v_mfma_f32_16x16x32_bf16 v[192:195], v[128:131], v[104:107], v[192:195]
  ds_read_b64_tr_b16 v[84:85], v147 offset:0
  v_mfma_f32_16x16x32_bf16 v[196:199], v[128:131], v[108:111], v[196:199]
  ds_read_b64_tr_b16 v[86:87], v147 offset:512
  v_mfma_f32_16x16x32_bf16 v[200:203], v[128:131], v[112:115], v[200:203]
  ds_read_b64_tr_b16 v[88:89], v146 offset:4096
  v_mfma_f32_16x16x32_bf16 v[204:207], v[128:131], v[116:119], v[204:207]
  ds_read_b64_tr_b16 v[90:91], v146 offset:4608
  v_mfma_f32_16x16x32_bf16 v[220:223], v[132:135], v[116:119], v[220:223]
  ds_read_b64_tr_b16 v[92:93], v147 offset:4096
  v_mfma_f32_16x16x32_bf16 v[216:219], v[132:135], v[112:115], v[216:219]
  ds_read_b64_tr_b16 v[94:95], v147 offset:4608
  v_mfma_f32_16x16x32_bf16 v[212:215], v[132:135], v[108:111], v[212:215]
  ds_read_b64_tr_b16 v[96:97], v146 offset:8192
  v_mfma_f32_16x16x32_bf16 v[208:211], v[132:135], v[104:107], v[208:211]
  ds_read_b64_tr_b16 v[98:99], v146 offset:8704
  v_mfma_f32_16x16x32_bf16 v[224:227], v[104:107], v[136:139], v[224:227]
  ds_read_b64_tr_b16 v[100:101], v147 offset:8192
  v_mfma_f32_16x16x32_bf16 v[228:231], v[108:111], v[136:139], v[228:231]
  ds_read_b64_tr_b16 v[102:103], v147 offset:8704
  v_mfma_f32_16x16x32_bf16 v[232:235], v[112:115], v[136:139], v[232:235]
  ds_read_b32 v151, v150
  s_add_u32 s30, s30, 12288
  v_mfma_f32_16x16x32_bf16 v[236:239], v[116:119], v[136:139], v[236:239]
  buffer_load_dword off, s[64:67], s31 lds
  s_cmp_eq_u32 s30, 86016
  v_mfma_f32_16x16x32_bf16 v[252:255], v[116:119], v[140:143], v[252:255]
  s_cselect_b32 s30, 0, s30
  s_add_u32 s31, s31, 4
  v_mfma_f32_16x16x32_bf16 v[248:251], v[112:115], v[140:143], v[248:251]
  v_add_u32 v146, s30, v148
  s_add_u32 s33, s33, 1
  v_mfma_f32_16x16x32_bf16 v[244:247], v[108:111], v[140:143], v[244:247]
  v_add_u32 v147, s30, v149
  v_mfma_f32_16x16x32_bf16 v[240:243], v[104:107], v[140:143], v[240:243]
  s_waitcnt lgkmcnt(0)
  v_mfma_f32_16x16x32_bf16 v[160:163], v[80:83], v[64:67], v[160:163]
  v_cmp_lt_i32 vcc, s33, v151
  v_mfma_f32_16x16x32_bf16 v[164:167], v[80:83], v[68:71], v[164:167]
  s_cbranch_vccz .g2_kernel_q_w4
.g2_kernel_q_back4:
  v_mfma_f32_16x16x32_bf16 v[168:171], v[80:83], v[72:75], v[168:171]
  ds_read_b64_tr_b16 v[120:121], v146 offset:0
  v_mfma_f32_16x16x32_bf16 v[172:175], v[80:83], v[76:79], v[172:175]
  ds_read_b64_tr_b16 v[122:123], v146 offset:512
  v_mfma_f32_16x16x32_bf16 v[188:191], v[84:87], v[76:79], v[188:191]
  ds_read_b128 v[104:107], v145 offset:32768
  v_mfma_f32_16x16x32_bf16 v[184:187], v[84:87], v[72:75], v[184:187]
  ds_read_b128 v[108:111], v145 offset:34816
  v_mfma_f32_16x16x32_bf16 v[180:183], v[84:87], v[68:71], v[180:183]
  ds_read_b128 v[112:115], v145 offset:36864
  v_mfma_f32_16x16x32_bf16 v[176:179], v[84:87], v[64:67], v[176:179]
  ds_read_b128 v[116:119], v145 offset:38912
  v_mfma_f32_16x16x32_bf16 v[192:195], v[88:91], v[64:67], v[192:195]
  ds_read_b64_tr_b16 v[124:125], v147 offset:0
  v_mfma_f32_16x16x32_bf16 v[196:199], v[88:91], v[68:71], v[196:199]
  ds_read_b64_tr_b16 v[126:127], v147 offset:512
  v_mfma_f32_16x16x32_bf16 v[200:203], v[88:91], v[72:75], v[200:203]
  ds_read_b64_tr_b16 v[128:129], v146 offset:4096
  v_mfma_f32_16x16x32_bf16 v[204:207], v[88:91], v[76:79], v[204:207]
  ds_read_b64_tr_b16 v[130:131], v146 offset:4608
  v_mfma_f32_16x16x32_bf16 v[220:223], v[92:95], v[76:79], v[220:223]
  ds_read_b64_tr_b16 v[132:133], v147 offset:4096
  v_mfma_f32_16x16x32_bf16 v[216:219], v[92:95], v[72:75], v[216:219]
  ds_read_b64_tr_b16 v[134:135], v147 offset:4608
  v_mfma_f32_16x16x32_bf16 v[212:215], v[92:95], v[68:71], v[212:215]
  ds_read_b64_tr_b16 v[136:137], v146 offset:8192
  v_mfma_f32_16x16x32_bf16 v[208:211], v[92:95], v[64:67], v[208:211]
  ds_read_b64_tr_b16 v[138:139], v146 offset:8704
  v_mfma_f32_16x16x32_bf16 v[224:227], v[64:67], v[96:99], v[224:227]
  ds_read_b64_tr_b16 v[140:141], v147 offset:8192
  v_mfma_f32_16x16x32_bf16 v[228:231], v[68:71], v[96:99], v[228:231]
  ds_read_b64_tr_b16 v[142:143], v147 offset:8704
  v_mfma_f32_16x16x32_bf16 v[232:235], v[72:75], v[96:99], v[232:235]
  ds_read_b32 v151, v150
  s_add_u32 s30, s30, 12288
  v_mfma_f32_16x16x32_bf16 v[236:239], v[76:79], v[96:99], v[236:239]
  buffer_load_dword off, s[64:67], s31 lds
  s_cmp_eq_u32 s30, 86016
  v_mfma_f32_16x16x32_bf16 v[252:255], v[76:79], v[100:103], v[252:255]
  s_cselect_b32 s30, 0, s30
  s_add_u32 s31, s31, 4
  v_mfma_f32_16x16x32_bf16 v[248:251], v[72:75], v[100:103], v[248:251]
  v_add_u32 v146, s30, v148
  s_add_u32 s33, s33, 1
  v_mfma_f32_16x16x32_bf16 v[244:247], v[68:71], v[100:103], v[244:247]
  v_add_u32 v147, s30, v149
  v_mfma_f32_16x16x32_bf16 v[240:243], v[64:67], v[100:103], v[240:243]
  s_waitcnt lgkmcnt(0)
  v_mfma_f32_16x16x32_bf16 v[160:163], v[120:123], v[104:107], v[160:163]
  v_cmp_lt_i32 vcc, s33, v151
  v_mfma_f32_16x16x32_bf16 v[164:167], v[120:123], v[108:111], v[164:167]
  s_cbranch_vccz .g2_kernel_q_w5
.g2_kernel_q_back5:
  v_mfma_f32_16x16x32_bf16 v[168:171], v[120:123], v[112:115], v[168:171]
  ds_read_b64_tr_b16 v[80:81], v146 offset:0
  v_mfma_f32_16x16x32_bf16 v[172:175], v[120:123], v[116:119], v[172:175]
  ds_read_b64_tr_b16 v[82:83], v146 offset:512
  v_mfma_f32_16x16x32_bf16 v[188:191], v[124:127], v[116:119], v[188:191]
  ds_read_b128 v[64:67], v144 offset:49152
  v_mfma_f32_16x16x32_bf16 v[184:187], v[124:127], v[112:115], v[184:187]
  ds_read_b128 v[68:71], v144 offset:51200
  v_mfma_f32_16x16x32_bf16 v[180:183], v[124:127], v[108:111], v[180:183]
  ds_read_b128 v[72:75], v144 offset:53248
  v_mfma_f32_16x16x32_bf16 v[176:179], v[124:127], v[104:107], v[176:179]
  ds_read_b128 v[76:79], v144 offset:55296
  v_mfma_f32_16x16x32_bf16 v[192:195], v[128:131], v[104:107], v[192:195]
  ds_read_b64_tr_b16 v[84:85], v147 offset:0
  v_mfma_f32_16x16x32_bf16 v[196:199], v[128:131], v[108:111], v[196:199]
  ds_read_b64_tr_b16 v[86:87], v147 offset:512
  v_mfma_f32_16x16x32_bf16 v[200:203], v[128:131], v[112:115], v[200:203]
  ds_read_b64_tr_b16 v[88:89], v146 offset:4096
  v_mfma_f32_16x16x32_bf16 v[204:207], v[128:131], v[116:119], v[204:207]
  ds_read_b64_tr_b16 v[90:91], v146 offset:4608
  v_mfma_f32_16x16x32_bf16 v[220:223], v[132:135], v[116:119], v[220:223]
  ds_read_b64_tr_b16 v[92:93], v147 offset:4096
  v_mfma_f32_16x16x32_bf16 v[216:219], v[132:135], v[112:115], v[216:219]
  ds_read_b64_tr_b16 v[94:95], v147 offset:4608
  v_mfma_f32_16x16x32_bf16 v[212:215], v[132:135], v[108:111], v[212:215]
  ds_read_b64_tr_b16 v[96:97], v146 offset:8192
  v_mfma_f32_16x16x32_bf16 v[208:211], v[132:135], v[104:107], v[208:211]
  ds_read_b64_tr_b16 v[98:99], v146 offset:8704
  v_mfma_f32_16x16x32_bf16 v[224:227], v[104:107], v[136:139], v[224:227]
  ds_read_b64_tr_b16 v[100:101], v147 offset:8192
  v_mfma_f32_16x16x32_bf16 v[228:231], v[108:111], v[136:139], v[228:231]
  ds_read_b64_tr_b16 v[102:103], v147 offset:8704
  v_mfma_f32_16x16x32_bf16 v[232:235], v[112:115], v[136:139], v[232:235]
  ds_read_b32 v151, v150
  s_add_u32 s30, s30, 12288
  v_mfma_f32_16x16x32_bf16 v[236:239], v[116:119], v[136:139], v[236:239]
  buffer_load_dword off, s[64:67], s31 lds
  s_cmp_eq_u32 s30, 86016
  v_mfma_f32_16x16x32_bf16 v[252:255], v[116:119], v[140:143], v[252:255]
  s_cselect_b32 s30, 0, s30
  s_add_u32 s31, s31, 4
  v_mfma_f32_16x16x32_bf16 v[248:251], v[112:115], v[140:143], v[248:251]
  v_add_u32 v146, s30, v148
  s_add_u32 s33, s33, 1
  v_mfma_f32_16x16x32_bf16 v[244:247], v[108:111], v[140:143], v[244:247]
  v_add_u32 v147, s30, v149
  v_mfma_f32_16x16x32_bf16 v[240:243], v[104:107], v[140:143], v[240:243]
  s_waitcnt lgkmcnt(0)
  v_mfma_f32_16x16x32_bf16 v[160:163], v[80:83], v[64:67], v[160:163]
  v_cmp_lt_i32 vcc, s33, v151
  v_mfma_f32_16x16x32_bf16 v[164:167], v[80:83], v[68:71], v[164:167]
  s_cbranch_vccz .g2_kernel_q_w6
.g2_kernel_q_back6:
  v_mfma_f32_16x16x32_bf16 v[168:171], v[80:83], v[72:75], v[168:171]
  ds_read_b64_tr_b16 v[120:121], v146 offset:0
  v_mfma_f32_16x16x32_bf16 v[172:175], v[80:83], v[76:79], v[172:175]
  ds_read_b64_tr_b16 v[122:123], v146 offset:512
  v_mfma_f32_16x16x32_bf16 v[188:191], v[84:87], v[76:79], v[188:191]
  ds_read_b128 v[104:107], v145 offset:49152
  v_mfma_f32_16x16x32_bf16 v[184:187], v[84:87], v[72:75], v[184:187]
  ds_read_b128 v[108:111], v145 offset:51200
  v_mfma_f32_16x16x32_bf16 v[180:183], v[84:87], v[68:71], v[180:183]
  ds_read_b128 v[112:115], v145 offset:53248
  v_mfma_f32_16x16x32_bf16 v[176:179], v[84:87], v[64:67], v[176:179]
  ds_read_b128 v[116:119], v145 offset:55296
  v_mfma_f32_16x16x32_bf16 v[192:195], v[88:91], v[64:67], v[192:195]
  ds_read_b64_tr_b16 v[124:125], v147 offset:0
  v_mfma_f32_16x16x32_bf16 v[196:199], v[88:91], v[68:71], v[196:199]
  ds_read_b64_tr_b16 v[126:127], v147 offset:512
  v_mfma_f32_16x16x32_bf16 v[200:203], v[88:91], v[72:75], v[200:203]
  ds_read_b64_tr_b16 v[128:129], v146 offset:4096
  v_mfma_f32_16x16x32_bf16 v[204:207], v[88:91], v[76:79], v[204:207]
  ds_read_b64_tr_b16 v[130:131], v146 offset:4608
  v_mfma_f32_16x16x32_bf16 v[220:223], v[92:95], v[76:79], v[220:223]
  ds_read_b64_tr_b16 v[132:133], v147 offset:4096
  v_mfma_f32_16x16x32_bf16 v[216:219], v[92:95], v[72:75], v[216:219]
  ds_read_b64_tr_b16 v[134:135], v147 offset:4608
  v_mfma_f32_16x16x32_bf16 v[212:215], v[92:95], v[68:71], v[212:215]
  ds_read_b64_tr_b16 v[136:137], v146 offset:8192
  v_mfma_f32_16x16x32_bf16 v[208:211], v[92:95], v[64:67], v[208:211]
  ds_read_b64_tr_b16 v[138:139], v146 offset:8704
  v_mfma_f32_16x16x32_bf16 v[224:227], v[64:67], v[96:99], v[224:227]
  ds_read_b64_tr_b16 v[140:141], v147 offset:8192
  v_mfma_f32_16x16x32_bf16 v[228:231], v[68:71], v[96:99], v[228:231]
  ds_read_b64_tr_b16 v[142:143], v147 offset:8704
  v_mfma_f32_16x16x32_bf16 v[232:235], v[72:75], v[96:99], v[232:235]
  ds_read_b32 v151, v150
  s_add_u32 s30, s30, 12288
  v_mfma_f32_16x16x32_bf16 v[236:239], v[76:79], v[96:99], v[236:239]
  buffer_load_dword off, s[64:67], s31 lds
  s_cmp_eq_u32 s30, 86016
  v_mfma_f32_16x16x32_bf16 v[252:255], v[76:79], v[100:103], v[252:255]
  s_cselect_b32 s30, 0, s30
  s_add_u32 s31, s31, 4
  v_mfma_f32_16x16x32_bf16 v[248:251], v[72:75], v[100:103], v[248:251]
  v_add_u32 v146, s30, v148
  s_add_u32 s33, s33, 1
  v_mfma_f32_16x16x32_bf16 v[244:247], v[68:71], v[100:103], v[244:247]
  v_add_u32 v147, s30, v149
  s_add_u32 s29, s29, 1
  v_mfma_f32_16x16x32_bf16 v[240:243], v[64:67], v[100:103], v[240:243]
  s_cmp_lg_u32 s29, 4
  s_cbranch_scc1 .g2_kernel_q_loop
  s_waitcnt lgkmcnt(0)
  v_mfma_f32_16x16x32_bf16 v[192:195], v[128:131], v[104:107], v[192:195]
  ds_read_b32 v62, v13 offset:0
  ds_read_b32 v63, v58
  v_mfma_f32_16x16x32_bf16 v[196:199], v[128:131], v[108:111], v[196:199]
  ds_read_b32 v57, v13 offset:24
  ds_read_b32 v21, v13 offset:84
  v_mfma_f32_16x16x32_bf16 v[200:203], v[128:131], v[112:115], v[200:203]
  ds_read_b128 v[40:43], v52 offset:5120
  ds_read_b128 v[44:47], v52 offset:5184
  v_mfma_f32_16x16x32_bf16 v[204:207], v[128:131], v[116:119], v[204:207]
  ds_read_b32 v24, v50 offset:2816
  ds_read_b32 v25, v50 offset:3328
  v_mfma_f32_16x16x32_bf16 v[220:223], v[132:135], v[116:119], v[220:223]
  ds_read_b32 v26, v50 offset:2880
  ds_read_b32 v27, v50 offset:3392
  v_mfma_f32_16x16x32_bf16 v[216:219], v[132:135], v[112:115], v[216:219]
  ds_read_b32 v28, v50 offset:2944
  ds_read_b32 v29, v50 offset:3456
  v_mfma_f32_16x16x32_bf16 v[212:215], v[132:135], v[108:111], v[212:215]
  ds_read_b32 v30, v50 offset:3008
  ds_read_b32 v31, v50 offset:3520
  v_mfma_f32_16x16x32_bf16 v[208:211], v[132:135], v[104:107], v[208:211]
  ds_read_b128 v[64:67], v51 offset:2816
  ds_read_b128 v[80:83], v51 offset:3328
  v_mfma_f32_16x16x32_bf16 v[224:227], v[104:107], v[136:139], v[224:227]
  ds_read_b128 v[68:71], v51 offset:2880
  v_mfma_f32_16x16x32_bf16 v[228:231], v[108:111], v[136:139], v[228:231]
  ds_read_b128 v[84:87], v51 offset:3392
  v_mfma_f32_16x16x32_bf16 v[232:235], v[112:115], v[136:139], v[232:235]
  ds_read_b128 v[72:75], v51 offset:2944
  v_mfma_f32_16x16x32_bf16 v[236:239], v[116:119], v[136:139], v[236:239]
  ds_read_b128 v[88:91], v51 offset:3456
  v_mfma_f32_16x16x32_bf16 v[252:255], v[116:119], v[140:143], v[252:255]
  ds_read_b128 v[76:79], v51 offset:3008
  v_mfma_f32_16x16x32_bf16 v[248:251], v[112:115], v[140:143], v[248:251]
  ds_read_b128 v[92:95], v51 offset:3520
  v_mfma_f32_16x16x32_bf16 v[244:247], v[108:111], v[140:143], v[244:247]
  ds_read_b32 v48, v53 offset:5376
  v_mfma_f32_16x16x32_bf16 v[240:243], v[104:107], v[140:143], v[240:243]
  ds_read_b32 v49, v53 offset:5440
  v_mfma_f32_16x16x32_bf16 v[160:163], v[120:123], v[104:107], v[160:163]
  ds_read_b128 v[32:35], v52 offset:4864
  v_mfma_f32_16x16x32_bf16 v[164:167], v[120:123], v[108:111], v[164:167]
  ds_read_b128 v[36:39], v52 offset:4928
  v_mfma_f32_16x16x32_bf16 v[168:171], v[120:123], v[112:115], v[168:171]
  v_mfma_f32_16x16x32_bf16 v[172:175], v[120:123], v[116:119], v[172:175]
  v_mfma_f32_16x16x32_bf16 v[188:191], v[124:127], v[116:119], v[188:191]
  buffer_load_dword off, s[64:67], s31 lds
  v_mfma_f32_16x16x32_bf16 v[184:187], v[124:127], v[112:115], v[184:187]
  v_mfma_f32_16x16x32_bf16 v[180:183], v[124:127], v[108:111], v[180:183]
  v_mfma_f32_16x16x32_bf16 v[176:179], v[124:127], v[104:107], v[176:179]
  s_waitcnt lgkmcnt(0)
  v_cmp_gt_u32 vcc, 2, v62
  v_cmp_gt_u32 s[14:15], s12, v63
  s_or_b64 vcc, vcc, s[14:15]
  s_cbranch_scc1 .g2_kernel_q_ew
.g2_kernel_q_eb:
  v_cmp_ne_u32 vcc, 0, v57
  s_cbranch_vccnz .g2_kernel_q_patch
.g2_kernel_q_pback:
  s_add_u32 s79, s77, 4096
  s_cmp_lg_u32 s10, 0
  s_cbranch_scc1 .g2_kernel_q_nk
  v_pk_mul_f32 v[152:153], v[40:41], v[24:25] op_sel:[0,1] op_sel_hi:[1,1]
  v_pk_mul_f32 v[154:155], v[42:43], v[24:25] op_sel:[0,1] op_sel_hi:[1,1]
  v_pk_mul_f32 v[156:157], v[44:45], v[24:25] op_sel:[0,1] op_sel_hi:[1,1]
  v_pk_mul_f32 v[158:159], v[46:47], v[24:25] op_sel:[0,1] op_sel_hi:[1,1]
  v_pk_fma_f32 v[192:193], v[192:193], v[24:25], v[152:153] op_sel_hi:[1,0,1]
  v_pk_fma_f32 v[194:195], v[194:195], v[24:25], v[154:155] op_sel_hi:[1,0,1]
  v_pk_fma_f32 v[208:209], v[208:209], v[24:25], v[156:157] op_sel_hi:[1,0,1]
  v_pk_fma_f32 v[210:211], v[210:211], v[24:25], v[158:159] op_sel_hi:[1,0,1]
  v_cvt_pk_bf16_f32 v192, v192, v193
  v_cvt_pk_bf16_f32 v193, v194, v195
  v_cvt_pk_bf16_f32 v194, v208, v209
  v_cvt_pk_bf16_f32 v195, v210, v211
  buffer_store_dwordx4 v[192:195], v54, s[4:7], s8 offen offset:0 sc1
  v_pk_mul_f32 v[152:153], v[40:41], v[26:27] op_sel:[0,1] op_sel_hi:[1,1]
  v_pk_mul_f32 v[154:155], v[42:43], v[26:27] op_sel:[0,1] op_sel_hi:[1,1]
  v_pk_mul_f32 v[156:157], v[44:45], v[26:27] op_sel:[0,1] op_sel_hi:[1,1]
  v_pk_mul_f32 v[158:159], v[46:47], v[26:27] op_sel:[0,1] op_sel_hi:[1,1]
  v_pk_fma_f32 v[196:197], v[196:197], v[26:27], v[152:153] op_sel_hi:[1,0,1]
  v_pk_fma_f32 v[198:199], v[198:199], v[26:27], v[154:155] op_sel_hi:[1,0,1]
  v_pk_fma_f32 v[212:213], v[212:213], v[26:27], v[156:157] op_sel_hi:[1,0,1]
  v_pk_fma_f32 v[214:215], v[214:215], v[26:27], v[158:159] op_sel_hi:[1,0,1]
  v_cvt_pk_bf16_f32 v196, v196, v197
  v_cvt_pk_bf16_f32 v197, v198, v199
  v_cvt_pk_bf16_f32 v198, v212, v213
  v_cvt_pk_bf16_f32 v199, v214, v215
  buffer_store_dwordx4 v[196:199], v54, s[4:7], s8 offen offset:128 sc1
  v_pk_mul_f32 v[152:153], v[40:41], v[28:29] op_sel:[0,1] op_sel_hi:[1,1]
  v_pk_mul_f32 v[154:155], v[42:43], v[28:29] op_sel:[0,1] op_sel_hi:[1,1]
  v_pk_mul_f32 v[156:157], v[44:45], v[28:29] op_sel:[0,1] op_sel_hi:[1,1]
  v_pk_mul_f32 v[158:159], v[46:47], v[28:29] op_sel:[0,1] op_sel_hi:[1,1]
  v_pk_fma_f32 v[200:201], v[200:201], v[28:29], v[152:153] op_sel_hi:[1,0,1]
  v_pk_fma_f32 v[202:203], v[202:203], v[28:29], v[154:155] op_sel_hi:[1,0,1]
  v_pk_fma_f32 v[216:217], v[216:217], v[28:29], v[156:157] op_sel_hi:[1,0,1]
  v_pk_fma_f32 v[218:219], v[218:219], v[28:29], v[158:159] op_sel_hi:[1,0,1]
  v_cvt_pk_bf16_f32 v200, v200, v201
  v_cvt_pk_bf16_f32 v201, v202, v203
  v_cvt_pk_bf16_f32 v202, v216, v217
  v_cvt_pk_bf16_f32 v203, v218, v219
  buffer_store_dwordx4 v[200:203], v54, s[4:7], s9 offen offset:0 sc1
  v_pk_mul_f32 v[152:153], v[40:41], v[30:31] op_sel:[0,1] op_sel_hi:[1,1]
  v_pk_mul_f32 v[154:155], v[42:43], v[30:31] op_sel:[0,1] op_sel_hi:[1,1]
  v_pk_mul_f32 v[156:157], v[44:45], v[30:31] op_sel:[0,1] op_sel_hi:[1,1]
  v_pk_mul_f32 v[158:159], v[46:47], v[30:31] op_sel:[0,1] op_sel_hi:[1,1]
  v_pk_fma_f32 v[204:205], v[204:205], v[30:31], v[152:153] op_sel_hi:[1,0,1]
  v_pk_fma_f32 v[206:207], v[206:207], v[30:31], v[154:155] op_sel_hi:[1,0,1]
  v_pk_fma_f32 v[220:221], v[220:221], v[30:31], v[156:157] op_sel_hi:[1,0,1]
  v_pk_fma_f32 v[222:223], v[222:223], v[30:31], v[158:159] op_sel_hi:[1,0,1]
  v_cvt_pk_bf16_f32 v204, v204, v205
  v_cvt_pk_bf16_f32 v205, v206, v207
  v_cvt_pk_bf16_f32 v206, v220, v221
  v_cvt_pk_bf16_f32 v207, v222, v223
  buffer_store_dwordx4 v[204:207], v54, s[4:7], s9 offen offset:128 sc1
  v_pk_mul_f32 v[152:153], v[80:81], v[48:49] op_sel:[0,0] op_sel_hi:[1,0]
  v_pk_mul_f32 v[154:155], v[82:83], v[48:49] op_sel:[0,0] op_sel_hi:[1,0]
  v_pk_mul_f32 v[156:157], v[84:85], v[48:49] op_sel:[0,0] op_sel_hi:[1,0]
  v_pk_mul_f32 v[158:159], v[86:87], v[48:49] op_sel:[0,0] op_sel_hi:[1,0]
  v_pk_fma_f32 v[224:225], v[224:225], v[64:65], v[152:153]
  v_pk_fma_f32 v[226:227], v[226:227], v[66:67], v[154:155]
  v_pk_fma_f32 v[228:229], v[228:229], v[68:69], v[156:157]
  v_pk_fma_f32 v[230:231], v[230:231], v[70:71], v[158:159]
  v_cvt_pk_bf16_f32 v224, v224, v225
  v_cvt_pk_bf16_f32 v225, v226, v227
  v_cvt_pk_bf16_f32 v226, v228, v229
  v_cvt_pk_bf16_f32 v227, v230, v231
  buffer_store_dwordx4 v[224:227], v55, s[4:7], s8 offen offset:2048 sc1
  v_pk_mul_f32 v[152:153], v[80:81], v[48:49] op_sel:[0,1] op_sel_hi:[1,1]
  v_pk_mul_f32 v[154:155], v[82:83], v[48:49] op_sel:[0,1] op_sel_hi:[1,1]
  v_pk_mul_f32 v[156:157], v[84:85], v[48:49] op_sel:[0,1] op_sel_hi:[1,1]
  v_pk_mul_f32 v[158:159], v[86:87], v[48:49] op_sel:[0,1] op_sel_hi:[1,1]
  v_pk_fma_f32 v[240:241], v[240:241], v[64:65], v[152:153]
  v_pk_fma_f32 v[242:243], v[242:243], v[66:67], v[154:155]
  v_pk_fma_f32 v[244:245], v[244:245], v[68:69], v[156:157]
  v_pk_fma_f32 v[246:247], v[246:247], v[70:71], v[158:159]
  v_cvt_pk_bf16_f32 v240, v240, v241
  v_cvt_pk_bf16_f32 v241, v242, v243
  v_cvt_pk_bf16_f32 v242, v244, v245
  v_cvt_pk_bf16_f32 v243, v246, v247
  buffer_store_dwordx4 v[240:243], v55, s[4:7], s8 offen offset:2304 sc1
  v_pk_mul_f32 v[152:153], v[88:89], v[48:49] op_sel:[0,0] op_sel_hi:[1,0]
  v_pk_mul_f32 v[154:155], v[90:91], v[48:49] op_sel:[0,0] op_sel_hi:[1,0]
  v_pk_mul_f32 v[156:157], v[92:93], v[48:49] op_sel:[0,0] op_sel_hi:[1,0]
  v_pk_mul_f32 v[158:159], v[94:95], v[48:49] op_sel:[0,0] op_sel_hi:[1,0]
  v_pk_fma_f32 v[232:233], v[232:233], v[72:73], v[152:153]
  v_pk_fma_f32 v[234:235], v[234:235], v[74:75], v[154:155]
  v_pk_fma_f32 v[236:237], v[236:237], v[76:77], v[156:157]
  v_pk_fma_f32 v[238:239], v[238:239], v[78:79], v[158:159]
  v_cvt_pk_bf16_f32 v232, v232, v233
  v_cvt_pk_bf16_f32 v233, v234, v235
  v_cvt_pk_bf16_f32 v234, v236, v237
  v_cvt_pk_bf16_f32 v235, v238, v239
  buffer_store_dwordx4 v[232:235], v55, s[4:7], s9 offen offset:2048 sc1
  v_pk_mul_f32 v[152:153], v[88:89], v[48:49] op_sel:[0,1] op_sel_hi:[1,1]
  v_pk_mul_f32 v[154:155], v[90:91], v[48:49] op_sel:[0,1] op_sel_hi:[1,1]
  v_pk_mul_f32 v[156:157], v[92:93], v[48:49] op_sel:[0,1] op_sel_hi:[1,1]
  v_pk_mul_f32 v[158:159], v[94:95], v[48:49] op_sel:[0,1] op_sel_hi:[1,1]
  v_pk_fma_f32 v[248:249], v[248:249], v[72:73], v[152:153]
  v_pk_fma_f32 v[250:251], v[250:251], v[74:75], v[154:155]
  v_pk_fma_f32 v[252:253], v[252:253], v[76:77], v[156:157]
  v_pk_fma_f32 v[254:255], v[254:255], v[78:79], v[158:159]
  v_cvt_pk_bf16_f32 v248, v248, v249
  v_cvt_pk_bf16_f32 v249, v250, v251
  v_cvt_pk_bf16_f32 v250, v252, v253
  v_cvt_pk_bf16_f32 v251, v254, v255
  buffer_store_dwordx4 v[248:251], v55, s[4:7], s9 offen offset:2304 sc1
  v_pk_mul_f32 v[24:25], v[24:25], v[56:57] op_sel_hi:[1,0]
  v_pk_mul_f32 v[26:27], v[26:27], v[56:57] op_sel_hi:[1,0]
  v_pk_mul_f32 v[28:29], v[28:29], v[56:57] op_sel_hi:[1,0]
  v_pk_mul_f32 v[30:31], v[30:31], v[56:57] op_sel_hi:[1,0]
  ds_write_b128 v59, v[192:195] offset:0
  ds_write_b128 v59, v[196:199] offset:128
  v_pk_mul_f32 v[152:153], v[32:33], v[24:25] op_sel:[0,1] op_sel_hi:[1,1]
  v_pk_mul_f32 v[154:155], v[34:35], v[24:25] op_sel:[0,1] op_sel_hi:[1,1]
  v_pk_mul_f32 v[156:157], v[36:37], v[24:25] op_sel:[0,1] op_sel_hi:[1,1]
  v_pk_mul_f32 v[158:159], v[38:39], v[24:25] op_sel:[0,1] op_sel_hi:[1,1]
  v_pk_fma_f32 v[160:161], v[160:161], v[24:25], v[152:153] op_sel_hi:[1,0,1]
  v_pk_fma_f32 v[162:163], v[162:163], v[24:25], v[154:155] op_sel_hi:[1,0,1]
  v_pk_fma_f32 v[176:177], v[176:177], v[24:25], v[156:157] op_sel_hi:[1,0,1]
  v_pk_fma_f32 v[178:179], v[178:179], v[24:25], v[158:159] op_sel_hi:[1,0,1]
  v_cvt_pk_bf16_f32 v160, v160, v161
  v_cvt_pk_bf16_f32 v161, v162, v163
  v_cvt_pk_bf16_f32 v162, v176, v177
  v_cvt_pk_bf16_f32 v163, v178, v179
  ds_write_b128 v61, v[160:163] offset:0
  ds_write_b128 v59, v[200:203] offset:4096
  ds_write_b128 v59, v[204:207] offset:4224
  v_pk_mul_f32 v[152:153], v[32:33], v[26:27] op_sel:[0,1] op_sel_hi:[1,1]
  v_pk_mul_f32 v[154:155], v[34:35], v[26:27] op_sel:[0,1] op_sel_hi:[1,1]
  v_pk_mul_f32 v[156:157], v[36:37], v[26:27] op_sel:[0,1] op_sel_hi:[1,1]
  v_pk_mul_f32 v[158:159], v[38:39], v[26:27] op_sel:[0,1] op_sel_hi:[1,1]
  v_pk_fma_f32 v[164:165], v[164:165], v[26:27], v[152:153] op_sel_hi:[1,0,1]
  v_pk_fma_f32 v[166:167], v[166:167], v[26:27], v[154:155] op_sel_hi:[1,0,1]
  v_pk_fma_f32 v[180:181], v[180:181], v[26:27], v[156:157] op_sel_hi:[1,0,1]
  v_pk_fma_f32 v[182:183], v[182:183], v[26:27], v[158:159] op_sel_hi:[1,0,1]
  v_cvt_pk_bf16_f32 v164, v164, v165
  v_cvt_pk_bf16_f32 v165, v166, v167
  v_cvt_pk_bf16_f32 v166, v180, v181
  v_cvt_pk_bf16_f32 v167, v182, v183
  ds_write_b128 v61, v[164:167] offset:256
  ds_write_b128 v60, v[224:227] offset:2048
  ds_write_b128 v60, v[240:243] offset:2304
  v_pk_mul_f32 v[152:153], v[32:33], v[28:29] op_sel:[0,1] op_sel_hi:[1,1]
  v_pk_mul_f32 v[154:155], v[34:35], v[28:29] op_sel:[0,1] op_sel_hi:[1,1]
  v_pk_mul_f32 v[156:157], v[36:37], v[28:29] op_sel:[0,1] op_sel_hi:[1,1]
  v_pk_mul_f32 v[158:159], v[38:39], v[28:29] op_sel:[0,1] op_sel_hi:[1,1]
  v_pk_fma_f32 v[168:169], v[168:169], v[28:29], v[152:153] op_sel_hi:[1,0,1]
  v_pk_fma_f32 v[170:171], v[170:171], v[28:29], v[154:155] op_sel_hi:[1,0,1]
  v_pk_fma_f32 v[184:185], v[184:185], v[28:29], v[156:157] op_sel_hi:[1,0,1]
  v_pk_fma_f32 v[186:187], v[186:187], v[28:29], v[158:159] op_sel_hi:[1,0,1]
  v_cvt_pk_bf16_f32 v168, v168, v169
  v_cvt_pk_bf16_f32 v169, v170, v171
  v_cvt_pk_bf16_f32 v170, v184, v185
  v_cvt_pk_bf16_f32 v171, v186, v187
  ds_write_b128 v61, v[168:171] offset:2048
  ds_write_b128 v60, v[232:235] offset:6144
  ds_write_b128 v60, v[248:251] offset:6400
  v_pk_mul_f32 v[152:153], v[32:33], v[30:31] op_sel:[0,1] op_sel_hi:[1,1]
  v_pk_mul_f32 v[154:155], v[34:35], v[30:31] op_sel:[0,1] op_sel_hi:[1,1]
  v_pk_mul_f32 v[156:157], v[36:37], v[30:31] op_sel:[0,1] op_sel_hi:[1,1]
  v_pk_mul_f32 v[158:159], v[38:39], v[30:31] op_sel:[0,1] op_sel_hi:[1,1]
  v_pk_fma_f32 v[172:173], v[172:173], v[30:31], v[152:153] op_sel_hi:[1,0,1]
  v_pk_fma_f32 v[174:175], v[174:175], v[30:31], v[154:155] op_sel_hi:[1,0,1]
  v_pk_fma_f32 v[188:189], v[188:189], v[30:31], v[156:157] op_sel_hi:[1,0,1]
  v_pk_fma_f32 v[190:191], v[190:191], v[30:31], v[158:159] op_sel_hi:[1,0,1]
  v_cvt_pk_bf16_f32 v172, v172, v173
  v_cvt_pk_bf16_f32 v173, v174, v175
  v_cvt_pk_bf16_f32 v174, v188, v189
  v_cvt_pk_bf16_f32 v175, v190, v191
  ds_write_b128 v61, v[172:175] offset:2304
.g2_kernel_q_kd:
  s_mov_b64 exec, 1
  ds_add_u32 v13, v5 offset:4
  s_mov_b64 exec, -1
  v_mov_b32 v120, 0
  v_mov_b32 v121, 0
  v_mov_b32 v124, 0
  v_mov_b32 v125, 0
  v_mov_b32 v128, 0
  v_mov_b32 v129, 0
  v_mov_b32 v132, 0
  v_mov_b32 v133, 0
  s_cmp_lg_u32 s62, 0
  s_cbranch_scc1 .g2_kernel_r2
  global_load_dwordx4 v[240:243], v23, s[74:75] offset:0
  global_load_dwordx4 v[244:247], v23, s[74:75] offset:32
  global_load_dwordx4 v[248:251], v23, s[74:75] offset:64
  global_load_dwordx4 v[252:255], v23, s[74:75] offset:96
.g2_kernel_r3:
  v_mov_b32 v6, s71
  s_mov_b32 s38, 0
.g2_kernel_wg2:
  ds_read_b32 v7, v6 offset:4
  s_add_u32 s38, s38, 1
  s_waitcnt lgkmcnt(0)
  v_cmp_le_u32 vcc, 4, v7
  s_cbranch_vccnz .g2_kernel_wg2d
  s_cmp_lt_u32 s38, 524288
  s_cbranch_scc1 .g2_kernel_wg2
.g2_kernel_wg2d:
  ds_read_b128 v[176:179], v9 offset:0
  ds_read_b128 v[180:183], v9 offset:1024
  ds_read_b128 v[24:27], v14 offset:8192
  ds_read_b128 v[28:31], v14 offset:9216
  ds_read_b128 v[184:187], v9 offset:2048
  ds_read_b128 v[188:191], v9 offset:3072
  ds_read_b128 v[32:35], v14 offset:10240
  ds_read_b128 v[36:39], v14 offset:11264
  ds_read_b128 v[40:43], v14 offset:12288
  ds_read_b128 v[44:47], v14 offset:13312
  ds_read_b128 v[48:51], v14 offset:14336
  ds_read_b128 v[52:55], v14 offset:15360
  s_cmp_lg_u32 s35, 0
  s_cbranch_scc1 .g2_kernel_a_own
  s_waitcnt lgkmcnt(8)
.g2_kernel_a_ob:
  v_mfma_f32_32x32x16_bf16 v[136:151], v[176:179], v[24:27], 0
  v_mfma_f32_32x32x16_bf16 v[136:151], v[180:183], v[28:31], v[136:151]
  s_waitcnt lgkmcnt(0)
  s_nop 7
  v_mfma_f32_32x32x16_bf16 v[152:167], v[176:179], v[32:35], 0
  s_waitcnt vmcnt(4)
  s_mov_b64 exec, 1
  buffer_store_dword v15, v4, s[4:7], s37 offen sc1
  s_mov_b64 exec, -1
  v_exp_f32 v136, v136
  v_exp_f32 v137, v137
  v_exp_f32 v138, v138
  v_exp_f32 v139, v139
  v_exp_f32 v140, v140
  v_exp_f32 v141, v141
  v_exp_f32 v142, v142
  v_exp_f32 v143, v143
  v_mfma_f32_32x32x16_bf16 v[152:167], v[180:183], v[36:39], v[152:167]
  s_mov_b64 exec, 1
  ds_add_u32 v13, v5 offset:8
  s_mov_b64 exec, -1
  v_cvt_pk_bf16_f32 v168, v136, v137
  v_cvt_pk_bf16_f32 v169, v138, v139
  v_cvt_pk_bf16_f32 v170, v140, v141
  v_cvt_pk_bf16_f32 v171, v142, v143
  v_exp_f32 v144, v144
  v_exp_f32 v145, v145
  v_exp_f32 v146, v146
  v_exp_f32 v147, v147
  v_mfma_f32_32x32x16_bf16 v[56:71], v[184:187], v[168:171], 0
  v_exp_f32 v148, v148
  v_exp_f32 v149, v149
  v_exp_f32 v150, v150
  v_exp_f32 v151, v151
  v_cvt_pk_bf16_f32 v172, v144, v145
  v_cvt_pk_bf16_f32 v173, v146, v147
  v_cvt_pk_bf16_f32 v174, v148, v149
  v_cvt_pk_bf16_f32 v175, v150, v151
  v_mfma_f32_32x32x16_bf16 v[136:151], v[176:179], v[40:43], 0
  v_exp_f32 v152, v152
  v_exp_f32 v153, v153
  v_exp_f32 v154, v154
  v_mfma_f32_32x32x16_bf16 v[56:71], v[188:191], v[172:175], v[56:71]
  v_exp_f32 v155, v155
  v_exp_f32 v156, v156
  v_exp_f32 v157, v157
  v_smfmac_f32_16x16x64_bf16 v[120:123], v[16:19], v[168:175], v20
  v_exp_f32 v158, v158
  v_exp_f32 v159, v159
  v_mfma_f32_32x32x16_bf16 v[136:151], v[180:183], v[44:47], v[136:151]
  v_cvt_pk_bf16_f32 v168, v152, v153
  v_cvt_pk_bf16_f32 v169, v154, v155
  v_cvt_pk_bf16_f32 v170, v156, v157
  v_cvt_pk_bf16_f32 v171, v158, v159
  v_exp_f32 v160, v160
  v_exp_f32 v161, v161
  v_exp_f32 v162, v162
  v_exp_f32 v163, v163
  v_mfma_f32_32x32x16_bf16 v[72:87], v[184:187], v[168:171], 0
  v_exp_f32 v164, v164
  v_exp_f32 v165, v165
  v_exp_f32 v166, v166
  v_exp_f32 v167, v167
  v_cvt_pk_bf16_f32 v172, v160, v161
  v_cvt_pk_bf16_f32 v173, v162, v163
  v_cvt_pk_bf16_f32 v174, v164, v165
  v_cvt_pk_bf16_f32 v175, v166, v167
  v_mfma_f32_32x32x16_bf16 v[152:167], v[176:179], v[48:51], 0
  ds_read_b32 v7, v8
  v_exp_f32 v136, v136
  v_exp_f32 v137, v137
  v_exp_f32 v138, v138
  v_mfma_f32_32x32x16_bf16 v[72:87], v[188:191], v[172:175], v[72:87]
  s_lshl_b32 s28, s16, 11
  v_exp_f32 v139, v139
  v_exp_f32 v140, v140
  v_exp_f32 v141, v141
  v_smfmac_f32_16x16x64_bf16 v[124:127], v[16:19], v[168:175], v20
  v_add_u32 v9, s28, v3
  v_exp_f32 v142, v142
  v_exp_f32 v143, v143
  v_mfma_f32_32x32x16_bf16 v[152:167], v[180:183], v[52:55], v[152:167]
  s_waitcnt lgkmcnt(0)
  v_cmp_lt_u32 vcc, s62, v7
  v_cvt_pk_bf16_f32 v168, v136, v137
  v_cvt_pk_bf16_f32 v169, v138, v139
  v_cvt_pk_bf16_f32 v170, v140, v141
  v_cvt_pk_bf16_f32 v171, v142, v143
  v_exp_f32 v144, v144
  v_exp_f32 v145, v145
  v_exp_f32 v146, v146
  v_exp_f32 v147, v147
  v_mfma_f32_32x32x16_bf16 v[88:103], v[184:187], v[168:171], 0
  s_mov_b32 s36, vcc_lo
  s_andn2_b32 s33, s36, s34
  v_exp_f32 v148, v148
  v_exp_f32 v149, v149
  v_exp_f32 v150, v150
  v_exp_f32 v151, v151
  v_cvt_pk_bf16_f32 v172, v144, v145
  v_cvt_pk_bf16_f32 v173, v146, v147
  v_cvt_pk_bf16_f32 v174, v148, v149
  v_cvt_pk_bf16_f32 v175, v150, v151
  v_exp_f32 v152, v152
  v_exp_f32 v153, v153
  v_exp_f32 v154, v154
  v_mfma_f32_32x32x16_bf16 v[88:103], v[188:191], v[172:175], v[88:103]
  s_bcnt1_i32_b32 s39, s33
  s_cmp_lt_u32 s39, 3
  v_exp_f32 v155, v155
  v_exp_f32 v156, v156
  v_exp_f32 v157, v157
  v_smfmac_f32_16x16x64_bf16 v[128:131], v[16:19], v[168:175], v20
  s_cbranch_scc1 .g2_kernel_a_F0n
  s_call_b64 s[72:73], .g2_kernel_a_three
.g2_kernel_a_F0n:
  v_exp_f32 v158, v158
  v_exp_f32 v159, v159
  v_cvt_pk_bf16_f32 v168, v152, v153
  v_cvt_pk_bf16_f32 v169, v154, v155
  v_cvt_pk_bf16_f32 v170, v156, v157
  v_cvt_pk_bf16_f32 v171, v158, v159
  v_exp_f32 v160, v160
  v_exp_f32 v161, v161
  v_exp_f32 v162, v162
  v_exp_f32 v163, v163
  v_mfma_f32_32x32x16_bf16 v[104:119], v[184:187], v[168:171], 0
  v_exp_f32 v164, v164
  v_exp_f32 v165, v165
  v_exp_f32 v166, v166
  v_exp_f32 v167, v167
  v_cvt_pk_bf16_f32 v172, v160, v161
  v_cvt_pk_bf16_f32 v173, v162, v163
  v_cvt_pk_bf16_f32 v174, v164, v165
  v_cvt_pk_bf16_f32 v175, v166, v167
  s_add_u32 s39, s39, s35
  s_cmp_ge_u32 s39, 3
  s_cbranch_scc1 .g2_kernel_a_p1
  s_call_b64 s[72:73], .g2_kernel_a_three
.g2_kernel_a_p1:
  s_waitcnt vmcnt(10)
  v_mfma_f32_32x32x16_bf16 v[136:151], v[192:195], v[24:27], 0
  v_mfma_f32_32x32x16_bf16 v[136:151], v[196:199], v[28:31], v[136:151]
  s_waitcnt vmcnt(8)
  s_mov_b32 s32, 0
  s_nop 8
  s_branch .g2_kernel_a_n1
  .p2align 6
.g2_kernel_a_loop:
  v_mfma_f32_32x32x16_bf16 v[152:167], v[176:179], v[32:35], 0
  s_andn2_b32 s33, s36, s34
  v_exp_f32 v136, v136
  v_exp_f32 v137, v137
  v_exp_f32 v138, v138
  v_mfma_f32_32x32x16_bf16 v[104:119], v[236:239], v[172:175], v[104:119]
  s_cbranch_scc0 .g2_kernel_a_N0c
.g2_kernel_a_N0b:
  v_exp_f32 v139, v139
  v_exp_f32 v140, v140
  v_exp_f32 v141, v141
  v_smfmac_f32_16x16x64_bf16 v[132:135], v[16:19], v[168:175], v20
  s_ff1_i32_b32 s33, s33
  v_exp_f32 v142, v142
  v_exp_f32 v143, v143
  v_mfma_f32_32x32x16_bf16 v[152:167], v[180:183], v[36:39], v[152:167]
  s_bitset1_b32 s34, s33
  v_cvt_pk_bf16_f32 v168, v136, v137
  v_cvt_pk_bf16_f32 v169, v138, v139
  v_cvt_pk_bf16_f32 v170, v140, v141
  v_cvt_pk_bf16_f32 v171, v142, v143
  v_exp_f32 v144, v144
  v_exp_f32 v145, v145
  v_exp_f32 v146, v146
  v_exp_f32 v147, v147
  v_mfma_f32_32x32x16_bf16 v[56:71], v[184:187], v[168:171], v[56:71]
  s_xor_b32 s33, s33, s24
  v_exp_f32 v148, v148
  v_exp_f32 v149, v149
  v_exp_f32 v150, v150
  v_exp_f32 v151, v151
  v_cvt_pk_bf16_f32 v172, v144, v145
  v_cvt_pk_bf16_f32 v173, v146, v147
  v_cvt_pk_bf16_f32 v174, v148, v149
  v_cvt_pk_bf16_f32 v175, v150, v151
  v_mfma_f32_32x32x16_bf16 v[136:151], v[176:179], v[40:43], 0
  s_lshl_b32 s33, s33, s25
  v_exp_f32 v152, v152
  v_exp_f32 v153, v153
  v_exp_f32 v154, v154
  v_mfma_f32_32x32x16_bf16 v[56:71], v[188:191], v[172:175], v[56:71]
  s_add_u32 s22, s20, s33
  v_exp_f32 v155, v155
  v_exp_f32 v156, v156
  v_exp_f32 v157, v157
  v_smfmac_f32_16x16x64_bf16 v[120:123], v[16:19], v[168:175], v20
  s_addc_u32 s23, s21, 0
  v_exp_f32 v158, v158
  v_exp_f32 v159, v159
  v_mfma_f32_32x32x16_bf16 v[136:151], v[180:183], v[44:47], v[136:151]
  v_cvt_pk_bf16_f32 v168, v152, v153
  v_cvt_pk_bf16_f32 v169, v154, v155
  v_cvt_pk_bf16_f32 v170, v156, v157
  v_cvt_pk_bf16_f32 v171, v158, v159
  v_exp_f32 v160, v160
  v_exp_f32 v161, v161
  v_exp_f32 v162, v162
  v_exp_f32 v163, v163
  v_mfma_f32_32x32x16_bf16 v[72:87], v[184:187], v[168:171], v[72:87]
  v_exp_f32 v164, v164
  v_exp_f32 v165, v165
  v_exp_f32 v166, v166
  v_exp_f32 v167, v167
  v_cvt_pk_bf16_f32 v172, v160, v161
  v_cvt_pk_bf16_f32 v173, v162, v163
  v_cvt_pk_bf16_f32 v174, v164, v165
  v_cvt_pk_bf16_f32 v175, v166, v167
  v_mfma_f32_32x32x16_bf16 v[152:167], v[176:179], v[48:51], 0
  v_exp_f32 v136, v136
  v_exp_f32 v137, v137
  v_exp_f32 v138, v138
  v_mfma_f32_32x32x16_bf16 v[72:87], v[188:191], v[172:175], v[72:87]
  v_exp_f32 v139, v139
  v_exp_f32 v140, v140
  v_exp_f32 v141, v141
  v_smfmac_f32_16x16x64_bf16 v[124:127], v[16:19], v[168:175], v20
  global_load_dwordx4 v[224:227], v3, s[22:23] offset:0
  global_load_dwordx4 v[228:231], v3, s[22:23] offset:1024
  global_load_dwordx4 v[232:235], v3, s[22:23] offset:2048
  global_load_dwordx4 v[236:239], v3, s[22:23] offset:3072
  v_exp_f32 v142, v142
  v_exp_f32 v143, v143
  v_mfma_f32_32x32x16_bf16 v[152:167], v[180:183], v[52:55], v[152:167]
  v_cvt_pk_bf16_f32 v168, v136, v137
  v_cvt_pk_bf16_f32 v169, v138, v139
  v_cvt_pk_bf16_f32 v170, v140, v141
  v_cvt_pk_bf16_f32 v171, v142, v143
  v_exp_f32 v144, v144
  v_exp_f32 v145, v145
  v_exp_f32 v146, v146
  v_exp_f32 v147, v147
  v_mfma_f32_32x32x16_bf16 v[88:103], v[184:187], v[168:171], v[88:103]
  s_waitcnt vmcnt(8)
  v_exp_f32 v148, v148
  v_exp_f32 v149, v149
  v_exp_f32 v150, v150
  v_exp_f32 v151, v151
  v_cvt_pk_bf16_f32 v172, v144, v145
  v_cvt_pk_bf16_f32 v173, v146, v147
  v_cvt_pk_bf16_f32 v174, v148, v149
  v_cvt_pk_bf16_f32 v175, v150, v151
  v_mfma_f32_32x32x16_bf16 v[136:151], v[192:195], v[24:27], 0
  v_exp_f32 v152, v152
  v_exp_f32 v153, v153
  v_exp_f32 v154, v154
  v_mfma_f32_32x32x16_bf16 v[88:103], v[188:191], v[172:175], v[88:103]
  v_exp_f32 v155, v155
  v_exp_f32 v156, v156
  v_exp_f32 v157, v157
  v_smfmac_f32_16x16x64_bf16 v[128:131], v[16:19], v[168:175], v20
  v_exp_f32 v158, v158
  v_exp_f32 v159, v159
  v_mfma_f32_32x32x16_bf16 v[136:151], v[196:199], v[28:31], v[136:151]
  v_cvt_pk_bf16_f32 v168, v152, v153
  v_cvt_pk_bf16_f32 v169, v154, v155
  v_cvt_pk_bf16_f32 v170, v156, v157
  v_cvt_pk_bf16_f32 v171, v158, v159
  v_exp_f32 v160, v160
  v_exp_f32 v161, v161
  v_exp_f32 v162, v162
  v_exp_f32 v163, v163
  v_mfma_f32_32x32x16_bf16 v[104:119], v[184:187], v[168:171], v[104:119]
  v_exp_f32 v164, v164
  v_exp_f32 v165, v165
  v_exp_f32 v166, v166
  v_exp_f32 v167, v167
  v_cvt_pk_bf16_f32 v172, v160, v161
  v_cvt_pk_bf16_f32 v173, v162, v163
  v_cvt_pk_bf16_f32 v174, v164, v165
  v_cvt_pk_bf16_f32 v175, v166, v167
.g2_kernel_a_n1:
  v_mfma_f32_32x32x16_bf16 v[152:167], v[192:195], v[32:35], 0
  s_andn2_b32 s33, s36, s34
  v_exp_f32 v136, v136
  v_exp_f32 v137, v137
  v_exp_f32 v138, v138
  v_mfma_f32_32x32x16_bf16 v[104:119], v[188:191], v[172:175], v[104:119]
  s_cbranch_scc0 .g2_kernel_a_N1c
.g2_kernel_a_N1b:
  v_exp_f32 v139, v139
  v_exp_f32 v140, v140
  v_exp_f32 v141, v141
  v_smfmac_f32_16x16x64_bf16 v[132:135], v[16:19], v[168:175], v20
  s_ff1_i32_b32 s33, s33
  v_exp_f32 v142, v142
  v_exp_f32 v143, v143
  v_mfma_f32_32x32x16_bf16 v[152:167], v[196:199], v[36:39], v[152:167]
  s_bitset1_b32 s34, s33
  v_cvt_pk_bf16_f32 v168, v136, v137
  v_cvt_pk_bf16_f32 v169, v138, v139
  v_cvt_pk_bf16_f32 v170, v140, v141
  v_cvt_pk_bf16_f32 v171, v142, v143
  v_exp_f32 v144, v144
  v_exp_f32 v145, v145
  v_exp_f32 v146, v146
  v_exp_f32 v147, v147
  v_mfma_f32_32x32x16_bf16 v[56:71], v[200:203], v[168:171], v[56:71]
  s_xor_b32 s33, s33, s24
  v_exp_f32 v148, v148
  v_exp_f32 v149, v149
  v_exp_f32 v150, v150
  v_exp_f32 v151, v151
  v_cvt_pk_bf16_f32 v172, v144, v145
  v_cvt_pk_bf16_f32 v173, v146, v147
  v_cvt_pk_bf16_f32 v174, v148, v149
  v_cvt_pk_bf16_f32 v175, v150, v151
  v_mfma_f32_32x32x16_bf16 v[136:151], v[192:195], v[40:43], 0
  s_lshl_b32 s33, s33, s25
  v_exp_f32 v152, v152
  v_exp_f32 v153, v153
  v_exp_f32 v154, v154
  v_mfma_f32_32x32x16_bf16 v[56:71], v[204:207], v[172:175], v[56:71]
  s_add_u32 s22, s20, s33
  v_exp_f32 v155, v155
  v_exp_f32 v156, v156
  v_exp_f32 v157, v157
  v_smfmac_f32_16x16x64_bf16 v[120:123], v[16:19], v[168:175], v20
  s_addc_u32 s23, s21, 0
  v_exp_f32 v158, v158
  v_exp_f32 v159, v159
  v_mfma_f32_32x32x16_bf16 v[136:151], v[196:199], v[44:47], v[136:151]
  v_cvt_pk_bf16_f32 v168, v152, v153
  v_cvt_pk_bf16_f32 v169, v154, v155
  v_cvt_pk_bf16_f32 v170, v156, v157
  v_cvt_pk_bf16_f32 v171, v158, v159
  v_exp_f32 v160, v160
  v_exp_f32 v161, v161
  v_exp_f32 v162, v162
  v_exp_f32 v163, v163
  v_mfma_f32_32x32x16_bf16 v[72:87], v[200:203], v[168:171], v[72:87]
  v_exp_f32 v164, v164
  v_exp_f32 v165, v165
  v_exp_f32 v166, v166
  v_exp_f32 v167, v167
  v_cvt_pk_bf16_f32 v172, v160, v161
  v_cvt_pk_bf16_f32 v173, v162, v163
  v_cvt_pk_bf16_f32 v174, v164, v165
  v_cvt_pk_bf16_f32 v175, v166, v167
  v_mfma_f32_32x32x16_bf16 v[152:167], v[192:195], v[48:51], 0
  v_exp_f32 v136, v136
  v_exp_f32 v137, v137
  v_exp_f32 v138, v138
  v_mfma_f32_32x32x16_bf16 v[72:87], v[204:207], v[172:175], v[72:87]
  v_exp_f32 v139, v139
  v_exp_f32 v140, v140
  v_exp_f32 v141, v141
  v_smfmac_f32_16x16x64_bf16 v[124:127], v[16:19], v[168:175], v20
  global_load_dwordx4 v[176:179], v3, s[22:23] offset:0
  global_load_dwordx4 v[180:183], v3, s[22:23] offset:1024
  global_load_dwordx4 v[184:187], v3, s[22:23] offset:2048
  global_load_dwordx4 v[188:191], v3, s[22:23] offset:3072
  v_exp_f32 v142, v142
  v_exp_f32 v143, v143
  v_mfma_f32_32x32x16_bf16 v[152:167], v[196:199], v[52:55], v[152:167]
  v_cvt_pk_bf16_f32 v168, v136, v137
  v_cvt_pk_bf16_f32 v169, v138, v139
  v_cvt_pk_bf16_f32 v170, v140, v141
  v_cvt_pk_bf16_f32 v171, v142, v143
  v_exp_f32 v144, v144
  v_exp_f32 v145, v145
  v_exp_f32 v146, v146
  v_exp_f32 v147, v147
  v_mfma_f32_32x32x16_bf16 v[88:103], v[200:203], v[168:171], v[88:103]
  s_waitcnt vmcnt(8)
  v_exp_f32 v148, v148
  v_exp_f32 v149, v149
  v_exp_f32 v150, v150
  v_exp_f32 v151, v151
  v_cvt_pk_bf16_f32 v172, v144, v145
  v_cvt_pk_bf16_f32 v173, v146, v147
  v_cvt_pk_bf16_f32 v174, v148, v149
  v_cvt_pk_bf16_f32 v175, v150, v151
  v_mfma_f32_32x32x16_bf16 v[136:151], v[208:211], v[24:27], 0
  v_exp_f32 v152, v152
  v_exp_f32 v153, v153
  v_exp_f32 v154, v154
  v_mfma_f32_32x32x16_bf16 v[88:103], v[204:207], v[172:175], v[88:103]
  v_exp_f32 v155, v155
  v_exp_f32 v156, v156
  v_exp_f32 v157, v157
  v_smfmac_f32_16x16x64_bf16 v[128:131], v[16:19], v[168:175], v20
  v_exp_f32 v158, v158
  v_exp_f32 v159, v159
  v_mfma_f32_32x32x16_bf16 v[136:151], v[212:215], v[28:31], v[136:151]
  v_cvt_pk_bf16_f32 v168, v152, v153
  v_cvt_pk_bf16_f32 v169, v154, v155
  v_cvt_pk_bf16_f32 v170, v156, v157
  v_cvt_pk_bf16_f32 v171, v158, v159
  v_exp_f32 v160, v160
  v_exp_f32 v161, v161
  v_exp_f32 v162, v162
  v_exp_f32 v163, v163
  v_mfma_f32_32x32x16_bf16 v[104:119], v[200:203], v[168:171], v[104:119]
  v_exp_f32 v164, v164
  v_exp_f32 v165, v165
  v_exp_f32 v166, v166
  v_exp_f32 v167, v167
  v_cvt_pk_bf16_f32 v172, v160, v161
  v_cvt_pk_bf16_f32 v173, v162, v163
  v_cvt_pk_bf16_f32 v174, v164, v165
  v_cvt_pk_bf16_f32 v175, v166, v167
  v_mfma_f32_32x32x16_bf16 v[152:167], v[208:211], v[32:35], 0
  s_andn2_b32 s33, s36, s34
  v_exp_f32 v136, v136
  v_exp_f32 v137, v137
  v_exp_f32 v138, v138
  v_mfma_f32_32x32x16_bf16 v[104:119], v[204:207], v[172:175], v[104:119]
  s_cbranch_scc0 .g2_kernel_a_N2c
.g2_kernel_a_N2b:
  v_exp_f32 v139, v139
  v_exp_f32 v140, v140
  v_exp_f32 v141, v141
  v_smfmac_f32_16x16x64_bf16 v[132:135], v[16:19], v[168:175], v20
  s_ff1_i32_b32 s33, s33
  v_exp_f32 v142, v142
  v_exp_f32 v143, v143
  v_mfma_f32_32x32x16_bf16 v[152:167], v[212:215], v[36:39], v[152:167]
  s_bitset1_b32 s34, s33
  v_cvt_pk_bf16_f32 v168, v136, v137
  v_cvt_pk_bf16_f32 v169, v138, v139
  v_cvt_pk_bf16_f32 v170, v140, v141
  v_cvt_pk_bf16_f32 v171, v142, v143
  v_exp_f32 v144, v144
  v_exp_f32 v145, v145
  v_exp_f32 v146, v146
  v_exp_f32 v147, v147
  v_mfma_f32_32x32x16_bf16 v[56:71], v[216:219], v[168:171], v[56:71]
  s_xor_b32 s33, s33, s24
  v_exp_f32 v148, v148
  v_exp_f32 v149, v149
  v_exp_f32 v150, v150
  v_exp_f32 v151, v151
  v_cvt_pk_bf16_f32 v172, v144, v145
  v_cvt_pk_bf16_f32 v173, v146, v147
  v_cvt_pk_bf16_f32 v174, v148, v149
  v_cvt_pk_bf16_f32 v175, v150, v151
  v_mfma_f32_32x32x16_bf16 v[136:151], v[208:211], v[40:43], 0
  s_lshl_b32 s33, s33, s25
  v_exp_f32 v152, v152
  v_exp_f32 v153, v153
  v_exp_f32 v154, v154
  v_mfma_f32_32x32x16_bf16 v[56:71], v[220:223], v[172:175], v[56:71]
  s_add_u32 s22, s20, s33
  v_exp_f32 v155, v155
  v_exp_f32 v156, v156
  v_exp_f32 v157, v157
  v_smfmac_f32_16x16x64_bf16 v[120:123], v[16:19], v[168:175], v20
  s_addc_u32 s23, s21, 0
  v_exp_f32 v158, v158
  v_exp_f32 v159, v159
  v_mfma_f32_32x32x16_bf16 v[136:151], v[212:215], v[44:47], v[136:151]
  v_cvt_pk_bf16_f32 v168, v152, v153
  v_cvt_pk_bf16_f32 v169, v154, v155
  v_cvt_pk_bf16_f32 v170, v156, v157
  v_cvt_pk_bf16_f32 v171, v158, v159
  v_exp_f32 v160, v160
  v_exp_f32 v161, v161
  v_exp_f32 v162, v162
  v_exp_f32 v163, v163
  v_mfma_f32_32x32x16_bf16 v[72:87], v[216:219], v[168:171], v[72:87]
  v_exp_f32 v164, v164
  v_exp_f32 v165, v165
  v_exp_f32 v166, v166
  v_exp_f32 v167, v167
  v_cvt_pk_bf16_f32 v172, v160, v161
  v_cvt_pk_bf16_f32 v173, v162, v163
  v_cvt_pk_bf16_f32 v174, v164, v165
  v_cvt_pk_bf16_f32 v175, v166, v167
  v_mfma_f32_32x32x16_bf16 v[152:167], v[208:211], v[48:51], 0
  v_exp_f32 v136, v136
  v_exp_f32 v137, v137
  v_exp_f32 v138, v138
  v_mfma_f32_32x32x16_bf16 v[72:87], v[220:223], v[172:175], v[72:87]
  v_exp_f32 v139, v139
  v_exp_f32 v140, v140
  v_exp_f32 v141, v141
  v_smfmac_f32_16x16x64_bf16 v[124:127], v[16:19], v[168:175], v20
  global_load_dwordx4 v[192:195], v3, s[22:23] offset:0
  global_load_dwordx4 v[196:199], v3, s[22:23] offset:1024
  global_load_dwordx4 v[200:203], v3, s[22:23] offset:2048
  global_load_dwordx4 v[204:207], v3, s[22:23] offset:3072
  v_exp_f32 v142, v142
  v_exp_f32 v143, v143
  v_mfma_f32_32x32x16_bf16 v[152:167], v[212:215], v[52:55], v[152:167]
  v_cvt_pk_bf16_f32 v168, v136, v137
  v_cvt_pk_bf16_f32 v169, v138, v139
  v_cvt_pk_bf16_f32 v170, v140, v141
  v_cvt_pk_bf16_f32 v171, v142, v143
  v_exp_f32 v144, v144
  v_exp_f32 v145, v145
  v_exp_f32 v146, v146
  v_exp_f32 v147, v147
  v_mfma_f32_32x32x16_bf16 v[88:103], v[216:219], v[168:171], v[88:103]
  s_waitcnt vmcnt(8)
  v_exp_f32 v148, v148
  v_exp_f32 v149, v149
  v_exp_f32 v150, v150
  v_exp_f32 v151, v151
  v_cvt_pk_bf16_f32 v172, v144, v145
  v_cvt_pk_bf16_f32 v173, v146, v147
  v_cvt_pk_bf16_f32 v174, v148, v149
  v_cvt_pk_bf16_f32 v175, v150, v151
  v_mfma_f32_32x32x16_bf16 v[136:151], v[224:227], v[24:27], 0
  v_exp_f32 v152, v152
  v_exp_f32 v153, v153
  v_exp_f32 v154, v154
  v_mfma_f32_32x32x16_bf16 v[88:103], v[220:223], v[172:175], v[88:103]
  v_exp_f32 v155, v155
  v_exp_f32 v156, v156
  v_exp_f32 v157, v157
  v_smfmac_f32_16x16x64_bf16 v[128:131], v[16:19], v[168:175], v20
  v_exp_f32 v158, v158
  v_exp_f32 v159, v159
  v_mfma_f32_32x32x16_bf16 v[136:151], v[228:231], v[28:31], v[136:151]
  s_and_b32 s28, s32, 3
  v_cvt_pk_bf16_f32 v168, v152, v153
  v_cvt_pk_bf16_f32 v169, v154, v155
  v_cvt_pk_bf16_f32 v170, v156, v157
  v_cvt_pk_bf16_f32 v171, v158, v159
  v_exp_f32 v160, v160
  v_exp_f32 v161, v161
  v_exp_f32 v162, v162
  v_exp_f32 v163, v163
  v_mfma_f32_32x32x16_bf16 v[104:119], v[216:219], v[168:171], v[104:119]
  s_cmp_eq_u32 s28, 3
  v_exp_f32 v164, v164
  v_exp_f32 v165, v165
  v_exp_f32 v166, v166
  v_exp_f32 v167, v167
  v_cvt_pk_bf16_f32 v172, v160, v161
  v_cvt_pk_bf16_f32 v173, v162, v163
  v_cvt_pk_bf16_f32 v174, v164, v165
  v_cvt_pk_bf16_f32 v175, v166, v167
  s_cbranch_scc1 .g2_kernel_a_last
  v_mfma_f32_32x32x16_bf16 v[152:167], v[224:227], v[32:35], 0
  s_andn2_b32 s33, s36, s34
  v_exp_f32 v136, v136
  v_exp_f32 v137, v137
  v_exp_f32 v138, v138
  v_mfma_f32_32x32x16_bf16 v[104:119], v[220:223], v[172:175], v[104:119]
  s_cbranch_scc0 .g2_kernel_a_N3c
.g2_kernel_a_N3b:
  v_exp_f32 v139, v139
  v_exp_f32 v140, v140
  v_exp_f32 v141, v141
  v_smfmac_f32_16x16x64_bf16 v[132:135], v[16:19], v[168:175], v20
  s_ff1_i32_b32 s33, s33
  v_exp_f32 v142, v142
  v_exp_f32 v143, v143
  v_mfma_f32_32x32x16_bf16 v[152:167], v[228:231], v[36:39], v[152:167]
  s_bitset1_b32 s34, s33
  v_cvt_pk_bf16_f32 v168, v136, v137
  v_cvt_pk_bf16_f32 v169, v138, v139
  v_cvt_pk_bf16_f32 v170, v140, v141
  v_cvt_pk_bf16_f32 v171, v142, v143
  v_exp_f32 v144, v144
  v_exp_f32 v145, v145
  v_exp_f32 v146, v146
  v_exp_f32 v147, v147
  v_mfma_f32_32x32x16_bf16 v[56:71], v[232:235], v[168:171], v[56:71]
  s_xor_b32 s33, s33, s24
  v_exp_f32 v148, v148
  v_exp_f32 v149, v149
  v_exp_f32 v150, v150
  v_exp_f32 v151, v151
  v_cvt_pk_bf16_f32 v172, v144, v145
  v_cvt_pk_bf16_f32 v173, v146, v147
  v_cvt_pk_bf16_f32 v174, v148, v149
  v_cvt_pk_bf16_f32 v175, v150, v151
  v_mfma_f32_32x32x16_bf16 v[136:151], v[224:227], v[40:43], 0
  s_lshl_b32 s33, s33, s25
  v_exp_f32 v152, v152
  v_exp_f32 v153, v153
  v_exp_f32 v154, v154
  v_mfma_f32_32x32x16_bf16 v[56:71], v[236:239], v[172:175], v[56:71]
  s_add_u32 s22, s20, s33
  v_exp_f32 v155, v155
  v_exp_f32 v156, v156
  v_exp_f32 v157, v157
  v_smfmac_f32_16x16x64_bf16 v[120:123], v[16:19], v[168:175], v20
  s_addc_u32 s23, s21, 0
  v_exp_f32 v158, v158
  v_exp_f32 v159, v159
  v_mfma_f32_32x32x16_bf16 v[136:151], v[228:231], v[44:47], v[136:151]
  v_cvt_pk_bf16_f32 v168, v152, v153
  v_cvt_pk_bf16_f32 v169, v154, v155
  v_cvt_pk_bf16_f32 v170, v156, v157
  v_cvt_pk_bf16_f32 v171, v158, v159
  v_exp_f32 v160, v160
  v_exp_f32 v161, v161
  v_exp_f32 v162, v162
  v_exp_f32 v163, v163
  v_mfma_f32_32x32x16_bf16 v[72:87], v[232:235], v[168:171], v[72:87]
  v_exp_f32 v164, v164
  v_exp_f32 v165, v165
  v_exp_f32 v166, v166
  v_exp_f32 v167, v167
  v_cvt_pk_bf16_f32 v172, v160, v161
  v_cvt_pk_bf16_f32 v173, v162, v163
  v_cvt_pk_bf16_f32 v174, v164, v165
  v_cvt_pk_bf16_f32 v175, v166, v167
  v_mfma_f32_32x32x16_bf16 v[152:167], v[224:227], v[48:51], 0
  v_exp_f32 v136, v136
  v_exp_f32 v137, v137
  v_exp_f32 v138, v138
  v_mfma_f32_32x32x16_bf16 v[72:87], v[236:239], v[172:175], v[72:87]
  v_exp_f32 v139, v139
  v_exp_f32 v140, v140
  v_exp_f32 v141, v141
  v_smfmac_f32_16x16x64_bf16 v[124:127], v[16:19], v[168:175], v20
  global_load_dwordx4 v[208:211], v3, s[22:23] offset:0
  global_load_dwordx4 v[212:215], v3, s[22:23] offset:1024
  global_load_dwordx4 v[216:219], v3, s[22:23] offset:2048
  global_load_dwordx4 v[220:223], v3, s[22:23] offset:3072
  v_exp_f32 v142, v142
  v_exp_f32 v143, v143
  v_mfma_f32_32x32x16_bf16 v[152:167], v[228:231], v[52:55], v[152:167]
  v_cvt_pk_bf16_f32 v168, v136, v137
  v_cvt_pk_bf16_f32 v169, v138, v139
  v_cvt_pk_bf16_f32 v170, v140, v141
  v_cvt_pk_bf16_f32 v171, v142, v143
  v_exp_f32 v144, v144
  v_exp_f32 v145, v145
  v_exp_f32 v146, v146
  v_exp_f32 v147, v147
  v_mfma_f32_32x32x16_bf16 v[88:103], v[232:235], v[168:171], v[88:103]
  s_waitcnt vmcnt(8)
  v_exp_f32 v148, v148
  v_exp_f32 v149, v149
  v_exp_f32 v150, v150
  v_exp_f32 v151, v151
  v_cvt_pk_bf16_f32 v172, v144, v145
  v_cvt_pk_bf16_f32 v173, v146, v147
  v_cvt_pk_bf16_f32 v174, v148, v149
  v_cvt_pk_bf16_f32 v175, v150, v151
  v_mfma_f32_32x32x16_bf16 v[136:151], v[176:179], v[24:27], 0
  v_exp_f32 v152, v152
  v_exp_f32 v153, v153
  v_exp_f32 v154, v154
  v_mfma_f32_32x32x16_bf16 v[88:103], v[236:239], v[172:175], v[88:103]
  v_exp_f32 v155, v155
  v_exp_f32 v156, v156
  v_exp_f32 v157, v157
  v_smfmac_f32_16x16x64_bf16 v[128:131], v[16:19], v[168:175], v20
  v_exp_f32 v158, v158
  v_exp_f32 v159, v159
  v_mfma_f32_32x32x16_bf16 v[136:151], v[180:183], v[28:31], v[136:151]
  s_add_u32 s32, s32, 1
  v_cvt_pk_bf16_f32 v168, v152, v153
  v_cvt_pk_bf16_f32 v169, v154, v155
  v_cvt_pk_bf16_f32 v170, v156, v157
  v_cvt_pk_bf16_f32 v171, v158, v159
  v_exp_f32 v160, v160
  v_exp_f32 v161, v161
  v_exp_f32 v162, v162
  v_exp_f32 v163, v163
  v_mfma_f32_32x32x16_bf16 v[104:119], v[232:235], v[168:171], v[104:119]
  s_cmp_eq_u32 s35, 0
  v_exp_f32 v164, v164
  v_exp_f32 v165, v165
  v_exp_f32 v166, v166
  v_exp_f32 v167, v167
  v_cvt_pk_bf16_f32 v172, v160, v161
  v_cvt_pk_bf16_f32 v173, v162, v163
  v_cvt_pk_bf16_f32 v174, v164, v165
  v_cvt_pk_bf16_f32 v175, v166, v167
  s_cbranch_scc1 .g2_kernel_a_loop
  s_branch .g2_kernel_a_redo
.g2_kernel_a_last:
  v_mfma_f32_32x32x16_bf16 v[152:167], v[224:227], v[32:35], 0
  ds_read_b32 v21, v13 offset:8
  s_andn2_b32 s33, s36, s34
  v_exp_f32 v136, v136
  v_exp_f32 v137, v137
  v_exp_f32 v138, v138
  v_mfma_f32_32x32x16_bf16 v[104:119], v[220:223], v[172:175], v[104:119]
  s_cbranch_scc0 .g2_kernel_a_L3c
.g2_kernel_a_L3b:
  v_exp_f32 v139, v139
  v_exp_f32 v140, v140
  v_exp_f32 v141, v141
  v_smfmac_f32_16x16x64_bf16 v[132:135], v[16:19], v[168:175], v20
  s_ff1_i32_b32 s33, s33
  v_exp_f32 v142, v142
  v_exp_f32 v143, v143
  v_mfma_f32_32x32x16_bf16 v[152:167], v[228:231], v[36:39], v[152:167]
  s_bitset1_b32 s34, s33
  ds_read_b128 v[24:27], v14 offset:0
  v_cvt_pk_bf16_f32 v168, v136, v137
  v_cvt_pk_bf16_f32 v169, v138, v139
  v_cvt_pk_bf16_f32 v170, v140, v141
  v_cvt_pk_bf16_f32 v171, v142, v143
  v_exp_f32 v144, v144
  v_exp_f32 v145, v145
  v_exp_f32 v146, v146
  v_exp_f32 v147, v147
  v_mfma_f32_32x32x16_bf16 v[56:71], v[232:235], v[168:171], v[56:71]
  s_xor_b32 s33, s33, s24
  ds_read_b128 v[28:31], v14 offset:1024
  v_exp_f32 v148, v148
  v_exp_f32 v149, v149
  v_exp_f32 v150, v150
  v_exp_f32 v151, v151
  v_cvt_pk_bf16_f32 v172, v144, v145
  v_cvt_pk_bf16_f32 v173, v146, v147
  v_cvt_pk_bf16_f32 v174, v148, v149
  v_cvt_pk_bf16_f32 v175, v150, v151
  v_mfma_f32_32x32x16_bf16 v[136:151], v[224:227], v[40:43], 0
  s_waitcnt lgkmcnt(2)
  s_lshl_b32 s33, s33, s25
  v_exp_f32 v152, v152
  v_exp_f32 v153, v153
  v_exp_f32 v154, v154
  v_mfma_f32_32x32x16_bf16 v[56:71], v[236:239], v[172:175], v[56:71]
  v_cmp_gt_u32 vcc, s27, v21
  s_add_u32 s22, s20, s33
  v_exp_f32 v155, v155
  v_exp_f32 v156, v156
  v_exp_f32 v157, v157
  v_smfmac_f32_16x16x64_bf16 v[120:123], v[16:19], v[168:175], v20
  s_addc_u32 s23, s21, 0
  v_exp_f32 v158, v158
  v_exp_f32 v159, v159
  v_mfma_f32_32x32x16_bf16 v[136:151], v[228:231], v[44:47], v[136:151]
  v_cvt_pk_bf16_f32 v168, v152, v153
  v_cvt_pk_bf16_f32 v169, v154, v155
  v_cvt_pk_bf16_f32 v170, v156, v157
  v_cvt_pk_bf16_f32 v171, v158, v159
  v_exp_f32 v160, v160
  v_exp_f32 v161, v161
  v_exp_f32 v162, v162
  v_exp_f32 v163, v163
  v_mfma_f32_32x32x16_bf16 v[72:87], v[232:235], v[168:171], v[72:87]
  s_cbranch_vccnz .g2_kernel_a_L3g
.g2_kernel_a_L3h:
  ds_read_b128 v[32:35], v14 offset:2048
  ds_read_b128 v[36:39], v14 offset:3072
  v_cvt_pk_bf16_f32 v56, v56, v57
  v_cvt_pk_bf16_f32 v57, v58, v59
  v_cvt_pk_bf16_f32 v58, v60, v61
  v_cvt_pk_bf16_f32 v59, v62, v63
  v_add_f32 v6, v120, v121
  v_exp_f32 v164, v164
  v_exp_f32 v165, v165
  v_exp_f32 v166, v166
  v_exp_f32 v167, v167
  v_cvt_pk_bf16_f32 v172, v160, v161
  v_cvt_pk_bf16_f32 v173, v162, v163
  v_cvt_pk_bf16_f32 v174, v164, v165
  v_cvt_pk_bf16_f32 v175, v166, v167
  v_mfma_f32_32x32x16_bf16 v[152:167], v[224:227], v[48:51], 0
  ds_write_b128 v9, v[56:59] offset:0
  v_cvt_pk_bf16_f32 v60, v64, v65
  v_cvt_pk_bf16_f32 v61, v66, v67
  v_cvt_pk_bf16_f32 v62, v68, v69
  v_cvt_pk_bf16_f32 v63, v70, v71
  v_exp_f32 v136, v136
  v_exp_f32 v137, v137
  v_exp_f32 v138, v138
  v_mfma_f32_32x32x16_bf16 v[72:87], v[236:239], v[172:175], v[72:87]
  ds_write_b128 v9, v[60:63] offset:1024
  v_mov_b32 v120, 0
  v_mov_b32 v121, 0
  v_exp_f32 v139, v139
  v_exp_f32 v140, v140
  v_exp_f32 v141, v141
  v_smfmac_f32_16x16x64_bf16 v[124:127], v[16:19], v[168:175], v20
  global_load_dwordx4 v[208:211], v3, s[22:23] offset:0
  global_load_dwordx4 v[212:215], v3, s[22:23] offset:1024
  global_load_dwordx4 v[216:219], v3, s[22:23] offset:2048
  global_load_dwordx4 v[220:223], v3, s[22:23] offset:3072
  ds_write_b32 v10, v6 offset:0
  ds_write_b32 v11, v12 offset:0
  v_exp_f32 v142, v142
  v_exp_f32 v143, v143
  v_mfma_f32_32x32x16_bf16 v[152:167], v[228:231], v[52:55], v[152:167]
  ds_read_b128 v[40:43], v14 offset:4096
  s_wakeup
  v_cvt_pk_bf16_f32 v168, v136, v137
  v_cvt_pk_bf16_f32 v169, v138, v139
  v_cvt_pk_bf16_f32 v170, v140, v141
  v_cvt_pk_bf16_f32 v171, v142, v143
  v_exp_f32 v144, v144
  v_exp_f32 v145, v145
  v_exp_f32 v146, v146
  v_exp_f32 v147, v147
  v_mfma_f32_32x32x16_bf16 v[88:103], v[232:235], v[168:171], v[88:103]
  s_waitcnt vmcnt(8)
  ds_read_b128 v[44:47], v14 offset:5120
  v_cvt_pk_bf16_f32 v72, v72, v73
  v_cvt_pk_bf16_f32 v73, v74, v75
  v_cvt_pk_bf16_f32 v74, v76, v77
  v_cvt_pk_bf16_f32 v75, v78, v79
  v_add_f32 v6, v124, v125
  v_exp_f32 v148, v148
  v_exp_f32 v149, v149
  v_exp_f32 v150, v150
  v_exp_f32 v151, v151
  v_cvt_pk_bf16_f32 v172, v144, v145
  v_cvt_pk_bf16_f32 v173, v146, v147
  v_cvt_pk_bf16_f32 v174, v148, v149
  v_cvt_pk_bf16_f32 v175, v150, v151
  s_waitcnt lgkmcnt(8)
  v_mfma_f32_32x32x16_bf16 v[136:151], v[176:179], v[24:27], 0
  ds_write_b128 v9, v[72:75] offset:8192
  v_cvt_pk_bf16_f32 v76, v80, v81
  v_cvt_pk_bf16_f32 v77, v82, v83
  v_cvt_pk_bf16_f32 v78, v84, v85
  v_cvt_pk_bf16_f32 v79, v86, v87
  v_exp_f32 v152, v152
  v_exp_f32 v153, v153
  v_exp_f32 v154, v154
  v_mfma_f32_32x32x16_bf16 v[88:103], v[236:239], v[172:175], v[88:103]
  ds_write_b128 v9, v[76:79] offset:9216
  v_mov_b32 v124, 0
  v_mov_b32 v125, 0
  v_exp_f32 v155, v155
  v_exp_f32 v156, v156
  v_exp_f32 v157, v157
  v_smfmac_f32_16x16x64_bf16 v[128:131], v[16:19], v[168:175], v20
  ds_write_b32 v10, v6 offset:512
  ds_write_b32 v11, v12 offset:16
  v_exp_f32 v158, v158
  v_exp_f32 v159, v159
  v_mfma_f32_32x32x16_bf16 v[136:151], v[180:183], v[28:31], v[136:151]
  ds_read_b128 v[48:51], v14 offset:6144
  s_wakeup
  v_cvt_pk_bf16_f32 v168, v152, v153
  v_cvt_pk_bf16_f32 v169, v154, v155
  v_cvt_pk_bf16_f32 v170, v156, v157
  v_cvt_pk_bf16_f32 v171, v158, v159
  v_exp_f32 v160, v160
  v_exp_f32 v161, v161
  v_exp_f32 v162, v162
  v_exp_f32 v163, v163
  v_mfma_f32_32x32x16_bf16 v[104:119], v[232:235], v[168:171], v[104:119]
  ds_read_b128 v[52:55], v14 offset:7168
  v_cvt_pk_bf16_f32 v88, v88, v89
  v_cvt_pk_bf16_f32 v89, v90, v91
  v_cvt_pk_bf16_f32 v90, v92, v93
  v_cvt_pk_bf16_f32 v91, v94, v95
  v_add_f32 v6, v128, v129
  ds_write_b128 v9, v[88:91] offset:16384
  v_cvt_pk_bf16_f32 v92, v96, v97
  v_cvt_pk_bf16_f32 v93, v98, v99
  v_cvt_pk_bf16_f32 v94, v100, v101
  v_cvt_pk_bf16_f32 v95, v102, v103
  ds_write_b128 v9, v[92:95] offset:17408
  v_mov_b32 v128, 0
  v_mov_b32 v129, 0
  ds_write_b32 v10, v6 offset:1024
  ds_write_b32 v11, v12 offset:32
  s_add_u32 s32, s32, 1
  v_exp_f32 v164, v164
  v_exp_f32 v165, v165
  v_exp_f32 v166, v166
  v_exp_f32 v167, v167
  v_cvt_pk_bf16_f32 v172, v160, v161
  v_cvt_pk_bf16_f32 v173, v162, v163
  v_cvt_pk_bf16_f32 v174, v164, v165
  v_cvt_pk_bf16_f32 v175, v166, v167
  s_cmp_eq_u32 s32, 8
  s_cbranch_scc1 .g2_kernel_a_end
  s_waitcnt lgkmcnt(15)
  v_mfma_f32_32x32x16_bf16 v[152:167], v[176:179], v[32:35], 0
  s_andn2_b32 s33, s36, s34
  v_exp_f32 v136, v136
  v_exp_f32 v137, v137
  v_exp_f32 v138, v138
  v_mfma_f32_32x32x16_bf16 v[104:119], v[236:239], v[172:175], v[104:119]
  s_cbranch_scc0 .g2_kernel_a_G0c
.g2_kernel_a_G0b:
  v_exp_f32 v139, v139
  v_exp_f32 v140, v140
  v_exp_f32 v141, v141
  v_smfmac_f32_16x16x64_bf16 v[132:135], v[16:19], v[168:175], v20
  s_ff1_i32_b32 s33, s33
  v_exp_f32 v142, v142
  v_exp_f32 v143, v143
  v_mfma_f32_32x32x16_bf16 v[152:167], v[180:183], v[36:39], v[152:167]
  s_bitset1_b32 s34, s33
  v_cvt_pk_bf16_f32 v168, v136, v137
  v_cvt_pk_bf16_f32 v169, v138, v139
  v_cvt_pk_bf16_f32 v170, v140, v141
  v_cvt_pk_bf16_f32 v171, v142, v143
  v_exp_f32 v144, v144
  v_exp_f32 v145, v145
  v_exp_f32 v146, v146
  v_exp_f32 v147, v147
  s_waitcnt lgkmcnt(14)
  v_mfma_f32_32x32x16_bf16 v[56:71], v[184:187], v[168:171], 0
  s_xor_b32 s33, s33, s24
  v_cvt_pk_bf16_f32 v104, v104, v105
  v_cvt_pk_bf16_f32 v105, v106, v107
  v_cvt_pk_bf16_f32 v106, v108, v109
  v_cvt_pk_bf16_f32 v107, v110, v111
  v_add_f32 v6, v132, v133
  v_exp_f32 v148, v148
  v_exp_f32 v149, v149
  v_exp_f32 v150, v150
  v_exp_f32 v151, v151
  v_cvt_pk_bf16_f32 v172, v144, v145
  v_cvt_pk_bf16_f32 v173, v146, v147
  v_cvt_pk_bf16_f32 v174, v148, v149
  v_cvt_pk_bf16_f32 v175, v150, v151
  s_waitcnt lgkmcnt(10)
  v_mfma_f32_32x32x16_bf16 v[136:151], v[176:179], v[40:43], 0
  s_lshl_b32 s33, s33, s25
  ds_write_b128 v9, v[104:107] offset:24576
  v_cvt_pk_bf16_f32 v108, v112, v113
  v_cvt_pk_bf16_f32 v109, v114, v115
  v_cvt_pk_bf16_f32 v110, v116, v117
  v_cvt_pk_bf16_f32 v111, v118, v119
  v_exp_f32 v152, v152
  v_exp_f32 v153, v153
  v_exp_f32 v154, v154
  v_mfma_f32_32x32x16_bf16 v[56:71], v[188:191], v[172:175], v[56:71]
  s_add_u32 s22, s20, s33
  ds_write_b128 v9, v[108:111] offset:25600
  v_mov_b32 v132, 0
  v_mov_b32 v133, 0
  v_exp_f32 v155, v155
  v_exp_f32 v156, v156
  v_exp_f32 v157, v157
  v_smfmac_f32_16x16x64_bf16 v[120:123], v[16:19], v[168:175], v20
  s_addc_u32 s23, s21, 0
  ds_write_b32 v10, v6 offset:1536
  v_exp_f32 v158, v158
  v_exp_f32 v159, v159
  v_mfma_f32_32x32x16_bf16 v[136:151], v[180:183], v[44:47], v[136:151]
  v_cvt_pk_bf16_f32 v168, v152, v153
  v_cvt_pk_bf16_f32 v169, v154, v155
  v_cvt_pk_bf16_f32 v170, v156, v157
  v_cvt_pk_bf16_f32 v171, v158, v159
  v_exp_f32 v160, v160
  v_exp_f32 v161, v161
  v_exp_f32 v162, v162
  v_exp_f32 v163, v163
  s_waitcnt lgkmcnt(11)
  v_mfma_f32_32x32x16_bf16 v[72:87], v[184:187], v[168:171], 0
  ds_write_b32 v11, v12 offset:48
  v_exp_f32 v164, v164
  v_exp_f32 v165, v165
  v_exp_f32 v166, v166
  v_exp_f32 v167, v167
  v_cvt_pk_bf16_f32 v172, v160, v161
  v_cvt_pk_bf16_f32 v173, v162, v163
  v_cvt_pk_bf16_f32 v174, v164, v165
  v_cvt_pk_bf16_f32 v175, v166, v167
  s_waitcnt lgkmcnt(8)
  v_mfma_f32_32x32x16_bf16 v[152:167], v[176:179], v[48:51], 0
  v_add_u32 v12, 1, v12
  v_exp_f32 v136, v136
  v_exp_f32 v137, v137
  v_exp_f32 v138, v138
  v_mfma_f32_32x32x16_bf16 v[72:87], v[188:191], v[172:175], v[72:87]
  v_exp_f32 v139, v139
  v_exp_f32 v140, v140
  v_exp_f32 v141, v141
  v_smfmac_f32_16x16x64_bf16 v[124:127], v[16:19], v[168:175], v20
  global_load_dwordx4 v[224:227], v3, s[22:23] offset:0
  global_load_dwordx4 v[228:231], v3, s[22:23] offset:1024
  global_load_dwordx4 v[232:235], v3, s[22:23] offset:2048
  global_load_dwordx4 v[236:239], v3, s[22:23] offset:3072
  s_add_u32 s27, s27, 4
  v_exp_f32 v142, v142
  v_exp_f32 v143, v143
  v_mfma_f32_32x32x16_bf16 v[152:167], v[180:183], v[52:55], v[152:167]
  v_cvt_pk_bf16_f32 v168, v136, v137
  v_cvt_pk_bf16_f32 v169, v138, v139
  v_cvt_pk_bf16_f32 v170, v140, v141
  v_cvt_pk_bf16_f32 v171, v142, v143
  v_exp_f32 v144, v144
  v_exp_f32 v145, v145
  v_exp_f32 v146, v146
  v_exp_f32 v147, v147
  s_waitcnt lgkmcnt(6)
  v_mfma_f32_32x32x16_bf16 v[88:103], v[184:187], v[168:171], 0
  s_waitcnt vmcnt(8)
  v_exp_f32 v148, v148
  v_exp_f32 v149, v149
  v_exp_f32 v150, v150
  v_exp_f32 v151, v151
  v_cvt_pk_bf16_f32 v172, v144, v145
  v_cvt_pk_bf16_f32 v173, v146, v147
  v_cvt_pk_bf16_f32 v174, v148, v149
  v_cvt_pk_bf16_f32 v175, v150, v151
  v_mfma_f32_32x32x16_bf16 v[136:151], v[192:195], v[24:27], 0
  v_exp_f32 v152, v152
  v_exp_f32 v153, v153
  v_exp_f32 v154, v154
  v_mfma_f32_32x32x16_bf16 v[88:103], v[188:191], v[172:175], v[88:103]
  v_exp_f32 v155, v155
  v_exp_f32 v156, v156
  v_exp_f32 v157, v157
  v_smfmac_f32_16x16x64_bf16 v[128:131], v[16:19], v[168:175], v20
  v_exp_f32 v158, v158
  v_exp_f32 v159, v159
  v_mfma_f32_32x32x16_bf16 v[136:151], v[196:199], v[28:31], v[136:151]
  v_cvt_pk_bf16_f32 v168, v152, v153
  v_cvt_pk_bf16_f32 v169, v154, v155
  v_cvt_pk_bf16_f32 v170, v156, v157
  v_cvt_pk_bf16_f32 v171, v158, v159
  v_exp_f32 v160, v160
  v_exp_f32 v161, v161
  v_exp_f32 v162, v162
  v_exp_f32 v163, v163
  s_waitcnt lgkmcnt(2)
  v_mfma_f32_32x32x16_bf16 v[104:119], v[184:187], v[168:171], 0
  v_exp_f32 v164, v164
  v_exp_f32 v165, v165
  v_exp_f32 v166, v166
  v_exp_f32 v167, v167
  v_cvt_pk_bf16_f32 v172, v160, v161
  v_cvt_pk_bf16_f32 v173, v162, v163
  v_cvt_pk_bf16_f32 v174, v164, v165
  v_cvt_pk_bf16_f32 v175, v166, v167
  s_branch .g2_kernel_a_n1
.g2_kernel_a_end:
  v_mfma_f32_32x32x16_bf16 v[104:119], v[236:239], v[172:175], v[104:119]
  v_smfmac_f32_16x16x64_bf16 v[132:135], v[16:19], v[168:175], v20
  s_wakeup
  s_nop 9
  v_cvt_pk_bf16_f32 v104, v104, v105
  v_cvt_pk_bf16_f32 v105, v106, v107
  v_cvt_pk_bf16_f32 v106, v108, v109
  v_cvt_pk_bf16_f32 v107, v110, v111
  v_add_f32 v6, v132, v133
  ds_write_b128 v9, v[104:107] offset:24576
  v_cvt_pk_bf16_f32 v108, v112, v113
  v_cvt_pk_bf16_f32 v109, v114, v115
  v_cvt_pk_bf16_f32 v110, v116, v117
  v_cvt_pk_bf16_f32 v111, v118, v119
  ds_write_b128 v9, v[108:111] offset:25600
  v_mov_b32 v132, 0
  v_mov_b32 v133, 0
  ds_write_b32 v10, v6 offset:1536
  ds_write_b32 v11, v12 offset:48
  s_waitcnt lgkmcnt(4)
  v_mov_b32 v20, s71
  v_lshrrev_b32 v17, 5, v2
  v_and_b32 v18, 31, v2
  s_lshl_b32 s28, s16, 5
  v_add_u32 v19, s28, v18
  v_lshlrev_b32 v7, 2, v19
  v_add_u32 v7, 155648, v7
  ds_read_b32 v8, v7 offset:3840
  ds_read_b32 v9, v7 offset:4352
  ds_read_b32 v16, v20 offset:24
  ds_read_b32 v6, v20 offset:52
  v_add_u32 v19, 1, v19
  v_bfe_u32 v7, v2, 2, 2
  v_lshl_add_u32 v14, v17, 2, v7
  v_lshlrev_b32 v14, 7, v14
  v_lshrrev_b32 v7, 1, v7
  v_lshl_add_u32 v14, v7, 6, v14
  v_bfe_u32 v7, v2, 4, 1
  v_lshl_add_u32 v14, v7, 5, v14
  v_and_b32 v7, 1, v2
  v_lshl_add_u32 v14, v7, 4, v14
  v_bfe_u32 v7, v2, 1, 1
  v_lshl_add_u32 v14, v7, 3, v14
  v_xor_b32 v15, 64, v14
  v_and_b32 v7, 7, v2
  v_xor_b32 v7, s24, v7
  s_mov_b32 s28, 192
  s_add_u32 s28, s28, 157952
  v_lshl_add_u32 v21, v7, 3, s28
  v_lshlrev_b32 v24, 16, v240
  v_and_b32 v25, 0xffff0000, v240
  v_lshlrev_b32 v26, 16, v241
  v_and_b32 v27, 0xffff0000, v241
  v_lshlrev_b32 v28, 16, v242
  v_and_b32 v29, 0xffff0000, v242
  v_lshlrev_b32 v30, 16, v243
  v_and_b32 v31, 0xffff0000, v243
  v_lshlrev_b32 v32, 16, v244
  v_and_b32 v33, 0xffff0000, v244
  v_lshlrev_b32 v34, 16, v245
  v_and_b32 v35, 0xffff0000, v245
  v_lshlrev_b32 v36, 16, v246
  v_and_b32 v37, 0xffff0000, v246
  v_lshlrev_b32 v38, 16, v247
  v_and_b32 v39, 0xffff0000, v247
  v_lshlrev_b32 v40, 16, v248
  v_and_b32 v41, 0xffff0000, v248
  v_lshlrev_b32 v42, 16, v249
  v_and_b32 v43, 0xffff0000, v249
  v_lshlrev_b32 v44, 16, v250
  v_and_b32 v45, 0xffff0000, v250
  v_lshlrev_b32 v46, 16, v251
  v_and_b32 v47, 0xffff0000, v251
  v_lshlrev_b32 v48, 16, v252
  v_and_b32 v49, 0xffff0000, v252
  v_lshlrev_b32 v50, 16, v253
  v_and_b32 v51, 0xffff0000, v253
  v_lshlrev_b32 v52, 16, v254
  v_and_b32 v53, 0xffff0000, v254
  v_lshlrev_b32 v54, 16, v255
  v_and_b32 v55, 0xffff0000, v255
  s_waitcnt lgkmcnt(0)
  v_cmp_gt_u32 vcc, 4, v6
  s_cbranch_vccnz .g2_kernel_w_aw
.g2_kernel_w_ab:
  s_xor_b32 s28, s24, 0
  s_lshl_b32 s28, s28, 13
  s_add_u32 s28, s28, 65536
  v_add_u32 v10, s28, v14
  v_add_u32 v11, s28, v15
  ds_read_b64_tr_b16 v[104:105], v10 offset:0
  ds_read_b64_tr_b16 v[106:107], v10 offset:1024
  ds_read_b64_tr_b16 v[108:109], v11 offset:0
  ds_read_b64_tr_b16 v[110:111], v11 offset:1024
  ds_read_b64_tr_b16 v[112:113], v10 offset:2048
  ds_read_b64_tr_b16 v[114:115], v10 offset:3072
  ds_read_b64_tr_b16 v[116:117], v11 offset:2048
  ds_read_b64_tr_b16 v[118:119], v11 offset:3072
  ds_read_b64_tr_b16 v[120:121], v10 offset:4096
  ds_read_b64_tr_b16 v[122:123], v10 offset:5120
  ds_read_b64_tr_b16 v[124:125], v11 offset:4096
  ds_read_b64_tr_b16 v[126:127], v11 offset:5120
  s_andn2_b32 s33, s36, s34
  s_ff1_i32_b32 s33, s33
  s_bitset1_b32 s34, s33
  s_xor_b32 s33, s33, s24
  s_lshl_b32 s33, s33, 12
  s_add_u32 s22, s20, s33
  s_addc_u32 s23, s21, 0
  global_load_dwordx4 v[224:227], v3, s[22:23] offset:0
  global_load_dwordx4 v[228:231], v3, s[22:23] offset:1024
  global_load_dwordx4 v[232:235], v3, s[22:23] offset:2048
  global_load_dwordx4 v[236:239], v3, s[22:23] offset:3072
  v_pk_fma_f32 v[24:25], v[24:25], v[8:9], v[8:9] op_sel:[0,0,1] op_sel_hi:[1,0,1]
  v_pk_fma_f32 v[26:27], v[26:27], v[8:9], v[8:9] op_sel:[0,0,1] op_sel_hi:[1,0,1]
  v_pk_fma_f32 v[28:29], v[28:29], v[8:9], v[8:9] op_sel:[0,0,1] op_sel_hi:[1,0,1]
  v_pk_fma_f32 v[30:31], v[30:31], v[8:9], v[8:9] op_sel:[0,0,1] op_sel_hi:[1,0,1]
  v_pk_fma_f32 v[32:33], v[32:33], v[8:9], v[8:9] op_sel:[0,0,1] op_sel_hi:[1,0,1]
  v_pk_fma_f32 v[34:35], v[34:35], v[8:9], v[8:9] op_sel:[0,0,1] op_sel_hi:[1,0,1]
  v_pk_fma_f32 v[36:37], v[36:37], v[8:9], v[8:9] op_sel:[0,0,1] op_sel_hi:[1,0,1]
  v_pk_fma_f32 v[38:39], v[38:39], v[8:9], v[8:9] op_sel:[0,0,1] op_sel_hi:[1,0,1]
  v_pk_fma_f32 v[40:41], v[40:41], v[8:9], v[8:9] op_sel:[0,0,1] op_sel_hi:[1,0,1]
  v_pk_fma_f32 v[42:43], v[42:43], v[8:9], v[8:9] op_sel:[0,0,1] op_sel_hi:[1,0,1]
  v_pk_fma_f32 v[44:45], v[44:45], v[8:9], v[8:9] op_sel:[0,0,1] op_sel_hi:[1,0,1]
  v_pk_fma_f32 v[46:47], v[46:47], v[8:9], v[8:9] op_sel:[0,0,1] op_sel_hi:[1,0,1]
  v_pk_fma_f32 v[48:49], v[48:49], v[8:9], v[8:9] op_sel:[0,0,1] op_sel_hi:[1,0,1]
  v_pk_fma_f32 v[50:51], v[50:51], v[8:9], v[8:9] op_sel:[0,0,1] op_sel_hi:[1,0,1]
  v_pk_fma_f32 v[52:53], v[52:53], v[8:9], v[8:9] op_sel:[0,0,1] op_sel_hi:[1,0,1]
  v_pk_fma_f32 v[54:55], v[54:55], v[8:9], v[8:9] op_sel:[0,0,1] op_sel_hi:[1,0,1]
  v_cmp_eq_u32 vcc, v16, v19
  s_cbranch_vccnz .g2_kernel_w_pt
.g2_kernel_w_pb:
  s_mov_b32 s72, s48
  s_mov_b32 s73, s49
  s_mov_b32 s74, 0x800
  s_mov_b32 s75, 0x00020000
  s_waitcnt vmcnt(15) lgkmcnt(8)
  v_mfma_f32_32x32x16_bf16 v[24:39], v[104:107], v[176:179], v[24:39]
  s_xor_b32 s28, s24, 1
  s_lshl_b32 s28, s28, 13
  s_add_u32 s28, s28, 65536
  ds_read_b64_tr_b16 v[128:129], v10 offset:6144
  ds_read_b64_tr_b16 v[130:131], v10 offset:7168
  v_mfma_f32_32x32x16_bf16 v[40:55], v[108:111], v[176:179], v[40:55]
  v_add_u32 v12, s28, v14
  v_add_u32 v13, s28, v15
  s_andn2_b32 s33, s36, s34
  ds_read_b64_tr_b16 v[132:133], v11 offset:6144
  ds_read_b64_tr_b16 v[134:135], v11 offset:7168
  s_waitcnt vmcnt(14) lgkmcnt(8)
  v_mfma_f32_32x32x16_bf16 v[24:39], v[112:115], v[180:183], v[24:39]
  s_ff1_i32_b32 s33, s33
  s_bitset1_b32 s34, s33
  s_xor_b32 s33, s33, s24
  ds_read_b64_tr_b16 v[104:105], v12 offset:0
  ds_read_b64_tr_b16 v[106:107], v12 offset:1024
  v_mfma_f32_32x32x16_bf16 v[40:55], v[116:119], v[180:183], v[40:55]
  s_lshl_b32 s33, s33, 12
  s_add_u32 s22, s20, s33
  s_addc_u32 s23, s21, 0
  ds_read_b64_tr_b16 v[108:109], v13 offset:0
  ds_read_b64_tr_b16 v[110:111], v13 offset:1024
  s_waitcnt vmcnt(13) lgkmcnt(8)
  v_mfma_f32_32x32x16_bf16 v[24:39], v[120:123], v[184:187], v[24:39]
  global_load_dwordx4 v[136:139], v3, s[22:23] offset:0
  global_load_dwordx4 v[140:143], v3, s[22:23] offset:1024
  global_load_dwordx4 v[144:147], v3, s[22:23] offset:2048
  ds_read_b64_tr_b16 v[112:113], v12 offset:2048
  ds_read_b64_tr_b16 v[114:115], v12 offset:3072
  v_mfma_f32_32x32x16_bf16 v[40:55], v[124:127], v[184:187], v[40:55]
  global_load_dwordx4 v[148:151], v3, s[22:23] offset:3072
  ds_read_b64_tr_b16 v[116:117], v13 offset:2048
  ds_read_b64_tr_b16 v[118:119], v13 offset:3072
  s_waitcnt vmcnt(16) lgkmcnt(8)
  v_mfma_f32_32x32x16_bf16 v[24:39], v[128:131], v[188:191], v[24:39]
  ds_read_b64_tr_b16 v[120:121], v12 offset:4096
  ds_read_b64_tr_b16 v[122:123], v12 offset:5120
  v_mfma_f32_32x32x16_bf16 v[40:55], v[132:135], v[188:191], v[40:55]
  ds_read_b64_tr_b16 v[124:125], v13 offset:4096
  ds_read_b64_tr_b16 v[126:127], v13 offset:5120
  s_waitcnt vmcnt(15) lgkmcnt(8)
  v_mfma_f32_32x32x16_bf16 v[24:39], v[104:107], v[192:195], v[24:39]
  s_xor_b32 s28, s24, 2
  s_lshl_b32 s28, s28, 13
  s_add_u32 s28, s28, 65536
  ds_read_b64_tr_b16 v[128:129], v12 offset:6144
  ds_read_b64_tr_b16 v[130:131], v12 offset:7168
  v_mfma_f32_32x32x16_bf16 v[40:55], v[108:111], v[192:195], v[40:55]
  v_add_u32 v10, s28, v14
  v_add_u32 v11, s28, v15
  s_andn2_b32 s33, s36, s34
  ds_read_b64_tr_b16 v[132:133], v13 offset:6144
  ds_read_b64_tr_b16 v[134:135], v13 offset:7168
  s_waitcnt vmcnt(14) lgkmcnt(8)
  v_mfma_f32_32x32x16_bf16 v[24:39], v[112:115], v[196:199], v[24:39]
  s_ff1_i32_b32 s33, s33
  s_bitset1_b32 s34, s33
  s_xor_b32 s33, s33, s24
  ds_read_b64_tr_b16 v[104:105], v10 offset:0
  ds_read_b64_tr_b16 v[106:107], v10 offset:1024
  v_mfma_f32_32x32x16_bf16 v[40:55], v[116:119], v[196:199], v[40:55]
  s_lshl_b32 s33, s33, 12
  s_add_u32 s22, s20, s33
  s_addc_u32 s23, s21, 0
  ds_read_b64_tr_b16 v[108:109], v11 offset:0
  ds_read_b64_tr_b16 v[110:111], v11 offset:1024
  s_waitcnt vmcnt(13) lgkmcnt(8)
  v_mfma_f32_32x32x16_bf16 v[24:39], v[120:123], v[200:203], v[24:39]
  global_load_dwordx4 v[152:155], v3, s[22:23] offset:0
  global_load_dwordx4 v[156:159], v3, s[22:23] offset:1024
  global_load_dwordx4 v[160:163], v3, s[22:23] offset:2048
  ds_read_b64_tr_b16 v[112:113], v10 offset:2048
  ds_read_b64_tr_b16 v[114:115], v10 offset:3072
  v_mfma_f32_32x32x16_bf16 v[40:55], v[124:127], v[200:203], v[40:55]
  global_load_dwordx4 v[164:167], v3, s[22:23] offset:3072
  ds_read_b64_tr_b16 v[116:117], v11 offset:2048
  ds_read_b64_tr_b16 v[118:119], v11 offset:3072
  s_waitcnt vmcnt(16) lgkmcnt(8)
  v_mfma_f32_32x32x16_bf16 v[24:39], v[128:131], v[204:207], v[24:39]
  ds_read_b64_tr_b16 v[120:121], v10 offset:4096
  ds_read_b64_tr_b16 v[122:123], v10 offset:5120
  v_mfma_f32_32x32x16_bf16 v[40:55], v[132:135], v[204:207], v[40:55]
  ds_read_b64_tr_b16 v[124:125], v11 offset:4096
  ds_read_b64_tr_b16 v[126:127], v11 offset:5120
  s_waitcnt vmcnt(15) lgkmcnt(8)
  v_mfma_f32_32x32x16_bf16 v[24:39], v[104:107], v[208:211], v[24:39]
  s_xor_b32 s28, s24, 3
  s_lshl_b32 s28, s28, 13
  s_add_u32 s28, s28, 65536
  ds_read_b64_tr_b16 v[128:129], v10 offset:6144
  ds_read_b64_tr_b16 v[130:131], v10 offset:7168
  v_mfma_f32_32x32x16_bf16 v[40:55], v[108:111], v[208:211], v[40:55]
  v_add_u32 v12, s28, v14
  v_add_u32 v13, s28, v15
  s_andn2_b32 s33, s36, s34
  ds_read_b64_tr_b16 v[132:133], v11 offset:6144
  ds_read_b64_tr_b16 v[134:135], v11 offset:7168
  s_waitcnt vmcnt(14) lgkmcnt(8)
  v_mfma_f32_32x32x16_bf16 v[24:39], v[112:115], v[212:215], v[24:39]
  s_ff1_i32_b32 s33, s33
  s_bitset1_b32 s34, s33
  s_xor_b32 s33, s33, s24
  ds_read_b64_tr_b16 v[104:105], v12 offset:0
  ds_read_b64_tr_b16 v[106:107], v12 offset:1024
  v_mfma_f32_32x32x16_bf16 v[40:55], v[116:119], v[212:215], v[40:55]
  s_lshl_b32 s33, s33, 12
  s_add_u32 s22, s20, s33
  s_addc_u32 s23, s21, 0
  ds_read_b64_tr_b16 v[108:109], v13 offset:0
  ds_read_b64_tr_b16 v[110:111], v13 offset:1024
  s_waitcnt vmcnt(13) lgkmcnt(8)
  v_mfma_f32_32x32x16_bf16 v[24:39], v[120:123], v[216:219], v[24:39]
  global_load_dwordx4 v[56:59], v3, s[22:23] offset:0
  global_load_dwordx4 v[60:63], v3, s[22:23] offset:1024
  global_load_dwordx4 v[64:67], v3, s[22:23] offset:2048
  ds_read_b64_tr_b16 v[112:113], v12 offset:2048
  ds_read_b64_tr_b16 v[114:115], v12 offset:3072
  v_mfma_f32_32x32x16_bf16 v[40:55], v[124:127], v[216:219], v[40:55]
  global_load_dwordx4 v[68:71], v3, s[22:23] offset:3072
  ds_read_b64_tr_b16 v[116:117], v13 offset:2048
  ds_read_b64_tr_b16 v[118:119], v13 offset:3072
  s_waitcnt vmcnt(16) lgkmcnt(8)
  v_mfma_f32_32x32x16_bf16 v[24:39], v[128:131], v[220:223], v[24:39]
  ds_read_b64_tr_b16 v[120:121], v12 offset:4096
  ds_read_b64_tr_b16 v[122:123], v12 offset:5120
  v_mfma_f32_32x32x16_bf16 v[40:55], v[132:135], v[220:223], v[40:55]
  ds_read_b64_tr_b16 v[124:125], v13 offset:4096
  ds_read_b64_tr_b16 v[126:127], v13 offset:5120
  s_waitcnt vmcnt(15) lgkmcnt(8)
  v_mfma_f32_32x32x16_bf16 v[24:39], v[104:107], v[224:227], v[24:39]
  s_xor_b32 s28, s24, 4
  s_lshl_b32 s28, s28, 13
  s_add_u32 s28, s28, 65536
  ds_read_b64_tr_b16 v[128:129], v12 offset:6144
  ds_read_b64_tr_b16 v[130:131], v12 offset:7168
  v_mfma_f32_32x32x16_bf16 v[40:55], v[108:111], v[224:227], v[40:55]
  v_add_u32 v10, s28, v14
  v_add_u32 v11, s28, v15
  s_andn2_b32 s33, s36, s34
  ds_read_b64_tr_b16 v[132:133], v13 offset:6144
  ds_read_b64_tr_b16 v[134:135], v13 offset:7168
  s_waitcnt vmcnt(14) lgkmcnt(8)
  v_mfma_f32_32x32x16_bf16 v[24:39], v[112:115], v[228:231], v[24:39]
  s_ff1_i32_b32 s33, s33
  s_bitset1_b32 s34, s33
  s_xor_b32 s33, s33, s24
  ds_read_b64_tr_b16 v[104:105], v10 offset:0
  ds_read_b64_tr_b16 v[106:107], v10 offset:1024
  v_mfma_f32_32x32x16_bf16 v[40:55], v[116:119], v[228:231], v[40:55]
  s_lshl_b32 s33, s33, 12
  s_add_u32 s22, s20, s33
  s_addc_u32 s23, s21, 0
  ds_read_b64_tr_b16 v[108:109], v11 offset:0
  ds_read_b64_tr_b16 v[110:111], v11 offset:1024
  s_waitcnt vmcnt(13) lgkmcnt(8)
  v_mfma_f32_32x32x16_bf16 v[24:39], v[120:123], v[232:235], v[24:39]
  global_load_dwordx4 v[72:75], v3, s[22:23] offset:0
  global_load_dwordx4 v[76:79], v3, s[22:23] offset:1024
  global_load_dwordx4 v[80:83], v3, s[22:23] offset:2048
  ds_read_b64_tr_b16 v[112:113], v10 offset:2048
  ds_read_b64_tr_b16 v[114:115], v10 offset:3072
  v_mfma_f32_32x32x16_bf16 v[40:55], v[124:127], v[232:235], v[40:55]
  global_load_dwordx4 v[84:87], v3, s[22:23] offset:3072
  ds_read_b64_tr_b16 v[116:117], v11 offset:2048
  ds_read_b64_tr_b16 v[118:119], v11 offset:3072
  s_waitcnt vmcnt(16) lgkmcnt(8)
  v_mfma_f32_32x32x16_bf16 v[24:39], v[128:131], v[236:239], v[24:39]
  ds_read_b64_tr_b16 v[120:121], v10 offset:4096
  ds_read_b64_tr_b16 v[122:123], v10 offset:5120
  v_mfma_f32_32x32x16_bf16 v[40:55], v[132:135], v[236:239], v[40:55]
  ds_read_b64_tr_b16 v[124:125], v11 offset:4096
  ds_read_b64_tr_b16 v[126:127], v11 offset:5120
  s_waitcnt vmcnt(15) lgkmcnt(8)
  v_mfma_f32_32x32x16_bf16 v[24:39], v[104:107], v[136:139], v[24:39]
  s_xor_b32 s28, s24, 5
  s_lshl_b32 s28, s28, 13
  s_add_u32 s28, s28, 65536
  v_add_u32 v12, s28, v14
  ds_read_b64_tr_b16 v[128:129], v10 offset:6144
  ds_read_b64_tr_b16 v[130:131], v10 offset:7168
  v_mfma_f32_32x32x16_bf16 v[40:55], v[108:111], v[136:139], v[40:55]
  v_add_u32 v13, s28, v15
  s_andn2_b32 s33, s36, s34
  s_cbranch_scc0 .g2_kernel_w_i8c
.g2_kernel_w_i8b:
  s_ff1_i32_b32 s33, s33
  ds_read_b64_tr_b16 v[132:133], v11 offset:6144
  ds_read_b64_tr_b16 v[134:135], v11 offset:7168
  s_waitcnt vmcnt(14) lgkmcnt(8)
  v_mfma_f32_32x32x16_bf16 v[24:39], v[112:115], v[140:143], v[24:39]
  s_bitset1_b32 s34, s33
  s_xor_b32 s33, s33, s24
  s_and_b32 s8, s33, 7
  s_cmp_lt_u32 s8, 2
  ds_read_b64_tr_b16 v[104:105], v12 offset:0
  ds_read_b64_tr_b16 v[106:107], v12 offset:1024
  v_mfma_f32_32x32x16_bf16 v[40:55], v[116:119], v[140:143], v[40:55]
  s_cselect_b32 s28, 139264, 0
  s_lshl_b32 s8, s8, 13
  s_add_u32 s8, s8, s28
  s_lshl_b32 s33, s33, 12
  ds_read_b64_tr_b16 v[108:109], v13 offset:0
  ds_read_b64_tr_b16 v[110:111], v13 offset:1024
  s_waitcnt vmcnt(13) lgkmcnt(8)
  v_mfma_f32_32x32x16_bf16 v[24:39], v[120:123], v[144:147], v[24:39]
  s_add_u32 s22, s20, s33
  s_addc_u32 s23, s21, 0
  global_load_dwordx4 v[88:91], v3, s[22:23] offset:0
  global_load_dwordx4 v[92:95], v3, s[22:23] offset:1024
  ds_read_b64_tr_b16 v[112:113], v12 offset:2048
  ds_read_b64_tr_b16 v[114:115], v12 offset:3072
  v_mfma_f32_32x32x16_bf16 v[40:55], v[124:127], v[144:147], v[40:55]
  global_load_dwordx4 v[96:99], v3, s[22:23] offset:2048
  global_load_dwordx4 v[100:103], v3, s[22:23] offset:3072
  ds_read_b64_tr_b16 v[116:117], v13 offset:2048
  ds_read_b64_tr_b16 v[118:119], v13 offset:3072
  s_waitcnt vmcnt(16) lgkmcnt(8)
  v_mfma_f32_32x32x16_bf16 v[24:39], v[128:131], v[148:151], v[24:39]
  ds_read_b64_tr_b16 v[120:121], v12 offset:4096
  ds_read_b64_tr_b16 v[122:123], v12 offset:5120
  v_mfma_f32_32x32x16_bf16 v[40:55], v[132:135], v[148:151], v[40:55]
  ds_read_b64_tr_b16 v[124:125], v13 offset:4096
  ds_read_b64_tr_b16 v[126:127], v13 offset:5120
  s_waitcnt vmcnt(15) lgkmcnt(8)
  v_mfma_f32_32x32x16_bf16 v[24:39], v[104:107], v[152:155], v[24:39]
  s_xor_b32 s28, s24, 6
  s_lshl_b32 s28, s28, 13
  s_add_u32 s28, s28, 65536
  v_add_u32 v10, s28, v14
  v_add_u32 v11, s28, v15
  ds_read_b64_tr_b16 v[128:129], v12 offset:6144
  ds_read_b64_tr_b16 v[130:131], v12 offset:7168
  v_mfma_f32_32x32x16_bf16 v[40:55], v[108:111], v[152:155], v[40:55]
  s_andn2_b32 s33, s36, s34
  s_cbranch_scc0 .g2_kernel_w_i9c
.g2_kernel_w_i9b:
  s_ff1_i32_b32 s33, s33
  s_bitset1_b32 s34, s33
  s_xor_b32 s33, s33, s24
  ds_read_b64_tr_b16 v[132:133], v13 offset:6144
  ds_read_b64_tr_b16 v[134:135], v13 offset:7168
  s_waitcnt vmcnt(14) lgkmcnt(8)
  v_mfma_f32_32x32x16_bf16 v[24:39], v[112:115], v[156:159], v[24:39]
  s_and_b32 s9, s33, 7
  s_cmp_lt_u32 s9, 2
  s_cselect_b32 s28, 139264, 0
  s_lshl_b32 s9, s9, 13
  s_add_u32 s9, s9, s28
  ds_read_b64_tr_b16 v[104:105], v10 offset:0
  ds_read_b64_tr_b16 v[106:107], v10 offset:1024
  v_mfma_f32_32x32x16_bf16 v[40:55], v[116:119], v[156:159], v[40:55]
  s_lshl_b32 s33, s33, 12
  s_add_u32 s22, s20, s33
  s_addc_u32 s23, s21, 0
  global_load_dwordx4 v[176:179], v3, s[22:23] offset:0
  global_load_dwordx4 v[180:183], v3, s[22:23] offset:1024
  ds_read_b64_tr_b16 v[108:109], v11 offset:0
  ds_read_b64_tr_b16 v[110:111], v11 offset:1024
  s_waitcnt vmcnt(15) lgkmcnt(8)
  v_mfma_f32_32x32x16_bf16 v[24:39], v[120:123], v[160:163], v[24:39]
  global_load_dwordx4 v[184:187], v3, s[22:23] offset:2048
  global_load_dwordx4 v[188:191], v3, s[22:23] offset:3072
  v_lshlrev_b32 v16, 4, v17
  s_lshl_b32 s29, s18, 7
  buffer_load_dwordx4 v[240:243], v16, s[72:75], s29 offen offset:0
  ds_read_b64_tr_b16 v[112:113], v10 offset:2048
  ds_read_b64_tr_b16 v[114:115], v10 offset:3072
  v_mfma_f32_32x32x16_bf16 v[40:55], v[124:127], v[160:163], v[40:55]
  buffer_load_dwordx4 v[244:247], v16, s[72:75], s29 offen offset:32
  buffer_load_dwordx4 v[248:251], v16, s[72:75], s29 offen offset:64
  buffer_load_dwordx4 v[252:255], v16, s[72:75], s29 offen offset:96
  ds_read_b64_tr_b16 v[116:117], v11 offset:2048
  ds_read_b64_tr_b16 v[118:119], v11 offset:3072
  s_waitcnt vmcnt(20) lgkmcnt(8)
  v_mfma_f32_32x32x16_bf16 v[24:39], v[128:131], v[164:167], v[24:39]
  ds_read_b64_tr_b16 v[120:121], v10 offset:4096
  ds_read_b64_tr_b16 v[122:123], v10 offset:5120
  v_mfma_f32_32x32x16_bf16 v[40:55], v[132:135], v[164:167], v[40:55]
  ds_read_b64_tr_b16 v[124:125], v11 offset:4096
  ds_read_b64_tr_b16 v[126:127], v11 offset:5120
  s_waitcnt vmcnt(19) lgkmcnt(8)
  v_mfma_f32_32x32x16_bf16 v[24:39], v[104:107], v[56:59], v[24:39]
  s_xor_b32 s28, s24, 7
  s_lshl_b32 s28, s28, 13
  s_add_u32 s28, s28, 65536
  v_add_u32 v12, s28, v14
  ds_read_b64_tr_b16 v[128:129], v10 offset:6144
  ds_read_b64_tr_b16 v[130:131], v10 offset:7168
  v_mfma_f32_32x32x16_bf16 v[40:55], v[108:111], v[56:59], v[40:55]
  v_add_u32 v13, s28, v15
  s_andn2_b32 s33, s36, s34
  s_cbranch_scc0 .g2_kernel_w_i10c
.g2_kernel_w_i10b:
  s_ff1_i32_b32 s33, s33
  ds_read_b64_tr_b16 v[132:133], v11 offset:6144
  ds_read_b64_tr_b16 v[134:135], v11 offset:7168
  s_waitcnt vmcnt(18) lgkmcnt(8)
  v_mfma_f32_32x32x16_bf16 v[24:39], v[112:115], v[60:63], v[24:39]
  s_bitset1_b32 s34, s33
  s_xor_b32 s33, s33, s24
  s_and_b32 s10, s33, 7
  s_cmp_lt_u32 s10, 2
  ds_read_b64_tr_b16 v[104:105], v12 offset:0
  ds_read_b64_tr_b16 v[106:107], v12 offset:1024
  v_mfma_f32_32x32x16_bf16 v[40:55], v[116:119], v[60:63], v[40:55]
  s_cselect_b32 s28, 139264, 0
  s_lshl_b32 s10, s10, 13
  s_add_u32 s10, s10, s28
  s_lshl_b32 s33, s33, 12
  ds_read_b64_tr_b16 v[108:109], v13 offset:0
  ds_read_b64_tr_b16 v[110:111], v13 offset:1024
  s_waitcnt vmcnt(17) lgkmcnt(8)
  v_mfma_f32_32x32x16_bf16 v[24:39], v[120:123], v[64:67], v[24:39]
  s_add_u32 s22, s20, s33
  s_addc_u32 s23, s21, 0
  global_load_dwordx4 v[192:195], v3, s[22:23] offset:0
  global_load_dwordx4 v[196:199], v3, s[22:23] offset:1024
  ds_read_b64_tr_b16 v[112:113], v12 offset:2048
  ds_read_b64_tr_b16 v[114:115], v12 offset:3072
  v_mfma_f32_32x32x16_bf16 v[40:55], v[124:127], v[64:67], v[40:55]
  global_load_dwordx4 v[200:203], v3, s[22:23] offset:2048
  global_load_dwordx4 v[204:207], v3, s[22:23] offset:3072
  ds_read_b64_tr_b16 v[116:117], v13 offset:2048
  ds_read_b64_tr_b16 v[118:119], v13 offset:3072
  s_waitcnt vmcnt(20) lgkmcnt(8)
  v_mfma_f32_32x32x16_bf16 v[24:39], v[128:131], v[68:71], v[24:39]
  ds_read_b64_tr_b16 v[120:121], v12 offset:4096
  ds_read_b64_tr_b16 v[122:123], v12 offset:5120
  v_mfma_f32_32x32x16_bf16 v[40:55], v[132:135], v[68:71], v[40:55]
  ds_read_b64_tr_b16 v[124:125], v13 offset:4096
  ds_read_b64_tr_b16 v[126:127], v13 offset:5120
  s_waitcnt vmcnt(19) lgkmcnt(8)
  v_mfma_f32_32x32x16_bf16 v[24:39], v[104:107], v[72:75], v[24:39]
  s_andn2_b32 s33, s36, s34
  s_cbranch_scc0 .g2_kernel_w_i11c
.g2_kernel_w_i11b:
  s_ff1_i32_b32 s33, s33
  ds_read_b64_tr_b16 v[128:129], v12 offset:6144
  ds_read_b64_tr_b16 v[130:131], v12 offset:7168
  v_mfma_f32_32x32x16_bf16 v[40:55], v[108:111], v[72:75], v[40:55]
  s_bitset1_b32 s34, s33
  s_xor_b32 s33, s33, s24
  s_and_b32 s11, s33, 7
  ds_read_b64_tr_b16 v[132:133], v13 offset:6144
  ds_read_b64_tr_b16 v[134:135], v13 offset:7168
  s_waitcnt vmcnt(18) lgkmcnt(8)
  v_mfma_f32_32x32x16_bf16 v[24:39], v[112:115], v[76:79], v[24:39]
  s_cmp_lt_u32 s11, 2
  s_cselect_b32 s28, 139264, 0
  s_lshl_b32 s11, s11, 13
  v_mfma_f32_32x32x16_bf16 v[40:55], v[116:119], v[76:79], v[40:55]
  s_add_u32 s11, s11, s28
  s_lshl_b32 s33, s33, 12
  s_add_u32 s22, s20, s33
  s_waitcnt vmcnt(17) lgkmcnt(4)
  v_mfma_f32_32x32x16_bf16 v[24:39], v[120:123], v[80:83], v[24:39]
  s_addc_u32 s23, s21, 0
  global_load_dwordx4 v[208:211], v3, s[22:23] offset:0
  global_load_dwordx4 v[212:215], v3, s[22:23] offset:1024
  v_mfma_f32_32x32x16_bf16 v[40:55], v[124:127], v[80:83], v[40:55]
  global_load_dwordx4 v[216:219], v3, s[22:23] offset:2048
  global_load_dwordx4 v[220:223], v3, s[22:23] offset:3072
  s_waitcnt vmcnt(20) lgkmcnt(0)
  v_mfma_f32_32x32x16_bf16 v[24:39], v[128:131], v[84:87], v[24:39]
  v_mfma_f32_32x32x16_bf16 v[40:55], v[132:135], v[84:87], v[40:55]
  ds_read_b32 v16, v20 offset:12
  v_add_u32 v10, s8, v14
  v_add_u32 v11, s8, v15
  s_waitcnt lgkmcnt(0)
  v_cmp_gt_u32 vcc, 4, v16
  s_cbranch_vccnz .g2_kernel_w_bw
.g2_kernel_w_bb:
  ds_read_b64_tr_b16 v[104:105], v10 offset:0
  ds_read_b64_tr_b16 v[106:107], v10 offset:1024
  ds_read_b64_tr_b16 v[108:109], v11 offset:0
  ds_read_b64_tr_b16 v[110:111], v11 offset:1024
  ds_read_b64_tr_b16 v[112:113], v10 offset:2048
  ds_read_b64_tr_b16 v[114:115], v10 offset:3072
  ds_read_b64_tr_b16 v[116:117], v11 offset:2048
  ds_read_b64_tr_b16 v[118:119], v11 offset:3072
  ds_read_b64_tr_b16 v[120:121], v10 offset:4096
  ds_read_b64_tr_b16 v[122:123], v10 offset:5120
  ds_read_b64_tr_b16 v[124:125], v11 offset:4096
  ds_read_b64_tr_b16 v[126:127], v11 offset:5120
  s_waitcnt vmcnt(16)
  v_min3_u32 v6, v88, v90, v92
  v_min3_u32 v7, v94, v96, v98
  v_min3_u32 v6, v6, v100, v102
  v_min_u32 v6, v6, v7
  v_cmp_eq_u32 vcc, 0, v6
  s_cbranch_vccnz .g2_kernel_w_v8
.g2_kernel_w_vb8:
  s_waitcnt lgkmcnt(8)
  v_mfma_f32_32x32x16_bf16 v[24:39], v[104:107], v[88:91], v[24:39]
  v_add_u32 v12, s9, v14
  v_add_u32 v13, s9, v15
  s_andn2_b32 s33, s36, s34
  s_cbranch_scc0 .g2_kernel_w_i12c
.g2_kernel_w_i12b:
  ds_read_b64_tr_b16 v[128:129], v10 offset:6144
  ds_read_b64_tr_b16 v[130:131], v10 offset:7168
  v_mfma_f32_32x32x16_bf16 v[40:55], v[108:111], v[88:91], v[40:55]
  s_ff1_i32_b32 s33, s33
  s_bitset1_b32 s34, s33
  s_xor_b32 s33, s33, s24
  s_and_b32 s12, s33, 7
  ds_read_b64_tr_b16 v[132:133], v11 offset:6144
  ds_read_b64_tr_b16 v[134:135], v11 offset:7168
  s_waitcnt lgkmcnt(8)
  v_mfma_f32_32x32x16_bf16 v[24:39], v[112:115], v[92:95], v[24:39]
  s_cmp_lt_u32 s12, 2
  s_cselect_b32 s28, 139264, 0
  s_lshl_b32 s12, s12, 13
  s_add_u32 s12, s12, s28
  ds_read_b64_tr_b16 v[104:105], v12 offset:0
  ds_read_b64_tr_b16 v[106:107], v12 offset:1024
  v_mfma_f32_32x32x16_bf16 v[40:55], v[116:119], v[92:95], v[40:55]
  s_lshl_b32 s33, s33, 12
  s_add_u32 s22, s20, s33
  s_addc_u32 s23, s21, 0
  global_load_dwordx4 v[224:227], v3, s[22:23] offset:0
  ds_read_b64_tr_b16 v[108:109], v13 offset:0
  ds_read_b64_tr_b16 v[110:111], v13 offset:1024
  s_waitcnt lgkmcnt(8)
  v_mfma_f32_32x32x16_bf16 v[24:39], v[120:123], v[96:99], v[24:39]
  global_load_dwordx4 v[228:231], v3, s[22:23] offset:1024
  global_load_dwordx4 v[232:235], v3, s[22:23] offset:2048
  global_load_dwordx4 v[236:239], v3, s[22:23] offset:3072
  ds_read_b64_tr_b16 v[112:113], v12 offset:2048
  ds_read_b64_tr_b16 v[114:115], v12 offset:3072
  v_mfma_f32_32x32x16_bf16 v[40:55], v[124:127], v[96:99], v[40:55]
  ds_read_b64_tr_b16 v[116:117], v13 offset:2048
  ds_read_b64_tr_b16 v[118:119], v13 offset:3072
  s_waitcnt lgkmcnt(8)
  v_mfma_f32_32x32x16_bf16 v[24:39], v[128:131], v[100:103], v[24:39]
  ds_read_b64_tr_b16 v[120:121], v12 offset:4096
  ds_read_b64_tr_b16 v[122:123], v12 offset:5120
  s_waitcnt vmcnt(16)
  v_min3_u32 v6, v176, v178, v180
  v_min3_u32 v7, v182, v184, v186
  v_min3_u32 v6, v6, v188, v190
  v_min_u32 v6, v6, v7
  v_cmp_eq_u32 vcc, 0, v6
  v_mfma_f32_32x32x16_bf16 v[40:55], v[132:135], v[100:103], v[40:55]
  ds_read_b64_tr_b16 v[124:125], v13 offset:4096
  ds_read_b64_tr_b16 v[126:127], v13 offset:5120
  s_cbranch_vccnz .g2_kernel_w_v9
.g2_kernel_w_vb9:
  s_waitcnt lgkmcnt(8)
  v_mfma_f32_32x32x16_bf16 v[24:39], v[104:107], v[176:179], v[24:39]
  v_add_u32 v10, s10, v14
  v_add_u32 v11, s10, v15
  s_andn2_b32 s33, s36, s34
  s_cbranch_scc0 .g2_kernel_w_i13c
.g2_kernel_w_i13b:
  ds_read_b64_tr_b16 v[128:129], v12 offset:6144
  ds_read_b64_tr_b16 v[130:131], v12 offset:7168
  v_mfma_f32_32x32x16_bf16 v[40:55], v[108:111], v[176:179], v[40:55]
  s_ff1_i32_b32 s33, s33
  s_bitset1_b32 s34, s33
  s_xor_b32 s33, s33, s24
  s_and_b32 s13, s33, 7
  ds_read_b64_tr_b16 v[132:133], v13 offset:6144
  ds_read_b64_tr_b16 v[134:135], v13 offset:7168
  s_waitcnt lgkmcnt(8)
  v_mfma_f32_32x32x16_bf16 v[24:39], v[112:115], v[180:183], v[24:39]
  s_cmp_lt_u32 s13, 2
  s_cselect_b32 s28, 139264, 0
  s_lshl_b32 s13, s13, 13
  s_add_u32 s13, s13, s28
  ds_read_b64_tr_b16 v[104:105], v10 offset:0
  ds_read_b64_tr_b16 v[106:107], v10 offset:1024
  v_mfma_f32_32x32x16_bf16 v[40:55], v[116:119], v[180:183], v[40:55]
  s_lshl_b32 s33, s33, 12
  s_add_u32 s22, s20, s33
  s_addc_u32 s23, s21, 0
  global_load_dwordx4 v[136:139], v3, s[22:23] offset:0
  ds_read_b64_tr_b16 v[108:109], v11 offset:0
  ds_read_b64_tr_b16 v[110:111], v11 offset:1024
  s_waitcnt lgkmcnt(8)
  v_mfma_f32_32x32x16_bf16 v[24:39], v[120:123], v[184:187], v[24:39]
  global_load_dwordx4 v[140:143], v3, s[22:23] offset:1024
  global_load_dwordx4 v[144:147], v3, s[22:23] offset:2048
  global_load_dwordx4 v[148:151], v3, s[22:23] offset:3072
  ds_read_b64_tr_b16 v[112:113], v10 offset:2048
  ds_read_b64_tr_b16 v[114:115], v10 offset:3072
  v_mfma_f32_32x32x16_bf16 v[40:55], v[124:127], v[184:187], v[40:55]
  ds_read_b64_tr_b16 v[116:117], v11 offset:2048
  ds_read_b64_tr_b16 v[118:119], v11 offset:3072
  s_waitcnt lgkmcnt(8)
  v_mfma_f32_32x32x16_bf16 v[24:39], v[128:131], v[188:191], v[24:39]
  ds_read_b64_tr_b16 v[120:121], v10 offset:4096
  ds_read_b64_tr_b16 v[122:123], v10 offset:5120
  s_waitcnt vmcnt(12)
  v_min3_u32 v6, v192, v194, v196
  v_min3_u32 v7, v198, v200, v202
  v_min3_u32 v6, v6, v204, v206
  v_min_u32 v6, v6, v7
  v_cmp_eq_u32 vcc, 0, v6
  v_mfma_f32_32x32x16_bf16 v[40:55], v[132:135], v[188:191], v[40:55]
  ds_read_b64_tr_b16 v[124:125], v11 offset:4096
  ds_read_b64_tr_b16 v[126:127], v11 offset:5120
  s_cbranch_vccnz .g2_kernel_w_v10
.g2_kernel_w_vb10:
  s_waitcnt lgkmcnt(8)
  v_mfma_f32_32x32x16_bf16 v[24:39], v[104:107], v[192:195], v[24:39]
  v_add_u32 v12, s11, v14
  v_add_u32 v13, s11, v15
  s_andn2_b32 s33, s36, s34
  s_cbranch_scc0 .g2_kernel_w_i14c
.g2_kernel_w_i14b:
  ds_read_b64_tr_b16 v[128:129], v10 offset:6144
  ds_read_b64_tr_b16 v[130:131], v10 offset:7168
  v_mfma_f32_32x32x16_bf16 v[40:55], v[108:111], v[192:195], v[40:55]
  s_ff1_i32_b32 s33, s33
  s_bitset1_b32 s34, s33
  s_xor_b32 s33, s33, s24
  s_and_b32 s14, s33, 7
  ds_read_b64_tr_b16 v[132:133], v11 offset:6144
  ds_read_b64_tr_b16 v[134:135], v11 offset:7168
  s_waitcnt lgkmcnt(8)
  v_mfma_f32_32x32x16_bf16 v[24:39], v[112:115], v[196:199], v[24:39]
  s_cmp_lt_u32 s14, 2
  s_cselect_b32 s28, 139264, 0
  s_lshl_b32 s14, s14, 13
  s_add_u32 s14, s14, s28
  ds_read_b64_tr_b16 v[104:105], v12 offset:0
  ds_read_b64_tr_b16 v[106:107], v12 offset:1024
  v_mfma_f32_32x32x16_bf16 v[40:55], v[116:119], v[196:199], v[40:55]
  s_lshl_b32 s33, s33, 12
  s_add_u32 s22, s20, s33
  s_addc_u32 s23, s21, 0
  global_load_dwordx4 v[152:155], v3, s[22:23] offset:0 sc1
  ds_read_b64_tr_b16 v[108:109], v13 offset:0
  ds_read_b64_tr_b16 v[110:111], v13 offset:1024
  s_waitcnt lgkmcnt(8)
  v_mfma_f32_32x32x16_bf16 v[24:39], v[120:123], v[200:203], v[24:39]
  global_load_dwordx4 v[156:159], v3, s[22:23] offset:1024 sc1
  global_load_dwordx4 v[160:163], v3, s[22:23] offset:2048 sc1
  global_load_dwordx4 v[164:167], v3, s[22:23] offset:3072 sc1
  ds_read_b64_tr_b16 v[112:113], v12 offset:2048
  ds_read_b64_tr_b16 v[114:115], v12 offset:3072
  v_mfma_f32_32x32x16_bf16 v[40:55], v[124:127], v[200:203], v[40:55]
  ds_read_b64_tr_b16 v[116:117], v13 offset:2048
  ds_read_b64_tr_b16 v[118:119], v13 offset:3072
  s_waitcnt lgkmcnt(8)
  v_mfma_f32_32x32x16_bf16 v[24:39], v[128:131], v[204:207], v[24:39]
  ds_read_b64_tr_b16 v[120:121], v12 offset:4096
  ds_read_b64_tr_b16 v[122:123], v12 offset:5120
  s_waitcnt vmcnt(12)
  v_min3_u32 v6, v208, v210, v212
  v_min3_u32 v7, v214, v216, v218
  v_min3_u32 v6, v6, v220, v222
  v_min_u32 v6, v6, v7
  v_cmp_eq_u32 vcc, 0, v6
  v_mfma_f32_32x32x16_bf16 v[40:55], v[132:135], v[204:207], v[40:55]
  ds_read_b64_tr_b16 v[124:125], v13 offset:4096
  ds_read_b64_tr_b16 v[126:127], v13 offset:5120
  s_cbranch_vccnz .g2_kernel_w_v11
.g2_kernel_w_vb11:
  s_mov_b64 exec, 1
  ds_add_u32 v20, v5 offset:16
  s_mov_b64 exec, -1
  s_waitcnt lgkmcnt(8)
  v_mfma_f32_32x32x16_bf16 v[24:39], v[104:107], v[208:211], v[24:39]
  v_add_u32 v10, s12, v14
  v_add_u32 v11, s12, v15
  s_andn2_b32 s33, s36, s34
  s_cbranch_scc0 .g2_kernel_w_i15c
.g2_kernel_w_i15b:
  ds_read_b64_tr_b16 v[128:129], v12 offset:6144
  ds_read_b64_tr_b16 v[130:131], v12 offset:7168
  v_mfma_f32_32x32x16_bf16 v[40:55], v[108:111], v[208:211], v[40:55]
  s_ff1_i32_b32 s33, s33
  s_bitset1_b32 s34, s33
  s_xor_b32 s33, s33, s24
  s_and_b32 s15, s33, 7
  ds_read_b64_tr_b16 v[132:133], v13 offset:6144
  ds_read_b64_tr_b16 v[134:135], v13 offset:7168
  s_waitcnt lgkmcnt(8)
  v_mfma_f32_32x32x16_bf16 v[24:39], v[112:115], v[212:215], v[24:39]
  s_cmp_lt_u32 s15, 2
  s_cselect_b32 s28, 139264, 0
  s_lshl_b32 s15, s15, 13
  s_add_u32 s15, s15, s28
  ds_read_b64_tr_b16 v[104:105], v10 offset:0
  ds_read_b64_tr_b16 v[106:107], v10 offset:1024
  v_mfma_f32_32x32x16_bf16 v[40:55], v[116:119], v[212:215], v[40:55]
  s_lshl_b32 s33, s33, 12
  s_add_u32 s22, s20, s33
  s_addc_u32 s23, s21, 0
  global_load_dwordx4 v[56:59], v3, s[22:23] offset:0 sc1
  ds_read_b64_tr_b16 v[108:109], v11 offset:0
  ds_read_b64_tr_b16 v[110:111], v11 offset:1024
  s_waitcnt lgkmcnt(8)
  v_mfma_f32_32x32x16_bf16 v[24:39], v[120:123], v[216:219], v[24:39]
  global_load_dwordx4 v[60:63], v3, s[22:23] offset:1024 sc1
  global_load_dwordx4 v[64:67], v3, s[22:23] offset:2048 sc1
  global_load_dwordx4 v[68:71], v3, s[22:23] offset:3072 sc1
  ds_read_b64_tr_b16 v[112:113], v10 offset:2048
  ds_read_b64_tr_b16 v[114:115], v10 offset:3072
  v_mfma_f32_32x32x16_bf16 v[40:55], v[124:127], v[216:219], v[40:55]
  ds_read_b64_tr_b16 v[116:117], v11 offset:2048
  ds_read_b64_tr_b16 v[118:119], v11 offset:3072
  s_waitcnt lgkmcnt(8)
  v_mfma_f32_32x32x16_bf16 v[24:39], v[128:131], v[220:223], v[24:39]
  ds_read_b64_tr_b16 v[120:121], v10 offset:4096
  ds_read_b64_tr_b16 v[122:123], v10 offset:5120
  s_waitcnt vmcnt(12)
  v_min3_u32 v6, v224, v226, v228
  v_min3_u32 v7, v230, v232, v234
  v_min3_u32 v6, v6, v236, v238
  v_min_u32 v6, v6, v7
  v_cmp_eq_u32 vcc, 0, v6
  v_mfma_f32_32x32x16_bf16 v[40:55], v[132:135], v[220:223], v[40:55]
  ds_read_b64_tr_b16 v[124:125], v11 offset:4096
  ds_read_b64_tr_b16 v[126:127], v11 offset:5120
  s_cbranch_vccnz .g2_kernel_w_v12
.g2_kernel_w_vb12:
  s_waitcnt lgkmcnt(8)
  v_mfma_f32_32x32x16_bf16 v[24:39], v[104:107], v[224:227], v[24:39]
  v_add_u32 v12, s13, v14
  v_add_u32 v13, s13, v15
  ds_read_b64_tr_b16 v[128:129], v10 offset:6144
  ds_read_b64_tr_b16 v[130:131], v10 offset:7168
  v_mfma_f32_32x32x16_bf16 v[40:55], v[108:111], v[224:227], v[40:55]
  ds_read_b64_tr_b16 v[132:133], v11 offset:6144
  ds_read_b64_tr_b16 v[134:135], v11 offset:7168
  s_waitcnt lgkmcnt(8)
  v_mfma_f32_32x32x16_bf16 v[24:39], v[112:115], v[228:231], v[24:39]
  ds_read_b64_tr_b16 v[104:105], v12 offset:0
  ds_read_b64_tr_b16 v[106:107], v12 offset:1024
  v_mfma_f32_32x32x16_bf16 v[40:55], v[116:119], v[228:231], v[40:55]
  ds_read_b64_tr_b16 v[108:109], v13 offset:0
  ds_read_b64_tr_b16 v[110:111], v13 offset:1024
  s_waitcnt lgkmcnt(8)
  v_mfma_f32_32x32x16_bf16 v[24:39], v[120:123], v[232:235], v[24:39]
  ds_read_b64_tr_b16 v[112:113], v12 offset:2048
  ds_read_b64_tr_b16 v[114:115], v12 offset:3072
  v_mfma_f32_32x32x16_bf16 v[40:55], v[124:127], v[232:235], v[40:55]
  ds_read_b64_tr_b16 v[116:117], v13 offset:2048
  ds_read_b64_tr_b16 v[118:119], v13 offset:3072
  s_waitcnt lgkmcnt(8)
  v_mfma_f32_32x32x16_bf16 v[24:39], v[128:131], v[236:239], v[24:39]
  ds_read_b64_tr_b16 v[120:121], v12 offset:4096
  ds_read_b64_tr_b16 v[122:123], v12 offset:5120
  s_waitcnt vmcnt(8)
  v_min3_u32 v6, v136, v138, v140
  v_min3_u32 v7, v142, v144, v146
  v_min3_u32 v6, v6, v148, v150
  v_min_u32 v6, v6, v7
  v_cmp_eq_u32 vcc, 0, v6
  v_mfma_f32_32x32x16_bf16 v[40:55], v[132:135], v[236:239], v[40:55]
  ds_read_b64_tr_b16 v[124:125], v13 offset:4096
  ds_read_b64_tr_b16 v[126:127], v13 offset:5120
  s_cbranch_vccnz .g2_kernel_w_v13
.g2_kernel_w_vb13:
  s_waitcnt lgkmcnt(8)
  v_mfma_f32_32x32x16_bf16 v[24:39], v[104:107], v[136:139], v[24:39]
  v_add_u32 v10, s14, v14
  v_add_u32 v11, s14, v15
  ds_read_b64_tr_b16 v[128:129], v12 offset:6144
  ds_read_b64_tr_b16 v[130:131], v12 offset:7168
  v_mfma_f32_32x32x16_bf16 v[40:55], v[108:111], v[136:139], v[40:55]
  ds_read_b64_tr_b16 v[132:133], v13 offset:6144
  ds_read_b64_tr_b16 v[134:135], v13 offset:7168
  s_waitcnt lgkmcnt(8)
  v_mfma_f32_32x32x16_bf16 v[24:39], v[112:115], v[140:143], v[24:39]
  ds_read_b64_tr_b16 v[104:105], v10 offset:0
  ds_read_b64_tr_b16 v[106:107], v10 offset:1024
  v_mfma_f32_32x32x16_bf16 v[40:55], v[116:119], v[140:143], v[40:55]
  ds_read_b64_tr_b16 v[108:109], v11 offset:0
  ds_read_b64_tr_b16 v[110:111], v11 offset:1024
  s_waitcnt lgkmcnt(8)
  v_mfma_f32_32x32x16_bf16 v[24:39], v[120:123], v[144:147], v[24:39]
  ds_read_b64_tr_b16 v[112:113], v10 offset:2048
  ds_read_b64_tr_b16 v[114:115], v10 offset:3072
  v_mfma_f32_32x32x16_bf16 v[40:55], v[124:127], v[144:147], v[40:55]
  ds_read_b64_tr_b16 v[116:117], v11 offset:2048
  ds_read_b64_tr_b16 v[118:119], v11 offset:3072
  s_waitcnt lgkmcnt(8)
  v_mfma_f32_32x32x16_bf16 v[24:39], v[128:131], v[148:151], v[24:39]
  ds_read_b64_tr_b16 v[120:121], v10 offset:4096
  ds_read_b64_tr_b16 v[122:123], v10 offset:5120
  s_waitcnt vmcnt(4)
  v_min3_u32 v6, v152, v154, v156
  v_min3_u32 v7, v158, v160, v162
  v_min3_u32 v6, v6, v164, v166
  v_min_u32 v6, v6, v7
  v_cmp_eq_u32 vcc, 0, v6
  v_mfma_f32_32x32x16_bf16 v[40:55], v[132:135], v[148:151], v[40:55]
  ds_read_b64_tr_b16 v[124:125], v11 offset:4096
  ds_read_b64_tr_b16 v[126:127], v11 offset:5120
  s_cbranch_vccnz .g2_kernel_w_v14
.g2_kernel_w_vb14:
  s_waitcnt lgkmcnt(8)
  v_mfma_f32_32x32x16_bf16 v[24:39], v[104:107], v[152:155], v[24:39]
  v_add_u32 v12, s15, v14
  v_add_u32 v13, s15, v15
  ds_read_b64_tr_b16 v[128:129], v10 offset:6144
  ds_read_b64_tr_b16 v[130:131], v10 offset:7168
  v_mfma_f32_32x32x16_bf16 v[40:55], v[108:111], v[152:155], v[40:55]
  ds_read_b64_tr_b16 v[132:133], v11 offset:6144
  ds_read_b64_tr_b16 v[134:135], v11 offset:7168
  s_waitcnt lgkmcnt(8)
  v_mfma_f32_32x32x16_bf16 v[24:39], v[112:115], v[156:159], v[24:39]
  ds_read_b64_tr_b16 v[104:105], v12 offset:0
  ds_read_b64_tr_b16 v[106:107], v12 offset:1024
  v_mfma_f32_32x32x16_bf16 v[40:55], v[116:119], v[156:159], v[40:55]
  ds_read_b64_tr_b16 v[108:109], v13 offset:0
  ds_read_b64_tr_b16 v[110:111], v13 offset:1024
  s_waitcnt lgkmcnt(8)
  v_mfma_f32_32x32x16_bf16 v[24:39], v[120:123], v[160:163], v[24:39]
  ds_read_b64_tr_b16 v[112:113], v12 offset:2048
  ds_read_b64_tr_b16 v[114:115], v12 offset:3072
  v_mfma_f32_32x32x16_bf16 v[40:55], v[124:127], v[160:163], v[40:55]
  ds_read_b64_tr_b16 v[116:117], v13 offset:2048
  ds_read_b64_tr_b16 v[118:119], v13 offset:3072
  s_waitcnt lgkmcnt(8)
  v_mfma_f32_32x32x16_bf16 v[24:39], v[128:131], v[164:167], v[24:39]
  ds_read_b64_tr_b16 v[120:121], v12 offset:4096
  ds_read_b64_tr_b16 v[122:123], v12 offset:5120
  s_waitcnt vmcnt(0)
  v_min3_u32 v6, v56, v58, v60
  v_min3_u32 v7, v62, v64, v66
  v_min3_u32 v6, v6, v68, v70
  v_min_u32 v6, v6, v7
  v_cmp_eq_u32 vcc, 0, v6
  v_mfma_f32_32x32x16_bf16 v[40:55], v[132:135], v[164:167], v[40:55]
  ds_read_b64_tr_b16 v[124:125], v13 offset:4096
  ds_read_b64_tr_b16 v[126:127], v13 offset:5120
  s_cbranch_vccnz .g2_kernel_w_v15
.g2_kernel_w_vb15:
  s_waitcnt lgkmcnt(8)
  v_mfma_f32_32x32x16_bf16 v[24:39], v[104:107], v[56:59], v[24:39]
  ds_read_b64_tr_b16 v[128:129], v12 offset:6144
  ds_read_b64_tr_b16 v[130:131], v12 offset:7168
  v_mfma_f32_32x32x16_bf16 v[40:55], v[108:111], v[56:59], v[40:55]
  ds_read_b64_tr_b16 v[132:133], v13 offset:6144
  ds_read_b64_tr_b16 v[134:135], v13 offset:7168
  s_waitcnt lgkmcnt(8)
  v_mfma_f32_32x32x16_bf16 v[24:39], v[112:115], v[60:63], v[24:39]
  v_mfma_f32_32x32x16_bf16 v[40:55], v[116:119], v[60:63], v[40:55]
  s_waitcnt lgkmcnt(4)
  v_mfma_f32_32x32x16_bf16 v[24:39], v[120:123], v[64:67], v[24:39]
  v_mfma_f32_32x32x16_bf16 v[40:55], v[124:127], v[64:67], v[40:55]
  s_waitcnt lgkmcnt(0)
  v_mfma_f32_32x32x16_bf16 v[24:39], v[128:131], v[68:71], v[24:39]
  v_mfma_f32_32x32x16_bf16 v[40:55], v[132:135], v[68:71], v[40:55]
  s_lshl_b32 s28, s17, 4
  s_add_u32 s28, s28, s18
  s_lshl_b32 s28, s28, 2
  s_add_u32 s28, s28, s16
  s_lshl_b32 s28, s28, 12
  s_add_u32 s28, s28, s63
  s_add_u32 s28, s28, 0xc00000
  s_lshl_b32 s29, s16, 12
  v_add_u32 v6, s29, v22
  s_mov_b32 s36, 0x3f803f80
  v_mov_b32 v8, 0
  v_mov_b32 v9, 0
  v_mov_b32 v10, 0
  v_cvt_pk_bf16_f32 v56, v24, v25
  v_cvt_pk_bf16_f32 v57, v26, v27
  v_cvt_pk_bf16_f32 v58, v28, v29
  v_cvt_pk_bf16_f32 v59, v30, v31
  buffer_store_dwordx4 v[56:59], v22, s[4:7], s28 offen offset:0 sc1
  v_cvt_pk_bf16_f32 v60, v32, v33
  v_cvt_pk_bf16_f32 v61, v34, v35
  v_cvt_pk_bf16_f32 v62, v36, v37
  v_cvt_pk_bf16_f32 v63, v38, v39
  buffer_store_dwordx4 v[60:63], v22, s[4:7], s28 offen offset:512 sc1
  v_cvt_pk_bf16_f32 v64, v40, v41
  v_cvt_pk_bf16_f32 v65, v42, v43
  v_cvt_pk_bf16_f32 v66, v44, v45
  v_cvt_pk_bf16_f32 v67, v46, v47
  buffer_store_dwordx4 v[64:67], v22, s[4:7], s28 offen offset:1024 sc1
  v_cvt_pk_bf16_f32 v68, v48, v49
  v_cvt_pk_bf16_f32 v69, v50, v51
  v_cvt_pk_bf16_f32 v70, v52, v53
  v_cvt_pk_bf16_f32 v71, v54, v55
  buffer_store_dwordx4 v[68:71], v22, s[4:7], s28 offen offset:1536 sc1
  ds_write_b128 v6, v[56:59] offset:0
  ds_write_b128 v6, v[60:63] offset:512
  ds_write_b128 v6, v[64:67] offset:1024
  ds_write_b128 v6, v[68:71] offset:1536
  s_mov_b64 exec, 1
  ds_add_u32 v20, v5 offset:20
  s_mov_b64 exec, -1
  s_lshl_b32 s28, s17, 2
  s_add_u32 s28, s28, s16
  s_lshl_b32 s28, s28, 13
  s_lshl_b32 s29, s18, 9
  s_add_u32 s28, s28, s29
  s_add_u32 s28, s28, s63
  s_add_u32 s28, s28, 0x1000000
  v_dot2c_f32_bf16 v8, s36, v56
  v_dot2c_f32_bf16 v9, v56, v56
  v_dot2c_f32_bf16 v10, v56, v240
  v_dot2c_f32_bf16 v8, s36, v57
  v_dot2c_f32_bf16 v9, v57, v57
  v_dot2c_f32_bf16 v10, v57, v241
  v_dot2c_f32_bf16 v8, s36, v58
  v_dot2c_f32_bf16 v9, v58, v58
  v_dot2c_f32_bf16 v10, v58, v242
  v_dot2c_f32_bf16 v8, s36, v59
  v_dot2c_f32_bf16 v9, v59, v59
  v_dot2c_f32_bf16 v10, v59, v243
  v_dot2c_f32_bf16 v8, s36, v60
  v_dot2c_f32_bf16 v9, v60, v60
  v_dot2c_f32_bf16 v10, v60, v244
  v_dot2c_f32_bf16 v8, s36, v61
  v_dot2c_f32_bf16 v9, v61, v61
  v_dot2c_f32_bf16 v10, v61, v245
  v_dot2c_f32_bf16 v8, s36, v62
  v_dot2c_f32_bf16 v9, v62, v62
  v_dot2c_f32_bf16 v10, v62, v246
  v_dot2c_f32_bf16 v8, s36, v63
  v_dot2c_f32_bf16 v9, v63, v63
  v_dot2c_f32_bf16 v10, v63, v247
  v_dot2c_f32_bf16 v8, s36, v64
  v_dot2c_f32_bf16 v9, v64, v64
  v_dot2c_f32_bf16 v10, v64, v248
  v_dot2c_f32_bf16 v8, s36, v65
  v_dot2c_f32_bf16 v9, v65, v65
  v_dot2c_f32_bf16 v10, v65, v249
  v_dot2c_f32_bf16 v8, s36, v66
  v_dot2c_f32_bf16 v9, v66, v66
  v_dot2c_f32_bf16 v10, v66, v250
  v_dot2c_f32_bf16 v8, s36, v67
  v_dot2c_f32_bf16 v9, v67, v67
  v_dot2c_f32_bf16 v10, v67, v251
  v_dot2c_f32_bf16 v8, s36, v68
  v_dot2c_f32_bf16 v9, v68, v68
  v_dot2c_f32_bf16 v10, v68, v252
  v_dot2c_f32_bf16 v8, s36, v69
  v_dot2c_f32_bf16 v9, v69, v69
  v_dot2c_f32_bf16 v10, v69, v253
  v_dot2c_f32_bf16 v8, s36, v70
  v_dot2c_f32_bf16 v9, v70, v70
  v_dot2c_f32_bf16 v10, v70, v254
  v_dot2c_f32_bf16 v8, s36, v71
  v_dot2c_f32_bf16 v9, v71, v71
  v_dot2c_f32_bf16 v10, v71, v255
  s_lshl_b32 s29, s16, 7
  s_add_u32 s37, s19, s29
  v_mov_b32 v24, v8
  v_mov_b32 v25, v9
  v_mov_b32 v26, v10
  v_mov_b32 v11, 1
  v_permlane32_swap_b32 v8, v24
  v_permlane32_swap_b32 v9, v25
  v_permlane32_swap_b32 v10, v26
  v_add_f32 v8, v8, v24
  v_add_f32 v9, v9, v25
  v_add_f32 v10, v10, v26
  v_or_b32 v8, 1, v8
  v_mov_b32 v16, s70
  s_mov_b32 exec_hi, 0
  s_waitcnt vmcnt(0)
  buffer_store_dwordx4 v[8:11], v3, s[4:7], s28 offen sc1
  s_mov_b64 exec, 1
  buffer_store_dword v16, v4, s[4:7], s37 offen offset:8 sc1
  s_mov_b64 exec, -1
  s_cmp_lg_u32 s62, 0
  s_cbranch_scc1 .g2_kernel_tail
  s_mov_b32 s62, 1
  s_mov_b32 s63, 0x1800000
  s_mov_b32 s70, 2
  s_mov_b32 s71, 155776
  s_branch .g2_kernel_q_cons2
.g2_kernel_tail:
  s_mov_b32 s28, s56
  s_mov_b32 s29, s57
  s_mov_b32 s30, 0x400000
  s_mov_b32 s31, 0x00020000
  v_lshrrev_b32 v8, 3, v2
  v_and_b32 v9, 7, v2
  v_lshlrev_b32 v10, 8, v9
  v_lshl_add_u32 v10, v8, 4, v10
  s_lshl_b32 s32, s16, 12
  v_add_u32 v10, s32, v10
  ds_read_b128 v[56:59], v10 offset:0
  ds_read_b128 v[60:63], v10 offset:128
  ds_read_b128 v[64:67], v10 offset:2048
  ds_read_b128 v[68:71], v10 offset:2176
  v_lshlrev_b32 v23, 11, v8
  v_lshl_add_u32 v23, v9, 4, v23
  s_lshl_b32 s32, s16, 5
  v_add_u32 v19, s32, v8
  v_lshlrev_b32 v10, 2, v19
  v_add_u32 v10, 155648, v10
  s_lshl_b32 s32, s17, 2
  s_add_u32 s32, s32, s16
  s_lshl_b32 s32, s32, 16
  s_lshl_b32 s33, s18, 7
  s_add_u32 s32, s32, s33
  s_waitcnt lgkmcnt(0)
  v_lshlrev_b32 v24, 16, v56
  v_and_b32 v25, 0xffff0000, v56
  v_lshlrev_b32 v26, 16, v57
  v_and_b32 v27, 0xffff0000, v57
  v_lshlrev_b32 v28, 16, v58
  v_and_b32 v29, 0xffff0000, v58
  v_lshlrev_b32 v30, 16, v59
  v_and_b32 v31, 0xffff0000, v59
  v_lshlrev_b32 v32, 16, v60
  v_and_b32 v33, 0xffff0000, v60
  v_lshlrev_b32 v34, 16, v61
  v_and_b32 v35, 0xffff0000, v61
  v_lshlrev_b32 v36, 16, v62
  v_and_b32 v37, 0xffff0000, v62
  v_lshlrev_b32 v38, 16, v63
  v_and_b32 v39, 0xffff0000, v63
  v_lshlrev_b32 v40, 16, v64
  v_and_b32 v41, 0xffff0000, v64
  v_lshlrev_b32 v42, 16, v65
  v_and_b32 v43, 0xffff0000, v65
  v_lshlrev_b32 v44, 16, v66
  v_and_b32 v45, 0xffff0000, v66
  v_lshlrev_b32 v46, 16, v67
  v_and_b32 v47, 0xffff0000, v67
  v_lshlrev_b32 v48, 16, v68
  v_and_b32 v49, 0xffff0000, v68
  v_lshlrev_b32 v50, 16, v69
  v_and_b32 v51, 0xffff0000, v69
  v_lshlrev_b32 v52, 16, v70
  v_and_b32 v53, 0xffff0000, v70
  v_lshlrev_b32 v54, 16, v71
  v_and_b32 v55, 0xffff0000, v71
  v_mov_b32 v6, s71
  s_mov_b32 s38, 0
.g2_kernel_wg5:
  ds_read_b32 v7, v6 offset:28
  s_add_u32 s38, s38, 1
  s_waitcnt lgkmcnt(0)
  v_cmp_le_u32 vcc, 1, v7
  s_cbranch_vccnz .g2_kernel_wg5d
  s_sleep 2
  s_cmp_lt_u32 s38, 524288
  s_cbranch_scc1 .g2_kernel_wg5
.g2_kernel_wg5d:
  ds_read_b32 v16, v20 offset:32
  ds_read_b32 v72, v10 offset:3840
  ds_read_b32 v73, v10 offset:4352
  ds_read_b32 v74, v10 offset:3872
  ds_read_b32 v75, v10 offset:4384
  ds_read_b32 v76, v10 offset:3904
  ds_read_b32 v77, v10 offset:4416
  ds_read_b32 v78, v10 offset:3936
  ds_read_b32 v79, v10 offset:4448
  s_waitcnt lgkmcnt(0)
  v_sub_u32 v16, v16, v19
  v_pk_fma_f32 v[24:25], v[24:25], v[72:73], v[72:73] op_sel:[0,0,1] op_sel_hi:[1,0,1]
  v_pk_fma_f32 v[26:27], v[26:27], v[72:73], v[72:73] op_sel:[0,0,1] op_sel_hi:[1,0,1]
  v_pk_fma_f32 v[28:29], v[28:29], v[72:73], v[72:73] op_sel:[0,0,1] op_sel_hi:[1,0,1]
  v_pk_fma_f32 v[30:31], v[30:31], v[72:73], v[72:73] op_sel:[0,0,1] op_sel_hi:[1,0,1]
  v_cvt_pk_bf16_f32 v56, v24, v25
  v_cvt_pk_bf16_f32 v57, v26, v27
  v_cvt_pk_bf16_f32 v58, v28, v29
  v_cvt_pk_bf16_f32 v59, v30, v31
  v_cmp_ne_u32 vcc, 1, v16
  s_mov_b64 exec, vcc
  buffer_store_dwordx4 v[56:59], v23, s[28:31], s32 offen sc1
  s_mov_b64 exec, -1
  s_add_u32 s32, s32, 16384
  v_pk_fma_f32 v[32:33], v[32:33], v[74:75], v[74:75] op_sel:[0,0,1] op_sel_hi:[1,0,1]
  v_pk_fma_f32 v[34:35], v[34:35], v[74:75], v[74:75] op_sel:[0,0,1] op_sel_hi:[1,0,1]
  v_pk_fma_f32 v[36:37], v[36:37], v[74:75], v[74:75] op_sel:[0,0,1] op_sel_hi:[1,0,1]
  v_pk_fma_f32 v[38:39], v[38:39], v[74:75], v[74:75] op_sel:[0,0,1] op_sel_hi:[1,0,1]
  v_cvt_pk_bf16_f32 v60, v32, v33
  v_cvt_pk_bf16_f32 v61, v34, v35
  v_cvt_pk_bf16_f32 v62, v36, v37
  v_cvt_pk_bf16_f32 v63, v38, v39
  v_cmp_ne_u32 vcc, 9, v16
  s_mov_b64 exec, vcc
  buffer_store_dwordx4 v[60:63], v23, s[28:31], s32 offen sc1
  s_mov_b64 exec, -1
  s_add_u32 s32, s32, 16384
  v_pk_fma_f32 v[40:41], v[40:41], v[76:77], v[76:77] op_sel:[0,0,1] op_sel_hi:[1,0,1]
  v_pk_fma_f32 v[42:43], v[42:43], v[76:77], v[76:77] op_sel:[0,0,1] op_sel_hi:[1,0,1]
  v_pk_fma_f32 v[44:45], v[44:45], v[76:77], v[76:77] op_sel:[0,0,1] op_sel_hi:[1,0,1]
  v_pk_fma_f32 v[46:47], v[46:47], v[76:77], v[76:77] op_sel:[0,0,1] op_sel_hi:[1,0,1]
  v_cvt_pk_bf16_f32 v64, v40, v41
  v_cvt_pk_bf16_f32 v65, v42, v43
  v_cvt_pk_bf16_f32 v66, v44, v45
  v_cvt_pk_bf16_f32 v67, v46, v47
  v_cmp_ne_u32 vcc, 17, v16
  s_mov_b64 exec, vcc
  buffer_store_dwordx4 v[64:67], v23, s[28:31], s32 offen sc1
  s_mov_b64 exec, -1
  s_add_u32 s32, s32, 16384
  v_pk_fma_f32 v[48:49], v[48:49], v[78:79], v[78:79] op_sel:[0,0,1] op_sel_hi:[1,0,1]
  v_pk_fma_f32 v[50:51], v[50:51], v[78:79], v[78:79] op_sel:[0,0,1] op_sel_hi:[1,0,1]
  v_pk_fma_f32 v[52:53], v[52:53], v[78:79], v[78:79] op_sel:[0,0,1] op_sel_hi:[1,0,1]
  v_pk_fma_f32 v[54:55], v[54:55], v[78:79], v[78:79] op_sel:[0,0,1] op_sel_hi:[1,0,1]
  v_cvt_pk_bf16_f32 v68, v48, v49
  v_cvt_pk_bf16_f32 v69, v50, v51
  v_cvt_pk_bf16_f32 v70, v52, v53
  v_cvt_pk_bf16_f32 v71, v54, v55
  v_cmp_ne_u32 vcc, 25, v16
  s_mov_b64 exec, vcc
  buffer_store_dwordx4 v[68:71], v23, s[28:31], s32 offen sc1
  s_mov_b64 exec, -1
  s_add_u32 s32, s32, 16384
  s_branch .g2_kernel_fin
.g2_kernel_svc:
  s_cmp_eq_u32 s16, 5
  s_cbranch_scc1 .g2_kernel_s1
  s_cmp_eq_u32 s16, 6
  s_cbranch_scc1 .g2_kernel_s2
  s_cmp_eq_u32 s16, 7
  s_cbranch_scc1 .g2_kernel_s3
  s_mov_b32 s8, s40
  s_mov_b32 s9, s41
  s_mov_b32 s10, 0x400000
  s_mov_b32 s11, 0x00020000
  s_setprio 3
  v_lshrrev_b32 v20, 3, v2
  v_and_b32 v21, 7, v2
  v_lshrrev_b32 v22, 4, v2
  v_xor_b32 v23, v21, v22
  v_lshlrev_b32 v23, 4, v23
  v_lshl_add_u32 v24, v20, 11, v23
  v_xor_b32 v25, 64, v24
  s_lshl_b32 s32, s17, 18
  v_add_u32 v32, 0, v24
  v_add_u32 v33, 15360, v25
  v_add_u32 v34, 30720, v24
  v_add_u32 v35, 46080, v25
  v_add_u32 v36, 65536, v24
  v_add_u32 v37, 80896, v25
  v_add_u32 v38, 96256, v24
  v_add_u32 v39, 111616, v25
  v_add_u32 v40, 131072, v24
  v_add_u32 v41, 146432, v25
  v_add_u32 v42, 161792, v24
  v_add_u32 v43, 177152, v25
  v_add_u32 v44, 196608, v24
  v_add_u32 v45, 211968, v25
  v_add_u32 v46, 227328, v24
  v_add_u32 v47, 242688, v25
  s_mov_b32 s29, 0
  s_add_u32 m0, s29, 0
  s_waitcnt vmcnt(63)
  buffer_load_dwordx4 v32, s[8:11], s32 offen offset:0 lds
  buffer_load_dwordx4 v33, s[8:11], s32 offen offset:1024 lds
  buffer_load_dwordx4 v34, s[8:11], s32 offen offset:2048 lds
  buffer_load_dwordx4 v35, s[8:11], s32 offen offset:3072 lds
  s_add_u32 m0, s29, 4096
  s_waitcnt vmcnt(63)
  buffer_load_dwordx4 v36, s[8:11], s32 offen offset:0 lds
  buffer_load_dwordx4 v37, s[8:11], s32 offen offset:1024 lds
  buffer_load_dwordx4 v38, s[8:11], s32 offen offset:2048 lds
  buffer_load_dwordx4 v39, s[8:11], s32 offen offset:3072 lds
  s_add_u32 m0, s29, 8192
  s_waitcnt vmcnt(63)
  buffer_load_dwordx4 v40, s[8:11], s32 offen offset:0 lds
  buffer_load_dwordx4 v41, s[8:11], s32 offen offset:1024 lds
  buffer_load_dwordx4 v42, s[8:11], s32 offen offset:2048 lds
  buffer_load_dwordx4 v43, s[8:11], s32 offen offset:3072 lds
  s_add_u32 m0, s29, 12288
  s_waitcnt vmcnt(63)
  buffer_load_dwordx4 v44, s[8:11], s32 offen offset:0 lds
  buffer_load_dwordx4 v45, s[8:11], s32 offen offset:1024 lds
  buffer_load_dwordx4 v46, s[8:11], s32 offen offset:2048 lds
  buffer_load_dwordx4 v47, s[8:11], s32 offen offset:3072 lds
  s_add_u32 s32, s32, 128
  s_mov_b32 s12, s42
  s_mov_b32 s13, s43
  s_mov_b32 s14, 0x600000
  s_mov_b32 s15, 0x00020000
  v_lshrrev_b32 v28, 3, v2
  v_and_b32 v29, 7, v2
  v_bfe_u32 v30, v2, 4, 1
  v_lshlrev_b32 v30, 1, v30
  v_xor_b32 v31, v29, v30
  v_lshlrev_b32 v31, 4, v31
  v_mul_u32_u24 v28, 6144, v28
  v_add_u32 v28, v28, v31
  v_xor_b32 v29, 64, v28
  v_lshlrev_b32 v9, 8, v2
  v_and_b32 v9, 0x300, v9
  v_add_u32 v9, 156416, v9
  v_add_u32 v48, 0, v28
  v_add_u32 v49, 48128, v29
  v_add_u32 v50, 96256, v28
  v_add_u32 v51, 144384, v29
  v_add_u32 v52, 2048, v28
  v_add_u32 v53, 50176, v29
  v_add_u32 v54, 98304, v28
  v_add_u32 v55, 146432, v29
  v_add_u32 v56, 4096, v28
  v_add_u32 v57, 52224, v29
  v_add_u32 v58, 100352, v28
  v_add_u32 v59, 148480, v29
  s_lshl_b32 s36, s18, 7
  s_mov_b32 s30, 0
  s_add_u32 m0, s30, 65536
  s_waitcnt vmcnt(63)
  buffer_load_dwordx4 v48, s[12:15], s36 offen offset:0 lds
  buffer_load_dwordx4 v49, s[12:15], s36 offen offset:1024 lds
  buffer_load_dwordx4 v50, s[12:15], s36 offen offset:2048 lds
  buffer_load_dwordx4 v51, s[12:15], s36 offen offset:3072 lds
  s_add_u32 m0, s30, 69632
  s_waitcnt vmcnt(63)
  buffer_load_dwordx4 v52, s[12:15], s36 offen offset:0 lds
  buffer_load_dwordx4 v53, s[12:15], s36 offen offset:1024 lds
  buffer_load_dwordx4 v54, s[12:15], s36 offen offset:2048 lds
  buffer_load_dwordx4 v55, s[12:15], s36 offen offset:3072 lds
  s_add_u32 m0, s30, 73728
  s_waitcnt vmcnt(63)
  buffer_load_dwordx4 v56, s[12:15], s36 offen offset:0 lds
  buffer_load_dwordx4 v57, s[12:15], s36 offen offset:1024 lds
  buffer_load_dwordx4 v58, s[12:15], s36 offen offset:2048 lds
  buffer_load_dwordx4 v59, s[12:15], s36 offen offset:3072 lds
  s_add_u32 s30, s30, 12288
  s_cmp_eq_u32 s30, 86016
  s_cselect_b32 s30, 0, s30
  s_barrier
  s_mov_b32 s35, .g2_kernel_tab-.g2_kernel_pc+4
  s_mov_b32 s34, -5
  v_mov_b32 v10, 0
  s_mov_b32 m0, 156160
  s_add_u32 s36, s36, 196608
  buffer_load_dword off, s[64:67], s35 lds
  s_add_u32 s35, s35, 4
  s_branch .g2_kernel_p1_o
  .p2align 6
.g2_kernel_p1_l:
  s_waitcnt lgkmcnt(0)
  v_cmp_gt_i32 vcc, s34, v10
  s_cbranch_vccnz .g2_kernel_p1_aw
.g2_kernel_p1_ai:
  s_add_u32 s29, s29, 16384
  s_and_b32 s29, s29, 0xffff
  s_add_u32 m0, s29, 0
  s_waitcnt vmcnt(63)
  buffer_load_dwordx4 v32, s[8:11], s32 offen offset:0 lds
  buffer_load_dwordx4 v33, s[8:11], s32 offen offset:1024 lds
  buffer_load_dwordx4 v34, s[8:11], s32 offen offset:2048 lds
  buffer_load_dwordx4 v35, s[8:11], s32 offen offset:3072 lds
  s_add_u32 m0, s29, 4096
  s_waitcnt vmcnt(63)
  buffer_load_dwordx4 v36, s[8:11], s32 offen offset:0 lds
  buffer_load_dwordx4 v37, s[8:11], s32 offen offset:1024 lds
  buffer_load_dwordx4 v38, s[8:11], s32 offen offset:2048 lds
  buffer_load_dwordx4 v39, s[8:11], s32 offen offset:3072 lds
  s_add_u32 m0, s29, 8192
  s_waitcnt vmcnt(63)
  buffer_load_dwordx4 v40, s[8:11], s32 offen offset:0 lds
  buffer_load_dwordx4 v41, s[8:11], s32 offen offset:1024 lds
  buffer_load_dwordx4 v42, s[8:11], s32 offen offset:2048 lds
  buffer_load_dwordx4 v43, s[8:11], s32 offen offset:3072 lds
  s_add_u32 m0, s29, 12288
  s_waitcnt vmcnt(63)
  buffer_load_dwordx4 v44, s[8:11], s32 offen offset:0 lds
  buffer_load_dwordx4 v45, s[8:11], s32 offen offset:1024 lds
  buffer_load_dwordx4 v46, s[8:11], s32 offen offset:2048 lds
  buffer_load_dwordx4 v47, s[8:11], s32 offen offset:3072 lds
  s_add_u32 s32, s32, 128
  s_add_u32 m0, s30, 65536
  s_waitcnt vmcnt(63)
  buffer_load_dwordx4 v48, s[12:15], s36 offen offset:0 lds
  buffer_load_dwordx4 v49, s[12:15], s36 offen offset:1024 lds
  buffer_load_dwordx4 v50, s[12:15], s36 offen offset:2048 lds
  buffer_load_dwordx4 v51, s[12:15], s36 offen offset:3072 lds
  s_add_u32 m0, s30, 69632
  s_waitcnt vmcnt(63)
  buffer_load_dwordx4 v52, s[12:15], s36 offen offset:0 lds
  buffer_load_dwordx4 v53, s[12:15], s36 offen offset:1024 lds
  buffer_load_dwordx4 v54, s[12:15], s36 offen offset:2048 lds
  buffer_load_dwordx4 v55, s[12:15], s36 offen offset:3072 lds
  s_add_u32 m0, s30, 73728
  s_waitcnt vmcnt(63)
  buffer_load_dwordx4 v56, s[12:15], s36 offen offset:0 lds
  buffer_load_dwordx4 v57, s[12:15], s36 offen offset:1024 lds
  buffer_load_dwordx4 v58, s[12:15], s36 offen offset:2048 lds
  buffer_load_dwordx4 v59, s[12:15], s36 offen offset:3072 lds
  s_add_u32 s30, s30, 12288
  s_cmp_eq_u32 s30, 86016
  s_cselect_b32 s30, 0, s30
  ds_read_b32 v10, v9
  s_mov_b32 m0, 156160
  s_add_u32 s34, s34, 1
  buffer_load_dword off, s[64:67], s35 lds
  s_add_u32 s35, s35, 4
  s_add_u32 s36, s36, 196608
.g2_kernel_p1_o:
  s_waitcnt lgkmcnt(0)
  v_cmp_gt_i32 vcc, s34, v10
  s_cbranch_vccnz .g2_kernel_p1_bw
.g2_kernel_p1_bi:
  s_add_u32 m0, s30, 65536
  s_waitcnt vmcnt(63)
  buffer_load_dwordx4 v48, s[12:15], s36 offen offset:0 lds
  buffer_load_dwordx4 v49, s[12:15], s36 offen offset:1024 lds
  buffer_load_dwordx4 v50, s[12:15], s36 offen offset:2048 lds
  buffer_load_dwordx4 v51, s[12:15], s36 offen offset:3072 lds
  s_add_u32 m0, s30, 69632
  s_waitcnt vmcnt(63)
  buffer_load_dwordx4 v52, s[12:15], s36 offen offset:0 lds
  buffer_load_dwordx4 v53, s[12:15], s36 offen offset:1024 lds
  buffer_load_dwordx4 v54, s[12:15], s36 offen offset:2048 lds
  buffer_load_dwordx4 v55, s[12:15], s36 offen offset:3072 lds
  s_add_u32 m0, s30, 73728
  s_waitcnt vmcnt(63)
  buffer_load_dwordx4 v56, s[12:15], s36 offen offset:0 lds
  buffer_load_dwordx4 v57, s[12:15], s36 offen offset:1024 lds
  buffer_load_dwordx4 v58, s[12:15], s36 offen offset:2048 lds
  buffer_load_dwordx4 v59, s[12:15], s36 offen offset:3072 lds
  s_add_u32 s30, s30, 12288
  s_cmp_eq_u32 s30, 86016
  s_cselect_b32 s30, 0, s30
  ds_read_b32 v10, v9
  s_mov_b32 m0, 156160
  s_add_u32 s34, s34, 1
  buffer_load_dword off, s[64:67], s35 lds
  s_add_u32 s35, s35, 4
  s_add_u32 s36, s36, 196608
  s_cmp_lt_i32 s34, 26
  s_cbranch_scc1 .g2_kernel_p1_l
  s_branch .g2_kernel_v
.g2_kernel_s1:
  s_mov_b32 s8, s40
  s_mov_b32 s9, s41
  s_mov_b32 s10, 0x400000
  s_mov_b32 s11, 0x00020000
  v_lshrrev_b32 v20, 3, v2
  v_and_b32 v21, 7, v2
  v_lshlrev_b32 v21, 4, v21
  v_lshl_add_u32 v21, v20, 11, v21
  s_lshl_b32 s30, s17, 4
  s_add_u32 s30, s30, s18
  s_lshl_b32 s33, s30, 5
  s_lshl_b32 s30, s30, 14
  s_barrier
  s_sleep 30
  buffer_load_dwordx4 v[64:67], v21, s[8:11], s30 offen offset:0
  buffer_load_dwordx4 v[68:71], v21, s[8:11], s30 offen offset:128
  buffer_load_dwordx4 v[72:75], v21, s[8:11], s30 offen offset:256
  buffer_load_dwordx4 v[76:79], v21, s[8:11], s30 offen offset:384
  buffer_load_dwordx4 v[80:83], v21, s[8:11], s30 offen offset:512
  buffer_load_dwordx4 v[84:87], v21, s[8:11], s30 offen offset:640
  buffer_load_dwordx4 v[88:91], v21, s[8:11], s30 offen offset:768
  buffer_load_dwordx4 v[92:95], v21, s[8:11], s30 offen offset:896
  buffer_load_dwordx4 v[96:99], v21, s[8:11], s30 offen offset:1024
  buffer_load_dwordx4 v[100:103], v21, s[8:11], s30 offen offset:1152
  buffer_load_dwordx4 v[104:107], v21, s[8:11], s30 offen offset:1280
  buffer_load_dwordx4 v[108:111], v21, s[8:11], s30 offen offset:1408
  buffer_load_dwordx4 v[112:115], v21, s[8:11], s30 offen offset:1536
  buffer_load_dwordx4 v[116:119], v21, s[8:11], s30 offen offset:1664
  buffer_load_dwordx4 v[120:123], v21, s[8:11], s30 offen offset:1792
  buffer_load_dwordx4 v[124:127], v21, s[8:11], s30 offen offset:1920
  v_mov_b32 v24, 0
  v_mov_b32 v25, 0
  v_mov_b32 v26, 0
  v_mov_b32 v27, 0
  s_waitcnt vmcnt(15)
  v_lshlrev_b32 v22, 16, v64
  v_and_b32 v64, 0xffff0000, v64
  v_add_f32 v24, v24, v22
  v_fmac_f32 v25, v22, v22
  v_add_f32 v26, v26, v64
  v_fmac_f32 v27, v64, v64
  v_lshlrev_b32 v22, 16, v65
  v_and_b32 v65, 0xffff0000, v65
  v_add_f32 v24, v24, v22
  v_fmac_f32 v25, v22, v22
  v_add_f32 v26, v26, v65
  v_fmac_f32 v27, v65, v65
  v_lshlrev_b32 v22, 16, v66
  v_and_b32 v66, 0xffff0000, v66
  v_add_f32 v24, v24, v22
  v_fmac_f32 v25, v22, v22
  v_add_f32 v26, v26, v66
  v_fmac_f32 v27, v66, v66
  v_lshlrev_b32 v22, 16, v67
  v_and_b32 v67, 0xffff0000, v67
  v_add_f32 v24, v24, v22
  v_fmac_f32 v25, v22, v22
  v_add_f32 v26, v26, v67
  v_fmac_f32 v27, v67, v67
  s_waitcnt vmcnt(14)
  v_lshlrev_b32 v22, 16, v68
  v_and_b32 v68, 0xffff0000, v68
  v_add_f32 v24, v24, v22
  v_fmac_f32 v25, v22, v22
  v_add_f32 v26, v26, v68
  v_fmac_f32 v27, v68, v68
  v_lshlrev_b32 v22, 16, v69
  v_and_b32 v69, 0xffff0000, v69
  v_add_f32 v24, v24, v22
  v_fmac_f32 v25, v22, v22
  v_add_f32 v26, v26, v69
  v_fmac_f32 v27, v69, v69
  v_lshlrev_b32 v22, 16, v70
  v_and_b32 v70, 0xffff0000, v70
  v_add_f32 v24, v24, v22
  v_fmac_f32 v25, v22, v22
  v_add_f32 v26, v26, v70
  v_fmac_f32 v27, v70, v70
  v_lshlrev_b32 v22, 16, v71
  v_and_b32 v71, 0xffff0000, v71
  v_add_f32 v24, v24, v22
  v_fmac_f32 v25, v22, v22
  v_add_f32 v26, v26, v71
  v_fmac_f32 v27, v71, v71
  s_waitcnt vmcnt(13)
  v_lshlrev_b32 v22, 16, v72
  v_and_b32 v72, 0xffff0000, v72
  v_add_f32 v24, v24, v22
  v_fmac_f32 v25, v22, v22
  v_add_f32 v26, v26, v72
  v_fmac_f32 v27, v72, v72
  v_lshlrev_b32 v22, 16, v73
  v_and_b32 v73, 0xffff0000, v73
  v_add_f32 v24, v24, v22
  v_fmac_f32 v25, v22, v22
  v_add_f32 v26, v26, v73
  v_fmac_f32 v27, v73, v73
  v_lshlrev_b32 v22, 16, v74
  v_and_b32 v74, 0xffff0000, v74
  v_add_f32 v24, v24, v22
  v_fmac_f32 v25, v22, v22
  v_add_f32 v26, v26, v74
  v_fmac_f32 v27, v74, v74
  v_lshlrev_b32 v22, 16, v75
  v_and_b32 v75, 0xffff0000, v75
  v_add_f32 v24, v24, v22
  v_fmac_f32 v25, v22, v22
  v_add_f32 v26, v26, v75
  v_fmac_f32 v27, v75, v75
  s_waitcnt vmcnt(12)
  v_lshlrev_b32 v22, 16, v76
  v_and_b32 v76, 0xffff0000, v76
  v_add_f32 v24, v24, v22
  v_fmac_f32 v25, v22, v22
  v_add_f32 v26, v26, v76
  v_fmac_f32 v27, v76, v76
  v_lshlrev_b32 v22, 16, v77
  v_and_b32 v77, 0xffff0000, v77
  v_add_f32 v24, v24, v22
  v_fmac_f32 v25, v22, v22
  v_add_f32 v26, v26, v77
  v_fmac_f32 v27, v77, v77
  v_lshlrev_b32 v22, 16, v78
  v_and_b32 v78, 0xffff0000, v78
  v_add_f32 v24, v24, v22
  v_fmac_f32 v25, v22, v22
  v_add_f32 v26, v26, v78
  v_fmac_f32 v27, v78, v78
  v_lshlrev_b32 v22, 16, v79
  v_and_b32 v79, 0xffff0000, v79
  v_add_f32 v24, v24, v22
  v_fmac_f32 v25, v22, v22
  v_add_f32 v26, v26, v79
  v_fmac_f32 v27, v79, v79
  s_waitcnt vmcnt(11)
  v_lshlrev_b32 v22, 16, v80
  v_and_b32 v80, 0xffff0000, v80
  v_add_f32 v24, v24, v22
  v_fmac_f32 v25, v22, v22
  v_add_f32 v26, v26, v80
  v_fmac_f32 v27, v80, v80
  v_lshlrev_b32 v22, 16, v81
  v_and_b32 v81, 0xffff0000, v81
  v_add_f32 v24, v24, v22
  v_fmac_f32 v25, v22, v22
  v_add_f32 v26, v26, v81
  v_fmac_f32 v27, v81, v81
  v_lshlrev_b32 v22, 16, v82
  v_and_b32 v82, 0xffff0000, v82
  v_add_f32 v24, v24, v22
  v_fmac_f32 v25, v22, v22
  v_add_f32 v26, v26, v82
  v_fmac_f32 v27, v82, v82
  v_lshlrev_b32 v22, 16, v83
  v_and_b32 v83, 0xffff0000, v83
  v_add_f32 v24, v24, v22
  v_fmac_f32 v25, v22, v22
  v_add_f32 v26, v26, v83
  v_fmac_f32 v27, v83, v83
  s_waitcnt vmcnt(10)
  v_lshlrev_b32 v22, 16, v84
  v_and_b32 v84, 0xffff0000, v84
  v_add_f32 v24, v24, v22
  v_fmac_f32 v25, v22, v22
  v_add_f32 v26, v26, v84
  v_fmac_f32 v27, v84, v84
  v_lshlrev_b32 v22, 16, v85
  v_and_b32 v85, 0xffff0000, v85
  v_add_f32 v24, v24, v22
  v_fmac_f32 v25, v22, v22
  v_add_f32 v26, v26, v85
  v_fmac_f32 v27, v85, v85
  v_lshlrev_b32 v22, 16, v86
  v_and_b32 v86, 0xffff0000, v86
  v_add_f32 v24, v24, v22
  v_fmac_f32 v25, v22, v22
  v_add_f32 v26, v26, v86
  v_fmac_f32 v27, v86, v86
  v_lshlrev_b32 v22, 16, v87
  v_and_b32 v87, 0xffff0000, v87
  v_add_f32 v24, v24, v22
  v_fmac_f32 v25, v22, v22
  v_add_f32 v26, v26, v87
  v_fmac_f32 v27, v87, v87
  s_waitcnt vmcnt(9)
  v_lshlrev_b32 v22, 16, v88
  v_and_b32 v88, 0xffff0000, v88
  v_add_f32 v24, v24, v22
  v_fmac_f32 v25, v22, v22
  v_add_f32 v26, v26, v88
  v_fmac_f32 v27, v88, v88
  v_lshlrev_b32 v22, 16, v89
  v_and_b32 v89, 0xffff0000, v89
  v_add_f32 v24, v24, v22
  v_fmac_f32 v25, v22, v22
  v_add_f32 v26, v26, v89
  v_fmac_f32 v27, v89, v89
  v_lshlrev_b32 v22, 16, v90
  v_and_b32 v90, 0xffff0000, v90
  v_add_f32 v24, v24, v22
  v_fmac_f32 v25, v22, v22
  v_add_f32 v26, v26, v90
  v_fmac_f32 v27, v90, v90
  v_lshlrev_b32 v22, 16, v91
  v_and_b32 v91, 0xffff0000, v91
  v_add_f32 v24, v24, v22
  v_fmac_f32 v25, v22, v22
  v_add_f32 v26, v26, v91
  v_fmac_f32 v27, v91, v91
  s_waitcnt vmcnt(8)
  v_lshlrev_b32 v22, 16, v92
  v_and_b32 v92, 0xffff0000, v92
  v_add_f32 v24, v24, v22
  v_fmac_f32 v25, v22, v22
  v_add_f32 v26, v26, v92
  v_fmac_f32 v27, v92, v92
  v_lshlrev_b32 v22, 16, v93
  v_and_b32 v93, 0xffff0000, v93
  v_add_f32 v24, v24, v22
  v_fmac_f32 v25, v22, v22
  v_add_f32 v26, v26, v93
  v_fmac_f32 v27, v93, v93
  v_lshlrev_b32 v22, 16, v94
  v_and_b32 v94, 0xffff0000, v94
  v_add_f32 v24, v24, v22
  v_fmac_f32 v25, v22, v22
  v_add_f32 v26, v26, v94
  v_fmac_f32 v27, v94, v94
  v_lshlrev_b32 v22, 16, v95
  v_and_b32 v95, 0xffff0000, v95
  v_add_f32 v24, v24, v22
  v_fmac_f32 v25, v22, v22
  v_add_f32 v26, v26, v95
  v_fmac_f32 v27, v95, v95
  s_waitcnt vmcnt(7)
  v_lshlrev_b32 v22, 16, v96
  v_and_b32 v96, 0xffff0000, v96
  v_add_f32 v24, v24, v22
  v_fmac_f32 v25, v22, v22
  v_add_f32 v26, v26, v96
  v_fmac_f32 v27, v96, v96
  v_lshlrev_b32 v22, 16, v97
  v_and_b32 v97, 0xffff0000, v97
  v_add_f32 v24, v24, v22
  v_fmac_f32 v25, v22, v22
  v_add_f32 v26, v26, v97
  v_fmac_f32 v27, v97, v97
  v_lshlrev_b32 v22, 16, v98
  v_and_b32 v98, 0xffff0000, v98
  v_add_f32 v24, v24, v22
  v_fmac_f32 v25, v22, v22
  v_add_f32 v26, v26, v98
  v_fmac_f32 v27, v98, v98
  v_lshlrev_b32 v22, 16, v99
  v_and_b32 v99, 0xffff0000, v99
  v_add_f32 v24, v24, v22
  v_fmac_f32 v25, v22, v22
  v_add_f32 v26, v26, v99
  v_fmac_f32 v27, v99, v99
  s_waitcnt vmcnt(6)
  v_lshlrev_b32 v22, 16, v100
  v_and_b32 v100, 0xffff0000, v100
  v_add_f32 v24, v24, v22
  v_fmac_f32 v25, v22, v22
  v_add_f32 v26, v26, v100
  v_fmac_f32 v27, v100, v100
  v_lshlrev_b32 v22, 16, v101
  v_and_b32 v101, 0xffff0000, v101
  v_add_f32 v24, v24, v22
  v_fmac_f32 v25, v22, v22
  v_add_f32 v26, v26, v101
  v_fmac_f32 v27, v101, v101
  v_lshlrev_b32 v22, 16, v102
  v_and_b32 v102, 0xffff0000, v102
  v_add_f32 v24, v24, v22
  v_fmac_f32 v25, v22, v22
  v_add_f32 v26, v26, v102
  v_fmac_f32 v27, v102, v102
  v_lshlrev_b32 v22, 16, v103
  v_and_b32 v103, 0xffff0000, v103
  v_add_f32 v24, v24, v22
  v_fmac_f32 v25, v22, v22
  v_add_f32 v26, v26, v103
  v_fmac_f32 v27, v103, v103
  s_waitcnt vmcnt(5)
  v_lshlrev_b32 v22, 16, v104
  v_and_b32 v104, 0xffff0000, v104
  v_add_f32 v24, v24, v22
  v_fmac_f32 v25, v22, v22
  v_add_f32 v26, v26, v104
  v_fmac_f32 v27, v104, v104
  v_lshlrev_b32 v22, 16, v105
  v_and_b32 v105, 0xffff0000, v105
  v_add_f32 v24, v24, v22
  v_fmac_f32 v25, v22, v22
  v_add_f32 v26, v26, v105
  v_fmac_f32 v27, v105, v105
  v_lshlrev_b32 v22, 16, v106
  v_and_b32 v106, 0xffff0000, v106
  v_add_f32 v24, v24, v22
  v_fmac_f32 v25, v22, v22
  v_add_f32 v26, v26, v106
  v_fmac_f32 v27, v106, v106
  v_lshlrev_b32 v22, 16, v107
  v_and_b32 v107, 0xffff0000, v107
  v_add_f32 v24, v24, v22
  v_fmac_f32 v25, v22, v22
  v_add_f32 v26, v26, v107
  v_fmac_f32 v27, v107, v107
  s_waitcnt vmcnt(4)
  v_lshlrev_b32 v22, 16, v108
  v_and_b32 v108, 0xffff0000, v108
  v_add_f32 v24, v24, v22
  v_fmac_f32 v25, v22, v22
  v_add_f32 v26, v26, v108
  v_fmac_f32 v27, v108, v108
  v_lshlrev_b32 v22, 16, v109
  v_and_b32 v109, 0xffff0000, v109
  v_add_f32 v24, v24, v22
  v_fmac_f32 v25, v22, v22
  v_add_f32 v26, v26, v109
  v_fmac_f32 v27, v109, v109
  v_lshlrev_b32 v22, 16, v110
  v_and_b32 v110, 0xffff0000, v110
  v_add_f32 v24, v24, v22
  v_fmac_f32 v25, v22, v22
  v_add_f32 v26, v26, v110
  v_fmac_f32 v27, v110, v110
  v_lshlrev_b32 v22, 16, v111
  v_and_b32 v111, 0xffff0000, v111
  v_add_f32 v24, v24, v22
  v_fmac_f32 v25, v22, v22
  v_add_f32 v26, v26, v111
  v_fmac_f32 v27, v111, v111
  s_waitcnt vmcnt(3)
  v_lshlrev_b32 v22, 16, v112
  v_and_b32 v112, 0xffff0000, v112
  v_add_f32 v24, v24, v22
  v_fmac_f32 v25, v22, v22
  v_add_f32 v26, v26, v112
  v_fmac_f32 v27, v112, v112
  v_lshlrev_b32 v22, 16, v113
  v_and_b32 v113, 0xffff0000, v113
  v_add_f32 v24, v24, v22
  v_fmac_f32 v25, v22, v22
  v_add_f32 v26, v26, v113
  v_fmac_f32 v27, v113, v113
  v_lshlrev_b32 v22, 16, v114
  v_and_b32 v114, 0xffff0000, v114
  v_add_f32 v24, v24, v22
  v_fmac_f32 v25, v22, v22
  v_add_f32 v26, v26, v114
  v_fmac_f32 v27, v114, v114
  v_lshlrev_b32 v22, 16, v115
  v_and_b32 v115, 0xffff0000, v115
  v_add_f32 v24, v24, v22
  v_fmac_f32 v25, v22, v22
  v_add_f32 v26, v26, v115
  v_fmac_f32 v27, v115, v115
  s_waitcnt vmcnt(2)
  v_lshlrev_b32 v22, 16, v116
  v_and_b32 v116, 0xffff0000, v116
  v_add_f32 v24, v24, v22
  v_fmac_f32 v25, v22, v22
  v_add_f32 v26, v26, v116
  v_fmac_f32 v27, v116, v116
  v_lshlrev_b32 v22, 16, v117
  v_and_b32 v117, 0xffff0000, v117
  v_add_f32 v24, v24, v22
  v_fmac_f32 v25, v22, v22
  v_add_f32 v26, v26, v117
  v_fmac_f32 v27, v117, v117
  v_lshlrev_b32 v22, 16, v118
  v_and_b32 v118, 0xffff0000, v118
  v_add_f32 v24, v24, v22
  v_fmac_f32 v25, v22, v22
  v_add_f32 v26, v26, v118
  v_fmac_f32 v27, v118, v118
  v_lshlrev_b32 v22, 16, v119
  v_and_b32 v119, 0xffff0000, v119
  v_add_f32 v24, v24, v22
  v_fmac_f32 v25, v22, v22
  v_add_f32 v26, v26, v119
  v_fmac_f32 v27, v119, v119
  s_waitcnt vmcnt(1)
  v_lshlrev_b32 v22, 16, v120
  v_and_b32 v120, 0xffff0000, v120
  v_add_f32 v24, v24, v22
  v_fmac_f32 v25, v22, v22
  v_add_f32 v26, v26, v120
  v_fmac_f32 v27, v120, v120
  v_lshlrev_b32 v22, 16, v121
  v_and_b32 v121, 0xffff0000, v121
  v_add_f32 v24, v24, v22
  v_fmac_f32 v25, v22, v22
  v_add_f32 v26, v26, v121
  v_fmac_f32 v27, v121, v121
  v_lshlrev_b32 v22, 16, v122
  v_and_b32 v122, 0xffff0000, v122
  v_add_f32 v24, v24, v22
  v_fmac_f32 v25, v22, v22
  v_add_f32 v26, v26, v122
  v_fmac_f32 v27, v122, v122
  v_lshlrev_b32 v22, 16, v123
  v_and_b32 v123, 0xffff0000, v123
  v_add_f32 v24, v24, v22
  v_fmac_f32 v25, v22, v22
  v_add_f32 v26, v26, v123
  v_fmac_f32 v27, v123, v123
  s_waitcnt vmcnt(0)
  v_lshlrev_b32 v22, 16, v124
  v_and_b32 v124, 0xffff0000, v124
  v_add_f32 v24, v24, v22
  v_fmac_f32 v25, v22, v22
  v_add_f32 v26, v26, v124
  v_fmac_f32 v27, v124, v124
  v_lshlrev_b32 v22, 16, v125
  v_and_b32 v125, 0xffff0000, v125
  v_add_f32 v24, v24, v22
  v_fmac_f32 v25, v22, v22
  v_add_f32 v26, v26, v125
  v_fmac_f32 v27, v125, v125
  v_lshlrev_b32 v22, 16, v126
  v_and_b32 v126, 0xffff0000, v126
  v_add_f32 v24, v24, v22
  v_fmac_f32 v25, v22, v22
  v_add_f32 v26, v26, v126
  v_fmac_f32 v27, v126, v126
  v_lshlrev_b32 v22, 16, v127
  v_and_b32 v127, 0xffff0000, v127
  v_add_f32 v24, v24, v22
  v_fmac_f32 v25, v22, v22
  v_add_f32 v26, v26, v127
  v_fmac_f32 v27, v127, v127
  v_add_f32 v24, v24, v26
  v_add_f32 v25, v25, v27
  s_nop 0
  v_add_f32 v24, v24, v24 quad_perm:[1,0,3,2] row_mask:0xf bank_mask:0xf
  v_add_f32 v25, v25, v25 quad_perm:[1,0,3,2] row_mask:0xf bank_mask:0xf
  s_nop 0
  v_add_f32 v24, v24, v24 quad_perm:[2,3,0,1] row_mask:0xf bank_mask:0xf
  v_add_f32 v25, v25, v25 quad_perm:[2,3,0,1] row_mask:0xf bank_mask:0xf
  s_nop 0
  v_add_f32 v24, v24, v24 row_half_mirror row_mask:0xf bank_mask:0xf
  v_add_f32 v25, v25, v25 row_half_mirror row_mask:0xf bank_mask:0xf
  v_mov_b32 v26, 0.0009765625
  v_mul_f32 v24, v26, v24
  v_mul_f32 v27, v24, v24
  v_fma_f32 v25, v25, v26, -v27
  v_max_f32 v25, 0, v25
  v_add_f32 v25, 1e-05, v25
  v_rsq_f32 v25, v25
  v_lshlrev_b32 v20, 2, v20
  v_mul_f32 v24, v24, v25
  v_sub_f32 v24, 0, v24
  s_add_u32 s33, s33, 0x3070000
  s_add_u32 s34, s33, 0x2000
  s_mov_b32 exec_lo, 0x01010101
  s_mov_b32 exec_hi, 0x01010101
  buffer_store_dword v25, v20, s[4:7], s33 offen sc1
  buffer_store_dword v24, v20, s[4:7], s34 offen sc1
  s_mov_b64 exec, -1
  s_mov_b32 s12, s58
  s_mov_b32 s13, s59
  s_mov_b32 s14, 0x100
  s_mov_b32 s15, 0x00020000
  s_mov_b32 s38, 0
  s_mov_b64 exec, 1
.g2_kernel_gt6:
  buffer_load_dword v6, v4, s[12:15], 0 offen sc1
  s_add_u32 s38, s38, 1
  s_waitcnt vmcnt(0)
  v_cmp_eq_u32 vcc, 0x60, v6
  s_cbranch_vccnz .g2_kernel_gt6d
  s_sleep 8
  s_cmp_lt_u32 s38, 131072
  s_cbranch_scc1 .g2_kernel_gt6
.g2_kernel_gt6d:
  s_mov_b64 exec, -1
  v_mov_b32 v6, s70
  s_mov_b64 exec, 1
  buffer_store_dword v6, v4, s[4:7], s19 offen offset:12 sc1
  s_mov_b64 exec, -1
  v_mov_b32 v6, 155648
  s_mov_b32 s38, 0
.g2_kernel_wg7:
  ds_read_b32 v7, v6 offset:512
  s_add_u32 s38, s38, 1
  s_waitcnt lgkmcnt(0)
  v_cmp_le_u32 vcc, 27, v7
  s_cbranch_vccnz .g2_kernel_wg7d
  s_sleep 4
  s_cmp_lt_u32 s38, 524288
  s_cbranch_scc1 .g2_kernel_wg7
.g2_kernel_wg7d:
  s_and_b32 s31, s19, 0xffffe000
  s_add_u32 s31, s31, 12
  v_and_b32 v6, 15, v2
  v_lshlrev_b32 v6, 9, v6
  v_lshrrev_b32 v7, 4, v2
  v_lshl_add_u32 v6, v7, 7, v6
  v_lshlrev_b32 v7, 2, v2
  v_add_u32 v7, 157952, v7
  s_mov_b32 m0, 157952
  s_mov_b32 s38, 0
  s_bfm_b64 exec, 16, 0
.g2_kernel_pa8:
  buffer_load_dword v6, s[4:7], s31 offen sc1 lds
  s_add_u32 s38, s38, 1
  s_waitcnt vmcnt(0)
  ds_read_b32 v8, v7
  s_waitcnt lgkmcnt(0)
  v_cmp_ge_u32 vcc, s62, v8
  s_cbranch_vccz .g2_kernel_pa8d
  s_mov_b64 exec, vcc
  s_sleep 16
  s_cmp_lt_u32 s38, 131072
  s_cbranch_scc1 .g2_kernel_pa8
.g2_kernel_pa8d:
  s_mov_b64 exec, -1
  s_lshl_b32 s33, s17, 9
  s_add_u32 s33, s33, 0x3070000
  s_add_u32 s34, s33, 0x2000
  s_mov_b32 exec_hi, 0
  s_mov_b32 m0, 158464
  s_nop 0
  buffer_load_dwordx4 v3, s[4:7], s33 offen sc1 lds
  s_mov_b32 m0, 158976
  s_nop 0
  buffer_load_dwordx4 v3, s[4:7], s34 offen sc1 lds
  s_mov_b64 exec, -1
  v_mov_b32 v20, 1.0
  v_mov_b32 v21, 1.0
  v_mov_b32 v22, 0
  v_mov_b32 v23, 0
  v_lshlrev_b32 v24, 3, v2
  v_add_u32 v24, 155648, v24
  v_mov_b32 v6, 155648
  s_mov_b32 s38, 0
.g2_kernel_wg9:
  ds_read_b32 v7, v6 offset:512
  s_add_u32 s38, s38, 1
  s_waitcnt lgkmcnt(0)
  v_cmp_le_u32 vcc, 32, v7
  s_cbranch_vccnz .g2_kernel_wg9d
  s_sleep 2
  s_cmp_lt_u32 s38, 524288
  s_cbranch_scc1 .g2_kernel_wg9
.g2_kernel_wg9d:
  ds_write_b64 v24, v[20:21] offset:3840
  ds_write_b64 v24, v[22:23] offset:4352
  v_lshlrev_b32 v24, 2, v2
  v_add_u32 v24, 155648, v24
  ds_write_b32 v24, v4 offset:2304
  s_waitcnt vmcnt(0)
  v_mov_b32 v6, s71
  s_mov_b64 exec, 1
  ds_add_u32 v6, v5 offset:0
  s_mov_b64 exec, -1
  s_branch .g2_kernel_v
.g2_kernel_s2:
  s_mov_b32 s8, s42
  s_mov_b32 s9, s43
  s_mov_b32 s10, 0x600000
  s_mov_b32 s11, 0x00020000
  v_lshrrev_b32 v20, 3, v2
  v_and_b32 v21, 7, v2
  v_mul_u32_u24 v20, 6144, v20
  v_lshl_add_u32 v20, v21, 4, v20
  s_mul_i32 s30, s17, 393216
  s_lshl_b32 s31, s18, 7
  s_add_u32 s30, s30, s31
  s_add_u32 s31, s30, 4096
  s_barrier
  s_sleep 30
  buffer_load_dwordx4 v[64:67], v20, s[8:11], s30 offen
  buffer_load_dwordx4 v[68:71], v20, s[8:11], s30 offen offset:2048
  buffer_load_dwordx4 v[72:75], v20, s[8:11], s31 offen
  s_add_u32 s30, s30, 49152
  s_add_u32 s31, s31, 49152
  buffer_load_dwordx4 v[76:79], v20, s[8:11], s30 offen
  buffer_load_dwordx4 v[80:83], v20, s[8:11], s30 offen offset:2048
  buffer_load_dwordx4 v[84:87], v20, s[8:11], s31 offen
  s_add_u32 s30, s30, 49152
  s_add_u32 s31, s31, 49152
  buffer_load_dwordx4 v[88:91], v20, s[8:11], s30 offen
  buffer_load_dwordx4 v[92:95], v20, s[8:11], s30 offen offset:2048
  buffer_load_dwordx4 v[96:99], v20, s[8:11], s31 offen
  s_add_u32 s30, s30, 49152
  s_add_u32 s31, s31, 49152
  buffer_load_dwordx4 v[100:103], v20, s[8:11], s30 offen
  buffer_load_dwordx4 v[104:107], v20, s[8:11], s30 offen offset:2048
  buffer_load_dwordx4 v[108:111], v20, s[8:11], s31 offen
  s_add_u32 s30, s30, 49152
  s_add_u32 s31, s31, 49152
  buffer_load_dwordx4 v[112:115], v20, s[8:11], s30 offen
  buffer_load_dwordx4 v[116:119], v20, s[8:11], s30 offen offset:2048
  buffer_load_dwordx4 v[120:123], v20, s[8:11], s31 offen
  s_add_u32 s30, s30, 49152
  s_add_u32 s31, s31, 49152
  buffer_load_dwordx4 v[124:127], v20, s[8:11], s30 offen
  buffer_load_dwordx4 v[128:131], v20, s[8:11], s30 offen offset:2048
  buffer_load_dwordx4 v[132:135], v20, s[8:11], s31 offen
  s_add_u32 s30, s30, 49152
  s_add_u32 s31, s31, 49152
  buffer_load_dwordx4 v[136:139], v20, s[8:11], s30 offen
  buffer_load_dwordx4 v[140:143], v20, s[8:11], s30 offen offset:2048
  buffer_load_dwordx4 v[144:147], v20, s[8:11], s31 offen
  s_add_u32 s30, s30, 49152
  s_add_u32 s31, s31, 49152
  buffer_load_dwordx4 v[148:151], v20, s[8:11], s30 offen
  buffer_load_dwordx4 v[152:155], v20, s[8:11], s30 offen offset:2048
  buffer_load_dwordx4 v[156:159], v20, s[8:11], s31 offen
  s_add_u32 s30, s30, 49152
  s_add_u32 s31, s31, 49152
  v_lshlrev_b32 v21, 5, v21
  v_lshrrev_b32 v22, 5, v2
  v_lshl_add_u32 v21, v22, 4, v21
  v_bfe_u32 v22, v2, 4, 1
  v_lshl_add_u32 v21, v22, 3, v21
  s_lshl_b32 s30, s18, 4
  s_add_u32 s30, s30, s17
  s_mul_i32 s30, s30, 768
  s_add_u32 s30, s30, 0x3080000
  s_waitcnt vmcnt(23)
  v_lshlrev_b32 v160, 16, v64
  v_and_b32 v161, 0xffff0000, v64
  v_lshlrev_b32 v162, 16, v65
  v_and_b32 v163, 0xffff0000, v65
  v_lshlrev_b32 v164, 16, v66
  v_and_b32 v165, 0xffff0000, v66
  v_lshlrev_b32 v166, 16, v67
  v_and_b32 v167, 0xffff0000, v67
  s_waitcnt vmcnt(22)
  v_lshlrev_b32 v168, 16, v68
  v_and_b32 v169, 0xffff0000, v68
  v_lshlrev_b32 v170, 16, v69
  v_and_b32 v171, 0xffff0000, v69
  v_lshlrev_b32 v172, 16, v70
  v_and_b32 v173, 0xffff0000, v70
  v_lshlrev_b32 v174, 16, v71
  v_and_b32 v175, 0xffff0000, v71
  s_waitcnt vmcnt(21)
  v_lshlrev_b32 v176, 16, v72
  v_and_b32 v177, 0xffff0000, v72
  v_lshlrev_b32 v178, 16, v73
  v_and_b32 v179, 0xffff0000, v73
  v_lshlrev_b32 v180, 16, v74
  v_and_b32 v181, 0xffff0000, v74
  v_lshlrev_b32 v182, 16, v75
  v_and_b32 v183, 0xffff0000, v75
  s_waitcnt vmcnt(20)
  v_lshlrev_b32 v184, 16, v76
  v_and_b32 v185, 0xffff0000, v76
  v_lshlrev_b32 v186, 16, v77
  v_and_b32 v187, 0xffff0000, v77
  v_lshlrev_b32 v188, 16, v78
  v_and_b32 v189, 0xffff0000, v78
  v_lshlrev_b32 v190, 16, v79
  v_and_b32 v191, 0xffff0000, v79
  v_add_f32 v160, v160, v184
  v_add_f32 v161, v161, v185
  v_add_f32 v162, v162, v186
  v_add_f32 v163, v163, v187
  v_add_f32 v164, v164, v188
  v_add_f32 v165, v165, v189
  v_add_f32 v166, v166, v190
  v_add_f32 v167, v167, v191
  s_waitcnt vmcnt(19)
  v_lshlrev_b32 v184, 16, v80
  v_and_b32 v185, 0xffff0000, v80
  v_lshlrev_b32 v186, 16, v81
  v_and_b32 v187, 0xffff0000, v81
  v_lshlrev_b32 v188, 16, v82
  v_and_b32 v189, 0xffff0000, v82
  v_lshlrev_b32 v190, 16, v83
  v_and_b32 v191, 0xffff0000, v83
  v_add_f32 v168, v168, v184
  v_add_f32 v169, v169, v185
  v_add_f32 v170, v170, v186
  v_add_f32 v171, v171, v187
  v_add_f32 v172, v172, v188
  v_add_f32 v173, v173, v189
  v_add_f32 v174, v174, v190
  v_add_f32 v175, v175, v191
  s_waitcnt vmcnt(18)
  v_lshlrev_b32 v184, 16, v84
  v_and_b32 v185, 0xffff0000, v84
  v_lshlrev_b32 v186, 16, v85
  v_and_b32 v187, 0xffff0000, v85
  v_lshlrev_b32 v188, 16, v86
  v_and_b32 v189, 0xffff0000, v86
  v_lshlrev_b32 v190, 16, v87
  v_and_b32 v191, 0xffff0000, v87
  v_add_f32 v176, v176, v184
  v_add_f32 v177, v177, v185
  v_add_f32 v178, v178, v186
  v_add_f32 v179, v179, v187
  v_add_f32 v180, v180, v188
  v_add_f32 v181, v181, v189
  v_add_f32 v182, v182, v190
  v_add_f32 v183, v183, v191
  s_waitcnt vmcnt(17)
  v_lshlrev_b32 v184, 16, v88
  v_and_b32 v185, 0xffff0000, v88
  v_lshlrev_b32 v186, 16, v89
  v_and_b32 v187, 0xffff0000, v89
  v_lshlrev_b32 v188, 16, v90
  v_and_b32 v189, 0xffff0000, v90
  v_lshlrev_b32 v190, 16, v91
  v_and_b32 v191, 0xffff0000, v91
  v_add_f32 v160, v160, v184
  v_add_f32 v161, v161, v185
  v_add_f32 v162, v162, v186
  v_add_f32 v163, v163, v187
  v_add_f32 v164, v164, v188
  v_add_f32 v165, v165, v189
  v_add_f32 v166, v166, v190
  v_add_f32 v167, v167, v191
  s_waitcnt vmcnt(16)
  v_lshlrev_b32 v184, 16, v92
  v_and_b32 v185, 0xffff0000, v92
  v_lshlrev_b32 v186, 16, v93
  v_and_b32 v187, 0xffff0000, v93
  v_lshlrev_b32 v188, 16, v94
  v_and_b32 v189, 0xffff0000, v94
  v_lshlrev_b32 v190, 16, v95
  v_and_b32 v191, 0xffff0000, v95
  v_add_f32 v168, v168, v184
  v_add_f32 v169, v169, v185
  v_add_f32 v170, v170, v186
  v_add_f32 v171, v171, v187
  v_add_f32 v172, v172, v188
  v_add_f32 v173, v173, v189
  v_add_f32 v174, v174, v190
  v_add_f32 v175, v175, v191
  s_waitcnt vmcnt(15)
  v_lshlrev_b32 v184, 16, v96
  v_and_b32 v185, 0xffff0000, v96
  v_lshlrev_b32 v186, 16, v97
  v_and_b32 v187, 0xffff0000, v97
  v_lshlrev_b32 v188, 16, v98
  v_and_b32 v189, 0xffff0000, v98
  v_lshlrev_b32 v190, 16, v99
  v_and_b32 v191, 0xffff0000, v99
  v_add_f32 v176, v176, v184
  v_add_f32 v177, v177, v185
  v_add_f32 v178, v178, v186
  v_add_f32 v179, v179, v187
  v_add_f32 v180, v180, v188
  v_add_f32 v181, v181, v189
  v_add_f32 v182, v182, v190
  v_add_f32 v183, v183, v191
  s_waitcnt vmcnt(14)
  v_lshlrev_b32 v184, 16, v100
  v_and_b32 v185, 0xffff0000, v100
  v_lshlrev_b32 v186, 16, v101
  v_and_b32 v187, 0xffff0000, v101
  v_lshlrev_b32 v188, 16, v102
  v_and_b32 v189, 0xffff0000, v102
  v_lshlrev_b32 v190, 16, v103
  v_and_b32 v191, 0xffff0000, v103
  v_add_f32 v160, v160, v184
  v_add_f32 v161, v161, v185
  v_add_f32 v162, v162, v186
  v_add_f32 v163, v163, v187
  v_add_f32 v164, v164, v188
  v_add_f32 v165, v165, v189
  v_add_f32 v166, v166, v190
  v_add_f32 v167, v167, v191
  s_waitcnt vmcnt(13)
  v_lshlrev_b32 v184, 16, v104
  v_and_b32 v185, 0xffff0000, v104
  v_lshlrev_b32 v186, 16, v105
  v_and_b32 v187, 0xffff0000, v105
  v_lshlrev_b32 v188, 16, v106
  v_and_b32 v189, 0xffff0000, v106
  v_lshlrev_b32 v190, 16, v107
  v_and_b32 v191, 0xffff0000, v107
  v_add_f32 v168, v168, v184
  v_add_f32 v169, v169, v185
  v_add_f32 v170, v170, v186
  v_add_f32 v171, v171, v187
  v_add_f32 v172, v172, v188
  v_add_f32 v173, v173, v189
  v_add_f32 v174, v174, v190
  v_add_f32 v175, v175, v191
  s_waitcnt vmcnt(12)
  v_lshlrev_b32 v184, 16, v108
  v_and_b32 v185, 0xffff0000, v108
  v_lshlrev_b32 v186, 16, v109
  v_and_b32 v187, 0xffff0000, v109
  v_lshlrev_b32 v188, 16, v110
  v_and_b32 v189, 0xffff0000, v110
  v_lshlrev_b32 v190, 16, v111
  v_and_b32 v191, 0xffff0000, v111
  v_add_f32 v176, v176, v184
  v_add_f32 v177, v177, v185
  v_add_f32 v178, v178, v186
  v_add_f32 v179, v179, v187
  v_add_f32 v180, v180, v188
  v_add_f32 v181, v181, v189
  v_add_f32 v182, v182, v190
  v_add_f32 v183, v183, v191
  s_waitcnt vmcnt(11)
  v_lshlrev_b32 v184, 16, v112
  v_and_b32 v185, 0xffff0000, v112
  v_lshlrev_b32 v186, 16, v113
  v_and_b32 v187, 0xffff0000, v113
  v_lshlrev_b32 v188, 16, v114
  v_and_b32 v189, 0xffff0000, v114
  v_lshlrev_b32 v190, 16, v115
  v_and_b32 v191, 0xffff0000, v115
  v_add_f32 v160, v160, v184
  v_add_f32 v161, v161, v185
  v_add_f32 v162, v162, v186
  v_add_f32 v163, v163, v187
  v_add_f32 v164, v164, v188
  v_add_f32 v165, v165, v189
  v_add_f32 v166, v166, v190
  v_add_f32 v167, v167, v191
  s_waitcnt vmcnt(10)
  v_lshlrev_b32 v184, 16, v116
  v_and_b32 v185, 0xffff0000, v116
  v_lshlrev_b32 v186, 16, v117
  v_and_b32 v187, 0xffff0000, v117
  v_lshlrev_b32 v188, 16, v118
  v_and_b32 v189, 0xffff0000, v118
  v_lshlrev_b32 v190, 16, v119
  v_and_b32 v191, 0xffff0000, v119
  v_add_f32 v168, v168, v184
  v_add_f32 v169, v169, v185
  v_add_f32 v170, v170, v186
  v_add_f32 v171, v171, v187
  v_add_f32 v172, v172, v188
  v_add_f32 v173, v173, v189
  v_add_f32 v174, v174, v190
  v_add_f32 v175, v175, v191
  s_waitcnt vmcnt(9)
  v_lshlrev_b32 v184, 16, v120
  v_and_b32 v185, 0xffff0000, v120
  v_lshlrev_b32 v186, 16, v121
  v_and_b32 v187, 0xffff0000, v121
  v_lshlrev_b32 v188, 16, v122
  v_and_b32 v189, 0xffff0000, v122
  v_lshlrev_b32 v190, 16, v123
  v_and_b32 v191, 0xffff0000, v123
  v_add_f32 v176, v176, v184
  v_add_f32 v177, v177, v185
  v_add_f32 v178, v178, v186
  v_add_f32 v179, v179, v187
  v_add_f32 v180, v180, v188
  v_add_f32 v181, v181, v189
  v_add_f32 v182, v182, v190
  v_add_f32 v183, v183, v191
  s_waitcnt vmcnt(8)
  v_lshlrev_b32 v184, 16, v124
  v_and_b32 v185, 0xffff0000, v124
  v_lshlrev_b32 v186, 16, v125
  v_and_b32 v187, 0xffff0000, v125
  v_lshlrev_b32 v188, 16, v126
  v_and_b32 v189, 0xffff0000, v126
  v_lshlrev_b32 v190, 16, v127
  v_and_b32 v191, 0xffff0000, v127
  v_add_f32 v160, v160, v184
  v_add_f32 v161, v161, v185
  v_add_f32 v162, v162, v186
  v_add_f32 v163, v163, v187
  v_add_f32 v164, v164, v188
  v_add_f32 v165, v165, v189
  v_add_f32 v166, v166, v190
  v_add_f32 v167, v167, v191
  s_waitcnt vmcnt(7)
  v_lshlrev_b32 v184, 16, v128
  v_and_b32 v185, 0xffff0000, v128
  v_lshlrev_b32 v186, 16, v129
  v_and_b32 v187, 0xffff0000, v129
  v_lshlrev_b32 v188, 16, v130
  v_and_b32 v189, 0xffff0000, v130
  v_lshlrev_b32 v190, 16, v131
  v_and_b32 v191, 0xffff0000, v131
  v_add_f32 v168, v168, v184
  v_add_f32 v169, v169, v185
  v_add_f32 v170, v170, v186
  v_add_f32 v171, v171, v187
  v_add_f32 v172, v172, v188
  v_add_f32 v173, v173, v189
  v_add_f32 v174, v174, v190
  v_add_f32 v175, v175, v191
  s_waitcnt vmcnt(6)
  v_lshlrev_b32 v184, 16, v132
  v_and_b32 v185, 0xffff0000, v132
  v_lshlrev_b32 v186, 16, v133
  v_and_b32 v187, 0xffff0000, v133
  v_lshlrev_b32 v188, 16, v134
  v_and_b32 v189, 0xffff0000, v134
  v_lshlrev_b32 v190, 16, v135
  v_and_b32 v191, 0xffff0000, v135
  v_add_f32 v176, v176, v184
  v_add_f32 v177, v177, v185
  v_add_f32 v178, v178, v186
  v_add_f32 v179, v179, v187
  v_add_f32 v180, v180, v188
  v_add_f32 v181, v181, v189
  v_add_f32 v182, v182, v190
  v_add_f32 v183, v183, v191
  s_waitcnt vmcnt(5)
  v_lshlrev_b32 v184, 16, v136
  v_and_b32 v185, 0xffff0000, v136
  v_lshlrev_b32 v186, 16, v137
  v_and_b32 v187, 0xffff0000, v137
  v_lshlrev_b32 v188, 16, v138
  v_and_b32 v189, 0xffff0000, v138
  v_lshlrev_b32 v190, 16, v139
  v_and_b32 v191, 0xffff0000, v139
  v_add_f32 v160, v160, v184
  v_add_f32 v161, v161, v185
  v_add_f32 v162, v162, v186
  v_add_f32 v163, v163, v187
  v_add_f32 v164, v164, v188
  v_add_f32 v165, v165, v189
  v_add_f32 v166, v166, v190
  v_add_f32 v167, v167, v191
  s_waitcnt vmcnt(4)
  v_lshlrev_b32 v184, 16, v140
  v_and_b32 v185, 0xffff0000, v140
  v_lshlrev_b32 v186, 16, v141
  v_and_b32 v187, 0xffff0000, v141
  v_lshlrev_b32 v188, 16, v142
  v_and_b32 v189, 0xffff0000, v142
  v_lshlrev_b32 v190, 16, v143
  v_and_b32 v191, 0xffff0000, v143
  v_add_f32 v168, v168, v184
  v_add_f32 v169, v169, v185
  v_add_f32 v170, v170, v186
  v_add_f32 v171, v171, v187
  v_add_f32 v172, v172, v188
  v_add_f32 v173, v173, v189
  v_add_f32 v174, v174, v190
  v_add_f32 v175, v175, v191
  s_waitcnt vmcnt(3)
  v_lshlrev_b32 v184, 16, v144
  v_and_b32 v185, 0xffff0000, v144
  v_lshlrev_b32 v186, 16, v145
  v_and_b32 v187, 0xffff0000, v145
  v_lshlrev_b32 v188, 16, v146
  v_and_b32 v189, 0xffff0000, v146
  v_lshlrev_b32 v190, 16, v147
  v_and_b32 v191, 0xffff0000, v147
  v_add_f32 v176, v176, v184
  v_add_f32 v177, v177, v185
  v_add_f32 v178, v178, v186
  v_add_f32 v179, v179, v187
  v_add_f32 v180, v180, v188
  v_add_f32 v181, v181, v189
  v_add_f32 v182, v182, v190
  v_add_f32 v183, v183, v191
  s_waitcnt vmcnt(2)
  v_lshlrev_b32 v184, 16, v148
  v_and_b32 v185, 0xffff0000, v148
  v_lshlrev_b32 v186, 16, v149
  v_and_b32 v187, 0xffff0000, v149
  v_lshlrev_b32 v188, 16, v150
  v_and_b32 v189, 0xffff0000, v150
  v_lshlrev_b32 v190, 16, v151
  v_and_b32 v191, 0xffff0000, v151
  v_add_f32 v160, v160, v184
  v_add_f32 v161, v161, v185
  v_add_f32 v162, v162, v186
  v_add_f32 v163, v163, v187
  v_add_f32 v164, v164, v188
  v_add_f32 v165, v165, v189
  v_add_f32 v166, v166, v190
  v_add_f32 v167, v167, v191
  s_waitcnt vmcnt(1)
  v_lshlrev_b32 v184, 16, v152
  v_and_b32 v185, 0xffff0000, v152
  v_lshlrev_b32 v186, 16, v153
  v_and_b32 v187, 0xffff0000, v153
  v_lshlrev_b32 v188, 16, v154
  v_and_b32 v189, 0xffff0000, v154
  v_lshlrev_b32 v190, 16, v155
  v_and_b32 v191, 0xffff0000, v155
  v_add_f32 v168, v168, v184
  v_add_f32 v169, v169, v185
  v_add_f32 v170, v170, v186
  v_add_f32 v171, v171, v187
  v_add_f32 v172, v172, v188
  v_add_f32 v173, v173, v189
  v_add_f32 v174, v174, v190
  v_add_f32 v175, v175, v191
  s_waitcnt vmcnt(0)
  v_lshlrev_b32 v184, 16, v156
  v_and_b32 v185, 0xffff0000, v156
  v_lshlrev_b32 v186, 16, v157
  v_and_b32 v187, 0xffff0000, v157
  v_lshlrev_b32 v188, 16, v158
  v_and_b32 v189, 0xffff0000, v158
  v_lshlrev_b32 v190, 16, v159
  v_and_b32 v191, 0xffff0000, v159
  v_add_f32 v176, v176, v184
  v_add_f32 v177, v177, v185
  v_add_f32 v178, v178, v186
  v_add_f32 v179, v179, v187
  v_add_f32 v180, v180, v188
  v_add_f32 v181, v181, v189
  v_add_f32 v182, v182, v190
  v_add_f32 v183, v183, v191
  v_permlane32_swap_b32 v160, v164
  v_permlane32_swap_b32 v161, v165
  v_permlane32_swap_b32 v162, v166
  v_permlane32_swap_b32 v163, v167
  v_add_f32 v160, v160, v164
  v_add_f32 v161, v161, v165
  v_add_f32 v162, v162, v166
  v_add_f32 v163, v163, v167
  s_nop 0
  v_permlane16_swap_b32 v160, v162
  v_permlane16_swap_b32 v161, v163
  v_add_f32 v160, v160, v162
  v_add_f32 v161, v161, v163
  s_nop 0
  v_add_f32 v160, v160, v160 row_ror:8 row_mask:0xf bank_mask:0xf
  v_add_f32 v161, v161, v161 row_ror:8 row_mask:0xf bank_mask:0xf
  v_permlane32_swap_b32 v168, v172
  v_permlane32_swap_b32 v169, v173
  v_permlane32_swap_b32 v170, v174
  v_permlane32_swap_b32 v171, v175
  v_add_f32 v168, v168, v172
  v_add_f32 v169, v169, v173
  v_add_f32 v170, v170, v174
  v_add_f32 v171, v171, v175
  s_nop 0
  v_permlane16_swap_b32 v168, v170
  v_permlane16_swap_b32 v169, v171
  v_add_f32 v168, v168, v170
  v_add_f32 v169, v169, v171
  s_nop 0
  v_add_f32 v168, v168, v168 row_ror:8 row_mask:0xf bank_mask:0xf
  v_add_f32 v169, v169, v169 row_ror:8 row_mask:0xf bank_mask:0xf
  v_permlane32_swap_b32 v176, v180
  v_permlane32_swap_b32 v177, v181
  v_permlane32_swap_b32 v178, v182
  v_permlane32_swap_b32 v179, v183
  v_add_f32 v176, v176, v180
  v_add_f32 v177, v177, v181
  v_add_f32 v178, v178, v182
  v_add_f32 v179, v179, v183
  s_nop 0
  v_permlane16_swap_b32 v176, v178
  v_permlane16_swap_b32 v177, v179
  v_add_f32 v176, v176, v178
  v_add_f32 v177, v177, v179
  s_nop 0
  v_add_f32 v176, v176, v176 row_ror:8 row_mask:0xf bank_mask:0xf
  v_add_f32 v177, v177, v177 row_ror:8 row_mask:0xf bank_mask:0xf
  s_mov_b32 exec_lo, 0x00ff00ff
  s_mov_b32 exec_hi, 0x00ff00ff
  buffer_store_dwordx2 v[160:161], v21, s[4:7], s30 offen offset:0 sc1
  buffer_store_dwordx2 v[168:169], v21, s[4:7], s30 offen offset:256 sc1
  buffer_store_dwordx2 v[176:177], v21, s[4:7], s30 offen offset:512 sc1
  s_mov_b64 exec, -1
  s_mov_b32 s12, s58
  s_mov_b32 s13, s59
  s_mov_b32 s14, 0x100
  s_mov_b32 s15, 0x00020000
  s_mov_b32 s38, 0
  s_mov_b64 exec, 1
.g2_kernel_gt10:
  buffer_load_dword v6, v4, s[12:15], 0 offen sc1
  s_add_u32 s38, s38, 1
  s_waitcnt vmcnt(0)
  v_cmp_eq_u32 vcc, 0x60, v6
  s_cbranch_vccnz .g2_kernel_gt10d
  s_sleep 8
  s_cmp_lt_u32 s38, 131072
  s_cbranch_scc1 .g2_kernel_gt10
.g2_kernel_gt10d:
  s_mov_b64 exec, -1
  v_mov_b32 v6, s70
  s_mov_b64 exec, 1
  buffer_store_dword v6, v4, s[4:7], s76 offen offset:4 sc1
  s_mov_b64 exec, -1
  v_mov_b32 v6, 155648
  s_mov_b32 s38, 0
.g2_kernel_wg11:
  ds_read_b32 v7, v6 offset:512
  s_add_u32 s38, s38, 1
  s_waitcnt lgkmcnt(0)
  v_cmp_le_u32 vcc, 27, v7
  s_cbranch_vccnz .g2_kernel_wg11d
  s_sleep 4
  s_cmp_lt_u32 s38, 524288
  s_cbranch_scc1 .g2_kernel_wg11
.g2_kernel_wg11d:
  s_and_b32 s31, s76, 0xffffe000
  s_add_u32 s31, s31, 4
  v_and_b32 v6, 15, v2
  v_lshlrev_b32 v6, 9, v6
  v_lshrrev_b32 v7, 4, v2
  v_lshl_add_u32 v6, v7, 7, v6
  v_lshlrev_b32 v7, 2, v2
  v_add_u32 v7, 157696, v7
  s_mov_b32 m0, 157696
  s_mov_b32 s38, 0
  s_bfm_b64 exec, 16, 0
.g2_kernel_pa12:
  buffer_load_dword v6, s[4:7], s31 offen sc1 lds
  s_add_u32 s38, s38, 1
  s_waitcnt vmcnt(0)
  ds_read_b32 v8, v7
  s_waitcnt lgkmcnt(0)
  v_cmp_ge_u32 vcc, s62, v8
  s_cbranch_vccz .g2_kernel_pa12d
  s_mov_b64 exec, vcc
  s_sleep 16
  s_cmp_lt_u32 s38, 131072
  s_cbranch_scc1 .g2_kernel_pa12
.g2_kernel_pa12d:
  s_mov_b64 exec, -1
  s_mul_i32 s30, s18, 12288
  s_add_u32 s30, s30, 0x3080000
  s_mov_b32 exec_hi, 0xffff
  buffer_load_dwordx4 v[64:67], v3, s[4:7], s30 offen offset:0 sc1
  buffer_load_dwordx4 v[68:71], v3, s[4:7], s30 offen offset:768 sc1
  buffer_load_dwordx4 v[72:75], v3, s[4:7], s30 offen offset:1536 sc1
  buffer_load_dwordx4 v[76:79], v3, s[4:7], s30 offen offset:2304 sc1
  s_add_u32 s30, s30, 3072
  buffer_load_dwordx4 v[80:83], v3, s[4:7], s30 offen offset:0 sc1
  buffer_load_dwordx4 v[84:87], v3, s[4:7], s30 offen offset:768 sc1
  buffer_load_dwordx4 v[88:91], v3, s[4:7], s30 offen offset:1536 sc1
  buffer_load_dwordx4 v[92:95], v3, s[4:7], s30 offen offset:2304 sc1
  s_add_u32 s30, s30, 3072
  buffer_load_dwordx4 v[96:99], v3, s[4:7], s30 offen offset:0 sc1
  buffer_load_dwordx4 v[100:103], v3, s[4:7], s30 offen offset:768 sc1
  buffer_load_dwordx4 v[104:107], v3, s[4:7], s30 offen offset:1536 sc1
  buffer_load_dwordx4 v[108:111], v3, s[4:7], s30 offen offset:2304 sc1
  s_add_u32 s30, s30, 3072
  buffer_load_dwordx4 v[112:115], v3, s[4:7], s30 offen offset:0 sc1
  buffer_load_dwordx4 v[116:119], v3, s[4:7], s30 offen offset:768 sc1
  buffer_load_dwordx4 v[120:123], v3, s[4:7], s30 offen offset:1536 sc1
  buffer_load_dwordx4 v[124:127], v3, s[4:7], s30 offen offset:2304 sc1
  s_add_u32 s30, s30, 3072
  s_waitcnt vmcnt(14)
  v_add_f32 v64, v64, v68
  v_add_f32 v65, v65, v69
  v_add_f32 v66, v66, v70
  v_add_f32 v67, v67, v71
  s_waitcnt vmcnt(13)
  v_add_f32 v64, v64, v72
  v_add_f32 v65, v65, v73
  v_add_f32 v66, v66, v74
  v_add_f32 v67, v67, v75
  s_waitcnt vmcnt(12)
  v_add_f32 v64, v64, v76
  v_add_f32 v65, v65, v77
  v_add_f32 v66, v66, v78
  v_add_f32 v67, v67, v79
  s_waitcnt vmcnt(11)
  v_add_f32 v64, v64, v80
  v_add_f32 v65, v65, v81
  v_add_f32 v66, v66, v82
  v_add_f32 v67, v67, v83
  s_waitcnt vmcnt(10)
  v_add_f32 v64, v64, v84
  v_add_f32 v65, v65, v85
  v_add_f32 v66, v66, v86
  v_add_f32 v67, v67, v87
  s_waitcnt vmcnt(9)
  v_add_f32 v64, v64, v88
  v_add_f32 v65, v65, v89
  v_add_f32 v66, v66, v90
  v_add_f32 v67, v67, v91
  s_waitcnt vmcnt(8)
  v_add_f32 v64, v64, v92
  v_add_f32 v65, v65, v93
  v_add_f32 v66, v66, v94
  v_add_f32 v67, v67, v95
  s_waitcnt vmcnt(7)
  v_add_f32 v64, v64, v96
  v_add_f32 v65, v65, v97
  v_add_f32 v66, v66, v98
  v_add_f32 v67, v67, v99
  s_waitcnt vmcnt(6)
  v_add_f32 v64, v64, v100
  v_add_f32 v65, v65, v101
  v_add_f32 v66, v66, v102
  v_add_f32 v67, v67, v103
  s_waitcnt vmcnt(5)
  v_add_f32 v64, v64, v104
  v_add_f32 v65, v65, v105
  v_add_f32 v66, v66, v106
  v_add_f32 v67, v67, v107
  s_waitcnt vmcnt(4)
  v_add_f32 v64, v64, v108
  v_add_f32 v65, v65, v109
  v_add_f32 v66, v66, v110
  v_add_f32 v67, v67, v111
  s_waitcnt vmcnt(3)
  v_add_f32 v64, v64, v112
  v_add_f32 v65, v65, v113
  v_add_f32 v66, v66, v114
  v_add_f32 v67, v67, v115
  s_waitcnt vmcnt(2)
  v_add_f32 v64, v64, v116
  v_add_f32 v65, v65, v117
  v_add_f32 v66, v66, v118
  v_add_f32 v67, v67, v119
  s_waitcnt vmcnt(1)
  v_add_f32 v64, v64, v120
  v_add_f32 v65, v65, v121
  v_add_f32 v66, v66, v122
  v_add_f32 v67, v67, v123
  s_waitcnt vmcnt(0)
  v_add_f32 v64, v64, v124
  v_add_f32 v65, v65, v125
  v_add_f32 v66, v66, v126
  v_add_f32 v67, v67, v127
  s_mov_b64 exec, -1
  v_mov_b32 v6, 155648
  s_mov_b32 s38, 0
.g2_kernel_wg13:
  ds_read_b32 v7, v6 offset:512
  s_add_u32 s38, s38, 1
  s_waitcnt lgkmcnt(0)
  v_cmp_le_u32 vcc, 32, v7
  s_cbranch_vccnz .g2_kernel_wg13d
  s_sleep 2
  s_cmp_lt_u32 s38, 524288
  s_cbranch_scc1 .g2_kernel_wg13
.g2_kernel_wg13d:
  v_lshlrev_b32 v24, 2, v2
  v_add_u32 v24, 155648, v24
  ds_write_b32 v24, v4 offset:2048
  v_add_u32 v24, 155648, v3
  s_mov_b32 exec_hi, 0xffff
  ds_write_b128 v24, v[64:67] offset:4864
  s_mov_b64 exec, -1
  v_mov_b32 v6, s71
  s_mov_b64 exec, 1
  ds_add_u32 v6, v5 offset:0
  s_mov_b64 exec, -1
  s_branch .g2_kernel_v
.g2_kernel_s3:
  s_mov_b32 s12, s58
  s_mov_b32 s13, s59
  s_mov_b32 s14, 0x100
  s_mov_b32 s15, 0x00020000
  s_mov_b32 s20, s48
  s_mov_b32 s21, s49
  s_mov_b32 s22, 0x800
  s_mov_b32 s23, 0x00020000
  v_mov_b32 v12, 0
  v_mov_b32 v13, 0
  v_mov_b32 v14, 0
  v_mov_b32 v15, 0
  s_cmp_ge_u32 s2, 96
  s_cbranch_scc1 .g2_kernel_zm14
  s_lshl_b32 s36, s2, 12
  s_add_u32 s36, s36, 0x3000000
  buffer_store_dwordx4 v[12:15], v3, s[4:7], s36 offen sc1
  buffer_store_dwordx4 v[12:15], v3, s[4:7], s36 offen offset:1024 sc1
  buffer_store_dwordx4 v[12:15], v3, s[4:7], s36 offen offset:2048 sc1
  buffer_store_dwordx4 v[12:15], v3, s[4:7], s36 offen offset:3072 sc1
.g2_kernel_zm14:
  s_barrier
  s_cbranch_scc1 .g2_kernel_zm14b
  s_mov_b64 exec, 1
  s_waitcnt vmcnt(0)
  buffer_atomic_add v5, v4, s[12:15], 0 offen sc1
  s_mov_b64 exec, -1
.g2_kernel_zm14b:
  s_and_b32 s36, s18, 7
  s_cmp_ge_u32 s36, 3
  s_cbranch_scc1 .g2_kernel_c315
  s_mov_b32 s24, s42
  s_mov_b32 s25, s43
  s_mov_b32 s26, 0x600000
  s_mov_b32 s27, 0x00020000
  v_mul_u32_u24 v7, 6144, v2
  s_lshl_b32 s36, s36, 11
  s_or_b32 s37, s18, 3
  s_lshl_b32 s37, s37, 7
  s_add_u32 s36, s36, s37
  s_and_b32 s37, s17, 7
  s_mul_i32 s37, s37, 393216
  s_add_u32 s36, s36, s37
  s_add_u32 s37, s36, 3145728
  s_sleep 0
  buffer_load_dword v1, v7, s[24:27], s36 offen
  s_sleep 30
  buffer_load_dword v1, v7, s[24:27], s37 offen
.g2_kernel_c315:
  v_lshlrev_b32 v20, 5, v2
  buffer_load_dwordx4 v[24:27], v20, s[20:23], 0 offen
  buffer_load_dwordx4 v[28:31], v20, s[20:23], 0 offen offset:16
  v_mov_b32 v20, 0
  s_waitcnt vmcnt(0)
  v_lshlrev_b32 v21, 16, v24
  v_and_b32 v22, 0xffff0000, v24
  v_add_f32 v20, v20, v21
  v_add_f32 v20, v20, v22
  v_lshlrev_b32 v21, 16, v25
  v_and_b32 v22, 0xffff0000, v25
  v_add_f32 v20, v20, v21
  v_add_f32 v20, v20, v22
  v_lshlrev_b32 v21, 16, v26
  v_and_b32 v22, 0xffff0000, v26
  v_add_f32 v20, v20, v21
  v_add_f32 v20, v20, v22
  v_lshlrev_b32 v21, 16, v27
  v_and_b32 v22, 0xffff0000, v27
  v_add_f32 v20, v20, v21
  v_add_f32 v20, v20, v22
  v_lshlrev_b32 v21, 16, v28
  v_and_b32 v22, 0xffff0000, v28
  v_add_f32 v20, v20, v21
  v_add_f32 v20, v20, v22
  v_lshlrev_b32 v21, 16, v29
  v_and_b32 v22, 0xffff0000, v29
  v_add_f32 v20, v20, v21
  v_add_f32 v20, v20, v22
  v_lshlrev_b32 v21, 16, v30
  v_and_b32 v22, 0xffff0000, v30
  v_add_f32 v20, v20, v21
  v_add_f32 v20, v20, v22
  v_lshlrev_b32 v21, 16, v31
  v_and_b32 v22, 0xffff0000, v31
  v_add_f32 v20, v20, v21
  v_add_f32 v20, v20, v22
  s_nop 1
  v_add_f32 v20, v20, v20 quad_perm:[1,0,3,2] row_mask:0xf bank_mask:0xf
  s_nop 1
  v_add_f32 v20, v20, v20 quad_perm:[2,3,0,1] row_mask:0xf bank_mask:0xf
  s_nop 1
  v_add_f32 v20, v20, v20 row_half_mirror row_mask:0xf bank_mask:0xf
  s_nop 1
  v_add_f32 v20, v20, v20 row_mirror row_mask:0xf bank_mask:0xf
  s_nop 0
  v_readlane_b32 s20, v20, 16
  v_readlane_b32 s21, v20, 32
  v_readlane_b32 s22, v20, 48
  v_add_f32 v20, s20, v20
  v_add_f32 v20, s21, v20
  v_add_f32 v20, s22, v20
  v_mul_f32 v20, 0x3a800000, v20
  v_mov_b32 v6, 155648
  s_mov_b32 s38, 0
.g2_kernel_wg16:
  ds_read_b32 v7, v6 offset:512
  s_add_u32 s38, s38, 1
  s_waitcnt lgkmcnt(0)
  v_cmp_le_u32 vcc, 32, v7
  s_cbranch_vccnz .g2_kernel_wg16d
  s_sleep 2
  s_cmp_lt_u32 s38, 524288
  s_cbranch_scc1 .g2_kernel_wg16
.g2_kernel_wg16d:
  v_mov_b32 v21, 155648
  s_mov_b64 exec, 1
  ds_write_b32 v21, v20 offset:256
  s_mov_b64 exec, -1
.g2_kernel_v:
  s_setprio 3
  s_cmp_lg_u32 s16, 4
  s_cbranch_scc1 .g2_kernel_v_1
  v_mov_b32 v6, s71
  s_mov_b32 s38, 0
.g2_kernel_wg17:
  ds_read_b32 v7, v6 offset:4
  s_add_u32 s38, s38, 1
  s_waitcnt lgkmcnt(0)
  v_cmp_le_u32 vcc, 4, v7
  s_cbranch_vccnz .g2_kernel_wg17d
  s_sleep 1
  s_cmp_lt_u32 s38, 524288
  s_cbranch_scc1 .g2_kernel_wg17
.g2_kernel_wg17d:
  s_sleep 2
  s_and_b32 s31, s76, 0xffffe000
  s_add_u32 s31, s31, 0
  v_and_b32 v6, 15, v2
  v_lshlrev_b32 v6, 9, v6
  v_lshrrev_b32 v7, 4, v2
  v_lshl_add_u32 v6, v7, 7, v6
  v_lshlrev_b32 v7, 2, v2
  v_add_u32 v7, 157440, v7
  s_mov_b32 m0, 157440
  s_mov_b32 s38, 0
  s_mov_b32 exec_lo, 0xffff
  s_mov_b32 exec_hi, 0xffff
.g2_kernel_pa18:
  buffer_load_dword v6, s[4:7], s31 offen sc1 lds
  s_add_u32 s38, s38, 1
  s_waitcnt vmcnt(0)
  ds_read_b32 v8, v7
  s_waitcnt lgkmcnt(0)
  v_cmp_ge_u32 vcc, s62, v8
  s_cbranch_vccz .g2_kernel_pa18d
  s_mov_b64 exec, vcc
  s_sleep 2
  s_cmp_lt_u32 s38, 131072
  s_cbranch_scc1 .g2_kernel_pa18
.g2_kernel_pa18d:
  s_mov_b64 exec, -1
  v_mov_b32 v6, s71
  s_mov_b64 exec, 1
  ds_add_u32 v6, v5 offset:80
  s_mov_b64 exec, -1
.g2_kernel_v_1:
  s_cmp_lt_u32 s16, 6
  s_cbranch_scc1 .g2_kernel_v_2
  v_mov_b32 v6, s71
  s_mov_b32 s38, 0
.g2_kernel_wg19:
  ds_read_b32 v7, v6 offset:4
  s_add_u32 s38, s38, 1
  s_waitcnt lgkmcnt(0)
  v_cmp_le_u32 vcc, 4, v7
  s_cbranch_vccnz .g2_kernel_wg19d
  s_sleep 4
  s_cmp_lt_u32 s38, 524288
  s_cbranch_scc1 .g2_kernel_wg19
.g2_kernel_wg19d:
  s_and_b32 s28, s16, 1
  s_lshl_b32 s30, s28, 13
  s_add_u32 s31, s30, 16384
  v_add_u32 v8, s31, v3
  ds_read_b32 v9, v6 offset:24
  ds_read_b128 v[16:19], v8 offset:0
  ds_read_b128 v[20:23], v8 offset:1024
  ds_read_b128 v[24:27], v8 offset:2048
  ds_read_b128 v[28:31], v8 offset:3072
  ds_read_b128 v[32:35], v8 offset:4096
  ds_read_b128 v[36:39], v8 offset:5120
  ds_read_b128 v[40:43], v8 offset:6144
  ds_read_b128 v[44:47], v8 offset:7168
  s_lshl_b32 s31, s18, 5
  s_add_u32 s31, s31, s17
  s_add_u32 s31, s31, 16
  s_lshl_b32 s31, s31, 14
  s_add_u32 s30, s30, s31
  s_add_u32 s30, s30, s63
  s_add_u32 s31, s30, 4096
  s_lshl_b32 s33, s28, 8
  s_add_u32 s33, s33, 128
  s_waitcnt lgkmcnt(0)
  v_readfirstlane_b32 s29, v9
  v_mov_b32 v6, s71
  s_mov_b64 exec, 1
  ds_add_u32 v6, v5 offset:8
  s_mov_b64 exec, -1
  s_sleep 40
  buffer_store_dwordx4 v[16:19], v3, s[4:7], s30 offen offset:0 sc1
  s_sleep 4
  buffer_store_dwordx4 v[20:23], v3, s[4:7], s30 offen offset:1024 sc1
  s_sleep 4
  buffer_store_dwordx4 v[24:27], v3, s[4:7], s30 offen offset:2048 sc1
  s_sleep 4
  buffer_store_dwordx4 v[28:31], v3, s[4:7], s30 offen offset:3072 sc1
  s_sleep 4
  buffer_store_dwordx4 v[32:35], v3, s[4:7], s31 offen offset:0 sc1
  s_sleep 4
  buffer_store_dwordx4 v[36:39], v3, s[4:7], s31 offen offset:1024 sc1
  s_sleep 4
  buffer_store_dwordx4 v[40:43], v3, s[4:7], s31 offen offset:2048 sc1
  s_sleep 4
  buffer_store_dwordx4 v[44:47], v3, s[4:7], s31 offen offset:3072 sc1
  s_sleep 4
  s_sub_u32 s29, s29, 1
  s_lshr_b32 s29, s29, 6
  s_waitcnt vmcnt(0)
  s_cmp_eq_u32 s29, s28
  s_cbranch_scc1 .g2_kernel_v_1h
  s_add_u32 s31, s76, s33
  v_mov_b32 v6, s70
  s_mov_b64 exec, 1
  buffer_store_dword v6, v4, s[4:7], s31 offen offset:0 sc1
  s_mov_b64 exec, -1
  s_branch .g2_kernel_v_2
.g2_kernel_v_1h:
  v_mov_b32 v6, s71
  s_mov_b64 exec, 1
  ds_add_u32 v6, v5 offset:56
  s_mov_b64 exec, -1
.g2_kernel_v_2:
  v_mov_b32 v6, s71
  s_mov_b32 s38, 0
.g2_kernel_wg20:
  ds_read_b32 v7, v6 offset:80
  s_add_u32 s38, s38, 1
  s_waitcnt lgkmcnt(0)
  v_cmp_le_u32 vcc, 1, v7
  s_cbranch_vccnz .g2_kernel_wg20d
  s_sleep 8
  s_cmp_lt_u32 s38, 524288
  s_cbranch_scc1 .g2_kernel_wg20
.g2_kernel_wg20d:
  s_sleep 20
  s_mov_b32 s39, 0
  v_mov_b32 v12, 0
  v_mov_b32 v13, 0
  v_mov_b32 v14, 0
  v_mov_b32 v15, 0
  s_lshl_b32 s30, s17, 2
  s_and_b32 s31, s16, 3
  s_add_u32 s30, s30, s31
  s_lshl_b32 s30, s30, 4
  s_add_u32 s30, s30, s18
  s_lshl_b32 s30, s30, 9
  s_add_u32 s30, s30, s63
  s_add_u32 s30, s30, 0x1000000
  s_mov_b32 exec_hi, 0
  s_sleep 6
  buffer_store_dwordx4 v[12:15], v3, s[4:7], s30 offen sc1
  s_mov_b64 exec, -1
  s_lshl_b32 s30, s17, 2
  s_add_u32 s30, s30, s31
  s_lshl_b32 s30, s30, 5
  s_add_u32 s30, s30, s18
  s_lshl_b32 s30, s30, 11
  s_add_u32 s30, s30, s63
  s_add_u32 s30, s30, 0x808000
  s_sleep 6
  buffer_store_dwordx4 v[12:15], v3, s[4:7], s30 offen sc1
  s_sleep 6
  buffer_store_dwordx4 v[12:15], v3, s[4:7], s30 offen offset:1024 sc1
  s_cmp_lg_u32 s62, 5
  s_cbranch_scc1 .g2_kernel_zs21k
  s_lshl_b32 s30, s18, 4
  s_add_u32 s30, s30, s17
  s_lshl_b32 s30, s30, 2
  s_add_u32 s30, s30, s31
  s_lshl_b32 s30, s30, 12
  s_add_u32 s30, s30, 0x2c00000
  s_sleep 6
  buffer_store_dwordx4 v[12:15], v3, s[4:7], s30 offen sc1
  s_sleep 6
  buffer_store_dwordx4 v[12:15], v3, s[4:7], s30 offen offset:1024 sc1
  s_sleep 6
  buffer_store_dwordx4 v[12:15], v3, s[4:7], s30 offen offset:2048 sc1
  s_sleep 6
  buffer_store_dwordx4 v[12:15], v3, s[4:7], s30 offen offset:3072 sc1
.g2_kernel_zs21k:
  s_lshl_b32 s30, s17, 4
  s_add_u32 s30, s30, s18
  s_cmp_gt_u32 s16, 5
  s_cbranch_scc1 .g2_kernel_zs21
  s_cmp_eq_u32 s16, 5
  s_cbranch_scc1 .g2_kernel_zs21a
  s_cmp_lg_u32 s62, 0
  s_cbranch_scc1 .g2_kernel_zs21
  s_lshl_b32 s30, s30, 12
  s_add_u32 s31, s30, 0x1090000
  s_sleep 6
  buffer_store_dwordx4 v[12:15], v3, s[4:7], s31 offen offset:0 sc1
  s_sleep 6
  buffer_store_dwordx4 v[12:15], v3, s[4:7], s31 offen offset:1024 sc1
  s_sleep 6
  buffer_store_dwordx4 v[12:15], v3, s[4:7], s31 offen offset:2048 sc1
  s_sleep 6
  buffer_store_dwordx4 v[12:15], v3, s[4:7], s31 offen offset:3072 sc1
  s_add_u32 s31, s30, 0x2890000
  s_sleep 6
  buffer_store_dwordx4 v[12:15], v3, s[4:7], s31 offen offset:0 sc1
  s_sleep 6
  buffer_store_dwordx4 v[12:15], v3, s[4:7], s31 offen offset:1024 sc1
  s_sleep 6
  buffer_store_dwordx4 v[12:15], v3, s[4:7], s31 offen offset:2048 sc1
  s_sleep 6
  buffer_store_dwordx4 v[12:15], v3, s[4:7], s31 offen offset:3072 sc1
  s_add_u32 s31, s30, 0x2b00000
  s_sleep 6
  buffer_store_dwordx4 v[12:15], v3, s[4:7], s31 offen offset:0 sc1
  s_sleep 6
  buffer_store_dwordx4 v[12:15], v3, s[4:7], s31 offen offset:1024 sc1
  s_sleep 6
  buffer_store_dwordx4 v[12:15], v3, s[4:7], s31 offen offset:2048 sc1
  s_sleep 6
  buffer_store_dwordx4 v[12:15], v3, s[4:7], s31 offen offset:3072 sc1
  s_branch .g2_kernel_zs21
.g2_kernel_zs21a:
  s_xor_b32 s31, s17, s18
  s_and_b32 s31, s31, 3
  s_cbranch_scc1 .g2_kernel_zs21b
  s_lshr_b32 s30, s30, 2
  s_lshl_b32 s30, s30, 8
  s_add_u32 s30, s30, s63
  s_add_u32 s30, s30, 0x1080000
  s_mov_b64 exec, 0xffff
  s_sleep 6
  buffer_store_dwordx4 v[12:15], v3, s[4:7], s30 offen sc1
  s_mov_b64 exec, -1
.g2_kernel_zs21b:
  s_and_b32 s30, s18, 14
  s_lshl_b32 s30, s30, 4
  s_add_u32 s30, s30, s17
  s_lshl_b32 s30, s30, 1
  s_and_b32 s31, s18, 1
  s_add_u32 s30, s30, s31
  s_lshl_b32 s30, s30, 10
  s_add_u32 s30, s30, s63
  s_add_u32 s30, s30, 0x1190000
  s_add_u32 s31, s30, 32768
  s_sleep 6
  buffer_store_dwordx4 v[12:15], v3, s[4:7], s30 offen sc1
  s_sleep 6
  buffer_store_dwordx4 v[12:15], v3, s[4:7], s31 offen sc1
.g2_kernel_zs21:
  s_cmp_eq_u32 s16, 4
  s_cbranch_scc1 .g2_kernel_v_3a
  s_cmp_lg_u32 s62, 0
  s_cbranch_scc1 .g2_kernel_g_e
  s_and_b32 s22, s16, 3
  s_lshl_b32 s22, s22, 14
  s_add_u32 s22, s22, 65536
  v_bfe_u32 v8, v2, 2, 2
  v_lshrrev_b32 v9, 4, v2
  v_and_b32 v10, 3, v2
  v_lshlrev_b32 v10, 3, v10
  v_add_u32 v10, s22, v10
  s_cmp_eq_u32 s16, 5
  s_cbranch_scc1 .g2_kernel_g_p
  s_cmp_ge_u32 s17, 14
  s_cbranch_scc1 .g2_kernel_g_e
  v_lshrrev_b32 v6, 1, v2
  v_mul_u32_u24 v6, 7168, v6
  v_and_b32 v7, 1, v2
  v_lshl_add_u32 v250, v7, 4, v6
  v_lshl_add_u32 v11, v9, 3, v8
  v_lshl_add_u32 v251, v11, 5, v10
  v_and_b32 v11, 1, v9
  v_lshl_add_u32 v11, v11, 3, v8
  v_lshl_add_u32 v11, v11, 10, v10
  v_lshrrev_b32 v7, 1, v9
  v_lshl_add_u32 v252, v7, 7, v11
  s_lshl_b32 s24, s17, 4
  s_add_u32 s24, s24, s18
  s_and_b32 s25, s16, 1
  s_mov_b32 s12, s50
  s_mov_b32 s13, s51
  s_mov_b32 s14, 0x700000
  s_mov_b32 s15, 0x00020000
  s_mul_i32 s20, s25, 3670016
  s_lshl_b32 s31, s24, 5
  s_add_u32 s20, s20, s31
  s_lshl_b32 s31, s18, 2
  s_mov_b32 s23, s31
  s_mov_b32 s21, 16
.g2_kernel_gl23:
  s_and_b32 s30, s21, 3
  s_cbranch_scc1 .g2_kernel_gl23m
  s_call_b64 s[26:27], .g2_kernel_v_may
.g2_kernel_gl23m:
  s_and_b32 s23, s23, 15
  s_lshl_b32 s30, s23, 10
  s_add_u32 s30, s30, 0
  s_add_u32 m0, s30, s22
  s_mul_i32 s30, s23, 229376
  s_add_u32 s30, s30, s20
  buffer_load_dwordx4 v250, s[12:15], s30 offen lds
  s_add_u32 s23, s23, 1
  s_sub_u32 s21, s21, 1
  s_sleep 3
  s_waitcnt vmcnt(2)
  s_cmp_lg_u32 s21, 0
  s_cbranch_scc1 .g2_kernel_gl23
  s_waitcnt vmcnt(0)
  ds_read_b64_tr_b16 v[64:65], v251 offset:0
  ds_read_b64_tr_b16 v[66:67], v251 offset:128
  ds_read_b64_tr_b16 v[68:69], v251 offset:1024
  ds_read_b64_tr_b16 v[70:71], v251 offset:1152
  ds_read_b64_tr_b16 v[72:73], v251 offset:2048
  ds_read_b64_tr_b16 v[74:75], v251 offset:2176
  ds_read_b64_tr_b16 v[76:77], v251 offset:3072
  ds_read_b64_tr_b16 v[78:79], v251 offset:3200
  ds_read_b64_tr_b16 v[80:81], v251 offset:4096
  ds_read_b64_tr_b16 v[82:83], v251 offset:4224
  ds_read_b64_tr_b16 v[84:85], v251 offset:5120
  ds_read_b64_tr_b16 v[86:87], v251 offset:5248
  ds_read_b64_tr_b16 v[88:89], v251 offset:6144
  ds_read_b64_tr_b16 v[90:91], v251 offset:6272
  ds_read_b64_tr_b16 v[92:93], v251 offset:7168
  ds_read_b64_tr_b16 v[94:95], v251 offset:7296
  ds_read_b64_tr_b16 v[96:97], v251 offset:8192
  ds_read_b64_tr_b16 v[98:99], v251 offset:8320
  ds_read_b64_tr_b16 v[100:101], v251 offset:9216
  ds_read_b64_tr_b16 v[102:103], v251 offset:9344
  ds_read_b64_tr_b16 v[104:105], v251 offset:10240
  ds_read_b64_tr_b16 v[106:107], v251 offset:10368
  ds_read_b64_tr_b16 v[108:109], v251 offset:11264
  ds_read_b64_tr_b16 v[110:111], v251 offset:11392
  ds_read_b64_tr_b16 v[112:113], v251 offset:12288
  ds_read_b64_tr_b16 v[114:115], v251 offset:12416
  ds_read_b64_tr_b16 v[116:117], v251 offset:13312
  ds_read_b64_tr_b16 v[118:119], v251 offset:13440
  ds_read_b64_tr_b16 v[120:121], v251 offset:14336
  ds_read_b64_tr_b16 v[122:123], v251 offset:14464
  ds_read_b64_tr_b16 v[124:125], v251 offset:15360
  ds_read_b64_tr_b16 v[126:127], v251 offset:15488
  s_waitcnt lgkmcnt(0)
  s_mov_b32 s12, s52
  s_mov_b32 s13, s53
  s_mov_b32 s14, 0x700000
  s_mov_b32 s15, 0x00020000
  s_mul_i32 s20, s25, 3670016
  s_lshl_b32 s31, s24, 5
  s_add_u32 s20, s20, s31
  s_lshl_b32 s31, s18, 2
  s_mov_b32 s23, s31
  s_mov_b32 s21, 16
.g2_kernel_gl24:
  s_and_b32 s30, s21, 3
  s_cbranch_scc1 .g2_kernel_gl24m
  s_call_b64 s[26:27], .g2_kernel_v_may
.g2_kernel_gl24m:
  s_and_b32 s23, s23, 15
  s_lshl_b32 s30, s23, 10
  s_add_u32 s30, s30, 0
  s_add_u32 m0, s30, s22
  s_mul_i32 s30, s23, 229376
  s_add_u32 s30, s30, s20
  buffer_load_dwordx4 v250, s[12:15], s30 offen lds
  s_add_u32 s23, s23, 1
  s_sub_u32 s21, s21, 1
  s_sleep 3
  s_waitcnt vmcnt(2)
  s_cmp_lg_u32 s21, 0
  s_cbranch_scc1 .g2_kernel_gl24
  s_waitcnt vmcnt(0)
  ds_read_b64_tr_b16 v[128:129], v251 offset:0
  ds_read_b64_tr_b16 v[130:131], v251 offset:128
  ds_read_b64_tr_b16 v[132:133], v251 offset:1024
  ds_read_b64_tr_b16 v[134:135], v251 offset:1152
  ds_read_b64_tr_b16 v[136:137], v251 offset:2048
  ds_read_b64_tr_b16 v[138:139], v251 offset:2176
  ds_read_b64_tr_b16 v[140:141], v251 offset:3072
  ds_read_b64_tr_b16 v[142:143], v251 offset:3200
  ds_read_b64_tr_b16 v[144:145], v251 offset:4096
  ds_read_b64_tr_b16 v[146:147], v251 offset:4224
  ds_read_b64_tr_b16 v[148:149], v251 offset:5120
  ds_read_b64_tr_b16 v[150:151], v251 offset:5248
  ds_read_b64_tr_b16 v[152:153], v251 offset:6144
  ds_read_b64_tr_b16 v[154:155], v251 offset:6272
  ds_read_b64_tr_b16 v[156:157], v251 offset:7168
  ds_read_b64_tr_b16 v[158:159], v251 offset:7296
  ds_read_b64_tr_b16 v[160:161], v251 offset:8192
  ds_read_b64_tr_b16 v[162:163], v251 offset:8320
  ds_read_b64_tr_b16 v[164:165], v251 offset:9216
  ds_read_b64_tr_b16 v[166:167], v251 offset:9344
  ds_read_b64_tr_b16 v[168:169], v251 offset:10240
  ds_read_b64_tr_b16 v[170:171], v251 offset:10368
  ds_read_b64_tr_b16 v[172:173], v251 offset:11264
  ds_read_b64_tr_b16 v[174:175], v251 offset:11392
  ds_read_b64_tr_b16 v[176:177], v251 offset:12288
  ds_read_b64_tr_b16 v[178:179], v251 offset:12416
  ds_read_b64_tr_b16 v[180:181], v251 offset:13312
  ds_read_b64_tr_b16 v[182:183], v251 offset:13440
  ds_read_b64_tr_b16 v[184:185], v251 offset:14336
  ds_read_b64_tr_b16 v[186:187], v251 offset:14464
  ds_read_b64_tr_b16 v[188:189], v251 offset:15360
  ds_read_b64_tr_b16 v[190:191], v251 offset:15488
  s_waitcnt lgkmcnt(0)
  s_mov_b32 s12, s54
  s_mov_b32 s13, s55
  s_mov_b32 s14, 0x700000
  s_mov_b32 s15, 0x00020000
  s_lshl_b32 s20, s24, 15
  s_lshl_b32 s31, s25, 10
  s_add_u32 s20, s20, s31
  s_mov_b32 s23, 0
  s_mov_b32 s21, 16
.g2_kernel_gl25:
  s_and_b32 s30, s21, 3
  s_cbranch_scc1 .g2_kernel_gl25m
  s_call_b64 s[26:27], .g2_kernel_v_may
.g2_kernel_gl25m:
  s_and_b32 s23, s23, 15
  s_lshl_b32 s30, s23, 10
  s_add_u32 s30, s30, 0
  s_add_u32 m0, s30, s22
  s_mul_i32 s30, s23, 2048
  s_add_u32 s30, s30, s20
  buffer_load_dwordx4 v3, s[12:15], s30 offen lds
  s_add_u32 s23, s23, 1
  s_sub_u32 s21, s21, 1
  s_sleep 2
  s_waitcnt vmcnt(2)
  s_cmp_lg_u32 s21, 0
  s_cbranch_scc1 .g2_kernel_gl25
  v_mov_b32 v11, v252
  s_waitcnt vmcnt(0)
  ds_read_b64_tr_b16 v[192:193], v11 offset:0
  ds_read_b64_tr_b16 v[194:195], v11 offset:4096
  ds_read_b64_tr_b16 v[196:197], v11 offset:32
  ds_read_b64_tr_b16 v[198:199], v11 offset:4128
  ds_read_b64_tr_b16 v[200:201], v11 offset:64
  ds_read_b64_tr_b16 v[202:203], v11 offset:4160
  ds_read_b64_tr_b16 v[204:205], v11 offset:96
  ds_read_b64_tr_b16 v[206:207], v11 offset:4192
  ds_read_b64_tr_b16 v[208:209], v11 offset:256
  ds_read_b64_tr_b16 v[210:211], v11 offset:4352
  ds_read_b64_tr_b16 v[212:213], v11 offset:288
  ds_read_b64_tr_b16 v[214:215], v11 offset:4384
  ds_read_b64_tr_b16 v[216:217], v11 offset:320
  ds_read_b64_tr_b16 v[218:219], v11 offset:4416
  ds_read_b64_tr_b16 v[220:221], v11 offset:352
  ds_read_b64_tr_b16 v[222:223], v11 offset:4448
  ds_read_b64_tr_b16 v[224:225], v11 offset:512
  ds_read_b64_tr_b16 v[226:227], v11 offset:4608
  ds_read_b64_tr_b16 v[228:229], v11 offset:544
  ds_read_b64_tr_b16 v[230:231], v11 offset:4640
  ds_read_b64_tr_b16 v[232:233], v11 offset:576
  ds_read_b64_tr_b16 v[234:235], v11 offset:4672
  ds_read_b64_tr_b16 v[236:237], v11 offset:608
  ds_read_b64_tr_b16 v[238:239], v11 offset:4704
  ds_read_b64_tr_b16 v[240:241], v11 offset:768
  ds_read_b64_tr_b16 v[242:243], v11 offset:4864
  ds_read_b64_tr_b16 v[244:245], v11 offset:800
  ds_read_b64_tr_b16 v[246:247], v11 offset:4896
  ds_read_b64_tr_b16 v[248:249], v11 offset:832
  ds_read_b64_tr_b16 v[250:251], v11 offset:4928
  ds_read_b64_tr_b16 v[252:253], v11 offset:864
  ds_read_b64_tr_b16 v[254:255], v11 offset:4960
  s_waitcnt lgkmcnt(0)
  s_branch .g2_kernel_g_e
.g2_kernel_g_p:
  s_mov_b32 s12, s42
  s_mov_b32 s13, s43
  s_mov_b32 s14, 0x600000
  s_mov_b32 s15, 0x00020000
  v_mul_u32_u24 v6, 6144, v9
  v_and_b32 v7, 15, v2
  v_lshl_add_u32 v250, v7, 4, v6
  v_lshl_add_u32 v11, v8, 2, v9
  v_lshl_add_u32 v251, v11, 9, v10
  s_lshl_b32 s20, s17, 3
  s_and_b32 s31, s18, 1
  s_add_u32 s20, s20, s31
  s_mul_i32 s20, s20, 49152
  s_and_b32 s31, s18, 14
  s_lshl_b32 s31, s31, 7
  s_add_u32 s20, s20, s31
  s_mov_b32 s23, 0
  s_mov_b32 s21, 8
.g2_kernel_gl26:
  s_and_b32 s30, s21, 3
  s_cbranch_scc1 .g2_kernel_gl26m
  s_call_b64 s[26:27], .g2_kernel_v_may
.g2_kernel_gl26m:
  s_and_b32 s23, s23, 7
  s_lshl_b32 s30, s23, 10
  s_add_u32 s30, s30, 0
  s_add_u32 m0, s30, s22
  s_mul_i32 s30, s23, 49152
  s_add_u32 s30, s30, s20
  s_and_b32 s31, s23, 1
  s_mul_i32 s31, s31, -24576
  s_add_u32 s30, s30, s31
  buffer_load_dwordx4 v250, s[12:15], s30 offen lds
  s_add_u32 s23, s23, 1
  s_sub_u32 s21, s21, 1
  s_sleep 3
  s_waitcnt vmcnt(2)
  s_cmp_lg_u32 s21, 0
  s_cbranch_scc1 .g2_kernel_gl26
  s_add_u32 s20, s20, 2048
  s_mov_b32 s23, 0
  s_mov_b32 s21, 8
.g2_kernel_gl27:
  s_and_b32 s30, s21, 3
  s_cbranch_scc1 .g2_kernel_gl27m
  s_call_b64 s[26:27], .g2_kernel_v_may
.g2_kernel_gl27m:
  s_and_b32 s23, s23, 7
  s_lshl_b32 s30, s23, 10
  s_add_u32 s30, s30, 8192
  s_add_u32 m0, s30, s22
  s_mul_i32 s30, s23, 49152
  s_add_u32 s30, s30, s20
  s_and_b32 s31, s23, 1
  s_mul_i32 s31, s31, -24576
  s_add_u32 s30, s30, s31
  buffer_load_dwordx4 v250, s[12:15], s30 offen lds
  s_add_u32 s23, s23, 1
  s_sub_u32 s21, s21, 1
  s_sleep 3
  s_waitcnt vmcnt(2)
  s_cmp_lg_u32 s21, 0
  s_cbranch_scc1 .g2_kernel_gl27
  s_add_u32 s20, s20, 2048
  s_waitcnt vmcnt(0)
  ds_read_b64_tr_b16 v[64:65], v251 offset:0
  ds_read_b64_tr_b16 v[66:67], v251 offset:256
  ds_read_b64_tr_b16 v[68:69], v251 offset:32
  ds_read_b64_tr_b16 v[70:71], v251 offset:288
  ds_read_b64_tr_b16 v[72:73], v251 offset:64
  ds_read_b64_tr_b16 v[74:75], v251 offset:320
  ds_read_b64_tr_b16 v[76:77], v251 offset:96
  ds_read_b64_tr_b16 v[78:79], v251 offset:352
  ds_read_b64_tr_b16 v[80:81], v251 offset:128
  ds_read_b64_tr_b16 v[82:83], v251 offset:384
  ds_read_b64_tr_b16 v[84:85], v251 offset:160
  ds_read_b64_tr_b16 v[86:87], v251 offset:416
  ds_read_b64_tr_b16 v[88:89], v251 offset:192
  ds_read_b64_tr_b16 v[90:91], v251 offset:448
  ds_read_b64_tr_b16 v[92:93], v251 offset:224
  ds_read_b64_tr_b16 v[94:95], v251 offset:480
  ds_read_b64_tr_b16 v[96:97], v251 offset:8192
  ds_read_b64_tr_b16 v[98:99], v251 offset:8448
  ds_read_b64_tr_b16 v[100:101], v251 offset:8224
  ds_read_b64_tr_b16 v[102:103], v251 offset:8480
  ds_read_b64_tr_b16 v[104:105], v251 offset:8256
  ds_read_b64_tr_b16 v[106:107], v251 offset:8512
  ds_read_b64_tr_b16 v[108:109], v251 offset:8288
  ds_read_b64_tr_b16 v[110:111], v251 offset:8544
  ds_read_b64_tr_b16 v[112:113], v251 offset:8320
  ds_read_b64_tr_b16 v[114:115], v251 offset:8576
  ds_read_b64_tr_b16 v[116:117], v251 offset:8352
  ds_read_b64_tr_b16 v[118:119], v251 offset:8608
  ds_read_b64_tr_b16 v[120:121], v251 offset:8384
  ds_read_b64_tr_b16 v[122:123], v251 offset:8640
  ds_read_b64_tr_b16 v[124:125], v251 offset:8416
  ds_read_b64_tr_b16 v[126:127], v251 offset:8672
  s_waitcnt lgkmcnt(0)
  s_mov_b32 s23, 0
  s_mov_b32 s21, 8
.g2_kernel_gl28:
  s_and_b32 s30, s21, 3
  s_cbranch_scc1 .g2_kernel_gl28m
  s_call_b64 s[26:27], .g2_kernel_v_may
.g2_kernel_gl28m:
  s_and_b32 s23, s23, 7
  s_lshl_b32 s30, s23, 10
  s_add_u32 s30, s30, 0
  s_add_u32 m0, s30, s22
  s_mul_i32 s30, s23, 49152
  s_add_u32 s30, s30, s20
  s_and_b32 s31, s23, 1
  s_mul_i32 s31, s31, -24576
  s_add_u32 s30, s30, s31
  buffer_load_dwordx4 v250, s[12:15], s30 offen lds
  s_add_u32 s23, s23, 1
  s_sub_u32 s21, s21, 1
  s_sleep 3
  s_waitcnt vmcnt(2)
  s_cmp_lg_u32 s21, 0
  s_cbranch_scc1 .g2_kernel_gl28
  s_add_u32 s20, s20, 2048
  s_waitcnt vmcnt(0)
  ds_read_b64_tr_b16 v[128:129], v251 offset:0
  ds_read_b64_tr_b16 v[130:131], v251 offset:256
  ds_read_b64_tr_b16 v[132:133], v251 offset:32
  ds_read_b64_tr_b16 v[134:135], v251 offset:288
  ds_read_b64_tr_b16 v[136:137], v251 offset:64
  ds_read_b64_tr_b16 v[138:139], v251 offset:320
  ds_read_b64_tr_b16 v[140:141], v251 offset:96
  ds_read_b64_tr_b16 v[142:143], v251 offset:352
  ds_read_b64_tr_b16 v[144:145], v251 offset:128
  ds_read_b64_tr_b16 v[146:147], v251 offset:384
  ds_read_b64_tr_b16 v[148:149], v251 offset:160
  ds_read_b64_tr_b16 v[150:151], v251 offset:416
  ds_read_b64_tr_b16 v[152:153], v251 offset:192
  ds_read_b64_tr_b16 v[154:155], v251 offset:448
  ds_read_b64_tr_b16 v[156:157], v251 offset:224
  ds_read_b64_tr_b16 v[158:159], v251 offset:480
  s_waitcnt lgkmcnt(0)
.g2_kernel_g_e:
.g2_kernel_v_3:
  s_mov_b32 s29, 0
  s_and_b32 s30, s16, 3
  s_lshl_b32 s30, s30, 14
  s_add_u32 s30, s30, 65536
  s_call_b64 s[68:69], .g2_kernel_v_wo
  s_waitcnt vmcnt(0)
  v_mov_b32 v6, s71
  s_mov_b64 exec, 1
  ds_add_u32 v6, v5 offset:52
  s_mov_b64 exec, -1
  s_cmp_lg_u32 s39, 0
  s_cbranch_scc1 .g2_kernel_v_3b
  s_call_b64 s[26:27], .g2_kernel_v_do
.g2_kernel_v_3b:
  s_cmp_lg_u32 s16, 4
  s_cbranch_scc1 .g2_kernel_v_4
  v_mov_b32 v6, s71
  s_mov_b32 s38, 0
.g2_kernel_wg29:
  ds_read_b32 v7, v6 offset:8
  s_add_u32 s38, s38, 1
  s_waitcnt lgkmcnt(0)
  v_cmp_le_u32 vcc, 10, v7
  s_cbranch_vccnz .g2_kernel_wg29d
  s_sleep 8
  s_cmp_lt_u32 s38, 524288
  s_cbranch_scc1 .g2_kernel_wg29
.g2_kernel_wg29d:
  s_mov_b32 s29, 1
  s_mov_b32 s30, 139264
  s_call_b64 s[68:69], .g2_kernel_v_wo
  s_add_u32 s31, s31, 81920
  s_sleep 6
  s_waitcnt vmcnt(4)
  buffer_load_dwordx4 v[64:67], v6, s[8:11], s31 offen
  s_add_u32 s31, s31, 16384
  buffer_load_dwordx4 v[68:71], v6, s[8:11], s31 offen
  s_add_u32 s31, s31, 16384
  buffer_load_dwordx4 v[72:75], v6, s[8:11], s31 offen
  s_add_u32 s31, s31, 16384
  buffer_load_dwordx4 v[76:79], v6, s[8:11], s31 offen
  s_add_u32 s31, s31, 81920
  s_sleep 6
  s_waitcnt vmcnt(4)
  buffer_load_dwordx4 v[80:83], v6, s[8:11], s31 offen
  s_add_u32 s31, s31, 16384
  buffer_load_dwordx4 v[84:87], v6, s[8:11], s31 offen
  s_add_u32 s31, s31, 16384
  buffer_load_dwordx4 v[88:91], v6, s[8:11], s31 offen
  s_add_u32 s31, s31, 16384
  buffer_load_dwordx4 v[92:95], v6, s[8:11], s31 offen
  s_add_u32 s31, s31, 81920
  s_sleep 6
  s_waitcnt vmcnt(4)
  buffer_load_dwordx4 v[96:99], v6, s[8:11], s31 offen
  s_add_u32 s31, s31, 16384
  buffer_load_dwordx4 v[100:103], v6, s[8:11], s31 offen
  s_add_u32 s31, s31, 16384
  buffer_load_dwordx4 v[104:107], v6, s[8:11], s31 offen
  s_add_u32 s31, s31, 16384
  buffer_load_dwordx4 v[108:111], v6, s[8:11], s31 offen
  s_add_u32 s31, s31, 81920
  s_sleep 6
  s_waitcnt vmcnt(4)
  buffer_load_dwordx4 v[112:115], v6, s[8:11], s31 offen
  s_add_u32 s31, s31, 16384
  buffer_load_dwordx4 v[116:119], v6, s[8:11], s31 offen
  s_add_u32 s31, s31, 16384
  buffer_load_dwordx4 v[120:123], v6, s[8:11], s31 offen
  s_add_u32 s31, s31, 16384
  buffer_load_dwordx4 v[124:127], v6, s[8:11], s31 offen
  s_add_u32 s31, s31, 81920
  s_sleep 6
  s_waitcnt vmcnt(4)
  s_mov_b32 m0, 32768
  s_nop 0
  buffer_load_dwordx4 v6, s[8:11], s31 offen lds
  s_add_u32 s31, s31, 16384
  s_mov_b32 m0, 33792
  s_nop 0
  buffer_load_dwordx4 v6, s[8:11], s31 offen lds
  s_add_u32 s31, s31, 16384
  s_mov_b32 m0, 34816
  s_nop 0
  buffer_load_dwordx4 v6, s[8:11], s31 offen lds
  s_add_u32 s31, s31, 16384
  s_mov_b32 m0, 35840
  s_nop 0
  buffer_load_dwordx4 v6, s[8:11], s31 offen lds
  s_add_u32 s31, s31, 81920
  s_sleep 6
  s_waitcnt vmcnt(4)
  s_mov_b32 m0, 36864
  s_nop 0
  buffer_load_dwordx4 v6, s[8:11], s31 offen lds
  s_add_u32 s31, s31, 16384
  s_mov_b32 m0, 37888
  s_nop 0
  buffer_load_dwordx4 v6, s[8:11], s31 offen lds
  s_add_u32 s31, s31, 16384
  s_mov_b32 m0, 38912
  s_nop 0
  buffer_load_dwordx4 v6, s[8:11], s31 offen lds
  s_add_u32 s31, s31, 16384
  s_mov_b32 m0, 39936
  s_nop 0
  buffer_load_dwordx4 v6, s[8:11], s31 offen lds
  s_add_u32 s31, s31, 81920
  s_sleep 6
  s_waitcnt vmcnt(4)
  s_mov_b32 m0, 40960
  s_nop 0
  buffer_load_dwordx4 v6, s[8:11], s31 offen lds
  s_add_u32 s31, s31, 16384
  s_mov_b32 m0, 41984
  s_nop 0
  buffer_load_dwordx4 v6, s[8:11], s31 offen lds
  s_add_u32 s31, s31, 16384
  s_mov_b32 m0, 43008
  s_nop 0
  buffer_load_dwordx4 v6, s[8:11], s31 offen lds
  s_add_u32 s31, s31, 16384
  s_mov_b32 m0, 44032
  s_nop 0
  buffer_load_dwordx4 v6, s[8:11], s31 offen lds
  s_add_u32 s31, s31, 81920
  s_sleep 6
  s_waitcnt vmcnt(4)
  s_mov_b32 m0, 45056
  s_nop 0
  buffer_load_dwordx4 v6, s[8:11], s31 offen lds
  s_add_u32 s31, s31, 16384
  s_mov_b32 m0, 46080
  s_nop 0
  buffer_load_dwordx4 v6, s[8:11], s31 offen lds
  s_add_u32 s31, s31, 16384
  s_mov_b32 m0, 47104
  s_nop 0
  buffer_load_dwordx4 v6, s[8:11], s31 offen lds
  s_add_u32 s31, s31, 16384
  s_mov_b32 m0, 48128
  s_nop 0
  buffer_load_dwordx4 v6, s[8:11], s31 offen lds
  s_add_u32 s31, s31, 81920
  s_sleep 6
  s_waitcnt vmcnt(4)
  s_mov_b32 m0, 49152
  s_nop 0
  buffer_load_dwordx4 v6, s[8:11], s31 offen lds
  s_add_u32 s31, s31, 16384
  s_mov_b32 m0, 50176
  s_nop 0
  buffer_load_dwordx4 v6, s[8:11], s31 offen lds
  s_add_u32 s31, s31, 16384
  s_mov_b32 m0, 51200
  s_nop 0
  buffer_load_dwordx4 v6, s[8:11], s31 offen lds
  s_add_u32 s31, s31, 16384
  s_mov_b32 m0, 52224
  s_nop 0
  buffer_load_dwordx4 v6, s[8:11], s31 offen lds
  s_add_u32 s31, s31, 81920
  s_sleep 6
  s_waitcnt vmcnt(4)
  s_mov_b32 m0, 53248
  s_nop 0
  buffer_load_dwordx4 v6, s[8:11], s31 offen lds
  s_add_u32 s31, s31, 16384
  s_mov_b32 m0, 54272
  s_nop 0
  buffer_load_dwordx4 v6, s[8:11], s31 offen lds
  s_add_u32 s31, s31, 16384
  s_mov_b32 m0, 55296
  s_nop 0
  buffer_load_dwordx4 v6, s[8:11], s31 offen lds
  s_add_u32 s31, s31, 16384
  s_mov_b32 m0, 56320
  s_nop 0
  buffer_load_dwordx4 v6, s[8:11], s31 offen lds
  s_add_u32 s31, s31, 81920
  s_sleep 6
  s_waitcnt vmcnt(4)
  s_mov_b32 m0, 57344
  s_nop 0
  buffer_load_dwordx4 v6, s[8:11], s31 offen lds
  s_add_u32 s31, s31, 16384
  s_mov_b32 m0, 58368
  s_nop 0
  buffer_load_dwordx4 v6, s[8:11], s31 offen lds
  s_add_u32 s31, s31, 16384
  s_mov_b32 m0, 59392
  s_nop 0
  buffer_load_dwordx4 v6, s[8:11], s31 offen lds
  s_add_u32 s31, s31, 16384
  s_mov_b32 m0, 60416
  s_nop 0
  buffer_load_dwordx4 v6, s[8:11], s31 offen lds
  s_add_u32 s31, s31, 81920
  s_sleep 6
  s_waitcnt vmcnt(4)
  s_mov_b32 m0, 61440
  s_nop 0
  buffer_load_dwordx4 v6, s[8:11], s31 offen lds
  s_add_u32 s31, s31, 16384
  s_mov_b32 m0, 62464
  s_nop 0
  buffer_load_dwordx4 v6, s[8:11], s31 offen lds
  s_add_u32 s31, s31, 16384
  s_mov_b32 m0, 63488
  s_nop 0
  buffer_load_dwordx4 v6, s[8:11], s31 offen lds
  s_add_u32 s31, s31, 16384
  s_mov_b32 m0, 64512
  s_nop 0
  buffer_load_dwordx4 v6, s[8:11], s31 offen lds
.g2_kernel_v_4:
  s_cmp_lg_u32 s16, 5
  s_cbranch_scc1 .g2_kernel_v_5
  s_sleep 64
  s_and_b32 s31, s19, 0xffffe000
  s_add_u32 s31, s31, 0
  v_and_b32 v6, 15, v2
  v_lshlrev_b32 v6, 9, v6
  v_lshrrev_b32 v7, 4, v2
  v_lshl_add_u32 v6, v7, 7, v6
  v_lshlrev_b32 v7, 2, v2
  v_add_u32 v7, 157696, v7
  s_mov_b32 m0, 157696
  s_mov_b32 s38, 0
.g2_kernel_pa30:
  buffer_load_dword v6, s[4:7], s31 offen sc1 lds
  s_add_u32 s38, s38, 1
  s_waitcnt vmcnt(0)
  ds_read_b32 v8, v7
  s_waitcnt lgkmcnt(0)
  v_cmp_ge_u32 vcc, s62, v8
  s_cbranch_vccz .g2_kernel_pa30d
  s_mov_b64 exec, vcc
  s_sleep 32
  s_cmp_lt_u32 s38, 131072
  s_cbranch_scc1 .g2_kernel_pa30
.g2_kernel_pa30d:
  s_mov_b64 exec, -1
  v_lshlrev_b32 v6, 7, v2
  s_lshl_b32 s30, s17, 2
  s_and_b32 s31, s18, 3
  s_add_u32 s30, s30, s31
  s_lshl_b32 s30, s30, 16
  s_add_u32 s30, s30, s63
  s_add_u32 s30, s30, 0x800000
  s_sleep 8
  buffer_load_dword v1, v6, s[4:7], s30 offen
  s_add_u32 s30, s30, 8192
  s_sleep 8
  buffer_load_dword v1, v6, s[4:7], s30 offen
  s_add_u32 s30, s30, 8192
  s_sleep 8
  buffer_load_dword v1, v6, s[4:7], s30 offen
  s_add_u32 s30, s30, 8192
  s_sleep 8
  buffer_load_dword v1, v6, s[4:7], s30 offen
  s_add_u32 s30, s30, 8192
  s_lshl_b32 s28, s2, 10
  s_and_b32 s28, s28, 0xe000
  v_lshlrev_b32 v7, 7, v2
  buffer_load_dword v1, v7, s[64:67], s28 offen
.g2_kernel_v_5:
  s_mov_b32 s29, 1
  s_call_b64 s[68:69], .g2_kernel_v_cmb
  s_cmp_lg_u32 s16, 7
  s_cbranch_scc1 .g2_kernel_v_7
  s_and_b32 s33, s16, 3
  s_lshl_b32 s33, s33, 7
  s_lshl_b32 s28, s29, 2
  s_add_u32 s33, s33, s28
  s_add_u32 s31, s19, s33
  v_mov_b32 v6, s70
  s_mov_b64 exec, 1
  buffer_store_dword v6, v4, s[4:7], s31 offen offset:0 sc1
  s_mov_b64 exec, -1
.g2_kernel_v_7:
  s_cmp_lg_u32 s16, 4
  s_cbranch_scc1 .g2_kernel_v_8
  s_waitcnt vmcnt(2)
  v_mov_b32 v6, s71
  s_mov_b32 s38, 0
.g2_kernel_wg31:
  ds_read_b32 v7, v6 offset:76
  s_add_u32 s38, s38, 1
  s_waitcnt lgkmcnt(0)
  v_cmp_le_u32 vcc, 1, v7
  s_cbranch_vccnz .g2_kernel_wg31d
  s_sleep 1
  s_cmp_lt_u32 s38, 524288
  s_cbranch_scc1 .g2_kernel_wg31
.g2_kernel_wg31d:
  v_mov_b32 v6, s71
  s_mov_b32 s38, 0
.g2_kernel_wg32:
  ds_read_b32 v7, v6 offset:72
  s_add_u32 s38, s38, 1
  s_waitcnt lgkmcnt(0)
  v_cmp_le_u32 vcc, 1, v7
  s_cbranch_vccnz .g2_kernel_wg32d
  s_sleep 1
  s_cmp_lt_u32 s38, 524288
  s_cbranch_scc1 .g2_kernel_wg32
.g2_kernel_wg32d:
  v_mov_b32 v6, s71
  s_mov_b32 s38, 0
.g2_kernel_wg33:
  ds_read_b32 v7, v6 offset:68
  s_add_u32 s38, s38, 1
  s_waitcnt lgkmcnt(0)
  v_cmp_le_u32 vcc, 1, v7
  s_cbranch_vccnz .g2_kernel_wg33d
  s_sleep 1
  s_cmp_lt_u32 s38, 524288
  s_cbranch_scc1 .g2_kernel_wg33
.g2_kernel_wg33d:
  ds_write_b128 v3, v[64:67] offset:16384
  ds_write_b128 v3, v[68:71] offset:17408
  ds_write_b128 v3, v[72:75] offset:18432
  ds_write_b128 v3, v[76:79] offset:19456
  ds_write_b128 v3, v[80:83] offset:20480
  ds_write_b128 v3, v[84:87] offset:21504
  ds_write_b128 v3, v[88:91] offset:22528
  ds_write_b128 v3, v[92:95] offset:23552
  ds_write_b128 v3, v[96:99] offset:24576
  ds_write_b128 v3, v[100:103] offset:25600
  ds_write_b128 v3, v[104:107] offset:26624
  ds_write_b128 v3, v[108:111] offset:27648
  ds_write_b128 v3, v[112:115] offset:28672
  ds_write_b128 v3, v[116:119] offset:29696
  ds_write_b128 v3, v[120:123] offset:30720
  ds_write_b128 v3, v[124:127] offset:31744
  v_mov_b32 v8, 4
  ds_write_b32 v6, v8 offset:12
.g2_kernel_v_8:
  s_cmp_eq_u32 s16, 5
  s_cbranch_scc1 .g2_kernel_c1
  s_cmp_lg_u32 s16, 4
  s_cbranch_scc1 .g2_kernel_c2
  s_cmp_lg_u32 s62, 0
  s_cbranch_scc1 .g2_kernel_fin1
  s_setprio 3
  s_mov_b32 s12, s42
  s_mov_b32 s13, s43
  s_mov_b32 s14, 0x600000
  s_mov_b32 s15, 0x00020000
  v_lshrrev_b32 v28, 3, v2
  v_and_b32 v29, 7, v2
  v_bfe_u32 v30, v2, 4, 1
  v_lshlrev_b32 v30, 1, v30
  v_xor_b32 v31, v29, v30
  v_lshlrev_b32 v31, 4, v31
  v_mul_u32_u24 v28, 6144, v28
  v_add_u32 v28, v28, v31
  v_xor_b32 v29, 64, v28
  v_lshlrev_b32 v9, 8, v2
  v_and_b32 v9, 0x300, v9
  v_add_u32 v9, 156416, v9
  v_add_u32 v48, 0, v28
  v_add_u32 v49, 48128, v29
  v_add_u32 v50, 96256, v28
  v_add_u32 v51, 144384, v29
  v_add_u32 v52, 2048, v28
  v_add_u32 v53, 50176, v29
  v_add_u32 v54, 98304, v28
  v_add_u32 v55, 146432, v29
  v_add_u32 v56, 4096, v28
  v_add_u32 v57, 52224, v29
  v_add_u32 v58, 100352, v28
  v_add_u32 v59, 148480, v29
  v_and_b32 v11, 15, v2
  v_xor_b32 v11, s18, v11
  v_and_b32 v12, 48, v2
  v_add_u32 v11, v11, v12
  v_lshlrev_b32 v11, 2, v11
  v_add_u32 v11, 158208, v11
  s_lshl_b32 s39, s18, 7
  s_lshl_b32 s32, s17, 18
  s_add_u32 s32, s32, 0xc00000
  s_mov_b32 s30, 0
  s_mov_b32 s29, 0
  s_mov_b32 s37, 0
  v_mov_b32 v6, s71
  s_mov_b32 s38, 0
.g2_kernel_wg34:
  ds_read_b32 v7, v6 offset:16
  s_add_u32 s38, s38, 1
  s_waitcnt lgkmcnt(0)
  v_cmp_le_u32 vcc, 4, v7
  s_cbranch_vccnz .g2_kernel_wg34d
  s_sleep 2
  s_cmp_lt_u32 s38, 524288
  s_cbranch_scc1 .g2_kernel_wg34
.g2_kernel_wg34d:
  s_xor_b32 s36, s18, 0
  s_mul_i32 s36, s36, 393216
  s_add_u32 s36, s36, s39
  s_add_u32 m0, s30, 65536
  s_waitcnt vmcnt(63)
  buffer_load_dwordx4 v48, s[12:15], s36 offen offset:0 lds
  buffer_load_dwordx4 v49, s[12:15], s36 offen offset:1024 lds
  buffer_load_dwordx4 v50, s[12:15], s36 offen offset:2048 lds
  buffer_load_dwordx4 v51, s[12:15], s36 offen offset:3072 lds
  s_add_u32 m0, s30, 69632
  s_waitcnt vmcnt(63)
  buffer_load_dwordx4 v52, s[12:15], s36 offen offset:0 lds
  buffer_load_dwordx4 v53, s[12:15], s36 offen offset:1024 lds
  buffer_load_dwordx4 v54, s[12:15], s36 offen offset:2048 lds
  buffer_load_dwordx4 v55, s[12:15], s36 offen offset:3072 lds
  s_add_u32 m0, s30, 73728
  s_waitcnt vmcnt(63)
  buffer_load_dwordx4 v56, s[12:15], s36 offen offset:0 lds
  buffer_load_dwordx4 v57, s[12:15], s36 offen offset:1024 lds
  buffer_load_dwordx4 v58, s[12:15], s36 offen offset:2048 lds
  buffer_load_dwordx4 v59, s[12:15], s36 offen offset:3072 lds
  s_add_u32 s30, s30, 12288
  s_cmp_eq_u32 s30, 86016
  s_cselect_b32 s30, 0, s30
  s_xor_b32 s36, s18, 0
  s_mul_i32 s36, s36, 393216
  s_add_u32 s36, s36, s39
  s_add_u32 s36, s36, 196608
  s_add_u32 m0, s30, 65536
  s_waitcnt vmcnt(63)
  buffer_load_dwordx4 v48, s[12:15], s36 offen offset:0 lds
  buffer_load_dwordx4 v49, s[12:15], s36 offen offset:1024 lds
  buffer_load_dwordx4 v50, s[12:15], s36 offen offset:2048 lds
  buffer_load_dwordx4 v51, s[12:15], s36 offen offset:3072 lds
  s_add_u32 m0, s30, 69632
  s_waitcnt vmcnt(63)
  buffer_load_dwordx4 v52, s[12:15], s36 offen offset:0 lds
  buffer_load_dwordx4 v53, s[12:15], s36 offen offset:1024 lds
  buffer_load_dwordx4 v54, s[12:15], s36 offen offset:2048 lds
  buffer_load_dwordx4 v55, s[12:15], s36 offen offset:3072 lds
  s_add_u32 m0, s30, 73728
  s_waitcnt vmcnt(63)
  buffer_load_dwordx4 v56, s[12:15], s36 offen offset:0 lds
  buffer_load_dwordx4 v57, s[12:15], s36 offen offset:1024 lds
  buffer_load_dwordx4 v58, s[12:15], s36 offen offset:2048 lds
  buffer_load_dwordx4 v59, s[12:15], s36 offen offset:3072 lds
  s_add_u32 s30, s30, 12288
  s_cmp_eq_u32 s30, 86016
  s_cselect_b32 s30, 0, s30
  s_mov_b32 m0, 156160
  s_mov_b32 s35, .g2_kernel_tab-.g2_kernel_pc+136
  buffer_load_dword off, s[64:67], s35 lds
  s_xor_b32 s36, s18, 1
  s_mul_i32 s36, s36, 393216
  s_add_u32 s36, s36, s39
  s_add_u32 m0, s30, 65536
  s_waitcnt vmcnt(63)
  buffer_load_dwordx4 v48, s[12:15], s36 offen offset:0 lds
  buffer_load_dwordx4 v49, s[12:15], s36 offen offset:1024 lds
  buffer_load_dwordx4 v50, s[12:15], s36 offen offset:2048 lds
  buffer_load_dwordx4 v51, s[12:15], s36 offen offset:3072 lds
  s_add_u32 m0, s30, 69632
  s_waitcnt vmcnt(63)
  buffer_load_dwordx4 v52, s[12:15], s36 offen offset:0 lds
  buffer_load_dwordx4 v53, s[12:15], s36 offen offset:1024 lds
  buffer_load_dwordx4 v54, s[12:15], s36 offen offset:2048 lds
  buffer_load_dwordx4 v55, s[12:15], s36 offen offset:3072 lds
  s_add_u32 m0, s30, 73728
  s_waitcnt vmcnt(63)
  buffer_load_dwordx4 v56, s[12:15], s36 offen offset:0 lds
  buffer_load_dwordx4 v57, s[12:15], s36 offen offset:1024 lds
  buffer_load_dwordx4 v58, s[12:15], s36 offen offset:2048 lds
  buffer_load_dwordx4 v59, s[12:15], s36 offen offset:3072 lds
  s_add_u32 s30, s30, 12288
  s_cmp_eq_u32 s30, 86016
  s_cselect_b32 s30, 0, s30
  s_xor_b32 s36, s18, 1
  s_mul_i32 s36, s36, 393216
  s_add_u32 s36, s36, s39
  s_add_u32 s36, s36, 196608
  s_add_u32 m0, s30, 65536
  s_waitcnt vmcnt(63)
  buffer_load_dwordx4 v48, s[12:15], s36 offen offset:0 lds
  buffer_load_dwordx4 v49, s[12:15], s36 offen offset:1024 lds
  buffer_load_dwordx4 v50, s[12:15], s36 offen offset:2048 lds
  buffer_load_dwordx4 v51, s[12:15], s36 offen offset:3072 lds
  s_add_u32 m0, s30, 69632
  s_waitcnt vmcnt(63)
  buffer_load_dwordx4 v52, s[12:15], s36 offen offset:0 lds
  buffer_load_dwordx4 v53, s[12:15], s36 offen offset:1024 lds
  buffer_load_dwordx4 v54, s[12:15], s36 offen offset:2048 lds
  buffer_load_dwordx4 v55, s[12:15], s36 offen offset:3072 lds
  s_add_u32 m0, s30, 73728
  s_waitcnt vmcnt(63)
  buffer_load_dwordx4 v56, s[12:15], s36 offen offset:0 lds
  buffer_load_dwordx4 v57, s[12:15], s36 offen offset:1024 lds
  buffer_load_dwordx4 v58, s[12:15], s36 offen offset:2048 lds
  buffer_load_dwordx4 v59, s[12:15], s36 offen offset:3072 lds
  s_add_u32 s30, s30, 12288
  s_cmp_eq_u32 s30, 86016
  s_cselect_b32 s30, 0, s30
  s_xor_b32 s36, s18, 2
  s_mul_i32 s36, s36, 393216
  s_add_u32 s36, s36, s39
  s_add_u32 m0, s30, 65536
  s_waitcnt vmcnt(63)
  buffer_load_dwordx4 v48, s[12:15], s36 offen offset:0 lds
  buffer_load_dwordx4 v49, s[12:15], s36 offen offset:1024 lds
  buffer_load_dwordx4 v50, s[12:15], s36 offen offset:2048 lds
  buffer_load_dwordx4 v51, s[12:15], s36 offen offset:3072 lds
  s_add_u32 m0, s30, 69632
  s_waitcnt vmcnt(63)
  buffer_load_dwordx4 v52, s[12:15], s36 offen offset:0 lds
  buffer_load_dwordx4 v53, s[12:15], s36 offen offset:1024 lds
  buffer_load_dwordx4 v54, s[12:15], s36 offen offset:2048 lds
  buffer_load_dwordx4 v55, s[12:15], s36 offen offset:3072 lds
  s_add_u32 m0, s30, 73728
  s_waitcnt vmcnt(63)
  buffer_load_dwordx4 v56, s[12:15], s36 offen offset:0 lds
  buffer_load_dwordx4 v57, s[12:15], s36 offen offset:1024 lds
  buffer_load_dwordx4 v58, s[12:15], s36 offen offset:2048 lds
  buffer_load_dwordx4 v59, s[12:15], s36 offen offset:3072 lds
  s_add_u32 s30, s30, 12288
  s_cmp_eq_u32 s30, 86016
  s_cselect_b32 s30, 0, s30
  v_mov_b32 v6, s71
  s_mov_b32 s38, 0
.g2_kernel_wg35:
  ds_read_b32 v7, v6 offset:20
  s_add_u32 s38, s38, 1
  s_waitcnt lgkmcnt(0)
  v_cmp_le_u32 vcc, 4, v7
  s_cbranch_vccnz .g2_kernel_wg35d
  s_sleep 1
  s_cmp_lt_u32 s38, 524288
  s_cbranch_scc1 .g2_kernel_wg35
.g2_kernel_wg35d:
  s_mov_b32 s62, 1
  s_mov_b32 s63, 0x1800000
  s_mov_b32 s70, 2
  s_mov_b32 s71, 155776
  s_xor_b32 s36, s18, 2
  s_mul_i32 s36, s36, 393216
  s_add_u32 s36, s36, s39
  s_add_u32 s36, s36, 196608
  s_add_u32 m0, s30, 65536
  s_waitcnt vmcnt(63)
  buffer_load_dwordx4 v48, s[12:15], s36 offen offset:0 lds
  buffer_load_dwordx4 v49, s[12:15], s36 offen offset:1024 lds
  buffer_load_dwordx4 v50, s[12:15], s36 offen offset:2048 lds
  buffer_load_dwordx4 v51, s[12:15], s36 offen offset:3072 lds
  s_add_u32 m0, s30, 69632
  s_waitcnt vmcnt(63)
  buffer_load_dwordx4 v52, s[12:15], s36 offen offset:0 lds
  buffer_load_dwordx4 v53, s[12:15], s36 offen offset:1024 lds
  buffer_load_dwordx4 v54, s[12:15], s36 offen offset:2048 lds
  buffer_load_dwordx4 v55, s[12:15], s36 offen offset:3072 lds
  s_add_u32 m0, s30, 73728
  s_waitcnt vmcnt(63)
  buffer_load_dwordx4 v56, s[12:15], s36 offen offset:0 lds
  buffer_load_dwordx4 v57, s[12:15], s36 offen offset:1024 lds
  buffer_load_dwordx4 v58, s[12:15], s36 offen offset:2048 lds
  buffer_load_dwordx4 v59, s[12:15], s36 offen offset:3072 lds
  s_add_u32 s30, s30, 12288
  s_cmp_eq_u32 s30, 86016
  s_cselect_b32 s30, 0, s30
  s_xor_b32 s36, s18, 3
  s_mul_i32 s36, s36, 393216
  s_add_u32 s36, s36, s39
  s_add_u32 m0, s30, 65536
  s_waitcnt vmcnt(63)
  buffer_load_dwordx4 v48, s[12:15], s36 offen offset:0 lds
  buffer_load_dwordx4 v49, s[12:15], s36 offen offset:1024 lds
  buffer_load_dwordx4 v50, s[12:15], s36 offen offset:2048 lds
  buffer_load_dwordx4 v51, s[12:15], s36 offen offset:3072 lds
  s_add_u32 m0, s30, 69632
  s_waitcnt vmcnt(63)
  buffer_load_dwordx4 v52, s[12:15], s36 offen offset:0 lds
  buffer_load_dwordx4 v53, s[12:15], s36 offen offset:1024 lds
  buffer_load_dwordx4 v54, s[12:15], s36 offen offset:2048 lds
  buffer_load_dwordx4 v55, s[12:15], s36 offen offset:3072 lds
  s_add_u32 m0, s30, 73728
  s_waitcnt vmcnt(63)
  buffer_load_dwordx4 v56, s[12:15], s36 offen offset:0 lds
  buffer_load_dwordx4 v57, s[12:15], s36 offen offset:1024 lds
  buffer_load_dwordx4 v58, s[12:15], s36 offen offset:2048 lds
  buffer_load_dwordx4 v59, s[12:15], s36 offen offset:3072 lds
  s_add_u32 s30, s30, 12288
  s_cmp_eq_u32 s30, 86016
  s_cselect_b32 s30, 0, s30
  s_mov_b32 s28, 1
  s_mov_b32 s29, 16384
  s_bitcmp1_b32 s37, s28
  s_cbranch_scc0 .g2_kernel_p2_x0w
.g2_kernel_p2_x0b:
  s_xor_b32 s33, s28, s18
  s_lshl_b32 s33, s33, 14
  s_add_u32 s33, s33, s32
  s_add_u32 m0, s29, 0
  s_waitcnt vmcnt(63)
  buffer_load_dwordx4 v3, s[4:7], s33 offen offset:0 lds
  buffer_load_dwordx4 v3, s[4:7], s33 offen offset:1024 lds
  buffer_load_dwordx4 v3, s[4:7], s33 offen offset:2048 lds
  buffer_load_dwordx4 v3, s[4:7], s33 offen offset:3072 lds
  s_add_u32 m0, s29, 4096
  s_waitcnt vmcnt(63)
  s_add_u32 s33, s33, 4096
  buffer_load_dwordx4 v3, s[4:7], s33 offen offset:0 lds
  buffer_load_dwordx4 v3, s[4:7], s33 offen offset:1024 lds
  buffer_load_dwordx4 v3, s[4:7], s33 offen offset:2048 lds
  buffer_load_dwordx4 v3, s[4:7], s33 offen offset:3072 lds
  s_add_u32 m0, s29, 8192
  s_waitcnt vmcnt(63)
  s_add_u32 s33, s33, 4096
  buffer_load_dwordx4 v3, s[4:7], s33 offen offset:0 lds
  buffer_load_dwordx4 v3, s[4:7], s33 offen offset:1024 lds
  buffer_load_dwordx4 v3, s[4:7], s33 offen offset:2048 lds
  buffer_load_dwordx4 v3, s[4:7], s33 offen offset:3072 lds
  s_add_u32 m0, s29, 12288
  s_waitcnt vmcnt(63)
  s_add_u32 s33, s33, 4096
  buffer_load_dwordx4 v3, s[4:7], s33 offen offset:0 lds
  buffer_load_dwordx4 v3, s[4:7], s33 offen offset:1024 lds
  buffer_load_dwordx4 v3, s[4:7], s33 offen offset:2048 lds
  buffer_load_dwordx4 v3, s[4:7], s33 offen offset:3072 lds
  s_mov_b32 m0, 156160
  s_mov_b32 s35, .g2_kernel_tab-.g2_kernel_pc+144
  buffer_load_dword off, s[64:67], s35 lds
  s_mov_b32 s28, 2
  s_mov_b32 s29, 32768
  s_bitcmp1_b32 s37, s28
  s_cbranch_scc0 .g2_kernel_p2_x1w
.g2_kernel_p2_x1b:
  s_xor_b32 s33, s28, s18
  s_lshl_b32 s33, s33, 14
  s_add_u32 s33, s33, s32
  s_add_u32 m0, s29, 0
  s_waitcnt vmcnt(63)
  buffer_load_dwordx4 v3, s[4:7], s33 offen offset:0 lds
  buffer_load_dwordx4 v3, s[4:7], s33 offen offset:1024 lds
  buffer_load_dwordx4 v3, s[4:7], s33 offen offset:2048 lds
  buffer_load_dwordx4 v3, s[4:7], s33 offen offset:3072 lds
  s_add_u32 m0, s29, 4096
  s_waitcnt vmcnt(63)
  s_add_u32 s33, s33, 4096
  buffer_load_dwordx4 v3, s[4:7], s33 offen offset:0 lds
  buffer_load_dwordx4 v3, s[4:7], s33 offen offset:1024 lds
  buffer_load_dwordx4 v3, s[4:7], s33 offen offset:2048 lds
  buffer_load_dwordx4 v3, s[4:7], s33 offen offset:3072 lds
  s_add_u32 m0, s29, 8192
  s_waitcnt vmcnt(63)
  s_add_u32 s33, s33, 4096
  buffer_load_dwordx4 v3, s[4:7], s33 offen offset:0 lds
  buffer_load_dwordx4 v3, s[4:7], s33 offen offset:1024 lds
  buffer_load_dwordx4 v3, s[4:7], s33 offen offset:2048 lds
  buffer_load_dwordx4 v3, s[4:7], s33 offen offset:3072 lds
  s_add_u32 m0, s29, 12288
  s_waitcnt vmcnt(63)
  s_add_u32 s33, s33, 4096
  buffer_load_dwordx4 v3, s[4:7], s33 offen offset:0 lds
  buffer_load_dwordx4 v3, s[4:7], s33 offen offset:1024 lds
  buffer_load_dwordx4 v3, s[4:7], s33 offen offset:2048 lds
  buffer_load_dwordx4 v3, s[4:7], s33 offen offset:3072 lds
  s_mov_b32 m0, 156160
  s_mov_b32 s35, .g2_kernel_tab-.g2_kernel_pc+152
  buffer_load_dword off, s[64:67], s35 lds
  s_mov_b32 s28, 3
  s_mov_b32 s29, 49152
  s_bitcmp1_b32 s37, s28
  s_cbranch_scc0 .g2_kernel_p2_x2w
.g2_kernel_p2_x2b:
  s_xor_b32 s33, s28, s18
  s_lshl_b32 s33, s33, 14
  s_add_u32 s33, s33, s32
  s_add_u32 m0, s29, 0
  s_waitcnt vmcnt(63)
  buffer_load_dwordx4 v3, s[4:7], s33 offen offset:0 lds
  buffer_load_dwordx4 v3, s[4:7], s33 offen offset:1024 lds
  buffer_load_dwordx4 v3, s[4:7], s33 offen offset:2048 lds
  buffer_load_dwordx4 v3, s[4:7], s33 offen offset:3072 lds
  s_add_u32 m0, s29, 4096
  s_waitcnt vmcnt(63)
  s_add_u32 s33, s33, 4096
  buffer_load_dwordx4 v3, s[4:7], s33 offen offset:0 lds
  buffer_load_dwordx4 v3, s[4:7], s33 offen offset:1024 lds
  buffer_load_dwordx4 v3, s[4:7], s33 offen offset:2048 lds
  buffer_load_dwordx4 v3, s[4:7], s33 offen offset:3072 lds
  s_add_u32 m0, s29, 8192
  s_waitcnt vmcnt(63)
  s_add_u32 s33, s33, 4096
  buffer_load_dwordx4 v3, s[4:7], s33 offen offset:0 lds
  buffer_load_dwordx4 v3, s[4:7], s33 offen offset:1024 lds
  buffer_load_dwordx4 v3, s[4:7], s33 offen offset:2048 lds
  buffer_load_dwordx4 v3, s[4:7], s33 offen offset:3072 lds
  s_add_u32 m0, s29, 12288
  s_waitcnt vmcnt(63)
  s_add_u32 s33, s33, 4096
  buffer_load_dwordx4 v3, s[4:7], s33 offen offset:0 lds
  buffer_load_dwordx4 v3, s[4:7], s33 offen offset:1024 lds
  buffer_load_dwordx4 v3, s[4:7], s33 offen offset:2048 lds
  buffer_load_dwordx4 v3, s[4:7], s33 offen offset:3072 lds
  s_mov_b32 m0, 156160
  s_mov_b32 s35, .g2_kernel_tab-.g2_kernel_pc+156
  buffer_load_dword off, s[64:67], s35 lds
  s_xor_b32 s36, s18, 3
  s_mul_i32 s36, s36, 393216
  s_add_u32 s36, s36, s39
  s_add_u32 s36, s36, 196608
  ds_read_b32 v10, v9
  s_mov_b32 s34, 33
  s_mov_b32 s35, .g2_kernel_tab-.g2_kernel_pc+160
  s_branch .g2_kernel_p2_o
  .p2align 6
.g2_kernel_p2_l:
  s_waitcnt lgkmcnt(0)
  v_cmp_gt_i32 vcc, s34, v10
  s_cbranch_vccnz .g2_kernel_p2_aw
.g2_kernel_p2_ai:
  s_add_u32 s29, s29, 16384
  s_and_b32 s29, s29, 0xffff
  s_bitcmp1_b32 s37, s28
  s_cbranch_scc0 .g2_kernel_p2_x3w
.g2_kernel_p2_x3b:
  s_xor_b32 s33, s28, s18
  s_lshl_b32 s33, s33, 14
  s_add_u32 s33, s33, s32
  s_add_u32 m0, s29, 0
  s_waitcnt vmcnt(63)
  buffer_load_dwordx4 v3, s[4:7], s33 offen offset:0 lds
  buffer_load_dwordx4 v3, s[4:7], s33 offen offset:1024 lds
  buffer_load_dwordx4 v3, s[4:7], s33 offen offset:2048 lds
  buffer_load_dwordx4 v3, s[4:7], s33 offen offset:3072 lds
  s_add_u32 m0, s29, 4096
  s_waitcnt vmcnt(63)
  s_add_u32 s33, s33, 4096
  buffer_load_dwordx4 v3, s[4:7], s33 offen offset:0 lds
  buffer_load_dwordx4 v3, s[4:7], s33 offen offset:1024 lds
  buffer_load_dwordx4 v3, s[4:7], s33 offen offset:2048 lds
  buffer_load_dwordx4 v3, s[4:7], s33 offen offset:3072 lds
  s_add_u32 m0, s29, 8192
  s_waitcnt vmcnt(63)
  s_add_u32 s33, s33, 4096
  buffer_load_dwordx4 v3, s[4:7], s33 offen offset:0 lds
  buffer_load_dwordx4 v3, s[4:7], s33 offen offset:1024 lds
  buffer_load_dwordx4 v3, s[4:7], s33 offen offset:2048 lds
  buffer_load_dwordx4 v3, s[4:7], s33 offen offset:3072 lds
  s_add_u32 m0, s29, 12288
  s_waitcnt vmcnt(63)
  s_add_u32 s33, s33, 4096
  buffer_load_dwordx4 v3, s[4:7], s33 offen offset:0 lds
  buffer_load_dwordx4 v3, s[4:7], s33 offen offset:1024 lds
  buffer_load_dwordx4 v3, s[4:7], s33 offen offset:2048 lds
  buffer_load_dwordx4 v3, s[4:7], s33 offen offset:3072 lds
  s_add_u32 m0, s30, 65536
  s_waitcnt vmcnt(63)
  buffer_load_dwordx4 v48, s[12:15], s36 offen offset:0 lds
  buffer_load_dwordx4 v49, s[12:15], s36 offen offset:1024 lds
  buffer_load_dwordx4 v50, s[12:15], s36 offen offset:2048 lds
  buffer_load_dwordx4 v51, s[12:15], s36 offen offset:3072 lds
  s_add_u32 m0, s30, 69632
  s_waitcnt vmcnt(63)
  buffer_load_dwordx4 v52, s[12:15], s36 offen offset:0 lds
  buffer_load_dwordx4 v53, s[12:15], s36 offen offset:1024 lds
  buffer_load_dwordx4 v54, s[12:15], s36 offen offset:2048 lds
  buffer_load_dwordx4 v55, s[12:15], s36 offen offset:3072 lds
  s_add_u32 m0, s30, 73728
  s_waitcnt vmcnt(63)
  buffer_load_dwordx4 v56, s[12:15], s36 offen offset:0 lds
  buffer_load_dwordx4 v57, s[12:15], s36 offen offset:1024 lds
  buffer_load_dwordx4 v58, s[12:15], s36 offen offset:2048 lds
  buffer_load_dwordx4 v59, s[12:15], s36 offen offset:3072 lds
  s_add_u32 s30, s30, 12288
  s_cmp_eq_u32 s30, 86016
  s_cselect_b32 s30, 0, s30
  ds_read_b32 v10, v9
  s_mov_b32 m0, 156160
  s_add_u32 s34, s34, 1
  buffer_load_dword off, s[64:67], s35 lds
  s_add_u32 s35, s35, 4
  s_add_u32 s36, s36, 196608
.g2_kernel_p2_o:
  s_waitcnt lgkmcnt(0)
  v_cmp_gt_i32 vcc, s34, v10
  s_cbranch_vccnz .g2_kernel_p2_bw
.g2_kernel_p2_bi:
  s_add_u32 m0, s30, 65536
  s_waitcnt vmcnt(63)
  buffer_load_dwordx4 v48, s[12:15], s36 offen offset:0 lds
  buffer_load_dwordx4 v49, s[12:15], s36 offen offset:1024 lds
  buffer_load_dwordx4 v50, s[12:15], s36 offen offset:2048 lds
  buffer_load_dwordx4 v51, s[12:15], s36 offen offset:3072 lds
  s_add_u32 m0, s30, 69632
  s_waitcnt vmcnt(63)
  buffer_load_dwordx4 v52, s[12:15], s36 offen offset:0 lds
  buffer_load_dwordx4 v53, s[12:15], s36 offen offset:1024 lds
  buffer_load_dwordx4 v54, s[12:15], s36 offen offset:2048 lds
  buffer_load_dwordx4 v55, s[12:15], s36 offen offset:3072 lds
  s_add_u32 m0, s30, 73728
  s_waitcnt vmcnt(63)
  buffer_load_dwordx4 v56, s[12:15], s36 offen offset:0 lds
  buffer_load_dwordx4 v57, s[12:15], s36 offen offset:1024 lds
  buffer_load_dwordx4 v58, s[12:15], s36 offen offset:2048 lds
  buffer_load_dwordx4 v59, s[12:15], s36 offen offset:3072 lds
  s_add_u32 s30, s30, 12288
  s_cmp_eq_u32 s30, 86016
  s_cselect_b32 s30, 0, s30
  ds_read_b32 v10, v9
  s_mov_b32 m0, 156160
  s_add_u32 s34, s34, 1
  buffer_load_dword off, s[64:67], s35 lds
  s_add_u32 s35, s35, 4
  s_add_u32 s28, s28, 1
  s_xor_b32 s36, s18, s28
  s_mul_i32 s36, s36, 393216
  s_add_u32 s36, s36, s39
  s_cmp_lt_i32 s34, 58
  s_cbranch_scc1 .g2_kernel_p2_l
  s_branch .g2_kernel_v
.g2_kernel_c1:
  v_mov_b32 v6, s71
  s_mov_b32 s38, 0
.g2_kernel_wg36:
  ds_read_b32 v7, v6 offset:76
  s_add_u32 s38, s38, 1
  s_waitcnt lgkmcnt(0)
  v_cmp_le_u32 vcc, 1, v7
  s_cbranch_vccnz .g2_kernel_wg36d
  s_sleep 1
  s_cmp_lt_u32 s38, 524288
  s_cbranch_scc1 .g2_kernel_wg36
.g2_kernel_wg36d:
  s_sleep 4
  s_and_b32 s31, s19, 0xffffe000
  s_add_u32 s31, s31, 4
  v_and_b32 v6, 15, v2
  v_lshlrev_b32 v6, 9, v6
  v_lshrrev_b32 v7, 4, v2
  v_lshl_add_u32 v6, v7, 7, v6
  v_lshlrev_b32 v7, 2, v2
  v_add_u32 v7, 157952, v7
  s_mov_b32 m0, 157952
  s_mov_b32 s38, 0
  s_bfm_b64 exec, 16, 48
.g2_kernel_pa37:
  buffer_load_dword v6, s[4:7], s31 offen sc1 lds
  s_add_u32 s38, s38, 1
  s_waitcnt vmcnt(0)
  ds_read_b32 v8, v7
  s_waitcnt lgkmcnt(0)
  v_cmp_ge_u32 vcc, s62, v8
  s_cbranch_vccz .g2_kernel_pa37d
  s_mov_b64 exec, vcc
  s_sleep 4
  s_cmp_lt_u32 s38, 131072
  s_cbranch_scc1 .g2_kernel_pa37
.g2_kernel_pa37d:
  s_mov_b64 exec, -1
  s_setprio 2
  s_mov_b32 s39, 0
  s_lshl_b32 s30, s17, 2
  s_lshr_b32 s28, s18, 2
  s_add_u32 s30, s30, s28
  s_lshl_b32 s20, s30, 13
  s_add_u32 s20, s20, s63
  s_add_u32 s20, s20, 0x1000000
  s_add_u32 s24, s20, 4096
  s_lshl_b32 s21, s30, 8
  s_add_u32 s21, s21, s63
  s_add_u32 s21, s21, 0x1080000
  s_lshl_b32 s23, s62, 16
  s_add_u32 s23, s23, 0x3040000
  s_lshl_b32 s22, s30, 7
  s_add_u32 s22, s22, s23
  s_and_b32 s28, s2, 7
  s_lshl_b32 s28, s28, 13
  s_add_u32 s23, s23, s28
  v_mov_b32 v9, 155648
  ds_read_b32 v26, v9 offset:256
  v_and_b32 v24, 31, v2
  v_lshlrev_b32 v25, 3, v2
  v_lshlrev_b32 v27, 13, v2
  v_mov_b32 v28, 0.0009765625
  v_mov_b32 v30, 1e-05
  v_mov_b32 v6, s71
  s_mov_b32 s38, 0
.g2_kernel_wg39:
  ds_read_b32 v7, v6 offset:20
  s_add_u32 s38, s38, 1
  s_waitcnt lgkmcnt(0)
  v_cmp_le_u32 vcc, 4, v7
  s_cbranch_vccnz .g2_kernel_wg39d
  s_sleep 1
  s_cmp_lt_u32 s38, 524288
  s_cbranch_scc1 .g2_kernel_wg39
.g2_kernel_wg39d:
  s_sleep 12
  s_cmp_lg_u32 s62, 0
  s_cbranch_scc1 .g2_kernel_nap40
  s_sleep 12
.g2_kernel_nap40:
  s_xor_b32 s28, s17, s18
  s_and_b32 s28, s28, 3
  s_cbranch_scc1 .g2_kernel_c_l1
  s_mov_b32 s38, 0
.g2_kernel_gx41:
  buffer_load_dwordx4 v[32:35], v3, s[4:7], s20 offen offset:0 sc1
  buffer_load_dwordx4 v[36:39], v3, s[4:7], s20 offen offset:1024 sc1
  buffer_load_dwordx4 v[40:43], v3, s[4:7], s20 offen offset:2048 sc1
  buffer_load_dwordx4 v[44:47], v3, s[4:7], s20 offen offset:3072 sc1
  buffer_load_dwordx4 v[48:51], v3, s[4:7], s24 offen offset:0 sc1
  buffer_load_dwordx4 v[52:55], v3, s[4:7], s24 offen offset:1024 sc1
  buffer_load_dwordx4 v[56:59], v3, s[4:7], s24 offen offset:2048 sc1
  buffer_load_dwordx4 v[60:63], v3, s[4:7], s24 offen offset:3072 sc1
  s_add_u32 s38, s38, 1
  s_waitcnt vmcnt(0)
  v_min3_u32 v6, v32, v35, v36
  v_min3_u32 v6, v6, v39, v40
  v_min3_u32 v6, v6, v43, v44
  v_min3_u32 v6, v6, v47, v48
  v_min3_u32 v6, v6, v51, v52
  v_min3_u32 v6, v6, v55, v56
  v_min3_u32 v6, v6, v59, v60
  v_min_u32 v6, v6, v63
  v_cmp_eq_u32 vcc, 0, v6
  s_cbranch_vccz .g2_kernel_gx41d
  s_mov_b64 exec, vcc
  s_sleep 1
  s_cmp_lg_u32 s62, 0
  s_cbranch_scc1 .g2_kernel_nap42
  s_sleep 9
.g2_kernel_nap42:
  s_cmp_lt_u32 s38, 131072
  s_cbranch_scc1 .g2_kernel_gx41
.g2_kernel_gx41d:
  s_mov_b64 exec, -1
  v_add_f32 v32, v32, v48
  v_add_f32 v33, v33, v49
  v_add_f32 v34, v34, v50
  v_add_f32 v36, v36, v52
  v_add_f32 v37, v37, v53
  v_add_f32 v38, v38, v54
  v_add_f32 v40, v40, v56
  v_add_f32 v41, v41, v57
  v_add_f32 v42, v42, v58
  v_add_f32 v44, v44, v60
  v_add_f32 v45, v45, v61
  v_add_f32 v46, v46, v62
  v_add_f32 v32, v32, v40
  v_add_f32 v33, v33, v41
  v_add_f32 v34, v34, v42
  v_add_f32 v36, v36, v44
  v_add_f32 v37, v37, v45
  v_add_f32 v38, v38, v46
  v_add_f32 v32, v32, v36
  v_add_f32 v33, v33, v37
  v_add_f32 v34, v34, v38
  v_mov_b32 v16, v32
  v_mov_b32 v17, v33
  v_mov_b32 v18, v34
  s_mov_b32 s28, -32
  v_permlane32_swap_b32 v16, v32
  v_permlane32_swap_b32 v17, v33
  v_permlane32_swap_b32 v18, v34
  v_add_f32 v16, v16, v32
  v_add_f32 v17, v17, v33
  v_add_f32 v18, v18, v34
  v_fma_f32 v18, -v16, v26, v18
  v_mul_f32 v16, v28, v16
  v_mul_f32 v19, v16, v16
  v_fma_f32 v17, v17, v28, -v19
  v_max_f32 v17, 0, v17
  v_add_f32 v17, v30, v17
  v_rsq_f32 v19, v17
  v_mov_b32 v11, 1
  v_mul_f32 v18, v18, v19
  v_and_or_b32 v10, v18, s28, v24
  s_nop 1
  v_max_f32 v10, v10, v10 row_ror:8 row_mask:0xf bank_mask:0xf
  s_nop 1
  v_max_f32 v10, v10, v10 row_ror:4 row_mask:0xf bank_mask:0xf
  s_nop 1
  v_max_f32 v10, v10, v10 row_ror:2 row_mask:0xf bank_mask:0xf
  s_nop 1
  v_max_f32 v10, v10, v10 row_ror:1 row_mask:0xf bank_mask:0xf
  s_nop 1
  v_max_f32 v10, v10, v10 row_bcast:15 row_mask:0xa bank_mask:0xf
  s_nop 0
  v_readlane_b32 s28, v10, 31
  s_nop 1
  v_mov_b32 v10, s28
  s_mov_b64 exec, 0xff
  buffer_store_dwordx2 v[10:11], v27, s[4:7], s22 offen sc1
  s_mov_b32 exec_lo, -1
  buffer_store_dwordx2 v[16:17], v25, s[4:7], s21 offen sc1
  s_mov_b64 exec, -1
.g2_kernel_c_l1:
  s_cmp_lg_u32 s62, 0
  s_cbranch_scc1 .g2_kernel_c_t3
  s_sleep 30
  s_mov_b64 s[8:9], -1
  s_call_b64 s[68:69], .g2_kernel_amax
  s_add_u32 s28, s77, 1
  v_mov_b32 v10, s28
  v_mov_b32 v9, s71
  ds_write_b32 v9, v10 offset:36
  s_lshr_b32 s24, s77, 7
  s_lshl_b32 s24, s24, 18
  s_bfe_u32 s28, s77, 0x30004
  s_lshl_b32 s28, s28, 11
  s_add_u32 s24, s24, s28
  s_and_b32 s28, s77, 15
  s_lshl_b32 s28, s28, 4
  s_add_u32 s24, s24, s28
  s_add_u32 s24, s24, s63
  s_add_u32 s24, s24, 0xc00000
  s_lshl_b32 s28, s17, 14
  s_add_u32 s24, s24, s28
  s_and_b32 s28, s18, 1
  s_lshl_b32 s28, s28, 8
  s_add_u32 s24, s24, s28
  v_lshrrev_b32 v12, 3, v2
  v_lshlrev_b32 v13, 1, v12
  s_waitcnt lgkmcnt(0)
  s_wakeup
  buffer_load_ushort v56, v13, s[4:7], s24 offen offset:0
  buffer_load_ushort v57, v13, s[4:7], s24 offen offset:512
  buffer_load_ushort v58, v13, s[4:7], s24 offen offset:1024
  buffer_load_ushort v59, v13, s[4:7], s24 offen offset:1536
  s_lshl_b32 s25, s77, 3
  s_add_u32 s25, s25, s63
  s_add_u32 s25, s25, 0x1080000
  s_lshl_b32 s21, s17, 10
  s_add_u32 s21, s21, s63
  s_add_u32 s21, s21, 0x1080000
  s_mov_b32 s38, 0
.g2_kernel_gx43:
  buffer_load_dwordx4 v[16:19], v3, s[4:7], s21 offen sc1
  buffer_load_dwordx2 v[20:21], v4, s[4:7], s25 offen sc1
  s_add_u32 s38, s38, 1
  s_waitcnt vmcnt(0)
  v_min3_u32 v6, v17, v19, v21
  v_cmp_eq_u32 vcc, 0, v6
  s_cbranch_vccz .g2_kernel_gx43d
  s_mov_b64 exec, vcc
  s_sleep 1
  s_cmp_lt_u32 s38, 131072
  s_cbranch_scc1 .g2_kernel_gx43
.g2_kernel_gx43d:
  s_mov_b64 exec, -1
  s_lshr_b32 s28, s77, 7
  s_and_b32 s79, s77, 127
  s_add_u32 s79, s79, 1
  s_cmp_eq_u32 s28, s17
  s_cselect_b32 s79, s79, 0
  v_rsq_f32 v22, v17
  v_rsq_f32 v23, v19
  v_rsq_f32 v21, v21
  v_mov_b32 v62, -1.4426950408889634
  v_mul_f32 v62, s27, v62
  v_exp_f32 v62, v62
  v_lshlrev_b32 v14, 3, v2
  v_add_u32 v14, 155648, v14
  v_mov_b32 v15, s79
  v_add_f32 v52, 1.0, v22
  v_mul_f32 v54, v16, v22
  v_sub_f32 v54, 0, v54
  v_add_f32 v53, 1.0, v23
  v_mul_f32 v55, v18, v23
  v_sub_f32 v55, 0, v55
  v_add_f32 v62, 1.0, v62
  v_rcp_f32 v62, v62
  v_add_f32 v60, 1.0, v21
  v_mul_f32 v61, v20, v21
  v_sub_f32 v61, 0, v61
  v_sub_f32 v17, v17, v30
  v_mul_f32 v48, v52, v52
  v_fma_f32 v48, v48, v17, v30
  v_rsq_f32 v48, v48
  s_nop 0
  v_mul_f32 v48, v48, v52
  v_mul_f32 v50, v48, v16
  v_sub_f32 v50, 0, v50
  v_sub_f32 v19, v19, v30
  v_mul_f32 v49, v53, v53
  v_fma_f32 v49, v49, v19, v30
  v_rsq_f32 v49, v49
  s_nop 0
  v_mul_f32 v49, v49, v53
  v_mul_f32 v51, v49, v18
  v_sub_f32 v51, 0, v51
  v_lshlrev_b32 v56, 16, v56
  v_fma_f32 v56, v56, v60, v61
  v_lshlrev_b32 v57, 16, v57
  v_fma_f32 v57, v57, v60, v61
  v_lshlrev_b32 v58, 16, v58
  v_fma_f32 v58, v58, v60, v61
  v_lshlrev_b32 v59, 16, v59
  v_fma_f32 v59, v59, v60, v61
  v_and_b32 v10, 7, v2
  v_lshlrev_b32 v10, 12, v10
  v_lshl_add_u32 v10, v12, 4, v10
  s_lshl_b32 s20, s17, 1
  s_and_b32 s28, s18, 1
  s_add_u32 s20, s20, s28
  s_lshl_b32 s20, s20, 7
  s_add_u32 s20, s20, s63
  s_add_u32 s20, s20, 0x1090000
  s_and_b32 s26, s18, 14
  s_lshl_b32 s26, s26, 4
  s_add_u32 s26, s26, s17
  s_lshl_b32 s26, s26, 1
  s_and_b32 s28, s18, 1
  s_add_u32 s26, s26, s28
  s_lshl_b32 s26, s26, 10
  s_add_u32 s26, s26, s63
  s_add_u32 s26, s26, 0x1190000
  s_add_u32 s25, s26, 32768
  ds_write_b64 v14, v[48:49] offset:2816
  ds_write_b64 v14, v[50:51] offset:3328
  ds_write_b64 v14, v[52:53] offset:3840
  ds_write_b64 v14, v[54:55] offset:4352
  s_lshr_b32 s28, s77, 7
  s_xor_b32 s28, s28, s17
  v_mov_b32 v8, s28
  ds_write_b32 v9, v8 offset:212
  v_mov_b32 v8, 2
  ds_write_b32 v9, v15 offset:152
  ds_write_b32 v9, v8 offset:128
  s_lshl_b32 s28, s2, 10
  s_and_b32 s28, s28, 0xe000
  v_lshlrev_b32 v7, 7, v2
  buffer_load_dword v1, v7, s[64:67], s28 offen
  v_mov_b32 v6, s71
  s_mov_b32 s38, 0
.g2_kernel_wg44:
  ds_read_b32 v7, v6 offset:48
  s_add_u32 s38, s38, 1
  s_waitcnt lgkmcnt(0)
  v_cmp_le_u32 vcc, 2, v7
  s_cbranch_vccnz .g2_kernel_wg44d
  s_sleep 1
  s_cmp_lt_u32 s38, 524288
  s_cbranch_scc1 .g2_kernel_wg44
.g2_kernel_wg44d:
  s_sleep 8
  s_cmp_lg_u32 s62, 0
  s_cbranch_scc1 .g2_kernel_nap45
  s_sleep 22
.g2_kernel_nap45:
  s_mov_b32 s38, 0
.g2_kernel_gx46:
  s_mov_b32 s21, s20
  buffer_load_dwordx4 v[160:163], v10, s[4:7], s21 offen sc1
  s_add_u32 s21, s21, 32768
  buffer_load_dwordx4 v[164:167], v10, s[4:7], s21 offen sc1
  s_add_u32 s21, s21, 32768
  buffer_load_dwordx4 v[168:171], v10, s[4:7], s21 offen sc1
  s_add_u32 s21, s21, 32768
  buffer_load_dwordx4 v[172:175], v10, s[4:7], s21 offen sc1
  s_add_u32 s21, s21, 32768
  buffer_load_dwordx4 v[176:179], v10, s[4:7], s21 offen sc1
  s_add_u32 s21, s21, 32768
  buffer_load_dwordx4 v[180:183], v10, s[4:7], s21 offen sc1
  s_add_u32 s21, s21, 32768
  buffer_load_dwordx4 v[184:187], v10, s[4:7], s21 offen sc1
  s_add_u32 s21, s21, 32768
  buffer_load_dwordx4 v[188:191], v10, s[4:7], s21 offen sc1
  s_add_u32 s21, s21, 32768
  buffer_load_dwordx4 v[192:195], v10, s[4:7], s21 offen sc1
  s_add_u32 s21, s21, 32768
  buffer_load_dwordx4 v[196:199], v10, s[4:7], s21 offen sc1
  s_add_u32 s21, s21, 32768
  buffer_load_dwordx4 v[200:203], v10, s[4:7], s21 offen sc1
  s_add_u32 s21, s21, 32768
  buffer_load_dwordx4 v[204:207], v10, s[4:7], s21 offen sc1
  s_add_u32 s21, s21, 32768
  buffer_load_dwordx4 v[208:211], v10, s[4:7], s21 offen sc1
  s_add_u32 s21, s21, 32768
  buffer_load_dwordx4 v[212:215], v10, s[4:7], s21 offen sc1
  s_add_u32 s21, s21, 32768
  buffer_load_dwordx4 v[216:219], v10, s[4:7], s21 offen sc1
  s_add_u32 s21, s21, 32768
  buffer_load_dwordx4 v[220:223], v10, s[4:7], s21 offen sc1
  s_add_u32 s21, s21, 32768
  buffer_load_dwordx4 v[224:227], v10, s[4:7], s21 offen sc1
  s_add_u32 s21, s21, 32768
  buffer_load_dwordx4 v[228:231], v10, s[4:7], s21 offen sc1
  s_add_u32 s21, s21, 32768
  buffer_load_dwordx4 v[232:235], v10, s[4:7], s21 offen sc1
  s_add_u32 s21, s21, 32768
  buffer_load_dwordx4 v[236:239], v10, s[4:7], s21 offen sc1
  s_add_u32 s21, s21, 32768
  buffer_load_dwordx4 v[240:243], v10, s[4:7], s21 offen sc1
  s_add_u32 s21, s21, 32768
  buffer_load_dwordx4 v[244:247], v10, s[4:7], s21 offen sc1
  s_add_u32 s21, s21, 32768
  buffer_load_dwordx4 v[248:251], v10, s[4:7], s21 offen sc1
  s_add_u32 s21, s21, 32768
  buffer_load_dwordx4 v[252:255], v10, s[4:7], s21 offen sc1
  s_add_u32 s21, s21, 32768
  buffer_load_dwordx4 v[16:19], v10, s[4:7], s21 offen sc1
  s_add_u32 s21, s21, 32768
  buffer_load_dwordx4 v[20:23], v10, s[4:7], s21 offen sc1
  s_add_u32 s21, s21, 32768
  buffer_load_dwordx4 v[24:27], v10, s[4:7], s21 offen sc1
  s_add_u32 s21, s21, 32768
  buffer_load_dwordx4 v[28:31], v10, s[4:7], s21 offen sc1
  s_add_u32 s21, s21, 32768
  s_add_u32 s38, s38, 1
  s_waitcnt vmcnt(0)
  v_min3_u32 v6, v160, v162, v164
  v_min3_u32 v6, v6, v166, v168
  v_min3_u32 v6, v6, v170, v172
  v_min3_u32 v6, v6, v174, v176
  v_min3_u32 v6, v6, v178, v180
  v_min3_u32 v6, v6, v182, v184
  v_min3_u32 v6, v6, v186, v188
  v_min3_u32 v6, v6, v190, v192
  v_min3_u32 v6, v6, v194, v196
  v_min3_u32 v6, v6, v198, v200
  v_min3_u32 v6, v6, v202, v204
  v_min3_u32 v6, v6, v206, v208
  v_min3_u32 v6, v6, v210, v212
  v_min3_u32 v6, v6, v214, v216
  v_min3_u32 v6, v6, v218, v220
  v_min3_u32 v6, v6, v222, v224
  v_min3_u32 v6, v6, v226, v228
  v_min3_u32 v6, v6, v230, v232
  v_min3_u32 v6, v6, v234, v236
  v_min3_u32 v6, v6, v238, v240
  v_min3_u32 v6, v6, v242, v244
  v_min3_u32 v6, v6, v246, v248
  v_min3_u32 v6, v6, v250, v252
  v_min3_u32 v6, v6, v254, v16
  v_min3_u32 v6, v6, v18, v20
  v_min3_u32 v6, v6, v22, v24
  v_min3_u32 v6, v6, v26, v28
  v_min_u32 v6, v6, v30
  v_cmp_eq_u32 vcc, 0, v6
  s_cbranch_vccz .g2_kernel_gx46d
  s_mov_b64 exec, vcc
  s_sleep 1
  s_cmp_lg_u32 s62, 0
  s_cbranch_scc1 .g2_kernel_nap47
  s_sleep 11
.g2_kernel_nap47:
  s_cmp_lt_u32 s38, 131072
  s_cbranch_scc1 .g2_kernel_gx46
.g2_kernel_gx46d:
  s_mov_b64 exec, -1
  v_add_f32 v164, v164, v160
  v_add_f32 v165, v165, v161
  v_add_f32 v166, v166, v162
  v_add_f32 v167, v167, v163
  v_add_f32 v172, v172, v168
  v_add_f32 v173, v173, v169
  v_add_f32 v174, v174, v170
  v_add_f32 v175, v175, v171
  v_add_f32 v180, v180, v176
  v_add_f32 v181, v181, v177
  v_add_f32 v182, v182, v178
  v_add_f32 v183, v183, v179
  v_add_f32 v188, v188, v184
  v_add_f32 v189, v189, v185
  v_add_f32 v190, v190, v186
  v_add_f32 v191, v191, v187
  v_add_f32 v196, v196, v192
  v_add_f32 v197, v197, v193
  v_add_f32 v198, v198, v194
  v_add_f32 v199, v199, v195
  v_add_f32 v204, v204, v200
  v_add_f32 v205, v205, v201
  v_add_f32 v206, v206, v202
  v_add_f32 v207, v207, v203
  v_add_f32 v212, v212, v208
  v_add_f32 v213, v213, v209
  v_add_f32 v214, v214, v210
  v_add_f32 v215, v215, v211
  v_add_f32 v220, v220, v216
  v_add_f32 v221, v221, v217
  v_add_f32 v222, v222, v218
  v_add_f32 v223, v223, v219
  v_add_f32 v228, v228, v224
  v_add_f32 v229, v229, v225
  v_add_f32 v230, v230, v226
  v_add_f32 v231, v231, v227
  v_add_f32 v236, v236, v232
  v_add_f32 v237, v237, v233
  v_add_f32 v238, v238, v234
  v_add_f32 v239, v239, v235
  v_add_f32 v244, v244, v240
  v_add_f32 v245, v245, v241
  v_add_f32 v246, v246, v242
  v_add_f32 v247, v247, v243
  v_add_f32 v252, v252, v248
  v_add_f32 v253, v253, v249
  v_add_f32 v254, v254, v250
  v_add_f32 v255, v255, v251
  v_add_f32 v20, v20, v16
  v_add_f32 v21, v21, v17
  v_add_f32 v22, v22, v18
  v_add_f32 v23, v23, v19
  v_add_f32 v28, v28, v24
  v_add_f32 v29, v29, v25
  v_add_f32 v30, v30, v26
  v_add_f32 v31, v31, v27
  v_add_f32 v172, v172, v164
  v_add_f32 v173, v173, v165
  v_add_f32 v174, v174, v166
  v_add_f32 v175, v175, v167
  v_add_f32 v188, v188, v180
  v_add_f32 v189, v189, v181
  v_add_f32 v190, v190, v182
  v_add_f32 v191, v191, v183
  v_add_f32 v204, v204, v196
  v_add_f32 v205, v205, v197
  v_add_f32 v206, v206, v198
  v_add_f32 v207, v207, v199
  v_add_f32 v220, v220, v212
  v_add_f32 v221, v221, v213
  v_add_f32 v222, v222, v214
  v_add_f32 v223, v223, v215
  v_add_f32 v236, v236, v228
  v_add_f32 v237, v237, v229
  v_add_f32 v238, v238, v230
  v_add_f32 v239, v239, v231
  v_add_f32 v252, v252, v244
  v_add_f32 v253, v253, v245
  v_add_f32 v254, v254, v246
  v_add_f32 v255, v255, v247
  v_add_f32 v28, v28, v20
  v_add_f32 v29, v29, v21
  v_add_f32 v30, v30, v22
  v_add_f32 v31, v31, v23
  v_add_f32 v188, v188, v172
  v_add_f32 v189, v189, v173
  v_add_f32 v190, v190, v174
  v_add_f32 v191, v191, v175
  v_add_f32 v220, v220, v204
  v_add_f32 v221, v221, v205
  v_add_f32 v222, v222, v206
  v_add_f32 v223, v223, v207
  v_add_f32 v252, v252, v236
  v_add_f32 v253, v253, v237
  v_add_f32 v254, v254, v238
  v_add_f32 v255, v255, v239
  v_add_f32 v220, v220, v188
  v_add_f32 v221, v221, v189
  v_add_f32 v222, v222, v190
  v_add_f32 v223, v223, v191
  v_add_f32 v28, v28, v252
  v_add_f32 v29, v29, v253
  v_add_f32 v30, v30, v254
  v_add_f32 v31, v31, v255
  v_add_f32 v28, v28, v220
  v_add_f32 v29, v29, v221
  v_add_f32 v30, v30, v222
  v_add_f32 v31, v31, v223
  v_add_f32 v28, v28, v28 quad_perm:[1,0,3,2] row_mask:0xf bank_mask:0xf
  v_add_f32 v29, v29, v29 quad_perm:[1,0,3,2] row_mask:0xf bank_mask:0xf
  v_add_f32 v30, v30, v30 quad_perm:[1,0,3,2] row_mask:0xf bank_mask:0xf
  v_add_f32 v31, v31, v31 quad_perm:[1,0,3,2] row_mask:0xf bank_mask:0xf
  v_add_f32 v28, v28, v28 quad_perm:[2,3,0,1] row_mask:0xf bank_mask:0xf
  v_add_f32 v29, v29, v29 quad_perm:[2,3,0,1] row_mask:0xf bank_mask:0xf
  v_add_f32 v30, v30, v30 quad_perm:[2,3,0,1] row_mask:0xf bank_mask:0xf
  v_add_f32 v31, v31, v31 quad_perm:[2,3,0,1] row_mask:0xf bank_mask:0xf
  v_add_f32 v28, v28, v28 row_half_mirror row_mask:0xf bank_mask:0xf
  v_add_f32 v29, v29, v29 row_half_mirror row_mask:0xf bank_mask:0xf
  v_add_f32 v30, v30, v30 row_half_mirror row_mask:0xf bank_mask:0xf
  v_add_f32 v31, v31, v31 row_half_mirror row_mask:0xf bank_mask:0xf
  v_mul_f32 v28, v28, v62
  v_mul_f32 v29, v29, v62
  v_mul_f32 v30, v30, v62
  v_mul_f32 v31, v31, v62
  v_cvt_pk_bf16_f32 v16, v28, v29
  v_cvt_pk_bf16_f32 v17, v30, v31
  s_mov_b32 s28, 0x00010001
  s_mov_b32 s29, 0x00010001
  v_mov_b32 v18, v16 row_ror:8 row_mask:0xf bank_mask:0xf
  v_mov_b32 v19, v17 row_ror:8 row_mask:0xf bank_mask:0xf
  v_lshlrev_b32 v28, 16, v16
  v_and_b32 v29, 0xffff0000, v16
  v_lshlrev_b32 v30, 16, v17
  v_and_b32 v31, 0xffff0000, v17
  v_cndmask_b32 v32, 0, v16, s[28:29]
  v_cndmask_b32 v33, 0, v17, s[28:29]
  v_cndmask_b32 v34, 0, v18, s[28:29]
  v_cndmask_b32 v35, 0, v19, s[28:29]
  s_lshl_b64 s[28:29], s[28:29], 1
  s_nop 0
  v_mfma_f32_16x16x32_bf16 v[160:163], v[32:35], v[64:67], 0
  v_mfma_f32_16x16x32_bf16 v[164:167], v[32:35], v[80:83], 0
  v_mfma_f32_16x16x32_bf16 v[168:171], v[32:35], v[96:99], 0
  v_mfma_f32_16x16x32_bf16 v[172:175], v[32:35], v[112:115], 0
  v_mfma_f32_16x16x32_bf16 v[176:179], v[32:35], v[128:131], 0
  v_mfma_f32_16x16x32_bf16 v[180:183], v[32:35], v[144:147], 0
  v_cndmask_b32 v36, 0, v16, s[28:29]
  v_cndmask_b32 v37, 0, v17, s[28:29]
  v_cndmask_b32 v38, 0, v18, s[28:29]
  v_cndmask_b32 v39, 0, v19, s[28:29]
  s_lshl_b64 s[28:29], s[28:29], 1
  s_nop 0
  v_mfma_f32_16x16x32_bf16 v[160:163], v[36:39], v[68:71], v[160:163]
  v_mfma_f32_16x16x32_bf16 v[164:167], v[36:39], v[84:87], v[164:167]
  v_mfma_f32_16x16x32_bf16 v[168:171], v[36:39], v[100:103], v[168:171]
  v_mfma_f32_16x16x32_bf16 v[172:175], v[36:39], v[116:119], v[172:175]
  v_mfma_f32_16x16x32_bf16 v[176:179], v[36:39], v[132:135], v[176:179]
  v_mfma_f32_16x16x32_bf16 v[180:183], v[36:39], v[148:151], v[180:183]
  v_cndmask_b32 v40, 0, v16, s[28:29]
  v_cndmask_b32 v41, 0, v17, s[28:29]
  v_cndmask_b32 v42, 0, v18, s[28:29]
  v_cndmask_b32 v43, 0, v19, s[28:29]
  s_lshl_b64 s[28:29], s[28:29], 1
  s_nop 0
  v_mfma_f32_16x16x32_bf16 v[160:163], v[40:43], v[72:75], v[160:163]
  v_mfma_f32_16x16x32_bf16 v[164:167], v[40:43], v[88:91], v[164:167]
  v_mfma_f32_16x16x32_bf16 v[168:171], v[40:43], v[104:107], v[168:171]
  v_mfma_f32_16x16x32_bf16 v[172:175], v[40:43], v[120:123], v[172:175]
  v_mfma_f32_16x16x32_bf16 v[176:179], v[40:43], v[136:139], v[176:179]
  v_mfma_f32_16x16x32_bf16 v[180:183], v[40:43], v[152:155], v[180:183]
  v_cndmask_b32 v44, 0, v16, s[28:29]
  v_cndmask_b32 v45, 0, v17, s[28:29]
  v_cndmask_b32 v46, 0, v18, s[28:29]
  v_cndmask_b32 v47, 0, v19, s[28:29]
  s_lshl_b64 s[28:29], s[28:29], 1
  s_nop 0
  v_mfma_f32_16x16x32_bf16 v[160:163], v[44:47], v[76:79], v[160:163]
  v_mfma_f32_16x16x32_bf16 v[164:167], v[44:47], v[92:95], v[164:167]
  v_mfma_f32_16x16x32_bf16 v[168:171], v[44:47], v[108:111], v[168:171]
  v_mfma_f32_16x16x32_bf16 v[172:175], v[44:47], v[124:127], v[172:175]
  v_mfma_f32_16x16x32_bf16 v[176:179], v[44:47], v[140:143], v[176:179]
  v_mfma_f32_16x16x32_bf16 v[180:183], v[44:47], v[156:159], v[180:183]
  v_add_f32 v56, v56, v28
  v_add_f32 v57, v57, v29
  v_add_f32 v58, v58, v30
  v_add_f32 v59, v59, v31
  v_add_f32 v20, v56, v57
  v_mul_f32 v22, v56, v56
  v_add_f32 v21, v58, v59
  v_fmac_f32 v22, v57, v57
  v_add_f32 v20, v20, v21
  v_fmac_f32 v22, v58, v58
  v_fmac_f32 v22, v59, v59
  v_or_b32 v28, 1, v28
  v_or_b32 v30, 1, v30
  v_add_f32 v20, v20, v20 row_ror:8 row_mask:0xf bank_mask:0xf
  v_add_f32 v22, v22, v22 row_ror:8 row_mask:0xf bank_mask:0xf
  v_lshlrev_b32 v11, 4, v12
  v_add_f32 v20, v20, v20 row_bcast:15 row_mask:0xa bank_mask:0xf
  v_add_f32 v22, v22, v22 row_bcast:15 row_mask:0xa bank_mask:0xf
  s_mov_b32 exec_lo, 0x01010101
  s_mov_b32 exec_hi, 0x01010101
  buffer_store_dwordx4 v[28:31], v11, s[4:7], s26 offen offset:768 sc1
  buffer_store_dwordx4 v[28:31], v11, s[4:7], s25 offen offset:768 sc1
  s_mov_b64 exec, -1
  v_add_f32 v20, v20, v20 row_bcast:31 row_mask:0xc bank_mask:0xf
  v_add_f32 v22, v22, v22 row_bcast:31 row_mask:0xc bank_mask:0xf
  v_or_b32 v20, 1, v20
  v_or_b32 v22, 1, v22
  s_mov_b32 exec_lo, 0
  s_mov_b32 exec_hi, 0x80000000
  buffer_store_dwordx4 v[20:23], v4, s[4:7], s26 offen offset:896 sc1
  buffer_store_dwordx4 v[20:23], v4, s[4:7], s25 offen offset:896 sc1
  s_mov_b64 exec, 0xffff
  v_or_b32 v160, 1, v160
  v_or_b32 v162, 1, v162
  buffer_store_dwordx4 v[160:163], v3, s[4:7], s26 offen offset:0 sc1
  v_or_b32 v164, 1, v164
  v_or_b32 v166, 1, v166
  buffer_store_dwordx4 v[164:167], v3, s[4:7], s25 offen offset:0 sc1
  v_or_b32 v168, 1, v168
  v_or_b32 v170, 1, v170
  buffer_store_dwordx4 v[168:171], v3, s[4:7], s26 offen offset:256 sc1
  v_or_b32 v172, 1, v172
  v_or_b32 v174, 1, v174
  buffer_store_dwordx4 v[172:175], v3, s[4:7], s25 offen offset:256 sc1
  v_or_b32 v176, 1, v176
  v_or_b32 v178, 1, v178
  buffer_store_dwordx4 v[176:179], v3, s[4:7], s26 offen offset:512 sc1
  v_or_b32 v180, 1, v180
  v_or_b32 v182, 1, v182
  buffer_store_dwordx4 v[180:183], v3, s[4:7], s25 offen offset:512 sc1
  s_mov_b64 exec, -1
  s_cmp_eq_u32 s79, 0
  s_cbranch_scc1 .g2_kernel_c_no
  s_lshl_b32 s20, s18, 15
  s_add_u32 s20, s20, 0x1190000
  s_lshl_b32 s22, s18, 11
  s_add_u32 s22, s22, s20
  v_lshlrev_b32 v16, 10, v2
  s_sleep 16
  s_mov_b32 s38, 0
  s_mov_b32 exec_hi, 0
.g2_kernel_gx48:
  buffer_load_dword v17, v16, s[4:7], s20 offen offset:752 sc1
  s_add_u32 s38, s38, 1
  s_waitcnt vmcnt(0)
  v_min_u32 v6, v17, v17
  v_cmp_eq_u32 vcc, 0, v6
  s_cbranch_vccz .g2_kernel_gx48d
  s_mov_b64 exec, vcc
  s_sleep 6
  s_cmp_lt_u32 s38, 131072
  s_cbranch_scc1 .g2_kernel_gx48
.g2_kernel_gx48d:
  s_mov_b64 exec, -1
  s_mov_b32 s38, 0
  s_bfm_b64 exec, 57, 0
.g2_kernel_gx49:
  s_mov_b32 s21, s20
  buffer_load_dwordx4 v[64:67], v3, s[4:7], s21 offen offset:0 sc1
  buffer_load_dwordx4 v[68:71], v3, s[4:7], s21 offen offset:1024 sc1
  buffer_load_dwordx4 v[72:75], v3, s[4:7], s21 offen offset:2048 sc1
  buffer_load_dwordx4 v[76:79], v3, s[4:7], s21 offen offset:3072 sc1
  s_add_u32 s21, s21, 4096
  buffer_load_dwordx4 v[80:83], v3, s[4:7], s21 offen offset:0 sc1
  buffer_load_dwordx4 v[84:87], v3, s[4:7], s21 offen offset:1024 sc1
  buffer_load_dwordx4 v[88:91], v3, s[4:7], s21 offen offset:2048 sc1
  buffer_load_dwordx4 v[92:95], v3, s[4:7], s21 offen offset:3072 sc1
  s_add_u32 s21, s21, 4096
  buffer_load_dwordx4 v[96:99], v3, s[4:7], s21 offen offset:0 sc1
  buffer_load_dwordx4 v[100:103], v3, s[4:7], s21 offen offset:1024 sc1
  buffer_load_dwordx4 v[104:107], v3, s[4:7], s21 offen offset:2048 sc1
  buffer_load_dwordx4 v[108:111], v3, s[4:7], s21 offen offset:3072 sc1
  s_add_u32 s21, s21, 4096
  buffer_load_dwordx4 v[112:115], v3, s[4:7], s21 offen offset:0 sc1
  buffer_load_dwordx4 v[116:119], v3, s[4:7], s21 offen offset:1024 sc1
  buffer_load_dwordx4 v[120:123], v3, s[4:7], s21 offen offset:2048 sc1
  buffer_load_dwordx4 v[124:127], v3, s[4:7], s21 offen offset:3072 sc1
  s_add_u32 s21, s21, 4096
  buffer_load_dwordx4 v[128:131], v3, s[4:7], s21 offen offset:0 sc1
  buffer_load_dwordx4 v[132:135], v3, s[4:7], s21 offen offset:1024 sc1
  buffer_load_dwordx4 v[136:139], v3, s[4:7], s21 offen offset:2048 sc1
  buffer_load_dwordx4 v[140:143], v3, s[4:7], s21 offen offset:3072 sc1
  s_add_u32 s21, s21, 4096
  buffer_load_dwordx4 v[144:147], v3, s[4:7], s21 offen offset:0 sc1
  buffer_load_dwordx4 v[148:151], v3, s[4:7], s21 offen offset:1024 sc1
  buffer_load_dwordx4 v[152:155], v3, s[4:7], s21 offen offset:2048 sc1
  buffer_load_dwordx4 v[156:159], v3, s[4:7], s21 offen offset:3072 sc1
  s_add_u32 s21, s21, 4096
  buffer_load_dwordx4 v[160:163], v3, s[4:7], s21 offen offset:0 sc1
  buffer_load_dwordx4 v[164:167], v3, s[4:7], s21 offen offset:1024 sc1
  buffer_load_dwordx4 v[168:171], v3, s[4:7], s21 offen offset:2048 sc1
  buffer_load_dwordx4 v[172:175], v3, s[4:7], s21 offen offset:3072 sc1
  s_add_u32 s21, s21, 4096
  buffer_load_dwordx4 v[176:179], v3, s[4:7], s21 offen offset:0 sc1
  buffer_load_dwordx4 v[180:183], v3, s[4:7], s21 offen offset:1024 sc1
  buffer_load_dwordx4 v[184:187], v3, s[4:7], s21 offen offset:2048 sc1
  buffer_load_dwordx4 v[188:191], v3, s[4:7], s21 offen offset:3072 sc1
  s_add_u32 s21, s21, 4096
  buffer_load_dwordx4 v[192:195], v3, s[4:7], s22 offen offset:0 sc1
  buffer_load_dwordx4 v[196:199], v3, s[4:7], s22 offen offset:1024 sc1
  s_add_u32 s38, s38, 1
  s_waitcnt vmcnt(0)
  v_min3_u32 v6, v64, v66, v68
  v_min3_u32 v6, v6, v70, v72
  v_min3_u32 v6, v6, v74, v76
  v_min3_u32 v6, v6, v78, v80
  v_min3_u32 v6, v6, v82, v84
  v_min3_u32 v6, v6, v86, v88
  v_min3_u32 v6, v6, v90, v92
  v_min3_u32 v6, v6, v94, v96
  v_min3_u32 v6, v6, v98, v100
  v_min3_u32 v6, v6, v102, v104
  v_min3_u32 v6, v6, v106, v108
  v_min3_u32 v6, v6, v110, v112
  v_min3_u32 v6, v6, v114, v116
  v_min3_u32 v6, v6, v118, v120
  v_min3_u32 v6, v6, v122, v124
  v_min3_u32 v6, v6, v126, v128
  v_min3_u32 v6, v6, v130, v132
  v_min3_u32 v6, v6, v134, v136
  v_min3_u32 v6, v6, v138, v140
  v_min3_u32 v6, v6, v142, v144
  v_min3_u32 v6, v6, v146, v148
  v_min3_u32 v6, v6, v150, v152
  v_min3_u32 v6, v6, v154, v156
  v_min3_u32 v6, v6, v158, v160
  v_min3_u32 v6, v6, v162, v164
  v_min3_u32 v6, v6, v166, v168
  v_min3_u32 v6, v6, v170, v172
  v_min3_u32 v6, v6, v174, v176
  v_min3_u32 v6, v6, v178, v180
  v_min3_u32 v6, v6, v182, v184
  v_min3_u32 v6, v6, v186, v188
  v_min3_u32 v6, v6, v190, v192
  v_min3_u32 v6, v6, v194, v196
  v_min_u32 v6, v6, v198
  v_cmp_eq_u32 vcc, 0, v6
  s_cbranch_vccz .g2_kernel_gx49d
  s_mov_b64 exec, vcc
  s_sleep 2
  s_cmp_lt_u32 s38, 131072
  s_cbranch_scc1 .g2_kernel_gx49
.g2_kernel_gx49d:
  s_mov_b64 exec, -1
  v_add_f32 v64, v64, v128
  v_add_f32 v65, v65, v129
  v_add_f32 v66, v66, v130
  v_add_f32 v67, v67, v131
  v_add_f32 v68, v68, v132
  v_add_f32 v69, v69, v133
  v_add_f32 v70, v70, v134
  v_add_f32 v71, v71, v135
  v_add_f32 v72, v72, v136
  v_add_f32 v73, v73, v137
  v_add_f32 v74, v74, v138
  v_add_f32 v75, v75, v139
  v_add_f32 v76, v76, v140
  v_add_f32 v77, v77, v141
  v_add_f32 v78, v78, v142
  v_add_f32 v79, v79, v143
  v_add_f32 v80, v80, v144
  v_add_f32 v81, v81, v145
  v_add_f32 v82, v82, v146
  v_add_f32 v83, v83, v147
  v_add_f32 v84, v84, v148
  v_add_f32 v85, v85, v149
  v_add_f32 v86, v86, v150
  v_add_f32 v87, v87, v151
  v_add_f32 v88, v88, v152
  v_add_f32 v89, v89, v153
  v_add_f32 v90, v90, v154
  v_add_f32 v91, v91, v155
  v_add_f32 v92, v92, v156
  v_add_f32 v93, v93, v157
  v_add_f32 v94, v94, v158
  v_add_f32 v95, v95, v159
  v_add_f32 v96, v96, v160
  v_add_f32 v97, v97, v161
  v_add_f32 v98, v98, v162
  v_add_f32 v99, v99, v163
  v_add_f32 v100, v100, v164
  v_add_f32 v101, v101, v165
  v_add_f32 v102, v102, v166
  v_add_f32 v103, v103, v167
  v_add_f32 v104, v104, v168
  v_add_f32 v105, v105, v169
  v_add_f32 v106, v106, v170
  v_add_f32 v107, v107, v171
  v_add_f32 v108, v108, v172
  v_add_f32 v109, v109, v173
  v_add_f32 v110, v110, v174
  v_add_f32 v111, v111, v175
  v_add_f32 v112, v112, v176
  v_add_f32 v113, v113, v177
  v_add_f32 v114, v114, v178
  v_add_f32 v115, v115, v179
  v_add_f32 v116, v116, v180
  v_add_f32 v117, v117, v181
  v_add_f32 v118, v118, v182
  v_add_f32 v119, v119, v183
  v_add_f32 v120, v120, v184
  v_add_f32 v121, v121, v185
  v_add_f32 v122, v122, v186
  v_add_f32 v123, v123, v187
  v_add_f32 v124, v124, v188
  v_add_f32 v125, v125, v189
  v_add_f32 v126, v126, v190
  v_add_f32 v127, v127, v191
  v_add_f32 v64, v64, v96
  v_add_f32 v65, v65, v97
  v_add_f32 v66, v66, v98
  v_add_f32 v67, v67, v99
  v_add_f32 v68, v68, v100
  v_add_f32 v69, v69, v101
  v_add_f32 v70, v70, v102
  v_add_f32 v71, v71, v103
  v_add_f32 v72, v72, v104
  v_add_f32 v73, v73, v105
  v_add_f32 v74, v74, v106
  v_add_f32 v75, v75, v107
  v_add_f32 v76, v76, v108
  v_add_f32 v77, v77, v109
  v_add_f32 v78, v78, v110
  v_add_f32 v79, v79, v111
  v_add_f32 v80, v80, v112
  v_add_f32 v81, v81, v113
  v_add_f32 v82, v82, v114
  v_add_f32 v83, v83, v115
  v_add_f32 v84, v84, v116
  v_add_f32 v85, v85, v117
  v_add_f32 v86, v86, v118
  v_add_f32 v87, v87, v119
  v_add_f32 v88, v88, v120
  v_add_f32 v89, v89, v121
  v_add_f32 v90, v90, v122
  v_add_f32 v91, v91, v123
  v_add_f32 v92, v92, v124
  v_add_f32 v93, v93, v125
  v_add_f32 v94, v94, v126
  v_add_f32 v95, v95, v127
  v_add_f32 v64, v64, v80
  v_add_f32 v65, v65, v81
  v_add_f32 v66, v66, v82
  v_add_f32 v67, v67, v83
  v_add_f32 v68, v68, v84
  v_add_f32 v69, v69, v85
  v_add_f32 v70, v70, v86
  v_add_f32 v71, v71, v87
  v_add_f32 v72, v72, v88
  v_add_f32 v73, v73, v89
  v_add_f32 v74, v74, v90
  v_add_f32 v75, v75, v91
  v_add_f32 v76, v76, v92
  v_add_f32 v77, v77, v93
  v_add_f32 v78, v78, v94
  v_add_f32 v79, v79, v95
  v_add_f32 v64, v64, v72
  v_add_f32 v65, v65, v73
  v_add_f32 v66, v66, v74
  v_add_f32 v67, v67, v75
  v_add_f32 v68, v68, v76
  v_add_f32 v69, v69, v77
  v_add_f32 v70, v70, v78
  v_add_f32 v71, v71, v79
  v_add_f32 v64, v64, v68
  v_add_f32 v65, v65, v69
  v_add_f32 v66, v66, v70
  v_add_f32 v67, v67, v71
  v_mov_b32 v28, 0.0009765625
  v_mov_b32 v30, 1e-05
  v_readlane_b32 s21, v64, 56
  v_readlane_b32 s22, v66, 56
  s_nop 0
  v_mul_f32 v20, s21, v28
  v_fma_f32 v21, s22, v28, v30
  v_fma_f32 v21, -v20, v20, v21
  v_rsq_f32 v21, abs(v21)
  v_sub_f32 v20, v61, v20
  v_mul_f32 v22, v21, v60
  v_mul_f32 v23, v21, v20
  v_and_b32 v10, 15, v2
  v_lshrrev_b32 v11, 4, v2
  v_lshlrev_b32 v16, 2, v10
  v_lshl_add_u32 v16, v11, 8, v16
  v_add_u32 v16, 155648, v16
  s_sub_u32 s20, s79, 1
  s_and_b32 s21, s20, 3
  s_lshl_b32 s21, s21, 2
  s_add_u32 s21, s21, 156160
  v_lshl_add_u32 v17, v10, 4, s21
  v_cmp_eq_u32 vcc, 2, v11
  v_mov_b32 v18, 64
  v_mov_b32 v19, 256
  v_cndmask_b32 v17, v16, v17, vcc
  v_cndmask_b32 v18, v18, v19, vcc
  v_lshrrev_b32 v24, 2, v10
  v_lshlrev_b32 v24, 9, v24
  v_and_b32 v25, 3, v10
  v_lshl_add_u32 v24, v25, 1, v24
  s_and_b32 s21, s20, 31
  s_lshl_b32 s22, s21, 4
  s_lshr_b32 s23, s20, 5
  s_lshl_b32 s24, s23, 11
  s_add_u32 s22, s22, s24
  s_add_u32 s22, s22, 131072
  v_add_u32 v26, s22, v24
  s_and_b32 s22, s21, 7
  s_and_b32 s24, s21, 8
  s_lshl_b32 s24, s24, 1
  s_add_u32 s22, s22, s24
  s_and_b32 s24, s21, 16
  s_lshr_b32 s24, s24, 1
  s_add_u32 s22, s22, s24
  s_lshl_b32 s22, s22, 4
  v_add_u32 v24, s22, v24
  s_bfe_u32 s22, s21, 0x20002
  s_lshl_b32 s22, s22, 9
  s_add_u32 s22, s22, s24
  s_and_b32 s24, s21, 3
  s_lshl_b32 s24, s24, 1
  s_add_u32 s22, s22, s24
  s_add_u32 s22, s22, 2048
  v_lshl_add_u32 v25, v10, 4, s22
  v_cndmask_b32 v24, v24, v25, vcc
  v_cndmask_b32 v19, 8, v19, vcc
  v_add_u32 v25, v24, v19
  s_lshl_b32 s22, s18, 7
  s_lshl_b32 s24, s17, 2
  s_add_u32 s22, s22, s24
  s_add_u32 s22, s22, s23
  s_lshl_b32 s22, s22, 12
  s_add_u32 s22, s22, 0x1800000
  s_add_u32 s23, s22, 262144
  s_lshr_b32 s24, s20, 6
  s_lshl_b32 s24, s24, 8
  s_add_u32 s24, s24, s76
  v_cmp_eq_u32 vcc, 0, v11
  v_mov_b32 v27, 0.25503486164919736
  s_nop 0
  v_cndmask_b32 v27, 1.0, v27, vcc
  v_mul_f32 v21, v21, v27
  v_mul_f32 v22, v22, v27
  v_mul_f32 v23, v23, v27
  s_mov_b32 s62, 1
  s_mov_b32 s63, 0x1800000
  s_mov_b32 s70, 2
  s_mov_b32 s71, 155776
  v_mov_b32 v6, s71
  s_mov_b32 s38, 0
.g2_kernel_wg50:
  ds_read_b32 v7, v6 offset:56
  s_add_u32 s38, s38, 1
  s_waitcnt lgkmcnt(0)
  v_cmp_le_u32 vcc, 2, v7
  s_cbranch_vccnz .g2_kernel_wg50d
  s_sleep 1
  s_cmp_lt_u32 s38, 524288
  s_cbranch_scc1 .g2_kernel_wg50
.g2_kernel_wg50d:
  ds_read_b32 v32, v17 offset:5632
  ds_read_b32 v36, v16 offset:4864
  v_add_u32 v17, v17, v18
  ds_read_b32 v33, v17 offset:5632
  ds_read_b32 v37, v16 offset:4928
  v_add_u32 v17, v17, v18
  ds_read_b32 v34, v17 offset:5632
  ds_read_b32 v38, v16 offset:4992
  v_add_u32 v17, v17, v18
  ds_read_b32 v35, v17 offset:5632
  ds_read_b32 v39, v16 offset:5056
  s_waitcnt lgkmcnt(0)
  v_mul_f32 v32, v32, v22
  v_fmac_f32 v32, v64, v21
  v_fmac_f32 v32, v36, v23
  v_mul_f32 v33, v33, v22
  v_fmac_f32 v33, v65, v21
  v_fmac_f32 v33, v37, v23
  v_mul_f32 v34, v34, v22
  v_fmac_f32 v34, v66, v21
  v_fmac_f32 v34, v38, v23
  v_mul_f32 v35, v35, v22
  v_fmac_f32 v35, v67, v21
  v_fmac_f32 v35, v39, v23
  v_cvt_pk_bf16_f32 v32, v32, v33
  v_cvt_pk_bf16_f32 v34, v34, v35
  v_mov_b32 v9, s71
  v_mov_b32 v8, 2
  s_mov_b32 exec_lo, 0xffff0000
  s_mov_b32 exec_hi, 0xffff
  buffer_store_short v32, v24, s[4:7], s22 offen sc1
  buffer_store_short_d16_hi v32, v25, s[4:7], s22 offen sc1
  buffer_store_short v34, v24, s[4:7], s23 offen sc1
  buffer_store_short_d16_hi v34, v25, s[4:7], s23 offen sc1
  s_mov_b64 exec, 0xffff
  ds_write_b16 v26, v32 offset:8192
  ds_write_b16_d16_hi v26, v32 offset:8200
  ds_write_b16 v26, v34
  ds_write_b16_d16_hi v26, v34 offset:8
  ds_write_b32 v9, v5 offset:60
  s_mov_b32 exec_lo, 0
  s_mov_b32 exec_hi, 0xff0000
  ds_write_b32 v16, v192 offset:6912
  ds_write_b32 v16, v193 offset:6976
  ds_write_b32 v16, v194 offset:7040
  ds_write_b32 v16, v195 offset:7104
  ds_write_b32 v16, v196 offset:6944
  ds_write_b32 v16, v197 offset:7008
  ds_write_b32 v16, v198 offset:7072
  ds_write_b32 v16, v199 offset:7136
  s_mov_b64 exec, 1
  s_waitcnt vmcnt(0)
  buffer_store_dword v8, v4, s[4:7], s24 offen sc1
  buffer_store_dword v8, v4, s[4:7], s24 offen offset:128 sc1
  s_mov_b64 exec, -1
  s_branch .g2_kernel_v
.g2_kernel_c_no:
  s_mov_b32 s62, 1
  s_mov_b32 s63, 0x1800000
  s_mov_b32 s70, 2
  s_mov_b32 s71, 155776
  s_branch .g2_kernel_v
.g2_kernel_c_t3:
  s_lshr_b32 s33, s77, 7
  s_lshl_b32 s28, s33, 2
  s_lshl_b64 s[8:9], 15, s28
  s_lshl_b32 s21, s17, 10
  s_add_u32 s21, s21, 0x2880000
  v_lshlrev_b32 v14, 3, v2
  v_add_u32 v14, 155648, v14
  v_mov_b32 v9, s71
  s_cmp_eq_u32 s33, s17
  s_cbranch_scc0 .g2_kernel_c_u1
  s_sleep 6
  s_call_b64 s[72:73], .g2_kernel_c_ph2
  s_branch .g2_kernel_c_u2
.g2_kernel_c_u1:
  v_mov_b32 v6, s71
  s_mov_b32 s38, 0
.g2_kernel_wg51:
  ds_read_b32 v7, v6 offset:36
  s_add_u32 s38, s38, 1
  s_waitcnt lgkmcnt(0)
  v_cmp_le_u32 vcc, 1, v7
  s_cbranch_vccnz .g2_kernel_wg51d
  s_sleep 1
  s_cmp_lt_u32 s38, 524288
  s_cbranch_scc1 .g2_kernel_wg51
.g2_kernel_wg51d:
  v_readfirstlane_b32 s77, v7
  s_sub_u32 s77, s77, 1
.g2_kernel_c_u2:
  s_mov_b32 s38, 0
.g2_kernel_gx52:
  buffer_load_dwordx4 v[16:19], v3, s[4:7], s21 offen sc1
  s_add_u32 s38, s38, 1
  s_waitcnt vmcnt(0)
  v_min_u32 v6, v17, v19
  v_cmp_eq_u32 vcc, 0, v6
  s_cbranch_vccz .g2_kernel_gx52d
  s_mov_b64 exec, vcc
  s_cmp_lt_u32 s38, 131072
  s_cbranch_scc1 .g2_kernel_gx52
.g2_kernel_gx52d:
  s_mov_b64 exec, -1
  s_lshr_b32 s28, s77, 7
  s_and_b32 s79, s77, 127
  s_add_u32 s79, s79, 1
  s_cmp_eq_u32 s28, s17
  s_cselect_b32 s79, s79, 0
  v_rsq_f32 v22, v17
  v_rsq_f32 v23, v19
  v_mov_b32 v15, s79
  v_add_f32 v52, 1.0, v22
  v_mul_f32 v54, v16, v22
  v_sub_f32 v54, 0, v54
  v_add_f32 v53, 1.0, v23
  v_mul_f32 v55, v18, v23
  v_sub_f32 v55, 0, v55
  ds_write_b64 v14, v[52:53] offset:3840
  ds_write_b64 v14, v[54:55] offset:4352
  ds_write_b32 v9, v15 offset:32
  ds_write_b32 v9, v5 offset:28
  s_cmp_eq_u32 s33, s17
  s_cbranch_scc1 .g2_kernel_fin
  s_sleep 28
  s_mov_b32 s39, 1
  s_call_b64 s[72:73], .g2_kernel_c_ph2
  s_branch .g2_kernel_fin
.g2_kernel_c_ph2:
  s_call_b64 s[68:69], .g2_kernel_amax
  v_mov_b32 v6, s71
  s_mov_b32 s38, 0
.g2_kernel_wg53:
  ds_read_b32 v7, v6 offset:36
  s_add_u32 s38, s38, 1
  s_waitcnt lgkmcnt(0)
  v_cmp_le_u32 vcc, 1, v7
  s_cbranch_vccnz .g2_kernel_wg53d
  s_cmp_lt_u32 s38, 524288
  s_cbranch_scc1 .g2_kernel_wg53
.g2_kernel_wg53d:
  ds_read_b32 v8, v9 offset:96
  v_readfirstlane_b32 s28, v7
  s_sub_u32 s28, s28, 1
  s_add_u32 s29, s77, 2
  s_waitcnt lgkmcnt(0)
  v_cmp_gt_f32 vcc, s27, v8
  s_cmp_lg_u64 vcc, 0
  s_cselect_b32 s77, s77, s28
  s_cselect_b32 s29, s29, 1
  v_mov_b32 v10, s29
  v_mov_b32 v11, s27
  ds_write_b64 v9, v[10:11] offset:88
  s_setpc_b64 s[72:73]
.g2_kernel_c2:
  s_cmp_lg_u32 s62, 0
  s_cbranch_scc1 .g2_kernel_d_a
  s_cmp_lg_u32 s16, 7
  s_cbranch_scc1 .g2_kernel_d_a
  v_mov_b32 v6, s71
  s_mov_b32 s38, 0
.g2_kernel_wg56:
  ds_read_b32 v7, v6 offset:20
  s_add_u32 s38, s38, 1
  s_waitcnt lgkmcnt(0)
  v_cmp_le_u32 vcc, 4, v7
  s_cbranch_vccnz .g2_kernel_wg56d
  s_sleep 2
  s_cmp_lt_u32 s38, 524288
  s_cbranch_scc1 .g2_kernel_wg56
.g2_kernel_wg56d:
  s_sleep 20
  s_and_b32 s31, s19, 0xffffe000
  s_add_u32 s31, s31, 8
  v_and_b32 v6, 15, v2
  v_lshlrev_b32 v6, 9, v6
  v_lshrrev_b32 v7, 4, v2
  v_lshl_add_u32 v6, v7, 7, v6
  v_lshlrev_b32 v7, 2, v2
  v_add_u32 v7, 158208, v7
  s_mov_b32 m0, 158208
  s_mov_b32 s38, 0
.g2_kernel_pa57:
  buffer_load_dword v6, s[4:7], s31 offen sc1 lds
  s_add_u32 s38, s38, 1
  s_waitcnt vmcnt(0)
  ds_read_b32 v8, v7
  s_waitcnt lgkmcnt(0)
  v_cmp_ge_u32 vcc, s62, v8
  s_cbranch_vccz .g2_kernel_pa57d
  s_mov_b64 exec, vcc
  s_sleep 10
  s_cmp_lt_u32 s38, 131072
  s_cbranch_scc1 .g2_kernel_pa57
.g2_kernel_pa57d:
  s_mov_b64 exec, -1
.g2_kernel_d_a:
  s_setprio 2
  s_and_b32 s20, s16, 1
  v_bfe_u32 v8, v2, 1, 3
  v_lshlrev_b32 v8, 14, v8
  v_and_b32 v9, 1, v2
  v_lshl_add_u32 v8, v9, 10, v8
  v_lshrrev_b32 v9, 4, v2
  v_lshl_add_u32 v8, v9, 8, v8
  v_and_b32 v9, 15, v2
  v_lshlrev_b32 v9, 3, v9
  s_lshl_b32 s28, s20, 7
  s_add_u32 s28, s28, 163584
  v_add_u32 v10, s28, v9
  v_xor_b32 v11, 128, v10
  s_lshl_b32 s28, s20, 2
  s_add_u32 s28, s28, s71
  v_mov_b32 v12, s28
  v_xor_b32 v13, 4, v12
  s_lshl_b32 s26, s17, 4
  s_add_u32 s26, s26, s18
  s_lshl_b32 s26, s26, 1
  s_add_u32 s26, s26, s20
  s_lshl_b32 s26, s26, 11
  s_add_u32 s26, s26, s63
  s_add_u32 s26, s26, 0x1090000
  s_mov_b32 s32, 0
  s_mov_b32 s39, 0
  s_lshl_b32 s28, s62, 3
  s_add_u32 s28, s28, s16
  s_cmp_lg_u32 s28, 14
  s_cbranch_scc1 .g2_kernel_d_w
  s_lshr_b32 s33, s77, 7
  s_lshl_b32 s28, s33, 2
  s_lshl_b64 s[8:9], 15, s28
  s_not_b64 s[8:9], s[8:9]
  s_and_b32 s28, s2, 7
  s_lshl_b32 s28, s28, 13
  s_add_u32 s23, s28, 0x3050000
  s_cmp_eq_u32 s33, s17
  s_cbranch_scc1 .g2_kernel_d_v
  v_mov_b32 v6, s71
  s_mov_b32 s38, 0
.g2_kernel_wg58:
  ds_read_b32 v7, v6 offset:20
  s_add_u32 s38, s38, 1
  s_waitcnt lgkmcnt(0)
  v_cmp_le_u32 vcc, 4, v7
  s_cbranch_vccnz .g2_kernel_wg58d
  s_sleep 1
  s_cmp_lt_u32 s38, 524288
  s_cbranch_scc1 .g2_kernel_wg58
.g2_kernel_wg58d:
.g2_kernel_d_v:
  s_sleep 60
  s_call_b64 s[68:69], .g2_kernel_amax
  s_add_u32 s28, s77, 1
  v_mov_b32 v6, s27
  v_mov_b32 v7, s28
  ds_write_b32 v12, v6 offset:96
  ds_write_b32 v12, v7 offset:36
  s_waitcnt lgkmcnt(0)
  s_wakeup
  s_branch .g2_kernel_d_r
.g2_kernel_d_w:
  v_mov_b32 v6, s71
  s_mov_b32 s38, 0
.g2_kernel_wg59:
  ds_read_b32 v7, v6 offset:36
  s_add_u32 s38, s38, 1
  s_waitcnt lgkmcnt(0)
  v_cmp_le_u32 vcc, 1, v7
  s_cbranch_vccnz .g2_kernel_wg59d
  s_sleep 4
  s_cmp_lt_u32 s38, 524288
  s_cbranch_scc1 .g2_kernel_wg59
.g2_kernel_wg59d:
  v_readfirstlane_b32 s77, v7
  s_sub_u32 s77, s77, 1
.g2_kernel_d_r:
  s_and_b32 s77, s77, 2047
  s_lshr_b32 s24, s77, 7
  s_lshl_b32 s24, s24, 18
  s_bfe_u32 s28, s77, 0x30004
  s_lshl_b32 s28, s28, 11
  s_add_u32 s24, s24, s28
  s_and_b32 s28, s77, 15
  s_lshl_b32 s28, s28, 4
  s_add_u32 s24, s24, s28
  s_add_u32 s24, s24, s63
  s_add_u32 s24, s24, 0xc00000
  s_lshl_b32 s28, s17, 14
  s_add_u32 s21, s24, s28
  s_and_b32 s28, s18, 8
  s_lshl_b32 s28, s28, 5
  s_add_u32 s21, s21, s28
  s_and_b32 s28, s18, 7
  s_lshl_b32 s28, s28, 1
  s_add_u32 s21, s21, s28
  s_lshl_b32 s28, s20, 17
  s_add_u32 s24, s24, s28
  buffer_load_dwordx4 v[16:19], v8, s[4:7], s24 offen
  buffer_load_ushort v56, v4, s[4:7], s21 offen
  buffer_load_ushort v57, v4, s[4:7], s21 offen offset:512
  buffer_load_ushort v58, v4, s[4:7], s21 offen offset:1024
  buffer_load_ushort v59, v4, s[4:7], s21 offen offset:1536
  s_lshl_b32 s25, s77, 3
  s_add_u32 s25, s25, s63
  s_add_u32 s25, s25, 0x1080000
  s_mov_b32 s38, 0
.g2_kernel_gx60:
  buffer_load_dwordx2 v[20:21], v4, s[4:7], s25 offen sc1
  s_add_u32 s38, s38, 1
  s_waitcnt vmcnt(0)
  v_min_u32 v6, v21, v21
  v_cmp_eq_u32 vcc, 0, v6
  s_cbranch_vccz .g2_kernel_gx60d
  s_mov_b64 exec, vcc
  s_sleep 1
  s_cmp_lt_u32 s38, 131072
  s_cbranch_scc1 .g2_kernel_gx60
.g2_kernel_gx60d:
  s_mov_b64 exec, -1
  v_rsq_f32 v21, v21
  v_lshlrev_b32 v24, 16, v16
  v_and_b32 v25, 0xffff0000, v16
  v_lshlrev_b32 v26, 16, v17
  v_and_b32 v27, 0xffff0000, v17
  v_lshlrev_b32 v28, 16, v18
  v_and_b32 v29, 0xffff0000, v18
  v_lshlrev_b32 v30, 16, v19
  v_and_b32 v31, 0xffff0000, v19
  v_mul_f32 v20, v20, v21
  v_mov_b32 v60, v20
  v_add_f32 v61, 1.0, v21
  s_cmp_ge_u32 s17, 14
  s_cbranch_scc1 .g2_kernel_d_none
  v_fma_f32 v24, v24, v21, -v20
  v_fma_f32 v25, v25, v21, -v20
  v_fma_f32 v26, v26, v21, -v20
  v_fma_f32 v27, v27, v21, -v20
  v_fma_f32 v28, v28, v21, -v20
  v_fma_f32 v29, v29, v21, -v20
  v_fma_f32 v30, v30, v21, -v20
  v_fma_f32 v31, v31, v21, -v20
  v_cvt_pk_bf16_f32 v16, v24, v25
  v_cvt_pk_bf16_f32 v17, v26, v27
  v_cvt_pk_bf16_f32 v18, v28, v29
  v_cvt_pk_bf16_f32 v19, v30, v31
  v_mov_b32 v24, v16 row_newbcast:0 row_mask:0xf bank_mask:0xf
  v_mov_b32 v25, v17 row_newbcast:0 row_mask:0xf bank_mask:0xf
  v_mov_b32 v26, v18 row_newbcast:0 row_mask:0xf bank_mask:0xf
  v_mov_b32 v27, v19 row_newbcast:0 row_mask:0xf bank_mask:0xf
  v_mov_b32 v28, v16 row_newbcast:1 row_mask:0xf bank_mask:0xf
  v_mov_b32 v29, v17 row_newbcast:1 row_mask:0xf bank_mask:0xf
  v_mov_b32 v30, v18 row_newbcast:1 row_mask:0xf bank_mask:0xf
  v_mov_b32 v31, v19 row_newbcast:1 row_mask:0xf bank_mask:0xf
  v_mfma_f32_16x16x32_bf16 v[32:35], v[24:27], v[64:67], 0
  v_mfma_f32_16x16x32_bf16 v[36:39], v[24:27], v[128:131], 0
  v_mov_b32 v24, v16 row_newbcast:2 row_mask:0xf bank_mask:0xf
  v_mov_b32 v25, v17 row_newbcast:2 row_mask:0xf bank_mask:0xf
  v_mov_b32 v26, v18 row_newbcast:2 row_mask:0xf bank_mask:0xf
  v_mov_b32 v27, v19 row_newbcast:2 row_mask:0xf bank_mask:0xf
  v_mfma_f32_16x16x32_bf16 v[32:35], v[28:31], v[68:71], v[32:35]
  v_mfma_f32_16x16x32_bf16 v[36:39], v[28:31], v[132:135], v[36:39]
  v_mov_b32 v28, v16 row_newbcast:3 row_mask:0xf bank_mask:0xf
  v_mov_b32 v29, v17 row_newbcast:3 row_mask:0xf bank_mask:0xf
  v_mov_b32 v30, v18 row_newbcast:3 row_mask:0xf bank_mask:0xf
  v_mov_b32 v31, v19 row_newbcast:3 row_mask:0xf bank_mask:0xf
  v_mfma_f32_16x16x32_bf16 v[32:35], v[24:27], v[72:75], v[32:35]
  v_mfma_f32_16x16x32_bf16 v[36:39], v[24:27], v[136:139], v[36:39]
  v_mov_b32 v24, v16 row_newbcast:4 row_mask:0xf bank_mask:0xf
  v_mov_b32 v25, v17 row_newbcast:4 row_mask:0xf bank_mask:0xf
  v_mov_b32 v26, v18 row_newbcast:4 row_mask:0xf bank_mask:0xf
  v_mov_b32 v27, v19 row_newbcast:4 row_mask:0xf bank_mask:0xf
  v_mfma_f32_16x16x32_bf16 v[32:35], v[28:31], v[76:79], v[32:35]
  v_mfma_f32_16x16x32_bf16 v[36:39], v[28:31], v[140:143], v[36:39]
  v_mov_b32 v28, v16 row_newbcast:5 row_mask:0xf bank_mask:0xf
  v_mov_b32 v29, v17 row_newbcast:5 row_mask:0xf bank_mask:0xf
  v_mov_b32 v30, v18 row_newbcast:5 row_mask:0xf bank_mask:0xf
  v_mov_b32 v31, v19 row_newbcast:5 row_mask:0xf bank_mask:0xf
  v_mfma_f32_16x16x32_bf16 v[32:35], v[24:27], v[80:83], v[32:35]
  v_mfma_f32_16x16x32_bf16 v[36:39], v[24:27], v[144:147], v[36:39]
  v_mov_b32 v24, v16 row_newbcast:6 row_mask:0xf bank_mask:0xf
  v_mov_b32 v25, v17 row_newbcast:6 row_mask:0xf bank_mask:0xf
  v_mov_b32 v26, v18 row_newbcast:6 row_mask:0xf bank_mask:0xf
  v_mov_b32 v27, v19 row_newbcast:6 row_mask:0xf bank_mask:0xf
  v_mfma_f32_16x16x32_bf16 v[32:35], v[28:31], v[84:87], v[32:35]
  v_mfma_f32_16x16x32_bf16 v[36:39], v[28:31], v[148:151], v[36:39]
  v_mov_b32 v28, v16 row_newbcast:7 row_mask:0xf bank_mask:0xf
  v_mov_b32 v29, v17 row_newbcast:7 row_mask:0xf bank_mask:0xf
  v_mov_b32 v30, v18 row_newbcast:7 row_mask:0xf bank_mask:0xf
  v_mov_b32 v31, v19 row_newbcast:7 row_mask:0xf bank_mask:0xf
  v_mfma_f32_16x16x32_bf16 v[32:35], v[24:27], v[88:91], v[32:35]
  v_mfma_f32_16x16x32_bf16 v[36:39], v[24:27], v[152:155], v[36:39]
  v_mov_b32 v24, v16 row_newbcast:8 row_mask:0xf bank_mask:0xf
  v_mov_b32 v25, v17 row_newbcast:8 row_mask:0xf bank_mask:0xf
  v_mov_b32 v26, v18 row_newbcast:8 row_mask:0xf bank_mask:0xf
  v_mov_b32 v27, v19 row_newbcast:8 row_mask:0xf bank_mask:0xf
  v_mfma_f32_16x16x32_bf16 v[32:35], v[28:31], v[92:95], v[32:35]
  v_mfma_f32_16x16x32_bf16 v[36:39], v[28:31], v[156:159], v[36:39]
  v_mov_b32 v28, v16 row_newbcast:9 row_mask:0xf bank_mask:0xf
  v_mov_b32 v29, v17 row_newbcast:9 row_mask:0xf bank_mask:0xf
  v_mov_b32 v30, v18 row_newbcast:9 row_mask:0xf bank_mask:0xf
  v_mov_b32 v31, v19 row_newbcast:9 row_mask:0xf bank_mask:0xf
  v_mfma_f32_16x16x32_bf16 v[32:35], v[24:27], v[96:99], v[32:35]
  v_mfma_f32_16x16x32_bf16 v[36:39], v[24:27], v[160:163], v[36:39]
  v_mov_b32 v24, v16 row_newbcast:10 row_mask:0xf bank_mask:0xf
  v_mov_b32 v25, v17 row_newbcast:10 row_mask:0xf bank_mask:0xf
  v_mov_b32 v26, v18 row_newbcast:10 row_mask:0xf bank_mask:0xf
  v_mov_b32 v27, v19 row_newbcast:10 row_mask:0xf bank_mask:0xf
  v_mfma_f32_16x16x32_bf16 v[32:35], v[28:31], v[100:103], v[32:35]
  v_mfma_f32_16x16x32_bf16 v[36:39], v[28:31], v[164:167], v[36:39]
  v_mov_b32 v28, v16 row_newbcast:11 row_mask:0xf bank_mask:0xf
  v_mov_b32 v29, v17 row_newbcast:11 row_mask:0xf bank_mask:0xf
  v_mov_b32 v30, v18 row_newbcast:11 row_mask:0xf bank_mask:0xf
  v_mov_b32 v31, v19 row_newbcast:11 row_mask:0xf bank_mask:0xf
  v_mfma_f32_16x16x32_bf16 v[32:35], v[24:27], v[104:107], v[32:35]
  v_mfma_f32_16x16x32_bf16 v[36:39], v[24:27], v[168:171], v[36:39]
  v_mov_b32 v24, v16 row_newbcast:12 row_mask:0xf bank_mask:0xf
  v_mov_b32 v25, v17 row_newbcast:12 row_mask:0xf bank_mask:0xf
  v_mov_b32 v26, v18 row_newbcast:12 row_mask:0xf bank_mask:0xf
  v_mov_b32 v27, v19 row_newbcast:12 row_mask:0xf bank_mask:0xf
  v_mfma_f32_16x16x32_bf16 v[32:35], v[28:31], v[108:111], v[32:35]
  v_mfma_f32_16x16x32_bf16 v[36:39], v[28:31], v[172:175], v[36:39]
  v_mov_b32 v28, v16 row_newbcast:13 row_mask:0xf bank_mask:0xf
  v_mov_b32 v29, v17 row_newbcast:13 row_mask:0xf bank_mask:0xf
  v_mov_b32 v30, v18 row_newbcast:13 row_mask:0xf bank_mask:0xf
  v_mov_b32 v31, v19 row_newbcast:13 row_mask:0xf bank_mask:0xf
  v_mfma_f32_16x16x32_bf16 v[32:35], v[24:27], v[112:115], v[32:35]
  v_mfma_f32_16x16x32_bf16 v[36:39], v[24:27], v[176:179], v[36:39]
  v_mov_b32 v24, v16 row_newbcast:14 row_mask:0xf bank_mask:0xf
  v_mov_b32 v25, v17 row_newbcast:14 row_mask:0xf bank_mask:0xf
  v_mov_b32 v26, v18 row_newbcast:14 row_mask:0xf bank_mask:0xf
  v_mov_b32 v27, v19 row_newbcast:14 row_mask:0xf bank_mask:0xf
  v_mfma_f32_16x16x32_bf16 v[32:35], v[28:31], v[116:119], v[32:35]
  v_mfma_f32_16x16x32_bf16 v[36:39], v[28:31], v[180:183], v[36:39]
  v_mov_b32 v28, v16 row_newbcast:15 row_mask:0xf bank_mask:0xf
  v_mov_b32 v29, v17 row_newbcast:15 row_mask:0xf bank_mask:0xf
  v_mov_b32 v30, v18 row_newbcast:15 row_mask:0xf bank_mask:0xf
  v_mov_b32 v31, v19 row_newbcast:15 row_mask:0xf bank_mask:0xf
  v_mfma_f32_16x16x32_bf16 v[32:35], v[24:27], v[120:123], v[32:35]
  v_mfma_f32_16x16x32_bf16 v[36:39], v[24:27], v[184:187], v[36:39]
  v_mfma_f32_16x16x32_bf16 v[32:35], v[28:31], v[124:127], v[32:35]
  v_mfma_f32_16x16x32_bf16 v[36:39], v[28:31], v[188:191], v[36:39]
  s_mov_b32 s38, 0
  s_add_u32 s28, s32, 1
  v_mov_b32 v14, s28
  s_mov_b32 s28, 0x00010001
  s_mov_b32 s29, 0x00100010
  s_nop 2
  v_mov_b32 v35, v36
  ds_write_b64 v10, v[34:35]
  ds_write_b32 v12, v14 offset:40
.g2_kernel_d_x:
  ds_read_b32 v6, v13 offset:40
  ds_read_b64 v[16:17], v11
  s_add_u32 s38, s38, 1
  s_waitcnt lgkmcnt(0)
  v_cmp_lt_u32 vcc, s32, v6
  s_cbranch_vccnz .g2_kernel_d_xd
  s_cmp_lt_u32 s38, 524288
  s_cbranch_scc1 .g2_kernel_d_x
.g2_kernel_d_xd:
  v_add_f32 v16, v16, v32
  v_add_f32 v17, v17, v36
  v_mul_f32 v18, -1.4426950408889634, v16
  v_exp_f32 v18, v18
  v_mul_f32 v16, v16, v17
  v_add_f32 v18, 1.0, v18
  v_rcp_f32 v18, v18
  s_nop 0
  v_mul_f32 v16, v16, v18
  s_nop 1
  v_mov_b32 v17, v16 quad_perm:[1,0,3,2] row_mask:0xf bank_mask:0xf
  v_cvt_pk_bf16_f32 v16, v16, v17
  s_nop 1
  v_mov_b32 v20, v16 row_newbcast:0 row_mask:0x5 bank_mask:0xf
  v_mov_b32 v21, v16 row_newbcast:2 row_mask:0x5 bank_mask:0xf
  v_mov_b32 v22, v16 row_newbcast:4 row_mask:0x5 bank_mask:0xf
  v_mov_b32 v23, v16 row_newbcast:6 row_mask:0x5 bank_mask:0xf
  v_mov_b32 v20, v16 row_newbcast:8 row_mask:0xa bank_mask:0xf
  v_mov_b32 v21, v16 row_newbcast:10 row_mask:0xa bank_mask:0xf
  v_mov_b32 v22, v16 row_newbcast:12 row_mask:0xa bank_mask:0xf
  v_mov_b32 v23, v16 row_newbcast:14 row_mask:0xa bank_mask:0xf
  v_cndmask_b32 v24, 0, v20, s[28:29]
  v_cndmask_b32 v25, 0, v21, s[28:29]
  v_cndmask_b32 v26, 0, v22, s[28:29]
  v_cndmask_b32 v27, 0, v23, s[28:29]
  s_lshl_b64 s[28:29], s[28:29], 1
  s_nop 0
  v_mfma_f32_16x16x32_bf16 v[40:43], v[24:27], v[192:195], 0
  v_mfma_f32_16x16x32_bf16 v[44:47], v[24:27], v[208:211], 0
  v_mfma_f32_16x16x32_bf16 v[48:51], v[24:27], v[224:227], 0
  v_mfma_f32_16x16x32_bf16 v[52:55], v[24:27], v[240:243], 0
  v_cndmask_b32 v28, 0, v20, s[28:29]
  v_cndmask_b32 v29, 0, v21, s[28:29]
  v_cndmask_b32 v30, 0, v22, s[28:29]
  v_cndmask_b32 v31, 0, v23, s[28:29]
  s_lshl_b64 s[28:29], s[28:29], 1
  s_nop 0
  v_mfma_f32_16x16x32_bf16 v[40:43], v[28:31], v[196:199], v[40:43]
  v_mfma_f32_16x16x32_bf16 v[44:47], v[28:31], v[212:215], v[44:47]
  v_mfma_f32_16x16x32_bf16 v[48:51], v[28:31], v[228:231], v[48:51]
  v_mfma_f32_16x16x32_bf16 v[52:55], v[28:31], v[244:247], v[52:55]
  v_cndmask_b32 v32, 0, v20, s[28:29]
  v_cndmask_b32 v33, 0, v21, s[28:29]
  v_cndmask_b32 v34, 0, v22, s[28:29]
  v_cndmask_b32 v35, 0, v23, s[28:29]
  s_lshl_b64 s[28:29], s[28:29], 1
  s_nop 0
  v_mfma_f32_16x16x32_bf16 v[40:43], v[32:35], v[200:203], v[40:43]
  v_mfma_f32_16x16x32_bf16 v[44:47], v[32:35], v[216:219], v[44:47]
  v_mfma_f32_16x16x32_bf16 v[48:51], v[32:35], v[232:235], v[48:51]
  v_mfma_f32_16x16x32_bf16 v[52:55], v[32:35], v[248:251], v[52:55]
  v_cndmask_b32 v36, 0, v20, s[28:29]
  v_cndmask_b32 v37, 0, v21, s[28:29]
  v_cndmask_b32 v38, 0, v22, s[28:29]
  v_cndmask_b32 v39, 0, v23, s[28:29]
  s_lshl_b64 s[28:29], s[28:29], 1
  s_nop 0
  v_mfma_f32_16x16x32_bf16 v[40:43], v[36:39], v[204:207], v[40:43]
  v_mfma_f32_16x16x32_bf16 v[44:47], v[36:39], v[220:223], v[44:47]
  v_mfma_f32_16x16x32_bf16 v[48:51], v[36:39], v[236:239], v[48:51]
  v_mfma_f32_16x16x32_bf16 v[52:55], v[36:39], v[252:255], v[52:55]
  s_mov_b32 exec_hi, 0
  s_nop 3
  v_or_b32 v40, 1, v40
  v_or_b32 v42, 1, v42
  buffer_store_dwordx4 v[40:43], v3, s[4:7], s26 offen offset:0 sc1
  v_or_b32 v44, 1, v44
  v_or_b32 v46, 1, v46
  buffer_store_dwordx4 v[44:47], v3, s[4:7], s26 offen offset:512 sc1
  v_or_b32 v48, 1, v48
  v_or_b32 v50, 1, v50
  buffer_store_dwordx4 v[48:51], v3, s[4:7], s26 offen offset:1024 sc1
  v_or_b32 v52, 1, v52
  v_or_b32 v54, 1, v54
  buffer_store_dwordx4 v[52:55], v3, s[4:7], s26 offen offset:1536 sc1
  s_mov_b64 exec, -1
  s_branch .g2_kernel_d_e
.g2_kernel_d_none:
  s_sleep 24
.g2_kernel_d_e:
  v_mov_b32 v6, s71
  s_mov_b64 exec, 1
  ds_add_u32 v6, v5 offset:48
  s_mov_b64 exec, -1
  s_cmp_lg_u32 s62, 0
  s_cbranch_scc1 .g2_kernel_d_t
  s_mov_b32 s62, 1
  s_mov_b32 s63, 0x1800000
  s_mov_b32 s70, 2
  s_mov_b32 s71, 155776
  s_branch .g2_kernel_v
.g2_kernel_d_t:
  s_cmp_lg_u32 s20, 0
  s_cbranch_scc1 .g2_kernel_d_t1
  v_mov_b32 v62, -1.4426950408889634
  v_mul_f32 v62, s27, v62
  v_exp_f32 v62, v62
  v_lshlrev_b32 v14, 12, v2
  v_min_u32 v15, 126976, v14
  s_lshl_b32 s21, s17, 4
  s_add_u32 s21, s21, s18
  s_lshl_b32 s21, s21, 4
  s_mul_i32 s22, s32, 0x270000
  s_add_u32 s21, s21, s22
  s_add_u32 s21, s21, 0x2890000
  s_add_u32 s22, s21, 262144
  s_add_u32 s24, s21, 524288
  s_add_u32 s25, s21, 786432
  v_add_f32 v62, 1.0, v62
  v_rcp_f32 v62, v62
  v_lshlrev_b32 v56, 16, v56
  v_fma_f32 v56, v56, v61, -v60
  v_lshlrev_b32 v57, 16, v57
  v_fma_f32 v57, v57, v61, -v60
  v_lshlrev_b32 v58, 16, v58
  v_fma_f32 v58, v58, v61, -v60
  v_lshlrev_b32 v59, 16, v59
  v_fma_f32 v59, v59, v61, -v60
  s_sleep 8
  s_mov_b32 s38, 0
.g2_kernel_gx61:
  buffer_load_dwordx4 v[16:19], v14, s[4:7], s21 offen sc1
  buffer_load_dwordx4 v[20:23], v14, s[4:7], s22 offen sc1
  buffer_load_dwordx4 v[24:27], v14, s[4:7], s24 offen sc1
  buffer_load_dwordx4 v[28:31], v15, s[4:7], s25 offen sc1
  s_add_u32 s38, s38, 1
  s_waitcnt vmcnt(0)
  v_min3_u32 v6, v16, v18, v20
  v_min3_u32 v6, v6, v22, v24
  v_min3_u32 v6, v6, v26, v28
  v_min_u32 v6, v6, v30
  v_cmp_eq_u32 vcc, 0, v6
  s_cbranch_vccz .g2_kernel_gx61d
  s_mov_b64 exec, vcc
  s_cmp_lt_u32 s38, 131072
  s_cbranch_scc1 .g2_kernel_gx61
.g2_kernel_gx61d:
  s_mov_b64 exec, -1
  v_add_f32 v16, v16, v20
  v_add_f32 v17, v17, v21
  v_add_f32 v18, v18, v22
  v_add_f32 v19, v19, v23
  s_mov_b32 exec_hi, 0
  v_add_f32 v24, v24, v28
  v_add_f32 v25, v25, v29
  v_add_f32 v26, v26, v30
  v_add_f32 v27, v27, v31
  s_mov_b64 exec, -1
  v_add_f32 v16, v16, v24
  v_add_f32 v17, v17, v25
  v_add_f32 v18, v18, v26
  v_add_f32 v19, v19, v27
  v_add_f32 v16, v16, v16 row_ror:8 row_mask:0xf bank_mask:0xf
  v_add_f32 v17, v17, v17 row_ror:8 row_mask:0xf bank_mask:0xf
  v_add_f32 v18, v18, v18 row_ror:8 row_mask:0xf bank_mask:0xf
  v_add_f32 v19, v19, v19 row_ror:8 row_mask:0xf bank_mask:0xf
  v_add_f32 v16, v16, v16 row_ror:4 row_mask:0xf bank_mask:0xf
  v_add_f32 v17, v17, v17 row_ror:4 row_mask:0xf bank_mask:0xf
  v_add_f32 v18, v18, v18 row_ror:4 row_mask:0xf bank_mask:0xf
  v_add_f32 v19, v19, v19 row_ror:4 row_mask:0xf bank_mask:0xf
  v_add_f32 v16, v16, v16 row_ror:2 row_mask:0xf bank_mask:0xf
  v_add_f32 v17, v17, v17 row_ror:2 row_mask:0xf bank_mask:0xf
  v_add_f32 v18, v18, v18 row_ror:2 row_mask:0xf bank_mask:0xf
  v_add_f32 v19, v19, v19 row_ror:2 row_mask:0xf bank_mask:0xf
  v_add_f32 v16, v16, v16 row_ror:1 row_mask:0xf bank_mask:0xf
  v_add_f32 v17, v17, v17 row_ror:1 row_mask:0xf bank_mask:0xf
  v_add_f32 v18, v18, v18 row_ror:1 row_mask:0xf bank_mask:0xf
  v_add_f32 v19, v19, v19 row_ror:1 row_mask:0xf bank_mask:0xf
  v_add_f32 v16, v16, v16 row_bcast:15 row_mask:0xa bank_mask:0xf
  v_add_f32 v17, v17, v17 row_bcast:15 row_mask:0xa bank_mask:0xf
  v_add_f32 v18, v18, v18 row_bcast:15 row_mask:0xa bank_mask:0xf
  v_add_f32 v19, v19, v19 row_bcast:15 row_mask:0xa bank_mask:0xf
  v_add_f32 v16, v16, v16 row_bcast:31 row_mask:0xc bank_mask:0xf
  v_add_f32 v17, v17, v17 row_bcast:31 row_mask:0xc bank_mask:0xf
  v_add_f32 v18, v18, v18 row_bcast:31 row_mask:0xc bank_mask:0xf
  v_add_f32 v19, v19, v19 row_bcast:31 row_mask:0xc bank_mask:0xf
  s_lshl_b32 s24, s77, 11
  s_lshl_b32 s25, s17, 7
  s_add_u32 s24, s24, s25
  s_lshl_b32 s25, s18, 1
  s_add_u32 s24, s24, s25
.g2_kernel_d_t1:
  v_mov_b32 v6, s71
  s_mov_b32 s38, 0
.g2_kernel_wg62:
  ds_read_b32 v7, v6 offset:88
  s_add_u32 s38, s38, 1
  s_waitcnt lgkmcnt(0)
  v_cmp_le_u32 vcc, 1, v7
  s_cbranch_vccnz .g2_kernel_wg62d
  s_cmp_lt_u32 s38, 524288
  s_cbranch_scc1 .g2_kernel_wg62
.g2_kernel_wg62d:
  ds_read_b32 v6, v6 offset:92
  v_readfirstlane_b32 s33, v7
  s_cmp_lg_u32 s32, 0
  s_cselect_b32 s33, 1, s33
  s_cmp_lg_u32 s20, 0
  s_cbranch_scc1 .g2_kernel_d_t2
  s_cmp_lg_u32 s33, 1
  s_cbranch_scc1 .g2_kernel_d_t4
  v_fmac_f32 v56, v16, v62
  v_fmac_f32 v57, v17, v62
  v_fmac_f32 v58, v18, v62
  v_fmac_f32 v59, v19, v62
.g2_kernel_d_t4:
  s_mov_b32 s28, s56
  s_mov_b32 s29, s57
  s_mov_b32 s30, 0x400000
  s_mov_b32 s31, 0x00020000
  v_cvt_pk_bf16_f32 v56, v56, v57
  v_cvt_pk_bf16_f32 v58, v58, v59
  s_mov_b32 exec_lo, 0
  s_mov_b32 exec_hi, 0x80000000
  buffer_store_short v56, v4, s[28:31], s24 offen
  buffer_store_short_d16_hi v56, v4, s[28:31], s24 offen offset:32
  buffer_store_short v58, v4, s[28:31], s24 offen offset:64
  buffer_store_short_d16_hi v58, v4, s[28:31], s24 offen offset:96
  s_mov_b64 exec, -1
.g2_kernel_d_t2:
  s_cmp_eq_u32 s33, 1
  s_cbranch_scc1 .g2_kernel_fin
  s_waitcnt vmcnt(0) lgkmcnt(0)
  v_readfirstlane_b32 s27, v6
  s_sub_u32 s77, s33, 2
  s_mov_b32 s32, 1
  s_add_u32 s26, s26, 0x270000
  s_branch .g2_kernel_d_r
.g2_kernel_fin1:
.g2_kernel_fin:
.g2_kernel_end:
  s_endpgm
.g2_kernel_q_i2:
  v_mov_b32 v6, 155648
  s_mov_b32 s38, 0
.g2_kernel_wg1:
  ds_read_b32 v7, v6 offset:20
  s_add_u32 s38, s38, 1
  s_waitcnt lgkmcnt(0)
  v_cmp_le_u32 vcc, 4, v7
  s_cbranch_vccnz .g2_kernel_wg1d
  s_cmp_lt_u32 s38, 524288
  s_cbranch_scc1 .g2_kernel_wg1
.g2_kernel_wg1d:
  s_branch .g2_kernel_q_i3
.g2_kernel_q_spin:
  s_mov_b32 s38, 0
.g2_kernel_q_spinl:
  ds_read_b32 v151, v150
  s_add_u32 s38, s38, 1
  s_waitcnt lgkmcnt(0)
  v_cmp_lt_i32 vcc, s33, v151
  s_cbranch_vccnz .g2_kernel_q_spinr
  s_cmp_lt_u32 s38, 524288
  s_cbranch_scc1 .g2_kernel_q_spinl
.g2_kernel_q_spinr:
  s_setpc_b64 s[68:69]
.g2_kernel_q_wf:
  s_call_b64 s[68:69], .g2_kernel_q_spin
  s_branch .g2_kernel_q_backf
.g2_kernel_q_w7:
  s_call_b64 s[68:69], .g2_kernel_q_spin
  s_branch .g2_kernel_q_back7
.g2_kernel_q_w0:
  s_call_b64 s[68:69], .g2_kernel_q_spin
  s_branch .g2_kernel_q_back0
.g2_kernel_q_w1:
  s_call_b64 s[68:69], .g2_kernel_q_spin
  s_branch .g2_kernel_q_back1
.g2_kernel_q_w2:
  s_call_b64 s[68:69], .g2_kernel_q_spin
  s_branch .g2_kernel_q_back2
.g2_kernel_q_w3:
  s_call_b64 s[68:69], .g2_kernel_q_spin
  s_branch .g2_kernel_q_back3
.g2_kernel_q_w4:
  s_call_b64 s[68:69], .g2_kernel_q_spin
  s_branch .g2_kernel_q_back4
.g2_kernel_q_w5:
  s_call_b64 s[68:69], .g2_kernel_q_spin
  s_branch .g2_kernel_q_back5
.g2_kernel_q_w6:
  s_call_b64 s[68:69], .g2_kernel_q_spin
  s_branch .g2_kernel_q_back6
.g2_kernel_q_cons2:
  s_lshr_b32 s26, s16, 1
  s_lshl_b32 s26, s26, 13
  v_add_u32 v144, s26, v3
  v_add_u32 v145, 1024, v144
  s_branch .g2_kernel_q_cs
.g2_kernel_q_ew:
  s_mov_b32 s38, 0
.g2_kernel_q_ewl:
  ds_read_b32 v62, v13 offset:0
  ds_read_b32 v63, v58
  s_add_u32 s38, s38, 1
  s_waitcnt lgkmcnt(0)
  v_cmp_gt_u32 vcc, 2, v62
  v_cmp_gt_u32 s[14:15], s12, v63
  s_or_b64 vcc, vcc, s[14:15]
  s_cbranch_scc0 .g2_kernel_q_ec
  s_cmp_lt_u32 s38, 524288
  s_cbranch_scc1 .g2_kernel_q_ewl
.g2_kernel_q_ec:
  ds_read_b32 v57, v13 offset:24
  ds_read_b32 v21, v13 offset:84
  ds_read_b128 v[40:43], v52 offset:5120
  ds_read_b128 v[44:47], v52 offset:5184
  ds_read_b32 v24, v50 offset:2816
  ds_read_b32 v25, v50 offset:3328
  ds_read_b32 v26, v50 offset:2880
  ds_read_b32 v27, v50 offset:3392
  ds_read_b32 v28, v50 offset:2944
  ds_read_b32 v29, v50 offset:3456
  ds_read_b32 v30, v50 offset:3008
  ds_read_b32 v31, v50 offset:3520
  ds_read_b128 v[64:67], v51 offset:2816
  ds_read_b128 v[80:83], v51 offset:3328
  ds_read_b128 v[68:71], v51 offset:2880
  ds_read_b128 v[84:87], v51 offset:3392
  ds_read_b128 v[72:75], v51 offset:2944
  ds_read_b128 v[88:91], v51 offset:3456
  ds_read_b128 v[76:79], v51 offset:3008
  ds_read_b128 v[92:95], v51 offset:3520
  ds_read_b32 v48, v53 offset:5376
  ds_read_b32 v49, v53 offset:5440
  ds_read_b128 v[32:35], v52 offset:4864
  ds_read_b128 v[36:39], v52 offset:4928
  s_waitcnt lgkmcnt(0)
  s_branch .g2_kernel_q_eb
.g2_kernel_q_patch:
  v_readfirstlane_b32 s35, v57
  s_sub_u32 s28, s35, 1
  s_lshr_b32 s29, s28, 6
  s_lshr_b32 s30, s16, 1
  s_add_u32 s35, s35, 0x100
  s_cmp_lg_u32 s29, s30
  s_cbranch_scc1 .g2_kernel_q_pback
  s_add_u32 s35, s35, 0x100
  s_mov_b32 s77, 0x40000000
  s_and_b32 s29, s28, 15
  s_mov_b32 s14, 0x00010001
  s_mov_b32 s15, 0x00010001
  s_lshl_b64 s[14:15], s[14:15], s29
  s_and_b32 s29, s28, 12
  s_lshl_b32 s29, s29, 2
  s_lshl_b64 s[30:31], 0xffff, s29
  v_subrev_u32 v96, 155648, v53
  v_lshlrev_b32 v96, 2, v96
  v_add_u32 v96, 155648, v96
  s_bfe_u32 s29, s28, 0x20004
  s_cmp_lg_u32 s29, 0
  s_cbranch_scc1 .g2_kernel_q_pv1
  s_mov_b64 exec, s[14:15]
  ds_write_b128 v52, v[160:163] offset:5632
  ds_write_b128 v52, v[176:179] offset:5696
  ds_write_b128 v52, v[192:195] offset:5888
  ds_write_b128 v52, v[208:211] offset:5952
  s_mov_b64 exec, s[30:31]
  ds_write_b128 v96, v[224:227] offset:6144
  ds_write_b128 v96, v[240:243] offset:6400
  s_mov_b64 exec, -1
  s_waitcnt lgkmcnt(0)
  s_branch .g2_kernel_q_pback
.g2_kernel_q_pv1:
  s_cmp_lg_u32 s29, 1
  s_cbranch_scc1 .g2_kernel_q_pv2
  s_mov_b64 exec, s[14:15]
  ds_write_b128 v52, v[164:167] offset:5632
  ds_write_b128 v52, v[180:183] offset:5696
  ds_write_b128 v52, v[196:199] offset:5888
  ds_write_b128 v52, v[212:215] offset:5952
  s_mov_b64 exec, s[30:31]
  ds_write_b128 v96, v[228:231] offset:6144
  ds_write_b128 v96, v[244:247] offset:6400
  s_mov_b64 exec, -1
  s_waitcnt lgkmcnt(0)
  s_branch .g2_kernel_q_pback
.g2_kernel_q_pv2:
  s_cmp_lg_u32 s29, 2
  s_cbranch_scc1 .g2_kernel_q_pv3
  s_mov_b64 exec, s[14:15]
  ds_write_b128 v52, v[168:171] offset:5632
  ds_write_b128 v52, v[184:187] offset:5696
  ds_write_b128 v52, v[200:203] offset:5888
  ds_write_b128 v52, v[216:219] offset:5952
  s_mov_b64 exec, s[30:31]
  ds_write_b128 v96, v[232:235] offset:6144
  ds_write_b128 v96, v[248:251] offset:6400
  s_mov_b64 exec, -1
  s_waitcnt lgkmcnt(0)
  s_branch .g2_kernel_q_pback
.g2_kernel_q_pv3:
  s_mov_b64 exec, s[14:15]
  ds_write_b128 v52, v[172:175] offset:5632
  ds_write_b128 v52, v[188:191] offset:5696
  ds_write_b128 v52, v[204:207] offset:5888
  ds_write_b128 v52, v[220:223] offset:5952
  s_mov_b64 exec, s[30:31]
  ds_write_b128 v96, v[236:239] offset:6144
  ds_write_b128 v96, v[252:255] offset:6400
  s_mov_b64 exec, -1
  s_waitcnt lgkmcnt(0)
  s_branch .g2_kernel_q_pback
.g2_kernel_q_nk:
  v_pk_mul_f32 v[152:153], v[40:41], v[24:25] op_sel:[0,1] op_sel_hi:[1,1]
  v_pk_mul_f32 v[154:155], v[42:43], v[24:25] op_sel:[0,1] op_sel_hi:[1,1]
  v_pk_mul_f32 v[156:157], v[44:45], v[24:25] op_sel:[0,1] op_sel_hi:[1,1]
  v_pk_mul_f32 v[158:159], v[46:47], v[24:25] op_sel:[0,1] op_sel_hi:[1,1]
  v_pk_fma_f32 v[192:193], v[192:193], v[24:25], v[152:153] op_sel_hi:[1,0,1]
  v_pk_fma_f32 v[194:195], v[194:195], v[24:25], v[154:155] op_sel_hi:[1,0,1]
  v_pk_fma_f32 v[208:209], v[208:209], v[24:25], v[156:157] op_sel_hi:[1,0,1]
  v_pk_fma_f32 v[210:211], v[210:211], v[24:25], v[158:159] op_sel_hi:[1,0,1]
  v_cvt_pk_bf16_f32 v192, v192, v193
  v_cvt_pk_bf16_f32 v193, v194, v195
  v_cvt_pk_bf16_f32 v194, v208, v209
  v_cvt_pk_bf16_f32 v195, v210, v211
  ds_write_b128 v59, v[192:195] offset:0
  v_pk_mul_f32 v[152:153], v[40:41], v[26:27] op_sel:[0,1] op_sel_hi:[1,1]
  v_pk_mul_f32 v[154:155], v[42:43], v[26:27] op_sel:[0,1] op_sel_hi:[1,1]
  v_pk_mul_f32 v[156:157], v[44:45], v[26:27] op_sel:[0,1] op_sel_hi:[1,1]
  v_pk_mul_f32 v[158:159], v[46:47], v[26:27] op_sel:[0,1] op_sel_hi:[1,1]
  v_pk_fma_f32 v[196:197], v[196:197], v[26:27], v[152:153] op_sel_hi:[1,0,1]
  v_pk_fma_f32 v[198:199], v[198:199], v[26:27], v[154:155] op_sel_hi:[1,0,1]
  v_pk_fma_f32 v[212:213], v[212:213], v[26:27], v[156:157] op_sel_hi:[1,0,1]
  v_pk_fma_f32 v[214:215], v[214:215], v[26:27], v[158:159] op_sel_hi:[1,0,1]
  v_cvt_pk_bf16_f32 v196, v196, v197
  v_cvt_pk_bf16_f32 v197, v198, v199
  v_cvt_pk_bf16_f32 v198, v212, v213
  v_cvt_pk_bf16_f32 v199, v214, v215
  ds_write_b128 v59, v[196:199] offset:128
  v_pk_mul_f32 v[152:153], v[40:41], v[28:29] op_sel:[0,1] op_sel_hi:[1,1]
  v_pk_mul_f32 v[154:155], v[42:43], v[28:29] op_sel:[0,1] op_sel_hi:[1,1]
  v_pk_mul_f32 v[156:157], v[44:45], v[28:29] op_sel:[0,1] op_sel_hi:[1,1]
  v_pk_mul_f32 v[158:159], v[46:47], v[28:29] op_sel:[0,1] op_sel_hi:[1,1]
  v_pk_fma_f32 v[200:201], v[200:201], v[28:29], v[152:153] op_sel_hi:[1,0,1]
  v_pk_fma_f32 v[202:203], v[202:203], v[28:29], v[154:155] op_sel_hi:[1,0,1]
  v_pk_fma_f32 v[216:217], v[216:217], v[28:29], v[156:157] op_sel_hi:[1,0,1]
  v_pk_fma_f32 v[218:219], v[218:219], v[28:29], v[158:159] op_sel_hi:[1,0,1]
  v_cvt_pk_bf16_f32 v200, v200, v201
  v_cvt_pk_bf16_f32 v201, v202, v203
  v_cvt_pk_bf16_f32 v202, v216, v217
  v_cvt_pk_bf16_f32 v203, v218, v219
  ds_write_b128 v59, v[200:203] offset:4096
  v_pk_mul_f32 v[152:153], v[40:41], v[30:31] op_sel:[0,1] op_sel_hi:[1,1]
  v_pk_mul_f32 v[154:155], v[42:43], v[30:31] op_sel:[0,1] op_sel_hi:[1,1]
  v_pk_mul_f32 v[156:157], v[44:45], v[30:31] op_sel:[0,1] op_sel_hi:[1,1]
  v_pk_mul_f32 v[158:159], v[46:47], v[30:31] op_sel:[0,1] op_sel_hi:[1,1]
  v_pk_fma_f32 v[204:205], v[204:205], v[30:31], v[152:153] op_sel_hi:[1,0,1]
  v_pk_fma_f32 v[206:207], v[206:207], v[30:31], v[154:155] op_sel_hi:[1,0,1]
  v_pk_fma_f32 v[220:221], v[220:221], v[30:31], v[156:157] op_sel_hi:[1,0,1]
  v_pk_fma_f32 v[222:223], v[222:223], v[30:31], v[158:159] op_sel_hi:[1,0,1]
  v_cvt_pk_bf16_f32 v204, v204, v205
  v_cvt_pk_bf16_f32 v205, v206, v207
  v_cvt_pk_bf16_f32 v206, v220, v221
  v_cvt_pk_bf16_f32 v207, v222, v223
  ds_write_b128 v59, v[204:207] offset:4224
  v_pk_mul_f32 v[152:153], v[80:81], v[48:49] op_sel:[0,0] op_sel_hi:[1,0]
  v_pk_mul_f32 v[154:155], v[82:83], v[48:49] op_sel:[0,0] op_sel_hi:[1,0]
  v_pk_mul_f32 v[156:157], v[84:85], v[48:49] op_sel:[0,0] op_sel_hi:[1,0]
  v_pk_mul_f32 v[158:159], v[86:87], v[48:49] op_sel:[0,0] op_sel_hi:[1,0]
  v_pk_fma_f32 v[224:225], v[224:225], v[64:65], v[152:153]
  v_pk_fma_f32 v[226:227], v[226:227], v[66:67], v[154:155]
  v_pk_fma_f32 v[228:229], v[228:229], v[68:69], v[156:157]
  v_pk_fma_f32 v[230:231], v[230:231], v[70:71], v[158:159]
  v_cvt_pk_bf16_f32 v224, v224, v225
  v_cvt_pk_bf16_f32 v225, v226, v227
  v_cvt_pk_bf16_f32 v226, v228, v229
  v_cvt_pk_bf16_f32 v227, v230, v231
  ds_write_b128 v60, v[224:227] offset:2048
  v_pk_mul_f32 v[152:153], v[80:81], v[48:49] op_sel:[0,1] op_sel_hi:[1,1]
  v_pk_mul_f32 v[154:155], v[82:83], v[48:49] op_sel:[0,1] op_sel_hi:[1,1]
  v_pk_mul_f32 v[156:157], v[84:85], v[48:49] op_sel:[0,1] op_sel_hi:[1,1]
  v_pk_mul_f32 v[158:159], v[86:87], v[48:49] op_sel:[0,1] op_sel_hi:[1,1]
  v_pk_fma_f32 v[240:241], v[240:241], v[64:65], v[152:153]
  v_pk_fma_f32 v[242:243], v[242:243], v[66:67], v[154:155]
  v_pk_fma_f32 v[244:245], v[244:245], v[68:69], v[156:157]
  v_pk_fma_f32 v[246:247], v[246:247], v[70:71], v[158:159]
  v_cvt_pk_bf16_f32 v240, v240, v241
  v_cvt_pk_bf16_f32 v241, v242, v243
  v_cvt_pk_bf16_f32 v242, v244, v245
  v_cvt_pk_bf16_f32 v243, v246, v247
  ds_write_b128 v60, v[240:243] offset:2304
  v_pk_mul_f32 v[152:153], v[88:89], v[48:49] op_sel:[0,0] op_sel_hi:[1,0]
  v_pk_mul_f32 v[154:155], v[90:91], v[48:49] op_sel:[0,0] op_sel_hi:[1,0]
  v_pk_mul_f32 v[156:157], v[92:93], v[48:49] op_sel:[0,0] op_sel_hi:[1,0]
  v_pk_mul_f32 v[158:159], v[94:95], v[48:49] op_sel:[0,0] op_sel_hi:[1,0]
  v_pk_fma_f32 v[232:233], v[232:233], v[72:73], v[152:153]
  v_pk_fma_f32 v[234:235], v[234:235], v[74:75], v[154:155]
  v_pk_fma_f32 v[236:237], v[236:237], v[76:77], v[156:157]
  v_pk_fma_f32 v[238:239], v[238:239], v[78:79], v[158:159]
  v_cvt_pk_bf16_f32 v232, v232, v233
  v_cvt_pk_bf16_f32 v233, v234, v235
  v_cvt_pk_bf16_f32 v234, v236, v237
  v_cvt_pk_bf16_f32 v235, v238, v239
  ds_write_b128 v60, v[232:235] offset:6144
  v_pk_mul_f32 v[152:153], v[88:89], v[48:49] op_sel:[0,1] op_sel_hi:[1,1]
  v_pk_mul_f32 v[154:155], v[90:91], v[48:49] op_sel:[0,1] op_sel_hi:[1,1]
  v_pk_mul_f32 v[156:157], v[92:93], v[48:49] op_sel:[0,1] op_sel_hi:[1,1]
  v_pk_mul_f32 v[158:159], v[94:95], v[48:49] op_sel:[0,1] op_sel_hi:[1,1]
  v_pk_fma_f32 v[248:249], v[248:249], v[72:73], v[152:153]
  v_pk_fma_f32 v[250:251], v[250:251], v[74:75], v[154:155]
  v_pk_fma_f32 v[252:253], v[252:253], v[76:77], v[156:157]
  v_pk_fma_f32 v[254:255], v[254:255], v[78:79], v[158:159]
  v_cvt_pk_bf16_f32 v248, v248, v249
  v_cvt_pk_bf16_f32 v249, v250, v251
  v_cvt_pk_bf16_f32 v250, v252, v253
  v_cvt_pk_bf16_f32 v251, v254, v255
  ds_write_b128 v60, v[248:251] offset:6400
  v_pk_mul_f32 v[24:25], v[24:25], v[56:57] op_sel_hi:[1,0]
  v_pk_mul_f32 v[26:27], v[26:27], v[56:57] op_sel_hi:[1,0]
  v_pk_mul_f32 v[28:29], v[28:29], v[56:57] op_sel_hi:[1,0]
  v_pk_mul_f32 v[30:31], v[30:31], v[56:57] op_sel_hi:[1,0]
  v_pk_mul_f32 v[152:153], v[32:33], v[24:25] op_sel:[0,1] op_sel_hi:[1,1]
  v_pk_mul_f32 v[154:155], v[34:35], v[24:25] op_sel:[0,1] op_sel_hi:[1,1]
  v_pk_mul_f32 v[156:157], v[36:37], v[24:25] op_sel:[0,1] op_sel_hi:[1,1]
  v_pk_mul_f32 v[158:159], v[38:39], v[24:25] op_sel:[0,1] op_sel_hi:[1,1]
  v_pk_fma_f32 v[160:161], v[160:161], v[24:25], v[152:153] op_sel_hi:[1,0,1]
  v_pk_fma_f32 v[162:163], v[162:163], v[24:25], v[154:155] op_sel_hi:[1,0,1]
  v_pk_fma_f32 v[176:177], v[176:177], v[24:25], v[156:157] op_sel_hi:[1,0,1]
  v_pk_fma_f32 v[178:179], v[178:179], v[24:25], v[158:159] op_sel_hi:[1,0,1]
  v_cvt_pk_bf16_f32 v160, v160, v161
  v_cvt_pk_bf16_f32 v161, v162, v163
  v_cvt_pk_bf16_f32 v162, v176, v177
  v_cvt_pk_bf16_f32 v163, v178, v179
  ds_write_b128 v61, v[160:163] offset:0
  v_pk_mul_f32 v[152:153], v[32:33], v[26:27] op_sel:[0,1] op_sel_hi:[1,1]
  v_pk_mul_f32 v[154:155], v[34:35], v[26:27] op_sel:[0,1] op_sel_hi:[1,1]
  v_pk_mul_f32 v[156:157], v[36:37], v[26:27] op_sel:[0,1] op_sel_hi:[1,1]
  v_pk_mul_f32 v[158:159], v[38:39], v[26:27] op_sel:[0,1] op_sel_hi:[1,1]
  v_pk_fma_f32 v[164:165], v[164:165], v[26:27], v[152:153] op_sel_hi:[1,0,1]
  v_pk_fma_f32 v[166:167], v[166:167], v[26:27], v[154:155] op_sel_hi:[1,0,1]
  v_pk_fma_f32 v[180:181], v[180:181], v[26:27], v[156:157] op_sel_hi:[1,0,1]
  v_pk_fma_f32 v[182:183], v[182:183], v[26:27], v[158:159] op_sel_hi:[1,0,1]
  v_cvt_pk_bf16_f32 v164, v164, v165
  v_cvt_pk_bf16_f32 v165, v166, v167
  v_cvt_pk_bf16_f32 v166, v180, v181
  v_cvt_pk_bf16_f32 v167, v182, v183
  ds_write_b128 v61, v[164:167] offset:256
  v_pk_mul_f32 v[152:153], v[32:33], v[28:29] op_sel:[0,1] op_sel_hi:[1,1]
  v_pk_mul_f32 v[154:155], v[34:35], v[28:29] op_sel:[0,1] op_sel_hi:[1,1]
  v_pk_mul_f32 v[156:157], v[36:37], v[28:29] op_sel:[0,1] op_sel_hi:[1,1]
  v_pk_mul_f32 v[158:159], v[38:39], v[28:29] op_sel:[0,1] op_sel_hi:[1,1]
  v_pk_fma_f32 v[168:169], v[168:169], v[28:29], v[152:153] op_sel_hi:[1,0,1]
  v_pk_fma_f32 v[170:171], v[170:171], v[28:29], v[154:155] op_sel_hi:[1,0,1]
  v_pk_fma_f32 v[184:185], v[184:185], v[28:29], v[156:157] op_sel_hi:[1,0,1]
  v_pk_fma_f32 v[186:187], v[186:187], v[28:29], v[158:159] op_sel_hi:[1,0,1]
  v_cvt_pk_bf16_f32 v168, v168, v169
  v_cvt_pk_bf16_f32 v169, v170, v171
  v_cvt_pk_bf16_f32 v170, v184, v185
  v_cvt_pk_bf16_f32 v171, v186, v187
  ds_write_b128 v61, v[168:171] offset:2048
  v_pk_mul_f32 v[152:153], v[32:33], v[30:31] op_sel:[0,1] op_sel_hi:[1,1]
  v_pk_mul_f32 v[154:155], v[34:35], v[30:31] op_sel:[0,1] op_sel_hi:[1,1]
  v_pk_mul_f32 v[156:157], v[36:37], v[30:31] op_sel:[0,1] op_sel_hi:[1,1]
  v_pk_mul_f32 v[158:159], v[38:39], v[30:31] op_sel:[0,1] op_sel_hi:[1,1]
  v_pk_fma_f32 v[172:173], v[172:173], v[30:31], v[152:153] op_sel_hi:[1,0,1]
  v_pk_fma_f32 v[174:175], v[174:175], v[30:31], v[154:155] op_sel_hi:[1,0,1]
  v_pk_fma_f32 v[188:189], v[188:189], v[30:31], v[156:157] op_sel_hi:[1,0,1]
  v_pk_fma_f32 v[190:191], v[190:191], v[30:31], v[158:159] op_sel_hi:[1,0,1]
  v_cvt_pk_bf16_f32 v172, v172, v173
  v_cvt_pk_bf16_f32 v173, v174, v175
  v_cvt_pk_bf16_f32 v174, v188, v189
  v_cvt_pk_bf16_f32 v175, v190, v191
  ds_write_b128 v61, v[172:175] offset:2304
  s_add_u32 s37, s37, 32
  s_and_b32 s35, s35, 0x1ff
  s_cmp_lg_u32 s35, 0
  s_cselect_b32 s28, 0x100, 0
  s_or_b32 s35, s35, s28
  s_branch .g2_kernel_q_kd
.g2_kernel_r2:
  buffer_load_dwordx4 v[240:243], v22, s[4:7], s13 offen offset:0
  buffer_load_dwordx4 v[244:247], v22, s[4:7], s13 offen offset:512
  buffer_load_dwordx4 v[248:251], v22, s[4:7], s13 offen offset:1024
  buffer_load_dwordx4 v[252:255], v22, s[4:7], s13 offen offset:1536
  s_branch .g2_kernel_r3
.g2_kernel_a_t1c:
  s_call_b64 s[68:69], .g2_kernel_a_pick
  s_branch .g2_kernel_a_t1b
.g2_kernel_a_t2c:
  s_call_b64 s[68:69], .g2_kernel_a_pick
  s_branch .g2_kernel_a_t2b
.g2_kernel_a_t3c:
  s_call_b64 s[68:69], .g2_kernel_a_pick
  s_branch .g2_kernel_a_t3b
.g2_kernel_a_three:
  s_andn2_b32 s33, s36, s34
  s_cbranch_scc0 .g2_kernel_a_t1c
.g2_kernel_a_t1b:
  s_ff1_i32_b32 s33, s33
  s_bitset1_b32 s34, s33
  s_xor_b32 s33, s33, s24
  s_lshl_b32 s33, s33, s25
  s_add_u32 s22, s20, s33
  s_addc_u32 s23, s21, 0
  global_load_dwordx4 v[192:195], v3, s[22:23] offset:0
  global_load_dwordx4 v[196:199], v3, s[22:23] offset:1024
  global_load_dwordx4 v[200:203], v3, s[22:23] offset:2048
  global_load_dwordx4 v[204:207], v3, s[22:23] offset:3072
  s_andn2_b32 s33, s36, s34
  s_cbranch_scc0 .g2_kernel_a_t2c
.g2_kernel_a_t2b:
  s_ff1_i32_b32 s33, s33
  s_bitset1_b32 s34, s33
  s_xor_b32 s33, s33, s24
  s_lshl_b32 s33, s33, s25
  s_add_u32 s22, s20, s33
  s_addc_u32 s23, s21, 0
  global_load_dwordx4 v[208:211], v3, s[22:23] offset:0
  global_load_dwordx4 v[212:215], v3, s[22:23] offset:1024
  global_load_dwordx4 v[216:219], v3, s[22:23] offset:2048
  global_load_dwordx4 v[220:223], v3, s[22:23] offset:3072
  s_andn2_b32 s33, s36, s34
  s_cbranch_scc0 .g2_kernel_a_t3c
.g2_kernel_a_t3b:
  s_ff1_i32_b32 s33, s33
  s_bitset1_b32 s34, s33
  s_xor_b32 s33, s33, s24
  s_lshl_b32 s33, s33, s25
  s_add_u32 s22, s20, s33
  s_addc_u32 s23, s21, 0
  global_load_dwordx4 v[224:227], v3, s[22:23] offset:0
  global_load_dwordx4 v[228:231], v3, s[22:23] offset:1024
  global_load_dwordx4 v[232:235], v3, s[22:23] offset:2048
  global_load_dwordx4 v[236:239], v3, s[22:23] offset:3072
  s_setpc_b64 s[72:73]
.g2_kernel_a_o0c:
  s_call_b64 s[68:69], .g2_kernel_a_pick
  s_branch .g2_kernel_a_o0b
.g2_kernel_a_o1c:
  s_call_b64 s[68:69], .g2_kernel_a_pick
  s_branch .g2_kernel_a_o1b
.g2_kernel_a_o2c:
  s_call_b64 s[68:69], .g2_kernel_a_pick
  s_branch .g2_kernel_a_o2b
.g2_kernel_a_o3c:
  s_call_b64 s[68:69], .g2_kernel_a_pick
  s_branch .g2_kernel_a_o3b
.g2_kernel_a_r0c:
  s_call_b64 s[68:69], .g2_kernel_a_pick
  s_branch .g2_kernel_a_r0b
.g2_kernel_a_r1c:
  s_call_b64 s[68:69], .g2_kernel_a_pick
  s_branch .g2_kernel_a_r1b
.g2_kernel_a_r2c:
  s_call_b64 s[68:69], .g2_kernel_a_pick
  s_branch .g2_kernel_a_r2b
.g2_kernel_a_own:
  s_waitcnt vmcnt(0) lgkmcnt(0)
  s_mov_b64 exec, 1
  s_cmp_ge_u32 s35, 0x200
  s_cbranch_scc1 .g2_kernel_a_ow1
  buffer_store_dword v15, v4, s[4:7], s37 offen sc1
  s_branch .g2_kernel_a_ow2
.g2_kernel_a_ow1:
  ds_add_u32 v13, v5 offset:56
.g2_kernel_a_ow2:
  s_mov_b64 exec, -1
  s_add_u32 s37, s37, 64
  s_mov_b32 s14, 0
  s_andn2_b32 s33, s36, s34
  s_cbranch_scc0 .g2_kernel_a_o0c
.g2_kernel_a_o0b:
  s_ff1_i32_b32 s33, s33
  s_bitset1_b32 s34, s33
  s_lshl_b32 s28, s33, 0
  s_or_b32 s14, s14, s28
  s_xor_b32 s33, s33, s24
  s_lshl_b32 s33, s33, s25
  s_add_u32 s22, s20, s33
  s_addc_u32 s23, s21, 0
  global_load_dwordx4 v[176:179], v3, s[22:23] offset:0
  global_load_dwordx4 v[180:183], v3, s[22:23] offset:1024
  global_load_dwordx4 v[184:187], v3, s[22:23] offset:2048
  global_load_dwordx4 v[188:191], v3, s[22:23] offset:3072
  s_andn2_b32 s33, s36, s34
  s_cbranch_scc0 .g2_kernel_a_o1c
.g2_kernel_a_o1b:
  s_ff1_i32_b32 s33, s33
  s_bitset1_b32 s34, s33
  s_lshl_b32 s28, s33, 8
  s_or_b32 s14, s14, s28
  s_xor_b32 s33, s33, s24
  s_lshl_b32 s33, s33, s25
  s_add_u32 s22, s20, s33
  s_addc_u32 s23, s21, 0
  global_load_dwordx4 v[192:195], v3, s[22:23] offset:0
  global_load_dwordx4 v[196:199], v3, s[22:23] offset:1024
  global_load_dwordx4 v[200:203], v3, s[22:23] offset:2048
  global_load_dwordx4 v[204:207], v3, s[22:23] offset:3072
  s_andn2_b32 s33, s36, s34
  s_cbranch_scc0 .g2_kernel_a_o2c
.g2_kernel_a_o2b:
  s_ff1_i32_b32 s33, s33
  s_bitset1_b32 s34, s33
  s_lshl_b32 s28, s33, 16
  s_or_b32 s14, s14, s28
  s_xor_b32 s33, s33, s24
  s_lshl_b32 s33, s33, s25
  s_add_u32 s22, s20, s33
  s_addc_u32 s23, s21, 0
  global_load_dwordx4 v[208:211], v3, s[22:23] offset:0
  global_load_dwordx4 v[212:215], v3, s[22:23] offset:1024
  global_load_dwordx4 v[216:219], v3, s[22:23] offset:2048
  global_load_dwordx4 v[220:223], v3, s[22:23] offset:3072
  s_andn2_b32 s33, s36, s34
  s_cbranch_scc0 .g2_kernel_a_o3c
.g2_kernel_a_o3b:
  s_ff1_i32_b32 s33, s33
  s_bitset1_b32 s34, s33
  s_lshl_b32 s28, s33, 24
  s_or_b32 s14, s14, s28
  s_xor_b32 s33, s33, s24
  s_lshl_b32 s33, s33, s25
  s_add_u32 s22, s20, s33
  s_addc_u32 s23, s21, 0
  global_load_dwordx4 v[224:227], v3, s[22:23] offset:0
  global_load_dwordx4 v[228:231], v3, s[22:23] offset:1024
  global_load_dwordx4 v[232:235], v3, s[22:23] offset:2048
  global_load_dwordx4 v[236:239], v3, s[22:23] offset:3072
  s_and_b32 s15, s34, -2
  s_mov_b32 s34, -1
  s_mov_b32 s26, -1
  s_waitcnt vmcnt(12)
  s_branch .g2_kernel_a_ob
.g2_kernel_a_redo:
  v_mfma_f32_32x32x16_bf16 v[104:119], v[236:239], v[172:175], v[104:119]
  v_smfmac_f32_16x16x64_bf16 v[132:135], v[16:19], v[168:175], v20
  v_mov_b32 v6, s71
  s_mov_b32 s38, 0
.g2_kernel_wg3:
  ds_read_b32 v7, v6 offset:60
  s_add_u32 s38, s38, 1
  s_waitcnt lgkmcnt(0)
  v_cmp_le_u32 vcc, 1, v7
  s_cbranch_vccnz .g2_kernel_wg3d
  s_sleep 1
  s_cmp_lt_u32 s38, 524288
  s_cbranch_scc1 .g2_kernel_wg3
.g2_kernel_wg3d:
  ds_read_b32 v7, v8
  s_mov_b32 s34, s15
  s_mov_b32 s26, 0
  s_waitcnt lgkmcnt(0)
  v_cmp_lt_u32 vcc, s62, v7
  s_mov_b32 s36, vcc_lo
  s_sub_u32 s28, s35, 1
  s_bfe_u32 s28, s28, 0x20005
  s_mov_b32 s35, 0
  s_waitcnt vmcnt(0)
  s_cmp_lg_u32 s28, 0
  s_cbranch_scc1 .g2_kernel_a_rd1
  ds_read_b128 v[24:27], v14 offset:8192
  ds_read_b128 v[28:31], v14 offset:9216
  v_mov_b32 v120, 0
  v_mov_b32 v121, 0
  s_waitcnt lgkmcnt(0)
  v_mfma_f32_32x32x16_bf16 v[136:151], v[176:179], v[24:27], 0
  v_mfma_f32_32x32x16_bf16 v[136:151], v[180:183], v[28:31], v[136:151]
  v_mfma_f32_32x32x16_bf16 v[152:167], v[192:195], v[24:27], 0
  s_nop 10
  v_exp_f32 v136, v136
  v_exp_f32 v137, v137
  v_exp_f32 v138, v138
  v_exp_f32 v139, v139
  v_exp_f32 v140, v140
  v_exp_f32 v141, v141
  v_exp_f32 v142, v142
  v_exp_f32 v143, v143
  v_mfma_f32_32x32x16_bf16 v[152:167], v[196:199], v[28:31], v[152:167]
  v_cvt_pk_bf16_f32 v168, v136, v137
  v_cvt_pk_bf16_f32 v169, v138, v139
  v_cvt_pk_bf16_f32 v170, v140, v141
  v_cvt_pk_bf16_f32 v171, v142, v143
  v_exp_f32 v144, v144
  v_exp_f32 v145, v145
  v_exp_f32 v146, v146
  v_exp_f32 v147, v147
  v_mfma_f32_32x32x16_bf16 v[56:71], v[184:187], v[168:171], 0
  v_exp_f32 v148, v148
  v_exp_f32 v149, v149
  v_exp_f32 v150, v150
  v_exp_f32 v151, v151
  v_cvt_pk_bf16_f32 v172, v144, v145
  v_cvt_pk_bf16_f32 v173, v146, v147
  v_cvt_pk_bf16_f32 v174, v148, v149
  v_cvt_pk_bf16_f32 v175, v150, v151
  v_mfma_f32_32x32x16_bf16 v[136:151], v[208:211], v[24:27], 0
  v_exp_f32 v152, v152
  v_exp_f32 v153, v153
  v_exp_f32 v154, v154
  v_mfma_f32_32x32x16_bf16 v[56:71], v[188:191], v[172:175], v[56:71]
  s_call_b64 s[72:73], .g2_kernel_a_ld0
  v_exp_f32 v155, v155
  v_exp_f32 v156, v156
  v_exp_f32 v157, v157
  v_smfmac_f32_16x16x64_bf16 v[120:123], v[16:19], v[168:175], v20
  v_exp_f32 v158, v158
  v_exp_f32 v159, v159
  v_mfma_f32_32x32x16_bf16 v[136:151], v[212:215], v[28:31], v[136:151]
  v_cvt_pk_bf16_f32 v168, v152, v153
  v_cvt_pk_bf16_f32 v169, v154, v155
  v_cvt_pk_bf16_f32 v170, v156, v157
  v_cvt_pk_bf16_f32 v171, v158, v159
  v_exp_f32 v160, v160
  v_exp_f32 v161, v161
  v_exp_f32 v162, v162
  v_exp_f32 v163, v163
  v_mfma_f32_32x32x16_bf16 v[56:71], v[200:203], v[168:171], v[56:71]
  v_exp_f32 v164, v164
  v_exp_f32 v165, v165
  v_exp_f32 v166, v166
  v_exp_f32 v167, v167
  v_cvt_pk_bf16_f32 v172, v160, v161
  v_cvt_pk_bf16_f32 v173, v162, v163
  v_cvt_pk_bf16_f32 v174, v164, v165
  v_cvt_pk_bf16_f32 v175, v166, v167
  v_mfma_f32_32x32x16_bf16 v[152:167], v[224:227], v[24:27], 0
  v_exp_f32 v136, v136
  v_exp_f32 v137, v137
  v_exp_f32 v138, v138
  v_mfma_f32_32x32x16_bf16 v[56:71], v[204:207], v[172:175], v[56:71]
  s_call_b64 s[72:73], .g2_kernel_a_ld1
  v_exp_f32 v139, v139
  v_exp_f32 v140, v140
  v_exp_f32 v141, v141
  v_smfmac_f32_16x16x64_bf16 v[120:123], v[16:19], v[168:175], v20
  v_exp_f32 v142, v142
  v_exp_f32 v143, v143
  v_mfma_f32_32x32x16_bf16 v[152:167], v[228:231], v[28:31], v[152:167]
  v_cvt_pk_bf16_f32 v168, v136, v137
  v_cvt_pk_bf16_f32 v169, v138, v139
  v_cvt_pk_bf16_f32 v170, v140, v141
  v_cvt_pk_bf16_f32 v171, v142, v143
  v_exp_f32 v144, v144
  v_exp_f32 v145, v145
  v_exp_f32 v146, v146
  v_exp_f32 v147, v147
  v_mfma_f32_32x32x16_bf16 v[56:71], v[216:219], v[168:171], v[56:71]
  v_exp_f32 v148, v148
  v_exp_f32 v149, v149
  v_exp_f32 v150, v150
  v_exp_f32 v151, v151
  v_cvt_pk_bf16_f32 v172, v144, v145
  v_cvt_pk_bf16_f32 v173, v146, v147
  v_cvt_pk_bf16_f32 v174, v148, v149
  v_cvt_pk_bf16_f32 v175, v150, v151
  v_exp_f32 v152, v152
  v_exp_f32 v153, v153
  v_exp_f32 v154, v154
  v_mfma_f32_32x32x16_bf16 v[56:71], v[220:223], v[172:175], v[56:71]
  s_call_b64 s[72:73], .g2_kernel_a_ld2
  v_exp_f32 v155, v155
  v_exp_f32 v156, v156
  v_exp_f32 v157, v157
  v_smfmac_f32_16x16x64_bf16 v[120:123], v[16:19], v[168:175], v20
  v_exp_f32 v158, v158
  v_exp_f32 v159, v159
  v_cvt_pk_bf16_f32 v168, v152, v153
  v_cvt_pk_bf16_f32 v169, v154, v155
  v_cvt_pk_bf16_f32 v170, v156, v157
  v_cvt_pk_bf16_f32 v171, v158, v159
  v_exp_f32 v160, v160
  v_exp_f32 v161, v161
  v_exp_f32 v162, v162
  v_exp_f32 v163, v163
  v_mfma_f32_32x32x16_bf16 v[56:71], v[232:235], v[168:171], v[56:71]
  v_exp_f32 v164, v164
  v_exp_f32 v165, v165
  v_exp_f32 v166, v166
  v_exp_f32 v167, v167
  v_cvt_pk_bf16_f32 v172, v160, v161
  v_cvt_pk_bf16_f32 v173, v162, v163
  v_cvt_pk_bf16_f32 v174, v164, v165
  v_cvt_pk_bf16_f32 v175, v166, v167
  s_nop 1
  v_mfma_f32_32x32x16_bf16 v[56:71], v[236:239], v[172:175], v[56:71]
  v_smfmac_f32_16x16x64_bf16 v[120:123], v[16:19], v[168:175], v20
  s_branch .g2_kernel_a_rde
.g2_kernel_a_rd1:
  s_cmp_lg_u32 s28, 1
  s_cbranch_scc1 .g2_kernel_a_rd2
  ds_read_b128 v[32:35], v14 offset:10240
  ds_read_b128 v[36:39], v14 offset:11264
  v_mov_b32 v124, 0
  v_mov_b32 v125, 0
  s_waitcnt lgkmcnt(0)
  v_mfma_f32_32x32x16_bf16 v[136:151], v[176:179], v[32:35], 0
  v_mfma_f32_32x32x16_bf16 v[136:151], v[180:183], v[36:39], v[136:151]
  v_mfma_f32_32x32x16_bf16 v[152:167], v[192:195], v[32:35], 0
  s_nop 10
  v_exp_f32 v136, v136
  v_exp_f32 v137, v137
  v_exp_f32 v138, v138
  v_exp_f32 v139, v139
  v_exp_f32 v140, v140
  v_exp_f32 v141, v141
  v_exp_f32 v142, v142
  v_exp_f32 v143, v143
  v_mfma_f32_32x32x16_bf16 v[152:167], v[196:199], v[36:39], v[152:167]
  v_cvt_pk_bf16_f32 v168, v136, v137
  v_cvt_pk_bf16_f32 v169, v138, v139
  v_cvt_pk_bf16_f32 v170, v140, v141
  v_cvt_pk_bf16_f32 v171, v142, v143
  v_exp_f32 v144, v144
  v_exp_f32 v145, v145
  v_exp_f32 v146, v146
  v_exp_f32 v147, v147
  v_mfma_f32_32x32x16_bf16 v[72:87], v[184:187], v[168:171], 0
  v_exp_f32 v148, v148
  v_exp_f32 v149, v149
  v_exp_f32 v150, v150
  v_exp_f32 v151, v151
  v_cvt_pk_bf16_f32 v172, v144, v145
  v_cvt_pk_bf16_f32 v173, v146, v147
  v_cvt_pk_bf16_f32 v174, v148, v149
  v_cvt_pk_bf16_f32 v175, v150, v151
  v_mfma_f32_32x32x16_bf16 v[136:151], v[208:211], v[32:35], 0
  v_exp_f32 v152, v152
  v_exp_f32 v153, v153
  v_exp_f32 v154, v154
  v_mfma_f32_32x32x16_bf16 v[72:87], v[188:191], v[172:175], v[72:87]
  s_call_b64 s[72:73], .g2_kernel_a_ld0
  v_exp_f32 v155, v155
  v_exp_f32 v156, v156
  v_exp_f32 v157, v157
  v_smfmac_f32_16x16x64_bf16 v[124:127], v[16:19], v[168:175], v20
  v_exp_f32 v158, v158
  v_exp_f32 v159, v159
  v_mfma_f32_32x32x16_bf16 v[136:151], v[212:215], v[36:39], v[136:151]
  v_cvt_pk_bf16_f32 v168, v152, v153
  v_cvt_pk_bf16_f32 v169, v154, v155
  v_cvt_pk_bf16_f32 v170, v156, v157
  v_cvt_pk_bf16_f32 v171, v158, v159
  v_exp_f32 v160, v160
  v_exp_f32 v161, v161
  v_exp_f32 v162, v162
  v_exp_f32 v163, v163
  v_mfma_f32_32x32x16_bf16 v[72:87], v[200:203], v[168:171], v[72:87]
  v_exp_f32 v164, v164
  v_exp_f32 v165, v165
  v_exp_f32 v166, v166
  v_exp_f32 v167, v167
  v_cvt_pk_bf16_f32 v172, v160, v161
  v_cvt_pk_bf16_f32 v173, v162, v163
  v_cvt_pk_bf16_f32 v174, v164, v165
  v_cvt_pk_bf16_f32 v175, v166, v167
  v_mfma_f32_32x32x16_bf16 v[152:167], v[224:227], v[32:35], 0
  v_exp_f32 v136, v136
  v_exp_f32 v137, v137
  v_exp_f32 v138, v138
  v_mfma_f32_32x32x16_bf16 v[72:87], v[204:207], v[172:175], v[72:87]
  s_call_b64 s[72:73], .g2_kernel_a_ld1
  v_exp_f32 v139, v139
  v_exp_f32 v140, v140
  v_exp_f32 v141, v141
  v_smfmac_f32_16x16x64_bf16 v[124:127], v[16:19], v[168:175], v20
  v_exp_f32 v142, v142
  v_exp_f32 v143, v143
  v_mfma_f32_32x32x16_bf16 v[152:167], v[228:231], v[36:39], v[152:167]
  v_cvt_pk_bf16_f32 v168, v136, v137
  v_cvt_pk_bf16_f32 v169, v138, v139
  v_cvt_pk_bf16_f32 v170, v140, v141
  v_cvt_pk_bf16_f32 v171, v142, v143
  v_exp_f32 v144, v144
  v_exp_f32 v145, v145
  v_exp_f32 v146, v146
  v_exp_f32 v147, v147
  v_mfma_f32_32x32x16_bf16 v[72:87], v[216:219], v[168:171], v[72:87]
  v_exp_f32 v148, v148
  v_exp_f32 v149, v149
  v_exp_f32 v150, v150
  v_exp_f32 v151, v151
  v_cvt_pk_bf16_f32 v172, v144, v145
  v_cvt_pk_bf16_f32 v173, v146, v147
  v_cvt_pk_bf16_f32 v174, v148, v149
  v_cvt_pk_bf16_f32 v175, v150, v151
  v_exp_f32 v152, v152
  v_exp_f32 v153, v153
  v_exp_f32 v154, v154
  v_mfma_f32_32x32x16_bf16 v[72:87], v[220:223], v[172:175], v[72:87]
  s_call_b64 s[72:73], .g2_kernel_a_ld2
  v_exp_f32 v155, v155
  v_exp_f32 v156, v156
  v_exp_f32 v157, v157
  v_smfmac_f32_16x16x64_bf16 v[124:127], v[16:19], v[168:175], v20
  v_exp_f32 v158, v158
  v_exp_f32 v159, v159
  v_cvt_pk_bf16_f32 v168, v152, v153
  v_cvt_pk_bf16_f32 v169, v154, v155
  v_cvt_pk_bf16_f32 v170, v156, v157
  v_cvt_pk_bf16_f32 v171, v158, v159
  v_exp_f32 v160, v160
  v_exp_f32 v161, v161
  v_exp_f32 v162, v162
  v_exp_f32 v163, v163
  v_mfma_f32_32x32x16_bf16 v[72:87], v[232:235], v[168:171], v[72:87]
  v_exp_f32 v164, v164
  v_exp_f32 v165, v165
  v_exp_f32 v166, v166
  v_exp_f32 v167, v167
  v_cvt_pk_bf16_f32 v172, v160, v161
  v_cvt_pk_bf16_f32 v173, v162, v163
  v_cvt_pk_bf16_f32 v174, v164, v165
  v_cvt_pk_bf16_f32 v175, v166, v167
  s_nop 1
  v_mfma_f32_32x32x16_bf16 v[72:87], v[236:239], v[172:175], v[72:87]
  v_smfmac_f32_16x16x64_bf16 v[124:127], v[16:19], v[168:175], v20
  s_branch .g2_kernel_a_rde
.g2_kernel_a_rd2:
  s_cmp_lg_u32 s28, 2
  s_cbranch_scc1 .g2_kernel_a_rd3
  ds_read_b128 v[40:43], v14 offset:12288
  ds_read_b128 v[44:47], v14 offset:13312
  v_mov_b32 v128, 0
  v_mov_b32 v129, 0
  s_waitcnt lgkmcnt(0)
  v_mfma_f32_32x32x16_bf16 v[136:151], v[176:179], v[40:43], 0
  v_mfma_f32_32x32x16_bf16 v[136:151], v[180:183], v[44:47], v[136:151]
  v_mfma_f32_32x32x16_bf16 v[152:167], v[192:195], v[40:43], 0
  s_nop 10
  v_exp_f32 v136, v136
  v_exp_f32 v137, v137
  v_exp_f32 v138, v138
  v_exp_f32 v139, v139
  v_exp_f32 v140, v140
  v_exp_f32 v141, v141
  v_exp_f32 v142, v142
  v_exp_f32 v143, v143
  v_mfma_f32_32x32x16_bf16 v[152:167], v[196:199], v[44:47], v[152:167]
  v_cvt_pk_bf16_f32 v168, v136, v137
  v_cvt_pk_bf16_f32 v169, v138, v139
  v_cvt_pk_bf16_f32 v170, v140, v141
  v_cvt_pk_bf16_f32 v171, v142, v143
  v_exp_f32 v144, v144
  v_exp_f32 v145, v145
  v_exp_f32 v146, v146
  v_exp_f32 v147, v147
  v_mfma_f32_32x32x16_bf16 v[88:103], v[184:187], v[168:171], 0
  v_exp_f32 v148, v148
  v_exp_f32 v149, v149
  v_exp_f32 v150, v150
  v_exp_f32 v151, v151
  v_cvt_pk_bf16_f32 v172, v144, v145
  v_cvt_pk_bf16_f32 v173, v146, v147
  v_cvt_pk_bf16_f32 v174, v148, v149
  v_cvt_pk_bf16_f32 v175, v150, v151
  v_mfma_f32_32x32x16_bf16 v[136:151], v[208:211], v[40:43], 0
  v_exp_f32 v152, v152
  v_exp_f32 v153, v153
  v_exp_f32 v154, v154
  v_mfma_f32_32x32x16_bf16 v[88:103], v[188:191], v[172:175], v[88:103]
  s_call_b64 s[72:73], .g2_kernel_a_ld0
  v_exp_f32 v155, v155
  v_exp_f32 v156, v156
  v_exp_f32 v157, v157
  v_smfmac_f32_16x16x64_bf16 v[128:131], v[16:19], v[168:175], v20
  v_exp_f32 v158, v158
  v_exp_f32 v159, v159
  v_mfma_f32_32x32x16_bf16 v[136:151], v[212:215], v[44:47], v[136:151]
  v_cvt_pk_bf16_f32 v168, v152, v153
  v_cvt_pk_bf16_f32 v169, v154, v155
  v_cvt_pk_bf16_f32 v170, v156, v157
  v_cvt_pk_bf16_f32 v171, v158, v159
  v_exp_f32 v160, v160
  v_exp_f32 v161, v161
  v_exp_f32 v162, v162
  v_exp_f32 v163, v163
  v_mfma_f32_32x32x16_bf16 v[88:103], v[200:203], v[168:171], v[88:103]
  v_exp_f32 v164, v164
  v_exp_f32 v165, v165
  v_exp_f32 v166, v166
  v_exp_f32 v167, v167
  v_cvt_pk_bf16_f32 v172, v160, v161
  v_cvt_pk_bf16_f32 v173, v162, v163
  v_cvt_pk_bf16_f32 v174, v164, v165
  v_cvt_pk_bf16_f32 v175, v166, v167
  v_mfma_f32_32x32x16_bf16 v[152:167], v[224:227], v[40:43], 0
  v_exp_f32 v136, v136
  v_exp_f32 v137, v137
  v_exp_f32 v138, v138
  v_mfma_f32_32x32x16_bf16 v[88:103], v[204:207], v[172:175], v[88:103]
  s_call_b64 s[72:73], .g2_kernel_a_ld1
  v_exp_f32 v139, v139
  v_exp_f32 v140, v140
  v_exp_f32 v141, v141
  v_smfmac_f32_16x16x64_bf16 v[128:131], v[16:19], v[168:175], v20
  v_exp_f32 v142, v142
  v_exp_f32 v143, v143
  v_mfma_f32_32x32x16_bf16 v[152:167], v[228:231], v[44:47], v[152:167]
  v_cvt_pk_bf16_f32 v168, v136, v137
  v_cvt_pk_bf16_f32 v169, v138, v139
  v_cvt_pk_bf16_f32 v170, v140, v141
  v_cvt_pk_bf16_f32 v171, v142, v143
  v_exp_f32 v144, v144
  v_exp_f32 v145, v145
  v_exp_f32 v146, v146
  v_exp_f32 v147, v147
  v_mfma_f32_32x32x16_bf16 v[88:103], v[216:219], v[168:171], v[88:103]
  v_exp_f32 v148, v148
  v_exp_f32 v149, v149
  v_exp_f32 v150, v150
  v_exp_f32 v151, v151
  v_cvt_pk_bf16_f32 v172, v144, v145
  v_cvt_pk_bf16_f32 v173, v146, v147
  v_cvt_pk_bf16_f32 v174, v148, v149
  v_cvt_pk_bf16_f32 v175, v150, v151
  v_exp_f32 v152, v152
  v_exp_f32 v153, v153
  v_exp_f32 v154, v154
  v_mfma_f32_32x32x16_bf16 v[88:103], v[220:223], v[172:175], v[88:103]
  s_call_b64 s[72:73], .g2_kernel_a_ld2
  v_exp_f32 v155, v155
  v_exp_f32 v156, v156
  v_exp_f32 v157, v157
  v_smfmac_f32_16x16x64_bf16 v[128:131], v[16:19], v[168:175], v20
  v_exp_f32 v158, v158
  v_exp_f32 v159, v159
  v_cvt_pk_bf16_f32 v168, v152, v153
  v_cvt_pk_bf16_f32 v169, v154, v155
  v_cvt_pk_bf16_f32 v170, v156, v157
  v_cvt_pk_bf16_f32 v171, v158, v159
  v_exp_f32 v160, v160
  v_exp_f32 v161, v161
  v_exp_f32 v162, v162
  v_exp_f32 v163, v163
  v_mfma_f32_32x32x16_bf16 v[88:103], v[232:235], v[168:171], v[88:103]
  v_exp_f32 v164, v164
  v_exp_f32 v165, v165
  v_exp_f32 v166, v166
  v_exp_f32 v167, v167
  v_cvt_pk_bf16_f32 v172, v160, v161
  v_cvt_pk_bf16_f32 v173, v162, v163
  v_cvt_pk_bf16_f32 v174, v164, v165
  v_cvt_pk_bf16_f32 v175, v166, v167
  s_nop 1
  v_mfma_f32_32x32x16_bf16 v[88:103], v[236:239], v[172:175], v[88:103]
  v_smfmac_f32_16x16x64_bf16 v[128:131], v[16:19], v[168:175], v20
  s_branch .g2_kernel_a_rde
.g2_kernel_a_rd3:
  ds_read_b128 v[48:51], v14 offset:14336
  ds_read_b128 v[52:55], v14 offset:15360
  v_mov_b32 v132, 0
  v_mov_b32 v133, 0
  s_waitcnt lgkmcnt(0)
  v_mfma_f32_32x32x16_bf16 v[136:151], v[176:179], v[48:51], 0
  v_mfma_f32_32x32x16_bf16 v[136:151], v[180:183], v[52:55], v[136:151]
  v_mfma_f32_32x32x16_bf16 v[152:167], v[192:195], v[48:51], 0
  s_nop 10
  v_exp_f32 v136, v136
  v_exp_f32 v137, v137
  v_exp_f32 v138, v138
  v_exp_f32 v139, v139
  v_exp_f32 v140, v140
  v_exp_f32 v141, v141
  v_exp_f32 v142, v142
  v_exp_f32 v143, v143
  v_mfma_f32_32x32x16_bf16 v[152:167], v[196:199], v[52:55], v[152:167]
  v_cvt_pk_bf16_f32 v168, v136, v137
  v_cvt_pk_bf16_f32 v169, v138, v139
  v_cvt_pk_bf16_f32 v170, v140, v141
  v_cvt_pk_bf16_f32 v171, v142, v143
  v_exp_f32 v144, v144
  v_exp_f32 v145, v145
  v_exp_f32 v146, v146
  v_exp_f32 v147, v147
  v_mfma_f32_32x32x16_bf16 v[104:119], v[184:187], v[168:171], 0
  v_exp_f32 v148, v148
  v_exp_f32 v149, v149
  v_exp_f32 v150, v150
  v_exp_f32 v151, v151
  v_cvt_pk_bf16_f32 v172, v144, v145
  v_cvt_pk_bf16_f32 v173, v146, v147
  v_cvt_pk_bf16_f32 v174, v148, v149
  v_cvt_pk_bf16_f32 v175, v150, v151
  v_mfma_f32_32x32x16_bf16 v[136:151], v[208:211], v[48:51], 0
  v_exp_f32 v152, v152
  v_exp_f32 v153, v153
  v_exp_f32 v154, v154
  v_mfma_f32_32x32x16_bf16 v[104:119], v[188:191], v[172:175], v[104:119]
  s_call_b64 s[72:73], .g2_kernel_a_ld0
  v_exp_f32 v155, v155
  v_exp_f32 v156, v156
  v_exp_f32 v157, v157
  v_smfmac_f32_16x16x64_bf16 v[132:135], v[16:19], v[168:175], v20
  v_exp_f32 v158, v158
  v_exp_f32 v159, v159
  v_mfma_f32_32x32x16_bf16 v[136:151], v[212:215], v[52:55], v[136:151]
  v_cvt_pk_bf16_f32 v168, v152, v153
  v_cvt_pk_bf16_f32 v169, v154, v155
  v_cvt_pk_bf16_f32 v170, v156, v157
  v_cvt_pk_bf16_f32 v171, v158, v159
  v_exp_f32 v160, v160
  v_exp_f32 v161, v161
  v_exp_f32 v162, v162
  v_exp_f32 v163, v163
  v_mfma_f32_32x32x16_bf16 v[104:119], v[200:203], v[168:171], v[104:119]
  v_exp_f32 v164, v164
  v_exp_f32 v165, v165
  v_exp_f32 v166, v166
  v_exp_f32 v167, v167
  v_cvt_pk_bf16_f32 v172, v160, v161
  v_cvt_pk_bf16_f32 v173, v162, v163
  v_cvt_pk_bf16_f32 v174, v164, v165
  v_cvt_pk_bf16_f32 v175, v166, v167
  v_mfma_f32_32x32x16_bf16 v[152:167], v[224:227], v[48:51], 0
  v_exp_f32 v136, v136
  v_exp_f32 v137, v137
  v_exp_f32 v138, v138
  v_mfma_f32_32x32x16_bf16 v[104:119], v[204:207], v[172:175], v[104:119]
  s_call_b64 s[72:73], .g2_kernel_a_ld1
  v_exp_f32 v139, v139
  v_exp_f32 v140, v140
  v_exp_f32 v141, v141
  v_smfmac_f32_16x16x64_bf16 v[132:135], v[16:19], v[168:175], v20
  v_exp_f32 v142, v142
  v_exp_f32 v143, v143
  v_mfma_f32_32x32x16_bf16 v[152:167], v[228:231], v[52:55], v[152:167]
  v_cvt_pk_bf16_f32 v168, v136, v137
  v_cvt_pk_bf16_f32 v169, v138, v139
  v_cvt_pk_bf16_f32 v170, v140, v141
  v_cvt_pk_bf16_f32 v171, v142, v143
  v_exp_f32 v144, v144
  v_exp_f32 v145, v145
  v_exp_f32 v146, v146
  v_exp_f32 v147, v147
  v_mfma_f32_32x32x16_bf16 v[104:119], v[216:219], v[168:171], v[104:119]
  v_exp_f32 v148, v148
  v_exp_f32 v149, v149
  v_exp_f32 v150, v150
  v_exp_f32 v151, v151
  v_cvt_pk_bf16_f32 v172, v144, v145
  v_cvt_pk_bf16_f32 v173, v146, v147
  v_cvt_pk_bf16_f32 v174, v148, v149
  v_cvt_pk_bf16_f32 v175, v150, v151
  v_exp_f32 v152, v152
  v_exp_f32 v153, v153
  v_exp_f32 v154, v154
  v_mfma_f32_32x32x16_bf16 v[104:119], v[220:223], v[172:175], v[104:119]
  s_call_b64 s[72:73], .g2_kernel_a_ld2
  v_exp_f32 v155, v155
  v_exp_f32 v156, v156
  v_exp_f32 v157, v157
  v_smfmac_f32_16x16x64_bf16 v[132:135], v[16:19], v[168:175], v20
  v_exp_f32 v158, v158
  v_exp_f32 v159, v159
  v_cvt_pk_bf16_f32 v168, v152, v153
  v_cvt_pk_bf16_f32 v169, v154, v155
  v_cvt_pk_bf16_f32 v170, v156, v157
  v_cvt_pk_bf16_f32 v171, v158, v159
  v_exp_f32 v160, v160
  v_exp_f32 v161, v161
  v_exp_f32 v162, v162
  v_exp_f32 v163, v163
  v_mfma_f32_32x32x16_bf16 v[104:119], v[232:235], v[168:171], v[104:119]
  v_exp_f32 v164, v164
  v_exp_f32 v165, v165
  v_exp_f32 v166, v166
  v_exp_f32 v167, v167
  v_cvt_pk_bf16_f32 v172, v160, v161
  v_cvt_pk_bf16_f32 v173, v162, v163
  v_cvt_pk_bf16_f32 v174, v164, v165
  v_cvt_pk_bf16_f32 v175, v166, v167
  s_nop 1
  v_mfma_f32_32x32x16_bf16 v[104:119], v[236:239], v[172:175], v[104:119]
  v_smfmac_f32_16x16x64_bf16 v[132:135], v[16:19], v[168:175], v20
  s_branch .g2_kernel_a_rde
.g2_kernel_a_rd4:
.g2_kernel_a_rde:
  v_mov_b32 v168, 0
  v_mov_b32 v169, 0
  v_mov_b32 v170, 0
  v_mov_b32 v171, 0
  v_mov_b32 v172, 0
  v_mov_b32 v173, 0
  v_mov_b32 v174, 0
  v_mov_b32 v175, 0
  s_waitcnt vmcnt(8)
  v_mfma_f32_32x32x16_bf16 v[136:151], v[176:179], v[24:27], 0
  v_mfma_f32_32x32x16_bf16 v[136:151], v[180:183], v[28:31], v[136:151]
  s_nop 10
  s_branch .g2_kernel_a_loop
.g2_kernel_a_ld0:
  s_andn2_b32 s33, s36, s34
  s_cbranch_scc0 .g2_kernel_a_r0c
.g2_kernel_a_r0b:
  s_ff1_i32_b32 s33, s33
  s_bitset1_b32 s34, s33
  s_xor_b32 s33, s33, s24
  s_lshl_b32 s33, s33, s25
  s_add_u32 s22, s20, s33
  s_addc_u32 s23, s21, 0
  global_load_dwordx4 v[176:179], v3, s[22:23] offset:0
  global_load_dwordx4 v[180:183], v3, s[22:23] offset:1024
  global_load_dwordx4 v[184:187], v3, s[22:23] offset:2048
  global_load_dwordx4 v[188:191], v3, s[22:23] offset:3072
  s_setpc_b64 s[72:73]
.g2_kernel_a_ld1:
  s_andn2_b32 s33, s36, s34
  s_cbranch_scc0 .g2_kernel_a_r1c
.g2_kernel_a_r1b:
  s_ff1_i32_b32 s33, s33
  s_bitset1_b32 s34, s33
  s_xor_b32 s33, s33, s24
  s_lshl_b32 s33, s33, s25
  s_add_u32 s22, s20, s33
  s_addc_u32 s23, s21, 0
  global_load_dwordx4 v[192:195], v3, s[22:23] offset:0
  global_load_dwordx4 v[196:199], v3, s[22:23] offset:1024
  global_load_dwordx4 v[200:203], v3, s[22:23] offset:2048
  global_load_dwordx4 v[204:207], v3, s[22:23] offset:3072
  s_setpc_b64 s[72:73]
.g2_kernel_a_ld2:
  s_andn2_b32 s33, s36, s34
  s_cbranch_scc0 .g2_kernel_a_r2c
.g2_kernel_a_r2b:
  s_ff1_i32_b32 s33, s33
  s_bitset1_b32 s34, s33
  s_xor_b32 s33, s33, s24
  s_lshl_b32 s33, s33, s25
  s_add_u32 s22, s20, s33
  s_addc_u32 s23, s21, 0
  global_load_dwordx4 v[208:211], v3, s[22:23] offset:0
  global_load_dwordx4 v[212:215], v3, s[22:23] offset:1024
  global_load_dwordx4 v[216:219], v3, s[22:23] offset:2048
  global_load_dwordx4 v[220:223], v3, s[22:23] offset:3072
  s_setpc_b64 s[72:73]
.g2_kernel_a_N0c:
  s_call_b64 s[68:69], .g2_kernel_a_pick
  s_branch .g2_kernel_a_N0b
.g2_kernel_a_N1c:
  s_call_b64 s[68:69], .g2_kernel_a_pick
  s_branch .g2_kernel_a_N1b
.g2_kernel_a_N2c:
  s_call_b64 s[68:69], .g2_kernel_a_pick
  s_branch .g2_kernel_a_N2b
.g2_kernel_a_N3c:
  s_call_b64 s[68:69], .g2_kernel_a_pick
  s_branch .g2_kernel_a_N3b
.g2_kernel_a_L3c:
  s_call_b64 s[68:69], .g2_kernel_a_pick
  s_branch .g2_kernel_a_L3b
.g2_kernel_a_G0c:
  s_call_b64 s[68:69], .g2_kernel_a_pick
  s_branch .g2_kernel_a_G0b
.g2_kernel_a_L3g:
  s_mov_b32 s38, 0
.g2_kernel_a_L3gl:
  ds_read_b32 v7, v13 offset:8
  s_add_u32 s38, s38, 1
  s_waitcnt lgkmcnt(0)
  v_cmp_gt_u32 vcc, s27, v7
  s_cbranch_vccz .g2_kernel_a_L3h
  s_cmp_lt_u32 s38, 524288
  s_cbranch_scc1 .g2_kernel_a_L3gl
  s_branch .g2_kernel_a_L3h
.g2_kernel_a_hold:
  s_lshl_b32 s33, 1, s14
  s_lshr_b32 s14, s14, 8
  s_setpc_b64 s[68:69]
.g2_kernel_a_pick:
  s_cmp_lg_u32 s34, -1
  s_cbranch_scc1 .g2_kernel_a_pk1
  s_cmp_eq_u32 s26, -1
  s_cbranch_scc1 .g2_kernel_a_hold
  s_add_u32 s26, s26, 1
  s_mov_b32 s34, 0xffff
  s_cmp_eq_u32 s26, 1
  s_cbranch_scc1 .g2_kernel_a_pk1
  v_and_b32 v8, 15, v2
  s_lshl_b32 s28, s16, 6
  s_add_u32 s28, s28, 157696
  v_lshl_add_u32 v8, v8, 2, s28
  s_lshl_b32 s28, s17, 2
  s_add_u32 s28, s28, s16
  s_lshl_b32 s28, s28, 16
  s_add_u32 s28, s28, s63
  s_add_u32 s28, s28, 0x800000
  s_add_u32 s20, s60, s28
  s_addc_u32 s21, s61, 0
  s_lshl_b32 s24, s18, 1
  s_and_b32 s24, s24, 6
  s_mov_b32 s25, 12
  s_mov_b32 s34, 0
  s_mov_b32 s36, 0xff
  s_mov_b32 s33, 0xff
  s_mov_b32 s38, 0
.g2_kernel_a_pk2:
  ds_read_b32 v7, v8
  s_add_u32 s38, s38, 1
  s_waitcnt lgkmcnt(0)
  v_cmp_ge_u32 vcc, s62, v7
  s_cbranch_vccz .g2_kernel_a_pkr
  s_cmp_lt_u32 s38, 524288
  s_cbranch_scc1 .g2_kernel_a_pk2
  s_branch .g2_kernel_a_pkr
.g2_kernel_a_pk1:
  s_mov_b32 s38, 0
.g2_kernel_a_pkl:
  ds_read_b32 v7, v8
  s_add_u32 s38, s38, 1
  s_waitcnt lgkmcnt(0)
  v_cmp_lt_u32 vcc, s62, v7
  s_mov_b32 s36, vcc_lo
  s_andn2_b32 s33, s36, s34
  s_cbranch_scc1 .g2_kernel_a_pkr
  s_cmp_lt_u32 s38, 524288
  s_cbranch_scc1 .g2_kernel_a_pkl
  s_not_b32 s33, s34
.g2_kernel_a_pkr:
  s_setpc_b64 s[68:69]
.g2_kernel_w_aw:
  v_mov_b32 v6, s71
  s_mov_b32 s38, 0
.g2_kernel_wg4:
  ds_read_b32 v7, v6 offset:52
  s_add_u32 s38, s38, 1
  s_waitcnt lgkmcnt(0)
  v_cmp_le_u32 vcc, 4, v7
  s_cbranch_vccnz .g2_kernel_wg4d
  s_sleep 1
  s_cmp_lt_u32 s38, 524288
  s_cbranch_scc1 .g2_kernel_wg4
.g2_kernel_wg4d:
  s_branch .g2_kernel_w_ab
.g2_kernel_w_pt:
  v_lshlrev_b32 v7, 5, v17
  v_add_u32 v7, 155648, v7
  s_mov_b64 exec, vcc
  ds_read_b128 v[240:243], v7 offset:7680
  ds_read_b128 v[244:247], v7 offset:7696
  ds_read_b128 v[248:251], v7 offset:7744
  ds_read_b128 v[252:255], v7 offset:7760
  s_waitcnt lgkmcnt(0)
  v_pk_add_f32 v[24:25], v[24:25], v[240:241]
  v_pk_add_f32 v[26:27], v[26:27], v[242:243]
  v_pk_add_f32 v[28:29], v[28:29], v[244:245]
  v_pk_add_f32 v[30:31], v[30:31], v[246:247]
  v_pk_add_f32 v[32:33], v[32:33], v[248:249]
  v_pk_add_f32 v[34:35], v[34:35], v[250:251]
  v_pk_add_f32 v[36:37], v[36:37], v[252:253]
  v_pk_add_f32 v[38:39], v[38:39], v[254:255]
  ds_read_b128 v[240:243], v7 offset:7808
  ds_read_b128 v[244:247], v7 offset:7824
  ds_read_b128 v[248:251], v7 offset:7872
  ds_read_b128 v[252:255], v7 offset:7888
  s_waitcnt lgkmcnt(0)
  v_pk_add_f32 v[40:41], v[40:41], v[240:241]
  v_pk_add_f32 v[42:43], v[42:43], v[242:243]
  v_pk_add_f32 v[44:45], v[44:45], v[244:245]
  v_pk_add_f32 v[46:47], v[46:47], v[246:247]
  v_pk_add_f32 v[48:49], v[48:49], v[248:249]
  v_pk_add_f32 v[50:51], v[50:51], v[250:251]
  v_pk_add_f32 v[52:53], v[52:53], v[252:253]
  v_pk_add_f32 v[54:55], v[54:55], v[254:255]
  s_mov_b64 exec, -1
  s_branch .g2_kernel_w_pb
.g2_kernel_w_i8c:
  s_mov_b32 s38, 0
  s_call_b64 s[68:69], .g2_kernel_w_pkl
  s_branch .g2_kernel_w_i8b
.g2_kernel_w_i9c:
  s_mov_b32 s38, 0
  s_call_b64 s[68:69], .g2_kernel_w_pkl
  s_branch .g2_kernel_w_i9b
.g2_kernel_w_i10c:
  s_mov_b32 s38, 0
  s_call_b64 s[68:69], .g2_kernel_w_pkl
  s_branch .g2_kernel_w_i10b
.g2_kernel_w_i11c:
  s_mov_b32 s38, 0
  s_call_b64 s[68:69], .g2_kernel_w_pkl
  s_branch .g2_kernel_w_i11b
.g2_kernel_w_v8:
  s_cmp_ge_u32 s8, 139264
  s_cselect_b32 s28, 139264, 0
  s_sub_u32 s28, s8, s28
  s_lshr_b32 s28, s28, 1
  s_add_u32 s28, s28, 32768
  s_add_u32 s22, s20, s28
  s_addc_u32 s23, s21, 0
  s_mov_b32 s38, 0
.g2_kernel_w_vl8:
  global_load_dwordx4 v[88:91], v3, s[22:23] offset:0 sc1
  global_load_dwordx4 v[92:95], v3, s[22:23] offset:1024 sc1
  global_load_dwordx4 v[96:99], v3, s[22:23] offset:2048 sc1
  global_load_dwordx4 v[100:103], v3, s[22:23] offset:3072 sc1
  s_add_u32 s38, s38, 1
  s_waitcnt vmcnt(0)
  v_min3_u32 v6, v88, v90, v92
  v_min3_u32 v7, v94, v96, v98
  v_min3_u32 v6, v6, v100, v102
  v_min_u32 v6, v6, v7
  v_cmp_eq_u32 vcc, 0, v6
  s_cbranch_vccz .g2_kernel_w_vb8
  s_cmp_lt_u32 s38, 131072
  s_cbranch_scc1 .g2_kernel_w_vl8
  s_branch .g2_kernel_w_vb8
.g2_kernel_w_i12c:
  s_mov_b32 s38, 0
  s_call_b64 s[68:69], .g2_kernel_w_pkl
  s_branch .g2_kernel_w_i12b
.g2_kernel_w_v9:
  s_cmp_ge_u32 s9, 139264
  s_cselect_b32 s28, 139264, 0
  s_sub_u32 s28, s9, s28
  s_lshr_b32 s28, s28, 1
  s_add_u32 s28, s28, 32768
  s_add_u32 s22, s20, s28
  s_addc_u32 s23, s21, 0
  s_mov_b32 s38, 0
.g2_kernel_w_vl9:
  global_load_dwordx4 v[176:179], v3, s[22:23] offset:0 sc1
  global_load_dwordx4 v[180:183], v3, s[22:23] offset:1024 sc1
  global_load_dwordx4 v[184:187], v3, s[22:23] offset:2048 sc1
  global_load_dwordx4 v[188:191], v3, s[22:23] offset:3072 sc1
  s_add_u32 s38, s38, 1
  s_waitcnt vmcnt(0)
  v_min3_u32 v6, v176, v178, v180
  v_min3_u32 v7, v182, v184, v186
  v_min3_u32 v6, v6, v188, v190
  v_min_u32 v6, v6, v7
  v_cmp_eq_u32 vcc, 0, v6
  s_cbranch_vccz .g2_kernel_w_vb9
  s_cmp_lt_u32 s38, 131072
  s_cbranch_scc1 .g2_kernel_w_vl9
  s_branch .g2_kernel_w_vb9
.g2_kernel_w_i13c:
  s_mov_b32 s38, 0
  s_call_b64 s[68:69], .g2_kernel_w_pkl
  s_branch .g2_kernel_w_i13b
.g2_kernel_w_v10:
  s_cmp_ge_u32 s10, 139264
  s_cselect_b32 s28, 139264, 0
  s_sub_u32 s28, s10, s28
  s_lshr_b32 s28, s28, 1
  s_add_u32 s28, s28, 32768
  s_add_u32 s22, s20, s28
  s_addc_u32 s23, s21, 0
  s_mov_b32 s38, 0
.g2_kernel_w_vl10:
  global_load_dwordx4 v[192:195], v3, s[22:23] offset:0 sc1
  global_load_dwordx4 v[196:199], v3, s[22:23] offset:1024 sc1
  global_load_dwordx4 v[200:203], v3, s[22:23] offset:2048 sc1
  global_load_dwordx4 v[204:207], v3, s[22:23] offset:3072 sc1
  s_add_u32 s38, s38, 1
  s_waitcnt vmcnt(0)
  v_min3_u32 v6, v192, v194, v196
  v_min3_u32 v7, v198, v200, v202
  v_min3_u32 v6, v6, v204, v206
  v_min_u32 v6, v6, v7
  v_cmp_eq_u32 vcc, 0, v6
  s_cbranch_vccz .g2_kernel_w_vb10
  s_cmp_lt_u32 s38, 131072
  s_cbranch_scc1 .g2_kernel_w_vl10
  s_branch .g2_kernel_w_vb10
.g2_kernel_w_i14c:
  s_mov_b32 s38, 524288
  s_call_b64 s[68:69], .g2_kernel_w_pkl
  s_branch .g2_kernel_w_i14b
.g2_kernel_w_v11:
  s_cmp_ge_u32 s11, 139264
  s_cselect_b32 s28, 139264, 0
  s_sub_u32 s28, s11, s28
  s_lshr_b32 s28, s28, 1
  s_add_u32 s28, s28, 32768
  s_add_u32 s22, s20, s28
  s_addc_u32 s23, s21, 0
  s_mov_b32 s38, 0
.g2_kernel_w_vl11:
  global_load_dwordx4 v[208:211], v3, s[22:23] offset:0 sc1
  global_load_dwordx4 v[212:215], v3, s[22:23] offset:1024 sc1
  global_load_dwordx4 v[216:219], v3, s[22:23] offset:2048 sc1
  global_load_dwordx4 v[220:223], v3, s[22:23] offset:3072 sc1
  s_add_u32 s38, s38, 1
  s_waitcnt vmcnt(0)
  v_min3_u32 v6, v208, v210, v212
  v_min3_u32 v7, v214, v216, v218
  v_min3_u32 v6, v6, v220, v222
  v_min_u32 v6, v6, v7
  v_cmp_eq_u32 vcc, 0, v6
  s_cbranch_vccz .g2_kernel_w_vb11
  s_cmp_lt_u32 s38, 131072
  s_cbranch_scc1 .g2_kernel_w_vl11
  s_branch .g2_kernel_w_vb11
.g2_kernel_w_i15c:
  s_mov_b32 s38, 524288
  s_call_b64 s[68:69], .g2_kernel_w_pkl
  s_branch .g2_kernel_w_i15b
.g2_kernel_w_v12:
  s_cmp_ge_u32 s12, 139264
  s_cselect_b32 s28, 139264, 0
  s_sub_u32 s28, s12, s28
  s_lshr_b32 s28, s28, 1
  s_add_u32 s28, s28, 32768
  s_add_u32 s22, s20, s28
  s_addc_u32 s23, s21, 0
  s_mov_b32 s38, 0
.g2_kernel_w_vl12:
  global_load_dwordx4 v[224:227], v3, s[22:23] offset:0 sc1
  global_load_dwordx4 v[228:231], v3, s[22:23] offset:1024 sc1
  global_load_dwordx4 v[232:235], v3, s[22:23] offset:2048 sc1
  global_load_dwordx4 v[236:239], v3, s[22:23] offset:3072 sc1
  s_add_u32 s38, s38, 1
  s_waitcnt vmcnt(0)
  v_min3_u32 v6, v224, v226, v228
  v_min3_u32 v7, v230, v232, v234
  v_min3_u32 v6, v6, v236, v238
  v_min_u32 v6, v6, v7
  v_cmp_eq_u32 vcc, 0, v6
  s_cbranch_vccz .g2_kernel_w_vb12
  s_cmp_lt_u32 s38, 131072
  s_cbranch_scc1 .g2_kernel_w_vl12
  s_branch .g2_kernel_w_vb12
.g2_kernel_w_v13:
  s_cmp_ge_u32 s13, 139264
  s_cselect_b32 s28, 139264, 0
  s_sub_u32 s28, s13, s28
  s_lshr_b32 s28, s28, 1
  s_add_u32 s28, s28, 32768
  s_add_u32 s22, s20, s28
  s_addc_u32 s23, s21, 0
  s_mov_b32 s38, 0
.g2_kernel_w_vl13:
  global_load_dwordx4 v[136:139], v3, s[22:23] offset:0 sc1
  global_load_dwordx4 v[140:143], v3, s[22:23] offset:1024 sc1
  global_load_dwordx4 v[144:147], v3, s[22:23] offset:2048 sc1
  global_load_dwordx4 v[148:151], v3, s[22:23] offset:3072 sc1
  s_add_u32 s38, s38, 1
  s_waitcnt vmcnt(0)
  v_min3_u32 v6, v136, v138, v140
  v_min3_u32 v7, v142, v144, v146
  v_min3_u32 v6, v6, v148, v150
  v_min_u32 v6, v6, v7
  v_cmp_eq_u32 vcc, 0, v6
  s_cbranch_vccz .g2_kernel_w_vb13
  s_cmp_lt_u32 s38, 131072
  s_cbranch_scc1 .g2_kernel_w_vl13
  s_branch .g2_kernel_w_vb13
.g2_kernel_w_v14:
  s_cmp_ge_u32 s14, 139264
  s_cselect_b32 s28, 139264, 0
  s_sub_u32 s28, s14, s28
  s_lshr_b32 s28, s28, 1
  s_add_u32 s28, s28, 32768
  s_add_u32 s22, s20, s28
  s_addc_u32 s23, s21, 0
  s_mov_b32 s38, 0
.g2_kernel_w_vl14:
  global_load_dwordx4 v[152:155], v3, s[22:23] offset:0 sc1
  global_load_dwordx4 v[156:159], v3, s[22:23] offset:1024 sc1
  global_load_dwordx4 v[160:163], v3, s[22:23] offset:2048 sc1
  global_load_dwordx4 v[164:167], v3, s[22:23] offset:3072 sc1
  s_add_u32 s38, s38, 1
  s_waitcnt vmcnt(0)
  v_min3_u32 v6, v152, v154, v156
  v_min3_u32 v7, v158, v160, v162
  v_min3_u32 v6, v6, v164, v166
  v_min_u32 v6, v6, v7
  v_cmp_eq_u32 vcc, 0, v6
  s_cbranch_vccz .g2_kernel_w_vb14
  s_cmp_lt_u32 s38, 131072
  s_cbranch_scc1 .g2_kernel_w_vl14
  s_branch .g2_kernel_w_vb14
.g2_kernel_w_v15:
  s_cmp_ge_u32 s15, 139264
  s_cselect_b32 s28, 139264, 0
  s_sub_u32 s28, s15, s28
  s_lshr_b32 s28, s28, 1
  s_add_u32 s28, s28, 32768
  s_add_u32 s22, s20, s28
  s_addc_u32 s23, s21, 0
  s_mov_b32 s38, 0
.g2_kernel_w_vl15:
  global_load_dwordx4 v[56:59], v3, s[22:23] offset:0 sc1
  global_load_dwordx4 v[60:63], v3, s[22:23] offset:1024 sc1
  global_load_dwordx4 v[64:67], v3, s[22:23] offset:2048 sc1
  global_load_dwordx4 v[68:71], v3, s[22:23] offset:3072 sc1
  s_add_u32 s38, s38, 1
  s_waitcnt vmcnt(0)
  v_min3_u32 v6, v56, v58, v60
  v_min3_u32 v7, v62, v64, v66
  v_min3_u32 v6, v6, v68, v70
  v_min_u32 v6, v6, v7
  v_cmp_eq_u32 vcc, 0, v6
  s_cbranch_vccz .g2_kernel_w_vb15
  s_cmp_lt_u32 s38, 131072
  s_cbranch_scc1 .g2_kernel_w_vl15
  s_branch .g2_kernel_w_vb15
.g2_kernel_w_bw:
  s_mov_b32 s38, 0
.g2_kernel_w_bwl:
  ds_read_b32 v16, v20 offset:12
  s_add_u32 s38, s38, 1
  s_waitcnt lgkmcnt(0)
  v_cmp_gt_u32 vcc, 4, v16
  s_cbranch_vccz .g2_kernel_w_bb
  s_cmp_lt_u32 s38, 524288
  s_cbranch_scc1 .g2_kernel_w_bwl
  s_branch .g2_kernel_w_bb
.g2_kernel_w_pick:
  s_mov_b32 s38, 0
.g2_kernel_w_pkl:
  ds_read_b64 v[6:7], v21
  s_add_u32 s38, s38, 1
  s_waitcnt lgkmcnt(0)
  v_min_u32 v6, v6, v7
  v_cmp_lt_u32 vcc, s62, v6
  s_and_b32 s36, vcc_lo, 0xff00
  s_andn2_b32 s33, s36, s34
  s_cbranch_scc1 .g2_kernel_w_pkr
  s_cmp_lt_u32 s38, 524288
  s_cbranch_scc1 .g2_kernel_w_pkl
  s_andn2_b32 s33, 0xff00, s34
.g2_kernel_w_pkr:
  s_setpc_b64 s[68:69]
.g2_kernel_p_spin:
  s_mov_b32 s38, 0
.g2_kernel_p_spinl:
  ds_read_b32 v10, v9
  s_add_u32 s38, s38, 1
  s_waitcnt lgkmcnt(0)
  v_cmp_gt_i32 vcc, s34, v10
  s_cbranch_vccz .g2_kernel_p_spinr
  s_sleep 1
  s_cmp_lt_u32 s38, 524288
  s_cbranch_scc1 .g2_kernel_p_spinl
.g2_kernel_p_spinr:
  s_setpc_b64 s[68:69]
.g2_kernel_p1_aw:
  s_call_b64 s[68:69], .g2_kernel_p_spin
  s_branch .g2_kernel_p1_ai
.g2_kernel_p1_bw:
  s_call_b64 s[68:69], .g2_kernel_p_spin
  s_branch .g2_kernel_p1_bi
.g2_kernel_v_3a:
  s_and_b32 s31, s76, 0xffffe000
  s_add_u32 s31, s31, 0
  v_and_b32 v6, 15, v2
  v_lshlrev_b32 v6, 9, v6
  v_lshrrev_b32 v7, 4, v2
  v_lshl_add_u32 v6, v7, 7, v6
  v_lshlrev_b32 v7, 2, v2
  v_add_u32 v7, 157440, v7
  s_mov_b32 m0, 157440
  s_mov_b32 s38, 0
  s_mov_b32 exec_lo, 0xffff0000
  s_mov_b32 exec_hi, 0xffff0000
.g2_kernel_pa22:
  buffer_load_dword v6, s[4:7], s31 offen sc1 lds
  s_add_u32 s38, s38, 1
  s_waitcnt vmcnt(0)
  ds_read_b32 v8, v7
  s_waitcnt lgkmcnt(0)
  v_cmp_ge_u32 vcc, s62, v8
  s_cbranch_vccz .g2_kernel_pa22d
  s_mov_b64 exec, vcc
  s_sleep 16
  s_cmp_lt_u32 s38, 131072
  s_cbranch_scc1 .g2_kernel_pa22
.g2_kernel_pa22d:
  s_mov_b64 exec, -1
  s_branch .g2_kernel_v_3
.g2_kernel_v_may:
  s_cmp_lg_u32 s39, 0
  s_cbranch_scc1 .g2_kernel_v_mr
  s_and_b32 s28, s16, 3
  s_lshl_b32 s28, s28, 4
  s_add_u32 s28, s28, 155968
  v_mov_b32 v6, s28
  ds_read_b32 v7, v6
  s_waitcnt lgkmcnt(0)
  v_cmp_ne_u32 vcc, 0, v7
  s_cbranch_vccz .g2_kernel_v_mr
.g2_kernel_v_do:
  s_mov_b32 s39, 1
  s_mov_b32 s29, 0
  s_call_b64 s[68:69], .g2_kernel_v_cmb
  s_waitcnt vmcnt(0)
  v_mov_b32 v6, s71
  s_mov_b64 exec, 1
  ds_add_u32 v6, v5 offset:8
  s_mov_b64 exec, -1
  s_and_b32 s33, s16, 3
  s_lshl_b32 s33, s33, 7
  s_lshl_b32 s28, s29, 2
  s_add_u32 s33, s33, s28
  s_add_u32 s31, s19, s33
  v_mov_b32 v6, s70
  s_mov_b64 exec, 1
  buffer_store_dword v6, v4, s[4:7], s31 offen offset:0 sc1
  s_mov_b64 exec, -1
.g2_kernel_v_mr:
  s_setpc_b64 s[26:27]
.g2_kernel_v_wo:
  s_mov_b32 s8, s44
  s_mov_b32 s9, s45
  s_mov_b32 s10, 0x200000
  s_mov_b32 s11, 0x00020000
  v_lshrrev_b32 v6, 3, v2
  v_and_b32 v7, 7, v2
  v_bfe_u32 v8, v2, 4, 1
  v_lshlrev_b32 v8, 2, v8
  v_xor_b32 v7, v7, v8
  v_lshlrev_b32 v7, 4, v7
  v_lshl_add_u32 v6, v6, 11, v7
  s_and_b32 s31, s16, 3
  s_lshl_b32 s31, s31, 3
  s_add_u32 s31, s31, s29
  s_lshl_b32 s31, s31, 16
  s_lshl_b32 s33, s18, 7
  s_add_u32 s31, s31, s33
  s_mov_b32 m0, s30
  s_nop 0
  buffer_load_dwordx4 v6, s[8:11], s31 offen lds
  s_add_u32 m0, m0, 1024
  s_add_u32 s31, s31, 16384
  s_sleep 1
  buffer_load_dwordx4 v6, s[8:11], s31 offen lds
  s_add_u32 m0, m0, 1024
  s_add_u32 s31, s31, 16384
  s_sleep 1
  buffer_load_dwordx4 v6, s[8:11], s31 offen lds
  s_add_u32 m0, m0, 1024
  s_add_u32 s31, s31, 16384
  s_sleep 1
  buffer_load_dwordx4 v6, s[8:11], s31 offen lds
  s_add_u32 m0, m0, 1024
  s_add_u32 s31, s31, 81920
  s_sleep 1
  buffer_load_dwordx4 v6, s[8:11], s31 offen lds
  s_add_u32 m0, m0, 1024
  s_add_u32 s31, s31, 16384
  s_sleep 1
  buffer_load_dwordx4 v6, s[8:11], s31 offen lds
  s_add_u32 m0, m0, 1024
  s_add_u32 s31, s31, 16384
  s_sleep 1
  buffer_load_dwordx4 v6, s[8:11], s31 offen lds
  s_add_u32 m0, m0, 1024
  s_add_u32 s31, s31, 16384
  s_sleep 1
  buffer_load_dwordx4 v6, s[8:11], s31 offen lds
  s_add_u32 m0, m0, 1024
  s_add_u32 s31, s31, 81920
  s_sleep 1
  buffer_load_dwordx4 v6, s[8:11], s31 offen lds
  s_add_u32 m0, m0, 1024
  s_add_u32 s31, s31, 16384
  s_sleep 1
  buffer_load_dwordx4 v6, s[8:11], s31 offen lds
  s_add_u32 m0, m0, 1024
  s_add_u32 s31, s31, 16384
  s_sleep 1
  buffer_load_dwordx4 v6, s[8:11], s31 offen lds
  s_add_u32 m0, m0, 1024
  s_add_u32 s31, s31, 16384
  s_sleep 1
  buffer_load_dwordx4 v6, s[8:11], s31 offen lds
  s_add_u32 m0, m0, 1024
  s_add_u32 s31, s31, 81920
  s_sleep 1
  buffer_load_dwordx4 v6, s[8:11], s31 offen lds
  s_add_u32 m0, m0, 1024
  s_add_u32 s31, s31, 16384
  s_sleep 1
  buffer_load_dwordx4 v6, s[8:11], s31 offen lds
  s_add_u32 m0, m0, 1024
  s_add_u32 s31, s31, 16384
  s_sleep 1
  buffer_load_dwordx4 v6, s[8:11], s31 offen lds
  s_add_u32 m0, m0, 1024
  s_add_u32 s31, s31, 16384
  s_sleep 1
  buffer_load_dwordx4 v6, s[8:11], s31 offen lds
  s_setpc_b64 s[68:69]
.g2_kernel_v_cmb:
  s_and_b32 s28, s16, 3
  s_lshl_b32 s30, s28, 2
  s_lshl_b32 s34, 15, s30
  s_lshr_b32 s32, s34, 4
  s_or_b32 s32, s32, s34
  s_mul_i32 s32, s32, s29
  v_and_b32 v6, 15, v2
  v_lshlrev_b32 v6, 2, v6
  v_add_u32 v6, 155968, v6
  s_mov_b32 s30, .g2_kernel_sel-.g2_kernel_pc
  buffer_load_dwordx4 v[8:11], v3, s[64:67], s30 offen
  buffer_load_dwordx4 v[12:15], v3, s[64:67], s30 offen offset:1024
  s_lshl_b32 s30, s28, 13
  v_add_u32 v0, s30, v3
  v_and_b32 v4, 31, v2
  s_lshl_b32 s31, s28, 9
  s_add_u32 s31, s31, 161280
  v_lshl_add_u32 v4, v4, 2, s31
  s_lshl_b32 s33, s62, 1
  s_add_u32 s33, s33, s29
  s_lshl_b32 s31, s17, 2
  s_add_u32 s31, s31, s28
  s_lshl_b32 s31, s31, 1
  s_add_u32 s31, s31, s29
  s_lshl_b32 s31, s31, 4
  s_add_u32 s31, s31, s18
  s_lshl_b32 s31, s31, 11
  s_add_u32 s31, s31, s63
  s_add_u32 s35, s31, 0x800000
  s_mov_b32 s38, 0
  s_waitcnt vmcnt(0)
.g2_kernel_v_cmbw:
  ds_read_b32 v7, v6
  s_add_u32 s38, s38, 1
  s_waitcnt lgkmcnt(0)
  v_cmp_ge_u32 vcc, s33, v7
  s_and_b32 s30, vcc_lo, s34
  s_cbranch_scc0 .g2_kernel_v_cmbd
  s_orn2_b32 s30, vcc_lo, s32
  s_cmp_lg_u32 s30, -1
  s_cbranch_scc1 .g2_kernel_v_cmbq
  s_sleep 6
.g2_kernel_v_cmbq:
  s_sleep 1
  s_cmp_lt_u32 s38, 524288
  s_cbranch_scc1 .g2_kernel_v_cmbw
.g2_kernel_v_cmbd:
  s_setprio 3
  ds_read_b128 v[32:35], v0 offset:0
  ds_read_b128 v[36:39], v0 offset:1024
  ds_read_b128 v[40:43], v0 offset:2048
  ds_read_b128 v[44:47], v0 offset:3072
  ds_read_b128 v[48:51], v0 offset:4096
  ds_read_b128 v[52:55], v0 offset:5120
  ds_read_b128 v[56:59], v0 offset:6144
  ds_read_b128 v[60:63], v0 offset:7168
  ds_read2_b32 v[6:7], v4 offset0:64 offset1:96
  ds_read2_b32 v[4:5], v4 offset0:0 offset1:32
  s_lshl_b32 s30, s28, 2
  s_add_u32 s30, s30, s71
  s_waitcnt lgkmcnt(9)
  v_mfma_f32_32x32x16_bf16 v[16:31], v[8:11], v[32:35], 0
  s_waitcnt lgkmcnt(8)
  v_mfma_f32_32x32x16_bf16 v[16:31], v[12:15], v[36:39], v[16:31]
  s_waitcnt lgkmcnt(7)
  v_mfma_f32_32x32x16_bf16 v[16:31], v[8:11], v[40:43], v[16:31]
  s_waitcnt lgkmcnt(6)
  v_mfma_f32_32x32x16_bf16 v[16:31], v[12:15], v[44:47], v[16:31]
  s_waitcnt lgkmcnt(5)
  v_mfma_f32_32x32x16_bf16 v[16:31], v[8:11], v[48:51], v[16:31]
  s_waitcnt lgkmcnt(4)
  v_mfma_f32_32x32x16_bf16 v[16:31], v[12:15], v[52:55], v[16:31]
  s_waitcnt lgkmcnt(3)
  v_mfma_f32_32x32x16_bf16 v[16:31], v[8:11], v[56:59], v[16:31]
  s_waitcnt lgkmcnt(2)
  v_mfma_f32_32x32x16_bf16 v[16:31], v[12:15], v[60:63], v[16:31]
  v_mov_b32 v0, s30
  s_waitcnt lgkmcnt(0)
  v_add_f32 v6, v6, v4
  v_add_f32 v7, v7, v5
  v_mov_b32 v4, 0
  v_mov_b32 v5, s29
  ds_write_b32 v0, v5 offset:64
  v_add_f32 v9, v6, v7
  s_mov_b32 s30, 8.673617379884035e-19
  s_mov_b32 s31, 1.152921504606847e+18
  v_rcp_f32 v10, v9
  v_cmp_le_f32 vcc, s30, v9
  v_cmp_ge_f32 s[36:37], s31, v9
  v_mov_b32 v5, 1
  v_mul_f32 v10, 4.0, v10
  s_and_b64 s[36:37], s[36:37], vcc
  v_cmp_o_f32 vcc, v16, v16
  s_and_b64 vcc, vcc, s[36:37]
  s_cmp_eq_u64 vcc, -1
  s_cbranch_scc0 .g2_kernel_v_cmbslow
.g2_kernel_v_cmbfin:
  v_mul_f32 v16, v16, v10
  v_mul_f32 v17, v17, v10
  v_mul_f32 v18, v18, v10
  v_mul_f32 v19, v19, v10
  v_mul_f32 v20, v20, v10
  v_mul_f32 v21, v21, v10
  v_mul_f32 v22, v22, v10
  v_mul_f32 v23, v23, v10
  v_cvt_pk_bf16_f32 v32, v16, v17
  v_cvt_pk_bf16_f32 v33, v18, v19
  v_cvt_pk_bf16_f32 v34, v20, v21
  v_cvt_pk_bf16_f32 v35, v22, v23
  v_max_u32 v32, 1, v32
  v_max_u32 v34, 1, v34
  buffer_store_dwordx4 v[32:35], v3, s[4:7], s35 offen offset:0 sc1
  v_mul_f32 v24, v24, v10
  v_mul_f32 v25, v25, v10
  v_mul_f32 v26, v26, v10
  v_mul_f32 v27, v27, v10
  v_mul_f32 v28, v28, v10
  v_mul_f32 v29, v29, v10
  v_mul_f32 v30, v30, v10
  v_mul_f32 v31, v31, v10
  v_cvt_pk_bf16_f32 v36, v24, v25
  v_cvt_pk_bf16_f32 v37, v26, v27
  v_cvt_pk_bf16_f32 v38, v28, v29
  v_cvt_pk_bf16_f32 v39, v30, v31
  v_max_u32 v36, 1, v36
  v_max_u32 v38, 1, v38
  buffer_store_dwordx4 v[36:39], v3, s[4:7], s35 offen offset:1024 sc1
  s_setprio 3
  s_setpc_b64 s[68:69]
.g2_kernel_v_cmbslow:
  s_setprio 0
  s_lshl_b32 s30, s28, 11
  s_mul_i32 s31, s29, -8192
  s_add_u32 s30, s30, s31
  s_add_u32 s30, s30, 139264
  v_add_u32 v6, s30, v3
  ds_read_b128 v[48:51], v6
  ds_read_b128 v[52:55], v6 offset:1024
  s_lshl_b32 s36, s18, 1
  s_add_u32 s36, s36, s29
  s_lshl_b32 s36, s36, 18
  s_add_u32 s36, s36, s63
  s_mov_b32 s30, s36
  s_mov_b32 s33, 64
  v_mov_b32 v10, 0xff800000
  s_waitcnt lgkmcnt(0)
.g2_kernel_v_cmbs1:
  buffer_load_dwordx4 v[56:59], v3, s[4:7], s30 offen offset:0
  buffer_load_dwordx4 v[60:63], v3, s[4:7], s30 offen offset:1024
  s_waitcnt vmcnt(0)
  v_mfma_f32_32x32x16_bf16 v[32:47], v[56:59], v[48:51], 0
  v_mfma_f32_32x32x16_bf16 v[32:47], v[60:63], v[52:55], v[32:47]
  s_nop 11
  v_max3_f32 v10, v10, v32, v33
  v_max3_f32 v10, v10, v34, v35
  v_max3_f32 v10, v10, v36, v37
  v_max3_f32 v10, v10, v38, v39
  v_max3_f32 v10, v10, v40, v41
  v_max3_f32 v10, v10, v42, v43
  v_max3_f32 v10, v10, v44, v45
  v_max3_f32 v10, v10, v46, v47
  s_add_u32 s30, s30, 4096
  s_sub_u32 s33, s33, 1
  s_cmp_lg_u32 s33, 0
  s_cbranch_scc1 .g2_kernel_v_cmbs1
  v_mov_b32 v11, v10
  s_nop 1
  v_permlane32_swap_b32 v11, v10
  v_max_f32 v10, v10, v11
  v_mov_b32 v9, 0
  v_mov_b32 v16, 0
  v_mov_b32 v17, 0
  v_mov_b32 v18, 0
  v_mov_b32 v19, 0
  v_mov_b32 v20, 0
  v_mov_b32 v21, 0
  v_mov_b32 v22, 0
  v_mov_b32 v23, 0
  v_mov_b32 v24, 0
  v_mov_b32 v25, 0
  v_mov_b32 v26, 0
  v_mov_b32 v27, 0
  v_mov_b32 v28, 0
  v_mov_b32 v29, 0
  v_mov_b32 v30, 0
  v_mov_b32 v31, 0
  s_mov_b32 s30, s36
  s_mov_b32 s33, 64
.g2_kernel_v_cmbs2:
  buffer_load_dwordx4 v[56:59], v3, s[4:7], s30 offen offset:0
  buffer_load_dwordx4 v[60:63], v3, s[4:7], s30 offen offset:1024
  s_waitcnt vmcnt(0)
  v_mfma_f32_32x32x16_bf16 v[32:47], v[56:59], v[48:51], 0
  v_mfma_f32_32x32x16_bf16 v[32:47], v[60:63], v[52:55], v[32:47]
  s_nop 11
  v_sub_f32 v32, v32, v10
  v_sub_f32 v33, v33, v10
  v_sub_f32 v34, v34, v10
  v_sub_f32 v35, v35, v10
  v_sub_f32 v36, v36, v10
  v_sub_f32 v37, v37, v10
  v_sub_f32 v38, v38, v10
  v_sub_f32 v39, v39, v10
  v_sub_f32 v40, v40, v10
  v_sub_f32 v41, v41, v10
  v_sub_f32 v42, v42, v10
  v_sub_f32 v43, v43, v10
  v_sub_f32 v44, v44, v10
  v_sub_f32 v45, v45, v10
  v_sub_f32 v46, v46, v10
  v_sub_f32 v47, v47, v10
  buffer_load_dwordx4 v[56:59], v3, s[4:7], s30 offen offset:2048
  buffer_load_dwordx4 v[60:63], v3, s[4:7], s30 offen offset:3072
  v_exp_f32 v32, v32
  v_exp_f32 v33, v33
  v_exp_f32 v34, v34
  v_exp_f32 v35, v35
  v_exp_f32 v36, v36
  v_exp_f32 v37, v37
  v_exp_f32 v38, v38
  v_exp_f32 v39, v39
  v_exp_f32 v40, v40
  v_exp_f32 v41, v41
  v_exp_f32 v42, v42
  v_exp_f32 v43, v43
  v_exp_f32 v44, v44
  v_exp_f32 v45, v45
  v_exp_f32 v46, v46
  v_exp_f32 v47, v47
  v_add_f32 v9, v9, v32
  v_add_f32 v9, v9, v33
  v_add_f32 v9, v9, v34
  v_add_f32 v9, v9, v35
  v_add_f32 v9, v9, v36
  v_add_f32 v9, v9, v37
  v_add_f32 v9, v9, v38
  v_add_f32 v9, v9, v39
  v_add_f32 v9, v9, v40
  v_add_f32 v9, v9, v41
  v_add_f32 v9, v9, v42
  v_add_f32 v9, v9, v43
  v_add_f32 v9, v9, v44
  v_add_f32 v9, v9, v45
  v_add_f32 v9, v9, v46
  v_add_f32 v9, v9, v47
  v_cvt_pk_bf16_f32 v32, v32, v33
  v_cvt_pk_bf16_f32 v33, v34, v35
  v_cvt_pk_bf16_f32 v34, v36, v37
  v_cvt_pk_bf16_f32 v35, v38, v39
  v_cvt_pk_bf16_f32 v36, v40, v41
  v_cvt_pk_bf16_f32 v37, v42, v43
  v_cvt_pk_bf16_f32 v38, v44, v45
  v_cvt_pk_bf16_f32 v39, v46, v47
  s_waitcnt vmcnt(0)
  v_mfma_f32_32x32x16_bf16 v[16:31], v[56:59], v[32:35], v[16:31]
  v_mfma_f32_32x32x16_bf16 v[16:31], v[60:63], v[36:39], v[16:31]
  s_nop 15
  s_add_u32 s30, s30, 4096
  s_sub_u32 s33, s33, 1
  s_cmp_lg_u32 s33, 0
  s_cbranch_scc1 .g2_kernel_v_cmbs2
  v_mov_b32 v11, v9
  s_nop 1
  v_permlane32_swap_b32 v11, v9
  v_add_f32 v9, v9, v11
  v_rcp_f32 v10, v9
  s_branch .g2_kernel_v_cmbfin
.g2_kernel_p2_xw:
  s_mov_b32 s38, 0
.g2_kernel_p2_xwl:
  ds_read_b32 v12, v11
  s_add_u32 s38, s38, 1
  s_waitcnt lgkmcnt(0)
  v_cmp_ne_u32 vcc, 0, v12
  s_and_b32 s37, vcc_lo, vcc_hi
  s_lshr_b32 s33, s37, 16
  s_and_b32 s37, s37, s33
  s_bitcmp1_b32 s37, s28
  s_cbranch_scc1 .g2_kernel_p2_xwr
  s_sleep 1
  s_cmp_lt_u32 s38, 524288
  s_cbranch_scc1 .g2_kernel_p2_xwl
.g2_kernel_p2_xwr:
  s_setpc_b64 s[68:69]
.g2_kernel_p2_x0w:
  s_call_b64 s[68:69], .g2_kernel_p2_xw
  s_branch .g2_kernel_p2_x0b
.g2_kernel_p2_x1w:
  s_call_b64 s[68:69], .g2_kernel_p2_xw
  s_branch .g2_kernel_p2_x1b
.g2_kernel_p2_x2w:
  s_call_b64 s[68:69], .g2_kernel_p2_xw
  s_branch .g2_kernel_p2_x2b
.g2_kernel_p2_aw:
  s_call_b64 s[68:69], .g2_kernel_p_spin
  s_branch .g2_kernel_p2_ai
.g2_kernel_p2_x3w:
  s_call_b64 s[68:69], .g2_kernel_p2_xw
  s_branch .g2_kernel_p2_x3b
.g2_kernel_p2_bw:
  s_call_b64 s[68:69], .g2_kernel_p_spin
  s_branch .g2_kernel_p2_bi
.g2_kernel_amax:
  v_mov_b32 v16, 0xff7fffff
  v_lshlrev_b32 v7, 7, v2
  s_mov_b32 s38, 0
  s_mov_b64 exec, s[8:9]
.g2_kernel_amaxl:
  buffer_load_dwordx2 v[16:17], v7, s[4:7], s23 offen sc1
  s_add_u32 s38, s38, 1
  s_waitcnt vmcnt(0)
  v_cmp_eq_u32 vcc, 0, v17
  s_cbranch_vccz .g2_kernel_amaxd
  s_mov_b64 exec, vcc
  s_sleep 4
  s_cmp_lg_u32 s62, 0
  s_cbranch_scc1 .g2_kernel_nap54
  s_sleep 8
.g2_kernel_nap54:
  s_cmp_eq_u32 s39, 1
  s_cbranch_scc0 .g2_kernel_amaxz
  s_sleep 8
.g2_kernel_amaxz:
  s_cmp_lt_u32 s38, 131072
  s_cbranch_scc1 .g2_kernel_amaxl
.g2_kernel_amaxd:
  s_mov_b64 exec, -1
  v_mov_b32 v6, v16
  s_nop 1
  v_max_f32 v7, v6, v6 row_ror:8 row_mask:0xf bank_mask:0xf
  s_nop 1
  v_max_f32 v7, v7, v7 row_ror:4 row_mask:0xf bank_mask:0xf
  s_nop 1
  v_max_f32 v7, v7, v7 row_ror:2 row_mask:0xf bank_mask:0xf
  s_nop 1
  v_max_f32 v7, v7, v7 row_ror:1 row_mask:0xf bank_mask:0xf
  s_nop 1
  v_max_f32 v7, v7, v7 row_bcast:15 row_mask:0xa bank_mask:0xf
  s_nop 1
  v_max_f32 v7, v7, v7 row_bcast:31 row_mask:0xc bank_mask:0xf
  s_nop 0
  v_readlane_b32 s27, v7, 63
  s_nop 1
  v_cmp_eq_u32 vcc, s27, v6
  s_ff1_i32_b64 s77, vcc
  s_lshl_b32 s77, s77, 5
  s_and_b32 s28, s27, 31
  s_add_u32 s77, s77, s28
  s_and_b32 s77, s77, 2047
  s_setpc_b64 s[68:69]
  .p2align 8
.g2_kernel_tab:
  .long 0, 1, 2, 3, 4, 5, 6, 7
  .long 8, 9, 10, 11, 12, 13, 14, 15
  .long 16, 17, 18, 19, 20, 21, 22, 23
  .long 24, 25, 26, 27, 28, 29, 30, 31
  .long 32, 33, 34, 35, 36, 37, 38, 39
  .long 40, 41, 42, 43, 44, 45, 46, 47
  .long 48, 49, 50, 51, 52, 53, 54, 55
  .long 56, 57, 58, 59, 60, 61, 62, 63
  .long 64, 65, 66, 67, 68, 69, 70, 71
  .p2align 4
.g2_kernel_sel:
  .long 0x3e80, 0x0, 0x0, 0x0
  .long 0x3e800000, 0x0, 0x0, 0x0
  .long 0x0, 0x3e80, 0x0, 0x0
  .long 0x0, 0x3e800000, 0x0, 0x0
  .long 0x0, 0x0, 0x0, 0x0
  .long 0x0, 0x0, 0x0, 0x0
  .long 0x0, 0x0, 0x0, 0x0
  .long 0x0, 0x0, 0x0, 0x0
  .long 0x0, 0x0, 0x3e80, 0x0
  .long 0x0, 0x0, 0x3e800000, 0x0
  .long 0x0, 0x0, 0x0, 0x3e80
  .long 0x0, 0x0, 0x0, 0x3e800000
  .long 0x0, 0x0, 0x0, 0x0
  .long 0x0, 0x0, 0x0, 0x0
  .long 0x0, 0x0, 0x0, 0x0
  .long 0x0, 0x0, 0x0, 0x0
  .long 0x0, 0x0, 0x0, 0x0
  .long 0x0, 0x0, 0x0, 0x0
  .long 0x0, 0x0, 0x0, 0x0
  .long 0x0, 0x0, 0x0, 0x0
  .long 0x0, 0x0, 0x0, 0x0
  .long 0x0, 0x0, 0x0, 0x0
  .long 0x0, 0x0, 0x0, 0x0
  .long 0x0, 0x0, 0x0, 0x0
  .long 0x0, 0x0, 0x0, 0x0
  .long 0x0, 0x0, 0x0, 0x0
  .long 0x0, 0x0, 0x0, 0x0
  .long 0x0, 0x0, 0x0, 0x0
  .long 0x0, 0x0, 0x0, 0x0
  .long 0x0, 0x0, 0x0, 0x0
  .long 0x0, 0x0, 0x0, 0x0
  .long 0x0, 0x0, 0x0, 0x0
  .long 0x0, 0x0, 0x0, 0x0
  .long 0x0, 0x0, 0x0, 0x0
  .long 0x0, 0x0, 0x0, 0x0
  .long 0x0, 0x0, 0x0, 0x0
  .long 0x3e80, 0x0, 0x0, 0x0
  .long 0x3e800000, 0x0, 0x0, 0x0
  .long 0x0, 0x3e80, 0x0, 0x0
  .long 0x0, 0x3e800000, 0x0, 0x0
  .long 0x0, 0x0, 0x0, 0x0
  .long 0x0, 0x0, 0x0, 0x0
  .long 0x0, 0x0, 0x0, 0x0
  .long 0x0, 0x0, 0x0, 0x0
  .long 0x0, 0x0, 0x3e80, 0x0
  .long 0x0, 0x0, 0x3e800000, 0x0
  .long 0x0, 0x0, 0x0, 0x3e80
  .long 0x0, 0x0, 0x0, 0x3e800000
  .long 0x0, 0x0, 0x0, 0x0
  .long 0x0, 0x0, 0x0, 0x0
  .long 0x0, 0x0, 0x0, 0x0
  .long 0x0, 0x0, 0x0, 0x0
  .long 0x0, 0x0, 0x0, 0x0
  .long 0x0, 0x0, 0x0, 0x0
  .long 0x0, 0x0, 0x0, 0x0
  .long 0x0, 0x0, 0x0, 0x0
  .long 0x0, 0x0, 0x0, 0x0
  .long 0x0, 0x0, 0x0, 0x0
  .long 0x0, 0x0, 0x0, 0x0
  .long 0x0, 0x0, 0x0, 0x0
  .long 0x0, 0x0, 0x0, 0x0
  .long 0x0, 0x0, 0x0, 0x0
  .long 0x0, 0x0, 0x0, 0x0
  .long 0x0, 0x0, 0x0, 0x0
  .long 0x0, 0x0, 0x0, 0x0
  .long 0x0, 0x0, 0x0, 0x0
  .long 0x0, 0x0, 0x0, 0x0
  .long 0x0, 0x0, 0x0, 0x0
  .long 0x0, 0x0, 0x0, 0x0
  .long 0x0, 0x0, 0x0, 0x0
  .long 0x0, 0x0, 0x0, 0x0
  .long 0x0, 0x0, 0x0, 0x0
  .long 0x0, 0x0, 0x0, 0x0
  .long 0x0, 0x0, 0x0, 0x0
  .long 0x0, 0x0, 0x0, 0x0
  .long 0x0, 0x0, 0x0, 0x0
  .long 0x0, 0x0, 0x0, 0x0
  .long 0x0, 0x0, 0x0, 0x0
  .long 0x0, 0x0, 0x0, 0x0
  .long 0x0, 0x0, 0x0, 0x0
  .long 0x3e80, 0x0, 0x0, 0x0
  .long 0x3e800000, 0x0, 0x0, 0x0
  .long 0x0, 0x3e80, 0x0, 0x0
  .long 0x0, 0x3e800000, 0x0, 0x0
  .long 0x0, 0x0, 0x0, 0x0
  .long 0x0, 0x0, 0x0, 0x0
  .long 0x0, 0x0, 0x0, 0x0
  .long 0x0, 0x0, 0x0, 0x0
  .long 0x0, 0x0, 0x3e80, 0x0
  .long 0x0, 0x0, 0x3e800000, 0x0
  .long 0x0, 0x0, 0x0, 0x3e80
  .long 0x0, 0x0, 0x0, 0x3e800000
  .long 0x0, 0x0, 0x0, 0x0
  .long 0x0, 0x0, 0x0, 0x0
  .long 0x0, 0x0, 0x0, 0x0
  .long 0x0, 0x0, 0x0, 0x0
  .long 0x0, 0x0, 0x0, 0x0
  .long 0x0, 0x0, 0x0, 0x0
  .long 0x0, 0x0, 0x0, 0x0
  .long 0x0, 0x0, 0x0, 0x0
  .long 0x0, 0x0, 0x0, 0x0
  .long 0x0, 0x0, 0x0, 0x0
  .long 0x0, 0x0, 0x0, 0x0
  .long 0x0, 0x0, 0x0, 0x0
  .long 0x0, 0x0, 0x0, 0x0
  .long 0x0, 0x0, 0x0, 0x0
  .long 0x0, 0x0, 0x0, 0x0
  .long 0x0, 0x0, 0x0, 0x0
  .long 0x0, 0x0, 0x0, 0x0
  .long 0x0, 0x0, 0x0, 0x0
  .long 0x0, 0x0, 0x0, 0x0
  .long 0x0, 0x0, 0x0, 0x0
  .long 0x0, 0x0, 0x0, 0x0
  .long 0x0, 0x0, 0x0, 0x0
  .long 0x0, 0x0, 0x0, 0x0
  .long 0x0, 0x0, 0x0, 0x0
  .long 0x3e80, 0x0, 0x0, 0x0
  .long 0x3e800000, 0x0, 0x0, 0x0
  .long 0x0, 0x3e80, 0x0, 0x0
  .long 0x0, 0x3e800000, 0x0, 0x0
  .long 0x0, 0x0, 0x0, 0x0
  .long 0x0, 0x0, 0x0, 0x0
  .long 0x0, 0x0, 0x0, 0x0
  .long 0x0, 0x0, 0x0, 0x0
  .long 0x0, 0x0, 0x3e80, 0x0
  .long 0x0, 0x0, 0x3e800000, 0x0
  .long 0x0, 0x0, 0x0, 0x3e80
  .long 0x0, 0x0, 0x0, 0x3e800000
.g2_kernel_cend:

.section .rodata,"a"
.p2align 6
.amdhsa_kernel g2_kernel
  .amdhsa_next_free_vgpr 256
  .amdhsa_next_free_sgpr 102
  .amdhsa_accum_offset 256
  .amdhsa_group_segment_fixed_size 0
  .amdhsa_kernarg_size 88
  .amdhsa_user_sgpr_count 2
  .amdhsa_user_sgpr_kernarg_segment_ptr 1
  .amdhsa_system_sgpr_workgroup_id_x 1
.end_amdhsa_kernel
```

```asm
; @launch kernel=g2_kernel grid=(256,1,1) block=(512,1,1) lds=163840
.amdgcn_target "amdgcn-amd-amdhsa--gfx950"
.text
.globl g2_kernel
.p2align 8
.type g2_kernel,@function
g2_kernel:
  s_cmp_ge_u32 s2, 256
  s_cbranch_scc1 .g2_kernel_end
  s_load_dwordx16 s[40:55], s[0:1], 0
  s_load_dwordx4 s[56:59], s[0:1], 64
  s_load_dwordx2 s[60:61], s[0:1], 80
  s_getpc_b64 s[64:65]
.g2_kernel_pc:
  s_mov_b32 s66, .g2_kernel_cend-.g2_kernel_pc
  s_mov_b32 s67, 0x00020000
  s_lshl_b32 s12, s2, 10
  s_and_b32 s12, s12, 0xe000
  v_lshrrev_b32 v3, 3, v0
  v_and_b32 v2, 7, v0
  v_and_b32 v3, 0x38, v3
  v_add_lshl_u32 v3, v3, v2, 7
  s_mov_b64 exec, 0xff
  buffer_load_dword v1, v3, s[64:67], s12 offen
  s_mov_b64 exec, -1
  v_lshrrev_b32 v3, 6, v0
  v_and_b32 v2, 63, v0
  v_readfirstlane_b32 s16, v3
  s_and_b32 s21, s2, 7
  s_lshr_b32 s22, s2, 3
  s_and_b32 s23, s21, 3
  s_lshl_b32 s23, s23, 2
  s_and_b32 s24, s22, 3
  s_add_u32 s18, s23, s24
  s_lshr_b32 s24, s21, 2
  s_lshl_b32 s24, s24, 3
  s_lshr_b32 s25, s22, 2
  s_add_u32 s17, s24, s25
  s_lshl_b32 s19, s17, 4
  s_add_u32 s19, s19, s18
  s_lshl_b32 s19, s19, 9
  s_add_u32 s19, s19, 0x3000000
  s_lshl_b32 s76, s18, 4
  s_add_u32 s76, s76, s17
  s_lshl_b32 s76, s76, 9
  s_add_u32 s76, s76, 0x3020000
  v_lshlrev_b32 v3, 4, v2
  v_mov_b32 v4, 0
  v_mov_b32 v5, 1
  s_mov_b32 s62, 0
  s_mov_b32 s63, 0
  s_mov_b32 s70, 1
  s_mov_b32 s71, 155648
  s_waitcnt lgkmcnt(0)
  s_mov_b32 s4, s60
  s_mov_b32 s5, s61
  s_mov_b32 s6, 0x3300000
  s_mov_b32 s7, 0x00020000
  s_cmp_ge_u32 s16, 4
  s_cbranch_scc1 .g2_kernel_svc
  v_mov_b32 v20, 0
  v_mov_b32 v21, 0
  v_mov_b32 v22, 0
  v_mov_b32 v23, 0
  v_lshlrev_b32 v24, 4, v0
  v_cmp_gt_u32 vcc, 2816, v24
  v_add_u32 v24, 155648, v24
  s_and_saveexec_b64 s[20:21], vcc
  s_cbranch_execz .g2_kernel_q_nz
  ds_write_b128 v24, v[20:23]
.g2_kernel_q_nz:
  s_mov_b64 exec, -1
  v_and_b32 v20, 15, v2
  v_lshrrev_b32 v21, 4, v2
  v_lshrrev_b32 v22, 1, v20
  v_xor_b32 v22, v22, v21
  v_lshlrev_b32 v22, 4, v22
  v_lshl_add_u32 v22, v20, 7, v22
  s_lshr_b32 s26, s16, 1
  s_lshl_b32 s26, s26, 13
  v_add_u32 v144, s26, v22
  v_xor_b32 v145, 64, v144
.g2_kernel_q_cs:
  s_and_b32 s27, s16, 1
  s_lshr_b32 s26, s16, 1
  v_bfe_u32 v20, v2, 2, 2
  v_lshrrev_b32 v49, 4, v2
  v_lshl_add_u32 v22, v49, 3, v20
  v_lshlrev_b32 v22, 7, v22
  v_lshrrev_b32 v23, 1, v20
  v_and_b32 v21, 1, v49
  v_xor_b32 v21, s27, v21
  v_lshl_add_u32 v23, v21, 1, v23
  v_lshl_add_u32 v22, v23, 5, v22
  v_and_b32 v23, 3, v2
  v_lshl_add_u32 v22, v23, 3, v22
  v_add_u32 v148, 65536, v22
  v_xor_b32 v149, 32, v148
  v_mov_b32 v146, v148
  v_mov_b32 v147, v149
  v_mov_b32 v150, 156160
  v_and_b32 v48, 15, v2
  s_lshl_b32 s28, s26, 8
  s_add_u32 s28, s28, 155648
  v_lshl_add_u32 v50, v48, 2, s28
  v_lshl_add_u32 v51, v49, 4, s28
  s_lshl_b32 s28, s27, 7
  s_add_u32 s28, s28, 155648
  v_lshl_add_u32 v52, v49, 4, s28
  v_lshl_add_u32 v53, v48, 2, s28
  v_lshlrev_b32 v54, 9, v49
  v_lshl_add_u32 v55, v48, 4, v54
  v_and_b32 v56, 8, v48
  v_lshl_add_u32 v54, v56, 4, v55
  v_mov_b32 v56, 0.25503486164919736
  v_lshlrev_b32 v58, 2, v2
  v_and_b32 v58, 12, v58
  v_add_u32 v58, 156416, v58
  s_lshl_b32 s8, s18, 1
  s_add_u32 s8, s8, s27
  s_lshl_b32 s8, s8, 6
  s_lshl_b32 s9, s17, 2
  s_add_u32 s8, s8, s9
  s_lshl_b32 s9, s26, 1
  s_add_u32 s8, s8, s9
  s_lshl_b32 s8, s8, 12
  s_add_u32 s8, s8, s63
  s_add_u32 s9, s8, 4096
  s_lshl_b32 s28, s26, 13
  s_lshl_b32 s10, s27, 14
  s_add_u32 s28, s28, s10
  v_add_u32 v59, s28, v54
  v_add_u32 v60, s28, v55
  s_lshl_b32 s28, s26, 12
  s_mul_i32 s10, s27, -8192
  s_add_u32 s28, s28, s10
  s_add_u32 s28, s28, 139264
  v_add_u32 v61, s28, v55
  s_mov_b32 s10, s27
  s_lshl_b32 s77, s18, 4
  s_add_u32 s77, s77, s17
  s_lshl_b32 s77, s77, 1
  s_add_u32 s77, s77, s26
  s_lshl_b32 s77, s77, 13
  s_add_u32 s77, s77, s63
  s_add_u32 s77, s77, 0x1400000
  s_lshl_b32 s28, s27, 30
  s_add_u32 s77, s77, s28
  s_lshl_b32 s12, s62, 5
  s_add_u32 s12, s12, 28
  v_and_b32 v6, 15, v2
  v_xor_b32 v6, s17, v6
  v_and_b32 v7, 16, v2
  v_add_u32 v6, v6, v7
  s_lshr_b32 s28, s16, 1
  s_lshl_b32 s28, s28, 7
  s_add_u32 s28, s28, 157440
  v_lshl_add_u32 v8, v6, 2, s28
  s_lshl_b32 s28, s16, 12
  v_add_u32 v9, s28, v3
  v_and_b32 v6, 31, v2
  s_lshl_b32 s28, s16, 7
  s_add_u32 s28, s28, 161280
  v_lshl_add_u32 v10, v6, 2, s28
  s_lshl_b32 s28, s16, 2
  s_add_u32 s28, s28, 155968
  v_mov_b32 v11, s28
  s_lshl_b32 s28, s62, 1
  s_add_u32 s28, s28, 1
  v_mov_b32 v12, s28
  v_mov_b32 v13, s71
  v_add_u32 v14, 131072, v3
  v_and_b32 v6, 4, v2
  v_cmp_eq_u32 vcc, 0, v6
  v_mov_b32 v7, 0x3f803f80
  v_and_b32 v6, 1, v2
  v_cndmask_b32 v16, 0, v7, vcc
  v_cndmask_b32 v17, 0, v7, vcc
  v_cndmask_b32 v18, v7, 0, vcc
  v_cndmask_b32 v19, v7, 0, vcc
  v_mul_u32_u24 v20, 0xaaaa, v6
  v_add_u32 v20, 0x4444, v20
  s_lshl_b32 s28, s18, 7
  s_add_u32 s28, s28, s16
  s_lshl_b32 s28, s28, 12
  s_add_u32 s28, s28, s63
  s_add_u32 s20, s60, s28
  s_addc_u32 s21, s61, 0
  s_mov_b32 s24, s17
  s_mov_b32 s25, 14
  s_mov_b32 s26, 0
  s_mov_b32 s27, 6
  s_mov_b32 s34, 0xffff0001
  s_mov_b32 s35, 0
  s_mov_b32 s36, 0
  s_mov_b32 s39, 0
  s_lshl_b32 s28, s16, 7
  s_add_u32 s37, s76, s28
  v_mov_b32 v15, s70
  v_lshrrev_b32 v6, 5, v2
  v_and_b32 v7, 15, v2
  v_lshlrev_b32 v22, 4, v7
  v_lshl_add_u32 v22, v6, 8, v22
  v_and_b32 v7, 16, v2
  v_lshl_add_u32 v22, v7, 7, v22
  v_and_b32 v7, 31, v2
  v_lshlrev_b32 v23, 4, v6
  v_lshl_add_u32 v23, v7, 11, v23
  s_lshl_b32 s28, s17, 2
  s_add_u32 s28, s28, s16
  s_lshl_b32 s28, s28, 16
  s_lshl_b32 s29, s18, 7
  s_add_u32 s28, s28, s29
  s_add_u32 s74, s40, s28
  s_addc_u32 s75, s41, 0
  s_lshl_b32 s13, s17, 4
  s_add_u32 s13, s13, s18
  s_lshl_b32 s13, s13, 2
  s_add_u32 s13, s13, s16
  s_lshl_b32 s13, s13, 12
  s_add_u32 s13, s13, 0xc00000
  s_lshl_b32 s28, s16, 2
  s_add_u32 m0, s28, 156416
  s_lshl_b32 s33, s62, 5
  s_lshl_b32 s31, s33, 2
  s_add_u32 s31, s31, .g2_kernel_tab-.g2_kernel_pc+4
  s_mov_b32 s29, 0
  s_cmp_lg_u32 s62, 0
  s_cbranch_scc1 .g2_kernel_q_i2
  s_waitcnt lgkmcnt(0)
  s_barrier
.g2_kernel_q_i3:
  s_call_b64 s[68:69], .g2_kernel_q_spin
  ds_read_b64_tr_b16 v[80:81], v146 offset:0
  ds_read_b64_tr_b16 v[82:83], v146 offset:512
  ds_read_b128 v[64:67], v144 offset:0
  ds_read_b128 v[68:71], v144 offset:2048
  ds_read_b128 v[72:75], v144 offset:4096
  ds_read_b128 v[76:79], v144 offset:6144
  ds_read_b64_tr_b16 v[84:85], v147 offset:0
  ds_read_b64_tr_b16 v[86:87], v147 offset:512
  ds_read_b64_tr_b16 v[88:89], v146 offset:4096
  ds_read_b64_tr_b16 v[90:91], v146 offset:4608
  ds_read_b64_tr_b16 v[92:93], v147 offset:4096
  ds_read_b64_tr_b16 v[94:95], v147 offset:4608
  ds_read_b64_tr_b16 v[96:97], v146 offset:8192
  ds_read_b64_tr_b16 v[98:99], v146 offset:8704
  ds_read_b64_tr_b16 v[100:101], v147 offset:8192
  ds_read_b64_tr_b16 v[102:103], v147 offset:8704
  s_mov_b32 s30, 12288
  s_add_u32 s33, s33, 1
  v_add_u32 v146, s30, v148
  v_add_u32 v147, s30, v149
  s_waitcnt lgkmcnt(0)
  v_mfma_f32_16x16x32_bf16 v[160:163], v[80:83], v[64:67], 0
  v_cmp_lt_i32 vcc, s33, v151
  v_mfma_f32_16x16x32_bf16 v[164:167], v[80:83], v[68:71], 0
  s_cbranch_vccz .g2_kernel_q_wf
.g2_kernel_q_backf:
  v_mfma_f32_16x16x32_bf16 v[168:171], v[80:83], v[72:75], 0
  ds_read_b64_tr_b16 v[120:121], v146 offset:0
  v_mfma_f32_16x16x32_bf16 v[172:175], v[80:83], v[76:79], 0
  ds_read_b64_tr_b16 v[122:123], v146 offset:512
  v_mfma_f32_16x16x32_bf16 v[188:191], v[84:87], v[76:79], 0
  ds_read_b128 v[104:107], v145 offset:0
  v_mfma_f32_16x16x32_bf16 v[184:187], v[84:87], v[72:75], 0
  ds_read_b128 v[108:111], v145 offset:2048
  v_mfma_f32_16x16x32_bf16 v[180:183], v[84:87], v[68:71], 0
  ds_read_b128 v[112:115], v145 offset:4096
  v_mfma_f32_16x16x32_bf16 v[176:179], v[84:87], v[64:67], 0
  ds_read_b128 v[116:119], v145 offset:6144
  v_mfma_f32_16x16x32_bf16 v[192:195], v[88:91], v[64:67], 0
  ds_read_b64_tr_b16 v[124:125], v147 offset:0
  v_mfma_f32_16x16x32_bf16 v[196:199], v[88:91], v[68:71], 0
  ds_read_b64_tr_b16 v[126:127], v147 offset:512
  v_mfma_f32_16x16x32_bf16 v[200:203], v[88:91], v[72:75], 0
  ds_read_b64_tr_b16 v[128:129], v146 offset:4096
  v_mfma_f32_16x16x32_bf16 v[204:207], v[88:91], v[76:79], 0
  ds_read_b64_tr_b16 v[130:131], v146 offset:4608
  v_mfma_f32_16x16x32_bf16 v[220:223], v[92:95], v[76:79], 0
  ds_read_b64_tr_b16 v[132:133], v147 offset:4096
  v_mfma_f32_16x16x32_bf16 v[216:219], v[92:95], v[72:75], 0
  ds_read_b64_tr_b16 v[134:135], v147 offset:4608
  v_mfma_f32_16x16x32_bf16 v[212:215], v[92:95], v[68:71], 0
  ds_read_b64_tr_b16 v[136:137], v146 offset:8192
  v_mfma_f32_16x16x32_bf16 v[208:211], v[92:95], v[64:67], 0
  ds_read_b64_tr_b16 v[138:139], v146 offset:8704
  v_mfma_f32_16x16x32_bf16 v[224:227], v[64:67], v[96:99], 0
  ds_read_b64_tr_b16 v[140:141], v147 offset:8192
  v_mfma_f32_16x16x32_bf16 v[228:231], v[68:71], v[96:99], 0
  ds_read_b64_tr_b16 v[142:143], v147 offset:8704
  v_mfma_f32_16x16x32_bf16 v[232:235], v[72:75], v[96:99], 0
  ds_read_b32 v151, v150
  s_add_u32 s30, s30, 12288
  v_mfma_f32_16x16x32_bf16 v[236:239], v[76:79], v[96:99], 0
  s_mov_b64 exec, 1
  buffer_load_dword off, s[64:67], s31 lds
  s_mov_b64 exec, -1
  s_cmp_eq_u32 s30, 86016
  v_mfma_f32_16x16x32_bf16 v[252:255], v[76:79], v[100:103], 0
  s_cselect_b32 s30, 0, s30
  s_add_u32 s31, s31, 4
  v_mfma_f32_16x16x32_bf16 v[248:251], v[72:75], v[100:103], 0
  v_add_u32 v146, s30, v148
  s_add_u32 s33, s33, 1
  v_mfma_f32_16x16x32_bf16 v[244:247], v[68:71], v[100:103], 0
  v_add_u32 v147, s30, v149
  v_mfma_f32_16x16x32_bf16 v[240:243], v[64:67], v[100:103], 0
  s_branch .g2_kernel_q_s1
  .p2align 6
.g2_kernel_q_loop:
  s_waitcnt lgkmcnt(0)
  v_mfma_f32_16x16x32_bf16 v[160:163], v[120:123], v[104:107], v[160:163]
  v_cmp_lt_i32 vcc, s33, v151
  v_mfma_f32_16x16x32_bf16 v[164:167], v[120:123], v[108:111], v[164:167]
  s_cbranch_vccz .g2_kernel_q_w7
.g2_kernel_q_back7:
  v_mfma_f32_16x16x32_bf16 v[168:171], v[120:123], v[112:115], v[168:171]
  ds_read_b64_tr_b16 v[80:81], v146 offset:0
  v_mfma_f32_16x16x32_bf16 v[172:175], v[120:123], v[116:119], v[172:175]
  ds_read_b64_tr_b16 v[82:83], v146 offset:512
  v_mfma_f32_16x16x32_bf16 v[188:191], v[124:127], v[116:119], v[188:191]
  ds_read_b128 v[64:67], v144 offset:0
  v_mfma_f32_16x16x32_bf16 v[184:187], v[124:127], v[112:115], v[184:187]
  ds_read_b128 v[68:71], v144 offset:2048
  v_mfma_f32_16x16x32_bf16 v[180:183], v[124:127], v[108:111], v[180:183]
  ds_read_b128 v[72:75], v144 offset:4096
  v_mfma_f32_16x16x32_bf16 v[176:179], v[124:127], v[104:107], v[176:179]
  ds_read_b128 v[76:79], v144 offset:6144
  v_mfma_f32_16x16x32_bf16 v[192:195], v[128:131], v[104:107], v[192:195]
  ds_read_b64_tr_b16 v[84:85], v147 offset:0
  v_mfma_f32_16x16x32_bf16 v[196:199], v[128:131], v[108:111], v[196:199]
  ds_read_b64_tr_b16 v[86:87], v147 offset:512
  v_mfma_f32_16x16x32_bf16 v[200:203], v[128:131], v[112:115], v[200:203]
  ds_read_b64_tr_b16 v[88:89], v146 offset:4096
  v_mfma_f32_16x16x32_bf16 v[204:207], v[128:131], v[116:119], v[204:207]
  ds_read_b64_tr_b16 v[90:91], v146 offset:4608
  v_mfma_f32_16x16x32_bf16 v[220:223], v[132:135], v[116:119], v[220:223]
  ds_read_b64_tr_b16 v[92:93], v147 offset:4096
  v_mfma_f32_16x16x32_bf16 v[216:219], v[132:135], v[112:115], v[216:219]
  ds_read_b64_tr_b16 v[94:95], v147 offset:4608
  v_mfma_f32_16x16x32_bf16 v[212:215], v[132:135], v[108:111], v[212:215]
  ds_read_b64_tr_b16 v[96:97], v146 offset:8192
  v_mfma_f32_16x16x32_bf16 v[208:211], v[132:135], v[104:107], v[208:211]
  ds_read_b64_tr_b16 v[98:99], v146 offset:8704
  v_mfma_f32_16x16x32_bf16 v[224:227], v[104:107], v[136:139], v[224:227]
  ds_read_b64_tr_b16 v[100:101], v147 offset:8192
  v_mfma_f32_16x16x32_bf16 v[228:231], v[108:111], v[136:139], v[228:231]
  ds_read_b64_tr_b16 v[102:103], v147 offset:8704
  v_mfma_f32_16x16x32_bf16 v[232:235], v[112:115], v[136:139], v[232:235]
  ds_read_b32 v151, v150
  s_add_u32 s30, s30, 12288
  v_mfma_f32_16x16x32_bf16 v[236:239], v[116:119], v[136:139], v[236:239]
  s_mov_b64 exec, 1
  buffer_load_dword off, s[64:67], s31 lds
  s_mov_b64 exec, -1
  s_cmp_eq_u32 s30, 86016
  v_mfma_f32_16x16x32_bf16 v[252:255], v[116:119], v[140:143], v[252:255]
  s_cselect_b32 s30, 0, s30
  s_add_u32 s31, s31, 4
  v_mfma_f32_16x16x32_bf16 v[248:251], v[112:115], v[140:143], v[248:251]
  v_add_u32 v146, s30, v148
  s_add_u32 s33, s33, 1
  v_mfma_f32_16x16x32_bf16 v[244:247], v[108:111], v[140:143], v[244:247]
  v_add_u32 v147, s30, v149
  v_mfma_f32_16x16x32_bf16 v[240:243], v[104:107], v[140:143], v[240:243]
  s_waitcnt lgkmcnt(0)
  v_mfma_f32_16x16x32_bf16 v[160:163], v[80:83], v[64:67], v[160:163]
  v_cmp_lt_i32 vcc, s33, v151
  v_mfma_f32_16x16x32_bf16 v[164:167], v[80:83], v[68:71], v[164:167]
  s_cbranch_vccz .g2_kernel_q_w0
.g2_kernel_q_back0:
  v_mfma_f32_16x16x32_bf16 v[168:171], v[80:83], v[72:75], v[168:171]
  ds_read_b64_tr_b16 v[120:121], v146 offset:0
  v_mfma_f32_16x16x32_bf16 v[172:175], v[80:83], v[76:79], v[172:175]
  ds_read_b64_tr_b16 v[122:123], v146 offset:512
  v_mfma_f32_16x16x32_bf16 v[188:191], v[84:87], v[76:79], v[188:191]
  ds_read_b128 v[104:107], v145 offset:0
  v_mfma_f32_16x16x32_bf16 v[184:187], v[84:87], v[72:75], v[184:187]
  ds_read_b128 v[108:111], v145 offset:2048
  v_mfma_f32_16x16x32_bf16 v[180:183], v[84:87], v[68:71], v[180:183]
  ds_read_b128 v[112:115], v145 offset:4096
  v_mfma_f32_16x16x32_bf16 v[176:179], v[84:87], v[64:67], v[176:179]
  ds_read_b128 v[116:119], v145 offset:6144
  v_mfma_f32_16x16x32_bf16 v[192:195], v[88:91], v[64:67], v[192:195]
  ds_read_b64_tr_b16 v[124:125], v147 offset:0
  v_mfma_f32_16x16x32_bf16 v[196:199], v[88:91], v[68:71], v[196:199]
  ds_read_b64_tr_b16 v[126:127], v147 offset:512
  v_mfma_f32_16x16x32_bf16 v[200:203], v[88:91], v[72:75], v[200:203]
  ds_read_b64_tr_b16 v[128:129], v146 offset:4096
  v_mfma_f32_16x16x32_bf16 v[204:207], v[88:91], v[76:79], v[204:207]
  ds_read_b64_tr_b16 v[130:131], v146 offset:4608
  v_mfma_f32_16x16x32_bf16 v[220:223], v[92:95], v[76:79], v[220:223]
  ds_read_b64_tr_b16 v[132:133], v147 offset:4096
  v_mfma_f32_16x16x32_bf16 v[216:219], v[92:95], v[72:75], v[216:219]
  ds_read_b64_tr_b16 v[134:135], v147 offset:4608
  v_mfma_f32_16x16x32_bf16 v[212:215], v[92:95], v[68:71], v[212:215]
  ds_read_b64_tr_b16 v[136:137], v146 offset:8192
  v_mfma_f32_16x16x32_bf16 v[208:211], v[92:95], v[64:67], v[208:211]
  ds_read_b64_tr_b16 v[138:139], v146 offset:8704
  v_mfma_f32_16x16x32_bf16 v[224:227], v[64:67], v[96:99], v[224:227]
  ds_read_b64_tr_b16 v[140:141], v147 offset:8192
  v_mfma_f32_16x16x32_bf16 v[228:231], v[68:71], v[96:99], v[228:231]
  ds_read_b64_tr_b16 v[142:143], v147 offset:8704
  v_mfma_f32_16x16x32_bf16 v[232:235], v[72:75], v[96:99], v[232:235]
  ds_read_b32 v151, v150
  s_add_u32 s30, s30, 12288
  v_mfma_f32_16x16x32_bf16 v[236:239], v[76:79], v[96:99], v[236:239]
  s_mov_b64 exec, 1
  buffer_load_dword off, s[64:67], s31 lds
  s_mov_b64 exec, -1
  s_cmp_eq_u32 s30, 86016
  v_mfma_f32_16x16x32_bf16 v[252:255], v[76:79], v[100:103], v[252:255]
  s_cselect_b32 s30, 0, s30
  s_add_u32 s31, s31, 4
  v_mfma_f32_16x16x32_bf16 v[248:251], v[72:75], v[100:103], v[248:251]
  v_add_u32 v146, s30, v148
  s_add_u32 s33, s33, 1
  v_mfma_f32_16x16x32_bf16 v[244:247], v[68:71], v[100:103], v[244:247]
  v_add_u32 v147, s30, v149
  v_mfma_f32_16x16x32_bf16 v[240:243], v[64:67], v[100:103], v[240:243]
.g2_kernel_q_s1:
  s_waitcnt lgkmcnt(0)
  v_mfma_f32_16x16x32_bf16 v[160:163], v[120:123], v[104:107], v[160:163]
  v_cmp_lt_i32 vcc, s33, v151
  v_mfma_f32_16x16x32_bf16 v[164:167], v[120:123], v[108:111], v[164:167]
  s_cbranch_vccz .g2_kernel_q_w1
.g2_kernel_q_back1:
  v_mfma_f32_16x16x32_bf16 v[168:171], v[120:123], v[112:115], v[168:171]
  ds_read_b64_tr_b16 v[80:81], v146 offset:0
  v_mfma_f32_16x16x32_bf16 v[172:175], v[120:123], v[116:119], v[172:175]
  ds_read_b64_tr_b16 v[82:83], v146 offset:512
  v_mfma_f32_16x16x32_bf16 v[188:191], v[124:127], v[116:119], v[188:191]
  ds_read_b128 v[64:67], v144 offset:16384
  v_mfma_f32_16x16x32_bf16 v[184:187], v[124:127], v[112:115], v[184:187]
  ds_read_b128 v[68:71], v144 offset:18432
  v_mfma_f32_16x16x32_bf16 v[180:183], v[124:127], v[108:111], v[180:183]
  ds_read_b128 v[72:75], v144 offset:20480
  v_mfma_f32_16x16x32_bf16 v[176:179], v[124:127], v[104:107], v[176:179]
  ds_read_b128 v[76:79], v144 offset:22528
  v_mfma_f32_16x16x32_bf16 v[192:195], v[128:131], v[104:107], v[192:195]
  ds_read_b64_tr_b16 v[84:85], v147 offset:0
  v_mfma_f32_16x16x32_bf16 v[196:199], v[128:131], v[108:111], v[196:199]
  ds_read_b64_tr_b16 v[86:87], v147 offset:512
  v_mfma_f32_16x16x32_bf16 v[200:203], v[128:131], v[112:115], v[200:203]
  ds_read_b64_tr_b16 v[88:89], v146 offset:4096
  v_mfma_f32_16x16x32_bf16 v[204:207], v[128:131], v[116:119], v[204:207]
  ds_read_b64_tr_b16 v[90:91], v146 offset:4608
  v_mfma_f32_16x16x32_bf16 v[220:223], v[132:135], v[116:119], v[220:223]
  ds_read_b64_tr_b16 v[92:93], v147 offset:4096
  v_mfma_f32_16x16x32_bf16 v[216:219], v[132:135], v[112:115], v[216:219]
  ds_read_b64_tr_b16 v[94:95], v147 offset:4608
  v_mfma_f32_16x16x32_bf16 v[212:215], v[132:135], v[108:111], v[212:215]
  ds_read_b64_tr_b16 v[96:97], v146 offset:8192
  v_mfma_f32_16x16x32_bf16 v[208:211], v[132:135], v[104:107], v[208:211]
  ds_read_b64_tr_b16 v[98:99], v146 offset:8704
  v_mfma_f32_16x16x32_bf16 v[224:227], v[104:107], v[136:139], v[224:227]
  ds_read_b64_tr_b16 v[100:101], v147 offset:8192
  v_mfma_f32_16x16x32_bf16 v[228:231], v[108:111], v[136:139], v[228:231]
  ds_read_b64_tr_b16 v[102:103], v147 offset:8704
  v_mfma_f32_16x16x32_bf16 v[232:235], v[112:115], v[136:139], v[232:235]
  ds_read_b32 v151, v150
  s_add_u32 s30, s30, 12288
  v_mfma_f32_16x16x32_bf16 v[236:239], v[116:119], v[136:139], v[236:239]
  s_mov_b64 exec, 1
  buffer_load_dword off, s[64:67], s31 lds
  s_mov_b64 exec, -1
  s_cmp_eq_u32 s30, 86016
  v_mfma_f32_16x16x32_bf16 v[252:255], v[116:119], v[140:143], v[252:255]
  s_cselect_b32 s30, 0, s30
  s_add_u32 s31, s31, 4
  v_mfma_f32_16x16x32_bf16 v[248:251], v[112:115], v[140:143], v[248:251]
  v_add_u32 v146, s30, v148
  s_add_u32 s33, s33, 1
  v_mfma_f32_16x16x32_bf16 v[244:247], v[108:111], v[140:143], v[244:247]
  v_add_u32 v147, s30, v149
  v_mfma_f32_16x16x32_bf16 v[240:243], v[104:107], v[140:143], v[240:243]
  s_waitcnt lgkmcnt(0)
  v_mfma_f32_16x16x32_bf16 v[160:163], v[80:83], v[64:67], v[160:163]
  v_cmp_lt_i32 vcc, s33, v151
  v_mfma_f32_16x16x32_bf16 v[164:167], v[80:83], v[68:71], v[164:167]
  s_cbranch_vccz .g2_kernel_q_w2
.g2_kernel_q_back2:
  v_mfma_f32_16x16x32_bf16 v[168:171], v[80:83], v[72:75], v[168:171]
  ds_read_b64_tr_b16 v[120:121], v146 offset:0
  v_mfma_f32_16x16x32_bf16 v[172:175], v[80:83], v[76:79], v[172:175]
  ds_read_b64_tr_b16 v[122:123], v146 offset:512
  v_mfma_f32_16x16x32_bf16 v[188:191], v[84:87], v[76:79], v[188:191]
  ds_read_b128 v[104:107], v145 offset:16384
  v_mfma_f32_16x16x32_bf16 v[184:187], v[84:87], v[72:75], v[184:187]
  ds_read_b128 v[108:111], v145 offset:18432
  v_mfma_f32_16x16x32_bf16 v[180:183], v[84:87], v[68:71], v[180:183]
  ds_read_b128 v[112:115], v145 offset:20480
  v_mfma_f32_16x16x32_bf16 v[176:179], v[84:87], v[64:67], v[176:179]
  ds_read_b128 v[116:119], v145 offset:22528
  v_mfma_f32_16x16x32_bf16 v[192:195], v[88:91], v[64:67], v[192:195]
  ds_read_b64_tr_b16 v[124:125], v147 offset:0
  v_mfma_f32_16x16x32_bf16 v[196:199], v[88:91], v[68:71], v[196:199]
  ds_read_b64_tr_b16 v[126:127], v147 offset:512
  v_mfma_f32_16x16x32_bf16 v[200:203], v[88:91], v[72:75], v[200:203]
  ds_read_b64_tr_b16 v[128:129], v146 offset:4096
  v_mfma_f32_16x16x32_bf16 v[204:207], v[88:91], v[76:79], v[204:207]
  ds_read_b64_tr_b16 v[130:131], v146 offset:4608
  v_mfma_f32_16x16x32_bf16 v[220:223], v[92:95], v[76:79], v[220:223]
  ds_read_b64_tr_b16 v[132:133], v147 offset:4096
  v_mfma_f32_16x16x32_bf16 v[216:219], v[92:95], v[72:75], v[216:219]
  ds_read_b64_tr_b16 v[134:135], v147 offset:4608
  v_mfma_f32_16x16x32_bf16 v[212:215], v[92:95], v[68:71], v[212:215]
  ds_read_b64_tr_b16 v[136:137], v146 offset:8192
  v_mfma_f32_16x16x32_bf16 v[208:211], v[92:95], v[64:67], v[208:211]
  ds_read_b64_tr_b16 v[138:139], v146 offset:8704
  v_mfma_f32_16x16x32_bf16 v[224:227], v[64:67], v[96:99], v[224:227]
  ds_read_b64_tr_b16 v[140:141], v147 offset:8192
  v_mfma_f32_16x16x32_bf16 v[228:231], v[68:71], v[96:99], v[228:231]
  ds_read_b64_tr_b16 v[142:143], v147 offset:8704
  v_mfma_f32_16x16x32_bf16 v[232:235], v[72:75], v[96:99], v[232:235]
  ds_read_b32 v151, v150
  s_add_u32 s30, s30, 12288
  v_mfma_f32_16x16x32_bf16 v[236:239], v[76:79], v[96:99], v[236:239]
  s_mov_b64 exec, 1
  buffer_load_dword off, s[64:67], s31 lds
  s_mov_b64 exec, -1
  s_cmp_eq_u32 s30, 86016
  v_mfma_f32_16x16x32_bf16 v[252:255], v[76:79], v[100:103], v[252:255]
  s_cselect_b32 s30, 0, s30
  s_add_u32 s31, s31, 4
  v_mfma_f32_16x16x32_bf16 v[248:251], v[72:75], v[100:103], v[248:251]
  v_add_u32 v146, s30, v148
  s_add_u32 s33, s33, 1
  v_mfma_f32_16x16x32_bf16 v[244:247], v[68:71], v[100:103], v[244:247]
  v_add_u32 v147, s30, v149
  v_mfma_f32_16x16x32_bf16 v[240:243], v[64:67], v[100:103], v[240:243]
  s_waitcnt lgkmcnt(0)
  v_mfma_f32_16x16x32_bf16 v[160:163], v[120:123], v[104:107], v[160:163]
  v_cmp_lt_i32 vcc, s33, v151
  v_mfma_f32_16x16x32_bf16 v[164:167], v[120:123], v[108:111], v[164:167]
  s_cbranch_vccz .g2_kernel_q_w3
.g2_kernel_q_back3:
  v_mfma_f32_16x16x32_bf16 v[168:171], v[120:123], v[112:115], v[168:171]
  ds_read_b64_tr_b16 v[80:81], v146 offset:0
  v_mfma_f32_16x16x32_bf16 v[172:175], v[120:123], v[116:119], v[172:175]
  ds_read_b64_tr_b16 v[82:83], v146 offset:512
  v_mfma_f32_16x16x32_bf16 v[188:191], v[124:127], v[116:119], v[188:191]
  ds_read_b128 v[64:67], v144 offset:32768
  v_mfma_f32_16x16x32_bf16 v[184:187], v[124:127], v[112:115], v[184:187]
  ds_read_b128 v[68:71], v144 offset:34816
  v_mfma_f32_16x16x32_bf16 v[180:183], v[124:127], v[108:111], v[180:183]
  ds_read_b128 v[72:75], v144 offset:36864
  v_mfma_f32_16x16x32_bf16 v[176:179], v[124:127], v[104:107], v[176:179]
  ds_read_b128 v[76:79], v144 offset:38912
  v_mfma_f32_16x16x32_bf16 v[192:195], v[128:131], v[104:107], v[192:195]
  ds_read_b64_tr_b16 v[84:85], v147 offset:0
  v_mfma_f32_16x16x32_bf16 v[196:199], v[128:131], v[108:111], v[196:199]
  ds_read_b64_tr_b16 v[86:87], v147 offset:512
  v_mfma_f32_16x16x32_bf16 v[200:203], v[128:131], v[112:115], v[200:203]
  ds_read_b64_tr_b16 v[88:89], v146 offset:4096
  v_mfma_f32_16x16x32_bf16 v[204:207], v[128:131], v[116:119], v[204:207]
  ds_read_b64_tr_b16 v[90:91], v146 offset:4608
  v_mfma_f32_16x16x32_bf16 v[220:223], v[132:135], v[116:119], v[220:223]
  ds_read_b64_tr_b16 v[92:93], v147 offset:4096
  v_mfma_f32_16x16x32_bf16 v[216:219], v[132:135], v[112:115], v[216:219]
  ds_read_b64_tr_b16 v[94:95], v147 offset:4608
  v_mfma_f32_16x16x32_bf16 v[212:215], v[132:135], v[108:111], v[212:215]
  ds_read_b64_tr_b16 v[96:97], v146 offset:8192
  v_mfma_f32_16x16x32_bf16 v[208:211], v[132:135], v[104:107], v[208:211]
  ds_read_b64_tr_b16 v[98:99], v146 offset:8704
  v_mfma_f32_16x16x32_bf16 v[224:227], v[104:107], v[136:139], v[224:227]
  ds_read_b64_tr_b16 v[100:101], v147 offset:8192
  v_mfma_f32_16x16x32_bf16 v[228:231], v[108:111], v[136:139], v[228:231]
  ds_read_b64_tr_b16 v[102:103], v147 offset:8704
  v_mfma_f32_16x16x32_bf16 v[232:235], v[112:115], v[136:139], v[232:235]
  ds_read_b32 v151, v150
  s_add_u32 s30, s30, 12288
  v_mfma_f32_16x16x32_bf16 v[236:239], v[116:119], v[136:139], v[236:239]
  s_mov_b64 exec, 1
  buffer_load_dword off, s[64:67], s31 lds
  s_mov_b64 exec, -1
  s_cmp_eq_u32 s30, 86016
  v_mfma_f32_16x16x32_bf16 v[252:255], v[116:119], v[140:143], v[252:255]
  s_cselect_b32 s30, 0, s30
  s_add_u32 s31, s31, 4
  v_mfma_f32_16x16x32_bf16 v[248:251], v[112:115], v[140:143], v[248:251]
  v_add_u32 v146, s30, v148
  s_add_u32 s33, s33, 1
  v_mfma_f32_16x16x32_bf16 v[244:247], v[108:111], v[140:143], v[244:247]
  v_add_u32 v147, s30, v149
  v_mfma_f32_16x16x32_bf16 v[240:243], v[104:107], v[140:143], v[240:243]
  s_waitcnt lgkmcnt(0)
  v_mfma_f32_16x16x32_bf16 v[160:163], v[80:83], v[64:67], v[160:163]
  v_cmp_lt_i32 vcc, s33, v151
  v_mfma_f32_16x16x32_bf16 v[164:167], v[80:83], v[68:71], v[164:167]
  s_cbranch_vccz .g2_kernel_q_w4
.g2_kernel_q_back4:
  v_mfma_f32_16x16x32_bf16 v[168:171], v[80:83], v[72:75], v[168:171]
  ds_read_b64_tr_b16 v[120:121], v146 offset:0
  v_mfma_f32_16x16x32_bf16 v[172:175], v[80:83], v[76:79], v[172:175]
  ds_read_b64_tr_b16 v[122:123], v146 offset:512
  v_mfma_f32_16x16x32_bf16 v[188:191], v[84:87], v[76:79], v[188:191]
  ds_read_b128 v[104:107], v145 offset:32768
  v_mfma_f32_16x16x32_bf16 v[184:187], v[84:87], v[72:75], v[184:187]
  ds_read_b128 v[108:111], v145 offset:34816
  v_mfma_f32_16x16x32_bf16 v[180:183], v[84:87], v[68:71], v[180:183]
  ds_read_b128 v[112:115], v145 offset:36864
  v_mfma_f32_16x16x32_bf16 v[176:179], v[84:87], v[64:67], v[176:179]
  ds_read_b128 v[116:119], v145 offset:38912
  v_mfma_f32_16x16x32_bf16 v[192:195], v[88:91], v[64:67], v[192:195]
  ds_read_b64_tr_b16 v[124:125], v147 offset:0
  v_mfma_f32_16x16x32_bf16 v[196:199], v[88:91], v[68:71], v[196:199]
  ds_read_b64_tr_b16 v[126:127], v147 offset:512
  v_mfma_f32_16x16x32_bf16 v[200:203], v[88:91], v[72:75], v[200:203]
  ds_read_b64_tr_b16 v[128:129], v146 offset:4096
  v_mfma_f32_16x16x32_bf16 v[204:207], v[88:91], v[76:79], v[204:207]
  ds_read_b64_tr_b16 v[130:131], v146 offset:4608
  v_mfma_f32_16x16x32_bf16 v[220:223], v[92:95], v[76:79], v[220:223]
  ds_read_b64_tr_b16 v[132:133], v147 offset:4096
  v_mfma_f32_16x16x32_bf16 v[216:219], v[92:95], v[72:75], v[216:219]
  ds_read_b64_tr_b16 v[134:135], v147 offset:4608
  v_mfma_f32_16x16x32_bf16 v[212:215], v[92:95], v[68:71], v[212:215]
  ds_read_b64_tr_b16 v[136:137], v146 offset:8192
  v_mfma_f32_16x16x32_bf16 v[208:211], v[92:95], v[64:67], v[208:211]
  ds_read_b64_tr_b16 v[138:139], v146 offset:8704
  v_mfma_f32_16x16x32_bf16 v[224:227], v[64:67], v[96:99], v[224:227]
  ds_read_b64_tr_b16 v[140:141], v147 offset:8192
  v_mfma_f32_16x16x32_bf16 v[228:231], v[68:71], v[96:99], v[228:231]
  ds_read_b64_tr_b16 v[142:143], v147 offset:8704
  v_mfma_f32_16x16x32_bf16 v[232:235], v[72:75], v[96:99], v[232:235]
  ds_read_b32 v151, v150
  s_add_u32 s30, s30, 12288
  v_mfma_f32_16x16x32_bf16 v[236:239], v[76:79], v[96:99], v[236:239]
  s_mov_b64 exec, 1
  buffer_load_dword off, s[64:67], s31 lds
  s_mov_b64 exec, -1
  s_cmp_eq_u32 s30, 86016
  v_mfma_f32_16x16x32_bf16 v[252:255], v[76:79], v[100:103], v[252:255]
  s_cselect_b32 s30, 0, s30
  s_add_u32 s31, s31, 4
  v_mfma_f32_16x16x32_bf16 v[248:251], v[72:75], v[100:103], v[248:251]
  v_add_u32 v146, s30, v148
  s_add_u32 s33, s33, 1
  v_mfma_f32_16x16x32_bf16 v[244:247], v[68:71], v[100:103], v[244:247]
  v_add_u32 v147, s30, v149
  v_mfma_f32_16x16x32_bf16 v[240:243], v[64:67], v[100:103], v[240:243]
  s_waitcnt lgkmcnt(0)
  v_mfma_f32_16x16x32_bf16 v[160:163], v[120:123], v[104:107], v[160:163]
  v_cmp_lt_i32 vcc, s33, v151
  v_mfma_f32_16x16x32_bf16 v[164:167], v[120:123], v[108:111], v[164:167]
  s_cbranch_vccz .g2_kernel_q_w5
.g2_kernel_q_back5:
  v_mfma_f32_16x16x32_bf16 v[168:171], v[120:123], v[112:115], v[168:171]
  ds_read_b64_tr_b16 v[80:81], v146 offset:0
  v_mfma_f32_16x16x32_bf16 v[172:175], v[120:123], v[116:119], v[172:175]
  ds_read_b64_tr_b16 v[82:83], v146 offset:512
  v_mfma_f32_16x16x32_bf16 v[188:191], v[124:127], v[116:119], v[188:191]
  ds_read_b128 v[64:67], v144 offset:49152
  v_mfma_f32_16x16x32_bf16 v[184:187], v[124:127], v[112:115], v[184:187]
  ds_read_b128 v[68:71], v144 offset:51200
  v_mfma_f32_16x16x32_bf16 v[180:183], v[124:127], v[108:111], v[180:183]
  ds_read_b128 v[72:75], v144 offset:53248
  v_mfma_f32_16x16x32_bf16 v[176:179], v[124:127], v[104:107], v[176:179]
  ds_read_b128 v[76:79], v144 offset:55296
  v_mfma_f32_16x16x32_bf16 v[192:195], v[128:131], v[104:107], v[192:195]
  ds_read_b64_tr_b16 v[84:85], v147 offset:0
  v_mfma_f32_16x16x32_bf16 v[196:199], v[128:131], v[108:111], v[196:199]
  ds_read_b64_tr_b16 v[86:87], v147 offset:512
  v_mfma_f32_16x16x32_bf16 v[200:203], v[128:131], v[112:115], v[200:203]
  ds_read_b64_tr_b16 v[88:89], v146 offset:4096
  v_mfma_f32_16x16x32_bf16 v[204:207], v[128:131], v[116:119], v[204:207]
  ds_read_b64_tr_b16 v[90:91], v146 offset:4608
  v_mfma_f32_16x16x32_bf16 v[220:223], v[132:135], v[116:119], v[220:223]
  ds_read_b64_tr_b16 v[92:93], v147 offset:4096
  v_mfma_f32_16x16x32_bf16 v[216:219], v[132:135], v[112:115], v[216:219]
  ds_read_b64_tr_b16 v[94:95], v147 offset:4608
  v_mfma_f32_16x16x32_bf16 v[212:215], v[132:135], v[108:111], v[212:215]
  ds_read_b64_tr_b16 v[96:97], v146 offset:8192
  v_mfma_f32_16x16x32_bf16 v[208:211], v[132:135], v[104:107], v[208:211]
  ds_read_b64_tr_b16 v[98:99], v146 offset:8704
  v_mfma_f32_16x16x32_bf16 v[224:227], v[104:107], v[136:139], v[224:227]
  ds_read_b64_tr_b16 v[100:101], v147 offset:8192
  v_mfma_f32_16x16x32_bf16 v[228:231], v[108:111], v[136:139], v[228:231]
  ds_read_b64_tr_b16 v[102:103], v147 offset:8704
  v_mfma_f32_16x16x32_bf16 v[232:235], v[112:115], v[136:139], v[232:235]
  ds_read_b32 v151, v150
  s_add_u32 s30, s30, 12288
  v_mfma_f32_16x16x32_bf16 v[236:239], v[116:119], v[136:139], v[236:239]
  s_mov_b64 exec, 1
  buffer_load_dword off, s[64:67], s31 lds
  s_mov_b64 exec, -1
  s_cmp_eq_u32 s30, 86016
  v_mfma_f32_16x16x32_bf16 v[252:255], v[116:119], v[140:143], v[252:255]
  s_cselect_b32 s30, 0, s30
  s_add_u32 s31, s31, 4
  v_mfma_f32_16x16x32_bf16 v[248:251], v[112:115], v[140:143], v[248:251]
  v_add_u32 v146, s30, v148
  s_add_u32 s33, s33, 1
  v_mfma_f32_16x16x32_bf16 v[244:247], v[108:111], v[140:143], v[244:247]
  v_add_u32 v147, s30, v149
  v_mfma_f32_16x16x32_bf16 v[240:243], v[104:107], v[140:143], v[240:243]
  s_waitcnt lgkmcnt(0)
  v_mfma_f32_16x16x32_bf16 v[160:163], v[80:83], v[64:67], v[160:163]
  v_cmp_lt_i32 vcc, s33, v151
  v_mfma_f32_16x16x32_bf16 v[164:167], v[80:83], v[68:71], v[164:167]
  s_cbranch_vccz .g2_kernel_q_w6
.g2_kernel_q_back6:
  v_mfma_f32_16x16x32_bf16 v[168:171], v[80:83], v[72:75], v[168:171]
  ds_read_b64_tr_b16 v[120:121], v146 offset:0
  v_mfma_f32_16x16x32_bf16 v[172:175], v[80:83], v[76:79], v[172:175]
  ds_read_b64_tr_b16 v[122:123], v146 offset:512
  v_mfma_f32_16x16x32_bf16 v[188:191], v[84:87], v[76:79], v[188:191]
  ds_read_b128 v[104:107], v145 offset:49152
  v_mfma_f32_16x16x32_bf16 v[184:187], v[84:87], v[72:75], v[184:187]
  ds_read_b128 v[108:111], v145 offset:51200
  v_mfma_f32_16x16x32_bf16 v[180:183], v[84:87], v[68:71], v[180:183]
  ds_read_b128 v[112:115], v145 offset:53248
  v_mfma_f32_16x16x32_bf16 v[176:179], v[84:87], v[64:67], v[176:179]
  ds_read_b128 v[116:119], v145 offset:55296
  v_mfma_f32_16x16x32_bf16 v[192:195], v[88:91], v[64:67], v[192:195]
  ds_read_b64_tr_b16 v[124:125], v147 offset:0
  v_mfma_f32_16x16x32_bf16 v[196:199], v[88:91], v[68:71], v[196:199]
  ds_read_b64_tr_b16 v[126:127], v147 offset:512
  v_mfma_f32_16x16x32_bf16 v[200:203], v[88:91], v[72:75], v[200:203]
  ds_read_b64_tr_b16 v[128:129], v146 offset:4096
  v_mfma_f32_16x16x32_bf16 v[204:207], v[88:91], v[76:79], v[204:207]
  ds_read_b64_tr_b16 v[130:131], v146 offset:4608
  v_mfma_f32_16x16x32_bf16 v[220:223], v[92:95], v[76:79], v[220:223]
  ds_read_b64_tr_b16 v[132:133], v147 offset:4096
  v_mfma_f32_16x16x32_bf16 v[216:219], v[92:95], v[72:75], v[216:219]
  ds_read_b64_tr_b16 v[134:135], v147 offset:4608
  v_mfma_f32_16x16x32_bf16 v[212:215], v[92:95], v[68:71], v[212:215]
  ds_read_b64_tr_b16 v[136:137], v146 offset:8192
  v_mfma_f32_16x16x32_bf16 v[208:211], v[92:95], v[64:67], v[208:211]
  ds_read_b64_tr_b16 v[138:139], v146 offset:8704
  v_mfma_f32_16x16x32_bf16 v[224:227], v[64:67], v[96:99], v[224:227]
  ds_read_b64_tr_b16 v[140:141], v147 offset:8192
  v_mfma_f32_16x16x32_bf16 v[228:231], v[68:71], v[96:99], v[228:231]
  ds_read_b64_tr_b16 v[142:143], v147 offset:8704
  v_mfma_f32_16x16x32_bf16 v[232:235], v[72:75], v[96:99], v[232:235]
  ds_read_b32 v151, v150
  s_add_u32 s30, s30, 12288
  v_mfma_f32_16x16x32_bf16 v[236:239], v[76:79], v[96:99], v[236:239]
  s_mov_b64 exec, 1
  buffer_load_dword off, s[64:67], s31 lds
  s_mov_b64 exec, -1
  s_cmp_eq_u32 s30, 86016
  v_mfma_f32_16x16x32_bf16 v[252:255], v[76:79], v[100:103], v[252:255]
  s_cselect_b32 s30, 0, s30
  s_add_u32 s31, s31, 4
  v_mfma_f32_16x16x32_bf16 v[248:251], v[72:75], v[100:103], v[248:251]
  v_add_u32 v146, s30, v148
  s_add_u32 s33, s33, 1
  v_mfma_f32_16x16x32_bf16 v[244:247], v[68:71], v[100:103], v[244:247]
  v_add_u32 v147, s30, v149
  s_add_u32 s29, s29, 1
  v_mfma_f32_16x16x32_bf16 v[240:243], v[64:67], v[100:103], v[240:243]
  s_cmp_lg_u32 s29, 4
  s_cbranch_scc1 .g2_kernel_q_loop
  s_waitcnt lgkmcnt(0)
  v_mfma_f32_16x16x32_bf16 v[192:195], v[128:131], v[104:107], v[192:195]
  ds_read_b32 v62, v13 offset:0
  ds_read_b32 v63, v58
  v_mfma_f32_16x16x32_bf16 v[196:199], v[128:131], v[108:111], v[196:199]
  ds_read_b32 v57, v13 offset:24
  ds_read_b128 v[40:43], v52 offset:5120
  v_mfma_f32_16x16x32_bf16 v[200:203], v[128:131], v[112:115], v[200:203]
  ds_read_b128 v[44:47], v52 offset:5184
  ds_read_b32 v24, v50 offset:2816
  v_mfma_f32_16x16x32_bf16 v[204:207], v[128:131], v[116:119], v[204:207]
  ds_read_b32 v25, v50 offset:3328
  ds_read_b32 v26, v50 offset:2880
  v_mfma_f32_16x16x32_bf16 v[220:223], v[132:135], v[116:119], v[220:223]
  ds_read_b32 v27, v50 offset:3392
  ds_read_b32 v28, v50 offset:2944
  v_mfma_f32_16x16x32_bf16 v[216:219], v[132:135], v[112:115], v[216:219]
  ds_read_b32 v29, v50 offset:3456
  ds_read_b32 v30, v50 offset:3008
  v_mfma_f32_16x16x32_bf16 v[212:215], v[132:135], v[108:111], v[212:215]
  ds_read_b32 v31, v50 offset:3520
  ds_read_b128 v[64:67], v51 offset:2816
  v_mfma_f32_16x16x32_bf16 v[208:211], v[132:135], v[104:107], v[208:211]
  ds_read_b128 v[80:83], v51 offset:3328
  ds_read_b128 v[68:71], v51 offset:2880
  v_mfma_f32_16x16x32_bf16 v[224:227], v[104:107], v[136:139], v[224:227]
  ds_read_b128 v[84:87], v51 offset:3392
  v_mfma_f32_16x16x32_bf16 v[228:231], v[108:111], v[136:139], v[228:231]
  ds_read_b128 v[72:75], v51 offset:2944
  v_mfma_f32_16x16x32_bf16 v[232:235], v[112:115], v[136:139], v[232:235]
  ds_read_b128 v[88:91], v51 offset:3456
  v_mfma_f32_16x16x32_bf16 v[236:239], v[116:119], v[136:139], v[236:239]
  ds_read_b128 v[76:79], v51 offset:3008
  v_mfma_f32_16x16x32_bf16 v[252:255], v[116:119], v[140:143], v[252:255]
  ds_read_b128 v[92:95], v51 offset:3520
  v_mfma_f32_16x16x32_bf16 v[248:251], v[112:115], v[140:143], v[248:251]
  ds_read_b32 v48, v53 offset:5376
  v_mfma_f32_16x16x32_bf16 v[244:247], v[108:111], v[140:143], v[244:247]
  ds_read_b32 v49, v53 offset:5440
  v_mfma_f32_16x16x32_bf16 v[240:243], v[104:107], v[140:143], v[240:243]
  ds_read_b128 v[32:35], v52 offset:4864
  v_mfma_f32_16x16x32_bf16 v[160:163], v[120:123], v[104:107], v[160:163]
  ds_read_b128 v[36:39], v52 offset:4928
  v_mfma_f32_16x16x32_bf16 v[164:167], v[120:123], v[108:111], v[164:167]
  v_mfma_f32_16x16x32_bf16 v[168:171], v[120:123], v[112:115], v[168:171]
  v_mfma_f32_16x16x32_bf16 v[172:175], v[120:123], v[116:119], v[172:175]
  v_mfma_f32_16x16x32_bf16 v[188:191], v[124:127], v[116:119], v[188:191]
  s_mov_b64 exec, 1
  buffer_load_dword off, s[64:67], s31 lds
  s_mov_b64 exec, -1
  v_mfma_f32_16x16x32_bf16 v[184:187], v[124:127], v[112:115], v[184:187]
  v_mfma_f32_16x16x32_bf16 v[180:183], v[124:127], v[108:111], v[180:183]
  v_mfma_f32_16x16x32_bf16 v[176:179], v[124:127], v[104:107], v[176:179]
  s_waitcnt lgkmcnt(0)
  v_cmp_gt_u32 vcc, 2, v62
  v_cmp_gt_u32 s[14:15], s12, v63
  s_or_b64 vcc, vcc, s[14:15]
  s_cbranch_scc1 .g2_kernel_q_ew
.g2_kernel_q_eb:
  v_cmp_ne_u32 vcc, 0, v57
  s_cbranch_vccnz .g2_kernel_q_patch
.g2_kernel_q_pback:
  s_add_u32 s79, s77, 4096
  s_cmp_lg_u32 s10, 0
  s_cbranch_scc1 .g2_kernel_q_nk
  v_pk_mul_f32 v[152:153], v[40:41], v[24:25] op_sel:[0,1] op_sel_hi:[1,1]
  v_pk_mul_f32 v[154:155], v[42:43], v[24:25] op_sel:[0,1] op_sel_hi:[1,1]
  v_pk_mul_f32 v[156:157], v[44:45], v[24:25] op_sel:[0,1] op_sel_hi:[1,1]
  v_pk_mul_f32 v[158:159], v[46:47], v[24:25] op_sel:[0,1] op_sel_hi:[1,1]
  v_pk_fma_f32 v[192:193], v[192:193], v[24:25], v[152:153] op_sel_hi:[1,0,1]
  v_pk_fma_f32 v[194:195], v[194:195], v[24:25], v[154:155] op_sel_hi:[1,0,1]
  v_pk_fma_f32 v[208:209], v[208:209], v[24:25], v[156:157] op_sel_hi:[1,0,1]
  v_pk_fma_f32 v[210:211], v[210:211], v[24:25], v[158:159] op_sel_hi:[1,0,1]
  v_cvt_pk_bf16_f32 v192, v192, v193
  v_cvt_pk_bf16_f32 v193, v194, v195
  v_cvt_pk_bf16_f32 v194, v208, v209
  v_cvt_pk_bf16_f32 v195, v210, v211
  buffer_store_dwordx4 v[192:195], v54, s[4:7], s8 offen offset:0 sc1
  v_pk_mul_f32 v[152:153], v[40:41], v[26:27] op_sel:[0,1] op_sel_hi:[1,1]
  v_pk_mul_f32 v[154:155], v[42:43], v[26:27] op_sel:[0,1] op_sel_hi:[1,1]
  v_pk_mul_f32 v[156:157], v[44:45], v[26:27] op_sel:[0,1] op_sel_hi:[1,1]
  v_pk_mul_f32 v[158:159], v[46:47], v[26:27] op_sel:[0,1] op_sel_hi:[1,1]
  v_pk_fma_f32 v[196:197], v[196:197], v[26:27], v[152:153] op_sel_hi:[1,0,1]
  v_pk_fma_f32 v[198:199], v[198:199], v[26:27], v[154:155] op_sel_hi:[1,0,1]
  v_pk_fma_f32 v[212:213], v[212:213], v[26:27], v[156:157] op_sel_hi:[1,0,1]
  v_pk_fma_f32 v[214:215], v[214:215], v[26:27], v[158:159] op_sel_hi:[1,0,1]
  v_cvt_pk_bf16_f32 v196, v196, v197
  v_cvt_pk_bf16_f32 v197, v198, v199
  v_cvt_pk_bf16_f32 v198, v212, v213
  v_cvt_pk_bf16_f32 v199, v214, v215
  buffer_store_dwordx4 v[196:199], v54, s[4:7], s8 offen offset:128 sc1
  v_pk_mul_f32 v[152:153], v[40:41], v[28:29] op_sel:[0,1] op_sel_hi:[1,1]
  v_pk_mul_f32 v[154:155], v[42:43], v[28:29] op_sel:[0,1] op_sel_hi:[1,1]
  v_pk_mul_f32 v[156:157], v[44:45], v[28:29] op_sel:[0,1] op_sel_hi:[1,1]
  v_pk_mul_f32 v[158:159], v[46:47], v[28:29] op_sel:[0,1] op_sel_hi:[1,1]
  v_pk_fma_f32 v[200:201], v[200:201], v[28:29], v[152:153] op_sel_hi:[1,0,1]
  v_pk_fma_f32 v[202:203], v[202:203], v[28:29], v[154:155] op_sel_hi:[1,0,1]
  v_pk_fma_f32 v[216:217], v[216:217], v[28:29], v[156:157] op_sel_hi:[1,0,1]
  v_pk_fma_f32 v[218:219], v[218:219], v[28:29], v[158:159] op_sel_hi:[1,0,1]
  v_cvt_pk_bf16_f32 v200, v200, v201
  v_cvt_pk_bf16_f32 v201, v202, v203
  v_cvt_pk_bf16_f32 v202, v216, v217
  v_cvt_pk_bf16_f32 v203, v218, v219
  buffer_store_dwordx4 v[200:203], v54, s[4:7], s9 offen offset:0 sc1
  v_pk_mul_f32 v[152:153], v[40:41], v[30:31] op_sel:[0,1] op_sel_hi:[1,1]
  v_pk_mul_f32 v[154:155], v[42:43], v[30:31] op_sel:[0,1] op_sel_hi:[1,1]
  v_pk_mul_f32 v[156:157], v[44:45], v[30:31] op_sel:[0,1] op_sel_hi:[1,1]
  v_pk_mul_f32 v[158:159], v[46:47], v[30:31] op_sel:[0,1] op_sel_hi:[1,1]
  v_pk_fma_f32 v[204:205], v[204:205], v[30:31], v[152:153] op_sel_hi:[1,0,1]
  v_pk_fma_f32 v[206:207], v[206:207], v[30:31], v[154:155] op_sel_hi:[1,0,1]
  v_pk_fma_f32 v[220:221], v[220:221], v[30:31], v[156:157] op_sel_hi:[1,0,1]
  v_pk_fma_f32 v[222:223], v[222:223], v[30:31], v[158:159] op_sel_hi:[1,0,1]
  v_cvt_pk_bf16_f32 v204, v204, v205
  v_cvt_pk_bf16_f32 v205, v206, v207
  v_cvt_pk_bf16_f32 v206, v220, v221
  v_cvt_pk_bf16_f32 v207, v222, v223
  buffer_store_dwordx4 v[204:207], v54, s[4:7], s9 offen offset:128 sc1
  v_pk_mul_f32 v[152:153], v[80:81], v[48:49] op_sel:[0,0] op_sel_hi:[1,0]
  v_pk_mul_f32 v[154:155], v[82:83], v[48:49] op_sel:[0,0] op_sel_hi:[1,0]
  v_pk_mul_f32 v[156:157], v[84:85], v[48:49] op_sel:[0,0] op_sel_hi:[1,0]
  v_pk_mul_f32 v[158:159], v[86:87], v[48:49] op_sel:[0,0] op_sel_hi:[1,0]
  v_pk_fma_f32 v[224:225], v[224:225], v[64:65], v[152:153]
  v_pk_fma_f32 v[226:227], v[226:227], v[66:67], v[154:155]
  v_pk_fma_f32 v[228:229], v[228:229], v[68:69], v[156:157]
  v_pk_fma_f32 v[230:231], v[230:231], v[70:71], v[158:159]
  v_cvt_pk_bf16_f32 v224, v224, v225
  v_cvt_pk_bf16_f32 v225, v226, v227
  v_cvt_pk_bf16_f32 v226, v228, v229
  v_cvt_pk_bf16_f32 v227, v230, v231
  buffer_store_dwordx4 v[224:227], v55, s[4:7], s8 offen offset:2048 sc1
  v_pk_mul_f32 v[152:153], v[80:81], v[48:49] op_sel:[0,1] op_sel_hi:[1,1]
  v_pk_mul_f32 v[154:155], v[82:83], v[48:49] op_sel:[0,1] op_sel_hi:[1,1]
  v_pk_mul_f32 v[156:157], v[84:85], v[48:49] op_sel:[0,1] op_sel_hi:[1,1]
  v_pk_mul_f32 v[158:159], v[86:87], v[48:49] op_sel:[0,1] op_sel_hi:[1,1]
  v_pk_fma_f32 v[240:241], v[240:241], v[64:65], v[152:153]
  v_pk_fma_f32 v[242:243], v[242:243], v[66:67], v[154:155]
  v_pk_fma_f32 v[244:245], v[244:245], v[68:69], v[156:157]
  v_pk_fma_f32 v[246:247], v[246:247], v[70:71], v[158:159]
  v_cvt_pk_bf16_f32 v240, v240, v241
  v_cvt_pk_bf16_f32 v241, v242, v243
  v_cvt_pk_bf16_f32 v242, v244, v245
  v_cvt_pk_bf16_f32 v243, v246, v247
  buffer_store_dwordx4 v[240:243], v55, s[4:7], s8 offen offset:2304 sc1
  v_pk_mul_f32 v[152:153], v[88:89], v[48:49] op_sel:[0,0] op_sel_hi:[1,0]
  v_pk_mul_f32 v[154:155], v[90:91], v[48:49] op_sel:[0,0] op_sel_hi:[1,0]
  v_pk_mul_f32 v[156:157], v[92:93], v[48:49] op_sel:[0,0] op_sel_hi:[1,0]
  v_pk_mul_f32 v[158:159], v[94:95], v[48:49] op_sel:[0,0] op_sel_hi:[1,0]
  v_pk_fma_f32 v[232:233], v[232:233], v[72:73], v[152:153]
  v_pk_fma_f32 v[234:235], v[234:235], v[74:75], v[154:155]
  v_pk_fma_f32 v[236:237], v[236:237], v[76:77], v[156:157]
  v_pk_fma_f32 v[238:239], v[238:239], v[78:79], v[158:159]
  v_cvt_pk_bf16_f32 v232, v232, v233
  v_cvt_pk_bf16_f32 v233, v234, v235
  v_cvt_pk_bf16_f32 v234, v236, v237
  v_cvt_pk_bf16_f32 v235, v238, v239
  buffer_store_dwordx4 v[232:235], v55, s[4:7], s9 offen offset:2048 sc1
  v_pk_mul_f32 v[152:153], v[88:89], v[48:49] op_sel:[0,1] op_sel_hi:[1,1]
  v_pk_mul_f32 v[154:155], v[90:91], v[48:49] op_sel:[0,1] op_sel_hi:[1,1]
  v_pk_mul_f32 v[156:157], v[92:93], v[48:49] op_sel:[0,1] op_sel_hi:[1,1]
  v_pk_mul_f32 v[158:159], v[94:95], v[48:49] op_sel:[0,1] op_sel_hi:[1,1]
  v_pk_fma_f32 v[248:249], v[248:249], v[72:73], v[152:153]
  v_pk_fma_f32 v[250:251], v[250:251], v[74:75], v[154:155]
  v_pk_fma_f32 v[252:253], v[252:253], v[76:77], v[156:157]
  v_pk_fma_f32 v[254:255], v[254:255], v[78:79], v[158:159]
  v_cvt_pk_bf16_f32 v248, v248, v249
  v_cvt_pk_bf16_f32 v249, v250, v251
  v_cvt_pk_bf16_f32 v250, v252, v253
  v_cvt_pk_bf16_f32 v251, v254, v255
  buffer_store_dwordx4 v[248:251], v55, s[4:7], s9 offen offset:2304 sc1
  v_pk_mul_f32 v[24:25], v[24:25], v[56:57] op_sel_hi:[1,0]
  v_pk_mul_f32 v[26:27], v[26:27], v[56:57] op_sel_hi:[1,0]
  v_pk_mul_f32 v[28:29], v[28:29], v[56:57] op_sel_hi:[1,0]
  v_pk_mul_f32 v[30:31], v[30:31], v[56:57] op_sel_hi:[1,0]
  ds_write_b128 v59, v[192:195] offset:0
  ds_write_b128 v59, v[196:199] offset:128
  v_pk_mul_f32 v[152:153], v[32:33], v[24:25] op_sel:[0,1] op_sel_hi:[1,1]
  v_pk_mul_f32 v[154:155], v[34:35], v[24:25] op_sel:[0,1] op_sel_hi:[1,1]
  v_pk_mul_f32 v[156:157], v[36:37], v[24:25] op_sel:[0,1] op_sel_hi:[1,1]
  v_pk_mul_f32 v[158:159], v[38:39], v[24:25] op_sel:[0,1] op_sel_hi:[1,1]
  v_pk_fma_f32 v[160:161], v[160:161], v[24:25], v[152:153] op_sel_hi:[1,0,1]
  v_pk_fma_f32 v[162:163], v[162:163], v[24:25], v[154:155] op_sel_hi:[1,0,1]
  v_pk_fma_f32 v[176:177], v[176:177], v[24:25], v[156:157] op_sel_hi:[1,0,1]
  v_pk_fma_f32 v[178:179], v[178:179], v[24:25], v[158:159] op_sel_hi:[1,0,1]
  v_cvt_pk_bf16_f32 v160, v160, v161
  v_cvt_pk_bf16_f32 v161, v162, v163
  v_cvt_pk_bf16_f32 v162, v176, v177
  v_cvt_pk_bf16_f32 v163, v178, v179
  ds_write_b128 v61, v[160:163] offset:0
  ds_write_b128 v59, v[200:203] offset:4096
  ds_write_b128 v59, v[204:207] offset:4224
  v_pk_mul_f32 v[152:153], v[32:33], v[26:27] op_sel:[0,1] op_sel_hi:[1,1]
  v_pk_mul_f32 v[154:155], v[34:35], v[26:27] op_sel:[0,1] op_sel_hi:[1,1]
  v_pk_mul_f32 v[156:157], v[36:37], v[26:27] op_sel:[0,1] op_sel_hi:[1,1]
  v_pk_mul_f32 v[158:159], v[38:39], v[26:27] op_sel:[0,1] op_sel_hi:[1,1]
  v_pk_fma_f32 v[164:165], v[164:165], v[26:27], v[152:153] op_sel_hi:[1,0,1]
  v_pk_fma_f32 v[166:167], v[166:167], v[26:27], v[154:155] op_sel_hi:[1,0,1]
  v_pk_fma_f32 v[180:181], v[180:181], v[26:27], v[156:157] op_sel_hi:[1,0,1]
  v_pk_fma_f32 v[182:183], v[182:183], v[26:27], v[158:159] op_sel_hi:[1,0,1]
  v_cvt_pk_bf16_f32 v164, v164, v165
  v_cvt_pk_bf16_f32 v165, v166, v167
  v_cvt_pk_bf16_f32 v166, v180, v181
  v_cvt_pk_bf16_f32 v167, v182, v183
  ds_write_b128 v61, v[164:167] offset:256
  ds_write_b128 v60, v[224:227] offset:2048
  ds_write_b128 v60, v[240:243] offset:2304
  v_pk_mul_f32 v[152:153], v[32:33], v[28:29] op_sel:[0,1] op_sel_hi:[1,1]
  v_pk_mul_f32 v[154:155], v[34:35], v[28:29] op_sel:[0,1] op_sel_hi:[1,1]
  v_pk_mul_f32 v[156:157], v[36:37], v[28:29] op_sel:[0,1] op_sel_hi:[1,1]
  v_pk_mul_f32 v[158:159], v[38:39], v[28:29] op_sel:[0,1] op_sel_hi:[1,1]
  v_pk_fma_f32 v[168:169], v[168:169], v[28:29], v[152:153] op_sel_hi:[1,0,1]
  v_pk_fma_f32 v[170:171], v[170:171], v[28:29], v[154:155] op_sel_hi:[1,0,1]
  v_pk_fma_f32 v[184:185], v[184:185], v[28:29], v[156:157] op_sel_hi:[1,0,1]
  v_pk_fma_f32 v[186:187], v[186:187], v[28:29], v[158:159] op_sel_hi:[1,0,1]
  v_cvt_pk_bf16_f32 v168, v168, v169
  v_cvt_pk_bf16_f32 v169, v170, v171
  v_cvt_pk_bf16_f32 v170, v184, v185
  v_cvt_pk_bf16_f32 v171, v186, v187
  ds_write_b128 v61, v[168:171] offset:2048
  ds_write_b128 v60, v[232:235] offset:6144
  ds_write_b128 v60, v[248:251] offset:6400
  v_pk_mul_f32 v[152:153], v[32:33], v[30:31] op_sel:[0,1] op_sel_hi:[1,1]
  v_pk_mul_f32 v[154:155], v[34:35], v[30:31] op_sel:[0,1] op_sel_hi:[1,1]
  v_pk_mul_f32 v[156:157], v[36:37], v[30:31] op_sel:[0,1] op_sel_hi:[1,1]
  v_pk_mul_f32 v[158:159], v[38:39], v[30:31] op_sel:[0,1] op_sel_hi:[1,1]
  v_pk_fma_f32 v[172:173], v[172:173], v[30:31], v[152:153] op_sel_hi:[1,0,1]
  v_pk_fma_f32 v[174:175], v[174:175], v[30:31], v[154:155] op_sel_hi:[1,0,1]
  v_pk_fma_f32 v[188:189], v[188:189], v[30:31], v[156:157] op_sel_hi:[1,0,1]
  v_pk_fma_f32 v[190:191], v[190:191], v[30:31], v[158:159] op_sel_hi:[1,0,1]
  v_cvt_pk_bf16_f32 v172, v172, v173
  v_cvt_pk_bf16_f32 v173, v174, v175
  v_cvt_pk_bf16_f32 v174, v188, v189
  v_cvt_pk_bf16_f32 v175, v190, v191
  ds_write_b128 v61, v[172:175] offset:2304
.g2_kernel_q_kd:
  s_mov_b64 exec, 1
  ds_add_u32 v13, v5 offset:4
  s_mov_b64 exec, -1
  v_mov_b32 v120, 0
  v_mov_b32 v121, 0
  v_mov_b32 v124, 0
  v_mov_b32 v125, 0
  v_mov_b32 v128, 0
  v_mov_b32 v129, 0
  v_mov_b32 v132, 0
  v_mov_b32 v133, 0
  s_cmp_lg_u32 s62, 0
  s_cbranch_scc1 .g2_kernel_r2
  global_load_dwordx4 v[240:243], v23, s[74:75] offset:0
  global_load_dwordx4 v[244:247], v23, s[74:75] offset:32
  global_load_dwordx4 v[248:251], v23, s[74:75] offset:64
  global_load_dwordx4 v[252:255], v23, s[74:75] offset:96
.g2_kernel_r3:
  v_mov_b32 v6, s71
  s_mov_b32 s38, 0
.g2_kernel_wg2:
  ds_read_b32 v7, v6 offset:4
  s_add_u32 s38, s38, 1
  s_waitcnt lgkmcnt(0)
  v_cmp_gt_u32 vcc, 4, v7
  s_cbranch_vccz .g2_kernel_wg2d
  s_cmp_lt_u32 s38, 524288
  s_cbranch_scc1 .g2_kernel_wg2
.g2_kernel_wg2d:
  ds_read_b128 v[176:179], v9 offset:0
  ds_read_b128 v[180:183], v9 offset:1024
  ds_read_b128 v[24:27], v14 offset:8192
  ds_read_b128 v[28:31], v14 offset:9216
  ds_read_b128 v[184:187], v9 offset:2048
  ds_read_b128 v[188:191], v9 offset:3072
  ds_read_b128 v[32:35], v14 offset:10240
  ds_read_b128 v[36:39], v14 offset:11264
  ds_read_b128 v[40:43], v14 offset:12288
  ds_read_b128 v[44:47], v14 offset:13312
  ds_read_b128 v[48:51], v14 offset:14336
  ds_read_b128 v[52:55], v14 offset:15360
  s_cmp_lg_u32 s35, 0
  s_cbranch_scc1 .g2_kernel_a_own
  s_waitcnt lgkmcnt(8)
.g2_kernel_a_ob:
  v_mfma_f32_32x32x16_bf16 v[136:151], v[176:179], v[24:27], 0
  v_mfma_f32_32x32x16_bf16 v[136:151], v[180:183], v[28:31], v[136:151]
  s_waitcnt lgkmcnt(0)
  s_nop 7
  v_mfma_f32_32x32x16_bf16 v[152:167], v[176:179], v[32:35], 0
  s_waitcnt vmcnt(4)
  s_mov_b64 exec, 1
  buffer_store_dword v15, v4, s[4:7], s37 offen sc1
  s_mov_b64 exec, -1
  v_exp_f32 v136, v136
  v_exp_f32 v137, v137
  v_exp_f32 v138, v138
  v_exp_f32 v139, v139
  v_exp_f32 v140, v140
  v_exp_f32 v141, v141
  v_exp_f32 v142, v142
  v_exp_f32 v143, v143
  v_mfma_f32_32x32x16_bf16 v[152:167], v[180:183], v[36:39], v[152:167]
  s_mov_b64 exec, 1
  ds_add_u32 v13, v5 offset:8
  s_mov_b64 exec, -1
  v_cvt_pk_bf16_f32 v168, v136, v137
  v_cvt_pk_bf16_f32 v169, v138, v139
  v_cvt_pk_bf16_f32 v170, v140, v141
  v_cvt_pk_bf16_f32 v171, v142, v143
  v_exp_f32 v144, v144
  v_exp_f32 v145, v145
  v_exp_f32 v146, v146
  v_exp_f32 v147, v147
  v_mfma_f32_32x32x16_bf16 v[56:71], v[184:187], v[168:171], 0
  v_exp_f32 v148, v148
  v_exp_f32 v149, v149
  v_exp_f32 v150, v150
  v_exp_f32 v151, v151
  v_cvt_pk_bf16_f32 v172, v144, v145
  v_cvt_pk_bf16_f32 v173, v146, v147
  v_cvt_pk_bf16_f32 v174, v148, v149
  v_cvt_pk_bf16_f32 v175, v150, v151
  v_mfma_f32_32x32x16_bf16 v[136:151], v[176:179], v[40:43], 0
  v_exp_f32 v152, v152
  v_exp_f32 v153, v153
  v_exp_f32 v154, v154
  v_mfma_f32_32x32x16_bf16 v[56:71], v[188:191], v[172:175], v[56:71]
  v_exp_f32 v155, v155
  v_exp_f32 v156, v156
  v_exp_f32 v157, v157
  v_smfmac_f32_16x16x64_bf16 v[120:123], v[16:19], v[168:175], v20
  v_exp_f32 v158, v158
  v_exp_f32 v159, v159
  v_mfma_f32_32x32x16_bf16 v[136:151], v[180:183], v[44:47], v[136:151]
  v_cvt_pk_bf16_f32 v168, v152, v153
  v_cvt_pk_bf16_f32 v169, v154, v155
  v_cvt_pk_bf16_f32 v170, v156, v157
  v_cvt_pk_bf16_f32 v171, v158, v159
  v_exp_f32 v160, v160
  v_exp_f32 v161, v161
  v_exp_f32 v162, v162
  v_exp_f32 v163, v163
  v_mfma_f32_32x32x16_bf16 v[72:87], v[184:187], v[168:171], 0
  v_exp_f32 v164, v164
  v_exp_f32 v165, v165
  v_exp_f32 v166, v166
  v_exp_f32 v167, v167
  v_cvt_pk_bf16_f32 v172, v160, v161
  v_cvt_pk_bf16_f32 v173, v162, v163
  v_cvt_pk_bf16_f32 v174, v164, v165
  v_cvt_pk_bf16_f32 v175, v166, v167
  v_mfma_f32_32x32x16_bf16 v[152:167], v[176:179], v[48:51], 0
  ds_read_b32 v7, v8
  v_exp_f32 v136, v136
  v_exp_f32 v137, v137
  v_exp_f32 v138, v138
  v_mfma_f32_32x32x16_bf16 v[72:87], v[188:191], v[172:175], v[72:87]
  s_lshl_b32 s28, s16, 11
  v_exp_f32 v139, v139
  v_exp_f32 v140, v140
  v_exp_f32 v141, v141
  v_smfmac_f32_16x16x64_bf16 v[124:127], v[16:19], v[168:175], v20
  v_add_u32 v9, s28, v3
  v_exp_f32 v142, v142
  v_exp_f32 v143, v143
  v_mfma_f32_32x32x16_bf16 v[152:167], v[180:183], v[52:55], v[152:167]
  s_waitcnt lgkmcnt(0)
  v_cmp_lt_u32 vcc, s62, v7
  v_cvt_pk_bf16_f32 v168, v136, v137
  v_cvt_pk_bf16_f32 v169, v138, v139
  v_cvt_pk_bf16_f32 v170, v140, v141
  v_cvt_pk_bf16_f32 v171, v142, v143
  v_exp_f32 v144, v144
  v_exp_f32 v145, v145
  v_exp_f32 v146, v146
  v_exp_f32 v147, v147
  v_mfma_f32_32x32x16_bf16 v[88:103], v[184:187], v[168:171], 0
  s_mov_b32 s36, vcc_lo
  s_andn2_b32 s33, s36, s34
  v_exp_f32 v148, v148
  v_exp_f32 v149, v149
  v_exp_f32 v150, v150
  v_exp_f32 v151, v151
  v_cvt_pk_bf16_f32 v172, v144, v145
  v_cvt_pk_bf16_f32 v173, v146, v147
  v_cvt_pk_bf16_f32 v174, v148, v149
  v_cvt_pk_bf16_f32 v175, v150, v151
  v_exp_f32 v152, v152
  v_exp_f32 v153, v153
  v_exp_f32 v154, v154
  v_mfma_f32_32x32x16_bf16 v[88:103], v[188:191], v[172:175], v[88:103]
  s_bcnt1_i32_b32 s39, s33
  s_cmp_lt_u32 s39, 3
  v_exp_f32 v155, v155
  v_exp_f32 v156, v156
  v_exp_f32 v157, v157
  v_smfmac_f32_16x16x64_bf16 v[128:131], v[16:19], v[168:175], v20
  s_cbranch_scc1 .g2_kernel_a_F0n
  s_call_b64 s[72:73], .g2_kernel_a_three
.g2_kernel_a_F0n:
  v_exp_f32 v158, v158
  v_exp_f32 v159, v159
  v_cvt_pk_bf16_f32 v168, v152, v153
  v_cvt_pk_bf16_f32 v169, v154, v155
  v_cvt_pk_bf16_f32 v170, v156, v157
  v_cvt_pk_bf16_f32 v171, v158, v159
  v_exp_f32 v160, v160
  v_exp_f32 v161, v161
  v_exp_f32 v162, v162
  v_exp_f32 v163, v163
  v_mfma_f32_32x32x16_bf16 v[104:119], v[184:187], v[168:171], 0
  v_exp_f32 v164, v164
  v_exp_f32 v165, v165
  v_exp_f32 v166, v166
  v_exp_f32 v167, v167
  v_cvt_pk_bf16_f32 v172, v160, v161
  v_cvt_pk_bf16_f32 v173, v162, v163
  v_cvt_pk_bf16_f32 v174, v164, v165
  v_cvt_pk_bf16_f32 v175, v166, v167
  s_add_u32 s39, s39, s35
  s_cmp_ge_u32 s39, 3
  s_cbranch_scc1 .g2_kernel_a_p1
  s_call_b64 s[72:73], .g2_kernel_a_three
.g2_kernel_a_p1:
  s_waitcnt vmcnt(10)
  v_mfma_f32_32x32x16_bf16 v[136:151], v[192:195], v[24:27], 0
  v_mfma_f32_32x32x16_bf16 v[136:151], v[196:199], v[28:31], v[136:151]
  s_waitcnt vmcnt(8)
  s_mov_b32 s32, 0
  s_nop 8
  s_branch .g2_kernel_a_n1
  .p2align 6
.g2_kernel_a_loop:
  v_mfma_f32_32x32x16_bf16 v[152:167], v[176:179], v[32:35], 0
  s_andn2_b32 s33, s36, s34
  v_exp_f32 v136, v136
  v_exp_f32 v137, v137
  v_exp_f32 v138, v138
  v_mfma_f32_32x32x16_bf16 v[104:119], v[236:239], v[172:175], v[104:119]
  s_cbranch_scc0 .g2_kernel_a_N0c
.g2_kernel_a_N0b:
  v_exp_f32 v139, v139
  v_exp_f32 v140, v140
  v_exp_f32 v141, v141
  v_smfmac_f32_16x16x64_bf16 v[132:135], v[16:19], v[168:175], v20
  s_ff1_i32_b32 s33, s33
  v_exp_f32 v142, v142
  v_exp_f32 v143, v143
  v_mfma_f32_32x32x16_bf16 v[152:167], v[180:183], v[36:39], v[152:167]
  s_bitset1_b32 s34, s33
  v_cvt_pk_bf16_f32 v168, v136, v137
  v_cvt_pk_bf16_f32 v169, v138, v139
  v_cvt_pk_bf16_f32 v170, v140, v141
  v_cvt_pk_bf16_f32 v171, v142, v143
  v_exp_f32 v144, v144
  v_exp_f32 v145, v145
  v_exp_f32 v146, v146
  v_exp_f32 v147, v147
  v_mfma_f32_32x32x16_bf16 v[56:71], v[184:187], v[168:171], v[56:71]
  s_xor_b32 s33, s33, s24
  v_exp_f32 v148, v148
  v_exp_f32 v149, v149
  v_exp_f32 v150, v150
  v_exp_f32 v151, v151
  v_cvt_pk_bf16_f32 v172, v144, v145
  v_cvt_pk_bf16_f32 v173, v146, v147
  v_cvt_pk_bf16_f32 v174, v148, v149
  v_cvt_pk_bf16_f32 v175, v150, v151
  v_mfma_f32_32x32x16_bf16 v[136:151], v[176:179], v[40:43], 0
  s_lshl_b32 s33, s33, s25
  v_exp_f32 v152, v152
  v_exp_f32 v153, v153
  v_exp_f32 v154, v154
  v_mfma_f32_32x32x16_bf16 v[56:71], v[188:191], v[172:175], v[56:71]
  s_add_u32 s22, s20, s33
  v_exp_f32 v155, v155
  v_exp_f32 v156, v156
  v_exp_f32 v157, v157
  v_smfmac_f32_16x16x64_bf16 v[120:123], v[16:19], v[168:175], v20
  s_addc_u32 s23, s21, 0
  v_exp_f32 v158, v158
  v_exp_f32 v159, v159
  v_mfma_f32_32x32x16_bf16 v[136:151], v[180:183], v[44:47], v[136:151]
  v_cvt_pk_bf16_f32 v168, v152, v153
  v_cvt_pk_bf16_f32 v169, v154, v155
  v_cvt_pk_bf16_f32 v170, v156, v157
  v_cvt_pk_bf16_f32 v171, v158, v159
  v_exp_f32 v160, v160
  v_exp_f32 v161, v161
  v_exp_f32 v162, v162
  v_exp_f32 v163, v163
  v_mfma_f32_32x32x16_bf16 v[72:87], v[184:187], v[168:171], v[72:87]
  v_exp_f32 v164, v164
  v_exp_f32 v165, v165
  v_exp_f32 v166, v166
  v_exp_f32 v167, v167
  v_cvt_pk_bf16_f32 v172, v160, v161
  v_cvt_pk_bf16_f32 v173, v162, v163
  v_cvt_pk_bf16_f32 v174, v164, v165
  v_cvt_pk_bf16_f32 v175, v166, v167
  v_mfma_f32_32x32x16_bf16 v[152:167], v[176:179], v[48:51], 0
  v_exp_f32 v136, v136
  v_exp_f32 v137, v137
  v_exp_f32 v138, v138
  v_mfma_f32_32x32x16_bf16 v[72:87], v[188:191], v[172:175], v[72:87]
  v_exp_f32 v139, v139
  v_exp_f32 v140, v140
  v_exp_f32 v141, v141
  v_smfmac_f32_16x16x64_bf16 v[124:127], v[16:19], v[168:175], v20
  global_load_dwordx4 v[224:227], v3, s[22:23] offset:0
  global_load_dwordx4 v[228:231], v3, s[22:23] offset:1024
  global_load_dwordx4 v[232:235], v3, s[22:23] offset:2048
  global_load_dwordx4 v[236:239], v3, s[22:23] offset:3072
  v_exp_f32 v142, v142
  v_exp_f32 v143, v143
  v_mfma_f32_32x32x16_bf16 v[152:167], v[180:183], v[52:55], v[152:167]
  v_cvt_pk_bf16_f32 v168, v136, v137
  v_cvt_pk_bf16_f32 v169, v138, v139
  v_cvt_pk_bf16_f32 v170, v140, v141
  v_cvt_pk_bf16_f32 v171, v142, v143
  v_exp_f32 v144, v144
  v_exp_f32 v145, v145
  v_exp_f32 v146, v146
  v_exp_f32 v147, v147
  v_mfma_f32_32x32x16_bf16 v[88:103], v[184:187], v[168:171], v[88:103]
  s_waitcnt vmcnt(8)
  v_exp_f32 v148, v148
  v_exp_f32 v149, v149
  v_exp_f32 v150, v150
  v_exp_f32 v151, v151
  v_cvt_pk_bf16_f32 v172, v144, v145
  v_cvt_pk_bf16_f32 v173, v146, v147
  v_cvt_pk_bf16_f32 v174, v148, v149
  v_cvt_pk_bf16_f32 v175, v150, v151
  v_mfma_f32_32x32x16_bf16 v[136:151], v[192:195], v[24:27], 0
  v_exp_f32 v152, v152
  v_exp_f32 v153, v153
  v_exp_f32 v154, v154
  v_mfma_f32_32x32x16_bf16 v[88:103], v[188:191], v[172:175], v[88:103]
  v_exp_f32 v155, v155
  v_exp_f32 v156, v156
  v_exp_f32 v157, v157
  v_smfmac_f32_16x16x64_bf16 v[128:131], v[16:19], v[168:175], v20
  v_exp_f32 v158, v158
  v_exp_f32 v159, v159
  v_mfma_f32_32x32x16_bf16 v[136:151], v[196:199], v[28:31], v[136:151]
  v_cvt_pk_bf16_f32 v168, v152, v153
  v_cvt_pk_bf16_f32 v169, v154, v155
  v_cvt_pk_bf16_f32 v170, v156, v157
  v_cvt_pk_bf16_f32 v171, v158, v159
  v_exp_f32 v160, v160
  v_exp_f32 v161, v161
  v_exp_f32 v162, v162
  v_exp_f32 v163, v163
  v_mfma_f32_32x32x16_bf16 v[104:119], v[184:187], v[168:171], v[104:119]
  v_exp_f32 v164, v164
  v_exp_f32 v165, v165
  v_exp_f32 v166, v166
  v_exp_f32 v167, v167
  v_cvt_pk_bf16_f32 v172, v160, v161
  v_cvt_pk_bf16_f32 v173, v162, v163
  v_cvt_pk_bf16_f32 v174, v164, v165
  v_cvt_pk_bf16_f32 v175, v166, v167
.g2_kernel_a_n1:
  v_mfma_f32_32x32x16_bf16 v[152:167], v[192:195], v[32:35], 0
  s_andn2_b32 s33, s36, s34
  v_exp_f32 v136, v136
  v_exp_f32 v137, v137
  v_exp_f32 v138, v138
  v_mfma_f32_32x32x16_bf16 v[104:119], v[188:191], v[172:175], v[104:119]
  s_cbranch_scc0 .g2_kernel_a_N1c
.g2_kernel_a_N1b:
  v_exp_f32 v139, v139
  v_exp_f32 v140, v140
  v_exp_f32 v141, v141
  v_smfmac_f32_16x16x64_bf16 v[132:135], v[16:19], v[168:175], v20
  s_ff1_i32_b32 s33, s33
  v_exp_f32 v142, v142
  v_exp_f32 v143, v143
  v_mfma_f32_32x32x16_bf16 v[152:167], v[196:199], v[36:39], v[152:167]
  s_bitset1_b32 s34, s33
  v_cvt_pk_bf16_f32 v168, v136, v137
  v_cvt_pk_bf16_f32 v169, v138, v139
  v_cvt_pk_bf16_f32 v170, v140, v141
  v_cvt_pk_bf16_f32 v171, v142, v143
  v_exp_f32 v144, v144
  v_exp_f32 v145, v145
  v_exp_f32 v146, v146
  v_exp_f32 v147, v147
  v_mfma_f32_32x32x16_bf16 v[56:71], v[200:203], v[168:171], v[56:71]
  s_xor_b32 s33, s33, s24
  v_exp_f32 v148, v148
  v_exp_f32 v149, v149
  v_exp_f32 v150, v150
  v_exp_f32 v151, v151
  v_cvt_pk_bf16_f32 v172, v144, v145
  v_cvt_pk_bf16_f32 v173, v146, v147
  v_cvt_pk_bf16_f32 v174, v148, v149
  v_cvt_pk_bf16_f32 v175, v150, v151
  v_mfma_f32_32x32x16_bf16 v[136:151], v[192:195], v[40:43], 0
  s_lshl_b32 s33, s33, s25
  v_exp_f32 v152, v152
  v_exp_f32 v153, v153
  v_exp_f32 v154, v154
  v_mfma_f32_32x32x16_bf16 v[56:71], v[204:207], v[172:175], v[56:71]
  s_add_u32 s22, s20, s33
  v_exp_f32 v155, v155
  v_exp_f32 v156, v156
  v_exp_f32 v157, v157
  v_smfmac_f32_16x16x64_bf16 v[120:123], v[16:19], v[168:175], v20
  s_addc_u32 s23, s21, 0
  v_exp_f32 v158, v158
  v_exp_f32 v159, v159
  v_mfma_f32_32x32x16_bf16 v[136:151], v[196:199], v[44:47], v[136:151]
  v_cvt_pk_bf16_f32 v168, v152, v153
  v_cvt_pk_bf16_f32 v169, v154, v155
  v_cvt_pk_bf16_f32 v170, v156, v157
  v_cvt_pk_bf16_f32 v171, v158, v159
  v_exp_f32 v160, v160
  v_exp_f32 v161, v161
  v_exp_f32 v162, v162
  v_exp_f32 v163, v163
  v_mfma_f32_32x32x16_bf16 v[72:87], v[200:203], v[168:171], v[72:87]
  v_exp_f32 v164, v164
  v_exp_f32 v165, v165
  v_exp_f32 v166, v166
  v_exp_f32 v167, v167
  v_cvt_pk_bf16_f32 v172, v160, v161
  v_cvt_pk_bf16_f32 v173, v162, v163
  v_cvt_pk_bf16_f32 v174, v164, v165
  v_cvt_pk_bf16_f32 v175, v166, v167
  v_mfma_f32_32x32x16_bf16 v[152:167], v[192:195], v[48:51], 0
  v_exp_f32 v136, v136
  v_exp_f32 v137, v137
  v_exp_f32 v138, v138
  v_mfma_f32_32x32x16_bf16 v[72:87], v[204:207], v[172:175], v[72:87]
  v_exp_f32 v139, v139
  v_exp_f32 v140, v140
  v_exp_f32 v141, v141
  v_smfmac_f32_16x16x64_bf16 v[124:127], v[16:19], v[168:175], v20
  global_load_dwordx4 v[176:179], v3, s[22:23] offset:0
  global_load_dwordx4 v[180:183], v3, s[22:23] offset:1024
  global_load_dwordx4 v[184:187], v3, s[22:23] offset:2048
  global_load_dwordx4 v[188:191], v3, s[22:23] offset:3072
  v_exp_f32 v142, v142
  v_exp_f32 v143, v143
  v_mfma_f32_32x32x16_bf16 v[152:167], v[196:199], v[52:55], v[152:167]
  v_cvt_pk_bf16_f32 v168, v136, v137
  v_cvt_pk_bf16_f32 v169, v138, v139
  v_cvt_pk_bf16_f32 v170, v140, v141
  v_cvt_pk_bf16_f32 v171, v142, v143
  v_exp_f32 v144, v144
  v_exp_f32 v145, v145
  v_exp_f32 v146, v146
  v_exp_f32 v147, v147
  v_mfma_f32_32x32x16_bf16 v[88:103], v[200:203], v[168:171], v[88:103]
  s_waitcnt vmcnt(8)
  v_exp_f32 v148, v148
  v_exp_f32 v149, v149
  v_exp_f32 v150, v150
  v_exp_f32 v151, v151
  v_cvt_pk_bf16_f32 v172, v144, v145
  v_cvt_pk_bf16_f32 v173, v146, v147
  v_cvt_pk_bf16_f32 v174, v148, v149
  v_cvt_pk_bf16_f32 v175, v150, v151
  v_mfma_f32_32x32x16_bf16 v[136:151], v[208:211], v[24:27], 0
  v_exp_f32 v152, v152
  v_exp_f32 v153, v153
  v_exp_f32 v154, v154
  v_mfma_f32_32x32x16_bf16 v[88:103], v[204:207], v[172:175], v[88:103]
  v_exp_f32 v155, v155
  v_exp_f32 v156, v156
  v_exp_f32 v157, v157
  v_smfmac_f32_16x16x64_bf16 v[128:131], v[16:19], v[168:175], v20
  v_exp_f32 v158, v158
  v_exp_f32 v159, v159
  v_mfma_f32_32x32x16_bf16 v[136:151], v[212:215], v[28:31], v[136:151]
  v_cvt_pk_bf16_f32 v168, v152, v153
  v_cvt_pk_bf16_f32 v169, v154, v155
  v_cvt_pk_bf16_f32 v170, v156, v157
  v_cvt_pk_bf16_f32 v171, v158, v159
  v_exp_f32 v160, v160
  v_exp_f32 v161, v161
  v_exp_f32 v162, v162
  v_exp_f32 v163, v163
  v_mfma_f32_32x32x16_bf16 v[104:119], v[200:203], v[168:171], v[104:119]
  v_exp_f32 v164, v164
  v_exp_f32 v165, v165
  v_exp_f32 v166, v166
  v_exp_f32 v167, v167
  v_cvt_pk_bf16_f32 v172, v160, v161
  v_cvt_pk_bf16_f32 v173, v162, v163
  v_cvt_pk_bf16_f32 v174, v164, v165
  v_cvt_pk_bf16_f32 v175, v166, v167
  v_mfma_f32_32x32x16_bf16 v[152:167], v[208:211], v[32:35], 0
  s_andn2_b32 s33, s36, s34
  v_exp_f32 v136, v136
  v_exp_f32 v137, v137
  v_exp_f32 v138, v138
  v_mfma_f32_32x32x16_bf16 v[104:119], v[204:207], v[172:175], v[104:119]
  s_cbranch_scc0 .g2_kernel_a_N2c
.g2_kernel_a_N2b:
  v_exp_f32 v139, v139
  v_exp_f32 v140, v140
  v_exp_f32 v141, v141
  v_smfmac_f32_16x16x64_bf16 v[132:135], v[16:19], v[168:175], v20
  s_ff1_i32_b32 s33, s33
  v_exp_f32 v142, v142
  v_exp_f32 v143, v143
  v_mfma_f32_32x32x16_bf16 v[152:167], v[212:215], v[36:39], v[152:167]
  s_bitset1_b32 s34, s33
  v_cvt_pk_bf16_f32 v168, v136, v137
  v_cvt_pk_bf16_f32 v169, v138, v139
  v_cvt_pk_bf16_f32 v170, v140, v141
  v_cvt_pk_bf16_f32 v171, v142, v143
  v_exp_f32 v144, v144
  v_exp_f32 v145, v145
  v_exp_f32 v146, v146
  v_exp_f32 v147, v147
  v_mfma_f32_32x32x16_bf16 v[56:71], v[216:219], v[168:171], v[56:71]
  s_xor_b32 s33, s33, s24
  v_exp_f32 v148, v148
  v_exp_f32 v149, v149
  v_exp_f32 v150, v150
  v_exp_f32 v151, v151
  v_cvt_pk_bf16_f32 v172, v144, v145
  v_cvt_pk_bf16_f32 v173, v146, v147
  v_cvt_pk_bf16_f32 v174, v148, v149
  v_cvt_pk_bf16_f32 v175, v150, v151
  v_mfma_f32_32x32x16_bf16 v[136:151], v[208:211], v[40:43], 0
  s_lshl_b32 s33, s33, s25
  v_exp_f32 v152, v152
  v_exp_f32 v153, v153
  v_exp_f32 v154, v154
  v_mfma_f32_32x32x16_bf16 v[56:71], v[220:223], v[172:175], v[56:71]
  s_add_u32 s22, s20, s33
  v_exp_f32 v155, v155
  v_exp_f32 v156, v156
  v_exp_f32 v157, v157
  v_smfmac_f32_16x16x64_bf16 v[120:123], v[16:19], v[168:175], v20
  s_addc_u32 s23, s21, 0
  v_exp_f32 v158, v158
  v_exp_f32 v159, v159
  v_mfma_f32_32x32x16_bf16 v[136:151], v[212:215], v[44:47], v[136:151]
  v_cvt_pk_bf16_f32 v168, v152, v153
  v_cvt_pk_bf16_f32 v169, v154, v155
  v_cvt_pk_bf16_f32 v170, v156, v157
  v_cvt_pk_bf16_f32 v171, v158, v159
  v_exp_f32 v160, v160
  v_exp_f32 v161, v161
  v_exp_f32 v162, v162
  v_exp_f32 v163, v163
  v_mfma_f32_32x32x16_bf16 v[72:87], v[216:219], v[168:171], v[72:87]
  v_exp_f32 v164, v164
  v_exp_f32 v165, v165
  v_exp_f32 v166, v166
  v_exp_f32 v167, v167
  v_cvt_pk_bf16_f32 v172, v160, v161
  v_cvt_pk_bf16_f32 v173, v162, v163
  v_cvt_pk_bf16_f32 v174, v164, v165
  v_cvt_pk_bf16_f32 v175, v166, v167
  v_mfma_f32_32x32x16_bf16 v[152:167], v[208:211], v[48:51], 0
  v_exp_f32 v136, v136
  v_exp_f32 v137, v137
  v_exp_f32 v138, v138
  v_mfma_f32_32x32x16_bf16 v[72:87], v[220:223], v[172:175], v[72:87]
  v_exp_f32 v139, v139
  v_exp_f32 v140, v140
  v_exp_f32 v141, v141
  v_smfmac_f32_16x16x64_bf16 v[124:127], v[16:19], v[168:175], v20
  global_load_dwordx4 v[192:195], v3, s[22:23] offset:0
  global_load_dwordx4 v[196:199], v3, s[22:23] offset:1024
  global_load_dwordx4 v[200:203], v3, s[22:23] offset:2048
  global_load_dwordx4 v[204:207], v3, s[22:23] offset:3072
  v_exp_f32 v142, v142
  v_exp_f32 v143, v143
  v_mfma_f32_32x32x16_bf16 v[152:167], v[212:215], v[52:55], v[152:167]
  v_cvt_pk_bf16_f32 v168, v136, v137
  v_cvt_pk_bf16_f32 v169, v138, v139
  v_cvt_pk_bf16_f32 v170, v140, v141
  v_cvt_pk_bf16_f32 v171, v142, v143
  v_exp_f32 v144, v144
  v_exp_f32 v145, v145
  v_exp_f32 v146, v146
  v_exp_f32 v147, v147
  v_mfma_f32_32x32x16_bf16 v[88:103], v[216:219], v[168:171], v[88:103]
  s_waitcnt vmcnt(8)
  v_exp_f32 v148, v148
  v_exp_f32 v149, v149
  v_exp_f32 v150, v150
  v_exp_f32 v151, v151
  v_cvt_pk_bf16_f32 v172, v144, v145
  v_cvt_pk_bf16_f32 v173, v146, v147
  v_cvt_pk_bf16_f32 v174, v148, v149
  v_cvt_pk_bf16_f32 v175, v150, v151
  v_mfma_f32_32x32x16_bf16 v[136:151], v[224:227], v[24:27], 0
  v_exp_f32 v152, v152
  v_exp_f32 v153, v153
  v_exp_f32 v154, v154
  v_mfma_f32_32x32x16_bf16 v[88:103], v[220:223], v[172:175], v[88:103]
  v_exp_f32 v155, v155
  v_exp_f32 v156, v156
  v_exp_f32 v157, v157
  v_smfmac_f32_16x16x64_bf16 v[128:131], v[16:19], v[168:175], v20
  v_exp_f32 v158, v158
  v_exp_f32 v159, v159
  v_mfma_f32_32x32x16_bf16 v[136:151], v[228:231], v[28:31], v[136:151]
  s_and_b32 s28, s32, 3
  v_cvt_pk_bf16_f32 v168, v152, v153
  v_cvt_pk_bf16_f32 v169, v154, v155
  v_cvt_pk_bf16_f32 v170, v156, v157
  v_cvt_pk_bf16_f32 v171, v158, v159
  v_exp_f32 v160, v160
  v_exp_f32 v161, v161
  v_exp_f32 v162, v162
  v_exp_f32 v163, v163
  v_mfma_f32_32x32x16_bf16 v[104:119], v[216:219], v[168:171], v[104:119]
  s_cmp_eq_u32 s28, 3
  v_exp_f32 v164, v164
  v_exp_f32 v165, v165
  v_exp_f32 v166, v166
  v_exp_f32 v167, v167
  v_cvt_pk_bf16_f32 v172, v160, v161
  v_cvt_pk_bf16_f32 v173, v162, v163
  v_cvt_pk_bf16_f32 v174, v164, v165
  v_cvt_pk_bf16_f32 v175, v166, v167
  s_cbranch_scc1 .g2_kernel_a_last
  v_mfma_f32_32x32x16_bf16 v[152:167], v[224:227], v[32:35], 0
  s_andn2_b32 s33, s36, s34
  v_exp_f32 v136, v136
  v_exp_f32 v137, v137
  v_exp_f32 v138, v138
  v_mfma_f32_32x32x16_bf16 v[104:119], v[220:223], v[172:175], v[104:119]
  s_cbranch_scc0 .g2_kernel_a_N3c
.g2_kernel_a_N3b:
  v_exp_f32 v139, v139
  v_exp_f32 v140, v140
  v_exp_f32 v141, v141
  v_smfmac_f32_16x16x64_bf16 v[132:135], v[16:19], v[168:175], v20
  s_ff1_i32_b32 s33, s33
  v_exp_f32 v142, v142
  v_exp_f32 v143, v143
  v_mfma_f32_32x32x16_bf16 v[152:167], v[228:231], v[36:39], v[152:167]
  s_bitset1_b32 s34, s33
  v_cvt_pk_bf16_f32 v168, v136, v137
  v_cvt_pk_bf16_f32 v169, v138, v139
  v_cvt_pk_bf16_f32 v170, v140, v141
  v_cvt_pk_bf16_f32 v171, v142, v143
  v_exp_f32 v144, v144
  v_exp_f32 v145, v145
  v_exp_f32 v146, v146
  v_exp_f32 v147, v147
  v_mfma_f32_32x32x16_bf16 v[56:71], v[232:235], v[168:171], v[56:71]
  s_xor_b32 s33, s33, s24
  v_exp_f32 v148, v148
  v_exp_f32 v149, v149
  v_exp_f32 v150, v150
  v_exp_f32 v151, v151
  v_cvt_pk_bf16_f32 v172, v144, v145
  v_cvt_pk_bf16_f32 v173, v146, v147
  v_cvt_pk_bf16_f32 v174, v148, v149
  v_cvt_pk_bf16_f32 v175, v150, v151
  v_mfma_f32_32x32x16_bf16 v[136:151], v[224:227], v[40:43], 0
  s_lshl_b32 s33, s33, s25
  v_exp_f32 v152, v152
  v_exp_f32 v153, v153
  v_exp_f32 v154, v154
  v_mfma_f32_32x32x16_bf16 v[56:71], v[236:239], v[172:175], v[56:71]
  s_add_u32 s22, s20, s33
  v_exp_f32 v155, v155
  v_exp_f32 v156, v156
  v_exp_f32 v157, v157
  v_smfmac_f32_16x16x64_bf16 v[120:123], v[16:19], v[168:175], v20
  s_addc_u32 s23, s21, 0
  v_exp_f32 v158, v158
  v_exp_f32 v159, v159
  v_mfma_f32_32x32x16_bf16 v[136:151], v[228:231], v[44:47], v[136:151]
  v_cvt_pk_bf16_f32 v168, v152, v153
  v_cvt_pk_bf16_f32 v169, v154, v155
  v_cvt_pk_bf16_f32 v170, v156, v157
  v_cvt_pk_bf16_f32 v171, v158, v159
  v_exp_f32 v160, v160
  v_exp_f32 v161, v161
  v_exp_f32 v162, v162
  v_exp_f32 v163, v163
  v_mfma_f32_32x32x16_bf16 v[72:87], v[232:235], v[168:171], v[72:87]
  v_exp_f32 v164, v164
  v_exp_f32 v165, v165
  v_exp_f32 v166, v166
  v_exp_f32 v167, v167
  v_cvt_pk_bf16_f32 v172, v160, v161
  v_cvt_pk_bf16_f32 v173, v162, v163
  v_cvt_pk_bf16_f32 v174, v164, v165
  v_cvt_pk_bf16_f32 v175, v166, v167
  v_mfma_f32_32x32x16_bf16 v[152:167], v[224:227], v[48:51], 0
  v_exp_f32 v136, v136
  v_exp_f32 v137, v137
  v_exp_f32 v138, v138
  v_mfma_f32_32x32x16_bf16 v[72:87], v[236:239], v[172:175], v[72:87]
  v_exp_f32 v139, v139
  v_exp_f32 v140, v140
  v_exp_f32 v141, v141
  v_smfmac_f32_16x16x64_bf16 v[124:127], v[16:19], v[168:175], v20
  global_load_dwordx4 v[208:211], v3, s[22:23] offset:0
  global_load_dwordx4 v[212:215], v3, s[22:23] offset:1024
  global_load_dwordx4 v[216:219], v3, s[22:23] offset:2048
  global_load_dwordx4 v[220:223], v3, s[22:23] offset:3072
  v_exp_f32 v142, v142
  v_exp_f32 v143, v143
  v_mfma_f32_32x32x16_bf16 v[152:167], v[228:231], v[52:55], v[152:167]
  v_cvt_pk_bf16_f32 v168, v136, v137
  v_cvt_pk_bf16_f32 v169, v138, v139
  v_cvt_pk_bf16_f32 v170, v140, v141
  v_cvt_pk_bf16_f32 v171, v142, v143
  v_exp_f32 v144, v144
  v_exp_f32 v145, v145
  v_exp_f32 v146, v146
  v_exp_f32 v147, v147
  v_mfma_f32_32x32x16_bf16 v[88:103], v[232:235], v[168:171], v[88:103]
  s_waitcnt vmcnt(8)
  v_exp_f32 v148, v148
  v_exp_f32 v149, v149
  v_exp_f32 v150, v150
  v_exp_f32 v151, v151
  v_cvt_pk_bf16_f32 v172, v144, v145
  v_cvt_pk_bf16_f32 v173, v146, v147
  v_cvt_pk_bf16_f32 v174, v148, v149
  v_cvt_pk_bf16_f32 v175, v150, v151
  v_mfma_f32_32x32x16_bf16 v[136:151], v[176:179], v[24:27], 0
  v_exp_f32 v152, v152
  v_exp_f32 v153, v153
  v_exp_f32 v154, v154
  v_mfma_f32_32x32x16_bf16 v[88:103], v[236:239], v[172:175], v[88:103]
  v_exp_f32 v155, v155
  v_exp_f32 v156, v156
  v_exp_f32 v157, v157
  v_smfmac_f32_16x16x64_bf16 v[128:131], v[16:19], v[168:175], v20
  v_exp_f32 v158, v158
  v_exp_f32 v159, v159
  v_mfma_f32_32x32x16_bf16 v[136:151], v[180:183], v[28:31], v[136:151]
  s_add_u32 s32, s32, 1
  v_cvt_pk_bf16_f32 v168, v152, v153
  v_cvt_pk_bf16_f32 v169, v154, v155
  v_cvt_pk_bf16_f32 v170, v156, v157
  v_cvt_pk_bf16_f32 v171, v158, v159
  v_exp_f32 v160, v160
  v_exp_f32 v161, v161
  v_exp_f32 v162, v162
  v_exp_f32 v163, v163
  v_mfma_f32_32x32x16_bf16 v[104:119], v[232:235], v[168:171], v[104:119]
  s_cmp_eq_u32 s35, 0
  v_exp_f32 v164, v164
  v_exp_f32 v165, v165
  v_exp_f32 v166, v166
  v_exp_f32 v167, v167
  v_cvt_pk_bf16_f32 v172, v160, v161
  v_cvt_pk_bf16_f32 v173, v162, v163
  v_cvt_pk_bf16_f32 v174, v164, v165
  v_cvt_pk_bf16_f32 v175, v166, v167
  s_cbranch_scc1 .g2_kernel_a_loop
  s_branch .g2_kernel_a_redo
.g2_kernel_a_last:
  v_mfma_f32_32x32x16_bf16 v[152:167], v[224:227], v[32:35], 0
  ds_read_b32 v21, v13 offset:8
  s_andn2_b32 s33, s36, s34
  v_exp_f32 v136, v136
  v_exp_f32 v137, v137
  v_exp_f32 v138, v138
  v_mfma_f32_32x32x16_bf16 v[104:119], v[220:223], v[172:175], v[104:119]
  s_cbranch_scc0 .g2_kernel_a_L3c
.g2_kernel_a_L3b:
  v_exp_f32 v139, v139
  v_exp_f32 v140, v140
  v_exp_f32 v141, v141
  v_smfmac_f32_16x16x64_bf16 v[132:135], v[16:19], v[168:175], v20
  s_ff1_i32_b32 s33, s33
  v_exp_f32 v142, v142
  v_exp_f32 v143, v143
  v_mfma_f32_32x32x16_bf16 v[152:167], v[228:231], v[36:39], v[152:167]
  s_bitset1_b32 s34, s33
  ds_read_b128 v[24:27], v14 offset:0
  v_cvt_pk_bf16_f32 v168, v136, v137
  v_cvt_pk_bf16_f32 v169, v138, v139
  v_cvt_pk_bf16_f32 v170, v140, v141
  v_cvt_pk_bf16_f32 v171, v142, v143
  v_exp_f32 v144, v144
  v_exp_f32 v145, v145
  v_exp_f32 v146, v146
  v_exp_f32 v147, v147
  v_mfma_f32_32x32x16_bf16 v[56:71], v[232:235], v[168:171], v[56:71]
  s_xor_b32 s33, s33, s24
  ds_read_b128 v[28:31], v14 offset:1024
  v_exp_f32 v148, v148
  v_exp_f32 v149, v149
  v_exp_f32 v150, v150
  v_exp_f32 v151, v151
  v_cvt_pk_bf16_f32 v172, v144, v145
  v_cvt_pk_bf16_f32 v173, v146, v147
  v_cvt_pk_bf16_f32 v174, v148, v149
  v_cvt_pk_bf16_f32 v175, v150, v151
  v_mfma_f32_32x32x16_bf16 v[136:151], v[224:227], v[40:43], 0
  s_waitcnt lgkmcnt(2)
  s_lshl_b32 s33, s33, s25
  v_exp_f32 v152, v152
  v_exp_f32 v153, v153
  v_exp_f32 v154, v154
  v_mfma_f32_32x32x16_bf16 v[56:71], v[236:239], v[172:175], v[56:71]
  v_cmp_gt_u32 vcc, s27, v21
  s_add_u32 s22, s20, s33
  v_exp_f32 v155, v155
  v_exp_f32 v156, v156
  v_exp_f32 v157, v157
  v_smfmac_f32_16x16x64_bf16 v[120:123], v[16:19], v[168:175], v20
  s_addc_u32 s23, s21, 0
  v_exp_f32 v158, v158
  v_exp_f32 v159, v159
  v_mfma_f32_32x32x16_bf16 v[136:151], v[228:231], v[44:47], v[136:151]
  v_cvt_pk_bf16_f32 v168, v152, v153
  v_cvt_pk_bf16_f32 v169, v154, v155
  v_cvt_pk_bf16_f32 v170, v156, v157
  v_cvt_pk_bf16_f32 v171, v158, v159
  v_exp_f32 v160, v160
  v_exp_f32 v161, v161
  v_exp_f32 v162, v162
  v_exp_f32 v163, v163
  v_mfma_f32_32x32x16_bf16 v[72:87], v[232:235], v[168:171], v[72:87]
  s_cbranch_vccnz .g2_kernel_a_L3g
.g2_kernel_a_L3h:
  ds_read_b128 v[32:35], v14 offset:2048
  ds_read_b128 v[36:39], v14 offset:3072
  v_cvt_pk_bf16_f32 v56, v56, v57
  v_cvt_pk_bf16_f32 v57, v58, v59
  v_cvt_pk_bf16_f32 v58, v60, v61
  v_cvt_pk_bf16_f32 v59, v62, v63
  v_add_f32 v6, v120, v121
  v_exp_f32 v164, v164
  v_exp_f32 v165, v165
  v_exp_f32 v166, v166
  v_exp_f32 v167, v167
  v_cvt_pk_bf16_f32 v172, v160, v161
  v_cvt_pk_bf16_f32 v173, v162, v163
  v_cvt_pk_bf16_f32 v174, v164, v165
  v_cvt_pk_bf16_f32 v175, v166, v167
  v_mfma_f32_32x32x16_bf16 v[152:167], v[224:227], v[48:51], 0
  ds_write_b128 v9, v[56:59] offset:0
  v_cvt_pk_bf16_f32 v60, v64, v65
  v_cvt_pk_bf16_f32 v61, v66, v67
  v_cvt_pk_bf16_f32 v62, v68, v69
  v_cvt_pk_bf16_f32 v63, v70, v71
  v_exp_f32 v136, v136
  v_exp_f32 v137, v137
  v_exp_f32 v138, v138
  v_mfma_f32_32x32x16_bf16 v[72:87], v[236:239], v[172:175], v[72:87]
  ds_write_b128 v9, v[60:63] offset:1024
  v_mov_b32 v120, 0
  v_mov_b32 v121, 0
  v_exp_f32 v139, v139
  v_exp_f32 v140, v140
  v_exp_f32 v141, v141
  v_smfmac_f32_16x16x64_bf16 v[124:127], v[16:19], v[168:175], v20
  global_load_dwordx4 v[208:211], v3, s[22:23] offset:0
  global_load_dwordx4 v[212:215], v3, s[22:23] offset:1024
  global_load_dwordx4 v[216:219], v3, s[22:23] offset:2048
  global_load_dwordx4 v[220:223], v3, s[22:23] offset:3072
  ds_write_b32 v10, v6 offset:0
  ds_write_b32 v11, v12 offset:0
  v_exp_f32 v142, v142
  v_exp_f32 v143, v143
  v_mfma_f32_32x32x16_bf16 v[152:167], v[228:231], v[52:55], v[152:167]
  ds_read_b128 v[40:43], v14 offset:4096
  s_wakeup
  v_cvt_pk_bf16_f32 v168, v136, v137
  v_cvt_pk_bf16_f32 v169, v138, v139
  v_cvt_pk_bf16_f32 v170, v140, v141
  v_cvt_pk_bf16_f32 v171, v142, v143
  v_exp_f32 v144, v144
  v_exp_f32 v145, v145
  v_exp_f32 v146, v146
  v_exp_f32 v147, v147
  v_mfma_f32_32x32x16_bf16 v[88:103], v[232:235], v[168:171], v[88:103]
  s_waitcnt vmcnt(8)
  ds_read_b128 v[44:47], v14 offset:5120
  v_cvt_pk_bf16_f32 v72, v72, v73
  v_cvt_pk_bf16_f32 v73, v74, v75
  v_cvt_pk_bf16_f32 v74, v76, v77
  v_cvt_pk_bf16_f32 v75, v78, v79
  v_add_f32 v6, v124, v125
  v_exp_f32 v148, v148
  v_exp_f32 v149, v149
  v_exp_f32 v150, v150
  v_exp_f32 v151, v151
  v_cvt_pk_bf16_f32 v172, v144, v145
  v_cvt_pk_bf16_f32 v173, v146, v147
  v_cvt_pk_bf16_f32 v174, v148, v149
  v_cvt_pk_bf16_f32 v175, v150, v151
  s_waitcnt lgkmcnt(8)
  v_mfma_f32_32x32x16_bf16 v[136:151], v[176:179], v[24:27], 0
  ds_write_b128 v9, v[72:75] offset:8192
  v_cvt_pk_bf16_f32 v76, v80, v81
  v_cvt_pk_bf16_f32 v77, v82, v83
  v_cvt_pk_bf16_f32 v78, v84, v85
  v_cvt_pk_bf16_f32 v79, v86, v87
  v_exp_f32 v152, v152
  v_exp_f32 v153, v153
  v_exp_f32 v154, v154
  v_mfma_f32_32x32x16_bf16 v[88:103], v[236:239], v[172:175], v[88:103]
  ds_write_b128 v9, v[76:79] offset:9216
  v_mov_b32 v124, 0
  v_mov_b32 v125, 0
  v_exp_f32 v155, v155
  v_exp_f32 v156, v156
  v_exp_f32 v157, v157
  v_smfmac_f32_16x16x64_bf16 v[128:131], v[16:19], v[168:175], v20
  ds_write_b32 v10, v6 offset:512
  ds_write_b32 v11, v12 offset:16
  v_exp_f32 v158, v158
  v_exp_f32 v159, v159
  v_mfma_f32_32x32x16_bf16 v[136:151], v[180:183], v[28:31], v[136:151]
  ds_read_b128 v[48:51], v14 offset:6144
  s_wakeup
  v_cvt_pk_bf16_f32 v168, v152, v153
  v_cvt_pk_bf16_f32 v169, v154, v155
  v_cvt_pk_bf16_f32 v170, v156, v157
  v_cvt_pk_bf16_f32 v171, v158, v159
  v_exp_f32 v160, v160
  v_exp_f32 v161, v161
  v_exp_f32 v162, v162
  v_exp_f32 v163, v163
  v_mfma_f32_32x32x16_bf16 v[104:119], v[232:235], v[168:171], v[104:119]
  ds_read_b128 v[52:55], v14 offset:7168
  v_cvt_pk_bf16_f32 v88, v88, v89
  v_cvt_pk_bf16_f32 v89, v90, v91
  v_cvt_pk_bf16_f32 v90, v92, v93
  v_cvt_pk_bf16_f32 v91, v94, v95
  v_add_f32 v6, v128, v129
  ds_write_b128 v9, v[88:91] offset:16384
  v_cvt_pk_bf16_f32 v92, v96, v97
  v_cvt_pk_bf16_f32 v93, v98, v99
  v_cvt_pk_bf16_f32 v94, v100, v101
  v_cvt_pk_bf16_f32 v95, v102, v103
  ds_write_b128 v9, v[92:95] offset:17408
  v_mov_b32 v128, 0
  v_mov_b32 v129, 0
  ds_write_b32 v10, v6 offset:1024
  ds_write_b32 v11, v12 offset:32
  s_add_u32 s32, s32, 1
  v_exp_f32 v164, v164
  v_exp_f32 v165, v165
  v_exp_f32 v166, v166
  v_exp_f32 v167, v167
  v_cvt_pk_bf16_f32 v172, v160, v161
  v_cvt_pk_bf16_f32 v173, v162, v163
  v_cvt_pk_bf16_f32 v174, v164, v165
  v_cvt_pk_bf16_f32 v175, v166, v167
  s_cmp_eq_u32 s32, 8
  s_cbranch_scc1 .g2_kernel_a_end
  s_waitcnt lgkmcnt(15)
  v_mfma_f32_32x32x16_bf16 v[152:167], v[176:179], v[32:35], 0
  s_andn2_b32 s33, s36, s34
  v_exp_f32 v136, v136
  v_exp_f32 v137, v137
  v_exp_f32 v138, v138
  v_mfma_f32_32x32x16_bf16 v[104:119], v[236:239], v[172:175], v[104:119]
  s_cbranch_scc0 .g2_kernel_a_G0c
.g2_kernel_a_G0b:
  v_exp_f32 v139, v139
  v_exp_f32 v140, v140
  v_exp_f32 v141, v141
  v_smfmac_f32_16x16x64_bf16 v[132:135], v[16:19], v[168:175], v20
  s_ff1_i32_b32 s33, s33
  v_exp_f32 v142, v142
  v_exp_f32 v143, v143
  v_mfma_f32_32x32x16_bf16 v[152:167], v[180:183], v[36:39], v[152:167]
  s_bitset1_b32 s34, s33
  v_cvt_pk_bf16_f32 v168, v136, v137
  v_cvt_pk_bf16_f32 v169, v138, v139
  v_cvt_pk_bf16_f32 v170, v140, v141
  v_cvt_pk_bf16_f32 v171, v142, v143
  v_exp_f32 v144, v144
  v_exp_f32 v145, v145
  v_exp_f32 v146, v146
  v_exp_f32 v147, v147
  s_waitcnt lgkmcnt(14)
  v_mfma_f32_32x32x16_bf16 v[56:71], v[184:187], v[168:171], 0
  s_xor_b32 s33, s33, s24
  v_cvt_pk_bf16_f32 v104, v104, v105
  v_cvt_pk_bf16_f32 v105, v106, v107
  v_cvt_pk_bf16_f32 v106, v108, v109
  v_cvt_pk_bf16_f32 v107, v110, v111
  v_add_f32 v6, v132, v133
  v_exp_f32 v148, v148
  v_exp_f32 v149, v149
  v_exp_f32 v150, v150
  v_exp_f32 v151, v151
  v_cvt_pk_bf16_f32 v172, v144, v145
  v_cvt_pk_bf16_f32 v173, v146, v147
  v_cvt_pk_bf16_f32 v174, v148, v149
  v_cvt_pk_bf16_f32 v175, v150, v151
  s_waitcnt lgkmcnt(10)
  v_mfma_f32_32x32x16_bf16 v[136:151], v[176:179], v[40:43], 0
  s_lshl_b32 s33, s33, s25
  ds_write_b128 v9, v[104:107] offset:24576
  v_cvt_pk_bf16_f32 v108, v112, v113
  v_cvt_pk_bf16_f32 v109, v114, v115
  v_cvt_pk_bf16_f32 v110, v116, v117
  v_cvt_pk_bf16_f32 v111, v118, v119
  v_exp_f32 v152, v152
  v_exp_f32 v153, v153
  v_exp_f32 v154, v154
  v_mfma_f32_32x32x16_bf16 v[56:71], v[188:191], v[172:175], v[56:71]
  s_add_u32 s22, s20, s33
  ds_write_b128 v9, v[108:111] offset:25600
  v_mov_b32 v132, 0
  v_mov_b32 v133, 0
  v_exp_f32 v155, v155
  v_exp_f32 v156, v156
  v_exp_f32 v157, v157
  v_smfmac_f32_16x16x64_bf16 v[120:123], v[16:19], v[168:175], v20
  s_addc_u32 s23, s21, 0
  ds_write_b32 v10, v6 offset:1536
  v_exp_f32 v158, v158
  v_exp_f32 v159, v159
  v_mfma_f32_32x32x16_bf16 v[136:151], v[180:183], v[44:47], v[136:151]
  v_cvt_pk_bf16_f32 v168, v152, v153
  v_cvt_pk_bf16_f32 v169, v154, v155
  v_cvt_pk_bf16_f32 v170, v156, v157
  v_cvt_pk_bf16_f32 v171, v158, v159
  v_exp_f32 v160, v160
  v_exp_f32 v161, v161
  v_exp_f32 v162, v162
  v_exp_f32 v163, v163
  s_waitcnt lgkmcnt(11)
  v_mfma_f32_32x32x16_bf16 v[72:87], v[184:187], v[168:171], 0
  ds_write_b32 v11, v12 offset:48
  v_exp_f32 v164, v164
  v_exp_f32 v165, v165
  v_exp_f32 v166, v166
  v_exp_f32 v167, v167
  v_cvt_pk_bf16_f32 v172, v160, v161
  v_cvt_pk_bf16_f32 v173, v162, v163
  v_cvt_pk_bf16_f32 v174, v164, v165
  v_cvt_pk_bf16_f32 v175, v166, v167
  s_waitcnt lgkmcnt(8)
  v_mfma_f32_32x32x16_bf16 v[152:167], v[176:179], v[48:51], 0
  v_add_u32 v12, 1, v12
  v_exp_f32 v136, v136
  v_exp_f32 v137, v137
  v_exp_f32 v138, v138
  v_mfma_f32_32x32x16_bf16 v[72:87], v[188:191], v[172:175], v[72:87]
  v_exp_f32 v139, v139
  v_exp_f32 v140, v140
  v_exp_f32 v141, v141
  v_smfmac_f32_16x16x64_bf16 v[124:127], v[16:19], v[168:175], v20
  global_load_dwordx4 v[224:227], v3, s[22:23] offset:0
  global_load_dwordx4 v[228:231], v3, s[22:23] offset:1024
  global_load_dwordx4 v[232:235], v3, s[22:23] offset:2048
  global_load_dwordx4 v[236:239], v3, s[22:23] offset:3072
  s_add_u32 s27, s27, 4
  v_exp_f32 v142, v142
  v_exp_f32 v143, v143
  v_mfma_f32_32x32x16_bf16 v[152:167], v[180:183], v[52:55], v[152:167]
  v_cvt_pk_bf16_f32 v168, v136, v137
  v_cvt_pk_bf16_f32 v169, v138, v139
  v_cvt_pk_bf16_f32 v170, v140, v141
  v_cvt_pk_bf16_f32 v171, v142, v143
  v_exp_f32 v144, v144
  v_exp_f32 v145, v145
  v_exp_f32 v146, v146
  v_exp_f32 v147, v147
  s_waitcnt lgkmcnt(6)
  v_mfma_f32_32x32x16_bf16 v[88:103], v[184:187], v[168:171], 0
  s_waitcnt vmcnt(8)
  v_exp_f32 v148, v148
  v_exp_f32 v149, v149
  v_exp_f32 v150, v150
  v_exp_f32 v151, v151
  v_cvt_pk_bf16_f32 v172, v144, v145
  v_cvt_pk_bf16_f32 v173, v146, v147
  v_cvt_pk_bf16_f32 v174, v148, v149
  v_cvt_pk_bf16_f32 v175, v150, v151
  v_mfma_f32_32x32x16_bf16 v[136:151], v[192:195], v[24:27], 0
  v_exp_f32 v152, v152
  v_exp_f32 v153, v153
  v_exp_f32 v154, v154
  v_mfma_f32_32x32x16_bf16 v[88:103], v[188:191], v[172:175], v[88:103]
  v_exp_f32 v155, v155
  v_exp_f32 v156, v156
  v_exp_f32 v157, v157
  v_smfmac_f32_16x16x64_bf16 v[128:131], v[16:19], v[168:175], v20
  v_exp_f32 v158, v158
  v_exp_f32 v159, v159
  v_mfma_f32_32x32x16_bf16 v[136:151], v[196:199], v[28:31], v[136:151]
  v_cvt_pk_bf16_f32 v168, v152, v153
  v_cvt_pk_bf16_f32 v169, v154, v155
  v_cvt_pk_bf16_f32 v170, v156, v157
  v_cvt_pk_bf16_f32 v171, v158, v159
  v_exp_f32 v160, v160
  v_exp_f32 v161, v161
  v_exp_f32 v162, v162
  v_exp_f32 v163, v163
  s_waitcnt lgkmcnt(2)
  v_mfma_f32_32x32x16_bf16 v[104:119], v[184:187], v[168:171], 0
  v_exp_f32 v164, v164
  v_exp_f32 v165, v165
  v_exp_f32 v166, v166
  v_exp_f32 v167, v167
  v_cvt_pk_bf16_f32 v172, v160, v161
  v_cvt_pk_bf16_f32 v173, v162, v163
  v_cvt_pk_bf16_f32 v174, v164, v165
  v_cvt_pk_bf16_f32 v175, v166, v167
  s_branch .g2_kernel_a_n1
.g2_kernel_a_end:
  v_mfma_f32_32x32x16_bf16 v[104:119], v[236:239], v[172:175], v[104:119]
  v_smfmac_f32_16x16x64_bf16 v[132:135], v[16:19], v[168:175], v20
  s_wakeup
  s_nop 9
  v_cvt_pk_bf16_f32 v104, v104, v105
  v_cvt_pk_bf16_f32 v105, v106, v107
  v_cvt_pk_bf16_f32 v106, v108, v109
  v_cvt_pk_bf16_f32 v107, v110, v111
  v_add_f32 v6, v132, v133
  ds_write_b128 v9, v[104:107] offset:24576
  v_cvt_pk_bf16_f32 v108, v112, v113
  v_cvt_pk_bf16_f32 v109, v114, v115
  v_cvt_pk_bf16_f32 v110, v116, v117
  v_cvt_pk_bf16_f32 v111, v118, v119
  ds_write_b128 v9, v[108:111] offset:25600
  v_mov_b32 v132, 0
  v_mov_b32 v133, 0
  ds_write_b32 v10, v6 offset:1536
  ds_write_b32 v11, v12 offset:48
  s_waitcnt lgkmcnt(4)
  v_mov_b32 v20, s71
  v_lshrrev_b32 v17, 5, v2
  v_and_b32 v18, 31, v2
  s_lshl_b32 s28, s16, 5
  v_add_u32 v19, s28, v18
  v_lshlrev_b32 v7, 2, v19
  v_add_u32 v7, 155648, v7
  ds_read_b32 v8, v7 offset:3840
  ds_read_b32 v9, v7 offset:4352
  ds_read_b32 v16, v20 offset:24
  ds_read_b32 v6, v20 offset:52
  v_add_u32 v19, 1, v19
  v_bfe_u32 v7, v2, 2, 2
  v_lshl_add_u32 v14, v17, 2, v7
  v_lshlrev_b32 v14, 7, v14
  v_lshrrev_b32 v7, 1, v7
  v_lshl_add_u32 v14, v7, 6, v14
  v_bfe_u32 v7, v2, 4, 1
  v_lshl_add_u32 v14, v7, 5, v14
  v_and_b32 v7, 1, v2
  v_lshl_add_u32 v14, v7, 4, v14
  v_bfe_u32 v7, v2, 1, 1
  v_lshl_add_u32 v14, v7, 3, v14
  v_xor_b32 v15, 64, v14
  v_and_b32 v7, 7, v2
  v_xor_b32 v7, s24, v7
  s_mov_b32 s28, 192
  s_add_u32 s28, s28, 157952
  v_lshl_add_u32 v21, v7, 3, s28
  v_lshlrev_b32 v24, 16, v240
  v_and_b32 v25, 0xffff0000, v240
  v_lshlrev_b32 v26, 16, v241
  v_and_b32 v27, 0xffff0000, v241
  v_lshlrev_b32 v28, 16, v242
  v_and_b32 v29, 0xffff0000, v242
  v_lshlrev_b32 v30, 16, v243
  v_and_b32 v31, 0xffff0000, v243
  v_lshlrev_b32 v32, 16, v244
  v_and_b32 v33, 0xffff0000, v244
  v_lshlrev_b32 v34, 16, v245
  v_and_b32 v35, 0xffff0000, v245
  v_lshlrev_b32 v36, 16, v246
  v_and_b32 v37, 0xffff0000, v246
  v_lshlrev_b32 v38, 16, v247
  v_and_b32 v39, 0xffff0000, v247
  v_lshlrev_b32 v40, 16, v248
  v_and_b32 v41, 0xffff0000, v248
  v_lshlrev_b32 v42, 16, v249
  v_and_b32 v43, 0xffff0000, v249
  v_lshlrev_b32 v44, 16, v250
  v_and_b32 v45, 0xffff0000, v250
  v_lshlrev_b32 v46, 16, v251
  v_and_b32 v47, 0xffff0000, v251
  v_lshlrev_b32 v48, 16, v252
  v_and_b32 v49, 0xffff0000, v252
  v_lshlrev_b32 v50, 16, v253
  v_and_b32 v51, 0xffff0000, v253
  v_lshlrev_b32 v52, 16, v254
  v_and_b32 v53, 0xffff0000, v254
  v_lshlrev_b32 v54, 16, v255
  v_and_b32 v55, 0xffff0000, v255
  s_waitcnt lgkmcnt(0)
  v_cmp_gt_u32 vcc, 4, v6
  s_cbranch_vccnz .g2_kernel_w_aw
.g2_kernel_w_ab:
  s_xor_b32 s28, s24, 0
  s_lshl_b32 s28, s28, 13
  s_add_u32 s28, s28, 65536
  v_add_u32 v10, s28, v14
  v_add_u32 v11, s28, v15
  ds_read_b64_tr_b16 v[104:105], v10 offset:0
  ds_read_b64_tr_b16 v[106:107], v10 offset:1024
  ds_read_b64_tr_b16 v[108:109], v11 offset:0
  ds_read_b64_tr_b16 v[110:111], v11 offset:1024
  ds_read_b64_tr_b16 v[112:113], v10 offset:2048
  ds_read_b64_tr_b16 v[114:115], v10 offset:3072
  ds_read_b64_tr_b16 v[116:117], v11 offset:2048
  ds_read_b64_tr_b16 v[118:119], v11 offset:3072
  ds_read_b64_tr_b16 v[120:121], v10 offset:4096
  ds_read_b64_tr_b16 v[122:123], v10 offset:5120
  ds_read_b64_tr_b16 v[124:125], v11 offset:4096
  ds_read_b64_tr_b16 v[126:127], v11 offset:5120
  s_andn2_b32 s33, s36, s34
  s_ff1_i32_b32 s33, s33
  s_bitset1_b32 s34, s33
  s_xor_b32 s33, s33, s24
  s_lshl_b32 s33, s33, 12
  s_add_u32 s22, s20, s33
  s_addc_u32 s23, s21, 0
  global_load_dwordx4 v[224:227], v3, s[22:23] offset:0
  global_load_dwordx4 v[228:231], v3, s[22:23] offset:1024
  global_load_dwordx4 v[232:235], v3, s[22:23] offset:2048
  global_load_dwordx4 v[236:239], v3, s[22:23] offset:3072
  v_pk_fma_f32 v[24:25], v[24:25], v[8:9], v[8:9] op_sel:[0,0,1] op_sel_hi:[1,0,1]
  v_pk_fma_f32 v[26:27], v[26:27], v[8:9], v[8:9] op_sel:[0,0,1] op_sel_hi:[1,0,1]
  v_pk_fma_f32 v[28:29], v[28:29], v[8:9], v[8:9] op_sel:[0,0,1] op_sel_hi:[1,0,1]
  v_pk_fma_f32 v[30:31], v[30:31], v[8:9], v[8:9] op_sel:[0,0,1] op_sel_hi:[1,0,1]
  v_pk_fma_f32 v[32:33], v[32:33], v[8:9], v[8:9] op_sel:[0,0,1] op_sel_hi:[1,0,1]
  v_pk_fma_f32 v[34:35], v[34:35], v[8:9], v[8:9] op_sel:[0,0,1] op_sel_hi:[1,0,1]
  v_pk_fma_f32 v[36:37], v[36:37], v[8:9], v[8:9] op_sel:[0,0,1] op_sel_hi:[1,0,1]
  v_pk_fma_f32 v[38:39], v[38:39], v[8:9], v[8:9] op_sel:[0,0,1] op_sel_hi:[1,0,1]
  v_pk_fma_f32 v[40:41], v[40:41], v[8:9], v[8:9] op_sel:[0,0,1] op_sel_hi:[1,0,1]
  v_pk_fma_f32 v[42:43], v[42:43], v[8:9], v[8:9] op_sel:[0,0,1] op_sel_hi:[1,0,1]
  v_pk_fma_f32 v[44:45], v[44:45], v[8:9], v[8:9] op_sel:[0,0,1] op_sel_hi:[1,0,1]
  v_pk_fma_f32 v[46:47], v[46:47], v[8:9], v[8:9] op_sel:[0,0,1] op_sel_hi:[1,0,1]
  v_pk_fma_f32 v[48:49], v[48:49], v[8:9], v[8:9] op_sel:[0,0,1] op_sel_hi:[1,0,1]
  v_pk_fma_f32 v[50:51], v[50:51], v[8:9], v[8:9] op_sel:[0,0,1] op_sel_hi:[1,0,1]
  v_pk_fma_f32 v[52:53], v[52:53], v[8:9], v[8:9] op_sel:[0,0,1] op_sel_hi:[1,0,1]
  v_pk_fma_f32 v[54:55], v[54:55], v[8:9], v[8:9] op_sel:[0,0,1] op_sel_hi:[1,0,1]
  v_cmp_eq_u32 vcc, v16, v19
  s_cbranch_vccnz .g2_kernel_w_pt
.g2_kernel_w_pb:
  s_mov_b32 s72, s48
  s_mov_b32 s73, s49
  s_mov_b32 s74, 0x800
  s_mov_b32 s75, 0x00020000
  s_waitcnt vmcnt(15) lgkmcnt(8)
  v_mfma_f32_32x32x16_bf16 v[24:39], v[104:107], v[176:179], v[24:39]
  s_xor_b32 s28, s24, 1
  s_lshl_b32 s28, s28, 13
  s_add_u32 s28, s28, 65536
  ds_read_b64_tr_b16 v[128:129], v10 offset:6144
  ds_read_b64_tr_b16 v[130:131], v10 offset:7168
  v_mfma_f32_32x32x16_bf16 v[40:55], v[108:111], v[176:179], v[40:55]
  v_add_u32 v12, s28, v14
  v_add_u32 v13, s28, v15
  s_andn2_b32 s33, s36, s34
  ds_read_b64_tr_b16 v[132:133], v11 offset:6144
  ds_read_b64_tr_b16 v[134:135], v11 offset:7168
  s_waitcnt vmcnt(14) lgkmcnt(8)
  v_mfma_f32_32x32x16_bf16 v[24:39], v[112:115], v[180:183], v[24:39]
  s_ff1_i32_b32 s33, s33
  s_bitset1_b32 s34, s33
  s_xor_b32 s33, s33, s24
  ds_read_b64_tr_b16 v[104:105], v12 offset:0
  ds_read_b64_tr_b16 v[106:107], v12 offset:1024
  v_mfma_f32_32x32x16_bf16 v[40:55], v[116:119], v[180:183], v[40:55]
  s_lshl_b32 s33, s33, 12
  s_add_u32 s22, s20, s33
  s_addc_u32 s23, s21, 0
  ds_read_b64_tr_b16 v[108:109], v13 offset:0
  ds_read_b64_tr_b16 v[110:111], v13 offset:1024
  s_waitcnt vmcnt(13) lgkmcnt(8)
  v_mfma_f32_32x32x16_bf16 v[24:39], v[120:123], v[184:187], v[24:39]
  global_load_dwordx4 v[136:139], v3, s[22:23] offset:0
  global_load_dwordx4 v[140:143], v3, s[22:23] offset:1024
  global_load_dwordx4 v[144:147], v3, s[22:23] offset:2048
  ds_read_b64_tr_b16 v[112:113], v12 offset:2048
  ds_read_b64_tr_b16 v[114:115], v12 offset:3072
  v_mfma_f32_32x32x16_bf16 v[40:55], v[124:127], v[184:187], v[40:55]
  global_load_dwordx4 v[148:151], v3, s[22:23] offset:3072
  ds_read_b64_tr_b16 v[116:117], v13 offset:2048
  ds_read_b64_tr_b16 v[118:119], v13 offset:3072
  s_waitcnt vmcnt(16) lgkmcnt(8)
  v_mfma_f32_32x32x16_bf16 v[24:39], v[128:131], v[188:191], v[24:39]
  ds_read_b64_tr_b16 v[120:121], v12 offset:4096
  ds_read_b64_tr_b16 v[122:123], v12 offset:5120
  v_mfma_f32_32x32x16_bf16 v[40:55], v[132:135], v[188:191], v[40:55]
  ds_read_b64_tr_b16 v[124:125], v13 offset:4096
  ds_read_b64_tr_b16 v[126:127], v13 offset:5120
  s_waitcnt vmcnt(15) lgkmcnt(8)
  v_mfma_f32_32x32x16_bf16 v[24:39], v[104:107], v[192:195], v[24:39]
  s_xor_b32 s28, s24, 2
  s_lshl_b32 s28, s28, 13
  s_add_u32 s28, s28, 65536
  ds_read_b64_tr_b16 v[128:129], v12 offset:6144
  ds_read_b64_tr_b16 v[130:131], v12 offset:7168
  v_mfma_f32_32x32x16_bf16 v[40:55], v[108:111], v[192:195], v[40:55]
  v_add_u32 v10, s28, v14
  v_add_u32 v11, s28, v15
  s_andn2_b32 s33, s36, s34
  ds_read_b64_tr_b16 v[132:133], v13 offset:6144
  ds_read_b64_tr_b16 v[134:135], v13 offset:7168
  s_waitcnt vmcnt(14) lgkmcnt(8)
  v_mfma_f32_32x32x16_bf16 v[24:39], v[112:115], v[196:199], v[24:39]
  s_ff1_i32_b32 s33, s33
  s_bitset1_b32 s34, s33
  s_xor_b32 s33, s33, s24
  ds_read_b64_tr_b16 v[104:105], v10 offset:0
  ds_read_b64_tr_b16 v[106:107], v10 offset:1024
  v_mfma_f32_32x32x16_bf16 v[40:55], v[116:119], v[196:199], v[40:55]
  s_lshl_b32 s33, s33, 12
  s_add_u32 s22, s20, s33
  s_addc_u32 s23, s21, 0
  ds_read_b64_tr_b16 v[108:109], v11 offset:0
  ds_read_b64_tr_b16 v[110:111], v11 offset:1024
  s_waitcnt vmcnt(13) lgkmcnt(8)
  v_mfma_f32_32x32x16_bf16 v[24:39], v[120:123], v[200:203], v[24:39]
  global_load_dwordx4 v[152:155], v3, s[22:23] offset:0
  global_load_dwordx4 v[156:159], v3, s[22:23] offset:1024
  global_load_dwordx4 v[160:163], v3, s[22:23] offset:2048
  ds_read_b64_tr_b16 v[112:113], v10 offset:2048
  ds_read_b64_tr_b16 v[114:115], v10 offset:3072
  v_mfma_f32_32x32x16_bf16 v[40:55], v[124:127], v[200:203], v[40:55]
  global_load_dwordx4 v[164:167], v3, s[22:23] offset:3072
  ds_read_b64_tr_b16 v[116:117], v11 offset:2048
  ds_read_b64_tr_b16 v[118:119], v11 offset:3072
  s_waitcnt vmcnt(16) lgkmcnt(8)
  v_mfma_f32_32x32x16_bf16 v[24:39], v[128:131], v[204:207], v[24:39]
  ds_read_b64_tr_b16 v[120:121], v10 offset:4096
  ds_read_b64_tr_b16 v[122:123], v10 offset:5120
  v_mfma_f32_32x32x16_bf16 v[40:55], v[132:135], v[204:207], v[40:55]
  ds_read_b64_tr_b16 v[124:125], v11 offset:4096
  ds_read_b64_tr_b16 v[126:127], v11 offset:5120
  s_waitcnt vmcnt(15) lgkmcnt(8)
  v_mfma_f32_32x32x16_bf16 v[24:39], v[104:107], v[208:211], v[24:39]
  s_xor_b32 s28, s24, 3
  s_lshl_b32 s28, s28, 13
  s_add_u32 s28, s28, 65536
  ds_read_b64_tr_b16 v[128:129], v10 offset:6144
  ds_read_b64_tr_b16 v[130:131], v10 offset:7168
  v_mfma_f32_32x32x16_bf16 v[40:55], v[108:111], v[208:211], v[40:55]
  v_add_u32 v12, s28, v14
  v_add_u32 v13, s28, v15
  s_andn2_b32 s33, s36, s34
  ds_read_b64_tr_b16 v[132:133], v11 offset:6144
  ds_read_b64_tr_b16 v[134:135], v11 offset:7168
  s_waitcnt vmcnt(14) lgkmcnt(8)
  v_mfma_f32_32x32x16_bf16 v[24:39], v[112:115], v[212:215], v[24:39]
  s_ff1_i32_b32 s33, s33
  s_bitset1_b32 s34, s33
  s_xor_b32 s33, s33, s24
  ds_read_b64_tr_b16 v[104:105], v12 offset:0
  ds_read_b64_tr_b16 v[106:107], v12 offset:1024
  v_mfma_f32_32x32x16_bf16 v[40:55], v[116:119], v[212:215], v[40:55]
  s_lshl_b32 s33, s33, 12
  s_add_u32 s22, s20, s33
  s_addc_u32 s23, s21, 0
  ds_read_b64_tr_b16 v[108:109], v13 offset:0
  ds_read_b64_tr_b16 v[110:111], v13 offset:1024
  s_waitcnt vmcnt(13) lgkmcnt(8)
  v_mfma_f32_32x32x16_bf16 v[24:39], v[120:123], v[216:219], v[24:39]
  global_load_dwordx4 v[56:59], v3, s[22:23] offset:0
  global_load_dwordx4 v[60:63], v3, s[22:23] offset:1024
  global_load_dwordx4 v[64:67], v3, s[22:23] offset:2048
  ds_read_b64_tr_b16 v[112:113], v12 offset:2048
  ds_read_b64_tr_b16 v[114:115], v12 offset:3072
  v_mfma_f32_32x32x16_bf16 v[40:55], v[124:127], v[216:219], v[40:55]
  global_load_dwordx4 v[68:71], v3, s[22:23] offset:3072
  ds_read_b64_tr_b16 v[116:117], v13 offset:2048
  ds_read_b64_tr_b16 v[118:119], v13 offset:3072
  s_waitcnt vmcnt(16) lgkmcnt(8)
  v_mfma_f32_32x32x16_bf16 v[24:39], v[128:131], v[220:223], v[24:39]
  ds_read_b64_tr_b16 v[120:121], v12 offset:4096
  ds_read_b64_tr_b16 v[122:123], v12 offset:5120
  v_mfma_f32_32x32x16_bf16 v[40:55], v[132:135], v[220:223], v[40:55]
  ds_read_b64_tr_b16 v[124:125], v13 offset:4096
  ds_read_b64_tr_b16 v[126:127], v13 offset:5120
  s_waitcnt vmcnt(15) lgkmcnt(8)
  v_mfma_f32_32x32x16_bf16 v[24:39], v[104:107], v[224:227], v[24:39]
  s_xor_b32 s28, s24, 4
  s_lshl_b32 s28, s28, 13
  s_add_u32 s28, s28, 65536
  ds_read_b64_tr_b16 v[128:129], v12 offset:6144
  ds_read_b64_tr_b16 v[130:131], v12 offset:7168
  v_mfma_f32_32x32x16_bf16 v[40:55], v[108:111], v[224:227], v[40:55]
  v_add_u32 v10, s28, v14
  v_add_u32 v11, s28, v15
  s_andn2_b32 s33, s36, s34
  ds_read_b64_tr_b16 v[132:133], v13 offset:6144
  ds_read_b64_tr_b16 v[134:135], v13 offset:7168
  s_waitcnt vmcnt(14) lgkmcnt(8)
  v_mfma_f32_32x32x16_bf16 v[24:39], v[112:115], v[228:231], v[24:39]
  s_ff1_i32_b32 s33, s33
  s_bitset1_b32 s34, s33
  s_xor_b32 s33, s33, s24
  ds_read_b64_tr_b16 v[104:105], v10 offset:0
  ds_read_b64_tr_b16 v[106:107], v10 offset:1024
  v_mfma_f32_32x32x16_bf16 v[40:55], v[116:119], v[228:231], v[40:55]
  s_lshl_b32 s33, s33, 12
  s_add_u32 s22, s20, s33
  s_addc_u32 s23, s21, 0
  ds_read_b64_tr_b16 v[108:109], v11 offset:0
  ds_read_b64_tr_b16 v[110:111], v11 offset:1024
  s_waitcnt vmcnt(13) lgkmcnt(8)
  v_mfma_f32_32x32x16_bf16 v[24:39], v[120:123], v[232:235], v[24:39]
  global_load_dwordx4 v[72:75], v3, s[22:23] offset:0
  global_load_dwordx4 v[76:79], v3, s[22:23] offset:1024
  global_load_dwordx4 v[80:83], v3, s[22:23] offset:2048
  ds_read_b64_tr_b16 v[112:113], v10 offset:2048
  ds_read_b64_tr_b16 v[114:115], v10 offset:3072
  v_mfma_f32_32x32x16_bf16 v[40:55], v[124:127], v[232:235], v[40:55]
  global_load_dwordx4 v[84:87], v3, s[22:23] offset:3072
  ds_read_b64_tr_b16 v[116:117], v11 offset:2048
  ds_read_b64_tr_b16 v[118:119], v11 offset:3072
  s_waitcnt vmcnt(16) lgkmcnt(8)
  v_mfma_f32_32x32x16_bf16 v[24:39], v[128:131], v[236:239], v[24:39]
  ds_read_b64_tr_b16 v[120:121], v10 offset:4096
  ds_read_b64_tr_b16 v[122:123], v10 offset:5120
  v_mfma_f32_32x32x16_bf16 v[40:55], v[132:135], v[236:239], v[40:55]
  ds_read_b64_tr_b16 v[124:125], v11 offset:4096
  ds_read_b64_tr_b16 v[126:127], v11 offset:5120
  s_waitcnt vmcnt(15) lgkmcnt(8)
  v_mfma_f32_32x32x16_bf16 v[24:39], v[104:107], v[136:139], v[24:39]
  s_xor_b32 s28, s24, 5
  s_lshl_b32 s28, s28, 13
  s_add_u32 s28, s28, 65536
  v_add_u32 v12, s28, v14
  ds_read_b64_tr_b16 v[128:129], v10 offset:6144
  ds_read_b64_tr_b16 v[130:131], v10 offset:7168
  v_mfma_f32_32x32x16_bf16 v[40:55], v[108:111], v[136:139], v[40:55]
  v_add_u32 v13, s28, v15
  s_andn2_b32 s33, s36, s34
  s_cbranch_scc0 .g2_kernel_w_i8c
.g2_kernel_w_i8b:
  s_ff1_i32_b32 s33, s33
  ds_read_b64_tr_b16 v[132:133], v11 offset:6144
  ds_read_b64_tr_b16 v[134:135], v11 offset:7168
  s_waitcnt vmcnt(14) lgkmcnt(8)
  v_mfma_f32_32x32x16_bf16 v[24:39], v[112:115], v[140:143], v[24:39]
  s_bitset1_b32 s34, s33
  s_xor_b32 s33, s33, s24
  s_and_b32 s8, s33, 7
  s_cmp_lt_u32 s8, 2
  ds_read_b64_tr_b16 v[104:105], v12 offset:0
  ds_read_b64_tr_b16 v[106:107], v12 offset:1024
  v_mfma_f32_32x32x16_bf16 v[40:55], v[116:119], v[140:143], v[40:55]
  s_cselect_b32 s28, 139264, 0
  s_lshl_b32 s8, s8, 13
  s_add_u32 s8, s8, s28
  s_lshl_b32 s33, s33, 12
  ds_read_b64_tr_b16 v[108:109], v13 offset:0
  ds_read_b64_tr_b16 v[110:111], v13 offset:1024
  s_waitcnt vmcnt(13) lgkmcnt(8)
  v_mfma_f32_32x32x16_bf16 v[24:39], v[120:123], v[144:147], v[24:39]
  s_add_u32 s22, s20, s33
  s_addc_u32 s23, s21, 0
  global_load_dwordx4 v[88:91], v3, s[22:23] offset:0
  global_load_dwordx4 v[92:95], v3, s[22:23] offset:1024
  ds_read_b64_tr_b16 v[112:113], v12 offset:2048
  ds_read_b64_tr_b16 v[114:115], v12 offset:3072
  v_mfma_f32_32x32x16_bf16 v[40:55], v[124:127], v[144:147], v[40:55]
  global_load_dwordx4 v[96:99], v3, s[22:23] offset:2048
  global_load_dwordx4 v[100:103], v3, s[22:23] offset:3072
  ds_read_b64_tr_b16 v[116:117], v13 offset:2048
  ds_read_b64_tr_b16 v[118:119], v13 offset:3072
  s_waitcnt vmcnt(16) lgkmcnt(8)
  v_mfma_f32_32x32x16_bf16 v[24:39], v[128:131], v[148:151], v[24:39]
  ds_read_b64_tr_b16 v[120:121], v12 offset:4096
  ds_read_b64_tr_b16 v[122:123], v12 offset:5120
  v_mfma_f32_32x32x16_bf16 v[40:55], v[132:135], v[148:151], v[40:55]
  ds_read_b64_tr_b16 v[124:125], v13 offset:4096
  ds_read_b64_tr_b16 v[126:127], v13 offset:5120
  s_waitcnt vmcnt(15) lgkmcnt(8)
  v_mfma_f32_32x32x16_bf16 v[24:39], v[104:107], v[152:155], v[24:39]
  s_xor_b32 s28, s24, 6
  s_lshl_b32 s28, s28, 13
  s_add_u32 s28, s28, 65536
  v_add_u32 v10, s28, v14
  v_add_u32 v11, s28, v15
  ds_read_b64_tr_b16 v[128:129], v12 offset:6144
  ds_read_b64_tr_b16 v[130:131], v12 offset:7168
  v_mfma_f32_32x32x16_bf16 v[40:55], v[108:111], v[152:155], v[40:55]
  s_andn2_b32 s33, s36, s34
  s_cbranch_scc0 .g2_kernel_w_i9c
.g2_kernel_w_i9b:
  s_ff1_i32_b32 s33, s33
  s_bitset1_b32 s34, s33
  s_xor_b32 s33, s33, s24
  ds_read_b64_tr_b16 v[132:133], v13 offset:6144
  ds_read_b64_tr_b16 v[134:135], v13 offset:7168
  s_waitcnt vmcnt(14) lgkmcnt(8)
  v_mfma_f32_32x32x16_bf16 v[24:39], v[112:115], v[156:159], v[24:39]
  s_and_b32 s9, s33, 7
  s_cmp_lt_u32 s9, 2
  s_cselect_b32 s28, 139264, 0
  s_lshl_b32 s9, s9, 13
  s_add_u32 s9, s9, s28
  ds_read_b64_tr_b16 v[104:105], v10 offset:0
  ds_read_b64_tr_b16 v[106:107], v10 offset:1024
  v_mfma_f32_32x32x16_bf16 v[40:55], v[116:119], v[156:159], v[40:55]
  s_lshl_b32 s33, s33, 12
  s_add_u32 s22, s20, s33
  s_addc_u32 s23, s21, 0
  global_load_dwordx4 v[176:179], v3, s[22:23] offset:0
  global_load_dwordx4 v[180:183], v3, s[22:23] offset:1024
  ds_read_b64_tr_b16 v[108:109], v11 offset:0
  ds_read_b64_tr_b16 v[110:111], v11 offset:1024
  s_waitcnt vmcnt(15) lgkmcnt(8)
  v_mfma_f32_32x32x16_bf16 v[24:39], v[120:123], v[160:163], v[24:39]
  global_load_dwordx4 v[184:187], v3, s[22:23] offset:2048
  global_load_dwordx4 v[188:191], v3, s[22:23] offset:3072
  v_lshlrev_b32 v16, 4, v17
  s_lshl_b32 s29, s18, 7
  buffer_load_dwordx4 v[240:243], v16, s[72:75], s29 offen offset:0
  ds_read_b64_tr_b16 v[112:113], v10 offset:2048
  ds_read_b64_tr_b16 v[114:115], v10 offset:3072
  v_mfma_f32_32x32x16_bf16 v[40:55], v[124:127], v[160:163], v[40:55]
  buffer_load_dwordx4 v[244:247], v16, s[72:75], s29 offen offset:32
  buffer_load_dwordx4 v[248:251], v16, s[72:75], s29 offen offset:64
  buffer_load_dwordx4 v[252:255], v16, s[72:75], s29 offen offset:96
  ds_read_b64_tr_b16 v[116:117], v11 offset:2048
  ds_read_b64_tr_b16 v[118:119], v11 offset:3072
  s_waitcnt vmcnt(20) lgkmcnt(8)
  v_mfma_f32_32x32x16_bf16 v[24:39], v[128:131], v[164:167], v[24:39]
  ds_read_b64_tr_b16 v[120:121], v10 offset:4096
  ds_read_b64_tr_b16 v[122:123], v10 offset:5120
  v_mfma_f32_32x32x16_bf16 v[40:55], v[132:135], v[164:167], v[40:55]
  ds_read_b64_tr_b16 v[124:125], v11 offset:4096
  ds_read_b64_tr_b16 v[126:127], v11 offset:5120
  s_waitcnt vmcnt(19) lgkmcnt(8)
  v_mfma_f32_32x32x16_bf16 v[24:39], v[104:107], v[56:59], v[24:39]
  s_xor_b32 s28, s24, 7
  s_lshl_b32 s28, s28, 13
  s_add_u32 s28, s28, 65536
  v_add_u32 v12, s28, v14
  ds_read_b64_tr_b16 v[128:129], v10 offset:6144
  ds_read_b64_tr_b16 v[130:131], v10 offset:7168
  v_mfma_f32_32x32x16_bf16 v[40:55], v[108:111], v[56:59], v[40:55]
  v_add_u32 v13, s28, v15
  s_andn2_b32 s33, s36, s34
  s_cbranch_scc0 .g2_kernel_w_i10c
.g2_kernel_w_i10b:
  s_ff1_i32_b32 s33, s33
  ds_read_b64_tr_b16 v[132:133], v11 offset:6144
  ds_read_b64_tr_b16 v[134:135], v11 offset:7168
  s_waitcnt vmcnt(18) lgkmcnt(8)
  v_mfma_f32_32x32x16_bf16 v[24:39], v[112:115], v[60:63], v[24:39]
  s_bitset1_b32 s34, s33
  s_xor_b32 s33, s33, s24
  s_and_b32 s10, s33, 7
  s_cmp_lt_u32 s10, 2
  ds_read_b64_tr_b16 v[104:105], v12 offset:0
  ds_read_b64_tr_b16 v[106:107], v12 offset:1024
  v_mfma_f32_32x32x16_bf16 v[40:55], v[116:119], v[60:63], v[40:55]
  s_cselect_b32 s28, 139264, 0
  s_lshl_b32 s10, s10, 13
  s_add_u32 s10, s10, s28
  s_lshl_b32 s33, s33, 12
  ds_read_b64_tr_b16 v[108:109], v13 offset:0
  ds_read_b64_tr_b16 v[110:111], v13 offset:1024
  s_waitcnt vmcnt(17) lgkmcnt(8)
  v_mfma_f32_32x32x16_bf16 v[24:39], v[120:123], v[64:67], v[24:39]
  s_add_u32 s22, s20, s33
  s_addc_u32 s23, s21, 0
  global_load_dwordx4 v[192:195], v3, s[22:23] offset:0
  global_load_dwordx4 v[196:199], v3, s[22:23] offset:1024
  ds_read_b64_tr_b16 v[112:113], v12 offset:2048
  ds_read_b64_tr_b16 v[114:115], v12 offset:3072
  v_mfma_f32_32x32x16_bf16 v[40:55], v[124:127], v[64:67], v[40:55]
  global_load_dwordx4 v[200:203], v3, s[22:23] offset:2048
  global_load_dwordx4 v[204:207], v3, s[22:23] offset:3072
  ds_read_b64_tr_b16 v[116:117], v13 offset:2048
  ds_read_b64_tr_b16 v[118:119], v13 offset:3072
  s_waitcnt vmcnt(20) lgkmcnt(8)
  v_mfma_f32_32x32x16_bf16 v[24:39], v[128:131], v[68:71], v[24:39]
  ds_read_b64_tr_b16 v[120:121], v12 offset:4096
  ds_read_b64_tr_b16 v[122:123], v12 offset:5120
  v_mfma_f32_32x32x16_bf16 v[40:55], v[132:135], v[68:71], v[40:55]
  ds_read_b64_tr_b16 v[124:125], v13 offset:4096
  ds_read_b64_tr_b16 v[126:127], v13 offset:5120
  s_waitcnt vmcnt(19) lgkmcnt(8)
  v_mfma_f32_32x32x16_bf16 v[24:39], v[104:107], v[72:75], v[24:39]
  s_andn2_b32 s33, s36, s34
  s_cbranch_scc0 .g2_kernel_w_i11c
.g2_kernel_w_i11b:
  s_ff1_i32_b32 s33, s33
  ds_read_b64_tr_b16 v[128:129], v12 offset:6144
  ds_read_b64_tr_b16 v[130:131], v12 offset:7168
  v_mfma_f32_32x32x16_bf16 v[40:55], v[108:111], v[72:75], v[40:55]
  s_bitset1_b32 s34, s33
  s_xor_b32 s33, s33, s24
  s_and_b32 s11, s33, 7
  ds_read_b64_tr_b16 v[132:133], v13 offset:6144
  ds_read_b64_tr_b16 v[134:135], v13 offset:7168
  s_waitcnt vmcnt(18) lgkmcnt(8)
  v_mfma_f32_32x32x16_bf16 v[24:39], v[112:115], v[76:79], v[24:39]
  s_cmp_lt_u32 s11, 2
  s_cselect_b32 s28, 139264, 0
  s_lshl_b32 s11, s11, 13
  v_mfma_f32_32x32x16_bf16 v[40:55], v[116:119], v[76:79], v[40:55]
  s_add_u32 s11, s11, s28
  s_lshl_b32 s33, s33, 12
  s_add_u32 s22, s20, s33
  s_waitcnt vmcnt(17) lgkmcnt(4)
  v_mfma_f32_32x32x16_bf16 v[24:39], v[120:123], v[80:83], v[24:39]
  s_addc_u32 s23, s21, 0
  global_load_dwordx4 v[208:211], v3, s[22:23] offset:0
  global_load_dwordx4 v[212:215], v3, s[22:23] offset:1024
  v_mfma_f32_32x32x16_bf16 v[40:55], v[124:127], v[80:83], v[40:55]
  global_load_dwordx4 v[216:219], v3, s[22:23] offset:2048
  global_load_dwordx4 v[220:223], v3, s[22:23] offset:3072
  s_waitcnt vmcnt(20) lgkmcnt(0)
  v_mfma_f32_32x32x16_bf16 v[24:39], v[128:131], v[84:87], v[24:39]
  v_mfma_f32_32x32x16_bf16 v[40:55], v[132:135], v[84:87], v[40:55]
  ds_read_b32 v16, v20 offset:12
  v_add_u32 v10, s8, v14
  v_add_u32 v11, s8, v15
  s_waitcnt lgkmcnt(0)
  v_cmp_gt_u32 vcc, 4, v16
  s_cbranch_vccnz .g2_kernel_w_bw
.g2_kernel_w_bb:
  ds_read_b64_tr_b16 v[104:105], v10 offset:0
  ds_read_b64_tr_b16 v[106:107], v10 offset:1024
  ds_read_b64_tr_b16 v[108:109], v11 offset:0
  ds_read_b64_tr_b16 v[110:111], v11 offset:1024
  ds_read_b64_tr_b16 v[112:113], v10 offset:2048
  ds_read_b64_tr_b16 v[114:115], v10 offset:3072
  ds_read_b64_tr_b16 v[116:117], v11 offset:2048
  ds_read_b64_tr_b16 v[118:119], v11 offset:3072
  ds_read_b64_tr_b16 v[120:121], v10 offset:4096
  ds_read_b64_tr_b16 v[122:123], v10 offset:5120
  ds_read_b64_tr_b16 v[124:125], v11 offset:4096
  ds_read_b64_tr_b16 v[126:127], v11 offset:5120
  s_waitcnt vmcnt(16)
  v_min3_u32 v6, v88, v90, v92
  v_min3_u32 v7, v94, v96, v98
  v_min3_u32 v6, v6, v100, v102
  v_min_u32 v6, v6, v7
  v_cmp_eq_u32 vcc, 0, v6
  s_cbranch_vccnz .g2_kernel_w_v8
.g2_kernel_w_vb8:
  s_waitcnt lgkmcnt(8)
  v_mfma_f32_32x32x16_bf16 v[24:39], v[104:107], v[88:91], v[24:39]
  v_add_u32 v12, s9, v14
  v_add_u32 v13, s9, v15
  s_andn2_b32 s33, s36, s34
  s_cbranch_scc0 .g2_kernel_w_i12c
.g2_kernel_w_i12b:
  ds_read_b64_tr_b16 v[128:129], v10 offset:6144
  ds_read_b64_tr_b16 v[130:131], v10 offset:7168
  v_mfma_f32_32x32x16_bf16 v[40:55], v[108:111], v[88:91], v[40:55]
  s_ff1_i32_b32 s33, s33
  s_bitset1_b32 s34, s33
  s_xor_b32 s33, s33, s24
  s_and_b32 s12, s33, 7
  ds_read_b64_tr_b16 v[132:133], v11 offset:6144
  ds_read_b64_tr_b16 v[134:135], v11 offset:7168
  s_waitcnt lgkmcnt(8)
  v_mfma_f32_32x32x16_bf16 v[24:39], v[112:115], v[92:95], v[24:39]
  s_cmp_lt_u32 s12, 2
  s_cselect_b32 s28, 139264, 0
  s_lshl_b32 s12, s12, 13
  s_add_u32 s12, s12, s28
  ds_read_b64_tr_b16 v[104:105], v12 offset:0
  ds_read_b64_tr_b16 v[106:107], v12 offset:1024
  v_mfma_f32_32x32x16_bf16 v[40:55], v[116:119], v[92:95], v[40:55]
  s_lshl_b32 s33, s33, 12
  s_add_u32 s22, s20, s33
  s_addc_u32 s23, s21, 0
  global_load_dwordx4 v[224:227], v3, s[22:23] offset:0
  ds_read_b64_tr_b16 v[108:109], v13 offset:0
  ds_read_b64_tr_b16 v[110:111], v13 offset:1024
  s_waitcnt lgkmcnt(8)
  v_mfma_f32_32x32x16_bf16 v[24:39], v[120:123], v[96:99], v[24:39]
  global_load_dwordx4 v[228:231], v3, s[22:23] offset:1024
  global_load_dwordx4 v[232:235], v3, s[22:23] offset:2048
  global_load_dwordx4 v[236:239], v3, s[22:23] offset:3072
  ds_read_b64_tr_b16 v[112:113], v12 offset:2048
  ds_read_b64_tr_b16 v[114:115], v12 offset:3072
  v_mfma_f32_32x32x16_bf16 v[40:55], v[124:127], v[96:99], v[40:55]
  ds_read_b64_tr_b16 v[116:117], v13 offset:2048
  ds_read_b64_tr_b16 v[118:119], v13 offset:3072
  s_waitcnt lgkmcnt(8)
  v_mfma_f32_32x32x16_bf16 v[24:39], v[128:131], v[100:103], v[24:39]
  ds_read_b64_tr_b16 v[120:121], v12 offset:4096
  ds_read_b64_tr_b16 v[122:123], v12 offset:5120
  s_waitcnt vmcnt(16)
  v_min3_u32 v6, v176, v178, v180
  v_min3_u32 v7, v182, v184, v186
  v_min3_u32 v6, v6, v188, v190
  v_min_u32 v6, v6, v7
  v_cmp_eq_u32 vcc, 0, v6
  v_mfma_f32_32x32x16_bf16 v[40:55], v[132:135], v[100:103], v[40:55]
  ds_read_b64_tr_b16 v[124:125], v13 offset:4096
  ds_read_b64_tr_b16 v[126:127], v13 offset:5120
  s_cbranch_vccnz .g2_kernel_w_v9
.g2_kernel_w_vb9:
  s_waitcnt lgkmcnt(8)
  v_mfma_f32_32x32x16_bf16 v[24:39], v[104:107], v[176:179], v[24:39]
  v_add_u32 v10, s10, v14
  v_add_u32 v11, s10, v15
  s_andn2_b32 s33, s36, s34
  s_cbranch_scc0 .g2_kernel_w_i13c
.g2_kernel_w_i13b:
  ds_read_b64_tr_b16 v[128:129], v12 offset:6144
  ds_read_b64_tr_b16 v[130:131], v12 offset:7168
  v_mfma_f32_32x32x16_bf16 v[40:55], v[108:111], v[176:179], v[40:55]
  s_ff1_i32_b32 s33, s33
  s_bitset1_b32 s34, s33
  s_xor_b32 s33, s33, s24
  s_and_b32 s13, s33, 7
  ds_read_b64_tr_b16 v[132:133], v13 offset:6144
  ds_read_b64_tr_b16 v[134:135], v13 offset:7168
  s_waitcnt lgkmcnt(8)
  v_mfma_f32_32x32x16_bf16 v[24:39], v[112:115], v[180:183], v[24:39]
  s_cmp_lt_u32 s13, 2
  s_cselect_b32 s28, 139264, 0
  s_lshl_b32 s13, s13, 13
  s_add_u32 s13, s13, s28
  ds_read_b64_tr_b16 v[104:105], v10 offset:0
  ds_read_b64_tr_b16 v[106:107], v10 offset:1024
  v_mfma_f32_32x32x16_bf16 v[40:55], v[116:119], v[180:183], v[40:55]
  s_lshl_b32 s33, s33, 12
  s_add_u32 s22, s20, s33
  s_addc_u32 s23, s21, 0
  global_load_dwordx4 v[136:139], v3, s[22:23] offset:0
  ds_read_b64_tr_b16 v[108:109], v11 offset:0
  ds_read_b64_tr_b16 v[110:111], v11 offset:1024
  s_waitcnt lgkmcnt(8)
  v_mfma_f32_32x32x16_bf16 v[24:39], v[120:123], v[184:187], v[24:39]
  global_load_dwordx4 v[140:143], v3, s[22:23] offset:1024
  global_load_dwordx4 v[144:147], v3, s[22:23] offset:2048
  global_load_dwordx4 v[148:151], v3, s[22:23] offset:3072
  ds_read_b64_tr_b16 v[112:113], v10 offset:2048
  ds_read_b64_tr_b16 v[114:115], v10 offset:3072
  v_mfma_f32_32x32x16_bf16 v[40:55], v[124:127], v[184:187], v[40:55]
  ds_read_b64_tr_b16 v[116:117], v11 offset:2048
  ds_read_b64_tr_b16 v[118:119], v11 offset:3072
  s_waitcnt lgkmcnt(8)
  v_mfma_f32_32x32x16_bf16 v[24:39], v[128:131], v[188:191], v[24:39]
  ds_read_b64_tr_b16 v[120:121], v10 offset:4096
  ds_read_b64_tr_b16 v[122:123], v10 offset:5120
  s_waitcnt vmcnt(12)
  v_min3_u32 v6, v192, v194, v196
  v_min3_u32 v7, v198, v200, v202
  v_min3_u32 v6, v6, v204, v206
  v_min_u32 v6, v6, v7
  v_cmp_eq_u32 vcc, 0, v6
  v_mfma_f32_32x32x16_bf16 v[40:55], v[132:135], v[188:191], v[40:55]
  ds_read_b64_tr_b16 v[124:125], v11 offset:4096
  ds_read_b64_tr_b16 v[126:127], v11 offset:5120
  s_cbranch_vccnz .g2_kernel_w_v10
.g2_kernel_w_vb10:
  s_waitcnt lgkmcnt(8)
  v_mfma_f32_32x32x16_bf16 v[24:39], v[104:107], v[192:195], v[24:39]
  v_add_u32 v12, s11, v14
  v_add_u32 v13, s11, v15
  s_andn2_b32 s33, s36, s34
  s_cbranch_scc0 .g2_kernel_w_i14c
.g2_kernel_w_i14b:
  ds_read_b64_tr_b16 v[128:129], v10 offset:6144
  ds_read_b64_tr_b16 v[130:131], v10 offset:7168
  v_mfma_f32_32x32x16_bf16 v[40:55], v[108:111], v[192:195], v[40:55]
  s_ff1_i32_b32 s33, s33
  s_bitset1_b32 s34, s33
  s_xor_b32 s33, s33, s24
  s_and_b32 s14, s33, 7
  ds_read_b64_tr_b16 v[132:133], v11 offset:6144
  ds_read_b64_tr_b16 v[134:135], v11 offset:7168
  s_waitcnt lgkmcnt(8)
  v_mfma_f32_32x32x16_bf16 v[24:39], v[112:115], v[196:199], v[24:39]
  s_cmp_lt_u32 s14, 2
  s_cselect_b32 s28, 139264, 0
  s_lshl_b32 s14, s14, 13
  s_add_u32 s14, s14, s28
  ds_read_b64_tr_b16 v[104:105], v12 offset:0
  ds_read_b64_tr_b16 v[106:107], v12 offset:1024
  v_mfma_f32_32x32x16_bf16 v[40:55], v[116:119], v[196:199], v[40:55]
  s_lshl_b32 s33, s33, 12
  s_add_u32 s22, s20, s33
  s_addc_u32 s23, s21, 0
  global_load_dwordx4 v[152:155], v3, s[22:23] offset:0 sc1
  ds_read_b64_tr_b16 v[108:109], v13 offset:0
  ds_read_b64_tr_b16 v[110:111], v13 offset:1024
  s_waitcnt lgkmcnt(8)
  v_mfma_f32_32x32x16_bf16 v[24:39], v[120:123], v[200:203], v[24:39]
  global_load_dwordx4 v[156:159], v3, s[22:23] offset:1024 sc1
  global_load_dwordx4 v[160:163], v3, s[22:23] offset:2048 sc1
  global_load_dwordx4 v[164:167], v3, s[22:23] offset:3072 sc1
  ds_read_b64_tr_b16 v[112:113], v12 offset:2048
  ds_read_b64_tr_b16 v[114:115], v12 offset:3072
  v_mfma_f32_32x32x16_bf16 v[40:55], v[124:127], v[200:203], v[40:55]
  ds_read_b64_tr_b16 v[116:117], v13 offset:2048
  ds_read_b64_tr_b16 v[118:119], v13 offset:3072
  s_waitcnt lgkmcnt(8)
  v_mfma_f32_32x32x16_bf16 v[24:39], v[128:131], v[204:207], v[24:39]
  ds_read_b64_tr_b16 v[120:121], v12 offset:4096
  ds_read_b64_tr_b16 v[122:123], v12 offset:5120
  s_waitcnt vmcnt(12)
  v_min3_u32 v6, v208, v210, v212
  v_min3_u32 v7, v214, v216, v218
  v_min3_u32 v6, v6, v220, v222
  v_min_u32 v6, v6, v7
  v_cmp_eq_u32 vcc, 0, v6
  v_mfma_f32_32x32x16_bf16 v[40:55], v[132:135], v[204:207], v[40:55]
  ds_read_b64_tr_b16 v[124:125], v13 offset:4096
  ds_read_b64_tr_b16 v[126:127], v13 offset:5120
  s_cbranch_vccnz .g2_kernel_w_v11
.g2_kernel_w_vb11:
  s_mov_b64 exec, 1
  ds_add_u32 v20, v5 offset:16
  s_mov_b64 exec, -1
  s_waitcnt lgkmcnt(8)
  v_mfma_f32_32x32x16_bf16 v[24:39], v[104:107], v[208:211], v[24:39]
  v_add_u32 v10, s12, v14
  v_add_u32 v11, s12, v15
  s_andn2_b32 s33, s36, s34
  s_cbranch_scc0 .g2_kernel_w_i15c
.g2_kernel_w_i15b:
  ds_read_b64_tr_b16 v[128:129], v12 offset:6144
  ds_read_b64_tr_b16 v[130:131], v12 offset:7168
  v_mfma_f32_32x32x16_bf16 v[40:55], v[108:111], v[208:211], v[40:55]
  s_ff1_i32_b32 s33, s33
  s_bitset1_b32 s34, s33
  s_xor_b32 s33, s33, s24
  s_and_b32 s15, s33, 7
  ds_read_b64_tr_b16 v[132:133], v13 offset:6144
  ds_read_b64_tr_b16 v[134:135], v13 offset:7168
  s_waitcnt lgkmcnt(8)
  v_mfma_f32_32x32x16_bf16 v[24:39], v[112:115], v[212:215], v[24:39]
  s_cmp_lt_u32 s15, 2
  s_cselect_b32 s28, 139264, 0
  s_lshl_b32 s15, s15, 13
  s_add_u32 s15, s15, s28
  ds_read_b64_tr_b16 v[104:105], v10 offset:0
  ds_read_b64_tr_b16 v[106:107], v10 offset:1024
  v_mfma_f32_32x32x16_bf16 v[40:55], v[116:119], v[212:215], v[40:55]
  s_lshl_b32 s33, s33, 12
  s_add_u32 s22, s20, s33
  s_addc_u32 s23, s21, 0
  global_load_dwordx4 v[56:59], v3, s[22:23] offset:0 sc1
  ds_read_b64_tr_b16 v[108:109], v11 offset:0
  ds_read_b64_tr_b16 v[110:111], v11 offset:1024
  s_waitcnt lgkmcnt(8)
  v_mfma_f32_32x32x16_bf16 v[24:39], v[120:123], v[216:219], v[24:39]
  global_load_dwordx4 v[60:63], v3, s[22:23] offset:1024 sc1
  global_load_dwordx4 v[64:67], v3, s[22:23] offset:2048 sc1
  global_load_dwordx4 v[68:71], v3, s[22:23] offset:3072 sc1
  ds_read_b64_tr_b16 v[112:113], v10 offset:2048
  ds_read_b64_tr_b16 v[114:115], v10 offset:3072
  v_mfma_f32_32x32x16_bf16 v[40:55], v[124:127], v[216:219], v[40:55]
  ds_read_b64_tr_b16 v[116:117], v11 offset:2048
  ds_read_b64_tr_b16 v[118:119], v11 offset:3072
  s_waitcnt lgkmcnt(8)
  v_mfma_f32_32x32x16_bf16 v[24:39], v[128:131], v[220:223], v[24:39]
  ds_read_b64_tr_b16 v[120:121], v10 offset:4096
  ds_read_b64_tr_b16 v[122:123], v10 offset:5120
  s_waitcnt vmcnt(12)
  v_min3_u32 v6, v224, v226, v228
  v_min3_u32 v7, v230, v232, v234
  v_min3_u32 v6, v6, v236, v238
  v_min_u32 v6, v6, v7
  v_cmp_eq_u32 vcc, 0, v6
  v_mfma_f32_32x32x16_bf16 v[40:55], v[132:135], v[220:223], v[40:55]
  ds_read_b64_tr_b16 v[124:125], v11 offset:4096
  ds_read_b64_tr_b16 v[126:127], v11 offset:5120
  s_cbranch_vccnz .g2_kernel_w_v12
.g2_kernel_w_vb12:
  s_waitcnt lgkmcnt(8)
  v_mfma_f32_32x32x16_bf16 v[24:39], v[104:107], v[224:227], v[24:39]
  v_add_u32 v12, s13, v14
  v_add_u32 v13, s13, v15
  ds_read_b64_tr_b16 v[128:129], v10 offset:6144
  ds_read_b64_tr_b16 v[130:131], v10 offset:7168
  v_mfma_f32_32x32x16_bf16 v[40:55], v[108:111], v[224:227], v[40:55]
  ds_read_b64_tr_b16 v[132:133], v11 offset:6144
  ds_read_b64_tr_b16 v[134:135], v11 offset:7168
  s_waitcnt lgkmcnt(8)
  v_mfma_f32_32x32x16_bf16 v[24:39], v[112:115], v[228:231], v[24:39]
  ds_read_b64_tr_b16 v[104:105], v12 offset:0
  ds_read_b64_tr_b16 v[106:107], v12 offset:1024
  v_mfma_f32_32x32x16_bf16 v[40:55], v[116:119], v[228:231], v[40:55]
  ds_read_b64_tr_b16 v[108:109], v13 offset:0
  ds_read_b64_tr_b16 v[110:111], v13 offset:1024
  s_waitcnt lgkmcnt(8)
  v_mfma_f32_32x32x16_bf16 v[24:39], v[120:123], v[232:235], v[24:39]
  ds_read_b64_tr_b16 v[112:113], v12 offset:2048
  ds_read_b64_tr_b16 v[114:115], v12 offset:3072
  v_mfma_f32_32x32x16_bf16 v[40:55], v[124:127], v[232:235], v[40:55]
  ds_read_b64_tr_b16 v[116:117], v13 offset:2048
  ds_read_b64_tr_b16 v[118:119], v13 offset:3072
  s_waitcnt lgkmcnt(8)
  v_mfma_f32_32x32x16_bf16 v[24:39], v[128:131], v[236:239], v[24:39]
  ds_read_b64_tr_b16 v[120:121], v12 offset:4096
  ds_read_b64_tr_b16 v[122:123], v12 offset:5120
  s_waitcnt vmcnt(8)
  v_min3_u32 v6, v136, v138, v140
  v_min3_u32 v7, v142, v144, v146
  v_min3_u32 v6, v6, v148, v150
  v_min_u32 v6, v6, v7
  v_cmp_eq_u32 vcc, 0, v6
  v_mfma_f32_32x32x16_bf16 v[40:55], v[132:135], v[236:239], v[40:55]
  ds_read_b64_tr_b16 v[124:125], v13 offset:4096
  ds_read_b64_tr_b16 v[126:127], v13 offset:5120
  s_cbranch_vccnz .g2_kernel_w_v13
.g2_kernel_w_vb13:
  s_waitcnt lgkmcnt(8)
  v_mfma_f32_32x32x16_bf16 v[24:39], v[104:107], v[136:139], v[24:39]
  v_add_u32 v10, s14, v14
  v_add_u32 v11, s14, v15
  ds_read_b64_tr_b16 v[128:129], v12 offset:6144
  ds_read_b64_tr_b16 v[130:131], v12 offset:7168
  v_mfma_f32_32x32x16_bf16 v[40:55], v[108:111], v[136:139], v[40:55]
  ds_read_b64_tr_b16 v[132:133], v13 offset:6144
  ds_read_b64_tr_b16 v[134:135], v13 offset:7168
  s_waitcnt lgkmcnt(8)
  v_mfma_f32_32x32x16_bf16 v[24:39], v[112:115], v[140:143], v[24:39]
  ds_read_b64_tr_b16 v[104:105], v10 offset:0
  ds_read_b64_tr_b16 v[106:107], v10 offset:1024
  v_mfma_f32_32x32x16_bf16 v[40:55], v[116:119], v[140:143], v[40:55]
  ds_read_b64_tr_b16 v[108:109], v11 offset:0
  ds_read_b64_tr_b16 v[110:111], v11 offset:1024
  s_waitcnt lgkmcnt(8)
  v_mfma_f32_32x32x16_bf16 v[24:39], v[120:123], v[144:147], v[24:39]
  ds_read_b64_tr_b16 v[112:113], v10 offset:2048
  ds_read_b64_tr_b16 v[114:115], v10 offset:3072
  v_mfma_f32_32x32x16_bf16 v[40:55], v[124:127], v[144:147], v[40:55]
  ds_read_b64_tr_b16 v[116:117], v11 offset:2048
  ds_read_b64_tr_b16 v[118:119], v11 offset:3072
  s_waitcnt lgkmcnt(8)
  v_mfma_f32_32x32x16_bf16 v[24:39], v[128:131], v[148:151], v[24:39]
  ds_read_b64_tr_b16 v[120:121], v10 offset:4096
  ds_read_b64_tr_b16 v[122:123], v10 offset:5120
  s_waitcnt vmcnt(4)
  v_min3_u32 v6, v152, v154, v156
  v_min3_u32 v7, v158, v160, v162
  v_min3_u32 v6, v6, v164, v166
  v_min_u32 v6, v6, v7
  v_cmp_eq_u32 vcc, 0, v6
  v_mfma_f32_32x32x16_bf16 v[40:55], v[132:135], v[148:151], v[40:55]
  ds_read_b64_tr_b16 v[124:125], v11 offset:4096
  ds_read_b64_tr_b16 v[126:127], v11 offset:5120
  s_cbranch_vccnz .g2_kernel_w_v14
.g2_kernel_w_vb14:
  s_waitcnt lgkmcnt(8)
  v_mfma_f32_32x32x16_bf16 v[24:39], v[104:107], v[152:155], v[24:39]
  v_add_u32 v12, s15, v14
  v_add_u32 v13, s15, v15
  ds_read_b64_tr_b16 v[128:129], v10 offset:6144
  ds_read_b64_tr_b16 v[130:131], v10 offset:7168
  v_mfma_f32_32x32x16_bf16 v[40:55], v[108:111], v[152:155], v[40:55]
  ds_read_b64_tr_b16 v[132:133], v11 offset:6144
  ds_read_b64_tr_b16 v[134:135], v11 offset:7168
  s_waitcnt lgkmcnt(8)
  v_mfma_f32_32x32x16_bf16 v[24:39], v[112:115], v[156:159], v[24:39]
  ds_read_b64_tr_b16 v[104:105], v12 offset:0
  ds_read_b64_tr_b16 v[106:107], v12 offset:1024
  v_mfma_f32_32x32x16_bf16 v[40:55], v[116:119], v[156:159], v[40:55]
  ds_read_b64_tr_b16 v[108:109], v13 offset:0
  ds_read_b64_tr_b16 v[110:111], v13 offset:1024
  s_waitcnt lgkmcnt(8)
  v_mfma_f32_32x32x16_bf16 v[24:39], v[120:123], v[160:163], v[24:39]
  ds_read_b64_tr_b16 v[112:113], v12 offset:2048
  ds_read_b64_tr_b16 v[114:115], v12 offset:3072
  v_mfma_f32_32x32x16_bf16 v[40:55], v[124:127], v[160:163], v[40:55]
  ds_read_b64_tr_b16 v[116:117], v13 offset:2048
  ds_read_b64_tr_b16 v[118:119], v13 offset:3072
  s_waitcnt lgkmcnt(8)
  v_mfma_f32_32x32x16_bf16 v[24:39], v[128:131], v[164:167], v[24:39]
  ds_read_b64_tr_b16 v[120:121], v12 offset:4096
  ds_read_b64_tr_b16 v[122:123], v12 offset:5120
  s_waitcnt vmcnt(0)
  v_min3_u32 v6, v56, v58, v60
  v_min3_u32 v7, v62, v64, v66
  v_min3_u32 v6, v6, v68, v70
  v_min_u32 v6, v6, v7
  v_cmp_eq_u32 vcc, 0, v6
  v_mfma_f32_32x32x16_bf16 v[40:55], v[132:135], v[164:167], v[40:55]
  ds_read_b64_tr_b16 v[124:125], v13 offset:4096
  ds_read_b64_tr_b16 v[126:127], v13 offset:5120
  s_cbranch_vccnz .g2_kernel_w_v15
.g2_kernel_w_vb15:
  s_waitcnt lgkmcnt(8)
  v_mfma_f32_32x32x16_bf16 v[24:39], v[104:107], v[56:59], v[24:39]
  ds_read_b64_tr_b16 v[128:129], v12 offset:6144
  ds_read_b64_tr_b16 v[130:131], v12 offset:7168
  v_mfma_f32_32x32x16_bf16 v[40:55], v[108:111], v[56:59], v[40:55]
  ds_read_b64_tr_b16 v[132:133], v13 offset:6144
  ds_read_b64_tr_b16 v[134:135], v13 offset:7168
  s_waitcnt lgkmcnt(8)
  v_mfma_f32_32x32x16_bf16 v[24:39], v[112:115], v[60:63], v[24:39]
  v_mfma_f32_32x32x16_bf16 v[40:55], v[116:119], v[60:63], v[40:55]
  s_waitcnt lgkmcnt(4)
  v_mfma_f32_32x32x16_bf16 v[24:39], v[120:123], v[64:67], v[24:39]
  v_mfma_f32_32x32x16_bf16 v[40:55], v[124:127], v[64:67], v[40:55]
  s_waitcnt lgkmcnt(0)
  v_mfma_f32_32x32x16_bf16 v[24:39], v[128:131], v[68:71], v[24:39]
  v_mfma_f32_32x32x16_bf16 v[40:55], v[132:135], v[68:71], v[40:55]
  s_lshl_b32 s28, s17, 4
  s_add_u32 s28, s28, s18
  s_lshl_b32 s28, s28, 2
  s_add_u32 s28, s28, s16
  s_lshl_b32 s28, s28, 12
  s_add_u32 s28, s28, s63
  s_add_u32 s28, s28, 0xc00000
  s_lshl_b32 s29, s16, 12
  v_add_u32 v6, s29, v22
  s_mov_b32 s36, 0x3f803f80
  v_mov_b32 v8, 0
  v_mov_b32 v9, 0
  v_mov_b32 v10, 0
  v_cvt_pk_bf16_f32 v56, v24, v25
  v_cvt_pk_bf16_f32 v57, v26, v27
  v_cvt_pk_bf16_f32 v58, v28, v29
  v_cvt_pk_bf16_f32 v59, v30, v31
  buffer_store_dwordx4 v[56:59], v22, s[4:7], s28 offen offset:0 sc1
  v_cvt_pk_bf16_f32 v60, v32, v33
  v_cvt_pk_bf16_f32 v61, v34, v35
  v_cvt_pk_bf16_f32 v62, v36, v37
  v_cvt_pk_bf16_f32 v63, v38, v39
  buffer_store_dwordx4 v[60:63], v22, s[4:7], s28 offen offset:512 sc1
  v_cvt_pk_bf16_f32 v64, v40, v41
  v_cvt_pk_bf16_f32 v65, v42, v43
  v_cvt_pk_bf16_f32 v66, v44, v45
  v_cvt_pk_bf16_f32 v67, v46, v47
  buffer_store_dwordx4 v[64:67], v22, s[4:7], s28 offen offset:1024 sc1
  v_cvt_pk_bf16_f32 v68, v48, v49
  v_cvt_pk_bf16_f32 v69, v50, v51
  v_cvt_pk_bf16_f32 v70, v52, v53
  v_cvt_pk_bf16_f32 v71, v54, v55
  buffer_store_dwordx4 v[68:71], v22, s[4:7], s28 offen offset:1536 sc1
  ds_write_b128 v6, v[56:59] offset:0
  ds_write_b128 v6, v[60:63] offset:512
  ds_write_b128 v6, v[64:67] offset:1024
  ds_write_b128 v6, v[68:71] offset:1536
  s_mov_b64 exec, 1
  ds_add_u32 v20, v5 offset:20
  s_mov_b64 exec, -1
  s_lshl_b32 s28, s17, 2
  s_add_u32 s28, s28, s16
  s_lshl_b32 s28, s28, 13
  s_lshl_b32 s29, s18, 9
  s_add_u32 s28, s28, s29
  s_add_u32 s28, s28, s63
  s_add_u32 s28, s28, 0x1000000
  v_dot2c_f32_bf16 v8, s36, v56
  v_dot2c_f32_bf16 v9, v56, v56
  v_dot2c_f32_bf16 v10, v56, v240
  v_dot2c_f32_bf16 v8, s36, v57
  v_dot2c_f32_bf16 v9, v57, v57
  v_dot2c_f32_bf16 v10, v57, v241
  v_dot2c_f32_bf16 v8, s36, v58
  v_dot2c_f32_bf16 v9, v58, v58
  v_dot2c_f32_bf16 v10, v58, v242
  v_dot2c_f32_bf16 v8, s36, v59
  v_dot2c_f32_bf16 v9, v59, v59
  v_dot2c_f32_bf16 v10, v59, v243
  v_dot2c_f32_bf16 v8, s36, v60
  v_dot2c_f32_bf16 v9, v60, v60
  v_dot2c_f32_bf16 v10, v60, v244
  v_dot2c_f32_bf16 v8, s36, v61
  v_dot2c_f32_bf16 v9, v61, v61
  v_dot2c_f32_bf16 v10, v61, v245
  v_dot2c_f32_bf16 v8, s36, v62
  v_dot2c_f32_bf16 v9, v62, v62
  v_dot2c_f32_bf16 v10, v62, v246
  v_dot2c_f32_bf16 v8, s36, v63
  v_dot2c_f32_bf16 v9, v63, v63
  v_dot2c_f32_bf16 v10, v63, v247
  v_dot2c_f32_bf16 v8, s36, v64
  v_dot2c_f32_bf16 v9, v64, v64
  v_dot2c_f32_bf16 v10, v64, v248
  v_dot2c_f32_bf16 v8, s36, v65
  v_dot2c_f32_bf16 v9, v65, v65
  v_dot2c_f32_bf16 v10, v65, v249
  v_dot2c_f32_bf16 v8, s36, v66
  v_dot2c_f32_bf16 v9, v66, v66
  v_dot2c_f32_bf16 v10, v66, v250
  v_dot2c_f32_bf16 v8, s36, v67
  v_dot2c_f32_bf16 v9, v67, v67
  v_dot2c_f32_bf16 v10, v67, v251
  v_dot2c_f32_bf16 v8, s36, v68
  v_dot2c_f32_bf16 v9, v68, v68
  v_dot2c_f32_bf16 v10, v68, v252
  v_dot2c_f32_bf16 v8, s36, v69
  v_dot2c_f32_bf16 v9, v69, v69
  v_dot2c_f32_bf16 v10, v69, v253
  v_dot2c_f32_bf16 v8, s36, v70
  v_dot2c_f32_bf16 v9, v70, v70
  v_dot2c_f32_bf16 v10, v70, v254
  v_dot2c_f32_bf16 v8, s36, v71
  v_dot2c_f32_bf16 v9, v71, v71
  v_dot2c_f32_bf16 v10, v71, v255
  s_lshl_b32 s29, s16, 7
  s_add_u32 s37, s19, s29
  v_mov_b32 v24, v8
  v_mov_b32 v25, v9
  v_mov_b32 v26, v10
  v_mov_b32 v11, 1
  v_permlane32_swap_b32 v8, v24
  v_permlane32_swap_b32 v9, v25
  v_permlane32_swap_b32 v10, v26
  v_add_f32 v8, v8, v24
  v_add_f32 v9, v9, v25
  v_add_f32 v10, v10, v26
  v_or_b32 v8, 1, v8
  v_mov_b32 v16, s70
  s_mov_b32 exec_hi, 0
  s_waitcnt vmcnt(0)
  buffer_store_dwordx4 v[8:11], v3, s[4:7], s28 offen sc1
  s_mov_b64 exec, 1
  buffer_store_dword v16, v4, s[4:7], s37 offen offset:8 sc1
  s_mov_b64 exec, -1
  s_cmp_lg_u32 s62, 0
  s_cbranch_scc1 .g2_kernel_tail
  s_mov_b32 s62, 1
  s_mov_b32 s63, 0x1800000
  s_mov_b32 s70, 2
  s_mov_b32 s71, 155776
  s_branch .g2_kernel_q_cons2
.g2_kernel_tail:
  s_mov_b32 s28, s56
  s_mov_b32 s29, s57
  s_mov_b32 s30, 0x400000
  s_mov_b32 s31, 0x00020000
  v_lshrrev_b32 v8, 3, v2
  v_and_b32 v9, 7, v2
  v_lshlrev_b32 v10, 8, v9
  v_lshl_add_u32 v10, v8, 4, v10
  s_lshl_b32 s32, s16, 12
  v_add_u32 v10, s32, v10
  ds_read_b128 v[56:59], v10 offset:0
  ds_read_b128 v[60:63], v10 offset:128
  ds_read_b128 v[64:67], v10 offset:2048
  ds_read_b128 v[68:71], v10 offset:2176
  v_lshlrev_b32 v23, 11, v8
  v_lshl_add_u32 v23, v9, 4, v23
  s_lshl_b32 s32, s16, 5
  v_add_u32 v19, s32, v8
  v_lshlrev_b32 v10, 2, v19
  v_add_u32 v10, 155648, v10
  s_lshl_b32 s32, s17, 2
  s_add_u32 s32, s32, s16
  s_lshl_b32 s32, s32, 16
  s_lshl_b32 s33, s18, 7
  s_add_u32 s32, s32, s33
  s_waitcnt lgkmcnt(0)
  v_lshlrev_b32 v24, 16, v56
  v_and_b32 v25, 0xffff0000, v56
  v_lshlrev_b32 v26, 16, v57
  v_and_b32 v27, 0xffff0000, v57
  v_lshlrev_b32 v28, 16, v58
  v_and_b32 v29, 0xffff0000, v58
  v_lshlrev_b32 v30, 16, v59
  v_and_b32 v31, 0xffff0000, v59
  v_lshlrev_b32 v32, 16, v60
  v_and_b32 v33, 0xffff0000, v60
  v_lshlrev_b32 v34, 16, v61
  v_and_b32 v35, 0xffff0000, v61
  v_lshlrev_b32 v36, 16, v62
  v_and_b32 v37, 0xffff0000, v62
  v_lshlrev_b32 v38, 16, v63
  v_and_b32 v39, 0xffff0000, v63
  v_lshlrev_b32 v40, 16, v64
  v_and_b32 v41, 0xffff0000, v64
  v_lshlrev_b32 v42, 16, v65
  v_and_b32 v43, 0xffff0000, v65
  v_lshlrev_b32 v44, 16, v66
  v_and_b32 v45, 0xffff0000, v66
  v_lshlrev_b32 v46, 16, v67
  v_and_b32 v47, 0xffff0000, v67
  v_lshlrev_b32 v48, 16, v68
  v_and_b32 v49, 0xffff0000, v68
  v_lshlrev_b32 v50, 16, v69
  v_and_b32 v51, 0xffff0000, v69
  v_lshlrev_b32 v52, 16, v70
  v_and_b32 v53, 0xffff0000, v70
  v_lshlrev_b32 v54, 16, v71
  v_and_b32 v55, 0xffff0000, v71
  v_mov_b32 v6, s71
  s_mov_b32 s38, 0
.g2_kernel_wg5:
  ds_read_b32 v7, v6 offset:28
  s_add_u32 s38, s38, 1
  s_waitcnt lgkmcnt(0)
  v_cmp_gt_u32 vcc, 1, v7
  s_cbranch_vccz .g2_kernel_wg5d
  s_sleep 2
  s_cmp_lt_u32 s38, 524288
  s_cbranch_scc1 .g2_kernel_wg5
.g2_kernel_wg5d:
  ds_read_b32 v16, v20 offset:32
  ds_read_b32 v72, v10 offset:3840
  ds_read_b32 v73, v10 offset:4352
  ds_read_b32 v74, v10 offset:3872
  ds_read_b32 v75, v10 offset:4384
  ds_read_b32 v76, v10 offset:3904
  ds_read_b32 v77, v10 offset:4416
  ds_read_b32 v78, v10 offset:3936
  ds_read_b32 v79, v10 offset:4448
  s_waitcnt lgkmcnt(0)
  v_sub_u32 v16, v16, v19
  v_pk_fma_f32 v[24:25], v[24:25], v[72:73], v[72:73] op_sel:[0,0,1] op_sel_hi:[1,0,1]
  v_pk_fma_f32 v[26:27], v[26:27], v[72:73], v[72:73] op_sel:[0,0,1] op_sel_hi:[1,0,1]
  v_pk_fma_f32 v[28:29], v[28:29], v[72:73], v[72:73] op_sel:[0,0,1] op_sel_hi:[1,0,1]
  v_pk_fma_f32 v[30:31], v[30:31], v[72:73], v[72:73] op_sel:[0,0,1] op_sel_hi:[1,0,1]
  v_cvt_pk_bf16_f32 v56, v24, v25
  v_cvt_pk_bf16_f32 v57, v26, v27
  v_cvt_pk_bf16_f32 v58, v28, v29
  v_cvt_pk_bf16_f32 v59, v30, v31
  v_cmp_ne_u32 vcc, 1, v16
  s_mov_b64 exec, vcc
  buffer_store_dwordx4 v[56:59], v23, s[28:31], s32 offen sc1
  s_mov_b64 exec, -1
  s_add_u32 s32, s32, 16384
  v_pk_fma_f32 v[32:33], v[32:33], v[74:75], v[74:75] op_sel:[0,0,1] op_sel_hi:[1,0,1]
  v_pk_fma_f32 v[34:35], v[34:35], v[74:75], v[74:75] op_sel:[0,0,1] op_sel_hi:[1,0,1]
  v_pk_fma_f32 v[36:37], v[36:37], v[74:75], v[74:75] op_sel:[0,0,1] op_sel_hi:[1,0,1]
  v_pk_fma_f32 v[38:39], v[38:39], v[74:75], v[74:75] op_sel:[0,0,1] op_sel_hi:[1,0,1]
  v_cvt_pk_bf16_f32 v60, v32, v33
  v_cvt_pk_bf16_f32 v61, v34, v35
  v_cvt_pk_bf16_f32 v62, v36, v37
  v_cvt_pk_bf16_f32 v63, v38, v39
  v_cmp_ne_u32 vcc, 9, v16
  s_mov_b64 exec, vcc
  buffer_store_dwordx4 v[60:63], v23, s[28:31], s32 offen sc1
  s_mov_b64 exec, -1
  s_add_u32 s32, s32, 16384
  v_pk_fma_f32 v[40:41], v[40:41], v[76:77], v[76:77] op_sel:[0,0,1] op_sel_hi:[1,0,1]
  v_pk_fma_f32 v[42:43], v[42:43], v[76:77], v[76:77] op_sel:[0,0,1] op_sel_hi:[1,0,1]
  v_pk_fma_f32 v[44:45], v[44:45], v[76:77], v[76:77] op_sel:[0,0,1] op_sel_hi:[1,0,1]
  v_pk_fma_f32 v[46:47], v[46:47], v[76:77], v[76:77] op_sel:[0,0,1] op_sel_hi:[1,0,1]
  v_cvt_pk_bf16_f32 v64, v40, v41
  v_cvt_pk_bf16_f32 v65, v42, v43
  v_cvt_pk_bf16_f32 v66, v44, v45
  v_cvt_pk_bf16_f32 v67, v46, v47
  v_cmp_ne_u32 vcc, 17, v16
  s_mov_b64 exec, vcc
  buffer_store_dwordx4 v[64:67], v23, s[28:31], s32 offen sc1
  s_mov_b64 exec, -1
  s_add_u32 s32, s32, 16384
  v_pk_fma_f32 v[48:49], v[48:49], v[78:79], v[78:79] op_sel:[0,0,1] op_sel_hi:[1,0,1]
  v_pk_fma_f32 v[50:51], v[50:51], v[78:79], v[78:79] op_sel:[0,0,1] op_sel_hi:[1,0,1]
  v_pk_fma_f32 v[52:53], v[52:53], v[78:79], v[78:79] op_sel:[0,0,1] op_sel_hi:[1,0,1]
  v_pk_fma_f32 v[54:55], v[54:55], v[78:79], v[78:79] op_sel:[0,0,1] op_sel_hi:[1,0,1]
  v_cvt_pk_bf16_f32 v68, v48, v49
  v_cvt_pk_bf16_f32 v69, v50, v51
  v_cvt_pk_bf16_f32 v70, v52, v53
  v_cvt_pk_bf16_f32 v71, v54, v55
  v_cmp_ne_u32 vcc, 25, v16
  s_mov_b64 exec, vcc
  buffer_store_dwordx4 v[68:71], v23, s[28:31], s32 offen sc1
  s_mov_b64 exec, -1
  s_add_u32 s32, s32, 16384
  s_branch .g2_kernel_fin
.g2_kernel_svc:
  s_cmp_eq_u32 s16, 5
  s_cbranch_scc1 .g2_kernel_s1
  s_cmp_eq_u32 s16, 6
  s_cbranch_scc1 .g2_kernel_s2
  s_cmp_eq_u32 s16, 7
  s_cbranch_scc1 .g2_kernel_s3
  s_mov_b32 s8, s40
  s_mov_b32 s9, s41
  s_mov_b32 s10, 0x400000
  s_mov_b32 s11, 0x00020000
  s_setprio 3
  v_lshrrev_b32 v20, 3, v2
  v_and_b32 v21, 7, v2
  v_lshrrev_b32 v22, 4, v2
  v_xor_b32 v23, v21, v22
  v_lshlrev_b32 v23, 4, v23
  v_lshl_add_u32 v24, v20, 11, v23
  v_xor_b32 v25, 64, v24
  s_lshl_b32 s32, s17, 18
  v_add_u32 v32, 0, v24
  v_add_u32 v33, 15360, v25
  v_add_u32 v34, 30720, v24
  v_add_u32 v35, 46080, v25
  v_add_u32 v36, 65536, v24
  v_add_u32 v37, 80896, v25
  v_add_u32 v38, 96256, v24
  v_add_u32 v39, 111616, v25
  v_add_u32 v40, 131072, v24
  v_add_u32 v41, 146432, v25
  v_add_u32 v42, 161792, v24
  v_add_u32 v43, 177152, v25
  v_add_u32 v44, 196608, v24
  v_add_u32 v45, 211968, v25
  v_add_u32 v46, 227328, v24
  v_add_u32 v47, 242688, v25
  s_mov_b32 s29, 0
  s_add_u32 m0, s29, 0
  s_waitcnt vmcnt(63)
  buffer_load_dwordx4 v32, s[8:11], s32 offen offset:0 lds
  buffer_load_dwordx4 v33, s[8:11], s32 offen offset:1024 lds
  buffer_load_dwordx4 v34, s[8:11], s32 offen offset:2048 lds
  buffer_load_dwordx4 v35, s[8:11], s32 offen offset:3072 lds
  s_add_u32 m0, s29, 4096
  s_waitcnt vmcnt(63)
  buffer_load_dwordx4 v36, s[8:11], s32 offen offset:0 lds
  buffer_load_dwordx4 v37, s[8:11], s32 offen offset:1024 lds
  buffer_load_dwordx4 v38, s[8:11], s32 offen offset:2048 lds
  buffer_load_dwordx4 v39, s[8:11], s32 offen offset:3072 lds
  s_add_u32 m0, s29, 8192
  s_waitcnt vmcnt(63)
  buffer_load_dwordx4 v40, s[8:11], s32 offen offset:0 lds
  buffer_load_dwordx4 v41, s[8:11], s32 offen offset:1024 lds
  buffer_load_dwordx4 v42, s[8:11], s32 offen offset:2048 lds
  buffer_load_dwordx4 v43, s[8:11], s32 offen offset:3072 lds
  s_add_u32 m0, s29, 12288
  s_waitcnt vmcnt(63)
  buffer_load_dwordx4 v44, s[8:11], s32 offen offset:0 lds
  buffer_load_dwordx4 v45, s[8:11], s32 offen offset:1024 lds
  buffer_load_dwordx4 v46, s[8:11], s32 offen offset:2048 lds
  buffer_load_dwordx4 v47, s[8:11], s32 offen offset:3072 lds
  s_add_u32 s32, s32, 128
  s_mov_b32 s12, s42
  s_mov_b32 s13, s43
  s_mov_b32 s14, 0x600000
  s_mov_b32 s15, 0x00020000
  v_lshrrev_b32 v28, 3, v2
  v_and_b32 v29, 7, v2
  v_bfe_u32 v30, v2, 4, 1
  v_lshlrev_b32 v30, 1, v30
  v_xor_b32 v31, v29, v30
  v_lshlrev_b32 v31, 4, v31
  v_mul_u32_u24 v28, 6144, v28
  v_add_u32 v28, v28, v31
  v_xor_b32 v29, 64, v28
  v_lshlrev_b32 v9, 2, v2
  v_and_b32 v9, 12, v9
  v_add_u32 v9, 156416, v9
  v_add_u32 v48, 0, v28
  v_add_u32 v49, 48128, v29
  v_add_u32 v50, 96256, v28
  v_add_u32 v51, 144384, v29
  v_add_u32 v52, 2048, v28
  v_add_u32 v53, 50176, v29
  v_add_u32 v54, 98304, v28
  v_add_u32 v55, 146432, v29
  v_add_u32 v56, 4096, v28
  v_add_u32 v57, 52224, v29
  v_add_u32 v58, 100352, v28
  v_add_u32 v59, 148480, v29
  s_lshl_b32 s36, s18, 7
  s_mov_b32 s30, 0
  s_add_u32 m0, s30, 65536
  s_waitcnt vmcnt(63)
  buffer_load_dwordx4 v48, s[12:15], s36 offen offset:0 lds
  buffer_load_dwordx4 v49, s[12:15], s36 offen offset:1024 lds
  buffer_load_dwordx4 v50, s[12:15], s36 offen offset:2048 lds
  buffer_load_dwordx4 v51, s[12:15], s36 offen offset:3072 lds
  s_add_u32 m0, s30, 69632
  s_waitcnt vmcnt(63)
  buffer_load_dwordx4 v52, s[12:15], s36 offen offset:0 lds
  buffer_load_dwordx4 v53, s[12:15], s36 offen offset:1024 lds
  buffer_load_dwordx4 v54, s[12:15], s36 offen offset:2048 lds
  buffer_load_dwordx4 v55, s[12:15], s36 offen offset:3072 lds
  s_add_u32 m0, s30, 73728
  s_waitcnt vmcnt(63)
  buffer_load_dwordx4 v56, s[12:15], s36 offen offset:0 lds
  buffer_load_dwordx4 v57, s[12:15], s36 offen offset:1024 lds
  buffer_load_dwordx4 v58, s[12:15], s36 offen offset:2048 lds
  buffer_load_dwordx4 v59, s[12:15], s36 offen offset:3072 lds
  s_add_u32 s30, s30, 12288
  s_cmp_eq_u32 s30, 86016
  s_cselect_b32 s30, 0, s30
  s_barrier
  s_mov_b32 s35, .g2_kernel_tab-.g2_kernel_pc+4
  s_mov_b32 s34, -5
  v_mov_b32 v10, 0
  s_mov_b32 m0, 156160
  s_add_u32 s36, s36, 196608
  s_mov_b64 exec, 1
  buffer_load_dword off, s[64:67], s35 lds
  s_mov_b64 exec, -1
  s_add_u32 s35, s35, 4
  s_branch .g2_kernel_p1_o
  .p2align 6
.g2_kernel_p1_l:
  s_waitcnt lgkmcnt(0)
  v_cmp_gt_i32 vcc, s34, v10
  s_cbranch_vccnz .g2_kernel_p1_aw
.g2_kernel_p1_ai:
  s_add_u32 s29, s29, 16384
  s_and_b32 s29, s29, 0xffff
  s_add_u32 m0, s29, 0
  s_waitcnt vmcnt(63)
  buffer_load_dwordx4 v32, s[8:11], s32 offen offset:0 lds
  buffer_load_dwordx4 v33, s[8:11], s32 offen offset:1024 lds
  buffer_load_dwordx4 v34, s[8:11], s32 offen offset:2048 lds
  buffer_load_dwordx4 v35, s[8:11], s32 offen offset:3072 lds
  s_add_u32 m0, s29, 4096
  s_waitcnt vmcnt(63)
  buffer_load_dwordx4 v36, s[8:11], s32 offen offset:0 lds
  buffer_load_dwordx4 v37, s[8:11], s32 offen offset:1024 lds
  buffer_load_dwordx4 v38, s[8:11], s32 offen offset:2048 lds
  buffer_load_dwordx4 v39, s[8:11], s32 offen offset:3072 lds
  s_add_u32 m0, s29, 8192
  s_waitcnt vmcnt(63)
  buffer_load_dwordx4 v40, s[8:11], s32 offen offset:0 lds
  buffer_load_dwordx4 v41, s[8:11], s32 offen offset:1024 lds
  buffer_load_dwordx4 v42, s[8:11], s32 offen offset:2048 lds
  buffer_load_dwordx4 v43, s[8:11], s32 offen offset:3072 lds
  s_add_u32 m0, s29, 12288
  s_waitcnt vmcnt(63)
  buffer_load_dwordx4 v44, s[8:11], s32 offen offset:0 lds
  buffer_load_dwordx4 v45, s[8:11], s32 offen offset:1024 lds
  buffer_load_dwordx4 v46, s[8:11], s32 offen offset:2048 lds
  buffer_load_dwordx4 v47, s[8:11], s32 offen offset:3072 lds
  s_add_u32 s32, s32, 128
  s_add_u32 m0, s30, 65536
  s_waitcnt vmcnt(63)
  buffer_load_dwordx4 v48, s[12:15], s36 offen offset:0 lds
  buffer_load_dwordx4 v49, s[12:15], s36 offen offset:1024 lds
  buffer_load_dwordx4 v50, s[12:15], s36 offen offset:2048 lds
  buffer_load_dwordx4 v51, s[12:15], s36 offen offset:3072 lds
  s_add_u32 m0, s30, 69632
  s_waitcnt vmcnt(63)
  buffer_load_dwordx4 v52, s[12:15], s36 offen offset:0 lds
  buffer_load_dwordx4 v53, s[12:15], s36 offen offset:1024 lds
  buffer_load_dwordx4 v54, s[12:15], s36 offen offset:2048 lds
  buffer_load_dwordx4 v55, s[12:15], s36 offen offset:3072 lds
  s_add_u32 m0, s30, 73728
  s_waitcnt vmcnt(63)
  buffer_load_dwordx4 v56, s[12:15], s36 offen offset:0 lds
  buffer_load_dwordx4 v57, s[12:15], s36 offen offset:1024 lds
  buffer_load_dwordx4 v58, s[12:15], s36 offen offset:2048 lds
  buffer_load_dwordx4 v59, s[12:15], s36 offen offset:3072 lds
  s_add_u32 s30, s30, 12288
  s_cmp_eq_u32 s30, 86016
  s_cselect_b32 s30, 0, s30
  ds_read_b32 v10, v9
  s_mov_b32 m0, 156160
  s_add_u32 s34, s34, 1
  s_mov_b64 exec, 1
  buffer_load_dword off, s[64:67], s35 lds
  s_mov_b64 exec, -1
  s_add_u32 s35, s35, 4
  s_add_u32 s36, s36, 196608
.g2_kernel_p1_o:
  s_waitcnt lgkmcnt(0)
  v_cmp_gt_i32 vcc, s34, v10
  s_cbranch_vccnz .g2_kernel_p1_bw
.g2_kernel_p1_bi:
  s_add_u32 m0, s30, 65536
  s_waitcnt vmcnt(63)
  buffer_load_dwordx4 v48, s[12:15], s36 offen offset:0 lds
  buffer_load_dwordx4 v49, s[12:15], s36 offen offset:1024 lds
  buffer_load_dwordx4 v50, s[12:15], s36 offen offset:2048 lds
  buffer_load_dwordx4 v51, s[12:15], s36 offen offset:3072 lds
  s_add_u32 m0, s30, 69632
  s_waitcnt vmcnt(63)
  buffer_load_dwordx4 v52, s[12:15], s36 offen offset:0 lds
  buffer_load_dwordx4 v53, s[12:15], s36 offen offset:1024 lds
  buffer_load_dwordx4 v54, s[12:15], s36 offen offset:2048 lds
  buffer_load_dwordx4 v55, s[12:15], s36 offen offset:3072 lds
  s_add_u32 m0, s30, 73728
  s_waitcnt vmcnt(63)
  buffer_load_dwordx4 v56, s[12:15], s36 offen offset:0 lds
  buffer_load_dwordx4 v57, s[12:15], s36 offen offset:1024 lds
  buffer_load_dwordx4 v58, s[12:15], s36 offen offset:2048 lds
  buffer_load_dwordx4 v59, s[12:15], s36 offen offset:3072 lds
  s_add_u32 s30, s30, 12288
  s_cmp_eq_u32 s30, 86016
  s_cselect_b32 s30, 0, s30
  ds_read_b32 v10, v9
  s_mov_b32 m0, 156160
  s_add_u32 s34, s34, 1
  s_mov_b64 exec, 1
  buffer_load_dword off, s[64:67], s35 lds
  s_mov_b64 exec, -1
  s_add_u32 s35, s35, 4
  s_add_u32 s36, s36, 196608
  s_cmp_lt_i32 s34, 26
  s_cbranch_scc1 .g2_kernel_p1_l
  s_branch .g2_kernel_v
.g2_kernel_s1:
  s_mov_b32 s8, s40
  s_mov_b32 s9, s41
  s_mov_b32 s10, 0x400000
  s_mov_b32 s11, 0x00020000
  v_lshrrev_b32 v20, 3, v2
  v_and_b32 v21, 7, v2
  v_lshlrev_b32 v21, 4, v21
  v_lshl_add_u32 v21, v20, 11, v21
  s_lshl_b32 s30, s17, 4
  s_add_u32 s30, s30, s18
  s_lshl_b32 s33, s30, 5
  s_lshl_b32 s30, s30, 14
  s_barrier
  s_sleep 30
  buffer_load_dwordx4 v[64:67], v21, s[8:11], s30 offen offset:0
  buffer_load_dwordx4 v[68:71], v21, s[8:11], s30 offen offset:128
  buffer_load_dwordx4 v[72:75], v21, s[8:11], s30 offen offset:256
  buffer_load_dwordx4 v[76:79], v21, s[8:11], s30 offen offset:384
  buffer_load_dwordx4 v[80:83], v21, s[8:11], s30 offen offset:512
  buffer_load_dwordx4 v[84:87], v21, s[8:11], s30 offen offset:640
  buffer_load_dwordx4 v[88:91], v21, s[8:11], s30 offen offset:768
  buffer_load_dwordx4 v[92:95], v21, s[8:11], s30 offen offset:896
  buffer_load_dwordx4 v[96:99], v21, s[8:11], s30 offen offset:1024
  buffer_load_dwordx4 v[100:103], v21, s[8:11], s30 offen offset:1152
  buffer_load_dwordx4 v[104:107], v21, s[8:11], s30 offen offset:1280
  buffer_load_dwordx4 v[108:111], v21, s[8:11], s30 offen offset:1408
  buffer_load_dwordx4 v[112:115], v21, s[8:11], s30 offen offset:1536
  buffer_load_dwordx4 v[116:119], v21, s[8:11], s30 offen offset:1664
  buffer_load_dwordx4 v[120:123], v21, s[8:11], s30 offen offset:1792
  buffer_load_dwordx4 v[124:127], v21, s[8:11], s30 offen offset:1920
  v_mov_b32 v24, 0
  v_mov_b32 v25, 0
  v_mov_b32 v26, 0
  v_mov_b32 v27, 0
  s_waitcnt vmcnt(15)
  v_lshlrev_b32 v22, 16, v64
  v_and_b32 v64, 0xffff0000, v64
  v_add_f32 v24, v24, v22
  v_fmac_f32 v25, v22, v22
  v_add_f32 v26, v26, v64
  v_fmac_f32 v27, v64, v64
  v_lshlrev_b32 v22, 16, v65
  v_and_b32 v65, 0xffff0000, v65
  v_add_f32 v24, v24, v22
  v_fmac_f32 v25, v22, v22
  v_add_f32 v26, v26, v65
  v_fmac_f32 v27, v65, v65
  v_lshlrev_b32 v22, 16, v66
  v_and_b32 v66, 0xffff0000, v66
  v_add_f32 v24, v24, v22
  v_fmac_f32 v25, v22, v22
  v_add_f32 v26, v26, v66
  v_fmac_f32 v27, v66, v66
  v_lshlrev_b32 v22, 16, v67
  v_and_b32 v67, 0xffff0000, v67
  v_add_f32 v24, v24, v22
  v_fmac_f32 v25, v22, v22
  v_add_f32 v26, v26, v67
  v_fmac_f32 v27, v67, v67
  s_waitcnt vmcnt(14)
  v_lshlrev_b32 v22, 16, v68
  v_and_b32 v68, 0xffff0000, v68
  v_add_f32 v24, v24, v22
  v_fmac_f32 v25, v22, v22
  v_add_f32 v26, v26, v68
  v_fmac_f32 v27, v68, v68
  v_lshlrev_b32 v22, 16, v69
  v_and_b32 v69, 0xffff0000, v69
  v_add_f32 v24, v24, v22
  v_fmac_f32 v25, v22, v22
  v_add_f32 v26, v26, v69
  v_fmac_f32 v27, v69, v69
  v_lshlrev_b32 v22, 16, v70
  v_and_b32 v70, 0xffff0000, v70
  v_add_f32 v24, v24, v22
  v_fmac_f32 v25, v22, v22
  v_add_f32 v26, v26, v70
  v_fmac_f32 v27, v70, v70
  v_lshlrev_b32 v22, 16, v71
  v_and_b32 v71, 0xffff0000, v71
  v_add_f32 v24, v24, v22
  v_fmac_f32 v25, v22, v22
  v_add_f32 v26, v26, v71
  v_fmac_f32 v27, v71, v71
  s_waitcnt vmcnt(13)
  v_lshlrev_b32 v22, 16, v72
  v_and_b32 v72, 0xffff0000, v72
  v_add_f32 v24, v24, v22
  v_fmac_f32 v25, v22, v22
  v_add_f32 v26, v26, v72
  v_fmac_f32 v27, v72, v72
  v_lshlrev_b32 v22, 16, v73
  v_and_b32 v73, 0xffff0000, v73
  v_add_f32 v24, v24, v22
  v_fmac_f32 v25, v22, v22
  v_add_f32 v26, v26, v73
  v_fmac_f32 v27, v73, v73
  v_lshlrev_b32 v22, 16, v74
  v_and_b32 v74, 0xffff0000, v74
  v_add_f32 v24, v24, v22
  v_fmac_f32 v25, v22, v22
  v_add_f32 v26, v26, v74
  v_fmac_f32 v27, v74, v74
  v_lshlrev_b32 v22, 16, v75
  v_and_b32 v75, 0xffff0000, v75
  v_add_f32 v24, v24, v22
  v_fmac_f32 v25, v22, v22
  v_add_f32 v26, v26, v75
  v_fmac_f32 v27, v75, v75
  s_waitcnt vmcnt(12)
  v_lshlrev_b32 v22, 16, v76
  v_and_b32 v76, 0xffff0000, v76
  v_add_f32 v24, v24, v22
  v_fmac_f32 v25, v22, v22
  v_add_f32 v26, v26, v76
  v_fmac_f32 v27, v76, v76
  v_lshlrev_b32 v22, 16, v77
  v_and_b32 v77, 0xffff0000, v77
  v_add_f32 v24, v24, v22
  v_fmac_f32 v25, v22, v22
  v_add_f32 v26, v26, v77
  v_fmac_f32 v27, v77, v77
  v_lshlrev_b32 v22, 16, v78
  v_and_b32 v78, 0xffff0000, v78
  v_add_f32 v24, v24, v22
  v_fmac_f32 v25, v22, v22
  v_add_f32 v26, v26, v78
  v_fmac_f32 v27, v78, v78
  v_lshlrev_b32 v22, 16, v79
  v_and_b32 v79, 0xffff0000, v79
  v_add_f32 v24, v24, v22
  v_fmac_f32 v25, v22, v22
  v_add_f32 v26, v26, v79
  v_fmac_f32 v27, v79, v79
  s_waitcnt vmcnt(11)
  v_lshlrev_b32 v22, 16, v80
  v_and_b32 v80, 0xffff0000, v80
  v_add_f32 v24, v24, v22
  v_fmac_f32 v25, v22, v22
  v_add_f32 v26, v26, v80
  v_fmac_f32 v27, v80, v80
  v_lshlrev_b32 v22, 16, v81
  v_and_b32 v81, 0xffff0000, v81
  v_add_f32 v24, v24, v22
  v_fmac_f32 v25, v22, v22
  v_add_f32 v26, v26, v81
  v_fmac_f32 v27, v81, v81
  v_lshlrev_b32 v22, 16, v82
  v_and_b32 v82, 0xffff0000, v82
  v_add_f32 v24, v24, v22
  v_fmac_f32 v25, v22, v22
  v_add_f32 v26, v26, v82
  v_fmac_f32 v27, v82, v82
  v_lshlrev_b32 v22, 16, v83
  v_and_b32 v83, 0xffff0000, v83
  v_add_f32 v24, v24, v22
  v_fmac_f32 v25, v22, v22
  v_add_f32 v26, v26, v83
  v_fmac_f32 v27, v83, v83
  s_waitcnt vmcnt(10)
  v_lshlrev_b32 v22, 16, v84
  v_and_b32 v84, 0xffff0000, v84
  v_add_f32 v24, v24, v22
  v_fmac_f32 v25, v22, v22
  v_add_f32 v26, v26, v84
  v_fmac_f32 v27, v84, v84
  v_lshlrev_b32 v22, 16, v85
  v_and_b32 v85, 0xffff0000, v85
  v_add_f32 v24, v24, v22
  v_fmac_f32 v25, v22, v22
  v_add_f32 v26, v26, v85
  v_fmac_f32 v27, v85, v85
  v_lshlrev_b32 v22, 16, v86
  v_and_b32 v86, 0xffff0000, v86
  v_add_f32 v24, v24, v22
  v_fmac_f32 v25, v22, v22
  v_add_f32 v26, v26, v86
  v_fmac_f32 v27, v86, v86
  v_lshlrev_b32 v22, 16, v87
  v_and_b32 v87, 0xffff0000, v87
  v_add_f32 v24, v24, v22
  v_fmac_f32 v25, v22, v22
  v_add_f32 v26, v26, v87
  v_fmac_f32 v27, v87, v87
  s_waitcnt vmcnt(9)
  v_lshlrev_b32 v22, 16, v88
  v_and_b32 v88, 0xffff0000, v88
  v_add_f32 v24, v24, v22
  v_fmac_f32 v25, v22, v22
  v_add_f32 v26, v26, v88
  v_fmac_f32 v27, v88, v88
  v_lshlrev_b32 v22, 16, v89
  v_and_b32 v89, 0xffff0000, v89
  v_add_f32 v24, v24, v22
  v_fmac_f32 v25, v22, v22
  v_add_f32 v26, v26, v89
  v_fmac_f32 v27, v89, v89
  v_lshlrev_b32 v22, 16, v90
  v_and_b32 v90, 0xffff0000, v90
  v_add_f32 v24, v24, v22
  v_fmac_f32 v25, v22, v22
  v_add_f32 v26, v26, v90
  v_fmac_f32 v27, v90, v90
  v_lshlrev_b32 v22, 16, v91
  v_and_b32 v91, 0xffff0000, v91
  v_add_f32 v24, v24, v22
  v_fmac_f32 v25, v22, v22
  v_add_f32 v26, v26, v91
  v_fmac_f32 v27, v91, v91
  s_waitcnt vmcnt(8)
  v_lshlrev_b32 v22, 16, v92
  v_and_b32 v92, 0xffff0000, v92
  v_add_f32 v24, v24, v22
  v_fmac_f32 v25, v22, v22
  v_add_f32 v26, v26, v92
  v_fmac_f32 v27, v92, v92
  v_lshlrev_b32 v22, 16, v93
  v_and_b32 v93, 0xffff0000, v93
  v_add_f32 v24, v24, v22
  v_fmac_f32 v25, v22, v22
  v_add_f32 v26, v26, v93
  v_fmac_f32 v27, v93, v93
  v_lshlrev_b32 v22, 16, v94
  v_and_b32 v94, 0xffff0000, v94
  v_add_f32 v24, v24, v22
  v_fmac_f32 v25, v22, v22
  v_add_f32 v26, v26, v94
  v_fmac_f32 v27, v94, v94
  v_lshlrev_b32 v22, 16, v95
  v_and_b32 v95, 0xffff0000, v95
  v_add_f32 v24, v24, v22
  v_fmac_f32 v25, v22, v22
  v_add_f32 v26, v26, v95
  v_fmac_f32 v27, v95, v95
  s_waitcnt vmcnt(7)
  v_lshlrev_b32 v22, 16, v96
  v_and_b32 v96, 0xffff0000, v96
  v_add_f32 v24, v24, v22
  v_fmac_f32 v25, v22, v22
  v_add_f32 v26, v26, v96
  v_fmac_f32 v27, v96, v96
  v_lshlrev_b32 v22, 16, v97
  v_and_b32 v97, 0xffff0000, v97
  v_add_f32 v24, v24, v22
  v_fmac_f32 v25, v22, v22
  v_add_f32 v26, v26, v97
  v_fmac_f32 v27, v97, v97
  v_lshlrev_b32 v22, 16, v98
  v_and_b32 v98, 0xffff0000, v98
  v_add_f32 v24, v24, v22
  v_fmac_f32 v25, v22, v22
  v_add_f32 v26, v26, v98
  v_fmac_f32 v27, v98, v98
  v_lshlrev_b32 v22, 16, v99
  v_and_b32 v99, 0xffff0000, v99
  v_add_f32 v24, v24, v22
  v_fmac_f32 v25, v22, v22
  v_add_f32 v26, v26, v99
  v_fmac_f32 v27, v99, v99
  s_waitcnt vmcnt(6)
  v_lshlrev_b32 v22, 16, v100
  v_and_b32 v100, 0xffff0000, v100
  v_add_f32 v24, v24, v22
  v_fmac_f32 v25, v22, v22
  v_add_f32 v26, v26, v100
  v_fmac_f32 v27, v100, v100
  v_lshlrev_b32 v22, 16, v101
  v_and_b32 v101, 0xffff0000, v101
  v_add_f32 v24, v24, v22
  v_fmac_f32 v25, v22, v22
  v_add_f32 v26, v26, v101
  v_fmac_f32 v27, v101, v101
  v_lshlrev_b32 v22, 16, v102
  v_and_b32 v102, 0xffff0000, v102
  v_add_f32 v24, v24, v22
  v_fmac_f32 v25, v22, v22
  v_add_f32 v26, v26, v102
  v_fmac_f32 v27, v102, v102
  v_lshlrev_b32 v22, 16, v103
  v_and_b32 v103, 0xffff0000, v103
  v_add_f32 v24, v24, v22
  v_fmac_f32 v25, v22, v22
  v_add_f32 v26, v26, v103
  v_fmac_f32 v27, v103, v103
  s_waitcnt vmcnt(5)
  v_lshlrev_b32 v22, 16, v104
  v_and_b32 v104, 0xffff0000, v104
  v_add_f32 v24, v24, v22
  v_fmac_f32 v25, v22, v22
  v_add_f32 v26, v26, v104
  v_fmac_f32 v27, v104, v104
  v_lshlrev_b32 v22, 16, v105
  v_and_b32 v105, 0xffff0000, v105
  v_add_f32 v24, v24, v22
  v_fmac_f32 v25, v22, v22
  v_add_f32 v26, v26, v105
  v_fmac_f32 v27, v105, v105
  v_lshlrev_b32 v22, 16, v106
  v_and_b32 v106, 0xffff0000, v106
  v_add_f32 v24, v24, v22
  v_fmac_f32 v25, v22, v22
  v_add_f32 v26, v26, v106
  v_fmac_f32 v27, v106, v106
  v_lshlrev_b32 v22, 16, v107
  v_and_b32 v107, 0xffff0000, v107
  v_add_f32 v24, v24, v22
  v_fmac_f32 v25, v22, v22
  v_add_f32 v26, v26, v107
  v_fmac_f32 v27, v107, v107
  s_waitcnt vmcnt(4)
  v_lshlrev_b32 v22, 16, v108
  v_and_b32 v108, 0xffff0000, v108
  v_add_f32 v24, v24, v22
  v_fmac_f32 v25, v22, v22
  v_add_f32 v26, v26, v108
  v_fmac_f32 v27, v108, v108
  v_lshlrev_b32 v22, 16, v109
  v_and_b32 v109, 0xffff0000, v109
  v_add_f32 v24, v24, v22
  v_fmac_f32 v25, v22, v22
  v_add_f32 v26, v26, v109
  v_fmac_f32 v27, v109, v109
  v_lshlrev_b32 v22, 16, v110
  v_and_b32 v110, 0xffff0000, v110
  v_add_f32 v24, v24, v22
  v_fmac_f32 v25, v22, v22
  v_add_f32 v26, v26, v110
  v_fmac_f32 v27, v110, v110
  v_lshlrev_b32 v22, 16, v111
  v_and_b32 v111, 0xffff0000, v111
  v_add_f32 v24, v24, v22
  v_fmac_f32 v25, v22, v22
  v_add_f32 v26, v26, v111
  v_fmac_f32 v27, v111, v111
  s_waitcnt vmcnt(3)
  v_lshlrev_b32 v22, 16, v112
  v_and_b32 v112, 0xffff0000, v112
  v_add_f32 v24, v24, v22
  v_fmac_f32 v25, v22, v22
  v_add_f32 v26, v26, v112
  v_fmac_f32 v27, v112, v112
  v_lshlrev_b32 v22, 16, v113
  v_and_b32 v113, 0xffff0000, v113
  v_add_f32 v24, v24, v22
  v_fmac_f32 v25, v22, v22
  v_add_f32 v26, v26, v113
  v_fmac_f32 v27, v113, v113
  v_lshlrev_b32 v22, 16, v114
  v_and_b32 v114, 0xffff0000, v114
  v_add_f32 v24, v24, v22
  v_fmac_f32 v25, v22, v22
  v_add_f32 v26, v26, v114
  v_fmac_f32 v27, v114, v114
  v_lshlrev_b32 v22, 16, v115
  v_and_b32 v115, 0xffff0000, v115
  v_add_f32 v24, v24, v22
  v_fmac_f32 v25, v22, v22
  v_add_f32 v26, v26, v115
  v_fmac_f32 v27, v115, v115
  s_waitcnt vmcnt(2)
  v_lshlrev_b32 v22, 16, v116
  v_and_b32 v116, 0xffff0000, v116
  v_add_f32 v24, v24, v22
  v_fmac_f32 v25, v22, v22
  v_add_f32 v26, v26, v116
  v_fmac_f32 v27, v116, v116
  v_lshlrev_b32 v22, 16, v117
  v_and_b32 v117, 0xffff0000, v117
  v_add_f32 v24, v24, v22
  v_fmac_f32 v25, v22, v22
  v_add_f32 v26, v26, v117
  v_fmac_f32 v27, v117, v117
  v_lshlrev_b32 v22, 16, v118
  v_and_b32 v118, 0xffff0000, v118
  v_add_f32 v24, v24, v22
  v_fmac_f32 v25, v22, v22
  v_add_f32 v26, v26, v118
  v_fmac_f32 v27, v118, v118
  v_lshlrev_b32 v22, 16, v119
  v_and_b32 v119, 0xffff0000, v119
  v_add_f32 v24, v24, v22
  v_fmac_f32 v25, v22, v22
  v_add_f32 v26, v26, v119
  v_fmac_f32 v27, v119, v119
  s_waitcnt vmcnt(1)
  v_lshlrev_b32 v22, 16, v120
  v_and_b32 v120, 0xffff0000, v120
  v_add_f32 v24, v24, v22
  v_fmac_f32 v25, v22, v22
  v_add_f32 v26, v26, v120
  v_fmac_f32 v27, v120, v120
  v_lshlrev_b32 v22, 16, v121
  v_and_b32 v121, 0xffff0000, v121
  v_add_f32 v24, v24, v22
  v_fmac_f32 v25, v22, v22
  v_add_f32 v26, v26, v121
  v_fmac_f32 v27, v121, v121
  v_lshlrev_b32 v22, 16, v122
  v_and_b32 v122, 0xffff0000, v122
  v_add_f32 v24, v24, v22
  v_fmac_f32 v25, v22, v22
  v_add_f32 v26, v26, v122
  v_fmac_f32 v27, v122, v122
  v_lshlrev_b32 v22, 16, v123
  v_and_b32 v123, 0xffff0000, v123
  v_add_f32 v24, v24, v22
  v_fmac_f32 v25, v22, v22
  v_add_f32 v26, v26, v123
  v_fmac_f32 v27, v123, v123
  s_waitcnt vmcnt(0)
  v_lshlrev_b32 v22, 16, v124
  v_and_b32 v124, 0xffff0000, v124
  v_add_f32 v24, v24, v22
  v_fmac_f32 v25, v22, v22
  v_add_f32 v26, v26, v124
  v_fmac_f32 v27, v124, v124
  v_lshlrev_b32 v22, 16, v125
  v_and_b32 v125, 0xffff0000, v125
  v_add_f32 v24, v24, v22
  v_fmac_f32 v25, v22, v22
  v_add_f32 v26, v26, v125
  v_fmac_f32 v27, v125, v125
  v_lshlrev_b32 v22, 16, v126
  v_and_b32 v126, 0xffff0000, v126
  v_add_f32 v24, v24, v22
  v_fmac_f32 v25, v22, v22
  v_add_f32 v26, v26, v126
  v_fmac_f32 v27, v126, v126
  v_lshlrev_b32 v22, 16, v127
  v_and_b32 v127, 0xffff0000, v127
  v_add_f32 v24, v24, v22
  v_fmac_f32 v25, v22, v22
  v_add_f32 v26, v26, v127
  v_fmac_f32 v27, v127, v127
  v_add_f32 v24, v24, v26
  v_add_f32 v25, v25, v27
  s_nop 0
  v_add_f32 v24, v24, v24 quad_perm:[1,0,3,2] row_mask:0xf bank_mask:0xf
  v_add_f32 v25, v25, v25 quad_perm:[1,0,3,2] row_mask:0xf bank_mask:0xf
  s_nop 0
  v_add_f32 v24, v24, v24 quad_perm:[2,3,0,1] row_mask:0xf bank_mask:0xf
  v_add_f32 v25, v25, v25 quad_perm:[2,3,0,1] row_mask:0xf bank_mask:0xf
  s_nop 0
  v_add_f32 v24, v24, v24 row_half_mirror row_mask:0xf bank_mask:0xf
  v_add_f32 v25, v25, v25 row_half_mirror row_mask:0xf bank_mask:0xf
  v_mov_b32 v26, 0.0009765625
  v_mul_f32 v24, v26, v24
  v_mul_f32 v27, v24, v24
  v_fma_f32 v25, v25, v26, -v27
  v_max_f32 v25, 0, v25
  v_add_f32 v25, 1e-05, v25
  v_rsq_f32 v25, v25
  v_lshlrev_b32 v20, 2, v20
  v_mul_f32 v24, v24, v25
  v_sub_f32 v24, 0, v24
  s_add_u32 s33, s33, 0x3070000
  s_add_u32 s34, s33, 0x2000
  s_mov_b32 exec_lo, 0x01010101
  s_mov_b32 exec_hi, 0x01010101
  buffer_store_dword v25, v20, s[4:7], s33 offen sc1
  buffer_store_dword v24, v20, s[4:7], s34 offen sc1
  s_mov_b64 exec, -1
  s_mov_b32 s12, s58
  s_mov_b32 s13, s59
  s_mov_b32 s14, 0x100
  s_mov_b32 s15, 0x00020000
  s_mov_b32 s38, 0
  s_mov_b64 exec, 1
.g2_kernel_gt6:
  buffer_load_dword v6, v4, s[12:15], 0 offen sc1
  s_add_u32 s38, s38, 1
  s_waitcnt vmcnt(0)
  v_cmp_eq_u32 vcc, 0x60, v6
  s_cbranch_vccnz .g2_kernel_gt6d
  s_sleep 8
  s_cmp_lt_u32 s38, 131072
  s_cbranch_scc1 .g2_kernel_gt6
.g2_kernel_gt6d:
  s_mov_b64 exec, -1
  v_mov_b32 v6, s70
  s_mov_b64 exec, 1
  buffer_store_dword v6, v4, s[4:7], s19 offen offset:12 sc1
  s_mov_b64 exec, -1
  v_mov_b32 v6, 155648
  s_mov_b32 s38, 0
.g2_kernel_wg7:
  ds_read_b32 v7, v6 offset:512
  s_add_u32 s38, s38, 1
  s_waitcnt lgkmcnt(0)
  v_cmp_gt_u32 vcc, 27, v7
  s_cbranch_vccz .g2_kernel_wg7d
  s_sleep 4
  s_cmp_lt_u32 s38, 524288
  s_cbranch_scc1 .g2_kernel_wg7
.g2_kernel_wg7d:
  s_and_b32 s31, s19, 0xffffe000
  s_add_u32 s31, s31, 12
  v_and_b32 v6, 15, v2
  v_lshlrev_b32 v6, 9, v6
  v_lshrrev_b32 v7, 4, v2
  v_lshl_add_u32 v6, v7, 7, v6
  v_lshlrev_b32 v7, 2, v2
  v_add_u32 v7, 157952, v7
  s_mov_b32 m0, 157952
  s_mov_b32 s38, 0
  s_bfm_b64 exec, 16, 0
.g2_kernel_pa8:
  buffer_load_dword v6, s[4:7], s31 offen sc1 lds
  s_add_u32 s38, s38, 1
  s_waitcnt vmcnt(0)
  ds_read_b32 v8, v7
  s_waitcnt lgkmcnt(0)
  v_cmp_ge_u32 vcc, s62, v8
  s_cbranch_vccz .g2_kernel_pa8d
  s_mov_b64 exec, vcc
  s_sleep 16
  s_cmp_lt_u32 s38, 131072
  s_cbranch_scc1 .g2_kernel_pa8
.g2_kernel_pa8d:
  s_mov_b64 exec, -1
  s_lshl_b32 s33, s17, 9
  s_add_u32 s33, s33, 0x3070000
  s_add_u32 s34, s33, 0x2000
  s_mov_b32 exec_hi, 0
  s_mov_b32 m0, 158464
  s_nop 0
  buffer_load_dwordx4 v3, s[4:7], s33 offen sc1 lds
  s_mov_b32 m0, 158976
  s_nop 0
  buffer_load_dwordx4 v3, s[4:7], s34 offen sc1 lds
  s_mov_b64 exec, -1
  v_mov_b32 v20, 1.0
  v_mov_b32 v21, 1.0
  v_mov_b32 v22, 0
  v_mov_b32 v23, 0
  v_lshlrev_b32 v24, 3, v2
  v_add_u32 v24, 155648, v24
  v_mov_b32 v6, 155648
  s_mov_b32 s38, 0
.g2_kernel_wg9:
  ds_read_b32 v7, v6 offset:512
  s_add_u32 s38, s38, 1
  s_waitcnt lgkmcnt(0)
  v_cmp_gt_u32 vcc, 32, v7
  s_cbranch_vccz .g2_kernel_wg9d
  s_sleep 2
  s_cmp_lt_u32 s38, 524288
  s_cbranch_scc1 .g2_kernel_wg9
.g2_kernel_wg9d:
  ds_write_b64 v24, v[20:21] offset:3840
  ds_write_b64 v24, v[22:23] offset:4352
  v_lshlrev_b32 v24, 2, v2
  v_add_u32 v24, 155648, v24
  ds_write_b32 v24, v4 offset:2304
  s_waitcnt vmcnt(0)
  v_mov_b32 v6, s71
  s_mov_b64 exec, 1
  ds_add_u32 v6, v5 offset:0
  s_mov_b64 exec, -1
  s_branch .g2_kernel_v
.g2_kernel_s2:
  s_mov_b32 s8, s42
  s_mov_b32 s9, s43
  s_mov_b32 s10, 0x600000
  s_mov_b32 s11, 0x00020000
  v_lshrrev_b32 v20, 3, v2
  v_and_b32 v21, 7, v2
  v_mul_u32_u24 v20, 6144, v20
  v_lshl_add_u32 v20, v21, 4, v20
  s_mul_i32 s30, s17, 393216
  s_lshl_b32 s31, s18, 7
  s_add_u32 s30, s30, s31
  s_add_u32 s31, s30, 4096
  s_barrier
  s_sleep 30
  buffer_load_dwordx4 v[64:67], v20, s[8:11], s30 offen
  buffer_load_dwordx4 v[68:71], v20, s[8:11], s30 offen offset:2048
  buffer_load_dwordx4 v[72:75], v20, s[8:11], s31 offen
  s_add_u32 s30, s30, 49152
  s_add_u32 s31, s31, 49152
  buffer_load_dwordx4 v[76:79], v20, s[8:11], s30 offen
  buffer_load_dwordx4 v[80:83], v20, s[8:11], s30 offen offset:2048
  buffer_load_dwordx4 v[84:87], v20, s[8:11], s31 offen
  s_add_u32 s30, s30, 49152
  s_add_u32 s31, s31, 49152
  buffer_load_dwordx4 v[88:91], v20, s[8:11], s30 offen
  buffer_load_dwordx4 v[92:95], v20, s[8:11], s30 offen offset:2048
  buffer_load_dwordx4 v[96:99], v20, s[8:11], s31 offen
  s_add_u32 s30, s30, 49152
  s_add_u32 s31, s31, 49152
  buffer_load_dwordx4 v[100:103], v20, s[8:11], s30 offen
  buffer_load_dwordx4 v[104:107], v20, s[8:11], s30 offen offset:2048
  buffer_load_dwordx4 v[108:111], v20, s[8:11], s31 offen
  s_add_u32 s30, s30, 49152
  s_add_u32 s31, s31, 49152
  buffer_load_dwordx4 v[112:115], v20, s[8:11], s30 offen
  buffer_load_dwordx4 v[116:119], v20, s[8:11], s30 offen offset:2048
  buffer_load_dwordx4 v[120:123], v20, s[8:11], s31 offen
  s_add_u32 s30, s30, 49152
  s_add_u32 s31, s31, 49152
  buffer_load_dwordx4 v[124:127], v20, s[8:11], s30 offen
  buffer_load_dwordx4 v[128:131], v20, s[8:11], s30 offen offset:2048
  buffer_load_dwordx4 v[132:135], v20, s[8:11], s31 offen
  s_add_u32 s30, s30, 49152
  s_add_u32 s31, s31, 49152
  buffer_load_dwordx4 v[136:139], v20, s[8:11], s30 offen
  buffer_load_dwordx4 v[140:143], v20, s[8:11], s30 offen offset:2048
  buffer_load_dwordx4 v[144:147], v20, s[8:11], s31 offen
  s_add_u32 s30, s30, 49152
  s_add_u32 s31, s31, 49152
  buffer_load_dwordx4 v[148:151], v20, s[8:11], s30 offen
  buffer_load_dwordx4 v[152:155], v20, s[8:11], s30 offen offset:2048
  buffer_load_dwordx4 v[156:159], v20, s[8:11], s31 offen
  s_add_u32 s30, s30, 49152
  s_add_u32 s31, s31, 49152
  v_lshlrev_b32 v21, 5, v21
  v_lshrrev_b32 v22, 5, v2
  v_lshl_add_u32 v21, v22, 4, v21
  v_bfe_u32 v22, v2, 4, 1
  v_lshl_add_u32 v21, v22, 3, v21
  s_lshl_b32 s30, s18, 4
  s_add_u32 s30, s30, s17
  s_mul_i32 s30, s30, 768
  s_add_u32 s30, s30, 0x3080000
  s_waitcnt vmcnt(23)
  v_lshlrev_b32 v160, 16, v64
  v_and_b32 v161, 0xffff0000, v64
  v_lshlrev_b32 v162, 16, v65
  v_and_b32 v163, 0xffff0000, v65
  v_lshlrev_b32 v164, 16, v66
  v_and_b32 v165, 0xffff0000, v66
  v_lshlrev_b32 v166, 16, v67
  v_and_b32 v167, 0xffff0000, v67
  s_waitcnt vmcnt(22)
  v_lshlrev_b32 v168, 16, v68
  v_and_b32 v169, 0xffff0000, v68
  v_lshlrev_b32 v170, 16, v69
  v_and_b32 v171, 0xffff0000, v69
  v_lshlrev_b32 v172, 16, v70
  v_and_b32 v173, 0xffff0000, v70
  v_lshlrev_b32 v174, 16, v71
  v_and_b32 v175, 0xffff0000, v71
  s_waitcnt vmcnt(21)
  v_lshlrev_b32 v176, 16, v72
  v_and_b32 v177, 0xffff0000, v72
  v_lshlrev_b32 v178, 16, v73
  v_and_b32 v179, 0xffff0000, v73
  v_lshlrev_b32 v180, 16, v74
  v_and_b32 v181, 0xffff0000, v74
  v_lshlrev_b32 v182, 16, v75
  v_and_b32 v183, 0xffff0000, v75
  s_waitcnt vmcnt(20)
  v_lshlrev_b32 v184, 16, v76
  v_and_b32 v185, 0xffff0000, v76
  v_lshlrev_b32 v186, 16, v77
  v_and_b32 v187, 0xffff0000, v77
  v_lshlrev_b32 v188, 16, v78
  v_and_b32 v189, 0xffff0000, v78
  v_lshlrev_b32 v190, 16, v79
  v_and_b32 v191, 0xffff0000, v79
  v_add_f32 v160, v160, v184
  v_add_f32 v161, v161, v185
  v_add_f32 v162, v162, v186
  v_add_f32 v163, v163, v187
  v_add_f32 v164, v164, v188
  v_add_f32 v165, v165, v189
  v_add_f32 v166, v166, v190
  v_add_f32 v167, v167, v191
  s_waitcnt vmcnt(19)
  v_lshlrev_b32 v184, 16, v80
  v_and_b32 v185, 0xffff0000, v80
  v_lshlrev_b32 v186, 16, v81
  v_and_b32 v187, 0xffff0000, v81
  v_lshlrev_b32 v188, 16, v82
  v_and_b32 v189, 0xffff0000, v82
  v_lshlrev_b32 v190, 16, v83
  v_and_b32 v191, 0xffff0000, v83
  v_add_f32 v168, v168, v184
  v_add_f32 v169, v169, v185
  v_add_f32 v170, v170, v186
  v_add_f32 v171, v171, v187
  v_add_f32 v172, v172, v188
  v_add_f32 v173, v173, v189
  v_add_f32 v174, v174, v190
  v_add_f32 v175, v175, v191
  s_waitcnt vmcnt(18)
  v_lshlrev_b32 v184, 16, v84
  v_and_b32 v185, 0xffff0000, v84
  v_lshlrev_b32 v186, 16, v85
  v_and_b32 v187, 0xffff0000, v85
  v_lshlrev_b32 v188, 16, v86
  v_and_b32 v189, 0xffff0000, v86
  v_lshlrev_b32 v190, 16, v87
  v_and_b32 v191, 0xffff0000, v87
  v_add_f32 v176, v176, v184
  v_add_f32 v177, v177, v185
  v_add_f32 v178, v178, v186
  v_add_f32 v179, v179, v187
  v_add_f32 v180, v180, v188
  v_add_f32 v181, v181, v189
  v_add_f32 v182, v182, v190
  v_add_f32 v183, v183, v191
  s_waitcnt vmcnt(17)
  v_lshlrev_b32 v184, 16, v88
  v_and_b32 v185, 0xffff0000, v88
  v_lshlrev_b32 v186, 16, v89
  v_and_b32 v187, 0xffff0000, v89
  v_lshlrev_b32 v188, 16, v90
  v_and_b32 v189, 0xffff0000, v90
  v_lshlrev_b32 v190, 16, v91
  v_and_b32 v191, 0xffff0000, v91
  v_add_f32 v160, v160, v184
  v_add_f32 v161, v161, v185
  v_add_f32 v162, v162, v186
  v_add_f32 v163, v163, v187
  v_add_f32 v164, v164, v188
  v_add_f32 v165, v165, v189
  v_add_f32 v166, v166, v190
  v_add_f32 v167, v167, v191
  s_waitcnt vmcnt(16)
  v_lshlrev_b32 v184, 16, v92
  v_and_b32 v185, 0xffff0000, v92
  v_lshlrev_b32 v186, 16, v93
  v_and_b32 v187, 0xffff0000, v93
  v_lshlrev_b32 v188, 16, v94
  v_and_b32 v189, 0xffff0000, v94
  v_lshlrev_b32 v190, 16, v95
  v_and_b32 v191, 0xffff0000, v95
  v_add_f32 v168, v168, v184
  v_add_f32 v169, v169, v185
  v_add_f32 v170, v170, v186
  v_add_f32 v171, v171, v187
  v_add_f32 v172, v172, v188
  v_add_f32 v173, v173, v189
  v_add_f32 v174, v174, v190
  v_add_f32 v175, v175, v191
  s_waitcnt vmcnt(15)
  v_lshlrev_b32 v184, 16, v96
  v_and_b32 v185, 0xffff0000, v96
  v_lshlrev_b32 v186, 16, v97
  v_and_b32 v187, 0xffff0000, v97
  v_lshlrev_b32 v188, 16, v98
  v_and_b32 v189, 0xffff0000, v98
  v_lshlrev_b32 v190, 16, v99
  v_and_b32 v191, 0xffff0000, v99
  v_add_f32 v176, v176, v184
  v_add_f32 v177, v177, v185
  v_add_f32 v178, v178, v186
  v_add_f32 v179, v179, v187
  v_add_f32 v180, v180, v188
  v_add_f32 v181, v181, v189
  v_add_f32 v182, v182, v190
  v_add_f32 v183, v183, v191
  s_waitcnt vmcnt(14)
  v_lshlrev_b32 v184, 16, v100
  v_and_b32 v185, 0xffff0000, v100
  v_lshlrev_b32 v186, 16, v101
  v_and_b32 v187, 0xffff0000, v101
  v_lshlrev_b32 v188, 16, v102
  v_and_b32 v189, 0xffff0000, v102
  v_lshlrev_b32 v190, 16, v103
  v_and_b32 v191, 0xffff0000, v103
  v_add_f32 v160, v160, v184
  v_add_f32 v161, v161, v185
  v_add_f32 v162, v162, v186
  v_add_f32 v163, v163, v187
  v_add_f32 v164, v164, v188
  v_add_f32 v165, v165, v189
  v_add_f32 v166, v166, v190
  v_add_f32 v167, v167, v191
  s_waitcnt vmcnt(13)
  v_lshlrev_b32 v184, 16, v104
  v_and_b32 v185, 0xffff0000, v104
  v_lshlrev_b32 v186, 16, v105
  v_and_b32 v187, 0xffff0000, v105
  v_lshlrev_b32 v188, 16, v106
  v_and_b32 v189, 0xffff0000, v106
  v_lshlrev_b32 v190, 16, v107
  v_and_b32 v191, 0xffff0000, v107
  v_add_f32 v168, v168, v184
  v_add_f32 v169, v169, v185
  v_add_f32 v170, v170, v186
  v_add_f32 v171, v171, v187
  v_add_f32 v172, v172, v188
  v_add_f32 v173, v173, v189
  v_add_f32 v174, v174, v190
  v_add_f32 v175, v175, v191
  s_waitcnt vmcnt(12)
  v_lshlrev_b32 v184, 16, v108
  v_and_b32 v185, 0xffff0000, v108
  v_lshlrev_b32 v186, 16, v109
  v_and_b32 v187, 0xffff0000, v109
  v_lshlrev_b32 v188, 16, v110
  v_and_b32 v189, 0xffff0000, v110
  v_lshlrev_b32 v190, 16, v111
  v_and_b32 v191, 0xffff0000, v111
  v_add_f32 v176, v176, v184
  v_add_f32 v177, v177, v185
  v_add_f32 v178, v178, v186
  v_add_f32 v179, v179, v187
  v_add_f32 v180, v180, v188
  v_add_f32 v181, v181, v189
  v_add_f32 v182, v182, v190
  v_add_f32 v183, v183, v191
  s_waitcnt vmcnt(11)
  v_lshlrev_b32 v184, 16, v112
  v_and_b32 v185, 0xffff0000, v112
  v_lshlrev_b32 v186, 16, v113
  v_and_b32 v187, 0xffff0000, v113
  v_lshlrev_b32 v188, 16, v114
  v_and_b32 v189, 0xffff0000, v114
  v_lshlrev_b32 v190, 16, v115
  v_and_b32 v191, 0xffff0000, v115
  v_add_f32 v160, v160, v184
  v_add_f32 v161, v161, v185
  v_add_f32 v162, v162, v186
  v_add_f32 v163, v163, v187
  v_add_f32 v164, v164, v188
  v_add_f32 v165, v165, v189
  v_add_f32 v166, v166, v190
  v_add_f32 v167, v167, v191
  s_waitcnt vmcnt(10)
  v_lshlrev_b32 v184, 16, v116
  v_and_b32 v185, 0xffff0000, v116
  v_lshlrev_b32 v186, 16, v117
  v_and_b32 v187, 0xffff0000, v117
  v_lshlrev_b32 v188, 16, v118
  v_and_b32 v189, 0xffff0000, v118
  v_lshlrev_b32 v190, 16, v119
  v_and_b32 v191, 0xffff0000, v119
  v_add_f32 v168, v168, v184
  v_add_f32 v169, v169, v185
  v_add_f32 v170, v170, v186
  v_add_f32 v171, v171, v187
  v_add_f32 v172, v172, v188
  v_add_f32 v173, v173, v189
  v_add_f32 v174, v174, v190
  v_add_f32 v175, v175, v191
  s_waitcnt vmcnt(9)
  v_lshlrev_b32 v184, 16, v120
  v_and_b32 v185, 0xffff0000, v120
  v_lshlrev_b32 v186, 16, v121
  v_and_b32 v187, 0xffff0000, v121
  v_lshlrev_b32 v188, 16, v122
  v_and_b32 v189, 0xffff0000, v122
  v_lshlrev_b32 v190, 16, v123
  v_and_b32 v191, 0xffff0000, v123
  v_add_f32 v176, v176, v184
  v_add_f32 v177, v177, v185
  v_add_f32 v178, v178, v186
  v_add_f32 v179, v179, v187
  v_add_f32 v180, v180, v188
  v_add_f32 v181, v181, v189
  v_add_f32 v182, v182, v190
  v_add_f32 v183, v183, v191
  s_waitcnt vmcnt(8)
  v_lshlrev_b32 v184, 16, v124
  v_and_b32 v185, 0xffff0000, v124
  v_lshlrev_b32 v186, 16, v125
  v_and_b32 v187, 0xffff0000, v125
  v_lshlrev_b32 v188, 16, v126
  v_and_b32 v189, 0xffff0000, v126
  v_lshlrev_b32 v190, 16, v127
  v_and_b32 v191, 0xffff0000, v127
  v_add_f32 v160, v160, v184
  v_add_f32 v161, v161, v185
  v_add_f32 v162, v162, v186
  v_add_f32 v163, v163, v187
  v_add_f32 v164, v164, v188
  v_add_f32 v165, v165, v189
  v_add_f32 v166, v166, v190
  v_add_f32 v167, v167, v191
  s_waitcnt vmcnt(7)
  v_lshlrev_b32 v184, 16, v128
  v_and_b32 v185, 0xffff0000, v128
  v_lshlrev_b32 v186, 16, v129
  v_and_b32 v187, 0xffff0000, v129
  v_lshlrev_b32 v188, 16, v130
  v_and_b32 v189, 0xffff0000, v130
  v_lshlrev_b32 v190, 16, v131
  v_and_b32 v191, 0xffff0000, v131
  v_add_f32 v168, v168, v184
  v_add_f32 v169, v169, v185
  v_add_f32 v170, v170, v186
  v_add_f32 v171, v171, v187
  v_add_f32 v172, v172, v188
  v_add_f32 v173, v173, v189
  v_add_f32 v174, v174, v190
  v_add_f32 v175, v175, v191
  s_waitcnt vmcnt(6)
  v_lshlrev_b32 v184, 16, v132
  v_and_b32 v185, 0xffff0000, v132
  v_lshlrev_b32 v186, 16, v133
  v_and_b32 v187, 0xffff0000, v133
  v_lshlrev_b32 v188, 16, v134
  v_and_b32 v189, 0xffff0000, v134
  v_lshlrev_b32 v190, 16, v135
  v_and_b32 v191, 0xffff0000, v135
  v_add_f32 v176, v176, v184
  v_add_f32 v177, v177, v185
  v_add_f32 v178, v178, v186
  v_add_f32 v179, v179, v187
  v_add_f32 v180, v180, v188
  v_add_f32 v181, v181, v189
  v_add_f32 v182, v182, v190
  v_add_f32 v183, v183, v191
  s_waitcnt vmcnt(5)
  v_lshlrev_b32 v184, 16, v136
  v_and_b32 v185, 0xffff0000, v136
  v_lshlrev_b32 v186, 16, v137
  v_and_b32 v187, 0xffff0000, v137
  v_lshlrev_b32 v188, 16, v138
  v_and_b32 v189, 0xffff0000, v138
  v_lshlrev_b32 v190, 16, v139
  v_and_b32 v191, 0xffff0000, v139
  v_add_f32 v160, v160, v184
  v_add_f32 v161, v161, v185
  v_add_f32 v162, v162, v186
  v_add_f32 v163, v163, v187
  v_add_f32 v164, v164, v188
  v_add_f32 v165, v165, v189
  v_add_f32 v166, v166, v190
  v_add_f32 v167, v167, v191
  s_waitcnt vmcnt(4)
  v_lshlrev_b32 v184, 16, v140
  v_and_b32 v185, 0xffff0000, v140
  v_lshlrev_b32 v186, 16, v141
  v_and_b32 v187, 0xffff0000, v141
  v_lshlrev_b32 v188, 16, v142
  v_and_b32 v189, 0xffff0000, v142
  v_lshlrev_b32 v190, 16, v143
  v_and_b32 v191, 0xffff0000, v143
  v_add_f32 v168, v168, v184
  v_add_f32 v169, v169, v185
  v_add_f32 v170, v170, v186
  v_add_f32 v171, v171, v187
  v_add_f32 v172, v172, v188
  v_add_f32 v173, v173, v189
  v_add_f32 v174, v174, v190
  v_add_f32 v175, v175, v191
  s_waitcnt vmcnt(3)
  v_lshlrev_b32 v184, 16, v144
  v_and_b32 v185, 0xffff0000, v144
  v_lshlrev_b32 v186, 16, v145
  v_and_b32 v187, 0xffff0000, v145
  v_lshlrev_b32 v188, 16, v146
  v_and_b32 v189, 0xffff0000, v146
  v_lshlrev_b32 v190, 16, v147
  v_and_b32 v191, 0xffff0000, v147
  v_add_f32 v176, v176, v184
  v_add_f32 v177, v177, v185
  v_add_f32 v178, v178, v186
  v_add_f32 v179, v179, v187
  v_add_f32 v180, v180, v188
  v_add_f32 v181, v181, v189
  v_add_f32 v182, v182, v190
  v_add_f32 v183, v183, v191
  s_waitcnt vmcnt(2)
  v_lshlrev_b32 v184, 16, v148
  v_and_b32 v185, 0xffff0000, v148
  v_lshlrev_b32 v186, 16, v149
  v_and_b32 v187, 0xffff0000, v149
  v_lshlrev_b32 v188, 16, v150
  v_and_b32 v189, 0xffff0000, v150
  v_lshlrev_b32 v190, 16, v151
  v_and_b32 v191, 0xffff0000, v151
  v_add_f32 v160, v160, v184
  v_add_f32 v161, v161, v185
  v_add_f32 v162, v162, v186
  v_add_f32 v163, v163, v187
  v_add_f32 v164, v164, v188
  v_add_f32 v165, v165, v189
  v_add_f32 v166, v166, v190
  v_add_f32 v167, v167, v191
  s_waitcnt vmcnt(1)
  v_lshlrev_b32 v184, 16, v152
  v_and_b32 v185, 0xffff0000, v152
  v_lshlrev_b32 v186, 16, v153
  v_and_b32 v187, 0xffff0000, v153
  v_lshlrev_b32 v188, 16, v154
  v_and_b32 v189, 0xffff0000, v154
  v_lshlrev_b32 v190, 16, v155
  v_and_b32 v191, 0xffff0000, v155
  v_add_f32 v168, v168, v184
  v_add_f32 v169, v169, v185
  v_add_f32 v170, v170, v186
  v_add_f32 v171, v171, v187
  v_add_f32 v172, v172, v188
  v_add_f32 v173, v173, v189
  v_add_f32 v174, v174, v190
  v_add_f32 v175, v175, v191
  s_waitcnt vmcnt(0)
  v_lshlrev_b32 v184, 16, v156
  v_and_b32 v185, 0xffff0000, v156
  v_lshlrev_b32 v186, 16, v157
  v_and_b32 v187, 0xffff0000, v157
  v_lshlrev_b32 v188, 16, v158
  v_and_b32 v189, 0xffff0000, v158
  v_lshlrev_b32 v190, 16, v159
  v_and_b32 v191, 0xffff0000, v159
  v_add_f32 v176, v176, v184
  v_add_f32 v177, v177, v185
  v_add_f32 v178, v178, v186
  v_add_f32 v179, v179, v187
  v_add_f32 v180, v180, v188
  v_add_f32 v181, v181, v189
  v_add_f32 v182, v182, v190
  v_add_f32 v183, v183, v191
  v_permlane32_swap_b32 v160, v164
  v_permlane32_swap_b32 v161, v165
  v_permlane32_swap_b32 v162, v166
  v_permlane32_swap_b32 v163, v167
  v_add_f32 v160, v160, v164
  v_add_f32 v161, v161, v165
  v_add_f32 v162, v162, v166
  v_add_f32 v163, v163, v167
  s_nop 0
  v_permlane16_swap_b32 v160, v162
  v_permlane16_swap_b32 v161, v163
  v_add_f32 v160, v160, v162
  v_add_f32 v161, v161, v163
  s_nop 0
  v_add_f32 v160, v160, v160 row_ror:8 row_mask:0xf bank_mask:0xf
  v_add_f32 v161, v161, v161 row_ror:8 row_mask:0xf bank_mask:0xf
  v_permlane32_swap_b32 v168, v172
  v_permlane32_swap_b32 v169, v173
  v_permlane32_swap_b32 v170, v174
  v_permlane32_swap_b32 v171, v175
  v_add_f32 v168, v168, v172
  v_add_f32 v169, v169, v173
  v_add_f32 v170, v170, v174
  v_add_f32 v171, v171, v175
  s_nop 0
  v_permlane16_swap_b32 v168, v170
  v_permlane16_swap_b32 v169, v171
  v_add_f32 v168, v168, v170
  v_add_f32 v169, v169, v171
  s_nop 0
  v_add_f32 v168, v168, v168 row_ror:8 row_mask:0xf bank_mask:0xf
  v_add_f32 v169, v169, v169 row_ror:8 row_mask:0xf bank_mask:0xf
  v_permlane32_swap_b32 v176, v180
  v_permlane32_swap_b32 v177, v181
  v_permlane32_swap_b32 v178, v182
  v_permlane32_swap_b32 v179, v183
  v_add_f32 v176, v176, v180
  v_add_f32 v177, v177, v181
  v_add_f32 v178, v178, v182
  v_add_f32 v179, v179, v183
  s_nop 0
  v_permlane16_swap_b32 v176, v178
  v_permlane16_swap_b32 v177, v179
  v_add_f32 v176, v176, v178
  v_add_f32 v177, v177, v179
  s_nop 0
  v_add_f32 v176, v176, v176 row_ror:8 row_mask:0xf bank_mask:0xf
  v_add_f32 v177, v177, v177 row_ror:8 row_mask:0xf bank_mask:0xf
  s_mov_b32 exec_lo, 0x00ff00ff
  s_mov_b32 exec_hi, 0x00ff00ff
  buffer_store_dwordx2 v[160:161], v21, s[4:7], s30 offen offset:0 sc1
  buffer_store_dwordx2 v[168:169], v21, s[4:7], s30 offen offset:256 sc1
  buffer_store_dwordx2 v[176:177], v21, s[4:7], s30 offen offset:512 sc1
  s_mov_b64 exec, -1
  s_mov_b32 s12, s58
  s_mov_b32 s13, s59
  s_mov_b32 s14, 0x100
  s_mov_b32 s15, 0x00020000
  s_mov_b32 s38, 0
  s_mov_b64 exec, 1
.g2_kernel_gt10:
  buffer_load_dword v6, v4, s[12:15], 0 offen sc1
  s_add_u32 s38, s38, 1
  s_waitcnt vmcnt(0)
  v_cmp_eq_u32 vcc, 0x60, v6
  s_cbranch_vccnz .g2_kernel_gt10d
  s_sleep 8
  s_cmp_lt_u32 s38, 131072
  s_cbranch_scc1 .g2_kernel_gt10
.g2_kernel_gt10d:
  s_mov_b64 exec, -1
  v_mov_b32 v6, s70
  s_mov_b64 exec, 1
  buffer_store_dword v6, v4, s[4:7], s76 offen offset:4 sc1
  s_mov_b64 exec, -1
  v_mov_b32 v6, 155648
  s_mov_b32 s38, 0
.g2_kernel_wg11:
  ds_read_b32 v7, v6 offset:512
  s_add_u32 s38, s38, 1
  s_waitcnt lgkmcnt(0)
  v_cmp_gt_u32 vcc, 27, v7
  s_cbranch_vccz .g2_kernel_wg11d
  s_sleep 4
  s_cmp_lt_u32 s38, 524288
  s_cbranch_scc1 .g2_kernel_wg11
.g2_kernel_wg11d:
  s_and_b32 s31, s76, 0xffffe000
  s_add_u32 s31, s31, 4
  v_and_b32 v6, 15, v2
  v_lshlrev_b32 v6, 9, v6
  v_lshrrev_b32 v7, 4, v2
  v_lshl_add_u32 v6, v7, 7, v6
  v_lshlrev_b32 v7, 2, v2
  v_add_u32 v7, 157696, v7
  s_mov_b32 m0, 157696
  s_mov_b32 s38, 0
  s_bfm_b64 exec, 16, 0
.g2_kernel_pa12:
  buffer_load_dword v6, s[4:7], s31 offen sc1 lds
  s_add_u32 s38, s38, 1
  s_waitcnt vmcnt(0)
  ds_read_b32 v8, v7
  s_waitcnt lgkmcnt(0)
  v_cmp_ge_u32 vcc, s62, v8
  s_cbranch_vccz .g2_kernel_pa12d
  s_mov_b64 exec, vcc
  s_sleep 16
  s_cmp_lt_u32 s38, 131072
  s_cbranch_scc1 .g2_kernel_pa12
.g2_kernel_pa12d:
  s_mov_b64 exec, -1
  s_mul_i32 s30, s18, 12288
  s_add_u32 s30, s30, 0x3080000
  s_mov_b32 exec_hi, 0xffff
  buffer_load_dwordx4 v[64:67], v3, s[4:7], s30 offen offset:0 sc1
  buffer_load_dwordx4 v[68:71], v3, s[4:7], s30 offen offset:768 sc1
  buffer_load_dwordx4 v[72:75], v3, s[4:7], s30 offen offset:1536 sc1
  buffer_load_dwordx4 v[76:79], v3, s[4:7], s30 offen offset:2304 sc1
  s_add_u32 s30, s30, 3072
  buffer_load_dwordx4 v[80:83], v3, s[4:7], s30 offen offset:0 sc1
  buffer_load_dwordx4 v[84:87], v3, s[4:7], s30 offen offset:768 sc1
  buffer_load_dwordx4 v[88:91], v3, s[4:7], s30 offen offset:1536 sc1
  buffer_load_dwordx4 v[92:95], v3, s[4:7], s30 offen offset:2304 sc1
  s_add_u32 s30, s30, 3072
  buffer_load_dwordx4 v[96:99], v3, s[4:7], s30 offen offset:0 sc1
  buffer_load_dwordx4 v[100:103], v3, s[4:7], s30 offen offset:768 sc1
  buffer_load_dwordx4 v[104:107], v3, s[4:7], s30 offen offset:1536 sc1
  buffer_load_dwordx4 v[108:111], v3, s[4:7], s30 offen offset:2304 sc1
  s_add_u32 s30, s30, 3072
  buffer_load_dwordx4 v[112:115], v3, s[4:7], s30 offen offset:0 sc1
  buffer_load_dwordx4 v[116:119], v3, s[4:7], s30 offen offset:768 sc1
  buffer_load_dwordx4 v[120:123], v3, s[4:7], s30 offen offset:1536 sc1
  buffer_load_dwordx4 v[124:127], v3, s[4:7], s30 offen offset:2304 sc1
  s_add_u32 s30, s30, 3072
  s_waitcnt vmcnt(14)
  v_add_f32 v64, v64, v68
  v_add_f32 v65, v65, v69
  v_add_f32 v66, v66, v70
  v_add_f32 v67, v67, v71
  s_waitcnt vmcnt(13)
  v_add_f32 v64, v64, v72
  v_add_f32 v65, v65, v73
  v_add_f32 v66, v66, v74
  v_add_f32 v67, v67, v75
  s_waitcnt vmcnt(12)
  v_add_f32 v64, v64, v76
  v_add_f32 v65, v65, v77
  v_add_f32 v66, v66, v78
  v_add_f32 v67, v67, v79
  s_waitcnt vmcnt(11)
  v_add_f32 v64, v64, v80
  v_add_f32 v65, v65, v81
  v_add_f32 v66, v66, v82
  v_add_f32 v67, v67, v83
  s_waitcnt vmcnt(10)
  v_add_f32 v64, v64, v84
  v_add_f32 v65, v65, v85
  v_add_f32 v66, v66, v86
  v_add_f32 v67, v67, v87
  s_waitcnt vmcnt(9)
  v_add_f32 v64, v64, v88
  v_add_f32 v65, v65, v89
  v_add_f32 v66, v66, v90
  v_add_f32 v67, v67, v91
  s_waitcnt vmcnt(8)
  v_add_f32 v64, v64, v92
  v_add_f32 v65, v65, v93
  v_add_f32 v66, v66, v94
  v_add_f32 v67, v67, v95
  s_waitcnt vmcnt(7)
  v_add_f32 v64, v64, v96
  v_add_f32 v65, v65, v97
  v_add_f32 v66, v66, v98
  v_add_f32 v67, v67, v99
  s_waitcnt vmcnt(6)
  v_add_f32 v64, v64, v100
  v_add_f32 v65, v65, v101
  v_add_f32 v66, v66, v102
  v_add_f32 v67, v67, v103
  s_waitcnt vmcnt(5)
  v_add_f32 v64, v64, v104
  v_add_f32 v65, v65, v105
  v_add_f32 v66, v66, v106
  v_add_f32 v67, v67, v107
  s_waitcnt vmcnt(4)
  v_add_f32 v64, v64, v108
  v_add_f32 v65, v65, v109
  v_add_f32 v66, v66, v110
  v_add_f32 v67, v67, v111
  s_waitcnt vmcnt(3)
  v_add_f32 v64, v64, v112
  v_add_f32 v65, v65, v113
  v_add_f32 v66, v66, v114
  v_add_f32 v67, v67, v115
  s_waitcnt vmcnt(2)
  v_add_f32 v64, v64, v116
  v_add_f32 v65, v65, v117
  v_add_f32 v66, v66, v118
  v_add_f32 v67, v67, v119
  s_waitcnt vmcnt(1)
  v_add_f32 v64, v64, v120
  v_add_f32 v65, v65, v121
  v_add_f32 v66, v66, v122
  v_add_f32 v67, v67, v123
  s_waitcnt vmcnt(0)
  v_add_f32 v64, v64, v124
  v_add_f32 v65, v65, v125
  v_add_f32 v66, v66, v126
  v_add_f32 v67, v67, v127
  s_mov_b64 exec, -1
  v_mov_b32 v6, 155648
  s_mov_b32 s38, 0
.g2_kernel_wg13:
  ds_read_b32 v7, v6 offset:512
  s_add_u32 s38, s38, 1
  s_waitcnt lgkmcnt(0)
  v_cmp_gt_u32 vcc, 32, v7
  s_cbranch_vccz .g2_kernel_wg13d
  s_sleep 2
  s_cmp_lt_u32 s38, 524288
  s_cbranch_scc1 .g2_kernel_wg13
.g2_kernel_wg13d:
  v_lshlrev_b32 v24, 2, v2
  v_add_u32 v24, 155648, v24
  ds_write_b32 v24, v4 offset:2048
  v_add_u32 v24, 155648, v3
  s_mov_b32 exec_hi, 0xffff
  ds_write_b128 v24, v[64:67] offset:4864
  s_mov_b64 exec, -1
  v_mov_b32 v6, s71
  s_mov_b64 exec, 1
  ds_add_u32 v6, v5 offset:0
  s_mov_b64 exec, -1
  s_branch .g2_kernel_v
.g2_kernel_s3:
  s_mov_b32 s12, s58
  s_mov_b32 s13, s59
  s_mov_b32 s14, 0x100
  s_mov_b32 s15, 0x00020000
  s_mov_b32 s20, s48
  s_mov_b32 s21, s49
  s_mov_b32 s22, 0x800
  s_mov_b32 s23, 0x00020000
  v_mov_b32 v12, 0
  v_mov_b32 v13, 0
  v_mov_b32 v14, 0
  v_mov_b32 v15, 0
  s_cmp_ge_u32 s2, 96
  s_cbranch_scc1 .g2_kernel_zm14
  s_lshl_b32 s36, s2, 12
  s_add_u32 s36, s36, 0x3000000
  buffer_store_dwordx4 v[12:15], v3, s[4:7], s36 offen sc1
  buffer_store_dwordx4 v[12:15], v3, s[4:7], s36 offen offset:1024 sc1
  buffer_store_dwordx4 v[12:15], v3, s[4:7], s36 offen offset:2048 sc1
  buffer_store_dwordx4 v[12:15], v3, s[4:7], s36 offen offset:3072 sc1
.g2_kernel_zm14:
  s_barrier
  s_cbranch_scc1 .g2_kernel_zm14b
  s_mov_b64 exec, 1
  s_waitcnt vmcnt(0)
  buffer_atomic_add v5, v4, s[12:15], 0 offen sc1
  s_mov_b64 exec, -1
.g2_kernel_zm14b:
  s_and_b32 s36, s18, 7
  s_cmp_ge_u32 s36, 3
  s_cbranch_scc1 .g2_kernel_c315
  s_mov_b32 s24, s42
  s_mov_b32 s25, s43
  s_mov_b32 s26, 0x600000
  s_mov_b32 s27, 0x00020000
  v_mul_u32_u24 v7, 6144, v2
  s_lshl_b32 s36, s36, 11
  s_or_b32 s37, s18, 3
  s_lshl_b32 s37, s37, 7
  s_add_u32 s36, s36, s37
  s_and_b32 s37, s17, 7
  s_mul_i32 s37, s37, 393216
  s_add_u32 s36, s36, s37
  s_add_u32 s37, s36, 3145728
  s_sleep 0
  buffer_load_dword v1, v7, s[24:27], s36 offen
  s_sleep 30
  buffer_load_dword v1, v7, s[24:27], s37 offen
.g2_kernel_c315:
  v_lshlrev_b32 v20, 5, v2
  buffer_load_dwordx4 v[24:27], v20, s[20:23], 0 offen
  buffer_load_dwordx4 v[28:31], v20, s[20:23], 0 offen offset:16
  v_mov_b32 v20, 0
  s_waitcnt vmcnt(0)
  v_lshlrev_b32 v21, 16, v24
  v_and_b32 v22, 0xffff0000, v24
  v_add_f32 v20, v20, v21
  v_add_f32 v20, v20, v22
  v_lshlrev_b32 v21, 16, v25
  v_and_b32 v22, 0xffff0000, v25
  v_add_f32 v20, v20, v21
  v_add_f32 v20, v20, v22
  v_lshlrev_b32 v21, 16, v26
  v_and_b32 v22, 0xffff0000, v26
  v_add_f32 v20, v20, v21
  v_add_f32 v20, v20, v22
  v_lshlrev_b32 v21, 16, v27
  v_and_b32 v22, 0xffff0000, v27
  v_add_f32 v20, v20, v21
  v_add_f32 v20, v20, v22
  v_lshlrev_b32 v21, 16, v28
  v_and_b32 v22, 0xffff0000, v28
  v_add_f32 v20, v20, v21
  v_add_f32 v20, v20, v22
  v_lshlrev_b32 v21, 16, v29
  v_and_b32 v22, 0xffff0000, v29
  v_add_f32 v20, v20, v21
  v_add_f32 v20, v20, v22
  v_lshlrev_b32 v21, 16, v30
  v_and_b32 v22, 0xffff0000, v30
  v_add_f32 v20, v20, v21
  v_add_f32 v20, v20, v22
  v_lshlrev_b32 v21, 16, v31
  v_and_b32 v22, 0xffff0000, v31
  v_add_f32 v20, v20, v21
  v_add_f32 v20, v20, v22
  s_nop 1
  v_add_f32 v20, v20, v20 quad_perm:[1,0,3,2] row_mask:0xf bank_mask:0xf
  s_nop 1
  v_add_f32 v20, v20, v20 quad_perm:[2,3,0,1] row_mask:0xf bank_mask:0xf
  s_nop 1
  v_add_f32 v20, v20, v20 row_half_mirror row_mask:0xf bank_mask:0xf
  s_nop 1
  v_add_f32 v20, v20, v20 row_mirror row_mask:0xf bank_mask:0xf
  s_nop 0
  v_readlane_b32 s20, v20, 16
  v_readlane_b32 s21, v20, 32
  v_readlane_b32 s22, v20, 48
  v_add_f32 v20, s20, v20
  v_add_f32 v20, s21, v20
  v_add_f32 v20, s22, v20
  v_mul_f32 v20, 0x3a800000, v20
  v_mov_b32 v6, 155648
  s_mov_b32 s38, 0
.g2_kernel_wg16:
  ds_read_b32 v7, v6 offset:512
  s_add_u32 s38, s38, 1
  s_waitcnt lgkmcnt(0)
  v_cmp_gt_u32 vcc, 32, v7
  s_cbranch_vccz .g2_kernel_wg16d
  s_sleep 2
  s_cmp_lt_u32 s38, 524288
  s_cbranch_scc1 .g2_kernel_wg16
.g2_kernel_wg16d:
  v_mov_b32 v21, 155648
  s_mov_b64 exec, 1
  ds_write_b32 v21, v20 offset:256
  s_mov_b64 exec, -1
.g2_kernel_v:
  s_setprio 3
  s_cmp_lg_u32 s16, 4
  s_cbranch_scc1 .g2_kernel_v_1
  v_mov_b32 v6, s71
  s_mov_b32 s38, 0
.g2_kernel_wg17:
  ds_read_b32 v7, v6 offset:4
  s_add_u32 s38, s38, 1
  s_waitcnt lgkmcnt(0)
  v_cmp_gt_u32 vcc, 4, v7
  s_cbranch_vccz .g2_kernel_wg17d
  s_sleep 1
  s_cmp_lt_u32 s38, 524288
  s_cbranch_scc1 .g2_kernel_wg17
.g2_kernel_wg17d:
  s_sleep 2
  s_and_b32 s31, s76, 0xffffe000
  s_add_u32 s31, s31, 0
  v_and_b32 v6, 15, v2
  v_lshlrev_b32 v6, 9, v6
  v_lshrrev_b32 v7, 4, v2
  v_lshl_add_u32 v6, v7, 7, v6
  v_lshlrev_b32 v7, 2, v2
  v_add_u32 v7, 157440, v7
  s_mov_b32 m0, 157440
  s_mov_b32 s38, 0
  s_mov_b32 exec_lo, 0xffff
  s_mov_b32 exec_hi, 0xffff
.g2_kernel_pa18:
  buffer_load_dword v6, s[4:7], s31 offen sc1 lds
  s_add_u32 s38, s38, 1
  s_waitcnt vmcnt(0)
  ds_read_b32 v8, v7
  s_waitcnt lgkmcnt(0)
  v_cmp_ge_u32 vcc, s62, v8
  s_cbranch_vccz .g2_kernel_pa18d
  s_mov_b64 exec, vcc
  s_sleep 2
  s_cmp_lt_u32 s38, 131072
  s_cbranch_scc1 .g2_kernel_pa18
.g2_kernel_pa18d:
  s_mov_b64 exec, -1
  v_mov_b32 v6, s71
  s_mov_b64 exec, 1
  ds_add_u32 v6, v5 offset:80
  s_mov_b64 exec, -1
.g2_kernel_v_1:
  s_cmp_lt_u32 s16, 6
  s_cbranch_scc1 .g2_kernel_v_2
  v_mov_b32 v6, s71
  s_mov_b32 s38, 0
.g2_kernel_wg19:
  ds_read_b32 v7, v6 offset:4
  s_add_u32 s38, s38, 1
  s_waitcnt lgkmcnt(0)
  v_cmp_gt_u32 vcc, 4, v7
  s_cbranch_vccz .g2_kernel_wg19d
  s_sleep 4
  s_cmp_lt_u32 s38, 524288
  s_cbranch_scc1 .g2_kernel_wg19
.g2_kernel_wg19d:
  s_and_b32 s28, s16, 1
  s_lshl_b32 s30, s28, 13
  s_add_u32 s31, s30, 16384
  v_add_u32 v8, s31, v3
  ds_read_b32 v9, v6 offset:24
  ds_read_b128 v[16:19], v8 offset:0
  ds_read_b128 v[20:23], v8 offset:1024
  ds_read_b128 v[24:27], v8 offset:2048
  ds_read_b128 v[28:31], v8 offset:3072
  ds_read_b128 v[32:35], v8 offset:4096
  ds_read_b128 v[36:39], v8 offset:5120
  ds_read_b128 v[40:43], v8 offset:6144
  ds_read_b128 v[44:47], v8 offset:7168
  s_lshl_b32 s31, s18, 5
  s_add_u32 s31, s31, s17
  s_add_u32 s31, s31, 16
  s_lshl_b32 s31, s31, 14
  s_add_u32 s30, s30, s31
  s_add_u32 s30, s30, s63
  s_add_u32 s31, s30, 4096
  s_lshl_b32 s33, s28, 8
  s_add_u32 s33, s33, 128
  s_waitcnt lgkmcnt(0)
  v_readfirstlane_b32 s29, v9
  v_mov_b32 v6, s71
  s_mov_b64 exec, 1
  ds_add_u32 v6, v5 offset:8
  s_mov_b64 exec, -1
  s_sleep 40
  buffer_store_dwordx4 v[16:19], v3, s[4:7], s30 offen offset:0 sc1
  s_sleep 4
  buffer_store_dwordx4 v[20:23], v3, s[4:7], s30 offen offset:1024 sc1
  s_sleep 4
  buffer_store_dwordx4 v[24:27], v3, s[4:7], s30 offen offset:2048 sc1
  s_sleep 4
  buffer_store_dwordx4 v[28:31], v3, s[4:7], s30 offen offset:3072 sc1
  s_sleep 4
  buffer_store_dwordx4 v[32:35], v3, s[4:7], s31 offen offset:0 sc1
  s_sleep 4
  buffer_store_dwordx4 v[36:39], v3, s[4:7], s31 offen offset:1024 sc1
  s_sleep 4
  buffer_store_dwordx4 v[40:43], v3, s[4:7], s31 offen offset:2048 sc1
  s_sleep 4
  buffer_store_dwordx4 v[44:47], v3, s[4:7], s31 offen offset:3072 sc1
  s_sleep 4
  s_sub_u32 s29, s29, 1
  s_lshr_b32 s29, s29, 6
  s_waitcnt vmcnt(0)
  s_cmp_eq_u32 s29, s28
  s_cbranch_scc1 .g2_kernel_v_1h
  s_add_u32 s31, s76, s33
  v_mov_b32 v6, s70
  s_mov_b64 exec, 1
  buffer_store_dword v6, v4, s[4:7], s31 offen offset:0 sc1
  s_mov_b64 exec, -1
  s_branch .g2_kernel_v_2
.g2_kernel_v_1h:
  v_mov_b32 v6, s71
  s_mov_b64 exec, 1
  ds_add_u32 v6, v5 offset:56
  s_mov_b64 exec, -1
.g2_kernel_v_2:
  v_mov_b32 v6, s71
  s_mov_b32 s38, 0
.g2_kernel_wg20:
  ds_read_b32 v7, v6 offset:80
  s_add_u32 s38, s38, 1
  s_waitcnt lgkmcnt(0)
  v_cmp_gt_u32 vcc, 1, v7
  s_cbranch_vccz .g2_kernel_wg20d
  s_sleep 8
  s_cmp_lt_u32 s38, 524288
  s_cbranch_scc1 .g2_kernel_wg20
.g2_kernel_wg20d:
  s_sleep 20
  s_mov_b32 s39, 0
  v_mov_b32 v12, 0
  v_mov_b32 v13, 0
  v_mov_b32 v14, 0
  v_mov_b32 v15, 0
  s_lshl_b32 s30, s17, 2
  s_and_b32 s31, s16, 3
  s_add_u32 s30, s30, s31
  s_lshl_b32 s30, s30, 4
  s_add_u32 s30, s30, s18
  s_lshl_b32 s30, s30, 9
  s_add_u32 s30, s30, s63
  s_add_u32 s30, s30, 0x1000000
  s_mov_b32 exec_hi, 0
  s_sleep 6
  buffer_store_dwordx4 v[12:15], v3, s[4:7], s30 offen sc1
  s_mov_b64 exec, -1
  s_lshl_b32 s30, s17, 2
  s_add_u32 s30, s30, s31
  s_lshl_b32 s30, s30, 5
  s_add_u32 s30, s30, s18
  s_lshl_b32 s30, s30, 11
  s_add_u32 s30, s30, s63
  s_add_u32 s30, s30, 0x808000
  s_sleep 6
  buffer_store_dwordx4 v[12:15], v3, s[4:7], s30 offen sc1
  s_sleep 6
  buffer_store_dwordx4 v[12:15], v3, s[4:7], s30 offen offset:1024 sc1
  s_cmp_lg_u32 s62, 5
  s_cbranch_scc1 .g2_kernel_zs21k
  s_lshl_b32 s30, s18, 4
  s_add_u32 s30, s30, s17
  s_lshl_b32 s30, s30, 2
  s_add_u32 s30, s30, s31
  s_lshl_b32 s30, s30, 12
  s_add_u32 s30, s30, 0x2c00000
  s_sleep 6
  buffer_store_dwordx4 v[12:15], v3, s[4:7], s30 offen sc1
  s_sleep 6
  buffer_store_dwordx4 v[12:15], v3, s[4:7], s30 offen offset:1024 sc1
  s_sleep 6
  buffer_store_dwordx4 v[12:15], v3, s[4:7], s30 offen offset:2048 sc1
  s_sleep 6
  buffer_store_dwordx4 v[12:15], v3, s[4:7], s30 offen offset:3072 sc1
.g2_kernel_zs21k:
  s_lshl_b32 s30, s17, 4
  s_add_u32 s30, s30, s18
  s_cmp_gt_u32 s16, 5
  s_cbranch_scc1 .g2_kernel_zs21
  s_cmp_eq_u32 s16, 5
  s_cbranch_scc1 .g2_kernel_zs21a
  s_cmp_lg_u32 s62, 0
  s_cbranch_scc1 .g2_kernel_zs21
  s_lshl_b32 s30, s30, 12
  s_add_u32 s31, s30, 0x1090000
  s_sleep 6
  buffer_store_dwordx4 v[12:15], v3, s[4:7], s31 offen offset:0 sc1
  s_sleep 6
  buffer_store_dwordx4 v[12:15], v3, s[4:7], s31 offen offset:1024 sc1
  s_sleep 6
  buffer_store_dwordx4 v[12:15], v3, s[4:7], s31 offen offset:2048 sc1
  s_sleep 6
  buffer_store_dwordx4 v[12:15], v3, s[4:7], s31 offen offset:3072 sc1
  s_add_u32 s31, s30, 0x2890000
  s_sleep 6
  buffer_store_dwordx4 v[12:15], v3, s[4:7], s31 offen offset:0 sc1
  s_sleep 6
  buffer_store_dwordx4 v[12:15], v3, s[4:7], s31 offen offset:1024 sc1
  s_sleep 6
  buffer_store_dwordx4 v[12:15], v3, s[4:7], s31 offen offset:2048 sc1
  s_sleep 6
  buffer_store_dwordx4 v[12:15], v3, s[4:7], s31 offen offset:3072 sc1
  s_add_u32 s31, s30, 0x2b00000
  s_sleep 6
  buffer_store_dwordx4 v[12:15], v3, s[4:7], s31 offen offset:0 sc1
  s_sleep 6
  buffer_store_dwordx4 v[12:15], v3, s[4:7], s31 offen offset:1024 sc1
  s_sleep 6
  buffer_store_dwordx4 v[12:15], v3, s[4:7], s31 offen offset:2048 sc1
  s_sleep 6
  buffer_store_dwordx4 v[12:15], v3, s[4:7], s31 offen offset:3072 sc1
  s_branch .g2_kernel_zs21
.g2_kernel_zs21a:
  s_xor_b32 s31, s17, s18
  s_and_b32 s31, s31, 3
  s_cbranch_scc1 .g2_kernel_zs21b
  s_lshr_b32 s30, s30, 2
  s_lshl_b32 s30, s30, 8
  s_add_u32 s30, s30, s63
  s_add_u32 s30, s30, 0x1080000
  s_mov_b64 exec, 0xffff
  s_sleep 6
  buffer_store_dwordx4 v[12:15], v3, s[4:7], s30 offen sc1
  s_mov_b64 exec, -1
.g2_kernel_zs21b:
  s_and_b32 s30, s18, 14
  s_lshl_b32 s30, s30, 4
  s_add_u32 s30, s30, s17
  s_lshl_b32 s30, s30, 1
  s_and_b32 s31, s18, 1
  s_add_u32 s30, s30, s31
  s_lshl_b32 s30, s30, 10
  s_add_u32 s30, s30, s63
  s_add_u32 s30, s30, 0x1190000
  s_add_u32 s31, s30, 32768
  s_sleep 6
  buffer_store_dwordx4 v[12:15], v3, s[4:7], s30 offen sc1
  s_sleep 6
  buffer_store_dwordx4 v[12:15], v3, s[4:7], s31 offen sc1
.g2_kernel_zs21:
  s_cmp_eq_u32 s16, 4
  s_cbranch_scc1 .g2_kernel_v_3a
  s_cmp_lg_u32 s62, 0
  s_cbranch_scc1 .g2_kernel_g_e
  s_and_b32 s22, s16, 3
  s_lshl_b32 s22, s22, 14
  s_cmp_eq_u32 s16, 5
  s_cselect_b32 s28, 65536, 0
  s_add_u32 s22, s22, s28
  v_bfe_u32 v8, v2, 2, 2
  v_lshrrev_b32 v9, 4, v2
  v_and_b32 v10, 3, v2
  v_lshlrev_b32 v10, 3, v10
  v_add_u32 v10, s22, v10
  s_cmp_eq_u32 s16, 5
  s_cbranch_scc1 .g2_kernel_g_p
  s_cmp_ge_u32 s17, 14
  s_cbranch_scc1 .g2_kernel_g_e
  v_lshrrev_b32 v6, 1, v2
  v_mul_u32_u24 v6, 7168, v6
  v_and_b32 v7, 1, v2
  v_lshl_add_u32 v250, v7, 4, v6
  v_lshl_add_u32 v11, v9, 3, v8
  v_lshl_add_u32 v251, v11, 5, v10
  v_and_b32 v11, 1, v9
  v_lshl_add_u32 v11, v11, 3, v8
  v_lshl_add_u32 v11, v11, 10, v10
  v_lshrrev_b32 v7, 1, v9
  v_lshl_add_u32 v252, v7, 7, v11
  s_lshl_b32 s24, s17, 4
  s_add_u32 s24, s24, s18
  s_and_b32 s25, s16, 1
  s_mov_b32 s12, s50
  s_mov_b32 s13, s51
  s_mov_b32 s14, 0x700000
  s_mov_b32 s15, 0x00020000
  s_mul_i32 s20, s25, 3670016
  s_lshl_b32 s31, s24, 5
  s_add_u32 s20, s20, s31
  s_lshl_b32 s31, s18, 2
  s_mov_b32 s23, s31
  s_mov_b32 s21, 16
.g2_kernel_gl23:
  s_and_b32 s30, s21, 3
  s_cbranch_scc1 .g2_kernel_gl23m
  s_call_b64 s[26:27], .g2_kernel_v_may
.g2_kernel_gl23m:
  s_and_b32 s23, s23, 15
  s_lshl_b32 s30, s23, 10
  s_add_u32 s30, s30, 0
  s_add_u32 m0, s30, s22
  s_mul_i32 s30, s23, 229376
  s_add_u32 s30, s30, s20
  buffer_load_dwordx4 v250, s[12:15], s30 offen lds
  s_add_u32 s23, s23, 1
  s_sub_u32 s21, s21, 1
  s_sleep 3
  s_waitcnt vmcnt(2)
  s_cmp_lg_u32 s21, 0
  s_cbranch_scc1 .g2_kernel_gl23
  s_waitcnt vmcnt(0)
  ds_read_b64_tr_b16 v[64:65], v251 offset:0
  ds_read_b64_tr_b16 v[66:67], v251 offset:128
  ds_read_b64_tr_b16 v[68:69], v251 offset:1024
  ds_read_b64_tr_b16 v[70:71], v251 offset:1152
  ds_read_b64_tr_b16 v[72:73], v251 offset:2048
  ds_read_b64_tr_b16 v[74:75], v251 offset:2176
  ds_read_b64_tr_b16 v[76:77], v251 offset:3072
  ds_read_b64_tr_b16 v[78:79], v251 offset:3200
  ds_read_b64_tr_b16 v[80:81], v251 offset:4096
  ds_read_b64_tr_b16 v[82:83], v251 offset:4224
  ds_read_b64_tr_b16 v[84:85], v251 offset:5120
  ds_read_b64_tr_b16 v[86:87], v251 offset:5248
  ds_read_b64_tr_b16 v[88:89], v251 offset:6144
  ds_read_b64_tr_b16 v[90:91], v251 offset:6272
  ds_read_b64_tr_b16 v[92:93], v251 offset:7168
  ds_read_b64_tr_b16 v[94:95], v251 offset:7296
  ds_read_b64_tr_b16 v[96:97], v251 offset:8192
  ds_read_b64_tr_b16 v[98:99], v251 offset:8320
  ds_read_b64_tr_b16 v[100:101], v251 offset:9216
  ds_read_b64_tr_b16 v[102:103], v251 offset:9344
  ds_read_b64_tr_b16 v[104:105], v251 offset:10240
  ds_read_b64_tr_b16 v[106:107], v251 offset:10368
  ds_read_b64_tr_b16 v[108:109], v251 offset:11264
  ds_read_b64_tr_b16 v[110:111], v251 offset:11392
  ds_read_b64_tr_b16 v[112:113], v251 offset:12288
  ds_read_b64_tr_b16 v[114:115], v251 offset:12416
  ds_read_b64_tr_b16 v[116:117], v251 offset:13312
  ds_read_b64_tr_b16 v[118:119], v251 offset:13440
  ds_read_b64_tr_b16 v[120:121], v251 offset:14336
  ds_read_b64_tr_b16 v[122:123], v251 offset:14464
  ds_read_b64_tr_b16 v[124:125], v251 offset:15360
  ds_read_b64_tr_b16 v[126:127], v251 offset:15488
  s_waitcnt lgkmcnt(0)
  s_mov_b32 s12, s52
  s_mov_b32 s13, s53
  s_mov_b32 s14, 0x700000
  s_mov_b32 s15, 0x00020000
  s_mul_i32 s20, s25, 3670016
  s_lshl_b32 s31, s24, 5
  s_add_u32 s20, s20, s31
  s_lshl_b32 s31, s18, 2
  s_mov_b32 s23, s31
  s_mov_b32 s21, 16
.g2_kernel_gl24:
  s_and_b32 s30, s21, 3
  s_cbranch_scc1 .g2_kernel_gl24m
  s_call_b64 s[26:27], .g2_kernel_v_may
.g2_kernel_gl24m:
  s_and_b32 s23, s23, 15
  s_lshl_b32 s30, s23, 10
  s_add_u32 s30, s30, 0
  s_add_u32 m0, s30, s22
  s_mul_i32 s30, s23, 229376
  s_add_u32 s30, s30, s20
  buffer_load_dwordx4 v250, s[12:15], s30 offen lds
  s_add_u32 s23, s23, 1
  s_sub_u32 s21, s21, 1
  s_sleep 3
  s_waitcnt vmcnt(2)
  s_cmp_lg_u32 s21, 0
  s_cbranch_scc1 .g2_kernel_gl24
  s_waitcnt vmcnt(0)
  ds_read_b64_tr_b16 v[128:129], v251 offset:0
  ds_read_b64_tr_b16 v[130:131], v251 offset:128
  ds_read_b64_tr_b16 v[132:133], v251 offset:1024
  ds_read_b64_tr_b16 v[134:135], v251 offset:1152
  ds_read_b64_tr_b16 v[136:137], v251 offset:2048
  ds_read_b64_tr_b16 v[138:139], v251 offset:2176
  ds_read_b64_tr_b16 v[140:141], v251 offset:3072
  ds_read_b64_tr_b16 v[142:143], v251 offset:3200
  ds_read_b64_tr_b16 v[144:145], v251 offset:4096
  ds_read_b64_tr_b16 v[146:147], v251 offset:4224
  ds_read_b64_tr_b16 v[148:149], v251 offset:5120
  ds_read_b64_tr_b16 v[150:151], v251 offset:5248
  ds_read_b64_tr_b16 v[152:153], v251 offset:6144
  ds_read_b64_tr_b16 v[154:155], v251 offset:6272
  ds_read_b64_tr_b16 v[156:157], v251 offset:7168
  ds_read_b64_tr_b16 v[158:159], v251 offset:7296
  ds_read_b64_tr_b16 v[160:161], v251 offset:8192
  ds_read_b64_tr_b16 v[162:163], v251 offset:8320
  ds_read_b64_tr_b16 v[164:165], v251 offset:9216
  ds_read_b64_tr_b16 v[166:167], v251 offset:9344
  ds_read_b64_tr_b16 v[168:169], v251 offset:10240
  ds_read_b64_tr_b16 v[170:171], v251 offset:10368
  ds_read_b64_tr_b16 v[172:173], v251 offset:11264
  ds_read_b64_tr_b16 v[174:175], v251 offset:11392
  ds_read_b64_tr_b16 v[176:177], v251 offset:12288
  ds_read_b64_tr_b16 v[178:179], v251 offset:12416
  ds_read_b64_tr_b16 v[180:181], v251 offset:13312
  ds_read_b64_tr_b16 v[182:183], v251 offset:13440
  ds_read_b64_tr_b16 v[184:185], v251 offset:14336
  ds_read_b64_tr_b16 v[186:187], v251 offset:14464
  ds_read_b64_tr_b16 v[188:189], v251 offset:15360
  ds_read_b64_tr_b16 v[190:191], v251 offset:15488
  s_waitcnt lgkmcnt(0)
  s_mov_b32 s12, s54
  s_mov_b32 s13, s55
  s_mov_b32 s14, 0x700000
  s_mov_b32 s15, 0x00020000
  s_lshl_b32 s20, s24, 15
  s_lshl_b32 s31, s25, 10
  s_add_u32 s20, s20, s31
  s_mov_b32 s23, 0
  s_mov_b32 s21, 16
.g2_kernel_gl25:
  s_and_b32 s30, s21, 3
  s_cbranch_scc1 .g2_kernel_gl25m
  s_call_b64 s[26:27], .g2_kernel_v_may
.g2_kernel_gl25m:
  s_and_b32 s23, s23, 15
  s_lshl_b32 s30, s23, 10
  s_add_u32 s30, s30, 0
  s_add_u32 m0, s30, s22
  s_mul_i32 s30, s23, 2048
  s_add_u32 s30, s30, s20
  buffer_load_dwordx4 v3, s[12:15], s30 offen lds
  s_add_u32 s23, s23, 1
  s_sub_u32 s21, s21, 1
  s_sleep 2
  s_waitcnt vmcnt(2)
  s_cmp_lg_u32 s21, 0
  s_cbranch_scc1 .g2_kernel_gl25
  v_mov_b32 v11, v252
  s_waitcnt vmcnt(0)
  ds_read_b64_tr_b16 v[192:193], v11 offset:0
  ds_read_b64_tr_b16 v[194:195], v11 offset:4096
  ds_read_b64_tr_b16 v[196:197], v11 offset:32
  ds_read_b64_tr_b16 v[198:199], v11 offset:4128
  ds_read_b64_tr_b16 v[200:201], v11 offset:64
  ds_read_b64_tr_b16 v[202:203], v11 offset:4160
  ds_read_b64_tr_b16 v[204:205], v11 offset:96
  ds_read_b64_tr_b16 v[206:207], v11 offset:4192
  ds_read_b64_tr_b16 v[208:209], v11 offset:256
  ds_read_b64_tr_b16 v[210:211], v11 offset:4352
  ds_read_b64_tr_b16 v[212:213], v11 offset:288
  ds_read_b64_tr_b16 v[214:215], v11 offset:4384
  ds_read_b64_tr_b16 v[216:217], v11 offset:320
  ds_read_b64_tr_b16 v[218:219], v11 offset:4416
  ds_read_b64_tr_b16 v[220:221], v11 offset:352
  ds_read_b64_tr_b16 v[222:223], v11 offset:4448
  ds_read_b64_tr_b16 v[224:225], v11 offset:512
  ds_read_b64_tr_b16 v[226:227], v11 offset:4608
  ds_read_b64_tr_b16 v[228:229], v11 offset:544
  ds_read_b64_tr_b16 v[230:231], v11 offset:4640
  ds_read_b64_tr_b16 v[232:233], v11 offset:576
  ds_read_b64_tr_b16 v[234:235], v11 offset:4672
  ds_read_b64_tr_b16 v[236:237], v11 offset:608
  ds_read_b64_tr_b16 v[238:239], v11 offset:4704
  ds_read_b64_tr_b16 v[240:241], v11 offset:768
  ds_read_b64_tr_b16 v[242:243], v11 offset:4864
  ds_read_b64_tr_b16 v[244:245], v11 offset:800
  ds_read_b64_tr_b16 v[246:247], v11 offset:4896
  ds_read_b64_tr_b16 v[248:249], v11 offset:832
  ds_read_b64_tr_b16 v[250:251], v11 offset:4928
  ds_read_b64_tr_b16 v[252:253], v11 offset:864
  ds_read_b64_tr_b16 v[254:255], v11 offset:4960
  s_waitcnt lgkmcnt(0)
  s_branch .g2_kernel_g_e
.g2_kernel_g_p:
  s_mov_b32 s12, s42
  s_mov_b32 s13, s43
  s_mov_b32 s14, 0x600000
  s_mov_b32 s15, 0x00020000
  v_mul_u32_u24 v6, 6144, v9
  v_and_b32 v7, 15, v2
  v_lshl_add_u32 v250, v7, 4, v6
  v_lshl_add_u32 v11, v8, 2, v9
  v_lshl_add_u32 v251, v11, 9, v10
  s_lshl_b32 s20, s17, 3
  s_and_b32 s31, s18, 1
  s_add_u32 s20, s20, s31
  s_mul_i32 s20, s20, 49152
  s_and_b32 s31, s18, 14
  s_lshl_b32 s31, s31, 7
  s_add_u32 s20, s20, s31
  s_mov_b32 s23, 0
  s_mov_b32 s21, 8
.g2_kernel_gl26:
  s_and_b32 s30, s21, 3
  s_cbranch_scc1 .g2_kernel_gl26m
  s_call_b64 s[26:27], .g2_kernel_v_may
.g2_kernel_gl26m:
  s_and_b32 s23, s23, 7
  s_lshl_b32 s30, s23, 10
  s_add_u32 s30, s30, 0
  s_add_u32 m0, s30, s22
  s_mul_i32 s30, s23, 49152
  s_add_u32 s30, s30, s20
  s_and_b32 s31, s23, 1
  s_mul_i32 s31, s31, -24576
  s_add_u32 s30, s30, s31
  buffer_load_dwordx4 v250, s[12:15], s30 offen lds
  s_add_u32 s23, s23, 1
  s_sub_u32 s21, s21, 1
  s_sleep 2
  s_waitcnt vmcnt(2)
  s_cmp_lg_u32 s21, 0
  s_cbranch_scc1 .g2_kernel_gl26
  s_add_u32 s20, s20, 2048
  s_mov_b32 s23, 0
  s_mov_b32 s21, 8
.g2_kernel_gl27:
  s_and_b32 s30, s21, 3
  s_cbranch_scc1 .g2_kernel_gl27m
  s_call_b64 s[26:27], .g2_kernel_v_may
.g2_kernel_gl27m:
  s_and_b32 s23, s23, 7
  s_lshl_b32 s30, s23, 10
  s_add_u32 s30, s30, 8192
  s_add_u32 m0, s30, s22
  s_mul_i32 s30, s23, 49152
  s_add_u32 s30, s30, s20
  s_and_b32 s31, s23, 1
  s_mul_i32 s31, s31, -24576
  s_add_u32 s30, s30, s31
  buffer_load_dwordx4 v250, s[12:15], s30 offen lds
  s_add_u32 s23, s23, 1
  s_sub_u32 s21, s21, 1
  s_sleep 2
  s_waitcnt vmcnt(2)
  s_cmp_lg_u32 s21, 0
  s_cbranch_scc1 .g2_kernel_gl27
  s_add_u32 s20, s20, 2048
  s_waitcnt vmcnt(0)
  ds_read_b64_tr_b16 v[64:65], v251 offset:0
  ds_read_b64_tr_b16 v[66:67], v251 offset:256
  ds_read_b64_tr_b16 v[68:69], v251 offset:32
  ds_read_b64_tr_b16 v[70:71], v251 offset:288
  ds_read_b64_tr_b16 v[72:73], v251 offset:64
  ds_read_b64_tr_b16 v[74:75], v251 offset:320
  ds_read_b64_tr_b16 v[76:77], v251 offset:96
  ds_read_b64_tr_b16 v[78:79], v251 offset:352
  ds_read_b64_tr_b16 v[80:81], v251 offset:128
  ds_read_b64_tr_b16 v[82:83], v251 offset:384
  ds_read_b64_tr_b16 v[84:85], v251 offset:160
  ds_read_b64_tr_b16 v[86:87], v251 offset:416
  ds_read_b64_tr_b16 v[88:89], v251 offset:192
  ds_read_b64_tr_b16 v[90:91], v251 offset:448
  ds_read_b64_tr_b16 v[92:93], v251 offset:224
  ds_read_b64_tr_b16 v[94:95], v251 offset:480
  ds_read_b64_tr_b16 v[96:97], v251 offset:8192
  ds_read_b64_tr_b16 v[98:99], v251 offset:8448
  ds_read_b64_tr_b16 v[100:101], v251 offset:8224
  ds_read_b64_tr_b16 v[102:103], v251 offset:8480
  ds_read_b64_tr_b16 v[104:105], v251 offset:8256
  ds_read_b64_tr_b16 v[106:107], v251 offset:8512
  ds_read_b64_tr_b16 v[108:109], v251 offset:8288
  ds_read_b64_tr_b16 v[110:111], v251 offset:8544
  ds_read_b64_tr_b16 v[112:113], v251 offset:8320
  ds_read_b64_tr_b16 v[114:115], v251 offset:8576
  ds_read_b64_tr_b16 v[116:117], v251 offset:8352
  ds_read_b64_tr_b16 v[118:119], v251 offset:8608
  ds_read_b64_tr_b16 v[120:121], v251 offset:8384
  ds_read_b64_tr_b16 v[122:123], v251 offset:8640
  ds_read_b64_tr_b16 v[124:125], v251 offset:8416
  ds_read_b64_tr_b16 v[126:127], v251 offset:8672
  s_waitcnt lgkmcnt(0)
  s_mov_b32 s23, 0
  s_mov_b32 s21, 8
.g2_kernel_gl28:
  s_and_b32 s30, s21, 3
  s_cbranch_scc1 .g2_kernel_gl28m
  s_call_b64 s[26:27], .g2_kernel_v_may
.g2_kernel_gl28m:
  s_and_b32 s23, s23, 7
  s_lshl_b32 s30, s23, 10
  s_add_u32 s30, s30, 0
  s_add_u32 m0, s30, s22
  s_mul_i32 s30, s23, 49152
  s_add_u32 s30, s30, s20
  s_and_b32 s31, s23, 1
  s_mul_i32 s31, s31, -24576
  s_add_u32 s30, s30, s31
  buffer_load_dwordx4 v250, s[12:15], s30 offen lds
  s_add_u32 s23, s23, 1
  s_sub_u32 s21, s21, 1
  s_sleep 2
  s_waitcnt vmcnt(2)
  s_cmp_lg_u32 s21, 0
  s_cbranch_scc1 .g2_kernel_gl28
  s_add_u32 s20, s20, 2048
  s_waitcnt vmcnt(0)
  ds_read_b64_tr_b16 v[128:129], v251 offset:0
  ds_read_b64_tr_b16 v[130:131], v251 offset:256
  ds_read_b64_tr_b16 v[132:133], v251 offset:32
  ds_read_b64_tr_b16 v[134:135], v251 offset:288
  ds_read_b64_tr_b16 v[136:137], v251 offset:64
  ds_read_b64_tr_b16 v[138:139], v251 offset:320
  ds_read_b64_tr_b16 v[140:141], v251 offset:96
  ds_read_b64_tr_b16 v[142:143], v251 offset:352
  ds_read_b64_tr_b16 v[144:145], v251 offset:128
  ds_read_b64_tr_b16 v[146:147], v251 offset:384
  ds_read_b64_tr_b16 v[148:149], v251 offset:160
  ds_read_b64_tr_b16 v[150:151], v251 offset:416
  ds_read_b64_tr_b16 v[152:153], v251 offset:192
  ds_read_b64_tr_b16 v[154:155], v251 offset:448
  ds_read_b64_tr_b16 v[156:157], v251 offset:224
  ds_read_b64_tr_b16 v[158:159], v251 offset:480
  s_waitcnt lgkmcnt(0)
.g2_kernel_g_e:
  s_cmp_lt_u32 s16, 6
  s_cbranch_scc1 .g2_kernel_v_3
  v_mov_b32 v6, s71
  s_mov_b64 exec, 1
  ds_add_u32 v6, v5 offset:116
  s_mov_b64 exec, -1
  s_branch .g2_kernel_v_3c
.g2_kernel_v_3:
  s_mov_b32 s29, 0
  s_and_b32 s32, s16, 3
  s_lshl_b32 s30, s32, 14
  s_add_u32 s30, s30, 65536
  s_call_b64 s[68:69], .g2_kernel_v_wo
  s_cmp_lg_u32 s16, 4
  s_cbranch_scc1 .g2_kernel_v_3d
  s_mov_b32 s32, 2
  s_mov_b32 s30, 98304
  s_call_b64 s[68:69], .g2_kernel_v_wo
  s_mov_b32 s32, 3
  s_mov_b32 s30, 114688
  s_call_b64 s[68:69], .g2_kernel_v_wo
.g2_kernel_v_3d:
  s_waitcnt vmcnt(0)
  v_mov_b32 v8, 2
  v_mov_b32 v6, s71
  s_mov_b64 exec, 1
  ds_add_u32 v6, v8 offset:52
  s_mov_b64 exec, -1
.g2_kernel_v_3c:
  s_cmp_lg_u32 s39, 0
  s_cbranch_scc1 .g2_kernel_v_3b
  s_call_b64 s[26:27], .g2_kernel_v_do
.g2_kernel_v_3b:
  s_cmp_lg_u32 s16, 4
  s_cbranch_scc1 .g2_kernel_v_4
  v_mov_b32 v6, s71
  s_mov_b32 s38, 0
.g2_kernel_wg29:
  ds_read_b32 v7, v6 offset:8
  s_add_u32 s38, s38, 1
  s_waitcnt lgkmcnt(0)
  v_cmp_gt_u32 vcc, 10, v7
  s_cbranch_vccz .g2_kernel_wg29d
  s_sleep 8
  s_cmp_lt_u32 s38, 524288
  s_cbranch_scc1 .g2_kernel_wg29
.g2_kernel_wg29d:
  s_mov_b32 s29, 1
  s_mov_b32 s32, 0
  s_mov_b32 s30, 139264
  s_call_b64 s[68:69], .g2_kernel_v_wo
  s_add_u32 s31, s31, 81920
  s_sleep 6
  s_waitcnt vmcnt(4)
  buffer_load_dwordx4 v[64:67], v6, s[8:11], s31 offen
  s_add_u32 s31, s31, 16384
  buffer_load_dwordx4 v[68:71], v6, s[8:11], s31 offen
  s_add_u32 s31, s31, 16384
  buffer_load_dwordx4 v[72:75], v6, s[8:11], s31 offen
  s_add_u32 s31, s31, 16384
  buffer_load_dwordx4 v[76:79], v6, s[8:11], s31 offen
  s_add_u32 s31, s31, 81920
  s_sleep 6
  s_waitcnt vmcnt(4)
  buffer_load_dwordx4 v[80:83], v6, s[8:11], s31 offen
  s_add_u32 s31, s31, 16384
  buffer_load_dwordx4 v[84:87], v6, s[8:11], s31 offen
  s_add_u32 s31, s31, 16384
  buffer_load_dwordx4 v[88:91], v6, s[8:11], s31 offen
  s_add_u32 s31, s31, 16384
  buffer_load_dwordx4 v[92:95], v6, s[8:11], s31 offen
  s_add_u32 s31, s31, 81920
  s_sleep 6
  s_waitcnt vmcnt(4)
  buffer_load_dwordx4 v[96:99], v6, s[8:11], s31 offen
  s_add_u32 s31, s31, 16384
  buffer_load_dwordx4 v[100:103], v6, s[8:11], s31 offen
  s_add_u32 s31, s31, 16384
  buffer_load_dwordx4 v[104:107], v6, s[8:11], s31 offen
  s_add_u32 s31, s31, 16384
  buffer_load_dwordx4 v[108:111], v6, s[8:11], s31 offen
  s_add_u32 s31, s31, 81920
  s_sleep 6
  s_waitcnt vmcnt(4)
  buffer_load_dwordx4 v[112:115], v6, s[8:11], s31 offen
  s_add_u32 s31, s31, 16384
  buffer_load_dwordx4 v[116:119], v6, s[8:11], s31 offen
  s_add_u32 s31, s31, 16384
  buffer_load_dwordx4 v[120:123], v6, s[8:11], s31 offen
  s_add_u32 s31, s31, 16384
  buffer_load_dwordx4 v[124:127], v6, s[8:11], s31 offen
  s_add_u32 s31, s31, 81920
  s_sleep 6
  s_waitcnt vmcnt(4)
  buffer_load_dwordx4 v[128:131], v6, s[8:11], s31 offen
  s_add_u32 s31, s31, 16384
  buffer_load_dwordx4 v[132:135], v6, s[8:11], s31 offen
  s_add_u32 s31, s31, 16384
  buffer_load_dwordx4 v[136:139], v6, s[8:11], s31 offen
  s_add_u32 s31, s31, 16384
  buffer_load_dwordx4 v[140:143], v6, s[8:11], s31 offen
  s_add_u32 s31, s31, 81920
  s_sleep 6
  s_waitcnt vmcnt(4)
  buffer_load_dwordx4 v[144:147], v6, s[8:11], s31 offen
  s_add_u32 s31, s31, 16384
  buffer_load_dwordx4 v[148:151], v6, s[8:11], s31 offen
  s_add_u32 s31, s31, 16384
  buffer_load_dwordx4 v[152:155], v6, s[8:11], s31 offen
  s_add_u32 s31, s31, 16384
  buffer_load_dwordx4 v[156:159], v6, s[8:11], s31 offen
  s_add_u32 s31, s31, 81920
  s_sleep 6
  s_waitcnt vmcnt(4)
  buffer_load_dwordx4 v[160:163], v6, s[8:11], s31 offen
  s_add_u32 s31, s31, 16384
  buffer_load_dwordx4 v[164:167], v6, s[8:11], s31 offen
  s_add_u32 s31, s31, 16384
  buffer_load_dwordx4 v[168:171], v6, s[8:11], s31 offen
  s_add_u32 s31, s31, 16384
  buffer_load_dwordx4 v[172:175], v6, s[8:11], s31 offen
  s_add_u32 s31, s31, 81920
  s_sleep 6
  s_waitcnt vmcnt(4)
  buffer_load_dwordx4 v[176:179], v6, s[8:11], s31 offen
  s_add_u32 s31, s31, 16384
  buffer_load_dwordx4 v[180:183], v6, s[8:11], s31 offen
  s_add_u32 s31, s31, 16384
  buffer_load_dwordx4 v[184:187], v6, s[8:11], s31 offen
  s_add_u32 s31, s31, 16384
  buffer_load_dwordx4 v[188:191], v6, s[8:11], s31 offen
  s_add_u32 s31, s31, 81920
  s_sleep 6
  s_waitcnt vmcnt(4)
  buffer_load_dwordx4 v[192:195], v6, s[8:11], s31 offen
  s_add_u32 s31, s31, 16384
  buffer_load_dwordx4 v[196:199], v6, s[8:11], s31 offen
  s_add_u32 s31, s31, 16384
  buffer_load_dwordx4 v[200:203], v6, s[8:11], s31 offen
  s_add_u32 s31, s31, 16384
  buffer_load_dwordx4 v[204:207], v6, s[8:11], s31 offen
  s_add_u32 s31, s31, 81920
  s_sleep 6
  s_waitcnt vmcnt(4)
  buffer_load_dwordx4 v[208:211], v6, s[8:11], s31 offen
  s_add_u32 s31, s31, 16384
  buffer_load_dwordx4 v[212:215], v6, s[8:11], s31 offen
  s_add_u32 s31, s31, 16384
  buffer_load_dwordx4 v[216:219], v6, s[8:11], s31 offen
  s_add_u32 s31, s31, 16384
  buffer_load_dwordx4 v[220:223], v6, s[8:11], s31 offen
  s_add_u32 s31, s31, 81920
  s_sleep 6
  s_waitcnt vmcnt(4)
  buffer_load_dwordx4 v[224:227], v6, s[8:11], s31 offen
  s_add_u32 s31, s31, 16384
  buffer_load_dwordx4 v[228:231], v6, s[8:11], s31 offen
  s_add_u32 s31, s31, 16384
  buffer_load_dwordx4 v[232:235], v6, s[8:11], s31 offen
  s_add_u32 s31, s31, 16384
  buffer_load_dwordx4 v[236:239], v6, s[8:11], s31 offen
  s_add_u32 s31, s31, 81920
  s_sleep 6
  s_waitcnt vmcnt(4)
  buffer_load_dwordx4 v[240:243], v6, s[8:11], s31 offen
  s_add_u32 s31, s31, 16384
  buffer_load_dwordx4 v[244:247], v6, s[8:11], s31 offen
  s_add_u32 s31, s31, 16384
  buffer_load_dwordx4 v[248:251], v6, s[8:11], s31 offen
  s_add_u32 s31, s31, 16384
  buffer_load_dwordx4 v[252:255], v6, s[8:11], s31 offen
  v_mov_b32 v8, s71
  s_mov_b32 s38, 0
.g2_kernel_wg30:
  ds_read_b32 v9, v8 offset:116
  s_add_u32 s38, s38, 1
  s_waitcnt lgkmcnt(0)
  v_cmp_gt_u32 vcc, 2, v9
  s_cbranch_vccz .g2_kernel_wg30d
  s_sleep 4
  s_cmp_lt_u32 s38, 524288
  s_cbranch_scc1 .g2_kernel_wg30
.g2_kernel_wg30d:
  s_waitcnt vmcnt(0)
  ds_write_b128 v3, v[128:131] offset:32768
  ds_write_b128 v3, v[132:135] offset:33792
  ds_write_b128 v3, v[136:139] offset:34816
  ds_write_b128 v3, v[140:143] offset:35840
  ds_write_b128 v3, v[144:147] offset:36864
  ds_write_b128 v3, v[148:151] offset:37888
  ds_write_b128 v3, v[152:155] offset:38912
  ds_write_b128 v3, v[156:159] offset:39936
  ds_write_b128 v3, v[160:163] offset:40960
  ds_write_b128 v3, v[164:167] offset:41984
  ds_write_b128 v3, v[168:171] offset:43008
  ds_write_b128 v3, v[172:175] offset:44032
  ds_write_b128 v3, v[176:179] offset:45056
  ds_write_b128 v3, v[180:183] offset:46080
  ds_write_b128 v3, v[184:187] offset:47104
  ds_write_b128 v3, v[188:191] offset:48128
  ds_write_b128 v3, v[192:195] offset:49152
  ds_write_b128 v3, v[196:199] offset:50176
  ds_write_b128 v3, v[200:203] offset:51200
  ds_write_b128 v3, v[204:207] offset:52224
  ds_write_b128 v3, v[208:211] offset:53248
  ds_write_b128 v3, v[212:215] offset:54272
  ds_write_b128 v3, v[216:219] offset:55296
  ds_write_b128 v3, v[220:223] offset:56320
  ds_write_b128 v3, v[224:227] offset:57344
  ds_write_b128 v3, v[228:231] offset:58368
  ds_write_b128 v3, v[232:235] offset:59392
  ds_write_b128 v3, v[236:239] offset:60416
  ds_write_b128 v3, v[240:243] offset:61440
  ds_write_b128 v3, v[244:247] offset:62464
  ds_write_b128 v3, v[248:251] offset:63488
  ds_write_b128 v3, v[252:255] offset:64512
.g2_kernel_v_4:
  s_cmp_lg_u32 s16, 5
  s_cbranch_scc1 .g2_kernel_v_5
  s_sleep 48
  s_and_b32 s31, s19, 0xffffe000
  s_add_u32 s31, s31, 0
  v_and_b32 v6, 15, v2
  v_lshlrev_b32 v6, 9, v6
  v_lshrrev_b32 v7, 4, v2
  v_lshl_add_u32 v6, v7, 7, v6
  v_lshlrev_b32 v7, 2, v2
  v_add_u32 v7, 157696, v7
  s_mov_b32 m0, 157696
  s_mov_b32 s38, 0
.g2_kernel_pa31:
  buffer_load_dword v6, s[4:7], s31 offen sc1 lds
  s_add_u32 s38, s38, 1
  s_waitcnt vmcnt(0)
  ds_read_b32 v8, v7
  s_waitcnt lgkmcnt(0)
  v_cmp_ge_u32 vcc, s62, v8
  s_cbranch_vccz .g2_kernel_pa31d
  s_mov_b64 exec, vcc
  s_sleep 32
  s_cmp_lt_u32 s38, 131072
  s_cbranch_scc1 .g2_kernel_pa31
.g2_kernel_pa31d:
  s_mov_b64 exec, -1
  v_lshlrev_b32 v6, 7, v2
  s_lshl_b32 s30, s17, 2
  s_and_b32 s31, s18, 3
  s_add_u32 s30, s30, s31
  s_lshl_b32 s30, s30, 16
  s_add_u32 s30, s30, s63
  s_add_u32 s30, s30, 0x800000
  s_sleep 8
  buffer_load_dword v1, v6, s[4:7], s30 offen
  s_add_u32 s30, s30, 8192
  s_sleep 8
  buffer_load_dword v1, v6, s[4:7], s30 offen
  s_add_u32 s30, s30, 8192
  s_sleep 8
  buffer_load_dword v1, v6, s[4:7], s30 offen
  s_add_u32 s30, s30, 8192
  s_sleep 8
  buffer_load_dword v1, v6, s[4:7], s30 offen
  s_add_u32 s30, s30, 8192
  s_lshl_b32 s28, s2, 10
  s_and_b32 s28, s28, 0xe000
  v_lshlrev_b32 v7, 7, v2
  buffer_load_dword v1, v7, s[64:67], s28 offen
.g2_kernel_v_5:
  s_mov_b32 s29, 1
  s_call_b64 s[68:69], .g2_kernel_v_cmb
  s_cmp_lg_u32 s16, 7
  s_cbranch_scc1 .g2_kernel_v_7
  s_and_b32 s33, s16, 3
  s_lshl_b32 s33, s33, 7
  s_lshl_b32 s28, s29, 2
  s_add_u32 s33, s33, s28
  s_add_u32 s31, s19, s33
  v_mov_b32 v6, s70
  s_mov_b64 exec, 1
  buffer_store_dword v6, v4, s[4:7], s31 offen offset:0 sc1
  s_mov_b64 exec, -1
.g2_kernel_v_7:
  s_cmp_lg_u32 s16, 4
  s_cbranch_scc1 .g2_kernel_v_8
  s_waitcnt vmcnt(2)
  v_mov_b32 v6, s71
  s_mov_b32 s38, 0
.g2_kernel_wg32:
  ds_read_b32 v7, v6 offset:76
  s_add_u32 s38, s38, 1
  s_waitcnt lgkmcnt(0)
  v_cmp_gt_u32 vcc, 1, v7
  s_cbranch_vccz .g2_kernel_wg32d
  s_sleep 1
  s_cmp_lt_u32 s38, 524288
  s_cbranch_scc1 .g2_kernel_wg32
.g2_kernel_wg32d:
  v_mov_b32 v6, s71
  s_mov_b32 s38, 0
.g2_kernel_wg33:
  ds_read_b32 v7, v6 offset:72
  s_add_u32 s38, s38, 1
  s_waitcnt lgkmcnt(0)
  v_cmp_gt_u32 vcc, 1, v7
  s_cbranch_vccz .g2_kernel_wg33d
  s_sleep 1
  s_cmp_lt_u32 s38, 524288
  s_cbranch_scc1 .g2_kernel_wg33
.g2_kernel_wg33d:
  v_mov_b32 v6, s71
  s_mov_b32 s38, 0
.g2_kernel_wg34:
  ds_read_b32 v7, v6 offset:68
  s_add_u32 s38, s38, 1
  s_waitcnt lgkmcnt(0)
  v_cmp_gt_u32 vcc, 1, v7
  s_cbranch_vccz .g2_kernel_wg34d
  s_sleep 1
  s_cmp_lt_u32 s38, 524288
  s_cbranch_scc1 .g2_kernel_wg34
.g2_kernel_wg34d:
  ds_write_b128 v3, v[64:67] offset:16384
  ds_write_b128 v3, v[68:71] offset:17408
  ds_write_b128 v3, v[72:75] offset:18432
  ds_write_b128 v3, v[76:79] offset:19456
  ds_write_b128 v3, v[80:83] offset:20480
  ds_write_b128 v3, v[84:87] offset:21504
  ds_write_b128 v3, v[88:91] offset:22528
  ds_write_b128 v3, v[92:95] offset:23552
  ds_write_b128 v3, v[96:99] offset:24576
  ds_write_b128 v3, v[100:103] offset:25600
  ds_write_b128 v3, v[104:107] offset:26624
  ds_write_b128 v3, v[108:111] offset:27648
  ds_write_b128 v3, v[112:115] offset:28672
  ds_write_b128 v3, v[116:119] offset:29696
  ds_write_b128 v3, v[120:123] offset:30720
  ds_write_b128 v3, v[124:127] offset:31744
  v_mov_b32 v8, 4
  ds_write_b32 v6, v8 offset:12
.g2_kernel_v_8:
  s_cmp_eq_u32 s16, 5
  s_cbranch_scc1 .g2_kernel_c1
  s_cmp_lg_u32 s16, 4
  s_cbranch_scc1 .g2_kernel_c2
  s_cmp_lg_u32 s62, 0
  s_cbranch_scc1 .g2_kernel_fin1
  s_setprio 3
  s_mov_b32 s12, s42
  s_mov_b32 s13, s43
  s_mov_b32 s14, 0x600000
  s_mov_b32 s15, 0x00020000
  v_lshrrev_b32 v28, 3, v2
  v_and_b32 v29, 7, v2
  v_bfe_u32 v30, v2, 4, 1
  v_lshlrev_b32 v30, 1, v30
  v_xor_b32 v31, v29, v30
  v_lshlrev_b32 v31, 4, v31
  v_mul_u32_u24 v28, 6144, v28
  v_add_u32 v28, v28, v31
  v_xor_b32 v29, 64, v28
  v_lshlrev_b32 v9, 2, v2
  v_and_b32 v9, 12, v9
  v_add_u32 v9, 156416, v9
  v_add_u32 v48, 0, v28
  v_add_u32 v49, 48128, v29
  v_add_u32 v50, 96256, v28
  v_add_u32 v51, 144384, v29
  v_add_u32 v52, 2048, v28
  v_add_u32 v53, 50176, v29
  v_add_u32 v54, 98304, v28
  v_add_u32 v55, 146432, v29
  v_add_u32 v56, 4096, v28
  v_add_u32 v57, 52224, v29
  v_add_u32 v58, 100352, v28
  v_add_u32 v59, 148480, v29
  v_and_b32 v11, 15, v2
  v_xor_b32 v11, s18, v11
  v_and_b32 v12, 48, v2
  v_add_u32 v11, v11, v12
  v_lshlrev_b32 v11, 2, v11
  v_add_u32 v11, 158208, v11
  s_lshl_b32 s39, s18, 7
  s_lshl_b32 s32, s17, 18
  s_add_u32 s32, s32, 0xc00000
  s_mov_b32 s30, 0
  s_mov_b32 s29, 0
  s_mov_b32 s37, 0
  v_mov_b32 v6, s71
  s_mov_b32 s38, 0
.g2_kernel_wg35:
  ds_read_b32 v7, v6 offset:16
  s_add_u32 s38, s38, 1
  s_waitcnt lgkmcnt(0)
  v_cmp_gt_u32 vcc, 4, v7
  s_cbranch_vccz .g2_kernel_wg35d
  s_sleep 2
  s_cmp_lt_u32 s38, 524288
  s_cbranch_scc1 .g2_kernel_wg35
.g2_kernel_wg35d:
  s_xor_b32 s36, s18, 0
  s_mul_i32 s36, s36, 393216
  s_add_u32 s36, s36, s39
  s_add_u32 m0, s30, 65536
  s_waitcnt vmcnt(63)
  buffer_load_dwordx4 v48, s[12:15], s36 offen offset:0 lds
  buffer_load_dwordx4 v49, s[12:15], s36 offen offset:1024 lds
  buffer_load_dwordx4 v50, s[12:15], s36 offen offset:2048 lds
  buffer_load_dwordx4 v51, s[12:15], s36 offen offset:3072 lds
  s_add_u32 m0, s30, 69632
  s_waitcnt vmcnt(63)
  buffer_load_dwordx4 v52, s[12:15], s36 offen offset:0 lds
  buffer_load_dwordx4 v53, s[12:15], s36 offen offset:1024 lds
  buffer_load_dwordx4 v54, s[12:15], s36 offen offset:2048 lds
  buffer_load_dwordx4 v55, s[12:15], s36 offen offset:3072 lds
  s_add_u32 m0, s30, 73728
  s_waitcnt vmcnt(63)
  buffer_load_dwordx4 v56, s[12:15], s36 offen offset:0 lds
  buffer_load_dwordx4 v57, s[12:15], s36 offen offset:1024 lds
  buffer_load_dwordx4 v58, s[12:15], s36 offen offset:2048 lds
  buffer_load_dwordx4 v59, s[12:15], s36 offen offset:3072 lds
  s_add_u32 s30, s30, 12288
  s_cmp_eq_u32 s30, 86016
  s_cselect_b32 s30, 0, s30
  s_xor_b32 s36, s18, 0
  s_mul_i32 s36, s36, 393216
  s_add_u32 s36, s36, s39
  s_add_u32 s36, s36, 196608
  s_add_u32 m0, s30, 65536
  s_waitcnt vmcnt(63)
  buffer_load_dwordx4 v48, s[12:15], s36 offen offset:0 lds
  buffer_load_dwordx4 v49, s[12:15], s36 offen offset:1024 lds
  buffer_load_dwordx4 v50, s[12:15], s36 offen offset:2048 lds
  buffer_load_dwordx4 v51, s[12:15], s36 offen offset:3072 lds
  s_add_u32 m0, s30, 69632
  s_waitcnt vmcnt(63)
  buffer_load_dwordx4 v52, s[12:15], s36 offen offset:0 lds
  buffer_load_dwordx4 v53, s[12:15], s36 offen offset:1024 lds
  buffer_load_dwordx4 v54, s[12:15], s36 offen offset:2048 lds
  buffer_load_dwordx4 v55, s[12:15], s36 offen offset:3072 lds
  s_add_u32 m0, s30, 73728
  s_waitcnt vmcnt(63)
  buffer_load_dwordx4 v56, s[12:15], s36 offen offset:0 lds
  buffer_load_dwordx4 v57, s[12:15], s36 offen offset:1024 lds
  buffer_load_dwordx4 v58, s[12:15], s36 offen offset:2048 lds
  buffer_load_dwordx4 v59, s[12:15], s36 offen offset:3072 lds
  s_add_u32 s30, s30, 12288
  s_cmp_eq_u32 s30, 86016
  s_cselect_b32 s30, 0, s30
  s_mov_b32 m0, 156160
  s_mov_b32 s35, .g2_kernel_tab-.g2_kernel_pc+136
  s_mov_b64 exec, 1
  buffer_load_dword off, s[64:67], s35 lds
  s_mov_b64 exec, -1
  s_xor_b32 s36, s18, 1
  s_mul_i32 s36, s36, 393216
  s_add_u32 s36, s36, s39
  s_add_u32 m0, s30, 65536
  s_waitcnt vmcnt(63)
  buffer_load_dwordx4 v48, s[12:15], s36 offen offset:0 lds
  buffer_load_dwordx4 v49, s[12:15], s36 offen offset:1024 lds
  buffer_load_dwordx4 v50, s[12:15], s36 offen offset:2048 lds
  buffer_load_dwordx4 v51, s[12:15], s36 offen offset:3072 lds
  s_add_u32 m0, s30, 69632
  s_waitcnt vmcnt(63)
  buffer_load_dwordx4 v52, s[12:15], s36 offen offset:0 lds
  buffer_load_dwordx4 v53, s[12:15], s36 offen offset:1024 lds
  buffer_load_dwordx4 v54, s[12:15], s36 offen offset:2048 lds
  buffer_load_dwordx4 v55, s[12:15], s36 offen offset:3072 lds
  s_add_u32 m0, s30, 73728
  s_waitcnt vmcnt(63)
  buffer_load_dwordx4 v56, s[12:15], s36 offen offset:0 lds
  buffer_load_dwordx4 v57, s[12:15], s36 offen offset:1024 lds
  buffer_load_dwordx4 v58, s[12:15], s36 offen offset:2048 lds
  buffer_load_dwordx4 v59, s[12:15], s36 offen offset:3072 lds
  s_add_u32 s30, s30, 12288
  s_cmp_eq_u32 s30, 86016
  s_cselect_b32 s30, 0, s30
  s_xor_b32 s36, s18, 1
  s_mul_i32 s36, s36, 393216
  s_add_u32 s36, s36, s39
  s_add_u32 s36, s36, 196608
  s_add_u32 m0, s30, 65536
  s_waitcnt vmcnt(63)
  buffer_load_dwordx4 v48, s[12:15], s36 offen offset:0 lds
  buffer_load_dwordx4 v49, s[12:15], s36 offen offset:1024 lds
  buffer_load_dwordx4 v50, s[12:15], s36 offen offset:2048 lds
  buffer_load_dwordx4 v51, s[12:15], s36 offen offset:3072 lds
  s_add_u32 m0, s30, 69632
  s_waitcnt vmcnt(63)
  buffer_load_dwordx4 v52, s[12:15], s36 offen offset:0 lds
  buffer_load_dwordx4 v53, s[12:15], s36 offen offset:1024 lds
  buffer_load_dwordx4 v54, s[12:15], s36 offen offset:2048 lds
  buffer_load_dwordx4 v55, s[12:15], s36 offen offset:3072 lds
  s_add_u32 m0, s30, 73728
  s_waitcnt vmcnt(63)
  buffer_load_dwordx4 v56, s[12:15], s36 offen offset:0 lds
  buffer_load_dwordx4 v57, s[12:15], s36 offen offset:1024 lds
  buffer_load_dwordx4 v58, s[12:15], s36 offen offset:2048 lds
  buffer_load_dwordx4 v59, s[12:15], s36 offen offset:3072 lds
  s_add_u32 s30, s30, 12288
  s_cmp_eq_u32 s30, 86016
  s_cselect_b32 s30, 0, s30
  s_xor_b32 s36, s18, 2
  s_mul_i32 s36, s36, 393216
  s_add_u32 s36, s36, s39
  s_add_u32 m0, s30, 65536
  s_waitcnt vmcnt(63)
  buffer_load_dwordx4 v48, s[12:15], s36 offen offset:0 lds
  buffer_load_dwordx4 v49, s[12:15], s36 offen offset:1024 lds
  buffer_load_dwordx4 v50, s[12:15], s36 offen offset:2048 lds
  buffer_load_dwordx4 v51, s[12:15], s36 offen offset:3072 lds
  s_add_u32 m0, s30, 69632
  s_waitcnt vmcnt(63)
  buffer_load_dwordx4 v52, s[12:15], s36 offen offset:0 lds
  buffer_load_dwordx4 v53, s[12:15], s36 offen offset:1024 lds
  buffer_load_dwordx4 v54, s[12:15], s36 offen offset:2048 lds
  buffer_load_dwordx4 v55, s[12:15], s36 offen offset:3072 lds
  s_add_u32 m0, s30, 73728
  s_waitcnt vmcnt(63)
  buffer_load_dwordx4 v56, s[12:15], s36 offen offset:0 lds
  buffer_load_dwordx4 v57, s[12:15], s36 offen offset:1024 lds
  buffer_load_dwordx4 v58, s[12:15], s36 offen offset:2048 lds
  buffer_load_dwordx4 v59, s[12:15], s36 offen offset:3072 lds
  s_add_u32 s30, s30, 12288
  s_cmp_eq_u32 s30, 86016
  s_cselect_b32 s30, 0, s30
  v_mov_b32 v6, s71
  s_mov_b32 s38, 0
.g2_kernel_wg36:
  ds_read_b32 v7, v6 offset:20
  s_add_u32 s38, s38, 1
  s_waitcnt lgkmcnt(0)
  v_cmp_gt_u32 vcc, 4, v7
  s_cbranch_vccz .g2_kernel_wg36d
  s_sleep 1
  s_cmp_lt_u32 s38, 524288
  s_cbranch_scc1 .g2_kernel_wg36
.g2_kernel_wg36d:
  s_mov_b32 s62, 1
  s_mov_b32 s63, 0x1800000
  s_mov_b32 s70, 2
  s_mov_b32 s71, 155776
  s_xor_b32 s36, s18, 2
  s_mul_i32 s36, s36, 393216
  s_add_u32 s36, s36, s39
  s_add_u32 s36, s36, 196608
  s_add_u32 m0, s30, 65536
  s_waitcnt vmcnt(63)
  buffer_load_dwordx4 v48, s[12:15], s36 offen offset:0 lds
  buffer_load_dwordx4 v49, s[12:15], s36 offen offset:1024 lds
  buffer_load_dwordx4 v50, s[12:15], s36 offen offset:2048 lds
  buffer_load_dwordx4 v51, s[12:15], s36 offen offset:3072 lds
  s_add_u32 m0, s30, 69632
  s_waitcnt vmcnt(63)
  buffer_load_dwordx4 v52, s[12:15], s36 offen offset:0 lds
  buffer_load_dwordx4 v53, s[12:15], s36 offen offset:1024 lds
  buffer_load_dwordx4 v54, s[12:15], s36 offen offset:2048 lds
  buffer_load_dwordx4 v55, s[12:15], s36 offen offset:3072 lds
  s_add_u32 m0, s30, 73728
  s_waitcnt vmcnt(63)
  buffer_load_dwordx4 v56, s[12:15], s36 offen offset:0 lds
  buffer_load_dwordx4 v57, s[12:15], s36 offen offset:1024 lds
  buffer_load_dwordx4 v58, s[12:15], s36 offen offset:2048 lds
  buffer_load_dwordx4 v59, s[12:15], s36 offen offset:3072 lds
  s_add_u32 s30, s30, 12288
  s_cmp_eq_u32 s30, 86016
  s_cselect_b32 s30, 0, s30
  s_xor_b32 s36, s18, 3
  s_mul_i32 s36, s36, 393216
  s_add_u32 s36, s36, s39
  s_add_u32 m0, s30, 65536
  s_waitcnt vmcnt(63)
  buffer_load_dwordx4 v48, s[12:15], s36 offen offset:0 lds
  buffer_load_dwordx4 v49, s[12:15], s36 offen offset:1024 lds
  buffer_load_dwordx4 v50, s[12:15], s36 offen offset:2048 lds
  buffer_load_dwordx4 v51, s[12:15], s36 offen offset:3072 lds
  s_add_u32 m0, s30, 69632
  s_waitcnt vmcnt(63)
  buffer_load_dwordx4 v52, s[12:15], s36 offen offset:0 lds
  buffer_load_dwordx4 v53, s[12:15], s36 offen offset:1024 lds
  buffer_load_dwordx4 v54, s[12:15], s36 offen offset:2048 lds
  buffer_load_dwordx4 v55, s[12:15], s36 offen offset:3072 lds
  s_add_u32 m0, s30, 73728
  s_waitcnt vmcnt(63)
  buffer_load_dwordx4 v56, s[12:15], s36 offen offset:0 lds
  buffer_load_dwordx4 v57, s[12:15], s36 offen offset:1024 lds
  buffer_load_dwordx4 v58, s[12:15], s36 offen offset:2048 lds
  buffer_load_dwordx4 v59, s[12:15], s36 offen offset:3072 lds
  s_add_u32 s30, s30, 12288
  s_cmp_eq_u32 s30, 86016
  s_cselect_b32 s30, 0, s30
  s_mov_b32 s28, 1
  s_mov_b32 s29, 16384
  s_bitcmp1_b32 s37, s28
  s_cbranch_scc0 .g2_kernel_p2_x0w
.g2_kernel_p2_x0b:
  s_xor_b32 s33, s28, s18
  s_lshl_b32 s33, s33, 14
  s_add_u32 s33, s33, s32
  s_add_u32 m0, s29, 0
  s_waitcnt vmcnt(63)
  buffer_load_dwordx4 v3, s[4:7], s33 offen offset:0 lds
  buffer_load_dwordx4 v3, s[4:7], s33 offen offset:1024 lds
  buffer_load_dwordx4 v3, s[4:7], s33 offen offset:2048 lds
  buffer_load_dwordx4 v3, s[4:7], s33 offen offset:3072 lds
  s_add_u32 m0, s29, 4096
  s_waitcnt vmcnt(63)
  s_add_u32 s33, s33, 4096
  buffer_load_dwordx4 v3, s[4:7], s33 offen offset:0 lds
  buffer_load_dwordx4 v3, s[4:7], s33 offen offset:1024 lds
  buffer_load_dwordx4 v3, s[4:7], s33 offen offset:2048 lds
  buffer_load_dwordx4 v3, s[4:7], s33 offen offset:3072 lds
  s_add_u32 m0, s29, 8192
  s_waitcnt vmcnt(63)
  s_add_u32 s33, s33, 4096
  buffer_load_dwordx4 v3, s[4:7], s33 offen offset:0 lds
  buffer_load_dwordx4 v3, s[4:7], s33 offen offset:1024 lds
  buffer_load_dwordx4 v3, s[4:7], s33 offen offset:2048 lds
  buffer_load_dwordx4 v3, s[4:7], s33 offen offset:3072 lds
  s_add_u32 m0, s29, 12288
  s_waitcnt vmcnt(63)
  s_add_u32 s33, s33, 4096
  buffer_load_dwordx4 v3, s[4:7], s33 offen offset:0 lds
  buffer_load_dwordx4 v3, s[4:7], s33 offen offset:1024 lds
  buffer_load_dwordx4 v3, s[4:7], s33 offen offset:2048 lds
  buffer_load_dwordx4 v3, s[4:7], s33 offen offset:3072 lds
  s_mov_b32 m0, 156160
  s_mov_b32 s35, .g2_kernel_tab-.g2_kernel_pc+144
  s_mov_b64 exec, 1
  buffer_load_dword off, s[64:67], s35 lds
  s_mov_b64 exec, -1
  s_mov_b32 s28, 2
  s_mov_b32 s29, 32768
  s_bitcmp1_b32 s37, s28
  s_cbranch_scc0 .g2_kernel_p2_x1w
.g2_kernel_p2_x1b:
  s_xor_b32 s33, s28, s18
  s_lshl_b32 s33, s33, 14
  s_add_u32 s33, s33, s32
  s_add_u32 m0, s29, 0
  s_waitcnt vmcnt(63)
  buffer_load_dwordx4 v3, s[4:7], s33 offen offset:0 lds
  buffer_load_dwordx4 v3, s[4:7], s33 offen offset:1024 lds
  buffer_load_dwordx4 v3, s[4:7], s33 offen offset:2048 lds
  buffer_load_dwordx4 v3, s[4:7], s33 offen offset:3072 lds
  s_add_u32 m0, s29, 4096
  s_waitcnt vmcnt(63)
  s_add_u32 s33, s33, 4096
  buffer_load_dwordx4 v3, s[4:7], s33 offen offset:0 lds
  buffer_load_dwordx4 v3, s[4:7], s33 offen offset:1024 lds
  buffer_load_dwordx4 v3, s[4:7], s33 offen offset:2048 lds
  buffer_load_dwordx4 v3, s[4:7], s33 offen offset:3072 lds
  s_add_u32 m0, s29, 8192
  s_waitcnt vmcnt(63)
  s_add_u32 s33, s33, 4096
  buffer_load_dwordx4 v3, s[4:7], s33 offen offset:0 lds
  buffer_load_dwordx4 v3, s[4:7], s33 offen offset:1024 lds
  buffer_load_dwordx4 v3, s[4:7], s33 offen offset:2048 lds
  buffer_load_dwordx4 v3, s[4:7], s33 offen offset:3072 lds
  s_add_u32 m0, s29, 12288
  s_waitcnt vmcnt(63)
  s_add_u32 s33, s33, 4096
  buffer_load_dwordx4 v3, s[4:7], s33 offen offset:0 lds
  buffer_load_dwordx4 v3, s[4:7], s33 offen offset:1024 lds
  buffer_load_dwordx4 v3, s[4:7], s33 offen offset:2048 lds
  buffer_load_dwordx4 v3, s[4:7], s33 offen offset:3072 lds
  s_mov_b32 m0, 156160
  s_mov_b32 s35, .g2_kernel_tab-.g2_kernel_pc+152
  s_mov_b64 exec, 1
  buffer_load_dword off, s[64:67], s35 lds
  s_mov_b64 exec, -1
  s_mov_b32 s28, 3
  s_mov_b32 s29, 49152
  s_bitcmp1_b32 s37, s28
  s_cbranch_scc0 .g2_kernel_p2_x2w
.g2_kernel_p2_x2b:
  s_xor_b32 s33, s28, s18
  s_lshl_b32 s33, s33, 14
  s_add_u32 s33, s33, s32
  s_add_u32 m0, s29, 0
  s_waitcnt vmcnt(63)
  buffer_load_dwordx4 v3, s[4:7], s33 offen offset:0 lds
  buffer_load_dwordx4 v3, s[4:7], s33 offen offset:1024 lds
  buffer_load_dwordx4 v3, s[4:7], s33 offen offset:2048 lds
  buffer_load_dwordx4 v3, s[4:7], s33 offen offset:3072 lds
  s_add_u32 m0, s29, 4096
  s_waitcnt vmcnt(63)
  s_add_u32 s33, s33, 4096
  buffer_load_dwordx4 v3, s[4:7], s33 offen offset:0 lds
  buffer_load_dwordx4 v3, s[4:7], s33 offen offset:1024 lds
  buffer_load_dwordx4 v3, s[4:7], s33 offen offset:2048 lds
  buffer_load_dwordx4 v3, s[4:7], s33 offen offset:3072 lds
  s_add_u32 m0, s29, 8192
  s_waitcnt vmcnt(63)
  s_add_u32 s33, s33, 4096
  buffer_load_dwordx4 v3, s[4:7], s33 offen offset:0 lds
  buffer_load_dwordx4 v3, s[4:7], s33 offen offset:1024 lds
  buffer_load_dwordx4 v3, s[4:7], s33 offen offset:2048 lds
  buffer_load_dwordx4 v3, s[4:7], s33 offen offset:3072 lds
  s_add_u32 m0, s29, 12288
  s_waitcnt vmcnt(63)
  s_add_u32 s33, s33, 4096
  buffer_load_dwordx4 v3, s[4:7], s33 offen offset:0 lds
  buffer_load_dwordx4 v3, s[4:7], s33 offen offset:1024 lds
  buffer_load_dwordx4 v3, s[4:7], s33 offen offset:2048 lds
  buffer_load_dwordx4 v3, s[4:7], s33 offen offset:3072 lds
  s_mov_b32 m0, 156160
  s_mov_b32 s35, .g2_kernel_tab-.g2_kernel_pc+156
  s_mov_b64 exec, 1
  buffer_load_dword off, s[64:67], s35 lds
  s_mov_b64 exec, -1
  s_xor_b32 s36, s18, 3
  s_mul_i32 s36, s36, 393216
  s_add_u32 s36, s36, s39
  s_add_u32 s36, s36, 196608
  ds_read_b32 v10, v9
  s_mov_b32 s34, 33
  s_mov_b32 s35, .g2_kernel_tab-.g2_kernel_pc+160
  s_branch .g2_kernel_p2_o
  .p2align 6
.g2_kernel_p2_l:
  s_waitcnt lgkmcnt(0)
  v_cmp_gt_i32 vcc, s34, v10
  s_cbranch_vccnz .g2_kernel_p2_aw
.g2_kernel_p2_ai:
  s_add_u32 s29, s29, 16384
  s_and_b32 s29, s29, 0xffff
  s_bitcmp1_b32 s37, s28
  s_cbranch_scc0 .g2_kernel_p2_x3w
.g2_kernel_p2_x3b:
  s_xor_b32 s33, s28, s18
  s_lshl_b32 s33, s33, 14
  s_add_u32 s33, s33, s32
  s_add_u32 m0, s29, 0
  s_waitcnt vmcnt(63)
  buffer_load_dwordx4 v3, s[4:7], s33 offen offset:0 lds
  buffer_load_dwordx4 v3, s[4:7], s33 offen offset:1024 lds
  buffer_load_dwordx4 v3, s[4:7], s33 offen offset:2048 lds
  buffer_load_dwordx4 v3, s[4:7], s33 offen offset:3072 lds
  s_add_u32 m0, s29, 4096
  s_waitcnt vmcnt(63)
  s_add_u32 s33, s33, 4096
  buffer_load_dwordx4 v3, s[4:7], s33 offen offset:0 lds
  buffer_load_dwordx4 v3, s[4:7], s33 offen offset:1024 lds
  buffer_load_dwordx4 v3, s[4:7], s33 offen offset:2048 lds
  buffer_load_dwordx4 v3, s[4:7], s33 offen offset:3072 lds
  s_add_u32 m0, s29, 8192
  s_waitcnt vmcnt(63)
  s_add_u32 s33, s33, 4096
  buffer_load_dwordx4 v3, s[4:7], s33 offen offset:0 lds
  buffer_load_dwordx4 v3, s[4:7], s33 offen offset:1024 lds
  buffer_load_dwordx4 v3, s[4:7], s33 offen offset:2048 lds
  buffer_load_dwordx4 v3, s[4:7], s33 offen offset:3072 lds
  s_add_u32 m0, s29, 12288
  s_waitcnt vmcnt(63)
  s_add_u32 s33, s33, 4096
  buffer_load_dwordx4 v3, s[4:7], s33 offen offset:0 lds
  buffer_load_dwordx4 v3, s[4:7], s33 offen offset:1024 lds
  buffer_load_dwordx4 v3, s[4:7], s33 offen offset:2048 lds
  buffer_load_dwordx4 v3, s[4:7], s33 offen offset:3072 lds
  s_add_u32 m0, s30, 65536
  s_waitcnt vmcnt(63)
  buffer_load_dwordx4 v48, s[12:15], s36 offen offset:0 lds
  buffer_load_dwordx4 v49, s[12:15], s36 offen offset:1024 lds
  buffer_load_dwordx4 v50, s[12:15], s36 offen offset:2048 lds
  buffer_load_dwordx4 v51, s[12:15], s36 offen offset:3072 lds
  s_add_u32 m0, s30, 69632
  s_waitcnt vmcnt(63)
  buffer_load_dwordx4 v52, s[12:15], s36 offen offset:0 lds
  buffer_load_dwordx4 v53, s[12:15], s36 offen offset:1024 lds
  buffer_load_dwordx4 v54, s[12:15], s36 offen offset:2048 lds
  buffer_load_dwordx4 v55, s[12:15], s36 offen offset:3072 lds
  s_add_u32 m0, s30, 73728
  s_waitcnt vmcnt(63)
  buffer_load_dwordx4 v56, s[12:15], s36 offen offset:0 lds
  buffer_load_dwordx4 v57, s[12:15], s36 offen offset:1024 lds
  buffer_load_dwordx4 v58, s[12:15], s36 offen offset:2048 lds
  buffer_load_dwordx4 v59, s[12:15], s36 offen offset:3072 lds
  s_add_u32 s30, s30, 12288
  s_cmp_eq_u32 s30, 86016
  s_cselect_b32 s30, 0, s30
  ds_read_b32 v10, v9
  s_mov_b32 m0, 156160
  s_add_u32 s34, s34, 1
  s_mov_b64 exec, 1
  buffer_load_dword off, s[64:67], s35 lds
  s_mov_b64 exec, -1
  s_add_u32 s35, s35, 4
  s_add_u32 s36, s36, 196608
.g2_kernel_p2_o:
  s_waitcnt lgkmcnt(0)
  v_cmp_gt_i32 vcc, s34, v10
  s_cbranch_vccnz .g2_kernel_p2_bw
.g2_kernel_p2_bi:
  s_add_u32 m0, s30, 65536
  s_waitcnt vmcnt(63)
  buffer_load_dwordx4 v48, s[12:15], s36 offen offset:0 lds
  buffer_load_dwordx4 v49, s[12:15], s36 offen offset:1024 lds
  buffer_load_dwordx4 v50, s[12:15], s36 offen offset:2048 lds
  buffer_load_dwordx4 v51, s[12:15], s36 offen offset:3072 lds
  s_add_u32 m0, s30, 69632
  s_waitcnt vmcnt(63)
  buffer_load_dwordx4 v52, s[12:15], s36 offen offset:0 lds
  buffer_load_dwordx4 v53, s[12:15], s36 offen offset:1024 lds
  buffer_load_dwordx4 v54, s[12:15], s36 offen offset:2048 lds
  buffer_load_dwordx4 v55, s[12:15], s36 offen offset:3072 lds
  s_add_u32 m0, s30, 73728
  s_waitcnt vmcnt(63)
  buffer_load_dwordx4 v56, s[12:15], s36 offen offset:0 lds
  buffer_load_dwordx4 v57, s[12:15], s36 offen offset:1024 lds
  buffer_load_dwordx4 v58, s[12:15], s36 offen offset:2048 lds
  buffer_load_dwordx4 v59, s[12:15], s36 offen offset:3072 lds
  s_add_u32 s30, s30, 12288
  s_cmp_eq_u32 s30, 86016
  s_cselect_b32 s30, 0, s30
  ds_read_b32 v10, v9
  s_mov_b32 m0, 156160
  s_add_u32 s34, s34, 1
  s_mov_b64 exec, 1
  buffer_load_dword off, s[64:67], s35 lds
  s_mov_b64 exec, -1
  s_add_u32 s35, s35, 4
  s_add_u32 s28, s28, 1
  s_xor_b32 s36, s18, s28
  s_mul_i32 s36, s36, 393216
  s_add_u32 s36, s36, s39
  s_cmp_lt_i32 s34, 58
  s_cbranch_scc1 .g2_kernel_p2_l
  s_branch .g2_kernel_v
.g2_kernel_c1:
  v_mov_b32 v6, s71
  s_mov_b32 s38, 0
.g2_kernel_wg37:
  ds_read_b32 v7, v6 offset:76
  s_add_u32 s38, s38, 1
  s_waitcnt lgkmcnt(0)
  v_cmp_gt_u32 vcc, 1, v7
  s_cbranch_vccz .g2_kernel_wg37d
  s_sleep 1
  s_cmp_lt_u32 s38, 524288
  s_cbranch_scc1 .g2_kernel_wg37
.g2_kernel_wg37d:
  s_sleep 4
  s_and_b32 s31, s19, 0xffffe000
  s_add_u32 s31, s31, 4
  v_and_b32 v6, 15, v2
  v_lshlrev_b32 v6, 9, v6
  v_lshrrev_b32 v7, 4, v2
  v_lshl_add_u32 v6, v7, 7, v6
  v_lshlrev_b32 v7, 2, v2
  v_add_u32 v7, 157952, v7
  s_mov_b32 m0, 157952
  s_mov_b32 s38, 0
  s_bfm_b64 exec, 16, 48
.g2_kernel_pa38:
  buffer_load_dword v6, s[4:7], s31 offen sc1 lds
  s_add_u32 s38, s38, 1
  s_waitcnt vmcnt(0)
  ds_read_b32 v8, v7
  s_waitcnt lgkmcnt(0)
  v_cmp_ge_u32 vcc, s62, v8
  s_cbranch_vccz .g2_kernel_pa38d
  s_mov_b64 exec, vcc
  s_sleep 4
  s_cmp_lt_u32 s38, 131072
  s_cbranch_scc1 .g2_kernel_pa38
.g2_kernel_pa38d:
  s_mov_b64 exec, -1
  s_setprio 2
  s_mov_b32 s39, 0
  s_lshl_b32 s30, s17, 2
  s_lshr_b32 s28, s18, 2
  s_add_u32 s30, s30, s28
  s_lshl_b32 s20, s30, 13
  s_add_u32 s20, s20, s63
  s_add_u32 s20, s20, 0x1000000
  s_add_u32 s24, s20, 4096
  s_lshl_b32 s21, s30, 8
  s_add_u32 s21, s21, s63
  s_add_u32 s21, s21, 0x1080000
  s_lshl_b32 s23, s62, 16
  s_add_u32 s23, s23, 0x3040000
  s_lshl_b32 s22, s30, 7
  s_add_u32 s22, s22, s23
  s_and_b32 s28, s2, 7
  s_lshl_b32 s28, s28, 13
  s_add_u32 s23, s23, s28
  v_mov_b32 v9, 155648
  ds_read_b32 v26, v9 offset:256
  v_and_b32 v24, 31, v2
  v_lshlrev_b32 v25, 3, v2
  v_lshlrev_b32 v27, 13, v2
  v_mov_b32 v28, 0.0009765625
  v_mov_b32 v30, 1e-05
  v_mov_b32 v6, s71
  s_mov_b32 s38, 0
.g2_kernel_wg40:
  ds_read_b32 v7, v6 offset:20
  s_add_u32 s38, s38, 1
  s_waitcnt lgkmcnt(0)
  v_cmp_gt_u32 vcc, 4, v7
  s_cbranch_vccz .g2_kernel_wg40d
  s_sleep 1
  s_cmp_lt_u32 s38, 524288
  s_cbranch_scc1 .g2_kernel_wg40
.g2_kernel_wg40d:
  s_sleep 12
  s_cmp_lg_u32 s62, 0
  s_cbranch_scc1 .g2_kernel_nap41
  s_sleep 12
.g2_kernel_nap41:
  s_xor_b32 s28, s17, s18
  s_and_b32 s28, s28, 3
  s_cbranch_scc1 .g2_kernel_c_l1
  s_mov_b32 s38, 0
.g2_kernel_gx42:
  buffer_load_dwordx4 v[32:35], v3, s[4:7], s20 offen offset:0 sc1
  buffer_load_dwordx4 v[36:39], v3, s[4:7], s20 offen offset:1024 sc1
  buffer_load_dwordx4 v[40:43], v3, s[4:7], s20 offen offset:2048 sc1
  buffer_load_dwordx4 v[44:47], v3, s[4:7], s20 offen offset:3072 sc1
  buffer_load_dwordx4 v[48:51], v3, s[4:7], s24 offen offset:0 sc1
  buffer_load_dwordx4 v[52:55], v3, s[4:7], s24 offen offset:1024 sc1
  buffer_load_dwordx4 v[56:59], v3, s[4:7], s24 offen offset:2048 sc1
  buffer_load_dwordx4 v[60:63], v3, s[4:7], s24 offen offset:3072 sc1
  s_add_u32 s38, s38, 1
  s_waitcnt vmcnt(0)
  v_min3_u32 v6, v32, v35, v36
  v_min3_u32 v6, v6, v39, v40
  v_min3_u32 v6, v6, v43, v44
  v_min3_u32 v6, v6, v47, v48
  v_min3_u32 v6, v6, v51, v52
  v_min3_u32 v6, v6, v55, v56
  v_min3_u32 v6, v6, v59, v60
  v_min_u32 v6, v6, v63
  v_cmp_eq_u32 vcc, 0, v6
  s_cbranch_vccz .g2_kernel_gx42d
  s_mov_b64 exec, vcc
  s_sleep 1
  s_cmp_lg_u32 s62, 0
  s_cbranch_scc1 .g2_kernel_nap43
  s_sleep 9
.g2_kernel_nap43:
  s_cmp_lt_u32 s38, 131072
  s_cbranch_scc1 .g2_kernel_gx42
.g2_kernel_gx42d:
  s_mov_b64 exec, -1
  v_add_f32 v32, v32, v48
  v_add_f32 v33, v33, v49
  v_add_f32 v34, v34, v50
  v_add_f32 v36, v36, v52
  v_add_f32 v37, v37, v53
  v_add_f32 v38, v38, v54
  v_add_f32 v40, v40, v56
  v_add_f32 v41, v41, v57
  v_add_f32 v42, v42, v58
  v_add_f32 v44, v44, v60
  v_add_f32 v45, v45, v61
  v_add_f32 v46, v46, v62
  v_add_f32 v32, v32, v40
  v_add_f32 v33, v33, v41
  v_add_f32 v34, v34, v42
  v_add_f32 v36, v36, v44
  v_add_f32 v37, v37, v45
  v_add_f32 v38, v38, v46
  v_add_f32 v32, v32, v36
  v_add_f32 v33, v33, v37
  v_add_f32 v34, v34, v38
  v_mov_b32 v16, v32
  v_mov_b32 v17, v33
  v_mov_b32 v18, v34
  s_mov_b32 s28, -32
  v_permlane32_swap_b32 v16, v32
  v_permlane32_swap_b32 v17, v33
  v_permlane32_swap_b32 v18, v34
  v_add_f32 v16, v16, v32
  v_add_f32 v17, v17, v33
  v_add_f32 v18, v18, v34
  v_fma_f32 v18, -v16, v26, v18
  v_mul_f32 v16, v28, v16
  v_mul_f32 v19, v16, v16
  v_fma_f32 v17, v17, v28, -v19
  v_max_f32 v17, 0, v17
  v_add_f32 v17, v30, v17
  v_rsq_f32 v19, v17
  v_mov_b32 v11, 1
  v_mul_f32 v18, v18, v19
  v_and_or_b32 v10, v18, s28, v24
  s_nop 1
  v_max_f32 v10, v10, v10 row_ror:8 row_mask:0xf bank_mask:0xf
  s_nop 1
  v_max_f32 v10, v10, v10 row_ror:4 row_mask:0xf bank_mask:0xf
  s_nop 1
  v_max_f32 v10, v10, v10 row_ror:2 row_mask:0xf bank_mask:0xf
  s_nop 1
  v_max_f32 v10, v10, v10 row_ror:1 row_mask:0xf bank_mask:0xf
  s_nop 1
  v_max_f32 v10, v10, v10 row_bcast:15 row_mask:0xa bank_mask:0xf
  s_nop 0
  v_readlane_b32 s28, v10, 31
  s_nop 1
  v_mov_b32 v10, s28
  s_mov_b64 exec, 0xff
  buffer_store_dwordx2 v[10:11], v27, s[4:7], s22 offen sc1
  s_mov_b32 exec_lo, -1
  buffer_store_dwordx2 v[16:17], v25, s[4:7], s21 offen sc1
  s_mov_b64 exec, -1
.g2_kernel_c_l1:
  s_cmp_lg_u32 s62, 0
  s_cbranch_scc1 .g2_kernel_c_t3
  s_sleep 30
  s_mov_b64 s[8:9], -1
  s_call_b64 s[68:69], .g2_kernel_amax
  s_lshr_b32 s28, s77, 5
  s_add_u32 m0, s71, 104
  s_lshl_b32 s29, s28, 2
  s_add_u32 s29, s29, .g2_kernel_tab-.g2_kernel_pc
  s_mov_b64 exec, 1
  buffer_load_dword off, s[64:67], s29 lds
  s_mov_b64 exec, -1
  s_and_b32 s28, s77, 31
  s_add_u32 s28, s28, 1
  s_add_u32 m0, s71, 36
  s_lshl_b32 s29, s28, 2
  s_add_u32 s29, s29, .g2_kernel_tab-.g2_kernel_pc
  s_mov_b64 exec, 1
  buffer_load_dword off, s[64:67], s29 lds
  s_mov_b64 exec, -1
  s_lshr_b32 s24, s77, 7
  s_lshl_b32 s24, s24, 18
  s_bfe_u32 s28, s77, 0x30004
  s_lshl_b32 s28, s28, 11
  s_add_u32 s24, s24, s28
  s_and_b32 s28, s77, 15
  s_lshl_b32 s28, s28, 4
  s_add_u32 s24, s24, s28
  s_add_u32 s24, s24, s63
  s_add_u32 s24, s24, 0xc00000
  s_lshl_b32 s28, s17, 14
  s_add_u32 s24, s24, s28
  s_and_b32 s28, s18, 1
  s_lshl_b32 s28, s28, 8
  s_add_u32 s24, s24, s28
  v_lshrrev_b32 v12, 3, v2
  v_lshlrev_b32 v13, 1, v12
  buffer_load_ushort v56, v13, s[4:7], s24 offen offset:0
  buffer_load_ushort v57, v13, s[4:7], s24 offen offset:512
  buffer_load_ushort v58, v13, s[4:7], s24 offen offset:1024
  buffer_load_ushort v59, v13, s[4:7], s24 offen offset:1536
  s_lshl_b32 s25, s77, 3
  s_add_u32 s25, s25, s63
  s_add_u32 s25, s25, 0x1080000
  s_lshl_b32 s21, s17, 10
  s_add_u32 s21, s21, s63
  s_add_u32 s21, s21, 0x1080000
  s_mov_b32 s38, 0
.g2_kernel_gx44:
  buffer_load_dwordx4 v[16:19], v3, s[4:7], s21 offen sc1
  buffer_load_dwordx2 v[20:21], v4, s[4:7], s25 offen sc1
  s_add_u32 s38, s38, 1
  s_waitcnt vmcnt(0)
  v_min3_u32 v6, v17, v19, v21
  v_cmp_eq_u32 vcc, 0, v6
  s_cbranch_vccz .g2_kernel_gx44d
  s_mov_b64 exec, vcc
  s_sleep 1
  s_cmp_lt_u32 s38, 131072
  s_cbranch_scc1 .g2_kernel_gx44
.g2_kernel_gx44d:
  s_mov_b64 exec, -1
  s_lshr_b32 s28, s77, 7
  s_and_b32 s79, s77, 127
  s_add_u32 s79, s79, 1
  s_cmp_eq_u32 s28, s17
  s_cselect_b32 s79, s79, 0
  v_rsq_f32 v22, v17
  v_rsq_f32 v23, v19
  v_rsq_f32 v21, v21
  v_mov_b32 v62, -1.4426950408889634
  v_mul_f32 v62, s27, v62
  v_exp_f32 v62, v62
  v_lshlrev_b32 v14, 3, v2
  v_add_u32 v14, 155648, v14
  v_mov_b32 v15, s79
  v_add_f32 v52, 1.0, v22
  v_mul_f32 v54, v16, v22
  v_sub_f32 v54, 0, v54
  v_add_f32 v53, 1.0, v23
  v_mul_f32 v55, v18, v23
  v_sub_f32 v55, 0, v55
  v_add_f32 v62, 1.0, v62
  v_rcp_f32 v62, v62
  v_add_f32 v60, 1.0, v21
  v_mul_f32 v61, v20, v21
  v_sub_f32 v61, 0, v61
  v_sub_f32 v17, v17, v30
  v_mul_f32 v48, v52, v52
  v_fma_f32 v48, v48, v17, v30
  v_rsq_f32 v48, v48
  s_nop 0
  v_mul_f32 v48, v48, v52
  v_mul_f32 v50, v48, v16
  v_sub_f32 v50, 0, v50
  v_sub_f32 v19, v19, v30
  v_mul_f32 v49, v53, v53
  v_fma_f32 v49, v49, v19, v30
  v_rsq_f32 v49, v49
  s_nop 0
  v_mul_f32 v49, v49, v53
  v_mul_f32 v51, v49, v18
  v_sub_f32 v51, 0, v51
  v_lshlrev_b32 v56, 16, v56
  v_fma_f32 v56, v56, v60, v61
  v_lshlrev_b32 v57, 16, v57
  v_fma_f32 v57, v57, v60, v61
  v_lshlrev_b32 v58, 16, v58
  v_fma_f32 v58, v58, v60, v61
  v_lshlrev_b32 v59, 16, v59
  v_fma_f32 v59, v59, v60, v61
  v_and_b32 v10, 7, v2
  v_lshlrev_b32 v10, 12, v10
  v_lshl_add_u32 v10, v12, 4, v10
  s_lshl_b32 s20, s17, 1
  s_and_b32 s28, s18, 1
  s_add_u32 s20, s20, s28
  s_lshl_b32 s20, s20, 7
  s_add_u32 s20, s20, s63
  s_add_u32 s20, s20, 0x1090000
  s_and_b32 s26, s18, 14
  s_lshl_b32 s26, s26, 4
  s_add_u32 s26, s26, s17
  s_lshl_b32 s26, s26, 1
  s_and_b32 s28, s18, 1
  s_add_u32 s26, s26, s28
  s_lshl_b32 s26, s26, 10
  s_add_u32 s26, s26, s63
  s_add_u32 s26, s26, 0x1190000
  s_add_u32 s25, s26, 32768
  s_lshl_b32 s21, s2, 12
  s_add_u32 s21, s21, 0x3200000
  v_lshlrev_b32 v14, 3, v2
  buffer_store_dwordx2 v[48:49], v14, s[4:7], s21 offen
  buffer_store_dwordx2 v[50:51], v14, s[4:7], s21 offen offset:512
  buffer_store_dwordx2 v[52:53], v14, s[4:7], s21 offen offset:1024
  buffer_store_dwordx2 v[54:55], v14, s[4:7], s21 offen offset:1536
  buffer_store_dword v15, v4, s[4:7], s21 offen offset:2048
  s_mov_b32 m0, 158464
  s_add_u32 s22, s21, 2048
  s_waitcnt vmcnt(0)
  buffer_load_dwordx4 v3, s[4:7], s21 offen lds
  buffer_load_dwordx4 v3, s[4:7], s21 offen offset:1024 lds
  s_mov_b32 m0, 155800
  s_mov_b64 exec, 1
  buffer_load_dword v4, s[4:7], s22 offen lds
  s_mov_b64 exec, -1
  s_add_u32 m0, s71, 128
  s_mov_b32 s29, .g2_kernel_tab-.g2_kernel_pc+8
  s_mov_b64 exec, 1
  buffer_load_dword off, s[64:67], s29 lds
  s_mov_b64 exec, -1
  s_lshl_b32 s28, s2, 10
  s_and_b32 s28, s28, 0xe000
  v_lshlrev_b32 v7, 7, v2
  buffer_load_dword v1, v7, s[64:67], s28 offen
  v_mov_b32 v6, s71
  s_mov_b32 s38, 0
.g2_kernel_wg45:
  ds_read_b32 v7, v6 offset:112
  s_add_u32 s38, s38, 1
  s_waitcnt lgkmcnt(0)
  v_cmp_gt_u32 vcc, 1, v7
  s_cbranch_vccz .g2_kernel_wg45d
  s_sleep 2
  s_cmp_lt_u32 s38, 524288
  s_cbranch_scc1 .g2_kernel_wg45
.g2_kernel_wg45d:
  s_sleep 8
  s_cmp_lg_u32 s62, 0
  s_cbranch_scc1 .g2_kernel_nap46
  s_sleep 22
.g2_kernel_nap46:
  s_mov_b32 s38, 0
.g2_kernel_gx47:
  s_mov_b32 s21, s20
  buffer_load_dwordx4 v[160:163], v10, s[4:7], s21 offen sc1
  s_add_u32 s21, s21, 32768
  buffer_load_dwordx4 v[164:167], v10, s[4:7], s21 offen sc1
  s_add_u32 s21, s21, 32768
  buffer_load_dwordx4 v[168:171], v10, s[4:7], s21 offen sc1
  s_add_u32 s21, s21, 32768
  buffer_load_dwordx4 v[172:175], v10, s[4:7], s21 offen sc1
  s_add_u32 s21, s21, 32768
  buffer_load_dwordx4 v[176:179], v10, s[4:7], s21 offen sc1
  s_add_u32 s21, s21, 32768
  buffer_load_dwordx4 v[180:183], v10, s[4:7], s21 offen sc1
  s_add_u32 s21, s21, 32768
  buffer_load_dwordx4 v[184:187], v10, s[4:7], s21 offen sc1
  s_add_u32 s21, s21, 32768
  buffer_load_dwordx4 v[188:191], v10, s[4:7], s21 offen sc1
  s_add_u32 s21, s21, 32768
  buffer_load_dwordx4 v[192:195], v10, s[4:7], s21 offen sc1
  s_add_u32 s21, s21, 32768
  buffer_load_dwordx4 v[196:199], v10, s[4:7], s21 offen sc1
  s_add_u32 s21, s21, 32768
  buffer_load_dwordx4 v[200:203], v10, s[4:7], s21 offen sc1
  s_add_u32 s21, s21, 32768
  buffer_load_dwordx4 v[204:207], v10, s[4:7], s21 offen sc1
  s_add_u32 s21, s21, 32768
  buffer_load_dwordx4 v[208:211], v10, s[4:7], s21 offen sc1
  s_add_u32 s21, s21, 32768
  buffer_load_dwordx4 v[212:215], v10, s[4:7], s21 offen sc1
  s_add_u32 s21, s21, 32768
  buffer_load_dwordx4 v[216:219], v10, s[4:7], s21 offen sc1
  s_add_u32 s21, s21, 32768
  buffer_load_dwordx4 v[220:223], v10, s[4:7], s21 offen sc1
  s_add_u32 s21, s21, 32768
  buffer_load_dwordx4 v[224:227], v10, s[4:7], s21 offen sc1
  s_add_u32 s21, s21, 32768
  buffer_load_dwordx4 v[228:231], v10, s[4:7], s21 offen sc1
  s_add_u32 s21, s21, 32768
  buffer_load_dwordx4 v[232:235], v10, s[4:7], s21 offen sc1
  s_add_u32 s21, s21, 32768
  buffer_load_dwordx4 v[236:239], v10, s[4:7], s21 offen sc1
  s_add_u32 s21, s21, 32768
  buffer_load_dwordx4 v[240:243], v10, s[4:7], s21 offen sc1
  s_add_u32 s21, s21, 32768
  buffer_load_dwordx4 v[244:247], v10, s[4:7], s21 offen sc1
  s_add_u32 s21, s21, 32768
  buffer_load_dwordx4 v[248:251], v10, s[4:7], s21 offen sc1
  s_add_u32 s21, s21, 32768
  buffer_load_dwordx4 v[252:255], v10, s[4:7], s21 offen sc1
  s_add_u32 s21, s21, 32768
  buffer_load_dwordx4 v[16:19], v10, s[4:7], s21 offen sc1
  s_add_u32 s21, s21, 32768
  buffer_load_dwordx4 v[20:23], v10, s[4:7], s21 offen sc1
  s_add_u32 s21, s21, 32768
  buffer_load_dwordx4 v[24:27], v10, s[4:7], s21 offen sc1
  s_add_u32 s21, s21, 32768
  buffer_load_dwordx4 v[28:31], v10, s[4:7], s21 offen sc1
  s_add_u32 s21, s21, 32768
  s_add_u32 s38, s38, 1
  s_waitcnt vmcnt(0)
  v_min3_u32 v6, v160, v162, v164
  v_min3_u32 v6, v6, v166, v168
  v_min3_u32 v6, v6, v170, v172
  v_min3_u32 v6, v6, v174, v176
  v_min3_u32 v6, v6, v178, v180
  v_min3_u32 v6, v6, v182, v184
  v_min3_u32 v6, v6, v186, v188
  v_min3_u32 v6, v6, v190, v192
  v_min3_u32 v6, v6, v194, v196
  v_min3_u32 v6, v6, v198, v200
  v_min3_u32 v6, v6, v202, v204
  v_min3_u32 v6, v6, v206, v208
  v_min3_u32 v6, v6, v210, v212
  v_min3_u32 v6, v6, v214, v216
  v_min3_u32 v6, v6, v218, v220
  v_min3_u32 v6, v6, v222, v224
  v_min3_u32 v6, v6, v226, v228
  v_min3_u32 v6, v6, v230, v232
  v_min3_u32 v6, v6, v234, v236
  v_min3_u32 v6, v6, v238, v240
  v_min3_u32 v6, v6, v242, v244
  v_min3_u32 v6, v6, v246, v248
  v_min3_u32 v6, v6, v250, v252
  v_min3_u32 v6, v6, v254, v16
  v_min3_u32 v6, v6, v18, v20
  v_min3_u32 v6, v6, v22, v24
  v_min3_u32 v6, v6, v26, v28
  v_min_u32 v6, v6, v30
  v_cmp_eq_u32 vcc, 0, v6
  s_cbranch_vccz .g2_kernel_gx47d
  s_mov_b64 exec, vcc
  s_sleep 1
  s_cmp_lg_u32 s62, 0
  s_cbranch_scc1 .g2_kernel_nap48
  s_sleep 11
.g2_kernel_nap48:
  s_cmp_lt_u32 s38, 131072
  s_cbranch_scc1 .g2_kernel_gx47
.g2_kernel_gx47d:
  s_mov_b64 exec, -1
  v_add_f32 v164, v164, v160
  v_add_f32 v165, v165, v161
  v_add_f32 v166, v166, v162
  v_add_f32 v167, v167, v163
  v_add_f32 v172, v172, v168
  v_add_f32 v173, v173, v169
  v_add_f32 v174, v174, v170
  v_add_f32 v175, v175, v171
  v_add_f32 v180, v180, v176
  v_add_f32 v181, v181, v177
  v_add_f32 v182, v182, v178
  v_add_f32 v183, v183, v179
  v_add_f32 v188, v188, v184
  v_add_f32 v189, v189, v185
  v_add_f32 v190, v190, v186
  v_add_f32 v191, v191, v187
  v_add_f32 v196, v196, v192
  v_add_f32 v197, v197, v193
  v_add_f32 v198, v198, v194
  v_add_f32 v199, v199, v195
  v_add_f32 v204, v204, v200
  v_add_f32 v205, v205, v201
  v_add_f32 v206, v206, v202
  v_add_f32 v207, v207, v203
  v_add_f32 v212, v212, v208
  v_add_f32 v213, v213, v209
  v_add_f32 v214, v214, v210
  v_add_f32 v215, v215, v211
  v_add_f32 v220, v220, v216
  v_add_f32 v221, v221, v217
  v_add_f32 v222, v222, v218
  v_add_f32 v223, v223, v219
  v_add_f32 v228, v228, v224
  v_add_f32 v229, v229, v225
  v_add_f32 v230, v230, v226
  v_add_f32 v231, v231, v227
  v_add_f32 v236, v236, v232
  v_add_f32 v237, v237, v233
  v_add_f32 v238, v238, v234
  v_add_f32 v239, v239, v235
  v_add_f32 v244, v244, v240
  v_add_f32 v245, v245, v241
  v_add_f32 v246, v246, v242
  v_add_f32 v247, v247, v243
  v_add_f32 v252, v252, v248
  v_add_f32 v253, v253, v249
  v_add_f32 v254, v254, v250
  v_add_f32 v255, v255, v251
  v_add_f32 v20, v20, v16
  v_add_f32 v21, v21, v17
  v_add_f32 v22, v22, v18
  v_add_f32 v23, v23, v19
  v_add_f32 v28, v28, v24
  v_add_f32 v29, v29, v25
  v_add_f32 v30, v30, v26
  v_add_f32 v31, v31, v27
  v_add_f32 v172, v172, v164
  v_add_f32 v173, v173, v165
  v_add_f32 v174, v174, v166
  v_add_f32 v175, v175, v167
  v_add_f32 v188, v188, v180
  v_add_f32 v189, v189, v181
  v_add_f32 v190, v190, v182
  v_add_f32 v191, v191, v183
  v_add_f32 v204, v204, v196
  v_add_f32 v205, v205, v197
  v_add_f32 v206, v206, v198
  v_add_f32 v207, v207, v199
  v_add_f32 v220, v220, v212
  v_add_f32 v221, v221, v213
  v_add_f32 v222, v222, v214
  v_add_f32 v223, v223, v215
  v_add_f32 v236, v236, v228
  v_add_f32 v237, v237, v229
  v_add_f32 v238, v238, v230
  v_add_f32 v239, v239, v231
  v_add_f32 v252, v252, v244
  v_add_f32 v253, v253, v245
  v_add_f32 v254, v254, v246
  v_add_f32 v255, v255, v247
  v_add_f32 v28, v28, v20
  v_add_f32 v29, v29, v21
  v_add_f32 v30, v30, v22
  v_add_f32 v31, v31, v23
  v_add_f32 v188, v188, v172
  v_add_f32 v189, v189, v173
  v_add_f32 v190, v190, v174
  v_add_f32 v191, v191, v175
  v_add_f32 v220, v220, v204
  v_add_f32 v221, v221, v205
  v_add_f32 v222, v222, v206
  v_add_f32 v223, v223, v207
  v_add_f32 v252, v252, v236
  v_add_f32 v253, v253, v237
  v_add_f32 v254, v254, v238
  v_add_f32 v255, v255, v239
  v_add_f32 v220, v220, v188
  v_add_f32 v221, v221, v189
  v_add_f32 v222, v222, v190
  v_add_f32 v223, v223, v191
  v_add_f32 v28, v28, v252
  v_add_f32 v29, v29, v253
  v_add_f32 v30, v30, v254
  v_add_f32 v31, v31, v255
  v_add_f32 v28, v28, v220
  v_add_f32 v29, v29, v221
  v_add_f32 v30, v30, v222
  v_add_f32 v31, v31, v223
  v_add_f32 v28, v28, v28 quad_perm:[1,0,3,2] row_mask:0xf bank_mask:0xf
  v_add_f32 v29, v29, v29 quad_perm:[1,0,3,2] row_mask:0xf bank_mask:0xf
  v_add_f32 v30, v30, v30 quad_perm:[1,0,3,2] row_mask:0xf bank_mask:0xf
  v_add_f32 v31, v31, v31 quad_perm:[1,0,3,2] row_mask:0xf bank_mask:0xf
  v_add_f32 v28, v28, v28 quad_perm:[2,3,0,1] row_mask:0xf bank_mask:0xf
  v_add_f32 v29, v29, v29 quad_perm:[2,3,0,1] row_mask:0xf bank_mask:0xf
  v_add_f32 v30, v30, v30 quad_perm:[2,3,0,1] row_mask:0xf bank_mask:0xf
  v_add_f32 v31, v31, v31 quad_perm:[2,3,0,1] row_mask:0xf bank_mask:0xf
  v_add_f32 v28, v28, v28 row_half_mirror row_mask:0xf bank_mask:0xf
  v_add_f32 v29, v29, v29 row_half_mirror row_mask:0xf bank_mask:0xf
  v_add_f32 v30, v30, v30 row_half_mirror row_mask:0xf bank_mask:0xf
  v_add_f32 v31, v31, v31 row_half_mirror row_mask:0xf bank_mask:0xf
  v_mul_f32 v28, v28, v62
  v_mul_f32 v29, v29, v62
  v_mul_f32 v30, v30, v62
  v_mul_f32 v31, v31, v62
  v_cvt_pk_bf16_f32 v16, v28, v29
  v_cvt_pk_bf16_f32 v17, v30, v31
  s_mov_b32 s28, 0x00010001
  s_mov_b32 s29, 0x00010001
  v_mov_b32 v18, v16 row_ror:8 row_mask:0xf bank_mask:0xf
  v_mov_b32 v19, v17 row_ror:8 row_mask:0xf bank_mask:0xf
  v_lshlrev_b32 v28, 16, v16
  v_and_b32 v29, 0xffff0000, v16
  v_lshlrev_b32 v30, 16, v17
  v_and_b32 v31, 0xffff0000, v17
  v_cndmask_b32 v32, 0, v16, s[28:29]
  v_cndmask_b32 v33, 0, v17, s[28:29]
  v_cndmask_b32 v34, 0, v18, s[28:29]
  v_cndmask_b32 v35, 0, v19, s[28:29]
  s_lshl_b64 s[28:29], s[28:29], 1
  s_nop 0
  v_mfma_f32_16x16x32_bf16 v[160:163], v[32:35], v[64:67], 0
  v_mfma_f32_16x16x32_bf16 v[164:167], v[32:35], v[80:83], 0
  v_mfma_f32_16x16x32_bf16 v[168:171], v[32:35], v[96:99], 0
  v_mfma_f32_16x16x32_bf16 v[172:175], v[32:35], v[112:115], 0
  v_mfma_f32_16x16x32_bf16 v[176:179], v[32:35], v[128:131], 0
  v_mfma_f32_16x16x32_bf16 v[180:183], v[32:35], v[144:147], 0
  v_cndmask_b32 v36, 0, v16, s[28:29]
  v_cndmask_b32 v37, 0, v17, s[28:29]
  v_cndmask_b32 v38, 0, v18, s[28:29]
  v_cndmask_b32 v39, 0, v19, s[28:29]
  s_lshl_b64 s[28:29], s[28:29], 1
  s_nop 0
  v_mfma_f32_16x16x32_bf16 v[160:163], v[36:39], v[68:71], v[160:163]
  v_mfma_f32_16x16x32_bf16 v[164:167], v[36:39], v[84:87], v[164:167]
  v_mfma_f32_16x16x32_bf16 v[168:171], v[36:39], v[100:103], v[168:171]
  v_mfma_f32_16x16x32_bf16 v[172:175], v[36:39], v[116:119], v[172:175]
  v_mfma_f32_16x16x32_bf16 v[176:179], v[36:39], v[132:135], v[176:179]
  v_mfma_f32_16x16x32_bf16 v[180:183], v[36:39], v[148:151], v[180:183]
  v_cndmask_b32 v40, 0, v16, s[28:29]
  v_cndmask_b32 v41, 0, v17, s[28:29]
  v_cndmask_b32 v42, 0, v18, s[28:29]
  v_cndmask_b32 v43, 0, v19, s[28:29]
  s_lshl_b64 s[28:29], s[28:29], 1
  s_nop 0
  v_mfma_f32_16x16x32_bf16 v[160:163], v[40:43], v[72:75], v[160:163]
  v_mfma_f32_16x16x32_bf16 v[164:167], v[40:43], v[88:91], v[164:167]
  v_mfma_f32_16x16x32_bf16 v[168:171], v[40:43], v[104:107], v[168:171]
  v_mfma_f32_16x16x32_bf16 v[172:175], v[40:43], v[120:123], v[172:175]
  v_mfma_f32_16x16x32_bf16 v[176:179], v[40:43], v[136:139], v[176:179]
  v_mfma_f32_16x16x32_bf16 v[180:183], v[40:43], v[152:155], v[180:183]
  v_cndmask_b32 v44, 0, v16, s[28:29]
  v_cndmask_b32 v45, 0, v17, s[28:29]
  v_cndmask_b32 v46, 0, v18, s[28:29]
  v_cndmask_b32 v47, 0, v19, s[28:29]
  s_lshl_b64 s[28:29], s[28:29], 1
  s_nop 0
  v_mfma_f32_16x16x32_bf16 v[160:163], v[44:47], v[76:79], v[160:163]
  v_mfma_f32_16x16x32_bf16 v[164:167], v[44:47], v[92:95], v[164:167]
  v_mfma_f32_16x16x32_bf16 v[168:171], v[44:47], v[108:111], v[168:171]
  v_mfma_f32_16x16x32_bf16 v[172:175], v[44:47], v[124:127], v[172:175]
  v_mfma_f32_16x16x32_bf16 v[176:179], v[44:47], v[140:143], v[176:179]
  v_mfma_f32_16x16x32_bf16 v[180:183], v[44:47], v[156:159], v[180:183]
  v_add_f32 v56, v56, v28
  v_add_f32 v57, v57, v29
  v_add_f32 v58, v58, v30
  v_add_f32 v59, v59, v31
  v_add_f32 v20, v56, v57
  v_mul_f32 v22, v56, v56
  v_add_f32 v21, v58, v59
  v_fmac_f32 v22, v57, v57
  v_add_f32 v20, v20, v21
  v_fmac_f32 v22, v58, v58
  v_fmac_f32 v22, v59, v59
  v_or_b32 v28, 1, v28
  v_or_b32 v30, 1, v30
  v_add_f32 v20, v20, v20 row_ror:8 row_mask:0xf bank_mask:0xf
  v_add_f32 v22, v22, v22 row_ror:8 row_mask:0xf bank_mask:0xf
  v_lshlrev_b32 v11, 4, v12
  v_add_f32 v20, v20, v20 row_bcast:15 row_mask:0xa bank_mask:0xf
  v_add_f32 v22, v22, v22 row_bcast:15 row_mask:0xa bank_mask:0xf
  s_mov_b32 exec_lo, 0x01010101
  s_mov_b32 exec_hi, 0x01010101
  buffer_store_dwordx4 v[28:31], v11, s[4:7], s26 offen offset:768 sc1
  buffer_store_dwordx4 v[28:31], v11, s[4:7], s25 offen offset:768 sc1
  s_mov_b64 exec, -1
  v_add_f32 v20, v20, v20 row_bcast:31 row_mask:0xc bank_mask:0xf
  v_add_f32 v22, v22, v22 row_bcast:31 row_mask:0xc bank_mask:0xf
  v_or_b32 v20, 1, v20
  v_or_b32 v22, 1, v22
  s_mov_b32 exec_lo, 0
  s_mov_b32 exec_hi, 0x80000000
  buffer_store_dwordx4 v[20:23], v4, s[4:7], s26 offen offset:896 sc1
  buffer_store_dwordx4 v[20:23], v4, s[4:7], s25 offen offset:896 sc1
  s_mov_b64 exec, 0xffff
  v_or_b32 v160, 1, v160
  v_or_b32 v162, 1, v162
  buffer_store_dwordx4 v[160:163], v3, s[4:7], s26 offen offset:0 sc1
  v_or_b32 v164, 1, v164
  v_or_b32 v166, 1, v166
  buffer_store_dwordx4 v[164:167], v3, s[4:7], s25 offen offset:0 sc1
  v_or_b32 v168, 1, v168
  v_or_b32 v170, 1, v170
  buffer_store_dwordx4 v[168:171], v3, s[4:7], s26 offen offset:256 sc1
  v_or_b32 v172, 1, v172
  v_or_b32 v174, 1, v174
  buffer_store_dwordx4 v[172:175], v3, s[4:7], s25 offen offset:256 sc1
  v_or_b32 v176, 1, v176
  v_or_b32 v178, 1, v178
  buffer_store_dwordx4 v[176:179], v3, s[4:7], s26 offen offset:512 sc1
  v_or_b32 v180, 1, v180
  v_or_b32 v182, 1, v182
  buffer_store_dwordx4 v[180:183], v3, s[4:7], s25 offen offset:512 sc1
  s_mov_b64 exec, -1
  s_cmp_eq_u32 s79, 0
  s_cbranch_scc1 .g2_kernel_c_no
  s_lshl_b32 s20, s18, 15
  s_add_u32 s20, s20, 0x1190000
  s_lshl_b32 s22, s18, 11
  s_add_u32 s22, s22, s20
  v_lshlrev_b32 v16, 10, v2
  s_sleep 16
  s_mov_b32 s38, 0
  s_mov_b32 exec_hi, 0
.g2_kernel_gx49:
  buffer_load_dword v17, v16, s[4:7], s20 offen offset:752 sc1
  s_add_u32 s38, s38, 1
  s_waitcnt vmcnt(0)
  v_min_u32 v6, v17, v17
  v_cmp_eq_u32 vcc, 0, v6
  s_cbranch_vccz .g2_kernel_gx49d
  s_mov_b64 exec, vcc
  s_sleep 6
  s_cmp_lt_u32 s38, 131072
  s_cbranch_scc1 .g2_kernel_gx49
.g2_kernel_gx49d:
  s_mov_b64 exec, -1
  s_mov_b32 s38, 0
  s_bfm_b64 exec, 57, 0
.g2_kernel_gx50:
  s_mov_b32 s21, s20
  buffer_load_dwordx4 v[64:67], v3, s[4:7], s21 offen offset:0 sc1
  buffer_load_dwordx4 v[68:71], v3, s[4:7], s21 offen offset:1024 sc1
  buffer_load_dwordx4 v[72:75], v3, s[4:7], s21 offen offset:2048 sc1
  buffer_load_dwordx4 v[76:79], v3, s[4:7], s21 offen offset:3072 sc1
  s_add_u32 s21, s21, 4096
  buffer_load_dwordx4 v[80:83], v3, s[4:7], s21 offen offset:0 sc1
  buffer_load_dwordx4 v[84:87], v3, s[4:7], s21 offen offset:1024 sc1
  buffer_load_dwordx4 v[88:91], v3, s[4:7], s21 offen offset:2048 sc1
  buffer_load_dwordx4 v[92:95], v3, s[4:7], s21 offen offset:3072 sc1
  s_add_u32 s21, s21, 4096
  buffer_load_dwordx4 v[96:99], v3, s[4:7], s21 offen offset:0 sc1
  buffer_load_dwordx4 v[100:103], v3, s[4:7], s21 offen offset:1024 sc1
  buffer_load_dwordx4 v[104:107], v3, s[4:7], s21 offen offset:2048 sc1
  buffer_load_dwordx4 v[108:111], v3, s[4:7], s21 offen offset:3072 sc1
  s_add_u32 s21, s21, 4096
  buffer_load_dwordx4 v[112:115], v3, s[4:7], s21 offen offset:0 sc1
  buffer_load_dwordx4 v[116:119], v3, s[4:7], s21 offen offset:1024 sc1
  buffer_load_dwordx4 v[120:123], v3, s[4:7], s21 offen offset:2048 sc1
  buffer_load_dwordx4 v[124:127], v3, s[4:7], s21 offen offset:3072 sc1
  s_add_u32 s21, s21, 4096
  buffer_load_dwordx4 v[128:131], v3, s[4:7], s21 offen offset:0 sc1
  buffer_load_dwordx4 v[132:135], v3, s[4:7], s21 offen offset:1024 sc1
  buffer_load_dwordx4 v[136:139], v3, s[4:7], s21 offen offset:2048 sc1
  buffer_load_dwordx4 v[140:143], v3, s[4:7], s21 offen offset:3072 sc1
  s_add_u32 s21, s21, 4096
  buffer_load_dwordx4 v[144:147], v3, s[4:7], s21 offen offset:0 sc1
  buffer_load_dwordx4 v[148:151], v3, s[4:7], s21 offen offset:1024 sc1
  buffer_load_dwordx4 v[152:155], v3, s[4:7], s21 offen offset:2048 sc1
  buffer_load_dwordx4 v[156:159], v3, s[4:7], s21 offen offset:3072 sc1
  s_add_u32 s21, s21, 4096
  buffer_load_dwordx4 v[160:163], v3, s[4:7], s21 offen offset:0 sc1
  buffer_load_dwordx4 v[164:167], v3, s[4:7], s21 offen offset:1024 sc1
  buffer_load_dwordx4 v[168:171], v3, s[4:7], s21 offen offset:2048 sc1
  buffer_load_dwordx4 v[172:175], v3, s[4:7], s21 offen offset:3072 sc1
  s_add_u32 s21, s21, 4096
  buffer_load_dwordx4 v[176:179], v3, s[4:7], s21 offen offset:0 sc1
  buffer_load_dwordx4 v[180:183], v3, s[4:7], s21 offen offset:1024 sc1
  buffer_load_dwordx4 v[184:187], v3, s[4:7], s21 offen offset:2048 sc1
  buffer_load_dwordx4 v[188:191], v3, s[4:7], s21 offen offset:3072 sc1
  s_add_u32 s21, s21, 4096
  buffer_load_dwordx4 v[192:195], v3, s[4:7], s22 offen offset:0 sc1
  buffer_load_dwordx4 v[196:199], v3, s[4:7], s22 offen offset:1024 sc1
  s_add_u32 s38, s38, 1
  s_waitcnt vmcnt(0)
  v_min3_u32 v6, v64, v66, v68
  v_min3_u32 v6, v6, v70, v72
  v_min3_u32 v6, v6, v74, v76
  v_min3_u32 v6, v6, v78, v80
  v_min3_u32 v6, v6, v82, v84
  v_min3_u32 v6, v6, v86, v88
  v_min3_u32 v6, v6, v90, v92
  v_min3_u32 v6, v6, v94, v96
  v_min3_u32 v6, v6, v98, v100
  v_min3_u32 v6, v6, v102, v104
  v_min3_u32 v6, v6, v106, v108
  v_min3_u32 v6, v6, v110, v112
  v_min3_u32 v6, v6, v114, v116
  v_min3_u32 v6, v6, v118, v120
  v_min3_u32 v6, v6, v122, v124
  v_min3_u32 v6, v6, v126, v128
  v_min3_u32 v6, v6, v130, v132
  v_min3_u32 v6, v6, v134, v136
  v_min3_u32 v6, v6, v138, v140
  v_min3_u32 v6, v6, v142, v144
  v_min3_u32 v6, v6, v146, v148
  v_min3_u32 v6, v6, v150, v152
  v_min3_u32 v6, v6, v154, v156
  v_min3_u32 v6, v6, v158, v160
  v_min3_u32 v6, v6, v162, v164
  v_min3_u32 v6, v6, v166, v168
  v_min3_u32 v6, v6, v170, v172
  v_min3_u32 v6, v6, v174, v176
  v_min3_u32 v6, v6, v178, v180
  v_min3_u32 v6, v6, v182, v184
  v_min3_u32 v6, v6, v186, v188
  v_min3_u32 v6, v6, v190, v192
  v_min3_u32 v6, v6, v194, v196
  v_min_u32 v6, v6, v198
  v_cmp_eq_u32 vcc, 0, v6
  s_cbranch_vccz .g2_kernel_gx50d
  s_mov_b64 exec, vcc
  s_sleep 2
  s_cmp_lt_u32 s38, 131072
  s_cbranch_scc1 .g2_kernel_gx50
.g2_kernel_gx50d:
  s_mov_b64 exec, -1
  v_add_f32 v64, v64, v128
  v_add_f32 v65, v65, v129
  v_add_f32 v66, v66, v130
  v_add_f32 v67, v67, v131
  v_add_f32 v68, v68, v132
  v_add_f32 v69, v69, v133
  v_add_f32 v70, v70, v134
  v_add_f32 v71, v71, v135
  v_add_f32 v72, v72, v136
  v_add_f32 v73, v73, v137
  v_add_f32 v74, v74, v138
  v_add_f32 v75, v75, v139
  v_add_f32 v76, v76, v140
  v_add_f32 v77, v77, v141
  v_add_f32 v78, v78, v142
  v_add_f32 v79, v79, v143
  v_add_f32 v80, v80, v144
  v_add_f32 v81, v81, v145
  v_add_f32 v82, v82, v146
  v_add_f32 v83, v83, v147
  v_add_f32 v84, v84, v148
  v_add_f32 v85, v85, v149
  v_add_f32 v86, v86, v150
  v_add_f32 v87, v87, v151
  v_add_f32 v88, v88, v152
  v_add_f32 v89, v89, v153
  v_add_f32 v90, v90, v154
  v_add_f32 v91, v91, v155
  v_add_f32 v92, v92, v156
  v_add_f32 v93, v93, v157
  v_add_f32 v94, v94, v158
  v_add_f32 v95, v95, v159
  v_add_f32 v96, v96, v160
  v_add_f32 v97, v97, v161
  v_add_f32 v98, v98, v162
  v_add_f32 v99, v99, v163
  v_add_f32 v100, v100, v164
  v_add_f32 v101, v101, v165
  v_add_f32 v102, v102, v166
  v_add_f32 v103, v103, v167
  v_add_f32 v104, v104, v168
  v_add_f32 v105, v105, v169
  v_add_f32 v106, v106, v170
  v_add_f32 v107, v107, v171
  v_add_f32 v108, v108, v172
  v_add_f32 v109, v109, v173
  v_add_f32 v110, v110, v174
  v_add_f32 v111, v111, v175
  v_add_f32 v112, v112, v176
  v_add_f32 v113, v113, v177
  v_add_f32 v114, v114, v178
  v_add_f32 v115, v115, v179
  v_add_f32 v116, v116, v180
  v_add_f32 v117, v117, v181
  v_add_f32 v118, v118, v182
  v_add_f32 v119, v119, v183
  v_add_f32 v120, v120, v184
  v_add_f32 v121, v121, v185
  v_add_f32 v122, v122, v186
  v_add_f32 v123, v123, v187
  v_add_f32 v124, v124, v188
  v_add_f32 v125, v125, v189
  v_add_f32 v126, v126, v190
  v_add_f32 v127, v127, v191
  v_add_f32 v64, v64, v96
  v_add_f32 v65, v65, v97
  v_add_f32 v66, v66, v98
  v_add_f32 v67, v67, v99
  v_add_f32 v68, v68, v100
  v_add_f32 v69, v69, v101
  v_add_f32 v70, v70, v102
  v_add_f32 v71, v71, v103
  v_add_f32 v72, v72, v104
  v_add_f32 v73, v73, v105
  v_add_f32 v74, v74, v106
  v_add_f32 v75, v75, v107
  v_add_f32 v76, v76, v108
  v_add_f32 v77, v77, v109
  v_add_f32 v78, v78, v110
  v_add_f32 v79, v79, v111
  v_add_f32 v80, v80, v112
  v_add_f32 v81, v81, v113
  v_add_f32 v82, v82, v114
  v_add_f32 v83, v83, v115
  v_add_f32 v84, v84, v116
  v_add_f32 v85, v85, v117
  v_add_f32 v86, v86, v118
  v_add_f32 v87, v87, v119
  v_add_f32 v88, v88, v120
  v_add_f32 v89, v89, v121
  v_add_f32 v90, v90, v122
  v_add_f32 v91, v91, v123
  v_add_f32 v92, v92, v124
  v_add_f32 v93, v93, v125
  v_add_f32 v94, v94, v126
  v_add_f32 v95, v95, v127
  v_add_f32 v64, v64, v80
  v_add_f32 v65, v65, v81
  v_add_f32 v66, v66, v82
  v_add_f32 v67, v67, v83
  v_add_f32 v68, v68, v84
  v_add_f32 v69, v69, v85
  v_add_f32 v70, v70, v86
  v_add_f32 v71, v71, v87
  v_add_f32 v72, v72, v88
  v_add_f32 v73, v73, v89
  v_add_f32 v74, v74, v90
  v_add_f32 v75, v75, v91
  v_add_f32 v76, v76, v92
  v_add_f32 v77, v77, v93
  v_add_f32 v78, v78, v94
  v_add_f32 v79, v79, v95
  v_add_f32 v64, v64, v72
  v_add_f32 v65, v65, v73
  v_add_f32 v66, v66, v74
  v_add_f32 v67, v67, v75
  v_add_f32 v68, v68, v76
  v_add_f32 v69, v69, v77
  v_add_f32 v70, v70, v78
  v_add_f32 v71, v71, v79
  v_add_f32 v64, v64, v68
  v_add_f32 v65, v65, v69
  v_add_f32 v66, v66, v70
  v_add_f32 v67, v67, v71
  v_mov_b32 v28, 0.0009765625
  v_mov_b32 v30, 1e-05
  v_readlane_b32 s21, v64, 56
  v_readlane_b32 s22, v66, 56
  s_nop 0
  v_mul_f32 v20, s21, v28
  v_fma_f32 v21, s22, v28, v30
  v_fma_f32 v21, -v20, v20, v21
  v_rsq_f32 v21, abs(v21)
  v_sub_f32 v20, v61, v20
  v_mul_f32 v22, v21, v60
  v_mul_f32 v23, v21, v20
  v_and_b32 v10, 15, v2
  v_lshrrev_b32 v11, 4, v2
  v_lshlrev_b32 v16, 2, v10
  v_lshl_add_u32 v16, v11, 8, v16
  v_add_u32 v16, 155648, v16
  s_sub_u32 s20, s79, 1
  s_and_b32 s21, s20, 3
  s_lshl_b32 s21, s21, 2
  s_add_u32 s21, s21, 156160
  v_lshl_add_u32 v17, v10, 4, s21
  v_cmp_eq_u32 vcc, 2, v11
  v_mov_b32 v18, 64
  v_mov_b32 v19, 256
  v_cndmask_b32 v17, v16, v17, vcc
  v_cndmask_b32 v18, v18, v19, vcc
  v_lshrrev_b32 v24, 2, v10
  v_lshlrev_b32 v24, 9, v24
  v_and_b32 v25, 3, v10
  v_lshl_add_u32 v24, v25, 1, v24
  s_and_b32 s21, s20, 31
  s_lshl_b32 s22, s21, 4
  s_lshr_b32 s23, s20, 5
  s_lshl_b32 s24, s23, 11
  s_add_u32 s22, s22, s24
  s_add_u32 s22, s22, 131072
  v_add_u32 v26, s22, v24
  s_and_b32 s22, s21, 7
  s_and_b32 s24, s21, 8
  s_lshl_b32 s24, s24, 1
  s_add_u32 s22, s22, s24
  s_and_b32 s24, s21, 16
  s_lshr_b32 s24, s24, 1
  s_add_u32 s22, s22, s24
  s_lshl_b32 s22, s22, 4
  v_add_u32 v24, s22, v24
  s_bfe_u32 s22, s21, 0x20002
  s_lshl_b32 s22, s22, 9
  s_add_u32 s22, s22, s24
  s_and_b32 s24, s21, 3
  s_lshl_b32 s24, s24, 1
  s_add_u32 s22, s22, s24
  s_add_u32 s22, s22, 2048
  v_lshl_add_u32 v25, v10, 4, s22
  v_cndmask_b32 v24, v24, v25, vcc
  v_cndmask_b32 v19, 8, v19, vcc
  v_add_u32 v25, v24, v19
  s_lshl_b32 s22, s18, 7
  s_lshl_b32 s24, s17, 2
  s_add_u32 s22, s22, s24
  s_add_u32 s22, s22, s23
  s_lshl_b32 s22, s22, 12
  s_add_u32 s22, s22, 0x1800000
  s_add_u32 s23, s22, 262144
  s_lshr_b32 s24, s20, 6
  s_lshl_b32 s24, s24, 8
  s_add_u32 s24, s24, s76
  v_cmp_eq_u32 vcc, 0, v11
  v_mov_b32 v27, 0.25503486164919736
  s_nop 0
  v_cndmask_b32 v27, 1.0, v27, vcc
  v_mul_f32 v21, v21, v27
  v_mul_f32 v22, v22, v27
  v_mul_f32 v23, v23, v27
  s_mov_b32 s62, 1
  s_mov_b32 s63, 0x1800000
  s_mov_b32 s70, 2
  s_mov_b32 s71, 155776
  v_mov_b32 v6, s71
  s_mov_b32 s38, 0
.g2_kernel_wg51:
  ds_read_b32 v7, v6 offset:56
  s_add_u32 s38, s38, 1
  s_waitcnt lgkmcnt(0)
  v_cmp_gt_u32 vcc, 2, v7
  s_cbranch_vccz .g2_kernel_wg51d
  s_sleep 1
  s_cmp_lt_u32 s38, 524288
  s_cbranch_scc1 .g2_kernel_wg51
.g2_kernel_wg51d:
  ds_read_b32 v32, v17 offset:5632
  ds_read_b32 v36, v16 offset:4864
  v_add_u32 v17, v17, v18
  ds_read_b32 v33, v17 offset:5632
  ds_read_b32 v37, v16 offset:4928
  v_add_u32 v17, v17, v18
  ds_read_b32 v34, v17 offset:5632
  ds_read_b32 v38, v16 offset:4992
  v_add_u32 v17, v17, v18
  ds_read_b32 v35, v17 offset:5632
  ds_read_b32 v39, v16 offset:5056
  s_waitcnt lgkmcnt(0)
  v_mul_f32 v32, v32, v22
  v_fmac_f32 v32, v64, v21
  v_fmac_f32 v32, v36, v23
  v_mul_f32 v33, v33, v22
  v_fmac_f32 v33, v65, v21
  v_fmac_f32 v33, v37, v23
  v_mul_f32 v34, v34, v22
  v_fmac_f32 v34, v66, v21
  v_fmac_f32 v34, v38, v23
  v_mul_f32 v35, v35, v22
  v_fmac_f32 v35, v67, v21
  v_fmac_f32 v35, v39, v23
  v_cvt_pk_bf16_f32 v32, v32, v33
  v_cvt_pk_bf16_f32 v34, v34, v35
  v_mov_b32 v9, s71
  v_mov_b32 v8, 2
  s_mov_b32 exec_lo, 0xffff0000
  s_mov_b32 exec_hi, 0xffff
  buffer_store_short v32, v24, s[4:7], s22 offen sc1
  buffer_store_short_d16_hi v32, v25, s[4:7], s22 offen sc1
  buffer_store_short v34, v24, s[4:7], s23 offen sc1
  buffer_store_short_d16_hi v34, v25, s[4:7], s23 offen sc1
  s_mov_b64 exec, 0xffff
  ds_write_b16 v26, v32 offset:8192
  ds_write_b16_d16_hi v26, v32 offset:8200
  ds_write_b16 v26, v34
  ds_write_b16_d16_hi v26, v34 offset:8
  ds_write_b32 v9, v5 offset:60
  s_mov_b32 exec_lo, 0
  s_mov_b32 exec_hi, 0xff0000
  ds_write_b32 v16, v192 offset:6912
  ds_write_b32 v16, v193 offset:6976
  ds_write_b32 v16, v194 offset:7040
  ds_write_b32 v16, v195 offset:7104
  ds_write_b32 v16, v196 offset:6944
  ds_write_b32 v16, v197 offset:7008
  ds_write_b32 v16, v198 offset:7072
  ds_write_b32 v16, v199 offset:7136
  s_mov_b64 exec, 1
  s_waitcnt vmcnt(0)
  buffer_store_dword v8, v4, s[4:7], s24 offen sc1
  buffer_store_dword v8, v4, s[4:7], s24 offen offset:128 sc1
  s_mov_b64 exec, -1
  s_branch .g2_kernel_v
.g2_kernel_c_no:
  s_mov_b32 s62, 1
  s_mov_b32 s63, 0x1800000
  s_mov_b32 s70, 2
  s_mov_b32 s71, 155776
  s_branch .g2_kernel_v
.g2_kernel_c_t3:
  s_lshr_b32 s33, s77, 7
  s_lshl_b32 s28, s33, 2
  s_lshl_b64 s[8:9], 15, s28
  s_lshl_b32 s21, s17, 10
  s_add_u32 s21, s21, 0x2880000
  v_lshlrev_b32 v14, 3, v2
  v_add_u32 v14, 155648, v14
  v_mov_b32 v9, s71
  s_cmp_eq_u32 s33, s17
  s_cbranch_scc0 .g2_kernel_c_u1
  s_sleep 6
  s_call_b64 s[72:73], .g2_kernel_c_ph2
  s_branch .g2_kernel_c_u2
.g2_kernel_c_u1:
  v_mov_b32 v6, s71
  s_mov_b32 s38, 0
.g2_kernel_wg52:
  ds_read_b32 v7, v6 offset:36
  s_add_u32 s38, s38, 1
  s_waitcnt lgkmcnt(0)
  v_cmp_gt_u32 vcc, 1, v7
  s_cbranch_vccz .g2_kernel_wg52d
  s_sleep 1
  s_cmp_lt_u32 s38, 524288
  s_cbranch_scc1 .g2_kernel_wg52
.g2_kernel_wg52d:
  ds_read_b32 v7, v6 offset:36
  ds_read_b32 v6, v6 offset:104
  s_waitcnt lgkmcnt(0)
  v_readfirstlane_b32 s77, v7
  v_readfirstlane_b32 s29, v6
  s_lshl_b32 s29, s29, 5
  s_add_u32 s77, s77, s29
  s_sub_u32 s77, s77, 1
.g2_kernel_c_u2:
  s_mov_b32 s38, 0
.g2_kernel_gx53:
  buffer_load_dwordx4 v[16:19], v3, s[4:7], s21 offen sc1
  s_add_u32 s38, s38, 1
  s_waitcnt vmcnt(0)
  v_min_u32 v6, v17, v19
  v_cmp_eq_u32 vcc, 0, v6
  s_cbranch_vccz .g2_kernel_gx53d
  s_mov_b64 exec, vcc
  s_cmp_lt_u32 s38, 131072
  s_cbranch_scc1 .g2_kernel_gx53
.g2_kernel_gx53d:
  s_mov_b64 exec, -1
  s_lshr_b32 s28, s77, 7
  s_and_b32 s79, s77, 127
  s_add_u32 s79, s79, 1
  s_cmp_eq_u32 s28, s17
  s_cselect_b32 s79, s79, 0
  v_rsq_f32 v22, v17
  v_rsq_f32 v23, v19
  v_mov_b32 v15, s79
  v_add_f32 v52, 1.0, v22
  v_mul_f32 v54, v16, v22
  v_sub_f32 v54, 0, v54
  v_add_f32 v53, 1.0, v23
  v_mul_f32 v55, v18, v23
  v_sub_f32 v55, 0, v55
  ds_write_b64 v14, v[52:53] offset:3840
  ds_write_b64 v14, v[54:55] offset:4352
  ds_write_b32 v9, v15 offset:32
  ds_write_b32 v9, v5 offset:28
  s_cmp_eq_u32 s33, s17
  s_cbranch_scc1 .g2_kernel_fin
  s_sleep 28
  s_mov_b32 s39, 1
  s_call_b64 s[72:73], .g2_kernel_c_ph2
  s_branch .g2_kernel_fin
.g2_kernel_c_ph2:
  s_call_b64 s[68:69], .g2_kernel_amax
  v_mov_b32 v6, s71
  s_mov_b32 s38, 0
.g2_kernel_wg54:
  ds_read_b32 v7, v6 offset:36
  s_add_u32 s38, s38, 1
  s_waitcnt lgkmcnt(0)
  v_cmp_gt_u32 vcc, 1, v7
  s_cbranch_vccz .g2_kernel_wg54d
  s_cmp_lt_u32 s38, 524288
  s_cbranch_scc1 .g2_kernel_wg54
.g2_kernel_wg54d:
  ds_read_b32 v8, v9 offset:96
  ds_read_b32 v7, v6 offset:36
  ds_read_b32 v6, v6 offset:104
  s_waitcnt lgkmcnt(0)
  v_readfirstlane_b32 s28, v7
  v_readfirstlane_b32 s29, v6
  s_lshl_b32 s29, s29, 5
  s_add_u32 s28, s28, s29
  s_sub_u32 s28, s28, 1
  s_add_u32 s29, s77, 2
  s_waitcnt lgkmcnt(0)
  v_cmp_gt_f32 vcc, s27, v8
  s_cmp_lg_u64 vcc, 0
  s_cselect_b32 s77, s77, s28
  s_cselect_b32 s29, s29, 1
  v_mov_b32 v10, s29
  v_mov_b32 v11, s27
  ds_write_b64 v9, v[10:11] offset:88
  s_setpc_b64 s[72:73]
.g2_kernel_c2:
  s_cmp_lg_u32 s62, 0
  s_cbranch_scc1 .g2_kernel_d_a
  s_cmp_lg_u32 s16, 7
  s_cbranch_scc1 .g2_kernel_d_a
  v_mov_b32 v6, s71
  s_mov_b32 s38, 0
.g2_kernel_wg57:
  ds_read_b32 v7, v6 offset:20
  s_add_u32 s38, s38, 1
  s_waitcnt lgkmcnt(0)
  v_cmp_gt_u32 vcc, 4, v7
  s_cbranch_vccz .g2_kernel_wg57d
  s_sleep 2
  s_cmp_lt_u32 s38, 524288
  s_cbranch_scc1 .g2_kernel_wg57
.g2_kernel_wg57d:
  s_sleep 20
  s_and_b32 s31, s19, 0xffffe000
  s_add_u32 s31, s31, 8
  v_and_b32 v6, 15, v2
  v_lshlrev_b32 v6, 9, v6
  v_lshrrev_b32 v7, 4, v2
  v_lshl_add_u32 v6, v7, 7, v6
  v_lshlrev_b32 v7, 2, v2
  v_add_u32 v7, 158208, v7
  s_mov_b32 m0, 158208
  s_mov_b32 s38, 0
.g2_kernel_pa58:
  buffer_load_dword v6, s[4:7], s31 offen sc1 lds
  s_add_u32 s38, s38, 1
  s_waitcnt vmcnt(0)
  ds_read_b32 v8, v7
  s_waitcnt lgkmcnt(0)
  v_cmp_ge_u32 vcc, s62, v8
  s_cbranch_vccz .g2_kernel_pa58d
  s_mov_b64 exec, vcc
  s_sleep 10
  s_cmp_lt_u32 s38, 131072
  s_cbranch_scc1 .g2_kernel_pa58
.g2_kernel_pa58d:
  s_mov_b64 exec, -1
.g2_kernel_d_a:
  s_setprio 2
  s_and_b32 s20, s16, 1
  v_bfe_u32 v8, v2, 1, 3
  v_lshlrev_b32 v8, 14, v8
  v_and_b32 v9, 1, v2
  v_lshl_add_u32 v8, v9, 10, v8
  v_lshrrev_b32 v9, 4, v2
  v_lshl_add_u32 v8, v9, 8, v8
  v_and_b32 v9, 15, v2
  v_lshlrev_b32 v9, 4, v9
  s_lshl_b32 s28, s20, 8
  s_add_u32 s28, s28, 156672
  v_add_u32 v10, s28, v9
  v_xor_b32 v11, 256, v10
  s_lshl_b32 s28, s20, 2
  s_add_u32 s28, s28, s71
  v_mov_b32 v12, s28
  v_xor_b32 v13, 4, v12
  s_lshl_b32 s26, s17, 4
  s_add_u32 s26, s26, s18
  s_lshl_b32 s26, s26, 1
  s_add_u32 s26, s26, s20
  s_lshl_b32 s26, s26, 11
  s_add_u32 s26, s26, s63
  s_add_u32 s26, s26, 0x1090000
  s_mov_b32 s32, 0
  s_mov_b32 s39, 0
  s_lshl_b32 s28, s62, 3
  s_add_u32 s28, s28, s16
  s_cmp_lg_u32 s28, 14
  s_cbranch_scc1 .g2_kernel_d_w
  s_lshr_b32 s33, s77, 7
  s_lshl_b32 s28, s33, 2
  s_lshl_b64 s[8:9], 15, s28
  s_not_b64 s[8:9], s[8:9]
  s_and_b32 s28, s2, 7
  s_lshl_b32 s28, s28, 13
  s_add_u32 s23, s28, 0x3050000
  s_cmp_eq_u32 s33, s17
  s_cbranch_scc1 .g2_kernel_d_v
  v_mov_b32 v6, s71
  s_mov_b32 s38, 0
.g2_kernel_wg59:
  ds_read_b32 v7, v6 offset:20
  s_add_u32 s38, s38, 1
  s_waitcnt lgkmcnt(0)
  v_cmp_gt_u32 vcc, 4, v7
  s_cbranch_vccz .g2_kernel_wg59d
  s_sleep 1
  s_cmp_lt_u32 s38, 524288
  s_cbranch_scc1 .g2_kernel_wg59
.g2_kernel_wg59d:
.g2_kernel_d_v:
  s_sleep 60
  s_call_b64 s[68:69], .g2_kernel_amax
  s_add_u32 s28, s77, 1
  v_mov_b32 v6, s27
  v_mov_b32 v7, s28
  ds_write_b32 v12, v6 offset:96
  ds_write_b32 v12, v7 offset:36
  s_waitcnt lgkmcnt(0)
  s_wakeup
  s_branch .g2_kernel_d_r
.g2_kernel_d_w:
  v_mov_b32 v6, s71
  s_mov_b32 s38, 0
.g2_kernel_wg60:
  ds_read_b32 v7, v6 offset:36
  s_add_u32 s38, s38, 1
  s_waitcnt lgkmcnt(0)
  v_cmp_gt_u32 vcc, 1, v7
  s_cbranch_vccz .g2_kernel_wg60d
  s_sleep 4
  s_cmp_lt_u32 s38, 524288
  s_cbranch_scc1 .g2_kernel_wg60
.g2_kernel_wg60d:
  ds_read_b32 v7, v6 offset:36
  ds_read_b32 v6, v6 offset:104
  s_waitcnt lgkmcnt(0)
  v_readfirstlane_b32 s77, v7
  v_readfirstlane_b32 s29, v6
  s_lshl_b32 s29, s29, 5
  s_add_u32 s77, s77, s29
  s_sub_u32 s77, s77, 1
.g2_kernel_d_r:
  s_and_b32 s77, s77, 2047
  s_lshr_b32 s24, s77, 7
  s_lshl_b32 s24, s24, 18
  s_bfe_u32 s28, s77, 0x30004
  s_lshl_b32 s28, s28, 11
  s_add_u32 s24, s24, s28
  s_and_b32 s28, s77, 15
  s_lshl_b32 s28, s28, 4
  s_add_u32 s24, s24, s28
  s_add_u32 s24, s24, s63
  s_add_u32 s24, s24, 0xc00000
  s_lshl_b32 s28, s17, 14
  s_add_u32 s21, s24, s28
  s_and_b32 s28, s18, 8
  s_lshl_b32 s28, s28, 5
  s_add_u32 s21, s21, s28
  s_and_b32 s28, s18, 7
  s_lshl_b32 s28, s28, 1
  s_add_u32 s21, s21, s28
  s_lshl_b32 s28, s20, 17
  s_add_u32 s24, s24, s28
  buffer_load_dwordx4 v[16:19], v8, s[4:7], s24 offen
  buffer_load_ushort v56, v4, s[4:7], s21 offen
  buffer_load_ushort v57, v4, s[4:7], s21 offen offset:512
  buffer_load_ushort v58, v4, s[4:7], s21 offen offset:1024
  buffer_load_ushort v59, v4, s[4:7], s21 offen offset:1536
  s_lshl_b32 s25, s77, 3
  s_add_u32 s25, s25, s63
  s_add_u32 s25, s25, 0x1080000
  s_mov_b32 s38, 0
.g2_kernel_gx61:
  buffer_load_dwordx2 v[20:21], v4, s[4:7], s25 offen sc1
  s_add_u32 s38, s38, 1
  s_waitcnt vmcnt(0)
  v_min_u32 v6, v21, v21
  v_cmp_eq_u32 vcc, 0, v6
  s_cbranch_vccz .g2_kernel_gx61d
  s_mov_b64 exec, vcc
  s_sleep 1
  s_cmp_lt_u32 s38, 131072
  s_cbranch_scc1 .g2_kernel_gx61
.g2_kernel_gx61d:
  s_mov_b64 exec, -1
  v_rsq_f32 v21, v21
  v_lshlrev_b32 v24, 16, v16
  v_and_b32 v25, 0xffff0000, v16
  v_lshlrev_b32 v26, 16, v17
  v_and_b32 v27, 0xffff0000, v17
  v_lshlrev_b32 v28, 16, v18
  v_and_b32 v29, 0xffff0000, v18
  v_lshlrev_b32 v30, 16, v19
  v_and_b32 v31, 0xffff0000, v19
  v_mul_f32 v20, v20, v21
  v_mov_b32 v60, v20
  v_add_f32 v61, 1.0, v21
  s_cmp_ge_u32 s17, 14
  s_cbranch_scc1 .g2_kernel_d_none
  v_fma_f32 v24, v24, v21, -v20
  v_fma_f32 v25, v25, v21, -v20
  v_fma_f32 v26, v26, v21, -v20
  v_fma_f32 v27, v27, v21, -v20
  v_fma_f32 v28, v28, v21, -v20
  v_fma_f32 v29, v29, v21, -v20
  v_fma_f32 v30, v30, v21, -v20
  v_fma_f32 v31, v31, v21, -v20
  v_cvt_pk_bf16_f32 v16, v24, v25
  v_cvt_pk_bf16_f32 v17, v26, v27
  v_cvt_pk_bf16_f32 v18, v28, v29
  v_cvt_pk_bf16_f32 v19, v30, v31
  v_mov_b32 v24, v16 row_newbcast:0 row_mask:0xf bank_mask:0xf
  v_mov_b32 v25, v17 row_newbcast:0 row_mask:0xf bank_mask:0xf
  v_mov_b32 v26, v18 row_newbcast:0 row_mask:0xf bank_mask:0xf
  v_mov_b32 v27, v19 row_newbcast:0 row_mask:0xf bank_mask:0xf
  v_mov_b32 v28, v16 row_newbcast:1 row_mask:0xf bank_mask:0xf
  v_mov_b32 v29, v17 row_newbcast:1 row_mask:0xf bank_mask:0xf
  v_mov_b32 v30, v18 row_newbcast:1 row_mask:0xf bank_mask:0xf
  v_mov_b32 v31, v19 row_newbcast:1 row_mask:0xf bank_mask:0xf
  v_mfma_f32_16x16x32_bf16 v[32:35], v[24:27], v[64:67], 0
  v_mfma_f32_16x16x32_bf16 v[36:39], v[24:27], v[128:131], 0
  v_mov_b32 v24, v16 row_newbcast:2 row_mask:0xf bank_mask:0xf
  v_mov_b32 v25, v17 row_newbcast:2 row_mask:0xf bank_mask:0xf
  v_mov_b32 v26, v18 row_newbcast:2 row_mask:0xf bank_mask:0xf
  v_mov_b32 v27, v19 row_newbcast:2 row_mask:0xf bank_mask:0xf
  v_mfma_f32_16x16x32_bf16 v[32:35], v[28:31], v[68:71], v[32:35]
  v_mfma_f32_16x16x32_bf16 v[36:39], v[28:31], v[132:135], v[36:39]
  v_mov_b32 v28, v16 row_newbcast:3 row_mask:0xf bank_mask:0xf
  v_mov_b32 v29, v17 row_newbcast:3 row_mask:0xf bank_mask:0xf
  v_mov_b32 v30, v18 row_newbcast:3 row_mask:0xf bank_mask:0xf
  v_mov_b32 v31, v19 row_newbcast:3 row_mask:0xf bank_mask:0xf
  v_mfma_f32_16x16x32_bf16 v[32:35], v[24:27], v[72:75], v[32:35]
  v_mfma_f32_16x16x32_bf16 v[36:39], v[24:27], v[136:139], v[36:39]
  v_mov_b32 v24, v16 row_newbcast:4 row_mask:0xf bank_mask:0xf
  v_mov_b32 v25, v17 row_newbcast:4 row_mask:0xf bank_mask:0xf
  v_mov_b32 v26, v18 row_newbcast:4 row_mask:0xf bank_mask:0xf
  v_mov_b32 v27, v19 row_newbcast:4 row_mask:0xf bank_mask:0xf
  v_mfma_f32_16x16x32_bf16 v[32:35], v[28:31], v[76:79], v[32:35]
  v_mfma_f32_16x16x32_bf16 v[36:39], v[28:31], v[140:143], v[36:39]
  v_mov_b32 v28, v16 row_newbcast:5 row_mask:0xf bank_mask:0xf
  v_mov_b32 v29, v17 row_newbcast:5 row_mask:0xf bank_mask:0xf
  v_mov_b32 v30, v18 row_newbcast:5 row_mask:0xf bank_mask:0xf
  v_mov_b32 v31, v19 row_newbcast:5 row_mask:0xf bank_mask:0xf
  v_mfma_f32_16x16x32_bf16 v[32:35], v[24:27], v[80:83], v[32:35]
  v_mfma_f32_16x16x32_bf16 v[36:39], v[24:27], v[144:147], v[36:39]
  v_mov_b32 v24, v16 row_newbcast:6 row_mask:0xf bank_mask:0xf
  v_mov_b32 v25, v17 row_newbcast:6 row_mask:0xf bank_mask:0xf
  v_mov_b32 v26, v18 row_newbcast:6 row_mask:0xf bank_mask:0xf
  v_mov_b32 v27, v19 row_newbcast:6 row_mask:0xf bank_mask:0xf
  v_mfma_f32_16x16x32_bf16 v[32:35], v[28:31], v[84:87], v[32:35]
  v_mfma_f32_16x16x32_bf16 v[36:39], v[28:31], v[148:151], v[36:39]
  v_mov_b32 v28, v16 row_newbcast:7 row_mask:0xf bank_mask:0xf
  v_mov_b32 v29, v17 row_newbcast:7 row_mask:0xf bank_mask:0xf
  v_mov_b32 v30, v18 row_newbcast:7 row_mask:0xf bank_mask:0xf
  v_mov_b32 v31, v19 row_newbcast:7 row_mask:0xf bank_mask:0xf
  v_mfma_f32_16x16x32_bf16 v[32:35], v[24:27], v[88:91], v[32:35]
  v_mfma_f32_16x16x32_bf16 v[36:39], v[24:27], v[152:155], v[36:39]
  v_mov_b32 v24, v16 row_newbcast:8 row_mask:0xf bank_mask:0xf
  v_mov_b32 v25, v17 row_newbcast:8 row_mask:0xf bank_mask:0xf
  v_mov_b32 v26, v18 row_newbcast:8 row_mask:0xf bank_mask:0xf
  v_mov_b32 v27, v19 row_newbcast:8 row_mask:0xf bank_mask:0xf
  v_mfma_f32_16x16x32_bf16 v[32:35], v[28:31], v[92:95], v[32:35]
  v_mfma_f32_16x16x32_bf16 v[36:39], v[28:31], v[156:159], v[36:39]
  v_mov_b32 v28, v16 row_newbcast:9 row_mask:0xf bank_mask:0xf
  v_mov_b32 v29, v17 row_newbcast:9 row_mask:0xf bank_mask:0xf
  v_mov_b32 v30, v18 row_newbcast:9 row_mask:0xf bank_mask:0xf
  v_mov_b32 v31, v19 row_newbcast:9 row_mask:0xf bank_mask:0xf
  v_mfma_f32_16x16x32_bf16 v[32:35], v[24:27], v[96:99], v[32:35]
  v_mfma_f32_16x16x32_bf16 v[36:39], v[24:27], v[160:163], v[36:39]
  v_mov_b32 v24, v16 row_newbcast:10 row_mask:0xf bank_mask:0xf
  v_mov_b32 v25, v17 row_newbcast:10 row_mask:0xf bank_mask:0xf
  v_mov_b32 v26, v18 row_newbcast:10 row_mask:0xf bank_mask:0xf
  v_mov_b32 v27, v19 row_newbcast:10 row_mask:0xf bank_mask:0xf
  v_mfma_f32_16x16x32_bf16 v[32:35], v[28:31], v[100:103], v[32:35]
  v_mfma_f32_16x16x32_bf16 v[36:39], v[28:31], v[164:167], v[36:39]
  v_mov_b32 v28, v16 row_newbcast:11 row_mask:0xf bank_mask:0xf
  v_mov_b32 v29, v17 row_newbcast:11 row_mask:0xf bank_mask:0xf
  v_mov_b32 v30, v18 row_newbcast:11 row_mask:0xf bank_mask:0xf
  v_mov_b32 v31, v19 row_newbcast:11 row_mask:0xf bank_mask:0xf
  v_mfma_f32_16x16x32_bf16 v[32:35], v[24:27], v[104:107], v[32:35]
  v_mfma_f32_16x16x32_bf16 v[36:39], v[24:27], v[168:171], v[36:39]
  v_mov_b32 v24, v16 row_newbcast:12 row_mask:0xf bank_mask:0xf
  v_mov_b32 v25, v17 row_newbcast:12 row_mask:0xf bank_mask:0xf
  v_mov_b32 v26, v18 row_newbcast:12 row_mask:0xf bank_mask:0xf
  v_mov_b32 v27, v19 row_newbcast:12 row_mask:0xf bank_mask:0xf
  v_mfma_f32_16x16x32_bf16 v[32:35], v[28:31], v[108:111], v[32:35]
  v_mfma_f32_16x16x32_bf16 v[36:39], v[28:31], v[172:175], v[36:39]
  v_mov_b32 v28, v16 row_newbcast:13 row_mask:0xf bank_mask:0xf
  v_mov_b32 v29, v17 row_newbcast:13 row_mask:0xf bank_mask:0xf
  v_mov_b32 v30, v18 row_newbcast:13 row_mask:0xf bank_mask:0xf
  v_mov_b32 v31, v19 row_newbcast:13 row_mask:0xf bank_mask:0xf
  v_mfma_f32_16x16x32_bf16 v[32:35], v[24:27], v[112:115], v[32:35]
  v_mfma_f32_16x16x32_bf16 v[36:39], v[24:27], v[176:179], v[36:39]
  v_mov_b32 v24, v16 row_newbcast:14 row_mask:0xf bank_mask:0xf
  v_mov_b32 v25, v17 row_newbcast:14 row_mask:0xf bank_mask:0xf
  v_mov_b32 v26, v18 row_newbcast:14 row_mask:0xf bank_mask:0xf
  v_mov_b32 v27, v19 row_newbcast:14 row_mask:0xf bank_mask:0xf
  v_mfma_f32_16x16x32_bf16 v[32:35], v[28:31], v[116:119], v[32:35]
  v_mfma_f32_16x16x32_bf16 v[36:39], v[28:31], v[180:183], v[36:39]
  v_mov_b32 v28, v16 row_newbcast:15 row_mask:0xf bank_mask:0xf
  v_mov_b32 v29, v17 row_newbcast:15 row_mask:0xf bank_mask:0xf
  v_mov_b32 v30, v18 row_newbcast:15 row_mask:0xf bank_mask:0xf
  v_mov_b32 v31, v19 row_newbcast:15 row_mask:0xf bank_mask:0xf
  v_mfma_f32_16x16x32_bf16 v[32:35], v[24:27], v[120:123], v[32:35]
  v_mfma_f32_16x16x32_bf16 v[36:39], v[24:27], v[184:187], v[36:39]
  v_mfma_f32_16x16x32_bf16 v[32:35], v[28:31], v[124:127], v[32:35]
  v_mfma_f32_16x16x32_bf16 v[36:39], v[28:31], v[188:191], v[36:39]
  s_mov_b32 s38, 0
  s_add_u32 s36, s32, s62
  s_add_u32 s28, s36, 1
  v_mov_b32 v18, s28
  s_mov_b32 s28, 0x00010001
  s_mov_b32 s29, 0x00100010
  s_nop 0
  v_and_or_b32 v14, v32, -4, v18
  v_and_or_b32 v15, v36, -4, v18
  ds_write_b64 v10, v[14:15]
.g2_kernel_d_x:
  ds_read_b64 v[16:17], v11
  s_add_u32 s38, s38, 1
  s_waitcnt lgkmcnt(0)
  v_and_b32 v18, 3, v16
  v_and_b32 v19, 3, v17
  v_min_u32 v18, v18, v19
  v_cmp_ge_u32 vcc, s36, v18
  s_cbranch_vccz .g2_kernel_d_xd
  s_cmp_lt_u32 s38, 524288
  s_cbranch_scc1 .g2_kernel_d_x
.g2_kernel_d_xd:
  v_add_f32 v16, v16, v14
  v_add_f32 v17, v17, v15
  v_mul_f32 v18, -1.4426950408889634, v16
  v_exp_f32 v18, v18
  v_mul_f32 v16, v16, v17
  v_add_f32 v18, 1.0, v18
  v_rcp_f32 v18, v18
  s_nop 0
  v_mul_f32 v16, v16, v18
  s_nop 1
  v_mov_b32 v17, v16 quad_perm:[1,0,3,2] row_mask:0xf bank_mask:0xf
  v_cvt_pk_bf16_f32 v16, v16, v17
  s_nop 1
  v_mov_b32 v20, v16 row_newbcast:0 row_mask:0x5 bank_mask:0xf
  v_mov_b32 v21, v16 row_newbcast:2 row_mask:0x5 bank_mask:0xf
  v_mov_b32 v22, v16 row_newbcast:4 row_mask:0x5 bank_mask:0xf
  v_mov_b32 v23, v16 row_newbcast:6 row_mask:0x5 bank_mask:0xf
  v_mov_b32 v20, v16 row_newbcast:8 row_mask:0xa bank_mask:0xf
  v_mov_b32 v21, v16 row_newbcast:10 row_mask:0xa bank_mask:0xf
  v_mov_b32 v22, v16 row_newbcast:12 row_mask:0xa bank_mask:0xf
  v_mov_b32 v23, v16 row_newbcast:14 row_mask:0xa bank_mask:0xf
  v_cndmask_b32 v24, 0, v20, s[28:29]
  v_cndmask_b32 v25, 0, v21, s[28:29]
  v_cndmask_b32 v26, 0, v22, s[28:29]
  v_cndmask_b32 v27, 0, v23, s[28:29]
  s_lshl_b64 s[28:29], s[28:29], 1
  s_nop 0
  v_mfma_f32_16x16x32_bf16 v[40:43], v[24:27], v[192:195], 0
  v_mfma_f32_16x16x32_bf16 v[44:47], v[24:27], v[208:211], 0
  v_mfma_f32_16x16x32_bf16 v[48:51], v[24:27], v[224:227], 0
  v_mfma_f32_16x16x32_bf16 v[52:55], v[24:27], v[240:243], 0
  v_cndmask_b32 v28, 0, v20, s[28:29]
  v_cndmask_b32 v29, 0, v21, s[28:29]
  v_cndmask_b32 v30, 0, v22, s[28:29]
  v_cndmask_b32 v31, 0, v23, s[28:29]
  s_lshl_b64 s[28:29], s[28:29], 1
  s_nop 0
  v_mfma_f32_16x16x32_bf16 v[40:43], v[28:31], v[196:199], v[40:43]
  v_mfma_f32_16x16x32_bf16 v[44:47], v[28:31], v[212:215], v[44:47]
  v_mfma_f32_16x16x32_bf16 v[48:51], v[28:31], v[228:231], v[48:51]
  v_mfma_f32_16x16x32_bf16 v[52:55], v[28:31], v[244:247], v[52:55]
  v_cndmask_b32 v32, 0, v20, s[28:29]
  v_cndmask_b32 v33, 0, v21, s[28:29]
  v_cndmask_b32 v34, 0, v22, s[28:29]
  v_cndmask_b32 v35, 0, v23, s[28:29]
  s_lshl_b64 s[28:29], s[28:29], 1
  s_nop 0
  v_mfma_f32_16x16x32_bf16 v[40:43], v[32:35], v[200:203], v[40:43]
  v_mfma_f32_16x16x32_bf16 v[44:47], v[32:35], v[216:219], v[44:47]
  v_mfma_f32_16x16x32_bf16 v[48:51], v[32:35], v[232:235], v[48:51]
  v_mfma_f32_16x16x32_bf16 v[52:55], v[32:35], v[248:251], v[52:55]
  v_cndmask_b32 v36, 0, v20, s[28:29]
  v_cndmask_b32 v37, 0, v21, s[28:29]
  v_cndmask_b32 v38, 0, v22, s[28:29]
  v_cndmask_b32 v39, 0, v23, s[28:29]
  s_lshl_b64 s[28:29], s[28:29], 1
  s_nop 0
  v_mfma_f32_16x16x32_bf16 v[40:43], v[36:39], v[204:207], v[40:43]
  v_mfma_f32_16x16x32_bf16 v[44:47], v[36:39], v[220:223], v[44:47]
  v_mfma_f32_16x16x32_bf16 v[48:51], v[36:39], v[236:239], v[48:51]
  v_mfma_f32_16x16x32_bf16 v[52:55], v[36:39], v[252:255], v[52:55]
  s_mov_b32 exec_hi, 0
  s_nop 3
  v_or_b32 v40, 1, v40
  v_or_b32 v42, 1, v42
  buffer_store_dwordx4 v[40:43], v3, s[4:7], s26 offen offset:0 sc1
  v_or_b32 v44, 1, v44
  v_or_b32 v46, 1, v46
  buffer_store_dwordx4 v[44:47], v3, s[4:7], s26 offen offset:512 sc1
  v_or_b32 v48, 1, v48
  v_or_b32 v50, 1, v50
  buffer_store_dwordx4 v[48:51], v3, s[4:7], s26 offen offset:1024 sc1
  v_or_b32 v52, 1, v52
  v_or_b32 v54, 1, v54
  buffer_store_dwordx4 v[52:55], v3, s[4:7], s26 offen offset:1536 sc1
  s_mov_b64 exec, -1
  s_branch .g2_kernel_d_e
.g2_kernel_d_none:
  s_sleep 24
.g2_kernel_d_e:
  s_add_u32 m0, s71, 112
  s_mov_b32 s29, .g2_kernel_tab-.g2_kernel_pc+4
  s_mov_b64 exec, 1
  buffer_load_dword off, s[64:67], s29 lds
  s_mov_b64 exec, -1
  s_cmp_lg_u32 s62, 0
  s_cbranch_scc1 .g2_kernel_d_t
  s_mov_b32 s62, 1
  s_mov_b32 s63, 0x1800000
  s_mov_b32 s70, 2
  s_mov_b32 s71, 155776
  s_branch .g2_kernel_v
.g2_kernel_d_t:
  s_cmp_lg_u32 s20, 0
  s_cbranch_scc1 .g2_kernel_d_t1
  v_mov_b32 v62, -1.4426950408889634
  v_mul_f32 v62, s27, v62
  v_exp_f32 v62, v62
  v_lshlrev_b32 v14, 12, v2
  v_min_u32 v15, 126976, v14
  s_lshl_b32 s21, s17, 4
  s_add_u32 s21, s21, s18
  s_lshl_b32 s21, s21, 4
  s_mul_i32 s22, s32, 0x270000
  s_add_u32 s21, s21, s22
  s_add_u32 s21, s21, 0x2890000
  s_add_u32 s22, s21, 262144
  s_add_u32 s24, s21, 524288
  s_add_u32 s25, s21, 786432
  v_add_f32 v62, 1.0, v62
  v_rcp_f32 v62, v62
  v_lshlrev_b32 v56, 16, v56
  v_fma_f32 v56, v56, v61, -v60
  v_lshlrev_b32 v57, 16, v57
  v_fma_f32 v57, v57, v61, -v60
  v_lshlrev_b32 v58, 16, v58
  v_fma_f32 v58, v58, v61, -v60
  v_lshlrev_b32 v59, 16, v59
  v_fma_f32 v59, v59, v61, -v60
  s_sleep 8
  s_mov_b32 s38, 0
.g2_kernel_gx62:
  buffer_load_dwordx4 v[16:19], v14, s[4:7], s21 offen sc1
  buffer_load_dwordx4 v[20:23], v14, s[4:7], s22 offen sc1
  buffer_load_dwordx4 v[24:27], v14, s[4:7], s24 offen sc1
  buffer_load_dwordx4 v[28:31], v15, s[4:7], s25 offen sc1
  s_add_u32 s38, s38, 1
  s_waitcnt vmcnt(0)
  v_min3_u32 v6, v16, v18, v20
  v_min3_u32 v6, v6, v22, v24
  v_min3_u32 v6, v6, v26, v28
  v_min_u32 v6, v6, v30
  v_cmp_eq_u32 vcc, 0, v6
  s_cbranch_vccz .g2_kernel_gx62d
  s_mov_b64 exec, vcc
  s_cmp_lt_u32 s38, 131072
  s_cbranch_scc1 .g2_kernel_gx62
.g2_kernel_gx62d:
  s_mov_b64 exec, -1
  v_add_f32 v16, v16, v20
  v_add_f32 v17, v17, v21
  v_add_f32 v18, v18, v22
  v_add_f32 v19, v19, v23
  s_mov_b32 exec_hi, 0
  v_add_f32 v24, v24, v28
  v_add_f32 v25, v25, v29
  v_add_f32 v26, v26, v30
  v_add_f32 v27, v27, v31
  s_mov_b64 exec, -1
  v_add_f32 v16, v16, v24
  v_add_f32 v17, v17, v25
  v_add_f32 v18, v18, v26
  v_add_f32 v19, v19, v27
  v_add_f32 v16, v16, v16 row_ror:8 row_mask:0xf bank_mask:0xf
  v_add_f32 v17, v17, v17 row_ror:8 row_mask:0xf bank_mask:0xf
  v_add_f32 v18, v18, v18 row_ror:8 row_mask:0xf bank_mask:0xf
  v_add_f32 v19, v19, v19 row_ror:8 row_mask:0xf bank_mask:0xf
  v_add_f32 v16, v16, v16 row_ror:4 row_mask:0xf bank_mask:0xf
  v_add_f32 v17, v17, v17 row_ror:4 row_mask:0xf bank_mask:0xf
  v_add_f32 v18, v18, v18 row_ror:4 row_mask:0xf bank_mask:0xf
  v_add_f32 v19, v19, v19 row_ror:4 row_mask:0xf bank_mask:0xf
  v_add_f32 v16, v16, v16 row_ror:2 row_mask:0xf bank_mask:0xf
  v_add_f32 v17, v17, v17 row_ror:2 row_mask:0xf bank_mask:0xf
  v_add_f32 v18, v18, v18 row_ror:2 row_mask:0xf bank_mask:0xf
  v_add_f32 v19, v19, v19 row_ror:2 row_mask:0xf bank_mask:0xf
  v_add_f32 v16, v16, v16 row_ror:1 row_mask:0xf bank_mask:0xf
  v_add_f32 v17, v17, v17 row_ror:1 row_mask:0xf bank_mask:0xf
  v_add_f32 v18, v18, v18 row_ror:1 row_mask:0xf bank_mask:0xf
  v_add_f32 v19, v19, v19 row_ror:1 row_mask:0xf bank_mask:0xf
  v_add_f32 v16, v16, v16 row_bcast:15 row_mask:0xa bank_mask:0xf
  v_add_f32 v17, v17, v17 row_bcast:15 row_mask:0xa bank_mask:0xf
  v_add_f32 v18, v18, v18 row_bcast:15 row_mask:0xa bank_mask:0xf
  v_add_f32 v19, v19, v19 row_bcast:15 row_mask:0xa bank_mask:0xf
  v_add_f32 v16, v16, v16 row_bcast:31 row_mask:0xc bank_mask:0xf
  v_add_f32 v17, v17, v17 row_bcast:31 row_mask:0xc bank_mask:0xf
  v_add_f32 v18, v18, v18 row_bcast:31 row_mask:0xc bank_mask:0xf
  v_add_f32 v19, v19, v19 row_bcast:31 row_mask:0xc bank_mask:0xf
  s_lshl_b32 s24, s77, 11
  s_lshl_b32 s25, s17, 7
  s_add_u32 s24, s24, s25
  s_lshl_b32 s25, s18, 1
  s_add_u32 s24, s24, s25
.g2_kernel_d_t1:
  v_mov_b32 v6, s71
  s_mov_b32 s38, 0
.g2_kernel_wg63:
  ds_read_b32 v7, v6 offset:88
  s_add_u32 s38, s38, 1
  s_waitcnt lgkmcnt(0)
  v_cmp_gt_u32 vcc, 1, v7
  s_cbranch_vccz .g2_kernel_wg63d
  s_cmp_lt_u32 s38, 524288
  s_cbranch_scc1 .g2_kernel_wg63
.g2_kernel_wg63d:
  ds_read_b32 v6, v6 offset:92
  v_readfirstlane_b32 s33, v7
  s_cmp_lg_u32 s32, 0
  s_cselect_b32 s33, 1, s33
  s_cmp_lg_u32 s20, 0
  s_cbranch_scc1 .g2_kernel_d_t2
  s_cmp_lg_u32 s33, 1
  s_cbranch_scc1 .g2_kernel_d_t4
  v_fmac_f32 v56, v16, v62
  v_fmac_f32 v57, v17, v62
  v_fmac_f32 v58, v18, v62
  v_fmac_f32 v59, v19, v62
.g2_kernel_d_t4:
  s_mov_b32 s28, s56
  s_mov_b32 s29, s57
  s_mov_b32 s30, 0x400000
  s_mov_b32 s31, 0x00020000
  v_cvt_pk_bf16_f32 v56, v56, v57
  v_cvt_pk_bf16_f32 v58, v58, v59
  s_mov_b32 exec_lo, 0
  s_mov_b32 exec_hi, 0x80000000
  buffer_store_short v56, v4, s[28:31], s24 offen
  buffer_store_short_d16_hi v56, v4, s[28:31], s24 offen offset:32
  buffer_store_short v58, v4, s[28:31], s24 offen offset:64
  buffer_store_short_d16_hi v58, v4, s[28:31], s24 offen offset:96
  s_mov_b64 exec, -1
.g2_kernel_d_t2:
  s_cmp_eq_u32 s33, 1
  s_cbranch_scc1 .g2_kernel_fin
  s_waitcnt vmcnt(0) lgkmcnt(0)
  v_readfirstlane_b32 s27, v6
  s_sub_u32 s77, s33, 2
  s_mov_b32 s32, 1
  s_add_u32 s26, s26, 0x270000
  s_branch .g2_kernel_d_r
.g2_kernel_fin1:
.g2_kernel_fin:
.g2_kernel_end:
  s_endpgm
.g2_kernel_q_i2:
  v_mov_b32 v6, 155648
  s_mov_b32 s38, 0
.g2_kernel_wg1:
  ds_read_b32 v7, v6 offset:20
  s_add_u32 s38, s38, 1
  s_waitcnt lgkmcnt(0)
  v_cmp_gt_u32 vcc, 4, v7
  s_cbranch_vccz .g2_kernel_wg1d
  s_cmp_lt_u32 s38, 524288
  s_cbranch_scc1 .g2_kernel_wg1
.g2_kernel_wg1d:
  s_branch .g2_kernel_q_i3
.g2_kernel_q_spin:
  s_mov_b32 s38, 0
.g2_kernel_q_spinl:
  ds_read_b32 v151, v150
  s_add_u32 s38, s38, 1
  s_waitcnt lgkmcnt(0)
  v_cmp_lt_i32 vcc, s33, v151
  s_cbranch_vccnz .g2_kernel_q_spinr
  s_cmp_lt_u32 s38, 524288
  s_cbranch_scc1 .g2_kernel_q_spinl
.g2_kernel_q_spinr:
  s_setpc_b64 s[68:69]
.g2_kernel_q_wf:
  s_call_b64 s[68:69], .g2_kernel_q_spin
  s_branch .g2_kernel_q_backf
.g2_kernel_q_w7:
  s_call_b64 s[68:69], .g2_kernel_q_spin
  s_branch .g2_kernel_q_back7
.g2_kernel_q_w0:
  s_call_b64 s[68:69], .g2_kernel_q_spin
  s_branch .g2_kernel_q_back0
.g2_kernel_q_w1:
  s_call_b64 s[68:69], .g2_kernel_q_spin
  s_branch .g2_kernel_q_back1
.g2_kernel_q_w2:
  s_call_b64 s[68:69], .g2_kernel_q_spin
  s_branch .g2_kernel_q_back2
.g2_kernel_q_w3:
  s_call_b64 s[68:69], .g2_kernel_q_spin
  s_branch .g2_kernel_q_back3
.g2_kernel_q_w4:
  s_call_b64 s[68:69], .g2_kernel_q_spin
  s_branch .g2_kernel_q_back4
.g2_kernel_q_w5:
  s_call_b64 s[68:69], .g2_kernel_q_spin
  s_branch .g2_kernel_q_back5
.g2_kernel_q_w6:
  s_call_b64 s[68:69], .g2_kernel_q_spin
  s_branch .g2_kernel_q_back6
.g2_kernel_q_cons2:
  s_lshr_b32 s26, s16, 1
  s_lshl_b32 s26, s26, 13
  v_add_u32 v144, s26, v3
  v_add_u32 v145, 1024, v144
  s_branch .g2_kernel_q_cs
.g2_kernel_q_ew:
  s_mov_b32 s38, 0
.g2_kernel_q_ewl:
  ds_read_b32 v62, v13 offset:0
  ds_read_b32 v63, v58
  s_add_u32 s38, s38, 1
  s_waitcnt lgkmcnt(0)
  v_cmp_gt_u32 vcc, 2, v62
  v_cmp_gt_u32 s[14:15], s12, v63
  s_or_b64 vcc, vcc, s[14:15]
  s_cbranch_scc0 .g2_kernel_q_ec
  s_cmp_lt_u32 s38, 524288
  s_cbranch_scc1 .g2_kernel_q_ewl
.g2_kernel_q_ec:
  ds_read_b32 v57, v13 offset:24
  ds_read_b128 v[40:43], v52 offset:5120
  ds_read_b128 v[44:47], v52 offset:5184
  ds_read_b32 v24, v50 offset:2816
  ds_read_b32 v25, v50 offset:3328
  ds_read_b32 v26, v50 offset:2880
  ds_read_b32 v27, v50 offset:3392
  ds_read_b32 v28, v50 offset:2944
  ds_read_b32 v29, v50 offset:3456
  ds_read_b32 v30, v50 offset:3008
  ds_read_b32 v31, v50 offset:3520
  ds_read_b128 v[64:67], v51 offset:2816
  ds_read_b128 v[80:83], v51 offset:3328
  ds_read_b128 v[68:71], v51 offset:2880
  ds_read_b128 v[84:87], v51 offset:3392
  ds_read_b128 v[72:75], v51 offset:2944
  ds_read_b128 v[88:91], v51 offset:3456
  ds_read_b128 v[76:79], v51 offset:3008
  ds_read_b128 v[92:95], v51 offset:3520
  ds_read_b32 v48, v53 offset:5376
  ds_read_b32 v49, v53 offset:5440
  ds_read_b128 v[32:35], v52 offset:4864
  ds_read_b128 v[36:39], v52 offset:4928
  s_waitcnt lgkmcnt(0)
  s_branch .g2_kernel_q_eb
.g2_kernel_q_patch:
  v_readfirstlane_b32 s35, v57
  s_sub_u32 s28, s35, 1
  s_lshr_b32 s29, s28, 6
  s_lshr_b32 s30, s16, 1
  s_add_u32 s35, s35, 0x100
  s_cmp_lg_u32 s29, s30
  s_cbranch_scc1 .g2_kernel_q_pback
  s_add_u32 s35, s35, 0x100
  s_mov_b32 s77, 0x40000000
  s_and_b32 s29, s28, 15
  s_mov_b32 s14, 0x00010001
  s_mov_b32 s15, 0x00010001
  s_lshl_b64 s[14:15], s[14:15], s29
  s_and_b32 s29, s28, 12
  s_lshl_b32 s29, s29, 2
  s_lshl_b64 s[30:31], 0xffff, s29
  v_subrev_u32 v96, 155648, v53
  v_lshlrev_b32 v96, 2, v96
  v_add_u32 v96, 155648, v96
  s_bfe_u32 s29, s28, 0x20004
  s_cmp_lg_u32 s29, 0
  s_cbranch_scc1 .g2_kernel_q_pv1
  s_mov_b64 exec, s[14:15]
  ds_write_b128 v52, v[160:163] offset:5632
  ds_write_b128 v52, v[176:179] offset:5696
  ds_write_b128 v52, v[192:195] offset:5888
  ds_write_b128 v52, v[208:211] offset:5952
  s_mov_b64 exec, s[30:31]
  ds_write_b128 v96, v[224:227] offset:6144
  ds_write_b128 v96, v[240:243] offset:6400
  s_mov_b64 exec, -1
  s_waitcnt lgkmcnt(0)
  s_branch .g2_kernel_q_pback
.g2_kernel_q_pv1:
  s_cmp_lg_u32 s29, 1
  s_cbranch_scc1 .g2_kernel_q_pv2
  s_mov_b64 exec, s[14:15]
  ds_write_b128 v52, v[164:167] offset:5632
  ds_write_b128 v52, v[180:183] offset:5696
  ds_write_b128 v52, v[196:199] offset:5888
  ds_write_b128 v52, v[212:215] offset:5952
  s_mov_b64 exec, s[30:31]
  ds_write_b128 v96, v[228:231] offset:6144
  ds_write_b128 v96, v[244:247] offset:6400
  s_mov_b64 exec, -1
  s_waitcnt lgkmcnt(0)
  s_branch .g2_kernel_q_pback
.g2_kernel_q_pv2:
  s_cmp_lg_u32 s29, 2
  s_cbranch_scc1 .g2_kernel_q_pv3
  s_mov_b64 exec, s[14:15]
  ds_write_b128 v52, v[168:171] offset:5632
  ds_write_b128 v52, v[184:187] offset:5696
  ds_write_b128 v52, v[200:203] offset:5888
  ds_write_b128 v52, v[216:219] offset:5952
  s_mov_b64 exec, s[30:31]
  ds_write_b128 v96, v[232:235] offset:6144
  ds_write_b128 v96, v[248:251] offset:6400
  s_mov_b64 exec, -1
  s_waitcnt lgkmcnt(0)
  s_branch .g2_kernel_q_pback
.g2_kernel_q_pv3:
  s_mov_b64 exec, s[14:15]
  ds_write_b128 v52, v[172:175] offset:5632
  ds_write_b128 v52, v[188:191] offset:5696
  ds_write_b128 v52, v[204:207] offset:5888
  ds_write_b128 v52, v[220:223] offset:5952
  s_mov_b64 exec, s[30:31]
  ds_write_b128 v96, v[236:239] offset:6144
  ds_write_b128 v96, v[252:255] offset:6400
  s_mov_b64 exec, -1
  s_waitcnt lgkmcnt(0)
  s_branch .g2_kernel_q_pback
.g2_kernel_q_nk:
  v_pk_mul_f32 v[152:153], v[40:41], v[24:25] op_sel:[0,1] op_sel_hi:[1,1]
  v_pk_mul_f32 v[154:155], v[42:43], v[24:25] op_sel:[0,1] op_sel_hi:[1,1]
  v_pk_mul_f32 v[156:157], v[44:45], v[24:25] op_sel:[0,1] op_sel_hi:[1,1]
  v_pk_mul_f32 v[158:159], v[46:47], v[24:25] op_sel:[0,1] op_sel_hi:[1,1]
  v_pk_fma_f32 v[192:193], v[192:193], v[24:25], v[152:153] op_sel_hi:[1,0,1]
  v_pk_fma_f32 v[194:195], v[194:195], v[24:25], v[154:155] op_sel_hi:[1,0,1]
  v_pk_fma_f32 v[208:209], v[208:209], v[24:25], v[156:157] op_sel_hi:[1,0,1]
  v_pk_fma_f32 v[210:211], v[210:211], v[24:25], v[158:159] op_sel_hi:[1,0,1]
  v_cvt_pk_bf16_f32 v192, v192, v193
  v_cvt_pk_bf16_f32 v193, v194, v195
  v_cvt_pk_bf16_f32 v194, v208, v209
  v_cvt_pk_bf16_f32 v195, v210, v211
  ds_write_b128 v59, v[192:195] offset:0
  v_pk_mul_f32 v[152:153], v[40:41], v[26:27] op_sel:[0,1] op_sel_hi:[1,1]
  v_pk_mul_f32 v[154:155], v[42:43], v[26:27] op_sel:[0,1] op_sel_hi:[1,1]
  v_pk_mul_f32 v[156:157], v[44:45], v[26:27] op_sel:[0,1] op_sel_hi:[1,1]
  v_pk_mul_f32 v[158:159], v[46:47], v[26:27] op_sel:[0,1] op_sel_hi:[1,1]
  v_pk_fma_f32 v[196:197], v[196:197], v[26:27], v[152:153] op_sel_hi:[1,0,1]
  v_pk_fma_f32 v[198:199], v[198:199], v[26:27], v[154:155] op_sel_hi:[1,0,1]
  v_pk_fma_f32 v[212:213], v[212:213], v[26:27], v[156:157] op_sel_hi:[1,0,1]
  v_pk_fma_f32 v[214:215], v[214:215], v[26:27], v[158:159] op_sel_hi:[1,0,1]
  v_cvt_pk_bf16_f32 v196, v196, v197
  v_cvt_pk_bf16_f32 v197, v198, v199
  v_cvt_pk_bf16_f32 v198, v212, v213
  v_cvt_pk_bf16_f32 v199, v214, v215
  ds_write_b128 v59, v[196:199] offset:128
  v_pk_mul_f32 v[152:153], v[40:41], v[28:29] op_sel:[0,1] op_sel_hi:[1,1]
  v_pk_mul_f32 v[154:155], v[42:43], v[28:29] op_sel:[0,1] op_sel_hi:[1,1]
  v_pk_mul_f32 v[156:157], v[44:45], v[28:29] op_sel:[0,1] op_sel_hi:[1,1]
  v_pk_mul_f32 v[158:159], v[46:47], v[28:29] op_sel:[0,1] op_sel_hi:[1,1]
  v_pk_fma_f32 v[200:201], v[200:201], v[28:29], v[152:153] op_sel_hi:[1,0,1]
  v_pk_fma_f32 v[202:203], v[202:203], v[28:29], v[154:155] op_sel_hi:[1,0,1]
  v_pk_fma_f32 v[216:217], v[216:217], v[28:29], v[156:157] op_sel_hi:[1,0,1]
  v_pk_fma_f32 v[218:219], v[218:219], v[28:29], v[158:159] op_sel_hi:[1,0,1]
  v_cvt_pk_bf16_f32 v200, v200, v201
  v_cvt_pk_bf16_f32 v201, v202, v203
  v_cvt_pk_bf16_f32 v202, v216, v217
  v_cvt_pk_bf16_f32 v203, v218, v219
  ds_write_b128 v59, v[200:203] offset:4096
  v_pk_mul_f32 v[152:153], v[40:41], v[30:31] op_sel:[0,1] op_sel_hi:[1,1]
  v_pk_mul_f32 v[154:155], v[42:43], v[30:31] op_sel:[0,1] op_sel_hi:[1,1]
  v_pk_mul_f32 v[156:157], v[44:45], v[30:31] op_sel:[0,1] op_sel_hi:[1,1]
  v_pk_mul_f32 v[158:159], v[46:47], v[30:31] op_sel:[0,1] op_sel_hi:[1,1]
  v_pk_fma_f32 v[204:205], v[204:205], v[30:31], v[152:153] op_sel_hi:[1,0,1]
  v_pk_fma_f32 v[206:207], v[206:207], v[30:31], v[154:155] op_sel_hi:[1,0,1]
  v_pk_fma_f32 v[220:221], v[220:221], v[30:31], v[156:157] op_sel_hi:[1,0,1]
  v_pk_fma_f32 v[222:223], v[222:223], v[30:31], v[158:159] op_sel_hi:[1,0,1]
  v_cvt_pk_bf16_f32 v204, v204, v205
  v_cvt_pk_bf16_f32 v205, v206, v207
  v_cvt_pk_bf16_f32 v206, v220, v221
  v_cvt_pk_bf16_f32 v207, v222, v223
  ds_write_b128 v59, v[204:207] offset:4224
  v_pk_mul_f32 v[152:153], v[80:81], v[48:49] op_sel:[0,0] op_sel_hi:[1,0]
  v_pk_mul_f32 v[154:155], v[82:83], v[48:49] op_sel:[0,0] op_sel_hi:[1,0]
  v_pk_mul_f32 v[156:157], v[84:85], v[48:49] op_sel:[0,0] op_sel_hi:[1,0]
  v_pk_mul_f32 v[158:159], v[86:87], v[48:49] op_sel:[0,0] op_sel_hi:[1,0]
  v_pk_fma_f32 v[224:225], v[224:225], v[64:65], v[152:153]
  v_pk_fma_f32 v[226:227], v[226:227], v[66:67], v[154:155]
  v_pk_fma_f32 v[228:229], v[228:229], v[68:69], v[156:157]
  v_pk_fma_f32 v[230:231], v[230:231], v[70:71], v[158:159]
  v_cvt_pk_bf16_f32 v224, v224, v225
  v_cvt_pk_bf16_f32 v225, v226, v227
  v_cvt_pk_bf16_f32 v226, v228, v229
  v_cvt_pk_bf16_f32 v227, v230, v231
  ds_write_b128 v60, v[224:227] offset:2048
  v_pk_mul_f32 v[152:153], v[80:81], v[48:49] op_sel:[0,1] op_sel_hi:[1,1]
  v_pk_mul_f32 v[154:155], v[82:83], v[48:49] op_sel:[0,1] op_sel_hi:[1,1]
  v_pk_mul_f32 v[156:157], v[84:85], v[48:49] op_sel:[0,1] op_sel_hi:[1,1]
  v_pk_mul_f32 v[158:159], v[86:87], v[48:49] op_sel:[0,1] op_sel_hi:[1,1]
  v_pk_fma_f32 v[240:241], v[240:241], v[64:65], v[152:153]
  v_pk_fma_f32 v[242:243], v[242:243], v[66:67], v[154:155]
  v_pk_fma_f32 v[244:245], v[244:245], v[68:69], v[156:157]
  v_pk_fma_f32 v[246:247], v[246:247], v[70:71], v[158:159]
  v_cvt_pk_bf16_f32 v240, v240, v241
  v_cvt_pk_bf16_f32 v241, v242, v243
  v_cvt_pk_bf16_f32 v242, v244, v245
  v_cvt_pk_bf16_f32 v243, v246, v247
  ds_write_b128 v60, v[240:243] offset:2304
  v_pk_mul_f32 v[152:153], v[88:89], v[48:49] op_sel:[0,0] op_sel_hi:[1,0]
  v_pk_mul_f32 v[154:155], v[90:91], v[48:49] op_sel:[0,0] op_sel_hi:[1,0]
  v_pk_mul_f32 v[156:157], v[92:93], v[48:49] op_sel:[0,0] op_sel_hi:[1,0]
  v_pk_mul_f32 v[158:159], v[94:95], v[48:49] op_sel:[0,0] op_sel_hi:[1,0]
  v_pk_fma_f32 v[232:233], v[232:233], v[72:73], v[152:153]
  v_pk_fma_f32 v[234:235], v[234:235], v[74:75], v[154:155]
  v_pk_fma_f32 v[236:237], v[236:237], v[76:77], v[156:157]
  v_pk_fma_f32 v[238:239], v[238:239], v[78:79], v[158:159]
  v_cvt_pk_bf16_f32 v232, v232, v233
  v_cvt_pk_bf16_f32 v233, v234, v235
  v_cvt_pk_bf16_f32 v234, v236, v237
  v_cvt_pk_bf16_f32 v235, v238, v239
  ds_write_b128 v60, v[232:235] offset:6144
  v_pk_mul_f32 v[152:153], v[88:89], v[48:49] op_sel:[0,1] op_sel_hi:[1,1]
  v_pk_mul_f32 v[154:155], v[90:91], v[48:49] op_sel:[0,1] op_sel_hi:[1,1]
  v_pk_mul_f32 v[156:157], v[92:93], v[48:49] op_sel:[0,1] op_sel_hi:[1,1]
  v_pk_mul_f32 v[158:159], v[94:95], v[48:49] op_sel:[0,1] op_sel_hi:[1,1]
  v_pk_fma_f32 v[248:249], v[248:249], v[72:73], v[152:153]
  v_pk_fma_f32 v[250:251], v[250:251], v[74:75], v[154:155]
  v_pk_fma_f32 v[252:253], v[252:253], v[76:77], v[156:157]
  v_pk_fma_f32 v[254:255], v[254:255], v[78:79], v[158:159]
  v_cvt_pk_bf16_f32 v248, v248, v249
  v_cvt_pk_bf16_f32 v249, v250, v251
  v_cvt_pk_bf16_f32 v250, v252, v253
  v_cvt_pk_bf16_f32 v251, v254, v255
  ds_write_b128 v60, v[248:251] offset:6400
  v_pk_mul_f32 v[24:25], v[24:25], v[56:57] op_sel_hi:[1,0]
  v_pk_mul_f32 v[26:27], v[26:27], v[56:57] op_sel_hi:[1,0]
  v_pk_mul_f32 v[28:29], v[28:29], v[56:57] op_sel_hi:[1,0]
  v_pk_mul_f32 v[30:31], v[30:31], v[56:57] op_sel_hi:[1,0]
  v_pk_mul_f32 v[152:153], v[32:33], v[24:25] op_sel:[0,1] op_sel_hi:[1,1]
  v_pk_mul_f32 v[154:155], v[34:35], v[24:25] op_sel:[0,1] op_sel_hi:[1,1]
  v_pk_mul_f32 v[156:157], v[36:37], v[24:25] op_sel:[0,1] op_sel_hi:[1,1]
  v_pk_mul_f32 v[158:159], v[38:39], v[24:25] op_sel:[0,1] op_sel_hi:[1,1]
  v_pk_fma_f32 v[160:161], v[160:161], v[24:25], v[152:153] op_sel_hi:[1,0,1]
  v_pk_fma_f32 v[162:163], v[162:163], v[24:25], v[154:155] op_sel_hi:[1,0,1]
  v_pk_fma_f32 v[176:177], v[176:177], v[24:25], v[156:157] op_sel_hi:[1,0,1]
  v_pk_fma_f32 v[178:179], v[178:179], v[24:25], v[158:159] op_sel_hi:[1,0,1]
  v_cvt_pk_bf16_f32 v160, v160, v161
  v_cvt_pk_bf16_f32 v161, v162, v163
  v_cvt_pk_bf16_f32 v162, v176, v177
  v_cvt_pk_bf16_f32 v163, v178, v179
  ds_write_b128 v61, v[160:163] offset:0
  v_pk_mul_f32 v[152:153], v[32:33], v[26:27] op_sel:[0,1] op_sel_hi:[1,1]
  v_pk_mul_f32 v[154:155], v[34:35], v[26:27] op_sel:[0,1] op_sel_hi:[1,1]
  v_pk_mul_f32 v[156:157], v[36:37], v[26:27] op_sel:[0,1] op_sel_hi:[1,1]
  v_pk_mul_f32 v[158:159], v[38:39], v[26:27] op_sel:[0,1] op_sel_hi:[1,1]
  v_pk_fma_f32 v[164:165], v[164:165], v[26:27], v[152:153] op_sel_hi:[1,0,1]
  v_pk_fma_f32 v[166:167], v[166:167], v[26:27], v[154:155] op_sel_hi:[1,0,1]
  v_pk_fma_f32 v[180:181], v[180:181], v[26:27], v[156:157] op_sel_hi:[1,0,1]
  v_pk_fma_f32 v[182:183], v[182:183], v[26:27], v[158:159] op_sel_hi:[1,0,1]
  v_cvt_pk_bf16_f32 v164, v164, v165
  v_cvt_pk_bf16_f32 v165, v166, v167
  v_cvt_pk_bf16_f32 v166, v180, v181
  v_cvt_pk_bf16_f32 v167, v182, v183
  ds_write_b128 v61, v[164:167] offset:256
  v_pk_mul_f32 v[152:153], v[32:33], v[28:29] op_sel:[0,1] op_sel_hi:[1,1]
  v_pk_mul_f32 v[154:155], v[34:35], v[28:29] op_sel:[0,1] op_sel_hi:[1,1]
  v_pk_mul_f32 v[156:157], v[36:37], v[28:29] op_sel:[0,1] op_sel_hi:[1,1]
  v_pk_mul_f32 v[158:159], v[38:39], v[28:29] op_sel:[0,1] op_sel_hi:[1,1]
  v_pk_fma_f32 v[168:169], v[168:169], v[28:29], v[152:153] op_sel_hi:[1,0,1]
  v_pk_fma_f32 v[170:171], v[170:171], v[28:29], v[154:155] op_sel_hi:[1,0,1]
  v_pk_fma_f32 v[184:185], v[184:185], v[28:29], v[156:157] op_sel_hi:[1,0,1]
  v_pk_fma_f32 v[186:187], v[186:187], v[28:29], v[158:159] op_sel_hi:[1,0,1]
  v_cvt_pk_bf16_f32 v168, v168, v169
  v_cvt_pk_bf16_f32 v169, v170, v171
  v_cvt_pk_bf16_f32 v170, v184, v185
  v_cvt_pk_bf16_f32 v171, v186, v187
  ds_write_b128 v61, v[168:171] offset:2048
  v_pk_mul_f32 v[152:153], v[32:33], v[30:31] op_sel:[0,1] op_sel_hi:[1,1]
  v_pk_mul_f32 v[154:155], v[34:35], v[30:31] op_sel:[0,1] op_sel_hi:[1,1]
  v_pk_mul_f32 v[156:157], v[36:37], v[30:31] op_sel:[0,1] op_sel_hi:[1,1]
  v_pk_mul_f32 v[158:159], v[38:39], v[30:31] op_sel:[0,1] op_sel_hi:[1,1]
  v_pk_fma_f32 v[172:173], v[172:173], v[30:31], v[152:153] op_sel_hi:[1,0,1]
  v_pk_fma_f32 v[174:175], v[174:175], v[30:31], v[154:155] op_sel_hi:[1,0,1]
  v_pk_fma_f32 v[188:189], v[188:189], v[30:31], v[156:157] op_sel_hi:[1,0,1]
  v_pk_fma_f32 v[190:191], v[190:191], v[30:31], v[158:159] op_sel_hi:[1,0,1]
  v_cvt_pk_bf16_f32 v172, v172, v173
  v_cvt_pk_bf16_f32 v173, v174, v175
  v_cvt_pk_bf16_f32 v174, v188, v189
  v_cvt_pk_bf16_f32 v175, v190, v191
  ds_write_b128 v61, v[172:175] offset:2304
  s_add_u32 s37, s37, 32
  s_and_b32 s35, s35, 0x1ff
  s_cmp_lg_u32 s35, 0
  s_cselect_b32 s28, 0x100, 0
  s_or_b32 s35, s35, s28
  s_branch .g2_kernel_q_kd
.g2_kernel_r2:
  buffer_load_dwordx4 v[240:243], v22, s[4:7], s13 offen offset:0
  buffer_load_dwordx4 v[244:247], v22, s[4:7], s13 offen offset:512
  buffer_load_dwordx4 v[248:251], v22, s[4:7], s13 offen offset:1024
  buffer_load_dwordx4 v[252:255], v22, s[4:7], s13 offen offset:1536
  s_branch .g2_kernel_r3
.g2_kernel_a_t1c:
  s_call_b64 s[68:69], .g2_kernel_a_pick
  s_branch .g2_kernel_a_t1b
.g2_kernel_a_t2c:
  s_call_b64 s[68:69], .g2_kernel_a_pick
  s_branch .g2_kernel_a_t2b
.g2_kernel_a_t3c:
  s_call_b64 s[68:69], .g2_kernel_a_pick
  s_branch .g2_kernel_a_t3b
.g2_kernel_a_three:
  s_andn2_b32 s33, s36, s34
  s_cbranch_scc0 .g2_kernel_a_t1c
.g2_kernel_a_t1b:
  s_ff1_i32_b32 s33, s33
  s_bitset1_b32 s34, s33
  s_xor_b32 s33, s33, s24
  s_lshl_b32 s33, s33, s25
  s_add_u32 s22, s20, s33
  s_addc_u32 s23, s21, 0
  global_load_dwordx4 v[192:195], v3, s[22:23] offset:0
  global_load_dwordx4 v[196:199], v3, s[22:23] offset:1024
  global_load_dwordx4 v[200:203], v3, s[22:23] offset:2048
  global_load_dwordx4 v[204:207], v3, s[22:23] offset:3072
  s_andn2_b32 s33, s36, s34
  s_cbranch_scc0 .g2_kernel_a_t2c
.g2_kernel_a_t2b:
  s_ff1_i32_b32 s33, s33
  s_bitset1_b32 s34, s33
  s_xor_b32 s33, s33, s24
  s_lshl_b32 s33, s33, s25
  s_add_u32 s22, s20, s33
  s_addc_u32 s23, s21, 0
  global_load_dwordx4 v[208:211], v3, s[22:23] offset:0
  global_load_dwordx4 v[212:215], v3, s[22:23] offset:1024
  global_load_dwordx4 v[216:219], v3, s[22:23] offset:2048
  global_load_dwordx4 v[220:223], v3, s[22:23] offset:3072
  s_andn2_b32 s33, s36, s34
  s_cbranch_scc0 .g2_kernel_a_t3c
.g2_kernel_a_t3b:
  s_ff1_i32_b32 s33, s33
  s_bitset1_b32 s34, s33
  s_xor_b32 s33, s33, s24
  s_lshl_b32 s33, s33, s25
  s_add_u32 s22, s20, s33
  s_addc_u32 s23, s21, 0
  global_load_dwordx4 v[224:227], v3, s[22:23] offset:0
  global_load_dwordx4 v[228:231], v3, s[22:23] offset:1024
  global_load_dwordx4 v[232:235], v3, s[22:23] offset:2048
  global_load_dwordx4 v[236:239], v3, s[22:23] offset:3072
  s_setpc_b64 s[72:73]
.g2_kernel_a_o0c:
  s_call_b64 s[68:69], .g2_kernel_a_pick
  s_branch .g2_kernel_a_o0b
.g2_kernel_a_o1c:
  s_call_b64 s[68:69], .g2_kernel_a_pick
  s_branch .g2_kernel_a_o1b
.g2_kernel_a_o2c:
  s_call_b64 s[68:69], .g2_kernel_a_pick
  s_branch .g2_kernel_a_o2b
.g2_kernel_a_o3c:
  s_call_b64 s[68:69], .g2_kernel_a_pick
  s_branch .g2_kernel_a_o3b
.g2_kernel_a_r0c:
  s_call_b64 s[68:69], .g2_kernel_a_pick
  s_branch .g2_kernel_a_r0b
.g2_kernel_a_r1c:
  s_call_b64 s[68:69], .g2_kernel_a_pick
  s_branch .g2_kernel_a_r1b
.g2_kernel_a_r2c:
  s_call_b64 s[68:69], .g2_kernel_a_pick
  s_branch .g2_kernel_a_r2b
.g2_kernel_a_own:
  s_waitcnt vmcnt(0) lgkmcnt(0)
  s_mov_b64 exec, 1
  s_cmp_ge_u32 s35, 0x200
  s_cbranch_scc1 .g2_kernel_a_ow1
  buffer_store_dword v15, v4, s[4:7], s37 offen sc1
  s_branch .g2_kernel_a_ow2
.g2_kernel_a_ow1:
  ds_add_u32 v13, v5 offset:56
.g2_kernel_a_ow2:
  s_mov_b64 exec, -1
  s_add_u32 s37, s37, 64
  s_mov_b32 s14, 0
  s_andn2_b32 s33, s36, s34
  s_cbranch_scc0 .g2_kernel_a_o0c
.g2_kernel_a_o0b:
  s_ff1_i32_b32 s33, s33
  s_bitset1_b32 s34, s33
  s_lshl_b32 s28, s33, 0
  s_or_b32 s14, s14, s28
  s_xor_b32 s33, s33, s24
  s_lshl_b32 s33, s33, s25
  s_add_u32 s22, s20, s33
  s_addc_u32 s23, s21, 0
  global_load_dwordx4 v[176:179], v3, s[22:23] offset:0
  global_load_dwordx4 v[180:183], v3, s[22:23] offset:1024
  global_load_dwordx4 v[184:187], v3, s[22:23] offset:2048
  global_load_dwordx4 v[188:191], v3, s[22:23] offset:3072
  s_andn2_b32 s33, s36, s34
  s_cbranch_scc0 .g2_kernel_a_o1c
.g2_kernel_a_o1b:
  s_ff1_i32_b32 s33, s33
  s_bitset1_b32 s34, s33
  s_lshl_b32 s28, s33, 8
  s_or_b32 s14, s14, s28
  s_xor_b32 s33, s33, s24
  s_lshl_b32 s33, s33, s25
  s_add_u32 s22, s20, s33
  s_addc_u32 s23, s21, 0
  global_load_dwordx4 v[192:195], v3, s[22:23] offset:0
  global_load_dwordx4 v[196:199], v3, s[22:23] offset:1024
  global_load_dwordx4 v[200:203], v3, s[22:23] offset:2048
  global_load_dwordx4 v[204:207], v3, s[22:23] offset:3072
  s_andn2_b32 s33, s36, s34
  s_cbranch_scc0 .g2_kernel_a_o2c
.g2_kernel_a_o2b:
  s_ff1_i32_b32 s33, s33
  s_bitset1_b32 s34, s33
  s_lshl_b32 s28, s33, 16
  s_or_b32 s14, s14, s28
  s_xor_b32 s33, s33, s24
  s_lshl_b32 s33, s33, s25
  s_add_u32 s22, s20, s33
  s_addc_u32 s23, s21, 0
  global_load_dwordx4 v[208:211], v3, s[22:23] offset:0
  global_load_dwordx4 v[212:215], v3, s[22:23] offset:1024
  global_load_dwordx4 v[216:219], v3, s[22:23] offset:2048
  global_load_dwordx4 v[220:223], v3, s[22:23] offset:3072
  s_andn2_b32 s33, s36, s34
  s_cbranch_scc0 .g2_kernel_a_o3c
.g2_kernel_a_o3b:
  s_ff1_i32_b32 s33, s33
  s_bitset1_b32 s34, s33
  s_lshl_b32 s28, s33, 24
  s_or_b32 s14, s14, s28
  s_xor_b32 s33, s33, s24
  s_lshl_b32 s33, s33, s25
  s_add_u32 s22, s20, s33
  s_addc_u32 s23, s21, 0
  global_load_dwordx4 v[224:227], v3, s[22:23] offset:0
  global_load_dwordx4 v[228:231], v3, s[22:23] offset:1024
  global_load_dwordx4 v[232:235], v3, s[22:23] offset:2048
  global_load_dwordx4 v[236:239], v3, s[22:23] offset:3072
  s_and_b32 s15, s34, -2
  s_mov_b32 s34, -1
  s_mov_b32 s26, -1
  s_waitcnt vmcnt(12)
  s_branch .g2_kernel_a_ob
.g2_kernel_a_redo:
  v_mfma_f32_32x32x16_bf16 v[104:119], v[236:239], v[172:175], v[104:119]
  v_smfmac_f32_16x16x64_bf16 v[132:135], v[16:19], v[168:175], v20
  v_mov_b32 v6, s71
  s_mov_b32 s38, 0
.g2_kernel_wg3:
  ds_read_b32 v7, v6 offset:60
  s_add_u32 s38, s38, 1
  s_waitcnt lgkmcnt(0)
  v_cmp_gt_u32 vcc, 1, v7
  s_cbranch_vccz .g2_kernel_wg3d
  s_sleep 1
  s_cmp_lt_u32 s38, 524288
  s_cbranch_scc1 .g2_kernel_wg3
.g2_kernel_wg3d:
  ds_read_b32 v7, v8
  s_mov_b32 s34, s15
  s_mov_b32 s26, 0
  s_waitcnt lgkmcnt(0)
  v_cmp_lt_u32 vcc, s62, v7
  s_mov_b32 s36, vcc_lo
  s_sub_u32 s28, s35, 1
  s_bfe_u32 s28, s28, 0x20005
  s_mov_b32 s35, 0
  s_waitcnt vmcnt(0)
  s_cmp_lg_u32 s28, 0
  s_cbranch_scc1 .g2_kernel_a_rd1
  ds_read_b128 v[24:27], v14 offset:8192
  ds_read_b128 v[28:31], v14 offset:9216
  v_mov_b32 v120, 0
  v_mov_b32 v121, 0
  s_waitcnt lgkmcnt(0)
  v_mfma_f32_32x32x16_bf16 v[136:151], v[176:179], v[24:27], 0
  v_mfma_f32_32x32x16_bf16 v[136:151], v[180:183], v[28:31], v[136:151]
  v_mfma_f32_32x32x16_bf16 v[152:167], v[192:195], v[24:27], 0
  s_nop 10
  v_exp_f32 v136, v136
  v_exp_f32 v137, v137
  v_exp_f32 v138, v138
  v_exp_f32 v139, v139
  v_exp_f32 v140, v140
  v_exp_f32 v141, v141
  v_exp_f32 v142, v142
  v_exp_f32 v143, v143
  v_mfma_f32_32x32x16_bf16 v[152:167], v[196:199], v[28:31], v[152:167]
  v_cvt_pk_bf16_f32 v168, v136, v137
  v_cvt_pk_bf16_f32 v169, v138, v139
  v_cvt_pk_bf16_f32 v170, v140, v141
  v_cvt_pk_bf16_f32 v171, v142, v143
  v_exp_f32 v144, v144
  v_exp_f32 v145, v145
  v_exp_f32 v146, v146
  v_exp_f32 v147, v147
  v_mfma_f32_32x32x16_bf16 v[56:71], v[184:187], v[168:171], 0
  v_exp_f32 v148, v148
  v_exp_f32 v149, v149
  v_exp_f32 v150, v150
  v_exp_f32 v151, v151
  v_cvt_pk_bf16_f32 v172, v144, v145
  v_cvt_pk_bf16_f32 v173, v146, v147
  v_cvt_pk_bf16_f32 v174, v148, v149
  v_cvt_pk_bf16_f32 v175, v150, v151
  v_mfma_f32_32x32x16_bf16 v[136:151], v[208:211], v[24:27], 0
  v_exp_f32 v152, v152
  v_exp_f32 v153, v153
  v_exp_f32 v154, v154
  v_mfma_f32_32x32x16_bf16 v[56:71], v[188:191], v[172:175], v[56:71]
  s_call_b64 s[72:73], .g2_kernel_a_ld0
  v_exp_f32 v155, v155
  v_exp_f32 v156, v156
  v_exp_f32 v157, v157
  v_smfmac_f32_16x16x64_bf16 v[120:123], v[16:19], v[168:175], v20
  v_exp_f32 v158, v158
  v_exp_f32 v159, v159
  v_mfma_f32_32x32x16_bf16 v[136:151], v[212:215], v[28:31], v[136:151]
  v_cvt_pk_bf16_f32 v168, v152, v153
  v_cvt_pk_bf16_f32 v169, v154, v155
  v_cvt_pk_bf16_f32 v170, v156, v157
  v_cvt_pk_bf16_f32 v171, v158, v159
  v_exp_f32 v160, v160
  v_exp_f32 v161, v161
  v_exp_f32 v162, v162
  v_exp_f32 v163, v163
  v_mfma_f32_32x32x16_bf16 v[56:71], v[200:203], v[168:171], v[56:71]
  v_exp_f32 v164, v164
  v_exp_f32 v165, v165
  v_exp_f32 v166, v166
  v_exp_f32 v167, v167
  v_cvt_pk_bf16_f32 v172, v160, v161
  v_cvt_pk_bf16_f32 v173, v162, v163
  v_cvt_pk_bf16_f32 v174, v164, v165
  v_cvt_pk_bf16_f32 v175, v166, v167
  v_mfma_f32_32x32x16_bf16 v[152:167], v[224:227], v[24:27], 0
  v_exp_f32 v136, v136
  v_exp_f32 v137, v137
  v_exp_f32 v138, v138
  v_mfma_f32_32x32x16_bf16 v[56:71], v[204:207], v[172:175], v[56:71]
  s_call_b64 s[72:73], .g2_kernel_a_ld1
  v_exp_f32 v139, v139
  v_exp_f32 v140, v140
  v_exp_f32 v141, v141
  v_smfmac_f32_16x16x64_bf16 v[120:123], v[16:19], v[168:175], v20
  v_exp_f32 v142, v142
  v_exp_f32 v143, v143
  v_mfma_f32_32x32x16_bf16 v[152:167], v[228:231], v[28:31], v[152:167]
  v_cvt_pk_bf16_f32 v168, v136, v137
  v_cvt_pk_bf16_f32 v169, v138, v139
  v_cvt_pk_bf16_f32 v170, v140, v141
  v_cvt_pk_bf16_f32 v171, v142, v143
  v_exp_f32 v144, v144
  v_exp_f32 v145, v145
  v_exp_f32 v146, v146
  v_exp_f32 v147, v147
  v_mfma_f32_32x32x16_bf16 v[56:71], v[216:219], v[168:171], v[56:71]
  v_exp_f32 v148, v148
  v_exp_f32 v149, v149
  v_exp_f32 v150, v150
  v_exp_f32 v151, v151
  v_cvt_pk_bf16_f32 v172, v144, v145
  v_cvt_pk_bf16_f32 v173, v146, v147
  v_cvt_pk_bf16_f32 v174, v148, v149
  v_cvt_pk_bf16_f32 v175, v150, v151
  v_exp_f32 v152, v152
  v_exp_f32 v153, v153
  v_exp_f32 v154, v154
  v_mfma_f32_32x32x16_bf16 v[56:71], v[220:223], v[172:175], v[56:71]
  s_call_b64 s[72:73], .g2_kernel_a_ld2
  v_exp_f32 v155, v155
  v_exp_f32 v156, v156
  v_exp_f32 v157, v157
  v_smfmac_f32_16x16x64_bf16 v[120:123], v[16:19], v[168:175], v20
  v_exp_f32 v158, v158
  v_exp_f32 v159, v159
  v_cvt_pk_bf16_f32 v168, v152, v153
  v_cvt_pk_bf16_f32 v169, v154, v155
  v_cvt_pk_bf16_f32 v170, v156, v157
  v_cvt_pk_bf16_f32 v171, v158, v159
  v_exp_f32 v160, v160
  v_exp_f32 v161, v161
  v_exp_f32 v162, v162
  v_exp_f32 v163, v163
  v_mfma_f32_32x32x16_bf16 v[56:71], v[232:235], v[168:171], v[56:71]
  v_exp_f32 v164, v164
  v_exp_f32 v165, v165
  v_exp_f32 v166, v166
  v_exp_f32 v167, v167
  v_cvt_pk_bf16_f32 v172, v160, v161
  v_cvt_pk_bf16_f32 v173, v162, v163
  v_cvt_pk_bf16_f32 v174, v164, v165
  v_cvt_pk_bf16_f32 v175, v166, v167
  s_nop 1
  v_mfma_f32_32x32x16_bf16 v[56:71], v[236:239], v[172:175], v[56:71]
  v_smfmac_f32_16x16x64_bf16 v[120:123], v[16:19], v[168:175], v20
  s_branch .g2_kernel_a_rde
.g2_kernel_a_rd1:
  s_cmp_lg_u32 s28, 1
  s_cbranch_scc1 .g2_kernel_a_rd2
  ds_read_b128 v[32:35], v14 offset:10240
  ds_read_b128 v[36:39], v14 offset:11264
  v_mov_b32 v124, 0
  v_mov_b32 v125, 0
  s_waitcnt lgkmcnt(0)
  v_mfma_f32_32x32x16_bf16 v[136:151], v[176:179], v[32:35], 0
  v_mfma_f32_32x32x16_bf16 v[136:151], v[180:183], v[36:39], v[136:151]
  v_mfma_f32_32x32x16_bf16 v[152:167], v[192:195], v[32:35], 0
  s_nop 10
  v_exp_f32 v136, v136
  v_exp_f32 v137, v137
  v_exp_f32 v138, v138
  v_exp_f32 v139, v139
  v_exp_f32 v140, v140
  v_exp_f32 v141, v141
  v_exp_f32 v142, v142
  v_exp_f32 v143, v143
  v_mfma_f32_32x32x16_bf16 v[152:167], v[196:199], v[36:39], v[152:167]
  v_cvt_pk_bf16_f32 v168, v136, v137
  v_cvt_pk_bf16_f32 v169, v138, v139
  v_cvt_pk_bf16_f32 v170, v140, v141
  v_cvt_pk_bf16_f32 v171, v142, v143
  v_exp_f32 v144, v144
  v_exp_f32 v145, v145
  v_exp_f32 v146, v146
  v_exp_f32 v147, v147
  v_mfma_f32_32x32x16_bf16 v[72:87], v[184:187], v[168:171], 0
  v_exp_f32 v148, v148
  v_exp_f32 v149, v149
  v_exp_f32 v150, v150
  v_exp_f32 v151, v151
  v_cvt_pk_bf16_f32 v172, v144, v145
  v_cvt_pk_bf16_f32 v173, v146, v147
  v_cvt_pk_bf16_f32 v174, v148, v149
  v_cvt_pk_bf16_f32 v175, v150, v151
  v_mfma_f32_32x32x16_bf16 v[136:151], v[208:211], v[32:35], 0
  v_exp_f32 v152, v152
  v_exp_f32 v153, v153
  v_exp_f32 v154, v154
  v_mfma_f32_32x32x16_bf16 v[72:87], v[188:191], v[172:175], v[72:87]
  s_call_b64 s[72:73], .g2_kernel_a_ld0
  v_exp_f32 v155, v155
  v_exp_f32 v156, v156
  v_exp_f32 v157, v157
  v_smfmac_f32_16x16x64_bf16 v[124:127], v[16:19], v[168:175], v20
  v_exp_f32 v158, v158
  v_exp_f32 v159, v159
  v_mfma_f32_32x32x16_bf16 v[136:151], v[212:215], v[36:39], v[136:151]
  v_cvt_pk_bf16_f32 v168, v152, v153
  v_cvt_pk_bf16_f32 v169, v154, v155
  v_cvt_pk_bf16_f32 v170, v156, v157
  v_cvt_pk_bf16_f32 v171, v158, v159
  v_exp_f32 v160, v160
  v_exp_f32 v161, v161
  v_exp_f32 v162, v162
  v_exp_f32 v163, v163
  v_mfma_f32_32x32x16_bf16 v[72:87], v[200:203], v[168:171], v[72:87]
  v_exp_f32 v164, v164
  v_exp_f32 v165, v165
  v_exp_f32 v166, v166
  v_exp_f32 v167, v167
  v_cvt_pk_bf16_f32 v172, v160, v161
  v_cvt_pk_bf16_f32 v173, v162, v163
  v_cvt_pk_bf16_f32 v174, v164, v165
  v_cvt_pk_bf16_f32 v175, v166, v167
  v_mfma_f32_32x32x16_bf16 v[152:167], v[224:227], v[32:35], 0
  v_exp_f32 v136, v136
  v_exp_f32 v137, v137
  v_exp_f32 v138, v138
  v_mfma_f32_32x32x16_bf16 v[72:87], v[204:207], v[172:175], v[72:87]
  s_call_b64 s[72:73], .g2_kernel_a_ld1
  v_exp_f32 v139, v139
  v_exp_f32 v140, v140
  v_exp_f32 v141, v141
  v_smfmac_f32_16x16x64_bf16 v[124:127], v[16:19], v[168:175], v20
  v_exp_f32 v142, v142
  v_exp_f32 v143, v143
  v_mfma_f32_32x32x16_bf16 v[152:167], v[228:231], v[36:39], v[152:167]
  v_cvt_pk_bf16_f32 v168, v136, v137
  v_cvt_pk_bf16_f32 v169, v138, v139
  v_cvt_pk_bf16_f32 v170, v140, v141
  v_cvt_pk_bf16_f32 v171, v142, v143
  v_exp_f32 v144, v144
  v_exp_f32 v145, v145
  v_exp_f32 v146, v146
  v_exp_f32 v147, v147
  v_mfma_f32_32x32x16_bf16 v[72:87], v[216:219], v[168:171], v[72:87]
  v_exp_f32 v148, v148
  v_exp_f32 v149, v149
  v_exp_f32 v150, v150
  v_exp_f32 v151, v151
  v_cvt_pk_bf16_f32 v172, v144, v145
  v_cvt_pk_bf16_f32 v173, v146, v147
  v_cvt_pk_bf16_f32 v174, v148, v149
  v_cvt_pk_bf16_f32 v175, v150, v151
  v_exp_f32 v152, v152
  v_exp_f32 v153, v153
  v_exp_f32 v154, v154
  v_mfma_f32_32x32x16_bf16 v[72:87], v[220:223], v[172:175], v[72:87]
  s_call_b64 s[72:73], .g2_kernel_a_ld2
  v_exp_f32 v155, v155
  v_exp_f32 v156, v156
  v_exp_f32 v157, v157
  v_smfmac_f32_16x16x64_bf16 v[124:127], v[16:19], v[168:175], v20
  v_exp_f32 v158, v158
  v_exp_f32 v159, v159
  v_cvt_pk_bf16_f32 v168, v152, v153
  v_cvt_pk_bf16_f32 v169, v154, v155
  v_cvt_pk_bf16_f32 v170, v156, v157
  v_cvt_pk_bf16_f32 v171, v158, v159
  v_exp_f32 v160, v160
  v_exp_f32 v161, v161
  v_exp_f32 v162, v162
  v_exp_f32 v163, v163
  v_mfma_f32_32x32x16_bf16 v[72:87], v[232:235], v[168:171], v[72:87]
  v_exp_f32 v164, v164
  v_exp_f32 v165, v165
  v_exp_f32 v166, v166
  v_exp_f32 v167, v167
  v_cvt_pk_bf16_f32 v172, v160, v161
  v_cvt_pk_bf16_f32 v173, v162, v163
  v_cvt_pk_bf16_f32 v174, v164, v165
  v_cvt_pk_bf16_f32 v175, v166, v167
  s_nop 1
  v_mfma_f32_32x32x16_bf16 v[72:87], v[236:239], v[172:175], v[72:87]
  v_smfmac_f32_16x16x64_bf16 v[124:127], v[16:19], v[168:175], v20
  s_branch .g2_kernel_a_rde
.g2_kernel_a_rd2:
  s_cmp_lg_u32 s28, 2
  s_cbranch_scc1 .g2_kernel_a_rd3
  ds_read_b128 v[40:43], v14 offset:12288
  ds_read_b128 v[44:47], v14 offset:13312
  v_mov_b32 v128, 0
  v_mov_b32 v129, 0
  s_waitcnt lgkmcnt(0)
  v_mfma_f32_32x32x16_bf16 v[136:151], v[176:179], v[40:43], 0
  v_mfma_f32_32x32x16_bf16 v[136:151], v[180:183], v[44:47], v[136:151]
  v_mfma_f32_32x32x16_bf16 v[152:167], v[192:195], v[40:43], 0
  s_nop 10
  v_exp_f32 v136, v136
  v_exp_f32 v137, v137
  v_exp_f32 v138, v138
  v_exp_f32 v139, v139
  v_exp_f32 v140, v140
  v_exp_f32 v141, v141
  v_exp_f32 v142, v142
  v_exp_f32 v143, v143
  v_mfma_f32_32x32x16_bf16 v[152:167], v[196:199], v[44:47], v[152:167]
  v_cvt_pk_bf16_f32 v168, v136, v137
  v_cvt_pk_bf16_f32 v169, v138, v139
  v_cvt_pk_bf16_f32 v170, v140, v141
  v_cvt_pk_bf16_f32 v171, v142, v143
  v_exp_f32 v144, v144
  v_exp_f32 v145, v145
  v_exp_f32 v146, v146
  v_exp_f32 v147, v147
  v_mfma_f32_32x32x16_bf16 v[88:103], v[184:187], v[168:171], 0
  v_exp_f32 v148, v148
  v_exp_f32 v149, v149
  v_exp_f32 v150, v150
  v_exp_f32 v151, v151
  v_cvt_pk_bf16_f32 v172, v144, v145
  v_cvt_pk_bf16_f32 v173, v146, v147
  v_cvt_pk_bf16_f32 v174, v148, v149
  v_cvt_pk_bf16_f32 v175, v150, v151
  v_mfma_f32_32x32x16_bf16 v[136:151], v[208:211], v[40:43], 0
  v_exp_f32 v152, v152
  v_exp_f32 v153, v153
  v_exp_f32 v154, v154
  v_mfma_f32_32x32x16_bf16 v[88:103], v[188:191], v[172:175], v[88:103]
  s_call_b64 s[72:73], .g2_kernel_a_ld0
  v_exp_f32 v155, v155
  v_exp_f32 v156, v156
  v_exp_f32 v157, v157
  v_smfmac_f32_16x16x64_bf16 v[128:131], v[16:19], v[168:175], v20
  v_exp_f32 v158, v158
  v_exp_f32 v159, v159
  v_mfma_f32_32x32x16_bf16 v[136:151], v[212:215], v[44:47], v[136:151]
  v_cvt_pk_bf16_f32 v168, v152, v153
  v_cvt_pk_bf16_f32 v169, v154, v155
  v_cvt_pk_bf16_f32 v170, v156, v157
  v_cvt_pk_bf16_f32 v171, v158, v159
  v_exp_f32 v160, v160
  v_exp_f32 v161, v161
  v_exp_f32 v162, v162
  v_exp_f32 v163, v163
  v_mfma_f32_32x32x16_bf16 v[88:103], v[200:203], v[168:171], v[88:103]
  v_exp_f32 v164, v164
  v_exp_f32 v165, v165
  v_exp_f32 v166, v166
  v_exp_f32 v167, v167
  v_cvt_pk_bf16_f32 v172, v160, v161
  v_cvt_pk_bf16_f32 v173, v162, v163
  v_cvt_pk_bf16_f32 v174, v164, v165
  v_cvt_pk_bf16_f32 v175, v166, v167
  v_mfma_f32_32x32x16_bf16 v[152:167], v[224:227], v[40:43], 0
  v_exp_f32 v136, v136
  v_exp_f32 v137, v137
  v_exp_f32 v138, v138
  v_mfma_f32_32x32x16_bf16 v[88:103], v[204:207], v[172:175], v[88:103]
  s_call_b64 s[72:73], .g2_kernel_a_ld1
  v_exp_f32 v139, v139
  v_exp_f32 v140, v140
  v_exp_f32 v141, v141
  v_smfmac_f32_16x16x64_bf16 v[128:131], v[16:19], v[168:175], v20
  v_exp_f32 v142, v142
  v_exp_f32 v143, v143
  v_mfma_f32_32x32x16_bf16 v[152:167], v[228:231], v[44:47], v[152:167]
  v_cvt_pk_bf16_f32 v168, v136, v137
  v_cvt_pk_bf16_f32 v169, v138, v139
  v_cvt_pk_bf16_f32 v170, v140, v141
  v_cvt_pk_bf16_f32 v171, v142, v143
  v_exp_f32 v144, v144
  v_exp_f32 v145, v145
  v_exp_f32 v146, v146
  v_exp_f32 v147, v147
  v_mfma_f32_32x32x16_bf16 v[88:103], v[216:219], v[168:171], v[88:103]
  v_exp_f32 v148, v148
  v_exp_f32 v149, v149
  v_exp_f32 v150, v150
  v_exp_f32 v151, v151
  v_cvt_pk_bf16_f32 v172, v144, v145
  v_cvt_pk_bf16_f32 v173, v146, v147
  v_cvt_pk_bf16_f32 v174, v148, v149
  v_cvt_pk_bf16_f32 v175, v150, v151
  v_exp_f32 v152, v152
  v_exp_f32 v153, v153
  v_exp_f32 v154, v154
  v_mfma_f32_32x32x16_bf16 v[88:103], v[220:223], v[172:175], v[88:103]
  s_call_b64 s[72:73], .g2_kernel_a_ld2
  v_exp_f32 v155, v155
  v_exp_f32 v156, v156
  v_exp_f32 v157, v157
  v_smfmac_f32_16x16x64_bf16 v[128:131], v[16:19], v[168:175], v20
  v_exp_f32 v158, v158
  v_exp_f32 v159, v159
  v_cvt_pk_bf16_f32 v168, v152, v153
  v_cvt_pk_bf16_f32 v169, v154, v155
  v_cvt_pk_bf16_f32 v170, v156, v157
  v_cvt_pk_bf16_f32 v171, v158, v159
  v_exp_f32 v160, v160
  v_exp_f32 v161, v161
  v_exp_f32 v162, v162
  v_exp_f32 v163, v163
  v_mfma_f32_32x32x16_bf16 v[88:103], v[232:235], v[168:171], v[88:103]
  v_exp_f32 v164, v164
  v_exp_f32 v165, v165
  v_exp_f32 v166, v166
  v_exp_f32 v167, v167
  v_cvt_pk_bf16_f32 v172, v160, v161
  v_cvt_pk_bf16_f32 v173, v162, v163
  v_cvt_pk_bf16_f32 v174, v164, v165
  v_cvt_pk_bf16_f32 v175, v166, v167
  s_nop 1
  v_mfma_f32_32x32x16_bf16 v[88:103], v[236:239], v[172:175], v[88:103]
  v_smfmac_f32_16x16x64_bf16 v[128:131], v[16:19], v[168:175], v20
  s_branch .g2_kernel_a_rde
.g2_kernel_a_rd3:
  ds_read_b128 v[48:51], v14 offset:14336
  ds_read_b128 v[52:55], v14 offset:15360
  v_mov_b32 v132, 0
  v_mov_b32 v133, 0
  s_waitcnt lgkmcnt(0)
  v_mfma_f32_32x32x16_bf16 v[136:151], v[176:179], v[48:51], 0
  v_mfma_f32_32x32x16_bf16 v[136:151], v[180:183], v[52:55], v[136:151]
  v_mfma_f32_32x32x16_bf16 v[152:167], v[192:195], v[48:51], 0
  s_nop 10
  v_exp_f32 v136, v136
  v_exp_f32 v137, v137
  v_exp_f32 v138, v138
  v_exp_f32 v139, v139
  v_exp_f32 v140, v140
  v_exp_f32 v141, v141
  v_exp_f32 v142, v142
  v_exp_f32 v143, v143
  v_mfma_f32_32x32x16_bf16 v[152:167], v[196:199], v[52:55], v[152:167]
  v_cvt_pk_bf16_f32 v168, v136, v137
  v_cvt_pk_bf16_f32 v169, v138, v139
  v_cvt_pk_bf16_f32 v170, v140, v141
  v_cvt_pk_bf16_f32 v171, v142, v143
  v_exp_f32 v144, v144
  v_exp_f32 v145, v145
  v_exp_f32 v146, v146
  v_exp_f32 v147, v147
  v_mfma_f32_32x32x16_bf16 v[104:119], v[184:187], v[168:171], 0
  v_exp_f32 v148, v148
  v_exp_f32 v149, v149
  v_exp_f32 v150, v150
  v_exp_f32 v151, v151
  v_cvt_pk_bf16_f32 v172, v144, v145
  v_cvt_pk_bf16_f32 v173, v146, v147
  v_cvt_pk_bf16_f32 v174, v148, v149
  v_cvt_pk_bf16_f32 v175, v150, v151
  v_mfma_f32_32x32x16_bf16 v[136:151], v[208:211], v[48:51], 0
  v_exp_f32 v152, v152
  v_exp_f32 v153, v153
  v_exp_f32 v154, v154
  v_mfma_f32_32x32x16_bf16 v[104:119], v[188:191], v[172:175], v[104:119]
  s_call_b64 s[72:73], .g2_kernel_a_ld0
  v_exp_f32 v155, v155
  v_exp_f32 v156, v156
  v_exp_f32 v157, v157
  v_smfmac_f32_16x16x64_bf16 v[132:135], v[16:19], v[168:175], v20
  v_exp_f32 v158, v158
  v_exp_f32 v159, v159
  v_mfma_f32_32x32x16_bf16 v[136:151], v[212:215], v[52:55], v[136:151]
  v_cvt_pk_bf16_f32 v168, v152, v153
  v_cvt_pk_bf16_f32 v169, v154, v155
  v_cvt_pk_bf16_f32 v170, v156, v157
  v_cvt_pk_bf16_f32 v171, v158, v159
  v_exp_f32 v160, v160
  v_exp_f32 v161, v161
  v_exp_f32 v162, v162
  v_exp_f32 v163, v163
  v_mfma_f32_32x32x16_bf16 v[104:119], v[200:203], v[168:171], v[104:119]
  v_exp_f32 v164, v164
  v_exp_f32 v165, v165
  v_exp_f32 v166, v166
  v_exp_f32 v167, v167
  v_cvt_pk_bf16_f32 v172, v160, v161
  v_cvt_pk_bf16_f32 v173, v162, v163
  v_cvt_pk_bf16_f32 v174, v164, v165
  v_cvt_pk_bf16_f32 v175, v166, v167
  v_mfma_f32_32x32x16_bf16 v[152:167], v[224:227], v[48:51], 0
  v_exp_f32 v136, v136
  v_exp_f32 v137, v137
  v_exp_f32 v138, v138
  v_mfma_f32_32x32x16_bf16 v[104:119], v[204:207], v[172:175], v[104:119]
  s_call_b64 s[72:73], .g2_kernel_a_ld1
  v_exp_f32 v139, v139
  v_exp_f32 v140, v140
  v_exp_f32 v141, v141
  v_smfmac_f32_16x16x64_bf16 v[132:135], v[16:19], v[168:175], v20
  v_exp_f32 v142, v142
  v_exp_f32 v143, v143
  v_mfma_f32_32x32x16_bf16 v[152:167], v[228:231], v[52:55], v[152:167]
  v_cvt_pk_bf16_f32 v168, v136, v137
  v_cvt_pk_bf16_f32 v169, v138, v139
  v_cvt_pk_bf16_f32 v170, v140, v141
  v_cvt_pk_bf16_f32 v171, v142, v143
  v_exp_f32 v144, v144
  v_exp_f32 v145, v145
  v_exp_f32 v146, v146
  v_exp_f32 v147, v147
  v_mfma_f32_32x32x16_bf16 v[104:119], v[216:219], v[168:171], v[104:119]
  v_exp_f32 v148, v148
  v_exp_f32 v149, v149
  v_exp_f32 v150, v150
  v_exp_f32 v151, v151
  v_cvt_pk_bf16_f32 v172, v144, v145
  v_cvt_pk_bf16_f32 v173, v146, v147
  v_cvt_pk_bf16_f32 v174, v148, v149
  v_cvt_pk_bf16_f32 v175, v150, v151
  v_exp_f32 v152, v152
  v_exp_f32 v153, v153
  v_exp_f32 v154, v154
  v_mfma_f32_32x32x16_bf16 v[104:119], v[220:223], v[172:175], v[104:119]
  s_call_b64 s[72:73], .g2_kernel_a_ld2
  v_exp_f32 v155, v155
  v_exp_f32 v156, v156
  v_exp_f32 v157, v157
  v_smfmac_f32_16x16x64_bf16 v[132:135], v[16:19], v[168:175], v20
  v_exp_f32 v158, v158
  v_exp_f32 v159, v159
  v_cvt_pk_bf16_f32 v168, v152, v153
  v_cvt_pk_bf16_f32 v169, v154, v155
  v_cvt_pk_bf16_f32 v170, v156, v157
  v_cvt_pk_bf16_f32 v171, v158, v159
  v_exp_f32 v160, v160
  v_exp_f32 v161, v161
  v_exp_f32 v162, v162
  v_exp_f32 v163, v163
  v_mfma_f32_32x32x16_bf16 v[104:119], v[232:235], v[168:171], v[104:119]
  v_exp_f32 v164, v164
  v_exp_f32 v165, v165
  v_exp_f32 v166, v166
  v_exp_f32 v167, v167
  v_cvt_pk_bf16_f32 v172, v160, v161
  v_cvt_pk_bf16_f32 v173, v162, v163
  v_cvt_pk_bf16_f32 v174, v164, v165
  v_cvt_pk_bf16_f32 v175, v166, v167
  s_nop 1
  v_mfma_f32_32x32x16_bf16 v[104:119], v[236:239], v[172:175], v[104:119]
  v_smfmac_f32_16x16x64_bf16 v[132:135], v[16:19], v[168:175], v20
  s_branch .g2_kernel_a_rde
.g2_kernel_a_rd4:
.g2_kernel_a_rde:
  v_mov_b32 v168, 0
  v_mov_b32 v169, 0
  v_mov_b32 v170, 0
  v_mov_b32 v171, 0
  v_mov_b32 v172, 0
  v_mov_b32 v173, 0
  v_mov_b32 v174, 0
  v_mov_b32 v175, 0
  s_waitcnt vmcnt(8)
  v_mfma_f32_32x32x16_bf16 v[136:151], v[176:179], v[24:27], 0
  v_mfma_f32_32x32x16_bf16 v[136:151], v[180:183], v[28:31], v[136:151]
  s_nop 10
  s_branch .g2_kernel_a_loop
.g2_kernel_a_ld0:
  s_andn2_b32 s33, s36, s34
  s_cbranch_scc0 .g2_kernel_a_r0c
.g2_kernel_a_r0b:
  s_ff1_i32_b32 s33, s33
  s_bitset1_b32 s34, s33
  s_xor_b32 s33, s33, s24
  s_lshl_b32 s33, s33, s25
  s_add_u32 s22, s20, s33
  s_addc_u32 s23, s21, 0
  global_load_dwordx4 v[176:179], v3, s[22:23] offset:0
  global_load_dwordx4 v[180:183], v3, s[22:23] offset:1024
  global_load_dwordx4 v[184:187], v3, s[22:23] offset:2048
  global_load_dwordx4 v[188:191], v3, s[22:23] offset:3072
  s_setpc_b64 s[72:73]
.g2_kernel_a_ld1:
  s_andn2_b32 s33, s36, s34
  s_cbranch_scc0 .g2_kernel_a_r1c
.g2_kernel_a_r1b:
  s_ff1_i32_b32 s33, s33
  s_bitset1_b32 s34, s33
  s_xor_b32 s33, s33, s24
  s_lshl_b32 s33, s33, s25
  s_add_u32 s22, s20, s33
  s_addc_u32 s23, s21, 0
  global_load_dwordx4 v[192:195], v3, s[22:23] offset:0
  global_load_dwordx4 v[196:199], v3, s[22:23] offset:1024
  global_load_dwordx4 v[200:203], v3, s[22:23] offset:2048
  global_load_dwordx4 v[204:207], v3, s[22:23] offset:3072
  s_setpc_b64 s[72:73]
.g2_kernel_a_ld2:
  s_andn2_b32 s33, s36, s34
  s_cbranch_scc0 .g2_kernel_a_r2c
.g2_kernel_a_r2b:
  s_ff1_i32_b32 s33, s33
  s_bitset1_b32 s34, s33
  s_xor_b32 s33, s33, s24
  s_lshl_b32 s33, s33, s25
  s_add_u32 s22, s20, s33
  s_addc_u32 s23, s21, 0
  global_load_dwordx4 v[208:211], v3, s[22:23] offset:0
  global_load_dwordx4 v[212:215], v3, s[22:23] offset:1024
  global_load_dwordx4 v[216:219], v3, s[22:23] offset:2048
  global_load_dwordx4 v[220:223], v3, s[22:23] offset:3072
  s_setpc_b64 s[72:73]
.g2_kernel_a_N0c:
  s_call_b64 s[68:69], .g2_kernel_a_pick
  s_branch .g2_kernel_a_N0b
.g2_kernel_a_N1c:
  s_call_b64 s[68:69], .g2_kernel_a_pick
  s_branch .g2_kernel_a_N1b
.g2_kernel_a_N2c:
  s_call_b64 s[68:69], .g2_kernel_a_pick
  s_branch .g2_kernel_a_N2b
.g2_kernel_a_N3c:
  s_call_b64 s[68:69], .g2_kernel_a_pick
  s_branch .g2_kernel_a_N3b
.g2_kernel_a_L3c:
  s_call_b64 s[68:69], .g2_kernel_a_pick
  s_branch .g2_kernel_a_L3b
.g2_kernel_a_G0c:
  s_call_b64 s[68:69], .g2_kernel_a_pick
  s_branch .g2_kernel_a_G0b
.g2_kernel_a_L3g:
  s_mov_b32 s38, 0
.g2_kernel_a_L3gl:
  ds_read_b32 v7, v13 offset:8
  s_add_u32 s38, s38, 1
  s_waitcnt lgkmcnt(0)
  v_cmp_gt_u32 vcc, s27, v7
  s_cbranch_vccz .g2_kernel_a_L3h
  s_cmp_lt_u32 s38, 524288
  s_cbranch_scc1 .g2_kernel_a_L3gl
  s_branch .g2_kernel_a_L3h
.g2_kernel_a_hold:
  s_lshl_b32 s33, 1, s14
  s_lshr_b32 s14, s14, 8
  s_setpc_b64 s[68:69]
.g2_kernel_a_pick:
  s_cmp_lg_u32 s34, -1
  s_cbranch_scc1 .g2_kernel_a_pk1
  s_cmp_eq_u32 s26, -1
  s_cbranch_scc1 .g2_kernel_a_hold
  s_add_u32 s26, s26, 1
  s_mov_b32 s34, 0xffff
  s_cmp_eq_u32 s26, 1
  s_cbranch_scc1 .g2_kernel_a_pk1
  v_and_b32 v8, 15, v2
  s_lshl_b32 s28, s16, 6
  s_add_u32 s28, s28, 157696
  v_lshl_add_u32 v8, v8, 2, s28
  s_lshl_b32 s28, s17, 2
  s_add_u32 s28, s28, s16
  s_lshl_b32 s28, s28, 16
  s_add_u32 s28, s28, s63
  s_add_u32 s28, s28, 0x800000
  s_add_u32 s20, s60, s28
  s_addc_u32 s21, s61, 0
  s_lshl_b32 s24, s18, 1
  s_and_b32 s24, s24, 6
  s_mov_b32 s25, 12
  s_mov_b32 s34, 0
  s_mov_b32 s36, 0xff
  s_mov_b32 s33, 0xff
  s_mov_b32 s38, 0
.g2_kernel_a_pk2:
  ds_read_b32 v7, v8
  s_add_u32 s38, s38, 1
  s_waitcnt lgkmcnt(0)
  v_cmp_ge_u32 vcc, s62, v7
  s_cbranch_vccz .g2_kernel_a_pkr
  s_cmp_lt_u32 s38, 524288
  s_cbranch_scc1 .g2_kernel_a_pk2
  s_branch .g2_kernel_a_pkr
.g2_kernel_a_pk1:
  s_mov_b32 s38, 0
.g2_kernel_a_pkl:
  ds_read_b32 v7, v8
  s_add_u32 s38, s38, 1
  s_waitcnt lgkmcnt(0)
  v_cmp_lt_u32 vcc, s62, v7
  s_mov_b32 s36, vcc_lo
  s_andn2_b32 s33, s36, s34
  s_cbranch_scc1 .g2_kernel_a_pkr
  s_cmp_lt_u32 s38, 524288
  s_cbranch_scc1 .g2_kernel_a_pkl
  s_not_b32 s33, s34
.g2_kernel_a_pkr:
  s_setpc_b64 s[68:69]
.g2_kernel_w_aw:
  v_mov_b32 v6, s71
  s_mov_b32 s38, 0
.g2_kernel_wg4:
  ds_read_b32 v7, v6 offset:52
  s_add_u32 s38, s38, 1
  s_waitcnt lgkmcnt(0)
  v_cmp_gt_u32 vcc, 4, v7
  s_cbranch_vccz .g2_kernel_wg4d
  s_sleep 1
  s_cmp_lt_u32 s38, 524288
  s_cbranch_scc1 .g2_kernel_wg4
.g2_kernel_wg4d:
  s_branch .g2_kernel_w_ab
.g2_kernel_w_pt:
  v_lshlrev_b32 v7, 5, v17
  v_add_u32 v7, 155648, v7
  s_mov_b64 exec, vcc
  ds_read_b128 v[240:243], v7 offset:7680
  ds_read_b128 v[244:247], v7 offset:7696
  ds_read_b128 v[248:251], v7 offset:7744
  ds_read_b128 v[252:255], v7 offset:7760
  s_waitcnt lgkmcnt(0)
  v_pk_add_f32 v[24:25], v[24:25], v[240:241]
  v_pk_add_f32 v[26:27], v[26:27], v[242:243]
  v_pk_add_f32 v[28:29], v[28:29], v[244:245]
  v_pk_add_f32 v[30:31], v[30:31], v[246:247]
  v_pk_add_f32 v[32:33], v[32:33], v[248:249]
  v_pk_add_f32 v[34:35], v[34:35], v[250:251]
  v_pk_add_f32 v[36:37], v[36:37], v[252:253]
  v_pk_add_f32 v[38:39], v[38:39], v[254:255]
  ds_read_b128 v[240:243], v7 offset:7808
  ds_read_b128 v[244:247], v7 offset:7824
  ds_read_b128 v[248:251], v7 offset:7872
  ds_read_b128 v[252:255], v7 offset:7888
  s_waitcnt lgkmcnt(0)
  v_pk_add_f32 v[40:41], v[40:41], v[240:241]
  v_pk_add_f32 v[42:43], v[42:43], v[242:243]
  v_pk_add_f32 v[44:45], v[44:45], v[244:245]
  v_pk_add_f32 v[46:47], v[46:47], v[246:247]
  v_pk_add_f32 v[48:49], v[48:49], v[248:249]
  v_pk_add_f32 v[50:51], v[50:51], v[250:251]
  v_pk_add_f32 v[52:53], v[52:53], v[252:253]
  v_pk_add_f32 v[54:55], v[54:55], v[254:255]
  s_mov_b64 exec, -1
  s_branch .g2_kernel_w_pb
.g2_kernel_w_i8c:
  s_mov_b32 s38, 0
  s_call_b64 s[68:69], .g2_kernel_w_pkl
  s_branch .g2_kernel_w_i8b
.g2_kernel_w_i9c:
  s_mov_b32 s38, 0
  s_call_b64 s[68:69], .g2_kernel_w_pkl
  s_branch .g2_kernel_w_i9b
.g2_kernel_w_i10c:
  s_mov_b32 s38, 0
  s_call_b64 s[68:69], .g2_kernel_w_pkl
  s_branch .g2_kernel_w_i10b
.g2_kernel_w_i11c:
  s_mov_b32 s38, 0
  s_call_b64 s[68:69], .g2_kernel_w_pkl
  s_branch .g2_kernel_w_i11b
.g2_kernel_w_v8:
  s_cmp_ge_u32 s8, 139264
  s_cselect_b32 s28, 139264, 0
  s_sub_u32 s28, s8, s28
  s_lshr_b32 s28, s28, 1
  s_add_u32 s28, s28, 32768
  s_add_u32 s22, s20, s28
  s_addc_u32 s23, s21, 0
  s_mov_b32 s38, 0
.g2_kernel_w_vl8:
  global_load_dwordx4 v[88:91], v3, s[22:23] offset:0 sc1
  global_load_dwordx4 v[92:95], v3, s[22:23] offset:1024 sc1
  global_load_dwordx4 v[96:99], v3, s[22:23] offset:2048 sc1
  global_load_dwordx4 v[100:103], v3, s[22:23] offset:3072 sc1
  s_add_u32 s38, s38, 1
  s_waitcnt vmcnt(0)
  v_min3_u32 v6, v88, v90, v92
  v_min3_u32 v7, v94, v96, v98
  v_min3_u32 v6, v6, v100, v102
  v_min_u32 v6, v6, v7
  v_cmp_eq_u32 vcc, 0, v6
  s_cbranch_vccz .g2_kernel_w_vb8
  s_cmp_lt_u32 s38, 131072
  s_cbranch_scc1 .g2_kernel_w_vl8
  s_branch .g2_kernel_w_vb8
.g2_kernel_w_i12c:
  s_mov_b32 s38, 0
  s_call_b64 s[68:69], .g2_kernel_w_pkl
  s_branch .g2_kernel_w_i12b
.g2_kernel_w_v9:
  s_cmp_ge_u32 s9, 139264
  s_cselect_b32 s28, 139264, 0
  s_sub_u32 s28, s9, s28
  s_lshr_b32 s28, s28, 1
  s_add_u32 s28, s28, 32768
  s_add_u32 s22, s20, s28
  s_addc_u32 s23, s21, 0
  s_mov_b32 s38, 0
.g2_kernel_w_vl9:
  global_load_dwordx4 v[176:179], v3, s[22:23] offset:0 sc1
  global_load_dwordx4 v[180:183], v3, s[22:23] offset:1024 sc1
  global_load_dwordx4 v[184:187], v3, s[22:23] offset:2048 sc1
  global_load_dwordx4 v[188:191], v3, s[22:23] offset:3072 sc1
  s_add_u32 s38, s38, 1
  s_waitcnt vmcnt(0)
  v_min3_u32 v6, v176, v178, v180
  v_min3_u32 v7, v182, v184, v186
  v_min3_u32 v6, v6, v188, v190
  v_min_u32 v6, v6, v7
  v_cmp_eq_u32 vcc, 0, v6
  s_cbranch_vccz .g2_kernel_w_vb9
  s_cmp_lt_u32 s38, 131072
  s_cbranch_scc1 .g2_kernel_w_vl9
  s_branch .g2_kernel_w_vb9
.g2_kernel_w_i13c:
  s_mov_b32 s38, 0
  s_call_b64 s[68:69], .g2_kernel_w_pkl
  s_branch .g2_kernel_w_i13b
.g2_kernel_w_v10:
  s_cmp_ge_u32 s10, 139264
  s_cselect_b32 s28, 139264, 0
  s_sub_u32 s28, s10, s28
  s_lshr_b32 s28, s28, 1
  s_add_u32 s28, s28, 32768
  s_add_u32 s22, s20, s28
  s_addc_u32 s23, s21, 0
  s_mov_b32 s38, 0
.g2_kernel_w_vl10:
  global_load_dwordx4 v[192:195], v3, s[22:23] offset:0 sc1
  global_load_dwordx4 v[196:199], v3, s[22:23] offset:1024 sc1
  global_load_dwordx4 v[200:203], v3, s[22:23] offset:2048 sc1
  global_load_dwordx4 v[204:207], v3, s[22:23] offset:3072 sc1
  s_add_u32 s38, s38, 1
  s_waitcnt vmcnt(0)
  v_min3_u32 v6, v192, v194, v196
  v_min3_u32 v7, v198, v200, v202
  v_min3_u32 v6, v6, v204, v206
  v_min_u32 v6, v6, v7
  v_cmp_eq_u32 vcc, 0, v6
  s_cbranch_vccz .g2_kernel_w_vb10
  s_cmp_lt_u32 s38, 131072
  s_cbranch_scc1 .g2_kernel_w_vl10
  s_branch .g2_kernel_w_vb10
.g2_kernel_w_i14c:
  s_mov_b32 s38, 524288
  s_call_b64 s[68:69], .g2_kernel_w_pkl
  s_branch .g2_kernel_w_i14b
.g2_kernel_w_v11:
  s_cmp_ge_u32 s11, 139264
  s_cselect_b32 s28, 139264, 0
  s_sub_u32 s28, s11, s28
  s_lshr_b32 s28, s28, 1
  s_add_u32 s28, s28, 32768
  s_add_u32 s22, s20, s28
  s_addc_u32 s23, s21, 0
  s_mov_b32 s38, 0
.g2_kernel_w_vl11:
  global_load_dwordx4 v[208:211], v3, s[22:23] offset:0 sc1
  global_load_dwordx4 v[212:215], v3, s[22:23] offset:1024 sc1
  global_load_dwordx4 v[216:219], v3, s[22:23] offset:2048 sc1
  global_load_dwordx4 v[220:223], v3, s[22:23] offset:3072 sc1
  s_add_u32 s38, s38, 1
  s_waitcnt vmcnt(0)
  v_min3_u32 v6, v208, v210, v212
  v_min3_u32 v7, v214, v216, v218
  v_min3_u32 v6, v6, v220, v222
  v_min_u32 v6, v6, v7
  v_cmp_eq_u32 vcc, 0, v6
  s_cbranch_vccz .g2_kernel_w_vb11
  s_cmp_lt_u32 s38, 131072
  s_cbranch_scc1 .g2_kernel_w_vl11
  s_branch .g2_kernel_w_vb11
.g2_kernel_w_i15c:
  s_mov_b32 s38, 524288
  s_call_b64 s[68:69], .g2_kernel_w_pkl
  s_branch .g2_kernel_w_i15b
.g2_kernel_w_v12:
  s_cmp_ge_u32 s12, 139264
  s_cselect_b32 s28, 139264, 0
  s_sub_u32 s28, s12, s28
  s_lshr_b32 s28, s28, 1
  s_add_u32 s28, s28, 32768
  s_add_u32 s22, s20, s28
  s_addc_u32 s23, s21, 0
  s_mov_b32 s38, 0
.g2_kernel_w_vl12:
  global_load_dwordx4 v[224:227], v3, s[22:23] offset:0 sc1
  global_load_dwordx4 v[228:231], v3, s[22:23] offset:1024 sc1
  global_load_dwordx4 v[232:235], v3, s[22:23] offset:2048 sc1
  global_load_dwordx4 v[236:239], v3, s[22:23] offset:3072 sc1
  s_add_u32 s38, s38, 1
  s_waitcnt vmcnt(0)
  v_min3_u32 v6, v224, v226, v228
  v_min3_u32 v7, v230, v232, v234
  v_min3_u32 v6, v6, v236, v238
  v_min_u32 v6, v6, v7
  v_cmp_eq_u32 vcc, 0, v6
  s_cbranch_vccz .g2_kernel_w_vb12
  s_cmp_lt_u32 s38, 131072
  s_cbranch_scc1 .g2_kernel_w_vl12
  s_branch .g2_kernel_w_vb12
.g2_kernel_w_v13:
  s_cmp_ge_u32 s13, 139264
  s_cselect_b32 s28, 139264, 0
  s_sub_u32 s28, s13, s28
  s_lshr_b32 s28, s28, 1
  s_add_u32 s28, s28, 32768
  s_add_u32 s22, s20, s28
  s_addc_u32 s23, s21, 0
  s_mov_b32 s38, 0
.g2_kernel_w_vl13:
  global_load_dwordx4 v[136:139], v3, s[22:23] offset:0 sc1
  global_load_dwordx4 v[140:143], v3, s[22:23] offset:1024 sc1
  global_load_dwordx4 v[144:147], v3, s[22:23] offset:2048 sc1
  global_load_dwordx4 v[148:151], v3, s[22:23] offset:3072 sc1
  s_add_u32 s38, s38, 1
  s_waitcnt vmcnt(0)
  v_min3_u32 v6, v136, v138, v140
  v_min3_u32 v7, v142, v144, v146
  v_min3_u32 v6, v6, v148, v150
  v_min_u32 v6, v6, v7
  v_cmp_eq_u32 vcc, 0, v6
  s_cbranch_vccz .g2_kernel_w_vb13
  s_cmp_lt_u32 s38, 131072
  s_cbranch_scc1 .g2_kernel_w_vl13
  s_branch .g2_kernel_w_vb13
.g2_kernel_w_v14:
  s_cmp_ge_u32 s14, 139264
  s_cselect_b32 s28, 139264, 0
  s_sub_u32 s28, s14, s28
  s_lshr_b32 s28, s28, 1
  s_add_u32 s28, s28, 32768
  s_add_u32 s22, s20, s28
  s_addc_u32 s23, s21, 0
  s_mov_b32 s38, 0
.g2_kernel_w_vl14:
  global_load_dwordx4 v[152:155], v3, s[22:23] offset:0 sc1
  global_load_dwordx4 v[156:159], v3, s[22:23] offset:1024 sc1
  global_load_dwordx4 v[160:163], v3, s[22:23] offset:2048 sc1
  global_load_dwordx4 v[164:167], v3, s[22:23] offset:3072 sc1
  s_add_u32 s38, s38, 1
  s_waitcnt vmcnt(0)
  v_min3_u32 v6, v152, v154, v156
  v_min3_u32 v7, v158, v160, v162
  v_min3_u32 v6, v6, v164, v166
  v_min_u32 v6, v6, v7
  v_cmp_eq_u32 vcc, 0, v6
  s_cbranch_vccz .g2_kernel_w_vb14
  s_cmp_lt_u32 s38, 131072
  s_cbranch_scc1 .g2_kernel_w_vl14
  s_branch .g2_kernel_w_vb14
.g2_kernel_w_v15:
  s_cmp_ge_u32 s15, 139264
  s_cselect_b32 s28, 139264, 0
  s_sub_u32 s28, s15, s28
  s_lshr_b32 s28, s28, 1
  s_add_u32 s28, s28, 32768
  s_add_u32 s22, s20, s28
  s_addc_u32 s23, s21, 0
  s_mov_b32 s38, 0
.g2_kernel_w_vl15:
  global_load_dwordx4 v[56:59], v3, s[22:23] offset:0 sc1
  global_load_dwordx4 v[60:63], v3, s[22:23] offset:1024 sc1
  global_load_dwordx4 v[64:67], v3, s[22:23] offset:2048 sc1
  global_load_dwordx4 v[68:71], v3, s[22:23] offset:3072 sc1
  s_add_u32 s38, s38, 1
  s_waitcnt vmcnt(0)
  v_min3_u32 v6, v56, v58, v60
  v_min3_u32 v7, v62, v64, v66
  v_min3_u32 v6, v6, v68, v70
  v_min_u32 v6, v6, v7
  v_cmp_eq_u32 vcc, 0, v6
  s_cbranch_vccz .g2_kernel_w_vb15
  s_cmp_lt_u32 s38, 131072
  s_cbranch_scc1 .g2_kernel_w_vl15
  s_branch .g2_kernel_w_vb15
.g2_kernel_w_bw:
  s_mov_b32 s38, 0
.g2_kernel_w_bwl:
  ds_read_b32 v16, v20 offset:12
  s_add_u32 s38, s38, 1
  s_waitcnt lgkmcnt(0)
  v_cmp_gt_u32 vcc, 4, v16
  s_cbranch_vccz .g2_kernel_w_bb
  s_cmp_lt_u32 s38, 524288
  s_cbranch_scc1 .g2_kernel_w_bwl
  s_branch .g2_kernel_w_bb
.g2_kernel_w_pick:
  s_mov_b32 s38, 0
.g2_kernel_w_pkl:
  ds_read_b64 v[6:7], v21
  s_add_u32 s38, s38, 1
  s_waitcnt lgkmcnt(0)
  v_min_u32 v6, v6, v7
  v_cmp_lt_u32 vcc, s62, v6
  s_and_b32 s36, vcc_lo, 0xff00
  s_andn2_b32 s33, s36, s34
  s_cbranch_scc1 .g2_kernel_w_pkr
  s_cmp_lt_u32 s38, 524288
  s_cbranch_scc1 .g2_kernel_w_pkl
  s_andn2_b32 s33, 0xff00, s34
.g2_kernel_w_pkr:
  s_setpc_b64 s[68:69]
.g2_kernel_p_spin:
  s_mov_b32 s38, 0
.g2_kernel_p_spinl:
  ds_read_b32 v10, v9
  s_add_u32 s38, s38, 1
  s_waitcnt lgkmcnt(0)
  v_cmp_gt_i32 vcc, s34, v10
  s_cbranch_vccz .g2_kernel_p_spinr
  s_sleep 1
  s_cmp_lt_u32 s38, 524288
  s_cbranch_scc1 .g2_kernel_p_spinl
.g2_kernel_p_spinr:
  s_setpc_b64 s[68:69]
.g2_kernel_p1_aw:
  s_call_b64 s[68:69], .g2_kernel_p_spin
  s_branch .g2_kernel_p1_ai
.g2_kernel_p1_bw:
  s_call_b64 s[68:69], .g2_kernel_p_spin
  s_branch .g2_kernel_p1_bi
.g2_kernel_v_3a:
  s_and_b32 s31, s76, 0xffffe000
  s_add_u32 s31, s31, 0
  v_and_b32 v6, 15, v2
  v_lshlrev_b32 v6, 9, v6
  v_lshrrev_b32 v7, 4, v2
  v_lshl_add_u32 v6, v7, 7, v6
  v_lshlrev_b32 v7, 2, v2
  v_add_u32 v7, 157440, v7
  s_mov_b32 m0, 157440
  s_mov_b32 s38, 0
  s_mov_b32 exec_lo, 0xffff0000
  s_mov_b32 exec_hi, 0xffff0000
.g2_kernel_pa22:
  buffer_load_dword v6, s[4:7], s31 offen sc1 lds
  s_add_u32 s38, s38, 1
  s_waitcnt vmcnt(0)
  ds_read_b32 v8, v7
  s_waitcnt lgkmcnt(0)
  v_cmp_ge_u32 vcc, s62, v8
  s_cbranch_vccz .g2_kernel_pa22d
  s_mov_b64 exec, vcc
  s_sleep 16
  s_cmp_lt_u32 s38, 131072
  s_cbranch_scc1 .g2_kernel_pa22
.g2_kernel_pa22d:
  s_mov_b64 exec, -1
  s_branch .g2_kernel_v_3
.g2_kernel_v_may:
  s_cmp_lg_u32 s39, 0
  s_cbranch_scc1 .g2_kernel_v_mr
  s_and_b32 s28, s16, 3
  s_lshl_b32 s28, s28, 4
  s_add_u32 s28, s28, 155968
  v_mov_b32 v6, s28
  ds_read_b32 v7, v6
  s_waitcnt lgkmcnt(0)
  v_cmp_ne_u32 vcc, 0, v7
  s_cbranch_vccz .g2_kernel_v_mr
.g2_kernel_v_do:
  s_mov_b32 s39, 1
  s_mov_b32 s29, 0
  s_call_b64 s[68:69], .g2_kernel_v_cmb
  s_waitcnt vmcnt(0)
  v_mov_b32 v6, s71
  s_mov_b64 exec, 1
  ds_add_u32 v6, v5 offset:8
  s_mov_b64 exec, -1
  s_and_b32 s33, s16, 3
  s_lshl_b32 s33, s33, 7
  s_lshl_b32 s28, s29, 2
  s_add_u32 s33, s33, s28
  s_add_u32 s31, s19, s33
  v_mov_b32 v6, s70
  s_mov_b64 exec, 1
  buffer_store_dword v6, v4, s[4:7], s31 offen offset:0 sc1
  s_mov_b64 exec, -1
.g2_kernel_v_mr:
  s_setpc_b64 s[26:27]
.g2_kernel_v_wo:
  s_mov_b32 s8, s44
  s_mov_b32 s9, s45
  s_mov_b32 s10, 0x200000
  s_mov_b32 s11, 0x00020000
  v_lshrrev_b32 v6, 3, v2
  v_and_b32 v7, 7, v2
  v_bfe_u32 v8, v2, 4, 1
  v_lshlrev_b32 v8, 2, v8
  v_xor_b32 v7, v7, v8
  v_lshlrev_b32 v7, 4, v7
  v_lshl_add_u32 v6, v6, 11, v7
  s_lshl_b32 s31, s32, 3
  s_add_u32 s31, s31, s29
  s_lshl_b32 s31, s31, 16
  s_lshl_b32 s33, s18, 7
  s_add_u32 s31, s31, s33
  s_mov_b32 m0, s30
  s_nop 0
  buffer_load_dwordx4 v6, s[8:11], s31 offen lds
  s_add_u32 m0, m0, 1024
  s_add_u32 s31, s31, 16384
  s_sleep 1
  buffer_load_dwordx4 v6, s[8:11], s31 offen lds
  s_add_u32 m0, m0, 1024
  s_add_u32 s31, s31, 16384
  s_sleep 1
  buffer_load_dwordx4 v6, s[8:11], s31 offen lds
  s_add_u32 m0, m0, 1024
  s_add_u32 s31, s31, 16384
  s_sleep 1
  buffer_load_dwordx4 v6, s[8:11], s31 offen lds
  s_add_u32 m0, m0, 1024
  s_add_u32 s31, s31, 81920
  s_sleep 1
  buffer_load_dwordx4 v6, s[8:11], s31 offen lds
  s_add_u32 m0, m0, 1024
  s_add_u32 s31, s31, 16384
  s_sleep 1
  buffer_load_dwordx4 v6, s[8:11], s31 offen lds
  s_add_u32 m0, m0, 1024
  s_add_u32 s31, s31, 16384
  s_sleep 1
  buffer_load_dwordx4 v6, s[8:11], s31 offen lds
  s_add_u32 m0, m0, 1024
  s_add_u32 s31, s31, 16384
  s_sleep 1
  buffer_load_dwordx4 v6, s[8:11], s31 offen lds
  s_add_u32 m0, m0, 1024
  s_add_u32 s31, s31, 81920
  s_sleep 1
  buffer_load_dwordx4 v6, s[8:11], s31 offen lds
  s_add_u32 m0, m0, 1024
  s_add_u32 s31, s31, 16384
  s_sleep 1
  buffer_load_dwordx4 v6, s[8:11], s31 offen lds
  s_add_u32 m0, m0, 1024
  s_add_u32 s31, s31, 16384
  s_sleep 1
  buffer_load_dwordx4 v6, s[8:11], s31 offen lds
  s_add_u32 m0, m0, 1024
  s_add_u32 s31, s31, 16384
  s_sleep 1
  buffer_load_dwordx4 v6, s[8:11], s31 offen lds
  s_add_u32 m0, m0, 1024
  s_add_u32 s31, s31, 81920
  s_sleep 1
  buffer_load_dwordx4 v6, s[8:11], s31 offen lds
  s_add_u32 m0, m0, 1024
  s_add_u32 s31, s31, 16384
  s_sleep 1
  buffer_load_dwordx4 v6, s[8:11], s31 offen lds
  s_add_u32 m0, m0, 1024
  s_add_u32 s31, s31, 16384
  s_sleep 1
  buffer_load_dwordx4 v6, s[8:11], s31 offen lds
  s_add_u32 m0, m0, 1024
  s_add_u32 s31, s31, 16384
  s_sleep 1
  buffer_load_dwordx4 v6, s[8:11], s31 offen lds
  s_setpc_b64 s[68:69]
.g2_kernel_v_cmb:
  s_and_b32 s28, s16, 3
  s_lshl_b32 s30, s28, 2
  s_lshl_b32 s34, 15, s30
  s_lshr_b32 s32, s34, 4
  s_or_b32 s32, s32, s34
  s_mul_i32 s32, s32, s29
  v_and_b32 v6, 15, v2
  v_lshlrev_b32 v6, 2, v6
  v_add_u32 v6, 155968, v6
  s_mov_b32 s30, .g2_kernel_sel-.g2_kernel_pc
  buffer_load_dwordx4 v[8:11], v3, s[64:67], s30 offen
  buffer_load_dwordx4 v[12:15], v3, s[64:67], s30 offen offset:1024
  s_lshl_b32 s30, s28, 13
  v_add_u32 v0, s30, v3
  v_and_b32 v4, 31, v2
  s_lshl_b32 s31, s28, 9
  s_add_u32 s31, s31, 161280
  v_lshl_add_u32 v4, v4, 2, s31
  s_lshl_b32 s33, s62, 1
  s_add_u32 s33, s33, s29
  s_lshl_b32 s31, s17, 2
  s_add_u32 s31, s31, s28
  s_lshl_b32 s31, s31, 1
  s_add_u32 s31, s31, s29
  s_lshl_b32 s31, s31, 4
  s_add_u32 s31, s31, s18
  s_lshl_b32 s31, s31, 11
  s_add_u32 s31, s31, s63
  s_add_u32 s35, s31, 0x800000
  s_mov_b32 s38, 0
  s_waitcnt vmcnt(0)
.g2_kernel_v_cmbw:
  ds_read_b32 v7, v6
  s_add_u32 s38, s38, 1
  s_waitcnt lgkmcnt(0)
  v_cmp_ge_u32 vcc, s33, v7
  s_and_b32 s30, vcc_lo, s34
  s_cbranch_scc0 .g2_kernel_v_cmbd
  s_orn2_b32 s30, vcc_lo, s32
  s_cmp_lg_u32 s30, -1
  s_cbranch_scc1 .g2_kernel_v_cmbq
  s_sleep 6
.g2_kernel_v_cmbq:
  s_sleep 1
  s_cmp_lt_u32 s38, 524288
  s_cbranch_scc1 .g2_kernel_v_cmbw
.g2_kernel_v_cmbd:
  s_setprio 3
  ds_read_b128 v[32:35], v0 offset:0
  ds_read_b128 v[36:39], v0 offset:1024
  ds_read_b128 v[40:43], v0 offset:2048
  ds_read_b128 v[44:47], v0 offset:3072
  ds_read_b128 v[48:51], v0 offset:4096
  ds_read_b128 v[52:55], v0 offset:5120
  ds_read_b128 v[56:59], v0 offset:6144
  ds_read_b128 v[60:63], v0 offset:7168
  ds_read2_b32 v[6:7], v4 offset0:64 offset1:96
  ds_read2_b32 v[4:5], v4 offset0:0 offset1:32
  s_lshl_b32 s30, s28, 2
  s_add_u32 s30, s30, s71
  s_waitcnt lgkmcnt(9)
  v_mfma_f32_32x32x16_bf16 v[16:31], v[8:11], v[32:35], 0
  s_waitcnt lgkmcnt(8)
  v_mfma_f32_32x32x16_bf16 v[16:31], v[12:15], v[36:39], v[16:31]
  s_waitcnt lgkmcnt(7)
  v_mfma_f32_32x32x16_bf16 v[16:31], v[8:11], v[40:43], v[16:31]
  s_waitcnt lgkmcnt(6)
  v_mfma_f32_32x32x16_bf16 v[16:31], v[12:15], v[44:47], v[16:31]
  s_waitcnt lgkmcnt(5)
  v_mfma_f32_32x32x16_bf16 v[16:31], v[8:11], v[48:51], v[16:31]
  s_waitcnt lgkmcnt(4)
  v_mfma_f32_32x32x16_bf16 v[16:31], v[12:15], v[52:55], v[16:31]
  s_waitcnt lgkmcnt(3)
  v_mfma_f32_32x32x16_bf16 v[16:31], v[8:11], v[56:59], v[16:31]
  s_waitcnt lgkmcnt(2)
  v_mfma_f32_32x32x16_bf16 v[16:31], v[12:15], v[60:63], v[16:31]
  v_mov_b32 v0, s30
  s_waitcnt lgkmcnt(0)
  v_add_f32 v6, v6, v4
  v_add_f32 v7, v7, v5
  v_mov_b32 v4, 0
  v_mov_b32 v5, s29
  ds_write_b32 v0, v5 offset:64
  v_add_f32 v9, v6, v7
  s_mov_b32 s30, 8.673617379884035e-19
  s_mov_b32 s31, 1.152921504606847e+18
  v_rcp_f32 v10, v9
  v_cmp_le_f32 vcc, s30, v9
  v_cmp_ge_f32 s[36:37], s31, v9
  v_mov_b32 v5, 1
  v_mul_f32 v10, 4.0, v10
  s_and_b64 s[36:37], s[36:37], vcc
  v_cmp_o_f32 vcc, v16, v16
  s_and_b64 vcc, vcc, s[36:37]
  s_cmp_eq_u64 vcc, -1
  s_cbranch_scc0 .g2_kernel_v_cmbslow
.g2_kernel_v_cmbfin:
  v_mul_f32 v16, v16, v10
  v_mul_f32 v17, v17, v10
  v_mul_f32 v18, v18, v10
  v_mul_f32 v19, v19, v10
  v_mul_f32 v20, v20, v10
  v_mul_f32 v21, v21, v10
  v_mul_f32 v22, v22, v10
  v_mul_f32 v23, v23, v10
  v_cvt_pk_bf16_f32 v32, v16, v17
  v_cvt_pk_bf16_f32 v33, v18, v19
  v_cvt_pk_bf16_f32 v34, v20, v21
  v_cvt_pk_bf16_f32 v35, v22, v23
  v_max_u32 v32, 1, v32
  v_max_u32 v34, 1, v34
  buffer_store_dwordx4 v[32:35], v3, s[4:7], s35 offen offset:0 sc1
  v_mul_f32 v24, v24, v10
  v_mul_f32 v25, v25, v10
  v_mul_f32 v26, v26, v10
  v_mul_f32 v27, v27, v10
  v_mul_f32 v28, v28, v10
  v_mul_f32 v29, v29, v10
  v_mul_f32 v30, v30, v10
  v_mul_f32 v31, v31, v10
  v_cvt_pk_bf16_f32 v36, v24, v25
  v_cvt_pk_bf16_f32 v37, v26, v27
  v_cvt_pk_bf16_f32 v38, v28, v29
  v_cvt_pk_bf16_f32 v39, v30, v31
  v_max_u32 v36, 1, v36
  v_max_u32 v38, 1, v38
  buffer_store_dwordx4 v[36:39], v3, s[4:7], s35 offen offset:1024 sc1
  s_setprio 3
  s_setpc_b64 s[68:69]
.g2_kernel_v_cmbslow:
  s_setprio 0
  s_lshl_b32 s30, s28, 11
  s_mul_i32 s31, s29, -8192
  s_add_u32 s30, s30, s31
  s_add_u32 s30, s30, 139264
  v_add_u32 v6, s30, v3
  ds_read_b128 v[48:51], v6
  ds_read_b128 v[52:55], v6 offset:1024
  s_lshl_b32 s36, s18, 1
  s_add_u32 s36, s36, s29
  s_lshl_b32 s36, s36, 18
  s_add_u32 s36, s36, s63
  s_mov_b32 s30, s36
  s_mov_b32 s33, 64
  v_mov_b32 v10, 0xff800000
  s_waitcnt lgkmcnt(0)
.g2_kernel_v_cmbs1:
  buffer_load_dwordx4 v[56:59], v3, s[4:7], s30 offen offset:0
  buffer_load_dwordx4 v[60:63], v3, s[4:7], s30 offen offset:1024
  s_waitcnt vmcnt(0)
  v_mfma_f32_32x32x16_bf16 v[32:47], v[56:59], v[48:51], 0
  v_mfma_f32_32x32x16_bf16 v[32:47], v[60:63], v[52:55], v[32:47]
  s_nop 11
  v_max3_f32 v10, v10, v32, v33
  v_max3_f32 v10, v10, v34, v35
  v_max3_f32 v10, v10, v36, v37
  v_max3_f32 v10, v10, v38, v39
  v_max3_f32 v10, v10, v40, v41
  v_max3_f32 v10, v10, v42, v43
  v_max3_f32 v10, v10, v44, v45
  v_max3_f32 v10, v10, v46, v47
  s_add_u32 s30, s30, 4096
  s_sub_u32 s33, s33, 1
  s_cmp_lg_u32 s33, 0
  s_cbranch_scc1 .g2_kernel_v_cmbs1
  v_mov_b32 v11, v10
  s_nop 1
  v_permlane32_swap_b32 v11, v10
  v_max_f32 v10, v10, v11
  v_mov_b32 v9, 0
  v_mov_b32 v16, 0
  v_mov_b32 v17, 0
  v_mov_b32 v18, 0
  v_mov_b32 v19, 0
  v_mov_b32 v20, 0
  v_mov_b32 v21, 0
  v_mov_b32 v22, 0
  v_mov_b32 v23, 0
  v_mov_b32 v24, 0
  v_mov_b32 v25, 0
  v_mov_b32 v26, 0
  v_mov_b32 v27, 0
  v_mov_b32 v28, 0
  v_mov_b32 v29, 0
  v_mov_b32 v30, 0
  v_mov_b32 v31, 0
  s_mov_b32 s30, s36
  s_mov_b32 s33, 64
.g2_kernel_v_cmbs2:
  buffer_load_dwordx4 v[56:59], v3, s[4:7], s30 offen offset:0
  buffer_load_dwordx4 v[60:63], v3, s[4:7], s30 offen offset:1024
  s_waitcnt vmcnt(0)
  v_mfma_f32_32x32x16_bf16 v[32:47], v[56:59], v[48:51], 0
  v_mfma_f32_32x32x16_bf16 v[32:47], v[60:63], v[52:55], v[32:47]
  s_nop 11
  v_sub_f32 v32, v32, v10
  v_sub_f32 v33, v33, v10
  v_sub_f32 v34, v34, v10
  v_sub_f32 v35, v35, v10
  v_sub_f32 v36, v36, v10
  v_sub_f32 v37, v37, v10
  v_sub_f32 v38, v38, v10
  v_sub_f32 v39, v39, v10
  v_sub_f32 v40, v40, v10
  v_sub_f32 v41, v41, v10
  v_sub_f32 v42, v42, v10
  v_sub_f32 v43, v43, v10
  v_sub_f32 v44, v44, v10
  v_sub_f32 v45, v45, v10
  v_sub_f32 v46, v46, v10
  v_sub_f32 v47, v47, v10
  buffer_load_dwordx4 v[56:59], v3, s[4:7], s30 offen offset:2048
  buffer_load_dwordx4 v[60:63], v3, s[4:7], s30 offen offset:3072
  v_exp_f32 v32, v32
  v_exp_f32 v33, v33
  v_exp_f32 v34, v34
  v_exp_f32 v35, v35
  v_exp_f32 v36, v36
  v_exp_f32 v37, v37
  v_exp_f32 v38, v38
  v_exp_f32 v39, v39
  v_exp_f32 v40, v40
  v_exp_f32 v41, v41
  v_exp_f32 v42, v42
  v_exp_f32 v43, v43
  v_exp_f32 v44, v44
  v_exp_f32 v45, v45
  v_exp_f32 v46, v46
  v_exp_f32 v47, v47
  v_add_f32 v9, v9, v32
  v_add_f32 v9, v9, v33
  v_add_f32 v9, v9, v34
  v_add_f32 v9, v9, v35
  v_add_f32 v9, v9, v36
  v_add_f32 v9, v9, v37
  v_add_f32 v9, v9, v38
  v_add_f32 v9, v9, v39
  v_add_f32 v9, v9, v40
  v_add_f32 v9, v9, v41
  v_add_f32 v9, v9, v42
  v_add_f32 v9, v9, v43
  v_add_f32 v9, v9, v44
  v_add_f32 v9, v9, v45
  v_add_f32 v9, v9, v46
  v_add_f32 v9, v9, v47
  v_cvt_pk_bf16_f32 v32, v32, v33
  v_cvt_pk_bf16_f32 v33, v34, v35
  v_cvt_pk_bf16_f32 v34, v36, v37
  v_cvt_pk_bf16_f32 v35, v38, v39
  v_cvt_pk_bf16_f32 v36, v40, v41
  v_cvt_pk_bf16_f32 v37, v42, v43
  v_cvt_pk_bf16_f32 v38, v44, v45
  v_cvt_pk_bf16_f32 v39, v46, v47
  s_waitcnt vmcnt(0)
  v_mfma_f32_32x32x16_bf16 v[16:31], v[56:59], v[32:35], v[16:31]
  v_mfma_f32_32x32x16_bf16 v[16:31], v[60:63], v[36:39], v[16:31]
  s_nop 15
  s_add_u32 s30, s30, 4096
  s_sub_u32 s33, s33, 1
  s_cmp_lg_u32 s33, 0
  s_cbranch_scc1 .g2_kernel_v_cmbs2
  v_mov_b32 v11, v9
  s_nop 1
  v_permlane32_swap_b32 v11, v9
  v_add_f32 v9, v9, v11
  v_rcp_f32 v10, v9
  s_branch .g2_kernel_v_cmbfin
.g2_kernel_p2_xw:
  s_mov_b32 s38, 0
.g2_kernel_p2_xwl:
  ds_read_b32 v12, v11
  s_add_u32 s38, s38, 1
  s_waitcnt lgkmcnt(0)
  v_cmp_ne_u32 vcc, 0, v12
  s_and_b32 s37, vcc_lo, vcc_hi
  s_lshr_b32 s33, s37, 16
  s_and_b32 s37, s37, s33
  s_bitcmp1_b32 s37, s28
  s_cbranch_scc1 .g2_kernel_p2_xwr
  s_sleep 1
  s_cmp_lt_u32 s38, 524288
  s_cbranch_scc1 .g2_kernel_p2_xwl
.g2_kernel_p2_xwr:
  s_setpc_b64 s[68:69]
.g2_kernel_p2_x0w:
  s_call_b64 s[68:69], .g2_kernel_p2_xw
  s_branch .g2_kernel_p2_x0b
.g2_kernel_p2_x1w:
  s_call_b64 s[68:69], .g2_kernel_p2_xw
  s_branch .g2_kernel_p2_x1b
.g2_kernel_p2_x2w:
  s_call_b64 s[68:69], .g2_kernel_p2_xw
  s_branch .g2_kernel_p2_x2b
.g2_kernel_p2_aw:
  s_call_b64 s[68:69], .g2_kernel_p_spin
  s_branch .g2_kernel_p2_ai
.g2_kernel_p2_x3w:
  s_call_b64 s[68:69], .g2_kernel_p2_xw
  s_branch .g2_kernel_p2_x3b
.g2_kernel_p2_bw:
  s_call_b64 s[68:69], .g2_kernel_p_spin
  s_branch .g2_kernel_p2_bi
.g2_kernel_amax:
  v_mov_b32 v16, 0xff7fffff
  v_lshlrev_b32 v7, 7, v2
  s_mov_b32 s38, 0
  s_mov_b64 exec, s[8:9]
.g2_kernel_amaxl:
  buffer_load_dwordx2 v[16:17], v7, s[4:7], s23 offen sc1
  s_add_u32 s38, s38, 1
  s_waitcnt vmcnt(0)
  v_cmp_eq_u32 vcc, 0, v17
  s_cbranch_vccz .g2_kernel_amaxd
  s_mov_b64 exec, vcc
  s_sleep 4
  s_cmp_lg_u32 s62, 0
  s_cbranch_scc1 .g2_kernel_nap55
  s_sleep 8
.g2_kernel_nap55:
  s_cmp_eq_u32 s39, 1
  s_cbranch_scc0 .g2_kernel_amaxz
  s_sleep 8
.g2_kernel_amaxz:
  s_cmp_lt_u32 s38, 131072
  s_cbranch_scc1 .g2_kernel_amaxl
.g2_kernel_amaxd:
  s_mov_b64 exec, -1
  v_mov_b32 v6, v16
  s_nop 1
  v_max_f32 v7, v6, v6 row_ror:8 row_mask:0xf bank_mask:0xf
  s_nop 1
  v_max_f32 v7, v7, v7 row_ror:4 row_mask:0xf bank_mask:0xf
  s_nop 1
  v_max_f32 v7, v7, v7 row_ror:2 row_mask:0xf bank_mask:0xf
  s_nop 1
  v_max_f32 v7, v7, v7 row_ror:1 row_mask:0xf bank_mask:0xf
  s_nop 1
  v_max_f32 v7, v7, v7 row_bcast:15 row_mask:0xa bank_mask:0xf
  s_nop 1
  v_max_f32 v7, v7, v7 row_bcast:31 row_mask:0xc bank_mask:0xf
  s_nop 0
  v_readlane_b32 s27, v7, 63
  s_nop 1
  v_cmp_eq_u32 vcc, s27, v6
  s_ff1_i32_b64 s77, vcc
  s_lshl_b32 s77, s77, 5
  s_and_b32 s28, s27, 31
  s_add_u32 s77, s77, s28
  s_and_b32 s77, s77, 2047
  s_setpc_b64 s[68:69]
  .p2align 8
.g2_kernel_tab:
  .long 0, 1, 2, 3, 4, 5, 6, 7
  .long 8, 9, 10, 11, 12, 13, 14, 15
  .long 16, 17, 18, 19, 20, 21, 22, 23
  .long 24, 25, 26, 27, 28, 29, 30, 31
  .long 32, 33, 34, 35, 36, 37, 38, 39
  .long 40, 41, 42, 43, 44, 45, 46, 47
  .long 48, 49, 50, 51, 52, 53, 54, 55
  .long 56, 57, 58, 59, 60, 61, 62, 63
  .long 64, 65, 66, 67, 68, 69, 70, 71
  .p2align 4
.g2_kernel_sel:
  .long 0x3e80, 0x0, 0x0, 0x0
  .long 0x3e800000, 0x0, 0x0, 0x0
  .long 0x0, 0x3e80, 0x0, 0x0
  .long 0x0, 0x3e800000, 0x0, 0x0
  .long 0x0, 0x0, 0x0, 0x0
  .long 0x0, 0x0, 0x0, 0x0
  .long 0x0, 0x0, 0x0, 0x0
  .long 0x0, 0x0, 0x0, 0x0
  .long 0x0, 0x0, 0x3e80, 0x0
  .long 0x0, 0x0, 0x3e800000, 0x0
  .long 0x0, 0x0, 0x0, 0x3e80
  .long 0x0, 0x0, 0x0, 0x3e800000
  .long 0x0, 0x0, 0x0, 0x0
  .long 0x0, 0x0, 0x0, 0x0
  .long 0x0, 0x0, 0x0, 0x0
  .long 0x0, 0x0, 0x0, 0x0
  .long 0x0, 0x0, 0x0, 0x0
  .long 0x0, 0x0, 0x0, 0x0
  .long 0x0, 0x0, 0x0, 0x0
  .long 0x0, 0x0, 0x0, 0x0
  .long 0x0, 0x0, 0x0, 0x0
  .long 0x0, 0x0, 0x0, 0x0
  .long 0x0, 0x0, 0x0, 0x0
  .long 0x0, 0x0, 0x0, 0x0
  .long 0x0, 0x0, 0x0, 0x0
  .long 0x0, 0x0, 0x0, 0x0
  .long 0x0, 0x0, 0x0, 0x0
  .long 0x0, 0x0, 0x0, 0x0
  .long 0x0, 0x0, 0x0, 0x0
  .long 0x0, 0x0, 0x0, 0x0
  .long 0x0, 0x0, 0x0, 0x0
  .long 0x0, 0x0, 0x0, 0x0
  .long 0x0, 0x0, 0x0, 0x0
  .long 0x0, 0x0, 0x0, 0x0
  .long 0x0, 0x0, 0x0, 0x0
  .long 0x0, 0x0, 0x0, 0x0
  .long 0x3e80, 0x0, 0x0, 0x0
  .long 0x3e800000, 0x0, 0x0, 0x0
  .long 0x0, 0x3e80, 0x0, 0x0
  .long 0x0, 0x3e800000, 0x0, 0x0
  .long 0x0, 0x0, 0x0, 0x0
  .long 0x0, 0x0, 0x0, 0x0
  .long 0x0, 0x0, 0x0, 0x0
  .long 0x0, 0x0, 0x0, 0x0
  .long 0x0, 0x0, 0x3e80, 0x0
  .long 0x0, 0x0, 0x3e800000, 0x0
  .long 0x0, 0x0, 0x0, 0x3e80
  .long 0x0, 0x0, 0x0, 0x3e800000
  .long 0x0, 0x0, 0x0, 0x0
  .long 0x0, 0x0, 0x0, 0x0
  .long 0x0, 0x0, 0x0, 0x0
  .long 0x0, 0x0, 0x0, 0x0
  .long 0x0, 0x0, 0x0, 0x0
  .long 0x0, 0x0, 0x0, 0x0
  .long 0x0, 0x0, 0x0, 0x0
  .long 0x0, 0x0, 0x0, 0x0
  .long 0x0, 0x0, 0x0, 0x0
  .long 0x0, 0x0, 0x0, 0x0
  .long 0x0, 0x0, 0x0, 0x0
  .long 0x0, 0x0, 0x0, 0x0
  .long 0x0, 0x0, 0x0, 0x0
  .long 0x0, 0x0, 0x0, 0x0
  .long 0x0, 0x0, 0x0, 0x0
  .long 0x0, 0x0, 0x0, 0x0
  .long 0x0, 0x0, 0x0, 0x0
  .long 0x0, 0x0, 0x0, 0x0
  .long 0x0, 0x0, 0x0, 0x0
  .long 0x0, 0x0, 0x0, 0x0
  .long 0x0, 0x0, 0x0, 0x0
  .long 0x0, 0x0, 0x0, 0x0
  .long 0x0, 0x0, 0x0, 0x0
  .long 0x0, 0x0, 0x0, 0x0
  .long 0x0, 0x0, 0x0, 0x0
  .long 0x0, 0x0, 0x0, 0x0
  .long 0x0, 0x0, 0x0, 0x0
  .long 0x0, 0x0, 0x0, 0x0
  .long 0x0, 0x0, 0x0, 0x0
  .long 0x0, 0x0, 0x0, 0x0
  .long 0x0, 0x0, 0x0, 0x0
  .long 0x0, 0x0, 0x0, 0x0
  .long 0x3e80, 0x0, 0x0, 0x0
  .long 0x3e800000, 0x0, 0x0, 0x0
  .long 0x0, 0x3e80, 0x0, 0x0
  .long 0x0, 0x3e800000, 0x0, 0x0
  .long 0x0, 0x0, 0x0, 0x0
  .long 0x0, 0x0, 0x0, 0x0
  .long 0x0, 0x0, 0x0, 0x0
  .long 0x0, 0x0, 0x0, 0x0
  .long 0x0, 0x0, 0x3e80, 0x0
  .long 0x0, 0x0, 0x3e800000, 0x0
  .long 0x0, 0x0, 0x0, 0x3e80
  .long 0x0, 0x0, 0x0, 0x3e800000
  .long 0x0, 0x0, 0x0, 0x0
  .long 0x0, 0x0, 0x0, 0x0
  .long 0x0, 0x0, 0x0, 0x0
  .long 0x0, 0x0, 0x0, 0x0
  .long 0x0, 0x0, 0x0, 0x0
  .long 0x0, 0x0, 0x0, 0x0
  .long 0x0, 0x0, 0x0, 0x0
  .long 0x0, 0x0, 0x0, 0x0
  .long 0x0, 0x0, 0x0, 0x0
  .long 0x0, 0x0, 0x0, 0x0
  .long 0x0, 0x0, 0x0, 0x0
  .long 0x0, 0x0, 0x0, 0x0
  .long 0x0, 0x0, 0x0, 0x0
  .long 0x0, 0x0, 0x0, 0x0
  .long 0x0, 0x0, 0x0, 0x0
  .long 0x0, 0x0, 0x0, 0x0
  .long 0x0, 0x0, 0x0, 0x0
  .long 0x0, 0x0, 0x0, 0x0
  .long 0x0, 0x0, 0x0, 0x0
  .long 0x0, 0x0, 0x0, 0x0
  .long 0x0, 0x0, 0x0, 0x0
  .long 0x0, 0x0, 0x0, 0x0
  .long 0x0, 0x0, 0x0, 0x0
  .long 0x0, 0x0, 0x0, 0x0
  .long 0x3e80, 0x0, 0x0, 0x0
  .long 0x3e800000, 0x0, 0x0, 0x0
  .long 0x0, 0x3e80, 0x0, 0x0
  .long 0x0, 0x3e800000, 0x0, 0x0
  .long 0x0, 0x0, 0x0, 0x0
  .long 0x0, 0x0, 0x0, 0x0
  .long 0x0, 0x0, 0x0, 0x0
  .long 0x0, 0x0, 0x0, 0x0
  .long 0x0, 0x0, 0x3e80, 0x0
  .long 0x0, 0x0, 0x3e800000, 0x0
  .long 0x0, 0x0, 0x0, 0x3e80
  .long 0x0, 0x0, 0x0, 0x3e800000
.g2_kernel_cend:

.section .rodata,"a"
.p2align 6
.amdhsa_kernel g2_kernel
  .amdhsa_next_free_vgpr 256
  .amdhsa_next_free_sgpr 102
  .amdhsa_accum_offset 256
  .amdhsa_group_segment_fixed_size 0
  .amdhsa_kernarg_size 88
  .amdhsa_user_sgpr_count 2
  .amdhsa_user_sgpr_kernarg_segment_ptr 1
  .amdhsa_system_sgpr_workgroup_id_x 1
.end_amdhsa_kernel
```

```asm
; @launch kernel=g2_kernel grid=(256,1,1) block=(512,1,1) lds=163840
.amdgcn_target "amdgcn-amd-amdhsa--gfx950"
.text
.globl g2_kernel
.p2align 8
.type g2_kernel,@function
g2_kernel:
  s_cmp_ge_u32 s2, 256
  s_cbranch_scc1 .g2_kernel_end
  s_load_dwordx16 s[40:55], s[0:1], 0
  s_load_dwordx4 s[56:59], s[0:1], 64
  s_load_dwordx2 s[60:61], s[0:1], 80
  s_getpc_b64 s[64:65]
.g2_kernel_pc:
  s_mov_b32 s66, .g2_kernel_cend-.g2_kernel_pc
  s_mov_b32 s67, 0x00020000
  s_lshl_b32 s12, s2, 10
  s_and_b32 s12, s12, 0xe000
  v_lshrrev_b32 v3, 3, v0
  v_and_b32 v2, 7, v0
  v_and_b32 v3, 0x38, v3
  v_add_lshl_u32 v3, v3, v2, 7
  s_mov_b64 exec, 0xff
  buffer_load_dword v1, v3, s[64:67], s12 offen
  s_mov_b64 exec, -1
  v_lshrrev_b32 v3, 6, v0
  v_and_b32 v2, 63, v0
  v_readfirstlane_b32 s16, v3
  s_and_b32 s21, s2, 7
  s_lshr_b32 s22, s2, 3
  s_and_b32 s23, s21, 3
  s_lshl_b32 s23, s23, 2
  s_and_b32 s24, s22, 3
  s_add_u32 s18, s23, s24
  s_lshr_b32 s24, s21, 2
  s_lshl_b32 s24, s24, 3
  s_lshr_b32 s25, s22, 2
  s_add_u32 s17, s24, s25
  s_lshl_b32 s19, s17, 4
  s_add_u32 s19, s19, s18
  s_lshl_b32 s19, s19, 9
  s_add_u32 s19, s19, 0x3000000
  s_lshl_b32 s76, s18, 4
  s_add_u32 s76, s76, s17
  s_lshl_b32 s76, s76, 9
  s_add_u32 s76, s76, 0x3020000
  v_lshlrev_b32 v3, 4, v2
  v_mov_b32 v4, 0
  v_mov_b32 v5, 1
  s_mov_b32 s62, 0
  s_mov_b32 s63, 0
  s_mov_b32 s70, 1
  s_mov_b32 s71, 155648
  s_waitcnt lgkmcnt(0)
  s_mov_b32 s4, s60
  s_mov_b32 s5, s61
  s_mov_b32 s6, 0x3300000
  s_mov_b32 s7, 0x00020000
  s_cmp_ge_u32 s16, 4
  s_cbranch_scc1 .g2_kernel_svc
  v_mov_b32 v20, 0
  v_mov_b32 v21, 0
  v_mov_b32 v22, 0
  v_mov_b32 v23, 0
  v_lshlrev_b32 v24, 4, v0
  v_cmp_gt_u32 vcc, 2816, v24
  v_add_u32 v24, 155648, v24
  s_and_saveexec_b64 s[20:21], vcc
  s_cbranch_execz .g2_kernel_q_nz
  ds_write_b128 v24, v[20:23]
.g2_kernel_q_nz:
  s_mov_b64 exec, -1
  v_and_b32 v20, 15, v2
  v_lshrrev_b32 v21, 4, v2
  v_lshrrev_b32 v22, 1, v20
  v_xor_b32 v22, v22, v21
  v_lshlrev_b32 v22, 4, v22
  v_lshl_add_u32 v22, v20, 7, v22
  s_lshr_b32 s26, s16, 1
  s_lshl_b32 s26, s26, 13
  v_add_u32 v144, s26, v22
  v_xor_b32 v145, 64, v144
.g2_kernel_q_cs:
  s_and_b32 s27, s16, 1
  s_lshr_b32 s26, s16, 1
  v_bfe_u32 v20, v2, 2, 2
  v_lshrrev_b32 v49, 4, v2
  v_lshl_add_u32 v22, v49, 3, v20
  v_lshlrev_b32 v22, 7, v22
  v_lshrrev_b32 v23, 1, v20
  v_and_b32 v21, 1, v49
  v_xor_b32 v21, s27, v21
  v_lshl_add_u32 v23, v21, 1, v23
  v_lshl_add_u32 v22, v23, 5, v22
  v_and_b32 v23, 3, v2
  v_lshl_add_u32 v22, v23, 3, v22
  v_add_u32 v148, 65536, v22
  v_xor_b32 v149, 32, v148
  v_mov_b32 v146, v148
  v_mov_b32 v147, v149
  v_mov_b32 v150, 156160
  v_and_b32 v48, 15, v2
  s_lshl_b32 s28, s26, 8
  s_add_u32 s28, s28, 155648
  v_lshl_add_u32 v50, v48, 2, s28
  v_lshl_add_u32 v51, v49, 4, s28
  s_lshl_b32 s28, s27, 7
  s_add_u32 s28, s28, 155648
  v_lshl_add_u32 v52, v49, 4, s28
  s_xor_b32 s28, s28, 128
  v_lshl_add_u32 v53, v48, 2, s28
  v_lshlrev_b32 v54, 9, v49
  v_lshl_add_u32 v55, v48, 4, v54
  v_and_b32 v56, 8, v48
  v_lshl_add_u32 v54, v56, 4, v55
  v_mov_b32 v56, 0.25503486164919736
  v_lshlrev_b32 v58, 2, v2
  v_and_b32 v58, 12, v58
  v_add_u32 v58, 156416, v58
  s_lshl_b32 s8, s18, 7
  s_lshl_b32 s9, s17, 2
  s_add_u32 s8, s8, s9
  s_lshl_b32 s9, s26, 1
  s_add_u32 s8, s8, s9
  s_lshl_b32 s8, s8, 12
  s_add_u32 s8, s8, s63
  s_add_u32 s9, s8, 4096
  s_lshl_b32 s28, s26, 13
  s_lshl_b32 s10, s27, 14
  s_add_u32 s28, s28, s10
  v_add_u32 v59, s28, v54
  s_xor_b32 s28, s28, 16384
  v_add_u32 v60, s28, v55
  s_lshl_b32 s28, s26, 12
  s_mul_i32 s10, s27, -8192
  s_add_u32 s28, s28, s10
  s_add_u32 s28, s28, 139264
  v_add_u32 v61, s28, v55
  s_mov_b32 s10, s27
  s_lshl_b32 s28, s26, 2
  s_add_u32 s28, s28, s71
  v_mov_b32 v62, s28
  s_lshl_b32 s12, s62, 5
  s_add_u32 s12, s12, 28
  v_and_b32 v6, 15, v2
  v_xor_b32 v6, s17, v6
  v_and_b32 v7, 16, v2
  v_add_u32 v6, v6, v7
  s_lshr_b32 s28, s16, 1
  s_lshl_b32 s28, s28, 7
  s_add_u32 s28, s28, 157440
  v_lshl_add_u32 v8, v6, 2, s28
  s_lshl_b32 s28, s16, 12
  v_add_u32 v9, s28, v3
  v_and_b32 v6, 31, v2
  s_lshl_b32 s28, s16, 7
  s_add_u32 s28, s28, 161280
  v_lshl_add_u32 v10, v6, 2, s28
  s_lshl_b32 s28, s16, 2
  s_add_u32 s28, s28, 155968
  v_mov_b32 v11, s28
  s_lshl_b32 s28, s62, 1
  s_add_u32 s28, s28, 1
  v_mov_b32 v12, s28
  v_mov_b32 v13, s71
  v_add_u32 v14, 131072, v3
  v_and_b32 v6, 4, v2
  v_cmp_eq_u32 vcc, 0, v6
  v_mov_b32 v7, 0x3f803f80
  v_and_b32 v6, 1, v2
  v_cndmask_b32 v16, 0, v7, vcc
  v_cndmask_b32 v17, 0, v7, vcc
  v_cndmask_b32 v18, v7, 0, vcc
  v_cndmask_b32 v19, v7, 0, vcc
  v_mul_u32_u24 v20, 0xaaaa, v6
  v_add_u32 v20, 0x4444, v20
  s_lshl_b32 s28, s18, 7
  s_add_u32 s28, s28, s16
  s_lshl_b32 s28, s28, 12
  s_add_u32 s28, s28, s63
  s_add_u32 s20, s60, s28
  s_addc_u32 s21, s61, 0
  s_mov_b32 s24, s17
  s_mov_b32 s25, 14
  s_mov_b32 s26, 0
  s_mov_b32 s27, 6
  s_mov_b32 s34, 0xffff0001
  s_mov_b32 s35, 0
  s_mov_b32 s36, 0
  s_mov_b32 s39, 0
  s_and_b32 s28, s16, 2
  s_lshl_b32 s28, s28, 7
  s_add_u32 s37, s76, s28
  v_mov_b32 v15, s70
  v_lshrrev_b32 v6, 5, v2
  v_and_b32 v7, 15, v2
  v_lshlrev_b32 v22, 4, v7
  v_lshl_add_u32 v22, v6, 8, v22
  v_and_b32 v7, 16, v2
  v_lshl_add_u32 v22, v7, 7, v22
  v_and_b32 v7, 31, v2
  v_lshlrev_b32 v23, 4, v6
  v_lshl_add_u32 v23, v7, 11, v23
  s_lshl_b32 s28, s17, 2
  s_add_u32 s28, s28, s16
  s_lshl_b32 s28, s28, 16
  s_lshl_b32 s29, s18, 7
  s_add_u32 s28, s28, s29
  s_add_u32 s74, s40, s28
  s_addc_u32 s75, s41, 0
  s_lshl_b32 s13, s17, 4
  s_add_u32 s13, s13, s18
  s_lshl_b32 s13, s13, 2
  s_add_u32 s13, s13, s16
  s_lshl_b32 s13, s13, 12
  s_add_u32 s13, s13, 0xc00000
  s_lshl_b32 s28, s16, 2
  s_add_u32 m0, s28, 156416
  s_lshl_b32 s33, s62, 5
  s_lshl_b32 s31, s33, 2
  s_add_u32 s31, s31, .g2_kernel_tab-.g2_kernel_pc+4
  s_mov_b32 s29, 0
  s_cmp_lg_u32 s62, 0
  s_cbranch_scc1 .g2_kernel_q_i2
  s_waitcnt lgkmcnt(0)
  s_barrier
.g2_kernel_q_i3:
  s_call_b64 s[68:69], .g2_kernel_q_spin
  ds_read_b64_tr_b16 v[80:81], v146 offset:0
  ds_read_b64_tr_b16 v[82:83], v146 offset:512
  ds_read_b128 v[64:67], v144 offset:0
  ds_read_b128 v[68:71], v144 offset:2048
  ds_read_b128 v[72:75], v144 offset:4096
  ds_read_b128 v[76:79], v144 offset:6144
  ds_read_b64_tr_b16 v[84:85], v147 offset:0
  ds_read_b64_tr_b16 v[86:87], v147 offset:512
  ds_read_b64_tr_b16 v[88:89], v146 offset:4096
  ds_read_b64_tr_b16 v[90:91], v146 offset:4608
  ds_read_b64_tr_b16 v[92:93], v147 offset:4096
  ds_read_b64_tr_b16 v[94:95], v147 offset:4608
  ds_read_b64_tr_b16 v[96:97], v146 offset:8192
  ds_read_b64_tr_b16 v[98:99], v146 offset:8704
  ds_read_b64_tr_b16 v[100:101], v147 offset:8192
  ds_read_b64_tr_b16 v[102:103], v147 offset:8704
  s_mov_b32 s30, 12288
  s_add_u32 s33, s33, 1
  v_add_u32 v146, s30, v148
  v_add_u32 v147, s30, v149
  s_waitcnt lgkmcnt(0)
  v_mfma_f32_16x16x32_bf16 v[160:163], v[80:83], v[64:67], 0
  v_cmp_lt_i32 vcc, s33, v151
  v_mfma_f32_16x16x32_bf16 v[164:167], v[80:83], v[68:71], 0
  s_cbranch_vccz .g2_kernel_q_wf
.g2_kernel_q_backf:
  v_mfma_f32_16x16x32_bf16 v[168:171], v[80:83], v[72:75], 0
  ds_read_b64_tr_b16 v[120:121], v146 offset:0
  v_mfma_f32_16x16x32_bf16 v[172:175], v[80:83], v[76:79], 0
  ds_read_b64_tr_b16 v[122:123], v146 offset:512
  v_mfma_f32_16x16x32_bf16 v[188:191], v[84:87], v[76:79], 0
  ds_read_b128 v[104:107], v145 offset:0
  v_mfma_f32_16x16x32_bf16 v[184:187], v[84:87], v[72:75], 0
  ds_read_b128 v[108:111], v145 offset:2048
  v_mfma_f32_16x16x32_bf16 v[180:183], v[84:87], v[68:71], 0
  ds_read_b128 v[112:115], v145 offset:4096
  v_mfma_f32_16x16x32_bf16 v[176:179], v[84:87], v[64:67], 0
  ds_read_b128 v[116:119], v145 offset:6144
  v_mfma_f32_16x16x32_bf16 v[192:195], v[88:91], v[64:67], 0
  ds_read_b64_tr_b16 v[124:125], v147 offset:0
  v_mfma_f32_16x16x32_bf16 v[196:199], v[88:91], v[68:71], 0
  ds_read_b64_tr_b16 v[126:127], v147 offset:512
  v_mfma_f32_16x16x32_bf16 v[200:203], v[88:91], v[72:75], 0
  ds_read_b64_tr_b16 v[128:129], v146 offset:4096
  v_mfma_f32_16x16x32_bf16 v[204:207], v[88:91], v[76:79], 0
  ds_read_b64_tr_b16 v[130:131], v146 offset:4608
  v_mfma_f32_16x16x32_bf16 v[220:223], v[92:95], v[76:79], 0
  ds_read_b64_tr_b16 v[132:133], v147 offset:4096
  v_mfma_f32_16x16x32_bf16 v[216:219], v[92:95], v[72:75], 0
  ds_read_b64_tr_b16 v[134:135], v147 offset:4608
  v_mfma_f32_16x16x32_bf16 v[212:215], v[92:95], v[68:71], 0
  ds_read_b64_tr_b16 v[136:137], v146 offset:8192
  v_mfma_f32_16x16x32_bf16 v[208:211], v[92:95], v[64:67], 0
  ds_read_b64_tr_b16 v[138:139], v146 offset:8704
  v_mfma_f32_16x16x32_bf16 v[224:227], v[64:67], v[96:99], 0
  ds_read_b64_tr_b16 v[140:141], v147 offset:8192
  v_mfma_f32_16x16x32_bf16 v[228:231], v[68:71], v[96:99], 0
  ds_read_b64_tr_b16 v[142:143], v147 offset:8704
  v_mfma_f32_16x16x32_bf16 v[232:235], v[72:75], v[96:99], 0
  ds_read_b32 v151, v150
  s_add_u32 s30, s30, 12288
  v_mfma_f32_16x16x32_bf16 v[236:239], v[76:79], v[96:99], 0
  s_mov_b64 exec, 1
  buffer_load_dword off, s[64:67], s31 lds
  s_mov_b64 exec, -1
  s_cmp_eq_u32 s30, 86016
  v_mfma_f32_16x16x32_bf16 v[252:255], v[76:79], v[100:103], 0
  s_cselect_b32 s30, 0, s30
  s_add_u32 s31, s31, 4
  v_mfma_f32_16x16x32_bf16 v[248:251], v[72:75], v[100:103], 0
  v_add_u32 v146, s30, v148
  s_add_u32 s33, s33, 1
  v_mfma_f32_16x16x32_bf16 v[244:247], v[68:71], v[100:103], 0
  v_add_u32 v147, s30, v149
  v_mfma_f32_16x16x32_bf16 v[240:243], v[64:67], v[100:103], 0
  s_branch .g2_kernel_q_s1
  .p2align 6
.g2_kernel_q_loop:
  s_waitcnt lgkmcnt(0)
  v_mfma_f32_16x16x32_bf16 v[160:163], v[120:123], v[104:107], v[160:163]
  v_cmp_lt_i32 vcc, s33, v151
  v_mfma_f32_16x16x32_bf16 v[164:167], v[120:123], v[108:111], v[164:167]
  s_cbranch_vccz .g2_kernel_q_w7
.g2_kernel_q_back7:
  v_mfma_f32_16x16x32_bf16 v[168:171], v[120:123], v[112:115], v[168:171]
  ds_read_b64_tr_b16 v[80:81], v146 offset:0
  v_mfma_f32_16x16x32_bf16 v[172:175], v[120:123], v[116:119], v[172:175]
  ds_read_b64_tr_b16 v[82:83], v146 offset:512
  v_mfma_f32_16x16x32_bf16 v[188:191], v[124:127], v[116:119], v[188:191]
  ds_read_b128 v[64:67], v144 offset:0
  v_mfma_f32_16x16x32_bf16 v[184:187], v[124:127], v[112:115], v[184:187]
  ds_read_b128 v[68:71], v144 offset:2048
  v_mfma_f32_16x16x32_bf16 v[180:183], v[124:127], v[108:111], v[180:183]
  ds_read_b128 v[72:75], v144 offset:4096
  v_mfma_f32_16x16x32_bf16 v[176:179], v[124:127], v[104:107], v[176:179]
  ds_read_b128 v[76:79], v144 offset:6144
  v_mfma_f32_16x16x32_bf16 v[192:195], v[128:131], v[104:107], v[192:195]
  ds_read_b64_tr_b16 v[84:85], v147 offset:0
  v_mfma_f32_16x16x32_bf16 v[196:199], v[128:131], v[108:111], v[196:199]
  ds_read_b64_tr_b16 v[86:87], v147 offset:512
  v_mfma_f32_16x16x32_bf16 v[200:203], v[128:131], v[112:115], v[200:203]
  ds_read_b64_tr_b16 v[88:89], v146 offset:4096
  v_mfma_f32_16x16x32_bf16 v[204:207], v[128:131], v[116:119], v[204:207]
  ds_read_b64_tr_b16 v[90:91], v146 offset:4608
  v_mfma_f32_16x16x32_bf16 v[220:223], v[132:135], v[116:119], v[220:223]
  ds_read_b64_tr_b16 v[92:93], v147 offset:4096
  v_mfma_f32_16x16x32_bf16 v[216:219], v[132:135], v[112:115], v[216:219]
  ds_read_b64_tr_b16 v[94:95], v147 offset:4608
  v_mfma_f32_16x16x32_bf16 v[212:215], v[132:135], v[108:111], v[212:215]
  ds_read_b64_tr_b16 v[96:97], v146 offset:8192
  v_mfma_f32_16x16x32_bf16 v[208:211], v[132:135], v[104:107], v[208:211]
  ds_read_b64_tr_b16 v[98:99], v146 offset:8704
  v_mfma_f32_16x16x32_bf16 v[224:227], v[104:107], v[136:139], v[224:227]
  ds_read_b64_tr_b16 v[100:101], v147 offset:8192
  v_mfma_f32_16x16x32_bf16 v[228:231], v[108:111], v[136:139], v[228:231]
  ds_read_b64_tr_b16 v[102:103], v147 offset:8704
  v_mfma_f32_16x16x32_bf16 v[232:235], v[112:115], v[136:139], v[232:235]
  ds_read_b32 v151, v150
  s_add_u32 s30, s30, 12288
  v_mfma_f32_16x16x32_bf16 v[236:239], v[116:119], v[136:139], v[236:239]
  s_mov_b64 exec, 1
  buffer_load_dword off, s[64:67], s31 lds
  s_mov_b64 exec, -1
  s_cmp_eq_u32 s30, 86016
  v_mfma_f32_16x16x32_bf16 v[252:255], v[116:119], v[140:143], v[252:255]
  s_cselect_b32 s30, 0, s30
  s_add_u32 s31, s31, 4
  v_mfma_f32_16x16x32_bf16 v[248:251], v[112:115], v[140:143], v[248:251]
  v_add_u32 v146, s30, v148
  s_add_u32 s33, s33, 1
  v_mfma_f32_16x16x32_bf16 v[244:247], v[108:111], v[140:143], v[244:247]
  v_add_u32 v147, s30, v149
  v_mfma_f32_16x16x32_bf16 v[240:243], v[104:107], v[140:143], v[240:243]
  s_waitcnt lgkmcnt(0)
  v_mfma_f32_16x16x32_bf16 v[160:163], v[80:83], v[64:67], v[160:163]
  v_cmp_lt_i32 vcc, s33, v151
  v_mfma_f32_16x16x32_bf16 v[164:167], v[80:83], v[68:71], v[164:167]
  s_cbranch_vccz .g2_kernel_q_w0
.g2_kernel_q_back0:
  v_mfma_f32_16x16x32_bf16 v[168:171], v[80:83], v[72:75], v[168:171]
  ds_read_b64_tr_b16 v[120:121], v146 offset:0
  v_mfma_f32_16x16x32_bf16 v[172:175], v[80:83], v[76:79], v[172:175]
  ds_read_b64_tr_b16 v[122:123], v146 offset:512
  v_mfma_f32_16x16x32_bf16 v[188:191], v[84:87], v[76:79], v[188:191]
  ds_read_b128 v[104:107], v145 offset:0
  v_mfma_f32_16x16x32_bf16 v[184:187], v[84:87], v[72:75], v[184:187]
  ds_read_b128 v[108:111], v145 offset:2048
  v_mfma_f32_16x16x32_bf16 v[180:183], v[84:87], v[68:71], v[180:183]
  ds_read_b128 v[112:115], v145 offset:4096
  v_mfma_f32_16x16x32_bf16 v[176:179], v[84:87], v[64:67], v[176:179]
  ds_read_b128 v[116:119], v145 offset:6144
  v_mfma_f32_16x16x32_bf16 v[192:195], v[88:91], v[64:67], v[192:195]
  ds_read_b64_tr_b16 v[124:125], v147 offset:0
  v_mfma_f32_16x16x32_bf16 v[196:199], v[88:91], v[68:71], v[196:199]
  ds_read_b64_tr_b16 v[126:127], v147 offset:512
  v_mfma_f32_16x16x32_bf16 v[200:203], v[88:91], v[72:75], v[200:203]
  ds_read_b64_tr_b16 v[128:129], v146 offset:4096
  v_mfma_f32_16x16x32_bf16 v[204:207], v[88:91], v[76:79], v[204:207]
  ds_read_b64_tr_b16 v[130:131], v146 offset:4608
  v_mfma_f32_16x16x32_bf16 v[220:223], v[92:95], v[76:79], v[220:223]
  ds_read_b64_tr_b16 v[132:133], v147 offset:4096
  v_mfma_f32_16x16x32_bf16 v[216:219], v[92:95], v[72:75], v[216:219]
  ds_read_b64_tr_b16 v[134:135], v147 offset:4608
  v_mfma_f32_16x16x32_bf16 v[212:215], v[92:95], v[68:71], v[212:215]
  ds_read_b64_tr_b16 v[136:137], v146 offset:8192
  v_mfma_f32_16x16x32_bf16 v[208:211], v[92:95], v[64:67], v[208:211]
  ds_read_b64_tr_b16 v[138:139], v146 offset:8704
  v_mfma_f32_16x16x32_bf16 v[224:227], v[64:67], v[96:99], v[224:227]
  ds_read_b64_tr_b16 v[140:141], v147 offset:8192
  v_mfma_f32_16x16x32_bf16 v[228:231], v[68:71], v[96:99], v[228:231]
  ds_read_b64_tr_b16 v[142:143], v147 offset:8704
  v_mfma_f32_16x16x32_bf16 v[232:235], v[72:75], v[96:99], v[232:235]
  ds_read_b32 v151, v150
  s_add_u32 s30, s30, 12288
  v_mfma_f32_16x16x32_bf16 v[236:239], v[76:79], v[96:99], v[236:239]
  s_mov_b64 exec, 1
  buffer_load_dword off, s[64:67], s31 lds
  s_mov_b64 exec, -1
  s_cmp_eq_u32 s30, 86016
  v_mfma_f32_16x16x32_bf16 v[252:255], v[76:79], v[100:103], v[252:255]
  s_cselect_b32 s30, 0, s30
  s_add_u32 s31, s31, 4
  v_mfma_f32_16x16x32_bf16 v[248:251], v[72:75], v[100:103], v[248:251]
  v_add_u32 v146, s30, v148
  s_add_u32 s33, s33, 1
  v_mfma_f32_16x16x32_bf16 v[244:247], v[68:71], v[100:103], v[244:247]
  v_add_u32 v147, s30, v149
  v_mfma_f32_16x16x32_bf16 v[240:243], v[64:67], v[100:103], v[240:243]
.g2_kernel_q_s1:
  s_waitcnt lgkmcnt(0)
  v_mfma_f32_16x16x32_bf16 v[160:163], v[120:123], v[104:107], v[160:163]
  v_cmp_lt_i32 vcc, s33, v151
  v_mfma_f32_16x16x32_bf16 v[164:167], v[120:123], v[108:111], v[164:167]
  s_cbranch_vccz .g2_kernel_q_w1
.g2_kernel_q_back1:
  v_mfma_f32_16x16x32_bf16 v[168:171], v[120:123], v[112:115], v[168:171]
  ds_read_b64_tr_b16 v[80:81], v146 offset:0
  v_mfma_f32_16x16x32_bf16 v[172:175], v[120:123], v[116:119], v[172:175]
  ds_read_b64_tr_b16 v[82:83], v146 offset:512
  v_mfma_f32_16x16x32_bf16 v[188:191], v[124:127], v[116:119], v[188:191]
  ds_read_b128 v[64:67], v144 offset:16384
  v_mfma_f32_16x16x32_bf16 v[184:187], v[124:127], v[112:115], v[184:187]
  ds_read_b128 v[68:71], v144 offset:18432
  v_mfma_f32_16x16x32_bf16 v[180:183], v[124:127], v[108:111], v[180:183]
  ds_read_b128 v[72:75], v144 offset:20480
  v_mfma_f32_16x16x32_bf16 v[176:179], v[124:127], v[104:107], v[176:179]
  ds_read_b128 v[76:79], v144 offset:22528
  v_mfma_f32_16x16x32_bf16 v[192:195], v[128:131], v[104:107], v[192:195]
  ds_read_b64_tr_b16 v[84:85], v147 offset:0
  v_mfma_f32_16x16x32_bf16 v[196:199], v[128:131], v[108:111], v[196:199]
  ds_read_b64_tr_b16 v[86:87], v147 offset:512
  v_mfma_f32_16x16x32_bf16 v[200:203], v[128:131], v[112:115], v[200:203]
  ds_read_b64_tr_b16 v[88:89], v146 offset:4096
  v_mfma_f32_16x16x32_bf16 v[204:207], v[128:131], v[116:119], v[204:207]
  ds_read_b64_tr_b16 v[90:91], v146 offset:4608
  v_mfma_f32_16x16x32_bf16 v[220:223], v[132:135], v[116:119], v[220:223]
  ds_read_b64_tr_b16 v[92:93], v147 offset:4096
  v_mfma_f32_16x16x32_bf16 v[216:219], v[132:135], v[112:115], v[216:219]
  ds_read_b64_tr_b16 v[94:95], v147 offset:4608
  v_mfma_f32_16x16x32_bf16 v[212:215], v[132:135], v[108:111], v[212:215]
  ds_read_b64_tr_b16 v[96:97], v146 offset:8192
  v_mfma_f32_16x16x32_bf16 v[208:211], v[132:135], v[104:107], v[208:211]
  ds_read_b64_tr_b16 v[98:99], v146 offset:8704
  v_mfma_f32_16x16x32_bf16 v[224:227], v[104:107], v[136:139], v[224:227]
  ds_read_b64_tr_b16 v[100:101], v147 offset:8192
  v_mfma_f32_16x16x32_bf16 v[228:231], v[108:111], v[136:139], v[228:231]
  ds_read_b64_tr_b16 v[102:103], v147 offset:8704
  v_mfma_f32_16x16x32_bf16 v[232:235], v[112:115], v[136:139], v[232:235]
  ds_read_b32 v151, v150
  s_add_u32 s30, s30, 12288
  v_mfma_f32_16x16x32_bf16 v[236:239], v[116:119], v[136:139], v[236:239]
  s_mov_b64 exec, 1
  buffer_load_dword off, s[64:67], s31 lds
  s_mov_b64 exec, -1
  s_cmp_eq_u32 s30, 86016
  v_mfma_f32_16x16x32_bf16 v[252:255], v[116:119], v[140:143], v[252:255]
  s_cselect_b32 s30, 0, s30
  s_add_u32 s31, s31, 4
  v_mfma_f32_16x16x32_bf16 v[248:251], v[112:115], v[140:143], v[248:251]
  v_add_u32 v146, s30, v148
  s_add_u32 s33, s33, 1
  v_mfma_f32_16x16x32_bf16 v[244:247], v[108:111], v[140:143], v[244:247]
  v_add_u32 v147, s30, v149
  v_mfma_f32_16x16x32_bf16 v[240:243], v[104:107], v[140:143], v[240:243]
  s_waitcnt lgkmcnt(0)
  v_mfma_f32_16x16x32_bf16 v[160:163], v[80:83], v[64:67], v[160:163]
  v_cmp_lt_i32 vcc, s33, v151
  v_mfma_f32_16x16x32_bf16 v[164:167], v[80:83], v[68:71], v[164:167]
  s_cbranch_vccz .g2_kernel_q_w2
.g2_kernel_q_back2:
  v_mfma_f32_16x16x32_bf16 v[168:171], v[80:83], v[72:75], v[168:171]
  ds_read_b64_tr_b16 v[120:121], v146 offset:0
  v_mfma_f32_16x16x32_bf16 v[172:175], v[80:83], v[76:79], v[172:175]
  ds_read_b64_tr_b16 v[122:123], v146 offset:512
  v_mfma_f32_16x16x32_bf16 v[188:191], v[84:87], v[76:79], v[188:191]
  ds_read_b128 v[104:107], v145 offset:16384
  v_mfma_f32_16x16x32_bf16 v[184:187], v[84:87], v[72:75], v[184:187]
  ds_read_b128 v[108:111], v145 offset:18432
  v_mfma_f32_16x16x32_bf16 v[180:183], v[84:87], v[68:71], v[180:183]
  ds_read_b128 v[112:115], v145 offset:20480
  v_mfma_f32_16x16x32_bf16 v[176:179], v[84:87], v[64:67], v[176:179]
  ds_read_b128 v[116:119], v145 offset:22528
  v_mfma_f32_16x16x32_bf16 v[192:195], v[88:91], v[64:67], v[192:195]
  ds_read_b64_tr_b16 v[124:125], v147 offset:0
  v_mfma_f32_16x16x32_bf16 v[196:199], v[88:91], v[68:71], v[196:199]
  ds_read_b64_tr_b16 v[126:127], v147 offset:512
  v_mfma_f32_16x16x32_bf16 v[200:203], v[88:91], v[72:75], v[200:203]
  ds_read_b64_tr_b16 v[128:129], v146 offset:4096
  v_mfma_f32_16x16x32_bf16 v[204:207], v[88:91], v[76:79], v[204:207]
  ds_read_b64_tr_b16 v[130:131], v146 offset:4608
  v_mfma_f32_16x16x32_bf16 v[220:223], v[92:95], v[76:79], v[220:223]
  ds_read_b64_tr_b16 v[132:133], v147 offset:4096
  v_mfma_f32_16x16x32_bf16 v[216:219], v[92:95], v[72:75], v[216:219]
  ds_read_b64_tr_b16 v[134:135], v147 offset:4608
  v_mfma_f32_16x16x32_bf16 v[212:215], v[92:95], v[68:71], v[212:215]
  ds_read_b64_tr_b16 v[136:137], v146 offset:8192
  v_mfma_f32_16x16x32_bf16 v[208:211], v[92:95], v[64:67], v[208:211]
  ds_read_b64_tr_b16 v[138:139], v146 offset:8704
  v_mfma_f32_16x16x32_bf16 v[224:227], v[64:67], v[96:99], v[224:227]
  ds_read_b64_tr_b16 v[140:141], v147 offset:8192
  v_mfma_f32_16x16x32_bf16 v[228:231], v[68:71], v[96:99], v[228:231]
  ds_read_b64_tr_b16 v[142:143], v147 offset:8704
  v_mfma_f32_16x16x32_bf16 v[232:235], v[72:75], v[96:99], v[232:235]
  ds_read_b32 v151, v150
  s_add_u32 s30, s30, 12288
  v_mfma_f32_16x16x32_bf16 v[236:239], v[76:79], v[96:99], v[236:239]
  s_mov_b64 exec, 1
  buffer_load_dword off, s[64:67], s31 lds
  s_mov_b64 exec, -1
  s_cmp_eq_u32 s30, 86016
  v_mfma_f32_16x16x32_bf16 v[252:255], v[76:79], v[100:103], v[252:255]
  s_cselect_b32 s30, 0, s30
  s_add_u32 s31, s31, 4
  v_mfma_f32_16x16x32_bf16 v[248:251], v[72:75], v[100:103], v[248:251]
  v_add_u32 v146, s30, v148
  s_add_u32 s33, s33, 1
  v_mfma_f32_16x16x32_bf16 v[244:247], v[68:71], v[100:103], v[244:247]
  v_add_u32 v147, s30, v149
  v_mfma_f32_16x16x32_bf16 v[240:243], v[64:67], v[100:103], v[240:243]
  s_waitcnt lgkmcnt(0)
  v_mfma_f32_16x16x32_bf16 v[160:163], v[120:123], v[104:107], v[160:163]
  v_cmp_lt_i32 vcc, s33, v151
  v_mfma_f32_16x16x32_bf16 v[164:167], v[120:123], v[108:111], v[164:167]
  s_cbranch_vccz .g2_kernel_q_w3
.g2_kernel_q_back3:
  v_mfma_f32_16x16x32_bf16 v[168:171], v[120:123], v[112:115], v[168:171]
  ds_read_b64_tr_b16 v[80:81], v146 offset:0
  v_mfma_f32_16x16x32_bf16 v[172:175], v[120:123], v[116:119], v[172:175]
  ds_read_b64_tr_b16 v[82:83], v146 offset:512
  v_mfma_f32_16x16x32_bf16 v[188:191], v[124:127], v[116:119], v[188:191]
  ds_read_b128 v[64:67], v144 offset:32768
  v_mfma_f32_16x16x32_bf16 v[184:187], v[124:127], v[112:115], v[184:187]
  ds_read_b128 v[68:71], v144 offset:34816
  v_mfma_f32_16x16x32_bf16 v[180:183], v[124:127], v[108:111], v[180:183]
  ds_read_b128 v[72:75], v144 offset:36864
  v_mfma_f32_16x16x32_bf16 v[176:179], v[124:127], v[104:107], v[176:179]
  ds_read_b128 v[76:79], v144 offset:38912
  v_mfma_f32_16x16x32_bf16 v[192:195], v[128:131], v[104:107], v[192:195]
  ds_read_b64_tr_b16 v[84:85], v147 offset:0
  v_mfma_f32_16x16x32_bf16 v[196:199], v[128:131], v[108:111], v[196:199]
  ds_read_b64_tr_b16 v[86:87], v147 offset:512
  v_mfma_f32_16x16x32_bf16 v[200:203], v[128:131], v[112:115], v[200:203]
  ds_read_b64_tr_b16 v[88:89], v146 offset:4096
  v_mfma_f32_16x16x32_bf16 v[204:207], v[128:131], v[116:119], v[204:207]
  ds_read_b64_tr_b16 v[90:91], v146 offset:4608
  v_mfma_f32_16x16x32_bf16 v[220:223], v[132:135], v[116:119], v[220:223]
  ds_read_b64_tr_b16 v[92:93], v147 offset:4096
  v_mfma_f32_16x16x32_bf16 v[216:219], v[132:135], v[112:115], v[216:219]
  ds_read_b64_tr_b16 v[94:95], v147 offset:4608
  v_mfma_f32_16x16x32_bf16 v[212:215], v[132:135], v[108:111], v[212:215]
  ds_read_b64_tr_b16 v[96:97], v146 offset:8192
  v_mfma_f32_16x16x32_bf16 v[208:211], v[132:135], v[104:107], v[208:211]
  ds_read_b64_tr_b16 v[98:99], v146 offset:8704
  v_mfma_f32_16x16x32_bf16 v[224:227], v[104:107], v[136:139], v[224:227]
  ds_read_b64_tr_b16 v[100:101], v147 offset:8192
  v_mfma_f32_16x16x32_bf16 v[228:231], v[108:111], v[136:139], v[228:231]
  ds_read_b64_tr_b16 v[102:103], v147 offset:8704
  v_mfma_f32_16x16x32_bf16 v[232:235], v[112:115], v[136:139], v[232:235]
  ds_read_b32 v151, v150
  s_add_u32 s30, s30, 12288
  v_mfma_f32_16x16x32_bf16 v[236:239], v[116:119], v[136:139], v[236:239]
  s_mov_b64 exec, 1
  buffer_load_dword off, s[64:67], s31 lds
  s_mov_b64 exec, -1
  s_cmp_eq_u32 s30, 86016
  v_mfma_f32_16x16x32_bf16 v[252:255], v[116:119], v[140:143], v[252:255]
  s_cselect_b32 s30, 0, s30
  s_add_u32 s31, s31, 4
  v_mfma_f32_16x16x32_bf16 v[248:251], v[112:115], v[140:143], v[248:251]
  v_add_u32 v146, s30, v148
  s_add_u32 s33, s33, 1
  v_mfma_f32_16x16x32_bf16 v[244:247], v[108:111], v[140:143], v[244:247]
  v_add_u32 v147, s30, v149
  v_mfma_f32_16x16x32_bf16 v[240:243], v[104:107], v[140:143], v[240:243]
  s_waitcnt lgkmcnt(0)
  v_mfma_f32_16x16x32_bf16 v[160:163], v[80:83], v[64:67], v[160:163]
  v_cmp_lt_i32 vcc, s33, v151
  v_mfma_f32_16x16x32_bf16 v[164:167], v[80:83], v[68:71], v[164:167]
  s_cbranch_vccz .g2_kernel_q_w4
.g2_kernel_q_back4:
  v_mfma_f32_16x16x32_bf16 v[168:171], v[80:83], v[72:75], v[168:171]
  ds_read_b64_tr_b16 v[120:121], v146 offset:0
  v_mfma_f32_16x16x32_bf16 v[172:175], v[80:83], v[76:79], v[172:175]
  ds_read_b64_tr_b16 v[122:123], v146 offset:512
  v_mfma_f32_16x16x32_bf16 v[188:191], v[84:87], v[76:79], v[188:191]
  ds_read_b128 v[104:107], v145 offset:32768
  v_mfma_f32_16x16x32_bf16 v[184:187], v[84:87], v[72:75], v[184:187]
  ds_read_b128 v[108:111], v145 offset:34816
  v_mfma_f32_16x16x32_bf16 v[180:183], v[84:87], v[68:71], v[180:183]
  ds_read_b128 v[112:115], v145 offset:36864
  v_mfma_f32_16x16x32_bf16 v[176:179], v[84:87], v[64:67], v[176:179]
  ds_read_b128 v[116:119], v145 offset:38912
  v_mfma_f32_16x16x32_bf16 v[192:195], v[88:91], v[64:67], v[192:195]
  ds_read_b64_tr_b16 v[124:125], v147 offset:0
  v_mfma_f32_16x16x32_bf16 v[196:199], v[88:91], v[68:71], v[196:199]
  ds_read_b64_tr_b16 v[126:127], v147 offset:512
  v_mfma_f32_16x16x32_bf16 v[200:203], v[88:91], v[72:75], v[200:203]
  ds_read_b64_tr_b16 v[128:129], v146 offset:4096
  v_mfma_f32_16x16x32_bf16 v[204:207], v[88:91], v[76:79], v[204:207]
  ds_read_b64_tr_b16 v[130:131], v146 offset:4608
  v_mfma_f32_16x16x32_bf16 v[220:223], v[92:95], v[76:79], v[220:223]
  ds_read_b64_tr_b16 v[132:133], v147 offset:4096
  v_mfma_f32_16x16x32_bf16 v[216:219], v[92:95], v[72:75], v[216:219]
  ds_read_b64_tr_b16 v[134:135], v147 offset:4608
  v_mfma_f32_16x16x32_bf16 v[212:215], v[92:95], v[68:71], v[212:215]
  ds_read_b64_tr_b16 v[136:137], v146 offset:8192
  v_mfma_f32_16x16x32_bf16 v[208:211], v[92:95], v[64:67], v[208:211]
  ds_read_b64_tr_b16 v[138:139], v146 offset:8704
  v_mfma_f32_16x16x32_bf16 v[224:227], v[64:67], v[96:99], v[224:227]
  ds_read_b64_tr_b16 v[140:141], v147 offset:8192
  v_mfma_f32_16x16x32_bf16 v[228:231], v[68:71], v[96:99], v[228:231]
  ds_read_b64_tr_b16 v[142:143], v147 offset:8704
  v_mfma_f32_16x16x32_bf16 v[232:235], v[72:75], v[96:99], v[232:235]
  ds_read_b32 v151, v150
  s_add_u32 s30, s30, 12288
  v_mfma_f32_16x16x32_bf16 v[236:239], v[76:79], v[96:99], v[236:239]
  s_mov_b64 exec, 1
  buffer_load_dword off, s[64:67], s31 lds
  s_mov_b64 exec, -1
  s_cmp_eq_u32 s30, 86016
  v_mfma_f32_16x16x32_bf16 v[252:255], v[76:79], v[100:103], v[252:255]
  s_cselect_b32 s30, 0, s30
  s_add_u32 s31, s31, 4
  v_mfma_f32_16x16x32_bf16 v[248:251], v[72:75], v[100:103], v[248:251]
  v_add_u32 v146, s30, v148
  s_add_u32 s33, s33, 1
  v_mfma_f32_16x16x32_bf16 v[244:247], v[68:71], v[100:103], v[244:247]
  v_add_u32 v147, s30, v149
  v_mfma_f32_16x16x32_bf16 v[240:243], v[64:67], v[100:103], v[240:243]
  s_waitcnt lgkmcnt(0)
  v_mfma_f32_16x16x32_bf16 v[160:163], v[120:123], v[104:107], v[160:163]
  v_cmp_lt_i32 vcc, s33, v151
  v_mfma_f32_16x16x32_bf16 v[164:167], v[120:123], v[108:111], v[164:167]
  s_cbranch_vccz .g2_kernel_q_w5
.g2_kernel_q_back5:
  v_mfma_f32_16x16x32_bf16 v[168:171], v[120:123], v[112:115], v[168:171]
  ds_read_b64_tr_b16 v[80:81], v146 offset:0
  v_mfma_f32_16x16x32_bf16 v[172:175], v[120:123], v[116:119], v[172:175]
  ds_read_b64_tr_b16 v[82:83], v146 offset:512
  v_mfma_f32_16x16x32_bf16 v[188:191], v[124:127], v[116:119], v[188:191]
  ds_read_b128 v[64:67], v144 offset:49152
  v_mfma_f32_16x16x32_bf16 v[184:187], v[124:127], v[112:115], v[184:187]
  ds_read_b128 v[68:71], v144 offset:51200
  v_mfma_f32_16x16x32_bf16 v[180:183], v[124:127], v[108:111], v[180:183]
  ds_read_b128 v[72:75], v144 offset:53248
  v_mfma_f32_16x16x32_bf16 v[176:179], v[124:127], v[104:107], v[176:179]
  ds_read_b128 v[76:79], v144 offset:55296
  v_mfma_f32_16x16x32_bf16 v[192:195], v[128:131], v[104:107], v[192:195]
  ds_read_b64_tr_b16 v[84:85], v147 offset:0
  v_mfma_f32_16x16x32_bf16 v[196:199], v[128:131], v[108:111], v[196:199]
  ds_read_b64_tr_b16 v[86:87], v147 offset:512
  v_mfma_f32_16x16x32_bf16 v[200:203], v[128:131], v[112:115], v[200:203]
  ds_read_b64_tr_b16 v[88:89], v146 offset:4096
  v_mfma_f32_16x16x32_bf16 v[204:207], v[128:131], v[116:119], v[204:207]
  ds_read_b64_tr_b16 v[90:91], v146 offset:4608
  v_mfma_f32_16x16x32_bf16 v[220:223], v[132:135], v[116:119], v[220:223]
  ds_read_b64_tr_b16 v[92:93], v147 offset:4096
  v_mfma_f32_16x16x32_bf16 v[216:219], v[132:135], v[112:115], v[216:219]
  ds_read_b64_tr_b16 v[94:95], v147 offset:4608
  v_mfma_f32_16x16x32_bf16 v[212:215], v[132:135], v[108:111], v[212:215]
  ds_read_b64_tr_b16 v[96:97], v146 offset:8192
  v_mfma_f32_16x16x32_bf16 v[208:211], v[132:135], v[104:107], v[208:211]
  ds_read_b64_tr_b16 v[98:99], v146 offset:8704
  v_mfma_f32_16x16x32_bf16 v[224:227], v[104:107], v[136:139], v[224:227]
  ds_read_b64_tr_b16 v[100:101], v147 offset:8192
  v_mfma_f32_16x16x32_bf16 v[228:231], v[108:111], v[136:139], v[228:231]
  ds_read_b64_tr_b16 v[102:103], v147 offset:8704
  v_mfma_f32_16x16x32_bf16 v[232:235], v[112:115], v[136:139], v[232:235]
  ds_read_b32 v151, v150
  s_add_u32 s30, s30, 12288
  v_mfma_f32_16x16x32_bf16 v[236:239], v[116:119], v[136:139], v[236:239]
  s_mov_b64 exec, 1
  buffer_load_dword off, s[64:67], s31 lds
  s_mov_b64 exec, -1
  s_cmp_eq_u32 s30, 86016
  v_mfma_f32_16x16x32_bf16 v[252:255], v[116:119], v[140:143], v[252:255]
  s_cselect_b32 s30, 0, s30
  s_add_u32 s31, s31, 4
  v_mfma_f32_16x16x32_bf16 v[248:251], v[112:115], v[140:143], v[248:251]
  v_add_u32 v146, s30, v148
  s_add_u32 s33, s33, 1
  v_mfma_f32_16x16x32_bf16 v[244:247], v[108:111], v[140:143], v[244:247]
  v_add_u32 v147, s30, v149
  v_mfma_f32_16x16x32_bf16 v[240:243], v[104:107], v[140:143], v[240:243]
  s_cmp_eq_u32 s29, 3
  s_cbranch_scc1 .g2_kernel_q_out
  s_waitcnt lgkmcnt(0)
  v_mfma_f32_16x16x32_bf16 v[160:163], v[80:83], v[64:67], v[160:163]
  v_cmp_lt_i32 vcc, s33, v151
  v_mfma_f32_16x16x32_bf16 v[164:167], v[80:83], v[68:71], v[164:167]
  s_cbranch_vccz .g2_kernel_q_w6
.g2_kernel_q_back6:
  v_mfma_f32_16x16x32_bf16 v[168:171], v[80:83], v[72:75], v[168:171]
  ds_read_b64_tr_b16 v[120:121], v146 offset:0
  v_mfma_f32_16x16x32_bf16 v[172:175], v[80:83], v[76:79], v[172:175]
  ds_read_b64_tr_b16 v[122:123], v146 offset:512
  v_mfma_f32_16x16x32_bf16 v[188:191], v[84:87], v[76:79], v[188:191]
  ds_read_b128 v[104:107], v145 offset:49152
  v_mfma_f32_16x16x32_bf16 v[184:187], v[84:87], v[72:75], v[184:187]
  ds_read_b128 v[108:111], v145 offset:51200
  v_mfma_f32_16x16x32_bf16 v[180:183], v[84:87], v[68:71], v[180:183]
  ds_read_b128 v[112:115], v145 offset:53248
  v_mfma_f32_16x16x32_bf16 v[176:179], v[84:87], v[64:67], v[176:179]
  ds_read_b128 v[116:119], v145 offset:55296
  v_mfma_f32_16x16x32_bf16 v[192:195], v[88:91], v[64:67], v[192:195]
  ds_read_b64_tr_b16 v[124:125], v147 offset:0
  v_mfma_f32_16x16x32_bf16 v[196:199], v[88:91], v[68:71], v[196:199]
  ds_read_b64_tr_b16 v[126:127], v147 offset:512
  v_mfma_f32_16x16x32_bf16 v[200:203], v[88:91], v[72:75], v[200:203]
  ds_read_b64_tr_b16 v[128:129], v146 offset:4096
  v_mfma_f32_16x16x32_bf16 v[204:207], v[88:91], v[76:79], v[204:207]
  ds_read_b64_tr_b16 v[130:131], v146 offset:4608
  v_mfma_f32_16x16x32_bf16 v[220:223], v[92:95], v[76:79], v[220:223]
  ds_read_b64_tr_b16 v[132:133], v147 offset:4096
  v_mfma_f32_16x16x32_bf16 v[216:219], v[92:95], v[72:75], v[216:219]
  ds_read_b64_tr_b16 v[134:135], v147 offset:4608
  v_mfma_f32_16x16x32_bf16 v[212:215], v[92:95], v[68:71], v[212:215]
  ds_read_b64_tr_b16 v[136:137], v146 offset:8192
  v_mfma_f32_16x16x32_bf16 v[208:211], v[92:95], v[64:67], v[208:211]
  ds_read_b64_tr_b16 v[138:139], v146 offset:8704
  v_mfma_f32_16x16x32_bf16 v[224:227], v[64:67], v[96:99], v[224:227]
  ds_read_b64_tr_b16 v[140:141], v147 offset:8192
  v_mfma_f32_16x16x32_bf16 v[228:231], v[68:71], v[96:99], v[228:231]
  ds_read_b64_tr_b16 v[142:143], v147 offset:8704
  v_mfma_f32_16x16x32_bf16 v[232:235], v[72:75], v[96:99], v[232:235]
  ds_read_b32 v151, v150
  s_add_u32 s30, s30, 12288
  v_mfma_f32_16x16x32_bf16 v[236:239], v[76:79], v[96:99], v[236:239]
  s_mov_b64 exec, 1
  buffer_load_dword off, s[64:67], s31 lds
  s_mov_b64 exec, -1
  s_cmp_eq_u32 s30, 86016
  v_mfma_f32_16x16x32_bf16 v[252:255], v[76:79], v[100:103], v[252:255]
  s_cselect_b32 s30, 0, s30
  s_add_u32 s31, s31, 4
  v_mfma_f32_16x16x32_bf16 v[248:251], v[72:75], v[100:103], v[248:251]
  v_add_u32 v146, s30, v148
  s_add_u32 s33, s33, 1
  v_mfma_f32_16x16x32_bf16 v[244:247], v[68:71], v[100:103], v[244:247]
  v_add_u32 v147, s30, v149
  s_add_u32 s29, s29, 1
  v_mfma_f32_16x16x32_bf16 v[240:243], v[64:67], v[100:103], v[240:243]
  s_branch .g2_kernel_q_loop
.g2_kernel_q_out:
  s_add_u32 s33, s33, 0
  s_waitcnt lgkmcnt(0)
  v_cmp_lt_i32 vcc, s33, v151
  s_cbranch_vccz .g2_kernel_q_wl
.g2_kernel_q_bl:
  s_cmp_lg_u32 s10, 0
  s_cbranch_scc1 .g2_kernel_q_v1
  v_mfma_f32_16x16x32_bf16 v[192:195], v[88:91], v[64:67], v[192:195]
  ds_read_b64_tr_b16 v[80:81], v148 offset:40960
  ds_read_b64_tr_b16 v[82:83], v148 offset:41472
  ds_read_b128 v[128:131], v145 offset:49152
  v_mfma_f32_16x16x32_bf16 v[196:199], v[88:91], v[68:71], v[196:199]
  ds_read_b128 v[132:135], v145 offset:51200
  ds_read_b128 v[136:139], v145 offset:53248
  ds_read_b128 v[140:143], v145 offset:55296
  v_mfma_f32_16x16x32_bf16 v[200:203], v[88:91], v[72:75], v[200:203]
  ds_read_b64_tr_b16 v[84:85], v149 offset:40960
  ds_read_b64_tr_b16 v[86:87], v149 offset:41472
  ds_read_b32 v63, v13 offset:0
  v_mfma_f32_16x16x32_bf16 v[204:207], v[88:91], v[76:79], v[204:207]
  ds_read_b32 v57, v13 offset:24
  ds_read_b128 v[40:43], v52 offset:5120
  ds_read_b128 v[44:47], v52 offset:5184
  v_mfma_f32_16x16x32_bf16 v[220:223], v[92:95], v[76:79], v[220:223]
  ds_read_b32 v24, v50 offset:2816
  ds_read_b32 v25, v50 offset:3328
  ds_read_b32 v26, v50 offset:2880
  v_mfma_f32_16x16x32_bf16 v[216:219], v[92:95], v[72:75], v[216:219]
  ds_read_b32 v27, v50 offset:3392
  ds_read_b32 v28, v50 offset:2944
  ds_read_b32 v29, v50 offset:3456
  v_mfma_f32_16x16x32_bf16 v[212:215], v[92:95], v[68:71], v[212:215]
  ds_read_b32 v30, v50 offset:3008
  ds_read_b32 v31, v50 offset:3520
  v_mfma_f32_16x16x32_bf16 v[208:211], v[92:95], v[64:67], v[208:211]
  s_waitcnt lgkmcnt(12)
  v_mfma_f32_16x16x32_bf16 v[192:195], v[80:83], v[128:131], v[192:195]
  v_mfma_f32_16x16x32_bf16 v[196:199], v[80:83], v[132:135], v[196:199]
  v_mfma_f32_16x16x32_bf16 v[200:203], v[80:83], v[136:139], v[200:203]
  v_mfma_f32_16x16x32_bf16 v[204:207], v[80:83], v[140:143], v[204:207]
  v_mfma_f32_16x16x32_bf16 v[220:223], v[84:87], v[140:143], v[220:223]
  v_mfma_f32_16x16x32_bf16 v[216:219], v[84:87], v[136:139], v[216:219]
  v_mfma_f32_16x16x32_bf16 v[212:215], v[84:87], v[132:135], v[212:215]
  v_mfma_f32_16x16x32_bf16 v[208:211], v[84:87], v[128:131], v[208:211]
  s_waitcnt lgkmcnt(0)
  v_cmp_gt_u32 vcc, 2, v63
  s_cbranch_vccnz .g2_kernel_q_v0ew
.g2_kernel_q_v0eb:
  ds_read_b64_tr_b16 v[120:121], v148 offset:24576
  ds_read_b64_tr_b16 v[122:123], v148 offset:25088
  ds_read_b128 v[104:107], v144 offset:49152
  ds_read_b128 v[108:111], v144 offset:51200
  ds_read_b128 v[112:115], v144 offset:53248
  ds_read_b128 v[116:119], v144 offset:55296
  ds_read_b64_tr_b16 v[124:125], v149 offset:24576
  ds_read_b64_tr_b16 v[126:127], v149 offset:25088
  ds_read_b64_tr_b16 v[128:129], v148 offset:32768
  ds_read_b64_tr_b16 v[130:131], v148 offset:33280
  ds_read_b64_tr_b16 v[132:133], v149 offset:32768
  ds_read_b64_tr_b16 v[134:135], v149 offset:33280
  v_cmp_ne_u32 vcc, 0, v57
  s_cbranch_vccnz .g2_kernel_q_v0p
.g2_kernel_q_v0pb:
  v_pk_mul_f32 v[152:153], v[40:41], v[24:25] op_sel:[0,1] op_sel_hi:[1,1]
  v_pk_mul_f32 v[154:155], v[42:43], v[24:25] op_sel:[0,1] op_sel_hi:[1,1]
  v_pk_mul_f32 v[156:157], v[44:45], v[24:25] op_sel:[0,1] op_sel_hi:[1,1]
  v_pk_mul_f32 v[158:159], v[46:47], v[24:25] op_sel:[0,1] op_sel_hi:[1,1]
  v_pk_fma_f32 v[192:193], v[192:193], v[24:25], v[152:153] op_sel_hi:[1,0,1]
  v_pk_fma_f32 v[194:195], v[194:195], v[24:25], v[154:155] op_sel_hi:[1,0,1]
  v_pk_fma_f32 v[208:209], v[208:209], v[24:25], v[156:157] op_sel_hi:[1,0,1]
  v_pk_fma_f32 v[210:211], v[210:211], v[24:25], v[158:159] op_sel_hi:[1,0,1]
  v_cvt_pk_bf16_f32 v192, v192, v193
  v_cvt_pk_bf16_f32 v193, v194, v195
  v_cvt_pk_bf16_f32 v194, v208, v209
  v_cvt_pk_bf16_f32 v195, v210, v211
  buffer_store_dwordx4 v[192:195], v54, s[4:7], s8 offen offset:0 sc1
  v_pk_mul_f32 v[152:153], v[40:41], v[26:27] op_sel:[0,1] op_sel_hi:[1,1]
  v_pk_mul_f32 v[154:155], v[42:43], v[26:27] op_sel:[0,1] op_sel_hi:[1,1]
  v_pk_mul_f32 v[156:157], v[44:45], v[26:27] op_sel:[0,1] op_sel_hi:[1,1]
  v_pk_mul_f32 v[158:159], v[46:47], v[26:27] op_sel:[0,1] op_sel_hi:[1,1]
  v_pk_fma_f32 v[196:197], v[196:197], v[26:27], v[152:153] op_sel_hi:[1,0,1]
  v_pk_fma_f32 v[198:199], v[198:199], v[26:27], v[154:155] op_sel_hi:[1,0,1]
  v_pk_fma_f32 v[212:213], v[212:213], v[26:27], v[156:157] op_sel_hi:[1,0,1]
  v_pk_fma_f32 v[214:215], v[214:215], v[26:27], v[158:159] op_sel_hi:[1,0,1]
  v_cvt_pk_bf16_f32 v196, v196, v197
  v_cvt_pk_bf16_f32 v197, v198, v199
  v_cvt_pk_bf16_f32 v198, v212, v213
  v_cvt_pk_bf16_f32 v199, v214, v215
  buffer_store_dwordx4 v[196:199], v54, s[4:7], s8 offen offset:128 sc1
  v_pk_mul_f32 v[152:153], v[40:41], v[28:29] op_sel:[0,1] op_sel_hi:[1,1]
  v_pk_mul_f32 v[154:155], v[42:43], v[28:29] op_sel:[0,1] op_sel_hi:[1,1]
  v_pk_mul_f32 v[156:157], v[44:45], v[28:29] op_sel:[0,1] op_sel_hi:[1,1]
  v_pk_mul_f32 v[158:159], v[46:47], v[28:29] op_sel:[0,1] op_sel_hi:[1,1]
  v_pk_fma_f32 v[200:201], v[200:201], v[28:29], v[152:153] op_sel_hi:[1,0,1]
  v_pk_fma_f32 v[202:203], v[202:203], v[28:29], v[154:155] op_sel_hi:[1,0,1]
  v_pk_fma_f32 v[216:217], v[216:217], v[28:29], v[156:157] op_sel_hi:[1,0,1]
  v_pk_fma_f32 v[218:219], v[218:219], v[28:29], v[158:159] op_sel_hi:[1,0,1]
  v_cvt_pk_bf16_f32 v200, v200, v201
  v_cvt_pk_bf16_f32 v201, v202, v203
  v_cvt_pk_bf16_f32 v202, v216, v217
  v_cvt_pk_bf16_f32 v203, v218, v219
  buffer_store_dwordx4 v[200:203], v54, s[4:7], s9 offen offset:0 sc1
  v_pk_mul_f32 v[152:153], v[40:41], v[30:31] op_sel:[0,1] op_sel_hi:[1,1]
  v_pk_mul_f32 v[154:155], v[42:43], v[30:31] op_sel:[0,1] op_sel_hi:[1,1]
  v_pk_mul_f32 v[156:157], v[44:45], v[30:31] op_sel:[0,1] op_sel_hi:[1,1]
  v_pk_mul_f32 v[158:159], v[46:47], v[30:31] op_sel:[0,1] op_sel_hi:[1,1]
  v_pk_fma_f32 v[204:205], v[204:205], v[30:31], v[152:153] op_sel_hi:[1,0,1]
  v_pk_fma_f32 v[206:207], v[206:207], v[30:31], v[154:155] op_sel_hi:[1,0,1]
  v_pk_fma_f32 v[220:221], v[220:221], v[30:31], v[156:157] op_sel_hi:[1,0,1]
  v_pk_fma_f32 v[222:223], v[222:223], v[30:31], v[158:159] op_sel_hi:[1,0,1]
  v_cvt_pk_bf16_f32 v204, v204, v205
  v_cvt_pk_bf16_f32 v205, v206, v207
  v_cvt_pk_bf16_f32 v206, v220, v221
  v_cvt_pk_bf16_f32 v207, v222, v223
  buffer_store_dwordx4 v[204:207], v54, s[4:7], s9 offen offset:128 sc1
  s_waitcnt lgkmcnt(0)
  v_mfma_f32_16x16x32_bf16 v[160:163], v[120:123], v[104:107], v[160:163]
  ds_read_b64_tr_b16 v[80:81], v148 offset:36864
  ds_read_b64_tr_b16 v[82:83], v148 offset:37376
  v_mfma_f32_16x16x32_bf16 v[164:167], v[120:123], v[108:111], v[164:167]
  ds_read_b128 v[64:67], v145 offset:49152
  ds_read_b128 v[68:71], v145 offset:51200
  v_mfma_f32_16x16x32_bf16 v[168:171], v[120:123], v[112:115], v[168:171]
  ds_read_b128 v[72:75], v145 offset:53248
  ds_read_b128 v[76:79], v145 offset:55296
  v_mfma_f32_16x16x32_bf16 v[172:175], v[120:123], v[116:119], v[172:175]
  ds_read_b64_tr_b16 v[84:85], v149 offset:36864
  ds_read_b64_tr_b16 v[86:87], v149 offset:37376
  v_mfma_f32_16x16x32_bf16 v[188:191], v[124:127], v[116:119], v[188:191]
  ds_read_b64_tr_b16 v[88:89], v148 offset:45056
  ds_read_b64_tr_b16 v[90:91], v148 offset:45568
  v_mfma_f32_16x16x32_bf16 v[184:187], v[124:127], v[112:115], v[184:187]
  ds_read_b64_tr_b16 v[92:93], v149 offset:45056
  ds_read_b64_tr_b16 v[94:95], v149 offset:45568
  v_mfma_f32_16x16x32_bf16 v[180:183], v[124:127], v[108:111], v[180:183]
  v_mfma_f32_16x16x32_bf16 v[176:179], v[124:127], v[104:107], v[176:179]
  v_mfma_f32_16x16x32_bf16 v[224:227], v[104:107], v[128:131], v[224:227]
  v_mfma_f32_16x16x32_bf16 v[228:231], v[108:111], v[128:131], v[228:231]
  v_mfma_f32_16x16x32_bf16 v[232:235], v[112:115], v[128:131], v[232:235]
  v_mfma_f32_16x16x32_bf16 v[236:239], v[116:119], v[128:131], v[236:239]
  v_mfma_f32_16x16x32_bf16 v[252:255], v[116:119], v[132:135], v[252:255]
  v_mfma_f32_16x16x32_bf16 v[248:251], v[112:115], v[132:135], v[248:251]
  v_mfma_f32_16x16x32_bf16 v[244:247], v[108:111], v[132:135], v[244:247]
  v_mfma_f32_16x16x32_bf16 v[240:243], v[104:107], v[132:135], v[240:243]
  s_waitcnt lgkmcnt(0)
  v_mfma_f32_16x16x32_bf16 v[160:163], v[80:83], v[64:67], v[160:163]
  ds_read_b32 v63, v58
  ds_read_b128 v[32:35], v52 offset:4864
  v_mfma_f32_16x16x32_bf16 v[164:167], v[80:83], v[68:71], v[164:167]
  ds_read_b128 v[36:39], v52 offset:4928
  ds_read_b128 v[104:107], v51 offset:2816
  v_mfma_f32_16x16x32_bf16 v[168:171], v[80:83], v[72:75], v[168:171]
  ds_read_b128 v[120:123], v51 offset:3328
  ds_read_b128 v[108:111], v51 offset:2880
  v_mfma_f32_16x16x32_bf16 v[172:175], v[80:83], v[76:79], v[172:175]
  ds_read_b128 v[124:127], v51 offset:3392
  ds_read_b128 v[112:115], v51 offset:2944
  v_mfma_f32_16x16x32_bf16 v[188:191], v[84:87], v[76:79], v[188:191]
  ds_read_b128 v[128:131], v51 offset:3456
  ds_read_b128 v[116:119], v51 offset:3008
  v_mfma_f32_16x16x32_bf16 v[184:187], v[84:87], v[72:75], v[184:187]
  ds_read_b128 v[132:135], v51 offset:3520
  ds_read_b32 v48, v53 offset:5376
  v_mfma_f32_16x16x32_bf16 v[180:183], v[84:87], v[68:71], v[180:183]
  ds_read_b32 v49, v53 offset:5440
  v_mfma_f32_16x16x32_bf16 v[176:179], v[84:87], v[64:67], v[176:179]
  v_mfma_f32_16x16x32_bf16 v[224:227], v[64:67], v[88:91], v[224:227]
  v_mfma_f32_16x16x32_bf16 v[228:231], v[68:71], v[88:91], v[228:231]
  v_mfma_f32_16x16x32_bf16 v[232:235], v[72:75], v[88:91], v[232:235]
  v_mfma_f32_16x16x32_bf16 v[236:239], v[76:79], v[88:91], v[236:239]
  v_mfma_f32_16x16x32_bf16 v[252:255], v[76:79], v[92:95], v[252:255]
  v_mfma_f32_16x16x32_bf16 v[248:251], v[72:75], v[92:95], v[248:251]
  v_mfma_f32_16x16x32_bf16 v[244:247], v[68:71], v[92:95], v[244:247]
  v_mfma_f32_16x16x32_bf16 v[240:243], v[64:67], v[92:95], v[240:243]
  s_waitcnt lgkmcnt(0)
  v_cmp_gt_u32 vcc, s12, v63
  s_cbranch_vccnz .g2_kernel_q_v0fw
.g2_kernel_q_v0fc:
  s_cmp_ge_u32 s35, 0x200
  s_cbranch_scc1 .g2_kernel_q_v0r
.g2_kernel_q_v0rb:
  v_pk_mul_f32 v[24:25], v[24:25], v[56:57] op_sel_hi:[1,0]
  v_pk_mul_f32 v[26:27], v[26:27], v[56:57] op_sel_hi:[1,0]
  v_pk_mul_f32 v[28:29], v[28:29], v[56:57] op_sel_hi:[1,0]
  v_pk_mul_f32 v[30:31], v[30:31], v[56:57] op_sel_hi:[1,0]
  ds_write_b128 v59, v[192:195] offset:0
  v_pk_mul_f32 v[152:153], v[32:33], v[24:25] op_sel:[0,1] op_sel_hi:[1,1]
  v_pk_mul_f32 v[154:155], v[34:35], v[24:25] op_sel:[0,1] op_sel_hi:[1,1]
  v_pk_mul_f32 v[156:157], v[36:37], v[24:25] op_sel:[0,1] op_sel_hi:[1,1]
  v_pk_mul_f32 v[158:159], v[38:39], v[24:25] op_sel:[0,1] op_sel_hi:[1,1]
  v_pk_fma_f32 v[160:161], v[160:161], v[24:25], v[152:153] op_sel_hi:[1,0,1]
  v_pk_fma_f32 v[162:163], v[162:163], v[24:25], v[154:155] op_sel_hi:[1,0,1]
  v_pk_fma_f32 v[176:177], v[176:177], v[24:25], v[156:157] op_sel_hi:[1,0,1]
  v_pk_fma_f32 v[178:179], v[178:179], v[24:25], v[158:159] op_sel_hi:[1,0,1]
  v_cvt_pk_bf16_f32 v160, v160, v161
  v_cvt_pk_bf16_f32 v161, v162, v163
  v_cvt_pk_bf16_f32 v162, v176, v177
  v_cvt_pk_bf16_f32 v163, v178, v179
  ds_write_b128 v61, v[160:163] offset:0
  ds_write_b128 v59, v[196:199] offset:128
  v_pk_mul_f32 v[152:153], v[32:33], v[26:27] op_sel:[0,1] op_sel_hi:[1,1]
  v_pk_mul_f32 v[154:155], v[34:35], v[26:27] op_sel:[0,1] op_sel_hi:[1,1]
  v_pk_mul_f32 v[156:157], v[36:37], v[26:27] op_sel:[0,1] op_sel_hi:[1,1]
  v_pk_mul_f32 v[158:159], v[38:39], v[26:27] op_sel:[0,1] op_sel_hi:[1,1]
  v_pk_fma_f32 v[164:165], v[164:165], v[26:27], v[152:153] op_sel_hi:[1,0,1]
  v_pk_fma_f32 v[166:167], v[166:167], v[26:27], v[154:155] op_sel_hi:[1,0,1]
  v_pk_fma_f32 v[180:181], v[180:181], v[26:27], v[156:157] op_sel_hi:[1,0,1]
  v_pk_fma_f32 v[182:183], v[182:183], v[26:27], v[158:159] op_sel_hi:[1,0,1]
  v_cvt_pk_bf16_f32 v164, v164, v165
  v_cvt_pk_bf16_f32 v165, v166, v167
  v_cvt_pk_bf16_f32 v166, v180, v181
  v_cvt_pk_bf16_f32 v167, v182, v183
  ds_write_b128 v61, v[164:167] offset:256
  ds_write_b128 v59, v[200:203] offset:4096
  v_pk_mul_f32 v[152:153], v[32:33], v[28:29] op_sel:[0,1] op_sel_hi:[1,1]
  v_pk_mul_f32 v[154:155], v[34:35], v[28:29] op_sel:[0,1] op_sel_hi:[1,1]
  v_pk_mul_f32 v[156:157], v[36:37], v[28:29] op_sel:[0,1] op_sel_hi:[1,1]
  v_pk_mul_f32 v[158:159], v[38:39], v[28:29] op_sel:[0,1] op_sel_hi:[1,1]
  v_pk_fma_f32 v[168:169], v[168:169], v[28:29], v[152:153] op_sel_hi:[1,0,1]
  v_pk_fma_f32 v[170:171], v[170:171], v[28:29], v[154:155] op_sel_hi:[1,0,1]
  v_pk_fma_f32 v[184:185], v[184:185], v[28:29], v[156:157] op_sel_hi:[1,0,1]
  v_pk_fma_f32 v[186:187], v[186:187], v[28:29], v[158:159] op_sel_hi:[1,0,1]
  v_cvt_pk_bf16_f32 v168, v168, v169
  v_cvt_pk_bf16_f32 v169, v170, v171
  v_cvt_pk_bf16_f32 v170, v184, v185
  v_cvt_pk_bf16_f32 v171, v186, v187
  ds_write_b128 v61, v[168:171] offset:2048
  s_waitcnt vmcnt(0)
  s_mov_b64 exec, 1
  ds_add_rtn_u32 v7, v62, v5 offset:120
  s_mov_b64 exec, -1
  ds_write_b128 v59, v[204:207] offset:4224
  v_pk_mul_f32 v[152:153], v[32:33], v[30:31] op_sel:[0,1] op_sel_hi:[1,1]
  v_pk_mul_f32 v[154:155], v[34:35], v[30:31] op_sel:[0,1] op_sel_hi:[1,1]
  v_pk_mul_f32 v[156:157], v[36:37], v[30:31] op_sel:[0,1] op_sel_hi:[1,1]
  v_pk_mul_f32 v[158:159], v[38:39], v[30:31] op_sel:[0,1] op_sel_hi:[1,1]
  v_pk_fma_f32 v[172:173], v[172:173], v[30:31], v[152:153] op_sel_hi:[1,0,1]
  v_pk_fma_f32 v[174:175], v[174:175], v[30:31], v[154:155] op_sel_hi:[1,0,1]
  v_pk_fma_f32 v[188:189], v[188:189], v[30:31], v[156:157] op_sel_hi:[1,0,1]
  v_pk_fma_f32 v[190:191], v[190:191], v[30:31], v[158:159] op_sel_hi:[1,0,1]
  v_cvt_pk_bf16_f32 v172, v172, v173
  v_cvt_pk_bf16_f32 v173, v174, v175
  v_cvt_pk_bf16_f32 v174, v188, v189
  v_cvt_pk_bf16_f32 v175, v190, v191
  s_waitcnt lgkmcnt(1)
  v_readfirstlane_b32 s28, v7
  s_cmp_eq_u32 s28, 1
  s_cbranch_scc1 .g2_kernel_q_v0f
.g2_kernel_q_v0fb:
  ds_write_b128 v61, v[172:175] offset:2304
  v_pk_mul_f32 v[152:153], v[120:121], v[48:49] op_sel:[0,0] op_sel_hi:[1,0]
  v_pk_mul_f32 v[154:155], v[122:123], v[48:49] op_sel:[0,0] op_sel_hi:[1,0]
  v_pk_mul_f32 v[156:157], v[124:125], v[48:49] op_sel:[0,0] op_sel_hi:[1,0]
  v_pk_mul_f32 v[158:159], v[126:127], v[48:49] op_sel:[0,0] op_sel_hi:[1,0]
  v_pk_fma_f32 v[224:225], v[224:225], v[104:105], v[152:153]
  v_pk_fma_f32 v[226:227], v[226:227], v[106:107], v[154:155]
  v_pk_fma_f32 v[228:229], v[228:229], v[108:109], v[156:157]
  v_pk_fma_f32 v[230:231], v[230:231], v[110:111], v[158:159]
  v_cvt_pk_bf16_f32 v224, v224, v225
  v_cvt_pk_bf16_f32 v225, v226, v227
  v_cvt_pk_bf16_f32 v226, v228, v229
  v_cvt_pk_bf16_f32 v227, v230, v231
  ds_write_b128 v60, v[224:227] offset:2048
  v_pk_mul_f32 v[152:153], v[120:121], v[48:49] op_sel:[0,1] op_sel_hi:[1,1]
  v_pk_mul_f32 v[154:155], v[122:123], v[48:49] op_sel:[0,1] op_sel_hi:[1,1]
  v_pk_mul_f32 v[156:157], v[124:125], v[48:49] op_sel:[0,1] op_sel_hi:[1,1]
  v_pk_mul_f32 v[158:159], v[126:127], v[48:49] op_sel:[0,1] op_sel_hi:[1,1]
  v_pk_fma_f32 v[240:241], v[240:241], v[104:105], v[152:153]
  v_pk_fma_f32 v[242:243], v[242:243], v[106:107], v[154:155]
  v_pk_fma_f32 v[244:245], v[244:245], v[108:109], v[156:157]
  v_pk_fma_f32 v[246:247], v[246:247], v[110:111], v[158:159]
  v_cvt_pk_bf16_f32 v240, v240, v241
  v_cvt_pk_bf16_f32 v241, v242, v243
  v_cvt_pk_bf16_f32 v242, v244, v245
  v_cvt_pk_bf16_f32 v243, v246, v247
  ds_write_b128 v60, v[240:243] offset:2304
  v_pk_mul_f32 v[152:153], v[128:129], v[48:49] op_sel:[0,0] op_sel_hi:[1,0]
  v_pk_mul_f32 v[154:155], v[130:131], v[48:49] op_sel:[0,0] op_sel_hi:[1,0]
  v_pk_mul_f32 v[156:157], v[132:133], v[48:49] op_sel:[0,0] op_sel_hi:[1,0]
  v_pk_mul_f32 v[158:159], v[134:135], v[48:49] op_sel:[0,0] op_sel_hi:[1,0]
  v_pk_fma_f32 v[232:233], v[232:233], v[112:113], v[152:153]
  v_pk_fma_f32 v[234:235], v[234:235], v[114:115], v[154:155]
  v_pk_fma_f32 v[236:237], v[236:237], v[116:117], v[156:157]
  v_pk_fma_f32 v[238:239], v[238:239], v[118:119], v[158:159]
  v_cvt_pk_bf16_f32 v232, v232, v233
  v_cvt_pk_bf16_f32 v233, v234, v235
  v_cvt_pk_bf16_f32 v234, v236, v237
  v_cvt_pk_bf16_f32 v235, v238, v239
  ds_write_b128 v60, v[232:235] offset:6144
  v_pk_mul_f32 v[152:153], v[128:129], v[48:49] op_sel:[0,1] op_sel_hi:[1,1]
  v_pk_mul_f32 v[154:155], v[130:131], v[48:49] op_sel:[0,1] op_sel_hi:[1,1]
  v_pk_mul_f32 v[156:157], v[132:133], v[48:49] op_sel:[0,1] op_sel_hi:[1,1]
  v_pk_mul_f32 v[158:159], v[134:135], v[48:49] op_sel:[0,1] op_sel_hi:[1,1]
  v_pk_fma_f32 v[248:249], v[248:249], v[112:113], v[152:153]
  v_pk_fma_f32 v[250:251], v[250:251], v[114:115], v[154:155]
  v_pk_fma_f32 v[252:253], v[252:253], v[116:117], v[156:157]
  v_pk_fma_f32 v[254:255], v[254:255], v[118:119], v[158:159]
  v_cvt_pk_bf16_f32 v248, v248, v249
  v_cvt_pk_bf16_f32 v249, v250, v251
  v_cvt_pk_bf16_f32 v250, v252, v253
  v_cvt_pk_bf16_f32 v251, v254, v255
  ds_write_b128 v60, v[248:251] offset:6400
.g2_kernel_q_kd:
  s_mov_b64 exec, 1
  ds_add_u32 v13, v5 offset:4
  s_mov_b64 exec, -1
  v_mov_b32 v120, 0
  v_mov_b32 v121, 0
  v_mov_b32 v124, 0
  v_mov_b32 v125, 0
  v_mov_b32 v128, 0
  v_mov_b32 v129, 0
  v_mov_b32 v132, 0
  v_mov_b32 v133, 0
  s_cmp_lg_u32 s62, 0
  s_cbranch_scc1 .g2_kernel_r2
  global_load_dwordx4 v[240:243], v23, s[74:75] offset:0
  global_load_dwordx4 v[244:247], v23, s[74:75] offset:32
  global_load_dwordx4 v[248:251], v23, s[74:75] offset:64
  global_load_dwordx4 v[252:255], v23, s[74:75] offset:96
.g2_kernel_r3:
  v_mov_b32 v6, s71
  s_mov_b32 s38, 0
.g2_kernel_wg4:
  ds_read_b32 v7, v6 offset:4
  s_add_u32 s38, s38, 1
  s_waitcnt lgkmcnt(0)
  v_cmp_gt_u32 vcc, 4, v7
  s_cbranch_vccz .g2_kernel_wg4d
  s_cmp_lt_u32 s38, 524288
  s_cbranch_scc1 .g2_kernel_wg4
.g2_kernel_wg4d:
  ds_read_b128 v[176:179], v9 offset:0
  ds_read_b128 v[180:183], v9 offset:1024
  ds_read_b128 v[24:27], v14 offset:8192
  ds_read_b128 v[28:31], v14 offset:9216
  ds_read_b128 v[184:187], v9 offset:2048
  ds_read_b128 v[188:191], v9 offset:3072
  ds_read_b128 v[32:35], v14 offset:10240
  ds_read_b128 v[36:39], v14 offset:11264
  ds_read_b128 v[40:43], v14 offset:12288
  ds_read_b128 v[44:47], v14 offset:13312
  ds_read_b128 v[48:51], v14 offset:14336
  ds_read_b128 v[52:55], v14 offset:15360
  s_cmp_lg_u32 s35, 0
  s_cbranch_scc1 .g2_kernel_a_own
  s_waitcnt lgkmcnt(8)
.g2_kernel_a_ob:
  v_mfma_f32_32x32x16_bf16 v[136:151], v[176:179], v[24:27], 0
  v_mfma_f32_32x32x16_bf16 v[136:151], v[180:183], v[28:31], v[136:151]
  s_waitcnt lgkmcnt(0)
  s_nop 7
  v_mfma_f32_32x32x16_bf16 v[152:167], v[176:179], v[32:35], 0
  ds_read_b32 v7, v8
  s_nop 0
  v_exp_f32 v136, v136
  v_exp_f32 v137, v137
  v_exp_f32 v138, v138
  v_exp_f32 v139, v139
  v_exp_f32 v140, v140
  v_exp_f32 v141, v141
  v_exp_f32 v142, v142
  v_exp_f32 v143, v143
  v_mfma_f32_32x32x16_bf16 v[152:167], v[180:183], v[36:39], v[152:167]
  s_mov_b64 exec, 1
  ds_add_u32 v13, v5 offset:8
  s_mov_b64 exec, -1
  s_waitcnt lgkmcnt(0)
  v_cmp_lt_u32 vcc, s62, v7
  v_cvt_pk_bf16_f32 v168, v136, v137
  v_cvt_pk_bf16_f32 v169, v138, v139
  v_cvt_pk_bf16_f32 v170, v140, v141
  v_cvt_pk_bf16_f32 v171, v142, v143
  v_exp_f32 v144, v144
  v_exp_f32 v145, v145
  v_exp_f32 v146, v146
  v_exp_f32 v147, v147
  v_mfma_f32_32x32x16_bf16 v[56:71], v[184:187], v[168:171], 0
  s_mov_b32 s36, vcc_lo
  s_andn2_b32 s33, s36, s34
  v_exp_f32 v148, v148
  v_exp_f32 v149, v149
  v_exp_f32 v150, v150
  v_exp_f32 v151, v151
  v_cvt_pk_bf16_f32 v172, v144, v145
  v_cvt_pk_bf16_f32 v173, v146, v147
  v_cvt_pk_bf16_f32 v174, v148, v149
  v_cvt_pk_bf16_f32 v175, v150, v151
  v_mfma_f32_32x32x16_bf16 v[136:151], v[176:179], v[40:43], 0
  v_exp_f32 v152, v152
  v_exp_f32 v153, v153
  v_exp_f32 v154, v154
  v_mfma_f32_32x32x16_bf16 v[56:71], v[188:191], v[172:175], v[56:71]
  s_bcnt1_i32_b32 s33, s33
  s_sub_u32 s33, s33, s39
  s_cmp_lt_i32 s33, 3
  v_exp_f32 v155, v155
  v_exp_f32 v156, v156
  v_exp_f32 v157, v157
  v_smfmac_f32_16x16x64_bf16 v[120:123], v[16:19], v[168:175], v20
  s_cbranch_scc1 .g2_kernel_a_F0n0
  s_mov_b32 s39, 64
  s_call_b64 s[72:73], .g2_kernel_a_three
.g2_kernel_a_F0n0:
  v_exp_f32 v158, v158
  v_exp_f32 v159, v159
  v_mfma_f32_32x32x16_bf16 v[136:151], v[180:183], v[44:47], v[136:151]
  v_cvt_pk_bf16_f32 v168, v152, v153
  v_cvt_pk_bf16_f32 v169, v154, v155
  v_cvt_pk_bf16_f32 v170, v156, v157
  v_cvt_pk_bf16_f32 v171, v158, v159
  v_exp_f32 v160, v160
  v_exp_f32 v161, v161
  v_exp_f32 v162, v162
  v_exp_f32 v163, v163
  v_mfma_f32_32x32x16_bf16 v[72:87], v[184:187], v[168:171], 0
  v_exp_f32 v164, v164
  v_exp_f32 v165, v165
  v_exp_f32 v166, v166
  v_exp_f32 v167, v167
  v_cvt_pk_bf16_f32 v172, v160, v161
  v_cvt_pk_bf16_f32 v173, v162, v163
  v_cvt_pk_bf16_f32 v174, v164, v165
  v_cvt_pk_bf16_f32 v175, v166, v167
  v_mfma_f32_32x32x16_bf16 v[152:167], v[176:179], v[48:51], 0
  ds_read_b32 v7, v8
  v_exp_f32 v136, v136
  v_exp_f32 v137, v137
  v_exp_f32 v138, v138
  v_mfma_f32_32x32x16_bf16 v[72:87], v[188:191], v[172:175], v[72:87]
  s_lshl_b32 s28, s16, 11
  v_exp_f32 v139, v139
  v_exp_f32 v140, v140
  v_exp_f32 v141, v141
  v_smfmac_f32_16x16x64_bf16 v[124:127], v[16:19], v[168:175], v20
  v_add_u32 v9, s28, v3
  v_exp_f32 v142, v142
  v_exp_f32 v143, v143
  v_mfma_f32_32x32x16_bf16 v[152:167], v[180:183], v[52:55], v[152:167]
  s_waitcnt lgkmcnt(0)
  v_cmp_lt_u32 vcc, s62, v7
  v_cvt_pk_bf16_f32 v168, v136, v137
  v_cvt_pk_bf16_f32 v169, v138, v139
  v_cvt_pk_bf16_f32 v170, v140, v141
  v_cvt_pk_bf16_f32 v171, v142, v143
  v_exp_f32 v144, v144
  v_exp_f32 v145, v145
  v_exp_f32 v146, v146
  v_exp_f32 v147, v147
  v_mfma_f32_32x32x16_bf16 v[88:103], v[184:187], v[168:171], 0
  s_mov_b32 s36, vcc_lo
  s_andn2_b32 s33, s36, s34
  v_exp_f32 v148, v148
  v_exp_f32 v149, v149
  v_exp_f32 v150, v150
  v_exp_f32 v151, v151
  v_cvt_pk_bf16_f32 v172, v144, v145
  v_cvt_pk_bf16_f32 v173, v146, v147
  v_cvt_pk_bf16_f32 v174, v148, v149
  v_cvt_pk_bf16_f32 v175, v150, v151
  v_exp_f32 v152, v152
  v_exp_f32 v153, v153
  v_exp_f32 v154, v154
  v_mfma_f32_32x32x16_bf16 v[88:103], v[188:191], v[172:175], v[88:103]
  s_bcnt1_i32_b32 s33, s33
  s_sub_u32 s33, s33, s39
  s_cmp_lt_i32 s33, 3
  v_exp_f32 v155, v155
  v_exp_f32 v156, v156
  v_exp_f32 v157, v157
  v_smfmac_f32_16x16x64_bf16 v[128:131], v[16:19], v[168:175], v20
  s_cbranch_scc1 .g2_kernel_a_F0n2
  s_mov_b32 s39, 64
  s_call_b64 s[72:73], .g2_kernel_a_three
.g2_kernel_a_F0n2:
  v_exp_f32 v158, v158
  v_exp_f32 v159, v159
  v_cvt_pk_bf16_f32 v168, v152, v153
  v_cvt_pk_bf16_f32 v169, v154, v155
  v_cvt_pk_bf16_f32 v170, v156, v157
  v_cvt_pk_bf16_f32 v171, v158, v159
  v_exp_f32 v160, v160
  v_exp_f32 v161, v161
  v_exp_f32 v162, v162
  v_exp_f32 v163, v163
  v_mfma_f32_32x32x16_bf16 v[104:119], v[184:187], v[168:171], 0
  v_exp_f32 v164, v164
  v_exp_f32 v165, v165
  v_exp_f32 v166, v166
  v_exp_f32 v167, v167
  v_cvt_pk_bf16_f32 v172, v160, v161
  v_cvt_pk_bf16_f32 v173, v162, v163
  v_cvt_pk_bf16_f32 v174, v164, v165
  v_cvt_pk_bf16_f32 v175, v166, v167
  s_add_u32 s39, s39, s35
  s_cmp_ge_u32 s39, 3
  s_cbranch_scc1 .g2_kernel_a_p1
  s_call_b64 s[72:73], .g2_kernel_a_three
.g2_kernel_a_p1:
  s_waitcnt vmcnt(10)
  v_mfma_f32_32x32x16_bf16 v[136:151], v[192:195], v[24:27], 0
  v_mfma_f32_32x32x16_bf16 v[136:151], v[196:199], v[28:31], v[136:151]
  s_waitcnt vmcnt(8)
  s_mov_b32 s32, 0
  s_nop 8
  s_branch .g2_kernel_a_n1
  .p2align 6
.g2_kernel_a_loop:
  v_mfma_f32_32x32x16_bf16 v[152:167], v[176:179], v[32:35], 0
  s_andn2_b32 s33, s36, s34
  v_exp_f32 v136, v136
  v_exp_f32 v137, v137
  v_exp_f32 v138, v138
  v_mfma_f32_32x32x16_bf16 v[104:119], v[236:239], v[172:175], v[104:119]
  s_cbranch_scc0 .g2_kernel_a_N0c
.g2_kernel_a_N0b:
  v_exp_f32 v139, v139
  v_exp_f32 v140, v140
  v_exp_f32 v141, v141
  v_smfmac_f32_16x16x64_bf16 v[132:135], v[16:19], v[168:175], v20
  s_ff1_i32_b32 s33, s33
  v_exp_f32 v142, v142
  v_exp_f32 v143, v143
  v_mfma_f32_32x32x16_bf16 v[152:167], v[180:183], v[36:39], v[152:167]
  s_bitset1_b32 s34, s33
  v_cvt_pk_bf16_f32 v168, v136, v137
  v_cvt_pk_bf16_f32 v169, v138, v139
  v_cvt_pk_bf16_f32 v170, v140, v141
  v_cvt_pk_bf16_f32 v171, v142, v143
  v_exp_f32 v144, v144
  v_exp_f32 v145, v145
  v_exp_f32 v146, v146
  v_exp_f32 v147, v147
  v_mfma_f32_32x32x16_bf16 v[56:71], v[184:187], v[168:171], v[56:71]
  s_xor_b32 s33, s33, s24
  v_exp_f32 v148, v148
  v_exp_f32 v149, v149
  v_exp_f32 v150, v150
  v_exp_f32 v151, v151
  v_cvt_pk_bf16_f32 v172, v144, v145
  v_cvt_pk_bf16_f32 v173, v146, v147
  v_cvt_pk_bf16_f32 v174, v148, v149
  v_cvt_pk_bf16_f32 v175, v150, v151
  v_mfma_f32_32x32x16_bf16 v[136:151], v[176:179], v[40:43], 0
  s_lshl_b32 s33, s33, s25
  v_exp_f32 v152, v152
  v_exp_f32 v153, v153
  v_exp_f32 v154, v154
  v_mfma_f32_32x32x16_bf16 v[56:71], v[188:191], v[172:175], v[56:71]
  s_add_u32 s22, s20, s33
  v_exp_f32 v155, v155
  v_exp_f32 v156, v156
  v_exp_f32 v157, v157
  v_smfmac_f32_16x16x64_bf16 v[120:123], v[16:19], v[168:175], v20
  s_addc_u32 s23, s21, 0
  v_exp_f32 v158, v158
  v_exp_f32 v159, v159
  v_mfma_f32_32x32x16_bf16 v[136:151], v[180:183], v[44:47], v[136:151]
  v_cvt_pk_bf16_f32 v168, v152, v153
  v_cvt_pk_bf16_f32 v169, v154, v155
  v_cvt_pk_bf16_f32 v170, v156, v157
  v_cvt_pk_bf16_f32 v171, v158, v159
  v_exp_f32 v160, v160
  v_exp_f32 v161, v161
  v_exp_f32 v162, v162
  v_exp_f32 v163, v163
  v_mfma_f32_32x32x16_bf16 v[72:87], v[184:187], v[168:171], v[72:87]
  v_exp_f32 v164, v164
  v_exp_f32 v165, v165
  v_exp_f32 v166, v166
  v_exp_f32 v167, v167
  v_cvt_pk_bf16_f32 v172, v160, v161
  v_cvt_pk_bf16_f32 v173, v162, v163
  v_cvt_pk_bf16_f32 v174, v164, v165
  v_cvt_pk_bf16_f32 v175, v166, v167
  v_mfma_f32_32x32x16_bf16 v[152:167], v[176:179], v[48:51], 0
  ds_read_b32 v7, v8
  v_exp_f32 v136, v136
  v_exp_f32 v137, v137
  v_exp_f32 v138, v138
  v_mfma_f32_32x32x16_bf16 v[72:87], v[188:191], v[172:175], v[72:87]
  v_exp_f32 v139, v139
  v_exp_f32 v140, v140
  v_exp_f32 v141, v141
  v_smfmac_f32_16x16x64_bf16 v[124:127], v[16:19], v[168:175], v20
  global_load_dwordx4 v[224:227], v3, s[22:23] offset:0
  global_load_dwordx4 v[228:231], v3, s[22:23] offset:1024
  global_load_dwordx4 v[232:235], v3, s[22:23] offset:2048
  global_load_dwordx4 v[236:239], v3, s[22:23] offset:3072
  v_exp_f32 v142, v142
  v_exp_f32 v143, v143
  v_mfma_f32_32x32x16_bf16 v[152:167], v[180:183], v[52:55], v[152:167]
  v_cvt_pk_bf16_f32 v168, v136, v137
  v_cvt_pk_bf16_f32 v169, v138, v139
  v_cvt_pk_bf16_f32 v170, v140, v141
  v_cvt_pk_bf16_f32 v171, v142, v143
  v_exp_f32 v144, v144
  v_exp_f32 v145, v145
  v_exp_f32 v146, v146
  v_exp_f32 v147, v147
  v_mfma_f32_32x32x16_bf16 v[88:103], v[184:187], v[168:171], v[88:103]
  s_waitcnt vmcnt(8)
  v_exp_f32 v148, v148
  v_exp_f32 v149, v149
  v_exp_f32 v150, v150
  v_exp_f32 v151, v151
  v_cvt_pk_bf16_f32 v172, v144, v145
  v_cvt_pk_bf16_f32 v173, v146, v147
  v_cvt_pk_bf16_f32 v174, v148, v149
  v_cvt_pk_bf16_f32 v175, v150, v151
  v_mfma_f32_32x32x16_bf16 v[136:151], v[192:195], v[24:27], 0
  s_waitcnt lgkmcnt(0)
  v_cmp_lt_u32 vcc, s62, v7
  v_exp_f32 v152, v152
  v_exp_f32 v153, v153
  v_exp_f32 v154, v154
  v_mfma_f32_32x32x16_bf16 v[88:103], v[188:191], v[172:175], v[88:103]
  s_mov_b32 s36, vcc_lo
  v_exp_f32 v155, v155
  v_exp_f32 v156, v156
  v_exp_f32 v157, v157
  v_smfmac_f32_16x16x64_bf16 v[128:131], v[16:19], v[168:175], v20
  v_exp_f32 v158, v158
  v_exp_f32 v159, v159
  v_mfma_f32_32x32x16_bf16 v[136:151], v[196:199], v[28:31], v[136:151]
  v_cvt_pk_bf16_f32 v168, v152, v153
  v_cvt_pk_bf16_f32 v169, v154, v155
  v_cvt_pk_bf16_f32 v170, v156, v157
  v_cvt_pk_bf16_f32 v171, v158, v159
  v_exp_f32 v160, v160
  v_exp_f32 v161, v161
  v_exp_f32 v162, v162
  v_exp_f32 v163, v163
  v_mfma_f32_32x32x16_bf16 v[104:119], v[184:187], v[168:171], v[104:119]
  v_exp_f32 v164, v164
  v_exp_f32 v165, v165
  v_exp_f32 v166, v166
  v_exp_f32 v167, v167
  v_cvt_pk_bf16_f32 v172, v160, v161
  v_cvt_pk_bf16_f32 v173, v162, v163
  v_cvt_pk_bf16_f32 v174, v164, v165
  v_cvt_pk_bf16_f32 v175, v166, v167
.g2_kernel_a_n1:
  v_mfma_f32_32x32x16_bf16 v[152:167], v[192:195], v[32:35], 0
  s_andn2_b32 s33, s36, s34
  v_exp_f32 v136, v136
  v_exp_f32 v137, v137
  v_exp_f32 v138, v138
  v_mfma_f32_32x32x16_bf16 v[104:119], v[188:191], v[172:175], v[104:119]
  s_cbranch_scc0 .g2_kernel_a_N1c
.g2_kernel_a_N1b:
  v_exp_f32 v139, v139
  v_exp_f32 v140, v140
  v_exp_f32 v141, v141
  v_smfmac_f32_16x16x64_bf16 v[132:135], v[16:19], v[168:175], v20
  s_ff1_i32_b32 s33, s33
  v_exp_f32 v142, v142
  v_exp_f32 v143, v143
  v_mfma_f32_32x32x16_bf16 v[152:167], v[196:199], v[36:39], v[152:167]
  s_bitset1_b32 s34, s33
  v_cvt_pk_bf16_f32 v168, v136, v137
  v_cvt_pk_bf16_f32 v169, v138, v139
  v_cvt_pk_bf16_f32 v170, v140, v141
  v_cvt_pk_bf16_f32 v171, v142, v143
  v_exp_f32 v144, v144
  v_exp_f32 v145, v145
  v_exp_f32 v146, v146
  v_exp_f32 v147, v147
  v_mfma_f32_32x32x16_bf16 v[56:71], v[200:203], v[168:171], v[56:71]
  s_xor_b32 s33, s33, s24
  v_exp_f32 v148, v148
  v_exp_f32 v149, v149
  v_exp_f32 v150, v150
  v_exp_f32 v151, v151
  v_cvt_pk_bf16_f32 v172, v144, v145
  v_cvt_pk_bf16_f32 v173, v146, v147
  v_cvt_pk_bf16_f32 v174, v148, v149
  v_cvt_pk_bf16_f32 v175, v150, v151
  v_mfma_f32_32x32x16_bf16 v[136:151], v[192:195], v[40:43], 0
  s_lshl_b32 s33, s33, s25
  v_exp_f32 v152, v152
  v_exp_f32 v153, v153
  v_exp_f32 v154, v154
  v_mfma_f32_32x32x16_bf16 v[56:71], v[204:207], v[172:175], v[56:71]
  s_add_u32 s22, s20, s33
  v_exp_f32 v155, v155
  v_exp_f32 v156, v156
  v_exp_f32 v157, v157
  v_smfmac_f32_16x16x64_bf16 v[120:123], v[16:19], v[168:175], v20
  s_addc_u32 s23, s21, 0
  v_exp_f32 v158, v158
  v_exp_f32 v159, v159
  v_mfma_f32_32x32x16_bf16 v[136:151], v[196:199], v[44:47], v[136:151]
  v_cvt_pk_bf16_f32 v168, v152, v153
  v_cvt_pk_bf16_f32 v169, v154, v155
  v_cvt_pk_bf16_f32 v170, v156, v157
  v_cvt_pk_bf16_f32 v171, v158, v159
  v_exp_f32 v160, v160
  v_exp_f32 v161, v161
  v_exp_f32 v162, v162
  v_exp_f32 v163, v163
  v_mfma_f32_32x32x16_bf16 v[72:87], v[200:203], v[168:171], v[72:87]
  v_exp_f32 v164, v164
  v_exp_f32 v165, v165
  v_exp_f32 v166, v166
  v_exp_f32 v167, v167
  v_cvt_pk_bf16_f32 v172, v160, v161
  v_cvt_pk_bf16_f32 v173, v162, v163
  v_cvt_pk_bf16_f32 v174, v164, v165
  v_cvt_pk_bf16_f32 v175, v166, v167
  v_mfma_f32_32x32x16_bf16 v[152:167], v[192:195], v[48:51], 0
  v_exp_f32 v136, v136
  v_exp_f32 v137, v137
  v_exp_f32 v138, v138
  v_mfma_f32_32x32x16_bf16 v[72:87], v[204:207], v[172:175], v[72:87]
  v_exp_f32 v139, v139
  v_exp_f32 v140, v140
  v_exp_f32 v141, v141
  v_smfmac_f32_16x16x64_bf16 v[124:127], v[16:19], v[168:175], v20
  global_load_dwordx4 v[176:179], v3, s[22:23] offset:0
  global_load_dwordx4 v[180:183], v3, s[22:23] offset:1024
  global_load_dwordx4 v[184:187], v3, s[22:23] offset:2048
  global_load_dwordx4 v[188:191], v3, s[22:23] offset:3072
  v_exp_f32 v142, v142
  v_exp_f32 v143, v143
  v_mfma_f32_32x32x16_bf16 v[152:167], v[196:199], v[52:55], v[152:167]
  v_cvt_pk_bf16_f32 v168, v136, v137
  v_cvt_pk_bf16_f32 v169, v138, v139
  v_cvt_pk_bf16_f32 v170, v140, v141
  v_cvt_pk_bf16_f32 v171, v142, v143
  v_exp_f32 v144, v144
  v_exp_f32 v145, v145
  v_exp_f32 v146, v146
  v_exp_f32 v147, v147
  v_mfma_f32_32x32x16_bf16 v[88:103], v[200:203], v[168:171], v[88:103]
  s_waitcnt vmcnt(8)
  v_exp_f32 v148, v148
  v_exp_f32 v149, v149
  v_exp_f32 v150, v150
  v_exp_f32 v151, v151
  v_cvt_pk_bf16_f32 v172, v144, v145
  v_cvt_pk_bf16_f32 v173, v146, v147
  v_cvt_pk_bf16_f32 v174, v148, v149
  v_cvt_pk_bf16_f32 v175, v150, v151
  v_mfma_f32_32x32x16_bf16 v[136:151], v[208:211], v[24:27], 0
  v_exp_f32 v152, v152
  v_exp_f32 v153, v153
  v_exp_f32 v154, v154
  v_mfma_f32_32x32x16_bf16 v[88:103], v[204:207], v[172:175], v[88:103]
  v_exp_f32 v155, v155
  v_exp_f32 v156, v156
  v_exp_f32 v157, v157
  v_smfmac_f32_16x16x64_bf16 v[128:131], v[16:19], v[168:175], v20
  v_exp_f32 v158, v158
  v_exp_f32 v159, v159
  v_mfma_f32_32x32x16_bf16 v[136:151], v[212:215], v[28:31], v[136:151]
  v_cvt_pk_bf16_f32 v168, v152, v153
  v_cvt_pk_bf16_f32 v169, v154, v155
  v_cvt_pk_bf16_f32 v170, v156, v157
  v_cvt_pk_bf16_f32 v171, v158, v159
  v_exp_f32 v160, v160
  v_exp_f32 v161, v161
  v_exp_f32 v162, v162
  v_exp_f32 v163, v163
  v_mfma_f32_32x32x16_bf16 v[104:119], v[200:203], v[168:171], v[104:119]
  v_exp_f32 v164, v164
  v_exp_f32 v165, v165
  v_exp_f32 v166, v166
  v_exp_f32 v167, v167
  v_cvt_pk_bf16_f32 v172, v160, v161
  v_cvt_pk_bf16_f32 v173, v162, v163
  v_cvt_pk_bf16_f32 v174, v164, v165
  v_cvt_pk_bf16_f32 v175, v166, v167
  v_mfma_f32_32x32x16_bf16 v[152:167], v[208:211], v[32:35], 0
  s_andn2_b32 s33, s36, s34
  v_exp_f32 v136, v136
  v_exp_f32 v137, v137
  v_exp_f32 v138, v138
  v_mfma_f32_32x32x16_bf16 v[104:119], v[204:207], v[172:175], v[104:119]
  s_cbranch_scc0 .g2_kernel_a_N2c
.g2_kernel_a_N2b:
  v_exp_f32 v139, v139
  v_exp_f32 v140, v140
  v_exp_f32 v141, v141
  v_smfmac_f32_16x16x64_bf16 v[132:135], v[16:19], v[168:175], v20
  s_ff1_i32_b32 s33, s33
  v_exp_f32 v142, v142
  v_exp_f32 v143, v143
  v_mfma_f32_32x32x16_bf16 v[152:167], v[212:215], v[36:39], v[152:167]
  s_bitset1_b32 s34, s33
  v_cvt_pk_bf16_f32 v168, v136, v137
  v_cvt_pk_bf16_f32 v169, v138, v139
  v_cvt_pk_bf16_f32 v170, v140, v141
  v_cvt_pk_bf16_f32 v171, v142, v143
  v_exp_f32 v144, v144
  v_exp_f32 v145, v145
  v_exp_f32 v146, v146
  v_exp_f32 v147, v147
  v_mfma_f32_32x32x16_bf16 v[56:71], v[216:219], v[168:171], v[56:71]
  s_xor_b32 s33, s33, s24
  v_exp_f32 v148, v148
  v_exp_f32 v149, v149
  v_exp_f32 v150, v150
  v_exp_f32 v151, v151
  v_cvt_pk_bf16_f32 v172, v144, v145
  v_cvt_pk_bf16_f32 v173, v146, v147
  v_cvt_pk_bf16_f32 v174, v148, v149
  v_cvt_pk_bf16_f32 v175, v150, v151
  v_mfma_f32_32x32x16_bf16 v[136:151], v[208:211], v[40:43], 0
  s_lshl_b32 s33, s33, s25
  v_exp_f32 v152, v152
  v_exp_f32 v153, v153
  v_exp_f32 v154, v154
  v_mfma_f32_32x32x16_bf16 v[56:71], v[220:223], v[172:175], v[56:71]
  s_add_u32 s22, s20, s33
  v_exp_f32 v155, v155
  v_exp_f32 v156, v156
  v_exp_f32 v157, v157
  v_smfmac_f32_16x16x64_bf16 v[120:123], v[16:19], v[168:175], v20
  s_addc_u32 s23, s21, 0
  v_exp_f32 v158, v158
  v_exp_f32 v159, v159
  v_mfma_f32_32x32x16_bf16 v[136:151], v[212:215], v[44:47], v[136:151]
  v_cvt_pk_bf16_f32 v168, v152, v153
  v_cvt_pk_bf16_f32 v169, v154, v155
  v_cvt_pk_bf16_f32 v170, v156, v157
  v_cvt_pk_bf16_f32 v171, v158, v159
  v_exp_f32 v160, v160
  v_exp_f32 v161, v161
  v_exp_f32 v162, v162
  v_exp_f32 v163, v163
  v_mfma_f32_32x32x16_bf16 v[72:87], v[216:219], v[168:171], v[72:87]
  v_exp_f32 v164, v164
  v_exp_f32 v165, v165
  v_exp_f32 v166, v166
  v_exp_f32 v167, v167
  v_cvt_pk_bf16_f32 v172, v160, v161
  v_cvt_pk_bf16_f32 v173, v162, v163
  v_cvt_pk_bf16_f32 v174, v164, v165
  v_cvt_pk_bf16_f32 v175, v166, v167
  v_mfma_f32_32x32x16_bf16 v[152:167], v[208:211], v[48:51], 0
  v_exp_f32 v136, v136
  v_exp_f32 v137, v137
  v_exp_f32 v138, v138
  v_mfma_f32_32x32x16_bf16 v[72:87], v[220:223], v[172:175], v[72:87]
  v_exp_f32 v139, v139
  v_exp_f32 v140, v140
  v_exp_f32 v141, v141
  v_smfmac_f32_16x16x64_bf16 v[124:127], v[16:19], v[168:175], v20
  global_load_dwordx4 v[192:195], v3, s[22:23] offset:0
  global_load_dwordx4 v[196:199], v3, s[22:23] offset:1024
  global_load_dwordx4 v[200:203], v3, s[22:23] offset:2048
  global_load_dwordx4 v[204:207], v3, s[22:23] offset:3072
  v_exp_f32 v142, v142
  v_exp_f32 v143, v143
  v_mfma_f32_32x32x16_bf16 v[152:167], v[212:215], v[52:55], v[152:167]
  v_cvt_pk_bf16_f32 v168, v136, v137
  v_cvt_pk_bf16_f32 v169, v138, v139
  v_cvt_pk_bf16_f32 v170, v140, v141
  v_cvt_pk_bf16_f32 v171, v142, v143
  v_exp_f32 v144, v144
  v_exp_f32 v145, v145
  v_exp_f32 v146, v146
  v_exp_f32 v147, v147
  v_mfma_f32_32x32x16_bf16 v[88:103], v[216:219], v[168:171], v[88:103]
  s_waitcnt vmcnt(8)
  v_exp_f32 v148, v148
  v_exp_f32 v149, v149
  v_exp_f32 v150, v150
  v_exp_f32 v151, v151
  v_cvt_pk_bf16_f32 v172, v144, v145
  v_cvt_pk_bf16_f32 v173, v146, v147
  v_cvt_pk_bf16_f32 v174, v148, v149
  v_cvt_pk_bf16_f32 v175, v150, v151
  v_mfma_f32_32x32x16_bf16 v[136:151], v[224:227], v[24:27], 0
  v_exp_f32 v152, v152
  v_exp_f32 v153, v153
  v_exp_f32 v154, v154
  v_mfma_f32_32x32x16_bf16 v[88:103], v[220:223], v[172:175], v[88:103]
  v_exp_f32 v155, v155
  v_exp_f32 v156, v156
  v_exp_f32 v157, v157
  v_smfmac_f32_16x16x64_bf16 v[128:131], v[16:19], v[168:175], v20
  v_exp_f32 v158, v158
  v_exp_f32 v159, v159
  v_mfma_f32_32x32x16_bf16 v[136:151], v[228:231], v[28:31], v[136:151]
  s_and_b32 s28, s32, 3
  v_cvt_pk_bf16_f32 v168, v152, v153
  v_cvt_pk_bf16_f32 v169, v154, v155
  v_cvt_pk_bf16_f32 v170, v156, v157
  v_cvt_pk_bf16_f32 v171, v158, v159
  v_exp_f32 v160, v160
  v_exp_f32 v161, v161
  v_exp_f32 v162, v162
  v_exp_f32 v163, v163
  v_mfma_f32_32x32x16_bf16 v[104:119], v[216:219], v[168:171], v[104:119]
  s_cmp_eq_u32 s28, 3
  v_exp_f32 v164, v164
  v_exp_f32 v165, v165
  v_exp_f32 v166, v166
  v_exp_f32 v167, v167
  v_cvt_pk_bf16_f32 v172, v160, v161
  v_cvt_pk_bf16_f32 v173, v162, v163
  v_cvt_pk_bf16_f32 v174, v164, v165
  v_cvt_pk_bf16_f32 v175, v166, v167
  s_cbranch_scc1 .g2_kernel_a_last
  v_mfma_f32_32x32x16_bf16 v[152:167], v[224:227], v[32:35], 0
  s_andn2_b32 s33, s36, s34
  v_exp_f32 v136, v136
  v_exp_f32 v137, v137
  v_exp_f32 v138, v138
  v_mfma_f32_32x32x16_bf16 v[104:119], v[220:223], v[172:175], v[104:119]
  s_cbranch_scc0 .g2_kernel_a_N3c
.g2_kernel_a_N3b:
  v_exp_f32 v139, v139
  v_exp_f32 v140, v140
  v_exp_f32 v141, v141
  v_smfmac_f32_16x16x64_bf16 v[132:135], v[16:19], v[168:175], v20
  s_ff1_i32_b32 s33, s33
  v_exp_f32 v142, v142
  v_exp_f32 v143, v143
  v_mfma_f32_32x32x16_bf16 v[152:167], v[228:231], v[36:39], v[152:167]
  s_bitset1_b32 s34, s33
  v_cvt_pk_bf16_f32 v168, v136, v137
  v_cvt_pk_bf16_f32 v169, v138, v139
  v_cvt_pk_bf16_f32 v170, v140, v141
  v_cvt_pk_bf16_f32 v171, v142, v143
  v_exp_f32 v144, v144
  v_exp_f32 v145, v145
  v_exp_f32 v146, v146
  v_exp_f32 v147, v147
  v_mfma_f32_32x32x16_bf16 v[56:71], v[232:235], v[168:171], v[56:71]
  s_xor_b32 s33, s33, s24
  v_exp_f32 v148, v148
  v_exp_f32 v149, v149
  v_exp_f32 v150, v150
  v_exp_f32 v151, v151
  v_cvt_pk_bf16_f32 v172, v144, v145
  v_cvt_pk_bf16_f32 v173, v146, v147
  v_cvt_pk_bf16_f32 v174, v148, v149
  v_cvt_pk_bf16_f32 v175, v150, v151
  v_mfma_f32_32x32x16_bf16 v[136:151], v[224:227], v[40:43], 0
  s_lshl_b32 s33, s33, s25
  v_exp_f32 v152, v152
  v_exp_f32 v153, v153
  v_exp_f32 v154, v154
  v_mfma_f32_32x32x16_bf16 v[56:71], v[236:239], v[172:175], v[56:71]
  s_add_u32 s22, s20, s33
  v_exp_f32 v155, v155
  v_exp_f32 v156, v156
  v_exp_f32 v157, v157
  v_smfmac_f32_16x16x64_bf16 v[120:123], v[16:19], v[168:175], v20
  s_addc_u32 s23, s21, 0
  v_exp_f32 v158, v158
  v_exp_f32 v159, v159
  v_mfma_f32_32x32x16_bf16 v[136:151], v[228:231], v[44:47], v[136:151]
  v_cvt_pk_bf16_f32 v168, v152, v153
  v_cvt_pk_bf16_f32 v169, v154, v155
  v_cvt_pk_bf16_f32 v170, v156, v157
  v_cvt_pk_bf16_f32 v171, v158, v159
  v_exp_f32 v160, v160
  v_exp_f32 v161, v161
  v_exp_f32 v162, v162
  v_exp_f32 v163, v163
  v_mfma_f32_32x32x16_bf16 v[72:87], v[232:235], v[168:171], v[72:87]
  v_exp_f32 v164, v164
  v_exp_f32 v165, v165
  v_exp_f32 v166, v166
  v_exp_f32 v167, v167
  v_cvt_pk_bf16_f32 v172, v160, v161
  v_cvt_pk_bf16_f32 v173, v162, v163
  v_cvt_pk_bf16_f32 v174, v164, v165
  v_cvt_pk_bf16_f32 v175, v166, v167
  v_mfma_f32_32x32x16_bf16 v[152:167], v[224:227], v[48:51], 0
  v_exp_f32 v136, v136
  v_exp_f32 v137, v137
  v_exp_f32 v138, v138
  v_mfma_f32_32x32x16_bf16 v[72:87], v[236:239], v[172:175], v[72:87]
  v_exp_f32 v139, v139
  v_exp_f32 v140, v140
  v_exp_f32 v141, v141
  v_smfmac_f32_16x16x64_bf16 v[124:127], v[16:19], v[168:175], v20
  global_load_dwordx4 v[208:211], v3, s[22:23] offset:0
  global_load_dwordx4 v[212:215], v3, s[22:23] offset:1024
  global_load_dwordx4 v[216:219], v3, s[22:23] offset:2048
  global_load_dwordx4 v[220:223], v3, s[22:23] offset:3072
  v_exp_f32 v142, v142
  v_exp_f32 v143, v143
  v_mfma_f32_32x32x16_bf16 v[152:167], v[228:231], v[52:55], v[152:167]
  v_cvt_pk_bf16_f32 v168, v136, v137
  v_cvt_pk_bf16_f32 v169, v138, v139
  v_cvt_pk_bf16_f32 v170, v140, v141
  v_cvt_pk_bf16_f32 v171, v142, v143
  v_exp_f32 v144, v144
  v_exp_f32 v145, v145
  v_exp_f32 v146, v146
  v_exp_f32 v147, v147
  v_mfma_f32_32x32x16_bf16 v[88:103], v[232:235], v[168:171], v[88:103]
  s_waitcnt vmcnt(8)
  v_exp_f32 v148, v148
  v_exp_f32 v149, v149
  v_exp_f32 v150, v150
  v_exp_f32 v151, v151
  v_cvt_pk_bf16_f32 v172, v144, v145
  v_cvt_pk_bf16_f32 v173, v146, v147
  v_cvt_pk_bf16_f32 v174, v148, v149
  v_cvt_pk_bf16_f32 v175, v150, v151
  v_mfma_f32_32x32x16_bf16 v[136:151], v[176:179], v[24:27], 0
  v_exp_f32 v152, v152
  v_exp_f32 v153, v153
  v_exp_f32 v154, v154
  v_mfma_f32_32x32x16_bf16 v[88:103], v[236:239], v[172:175], v[88:103]
  v_exp_f32 v155, v155
  v_exp_f32 v156, v156
  v_exp_f32 v157, v157
  v_smfmac_f32_16x16x64_bf16 v[128:131], v[16:19], v[168:175], v20
  v_exp_f32 v158, v158
  v_exp_f32 v159, v159
  v_mfma_f32_32x32x16_bf16 v[136:151], v[180:183], v[28:31], v[136:151]
  s_add_u32 s32, s32, 1
  v_cvt_pk_bf16_f32 v168, v152, v153
  v_cvt_pk_bf16_f32 v169, v154, v155
  v_cvt_pk_bf16_f32 v170, v156, v157
  v_cvt_pk_bf16_f32 v171, v158, v159
  v_exp_f32 v160, v160
  v_exp_f32 v161, v161
  v_exp_f32 v162, v162
  v_exp_f32 v163, v163
  v_mfma_f32_32x32x16_bf16 v[104:119], v[232:235], v[168:171], v[104:119]
  s_cmp_eq_u32 s35, 0
  v_exp_f32 v164, v164
  v_exp_f32 v165, v165
  v_exp_f32 v166, v166
  v_exp_f32 v167, v167
  v_cvt_pk_bf16_f32 v172, v160, v161
  v_cvt_pk_bf16_f32 v173, v162, v163
  v_cvt_pk_bf16_f32 v174, v164, v165
  v_cvt_pk_bf16_f32 v175, v166, v167
  s_cbranch_scc1 .g2_kernel_a_loop
  s_branch .g2_kernel_a_redo
.g2_kernel_a_last:
  v_mfma_f32_32x32x16_bf16 v[152:167], v[224:227], v[32:35], 0
  ds_read_b32 v21, v13 offset:8
  s_andn2_b32 s33, s36, s34
  v_exp_f32 v136, v136
  v_exp_f32 v137, v137
  v_exp_f32 v138, v138
  v_mfma_f32_32x32x16_bf16 v[104:119], v[220:223], v[172:175], v[104:119]
  s_cbranch_scc0 .g2_kernel_a_L3c
.g2_kernel_a_L3b:
  v_exp_f32 v139, v139
  v_exp_f32 v140, v140
  v_exp_f32 v141, v141
  v_smfmac_f32_16x16x64_bf16 v[132:135], v[16:19], v[168:175], v20
  s_ff1_i32_b32 s33, s33
  v_exp_f32 v142, v142
  v_exp_f32 v143, v143
  v_mfma_f32_32x32x16_bf16 v[152:167], v[228:231], v[36:39], v[152:167]
  s_bitset1_b32 s34, s33
  ds_read_b128 v[24:27], v14 offset:0
  v_cvt_pk_bf16_f32 v168, v136, v137
  v_cvt_pk_bf16_f32 v169, v138, v139
  v_cvt_pk_bf16_f32 v170, v140, v141
  v_cvt_pk_bf16_f32 v171, v142, v143
  v_exp_f32 v144, v144
  v_exp_f32 v145, v145
  v_exp_f32 v146, v146
  v_exp_f32 v147, v147
  v_mfma_f32_32x32x16_bf16 v[56:71], v[232:235], v[168:171], v[56:71]
  s_xor_b32 s33, s33, s24
  ds_read_b128 v[28:31], v14 offset:1024
  v_exp_f32 v148, v148
  v_exp_f32 v149, v149
  v_exp_f32 v150, v150
  v_exp_f32 v151, v151
  v_cvt_pk_bf16_f32 v172, v144, v145
  v_cvt_pk_bf16_f32 v173, v146, v147
  v_cvt_pk_bf16_f32 v174, v148, v149
  v_cvt_pk_bf16_f32 v175, v150, v151
  v_mfma_f32_32x32x16_bf16 v[136:151], v[224:227], v[40:43], 0
  s_waitcnt lgkmcnt(2)
  s_lshl_b32 s33, s33, s25
  v_exp_f32 v152, v152
  v_exp_f32 v153, v153
  v_exp_f32 v154, v154
  v_mfma_f32_32x32x16_bf16 v[56:71], v[236:239], v[172:175], v[56:71]
  v_cmp_gt_u32 vcc, s27, v21
  s_add_u32 s22, s20, s33
  v_exp_f32 v155, v155
  v_exp_f32 v156, v156
  v_exp_f32 v157, v157
  v_smfmac_f32_16x16x64_bf16 v[120:123], v[16:19], v[168:175], v20
  s_addc_u32 s23, s21, 0
  v_exp_f32 v158, v158
  v_exp_f32 v159, v159
  v_mfma_f32_32x32x16_bf16 v[136:151], v[228:231], v[44:47], v[136:151]
  v_cvt_pk_bf16_f32 v168, v152, v153
  v_cvt_pk_bf16_f32 v169, v154, v155
  v_cvt_pk_bf16_f32 v170, v156, v157
  v_cvt_pk_bf16_f32 v171, v158, v159
  v_exp_f32 v160, v160
  v_exp_f32 v161, v161
  v_exp_f32 v162, v162
  v_exp_f32 v163, v163
  v_mfma_f32_32x32x16_bf16 v[72:87], v[232:235], v[168:171], v[72:87]
  s_cbranch_vccnz .g2_kernel_a_L3g
.g2_kernel_a_L3h:
  ds_read_b128 v[32:35], v14 offset:2048
  ds_read_b128 v[36:39], v14 offset:3072
  v_cvt_pk_bf16_f32 v56, v56, v57
  v_cvt_pk_bf16_f32 v57, v58, v59
  v_cvt_pk_bf16_f32 v58, v60, v61
  v_cvt_pk_bf16_f32 v59, v62, v63
  v_add_f32 v6, v120, v121
  v_exp_f32 v164, v164
  v_exp_f32 v165, v165
  v_exp_f32 v166, v166
  v_exp_f32 v167, v167
  v_cvt_pk_bf16_f32 v172, v160, v161
  v_cvt_pk_bf16_f32 v173, v162, v163
  v_cvt_pk_bf16_f32 v174, v164, v165
  v_cvt_pk_bf16_f32 v175, v166, v167
  v_mfma_f32_32x32x16_bf16 v[152:167], v[224:227], v[48:51], 0
  ds_write_b128 v9, v[56:59] offset:0
  v_cvt_pk_bf16_f32 v60, v64, v65
  v_cvt_pk_bf16_f32 v61, v66, v67
  v_cvt_pk_bf16_f32 v62, v68, v69
  v_cvt_pk_bf16_f32 v63, v70, v71
  v_exp_f32 v136, v136
  v_exp_f32 v137, v137
  v_exp_f32 v138, v138
  v_mfma_f32_32x32x16_bf16 v[72:87], v[236:239], v[172:175], v[72:87]
  ds_write_b128 v9, v[60:63] offset:1024
  v_mov_b32 v120, 0
  v_mov_b32 v121, 0
  v_exp_f32 v139, v139
  v_exp_f32 v140, v140
  v_exp_f32 v141, v141
  v_smfmac_f32_16x16x64_bf16 v[124:127], v[16:19], v[168:175], v20
  global_load_dwordx4 v[208:211], v3, s[22:23] offset:0
  global_load_dwordx4 v[212:215], v3, s[22:23] offset:1024
  global_load_dwordx4 v[216:219], v3, s[22:23] offset:2048
  global_load_dwordx4 v[220:223], v3, s[22:23] offset:3072
  ds_write_b32 v10, v6 offset:0
  ds_write_b32 v11, v12 offset:0
  v_exp_f32 v142, v142
  v_exp_f32 v143, v143
  v_mfma_f32_32x32x16_bf16 v[152:167], v[228:231], v[52:55], v[152:167]
  ds_read_b128 v[40:43], v14 offset:4096
  s_wakeup
  v_cvt_pk_bf16_f32 v168, v136, v137
  v_cvt_pk_bf16_f32 v169, v138, v139
  v_cvt_pk_bf16_f32 v170, v140, v141
  v_cvt_pk_bf16_f32 v171, v142, v143
  v_exp_f32 v144, v144
  v_exp_f32 v145, v145
  v_exp_f32 v146, v146
  v_exp_f32 v147, v147
  v_mfma_f32_32x32x16_bf16 v[88:103], v[232:235], v[168:171], v[88:103]
  s_waitcnt vmcnt(8)
  ds_read_b128 v[44:47], v14 offset:5120
  v_cvt_pk_bf16_f32 v72, v72, v73
  v_cvt_pk_bf16_f32 v73, v74, v75
  v_cvt_pk_bf16_f32 v74, v76, v77
  v_cvt_pk_bf16_f32 v75, v78, v79
  v_add_f32 v6, v124, v125
  v_exp_f32 v148, v148
  v_exp_f32 v149, v149
  v_exp_f32 v150, v150
  v_exp_f32 v151, v151
  v_cvt_pk_bf16_f32 v172, v144, v145
  v_cvt_pk_bf16_f32 v173, v146, v147
  v_cvt_pk_bf16_f32 v174, v148, v149
  v_cvt_pk_bf16_f32 v175, v150, v151
  s_waitcnt lgkmcnt(8)
  v_mfma_f32_32x32x16_bf16 v[136:151], v[176:179], v[24:27], 0
  ds_write_b128 v9, v[72:75] offset:8192
  v_cvt_pk_bf16_f32 v76, v80, v81
  v_cvt_pk_bf16_f32 v77, v82, v83
  v_cvt_pk_bf16_f32 v78, v84, v85
  v_cvt_pk_bf16_f32 v79, v86, v87
  v_exp_f32 v152, v152
  v_exp_f32 v153, v153
  v_exp_f32 v154, v154
  v_mfma_f32_32x32x16_bf16 v[88:103], v[236:239], v[172:175], v[88:103]
  ds_write_b128 v9, v[76:79] offset:9216
  v_mov_b32 v124, 0
  v_mov_b32 v125, 0
  v_exp_f32 v155, v155
  v_exp_f32 v156, v156
  v_exp_f32 v157, v157
  v_smfmac_f32_16x16x64_bf16 v[128:131], v[16:19], v[168:175], v20
  ds_write_b32 v10, v6 offset:512
  ds_write_b32 v11, v12 offset:16
  v_exp_f32 v158, v158
  v_exp_f32 v159, v159
  v_mfma_f32_32x32x16_bf16 v[136:151], v[180:183], v[28:31], v[136:151]
  ds_read_b128 v[48:51], v14 offset:6144
  s_wakeup
  v_cvt_pk_bf16_f32 v168, v152, v153
  v_cvt_pk_bf16_f32 v169, v154, v155
  v_cvt_pk_bf16_f32 v170, v156, v157
  v_cvt_pk_bf16_f32 v171, v158, v159
  v_exp_f32 v160, v160
  v_exp_f32 v161, v161
  v_exp_f32 v162, v162
  v_exp_f32 v163, v163
  v_mfma_f32_32x32x16_bf16 v[104:119], v[232:235], v[168:171], v[104:119]
  ds_read_b128 v[52:55], v14 offset:7168
  v_cvt_pk_bf16_f32 v88, v88, v89
  v_cvt_pk_bf16_f32 v89, v90, v91
  v_cvt_pk_bf16_f32 v90, v92, v93
  v_cvt_pk_bf16_f32 v91, v94, v95
  v_add_f32 v6, v128, v129
  ds_write_b128 v9, v[88:91] offset:16384
  v_cvt_pk_bf16_f32 v92, v96, v97
  v_cvt_pk_bf16_f32 v93, v98, v99
  v_cvt_pk_bf16_f32 v94, v100, v101
  v_cvt_pk_bf16_f32 v95, v102, v103
  ds_write_b128 v9, v[92:95] offset:17408
  v_mov_b32 v128, 0
  v_mov_b32 v129, 0
  ds_write_b32 v10, v6 offset:1024
  ds_write_b32 v11, v12 offset:32
  s_add_u32 s32, s32, 1
  v_exp_f32 v164, v164
  v_exp_f32 v165, v165
  v_exp_f32 v166, v166
  v_exp_f32 v167, v167
  v_cvt_pk_bf16_f32 v172, v160, v161
  v_cvt_pk_bf16_f32 v173, v162, v163
  v_cvt_pk_bf16_f32 v174, v164, v165
  v_cvt_pk_bf16_f32 v175, v166, v167
  s_cmp_eq_u32 s32, 8
  s_cbranch_scc1 .g2_kernel_a_end
  s_waitcnt lgkmcnt(15)
  v_mfma_f32_32x32x16_bf16 v[152:167], v[176:179], v[32:35], 0
  s_andn2_b32 s33, s36, s34
  v_exp_f32 v136, v136
  v_exp_f32 v137, v137
  v_exp_f32 v138, v138
  v_mfma_f32_32x32x16_bf16 v[104:119], v[236:239], v[172:175], v[104:119]
  s_cbranch_scc0 .g2_kernel_a_G0c
.g2_kernel_a_G0b:
  v_exp_f32 v139, v139
  v_exp_f32 v140, v140
  v_exp_f32 v141, v141
  v_smfmac_f32_16x16x64_bf16 v[132:135], v[16:19], v[168:175], v20
  s_ff1_i32_b32 s33, s33
  v_exp_f32 v142, v142
  v_exp_f32 v143, v143
  v_mfma_f32_32x32x16_bf16 v[152:167], v[180:183], v[36:39], v[152:167]
  s_bitset1_b32 s34, s33
  v_cvt_pk_bf16_f32 v168, v136, v137
  v_cvt_pk_bf16_f32 v169, v138, v139
  v_cvt_pk_bf16_f32 v170, v140, v141
  v_cvt_pk_bf16_f32 v171, v142, v143
  v_exp_f32 v144, v144
  v_exp_f32 v145, v145
  v_exp_f32 v146, v146
  v_exp_f32 v147, v147
  s_waitcnt lgkmcnt(14)
  v_mfma_f32_32x32x16_bf16 v[56:71], v[184:187], v[168:171], 0
  s_xor_b32 s33, s33, s24
  v_cvt_pk_bf16_f32 v104, v104, v105
  v_cvt_pk_bf16_f32 v105, v106, v107
  v_cvt_pk_bf16_f32 v106, v108, v109
  v_cvt_pk_bf16_f32 v107, v110, v111
  v_add_f32 v6, v132, v133
  v_exp_f32 v148, v148
  v_exp_f32 v149, v149
  v_exp_f32 v150, v150
  v_exp_f32 v151, v151
  v_cvt_pk_bf16_f32 v172, v144, v145
  v_cvt_pk_bf16_f32 v173, v146, v147
  v_cvt_pk_bf16_f32 v174, v148, v149
  v_cvt_pk_bf16_f32 v175, v150, v151
  s_waitcnt lgkmcnt(10)
  v_mfma_f32_32x32x16_bf16 v[136:151], v[176:179], v[40:43], 0
  s_lshl_b32 s33, s33, s25
  ds_write_b128 v9, v[104:107] offset:24576
  v_cvt_pk_bf16_f32 v108, v112, v113
  v_cvt_pk_bf16_f32 v109, v114, v115
  v_cvt_pk_bf16_f32 v110, v116, v117
  v_cvt_pk_bf16_f32 v111, v118, v119
  v_exp_f32 v152, v152
  v_exp_f32 v153, v153
  v_exp_f32 v154, v154
  v_mfma_f32_32x32x16_bf16 v[56:71], v[188:191], v[172:175], v[56:71]
  s_add_u32 s22, s20, s33
  ds_write_b128 v9, v[108:111] offset:25600
  v_mov_b32 v132, 0
  v_mov_b32 v133, 0
  v_exp_f32 v155, v155
  v_exp_f32 v156, v156
  v_exp_f32 v157, v157
  v_smfmac_f32_16x16x64_bf16 v[120:123], v[16:19], v[168:175], v20
  s_addc_u32 s23, s21, 0
  ds_write_b32 v10, v6 offset:1536
  v_exp_f32 v158, v158
  v_exp_f32 v159, v159
  v_mfma_f32_32x32x16_bf16 v[136:151], v[180:183], v[44:47], v[136:151]
  v_cvt_pk_bf16_f32 v168, v152, v153
  v_cvt_pk_bf16_f32 v169, v154, v155
  v_cvt_pk_bf16_f32 v170, v156, v157
  v_cvt_pk_bf16_f32 v171, v158, v159
  v_exp_f32 v160, v160
  v_exp_f32 v161, v161
  v_exp_f32 v162, v162
  v_exp_f32 v163, v163
  s_waitcnt lgkmcnt(11)
  v_mfma_f32_32x32x16_bf16 v[72:87], v[184:187], v[168:171], 0
  ds_write_b32 v11, v12 offset:48
  v_exp_f32 v164, v164
  v_exp_f32 v165, v165
  v_exp_f32 v166, v166
  v_exp_f32 v167, v167
  v_cvt_pk_bf16_f32 v172, v160, v161
  v_cvt_pk_bf16_f32 v173, v162, v163
  v_cvt_pk_bf16_f32 v174, v164, v165
  v_cvt_pk_bf16_f32 v175, v166, v167
  s_waitcnt lgkmcnt(8)
  v_mfma_f32_32x32x16_bf16 v[152:167], v[176:179], v[48:51], 0
  v_add_u32 v12, 1, v12
  v_exp_f32 v136, v136
  v_exp_f32 v137, v137
  v_exp_f32 v138, v138
  v_mfma_f32_32x32x16_bf16 v[72:87], v[188:191], v[172:175], v[72:87]
  v_exp_f32 v139, v139
  v_exp_f32 v140, v140
  v_exp_f32 v141, v141
  v_smfmac_f32_16x16x64_bf16 v[124:127], v[16:19], v[168:175], v20
  global_load_dwordx4 v[224:227], v3, s[22:23] offset:0
  global_load_dwordx4 v[228:231], v3, s[22:23] offset:1024
  global_load_dwordx4 v[232:235], v3, s[22:23] offset:2048
  global_load_dwordx4 v[236:239], v3, s[22:23] offset:3072
  s_add_u32 s27, s27, 4
  v_exp_f32 v142, v142
  v_exp_f32 v143, v143
  v_mfma_f32_32x32x16_bf16 v[152:167], v[180:183], v[52:55], v[152:167]
  v_cvt_pk_bf16_f32 v168, v136, v137
  v_cvt_pk_bf16_f32 v169, v138, v139
  v_cvt_pk_bf16_f32 v170, v140, v141
  v_cvt_pk_bf16_f32 v171, v142, v143
  v_exp_f32 v144, v144
  v_exp_f32 v145, v145
  v_exp_f32 v146, v146
  v_exp_f32 v147, v147
  s_waitcnt lgkmcnt(6)
  v_mfma_f32_32x32x16_bf16 v[88:103], v[184:187], v[168:171], 0
  s_waitcnt vmcnt(8)
  v_exp_f32 v148, v148
  v_exp_f32 v149, v149
  v_exp_f32 v150, v150
  v_exp_f32 v151, v151
  v_cvt_pk_bf16_f32 v172, v144, v145
  v_cvt_pk_bf16_f32 v173, v146, v147
  v_cvt_pk_bf16_f32 v174, v148, v149
  v_cvt_pk_bf16_f32 v175, v150, v151
  v_mfma_f32_32x32x16_bf16 v[136:151], v[192:195], v[24:27], 0
  v_exp_f32 v152, v152
  v_exp_f32 v153, v153
  v_exp_f32 v154, v154
  v_mfma_f32_32x32x16_bf16 v[88:103], v[188:191], v[172:175], v[88:103]
  v_exp_f32 v155, v155
  v_exp_f32 v156, v156
  v_exp_f32 v157, v157
  v_smfmac_f32_16x16x64_bf16 v[128:131], v[16:19], v[168:175], v20
  v_exp_f32 v158, v158
  v_exp_f32 v159, v159
  v_mfma_f32_32x32x16_bf16 v[136:151], v[196:199], v[28:31], v[136:151]
  v_cvt_pk_bf16_f32 v168, v152, v153
  v_cvt_pk_bf16_f32 v169, v154, v155
  v_cvt_pk_bf16_f32 v170, v156, v157
  v_cvt_pk_bf16_f32 v171, v158, v159
  v_exp_f32 v160, v160
  v_exp_f32 v161, v161
  v_exp_f32 v162, v162
  v_exp_f32 v163, v163
  s_waitcnt lgkmcnt(2)
  v_mfma_f32_32x32x16_bf16 v[104:119], v[184:187], v[168:171], 0
  v_exp_f32 v164, v164
  v_exp_f32 v165, v165
  v_exp_f32 v166, v166
  v_exp_f32 v167, v167
  v_cvt_pk_bf16_f32 v172, v160, v161
  v_cvt_pk_bf16_f32 v173, v162, v163
  v_cvt_pk_bf16_f32 v174, v164, v165
  v_cvt_pk_bf16_f32 v175, v166, v167
  s_branch .g2_kernel_a_n1
.g2_kernel_a_end:
  v_mfma_f32_32x32x16_bf16 v[104:119], v[236:239], v[172:175], v[104:119]
  v_smfmac_f32_16x16x64_bf16 v[132:135], v[16:19], v[168:175], v20
  s_wakeup
  s_nop 9
  v_cvt_pk_bf16_f32 v104, v104, v105
  v_cvt_pk_bf16_f32 v105, v106, v107
  v_cvt_pk_bf16_f32 v106, v108, v109
  v_cvt_pk_bf16_f32 v107, v110, v111
  v_add_f32 v6, v132, v133
  ds_write_b128 v9, v[104:107] offset:24576
  v_cvt_pk_bf16_f32 v108, v112, v113
  v_cvt_pk_bf16_f32 v109, v114, v115
  v_cvt_pk_bf16_f32 v110, v116, v117
  v_cvt_pk_bf16_f32 v111, v118, v119
  ds_write_b128 v9, v[108:111] offset:25600
  v_mov_b32 v132, 0
  v_mov_b32 v133, 0
  ds_write_b32 v10, v6 offset:1536
  ds_write_b32 v11, v12 offset:48
  s_waitcnt lgkmcnt(4)
  v_mov_b32 v20, s71
  v_lshrrev_b32 v17, 5, v2
  v_and_b32 v18, 31, v2
  s_lshl_b32 s28, s16, 5
  v_add_u32 v19, s28, v18
  v_lshlrev_b32 v7, 2, v19
  v_add_u32 v7, 155648, v7
  ds_read_b32 v8, v7 offset:3840
  ds_read_b32 v9, v7 offset:4352
  ds_read_b32 v16, v20 offset:24
  ds_read_b32 v6, v20 offset:52
  v_add_u32 v19, 1, v19
  v_bfe_u32 v7, v2, 2, 2
  v_lshl_add_u32 v14, v17, 2, v7
  v_lshlrev_b32 v14, 7, v14
  v_lshrrev_b32 v7, 1, v7
  v_lshl_add_u32 v14, v7, 6, v14
  v_bfe_u32 v7, v2, 4, 1
  v_lshl_add_u32 v14, v7, 5, v14
  v_and_b32 v7, 1, v2
  v_lshl_add_u32 v14, v7, 4, v14
  v_bfe_u32 v7, v2, 1, 1
  v_lshl_add_u32 v14, v7, 3, v14
  v_xor_b32 v15, 64, v14
  v_and_b32 v7, 7, v2
  v_xor_b32 v7, s24, v7
  s_mov_b32 s28, 192
  s_add_u32 s28, s28, 157952
  v_lshl_add_u32 v21, v7, 3, s28
  v_lshlrev_b32 v24, 16, v240
  v_and_b32 v25, 0xffff0000, v240
  v_lshlrev_b32 v26, 16, v241
  v_and_b32 v27, 0xffff0000, v241
  v_lshlrev_b32 v28, 16, v242
  v_and_b32 v29, 0xffff0000, v242
  v_lshlrev_b32 v30, 16, v243
  v_and_b32 v31, 0xffff0000, v243
  v_lshlrev_b32 v32, 16, v244
  v_and_b32 v33, 0xffff0000, v244
  v_lshlrev_b32 v34, 16, v245
  v_and_b32 v35, 0xffff0000, v245
  v_lshlrev_b32 v36, 16, v246
  v_and_b32 v37, 0xffff0000, v246
  v_lshlrev_b32 v38, 16, v247
  v_and_b32 v39, 0xffff0000, v247
  v_lshlrev_b32 v40, 16, v248
  v_and_b32 v41, 0xffff0000, v248
  v_lshlrev_b32 v42, 16, v249
  v_and_b32 v43, 0xffff0000, v249
  v_lshlrev_b32 v44, 16, v250
  v_and_b32 v45, 0xffff0000, v250
  v_lshlrev_b32 v46, 16, v251
  v_and_b32 v47, 0xffff0000, v251
  v_lshlrev_b32 v48, 16, v252
  v_and_b32 v49, 0xffff0000, v252
  v_lshlrev_b32 v50, 16, v253
  v_and_b32 v51, 0xffff0000, v253
  v_lshlrev_b32 v52, 16, v254
  v_and_b32 v53, 0xffff0000, v254
  v_lshlrev_b32 v54, 16, v255
  v_and_b32 v55, 0xffff0000, v255
  s_waitcnt lgkmcnt(0)
  v_cmp_gt_u32 vcc, 4, v6
  s_cbranch_vccnz .g2_kernel_w_aw
.g2_kernel_w_ab:
  s_xor_b32 s28, s24, 0
  s_lshl_b32 s28, s28, 13
  s_add_u32 s28, s28, 65536
  v_add_u32 v10, s28, v14
  v_add_u32 v11, s28, v15
  ds_read_b64_tr_b16 v[104:105], v10 offset:0
  ds_read_b64_tr_b16 v[106:107], v10 offset:1024
  ds_read_b64_tr_b16 v[108:109], v11 offset:0
  ds_read_b64_tr_b16 v[110:111], v11 offset:1024
  ds_read_b64_tr_b16 v[112:113], v10 offset:2048
  ds_read_b64_tr_b16 v[114:115], v10 offset:3072
  ds_read_b64_tr_b16 v[116:117], v11 offset:2048
  ds_read_b64_tr_b16 v[118:119], v11 offset:3072
  ds_read_b64_tr_b16 v[120:121], v10 offset:4096
  ds_read_b64_tr_b16 v[122:123], v10 offset:5120
  ds_read_b64_tr_b16 v[124:125], v11 offset:4096
  ds_read_b64_tr_b16 v[126:127], v11 offset:5120
  s_andn2_b32 s33, s36, s34
  s_ff1_i32_b32 s33, s33
  s_bitset1_b32 s34, s33
  s_xor_b32 s33, s33, s24
  s_lshl_b32 s33, s33, 12
  s_add_u32 s22, s20, s33
  s_addc_u32 s23, s21, 0
  global_load_dwordx4 v[224:227], v3, s[22:23] offset:0
  global_load_dwordx4 v[228:231], v3, s[22:23] offset:1024
  global_load_dwordx4 v[232:235], v3, s[22:23] offset:2048
  global_load_dwordx4 v[236:239], v3, s[22:23] offset:3072
  v_pk_fma_f32 v[24:25], v[24:25], v[8:9], v[8:9] op_sel:[0,0,1] op_sel_hi:[1,0,1]
  v_pk_fma_f32 v[26:27], v[26:27], v[8:9], v[8:9] op_sel:[0,0,1] op_sel_hi:[1,0,1]
  v_pk_fma_f32 v[28:29], v[28:29], v[8:9], v[8:9] op_sel:[0,0,1] op_sel_hi:[1,0,1]
  v_pk_fma_f32 v[30:31], v[30:31], v[8:9], v[8:9] op_sel:[0,0,1] op_sel_hi:[1,0,1]
  v_pk_fma_f32 v[32:33], v[32:33], v[8:9], v[8:9] op_sel:[0,0,1] op_sel_hi:[1,0,1]
  v_pk_fma_f32 v[34:35], v[34:35], v[8:9], v[8:9] op_sel:[0,0,1] op_sel_hi:[1,0,1]
  v_pk_fma_f32 v[36:37], v[36:37], v[8:9], v[8:9] op_sel:[0,0,1] op_sel_hi:[1,0,1]
  v_pk_fma_f32 v[38:39], v[38:39], v[8:9], v[8:9] op_sel:[0,0,1] op_sel_hi:[1,0,1]
  v_pk_fma_f32 v[40:41], v[40:41], v[8:9], v[8:9] op_sel:[0,0,1] op_sel_hi:[1,0,1]
  v_pk_fma_f32 v[42:43], v[42:43], v[8:9], v[8:9] op_sel:[0,0,1] op_sel_hi:[1,0,1]
  v_pk_fma_f32 v[44:45], v[44:45], v[8:9], v[8:9] op_sel:[0,0,1] op_sel_hi:[1,0,1]
  v_pk_fma_f32 v[46:47], v[46:47], v[8:9], v[8:9] op_sel:[0,0,1] op_sel_hi:[1,0,1]
  v_pk_fma_f32 v[48:49], v[48:49], v[8:9], v[8:9] op_sel:[0,0,1] op_sel_hi:[1,0,1]
  v_pk_fma_f32 v[50:51], v[50:51], v[8:9], v[8:9] op_sel:[0,0,1] op_sel_hi:[1,0,1]
  v_pk_fma_f32 v[52:53], v[52:53], v[8:9], v[8:9] op_sel:[0,0,1] op_sel_hi:[1,0,1]
  v_pk_fma_f32 v[54:55], v[54:55], v[8:9], v[8:9] op_sel:[0,0,1] op_sel_hi:[1,0,1]
  v_cmp_eq_u32 vcc, v16, v19
  s_cbranch_vccnz .g2_kernel_w_pt
.g2_kernel_w_pb:
  s_mov_b32 s72, s48
  s_mov_b32 s73, s49
  s_mov_b32 s74, 0x800
  s_mov_b32 s75, 0x00020000
  s_waitcnt vmcnt(15) lgkmcnt(8)
  v_mfma_f32_32x32x16_bf16 v[24:39], v[104:107], v[176:179], v[24:39]
  s_xor_b32 s28, s24, 1
  s_lshl_b32 s28, s28, 13
  s_add_u32 s28, s28, 65536
  ds_read_b64_tr_b16 v[128:129], v10 offset:6144
  ds_read_b64_tr_b16 v[130:131], v10 offset:7168
  v_mfma_f32_32x32x16_bf16 v[40:55], v[108:111], v[176:179], v[40:55]
  v_add_u32 v12, s28, v14
  v_add_u32 v13, s28, v15
  s_andn2_b32 s33, s36, s34
  ds_read_b64_tr_b16 v[132:133], v11 offset:6144
  ds_read_b64_tr_b16 v[134:135], v11 offset:7168
  s_waitcnt vmcnt(14) lgkmcnt(8)
  v_mfma_f32_32x32x16_bf16 v[24:39], v[112:115], v[180:183], v[24:39]
  s_ff1_i32_b32 s33, s33
  s_bitset1_b32 s34, s33
  s_xor_b32 s33, s33, s24
  ds_read_b64_tr_b16 v[104:105], v12 offset:0
  ds_read_b64_tr_b16 v[106:107], v12 offset:1024
  v_mfma_f32_32x32x16_bf16 v[40:55], v[116:119], v[180:183], v[40:55]
  s_lshl_b32 s33, s33, 12
  s_add_u32 s22, s20, s33
  s_addc_u32 s23, s21, 0
  ds_read_b64_tr_b16 v[108:109], v13 offset:0
  ds_read_b64_tr_b16 v[110:111], v13 offset:1024
  s_waitcnt vmcnt(13) lgkmcnt(8)
  v_mfma_f32_32x32x16_bf16 v[24:39], v[120:123], v[184:187], v[24:39]
  global_load_dwordx4 v[136:139], v3, s[22:23] offset:0
  global_load_dwordx4 v[140:143], v3, s[22:23] offset:1024
  global_load_dwordx4 v[144:147], v3, s[22:23] offset:2048
  ds_read_b64_tr_b16 v[112:113], v12 offset:2048
  ds_read_b64_tr_b16 v[114:115], v12 offset:3072
  v_mfma_f32_32x32x16_bf16 v[40:55], v[124:127], v[184:187], v[40:55]
  global_load_dwordx4 v[148:151], v3, s[22:23] offset:3072
  ds_read_b64_tr_b16 v[116:117], v13 offset:2048
  ds_read_b64_tr_b16 v[118:119], v13 offset:3072
  s_waitcnt vmcnt(16) lgkmcnt(8)
  v_mfma_f32_32x32x16_bf16 v[24:39], v[128:131], v[188:191], v[24:39]
  ds_read_b64_tr_b16 v[120:121], v12 offset:4096
  ds_read_b64_tr_b16 v[122:123], v12 offset:5120
  v_mfma_f32_32x32x16_bf16 v[40:55], v[132:135], v[188:191], v[40:55]
  ds_read_b64_tr_b16 v[124:125], v13 offset:4096
  ds_read_b64_tr_b16 v[126:127], v13 offset:5120
  s_waitcnt vmcnt(15) lgkmcnt(8)
  v_mfma_f32_32x32x16_bf16 v[24:39], v[104:107], v[192:195], v[24:39]
  s_xor_b32 s28, s24, 2
  s_lshl_b32 s28, s28, 13
  s_add_u32 s28, s28, 65536
  ds_read_b64_tr_b16 v[128:129], v12 offset:6144
  ds_read_b64_tr_b16 v[130:131], v12 offset:7168
  v_mfma_f32_32x32x16_bf16 v[40:55], v[108:111], v[192:195], v[40:55]
  v_add_u32 v10, s28, v14
  v_add_u32 v11, s28, v15
  s_andn2_b32 s33, s36, s34
  ds_read_b64_tr_b16 v[132:133], v13 offset:6144
  ds_read_b64_tr_b16 v[134:135], v13 offset:7168
  s_waitcnt vmcnt(14) lgkmcnt(8)
  v_mfma_f32_32x32x16_bf16 v[24:39], v[112:115], v[196:199], v[24:39]
  s_ff1_i32_b32 s33, s33
  s_bitset1_b32 s34, s33
  s_xor_b32 s33, s33, s24
  ds_read_b64_tr_b16 v[104:105], v10 offset:0
  ds_read_b64_tr_b16 v[106:107], v10 offset:1024
  v_mfma_f32_32x32x16_bf16 v[40:55], v[116:119], v[196:199], v[40:55]
  s_lshl_b32 s33, s33, 12
  s_add_u32 s22, s20, s33
  s_addc_u32 s23, s21, 0
  ds_read_b64_tr_b16 v[108:109], v11 offset:0
  ds_read_b64_tr_b16 v[110:111], v11 offset:1024
  s_waitcnt vmcnt(13) lgkmcnt(8)
  v_mfma_f32_32x32x16_bf16 v[24:39], v[120:123], v[200:203], v[24:39]
  global_load_dwordx4 v[152:155], v3, s[22:23] offset:0
  global_load_dwordx4 v[156:159], v3, s[22:23] offset:1024
  global_load_dwordx4 v[160:163], v3, s[22:23] offset:2048
  ds_read_b64_tr_b16 v[112:113], v10 offset:2048
  ds_read_b64_tr_b16 v[114:115], v10 offset:3072
  v_mfma_f32_32x32x16_bf16 v[40:55], v[124:127], v[200:203], v[40:55]
  global_load_dwordx4 v[164:167], v3, s[22:23] offset:3072
  ds_read_b64_tr_b16 v[116:117], v11 offset:2048
  ds_read_b64_tr_b16 v[118:119], v11 offset:3072
  s_waitcnt vmcnt(16) lgkmcnt(8)
  v_mfma_f32_32x32x16_bf16 v[24:39], v[128:131], v[204:207], v[24:39]
  ds_read_b64_tr_b16 v[120:121], v10 offset:4096
  ds_read_b64_tr_b16 v[122:123], v10 offset:5120
  v_mfma_f32_32x32x16_bf16 v[40:55], v[132:135], v[204:207], v[40:55]
  ds_read_b64_tr_b16 v[124:125], v11 offset:4096
  ds_read_b64_tr_b16 v[126:127], v11 offset:5120
  s_waitcnt vmcnt(15) lgkmcnt(8)
  v_mfma_f32_32x32x16_bf16 v[24:39], v[104:107], v[208:211], v[24:39]
  s_xor_b32 s28, s24, 3
  s_lshl_b32 s28, s28, 13
  s_add_u32 s28, s28, 65536
  ds_read_b64_tr_b16 v[128:129], v10 offset:6144
  ds_read_b64_tr_b16 v[130:131], v10 offset:7168
  v_mfma_f32_32x32x16_bf16 v[40:55], v[108:111], v[208:211], v[40:55]
  v_add_u32 v12, s28, v14
  v_add_u32 v13, s28, v15
  s_andn2_b32 s33, s36, s34
  ds_read_b64_tr_b16 v[132:133], v11 offset:6144
  ds_read_b64_tr_b16 v[134:135], v11 offset:7168
  s_waitcnt vmcnt(14) lgkmcnt(8)
  v_mfma_f32_32x32x16_bf16 v[24:39], v[112:115], v[212:215], v[24:39]
  s_ff1_i32_b32 s33, s33
  s_bitset1_b32 s34, s33
  s_xor_b32 s33, s33, s24
  ds_read_b64_tr_b16 v[104:105], v12 offset:0
  ds_read_b64_tr_b16 v[106:107], v12 offset:1024
  v_mfma_f32_32x32x16_bf16 v[40:55], v[116:119], v[212:215], v[40:55]
  s_lshl_b32 s33, s33, 12
  s_add_u32 s22, s20, s33
  s_addc_u32 s23, s21, 0
  ds_read_b64_tr_b16 v[108:109], v13 offset:0
  ds_read_b64_tr_b16 v[110:111], v13 offset:1024
  s_waitcnt vmcnt(13) lgkmcnt(8)
  v_mfma_f32_32x32x16_bf16 v[24:39], v[120:123], v[216:219], v[24:39]
  global_load_dwordx4 v[56:59], v3, s[22:23] offset:0
  global_load_dwordx4 v[60:63], v3, s[22:23] offset:1024
  global_load_dwordx4 v[64:67], v3, s[22:23] offset:2048
  ds_read_b64_tr_b16 v[112:113], v12 offset:2048
  ds_read_b64_tr_b16 v[114:115], v12 offset:3072
  v_mfma_f32_32x32x16_bf16 v[40:55], v[124:127], v[216:219], v[40:55]
  global_load_dwordx4 v[68:71], v3, s[22:23] offset:3072
  ds_read_b64_tr_b16 v[116:117], v13 offset:2048
  ds_read_b64_tr_b16 v[118:119], v13 offset:3072
  s_waitcnt vmcnt(16) lgkmcnt(8)
  v_mfma_f32_32x32x16_bf16 v[24:39], v[128:131], v[220:223], v[24:39]
  ds_read_b64_tr_b16 v[120:121], v12 offset:4096
  ds_read_b64_tr_b16 v[122:123], v12 offset:5120
  v_mfma_f32_32x32x16_bf16 v[40:55], v[132:135], v[220:223], v[40:55]
  ds_read_b64_tr_b16 v[124:125], v13 offset:4096
  ds_read_b64_tr_b16 v[126:127], v13 offset:5120
  s_waitcnt vmcnt(15) lgkmcnt(8)
  v_mfma_f32_32x32x16_bf16 v[24:39], v[104:107], v[224:227], v[24:39]
  s_xor_b32 s28, s24, 4
  s_lshl_b32 s28, s28, 13
  s_add_u32 s28, s28, 65536
  ds_read_b64_tr_b16 v[128:129], v12 offset:6144
  ds_read_b64_tr_b16 v[130:131], v12 offset:7168
  v_mfma_f32_32x32x16_bf16 v[40:55], v[108:111], v[224:227], v[40:55]
  v_add_u32 v10, s28, v14
  v_add_u32 v11, s28, v15
  s_andn2_b32 s33, s36, s34
  ds_read_b64_tr_b16 v[132:133], v13 offset:6144
  ds_read_b64_tr_b16 v[134:135], v13 offset:7168
  s_waitcnt vmcnt(14) lgkmcnt(8)
  v_mfma_f32_32x32x16_bf16 v[24:39], v[112:115], v[228:231], v[24:39]
  s_ff1_i32_b32 s33, s33
  s_bitset1_b32 s34, s33
  s_xor_b32 s33, s33, s24
  ds_read_b64_tr_b16 v[104:105], v10 offset:0
  ds_read_b64_tr_b16 v[106:107], v10 offset:1024
  v_mfma_f32_32x32x16_bf16 v[40:55], v[116:119], v[228:231], v[40:55]
  s_lshl_b32 s33, s33, 12
  s_add_u32 s22, s20, s33
  s_addc_u32 s23, s21, 0
  ds_read_b64_tr_b16 v[108:109], v11 offset:0
  ds_read_b64_tr_b16 v[110:111], v11 offset:1024
  s_waitcnt vmcnt(13) lgkmcnt(8)
  v_mfma_f32_32x32x16_bf16 v[24:39], v[120:123], v[232:235], v[24:39]
  global_load_dwordx4 v[72:75], v3, s[22:23] offset:0
  global_load_dwordx4 v[76:79], v3, s[22:23] offset:1024
  global_load_dwordx4 v[80:83], v3, s[22:23] offset:2048
  ds_read_b64_tr_b16 v[112:113], v10 offset:2048
  ds_read_b64_tr_b16 v[114:115], v10 offset:3072
  v_mfma_f32_32x32x16_bf16 v[40:55], v[124:127], v[232:235], v[40:55]
  global_load_dwordx4 v[84:87], v3, s[22:23] offset:3072
  ds_read_b64_tr_b16 v[116:117], v11 offset:2048
  ds_read_b64_tr_b16 v[118:119], v11 offset:3072
  s_waitcnt vmcnt(16) lgkmcnt(8)
  v_mfma_f32_32x32x16_bf16 v[24:39], v[128:131], v[236:239], v[24:39]
  ds_read_b64_tr_b16 v[120:121], v10 offset:4096
  ds_read_b64_tr_b16 v[122:123], v10 offset:5120
  v_mfma_f32_32x32x16_bf16 v[40:55], v[132:135], v[236:239], v[40:55]
  ds_read_b64_tr_b16 v[124:125], v11 offset:4096
  ds_read_b64_tr_b16 v[126:127], v11 offset:5120
  s_waitcnt vmcnt(15) lgkmcnt(8)
  v_mfma_f32_32x32x16_bf16 v[24:39], v[104:107], v[136:139], v[24:39]
  s_xor_b32 s28, s24, 5
  s_lshl_b32 s28, s28, 13
  s_add_u32 s28, s28, 65536
  v_add_u32 v12, s28, v14
  ds_read_b64_tr_b16 v[128:129], v10 offset:6144
  ds_read_b64_tr_b16 v[130:131], v10 offset:7168
  v_mfma_f32_32x32x16_bf16 v[40:55], v[108:111], v[136:139], v[40:55]
  v_add_u32 v13, s28, v15
  s_andn2_b32 s33, s36, s34
  s_cbranch_scc0 .g2_kernel_w_i8c
.g2_kernel_w_i8b:
  s_ff1_i32_b32 s33, s33
  ds_read_b64_tr_b16 v[132:133], v11 offset:6144
  ds_read_b64_tr_b16 v[134:135], v11 offset:7168
  s_waitcnt vmcnt(14) lgkmcnt(8)
  v_mfma_f32_32x32x16_bf16 v[24:39], v[112:115], v[140:143], v[24:39]
  s_bitset1_b32 s34, s33
  s_xor_b32 s33, s33, s24
  s_and_b32 s8, s33, 7
  s_cmp_lt_u32 s8, 2
  ds_read_b64_tr_b16 v[104:105], v12 offset:0
  ds_read_b64_tr_b16 v[106:107], v12 offset:1024
  v_mfma_f32_32x32x16_bf16 v[40:55], v[116:119], v[140:143], v[40:55]
  s_cselect_b32 s28, 139264, 0
  s_lshl_b32 s8, s8, 13
  s_add_u32 s8, s8, s28
  s_lshl_b32 s33, s33, 12
  ds_read_b64_tr_b16 v[108:109], v13 offset:0
  ds_read_b64_tr_b16 v[110:111], v13 offset:1024
  s_waitcnt vmcnt(13) lgkmcnt(8)
  v_mfma_f32_32x32x16_bf16 v[24:39], v[120:123], v[144:147], v[24:39]
  s_add_u32 s22, s20, s33
  s_addc_u32 s23, s21, 0
  global_load_dwordx4 v[88:91], v3, s[22:23] offset:0
  global_load_dwordx4 v[92:95], v3, s[22:23] offset:1024
  ds_read_b64_tr_b16 v[112:113], v12 offset:2048
  ds_read_b64_tr_b16 v[114:115], v12 offset:3072
  v_mfma_f32_32x32x16_bf16 v[40:55], v[124:127], v[144:147], v[40:55]
  global_load_dwordx4 v[96:99], v3, s[22:23] offset:2048
  global_load_dwordx4 v[100:103], v3, s[22:23] offset:3072
  ds_read_b64_tr_b16 v[116:117], v13 offset:2048
  ds_read_b64_tr_b16 v[118:119], v13 offset:3072
  s_waitcnt vmcnt(16) lgkmcnt(8)
  v_mfma_f32_32x32x16_bf16 v[24:39], v[128:131], v[148:151], v[24:39]
  ds_read_b64_tr_b16 v[120:121], v12 offset:4096
  ds_read_b64_tr_b16 v[122:123], v12 offset:5120
  v_mfma_f32_32x32x16_bf16 v[40:55], v[132:135], v[148:151], v[40:55]
  ds_read_b64_tr_b16 v[124:125], v13 offset:4096
  ds_read_b64_tr_b16 v[126:127], v13 offset:5120
  s_waitcnt vmcnt(15) lgkmcnt(8)
  v_mfma_f32_32x32x16_bf16 v[24:39], v[104:107], v[152:155], v[24:39]
  s_xor_b32 s28, s24, 6
  s_lshl_b32 s28, s28, 13
  s_add_u32 s28, s28, 65536
  v_add_u32 v10, s28, v14
  v_add_u32 v11, s28, v15
  ds_read_b64_tr_b16 v[128:129], v12 offset:6144
  ds_read_b64_tr_b16 v[130:131], v12 offset:7168
  v_mfma_f32_32x32x16_bf16 v[40:55], v[108:111], v[152:155], v[40:55]
  s_andn2_b32 s33, s36, s34
  s_cbranch_scc0 .g2_kernel_w_i9c
.g2_kernel_w_i9b:
  s_ff1_i32_b32 s33, s33
  s_bitset1_b32 s34, s33
  s_xor_b32 s33, s33, s24
  ds_read_b64_tr_b16 v[132:133], v13 offset:6144
  ds_read_b64_tr_b16 v[134:135], v13 offset:7168
  s_waitcnt vmcnt(14) lgkmcnt(8)
  v_mfma_f32_32x32x16_bf16 v[24:39], v[112:115], v[156:159], v[24:39]
  s_and_b32 s9, s33, 7
  s_cmp_lt_u32 s9, 2
  s_cselect_b32 s28, 139264, 0
  s_lshl_b32 s9, s9, 13
  s_add_u32 s9, s9, s28
  ds_read_b64_tr_b16 v[104:105], v10 offset:0
  ds_read_b64_tr_b16 v[106:107], v10 offset:1024
  v_mfma_f32_32x32x16_bf16 v[40:55], v[116:119], v[156:159], v[40:55]
  s_lshl_b32 s33, s33, 12
  s_add_u32 s22, s20, s33
  s_addc_u32 s23, s21, 0
  global_load_dwordx4 v[176:179], v3, s[22:23] offset:0
  global_load_dwordx4 v[180:183], v3, s[22:23] offset:1024
  ds_read_b64_tr_b16 v[108:109], v11 offset:0
  ds_read_b64_tr_b16 v[110:111], v11 offset:1024
  s_waitcnt vmcnt(15) lgkmcnt(8)
  v_mfma_f32_32x32x16_bf16 v[24:39], v[120:123], v[160:163], v[24:39]
  global_load_dwordx4 v[184:187], v3, s[22:23] offset:2048
  global_load_dwordx4 v[188:191], v3, s[22:23] offset:3072
  v_lshlrev_b32 v16, 4, v17
  s_lshl_b32 s29, s18, 7
  buffer_load_dwordx4 v[240:243], v16, s[72:75], s29 offen offset:0
  ds_read_b64_tr_b16 v[112:113], v10 offset:2048
  ds_read_b64_tr_b16 v[114:115], v10 offset:3072
  v_mfma_f32_32x32x16_bf16 v[40:55], v[124:127], v[160:163], v[40:55]
  buffer_load_dwordx4 v[244:247], v16, s[72:75], s29 offen offset:32
  buffer_load_dwordx4 v[248:251], v16, s[72:75], s29 offen offset:64
  buffer_load_dwordx4 v[252:255], v16, s[72:75], s29 offen offset:96
  ds_read_b64_tr_b16 v[116:117], v11 offset:2048
  ds_read_b64_tr_b16 v[118:119], v11 offset:3072
  s_waitcnt vmcnt(20) lgkmcnt(8)
  v_mfma_f32_32x32x16_bf16 v[24:39], v[128:131], v[164:167], v[24:39]
  ds_read_b64_tr_b16 v[120:121], v10 offset:4096
  ds_read_b64_tr_b16 v[122:123], v10 offset:5120
  v_mfma_f32_32x32x16_bf16 v[40:55], v[132:135], v[164:167], v[40:55]
  ds_read_b64_tr_b16 v[124:125], v11 offset:4096
  ds_read_b64_tr_b16 v[126:127], v11 offset:5120
  s_waitcnt vmcnt(19) lgkmcnt(8)
  v_mfma_f32_32x32x16_bf16 v[24:39], v[104:107], v[56:59], v[24:39]
  s_xor_b32 s28, s24, 7
  s_lshl_b32 s28, s28, 13
  s_add_u32 s28, s28, 65536
  v_add_u32 v12, s28, v14
  ds_read_b64_tr_b16 v[128:129], v10 offset:6144
  ds_read_b64_tr_b16 v[130:131], v10 offset:7168
  v_mfma_f32_32x32x16_bf16 v[40:55], v[108:111], v[56:59], v[40:55]
  v_add_u32 v13, s28, v15
  s_andn2_b32 s33, s36, s34
  s_cbranch_scc0 .g2_kernel_w_i10c
.g2_kernel_w_i10b:
  s_ff1_i32_b32 s33, s33
  ds_read_b64_tr_b16 v[132:133], v11 offset:6144
  ds_read_b64_tr_b16 v[134:135], v11 offset:7168
  s_waitcnt vmcnt(18) lgkmcnt(8)
  v_mfma_f32_32x32x16_bf16 v[24:39], v[112:115], v[60:63], v[24:39]
  s_bitset1_b32 s34, s33
  s_xor_b32 s33, s33, s24
  s_and_b32 s10, s33, 7
  s_cmp_lt_u32 s10, 2
  ds_read_b64_tr_b16 v[104:105], v12 offset:0
  ds_read_b64_tr_b16 v[106:107], v12 offset:1024
  v_mfma_f32_32x32x16_bf16 v[40:55], v[116:119], v[60:63], v[40:55]
  s_cselect_b32 s28, 139264, 0
  s_lshl_b32 s10, s10, 13
  s_add_u32 s10, s10, s28
  s_lshl_b32 s33, s33, 12
  ds_read_b64_tr_b16 v[108:109], v13 offset:0
  ds_read_b64_tr_b16 v[110:111], v13 offset:1024
  s_waitcnt vmcnt(17) lgkmcnt(8)
  v_mfma_f32_32x32x16_bf16 v[24:39], v[120:123], v[64:67], v[24:39]
  s_add_u32 s22, s20, s33
  s_addc_u32 s23, s21, 0
  global_load_dwordx4 v[192:195], v3, s[22:23] offset:0
  global_load_dwordx4 v[196:199], v3, s[22:23] offset:1024
  ds_read_b64_tr_b16 v[112:113], v12 offset:2048
  ds_read_b64_tr_b16 v[114:115], v12 offset:3072
  v_mfma_f32_32x32x16_bf16 v[40:55], v[124:127], v[64:67], v[40:55]
  global_load_dwordx4 v[200:203], v3, s[22:23] offset:2048
  global_load_dwordx4 v[204:207], v3, s[22:23] offset:3072
  ds_read_b64_tr_b16 v[116:117], v13 offset:2048
  ds_read_b64_tr_b16 v[118:119], v13 offset:3072
  s_waitcnt vmcnt(20) lgkmcnt(8)
  v_mfma_f32_32x32x16_bf16 v[24:39], v[128:131], v[68:71], v[24:39]
  ds_read_b64_tr_b16 v[120:121], v12 offset:4096
  ds_read_b64_tr_b16 v[122:123], v12 offset:5120
  v_mfma_f32_32x32x16_bf16 v[40:55], v[132:135], v[68:71], v[40:55]
  ds_read_b64_tr_b16 v[124:125], v13 offset:4096
  ds_read_b64_tr_b16 v[126:127], v13 offset:5120
  s_waitcnt vmcnt(19) lgkmcnt(8)
  v_mfma_f32_32x32x16_bf16 v[24:39], v[104:107], v[72:75], v[24:39]
  s_andn2_b32 s33, s36, s34
  s_cbranch_scc0 .g2_kernel_w_i11c
.g2_kernel_w_i11b:
  s_ff1_i32_b32 s33, s33
  ds_read_b64_tr_b16 v[128:129], v12 offset:6144
  ds_read_b64_tr_b16 v[130:131], v12 offset:7168
  v_mfma_f32_32x32x16_bf16 v[40:55], v[108:111], v[72:75], v[40:55]
  s_bitset1_b32 s34, s33
  s_xor_b32 s33, s33, s24
  s_and_b32 s11, s33, 7
  ds_read_b64_tr_b16 v[132:133], v13 offset:6144
  ds_read_b64_tr_b16 v[134:135], v13 offset:7168
  s_waitcnt vmcnt(18) lgkmcnt(8)
  v_mfma_f32_32x32x16_bf16 v[24:39], v[112:115], v[76:79], v[24:39]
  s_cmp_lt_u32 s11, 2
  s_cselect_b32 s28, 139264, 0
  s_lshl_b32 s11, s11, 13
  v_mfma_f32_32x32x16_bf16 v[40:55], v[116:119], v[76:79], v[40:55]
  s_add_u32 s11, s11, s28
  s_lshl_b32 s33, s33, 12
  s_add_u32 s22, s20, s33
  s_waitcnt vmcnt(17) lgkmcnt(4)
  v_mfma_f32_32x32x16_bf16 v[24:39], v[120:123], v[80:83], v[24:39]
  s_addc_u32 s23, s21, 0
  global_load_dwordx4 v[208:211], v3, s[22:23] offset:0
  global_load_dwordx4 v[212:215], v3, s[22:23] offset:1024
  v_mfma_f32_32x32x16_bf16 v[40:55], v[124:127], v[80:83], v[40:55]
  global_load_dwordx4 v[216:219], v3, s[22:23] offset:2048
  global_load_dwordx4 v[220:223], v3, s[22:23] offset:3072
  s_waitcnt vmcnt(20) lgkmcnt(0)
  v_mfma_f32_32x32x16_bf16 v[24:39], v[128:131], v[84:87], v[24:39]
  v_mfma_f32_32x32x16_bf16 v[40:55], v[132:135], v[84:87], v[40:55]
  ds_read_b32 v16, v20 offset:12
  v_add_u32 v10, s8, v14
  v_add_u32 v11, s8, v15
  s_waitcnt lgkmcnt(0)
  v_cmp_gt_u32 vcc, 4, v16
  s_cbranch_vccnz .g2_kernel_w_bw
.g2_kernel_w_bb:
  ds_read_b64_tr_b16 v[104:105], v10 offset:0
  ds_read_b64_tr_b16 v[106:107], v10 offset:1024
  ds_read_b64_tr_b16 v[108:109], v11 offset:0
  ds_read_b64_tr_b16 v[110:111], v11 offset:1024
  ds_read_b64_tr_b16 v[112:113], v10 offset:2048
  ds_read_b64_tr_b16 v[114:115], v10 offset:3072
  ds_read_b64_tr_b16 v[116:117], v11 offset:2048
  ds_read_b64_tr_b16 v[118:119], v11 offset:3072
  ds_read_b64_tr_b16 v[120:121], v10 offset:4096
  ds_read_b64_tr_b16 v[122:123], v10 offset:5120
  ds_read_b64_tr_b16 v[124:125], v11 offset:4096
  ds_read_b64_tr_b16 v[126:127], v11 offset:5120
  s_waitcnt vmcnt(16)
  v_min3_u32 v6, v88, v90, v92
  v_min3_u32 v7, v94, v96, v98
  v_min3_u32 v6, v6, v100, v102
  v_min_u32 v6, v6, v7
  v_cmp_eq_u32 vcc, 0, v6
  s_cbranch_vccnz .g2_kernel_w_v8
.g2_kernel_w_vb8:
  s_waitcnt lgkmcnt(8)
  v_mfma_f32_32x32x16_bf16 v[24:39], v[104:107], v[88:91], v[24:39]
  v_add_u32 v12, s9, v14
  v_add_u32 v13, s9, v15
  s_andn2_b32 s33, s36, s34
  s_cbranch_scc0 .g2_kernel_w_i12c
.g2_kernel_w_i12b:
  ds_read_b64_tr_b16 v[128:129], v10 offset:6144
  ds_read_b64_tr_b16 v[130:131], v10 offset:7168
  v_mfma_f32_32x32x16_bf16 v[40:55], v[108:111], v[88:91], v[40:55]
  s_ff1_i32_b32 s33, s33
  s_bitset1_b32 s34, s33
  s_xor_b32 s33, s33, s24
  s_and_b32 s12, s33, 7
  ds_read_b64_tr_b16 v[132:133], v11 offset:6144
  ds_read_b64_tr_b16 v[134:135], v11 offset:7168
  s_waitcnt lgkmcnt(8)
  v_mfma_f32_32x32x16_bf16 v[24:39], v[112:115], v[92:95], v[24:39]
  s_cmp_lt_u32 s12, 2
  s_cselect_b32 s28, 139264, 0
  s_lshl_b32 s12, s12, 13
  s_add_u32 s12, s12, s28
  ds_read_b64_tr_b16 v[104:105], v12 offset:0
  ds_read_b64_tr_b16 v[106:107], v12 offset:1024
  v_mfma_f32_32x32x16_bf16 v[40:55], v[116:119], v[92:95], v[40:55]
  s_lshl_b32 s33, s33, 12
  s_add_u32 s22, s20, s33
  s_addc_u32 s23, s21, 0
  global_load_dwordx4 v[224:227], v3, s[22:23] offset:0
  ds_read_b64_tr_b16 v[108:109], v13 offset:0
  ds_read_b64_tr_b16 v[110:111], v13 offset:1024
  s_waitcnt lgkmcnt(8)
  v_mfma_f32_32x32x16_bf16 v[24:39], v[120:123], v[96:99], v[24:39]
  global_load_dwordx4 v[228:231], v3, s[22:23] offset:1024
  global_load_dwordx4 v[232:235], v3, s[22:23] offset:2048
  global_load_dwordx4 v[236:239], v3, s[22:23] offset:3072
  ds_read_b64_tr_b16 v[112:113], v12 offset:2048
  ds_read_b64_tr_b16 v[114:115], v12 offset:3072
  v_mfma_f32_32x32x16_bf16 v[40:55], v[124:127], v[96:99], v[40:55]
  ds_read_b64_tr_b16 v[116:117], v13 offset:2048
  ds_read_b64_tr_b16 v[118:119], v13 offset:3072
  s_waitcnt lgkmcnt(8)
  v_mfma_f32_32x32x16_bf16 v[24:39], v[128:131], v[100:103], v[24:39]
  ds_read_b64_tr_b16 v[120:121], v12 offset:4096
  ds_read_b64_tr_b16 v[122:123], v12 offset:5120
  s_waitcnt vmcnt(16)
  v_min3_u32 v6, v176, v178, v180
  v_min3_u32 v7, v182, v184, v186
  v_min3_u32 v6, v6, v188, v190
  v_min_u32 v6, v6, v7
  v_cmp_eq_u32 vcc, 0, v6
  v_mfma_f32_32x32x16_bf16 v[40:55], v[132:135], v[100:103], v[40:55]
  ds_read_b64_tr_b16 v[124:125], v13 offset:4096
  ds_read_b64_tr_b16 v[126:127], v13 offset:5120
  s_cbranch_vccnz .g2_kernel_w_v9
.g2_kernel_w_vb9:
  s_waitcnt lgkmcnt(8)
  v_mfma_f32_32x32x16_bf16 v[24:39], v[104:107], v[176:179], v[24:39]
  v_add_u32 v10, s10, v14
  v_add_u32 v11, s10, v15
  s_andn2_b32 s33, s36, s34
  s_cbranch_scc0 .g2_kernel_w_i13c
.g2_kernel_w_i13b:
  ds_read_b64_tr_b16 v[128:129], v12 offset:6144
  ds_read_b64_tr_b16 v[130:131], v12 offset:7168
  v_mfma_f32_32x32x16_bf16 v[40:55], v[108:111], v[176:179], v[40:55]
  s_ff1_i32_b32 s33, s33
  s_bitset1_b32 s34, s33
  s_xor_b32 s33, s33, s24
  s_and_b32 s13, s33, 7
  ds_read_b64_tr_b16 v[132:133], v13 offset:6144
  ds_read_b64_tr_b16 v[134:135], v13 offset:7168
  s_waitcnt lgkmcnt(8)
  v_mfma_f32_32x32x16_bf16 v[24:39], v[112:115], v[180:183], v[24:39]
  s_cmp_lt_u32 s13, 2
  s_cselect_b32 s28, 139264, 0
  s_lshl_b32 s13, s13, 13
  s_add_u32 s13, s13, s28
  ds_read_b64_tr_b16 v[104:105], v10 offset:0
  ds_read_b64_tr_b16 v[106:107], v10 offset:1024
  v_mfma_f32_32x32x16_bf16 v[40:55], v[116:119], v[180:183], v[40:55]
  s_lshl_b32 s33, s33, 12
  s_add_u32 s22, s20, s33
  s_addc_u32 s23, s21, 0
  global_load_dwordx4 v[136:139], v3, s[22:23] offset:0
  ds_read_b64_tr_b16 v[108:109], v11 offset:0
  ds_read_b64_tr_b16 v[110:111], v11 offset:1024
  s_waitcnt lgkmcnt(8)
  v_mfma_f32_32x32x16_bf16 v[24:39], v[120:123], v[184:187], v[24:39]
  global_load_dwordx4 v[140:143], v3, s[22:23] offset:1024
  global_load_dwordx4 v[144:147], v3, s[22:23] offset:2048
  global_load_dwordx4 v[148:151], v3, s[22:23] offset:3072
  ds_read_b64_tr_b16 v[112:113], v10 offset:2048
  ds_read_b64_tr_b16 v[114:115], v10 offset:3072
  v_mfma_f32_32x32x16_bf16 v[40:55], v[124:127], v[184:187], v[40:55]
  ds_read_b64_tr_b16 v[116:117], v11 offset:2048
  ds_read_b64_tr_b16 v[118:119], v11 offset:3072
  s_waitcnt lgkmcnt(8)
  v_mfma_f32_32x32x16_bf16 v[24:39], v[128:131], v[188:191], v[24:39]
  ds_read_b64_tr_b16 v[120:121], v10 offset:4096
  ds_read_b64_tr_b16 v[122:123], v10 offset:5120
  s_waitcnt vmcnt(12)
  v_min3_u32 v6, v192, v194, v196
  v_min3_u32 v7, v198, v200, v202
  v_min3_u32 v6, v6, v204, v206
  v_min_u32 v6, v6, v7
  v_cmp_eq_u32 vcc, 0, v6
  v_mfma_f32_32x32x16_bf16 v[40:55], v[132:135], v[188:191], v[40:55]
  ds_read_b64_tr_b16 v[124:125], v11 offset:4096
  ds_read_b64_tr_b16 v[126:127], v11 offset:5120
  s_cbranch_vccnz .g2_kernel_w_v10
.g2_kernel_w_vb10:
  s_waitcnt lgkmcnt(8)
  v_mfma_f32_32x32x16_bf16 v[24:39], v[104:107], v[192:195], v[24:39]
  v_add_u32 v12, s11, v14
  v_add_u32 v13, s11, v15
  s_andn2_b32 s33, s36, s34
  s_cbranch_scc0 .g2_kernel_w_i14c
.g2_kernel_w_i14b:
  ds_read_b64_tr_b16 v[128:129], v10 offset:6144
  ds_read_b64_tr_b16 v[130:131], v10 offset:7168
  v_mfma_f32_32x32x16_bf16 v[40:55], v[108:111], v[192:195], v[40:55]
  s_ff1_i32_b32 s33, s33
  s_bitset1_b32 s34, s33
  s_xor_b32 s33, s33, s24
  s_and_b32 s14, s33, 7
  ds_read_b64_tr_b16 v[132:133], v11 offset:6144
  ds_read_b64_tr_b16 v[134:135], v11 offset:7168
  s_waitcnt lgkmcnt(8)
  v_mfma_f32_32x32x16_bf16 v[24:39], v[112:115], v[196:199], v[24:39]
  s_cmp_lt_u32 s14, 2
  s_cselect_b32 s28, 139264, 0
  s_lshl_b32 s14, s14, 13
  s_add_u32 s14, s14, s28
  ds_read_b64_tr_b16 v[104:105], v12 offset:0
  ds_read_b64_tr_b16 v[106:107], v12 offset:1024
  v_mfma_f32_32x32x16_bf16 v[40:55], v[116:119], v[196:199], v[40:55]
  s_lshl_b32 s33, s33, 12
  s_add_u32 s22, s20, s33
  s_addc_u32 s23, s21, 0
  global_load_dwordx4 v[152:155], v3, s[22:23] offset:0 sc1
  ds_read_b64_tr_b16 v[108:109], v13 offset:0
  ds_read_b64_tr_b16 v[110:111], v13 offset:1024
  s_waitcnt lgkmcnt(8)
  v_mfma_f32_32x32x16_bf16 v[24:39], v[120:123], v[200:203], v[24:39]
  global_load_dwordx4 v[156:159], v3, s[22:23] offset:1024 sc1
  global_load_dwordx4 v[160:163], v3, s[22:23] offset:2048 sc1
  global_load_dwordx4 v[164:167], v3, s[22:23] offset:3072 sc1
  ds_read_b64_tr_b16 v[112:113], v12 offset:2048
  ds_read_b64_tr_b16 v[114:115], v12 offset:3072
  v_mfma_f32_32x32x16_bf16 v[40:55], v[124:127], v[200:203], v[40:55]
  ds_read_b64_tr_b16 v[116:117], v13 offset:2048
  ds_read_b64_tr_b16 v[118:119], v13 offset:3072
  s_waitcnt lgkmcnt(8)
  v_mfma_f32_32x32x16_bf16 v[24:39], v[128:131], v[204:207], v[24:39]
  ds_read_b64_tr_b16 v[120:121], v12 offset:4096
  ds_read_b64_tr_b16 v[122:123], v12 offset:5120
  s_waitcnt vmcnt(12)
  v_min3_u32 v6, v208, v210, v212
  v_min3_u32 v7, v214, v216, v218
  v_min3_u32 v6, v6, v220, v222
  v_min_u32 v6, v6, v7
  v_cmp_eq_u32 vcc, 0, v6
  v_mfma_f32_32x32x16_bf16 v[40:55], v[132:135], v[204:207], v[40:55]
  ds_read_b64_tr_b16 v[124:125], v13 offset:4096
  ds_read_b64_tr_b16 v[126:127], v13 offset:5120
  s_cbranch_vccnz .g2_kernel_w_v11
.g2_kernel_w_vb11:
  s_mov_b64 exec, 1
  ds_add_u32 v20, v5 offset:16
  s_mov_b64 exec, -1
  s_waitcnt lgkmcnt(8)
  v_mfma_f32_32x32x16_bf16 v[24:39], v[104:107], v[208:211], v[24:39]
  v_add_u32 v10, s12, v14
  v_add_u32 v11, s12, v15
  s_andn2_b32 s33, s36, s34
  s_cbranch_scc0 .g2_kernel_w_i15c
.g2_kernel_w_i15b:
  ds_read_b64_tr_b16 v[128:129], v12 offset:6144
  ds_read_b64_tr_b16 v[130:131], v12 offset:7168
  v_mfma_f32_32x32x16_bf16 v[40:55], v[108:111], v[208:211], v[40:55]
  s_ff1_i32_b32 s33, s33
  s_bitset1_b32 s34, s33
  s_xor_b32 s33, s33, s24
  s_and_b32 s15, s33, 7
  ds_read_b64_tr_b16 v[132:133], v13 offset:6144
  ds_read_b64_tr_b16 v[134:135], v13 offset:7168
  s_waitcnt lgkmcnt(8)
  v_mfma_f32_32x32x16_bf16 v[24:39], v[112:115], v[212:215], v[24:39]
  s_cmp_lt_u32 s15, 2
  s_cselect_b32 s28, 139264, 0
  s_lshl_b32 s15, s15, 13
  s_add_u32 s15, s15, s28
  ds_read_b64_tr_b16 v[104:105], v10 offset:0
  ds_read_b64_tr_b16 v[106:107], v10 offset:1024
  v_mfma_f32_32x32x16_bf16 v[40:55], v[116:119], v[212:215], v[40:55]
  s_lshl_b32 s33, s33, 12
  s_add_u32 s22, s20, s33
  s_addc_u32 s23, s21, 0
  global_load_dwordx4 v[56:59], v3, s[22:23] offset:0 sc1
  ds_read_b64_tr_b16 v[108:109], v11 offset:0
  ds_read_b64_tr_b16 v[110:111], v11 offset:1024
  s_waitcnt lgkmcnt(8)
  v_mfma_f32_32x32x16_bf16 v[24:39], v[120:123], v[216:219], v[24:39]
  global_load_dwordx4 v[60:63], v3, s[22:23] offset:1024 sc1
  global_load_dwordx4 v[64:67], v3, s[22:23] offset:2048 sc1
  global_load_dwordx4 v[68:71], v3, s[22:23] offset:3072 sc1
  ds_read_b64_tr_b16 v[112:113], v10 offset:2048
  ds_read_b64_tr_b16 v[114:115], v10 offset:3072
  v_mfma_f32_32x32x16_bf16 v[40:55], v[124:127], v[216:219], v[40:55]
  ds_read_b64_tr_b16 v[116:117], v11 offset:2048
  ds_read_b64_tr_b16 v[118:119], v11 offset:3072
  s_waitcnt lgkmcnt(8)
  v_mfma_f32_32x32x16_bf16 v[24:39], v[128:131], v[220:223], v[24:39]
  ds_read_b64_tr_b16 v[120:121], v10 offset:4096
  ds_read_b64_tr_b16 v[122:123], v10 offset:5120
  s_waitcnt vmcnt(12)
  v_min3_u32 v6, v224, v226, v228
  v_min3_u32 v7, v230, v232, v234
  v_min3_u32 v6, v6, v236, v238
  v_min_u32 v6, v6, v7
  v_cmp_eq_u32 vcc, 0, v6
  v_mfma_f32_32x32x16_bf16 v[40:55], v[132:135], v[220:223], v[40:55]
  ds_read_b64_tr_b16 v[124:125], v11 offset:4096
  ds_read_b64_tr_b16 v[126:127], v11 offset:5120
  s_cbranch_vccnz .g2_kernel_w_v12
.g2_kernel_w_vb12:
  s_waitcnt lgkmcnt(8)
  v_mfma_f32_32x32x16_bf16 v[24:39], v[104:107], v[224:227], v[24:39]
  v_add_u32 v12, s13, v14
  v_add_u32 v13, s13, v15
  ds_read_b64_tr_b16 v[128:129], v10 offset:6144
  ds_read_b64_tr_b16 v[130:131], v10 offset:7168
  v_mfma_f32_32x32x16_bf16 v[40:55], v[108:111], v[224:227], v[40:55]
  ds_read_b64_tr_b16 v[132:133], v11 offset:6144
  ds_read_b64_tr_b16 v[134:135], v11 offset:7168
  s_waitcnt lgkmcnt(8)
  v_mfma_f32_32x32x16_bf16 v[24:39], v[112:115], v[228:231], v[24:39]
  ds_read_b64_tr_b16 v[104:105], v12 offset:0
  ds_read_b64_tr_b16 v[106:107], v12 offset:1024
  v_mfma_f32_32x32x16_bf16 v[40:55], v[116:119], v[228:231], v[40:55]
  ds_read_b64_tr_b16 v[108:109], v13 offset:0
  ds_read_b64_tr_b16 v[110:111], v13 offset:1024
  s_waitcnt lgkmcnt(8)
  v_mfma_f32_32x32x16_bf16 v[24:39], v[120:123], v[232:235], v[24:39]
  ds_read_b64_tr_b16 v[112:113], v12 offset:2048
  ds_read_b64_tr_b16 v[114:115], v12 offset:3072
  v_mfma_f32_32x32x16_bf16 v[40:55], v[124:127], v[232:235], v[40:55]
  ds_read_b64_tr_b16 v[116:117], v13 offset:2048
  ds_read_b64_tr_b16 v[118:119], v13 offset:3072
  s_waitcnt lgkmcnt(8)
  v_mfma_f32_32x32x16_bf16 v[24:39], v[128:131], v[236:239], v[24:39]
  ds_read_b64_tr_b16 v[120:121], v12 offset:4096
  ds_read_b64_tr_b16 v[122:123], v12 offset:5120
  s_waitcnt vmcnt(8)
  v_min3_u32 v6, v136, v138, v140
  v_min3_u32 v7, v142, v144, v146
  v_min3_u32 v6, v6, v148, v150
  v_min_u32 v6, v6, v7
  v_cmp_eq_u32 vcc, 0, v6
  v_mfma_f32_32x32x16_bf16 v[40:55], v[132:135], v[236:239], v[40:55]
  ds_read_b64_tr_b16 v[124:125], v13 offset:4096
  ds_read_b64_tr_b16 v[126:127], v13 offset:5120
  s_cbranch_vccnz .g2_kernel_w_v13
.g2_kernel_w_vb13:
  s_waitcnt lgkmcnt(8)
  v_mfma_f32_32x32x16_bf16 v[24:39], v[104:107], v[136:139], v[24:39]
  v_add_u32 v10, s14, v14
  v_add_u32 v11, s14, v15
  ds_read_b64_tr_b16 v[128:129], v12 offset:6144
  ds_read_b64_tr_b16 v[130:131], v12 offset:7168
  v_mfma_f32_32x32x16_bf16 v[40:55], v[108:111], v[136:139], v[40:55]
  ds_read_b64_tr_b16 v[132:133], v13 offset:6144
  ds_read_b64_tr_b16 v[134:135], v13 offset:7168
  s_waitcnt lgkmcnt(8)
  v_mfma_f32_32x32x16_bf16 v[24:39], v[112:115], v[140:143], v[24:39]
  ds_read_b64_tr_b16 v[104:105], v10 offset:0
  ds_read_b64_tr_b16 v[106:107], v10 offset:1024
  v_mfma_f32_32x32x16_bf16 v[40:55], v[116:119], v[140:143], v[40:55]
  ds_read_b64_tr_b16 v[108:109], v11 offset:0
  ds_read_b64_tr_b16 v[110:111], v11 offset:1024
  s_waitcnt lgkmcnt(8)
  v_mfma_f32_32x32x16_bf16 v[24:39], v[120:123], v[144:147], v[24:39]
  ds_read_b64_tr_b16 v[112:113], v10 offset:2048
  ds_read_b64_tr_b16 v[114:115], v10 offset:3072
  v_mfma_f32_32x32x16_bf16 v[40:55], v[124:127], v[144:147], v[40:55]
  ds_read_b64_tr_b16 v[116:117], v11 offset:2048
  ds_read_b64_tr_b16 v[118:119], v11 offset:3072
  s_waitcnt lgkmcnt(8)
  v_mfma_f32_32x32x16_bf16 v[24:39], v[128:131], v[148:151], v[24:39]
  ds_read_b64_tr_b16 v[120:121], v10 offset:4096
  ds_read_b64_tr_b16 v[122:123], v10 offset:5120
  s_waitcnt vmcnt(4)
  v_min3_u32 v6, v152, v154, v156
  v_min3_u32 v7, v158, v160, v162
  v_min3_u32 v6, v6, v164, v166
  v_min_u32 v6, v6, v7
  v_cmp_eq_u32 vcc, 0, v6
  v_mfma_f32_32x32x16_bf16 v[40:55], v[132:135], v[148:151], v[40:55]
  ds_read_b64_tr_b16 v[124:125], v11 offset:4096
  ds_read_b64_tr_b16 v[126:127], v11 offset:5120
  s_cbranch_vccnz .g2_kernel_w_v14
.g2_kernel_w_vb14:
  s_waitcnt lgkmcnt(8)
  v_mfma_f32_32x32x16_bf16 v[24:39], v[104:107], v[152:155], v[24:39]
  v_add_u32 v12, s15, v14
  v_add_u32 v13, s15, v15
  ds_read_b64_tr_b16 v[128:129], v10 offset:6144
  ds_read_b64_tr_b16 v[130:131], v10 offset:7168
  v_mfma_f32_32x32x16_bf16 v[40:55], v[108:111], v[152:155], v[40:55]
  ds_read_b64_tr_b16 v[132:133], v11 offset:6144
  ds_read_b64_tr_b16 v[134:135], v11 offset:7168
  s_waitcnt lgkmcnt(8)
  v_mfma_f32_32x32x16_bf16 v[24:39], v[112:115], v[156:159], v[24:39]
  ds_read_b64_tr_b16 v[104:105], v12 offset:0
  ds_read_b64_tr_b16 v[106:107], v12 offset:1024
  v_mfma_f32_32x32x16_bf16 v[40:55], v[116:119], v[156:159], v[40:55]
  ds_read_b64_tr_b16 v[108:109], v13 offset:0
  ds_read_b64_tr_b16 v[110:111], v13 offset:1024
  s_waitcnt lgkmcnt(8)
  v_mfma_f32_32x32x16_bf16 v[24:39], v[120:123], v[160:163], v[24:39]
  ds_read_b64_tr_b16 v[112:113], v12 offset:2048
  ds_read_b64_tr_b16 v[114:115], v12 offset:3072
  v_mfma_f32_32x32x16_bf16 v[40:55], v[124:127], v[160:163], v[40:55]
  ds_read_b64_tr_b16 v[116:117], v13 offset:2048
  ds_read_b64_tr_b16 v[118:119], v13 offset:3072
  s_waitcnt lgkmcnt(8)
  v_mfma_f32_32x32x16_bf16 v[24:39], v[128:131], v[164:167], v[24:39]
  ds_read_b64_tr_b16 v[120:121], v12 offset:4096
  ds_read_b64_tr_b16 v[122:123], v12 offset:5120
  s_waitcnt vmcnt(0)
  v_min3_u32 v6, v56, v58, v60
  v_min3_u32 v7, v62, v64, v66
  v_min3_u32 v6, v6, v68, v70
  v_min_u32 v6, v6, v7
  v_cmp_eq_u32 vcc, 0, v6
  v_mfma_f32_32x32x16_bf16 v[40:55], v[132:135], v[164:167], v[40:55]
  ds_read_b64_tr_b16 v[124:125], v13 offset:4096
  ds_read_b64_tr_b16 v[126:127], v13 offset:5120
  s_cbranch_vccnz .g2_kernel_w_v15
.g2_kernel_w_vb15:
  s_waitcnt lgkmcnt(8)
  v_mfma_f32_32x32x16_bf16 v[24:39], v[104:107], v[56:59], v[24:39]
  ds_read_b64_tr_b16 v[128:129], v12 offset:6144
  ds_read_b64_tr_b16 v[130:131], v12 offset:7168
  v_mfma_f32_32x32x16_bf16 v[40:55], v[108:111], v[56:59], v[40:55]
  ds_read_b64_tr_b16 v[132:133], v13 offset:6144
  ds_read_b64_tr_b16 v[134:135], v13 offset:7168
  s_waitcnt lgkmcnt(8)
  v_mfma_f32_32x32x16_bf16 v[24:39], v[112:115], v[60:63], v[24:39]
  v_mfma_f32_32x32x16_bf16 v[40:55], v[116:119], v[60:63], v[40:55]
  s_waitcnt lgkmcnt(4)
  v_mfma_f32_32x32x16_bf16 v[24:39], v[120:123], v[64:67], v[24:39]
  v_mfma_f32_32x32x16_bf16 v[40:55], v[124:127], v[64:67], v[40:55]
  s_waitcnt lgkmcnt(0)
  v_mfma_f32_32x32x16_bf16 v[24:39], v[128:131], v[68:71], v[24:39]
  v_mfma_f32_32x32x16_bf16 v[40:55], v[132:135], v[68:71], v[40:55]
  s_lshl_b32 s28, s17, 4
  s_add_u32 s28, s28, s18
  s_lshl_b32 s28, s28, 2
  s_add_u32 s28, s28, s16
  s_lshl_b32 s28, s28, 12
  s_add_u32 s28, s28, s63
  s_add_u32 s28, s28, 0xc00000
  s_lshl_b32 s29, s16, 12
  v_add_u32 v6, s29, v22
  s_mov_b32 s36, 0x3f803f80
  v_mov_b32 v8, 0
  v_mov_b32 v9, 0
  v_mov_b32 v10, 0
  v_cvt_pk_bf16_f32 v56, v24, v25
  v_cvt_pk_bf16_f32 v57, v26, v27
  v_cvt_pk_bf16_f32 v58, v28, v29
  v_cvt_pk_bf16_f32 v59, v30, v31
  buffer_store_dwordx4 v[56:59], v22, s[4:7], s28 offen offset:0 sc1
  v_cvt_pk_bf16_f32 v60, v32, v33
  v_cvt_pk_bf16_f32 v61, v34, v35
  v_cvt_pk_bf16_f32 v62, v36, v37
  v_cvt_pk_bf16_f32 v63, v38, v39
  buffer_store_dwordx4 v[60:63], v22, s[4:7], s28 offen offset:512 sc1
  v_cvt_pk_bf16_f32 v64, v40, v41
  v_cvt_pk_bf16_f32 v65, v42, v43
  v_cvt_pk_bf16_f32 v66, v44, v45
  v_cvt_pk_bf16_f32 v67, v46, v47
  buffer_store_dwordx4 v[64:67], v22, s[4:7], s28 offen offset:1024 sc1
  v_cvt_pk_bf16_f32 v68, v48, v49
  v_cvt_pk_bf16_f32 v69, v50, v51
  v_cvt_pk_bf16_f32 v70, v52, v53
  v_cvt_pk_bf16_f32 v71, v54, v55
  buffer_store_dwordx4 v[68:71], v22, s[4:7], s28 offen offset:1536 sc1
  ds_write_b128 v6, v[56:59] offset:0
  ds_write_b128 v6, v[60:63] offset:512
  ds_write_b128 v6, v[64:67] offset:1024
  ds_write_b128 v6, v[68:71] offset:1536
  s_mov_b64 exec, 1
  ds_add_u32 v20, v5 offset:20
  s_mov_b64 exec, -1
  s_lshl_b32 s28, s17, 2
  s_add_u32 s28, s28, s16
  s_lshl_b32 s28, s28, 13
  s_lshl_b32 s29, s18, 9
  s_add_u32 s28, s28, s29
  s_add_u32 s28, s28, s63
  s_add_u32 s28, s28, 0x1000000
  v_dot2c_f32_bf16 v8, s36, v56
  v_dot2c_f32_bf16 v9, v56, v56
  v_dot2c_f32_bf16 v10, v56, v240
  v_dot2c_f32_bf16 v8, s36, v57
  v_dot2c_f32_bf16 v9, v57, v57
  v_dot2c_f32_bf16 v10, v57, v241
  v_dot2c_f32_bf16 v8, s36, v58
  v_dot2c_f32_bf16 v9, v58, v58
  v_dot2c_f32_bf16 v10, v58, v242
  v_dot2c_f32_bf16 v8, s36, v59
  v_dot2c_f32_bf16 v9, v59, v59
  v_dot2c_f32_bf16 v10, v59, v243
  v_dot2c_f32_bf16 v8, s36, v60
  v_dot2c_f32_bf16 v9, v60, v60
  v_dot2c_f32_bf16 v10, v60, v244
  v_dot2c_f32_bf16 v8, s36, v61
  v_dot2c_f32_bf16 v9, v61, v61
  v_dot2c_f32_bf16 v10, v61, v245
  v_dot2c_f32_bf16 v8, s36, v62
  v_dot2c_f32_bf16 v9, v62, v62
  v_dot2c_f32_bf16 v10, v62, v246
  v_dot2c_f32_bf16 v8, s36, v63
  v_dot2c_f32_bf16 v9, v63, v63
  v_dot2c_f32_bf16 v10, v63, v247
  v_dot2c_f32_bf16 v8, s36, v64
  v_dot2c_f32_bf16 v9, v64, v64
  v_dot2c_f32_bf16 v10, v64, v248
  v_dot2c_f32_bf16 v8, s36, v65
  v_dot2c_f32_bf16 v9, v65, v65
  v_dot2c_f32_bf16 v10, v65, v249
  v_dot2c_f32_bf16 v8, s36, v66
  v_dot2c_f32_bf16 v9, v66, v66
  v_dot2c_f32_bf16 v10, v66, v250
  v_dot2c_f32_bf16 v8, s36, v67
  v_dot2c_f32_bf16 v9, v67, v67
  v_dot2c_f32_bf16 v10, v67, v251
  v_dot2c_f32_bf16 v8, s36, v68
  v_dot2c_f32_bf16 v9, v68, v68
  v_dot2c_f32_bf16 v10, v68, v252
  v_dot2c_f32_bf16 v8, s36, v69
  v_dot2c_f32_bf16 v9, v69, v69
  v_dot2c_f32_bf16 v10, v69, v253
  v_dot2c_f32_bf16 v8, s36, v70
  v_dot2c_f32_bf16 v9, v70, v70
  v_dot2c_f32_bf16 v10, v70, v254
  v_dot2c_f32_bf16 v8, s36, v71
  v_dot2c_f32_bf16 v9, v71, v71
  v_dot2c_f32_bf16 v10, v71, v255
  s_lshl_b32 s29, s16, 7
  s_add_u32 s37, s19, s29
  v_mov_b32 v24, v8
  v_mov_b32 v25, v9
  v_mov_b32 v26, v10
  v_mov_b32 v11, 1
  v_permlane32_swap_b32 v8, v24
  v_permlane32_swap_b32 v9, v25
  v_permlane32_swap_b32 v10, v26
  v_add_f32 v8, v8, v24
  v_add_f32 v9, v9, v25
  v_add_f32 v10, v10, v26
  v_or_b32 v8, 1, v8
  v_mov_b32 v16, s70
  s_mov_b32 exec_hi, 0
  s_waitcnt vmcnt(0)
  buffer_store_dwordx4 v[8:11], v3, s[4:7], s28 offen sc1
  s_mov_b64 exec, 1
  buffer_store_dword v16, v4, s[4:7], s37 offen offset:8 sc1
  s_mov_b64 exec, -1
  s_cmp_lg_u32 s62, 0
  s_cbranch_scc1 .g2_kernel_tail
  s_mov_b32 s62, 1
  s_mov_b32 s63, 0x1800000
  s_mov_b32 s70, 2
  s_mov_b32 s71, 155776
  s_branch .g2_kernel_q_cons2
.g2_kernel_tail:
  s_mov_b32 s28, s56
  s_mov_b32 s29, s57
  s_mov_b32 s30, 0x400000
  s_mov_b32 s31, 0x00020000
  v_lshrrev_b32 v8, 3, v2
  v_and_b32 v9, 7, v2
  v_lshlrev_b32 v10, 8, v9
  v_lshl_add_u32 v10, v8, 4, v10
  s_lshl_b32 s32, s16, 12
  v_add_u32 v10, s32, v10
  ds_read_b128 v[56:59], v10 offset:0
  ds_read_b128 v[60:63], v10 offset:128
  ds_read_b128 v[64:67], v10 offset:2048
  ds_read_b128 v[68:71], v10 offset:2176
  v_lshlrev_b32 v23, 11, v8
  v_lshl_add_u32 v23, v9, 4, v23
  s_lshl_b32 s32, s16, 5
  v_add_u32 v19, s32, v8
  v_lshlrev_b32 v10, 2, v19
  v_add_u32 v10, 155648, v10
  s_lshl_b32 s32, s17, 2
  s_add_u32 s32, s32, s16
  s_lshl_b32 s32, s32, 16
  s_lshl_b32 s33, s18, 7
  s_add_u32 s32, s32, s33
  s_waitcnt lgkmcnt(0)
  v_lshlrev_b32 v24, 16, v56
  v_and_b32 v25, 0xffff0000, v56
  v_lshlrev_b32 v26, 16, v57
  v_and_b32 v27, 0xffff0000, v57
  v_lshlrev_b32 v28, 16, v58
  v_and_b32 v29, 0xffff0000, v58
  v_lshlrev_b32 v30, 16, v59
  v_and_b32 v31, 0xffff0000, v59
  v_lshlrev_b32 v32, 16, v60
  v_and_b32 v33, 0xffff0000, v60
  v_lshlrev_b32 v34, 16, v61
  v_and_b32 v35, 0xffff0000, v61
  v_lshlrev_b32 v36, 16, v62
  v_and_b32 v37, 0xffff0000, v62
  v_lshlrev_b32 v38, 16, v63
  v_and_b32 v39, 0xffff0000, v63
  v_lshlrev_b32 v40, 16, v64
  v_and_b32 v41, 0xffff0000, v64
  v_lshlrev_b32 v42, 16, v65
  v_and_b32 v43, 0xffff0000, v65
  v_lshlrev_b32 v44, 16, v66
  v_and_b32 v45, 0xffff0000, v66
  v_lshlrev_b32 v46, 16, v67
  v_and_b32 v47, 0xffff0000, v67
  v_lshlrev_b32 v48, 16, v68
  v_and_b32 v49, 0xffff0000, v68
  v_lshlrev_b32 v50, 16, v69
  v_and_b32 v51, 0xffff0000, v69
  v_lshlrev_b32 v52, 16, v70
  v_and_b32 v53, 0xffff0000, v70
  v_lshlrev_b32 v54, 16, v71
  v_and_b32 v55, 0xffff0000, v71
  v_mov_b32 v6, s71
  s_mov_b32 s38, 0
.g2_kernel_wg7:
  ds_read_b32 v7, v6 offset:28
  s_add_u32 s38, s38, 1
  s_waitcnt lgkmcnt(0)
  v_cmp_gt_u32 vcc, 1, v7
  s_cbranch_vccz .g2_kernel_wg7d
  s_sleep 2
  s_cmp_lt_u32 s38, 524288
  s_cbranch_scc1 .g2_kernel_wg7
.g2_kernel_wg7d:
  ds_read_b32 v16, v20 offset:32
  ds_read_b32 v72, v10 offset:3840
  ds_read_b32 v73, v10 offset:4352
  ds_read_b32 v74, v10 offset:3872
  ds_read_b32 v75, v10 offset:4384
  ds_read_b32 v76, v10 offset:3904
  ds_read_b32 v77, v10 offset:4416
  ds_read_b32 v78, v10 offset:3936
  ds_read_b32 v79, v10 offset:4448
  s_waitcnt lgkmcnt(0)
  v_sub_u32 v16, v16, v19
  v_pk_fma_f32 v[24:25], v[24:25], v[72:73], v[72:73] op_sel:[0,0,1] op_sel_hi:[1,0,1]
  v_pk_fma_f32 v[26:27], v[26:27], v[72:73], v[72:73] op_sel:[0,0,1] op_sel_hi:[1,0,1]
  v_pk_fma_f32 v[28:29], v[28:29], v[72:73], v[72:73] op_sel:[0,0,1] op_sel_hi:[1,0,1]
  v_pk_fma_f32 v[30:31], v[30:31], v[72:73], v[72:73] op_sel:[0,0,1] op_sel_hi:[1,0,1]
  v_cvt_pk_bf16_f32 v56, v24, v25
  v_cvt_pk_bf16_f32 v57, v26, v27
  v_cvt_pk_bf16_f32 v58, v28, v29
  v_cvt_pk_bf16_f32 v59, v30, v31
  v_cmp_ne_u32 vcc, 1, v16
  s_mov_b64 exec, vcc
  buffer_store_dwordx4 v[56:59], v23, s[28:31], s32 offen sc1
  s_mov_b64 exec, -1
  s_add_u32 s32, s32, 16384
  v_pk_fma_f32 v[32:33], v[32:33], v[74:75], v[74:75] op_sel:[0,0,1] op_sel_hi:[1,0,1]
  v_pk_fma_f32 v[34:35], v[34:35], v[74:75], v[74:75] op_sel:[0,0,1] op_sel_hi:[1,0,1]
  v_pk_fma_f32 v[36:37], v[36:37], v[74:75], v[74:75] op_sel:[0,0,1] op_sel_hi:[1,0,1]
  v_pk_fma_f32 v[38:39], v[38:39], v[74:75], v[74:75] op_sel:[0,0,1] op_sel_hi:[1,0,1]
  v_cvt_pk_bf16_f32 v60, v32, v33
  v_cvt_pk_bf16_f32 v61, v34, v35
  v_cvt_pk_bf16_f32 v62, v36, v37
  v_cvt_pk_bf16_f32 v63, v38, v39
  v_cmp_ne_u32 vcc, 9, v16
  s_mov_b64 exec, vcc
  buffer_store_dwordx4 v[60:63], v23, s[28:31], s32 offen sc1
  s_mov_b64 exec, -1
  s_add_u32 s32, s32, 16384
  v_pk_fma_f32 v[40:41], v[40:41], v[76:77], v[76:77] op_sel:[0,0,1] op_sel_hi:[1,0,1]
  v_pk_fma_f32 v[42:43], v[42:43], v[76:77], v[76:77] op_sel:[0,0,1] op_sel_hi:[1,0,1]
  v_pk_fma_f32 v[44:45], v[44:45], v[76:77], v[76:77] op_sel:[0,0,1] op_sel_hi:[1,0,1]
  v_pk_fma_f32 v[46:47], v[46:47], v[76:77], v[76:77] op_sel:[0,0,1] op_sel_hi:[1,0,1]
  v_cvt_pk_bf16_f32 v64, v40, v41
  v_cvt_pk_bf16_f32 v65, v42, v43
  v_cvt_pk_bf16_f32 v66, v44, v45
  v_cvt_pk_bf16_f32 v67, v46, v47
  v_cmp_ne_u32 vcc, 17, v16
  s_mov_b64 exec, vcc
  buffer_store_dwordx4 v[64:67], v23, s[28:31], s32 offen sc1
  s_mov_b64 exec, -1
  s_add_u32 s32, s32, 16384
  v_pk_fma_f32 v[48:49], v[48:49], v[78:79], v[78:79] op_sel:[0,0,1] op_sel_hi:[1,0,1]
  v_pk_fma_f32 v[50:51], v[50:51], v[78:79], v[78:79] op_sel:[0,0,1] op_sel_hi:[1,0,1]
  v_pk_fma_f32 v[52:53], v[52:53], v[78:79], v[78:79] op_sel:[0,0,1] op_sel_hi:[1,0,1]
  v_pk_fma_f32 v[54:55], v[54:55], v[78:79], v[78:79] op_sel:[0,0,1] op_sel_hi:[1,0,1]
  v_cvt_pk_bf16_f32 v68, v48, v49
  v_cvt_pk_bf16_f32 v69, v50, v51
  v_cvt_pk_bf16_f32 v70, v52, v53
  v_cvt_pk_bf16_f32 v71, v54, v55
  v_cmp_ne_u32 vcc, 25, v16
  s_mov_b64 exec, vcc
  buffer_store_dwordx4 v[68:71], v23, s[28:31], s32 offen sc1
  s_mov_b64 exec, -1
  s_add_u32 s32, s32, 16384
  s_branch .g2_kernel_fin
.g2_kernel_svc:
  s_cmp_eq_u32 s16, 5
  s_cbranch_scc1 .g2_kernel_s1
  s_cmp_eq_u32 s16, 6
  s_cbranch_scc1 .g2_kernel_s2
  s_cmp_eq_u32 s16, 7
  s_cbranch_scc1 .g2_kernel_s3
  s_mov_b32 s8, s40
  s_mov_b32 s9, s41
  s_mov_b32 s10, 0x400000
  s_mov_b32 s11, 0x00020000
  s_setprio 3
  v_lshrrev_b32 v20, 3, v2
  v_and_b32 v21, 7, v2
  v_lshrrev_b32 v22, 4, v2
  v_xor_b32 v23, v21, v22
  v_lshlrev_b32 v23, 4, v23
  v_lshl_add_u32 v24, v20, 11, v23
  v_xor_b32 v25, 64, v24
  s_lshl_b32 s32, s17, 18
  v_add_u32 v32, 0, v24
  v_add_u32 v33, 15360, v25
  v_add_u32 v34, 30720, v24
  v_add_u32 v35, 46080, v25
  v_add_u32 v36, 65536, v24
  v_add_u32 v37, 80896, v25
  v_add_u32 v38, 96256, v24
  v_add_u32 v39, 111616, v25
  v_add_u32 v40, 131072, v24
  v_add_u32 v41, 146432, v25
  v_add_u32 v42, 161792, v24
  v_add_u32 v43, 177152, v25
  v_add_u32 v44, 196608, v24
  v_add_u32 v45, 211968, v25
  v_add_u32 v46, 227328, v24
  v_add_u32 v47, 242688, v25
  s_mov_b32 s29, 0
  s_add_u32 m0, s29, 0
  s_waitcnt vmcnt(63)
  buffer_load_dwordx4 v32, s[8:11], s32 offen offset:0 lds
  buffer_load_dwordx4 v33, s[8:11], s32 offen offset:1024 lds
  buffer_load_dwordx4 v34, s[8:11], s32 offen offset:2048 lds
  buffer_load_dwordx4 v35, s[8:11], s32 offen offset:3072 lds
  s_add_u32 m0, s29, 4096
  s_waitcnt vmcnt(63)
  buffer_load_dwordx4 v36, s[8:11], s32 offen offset:0 lds
  buffer_load_dwordx4 v37, s[8:11], s32 offen offset:1024 lds
  buffer_load_dwordx4 v38, s[8:11], s32 offen offset:2048 lds
  buffer_load_dwordx4 v39, s[8:11], s32 offen offset:3072 lds
  s_add_u32 m0, s29, 8192
  s_waitcnt vmcnt(63)
  buffer_load_dwordx4 v40, s[8:11], s32 offen offset:0 lds
  buffer_load_dwordx4 v41, s[8:11], s32 offen offset:1024 lds
  buffer_load_dwordx4 v42, s[8:11], s32 offen offset:2048 lds
  buffer_load_dwordx4 v43, s[8:11], s32 offen offset:3072 lds
  s_add_u32 m0, s29, 12288
  s_waitcnt vmcnt(63)
  buffer_load_dwordx4 v44, s[8:11], s32 offen offset:0 lds
  buffer_load_dwordx4 v45, s[8:11], s32 offen offset:1024 lds
  buffer_load_dwordx4 v46, s[8:11], s32 offen offset:2048 lds
  buffer_load_dwordx4 v47, s[8:11], s32 offen offset:3072 lds
  s_add_u32 s32, s32, 128
  s_mov_b32 s12, s42
  s_mov_b32 s13, s43
  s_mov_b32 s14, 0x600000
  s_mov_b32 s15, 0x00020000
  v_lshrrev_b32 v28, 3, v2
  v_and_b32 v29, 7, v2
  v_bfe_u32 v30, v2, 4, 1
  v_lshlrev_b32 v30, 1, v30
  v_xor_b32 v31, v29, v30
  v_lshlrev_b32 v31, 4, v31
  v_mul_u32_u24 v28, 6144, v28
  v_add_u32 v28, v28, v31
  v_xor_b32 v29, 64, v28
  v_lshlrev_b32 v9, 2, v2
  v_and_b32 v9, 12, v9
  v_add_u32 v9, 156416, v9
  v_add_u32 v48, 0, v28
  v_add_u32 v49, 48128, v29
  v_add_u32 v50, 96256, v28
  v_add_u32 v51, 144384, v29
  v_add_u32 v52, 2048, v28
  v_add_u32 v53, 50176, v29
  v_add_u32 v54, 98304, v28
  v_add_u32 v55, 146432, v29
  v_add_u32 v56, 4096, v29
  v_add_u32 v57, 52224, v28
  v_add_u32 v58, 100352, v29
  v_add_u32 v59, 148480, v28
  s_lshl_b32 s36, s18, 7
  s_mov_b32 s30, 0
  s_add_u32 m0, s30, 65536
  s_waitcnt vmcnt(63)
  buffer_load_dwordx4 v48, s[12:15], s36 offen offset:0 lds
  buffer_load_dwordx4 v49, s[12:15], s36 offen offset:1024 lds
  buffer_load_dwordx4 v50, s[12:15], s36 offen offset:2048 lds
  buffer_load_dwordx4 v51, s[12:15], s36 offen offset:3072 lds
  s_add_u32 m0, s30, 69632
  s_waitcnt vmcnt(63)
  buffer_load_dwordx4 v52, s[12:15], s36 offen offset:0 lds
  buffer_load_dwordx4 v53, s[12:15], s36 offen offset:1024 lds
  buffer_load_dwordx4 v54, s[12:15], s36 offen offset:2048 lds
  buffer_load_dwordx4 v55, s[12:15], s36 offen offset:3072 lds
  s_add_u32 m0, s30, 73728
  s_waitcnt vmcnt(63)
  buffer_load_dwordx4 v56, s[12:15], s36 offen offset:0 lds
  buffer_load_dwordx4 v57, s[12:15], s36 offen offset:1024 lds
  buffer_load_dwordx4 v58, s[12:15], s36 offen offset:2048 lds
  buffer_load_dwordx4 v59, s[12:15], s36 offen offset:3072 lds
  s_add_u32 s30, s30, 12288
  s_cmp_eq_u32 s30, 86016
  s_cselect_b32 s30, 0, s30
  s_barrier
  s_mov_b32 s35, .g2_kernel_tab-.g2_kernel_pc+4
  s_mov_b32 s34, -5
  v_mov_b32 v10, 0
  s_mov_b32 m0, 156160
  s_add_u32 s36, s36, 196608
  s_mov_b64 exec, 1
  buffer_load_dword off, s[64:67], s35 lds
  s_mov_b64 exec, -1
  s_add_u32 s35, s35, 4
  s_branch .g2_kernel_p1_o
  .p2align 6
.g2_kernel_p1_l:
  s_waitcnt lgkmcnt(0)
  v_cmp_gt_i32 vcc, s34, v10
  s_cbranch_vccnz .g2_kernel_p1_aw
.g2_kernel_p1_ai:
  s_add_u32 s29, s29, 16384
  s_and_b32 s29, s29, 0xffff
  s_add_u32 m0, s29, 0
  s_waitcnt vmcnt(63)
  buffer_load_dwordx4 v32, s[8:11], s32 offen offset:0 lds
  buffer_load_dwordx4 v33, s[8:11], s32 offen offset:1024 lds
  buffer_load_dwordx4 v34, s[8:11], s32 offen offset:2048 lds
  buffer_load_dwordx4 v35, s[8:11], s32 offen offset:3072 lds
  s_add_u32 m0, s29, 4096
  s_waitcnt vmcnt(63)
  buffer_load_dwordx4 v36, s[8:11], s32 offen offset:0 lds
  buffer_load_dwordx4 v37, s[8:11], s32 offen offset:1024 lds
  buffer_load_dwordx4 v38, s[8:11], s32 offen offset:2048 lds
  buffer_load_dwordx4 v39, s[8:11], s32 offen offset:3072 lds
  s_add_u32 m0, s29, 8192
  s_waitcnt vmcnt(63)
  buffer_load_dwordx4 v40, s[8:11], s32 offen offset:0 lds
  buffer_load_dwordx4 v41, s[8:11], s32 offen offset:1024 lds
  buffer_load_dwordx4 v42, s[8:11], s32 offen offset:2048 lds
  buffer_load_dwordx4 v43, s[8:11], s32 offen offset:3072 lds
  s_add_u32 m0, s29, 12288
  s_waitcnt vmcnt(63)
  buffer_load_dwordx4 v44, s[8:11], s32 offen offset:0 lds
  buffer_load_dwordx4 v45, s[8:11], s32 offen offset:1024 lds
  buffer_load_dwordx4 v46, s[8:11], s32 offen offset:2048 lds
  buffer_load_dwordx4 v47, s[8:11], s32 offen offset:3072 lds
  s_add_u32 s32, s32, 128
  s_add_u32 m0, s30, 65536
  s_waitcnt vmcnt(63)
  buffer_load_dwordx4 v48, s[12:15], s36 offen offset:0 lds
  buffer_load_dwordx4 v49, s[12:15], s36 offen offset:1024 lds
  buffer_load_dwordx4 v50, s[12:15], s36 offen offset:2048 lds
  buffer_load_dwordx4 v51, s[12:15], s36 offen offset:3072 lds
  s_add_u32 m0, s30, 69632
  s_waitcnt vmcnt(63)
  buffer_load_dwordx4 v52, s[12:15], s36 offen offset:0 lds
  buffer_load_dwordx4 v53, s[12:15], s36 offen offset:1024 lds
  buffer_load_dwordx4 v54, s[12:15], s36 offen offset:2048 lds
  buffer_load_dwordx4 v55, s[12:15], s36 offen offset:3072 lds
  s_add_u32 m0, s30, 73728
  s_waitcnt vmcnt(63)
  buffer_load_dwordx4 v56, s[12:15], s36 offen offset:0 lds
  buffer_load_dwordx4 v57, s[12:15], s36 offen offset:1024 lds
  buffer_load_dwordx4 v58, s[12:15], s36 offen offset:2048 lds
  buffer_load_dwordx4 v59, s[12:15], s36 offen offset:3072 lds
  s_add_u32 s30, s30, 12288
  s_cmp_eq_u32 s30, 86016
  s_cselect_b32 s30, 0, s30
  ds_read_b32 v10, v9
  s_mov_b32 m0, 156160
  s_add_u32 s34, s34, 1
  s_mov_b64 exec, 1
  buffer_load_dword off, s[64:67], s35 lds
  s_mov_b64 exec, -1
  s_add_u32 s35, s35, 4
  s_add_u32 s36, s36, 196608
.g2_kernel_p1_o:
  s_waitcnt lgkmcnt(0)
  v_cmp_gt_i32 vcc, s34, v10
  s_cbranch_vccnz .g2_kernel_p1_bw
.g2_kernel_p1_bi:
  s_add_u32 m0, s30, 65536
  s_waitcnt vmcnt(63)
  buffer_load_dwordx4 v48, s[12:15], s36 offen offset:0 lds
  buffer_load_dwordx4 v49, s[12:15], s36 offen offset:1024 lds
  buffer_load_dwordx4 v50, s[12:15], s36 offen offset:2048 lds
  buffer_load_dwordx4 v51, s[12:15], s36 offen offset:3072 lds
  s_add_u32 m0, s30, 69632
  s_waitcnt vmcnt(63)
  buffer_load_dwordx4 v52, s[12:15], s36 offen offset:0 lds
  buffer_load_dwordx4 v53, s[12:15], s36 offen offset:1024 lds
  buffer_load_dwordx4 v54, s[12:15], s36 offen offset:2048 lds
  buffer_load_dwordx4 v55, s[12:15], s36 offen offset:3072 lds
  s_add_u32 m0, s30, 73728
  s_waitcnt vmcnt(63)
  buffer_load_dwordx4 v56, s[12:15], s36 offen offset:0 lds
  buffer_load_dwordx4 v57, s[12:15], s36 offen offset:1024 lds
  buffer_load_dwordx4 v58, s[12:15], s36 offen offset:2048 lds
  buffer_load_dwordx4 v59, s[12:15], s36 offen offset:3072 lds
  s_add_u32 s30, s30, 12288
  s_cmp_eq_u32 s30, 86016
  s_cselect_b32 s30, 0, s30
  ds_read_b32 v10, v9
  s_mov_b32 m0, 156160
  s_add_u32 s34, s34, 1
  s_mov_b64 exec, 1
  buffer_load_dword off, s[64:67], s35 lds
  s_mov_b64 exec, -1
  s_add_u32 s35, s35, 4
  s_add_u32 s36, s36, 196608
  s_cmp_lt_i32 s34, 26
  s_cbranch_scc1 .g2_kernel_p1_l
  s_branch .g2_kernel_v
.g2_kernel_s1:
  s_mov_b32 s8, s40
  s_mov_b32 s9, s41
  s_mov_b32 s10, 0x400000
  s_mov_b32 s11, 0x00020000
  v_lshrrev_b32 v20, 3, v2
  v_and_b32 v21, 7, v2
  v_lshlrev_b32 v21, 4, v21
  v_lshl_add_u32 v21, v20, 11, v21
  s_lshl_b32 s30, s17, 4
  s_add_u32 s30, s30, s18
  s_lshl_b32 s33, s30, 5
  s_lshl_b32 s30, s30, 14
  s_barrier
  s_sleep 30
  buffer_load_dwordx4 v[64:67], v21, s[8:11], s30 offen offset:0
  buffer_load_dwordx4 v[68:71], v21, s[8:11], s30 offen offset:128
  buffer_load_dwordx4 v[72:75], v21, s[8:11], s30 offen offset:256
  buffer_load_dwordx4 v[76:79], v21, s[8:11], s30 offen offset:384
  buffer_load_dwordx4 v[80:83], v21, s[8:11], s30 offen offset:512
  buffer_load_dwordx4 v[84:87], v21, s[8:11], s30 offen offset:640
  buffer_load_dwordx4 v[88:91], v21, s[8:11], s30 offen offset:768
  buffer_load_dwordx4 v[92:95], v21, s[8:11], s30 offen offset:896
  buffer_load_dwordx4 v[96:99], v21, s[8:11], s30 offen offset:1024
  buffer_load_dwordx4 v[100:103], v21, s[8:11], s30 offen offset:1152
  buffer_load_dwordx4 v[104:107], v21, s[8:11], s30 offen offset:1280
  buffer_load_dwordx4 v[108:111], v21, s[8:11], s30 offen offset:1408
  buffer_load_dwordx4 v[112:115], v21, s[8:11], s30 offen offset:1536
  buffer_load_dwordx4 v[116:119], v21, s[8:11], s30 offen offset:1664
  buffer_load_dwordx4 v[120:123], v21, s[8:11], s30 offen offset:1792
  buffer_load_dwordx4 v[124:127], v21, s[8:11], s30 offen offset:1920
  v_mov_b32 v24, 0
  v_mov_b32 v25, 0
  v_mov_b32 v26, 0
  v_mov_b32 v27, 0
  s_waitcnt vmcnt(15)
  v_lshlrev_b32 v22, 16, v64
  v_and_b32 v64, 0xffff0000, v64
  v_add_f32 v24, v24, v22
  v_fmac_f32 v25, v22, v22
  v_add_f32 v26, v26, v64
  v_fmac_f32 v27, v64, v64
  v_lshlrev_b32 v22, 16, v65
  v_and_b32 v65, 0xffff0000, v65
  v_add_f32 v24, v24, v22
  v_fmac_f32 v25, v22, v22
  v_add_f32 v26, v26, v65
  v_fmac_f32 v27, v65, v65
  v_lshlrev_b32 v22, 16, v66
  v_and_b32 v66, 0xffff0000, v66
  v_add_f32 v24, v24, v22
  v_fmac_f32 v25, v22, v22
  v_add_f32 v26, v26, v66
  v_fmac_f32 v27, v66, v66
  v_lshlrev_b32 v22, 16, v67
  v_and_b32 v67, 0xffff0000, v67
  v_add_f32 v24, v24, v22
  v_fmac_f32 v25, v22, v22
  v_add_f32 v26, v26, v67
  v_fmac_f32 v27, v67, v67
  s_waitcnt vmcnt(14)
  v_lshlrev_b32 v22, 16, v68
  v_and_b32 v68, 0xffff0000, v68
  v_add_f32 v24, v24, v22
  v_fmac_f32 v25, v22, v22
  v_add_f32 v26, v26, v68
  v_fmac_f32 v27, v68, v68
  v_lshlrev_b32 v22, 16, v69
  v_and_b32 v69, 0xffff0000, v69
  v_add_f32 v24, v24, v22
  v_fmac_f32 v25, v22, v22
  v_add_f32 v26, v26, v69
  v_fmac_f32 v27, v69, v69
  v_lshlrev_b32 v22, 16, v70
  v_and_b32 v70, 0xffff0000, v70
  v_add_f32 v24, v24, v22
  v_fmac_f32 v25, v22, v22
  v_add_f32 v26, v26, v70
  v_fmac_f32 v27, v70, v70
  v_lshlrev_b32 v22, 16, v71
  v_and_b32 v71, 0xffff0000, v71
  v_add_f32 v24, v24, v22
  v_fmac_f32 v25, v22, v22
  v_add_f32 v26, v26, v71
  v_fmac_f32 v27, v71, v71
  s_waitcnt vmcnt(13)
  v_lshlrev_b32 v22, 16, v72
  v_and_b32 v72, 0xffff0000, v72
  v_add_f32 v24, v24, v22
  v_fmac_f32 v25, v22, v22
  v_add_f32 v26, v26, v72
  v_fmac_f32 v27, v72, v72
  v_lshlrev_b32 v22, 16, v73
  v_and_b32 v73, 0xffff0000, v73
  v_add_f32 v24, v24, v22
  v_fmac_f32 v25, v22, v22
  v_add_f32 v26, v26, v73
  v_fmac_f32 v27, v73, v73
  v_lshlrev_b32 v22, 16, v74
  v_and_b32 v74, 0xffff0000, v74
  v_add_f32 v24, v24, v22
  v_fmac_f32 v25, v22, v22
  v_add_f32 v26, v26, v74
  v_fmac_f32 v27, v74, v74
  v_lshlrev_b32 v22, 16, v75
  v_and_b32 v75, 0xffff0000, v75
  v_add_f32 v24, v24, v22
  v_fmac_f32 v25, v22, v22
  v_add_f32 v26, v26, v75
  v_fmac_f32 v27, v75, v75
  s_waitcnt vmcnt(12)
  v_lshlrev_b32 v22, 16, v76
  v_and_b32 v76, 0xffff0000, v76
  v_add_f32 v24, v24, v22
  v_fmac_f32 v25, v22, v22
  v_add_f32 v26, v26, v76
  v_fmac_f32 v27, v76, v76
  v_lshlrev_b32 v22, 16, v77
  v_and_b32 v77, 0xffff0000, v77
  v_add_f32 v24, v24, v22
  v_fmac_f32 v25, v22, v22
  v_add_f32 v26, v26, v77
  v_fmac_f32 v27, v77, v77
  v_lshlrev_b32 v22, 16, v78
  v_and_b32 v78, 0xffff0000, v78
  v_add_f32 v24, v24, v22
  v_fmac_f32 v25, v22, v22
  v_add_f32 v26, v26, v78
  v_fmac_f32 v27, v78, v78
  v_lshlrev_b32 v22, 16, v79
  v_and_b32 v79, 0xffff0000, v79
  v_add_f32 v24, v24, v22
  v_fmac_f32 v25, v22, v22
  v_add_f32 v26, v26, v79
  v_fmac_f32 v27, v79, v79
  s_waitcnt vmcnt(11)
  v_lshlrev_b32 v22, 16, v80
  v_and_b32 v80, 0xffff0000, v80
  v_add_f32 v24, v24, v22
  v_fmac_f32 v25, v22, v22
  v_add_f32 v26, v26, v80
  v_fmac_f32 v27, v80, v80
  v_lshlrev_b32 v22, 16, v81
  v_and_b32 v81, 0xffff0000, v81
  v_add_f32 v24, v24, v22
  v_fmac_f32 v25, v22, v22
  v_add_f32 v26, v26, v81
  v_fmac_f32 v27, v81, v81
  v_lshlrev_b32 v22, 16, v82
  v_and_b32 v82, 0xffff0000, v82
  v_add_f32 v24, v24, v22
  v_fmac_f32 v25, v22, v22
  v_add_f32 v26, v26, v82
  v_fmac_f32 v27, v82, v82
  v_lshlrev_b32 v22, 16, v83
  v_and_b32 v83, 0xffff0000, v83
  v_add_f32 v24, v24, v22
  v_fmac_f32 v25, v22, v22
  v_add_f32 v26, v26, v83
  v_fmac_f32 v27, v83, v83
  s_waitcnt vmcnt(10)
  v_lshlrev_b32 v22, 16, v84
  v_and_b32 v84, 0xffff0000, v84
  v_add_f32 v24, v24, v22
  v_fmac_f32 v25, v22, v22
  v_add_f32 v26, v26, v84
  v_fmac_f32 v27, v84, v84
  v_lshlrev_b32 v22, 16, v85
  v_and_b32 v85, 0xffff0000, v85
  v_add_f32 v24, v24, v22
  v_fmac_f32 v25, v22, v22
  v_add_f32 v26, v26, v85
  v_fmac_f32 v27, v85, v85
  v_lshlrev_b32 v22, 16, v86
  v_and_b32 v86, 0xffff0000, v86
  v_add_f32 v24, v24, v22
  v_fmac_f32 v25, v22, v22
  v_add_f32 v26, v26, v86
  v_fmac_f32 v27, v86, v86
  v_lshlrev_b32 v22, 16, v87
  v_and_b32 v87, 0xffff0000, v87
  v_add_f32 v24, v24, v22
  v_fmac_f32 v25, v22, v22
  v_add_f32 v26, v26, v87
  v_fmac_f32 v27, v87, v87
  s_waitcnt vmcnt(9)
  v_lshlrev_b32 v22, 16, v88
  v_and_b32 v88, 0xffff0000, v88
  v_add_f32 v24, v24, v22
  v_fmac_f32 v25, v22, v22
  v_add_f32 v26, v26, v88
  v_fmac_f32 v27, v88, v88
  v_lshlrev_b32 v22, 16, v89
  v_and_b32 v89, 0xffff0000, v89
  v_add_f32 v24, v24, v22
  v_fmac_f32 v25, v22, v22
  v_add_f32 v26, v26, v89
  v_fmac_f32 v27, v89, v89
  v_lshlrev_b32 v22, 16, v90
  v_and_b32 v90, 0xffff0000, v90
  v_add_f32 v24, v24, v22
  v_fmac_f32 v25, v22, v22
  v_add_f32 v26, v26, v90
  v_fmac_f32 v27, v90, v90
  v_lshlrev_b32 v22, 16, v91
  v_and_b32 v91, 0xffff0000, v91
  v_add_f32 v24, v24, v22
  v_fmac_f32 v25, v22, v22
  v_add_f32 v26, v26, v91
  v_fmac_f32 v27, v91, v91
  s_waitcnt vmcnt(8)
  v_lshlrev_b32 v22, 16, v92
  v_and_b32 v92, 0xffff0000, v92
  v_add_f32 v24, v24, v22
  v_fmac_f32 v25, v22, v22
  v_add_f32 v26, v26, v92
  v_fmac_f32 v27, v92, v92
  v_lshlrev_b32 v22, 16, v93
  v_and_b32 v93, 0xffff0000, v93
  v_add_f32 v24, v24, v22
  v_fmac_f32 v25, v22, v22
  v_add_f32 v26, v26, v93
  v_fmac_f32 v27, v93, v93
  v_lshlrev_b32 v22, 16, v94
  v_and_b32 v94, 0xffff0000, v94
  v_add_f32 v24, v24, v22
  v_fmac_f32 v25, v22, v22
  v_add_f32 v26, v26, v94
  v_fmac_f32 v27, v94, v94
  v_lshlrev_b32 v22, 16, v95
  v_and_b32 v95, 0xffff0000, v95
  v_add_f32 v24, v24, v22
  v_fmac_f32 v25, v22, v22
  v_add_f32 v26, v26, v95
  v_fmac_f32 v27, v95, v95
  s_waitcnt vmcnt(7)
  v_lshlrev_b32 v22, 16, v96
  v_and_b32 v96, 0xffff0000, v96
  v_add_f32 v24, v24, v22
  v_fmac_f32 v25, v22, v22
  v_add_f32 v26, v26, v96
  v_fmac_f32 v27, v96, v96
  v_lshlrev_b32 v22, 16, v97
  v_and_b32 v97, 0xffff0000, v97
  v_add_f32 v24, v24, v22
  v_fmac_f32 v25, v22, v22
  v_add_f32 v26, v26, v97
  v_fmac_f32 v27, v97, v97
  v_lshlrev_b32 v22, 16, v98
  v_and_b32 v98, 0xffff0000, v98
  v_add_f32 v24, v24, v22
  v_fmac_f32 v25, v22, v22
  v_add_f32 v26, v26, v98
  v_fmac_f32 v27, v98, v98
  v_lshlrev_b32 v22, 16, v99
  v_and_b32 v99, 0xffff0000, v99
  v_add_f32 v24, v24, v22
  v_fmac_f32 v25, v22, v22
  v_add_f32 v26, v26, v99
  v_fmac_f32 v27, v99, v99
  s_waitcnt vmcnt(6)
  v_lshlrev_b32 v22, 16, v100
  v_and_b32 v100, 0xffff0000, v100
  v_add_f32 v24, v24, v22
  v_fmac_f32 v25, v22, v22
  v_add_f32 v26, v26, v100
  v_fmac_f32 v27, v100, v100
  v_lshlrev_b32 v22, 16, v101
  v_and_b32 v101, 0xffff0000, v101
  v_add_f32 v24, v24, v22
  v_fmac_f32 v25, v22, v22
  v_add_f32 v26, v26, v101
  v_fmac_f32 v27, v101, v101
  v_lshlrev_b32 v22, 16, v102
  v_and_b32 v102, 0xffff0000, v102
  v_add_f32 v24, v24, v22
  v_fmac_f32 v25, v22, v22
  v_add_f32 v26, v26, v102
  v_fmac_f32 v27, v102, v102
  v_lshlrev_b32 v22, 16, v103
  v_and_b32 v103, 0xffff0000, v103
  v_add_f32 v24, v24, v22
  v_fmac_f32 v25, v22, v22
  v_add_f32 v26, v26, v103
  v_fmac_f32 v27, v103, v103
  s_waitcnt vmcnt(5)
  v_lshlrev_b32 v22, 16, v104
  v_and_b32 v104, 0xffff0000, v104
  v_add_f32 v24, v24, v22
  v_fmac_f32 v25, v22, v22
  v_add_f32 v26, v26, v104
  v_fmac_f32 v27, v104, v104
  v_lshlrev_b32 v22, 16, v105
  v_and_b32 v105, 0xffff0000, v105
  v_add_f32 v24, v24, v22
  v_fmac_f32 v25, v22, v22
  v_add_f32 v26, v26, v105
  v_fmac_f32 v27, v105, v105
  v_lshlrev_b32 v22, 16, v106
  v_and_b32 v106, 0xffff0000, v106
  v_add_f32 v24, v24, v22
  v_fmac_f32 v25, v22, v22
  v_add_f32 v26, v26, v106
  v_fmac_f32 v27, v106, v106
  v_lshlrev_b32 v22, 16, v107
  v_and_b32 v107, 0xffff0000, v107
  v_add_f32 v24, v24, v22
  v_fmac_f32 v25, v22, v22
  v_add_f32 v26, v26, v107
  v_fmac_f32 v27, v107, v107
  s_waitcnt vmcnt(4)
  v_lshlrev_b32 v22, 16, v108
  v_and_b32 v108, 0xffff0000, v108
  v_add_f32 v24, v24, v22
  v_fmac_f32 v25, v22, v22
  v_add_f32 v26, v26, v108
  v_fmac_f32 v27, v108, v108
  v_lshlrev_b32 v22, 16, v109
  v_and_b32 v109, 0xffff0000, v109
  v_add_f32 v24, v24, v22
  v_fmac_f32 v25, v22, v22
  v_add_f32 v26, v26, v109
  v_fmac_f32 v27, v109, v109
  v_lshlrev_b32 v22, 16, v110
  v_and_b32 v110, 0xffff0000, v110
  v_add_f32 v24, v24, v22
  v_fmac_f32 v25, v22, v22
  v_add_f32 v26, v26, v110
  v_fmac_f32 v27, v110, v110
  v_lshlrev_b32 v22, 16, v111
  v_and_b32 v111, 0xffff0000, v111
  v_add_f32 v24, v24, v22
  v_fmac_f32 v25, v22, v22
  v_add_f32 v26, v26, v111
  v_fmac_f32 v27, v111, v111
  s_waitcnt vmcnt(3)
  v_lshlrev_b32 v22, 16, v112
  v_and_b32 v112, 0xffff0000, v112
  v_add_f32 v24, v24, v22
  v_fmac_f32 v25, v22, v22
  v_add_f32 v26, v26, v112
  v_fmac_f32 v27, v112, v112
  v_lshlrev_b32 v22, 16, v113
  v_and_b32 v113, 0xffff0000, v113
  v_add_f32 v24, v24, v22
  v_fmac_f32 v25, v22, v22
  v_add_f32 v26, v26, v113
  v_fmac_f32 v27, v113, v113
  v_lshlrev_b32 v22, 16, v114
  v_and_b32 v114, 0xffff0000, v114
  v_add_f32 v24, v24, v22
  v_fmac_f32 v25, v22, v22
  v_add_f32 v26, v26, v114
  v_fmac_f32 v27, v114, v114
  v_lshlrev_b32 v22, 16, v115
  v_and_b32 v115, 0xffff0000, v115
  v_add_f32 v24, v24, v22
  v_fmac_f32 v25, v22, v22
  v_add_f32 v26, v26, v115
  v_fmac_f32 v27, v115, v115
  s_waitcnt vmcnt(2)
  v_lshlrev_b32 v22, 16, v116
  v_and_b32 v116, 0xffff0000, v116
  v_add_f32 v24, v24, v22
  v_fmac_f32 v25, v22, v22
  v_add_f32 v26, v26, v116
  v_fmac_f32 v27, v116, v116
  v_lshlrev_b32 v22, 16, v117
  v_and_b32 v117, 0xffff0000, v117
  v_add_f32 v24, v24, v22
  v_fmac_f32 v25, v22, v22
  v_add_f32 v26, v26, v117
  v_fmac_f32 v27, v117, v117
  v_lshlrev_b32 v22, 16, v118
  v_and_b32 v118, 0xffff0000, v118
  v_add_f32 v24, v24, v22
  v_fmac_f32 v25, v22, v22
  v_add_f32 v26, v26, v118
  v_fmac_f32 v27, v118, v118
  v_lshlrev_b32 v22, 16, v119
  v_and_b32 v119, 0xffff0000, v119
  v_add_f32 v24, v24, v22
  v_fmac_f32 v25, v22, v22
  v_add_f32 v26, v26, v119
  v_fmac_f32 v27, v119, v119
  s_waitcnt vmcnt(1)
  v_lshlrev_b32 v22, 16, v120
  v_and_b32 v120, 0xffff0000, v120
  v_add_f32 v24, v24, v22
  v_fmac_f32 v25, v22, v22
  v_add_f32 v26, v26, v120
  v_fmac_f32 v27, v120, v120
  v_lshlrev_b32 v22, 16, v121
  v_and_b32 v121, 0xffff0000, v121
  v_add_f32 v24, v24, v22
  v_fmac_f32 v25, v22, v22
  v_add_f32 v26, v26, v121
  v_fmac_f32 v27, v121, v121
  v_lshlrev_b32 v22, 16, v122
  v_and_b32 v122, 0xffff0000, v122
  v_add_f32 v24, v24, v22
  v_fmac_f32 v25, v22, v22
  v_add_f32 v26, v26, v122
  v_fmac_f32 v27, v122, v122
  v_lshlrev_b32 v22, 16, v123
  v_and_b32 v123, 0xffff0000, v123
  v_add_f32 v24, v24, v22
  v_fmac_f32 v25, v22, v22
  v_add_f32 v26, v26, v123
  v_fmac_f32 v27, v123, v123
  s_waitcnt vmcnt(0)
  v_lshlrev_b32 v22, 16, v124
  v_and_b32 v124, 0xffff0000, v124
  v_add_f32 v24, v24, v22
  v_fmac_f32 v25, v22, v22
  v_add_f32 v26, v26, v124
  v_fmac_f32 v27, v124, v124
  v_lshlrev_b32 v22, 16, v125
  v_and_b32 v125, 0xffff0000, v125
  v_add_f32 v24, v24, v22
  v_fmac_f32 v25, v22, v22
  v_add_f32 v26, v26, v125
  v_fmac_f32 v27, v125, v125
  v_lshlrev_b32 v22, 16, v126
  v_and_b32 v126, 0xffff0000, v126
  v_add_f32 v24, v24, v22
  v_fmac_f32 v25, v22, v22
  v_add_f32 v26, v26, v126
  v_fmac_f32 v27, v126, v126
  v_lshlrev_b32 v22, 16, v127
  v_and_b32 v127, 0xffff0000, v127
  v_add_f32 v24, v24, v22
  v_fmac_f32 v25, v22, v22
  v_add_f32 v26, v26, v127
  v_fmac_f32 v27, v127, v127
  v_add_f32 v24, v24, v26
  v_add_f32 v25, v25, v27
  s_nop 0
  v_add_f32 v24, v24, v24 quad_perm:[1,0,3,2] row_mask:0xf bank_mask:0xf
  v_add_f32 v25, v25, v25 quad_perm:[1,0,3,2] row_mask:0xf bank_mask:0xf
  s_nop 0
  v_add_f32 v24, v24, v24 quad_perm:[2,3,0,1] row_mask:0xf bank_mask:0xf
  v_add_f32 v25, v25, v25 quad_perm:[2,3,0,1] row_mask:0xf bank_mask:0xf
  s_nop 0
  v_add_f32 v24, v24, v24 row_half_mirror row_mask:0xf bank_mask:0xf
  v_add_f32 v25, v25, v25 row_half_mirror row_mask:0xf bank_mask:0xf
  v_mov_b32 v26, 0.0009765625
  v_mul_f32 v24, v26, v24
  v_mul_f32 v27, v24, v24
  v_fma_f32 v25, v25, v26, -v27
  v_max_f32 v25, 0, v25
  v_add_f32 v25, 1e-05, v25
  v_rsq_f32 v25, v25
  v_lshlrev_b32 v20, 2, v20
  v_mul_f32 v24, v24, v25
  v_sub_f32 v24, 0, v24
  s_add_u32 s33, s33, 0x3070000
  s_add_u32 s34, s33, 0x2000
  s_mov_b32 exec_lo, 0x01010101
  s_mov_b32 exec_hi, 0x01010101
  buffer_store_dword v25, v20, s[4:7], s33 offen sc1
  buffer_store_dword v24, v20, s[4:7], s34 offen sc1
  s_mov_b64 exec, -1
  s_mov_b32 s12, s58
  s_mov_b32 s13, s59
  s_mov_b32 s14, 0x100
  s_mov_b32 s15, 0x00020000
  s_mov_b32 s38, 0
  s_mov_b64 exec, 1
.g2_kernel_gt8:
  buffer_load_dword v6, v4, s[12:15], 0 offen sc1
  s_add_u32 s38, s38, 1
  s_waitcnt vmcnt(0)
  v_cmp_eq_u32 vcc, 0x60, v6
  s_cbranch_vccnz .g2_kernel_gt8d
  s_sleep 8
  s_cmp_lt_u32 s38, 131072
  s_cbranch_scc1 .g2_kernel_gt8
.g2_kernel_gt8d:
  s_mov_b64 exec, -1
  v_mov_b32 v6, s70
  s_mov_b64 exec, 1
  buffer_store_dword v6, v4, s[4:7], s19 offen offset:12 sc1
  s_mov_b64 exec, -1
  v_mov_b32 v6, 155648
  s_mov_b32 s38, 0
.g2_kernel_wg9:
  ds_read_b32 v7, v6 offset:512
  s_add_u32 s38, s38, 1
  s_waitcnt lgkmcnt(0)
  v_cmp_gt_u32 vcc, 22, v7
  s_cbranch_vccz .g2_kernel_wg9d
  s_sleep 4
  s_cmp_lt_u32 s38, 524288
  s_cbranch_scc1 .g2_kernel_wg9
.g2_kernel_wg9d:
  s_and_b32 s31, s19, 0xffffe000
  s_add_u32 s31, s31, 12
  v_and_b32 v6, 15, v2
  v_lshlrev_b32 v6, 9, v6
  v_lshrrev_b32 v7, 4, v2
  v_lshl_add_u32 v6, v7, 7, v6
  v_lshlrev_b32 v7, 2, v2
  v_add_u32 v7, 157952, v7
  s_mov_b32 m0, 157952
  s_mov_b32 s38, 0
  s_bfm_b64 exec, 16, 0
.g2_kernel_pa10:
  buffer_load_dword v6, s[4:7], s31 offen sc1 lds
  s_add_u32 s38, s38, 1
  s_waitcnt vmcnt(0)
  ds_read_b32 v8, v7
  s_waitcnt lgkmcnt(0)
  v_cmp_ge_u32 vcc, s62, v8
  s_cbranch_vccz .g2_kernel_pa10d
  s_mov_b64 exec, vcc
  s_sleep 16
  s_cmp_lt_u32 s38, 131072
  s_cbranch_scc1 .g2_kernel_pa10
.g2_kernel_pa10d:
  s_mov_b64 exec, -1
  s_lshl_b32 s33, s17, 9
  s_add_u32 s33, s33, 0x3070000
  s_add_u32 s34, s33, 0x2000
  s_mov_b32 exec_hi, 0
  s_mov_b32 m0, 158464
  s_nop 0
  buffer_load_dwordx4 v3, s[4:7], s33 offen sc1 lds
  s_mov_b32 m0, 158976
  s_nop 0
  buffer_load_dwordx4 v3, s[4:7], s34 offen sc1 lds
  s_mov_b64 exec, -1
  v_mov_b32 v20, 1.0
  v_mov_b32 v21, 1.0
  v_mov_b32 v22, 0
  v_mov_b32 v23, 0
  v_lshlrev_b32 v24, 3, v2
  v_add_u32 v24, 155648, v24
  v_mov_b32 v6, 155648
  s_mov_b32 s38, 0
.g2_kernel_wg11:
  ds_read_b32 v7, v6 offset:512
  s_add_u32 s38, s38, 1
  s_waitcnt lgkmcnt(0)
  v_cmp_gt_u32 vcc, 32, v7
  s_cbranch_vccz .g2_kernel_wg11d
  s_sleep 2
  s_cmp_lt_u32 s38, 524288
  s_cbranch_scc1 .g2_kernel_wg11
.g2_kernel_wg11d:
  ds_write_b64 v24, v[20:21] offset:3840
  ds_write_b64 v24, v[22:23] offset:4352
  v_lshlrev_b32 v24, 2, v2
  v_add_u32 v24, 155648, v24
  ds_write_b32 v24, v4 offset:2304
  s_waitcnt vmcnt(0)
  v_mov_b32 v6, s71
  s_mov_b64 exec, 1
  ds_add_u32 v6, v5 offset:0
  s_mov_b64 exec, -1
  s_branch .g2_kernel_v
.g2_kernel_s2:
  s_mov_b32 s8, s42
  s_mov_b32 s9, s43
  s_mov_b32 s10, 0x600000
  s_mov_b32 s11, 0x00020000
  v_lshrrev_b32 v20, 3, v2
  v_and_b32 v21, 7, v2
  v_mul_u32_u24 v20, 6144, v20
  v_lshl_add_u32 v20, v21, 4, v20
  s_mul_i32 s30, s17, 393216
  s_lshl_b32 s31, s18, 7
  s_add_u32 s30, s30, s31
  s_add_u32 s31, s30, 4096
  s_barrier
  s_sleep 30
  buffer_load_dwordx4 v[64:67], v20, s[8:11], s30 offen
  buffer_load_dwordx4 v[68:71], v20, s[8:11], s30 offen offset:2048
  buffer_load_dwordx4 v[72:75], v20, s[8:11], s31 offen
  s_add_u32 s30, s30, 49152
  s_add_u32 s31, s31, 49152
  buffer_load_dwordx4 v[76:79], v20, s[8:11], s30 offen
  buffer_load_dwordx4 v[80:83], v20, s[8:11], s30 offen offset:2048
  buffer_load_dwordx4 v[84:87], v20, s[8:11], s31 offen
  s_add_u32 s30, s30, 49152
  s_add_u32 s31, s31, 49152
  buffer_load_dwordx4 v[88:91], v20, s[8:11], s30 offen
  buffer_load_dwordx4 v[92:95], v20, s[8:11], s30 offen offset:2048
  buffer_load_dwordx4 v[96:99], v20, s[8:11], s31 offen
  s_add_u32 s30, s30, 49152
  s_add_u32 s31, s31, 49152
  buffer_load_dwordx4 v[100:103], v20, s[8:11], s30 offen
  buffer_load_dwordx4 v[104:107], v20, s[8:11], s30 offen offset:2048
  buffer_load_dwordx4 v[108:111], v20, s[8:11], s31 offen
  s_add_u32 s30, s30, 49152
  s_add_u32 s31, s31, 49152
  buffer_load_dwordx4 v[112:115], v20, s[8:11], s30 offen
  buffer_load_dwordx4 v[116:119], v20, s[8:11], s30 offen offset:2048
  buffer_load_dwordx4 v[120:123], v20, s[8:11], s31 offen
  s_add_u32 s30, s30, 49152
  s_add_u32 s31, s31, 49152
  buffer_load_dwordx4 v[124:127], v20, s[8:11], s30 offen
  buffer_load_dwordx4 v[128:131], v20, s[8:11], s30 offen offset:2048
  buffer_load_dwordx4 v[132:135], v20, s[8:11], s31 offen
  s_add_u32 s30, s30, 49152
  s_add_u32 s31, s31, 49152
  buffer_load_dwordx4 v[136:139], v20, s[8:11], s30 offen
  buffer_load_dwordx4 v[140:143], v20, s[8:11], s30 offen offset:2048
  buffer_load_dwordx4 v[144:147], v20, s[8:11], s31 offen
  s_add_u32 s30, s30, 49152
  s_add_u32 s31, s31, 49152
  buffer_load_dwordx4 v[148:151], v20, s[8:11], s30 offen
  buffer_load_dwordx4 v[152:155], v20, s[8:11], s30 offen offset:2048
  buffer_load_dwordx4 v[156:159], v20, s[8:11], s31 offen
  s_add_u32 s30, s30, 49152
  s_add_u32 s31, s31, 49152
  v_lshlrev_b32 v21, 5, v21
  v_lshrrev_b32 v22, 5, v2
  v_lshl_add_u32 v21, v22, 4, v21
  v_bfe_u32 v22, v2, 4, 1
  v_lshl_add_u32 v21, v22, 3, v21
  s_lshl_b32 s30, s18, 4
  s_add_u32 s30, s30, s17
  s_mul_i32 s30, s30, 768
  s_add_u32 s30, s30, 0x3080000
  s_waitcnt vmcnt(23)
  v_lshlrev_b32 v160, 16, v64
  v_and_b32 v161, 0xffff0000, v64
  v_lshlrev_b32 v162, 16, v65
  v_and_b32 v163, 0xffff0000, v65
  v_lshlrev_b32 v164, 16, v66
  v_and_b32 v165, 0xffff0000, v66
  v_lshlrev_b32 v166, 16, v67
  v_and_b32 v167, 0xffff0000, v67
  s_waitcnt vmcnt(22)
  v_lshlrev_b32 v168, 16, v68
  v_and_b32 v169, 0xffff0000, v68
  v_lshlrev_b32 v170, 16, v69
  v_and_b32 v171, 0xffff0000, v69
  v_lshlrev_b32 v172, 16, v70
  v_and_b32 v173, 0xffff0000, v70
  v_lshlrev_b32 v174, 16, v71
  v_and_b32 v175, 0xffff0000, v71
  s_waitcnt vmcnt(21)
  v_lshlrev_b32 v176, 16, v72
  v_and_b32 v177, 0xffff0000, v72
  v_lshlrev_b32 v178, 16, v73
  v_and_b32 v179, 0xffff0000, v73
  v_lshlrev_b32 v180, 16, v74
  v_and_b32 v181, 0xffff0000, v74
  v_lshlrev_b32 v182, 16, v75
  v_and_b32 v183, 0xffff0000, v75
  s_waitcnt vmcnt(20)
  v_lshlrev_b32 v184, 16, v76
  v_and_b32 v185, 0xffff0000, v76
  v_lshlrev_b32 v186, 16, v77
  v_and_b32 v187, 0xffff0000, v77
  v_lshlrev_b32 v188, 16, v78
  v_and_b32 v189, 0xffff0000, v78
  v_lshlrev_b32 v190, 16, v79
  v_and_b32 v191, 0xffff0000, v79
  v_add_f32 v160, v160, v184
  v_add_f32 v161, v161, v185
  v_add_f32 v162, v162, v186
  v_add_f32 v163, v163, v187
  v_add_f32 v164, v164, v188
  v_add_f32 v165, v165, v189
  v_add_f32 v166, v166, v190
  v_add_f32 v167, v167, v191
  s_waitcnt vmcnt(19)
  v_lshlrev_b32 v184, 16, v80
  v_and_b32 v185, 0xffff0000, v80
  v_lshlrev_b32 v186, 16, v81
  v_and_b32 v187, 0xffff0000, v81
  v_lshlrev_b32 v188, 16, v82
  v_and_b32 v189, 0xffff0000, v82
  v_lshlrev_b32 v190, 16, v83
  v_and_b32 v191, 0xffff0000, v83
  v_add_f32 v168, v168, v184
  v_add_f32 v169, v169, v185
  v_add_f32 v170, v170, v186
  v_add_f32 v171, v171, v187
  v_add_f32 v172, v172, v188
  v_add_f32 v173, v173, v189
  v_add_f32 v174, v174, v190
  v_add_f32 v175, v175, v191
  s_waitcnt vmcnt(18)
  v_lshlrev_b32 v184, 16, v84
  v_and_b32 v185, 0xffff0000, v84
  v_lshlrev_b32 v186, 16, v85
  v_and_b32 v187, 0xffff0000, v85
  v_lshlrev_b32 v188, 16, v86
  v_and_b32 v189, 0xffff0000, v86
  v_lshlrev_b32 v190, 16, v87
  v_and_b32 v191, 0xffff0000, v87
  v_add_f32 v176, v176, v184
  v_add_f32 v177, v177, v185
  v_add_f32 v178, v178, v186
  v_add_f32 v179, v179, v187
  v_add_f32 v180, v180, v188
  v_add_f32 v181, v181, v189
  v_add_f32 v182, v182, v190
  v_add_f32 v183, v183, v191
  s_waitcnt vmcnt(17)
  v_lshlrev_b32 v184, 16, v88
  v_and_b32 v185, 0xffff0000, v88
  v_lshlrev_b32 v186, 16, v89
  v_and_b32 v187, 0xffff0000, v89
  v_lshlrev_b32 v188, 16, v90
  v_and_b32 v189, 0xffff0000, v90
  v_lshlrev_b32 v190, 16, v91
  v_and_b32 v191, 0xffff0000, v91
  v_add_f32 v160, v160, v184
  v_add_f32 v161, v161, v185
  v_add_f32 v162, v162, v186
  v_add_f32 v163, v163, v187
  v_add_f32 v164, v164, v188
  v_add_f32 v165, v165, v189
  v_add_f32 v166, v166, v190
  v_add_f32 v167, v167, v191
  s_waitcnt vmcnt(16)
  v_lshlrev_b32 v184, 16, v92
  v_and_b32 v185, 0xffff0000, v92
  v_lshlrev_b32 v186, 16, v93
  v_and_b32 v187, 0xffff0000, v93
  v_lshlrev_b32 v188, 16, v94
  v_and_b32 v189, 0xffff0000, v94
  v_lshlrev_b32 v190, 16, v95
  v_and_b32 v191, 0xffff0000, v95
  v_add_f32 v168, v168, v184
  v_add_f32 v169, v169, v185
  v_add_f32 v170, v170, v186
  v_add_f32 v171, v171, v187
  v_add_f32 v172, v172, v188
  v_add_f32 v173, v173, v189
  v_add_f32 v174, v174, v190
  v_add_f32 v175, v175, v191
  s_waitcnt vmcnt(15)
  v_lshlrev_b32 v184, 16, v96
  v_and_b32 v185, 0xffff0000, v96
  v_lshlrev_b32 v186, 16, v97
  v_and_b32 v187, 0xffff0000, v97
  v_lshlrev_b32 v188, 16, v98
  v_and_b32 v189, 0xffff0000, v98
  v_lshlrev_b32 v190, 16, v99
  v_and_b32 v191, 0xffff0000, v99
  v_add_f32 v176, v176, v184
  v_add_f32 v177, v177, v185
  v_add_f32 v178, v178, v186
  v_add_f32 v179, v179, v187
  v_add_f32 v180, v180, v188
  v_add_f32 v181, v181, v189
  v_add_f32 v182, v182, v190
  v_add_f32 v183, v183, v191
  s_waitcnt vmcnt(14)
  v_lshlrev_b32 v184, 16, v100
  v_and_b32 v185, 0xffff0000, v100
  v_lshlrev_b32 v186, 16, v101
  v_and_b32 v187, 0xffff0000, v101
  v_lshlrev_b32 v188, 16, v102
  v_and_b32 v189, 0xffff0000, v102
  v_lshlrev_b32 v190, 16, v103
  v_and_b32 v191, 0xffff0000, v103
  v_add_f32 v160, v160, v184
  v_add_f32 v161, v161, v185
  v_add_f32 v162, v162, v186
  v_add_f32 v163, v163, v187
  v_add_f32 v164, v164, v188
  v_add_f32 v165, v165, v189
  v_add_f32 v166, v166, v190
  v_add_f32 v167, v167, v191
  s_waitcnt vmcnt(13)
  v_lshlrev_b32 v184, 16, v104
  v_and_b32 v185, 0xffff0000, v104
  v_lshlrev_b32 v186, 16, v105
  v_and_b32 v187, 0xffff0000, v105
  v_lshlrev_b32 v188, 16, v106
  v_and_b32 v189, 0xffff0000, v106
  v_lshlrev_b32 v190, 16, v107
  v_and_b32 v191, 0xffff0000, v107
  v_add_f32 v168, v168, v184
  v_add_f32 v169, v169, v185
  v_add_f32 v170, v170, v186
  v_add_f32 v171, v171, v187
  v_add_f32 v172, v172, v188
  v_add_f32 v173, v173, v189
  v_add_f32 v174, v174, v190
  v_add_f32 v175, v175, v191
  s_waitcnt vmcnt(12)
  v_lshlrev_b32 v184, 16, v108
  v_and_b32 v185, 0xffff0000, v108
  v_lshlrev_b32 v186, 16, v109
  v_and_b32 v187, 0xffff0000, v109
  v_lshlrev_b32 v188, 16, v110
  v_and_b32 v189, 0xffff0000, v110
  v_lshlrev_b32 v190, 16, v111
  v_and_b32 v191, 0xffff0000, v111
  v_add_f32 v176, v176, v184
  v_add_f32 v177, v177, v185
  v_add_f32 v178, v178, v186
  v_add_f32 v179, v179, v187
  v_add_f32 v180, v180, v188
  v_add_f32 v181, v181, v189
  v_add_f32 v182, v182, v190
  v_add_f32 v183, v183, v191
  s_waitcnt vmcnt(11)
  v_lshlrev_b32 v184, 16, v112
  v_and_b32 v185, 0xffff0000, v112
  v_lshlrev_b32 v186, 16, v113
  v_and_b32 v187, 0xffff0000, v113
  v_lshlrev_b32 v188, 16, v114
  v_and_b32 v189, 0xffff0000, v114
  v_lshlrev_b32 v190, 16, v115
  v_and_b32 v191, 0xffff0000, v115
  v_add_f32 v160, v160, v184
  v_add_f32 v161, v161, v185
  v_add_f32 v162, v162, v186
  v_add_f32 v163, v163, v187
  v_add_f32 v164, v164, v188
  v_add_f32 v165, v165, v189
  v_add_f32 v166, v166, v190
  v_add_f32 v167, v167, v191
  s_waitcnt vmcnt(10)
  v_lshlrev_b32 v184, 16, v116
  v_and_b32 v185, 0xffff0000, v116
  v_lshlrev_b32 v186, 16, v117
  v_and_b32 v187, 0xffff0000, v117
  v_lshlrev_b32 v188, 16, v118
  v_and_b32 v189, 0xffff0000, v118
  v_lshlrev_b32 v190, 16, v119
  v_and_b32 v191, 0xffff0000, v119
  v_add_f32 v168, v168, v184
  v_add_f32 v169, v169, v185
  v_add_f32 v170, v170, v186
  v_add_f32 v171, v171, v187
  v_add_f32 v172, v172, v188
  v_add_f32 v173, v173, v189
  v_add_f32 v174, v174, v190
  v_add_f32 v175, v175, v191
  s_waitcnt vmcnt(9)
  v_lshlrev_b32 v184, 16, v120
  v_and_b32 v185, 0xffff0000, v120
  v_lshlrev_b32 v186, 16, v121
  v_and_b32 v187, 0xffff0000, v121
  v_lshlrev_b32 v188, 16, v122
  v_and_b32 v189, 0xffff0000, v122
  v_lshlrev_b32 v190, 16, v123
  v_and_b32 v191, 0xffff0000, v123
  v_add_f32 v176, v176, v184
  v_add_f32 v177, v177, v185
  v_add_f32 v178, v178, v186
  v_add_f32 v179, v179, v187
  v_add_f32 v180, v180, v188
  v_add_f32 v181, v181, v189
  v_add_f32 v182, v182, v190
  v_add_f32 v183, v183, v191
  s_waitcnt vmcnt(8)
  v_lshlrev_b32 v184, 16, v124
  v_and_b32 v185, 0xffff0000, v124
  v_lshlrev_b32 v186, 16, v125
  v_and_b32 v187, 0xffff0000, v125
  v_lshlrev_b32 v188, 16, v126
  v_and_b32 v189, 0xffff0000, v126
  v_lshlrev_b32 v190, 16, v127
  v_and_b32 v191, 0xffff0000, v127
  v_add_f32 v160, v160, v184
  v_add_f32 v161, v161, v185
  v_add_f32 v162, v162, v186
  v_add_f32 v163, v163, v187
  v_add_f32 v164, v164, v188
  v_add_f32 v165, v165, v189
  v_add_f32 v166, v166, v190
  v_add_f32 v167, v167, v191
  s_waitcnt vmcnt(7)
  v_lshlrev_b32 v184, 16, v128
  v_and_b32 v185, 0xffff0000, v128
  v_lshlrev_b32 v186, 16, v129
  v_and_b32 v187, 0xffff0000, v129
  v_lshlrev_b32 v188, 16, v130
  v_and_b32 v189, 0xffff0000, v130
  v_lshlrev_b32 v190, 16, v131
  v_and_b32 v191, 0xffff0000, v131
  v_add_f32 v168, v168, v184
  v_add_f32 v169, v169, v185
  v_add_f32 v170, v170, v186
  v_add_f32 v171, v171, v187
  v_add_f32 v172, v172, v188
  v_add_f32 v173, v173, v189
  v_add_f32 v174, v174, v190
  v_add_f32 v175, v175, v191
  s_waitcnt vmcnt(6)
  v_lshlrev_b32 v184, 16, v132
  v_and_b32 v185, 0xffff0000, v132
  v_lshlrev_b32 v186, 16, v133
  v_and_b32 v187, 0xffff0000, v133
  v_lshlrev_b32 v188, 16, v134
  v_and_b32 v189, 0xffff0000, v134
  v_lshlrev_b32 v190, 16, v135
  v_and_b32 v191, 0xffff0000, v135
  v_add_f32 v176, v176, v184
  v_add_f32 v177, v177, v185
  v_add_f32 v178, v178, v186
  v_add_f32 v179, v179, v187
  v_add_f32 v180, v180, v188
  v_add_f32 v181, v181, v189
  v_add_f32 v182, v182, v190
  v_add_f32 v183, v183, v191
  s_waitcnt vmcnt(5)
  v_lshlrev_b32 v184, 16, v136
  v_and_b32 v185, 0xffff0000, v136
  v_lshlrev_b32 v186, 16, v137
  v_and_b32 v187, 0xffff0000, v137
  v_lshlrev_b32 v188, 16, v138
  v_and_b32 v189, 0xffff0000, v138
  v_lshlrev_b32 v190, 16, v139
  v_and_b32 v191, 0xffff0000, v139
  v_add_f32 v160, v160, v184
  v_add_f32 v161, v161, v185
  v_add_f32 v162, v162, v186
  v_add_f32 v163, v163, v187
  v_add_f32 v164, v164, v188
  v_add_f32 v165, v165, v189
  v_add_f32 v166, v166, v190
  v_add_f32 v167, v167, v191
  s_waitcnt vmcnt(4)
  v_lshlrev_b32 v184, 16, v140
  v_and_b32 v185, 0xffff0000, v140
  v_lshlrev_b32 v186, 16, v141
  v_and_b32 v187, 0xffff0000, v141
  v_lshlrev_b32 v188, 16, v142
  v_and_b32 v189, 0xffff0000, v142
  v_lshlrev_b32 v190, 16, v143
  v_and_b32 v191, 0xffff0000, v143
  v_add_f32 v168, v168, v184
  v_add_f32 v169, v169, v185
  v_add_f32 v170, v170, v186
  v_add_f32 v171, v171, v187
  v_add_f32 v172, v172, v188
  v_add_f32 v173, v173, v189
  v_add_f32 v174, v174, v190
  v_add_f32 v175, v175, v191
  s_waitcnt vmcnt(3)
  v_lshlrev_b32 v184, 16, v144
  v_and_b32 v185, 0xffff0000, v144
  v_lshlrev_b32 v186, 16, v145
  v_and_b32 v187, 0xffff0000, v145
  v_lshlrev_b32 v188, 16, v146
  v_and_b32 v189, 0xffff0000, v146
  v_lshlrev_b32 v190, 16, v147
  v_and_b32 v191, 0xffff0000, v147
  v_add_f32 v176, v176, v184
  v_add_f32 v177, v177, v185
  v_add_f32 v178, v178, v186
  v_add_f32 v179, v179, v187
  v_add_f32 v180, v180, v188
  v_add_f32 v181, v181, v189
  v_add_f32 v182, v182, v190
  v_add_f32 v183, v183, v191
  s_waitcnt vmcnt(2)
  v_lshlrev_b32 v184, 16, v148
  v_and_b32 v185, 0xffff0000, v148
  v_lshlrev_b32 v186, 16, v149
  v_and_b32 v187, 0xffff0000, v149
  v_lshlrev_b32 v188, 16, v150
  v_and_b32 v189, 0xffff0000, v150
  v_lshlrev_b32 v190, 16, v151
  v_and_b32 v191, 0xffff0000, v151
  v_add_f32 v160, v160, v184
  v_add_f32 v161, v161, v185
  v_add_f32 v162, v162, v186
  v_add_f32 v163, v163, v187
  v_add_f32 v164, v164, v188
  v_add_f32 v165, v165, v189
  v_add_f32 v166, v166, v190
  v_add_f32 v167, v167, v191
  s_waitcnt vmcnt(1)
  v_lshlrev_b32 v184, 16, v152
  v_and_b32 v185, 0xffff0000, v152
  v_lshlrev_b32 v186, 16, v153
  v_and_b32 v187, 0xffff0000, v153
  v_lshlrev_b32 v188, 16, v154
  v_and_b32 v189, 0xffff0000, v154
  v_lshlrev_b32 v190, 16, v155
  v_and_b32 v191, 0xffff0000, v155
  v_add_f32 v168, v168, v184
  v_add_f32 v169, v169, v185
  v_add_f32 v170, v170, v186
  v_add_f32 v171, v171, v187
  v_add_f32 v172, v172, v188
  v_add_f32 v173, v173, v189
  v_add_f32 v174, v174, v190
  v_add_f32 v175, v175, v191
  s_waitcnt vmcnt(0)
  v_lshlrev_b32 v184, 16, v156
  v_and_b32 v185, 0xffff0000, v156
  v_lshlrev_b32 v186, 16, v157
  v_and_b32 v187, 0xffff0000, v157
  v_lshlrev_b32 v188, 16, v158
  v_and_b32 v189, 0xffff0000, v158
  v_lshlrev_b32 v190, 16, v159
  v_and_b32 v191, 0xffff0000, v159
  v_add_f32 v176, v176, v184
  v_add_f32 v177, v177, v185
  v_add_f32 v178, v178, v186
  v_add_f32 v179, v179, v187
  v_add_f32 v180, v180, v188
  v_add_f32 v181, v181, v189
  v_add_f32 v182, v182, v190
  v_add_f32 v183, v183, v191
  v_permlane32_swap_b32 v160, v164
  v_permlane32_swap_b32 v161, v165
  v_permlane32_swap_b32 v162, v166
  v_permlane32_swap_b32 v163, v167
  v_add_f32 v160, v160, v164
  v_add_f32 v161, v161, v165
  v_add_f32 v162, v162, v166
  v_add_f32 v163, v163, v167
  s_nop 0
  v_permlane16_swap_b32 v160, v162
  v_permlane16_swap_b32 v161, v163
  v_add_f32 v160, v160, v162
  v_add_f32 v161, v161, v163
  s_nop 0
  v_add_f32 v160, v160, v160 row_ror:8 row_mask:0xf bank_mask:0xf
  v_add_f32 v161, v161, v161 row_ror:8 row_mask:0xf bank_mask:0xf
  v_permlane32_swap_b32 v168, v172
  v_permlane32_swap_b32 v169, v173
  v_permlane32_swap_b32 v170, v174
  v_permlane32_swap_b32 v171, v175
  v_add_f32 v168, v168, v172
  v_add_f32 v169, v169, v173
  v_add_f32 v170, v170, v174
  v_add_f32 v171, v171, v175
  s_nop 0
  v_permlane16_swap_b32 v168, v170
  v_permlane16_swap_b32 v169, v171
  v_add_f32 v168, v168, v170
  v_add_f32 v169, v169, v171
  s_nop 0
  v_add_f32 v168, v168, v168 row_ror:8 row_mask:0xf bank_mask:0xf
  v_add_f32 v169, v169, v169 row_ror:8 row_mask:0xf bank_mask:0xf
  v_permlane32_swap_b32 v176, v180
  v_permlane32_swap_b32 v177, v181
  v_permlane32_swap_b32 v178, v182
  v_permlane32_swap_b32 v179, v183
  v_add_f32 v176, v176, v180
  v_add_f32 v177, v177, v181
  v_add_f32 v178, v178, v182
  v_add_f32 v179, v179, v183
  s_nop 0
  v_permlane16_swap_b32 v176, v178
  v_permlane16_swap_b32 v177, v179
  v_add_f32 v176, v176, v178
  v_add_f32 v177, v177, v179
  s_nop 0
  v_add_f32 v176, v176, v176 row_ror:8 row_mask:0xf bank_mask:0xf
  v_add_f32 v177, v177, v177 row_ror:8 row_mask:0xf bank_mask:0xf
  s_mov_b32 exec_lo, 0x00ff00ff
  s_mov_b32 exec_hi, 0x00ff00ff
  buffer_store_dwordx2 v[160:161], v21, s[4:7], s30 offen offset:0 sc1
  buffer_store_dwordx2 v[168:169], v21, s[4:7], s30 offen offset:256 sc1
  buffer_store_dwordx2 v[176:177], v21, s[4:7], s30 offen offset:512 sc1
  s_mov_b64 exec, -1
  s_mov_b32 s12, s58
  s_mov_b32 s13, s59
  s_mov_b32 s14, 0x100
  s_mov_b32 s15, 0x00020000
  s_mov_b32 s38, 0
  s_mov_b64 exec, 1
.g2_kernel_gt12:
  buffer_load_dword v6, v4, s[12:15], 0 offen sc1
  s_add_u32 s38, s38, 1
  s_waitcnt vmcnt(0)
  v_cmp_eq_u32 vcc, 0x60, v6
  s_cbranch_vccnz .g2_kernel_gt12d
  s_sleep 8
  s_cmp_lt_u32 s38, 131072
  s_cbranch_scc1 .g2_kernel_gt12
.g2_kernel_gt12d:
  s_mov_b64 exec, -1
  v_mov_b32 v6, s70
  s_mov_b64 exec, 1
  buffer_store_dword v6, v4, s[4:7], s76 offen offset:4 sc1
  s_mov_b64 exec, -1
  v_mov_b32 v6, 155648
  s_mov_b32 s38, 0
.g2_kernel_wg13:
  ds_read_b32 v7, v6 offset:512
  s_add_u32 s38, s38, 1
  s_waitcnt lgkmcnt(0)
  v_cmp_gt_u32 vcc, 22, v7
  s_cbranch_vccz .g2_kernel_wg13d
  s_sleep 4
  s_cmp_lt_u32 s38, 524288
  s_cbranch_scc1 .g2_kernel_wg13
.g2_kernel_wg13d:
  s_and_b32 s31, s76, 0xffffe000
  s_add_u32 s31, s31, 4
  v_and_b32 v6, 15, v2
  v_lshlrev_b32 v6, 9, v6
  v_lshrrev_b32 v7, 4, v2
  v_lshl_add_u32 v6, v7, 7, v6
  v_lshlrev_b32 v7, 2, v2
  v_add_u32 v7, 157696, v7
  s_mov_b32 m0, 157696
  s_mov_b32 s38, 0
  s_bfm_b64 exec, 16, 0
.g2_kernel_pa14:
  buffer_load_dword v6, s[4:7], s31 offen sc1 lds
  s_add_u32 s38, s38, 1
  s_waitcnt vmcnt(0)
  ds_read_b32 v8, v7
  s_waitcnt lgkmcnt(0)
  v_cmp_ge_u32 vcc, s62, v8
  s_cbranch_vccz .g2_kernel_pa14d
  s_mov_b64 exec, vcc
  s_sleep 16
  s_cmp_lt_u32 s38, 131072
  s_cbranch_scc1 .g2_kernel_pa14
.g2_kernel_pa14d:
  s_mov_b64 exec, -1
  s_mul_i32 s30, s18, 12288
  s_add_u32 s30, s30, 0x3080000
  s_mov_b32 exec_hi, 0xffff
  buffer_load_dwordx4 v[64:67], v3, s[4:7], s30 offen offset:0 sc1
  buffer_load_dwordx4 v[68:71], v3, s[4:7], s30 offen offset:768 sc1
  buffer_load_dwordx4 v[72:75], v3, s[4:7], s30 offen offset:1536 sc1
  buffer_load_dwordx4 v[76:79], v3, s[4:7], s30 offen offset:2304 sc1
  s_add_u32 s30, s30, 3072
  buffer_load_dwordx4 v[80:83], v3, s[4:7], s30 offen offset:0 sc1
  buffer_load_dwordx4 v[84:87], v3, s[4:7], s30 offen offset:768 sc1
  buffer_load_dwordx4 v[88:91], v3, s[4:7], s30 offen offset:1536 sc1
  buffer_load_dwordx4 v[92:95], v3, s[4:7], s30 offen offset:2304 sc1
  s_add_u32 s30, s30, 3072
  buffer_load_dwordx4 v[96:99], v3, s[4:7], s30 offen offset:0 sc1
  buffer_load_dwordx4 v[100:103], v3, s[4:7], s30 offen offset:768 sc1
  buffer_load_dwordx4 v[104:107], v3, s[4:7], s30 offen offset:1536 sc1
  buffer_load_dwordx4 v[108:111], v3, s[4:7], s30 offen offset:2304 sc1
  s_add_u32 s30, s30, 3072
  buffer_load_dwordx4 v[112:115], v3, s[4:7], s30 offen offset:0 sc1
  buffer_load_dwordx4 v[116:119], v3, s[4:7], s30 offen offset:768 sc1
  buffer_load_dwordx4 v[120:123], v3, s[4:7], s30 offen offset:1536 sc1
  buffer_load_dwordx4 v[124:127], v3, s[4:7], s30 offen offset:2304 sc1
  s_add_u32 s30, s30, 3072
  s_waitcnt vmcnt(14)
  v_add_f32 v64, v64, v68
  v_add_f32 v65, v65, v69
  v_add_f32 v66, v66, v70
  v_add_f32 v67, v67, v71
  s_waitcnt vmcnt(13)
  v_add_f32 v64, v64, v72
  v_add_f32 v65, v65, v73
  v_add_f32 v66, v66, v74
  v_add_f32 v67, v67, v75
  s_waitcnt vmcnt(12)
  v_add_f32 v64, v64, v76
  v_add_f32 v65, v65, v77
  v_add_f32 v66, v66, v78
  v_add_f32 v67, v67, v79
  s_waitcnt vmcnt(11)
  v_add_f32 v64, v64, v80
  v_add_f32 v65, v65, v81
  v_add_f32 v66, v66, v82
  v_add_f32 v67, v67, v83
  s_waitcnt vmcnt(10)
  v_add_f32 v64, v64, v84
  v_add_f32 v65, v65, v85
  v_add_f32 v66, v66, v86
  v_add_f32 v67, v67, v87
  s_waitcnt vmcnt(9)
  v_add_f32 v64, v64, v88
  v_add_f32 v65, v65, v89
  v_add_f32 v66, v66, v90
  v_add_f32 v67, v67, v91
  s_waitcnt vmcnt(8)
  v_add_f32 v64, v64, v92
  v_add_f32 v65, v65, v93
  v_add_f32 v66, v66, v94
  v_add_f32 v67, v67, v95
  s_waitcnt vmcnt(7)
  v_add_f32 v64, v64, v96
  v_add_f32 v65, v65, v97
  v_add_f32 v66, v66, v98
  v_add_f32 v67, v67, v99
  s_waitcnt vmcnt(6)
  v_add_f32 v64, v64, v100
  v_add_f32 v65, v65, v101
  v_add_f32 v66, v66, v102
  v_add_f32 v67, v67, v103
  s_waitcnt vmcnt(5)
  v_add_f32 v64, v64, v104
  v_add_f32 v65, v65, v105
  v_add_f32 v66, v66, v106
  v_add_f32 v67, v67, v107
  s_waitcnt vmcnt(4)
  v_add_f32 v64, v64, v108
  v_add_f32 v65, v65, v109
  v_add_f32 v66, v66, v110
  v_add_f32 v67, v67, v111
  s_waitcnt vmcnt(3)
  v_add_f32 v64, v64, v112
  v_add_f32 v65, v65, v113
  v_add_f32 v66, v66, v114
  v_add_f32 v67, v67, v115
  s_waitcnt vmcnt(2)
  v_add_f32 v64, v64, v116
  v_add_f32 v65, v65, v117
  v_add_f32 v66, v66, v118
  v_add_f32 v67, v67, v119
  s_waitcnt vmcnt(1)
  v_add_f32 v64, v64, v120
  v_add_f32 v65, v65, v121
  v_add_f32 v66, v66, v122
  v_add_f32 v67, v67, v123
  s_waitcnt vmcnt(0)
  v_add_f32 v64, v64, v124
  v_add_f32 v65, v65, v125
  v_add_f32 v66, v66, v126
  v_add_f32 v67, v67, v127
  s_mov_b64 exec, -1
  v_mov_b32 v6, 155648
  s_mov_b32 s38, 0
.g2_kernel_wg15:
  ds_read_b32 v7, v6 offset:512
  s_add_u32 s38, s38, 1
  s_waitcnt lgkmcnt(0)
  v_cmp_gt_u32 vcc, 32, v7
  s_cbranch_vccz .g2_kernel_wg15d
  s_sleep 2
  s_cmp_lt_u32 s38, 524288
  s_cbranch_scc1 .g2_kernel_wg15
.g2_kernel_wg15d:
  v_lshlrev_b32 v24, 2, v2
  v_add_u32 v24, 155648, v24
  ds_write_b32 v24, v4 offset:2048
  v_add_u32 v24, 155648, v3
  s_mov_b32 exec_hi, 0xffff
  ds_write_b128 v24, v[64:67] offset:4864
  s_mov_b64 exec, -1
  v_mov_b32 v6, s71
  s_mov_b64 exec, 1
  ds_add_u32 v6, v5 offset:0
  s_mov_b64 exec, -1
  s_branch .g2_kernel_v
.g2_kernel_s3:
  s_mov_b32 s12, s58
  s_mov_b32 s13, s59
  s_mov_b32 s14, 0x100
  s_mov_b32 s15, 0x00020000
  s_mov_b32 s20, s48
  s_mov_b32 s21, s49
  s_mov_b32 s22, 0x800
  s_mov_b32 s23, 0x00020000
  v_mov_b32 v12, 0
  v_mov_b32 v13, 0
  v_mov_b32 v14, 0
  v_mov_b32 v15, 0
  s_cmp_ge_u32 s2, 96
  s_cbranch_scc1 .g2_kernel_zm16
  s_lshl_b32 s36, s2, 12
  s_add_u32 s36, s36, 0x3000000
  buffer_store_dwordx4 v[12:15], v3, s[4:7], s36 offen sc1
  buffer_store_dwordx4 v[12:15], v3, s[4:7], s36 offen offset:1024 sc1
  buffer_store_dwordx4 v[12:15], v3, s[4:7], s36 offen offset:2048 sc1
  buffer_store_dwordx4 v[12:15], v3, s[4:7], s36 offen offset:3072 sc1
.g2_kernel_zm16:
  s_barrier
  s_cbranch_scc1 .g2_kernel_zm16b
  s_mov_b64 exec, 1
  s_waitcnt vmcnt(0)
  buffer_atomic_add v5, v4, s[12:15], 0 offen sc1
  s_mov_b64 exec, -1
.g2_kernel_zm16b:
  s_and_b32 s36, s18, 7
  s_cmp_ge_u32 s36, 3
  s_cbranch_scc1 .g2_kernel_c317
  s_mov_b32 s24, s42
  s_mov_b32 s25, s43
  s_mov_b32 s26, 0x600000
  s_mov_b32 s27, 0x00020000
  v_mul_u32_u24 v7, 6144, v2
  s_lshl_b32 s36, s36, 11
  s_or_b32 s37, s18, 3
  s_lshl_b32 s37, s37, 7
  s_add_u32 s36, s36, s37
  s_and_b32 s37, s17, 7
  s_mul_i32 s37, s37, 393216
  s_add_u32 s36, s36, s37
  s_add_u32 s37, s36, 3145728
  s_sleep 0
  buffer_load_dword v1, v7, s[24:27], s36 offen
  s_sleep 30
  buffer_load_dword v1, v7, s[24:27], s37 offen
.g2_kernel_c317:
  v_lshlrev_b32 v20, 5, v2
  buffer_load_dwordx4 v[24:27], v20, s[20:23], 0 offen
  buffer_load_dwordx4 v[28:31], v20, s[20:23], 0 offen offset:16
  v_mov_b32 v20, 0
  s_waitcnt vmcnt(0)
  v_lshlrev_b32 v21, 16, v24
  v_and_b32 v22, 0xffff0000, v24
  v_add_f32 v20, v20, v21
  v_add_f32 v20, v20, v22
  v_lshlrev_b32 v21, 16, v25
  v_and_b32 v22, 0xffff0000, v25
  v_add_f32 v20, v20, v21
  v_add_f32 v20, v20, v22
  v_lshlrev_b32 v21, 16, v26
  v_and_b32 v22, 0xffff0000, v26
  v_add_f32 v20, v20, v21
  v_add_f32 v20, v20, v22
  v_lshlrev_b32 v21, 16, v27
  v_and_b32 v22, 0xffff0000, v27
  v_add_f32 v20, v20, v21
  v_add_f32 v20, v20, v22
  v_lshlrev_b32 v21, 16, v28
  v_and_b32 v22, 0xffff0000, v28
  v_add_f32 v20, v20, v21
  v_add_f32 v20, v20, v22
  v_lshlrev_b32 v21, 16, v29
  v_and_b32 v22, 0xffff0000, v29
  v_add_f32 v20, v20, v21
  v_add_f32 v20, v20, v22
  v_lshlrev_b32 v21, 16, v30
  v_and_b32 v22, 0xffff0000, v30
  v_add_f32 v20, v20, v21
  v_add_f32 v20, v20, v22
  v_lshlrev_b32 v21, 16, v31
  v_and_b32 v22, 0xffff0000, v31
  v_add_f32 v20, v20, v21
  v_add_f32 v20, v20, v22
  s_nop 1
  v_add_f32 v20, v20, v20 quad_perm:[1,0,3,2] row_mask:0xf bank_mask:0xf
  s_nop 1
  v_add_f32 v20, v20, v20 quad_perm:[2,3,0,1] row_mask:0xf bank_mask:0xf
  s_nop 1
  v_add_f32 v20, v20, v20 row_half_mirror row_mask:0xf bank_mask:0xf
  s_nop 1
  v_add_f32 v20, v20, v20 row_mirror row_mask:0xf bank_mask:0xf
  s_nop 0
  v_readlane_b32 s20, v20, 16
  v_readlane_b32 s21, v20, 32
  v_readlane_b32 s22, v20, 48
  v_add_f32 v20, s20, v20
  v_add_f32 v20, s21, v20
  v_add_f32 v20, s22, v20
  v_mul_f32 v20, 0x3a800000, v20
  v_mov_b32 v6, 155648
  s_mov_b32 s38, 0
.g2_kernel_wg18:
  ds_read_b32 v7, v6 offset:512
  s_add_u32 s38, s38, 1
  s_waitcnt lgkmcnt(0)
  v_cmp_gt_u32 vcc, 32, v7
  s_cbranch_vccz .g2_kernel_wg18d
  s_sleep 2
  s_cmp_lt_u32 s38, 524288
  s_cbranch_scc1 .g2_kernel_wg18
.g2_kernel_wg18d:
  v_mov_b32 v21, 155648
  s_mov_b64 exec, 1
  ds_write_b32 v21, v20 offset:256
  s_mov_b64 exec, -1
.g2_kernel_v:
  s_setprio 3
  s_cmp_lg_u32 s16, 4
  s_cbranch_scc1 .g2_kernel_v_1
  v_mov_b32 v6, s71
  s_mov_b32 s38, 0
.g2_kernel_wg19:
  ds_read_b32 v7, v6 offset:120
  s_add_u32 s38, s38, 1
  s_waitcnt lgkmcnt(0)
  v_cmp_gt_u32 vcc, 2, v7
  s_cbranch_vccz .g2_kernel_wg19d
  s_sleep 1
  s_cmp_lt_u32 s38, 524288
  s_cbranch_scc1 .g2_kernel_wg19
.g2_kernel_wg19d:
  s_sleep 4
  s_and_b32 s31, s76, 0xffffe000
  s_add_u32 s31, s31, 0
  v_and_b32 v6, 15, v2
  v_lshlrev_b32 v6, 9, v6
  v_lshrrev_b32 v7, 4, v2
  v_lshl_add_u32 v6, v7, 7, v6
  v_lshlrev_b32 v7, 2, v2
  v_add_u32 v7, 157440, v7
  s_mov_b32 m0, 157440
  s_mov_b32 s38, 0
  s_mov_b32 exec_lo, 0xffff
  s_mov_b32 exec_hi, 0xffff
.g2_kernel_pa20:
  buffer_load_dword v6, s[4:7], s31 offen sc1 lds
  s_add_u32 s38, s38, 1
  s_waitcnt vmcnt(0)
  ds_read_b32 v8, v7
  s_waitcnt lgkmcnt(0)
  v_cmp_ge_u32 vcc, s62, v8
  s_cbranch_vccz .g2_kernel_pa20d
  s_mov_b64 exec, vcc
  s_sleep 2
  s_cmp_lt_u32 s38, 131072
  s_cbranch_scc1 .g2_kernel_pa20
.g2_kernel_pa20d:
  s_mov_b64 exec, -1
  v_mov_b32 v6, s71
  s_mov_b32 s38, 0
.g2_kernel_wg21:
  ds_read_b32 v7, v6 offset:4
  s_add_u32 s38, s38, 1
  s_waitcnt lgkmcnt(0)
  v_cmp_gt_u32 vcc, 4, v7
  s_cbranch_vccz .g2_kernel_wg21d
  s_sleep 2
  s_cmp_lt_u32 s38, 524288
  s_cbranch_scc1 .g2_kernel_wg21
.g2_kernel_wg21d:
  v_mov_b32 v6, s71
  s_mov_b64 exec, 1
  ds_add_u32 v6, v5 offset:80
  s_mov_b64 exec, -1
.g2_kernel_v_1:
  s_cmp_lt_u32 s16, 6
  s_cbranch_scc1 .g2_kernel_v_2
  v_mov_b32 v6, s71
  s_mov_b32 s38, 0
.g2_kernel_wg22:
  ds_read_b32 v7, v6 offset:4
  s_add_u32 s38, s38, 1
  s_waitcnt lgkmcnt(0)
  v_cmp_gt_u32 vcc, 4, v7
  s_cbranch_vccz .g2_kernel_wg22d
  s_sleep 4
  s_cmp_lt_u32 s38, 524288
  s_cbranch_scc1 .g2_kernel_wg22
.g2_kernel_wg22d:
  s_and_b32 s28, s16, 1
  s_lshl_b32 s30, s28, 13
  s_add_u32 s31, s30, 16384
  v_add_u32 v8, s31, v3
  ds_read_b32 v9, v6 offset:24
  ds_read_b128 v[16:19], v8 offset:0
  ds_read_b128 v[20:23], v8 offset:1024
  ds_read_b128 v[24:27], v8 offset:2048
  ds_read_b128 v[28:31], v8 offset:3072
  ds_read_b128 v[32:35], v8 offset:4096
  ds_read_b128 v[36:39], v8 offset:5120
  ds_read_b128 v[40:43], v8 offset:6144
  ds_read_b128 v[44:47], v8 offset:7168
  s_lshl_b32 s31, s18, 5
  s_add_u32 s31, s31, s17
  s_add_u32 s31, s31, 16
  s_lshl_b32 s31, s31, 14
  s_add_u32 s30, s30, s31
  s_add_u32 s30, s30, s63
  s_add_u32 s31, s30, 4096
  s_lshl_b32 s33, s28, 8
  s_add_u32 s33, s33, 128
  s_waitcnt lgkmcnt(0)
  v_readfirstlane_b32 s29, v9
  v_mov_b32 v6, s71
  s_mov_b64 exec, 1
  ds_add_u32 v6, v5 offset:8
  s_mov_b64 exec, -1
  s_sleep 40
  buffer_store_dwordx4 v[16:19], v3, s[4:7], s30 offen offset:0 sc1
  s_sleep 4
  buffer_store_dwordx4 v[20:23], v3, s[4:7], s30 offen offset:1024 sc1
  s_sleep 4
  buffer_store_dwordx4 v[24:27], v3, s[4:7], s30 offen offset:2048 sc1
  s_sleep 4
  buffer_store_dwordx4 v[28:31], v3, s[4:7], s30 offen offset:3072 sc1
  s_sleep 4
  buffer_store_dwordx4 v[32:35], v3, s[4:7], s31 offen offset:0 sc1
  s_sleep 4
  buffer_store_dwordx4 v[36:39], v3, s[4:7], s31 offen offset:1024 sc1
  s_sleep 4
  buffer_store_dwordx4 v[40:43], v3, s[4:7], s31 offen offset:2048 sc1
  s_sleep 4
  buffer_store_dwordx4 v[44:47], v3, s[4:7], s31 offen offset:3072 sc1
  s_sleep 4
  s_sub_u32 s29, s29, 1
  s_lshr_b32 s29, s29, 6
  s_waitcnt vmcnt(0)
  s_cmp_eq_u32 s29, s28
  s_cbranch_scc1 .g2_kernel_v_1h
  s_add_u32 s31, s76, s33
  v_mov_b32 v6, s70
  s_mov_b64 exec, 1
  buffer_store_dword v6, v4, s[4:7], s31 offen offset:0 sc1
  s_mov_b64 exec, -1
  s_branch .g2_kernel_v_2
.g2_kernel_v_1h:
  v_mov_b32 v6, s71
  s_mov_b64 exec, 1
  ds_add_u32 v6, v5 offset:56
  s_mov_b64 exec, -1
.g2_kernel_v_2:
  v_mov_b32 v6, s71
  s_mov_b32 s38, 0
.g2_kernel_wg23:
  ds_read_b32 v7, v6 offset:80
  s_add_u32 s38, s38, 1
  s_waitcnt lgkmcnt(0)
  v_cmp_gt_u32 vcc, 1, v7
  s_cbranch_vccz .g2_kernel_wg23d
  s_sleep 8
  s_cmp_lt_u32 s38, 524288
  s_cbranch_scc1 .g2_kernel_wg23
.g2_kernel_wg23d:
  s_sleep 20
  s_mov_b32 s39, 0
  v_mov_b32 v12, 0
  v_mov_b32 v13, 0
  v_mov_b32 v14, 0
  v_mov_b32 v15, 0
  s_lshl_b32 s30, s17, 2
  s_and_b32 s31, s16, 3
  s_add_u32 s30, s30, s31
  s_lshl_b32 s30, s30, 4
  s_add_u32 s30, s30, s18
  s_lshl_b32 s30, s30, 9
  s_add_u32 s30, s30, s63
  s_add_u32 s30, s30, 0x1000000
  s_mov_b32 exec_hi, 0
  s_sleep 6
  buffer_store_dwordx4 v[12:15], v3, s[4:7], s30 offen sc1
  s_mov_b64 exec, -1
  s_lshl_b32 s30, s17, 2
  s_add_u32 s30, s30, s31
  s_lshl_b32 s30, s30, 5
  s_add_u32 s30, s30, s18
  s_lshl_b32 s30, s30, 11
  s_add_u32 s30, s30, s63
  s_add_u32 s30, s30, 0x808000
  s_sleep 6
  buffer_store_dwordx4 v[12:15], v3, s[4:7], s30 offen sc1
  s_sleep 6
  buffer_store_dwordx4 v[12:15], v3, s[4:7], s30 offen offset:1024 sc1
  s_cmp_lg_u32 s62, 5
  s_cbranch_scc1 .g2_kernel_zs24k
  s_lshl_b32 s30, s18, 4
  s_add_u32 s30, s30, s17
  s_lshl_b32 s30, s30, 2
  s_add_u32 s30, s30, s31
  s_lshl_b32 s30, s30, 12
  s_add_u32 s30, s30, 0x2c00000
  s_sleep 6
  buffer_store_dwordx4 v[12:15], v3, s[4:7], s30 offen sc1
  s_sleep 6
  buffer_store_dwordx4 v[12:15], v3, s[4:7], s30 offen offset:1024 sc1
  s_sleep 6
  buffer_store_dwordx4 v[12:15], v3, s[4:7], s30 offen offset:2048 sc1
  s_sleep 6
  buffer_store_dwordx4 v[12:15], v3, s[4:7], s30 offen offset:3072 sc1
.g2_kernel_zs24k:
  s_lshl_b32 s30, s17, 4
  s_add_u32 s30, s30, s18
  s_cmp_gt_u32 s16, 5
  s_cbranch_scc1 .g2_kernel_zs24
  s_cmp_eq_u32 s16, 5
  s_cbranch_scc1 .g2_kernel_zs24a
  s_cmp_lg_u32 s62, 0
  s_cbranch_scc1 .g2_kernel_zs24
  s_lshl_b32 s30, s30, 12
  s_add_u32 s31, s30, 0x1090000
  s_sleep 6
  buffer_store_dwordx4 v[12:15], v3, s[4:7], s31 offen offset:0 sc1
  s_sleep 6
  buffer_store_dwordx4 v[12:15], v3, s[4:7], s31 offen offset:1024 sc1
  s_sleep 6
  buffer_store_dwordx4 v[12:15], v3, s[4:7], s31 offen offset:2048 sc1
  s_sleep 6
  buffer_store_dwordx4 v[12:15], v3, s[4:7], s31 offen offset:3072 sc1
  s_add_u32 s31, s30, 0x2890000
  s_sleep 6
  buffer_store_dwordx4 v[12:15], v3, s[4:7], s31 offen offset:0 sc1
  s_sleep 6
  buffer_store_dwordx4 v[12:15], v3, s[4:7], s31 offen offset:1024 sc1
  s_sleep 6
  buffer_store_dwordx4 v[12:15], v3, s[4:7], s31 offen offset:2048 sc1
  s_sleep 6
  buffer_store_dwordx4 v[12:15], v3, s[4:7], s31 offen offset:3072 sc1
  s_add_u32 s31, s30, 0x2b00000
  s_sleep 6
  buffer_store_dwordx4 v[12:15], v3, s[4:7], s31 offen offset:0 sc1
  s_sleep 6
  buffer_store_dwordx4 v[12:15], v3, s[4:7], s31 offen offset:1024 sc1
  s_sleep 6
  buffer_store_dwordx4 v[12:15], v3, s[4:7], s31 offen offset:2048 sc1
  s_sleep 6
  buffer_store_dwordx4 v[12:15], v3, s[4:7], s31 offen offset:3072 sc1
  s_branch .g2_kernel_zs24
.g2_kernel_zs24a:
  s_xor_b32 s31, s17, s18
  s_and_b32 s31, s31, 3
  s_cbranch_scc1 .g2_kernel_zs24b
  s_lshr_b32 s30, s30, 2
  s_lshl_b32 s30, s30, 8
  s_add_u32 s30, s30, s63
  s_add_u32 s30, s30, 0x1080000
  s_mov_b64 exec, 0xffff
  s_sleep 6
  buffer_store_dwordx4 v[12:15], v3, s[4:7], s30 offen sc1
  s_mov_b64 exec, -1
.g2_kernel_zs24b:
  s_and_b32 s30, s18, 14
  s_lshl_b32 s30, s30, 4
  s_add_u32 s30, s30, s17
  s_lshl_b32 s30, s30, 1
  s_and_b32 s31, s18, 1
  s_add_u32 s30, s30, s31
  s_lshl_b32 s30, s30, 10
  s_add_u32 s30, s30, s63
  s_add_u32 s30, s30, 0x1190000
  s_add_u32 s31, s30, 32768
  s_sleep 6
  buffer_store_dwordx4 v[12:15], v3, s[4:7], s30 offen sc1
  s_sleep 6
  buffer_store_dwordx4 v[12:15], v3, s[4:7], s31 offen sc1
.g2_kernel_zs24:
  s_cmp_eq_u32 s16, 4
  s_cbranch_scc1 .g2_kernel_v_3a
  s_cmp_lg_u32 s62, 0
  s_cbranch_scc1 .g2_kernel_g_e
  s_and_b32 s22, s16, 3
  s_lshl_b32 s22, s22, 14
  s_cmp_eq_u32 s16, 5
  s_cselect_b32 s28, 65536, 0
  s_add_u32 s22, s22, s28
  v_bfe_u32 v8, v2, 2, 2
  v_lshrrev_b32 v9, 4, v2
  v_and_b32 v10, 3, v2
  v_lshlrev_b32 v10, 3, v10
  v_add_u32 v10, s22, v10
  s_cmp_eq_u32 s16, 5
  s_cbranch_scc1 .g2_kernel_g_p
  s_cmp_ge_u32 s17, 14
  s_cbranch_scc1 .g2_kernel_g_e
  v_lshrrev_b32 v6, 1, v2
  v_mul_u32_u24 v6, 7168, v6
  v_and_b32 v7, 1, v2
  v_lshl_add_u32 v250, v7, 4, v6
  v_lshl_add_u32 v11, v9, 3, v8
  v_lshl_add_u32 v251, v11, 5, v10
  v_and_b32 v11, 1, v9
  v_lshl_add_u32 v11, v11, 3, v8
  v_lshl_add_u32 v11, v11, 10, v10
  v_lshrrev_b32 v7, 1, v9
  v_lshl_add_u32 v252, v7, 7, v11
  s_lshl_b32 s24, s17, 4
  s_add_u32 s24, s24, s18
  s_and_b32 s25, s16, 1
  s_mov_b32 s12, s50
  s_mov_b32 s13, s51
  s_mov_b32 s14, 0x700000
  s_mov_b32 s15, 0x00020000
  s_mul_i32 s20, s25, 3670016
  s_lshl_b32 s31, s24, 5
  s_add_u32 s20, s20, s31
  s_lshl_b32 s31, s18, 2
  s_mov_b32 s23, s31
  s_mov_b32 s21, 16
.g2_kernel_gl26:
  s_and_b32 s30, s21, 3
  s_cbranch_scc1 .g2_kernel_gl26m
  s_call_b64 s[26:27], .g2_kernel_v_may
.g2_kernel_gl26m:
  s_and_b32 s23, s23, 15
  s_lshl_b32 s30, s23, 10
  s_add_u32 s30, s30, 0
  s_add_u32 m0, s30, s22
  s_mul_i32 s30, s23, 229376
  s_add_u32 s30, s30, s20
  buffer_load_dwordx4 v250, s[12:15], s30 offen lds
  s_add_u32 s23, s23, 1
  s_sub_u32 s21, s21, 1
  s_sleep 3
  s_waitcnt vmcnt(2)
  s_cmp_lg_u32 s21, 0
  s_cbranch_scc1 .g2_kernel_gl26
  s_waitcnt vmcnt(0)
  ds_read_b64_tr_b16 v[64:65], v251 offset:0
  ds_read_b64_tr_b16 v[66:67], v251 offset:128
  ds_read_b64_tr_b16 v[68:69], v251 offset:1024
  ds_read_b64_tr_b16 v[70:71], v251 offset:1152
  ds_read_b64_tr_b16 v[72:73], v251 offset:2048
  ds_read_b64_tr_b16 v[74:75], v251 offset:2176
  ds_read_b64_tr_b16 v[76:77], v251 offset:3072
  ds_read_b64_tr_b16 v[78:79], v251 offset:3200
  ds_read_b64_tr_b16 v[80:81], v251 offset:4096
  ds_read_b64_tr_b16 v[82:83], v251 offset:4224
  ds_read_b64_tr_b16 v[84:85], v251 offset:5120
  ds_read_b64_tr_b16 v[86:87], v251 offset:5248
  ds_read_b64_tr_b16 v[88:89], v251 offset:6144
  ds_read_b64_tr_b16 v[90:91], v251 offset:6272
  ds_read_b64_tr_b16 v[92:93], v251 offset:7168
  ds_read_b64_tr_b16 v[94:95], v251 offset:7296
  ds_read_b64_tr_b16 v[96:97], v251 offset:8192
  ds_read_b64_tr_b16 v[98:99], v251 offset:8320
  ds_read_b64_tr_b16 v[100:101], v251 offset:9216
  ds_read_b64_tr_b16 v[102:103], v251 offset:9344
  ds_read_b64_tr_b16 v[104:105], v251 offset:10240
  ds_read_b64_tr_b16 v[106:107], v251 offset:10368
  ds_read_b64_tr_b16 v[108:109], v251 offset:11264
  ds_read_b64_tr_b16 v[110:111], v251 offset:11392
  ds_read_b64_tr_b16 v[112:113], v251 offset:12288
  ds_read_b64_tr_b16 v[114:115], v251 offset:12416
  ds_read_b64_tr_b16 v[116:117], v251 offset:13312
  ds_read_b64_tr_b16 v[118:119], v251 offset:13440
  ds_read_b64_tr_b16 v[120:121], v251 offset:14336
  ds_read_b64_tr_b16 v[122:123], v251 offset:14464
  ds_read_b64_tr_b16 v[124:125], v251 offset:15360
  ds_read_b64_tr_b16 v[126:127], v251 offset:15488
  s_waitcnt lgkmcnt(0)
  s_mov_b32 s12, s52
  s_mov_b32 s13, s53
  s_mov_b32 s14, 0x700000
  s_mov_b32 s15, 0x00020000
  s_mul_i32 s20, s25, 3670016
  s_lshl_b32 s31, s24, 5
  s_add_u32 s20, s20, s31
  s_lshl_b32 s31, s18, 2
  s_mov_b32 s23, s31
  s_mov_b32 s21, 16
.g2_kernel_gl27:
  s_and_b32 s30, s21, 3
  s_cbranch_scc1 .g2_kernel_gl27m
  s_call_b64 s[26:27], .g2_kernel_v_may
.g2_kernel_gl27m:
  s_and_b32 s23, s23, 15
  s_lshl_b32 s30, s23, 10
  s_add_u32 s30, s30, 0
  s_add_u32 m0, s30, s22
  s_mul_i32 s30, s23, 229376
  s_add_u32 s30, s30, s20
  buffer_load_dwordx4 v250, s[12:15], s30 offen lds
  s_add_u32 s23, s23, 1
  s_sub_u32 s21, s21, 1
  s_sleep 3
  s_waitcnt vmcnt(2)
  s_cmp_lg_u32 s21, 0
  s_cbranch_scc1 .g2_kernel_gl27
  s_waitcnt vmcnt(0)
  ds_read_b64_tr_b16 v[128:129], v251 offset:0
  ds_read_b64_tr_b16 v[130:131], v251 offset:128
  ds_read_b64_tr_b16 v[132:133], v251 offset:1024
  ds_read_b64_tr_b16 v[134:135], v251 offset:1152
  ds_read_b64_tr_b16 v[136:137], v251 offset:2048
  ds_read_b64_tr_b16 v[138:139], v251 offset:2176
  ds_read_b64_tr_b16 v[140:141], v251 offset:3072
  ds_read_b64_tr_b16 v[142:143], v251 offset:3200
  ds_read_b64_tr_b16 v[144:145], v251 offset:4096
  ds_read_b64_tr_b16 v[146:147], v251 offset:4224
  ds_read_b64_tr_b16 v[148:149], v251 offset:5120
  ds_read_b64_tr_b16 v[150:151], v251 offset:5248
  ds_read_b64_tr_b16 v[152:153], v251 offset:6144
  ds_read_b64_tr_b16 v[154:155], v251 offset:6272
  ds_read_b64_tr_b16 v[156:157], v251 offset:7168
  ds_read_b64_tr_b16 v[158:159], v251 offset:7296
  ds_read_b64_tr_b16 v[160:161], v251 offset:8192
  ds_read_b64_tr_b16 v[162:163], v251 offset:8320
  ds_read_b64_tr_b16 v[164:165], v251 offset:9216
  ds_read_b64_tr_b16 v[166:167], v251 offset:9344
  ds_read_b64_tr_b16 v[168:169], v251 offset:10240
  ds_read_b64_tr_b16 v[170:171], v251 offset:10368
  ds_read_b64_tr_b16 v[172:173], v251 offset:11264
  ds_read_b64_tr_b16 v[174:175], v251 offset:11392
  ds_read_b64_tr_b16 v[176:177], v251 offset:12288
  ds_read_b64_tr_b16 v[178:179], v251 offset:12416
  ds_read_b64_tr_b16 v[180:181], v251 offset:13312
  ds_read_b64_tr_b16 v[182:183], v251 offset:13440
  ds_read_b64_tr_b16 v[184:185], v251 offset:14336
  ds_read_b64_tr_b16 v[186:187], v251 offset:14464
  ds_read_b64_tr_b16 v[188:189], v251 offset:15360
  ds_read_b64_tr_b16 v[190:191], v251 offset:15488
  s_waitcnt lgkmcnt(0)
  s_mov_b32 s12, s54
  s_mov_b32 s13, s55
  s_mov_b32 s14, 0x700000
  s_mov_b32 s15, 0x00020000
  s_lshl_b32 s20, s24, 15
  s_lshl_b32 s31, s25, 10
  s_add_u32 s20, s20, s31
  s_mov_b32 s23, 0
  s_mov_b32 s21, 16
.g2_kernel_gl28:
  s_and_b32 s30, s21, 3
  s_cbranch_scc1 .g2_kernel_gl28m
  s_call_b64 s[26:27], .g2_kernel_v_may
.g2_kernel_gl28m:
  s_and_b32 s23, s23, 15
  s_lshl_b32 s30, s23, 10
  s_add_u32 s30, s30, 0
  s_add_u32 m0, s30, s22
  s_mul_i32 s30, s23, 2048
  s_add_u32 s30, s30, s20
  buffer_load_dwordx4 v3, s[12:15], s30 offen lds
  s_add_u32 s23, s23, 1
  s_sub_u32 s21, s21, 1
  s_sleep 2
  s_waitcnt vmcnt(2)
  s_cmp_lg_u32 s21, 0
  s_cbranch_scc1 .g2_kernel_gl28
  v_mov_b32 v11, v252
  s_waitcnt vmcnt(0)
  ds_read_b64_tr_b16 v[192:193], v11 offset:0
  ds_read_b64_tr_b16 v[194:195], v11 offset:4096
  ds_read_b64_tr_b16 v[196:197], v11 offset:32
  ds_read_b64_tr_b16 v[198:199], v11 offset:4128
  ds_read_b64_tr_b16 v[200:201], v11 offset:64
  ds_read_b64_tr_b16 v[202:203], v11 offset:4160
  ds_read_b64_tr_b16 v[204:205], v11 offset:96
  ds_read_b64_tr_b16 v[206:207], v11 offset:4192
  ds_read_b64_tr_b16 v[208:209], v11 offset:256
  ds_read_b64_tr_b16 v[210:211], v11 offset:4352
  ds_read_b64_tr_b16 v[212:213], v11 offset:288
  ds_read_b64_tr_b16 v[214:215], v11 offset:4384
  ds_read_b64_tr_b16 v[216:217], v11 offset:320
  ds_read_b64_tr_b16 v[218:219], v11 offset:4416
  ds_read_b64_tr_b16 v[220:221], v11 offset:352
  ds_read_b64_tr_b16 v[222:223], v11 offset:4448
  ds_read_b64_tr_b16 v[224:225], v11 offset:512
  ds_read_b64_tr_b16 v[226:227], v11 offset:4608
  ds_read_b64_tr_b16 v[228:229], v11 offset:544
  ds_read_b64_tr_b16 v[230:231], v11 offset:4640
  ds_read_b64_tr_b16 v[232:233], v11 offset:576
  ds_read_b64_tr_b16 v[234:235], v11 offset:4672
  ds_read_b64_tr_b16 v[236:237], v11 offset:608
  ds_read_b64_tr_b16 v[238:239], v11 offset:4704
  ds_read_b64_tr_b16 v[240:241], v11 offset:768
  ds_read_b64_tr_b16 v[242:243], v11 offset:4864
  ds_read_b64_tr_b16 v[244:245], v11 offset:800
  ds_read_b64_tr_b16 v[246:247], v11 offset:4896
  ds_read_b64_tr_b16 v[248:249], v11 offset:832
  ds_read_b64_tr_b16 v[250:251], v11 offset:4928
  ds_read_b64_tr_b16 v[252:253], v11 offset:864
  ds_read_b64_tr_b16 v[254:255], v11 offset:4960
  s_waitcnt lgkmcnt(0)
  s_branch .g2_kernel_g_e
.g2_kernel_g_p:
  s_mov_b32 s12, s42
  s_mov_b32 s13, s43
  s_mov_b32 s14, 0x600000
  s_mov_b32 s15, 0x00020000
  v_mul_u32_u24 v6, 6144, v9
  v_and_b32 v7, 15, v2
  v_lshl_add_u32 v250, v7, 4, v6
  v_lshl_add_u32 v11, v8, 2, v9
  v_lshl_add_u32 v251, v11, 9, v10
  s_lshl_b32 s20, s17, 3
  s_and_b32 s31, s18, 1
  s_add_u32 s20, s20, s31
  s_mul_i32 s20, s20, 49152
  s_and_b32 s31, s18, 14
  s_lshl_b32 s31, s31, 7
  s_add_u32 s20, s20, s31
  s_mov_b32 s23, 0
  s_mov_b32 s21, 8
.g2_kernel_gl29:
  s_and_b32 s30, s21, 3
  s_cbranch_scc1 .g2_kernel_gl29m
  s_call_b64 s[26:27], .g2_kernel_v_may
.g2_kernel_gl29m:
  s_and_b32 s23, s23, 7
  s_lshl_b32 s30, s23, 10
  s_add_u32 s30, s30, 0
  s_add_u32 m0, s30, s22
  s_mul_i32 s30, s23, 49152
  s_add_u32 s30, s30, s20
  s_and_b32 s31, s23, 1
  s_mul_i32 s31, s31, -24576
  s_add_u32 s30, s30, s31
  buffer_load_dwordx4 v250, s[12:15], s30 offen lds
  s_add_u32 s23, s23, 1
  s_sub_u32 s21, s21, 1
  s_sleep 2
  s_waitcnt vmcnt(2)
  s_cmp_lg_u32 s21, 0
  s_cbranch_scc1 .g2_kernel_gl29
  s_add_u32 s20, s20, 2048
  s_mov_b32 s23, 0
  s_mov_b32 s21, 8
.g2_kernel_gl30:
  s_and_b32 s30, s21, 3
  s_cbranch_scc1 .g2_kernel_gl30m
  s_call_b64 s[26:27], .g2_kernel_v_may
.g2_kernel_gl30m:
  s_and_b32 s23, s23, 7
  s_lshl_b32 s30, s23, 10
  s_add_u32 s30, s30, 8192
  s_add_u32 m0, s30, s22
  s_mul_i32 s30, s23, 49152
  s_add_u32 s30, s30, s20
  s_and_b32 s31, s23, 1
  s_mul_i32 s31, s31, -24576
  s_add_u32 s30, s30, s31
  buffer_load_dwordx4 v250, s[12:15], s30 offen lds
  s_add_u32 s23, s23, 1
  s_sub_u32 s21, s21, 1
  s_sleep 2
  s_waitcnt vmcnt(2)
  s_cmp_lg_u32 s21, 0
  s_cbranch_scc1 .g2_kernel_gl30
  s_add_u32 s20, s20, 2048
  s_waitcnt vmcnt(0)
  ds_read_b64_tr_b16 v[64:65], v251 offset:0
  ds_read_b64_tr_b16 v[66:67], v251 offset:256
  ds_read_b64_tr_b16 v[68:69], v251 offset:32
  ds_read_b64_tr_b16 v[70:71], v251 offset:288
  ds_read_b64_tr_b16 v[72:73], v251 offset:64
  ds_read_b64_tr_b16 v[74:75], v251 offset:320
  ds_read_b64_tr_b16 v[76:77], v251 offset:96
  ds_read_b64_tr_b16 v[78:79], v251 offset:352
  ds_read_b64_tr_b16 v[80:81], v251 offset:128
  ds_read_b64_tr_b16 v[82:83], v251 offset:384
  ds_read_b64_tr_b16 v[84:85], v251 offset:160
  ds_read_b64_tr_b16 v[86:87], v251 offset:416
  ds_read_b64_tr_b16 v[88:89], v251 offset:192
  ds_read_b64_tr_b16 v[90:91], v251 offset:448
  ds_read_b64_tr_b16 v[92:93], v251 offset:224
  ds_read_b64_tr_b16 v[94:95], v251 offset:480
  ds_read_b64_tr_b16 v[96:97], v251 offset:8192
  ds_read_b64_tr_b16 v[98:99], v251 offset:8448
  ds_read_b64_tr_b16 v[100:101], v251 offset:8224
  ds_read_b64_tr_b16 v[102:103], v251 offset:8480
  ds_read_b64_tr_b16 v[104:105], v251 offset:8256
  ds_read_b64_tr_b16 v[106:107], v251 offset:8512
  ds_read_b64_tr_b16 v[108:109], v251 offset:8288
  ds_read_b64_tr_b16 v[110:111], v251 offset:8544
  ds_read_b64_tr_b16 v[112:113], v251 offset:8320
  ds_read_b64_tr_b16 v[114:115], v251 offset:8576
  ds_read_b64_tr_b16 v[116:117], v251 offset:8352
  ds_read_b64_tr_b16 v[118:119], v251 offset:8608
  ds_read_b64_tr_b16 v[120:121], v251 offset:8384
  ds_read_b64_tr_b16 v[122:123], v251 offset:8640
  ds_read_b64_tr_b16 v[124:125], v251 offset:8416
  ds_read_b64_tr_b16 v[126:127], v251 offset:8672
  s_waitcnt lgkmcnt(0)
  s_mov_b32 s23, 0
  s_mov_b32 s21, 8
.g2_kernel_gl31:
  s_and_b32 s30, s21, 3
  s_cbranch_scc1 .g2_kernel_gl31m
  s_call_b64 s[26:27], .g2_kernel_v_may
.g2_kernel_gl31m:
  s_and_b32 s23, s23, 7
  s_lshl_b32 s30, s23, 10
  s_add_u32 s30, s30, 0
  s_add_u32 m0, s30, s22
  s_mul_i32 s30, s23, 49152
  s_add_u32 s30, s30, s20
  s_and_b32 s31, s23, 1
  s_mul_i32 s31, s31, -24576
  s_add_u32 s30, s30, s31
  buffer_load_dwordx4 v250, s[12:15], s30 offen lds
  s_add_u32 s23, s23, 1
  s_sub_u32 s21, s21, 1
  s_sleep 2
  s_waitcnt vmcnt(2)
  s_cmp_lg_u32 s21, 0
  s_cbranch_scc1 .g2_kernel_gl31
  s_add_u32 s20, s20, 2048
  s_waitcnt vmcnt(0)
  ds_read_b64_tr_b16 v[128:129], v251 offset:0
  ds_read_b64_tr_b16 v[130:131], v251 offset:256
  ds_read_b64_tr_b16 v[132:133], v251 offset:32
  ds_read_b64_tr_b16 v[134:135], v251 offset:288
  ds_read_b64_tr_b16 v[136:137], v251 offset:64
  ds_read_b64_tr_b16 v[138:139], v251 offset:320
  ds_read_b64_tr_b16 v[140:141], v251 offset:96
  ds_read_b64_tr_b16 v[142:143], v251 offset:352
  ds_read_b64_tr_b16 v[144:145], v251 offset:128
  ds_read_b64_tr_b16 v[146:147], v251 offset:384
  ds_read_b64_tr_b16 v[148:149], v251 offset:160
  ds_read_b64_tr_b16 v[150:151], v251 offset:416
  ds_read_b64_tr_b16 v[152:153], v251 offset:192
  ds_read_b64_tr_b16 v[154:155], v251 offset:448
  ds_read_b64_tr_b16 v[156:157], v251 offset:224
  ds_read_b64_tr_b16 v[158:159], v251 offset:480
  s_waitcnt lgkmcnt(0)
.g2_kernel_g_e:
  s_cmp_lt_u32 s16, 6
  s_cbranch_scc1 .g2_kernel_v_3
  v_mov_b32 v6, s71
  s_mov_b64 exec, 1
  ds_add_u32 v6, v5 offset:116
  s_mov_b64 exec, -1
  s_branch .g2_kernel_v_3c
.g2_kernel_v_3:
  s_mov_b32 s29, 0
  s_and_b32 s32, s16, 3
  s_lshl_b32 s30, s32, 14
  s_add_u32 s30, s30, 65536
  s_call_b64 s[68:69], .g2_kernel_v_wo
  s_cmp_lg_u32 s16, 4
  s_cbranch_scc1 .g2_kernel_v_3d
  s_mov_b32 s32, 2
  s_mov_b32 s30, 98304
  s_call_b64 s[68:69], .g2_kernel_v_wo
  s_mov_b32 s32, 3
  s_mov_b32 s30, 114688
  s_call_b64 s[68:69], .g2_kernel_v_wo
.g2_kernel_v_3d:
  s_waitcnt vmcnt(0)
  v_mov_b32 v8, 2
  v_mov_b32 v6, s71
  s_mov_b64 exec, 1
  ds_add_u32 v6, v8 offset:52
  s_mov_b64 exec, -1
.g2_kernel_v_3c:
  s_cmp_lg_u32 s39, 0
  s_cbranch_scc1 .g2_kernel_v_3b
  s_call_b64 s[26:27], .g2_kernel_v_do
.g2_kernel_v_3b:
  s_cmp_lg_u32 s16, 4
  s_cbranch_scc1 .g2_kernel_v_4
  v_mov_b32 v6, s71
  s_mov_b32 s38, 0
.g2_kernel_wg32:
  ds_read_b32 v7, v6 offset:8
  s_add_u32 s38, s38, 1
  s_waitcnt lgkmcnt(0)
  v_cmp_gt_u32 vcc, 10, v7
  s_cbranch_vccz .g2_kernel_wg32d
  s_sleep 8
  s_cmp_lt_u32 s38, 524288
  s_cbranch_scc1 .g2_kernel_wg32
.g2_kernel_wg32d:
  s_mov_b32 s29, 1
  s_mov_b32 s32, 0
  s_mov_b32 s30, 139264
  s_call_b64 s[68:69], .g2_kernel_v_wo
  s_add_u32 s31, s31, 81920
  s_sleep 6
  s_waitcnt vmcnt(4)
  buffer_load_dwordx4 v[64:67], v6, s[8:11], s31 offen
  s_add_u32 s31, s31, 16384
  buffer_load_dwordx4 v[68:71], v6, s[8:11], s31 offen
  s_add_u32 s31, s31, 16384
  buffer_load_dwordx4 v[72:75], v6, s[8:11], s31 offen
  s_add_u32 s31, s31, 16384
  buffer_load_dwordx4 v[76:79], v6, s[8:11], s31 offen
  s_add_u32 s31, s31, 81920
  s_sleep 6
  s_waitcnt vmcnt(4)
  buffer_load_dwordx4 v[80:83], v6, s[8:11], s31 offen
  s_add_u32 s31, s31, 16384
  buffer_load_dwordx4 v[84:87], v6, s[8:11], s31 offen
  s_add_u32 s31, s31, 16384
  buffer_load_dwordx4 v[88:91], v6, s[8:11], s31 offen
  s_add_u32 s31, s31, 16384
  buffer_load_dwordx4 v[92:95], v6, s[8:11], s31 offen
  s_add_u32 s31, s31, 81920
  s_sleep 6
  s_waitcnt vmcnt(4)
  buffer_load_dwordx4 v[96:99], v6, s[8:11], s31 offen
  s_add_u32 s31, s31, 16384
  buffer_load_dwordx4 v[100:103], v6, s[8:11], s31 offen
  s_add_u32 s31, s31, 16384
  buffer_load_dwordx4 v[104:107], v6, s[8:11], s31 offen
  s_add_u32 s31, s31, 16384
  buffer_load_dwordx4 v[108:111], v6, s[8:11], s31 offen
  s_add_u32 s31, s31, 81920
  s_sleep 6
  s_waitcnt vmcnt(4)
  buffer_load_dwordx4 v[112:115], v6, s[8:11], s31 offen
  s_add_u32 s31, s31, 16384
  buffer_load_dwordx4 v[116:119], v6, s[8:11], s31 offen
  s_add_u32 s31, s31, 16384
  buffer_load_dwordx4 v[120:123], v6, s[8:11], s31 offen
  s_add_u32 s31, s31, 16384
  buffer_load_dwordx4 v[124:127], v6, s[8:11], s31 offen
  s_add_u32 s31, s31, 81920
  s_sleep 6
  s_waitcnt vmcnt(4)
  buffer_load_dwordx4 v[128:131], v6, s[8:11], s31 offen
  s_add_u32 s31, s31, 16384
  buffer_load_dwordx4 v[132:135], v6, s[8:11], s31 offen
  s_add_u32 s31, s31, 16384
  buffer_load_dwordx4 v[136:139], v6, s[8:11], s31 offen
  s_add_u32 s31, s31, 16384
  buffer_load_dwordx4 v[140:143], v6, s[8:11], s31 offen
  s_add_u32 s31, s31, 81920
  s_sleep 6
  s_waitcnt vmcnt(4)
  buffer_load_dwordx4 v[144:147], v6, s[8:11], s31 offen
  s_add_u32 s31, s31, 16384
  buffer_load_dwordx4 v[148:151], v6, s[8:11], s31 offen
  s_add_u32 s31, s31, 16384
  buffer_load_dwordx4 v[152:155], v6, s[8:11], s31 offen
  s_add_u32 s31, s31, 16384
  buffer_load_dwordx4 v[156:159], v6, s[8:11], s31 offen
  s_add_u32 s31, s31, 81920
  s_sleep 6
  s_waitcnt vmcnt(4)
  buffer_load_dwordx4 v[160:163], v6, s[8:11], s31 offen
  s_add_u32 s31, s31, 16384
  buffer_load_dwordx4 v[164:167], v6, s[8:11], s31 offen
  s_add_u32 s31, s31, 16384
  buffer_load_dwordx4 v[168:171], v6, s[8:11], s31 offen
  s_add_u32 s31, s31, 16384
  buffer_load_dwordx4 v[172:175], v6, s[8:11], s31 offen
  s_add_u32 s31, s31, 81920
  s_sleep 6
  s_waitcnt vmcnt(4)
  buffer_load_dwordx4 v[176:179], v6, s[8:11], s31 offen
  s_add_u32 s31, s31, 16384
  buffer_load_dwordx4 v[180:183], v6, s[8:11], s31 offen
  s_add_u32 s31, s31, 16384
  buffer_load_dwordx4 v[184:187], v6, s[8:11], s31 offen
  s_add_u32 s31, s31, 16384
  buffer_load_dwordx4 v[188:191], v6, s[8:11], s31 offen
  s_add_u32 s31, s31, 81920
  s_sleep 6
  s_waitcnt vmcnt(4)
  buffer_load_dwordx4 v[192:195], v6, s[8:11], s31 offen
  s_add_u32 s31, s31, 16384
  buffer_load_dwordx4 v[196:199], v6, s[8:11], s31 offen
  s_add_u32 s31, s31, 16384
  buffer_load_dwordx4 v[200:203], v6, s[8:11], s31 offen
  s_add_u32 s31, s31, 16384
  buffer_load_dwordx4 v[204:207], v6, s[8:11], s31 offen
  s_add_u32 s31, s31, 81920
  s_sleep 6
  s_waitcnt vmcnt(4)
  buffer_load_dwordx4 v[208:211], v6, s[8:11], s31 offen
  s_add_u32 s31, s31, 16384
  buffer_load_dwordx4 v[212:215], v6, s[8:11], s31 offen
  s_add_u32 s31, s31, 16384
  buffer_load_dwordx4 v[216:219], v6, s[8:11], s31 offen
  s_add_u32 s31, s31, 16384
  buffer_load_dwordx4 v[220:223], v6, s[8:11], s31 offen
  s_add_u32 s31, s31, 81920
  s_sleep 6
  s_waitcnt vmcnt(4)
  buffer_load_dwordx4 v[224:227], v6, s[8:11], s31 offen
  s_add_u32 s31, s31, 16384
  buffer_load_dwordx4 v[228:231], v6, s[8:11], s31 offen
  s_add_u32 s31, s31, 16384
  buffer_load_dwordx4 v[232:235], v6, s[8:11], s31 offen
  s_add_u32 s31, s31, 16384
  buffer_load_dwordx4 v[236:239], v6, s[8:11], s31 offen
  s_add_u32 s31, s31, 81920
  s_sleep 6
  s_waitcnt vmcnt(4)
  buffer_load_dwordx4 v[240:243], v6, s[8:11], s31 offen
  s_add_u32 s31, s31, 16384
  buffer_load_dwordx4 v[244:247], v6, s[8:11], s31 offen
  s_add_u32 s31, s31, 16384
  buffer_load_dwordx4 v[248:251], v6, s[8:11], s31 offen
  s_add_u32 s31, s31, 16384
  buffer_load_dwordx4 v[252:255], v6, s[8:11], s31 offen
  s_cmp_eq_u32 s62, 0
  s_cbranch_scc1 .g2_kernel_v_4
  v_mov_b32 v8, s71
  s_mov_b32 s38, 0
.g2_kernel_wg33:
  ds_read_b32 v9, v8 offset:116
  s_add_u32 s38, s38, 1
  s_waitcnt lgkmcnt(0)
  v_cmp_gt_u32 vcc, 2, v9
  s_cbranch_vccz .g2_kernel_wg33d
  s_sleep 4
  s_cmp_lt_u32 s38, 524288
  s_cbranch_scc1 .g2_kernel_wg33
.g2_kernel_wg33d:
  s_waitcnt vmcnt(0)
  s_call_b64 s[68:69], .g2_kernel_v_w23
.g2_kernel_v_4:
  s_cmp_lg_u32 s16, 5
  s_cbranch_scc1 .g2_kernel_v_5
  s_sleep 48
  s_and_b32 s31, s19, 0xffffe000
  s_add_u32 s31, s31, 0
  v_and_b32 v6, 15, v2
  v_lshlrev_b32 v6, 9, v6
  v_lshrrev_b32 v7, 4, v2
  v_lshl_add_u32 v6, v7, 7, v6
  v_lshlrev_b32 v7, 2, v2
  v_add_u32 v7, 157696, v7
  s_mov_b32 m0, 157696
  s_mov_b32 s38, 0
.g2_kernel_pa34:
  buffer_load_dword v6, s[4:7], s31 offen sc1 lds
  s_add_u32 s38, s38, 1
  s_waitcnt vmcnt(0)
  ds_read_b32 v8, v7
  s_waitcnt lgkmcnt(0)
  v_cmp_ge_u32 vcc, s62, v8
  s_cbranch_vccz .g2_kernel_pa34d
  s_mov_b64 exec, vcc
  s_sleep 32
  s_cmp_lt_u32 s38, 131072
  s_cbranch_scc1 .g2_kernel_pa34
.g2_kernel_pa34d:
  s_mov_b64 exec, -1
  v_lshlrev_b32 v6, 7, v2
  s_lshl_b32 s30, s17, 2
  s_and_b32 s31, s18, 3
  s_add_u32 s30, s30, s31
  s_lshl_b32 s30, s30, 16
  s_add_u32 s30, s30, s63
  s_add_u32 s30, s30, 0x800000
  s_sleep 8
  buffer_load_dword v1, v6, s[4:7], s30 offen
  s_add_u32 s30, s30, 8192
  s_sleep 8
  buffer_load_dword v1, v6, s[4:7], s30 offen
  s_add_u32 s30, s30, 8192
  s_sleep 8
  buffer_load_dword v1, v6, s[4:7], s30 offen
  s_add_u32 s30, s30, 8192
  s_sleep 8
  buffer_load_dword v1, v6, s[4:7], s30 offen
  s_add_u32 s30, s30, 8192
  s_lshl_b32 s28, s2, 10
  s_and_b32 s28, s28, 0xe000
  v_lshlrev_b32 v7, 7, v2
  buffer_load_dword v1, v7, s[64:67], s28 offen
.g2_kernel_v_5:
  s_mov_b32 s29, 1
  s_call_b64 s[68:69], .g2_kernel_v_cmb
  s_cmp_lg_u32 s16, 7
  s_cbranch_scc1 .g2_kernel_v_7
  s_and_b32 s33, s16, 3
  s_lshl_b32 s33, s33, 7
  s_lshl_b32 s28, s29, 2
  s_add_u32 s33, s33, s28
  s_add_u32 s31, s19, s33
  v_mov_b32 v6, s70
  s_mov_b64 exec, 1
  buffer_store_dword v6, v4, s[4:7], s31 offen offset:0 sc1
  s_mov_b64 exec, -1
.g2_kernel_v_7:
  s_cmp_lg_u32 s16, 4
  s_cbranch_scc1 .g2_kernel_v_8
  s_waitcnt vmcnt(2)
  v_mov_b32 v6, s71
  s_mov_b32 s38, 0
.g2_kernel_wg35:
  ds_read_b32 v7, v6 offset:76
  s_add_u32 s38, s38, 1
  s_waitcnt lgkmcnt(0)
  v_cmp_gt_u32 vcc, 1, v7
  s_cbranch_vccz .g2_kernel_wg35d
  s_sleep 1
  s_cmp_lt_u32 s38, 524288
  s_cbranch_scc1 .g2_kernel_wg35
.g2_kernel_wg35d:
  v_mov_b32 v6, s71
  s_mov_b32 s38, 0
.g2_kernel_wg36:
  ds_read_b32 v7, v6 offset:72
  s_add_u32 s38, s38, 1
  s_waitcnt lgkmcnt(0)
  v_cmp_gt_u32 vcc, 1, v7
  s_cbranch_vccz .g2_kernel_wg36d
  s_sleep 1
  s_cmp_lt_u32 s38, 524288
  s_cbranch_scc1 .g2_kernel_wg36
.g2_kernel_wg36d:
  v_mov_b32 v6, s71
  s_mov_b32 s38, 0
.g2_kernel_wg37:
  ds_read_b32 v7, v6 offset:68
  s_add_u32 s38, s38, 1
  s_waitcnt lgkmcnt(0)
  v_cmp_gt_u32 vcc, 1, v7
  s_cbranch_vccz .g2_kernel_wg37d
  s_sleep 1
  s_cmp_lt_u32 s38, 524288
  s_cbranch_scc1 .g2_kernel_wg37
.g2_kernel_wg37d:
  ds_write_b128 v3, v[64:67] offset:16384
  ds_write_b128 v3, v[68:71] offset:17408
  ds_write_b128 v3, v[72:75] offset:18432
  ds_write_b128 v3, v[76:79] offset:19456
  ds_write_b128 v3, v[80:83] offset:20480
  ds_write_b128 v3, v[84:87] offset:21504
  ds_write_b128 v3, v[88:91] offset:22528
  ds_write_b128 v3, v[92:95] offset:23552
  ds_write_b128 v3, v[96:99] offset:24576
  ds_write_b128 v3, v[100:103] offset:25600
  ds_write_b128 v3, v[104:107] offset:26624
  ds_write_b128 v3, v[108:111] offset:27648
  ds_write_b128 v3, v[112:115] offset:28672
  ds_write_b128 v3, v[116:119] offset:29696
  ds_write_b128 v3, v[120:123] offset:30720
  ds_write_b128 v3, v[124:127] offset:31744
  s_cmp_lg_u32 s62, 0
  s_cbranch_scc1 .g2_kernel_v_9
  s_call_b64 s[68:69], .g2_kernel_v_w23
.g2_kernel_v_9:
  v_mov_b32 v8, 4
  ds_write_b32 v6, v8 offset:12
.g2_kernel_v_8:
  s_cmp_eq_u32 s16, 5
  s_cbranch_scc1 .g2_kernel_c1
  s_cmp_lg_u32 s16, 4
  s_cbranch_scc1 .g2_kernel_c2
  s_cmp_lg_u32 s62, 0
  s_cbranch_scc1 .g2_kernel_fin1
  s_setprio 3
  s_mov_b32 s12, s42
  s_mov_b32 s13, s43
  s_mov_b32 s14, 0x600000
  s_mov_b32 s15, 0x00020000
  v_lshrrev_b32 v28, 3, v2
  v_and_b32 v29, 7, v2
  v_bfe_u32 v30, v2, 4, 1
  v_lshlrev_b32 v30, 1, v30
  v_xor_b32 v31, v29, v30
  v_lshlrev_b32 v31, 4, v31
  v_mul_u32_u24 v28, 6144, v28
  v_add_u32 v28, v28, v31
  v_xor_b32 v29, 64, v28
  v_lshlrev_b32 v9, 2, v2
  v_and_b32 v9, 12, v9
  v_add_u32 v9, 156416, v9
  v_add_u32 v48, 0, v28
  v_add_u32 v49, 48128, v29
  v_add_u32 v50, 96256, v28
  v_add_u32 v51, 144384, v29
  v_add_u32 v52, 2048, v28
  v_add_u32 v53, 50176, v29
  v_add_u32 v54, 98304, v28
  v_add_u32 v55, 146432, v29
  v_add_u32 v56, 4096, v29
  v_add_u32 v57, 52224, v28
  v_add_u32 v58, 100352, v29
  v_add_u32 v59, 148480, v28
  v_and_b32 v11, 15, v2
  v_xor_b32 v11, s18, v11
  v_and_b32 v12, 48, v2
  v_add_u32 v11, v11, v12
  v_lshlrev_b32 v11, 2, v11
  v_add_u32 v11, 158208, v11
  s_lshl_b32 s39, s18, 7
  s_lshl_b32 s32, s17, 18
  s_add_u32 s32, s32, 0xc00000
  s_mov_b32 s30, 0
  s_mov_b32 s29, 0
  s_mov_b32 s37, 0
  v_mov_b32 v6, s71
  s_mov_b32 s38, 0
.g2_kernel_wg38:
  ds_read_b32 v7, v6 offset:16
  s_add_u32 s38, s38, 1
  s_waitcnt lgkmcnt(0)
  v_cmp_gt_u32 vcc, 4, v7
  s_cbranch_vccz .g2_kernel_wg38d
  s_sleep 2
  s_cmp_lt_u32 s38, 524288
  s_cbranch_scc1 .g2_kernel_wg38
.g2_kernel_wg38d:
  s_xor_b32 s36, s18, 0
  s_mul_i32 s36, s36, 393216
  s_add_u32 s36, s36, s39
  s_add_u32 m0, s30, 65536
  s_waitcnt vmcnt(63)
  buffer_load_dwordx4 v48, s[12:15], s36 offen offset:0 lds
  buffer_load_dwordx4 v49, s[12:15], s36 offen offset:1024 lds
  buffer_load_dwordx4 v50, s[12:15], s36 offen offset:2048 lds
  buffer_load_dwordx4 v51, s[12:15], s36 offen offset:3072 lds
  s_add_u32 m0, s30, 69632
  s_waitcnt vmcnt(63)
  buffer_load_dwordx4 v52, s[12:15], s36 offen offset:0 lds
  buffer_load_dwordx4 v53, s[12:15], s36 offen offset:1024 lds
  buffer_load_dwordx4 v54, s[12:15], s36 offen offset:2048 lds
  buffer_load_dwordx4 v55, s[12:15], s36 offen offset:3072 lds
  s_add_u32 m0, s30, 73728
  s_waitcnt vmcnt(63)
  buffer_load_dwordx4 v56, s[12:15], s36 offen offset:0 lds
  buffer_load_dwordx4 v57, s[12:15], s36 offen offset:1024 lds
  buffer_load_dwordx4 v58, s[12:15], s36 offen offset:2048 lds
  buffer_load_dwordx4 v59, s[12:15], s36 offen offset:3072 lds
  s_add_u32 s30, s30, 12288
  s_cmp_eq_u32 s30, 86016
  s_cselect_b32 s30, 0, s30
  s_xor_b32 s36, s18, 0
  s_mul_i32 s36, s36, 393216
  s_add_u32 s36, s36, s39
  s_add_u32 s36, s36, 196608
  s_add_u32 m0, s30, 65536
  s_waitcnt vmcnt(63)
  buffer_load_dwordx4 v48, s[12:15], s36 offen offset:0 lds
  buffer_load_dwordx4 v49, s[12:15], s36 offen offset:1024 lds
  buffer_load_dwordx4 v50, s[12:15], s36 offen offset:2048 lds
  buffer_load_dwordx4 v51, s[12:15], s36 offen offset:3072 lds
  s_add_u32 m0, s30, 69632
  s_waitcnt vmcnt(63)
  buffer_load_dwordx4 v52, s[12:15], s36 offen offset:0 lds
  buffer_load_dwordx4 v53, s[12:15], s36 offen offset:1024 lds
  buffer_load_dwordx4 v54, s[12:15], s36 offen offset:2048 lds
  buffer_load_dwordx4 v55, s[12:15], s36 offen offset:3072 lds
  s_add_u32 m0, s30, 73728
  s_waitcnt vmcnt(63)
  buffer_load_dwordx4 v56, s[12:15], s36 offen offset:0 lds
  buffer_load_dwordx4 v57, s[12:15], s36 offen offset:1024 lds
  buffer_load_dwordx4 v58, s[12:15], s36 offen offset:2048 lds
  buffer_load_dwordx4 v59, s[12:15], s36 offen offset:3072 lds
  s_add_u32 s30, s30, 12288
  s_cmp_eq_u32 s30, 86016
  s_cselect_b32 s30, 0, s30
  s_mov_b32 m0, 156160
  s_mov_b32 s35, .g2_kernel_tab-.g2_kernel_pc+136
  s_mov_b64 exec, 1
  buffer_load_dword off, s[64:67], s35 lds
  s_mov_b64 exec, -1
  s_xor_b32 s36, s18, 1
  s_mul_i32 s36, s36, 393216
  s_add_u32 s36, s36, s39
  s_add_u32 m0, s30, 65536
  s_waitcnt vmcnt(63)
  buffer_load_dwordx4 v48, s[12:15], s36 offen offset:0 lds
  buffer_load_dwordx4 v49, s[12:15], s36 offen offset:1024 lds
  buffer_load_dwordx4 v50, s[12:15], s36 offen offset:2048 lds
  buffer_load_dwordx4 v51, s[12:15], s36 offen offset:3072 lds
  s_add_u32 m0, s30, 69632
  s_waitcnt vmcnt(63)
  buffer_load_dwordx4 v52, s[12:15], s36 offen offset:0 lds
  buffer_load_dwordx4 v53, s[12:15], s36 offen offset:1024 lds
  buffer_load_dwordx4 v54, s[12:15], s36 offen offset:2048 lds
  buffer_load_dwordx4 v55, s[12:15], s36 offen offset:3072 lds
  s_add_u32 m0, s30, 73728
  s_waitcnt vmcnt(63)
  buffer_load_dwordx4 v56, s[12:15], s36 offen offset:0 lds
  buffer_load_dwordx4 v57, s[12:15], s36 offen offset:1024 lds
  buffer_load_dwordx4 v58, s[12:15], s36 offen offset:2048 lds
  buffer_load_dwordx4 v59, s[12:15], s36 offen offset:3072 lds
  s_add_u32 s30, s30, 12288
  s_cmp_eq_u32 s30, 86016
  s_cselect_b32 s30, 0, s30
  s_xor_b32 s36, s18, 1
  s_mul_i32 s36, s36, 393216
  s_add_u32 s36, s36, s39
  s_add_u32 s36, s36, 196608
  s_add_u32 m0, s30, 65536
  s_waitcnt vmcnt(63)
  buffer_load_dwordx4 v48, s[12:15], s36 offen offset:0 lds
  buffer_load_dwordx4 v49, s[12:15], s36 offen offset:1024 lds
  buffer_load_dwordx4 v50, s[12:15], s36 offen offset:2048 lds
  buffer_load_dwordx4 v51, s[12:15], s36 offen offset:3072 lds
  s_add_u32 m0, s30, 69632
  s_waitcnt vmcnt(63)
  buffer_load_dwordx4 v52, s[12:15], s36 offen offset:0 lds
  buffer_load_dwordx4 v53, s[12:15], s36 offen offset:1024 lds
  buffer_load_dwordx4 v54, s[12:15], s36 offen offset:2048 lds
  buffer_load_dwordx4 v55, s[12:15], s36 offen offset:3072 lds
  s_add_u32 m0, s30, 73728
  s_waitcnt vmcnt(63)
  buffer_load_dwordx4 v56, s[12:15], s36 offen offset:0 lds
  buffer_load_dwordx4 v57, s[12:15], s36 offen offset:1024 lds
  buffer_load_dwordx4 v58, s[12:15], s36 offen offset:2048 lds
  buffer_load_dwordx4 v59, s[12:15], s36 offen offset:3072 lds
  s_add_u32 s30, s30, 12288
  s_cmp_eq_u32 s30, 86016
  s_cselect_b32 s30, 0, s30
  s_xor_b32 s36, s18, 2
  s_mul_i32 s36, s36, 393216
  s_add_u32 s36, s36, s39
  s_add_u32 m0, s30, 65536
  s_waitcnt vmcnt(63)
  buffer_load_dwordx4 v48, s[12:15], s36 offen offset:0 lds
  buffer_load_dwordx4 v49, s[12:15], s36 offen offset:1024 lds
  buffer_load_dwordx4 v50, s[12:15], s36 offen offset:2048 lds
  buffer_load_dwordx4 v51, s[12:15], s36 offen offset:3072 lds
  s_add_u32 m0, s30, 69632
  s_waitcnt vmcnt(63)
  buffer_load_dwordx4 v52, s[12:15], s36 offen offset:0 lds
  buffer_load_dwordx4 v53, s[12:15], s36 offen offset:1024 lds
  buffer_load_dwordx4 v54, s[12:15], s36 offen offset:2048 lds
  buffer_load_dwordx4 v55, s[12:15], s36 offen offset:3072 lds
  s_add_u32 m0, s30, 73728
  s_waitcnt vmcnt(63)
  buffer_load_dwordx4 v56, s[12:15], s36 offen offset:0 lds
  buffer_load_dwordx4 v57, s[12:15], s36 offen offset:1024 lds
  buffer_load_dwordx4 v58, s[12:15], s36 offen offset:2048 lds
  buffer_load_dwordx4 v59, s[12:15], s36 offen offset:3072 lds
  s_add_u32 s30, s30, 12288
  s_cmp_eq_u32 s30, 86016
  s_cselect_b32 s30, 0, s30
  v_mov_b32 v6, s71
  s_mov_b32 s38, 0
.g2_kernel_wg39:
  ds_read_b32 v7, v6 offset:20
  s_add_u32 s38, s38, 1
  s_waitcnt lgkmcnt(0)
  v_cmp_gt_u32 vcc, 4, v7
  s_cbranch_vccz .g2_kernel_wg39d
  s_sleep 1
  s_cmp_lt_u32 s38, 524288
  s_cbranch_scc1 .g2_kernel_wg39
.g2_kernel_wg39d:
  s_mov_b32 s62, 1
  s_mov_b32 s63, 0x1800000
  s_mov_b32 s70, 2
  s_mov_b32 s71, 155776
  s_xor_b32 s36, s18, 2
  s_mul_i32 s36, s36, 393216
  s_add_u32 s36, s36, s39
  s_add_u32 s36, s36, 196608
  s_add_u32 m0, s30, 65536
  s_waitcnt vmcnt(63)
  buffer_load_dwordx4 v48, s[12:15], s36 offen offset:0 lds
  buffer_load_dwordx4 v49, s[12:15], s36 offen offset:1024 lds
  buffer_load_dwordx4 v50, s[12:15], s36 offen offset:2048 lds
  buffer_load_dwordx4 v51, s[12:15], s36 offen offset:3072 lds
  s_add_u32 m0, s30, 69632
  s_waitcnt vmcnt(63)
  buffer_load_dwordx4 v52, s[12:15], s36 offen offset:0 lds
  buffer_load_dwordx4 v53, s[12:15], s36 offen offset:1024 lds
  buffer_load_dwordx4 v54, s[12:15], s36 offen offset:2048 lds
  buffer_load_dwordx4 v55, s[12:15], s36 offen offset:3072 lds
  s_add_u32 m0, s30, 73728
  s_waitcnt vmcnt(63)
  buffer_load_dwordx4 v56, s[12:15], s36 offen offset:0 lds
  buffer_load_dwordx4 v57, s[12:15], s36 offen offset:1024 lds
  buffer_load_dwordx4 v58, s[12:15], s36 offen offset:2048 lds
  buffer_load_dwordx4 v59, s[12:15], s36 offen offset:3072 lds
  s_add_u32 s30, s30, 12288
  s_cmp_eq_u32 s30, 86016
  s_cselect_b32 s30, 0, s30
  s_xor_b32 s36, s18, 3
  s_mul_i32 s36, s36, 393216
  s_add_u32 s36, s36, s39
  s_add_u32 m0, s30, 65536
  s_waitcnt vmcnt(63)
  buffer_load_dwordx4 v48, s[12:15], s36 offen offset:0 lds
  buffer_load_dwordx4 v49, s[12:15], s36 offen offset:1024 lds
  buffer_load_dwordx4 v50, s[12:15], s36 offen offset:2048 lds
  buffer_load_dwordx4 v51, s[12:15], s36 offen offset:3072 lds
  s_add_u32 m0, s30, 69632
  s_waitcnt vmcnt(63)
  buffer_load_dwordx4 v52, s[12:15], s36 offen offset:0 lds
  buffer_load_dwordx4 v53, s[12:15], s36 offen offset:1024 lds
  buffer_load_dwordx4 v54, s[12:15], s36 offen offset:2048 lds
  buffer_load_dwordx4 v55, s[12:15], s36 offen offset:3072 lds
  s_add_u32 m0, s30, 73728
  s_waitcnt vmcnt(63)
  buffer_load_dwordx4 v56, s[12:15], s36 offen offset:0 lds
  buffer_load_dwordx4 v57, s[12:15], s36 offen offset:1024 lds
  buffer_load_dwordx4 v58, s[12:15], s36 offen offset:2048 lds
  buffer_load_dwordx4 v59, s[12:15], s36 offen offset:3072 lds
  s_add_u32 s30, s30, 12288
  s_cmp_eq_u32 s30, 86016
  s_cselect_b32 s30, 0, s30
  s_mov_b32 s28, 1
  s_mov_b32 s29, 16384
  s_bitcmp1_b32 s37, s28
  s_cbranch_scc0 .g2_kernel_p2_x0w
.g2_kernel_p2_x0b:
  s_xor_b32 s33, s28, s18
  s_lshl_b32 s33, s33, 14
  s_add_u32 s33, s33, s32
  s_add_u32 m0, s29, 0
  s_waitcnt vmcnt(63)
  buffer_load_dwordx4 v3, s[4:7], s33 offen offset:0 lds
  buffer_load_dwordx4 v3, s[4:7], s33 offen offset:1024 lds
  buffer_load_dwordx4 v3, s[4:7], s33 offen offset:2048 lds
  buffer_load_dwordx4 v3, s[4:7], s33 offen offset:3072 lds
  s_add_u32 m0, s29, 4096
  s_waitcnt vmcnt(63)
  s_add_u32 s33, s33, 4096
  buffer_load_dwordx4 v3, s[4:7], s33 offen offset:0 lds
  buffer_load_dwordx4 v3, s[4:7], s33 offen offset:1024 lds
  buffer_load_dwordx4 v3, s[4:7], s33 offen offset:2048 lds
  buffer_load_dwordx4 v3, s[4:7], s33 offen offset:3072 lds
  s_add_u32 m0, s29, 8192
  s_waitcnt vmcnt(63)
  s_add_u32 s33, s33, 4096
  buffer_load_dwordx4 v3, s[4:7], s33 offen offset:0 lds
  buffer_load_dwordx4 v3, s[4:7], s33 offen offset:1024 lds
  buffer_load_dwordx4 v3, s[4:7], s33 offen offset:2048 lds
  buffer_load_dwordx4 v3, s[4:7], s33 offen offset:3072 lds
  s_add_u32 m0, s29, 12288
  s_waitcnt vmcnt(63)
  s_add_u32 s33, s33, 4096
  buffer_load_dwordx4 v3, s[4:7], s33 offen offset:0 lds
  buffer_load_dwordx4 v3, s[4:7], s33 offen offset:1024 lds
  buffer_load_dwordx4 v3, s[4:7], s33 offen offset:2048 lds
  buffer_load_dwordx4 v3, s[4:7], s33 offen offset:3072 lds
  s_mov_b32 m0, 156160
  s_mov_b32 s35, .g2_kernel_tab-.g2_kernel_pc+144
  s_mov_b64 exec, 1
  buffer_load_dword off, s[64:67], s35 lds
  s_mov_b64 exec, -1
  s_mov_b32 s28, 2
  s_mov_b32 s29, 32768
  s_bitcmp1_b32 s37, s28
  s_cbranch_scc0 .g2_kernel_p2_x1w
.g2_kernel_p2_x1b:
  s_xor_b32 s33, s28, s18
  s_lshl_b32 s33, s33, 14
  s_add_u32 s33, s33, s32
  s_add_u32 m0, s29, 0
  s_waitcnt vmcnt(63)
  buffer_load_dwordx4 v3, s[4:7], s33 offen offset:0 lds
  buffer_load_dwordx4 v3, s[4:7], s33 offen offset:1024 lds
  buffer_load_dwordx4 v3, s[4:7], s33 offen offset:2048 lds
  buffer_load_dwordx4 v3, s[4:7], s33 offen offset:3072 lds
  s_add_u32 m0, s29, 4096
  s_waitcnt vmcnt(63)
  s_add_u32 s33, s33, 4096
  buffer_load_dwordx4 v3, s[4:7], s33 offen offset:0 lds
  buffer_load_dwordx4 v3, s[4:7], s33 offen offset:1024 lds
  buffer_load_dwordx4 v3, s[4:7], s33 offen offset:2048 lds
  buffer_load_dwordx4 v3, s[4:7], s33 offen offset:3072 lds
  s_add_u32 m0, s29, 8192
  s_waitcnt vmcnt(63)
  s_add_u32 s33, s33, 4096
  buffer_load_dwordx4 v3, s[4:7], s33 offen offset:0 lds
  buffer_load_dwordx4 v3, s[4:7], s33 offen offset:1024 lds
  buffer_load_dwordx4 v3, s[4:7], s33 offen offset:2048 lds
  buffer_load_dwordx4 v3, s[4:7], s33 offen offset:3072 lds
  s_add_u32 m0, s29, 12288
  s_waitcnt vmcnt(63)
  s_add_u32 s33, s33, 4096
  buffer_load_dwordx4 v3, s[4:7], s33 offen offset:0 lds
  buffer_load_dwordx4 v3, s[4:7], s33 offen offset:1024 lds
  buffer_load_dwordx4 v3, s[4:7], s33 offen offset:2048 lds
  buffer_load_dwordx4 v3, s[4:7], s33 offen offset:3072 lds
  s_mov_b32 m0, 156160
  s_mov_b32 s35, .g2_kernel_tab-.g2_kernel_pc+152
  s_mov_b64 exec, 1
  buffer_load_dword off, s[64:67], s35 lds
  s_mov_b64 exec, -1
  s_mov_b32 s28, 3
  s_mov_b32 s29, 49152
  s_bitcmp1_b32 s37, s28
  s_cbranch_scc0 .g2_kernel_p2_x2w
.g2_kernel_p2_x2b:
  s_xor_b32 s33, s28, s18
  s_lshl_b32 s33, s33, 14
  s_add_u32 s33, s33, s32
  s_add_u32 m0, s29, 0
  s_waitcnt vmcnt(63)
  buffer_load_dwordx4 v3, s[4:7], s33 offen offset:0 lds
  buffer_load_dwordx4 v3, s[4:7], s33 offen offset:1024 lds
  buffer_load_dwordx4 v3, s[4:7], s33 offen offset:2048 lds
  buffer_load_dwordx4 v3, s[4:7], s33 offen offset:3072 lds
  s_add_u32 m0, s29, 4096
  s_waitcnt vmcnt(63)
  s_add_u32 s33, s33, 4096
  buffer_load_dwordx4 v3, s[4:7], s33 offen offset:0 lds
  buffer_load_dwordx4 v3, s[4:7], s33 offen offset:1024 lds
  buffer_load_dwordx4 v3, s[4:7], s33 offen offset:2048 lds
  buffer_load_dwordx4 v3, s[4:7], s33 offen offset:3072 lds
  s_add_u32 m0, s29, 8192
  s_waitcnt vmcnt(63)
  s_add_u32 s33, s33, 4096
  buffer_load_dwordx4 v3, s[4:7], s33 offen offset:0 lds
  buffer_load_dwordx4 v3, s[4:7], s33 offen offset:1024 lds
  buffer_load_dwordx4 v3, s[4:7], s33 offen offset:2048 lds
  buffer_load_dwordx4 v3, s[4:7], s33 offen offset:3072 lds
  s_add_u32 m0, s29, 12288
  s_waitcnt vmcnt(63)
  s_add_u32 s33, s33, 4096
  buffer_load_dwordx4 v3, s[4:7], s33 offen offset:0 lds
  buffer_load_dwordx4 v3, s[4:7], s33 offen offset:1024 lds
  buffer_load_dwordx4 v3, s[4:7], s33 offen offset:2048 lds
  buffer_load_dwordx4 v3, s[4:7], s33 offen offset:3072 lds
  s_mov_b32 m0, 156160
  s_mov_b32 s35, .g2_kernel_tab-.g2_kernel_pc+156
  s_mov_b64 exec, 1
  buffer_load_dword off, s[64:67], s35 lds
  s_mov_b64 exec, -1
  s_xor_b32 s36, s18, 3
  s_mul_i32 s36, s36, 393216
  s_add_u32 s36, s36, s39
  s_add_u32 s36, s36, 196608
  ds_read_b32 v10, v9
  s_mov_b32 s34, 33
  s_mov_b32 s35, .g2_kernel_tab-.g2_kernel_pc+160
  s_branch .g2_kernel_p2_o
  .p2align 6
.g2_kernel_p2_l:
  s_waitcnt lgkmcnt(0)
  v_cmp_gt_i32 vcc, s34, v10
  s_cbranch_vccnz .g2_kernel_p2_aw
.g2_kernel_p2_ai:
  s_add_u32 s29, s29, 16384
  s_and_b32 s29, s29, 0xffff
  s_bitcmp1_b32 s37, s28
  s_cbranch_scc0 .g2_kernel_p2_x3w
.g2_kernel_p2_x3b:
  s_xor_b32 s33, s28, s18
  s_lshl_b32 s33, s33, 14
  s_add_u32 s33, s33, s32
  s_add_u32 m0, s29, 0
  s_waitcnt vmcnt(63)
  buffer_load_dwordx4 v3, s[4:7], s33 offen offset:0 lds
  buffer_load_dwordx4 v3, s[4:7], s33 offen offset:1024 lds
  buffer_load_dwordx4 v3, s[4:7], s33 offen offset:2048 lds
  buffer_load_dwordx4 v3, s[4:7], s33 offen offset:3072 lds
  s_add_u32 m0, s29, 4096
  s_waitcnt vmcnt(63)
  s_add_u32 s33, s33, 4096
  buffer_load_dwordx4 v3, s[4:7], s33 offen offset:0 lds
  buffer_load_dwordx4 v3, s[4:7], s33 offen offset:1024 lds
  buffer_load_dwordx4 v3, s[4:7], s33 offen offset:2048 lds
  buffer_load_dwordx4 v3, s[4:7], s33 offen offset:3072 lds
  s_add_u32 m0, s29, 8192
  s_waitcnt vmcnt(63)
  s_add_u32 s33, s33, 4096
  buffer_load_dwordx4 v3, s[4:7], s33 offen offset:0 lds
  buffer_load_dwordx4 v3, s[4:7], s33 offen offset:1024 lds
  buffer_load_dwordx4 v3, s[4:7], s33 offen offset:2048 lds
  buffer_load_dwordx4 v3, s[4:7], s33 offen offset:3072 lds
  s_add_u32 m0, s29, 12288
  s_waitcnt vmcnt(63)
  s_add_u32 s33, s33, 4096
  buffer_load_dwordx4 v3, s[4:7], s33 offen offset:0 lds
  buffer_load_dwordx4 v3, s[4:7], s33 offen offset:1024 lds
  buffer_load_dwordx4 v3, s[4:7], s33 offen offset:2048 lds
  buffer_load_dwordx4 v3, s[4:7], s33 offen offset:3072 lds
  s_add_u32 m0, s30, 65536
  s_waitcnt vmcnt(63)
  buffer_load_dwordx4 v48, s[12:15], s36 offen offset:0 lds
  buffer_load_dwordx4 v49, s[12:15], s36 offen offset:1024 lds
  buffer_load_dwordx4 v50, s[12:15], s36 offen offset:2048 lds
  buffer_load_dwordx4 v51, s[12:15], s36 offen offset:3072 lds
  s_add_u32 m0, s30, 69632
  s_waitcnt vmcnt(63)
  buffer_load_dwordx4 v52, s[12:15], s36 offen offset:0 lds
  buffer_load_dwordx4 v53, s[12:15], s36 offen offset:1024 lds
  buffer_load_dwordx4 v54, s[12:15], s36 offen offset:2048 lds
  buffer_load_dwordx4 v55, s[12:15], s36 offen offset:3072 lds
  s_add_u32 m0, s30, 73728
  s_waitcnt vmcnt(63)
  buffer_load_dwordx4 v56, s[12:15], s36 offen offset:0 lds
  buffer_load_dwordx4 v57, s[12:15], s36 offen offset:1024 lds
  buffer_load_dwordx4 v58, s[12:15], s36 offen offset:2048 lds
  buffer_load_dwordx4 v59, s[12:15], s36 offen offset:3072 lds
  s_add_u32 s30, s30, 12288
  s_cmp_eq_u32 s30, 86016
  s_cselect_b32 s30, 0, s30
  ds_read_b32 v10, v9
  s_mov_b32 m0, 156160
  s_add_u32 s34, s34, 1
  s_mov_b64 exec, 1
  buffer_load_dword off, s[64:67], s35 lds
  s_mov_b64 exec, -1
  s_add_u32 s35, s35, 4
  s_add_u32 s36, s36, 196608
.g2_kernel_p2_o:
  s_waitcnt lgkmcnt(0)
  v_cmp_gt_i32 vcc, s34, v10
  s_cbranch_vccnz .g2_kernel_p2_bw
.g2_kernel_p2_bi:
  s_add_u32 m0, s30, 65536
  s_waitcnt vmcnt(63)
  buffer_load_dwordx4 v48, s[12:15], s36 offen offset:0 lds
  buffer_load_dwordx4 v49, s[12:15], s36 offen offset:1024 lds
  buffer_load_dwordx4 v50, s[12:15], s36 offen offset:2048 lds
  buffer_load_dwordx4 v51, s[12:15], s36 offen offset:3072 lds
  s_add_u32 m0, s30, 69632
  s_waitcnt vmcnt(63)
  buffer_load_dwordx4 v52, s[12:15], s36 offen offset:0 lds
  buffer_load_dwordx4 v53, s[12:15], s36 offen offset:1024 lds
  buffer_load_dwordx4 v54, s[12:15], s36 offen offset:2048 lds
  buffer_load_dwordx4 v55, s[12:15], s36 offen offset:3072 lds
  s_add_u32 m0, s30, 73728
  s_waitcnt vmcnt(63)
  buffer_load_dwordx4 v56, s[12:15], s36 offen offset:0 lds
  buffer_load_dwordx4 v57, s[12:15], s36 offen offset:1024 lds
  buffer_load_dwordx4 v58, s[12:15], s36 offen offset:2048 lds
  buffer_load_dwordx4 v59, s[12:15], s36 offen offset:3072 lds
  s_add_u32 s30, s30, 12288
  s_cmp_eq_u32 s30, 86016
  s_cselect_b32 s30, 0, s30
  ds_read_b32 v10, v9
  s_mov_b32 m0, 156160
  s_add_u32 s34, s34, 1
  s_mov_b64 exec, 1
  buffer_load_dword off, s[64:67], s35 lds
  s_mov_b64 exec, -1
  s_add_u32 s35, s35, 4
  s_add_u32 s28, s28, 1
  s_xor_b32 s36, s18, s28
  s_mul_i32 s36, s36, 393216
  s_add_u32 s36, s36, s39
  s_cmp_lt_i32 s34, 58
  s_cbranch_scc1 .g2_kernel_p2_l
  s_branch .g2_kernel_v
.g2_kernel_c1:
  v_mov_b32 v6, s71
  s_mov_b32 s38, 0
.g2_kernel_wg40:
  ds_read_b32 v7, v6 offset:76
  s_add_u32 s38, s38, 1
  s_waitcnt lgkmcnt(0)
  v_cmp_gt_u32 vcc, 1, v7
  s_cbranch_vccz .g2_kernel_wg40d
  s_sleep 1
  s_cmp_lt_u32 s38, 524288
  s_cbranch_scc1 .g2_kernel_wg40
.g2_kernel_wg40d:
  s_sleep 4
  s_and_b32 s31, s19, 0xffffe000
  s_add_u32 s31, s31, 4
  v_and_b32 v6, 15, v2
  v_lshlrev_b32 v6, 9, v6
  v_lshrrev_b32 v7, 4, v2
  v_lshl_add_u32 v6, v7, 7, v6
  v_lshlrev_b32 v7, 2, v2
  v_add_u32 v7, 157952, v7
  s_mov_b32 m0, 157952
  s_mov_b32 s38, 0
  s_bfm_b64 exec, 16, 48
.g2_kernel_pa41:
  buffer_load_dword v6, s[4:7], s31 offen sc1 lds
  s_add_u32 s38, s38, 1
  s_waitcnt vmcnt(0)
  ds_read_b32 v8, v7
  s_waitcnt lgkmcnt(0)
  v_cmp_ge_u32 vcc, s62, v8
  s_cbranch_vccz .g2_kernel_pa41d
  s_mov_b64 exec, vcc
  s_sleep 4
  s_cmp_lt_u32 s38, 131072
  s_cbranch_scc1 .g2_kernel_pa41
.g2_kernel_pa41d:
  s_mov_b64 exec, -1
  s_setprio 2
  s_mov_b32 s39, 0
  s_lshl_b32 s30, s17, 2
  s_lshr_b32 s28, s18, 2
  s_add_u32 s30, s30, s28
  s_lshl_b32 s20, s30, 13
  s_add_u32 s20, s20, s63
  s_add_u32 s20, s20, 0x1000000
  s_add_u32 s24, s20, 4096
  s_lshl_b32 s21, s30, 8
  s_add_u32 s21, s21, s63
  s_add_u32 s21, s21, 0x1080000
  s_lshl_b32 s23, s62, 16
  s_add_u32 s23, s23, 0x3040000
  s_lshl_b32 s22, s30, 7
  s_add_u32 s22, s22, s23
  s_and_b32 s28, s2, 7
  s_lshl_b32 s28, s28, 13
  s_add_u32 s23, s23, s28
  v_mov_b32 v9, 155648
  ds_read_b32 v26, v9 offset:256
  v_and_b32 v24, 31, v2
  v_lshlrev_b32 v25, 3, v2
  v_lshlrev_b32 v27, 13, v2
  v_mov_b32 v28, 0.0009765625
  v_mov_b32 v30, 1e-05
  v_mov_b32 v6, s71
  s_mov_b32 s38, 0
.g2_kernel_wg43:
  ds_read_b32 v7, v6 offset:20
  s_add_u32 s38, s38, 1
  s_waitcnt lgkmcnt(0)
  v_cmp_gt_u32 vcc, 4, v7
  s_cbranch_vccz .g2_kernel_wg43d
  s_sleep 1
  s_cmp_lt_u32 s38, 524288
  s_cbranch_scc1 .g2_kernel_wg43
.g2_kernel_wg43d:
  s_sleep 12
  s_cmp_lg_u32 s62, 0
  s_cbranch_scc1 .g2_kernel_nap44
  s_sleep 12
.g2_kernel_nap44:
  s_xor_b32 s28, s17, s18
  s_and_b32 s28, s28, 3
  s_cbranch_scc1 .g2_kernel_c_l1
  s_mov_b32 s38, 0
.g2_kernel_gx45:
  buffer_load_dwordx4 v[32:35], v3, s[4:7], s20 offen offset:0 sc1
  buffer_load_dwordx4 v[36:39], v3, s[4:7], s20 offen offset:1024 sc1
  buffer_load_dwordx4 v[40:43], v3, s[4:7], s20 offen offset:2048 sc1
  buffer_load_dwordx4 v[44:47], v3, s[4:7], s20 offen offset:3072 sc1
  buffer_load_dwordx4 v[48:51], v3, s[4:7], s24 offen offset:0 sc1
  buffer_load_dwordx4 v[52:55], v3, s[4:7], s24 offen offset:1024 sc1
  buffer_load_dwordx4 v[56:59], v3, s[4:7], s24 offen offset:2048 sc1
  buffer_load_dwordx4 v[60:63], v3, s[4:7], s24 offen offset:3072 sc1
  s_add_u32 s38, s38, 1
  s_waitcnt vmcnt(0)
  v_min3_u32 v6, v32, v35, v36
  v_min3_u32 v6, v6, v39, v40
  v_min3_u32 v6, v6, v43, v44
  v_min3_u32 v6, v6, v47, v48
  v_min3_u32 v6, v6, v51, v52
  v_min3_u32 v6, v6, v55, v56
  v_min3_u32 v6, v6, v59, v60
  v_min_u32 v6, v6, v63
  v_cmp_eq_u32 vcc, 0, v6
  s_cbranch_vccz .g2_kernel_gx45d
  s_mov_b64 exec, vcc
  s_sleep 1
  s_cmp_lg_u32 s62, 0
  s_cbranch_scc1 .g2_kernel_nap46
  s_sleep 9
.g2_kernel_nap46:
  s_cmp_lt_u32 s38, 131072
  s_cbranch_scc1 .g2_kernel_gx45
.g2_kernel_gx45d:
  s_mov_b64 exec, -1
  v_add_f32 v32, v32, v48
  v_add_f32 v33, v33, v49
  v_add_f32 v34, v34, v50
  v_add_f32 v36, v36, v52
  v_add_f32 v37, v37, v53
  v_add_f32 v38, v38, v54
  v_add_f32 v40, v40, v56
  v_add_f32 v41, v41, v57
  v_add_f32 v42, v42, v58
  v_add_f32 v44, v44, v60
  v_add_f32 v45, v45, v61
  v_add_f32 v46, v46, v62
  v_add_f32 v32, v32, v40
  v_add_f32 v33, v33, v41
  v_add_f32 v34, v34, v42
  v_add_f32 v36, v36, v44
  v_add_f32 v37, v37, v45
  v_add_f32 v38, v38, v46
  v_add_f32 v32, v32, v36
  v_add_f32 v33, v33, v37
  v_add_f32 v34, v34, v38
  v_mov_b32 v16, v32
  v_mov_b32 v17, v33
  v_mov_b32 v18, v34
  s_mov_b32 s28, -32
  v_permlane32_swap_b32 v16, v32
  v_permlane32_swap_b32 v17, v33
  v_permlane32_swap_b32 v18, v34
  v_add_f32 v16, v16, v32
  v_add_f32 v17, v17, v33
  v_add_f32 v18, v18, v34
  v_fma_f32 v18, -v16, v26, v18
  v_mul_f32 v16, v28, v16
  v_mul_f32 v19, v16, v16
  v_fma_f32 v17, v17, v28, -v19
  v_max_f32 v17, 0, v17
  v_add_f32 v17, v30, v17
  v_rsq_f32 v19, v17
  v_mov_b32 v11, 1
  v_mul_f32 v18, v18, v19
  v_and_or_b32 v10, v18, s28, v24
  s_nop 1
  v_max_f32 v10, v10, v10 row_ror:8 row_mask:0xf bank_mask:0xf
  s_nop 1
  v_max_f32 v10, v10, v10 row_ror:4 row_mask:0xf bank_mask:0xf
  s_nop 1
  v_max_f32 v10, v10, v10 row_ror:2 row_mask:0xf bank_mask:0xf
  s_nop 1
  v_max_f32 v10, v10, v10 row_ror:1 row_mask:0xf bank_mask:0xf
  s_nop 1
  v_max_f32 v10, v10, v10 row_bcast:15 row_mask:0xa bank_mask:0xf
  s_nop 0
  v_readlane_b32 s28, v10, 31
  s_nop 1
  v_mov_b32 v10, s28
  s_mov_b64 exec, 0xff
  buffer_store_dwordx2 v[10:11], v27, s[4:7], s22 offen sc1
  s_mov_b32 exec_lo, -1
  buffer_store_dwordx2 v[16:17], v25, s[4:7], s21 offen sc1
  s_mov_b64 exec, -1
.g2_kernel_c_l1:
  s_cmp_lg_u32 s62, 0
  s_cbranch_scc1 .g2_kernel_c_t3
  s_sleep 30
  s_mov_b64 s[8:9], -1
  s_call_b64 s[68:69], .g2_kernel_amax
  s_lshr_b32 s28, s77, 5
  s_add_u32 m0, s71, 104
  s_lshl_b32 s29, s28, 2
  s_add_u32 s29, s29, .g2_kernel_tab-.g2_kernel_pc
  s_mov_b64 exec, 1
  buffer_load_dword off, s[64:67], s29 lds
  s_mov_b64 exec, -1
  s_and_b32 s28, s77, 31
  s_add_u32 s28, s28, 1
  s_add_u32 m0, s71, 36
  s_lshl_b32 s29, s28, 2
  s_add_u32 s29, s29, .g2_kernel_tab-.g2_kernel_pc
  s_mov_b64 exec, 1
  buffer_load_dword off, s[64:67], s29 lds
  s_mov_b64 exec, -1
  s_lshr_b32 s24, s77, 7
  s_lshl_b32 s24, s24, 18
  s_bfe_u32 s28, s77, 0x30004
  s_lshl_b32 s28, s28, 11
  s_add_u32 s24, s24, s28
  s_and_b32 s28, s77, 15
  s_lshl_b32 s28, s28, 4
  s_add_u32 s24, s24, s28
  s_add_u32 s24, s24, s63
  s_add_u32 s24, s24, 0xc00000
  s_lshl_b32 s28, s17, 14
  s_add_u32 s24, s24, s28
  s_and_b32 s28, s18, 1
  s_lshl_b32 s28, s28, 8
  s_add_u32 s24, s24, s28
  v_lshrrev_b32 v12, 3, v2
  v_lshlrev_b32 v13, 1, v12
  buffer_load_ushort v56, v13, s[4:7], s24 offen offset:0
  buffer_load_ushort v57, v13, s[4:7], s24 offen offset:512
  buffer_load_ushort v58, v13, s[4:7], s24 offen offset:1024
  buffer_load_ushort v59, v13, s[4:7], s24 offen offset:1536
  s_lshl_b32 s25, s77, 3
  s_add_u32 s25, s25, s63
  s_add_u32 s25, s25, 0x1080000
  s_lshl_b32 s21, s17, 10
  s_add_u32 s21, s21, s63
  s_add_u32 s21, s21, 0x1080000
  s_mov_b32 s38, 0
.g2_kernel_gx47:
  buffer_load_dwordx4 v[16:19], v3, s[4:7], s21 offen sc1
  buffer_load_dwordx2 v[20:21], v4, s[4:7], s25 offen sc1
  s_add_u32 s38, s38, 1
  s_waitcnt vmcnt(0)
  v_min3_u32 v6, v17, v19, v21
  v_cmp_eq_u32 vcc, 0, v6
  s_cbranch_vccz .g2_kernel_gx47d
  s_mov_b64 exec, vcc
  s_sleep 1
  s_cmp_lt_u32 s38, 131072
  s_cbranch_scc1 .g2_kernel_gx47
.g2_kernel_gx47d:
  s_mov_b64 exec, -1
  s_lshr_b32 s28, s77, 7
  s_and_b32 s79, s77, 127
  s_add_u32 s79, s79, 1
  s_cmp_eq_u32 s28, s17
  s_cselect_b32 s79, s79, 0
  v_rsq_f32 v22, v17
  v_rsq_f32 v23, v19
  v_rsq_f32 v21, v21
  v_mov_b32 v62, -1.4426950408889634
  v_mul_f32 v62, s27, v62
  v_exp_f32 v62, v62
  v_lshlrev_b32 v14, 3, v2
  v_add_u32 v14, 155648, v14
  v_mov_b32 v15, s79
  v_add_f32 v52, 1.0, v22
  v_mul_f32 v54, v16, v22
  v_sub_f32 v54, 0, v54
  v_add_f32 v53, 1.0, v23
  v_mul_f32 v55, v18, v23
  v_sub_f32 v55, 0, v55
  v_add_f32 v62, 1.0, v62
  v_rcp_f32 v62, v62
  v_add_f32 v60, 1.0, v21
  v_mul_f32 v61, v20, v21
  v_sub_f32 v61, 0, v61
  v_sub_f32 v17, v17, v30
  v_mul_f32 v48, v52, v52
  v_fma_f32 v48, v48, v17, v30
  v_rsq_f32 v48, v48
  s_nop 0
  v_mul_f32 v48, v48, v52
  v_mul_f32 v50, v48, v16
  v_sub_f32 v50, 0, v50
  v_sub_f32 v19, v19, v30
  v_mul_f32 v49, v53, v53
  v_fma_f32 v49, v49, v19, v30
  v_rsq_f32 v49, v49
  s_nop 0
  v_mul_f32 v49, v49, v53
  v_mul_f32 v51, v49, v18
  v_sub_f32 v51, 0, v51
  v_lshlrev_b32 v56, 16, v56
  v_fma_f32 v56, v56, v60, v61
  v_lshlrev_b32 v57, 16, v57
  v_fma_f32 v57, v57, v60, v61
  v_lshlrev_b32 v58, 16, v58
  v_fma_f32 v58, v58, v60, v61
  v_lshlrev_b32 v59, 16, v59
  v_fma_f32 v59, v59, v60, v61
  v_and_b32 v10, 7, v2
  v_lshlrev_b32 v10, 12, v10
  v_lshl_add_u32 v10, v12, 4, v10
  s_lshl_b32 s20, s17, 1
  s_and_b32 s28, s18, 1
  s_add_u32 s20, s20, s28
  s_lshl_b32 s20, s20, 7
  s_add_u32 s20, s20, s63
  s_add_u32 s20, s20, 0x1090000
  s_and_b32 s26, s18, 14
  s_lshl_b32 s26, s26, 4
  s_add_u32 s26, s26, s17
  s_lshl_b32 s26, s26, 1
  s_and_b32 s28, s18, 1
  s_add_u32 s26, s26, s28
  s_lshl_b32 s26, s26, 10
  s_add_u32 s26, s26, s63
  s_add_u32 s26, s26, 0x1190000
  s_add_u32 s25, s26, 32768
  s_lshl_b32 s21, s2, 12
  s_add_u32 s21, s21, 0x3200000
  v_lshlrev_b32 v14, 3, v2
  buffer_store_dwordx2 v[48:49], v14, s[4:7], s21 offen
  buffer_store_dwordx2 v[50:51], v14, s[4:7], s21 offen offset:512
  buffer_store_dwordx2 v[52:53], v14, s[4:7], s21 offen offset:1024
  buffer_store_dwordx2 v[54:55], v14, s[4:7], s21 offen offset:1536
  buffer_store_dword v15, v4, s[4:7], s21 offen offset:2048
  s_mov_b32 m0, 158464
  s_add_u32 s22, s21, 2048
  s_waitcnt vmcnt(0)
  buffer_load_dwordx4 v3, s[4:7], s21 offen lds
  buffer_load_dwordx4 v3, s[4:7], s21 offen offset:1024 lds
  s_mov_b32 m0, 155800
  s_mov_b64 exec, 1
  buffer_load_dword v4, s[4:7], s22 offen lds
  s_mov_b64 exec, -1
  s_add_u32 m0, s71, 128
  s_mov_b32 s29, .g2_kernel_tab-.g2_kernel_pc+8
  s_mov_b64 exec, 1
  buffer_load_dword off, s[64:67], s29 lds
  s_mov_b64 exec, -1
  s_lshl_b32 s28, s2, 10
  s_and_b32 s28, s28, 0xe000
  v_lshlrev_b32 v7, 7, v2
  buffer_load_dword v1, v7, s[64:67], s28 offen
  v_mov_b32 v6, s71
  s_mov_b32 s38, 0
.g2_kernel_wg48:
  ds_read_b32 v7, v6 offset:112
  s_add_u32 s38, s38, 1
  s_waitcnt lgkmcnt(0)
  v_cmp_gt_u32 vcc, 1, v7
  s_cbranch_vccz .g2_kernel_wg48d
  s_sleep 2
  s_cmp_lt_u32 s38, 524288
  s_cbranch_scc1 .g2_kernel_wg48
.g2_kernel_wg48d:
  s_sleep 8
  s_cmp_lg_u32 s62, 0
  s_cbranch_scc1 .g2_kernel_nap49
  s_sleep 22
.g2_kernel_nap49:
  s_mov_b32 s38, 0
.g2_kernel_gx50:
  s_mov_b32 s21, s20
  buffer_load_dwordx4 v[160:163], v10, s[4:7], s21 offen sc1
  s_add_u32 s21, s21, 32768
  buffer_load_dwordx4 v[164:167], v10, s[4:7], s21 offen sc1
  s_add_u32 s21, s21, 32768
  buffer_load_dwordx4 v[168:171], v10, s[4:7], s21 offen sc1
  s_add_u32 s21, s21, 32768
  buffer_load_dwordx4 v[172:175], v10, s[4:7], s21 offen sc1
  s_add_u32 s21, s21, 32768
  buffer_load_dwordx4 v[176:179], v10, s[4:7], s21 offen sc1
  s_add_u32 s21, s21, 32768
  buffer_load_dwordx4 v[180:183], v10, s[4:7], s21 offen sc1
  s_add_u32 s21, s21, 32768
  buffer_load_dwordx4 v[184:187], v10, s[4:7], s21 offen sc1
  s_add_u32 s21, s21, 32768
  buffer_load_dwordx4 v[188:191], v10, s[4:7], s21 offen sc1
  s_add_u32 s21, s21, 32768
  buffer_load_dwordx4 v[192:195], v10, s[4:7], s21 offen sc1
  s_add_u32 s21, s21, 32768
  buffer_load_dwordx4 v[196:199], v10, s[4:7], s21 offen sc1
  s_add_u32 s21, s21, 32768
  buffer_load_dwordx4 v[200:203], v10, s[4:7], s21 offen sc1
  s_add_u32 s21, s21, 32768
  buffer_load_dwordx4 v[204:207], v10, s[4:7], s21 offen sc1
  s_add_u32 s21, s21, 32768
  buffer_load_dwordx4 v[208:211], v10, s[4:7], s21 offen sc1
  s_add_u32 s21, s21, 32768
  buffer_load_dwordx4 v[212:215], v10, s[4:7], s21 offen sc1
  s_add_u32 s21, s21, 32768
  buffer_load_dwordx4 v[216:219], v10, s[4:7], s21 offen sc1
  s_add_u32 s21, s21, 32768
  buffer_load_dwordx4 v[220:223], v10, s[4:7], s21 offen sc1
  s_add_u32 s21, s21, 32768
  buffer_load_dwordx4 v[224:227], v10, s[4:7], s21 offen sc1
  s_add_u32 s21, s21, 32768
  buffer_load_dwordx4 v[228:231], v10, s[4:7], s21 offen sc1
  s_add_u32 s21, s21, 32768
  buffer_load_dwordx4 v[232:235], v10, s[4:7], s21 offen sc1
  s_add_u32 s21, s21, 32768
  buffer_load_dwordx4 v[236:239], v10, s[4:7], s21 offen sc1
  s_add_u32 s21, s21, 32768
  buffer_load_dwordx4 v[240:243], v10, s[4:7], s21 offen sc1
  s_add_u32 s21, s21, 32768
  buffer_load_dwordx4 v[244:247], v10, s[4:7], s21 offen sc1
  s_add_u32 s21, s21, 32768
  buffer_load_dwordx4 v[248:251], v10, s[4:7], s21 offen sc1
  s_add_u32 s21, s21, 32768
  buffer_load_dwordx4 v[252:255], v10, s[4:7], s21 offen sc1
  s_add_u32 s21, s21, 32768
  buffer_load_dwordx4 v[16:19], v10, s[4:7], s21 offen sc1
  s_add_u32 s21, s21, 32768
  buffer_load_dwordx4 v[20:23], v10, s[4:7], s21 offen sc1
  s_add_u32 s21, s21, 32768
  buffer_load_dwordx4 v[24:27], v10, s[4:7], s21 offen sc1
  s_add_u32 s21, s21, 32768
  buffer_load_dwordx4 v[28:31], v10, s[4:7], s21 offen sc1
  s_add_u32 s21, s21, 32768
  s_add_u32 s38, s38, 1
  s_waitcnt vmcnt(0)
  v_min3_u32 v6, v160, v162, v164
  v_min3_u32 v6, v6, v166, v168
  v_min3_u32 v6, v6, v170, v172
  v_min3_u32 v6, v6, v174, v176
  v_min3_u32 v6, v6, v178, v180
  v_min3_u32 v6, v6, v182, v184
  v_min3_u32 v6, v6, v186, v188
  v_min3_u32 v6, v6, v190, v192
  v_min3_u32 v6, v6, v194, v196
  v_min3_u32 v6, v6, v198, v200
  v_min3_u32 v6, v6, v202, v204
  v_min3_u32 v6, v6, v206, v208
  v_min3_u32 v6, v6, v210, v212
  v_min3_u32 v6, v6, v214, v216
  v_min3_u32 v6, v6, v218, v220
  v_min3_u32 v6, v6, v222, v224
  v_min3_u32 v6, v6, v226, v228
  v_min3_u32 v6, v6, v230, v232
  v_min3_u32 v6, v6, v234, v236
  v_min3_u32 v6, v6, v238, v240
  v_min3_u32 v6, v6, v242, v244
  v_min3_u32 v6, v6, v246, v248
  v_min3_u32 v6, v6, v250, v252
  v_min3_u32 v6, v6, v254, v16
  v_min3_u32 v6, v6, v18, v20
  v_min3_u32 v6, v6, v22, v24
  v_min3_u32 v6, v6, v26, v28
  v_min_u32 v6, v6, v30
  v_cmp_eq_u32 vcc, 0, v6
  s_cbranch_vccz .g2_kernel_gx50d
  s_mov_b64 exec, vcc
  s_sleep 1
  s_cmp_lg_u32 s62, 0
  s_cbranch_scc1 .g2_kernel_nap51
  s_sleep 11
.g2_kernel_nap51:
  s_cmp_lt_u32 s38, 131072
  s_cbranch_scc1 .g2_kernel_gx50
.g2_kernel_gx50d:
  s_mov_b64 exec, -1
  v_add_f32 v164, v164, v160
  v_add_f32 v165, v165, v161
  v_add_f32 v166, v166, v162
  v_add_f32 v167, v167, v163
  v_add_f32 v172, v172, v168
  v_add_f32 v173, v173, v169
  v_add_f32 v174, v174, v170
  v_add_f32 v175, v175, v171
  v_add_f32 v180, v180, v176
  v_add_f32 v181, v181, v177
  v_add_f32 v182, v182, v178
  v_add_f32 v183, v183, v179
  v_add_f32 v188, v188, v184
  v_add_f32 v189, v189, v185
  v_add_f32 v190, v190, v186
  v_add_f32 v191, v191, v187
  v_add_f32 v196, v196, v192
  v_add_f32 v197, v197, v193
  v_add_f32 v198, v198, v194
  v_add_f32 v199, v199, v195
  v_add_f32 v204, v204, v200
  v_add_f32 v205, v205, v201
  v_add_f32 v206, v206, v202
  v_add_f32 v207, v207, v203
  v_add_f32 v212, v212, v208
  v_add_f32 v213, v213, v209
  v_add_f32 v214, v214, v210
  v_add_f32 v215, v215, v211
  v_add_f32 v220, v220, v216
  v_add_f32 v221, v221, v217
  v_add_f32 v222, v222, v218
  v_add_f32 v223, v223, v219
  v_add_f32 v228, v228, v224
  v_add_f32 v229, v229, v225
  v_add_f32 v230, v230, v226
  v_add_f32 v231, v231, v227
  v_add_f32 v236, v236, v232
  v_add_f32 v237, v237, v233
  v_add_f32 v238, v238, v234
  v_add_f32 v239, v239, v235
  v_add_f32 v244, v244, v240
  v_add_f32 v245, v245, v241
  v_add_f32 v246, v246, v242
  v_add_f32 v247, v247, v243
  v_add_f32 v252, v252, v248
  v_add_f32 v253, v253, v249
  v_add_f32 v254, v254, v250
  v_add_f32 v255, v255, v251
  v_add_f32 v20, v20, v16
  v_add_f32 v21, v21, v17
  v_add_f32 v22, v22, v18
  v_add_f32 v23, v23, v19
  v_add_f32 v28, v28, v24
  v_add_f32 v29, v29, v25
  v_add_f32 v30, v30, v26
  v_add_f32 v31, v31, v27
  v_add_f32 v172, v172, v164
  v_add_f32 v173, v173, v165
  v_add_f32 v174, v174, v166
  v_add_f32 v175, v175, v167
  v_add_f32 v188, v188, v180
  v_add_f32 v189, v189, v181
  v_add_f32 v190, v190, v182
  v_add_f32 v191, v191, v183
  v_add_f32 v204, v204, v196
  v_add_f32 v205, v205, v197
  v_add_f32 v206, v206, v198
  v_add_f32 v207, v207, v199
  v_add_f32 v220, v220, v212
  v_add_f32 v221, v221, v213
  v_add_f32 v222, v222, v214
  v_add_f32 v223, v223, v215
  v_add_f32 v236, v236, v228
  v_add_f32 v237, v237, v229
  v_add_f32 v238, v238, v230
  v_add_f32 v239, v239, v231
  v_add_f32 v252, v252, v244
  v_add_f32 v253, v253, v245
  v_add_f32 v254, v254, v246
  v_add_f32 v255, v255, v247
  v_add_f32 v28, v28, v20
  v_add_f32 v29, v29, v21
  v_add_f32 v30, v30, v22
  v_add_f32 v31, v31, v23
  v_add_f32 v188, v188, v172
  v_add_f32 v189, v189, v173
  v_add_f32 v190, v190, v174
  v_add_f32 v191, v191, v175
  v_add_f32 v220, v220, v204
  v_add_f32 v221, v221, v205
  v_add_f32 v222, v222, v206
  v_add_f32 v223, v223, v207
  v_add_f32 v252, v252, v236
  v_add_f32 v253, v253, v237
  v_add_f32 v254, v254, v238
  v_add_f32 v255, v255, v239
  v_add_f32 v220, v220, v188
  v_add_f32 v221, v221, v189
  v_add_f32 v222, v222, v190
  v_add_f32 v223, v223, v191
  v_add_f32 v28, v28, v252
  v_add_f32 v29, v29, v253
  v_add_f32 v30, v30, v254
  v_add_f32 v31, v31, v255
  v_add_f32 v28, v28, v220
  v_add_f32 v29, v29, v221
  v_add_f32 v30, v30, v222
  v_add_f32 v31, v31, v223
  v_add_f32 v28, v28, v28 quad_perm:[1,0,3,2] row_mask:0xf bank_mask:0xf
  v_add_f32 v29, v29, v29 quad_perm:[1,0,3,2] row_mask:0xf bank_mask:0xf
  v_add_f32 v30, v30, v30 quad_perm:[1,0,3,2] row_mask:0xf bank_mask:0xf
  v_add_f32 v31, v31, v31 quad_perm:[1,0,3,2] row_mask:0xf bank_mask:0xf
  v_add_f32 v28, v28, v28 quad_perm:[2,3,0,1] row_mask:0xf bank_mask:0xf
  v_add_f32 v29, v29, v29 quad_perm:[2,3,0,1] row_mask:0xf bank_mask:0xf
  v_add_f32 v30, v30, v30 quad_perm:[2,3,0,1] row_mask:0xf bank_mask:0xf
  v_add_f32 v31, v31, v31 quad_perm:[2,3,0,1] row_mask:0xf bank_mask:0xf
  v_add_f32 v28, v28, v28 row_half_mirror row_mask:0xf bank_mask:0xf
  v_add_f32 v29, v29, v29 row_half_mirror row_mask:0xf bank_mask:0xf
  v_add_f32 v30, v30, v30 row_half_mirror row_mask:0xf bank_mask:0xf
  v_add_f32 v31, v31, v31 row_half_mirror row_mask:0xf bank_mask:0xf
  v_mul_f32 v28, v28, v62
  v_mul_f32 v29, v29, v62
  v_mul_f32 v30, v30, v62
  v_mul_f32 v31, v31, v62
  v_cvt_pk_bf16_f32 v16, v28, v29
  v_cvt_pk_bf16_f32 v17, v30, v31
  s_mov_b32 s28, 0x00010001
  s_mov_b32 s29, 0x00010001
  v_mov_b32 v18, v16 row_ror:8 row_mask:0xf bank_mask:0xf
  v_mov_b32 v19, v17 row_ror:8 row_mask:0xf bank_mask:0xf
  v_lshlrev_b32 v28, 16, v16
  v_and_b32 v29, 0xffff0000, v16
  v_lshlrev_b32 v30, 16, v17
  v_and_b32 v31, 0xffff0000, v17
  v_cndmask_b32 v32, 0, v16, s[28:29]
  v_cndmask_b32 v33, 0, v17, s[28:29]
  v_cndmask_b32 v34, 0, v18, s[28:29]
  v_cndmask_b32 v35, 0, v19, s[28:29]
  s_lshl_b64 s[28:29], s[28:29], 1
  s_nop 0
  v_mfma_f32_16x16x32_bf16 v[160:163], v[32:35], v[64:67], 0
  v_mfma_f32_16x16x32_bf16 v[164:167], v[32:35], v[80:83], 0
  v_mfma_f32_16x16x32_bf16 v[168:171], v[32:35], v[96:99], 0
  v_mfma_f32_16x16x32_bf16 v[172:175], v[32:35], v[112:115], 0
  v_mfma_f32_16x16x32_bf16 v[176:179], v[32:35], v[128:131], 0
  v_mfma_f32_16x16x32_bf16 v[180:183], v[32:35], v[144:147], 0
  v_cndmask_b32 v36, 0, v16, s[28:29]
  v_cndmask_b32 v37, 0, v17, s[28:29]
  v_cndmask_b32 v38, 0, v18, s[28:29]
  v_cndmask_b32 v39, 0, v19, s[28:29]
  s_lshl_b64 s[28:29], s[28:29], 1
  s_nop 0
  v_mfma_f32_16x16x32_bf16 v[160:163], v[36:39], v[68:71], v[160:163]
  v_mfma_f32_16x16x32_bf16 v[164:167], v[36:39], v[84:87], v[164:167]
  v_mfma_f32_16x16x32_bf16 v[168:171], v[36:39], v[100:103], v[168:171]
  v_mfma_f32_16x16x32_bf16 v[172:175], v[36:39], v[116:119], v[172:175]
  v_mfma_f32_16x16x32_bf16 v[176:179], v[36:39], v[132:135], v[176:179]
  v_mfma_f32_16x16x32_bf16 v[180:183], v[36:39], v[148:151], v[180:183]
  v_cndmask_b32 v40, 0, v16, s[28:29]
  v_cndmask_b32 v41, 0, v17, s[28:29]
  v_cndmask_b32 v42, 0, v18, s[28:29]
  v_cndmask_b32 v43, 0, v19, s[28:29]
  s_lshl_b64 s[28:29], s[28:29], 1
  s_nop 0
  v_mfma_f32_16x16x32_bf16 v[160:163], v[40:43], v[72:75], v[160:163]
  v_mfma_f32_16x16x32_bf16 v[164:167], v[40:43], v[88:91], v[164:167]
  v_mfma_f32_16x16x32_bf16 v[168:171], v[40:43], v[104:107], v[168:171]
  v_mfma_f32_16x16x32_bf16 v[172:175], v[40:43], v[120:123], v[172:175]
  v_mfma_f32_16x16x32_bf16 v[176:179], v[40:43], v[136:139], v[176:179]
  v_mfma_f32_16x16x32_bf16 v[180:183], v[40:43], v[152:155], v[180:183]
  v_cndmask_b32 v44, 0, v16, s[28:29]
  v_cndmask_b32 v45, 0, v17, s[28:29]
  v_cndmask_b32 v46, 0, v18, s[28:29]
  v_cndmask_b32 v47, 0, v19, s[28:29]
  s_lshl_b64 s[28:29], s[28:29], 1
  s_nop 0
  v_mfma_f32_16x16x32_bf16 v[160:163], v[44:47], v[76:79], v[160:163]
  v_mfma_f32_16x16x32_bf16 v[164:167], v[44:47], v[92:95], v[164:167]
  v_mfma_f32_16x16x32_bf16 v[168:171], v[44:47], v[108:111], v[168:171]
  v_mfma_f32_16x16x32_bf16 v[172:175], v[44:47], v[124:127], v[172:175]
  v_mfma_f32_16x16x32_bf16 v[176:179], v[44:47], v[140:143], v[176:179]
  v_mfma_f32_16x16x32_bf16 v[180:183], v[44:47], v[156:159], v[180:183]
  v_add_f32 v56, v56, v28
  v_add_f32 v57, v57, v29
  v_add_f32 v58, v58, v30
  v_add_f32 v59, v59, v31
  v_add_f32 v20, v56, v57
  v_mul_f32 v22, v56, v56
  v_add_f32 v21, v58, v59
  v_fmac_f32 v22, v57, v57
  v_add_f32 v20, v20, v21
  v_fmac_f32 v22, v58, v58
  v_fmac_f32 v22, v59, v59
  v_or_b32 v28, 1, v28
  v_or_b32 v30, 1, v30
  v_add_f32 v20, v20, v20 row_ror:8 row_mask:0xf bank_mask:0xf
  v_add_f32 v22, v22, v22 row_ror:8 row_mask:0xf bank_mask:0xf
  v_lshlrev_b32 v11, 4, v12
  v_add_f32 v20, v20, v20 row_bcast:15 row_mask:0xa bank_mask:0xf
  v_add_f32 v22, v22, v22 row_bcast:15 row_mask:0xa bank_mask:0xf
  s_mov_b32 exec_lo, 0x01010101
  s_mov_b32 exec_hi, 0x01010101
  buffer_store_dwordx4 v[28:31], v11, s[4:7], s26 offen offset:768 sc1
  buffer_store_dwordx4 v[28:31], v11, s[4:7], s25 offen offset:768 sc1
  s_mov_b64 exec, -1
  v_add_f32 v20, v20, v20 row_bcast:31 row_mask:0xc bank_mask:0xf
  v_add_f32 v22, v22, v22 row_bcast:31 row_mask:0xc bank_mask:0xf
  v_or_b32 v20, 1, v20
  v_or_b32 v22, 1, v22
  s_mov_b32 exec_lo, 0
  s_mov_b32 exec_hi, 0x80000000
  buffer_store_dwordx4 v[20:23], v4, s[4:7], s26 offen offset:896 sc1
  buffer_store_dwordx4 v[20:23], v4, s[4:7], s25 offen offset:896 sc1
  s_mov_b64 exec, 0xffff
  v_or_b32 v160, 1, v160
  v_or_b32 v162, 1, v162
  buffer_store_dwordx4 v[160:163], v3, s[4:7], s26 offen offset:0 sc1
  v_or_b32 v164, 1, v164
  v_or_b32 v166, 1, v166
  buffer_store_dwordx4 v[164:167], v3, s[4:7], s25 offen offset:0 sc1
  v_or_b32 v168, 1, v168
  v_or_b32 v170, 1, v170
  buffer_store_dwordx4 v[168:171], v3, s[4:7], s26 offen offset:256 sc1
  v_or_b32 v172, 1, v172
  v_or_b32 v174, 1, v174
  buffer_store_dwordx4 v[172:175], v3, s[4:7], s25 offen offset:256 sc1
  v_or_b32 v176, 1, v176
  v_or_b32 v178, 1, v178
  buffer_store_dwordx4 v[176:179], v3, s[4:7], s26 offen offset:512 sc1
  v_or_b32 v180, 1, v180
  v_or_b32 v182, 1, v182
  buffer_store_dwordx4 v[180:183], v3, s[4:7], s25 offen offset:512 sc1
  s_mov_b64 exec, -1
  s_cmp_eq_u32 s79, 0
  s_cbranch_scc1 .g2_kernel_c_no
  s_lshl_b32 s20, s18, 15
  s_add_u32 s20, s20, 0x1190000
  s_lshl_b32 s22, s18, 11
  s_add_u32 s22, s22, s20
  v_lshlrev_b32 v16, 10, v2
  s_sleep 16
  s_mov_b32 s38, 0
  s_mov_b32 exec_hi, 0
.g2_kernel_gx52:
  buffer_load_dword v17, v16, s[4:7], s20 offen offset:752 sc1
  s_add_u32 s38, s38, 1
  s_waitcnt vmcnt(0)
  v_min_u32 v6, v17, v17
  v_cmp_eq_u32 vcc, 0, v6
  s_cbranch_vccz .g2_kernel_gx52d
  s_mov_b64 exec, vcc
  s_sleep 6
  s_cmp_lt_u32 s38, 131072
  s_cbranch_scc1 .g2_kernel_gx52
.g2_kernel_gx52d:
  s_mov_b64 exec, -1
  s_mov_b32 s38, 0
  s_bfm_b64 exec, 57, 0
.g2_kernel_gx53:
  s_mov_b32 s21, s20
  buffer_load_dwordx4 v[64:67], v3, s[4:7], s21 offen offset:0 sc1
  buffer_load_dwordx4 v[68:71], v3, s[4:7], s21 offen offset:1024 sc1
  buffer_load_dwordx4 v[72:75], v3, s[4:7], s21 offen offset:2048 sc1
  buffer_load_dwordx4 v[76:79], v3, s[4:7], s21 offen offset:3072 sc1
  s_add_u32 s21, s21, 4096
  buffer_load_dwordx4 v[80:83], v3, s[4:7], s21 offen offset:0 sc1
  buffer_load_dwordx4 v[84:87], v3, s[4:7], s21 offen offset:1024 sc1
  buffer_load_dwordx4 v[88:91], v3, s[4:7], s21 offen offset:2048 sc1
  buffer_load_dwordx4 v[92:95], v3, s[4:7], s21 offen offset:3072 sc1
  s_add_u32 s21, s21, 4096
  buffer_load_dwordx4 v[96:99], v3, s[4:7], s21 offen offset:0 sc1
  buffer_load_dwordx4 v[100:103], v3, s[4:7], s21 offen offset:1024 sc1
  buffer_load_dwordx4 v[104:107], v3, s[4:7], s21 offen offset:2048 sc1
  buffer_load_dwordx4 v[108:111], v3, s[4:7], s21 offen offset:3072 sc1
  s_add_u32 s21, s21, 4096
  buffer_load_dwordx4 v[112:115], v3, s[4:7], s21 offen offset:0 sc1
  buffer_load_dwordx4 v[116:119], v3, s[4:7], s21 offen offset:1024 sc1
  buffer_load_dwordx4 v[120:123], v3, s[4:7], s21 offen offset:2048 sc1
  buffer_load_dwordx4 v[124:127], v3, s[4:7], s21 offen offset:3072 sc1
  s_add_u32 s21, s21, 4096
  buffer_load_dwordx4 v[128:131], v3, s[4:7], s21 offen offset:0 sc1
  buffer_load_dwordx4 v[132:135], v3, s[4:7], s21 offen offset:1024 sc1
  buffer_load_dwordx4 v[136:139], v3, s[4:7], s21 offen offset:2048 sc1
  buffer_load_dwordx4 v[140:143], v3, s[4:7], s21 offen offset:3072 sc1
  s_add_u32 s21, s21, 4096
  buffer_load_dwordx4 v[144:147], v3, s[4:7], s21 offen offset:0 sc1
  buffer_load_dwordx4 v[148:151], v3, s[4:7], s21 offen offset:1024 sc1
  buffer_load_dwordx4 v[152:155], v3, s[4:7], s21 offen offset:2048 sc1
  buffer_load_dwordx4 v[156:159], v3, s[4:7], s21 offen offset:3072 sc1
  s_add_u32 s21, s21, 4096
  buffer_load_dwordx4 v[160:163], v3, s[4:7], s21 offen offset:0 sc1
  buffer_load_dwordx4 v[164:167], v3, s[4:7], s21 offen offset:1024 sc1
  buffer_load_dwordx4 v[168:171], v3, s[4:7], s21 offen offset:2048 sc1
  buffer_load_dwordx4 v[172:175], v3, s[4:7], s21 offen offset:3072 sc1
  s_add_u32 s21, s21, 4096
  buffer_load_dwordx4 v[176:179], v3, s[4:7], s21 offen offset:0 sc1
  buffer_load_dwordx4 v[180:183], v3, s[4:7], s21 offen offset:1024 sc1
  buffer_load_dwordx4 v[184:187], v3, s[4:7], s21 offen offset:2048 sc1
  buffer_load_dwordx4 v[188:191], v3, s[4:7], s21 offen offset:3072 sc1
  s_add_u32 s21, s21, 4096
  buffer_load_dwordx4 v[192:195], v3, s[4:7], s22 offen offset:0 sc1
  buffer_load_dwordx4 v[196:199], v3, s[4:7], s22 offen offset:1024 sc1
  s_add_u32 s38, s38, 1
  s_waitcnt vmcnt(0)
  v_min3_u32 v6, v64, v66, v68
  v_min3_u32 v6, v6, v70, v72
  v_min3_u32 v6, v6, v74, v76
  v_min3_u32 v6, v6, v78, v80
  v_min3_u32 v6, v6, v82, v84
  v_min3_u32 v6, v6, v86, v88
  v_min3_u32 v6, v6, v90, v92
  v_min3_u32 v6, v6, v94, v96
  v_min3_u32 v6, v6, v98, v100
  v_min3_u32 v6, v6, v102, v104
  v_min3_u32 v6, v6, v106, v108
  v_min3_u32 v6, v6, v110, v112
  v_min3_u32 v6, v6, v114, v116
  v_min3_u32 v6, v6, v118, v120
  v_min3_u32 v6, v6, v122, v124
  v_min3_u32 v6, v6, v126, v128
  v_min3_u32 v6, v6, v130, v132
  v_min3_u32 v6, v6, v134, v136
  v_min3_u32 v6, v6, v138, v140
  v_min3_u32 v6, v6, v142, v144
  v_min3_u32 v6, v6, v146, v148
  v_min3_u32 v6, v6, v150, v152
  v_min3_u32 v6, v6, v154, v156
  v_min3_u32 v6, v6, v158, v160
  v_min3_u32 v6, v6, v162, v164
  v_min3_u32 v6, v6, v166, v168
  v_min3_u32 v6, v6, v170, v172
  v_min3_u32 v6, v6, v174, v176
  v_min3_u32 v6, v6, v178, v180
  v_min3_u32 v6, v6, v182, v184
  v_min3_u32 v6, v6, v186, v188
  v_min3_u32 v6, v6, v190, v192
  v_min3_u32 v6, v6, v194, v196
  v_min_u32 v6, v6, v198
  v_cmp_eq_u32 vcc, 0, v6
  s_cbranch_vccz .g2_kernel_gx53d
  s_mov_b64 exec, vcc
  s_sleep 2
  s_cmp_lt_u32 s38, 131072
  s_cbranch_scc1 .g2_kernel_gx53
.g2_kernel_gx53d:
  s_mov_b64 exec, -1
  v_add_f32 v64, v64, v128
  v_add_f32 v65, v65, v129
  v_add_f32 v66, v66, v130
  v_add_f32 v67, v67, v131
  v_add_f32 v68, v68, v132
  v_add_f32 v69, v69, v133
  v_add_f32 v70, v70, v134
  v_add_f32 v71, v71, v135
  v_add_f32 v72, v72, v136
  v_add_f32 v73, v73, v137
  v_add_f32 v74, v74, v138
  v_add_f32 v75, v75, v139
  v_add_f32 v76, v76, v140
  v_add_f32 v77, v77, v141
  v_add_f32 v78, v78, v142
  v_add_f32 v79, v79, v143
  v_add_f32 v80, v80, v144
  v_add_f32 v81, v81, v145
  v_add_f32 v82, v82, v146
  v_add_f32 v83, v83, v147
  v_add_f32 v84, v84, v148
  v_add_f32 v85, v85, v149
  v_add_f32 v86, v86, v150
  v_add_f32 v87, v87, v151
  v_add_f32 v88, v88, v152
  v_add_f32 v89, v89, v153
  v_add_f32 v90, v90, v154
  v_add_f32 v91, v91, v155
  v_add_f32 v92, v92, v156
  v_add_f32 v93, v93, v157
  v_add_f32 v94, v94, v158
  v_add_f32 v95, v95, v159
  v_add_f32 v96, v96, v160
  v_add_f32 v97, v97, v161
  v_add_f32 v98, v98, v162
  v_add_f32 v99, v99, v163
  v_add_f32 v100, v100, v164
  v_add_f32 v101, v101, v165
  v_add_f32 v102, v102, v166
  v_add_f32 v103, v103, v167
  v_add_f32 v104, v104, v168
  v_add_f32 v105, v105, v169
  v_add_f32 v106, v106, v170
  v_add_f32 v107, v107, v171
  v_add_f32 v108, v108, v172
  v_add_f32 v109, v109, v173
  v_add_f32 v110, v110, v174
  v_add_f32 v111, v111, v175
  v_add_f32 v112, v112, v176
  v_add_f32 v113, v113, v177
  v_add_f32 v114, v114, v178
  v_add_f32 v115, v115, v179
  v_add_f32 v116, v116, v180
  v_add_f32 v117, v117, v181
  v_add_f32 v118, v118, v182
  v_add_f32 v119, v119, v183
  v_add_f32 v120, v120, v184
  v_add_f32 v121, v121, v185
  v_add_f32 v122, v122, v186
  v_add_f32 v123, v123, v187
  v_add_f32 v124, v124, v188
  v_add_f32 v125, v125, v189
  v_add_f32 v126, v126, v190
  v_add_f32 v127, v127, v191
  v_add_f32 v64, v64, v96
  v_add_f32 v65, v65, v97
  v_add_f32 v66, v66, v98
  v_add_f32 v67, v67, v99
  v_add_f32 v68, v68, v100
  v_add_f32 v69, v69, v101
  v_add_f32 v70, v70, v102
  v_add_f32 v71, v71, v103
  v_add_f32 v72, v72, v104
  v_add_f32 v73, v73, v105
  v_add_f32 v74, v74, v106
  v_add_f32 v75, v75, v107
  v_add_f32 v76, v76, v108
  v_add_f32 v77, v77, v109
  v_add_f32 v78, v78, v110
  v_add_f32 v79, v79, v111
  v_add_f32 v80, v80, v112
  v_add_f32 v81, v81, v113
  v_add_f32 v82, v82, v114
  v_add_f32 v83, v83, v115
  v_add_f32 v84, v84, v116
  v_add_f32 v85, v85, v117
  v_add_f32 v86, v86, v118
  v_add_f32 v87, v87, v119
  v_add_f32 v88, v88, v120
  v_add_f32 v89, v89, v121
  v_add_f32 v90, v90, v122
  v_add_f32 v91, v91, v123
  v_add_f32 v92, v92, v124
  v_add_f32 v93, v93, v125
  v_add_f32 v94, v94, v126
  v_add_f32 v95, v95, v127
  v_add_f32 v64, v64, v80
  v_add_f32 v65, v65, v81
  v_add_f32 v66, v66, v82
  v_add_f32 v67, v67, v83
  v_add_f32 v68, v68, v84
  v_add_f32 v69, v69, v85
  v_add_f32 v70, v70, v86
  v_add_f32 v71, v71, v87
  v_add_f32 v72, v72, v88
  v_add_f32 v73, v73, v89
  v_add_f32 v74, v74, v90
  v_add_f32 v75, v75, v91
  v_add_f32 v76, v76, v92
  v_add_f32 v77, v77, v93
  v_add_f32 v78, v78, v94
  v_add_f32 v79, v79, v95
  v_add_f32 v64, v64, v72
  v_add_f32 v65, v65, v73
  v_add_f32 v66, v66, v74
  v_add_f32 v67, v67, v75
  v_add_f32 v68, v68, v76
  v_add_f32 v69, v69, v77
  v_add_f32 v70, v70, v78
  v_add_f32 v71, v71, v79
  v_add_f32 v64, v64, v68
  v_add_f32 v65, v65, v69
  v_add_f32 v66, v66, v70
  v_add_f32 v67, v67, v71
  v_mov_b32 v28, 0.0009765625
  v_mov_b32 v30, 1e-05
  v_readlane_b32 s21, v64, 56
  v_readlane_b32 s22, v66, 56
  s_nop 0
  v_mul_f32 v20, s21, v28
  v_fma_f32 v21, s22, v28, v30
  v_fma_f32 v21, -v20, v20, v21
  v_rsq_f32 v21, abs(v21)
  v_sub_f32 v20, v61, v20
  v_mul_f32 v22, v21, v60
  v_mul_f32 v23, v21, v20
  v_and_b32 v10, 15, v2
  v_lshrrev_b32 v11, 4, v2
  v_lshlrev_b32 v16, 2, v10
  v_lshl_add_u32 v16, v11, 8, v16
  v_add_u32 v16, 155648, v16
  s_sub_u32 s20, s79, 1
  s_and_b32 s21, s20, 3
  s_lshl_b32 s21, s21, 2
  s_add_u32 s21, s21, 156160
  v_lshl_add_u32 v17, v10, 4, s21
  v_cmp_eq_u32 vcc, 2, v11
  v_mov_b32 v18, 64
  v_mov_b32 v19, 256
  v_cndmask_b32 v17, v16, v17, vcc
  v_cndmask_b32 v18, v18, v19, vcc
  v_lshrrev_b32 v24, 2, v10
  v_lshlrev_b32 v24, 9, v24
  v_and_b32 v25, 3, v10
  v_lshl_add_u32 v24, v25, 1, v24
  s_and_b32 s21, s20, 31
  s_lshl_b32 s22, s21, 4
  s_lshr_b32 s23, s20, 5
  s_lshl_b32 s24, s23, 11
  s_add_u32 s22, s22, s24
  s_add_u32 s22, s22, 131072
  v_add_u32 v26, s22, v24
  s_and_b32 s22, s21, 7
  s_and_b32 s24, s21, 8
  s_lshl_b32 s24, s24, 1
  s_add_u32 s22, s22, s24
  s_and_b32 s24, s21, 16
  s_lshr_b32 s24, s24, 1
  s_add_u32 s22, s22, s24
  s_lshl_b32 s22, s22, 4
  v_add_u32 v24, s22, v24
  s_bfe_u32 s22, s21, 0x20002
  s_lshl_b32 s22, s22, 9
  s_add_u32 s22, s22, s24
  s_and_b32 s24, s21, 3
  s_lshl_b32 s24, s24, 1
  s_add_u32 s22, s22, s24
  s_add_u32 s22, s22, 2048
  v_lshl_add_u32 v25, v10, 4, s22
  v_cndmask_b32 v24, v24, v25, vcc
  v_cndmask_b32 v19, 8, v19, vcc
  v_add_u32 v25, v24, v19
  s_lshl_b32 s22, s18, 7
  s_lshl_b32 s24, s17, 2
  s_add_u32 s22, s22, s24
  s_add_u32 s22, s22, s23
  s_lshl_b32 s22, s22, 12
  s_add_u32 s22, s22, 0x1800000
  s_add_u32 s23, s22, 262144
  s_lshr_b32 s24, s20, 6
  s_lshl_b32 s24, s24, 8
  s_add_u32 s24, s24, s76
  v_cmp_eq_u32 vcc, 0, v11
  v_mov_b32 v27, 0.25503486164919736
  s_nop 0
  v_cndmask_b32 v27, 1.0, v27, vcc
  v_mul_f32 v21, v21, v27
  v_mul_f32 v22, v22, v27
  v_mul_f32 v23, v23, v27
  s_mov_b32 s62, 1
  s_mov_b32 s63, 0x1800000
  s_mov_b32 s70, 2
  s_mov_b32 s71, 155776
  v_mov_b32 v6, s71
  s_mov_b32 s38, 0
.g2_kernel_wg54:
  ds_read_b32 v7, v6 offset:56
  s_add_u32 s38, s38, 1
  s_waitcnt lgkmcnt(0)
  v_cmp_gt_u32 vcc, 2, v7
  s_cbranch_vccz .g2_kernel_wg54d
  s_sleep 1
  s_cmp_lt_u32 s38, 524288
  s_cbranch_scc1 .g2_kernel_wg54
.g2_kernel_wg54d:
  ds_read_b32 v32, v17 offset:5632
  ds_read_b32 v36, v16 offset:4864
  v_add_u32 v17, v17, v18
  ds_read_b32 v33, v17 offset:5632
  ds_read_b32 v37, v16 offset:4928
  v_add_u32 v17, v17, v18
  ds_read_b32 v34, v17 offset:5632
  ds_read_b32 v38, v16 offset:4992
  v_add_u32 v17, v17, v18
  ds_read_b32 v35, v17 offset:5632
  ds_read_b32 v39, v16 offset:5056
  s_waitcnt lgkmcnt(0)
  v_mul_f32 v32, v32, v22
  v_fmac_f32 v32, v64, v21
  v_fmac_f32 v32, v36, v23
  v_mul_f32 v33, v33, v22
  v_fmac_f32 v33, v65, v21
  v_fmac_f32 v33, v37, v23
  v_mul_f32 v34, v34, v22
  v_fmac_f32 v34, v66, v21
  v_fmac_f32 v34, v38, v23
  v_mul_f32 v35, v35, v22
  v_fmac_f32 v35, v67, v21
  v_fmac_f32 v35, v39, v23
  v_cvt_pk_bf16_f32 v32, v32, v33
  v_cvt_pk_bf16_f32 v34, v34, v35
  v_mov_b32 v9, s71
  v_mov_b32 v8, 2
  s_mov_b32 exec_lo, 0xffff0000
  s_mov_b32 exec_hi, 0xffff
  buffer_store_short v32, v24, s[4:7], s22 offen sc1
  buffer_store_short_d16_hi v32, v25, s[4:7], s22 offen sc1
  buffer_store_short v34, v24, s[4:7], s23 offen sc1
  buffer_store_short_d16_hi v34, v25, s[4:7], s23 offen sc1
  s_mov_b64 exec, 0xffff
  ds_write_b16 v26, v32 offset:8192
  ds_write_b16_d16_hi v26, v32 offset:8200
  ds_write_b16 v26, v34
  ds_write_b16_d16_hi v26, v34 offset:8
  ds_write_b32 v9, v5 offset:60
  s_mov_b32 exec_lo, 0
  s_mov_b32 exec_hi, 0xff0000
  ds_write_b32 v16, v192 offset:6912
  ds_write_b32 v16, v193 offset:6976
  ds_write_b32 v16, v194 offset:7040
  ds_write_b32 v16, v195 offset:7104
  ds_write_b32 v16, v196 offset:6944
  ds_write_b32 v16, v197 offset:7008
  ds_write_b32 v16, v198 offset:7072
  ds_write_b32 v16, v199 offset:7136
  s_mov_b64 exec, 1
  s_waitcnt vmcnt(0)
  buffer_store_dword v8, v4, s[4:7], s24 offen sc1
  buffer_store_dword v8, v4, s[4:7], s24 offen offset:128 sc1
  s_mov_b64 exec, -1
  s_branch .g2_kernel_v
.g2_kernel_c_no:
  s_mov_b32 s62, 1
  s_mov_b32 s63, 0x1800000
  s_mov_b32 s70, 2
  s_mov_b32 s71, 155776
  s_branch .g2_kernel_v
.g2_kernel_c_t3:
  s_lshr_b32 s33, s77, 7
  s_lshl_b32 s28, s33, 2
  s_lshl_b64 s[8:9], 15, s28
  s_lshl_b32 s21, s17, 10
  s_add_u32 s21, s21, 0x2880000
  v_lshlrev_b32 v14, 3, v2
  v_add_u32 v14, 155648, v14
  v_mov_b32 v9, s71
  s_cmp_eq_u32 s33, s17
  s_cbranch_scc0 .g2_kernel_c_u1
  s_sleep 6
  s_call_b64 s[72:73], .g2_kernel_c_ph2
  s_branch .g2_kernel_c_u2
.g2_kernel_c_u1:
  v_mov_b32 v6, s71
  s_mov_b32 s38, 0
.g2_kernel_wg55:
  ds_read_b32 v7, v6 offset:36
  s_add_u32 s38, s38, 1
  s_waitcnt lgkmcnt(0)
  v_cmp_gt_u32 vcc, 1, v7
  s_cbranch_vccz .g2_kernel_wg55d
  s_sleep 1
  s_cmp_lt_u32 s38, 524288
  s_cbranch_scc1 .g2_kernel_wg55
.g2_kernel_wg55d:
  ds_read_b32 v7, v6 offset:36
  ds_read_b32 v6, v6 offset:104
  s_waitcnt lgkmcnt(0)
  v_readfirstlane_b32 s77, v7
  v_readfirstlane_b32 s29, v6
  s_lshl_b32 s29, s29, 5
  s_add_u32 s77, s77, s29
  s_sub_u32 s77, s77, 1
.g2_kernel_c_u2:
  s_mov_b32 s38, 0
.g2_kernel_gx56:
  buffer_load_dwordx4 v[16:19], v3, s[4:7], s21 offen sc1
  s_add_u32 s38, s38, 1
  s_waitcnt vmcnt(0)
  v_min_u32 v6, v17, v19
  v_cmp_eq_u32 vcc, 0, v6
  s_cbranch_vccz .g2_kernel_gx56d
  s_mov_b64 exec, vcc
  s_cmp_lt_u32 s38, 131072
  s_cbranch_scc1 .g2_kernel_gx56
.g2_kernel_gx56d:
  s_mov_b64 exec, -1
  s_lshr_b32 s28, s77, 7
  s_and_b32 s79, s77, 127
  s_add_u32 s79, s79, 1
  s_cmp_eq_u32 s28, s17
  s_cselect_b32 s79, s79, 0
  v_rsq_f32 v22, v17
  v_rsq_f32 v23, v19
  v_mov_b32 v15, s79
  v_add_f32 v52, 1.0, v22
  v_mul_f32 v54, v16, v22
  v_sub_f32 v54, 0, v54
  v_add_f32 v53, 1.0, v23
  v_mul_f32 v55, v18, v23
  v_sub_f32 v55, 0, v55
  ds_write_b64 v14, v[52:53] offset:3840
  ds_write_b64 v14, v[54:55] offset:4352
  ds_write_b32 v9, v15 offset:32
  ds_write_b32 v9, v5 offset:28
  s_cmp_eq_u32 s33, s17
  s_cbranch_scc1 .g2_kernel_fin
  s_sleep 28
  s_mov_b32 s39, 1
  s_call_b64 s[72:73], .g2_kernel_c_ph2
  s_branch .g2_kernel_fin
.g2_kernel_c_ph2:
  s_call_b64 s[68:69], .g2_kernel_amax
  v_mov_b32 v6, s71
  s_mov_b32 s38, 0
.g2_kernel_wg57:
  ds_read_b32 v7, v6 offset:36
  s_add_u32 s38, s38, 1
  s_waitcnt lgkmcnt(0)
  v_cmp_gt_u32 vcc, 1, v7
  s_cbranch_vccz .g2_kernel_wg57d
  s_cmp_lt_u32 s38, 524288
  s_cbranch_scc1 .g2_kernel_wg57
.g2_kernel_wg57d:
  ds_read_b32 v8, v9 offset:96
  ds_read_b32 v7, v6 offset:36
  ds_read_b32 v6, v6 offset:104
  s_waitcnt lgkmcnt(0)
  v_readfirstlane_b32 s28, v7
  v_readfirstlane_b32 s29, v6
  s_lshl_b32 s29, s29, 5
  s_add_u32 s28, s28, s29
  s_sub_u32 s28, s28, 1
  s_add_u32 s29, s77, 2
  s_waitcnt lgkmcnt(0)
  v_cmp_gt_f32 vcc, s27, v8
  s_cmp_lg_u64 vcc, 0
  s_cselect_b32 s77, s77, s28
  s_cselect_b32 s29, s29, 1
  v_mov_b32 v10, s29
  v_mov_b32 v11, s27
  ds_write_b64 v9, v[10:11] offset:88
  s_setpc_b64 s[72:73]
.g2_kernel_c2:
  s_cmp_lg_u32 s62, 0
  s_cbranch_scc1 .g2_kernel_d_a
  s_cmp_lg_u32 s16, 7
  s_cbranch_scc1 .g2_kernel_d_a
  v_mov_b32 v6, s71
  s_mov_b32 s38, 0
.g2_kernel_wg60:
  ds_read_b32 v7, v6 offset:20
  s_add_u32 s38, s38, 1
  s_waitcnt lgkmcnt(0)
  v_cmp_gt_u32 vcc, 4, v7
  s_cbranch_vccz .g2_kernel_wg60d
  s_sleep 2
  s_cmp_lt_u32 s38, 524288
  s_cbranch_scc1 .g2_kernel_wg60
.g2_kernel_wg60d:
  s_sleep 20
  s_and_b32 s31, s19, 0xffffe000
  s_add_u32 s31, s31, 8
  v_and_b32 v6, 15, v2
  v_lshlrev_b32 v6, 9, v6
  v_lshrrev_b32 v7, 4, v2
  v_lshl_add_u32 v6, v7, 7, v6
  v_lshlrev_b32 v7, 2, v2
  v_add_u32 v7, 158208, v7
  s_mov_b32 m0, 158208
  s_mov_b32 s38, 0
.g2_kernel_pa61:
  buffer_load_dword v6, s[4:7], s31 offen sc1 lds
  s_add_u32 s38, s38, 1
  s_waitcnt vmcnt(0)
  ds_read_b32 v8, v7
  s_waitcnt lgkmcnt(0)
  v_cmp_ge_u32 vcc, s62, v8
  s_cbranch_vccz .g2_kernel_pa61d
  s_mov_b64 exec, vcc
  s_sleep 10
  s_cmp_lt_u32 s38, 131072
  s_cbranch_scc1 .g2_kernel_pa61
.g2_kernel_pa61d:
  s_mov_b64 exec, -1
.g2_kernel_d_a:
  s_setprio 2
  s_and_b32 s20, s16, 1
  v_bfe_u32 v8, v2, 1, 3
  v_lshlrev_b32 v8, 14, v8
  v_and_b32 v9, 1, v2
  v_lshl_add_u32 v8, v9, 10, v8
  v_lshrrev_b32 v9, 4, v2
  v_lshl_add_u32 v8, v9, 8, v8
  v_and_b32 v9, 15, v2
  v_lshlrev_b32 v9, 4, v9
  s_lshl_b32 s28, s20, 8
  s_add_u32 s28, s28, 156672
  v_add_u32 v10, s28, v9
  v_xor_b32 v11, 256, v10
  s_lshl_b32 s28, s20, 2
  s_add_u32 s28, s28, s71
  v_mov_b32 v12, s28
  v_xor_b32 v13, 4, v12
  s_lshl_b32 s26, s17, 4
  s_add_u32 s26, s26, s18
  s_lshl_b32 s26, s26, 1
  s_add_u32 s26, s26, s20
  s_lshl_b32 s26, s26, 11
  s_add_u32 s26, s26, s63
  s_add_u32 s26, s26, 0x1090000
  s_mov_b32 s32, 0
  s_mov_b32 s39, 0
  s_lshl_b32 s28, s62, 3
  s_add_u32 s28, s28, s16
  s_cmp_lg_u32 s28, 14
  s_cbranch_scc1 .g2_kernel_d_w
  s_lshr_b32 s33, s77, 7
  s_lshl_b32 s28, s33, 2
  s_lshl_b64 s[8:9], 15, s28
  s_not_b64 s[8:9], s[8:9]
  s_and_b32 s28, s2, 7
  s_lshl_b32 s28, s28, 13
  s_add_u32 s23, s28, 0x3050000
  s_cmp_eq_u32 s33, s17
  s_cbranch_scc1 .g2_kernel_d_v
  v_mov_b32 v6, s71
  s_mov_b32 s38, 0
.g2_kernel_wg62:
  ds_read_b32 v7, v6 offset:20
  s_add_u32 s38, s38, 1
  s_waitcnt lgkmcnt(0)
  v_cmp_gt_u32 vcc, 4, v7
  s_cbranch_vccz .g2_kernel_wg62d
  s_sleep 1
  s_cmp_lt_u32 s38, 524288
  s_cbranch_scc1 .g2_kernel_wg62
.g2_kernel_wg62d:
.g2_kernel_d_v:
  s_sleep 60
  s_call_b64 s[68:69], .g2_kernel_amax
  s_add_u32 s28, s77, 1
  v_mov_b32 v6, s27
  v_mov_b32 v7, s28
  ds_write_b32 v12, v6 offset:96
  ds_write_b32 v12, v7 offset:36
  s_waitcnt lgkmcnt(0)
  s_wakeup
  s_branch .g2_kernel_d_r
.g2_kernel_d_w:
  v_mov_b32 v6, s71
  s_mov_b32 s38, 0
.g2_kernel_wg63:
  ds_read_b32 v7, v6 offset:36
  s_add_u32 s38, s38, 1
  s_waitcnt lgkmcnt(0)
  v_cmp_gt_u32 vcc, 1, v7
  s_cbranch_vccz .g2_kernel_wg63d
  s_sleep 4
  s_cmp_lt_u32 s38, 524288
  s_cbranch_scc1 .g2_kernel_wg63
.g2_kernel_wg63d:
  ds_read_b32 v7, v6 offset:36
  ds_read_b32 v6, v6 offset:104
  s_waitcnt lgkmcnt(0)
  v_readfirstlane_b32 s77, v7
  v_readfirstlane_b32 s29, v6
  s_lshl_b32 s29, s29, 5
  s_add_u32 s77, s77, s29
  s_sub_u32 s77, s77, 1
.g2_kernel_d_r:
  s_and_b32 s77, s77, 2047
  s_lshr_b32 s24, s77, 7
  s_lshl_b32 s24, s24, 18
  s_bfe_u32 s28, s77, 0x30004
  s_lshl_b32 s28, s28, 11
  s_add_u32 s24, s24, s28
  s_and_b32 s28, s77, 15
  s_lshl_b32 s28, s28, 4
  s_add_u32 s24, s24, s28
  s_add_u32 s24, s24, s63
  s_add_u32 s24, s24, 0xc00000
  s_lshl_b32 s28, s17, 14
  s_add_u32 s21, s24, s28
  s_and_b32 s28, s18, 8
  s_lshl_b32 s28, s28, 5
  s_add_u32 s21, s21, s28
  s_and_b32 s28, s18, 7
  s_lshl_b32 s28, s28, 1
  s_add_u32 s21, s21, s28
  s_lshl_b32 s28, s20, 17
  s_add_u32 s24, s24, s28
  buffer_load_dwordx4 v[16:19], v8, s[4:7], s24 offen
  buffer_load_ushort v56, v4, s[4:7], s21 offen
  buffer_load_ushort v57, v4, s[4:7], s21 offen offset:512
  buffer_load_ushort v58, v4, s[4:7], s21 offen offset:1024
  buffer_load_ushort v59, v4, s[4:7], s21 offen offset:1536
  s_lshl_b32 s25, s77, 3
  s_add_u32 s25, s25, s63
  s_add_u32 s25, s25, 0x1080000
  s_mov_b32 s38, 0
.g2_kernel_gx64:
  buffer_load_dwordx2 v[20:21], v4, s[4:7], s25 offen sc1
  s_add_u32 s38, s38, 1
  s_waitcnt vmcnt(0)
  v_min_u32 v6, v21, v21
  v_cmp_eq_u32 vcc, 0, v6
  s_cbranch_vccz .g2_kernel_gx64d
  s_mov_b64 exec, vcc
  s_sleep 1
  s_cmp_lt_u32 s38, 131072
  s_cbranch_scc1 .g2_kernel_gx64
.g2_kernel_gx64d:
  s_mov_b64 exec, -1
  v_rsq_f32 v21, v21
  v_lshlrev_b32 v24, 16, v16
  v_and_b32 v25, 0xffff0000, v16
  v_lshlrev_b32 v26, 16, v17
  v_and_b32 v27, 0xffff0000, v17
  v_lshlrev_b32 v28, 16, v18
  v_and_b32 v29, 0xffff0000, v18
  v_lshlrev_b32 v30, 16, v19
  v_and_b32 v31, 0xffff0000, v19
  v_mul_f32 v20, v20, v21
  v_mov_b32 v60, v20
  v_add_f32 v61, 1.0, v21
  s_cmp_ge_u32 s17, 14
  s_cbranch_scc1 .g2_kernel_d_none
  v_fma_f32 v24, v24, v21, -v20
  v_fma_f32 v25, v25, v21, -v20
  v_fma_f32 v26, v26, v21, -v20
  v_fma_f32 v27, v27, v21, -v20
  v_fma_f32 v28, v28, v21, -v20
  v_fma_f32 v29, v29, v21, -v20
  v_fma_f32 v30, v30, v21, -v20
  v_fma_f32 v31, v31, v21, -v20
  v_cvt_pk_bf16_f32 v16, v24, v25
  v_cvt_pk_bf16_f32 v17, v26, v27
  v_cvt_pk_bf16_f32 v18, v28, v29
  v_cvt_pk_bf16_f32 v19, v30, v31
  v_mov_b32 v24, v16 row_newbcast:0 row_mask:0xf bank_mask:0xf
  v_mov_b32 v25, v17 row_newbcast:0 row_mask:0xf bank_mask:0xf
  v_mov_b32 v26, v18 row_newbcast:0 row_mask:0xf bank_mask:0xf
  v_mov_b32 v27, v19 row_newbcast:0 row_mask:0xf bank_mask:0xf
  v_mov_b32 v28, v16 row_newbcast:1 row_mask:0xf bank_mask:0xf
  v_mov_b32 v29, v17 row_newbcast:1 row_mask:0xf bank_mask:0xf
  v_mov_b32 v30, v18 row_newbcast:1 row_mask:0xf bank_mask:0xf
  v_mov_b32 v31, v19 row_newbcast:1 row_mask:0xf bank_mask:0xf
  v_mfma_f32_16x16x32_bf16 v[32:35], v[24:27], v[64:67], 0
  v_mfma_f32_16x16x32_bf16 v[36:39], v[24:27], v[128:131], 0
  v_mov_b32 v24, v16 row_newbcast:2 row_mask:0xf bank_mask:0xf
  v_mov_b32 v25, v17 row_newbcast:2 row_mask:0xf bank_mask:0xf
  v_mov_b32 v26, v18 row_newbcast:2 row_mask:0xf bank_mask:0xf
  v_mov_b32 v27, v19 row_newbcast:2 row_mask:0xf bank_mask:0xf
  v_mfma_f32_16x16x32_bf16 v[32:35], v[28:31], v[68:71], v[32:35]
  v_mfma_f32_16x16x32_bf16 v[36:39], v[28:31], v[132:135], v[36:39]
  v_mov_b32 v28, v16 row_newbcast:3 row_mask:0xf bank_mask:0xf
  v_mov_b32 v29, v17 row_newbcast:3 row_mask:0xf bank_mask:0xf
  v_mov_b32 v30, v18 row_newbcast:3 row_mask:0xf bank_mask:0xf
  v_mov_b32 v31, v19 row_newbcast:3 row_mask:0xf bank_mask:0xf
  v_mfma_f32_16x16x32_bf16 v[32:35], v[24:27], v[72:75], v[32:35]
  v_mfma_f32_16x16x32_bf16 v[36:39], v[24:27], v[136:139], v[36:39]
  v_mov_b32 v24, v16 row_newbcast:4 row_mask:0xf bank_mask:0xf
  v_mov_b32 v25, v17 row_newbcast:4 row_mask:0xf bank_mask:0xf
  v_mov_b32 v26, v18 row_newbcast:4 row_mask:0xf bank_mask:0xf
  v_mov_b32 v27, v19 row_newbcast:4 row_mask:0xf bank_mask:0xf
  v_mfma_f32_16x16x32_bf16 v[32:35], v[28:31], v[76:79], v[32:35]
  v_mfma_f32_16x16x32_bf16 v[36:39], v[28:31], v[140:143], v[36:39]
  v_mov_b32 v28, v16 row_newbcast:5 row_mask:0xf bank_mask:0xf
  v_mov_b32 v29, v17 row_newbcast:5 row_mask:0xf bank_mask:0xf
  v_mov_b32 v30, v18 row_newbcast:5 row_mask:0xf bank_mask:0xf
  v_mov_b32 v31, v19 row_newbcast:5 row_mask:0xf bank_mask:0xf
  v_mfma_f32_16x16x32_bf16 v[32:35], v[24:27], v[80:83], v[32:35]
  v_mfma_f32_16x16x32_bf16 v[36:39], v[24:27], v[144:147], v[36:39]
  v_mov_b32 v24, v16 row_newbcast:6 row_mask:0xf bank_mask:0xf
  v_mov_b32 v25, v17 row_newbcast:6 row_mask:0xf bank_mask:0xf
  v_mov_b32 v26, v18 row_newbcast:6 row_mask:0xf bank_mask:0xf
  v_mov_b32 v27, v19 row_newbcast:6 row_mask:0xf bank_mask:0xf
  v_mfma_f32_16x16x32_bf16 v[32:35], v[28:31], v[84:87], v[32:35]
  v_mfma_f32_16x16x32_bf16 v[36:39], v[28:31], v[148:151], v[36:39]
  v_mov_b32 v28, v16 row_newbcast:7 row_mask:0xf bank_mask:0xf
  v_mov_b32 v29, v17 row_newbcast:7 row_mask:0xf bank_mask:0xf
  v_mov_b32 v30, v18 row_newbcast:7 row_mask:0xf bank_mask:0xf
  v_mov_b32 v31, v19 row_newbcast:7 row_mask:0xf bank_mask:0xf
  v_mfma_f32_16x16x32_bf16 v[32:35], v[24:27], v[88:91], v[32:35]
  v_mfma_f32_16x16x32_bf16 v[36:39], v[24:27], v[152:155], v[36:39]
  v_mov_b32 v24, v16 row_newbcast:8 row_mask:0xf bank_mask:0xf
  v_mov_b32 v25, v17 row_newbcast:8 row_mask:0xf bank_mask:0xf
  v_mov_b32 v26, v18 row_newbcast:8 row_mask:0xf bank_mask:0xf
  v_mov_b32 v27, v19 row_newbcast:8 row_mask:0xf bank_mask:0xf
  v_mfma_f32_16x16x32_bf16 v[32:35], v[28:31], v[92:95], v[32:35]
  v_mfma_f32_16x16x32_bf16 v[36:39], v[28:31], v[156:159], v[36:39]
  v_mov_b32 v28, v16 row_newbcast:9 row_mask:0xf bank_mask:0xf
  v_mov_b32 v29, v17 row_newbcast:9 row_mask:0xf bank_mask:0xf
  v_mov_b32 v30, v18 row_newbcast:9 row_mask:0xf bank_mask:0xf
  v_mov_b32 v31, v19 row_newbcast:9 row_mask:0xf bank_mask:0xf
  v_mfma_f32_16x16x32_bf16 v[32:35], v[24:27], v[96:99], v[32:35]
  v_mfma_f32_16x16x32_bf16 v[36:39], v[24:27], v[160:163], v[36:39]
  v_mov_b32 v24, v16 row_newbcast:10 row_mask:0xf bank_mask:0xf
  v_mov_b32 v25, v17 row_newbcast:10 row_mask:0xf bank_mask:0xf
  v_mov_b32 v26, v18 row_newbcast:10 row_mask:0xf bank_mask:0xf
  v_mov_b32 v27, v19 row_newbcast:10 row_mask:0xf bank_mask:0xf
  v_mfma_f32_16x16x32_bf16 v[32:35], v[28:31], v[100:103], v[32:35]
  v_mfma_f32_16x16x32_bf16 v[36:39], v[28:31], v[164:167], v[36:39]
  v_mov_b32 v28, v16 row_newbcast:11 row_mask:0xf bank_mask:0xf
  v_mov_b32 v29, v17 row_newbcast:11 row_mask:0xf bank_mask:0xf
  v_mov_b32 v30, v18 row_newbcast:11 row_mask:0xf bank_mask:0xf
  v_mov_b32 v31, v19 row_newbcast:11 row_mask:0xf bank_mask:0xf
  v_mfma_f32_16x16x32_bf16 v[32:35], v[24:27], v[104:107], v[32:35]
  v_mfma_f32_16x16x32_bf16 v[36:39], v[24:27], v[168:171], v[36:39]
  v_mov_b32 v24, v16 row_newbcast:12 row_mask:0xf bank_mask:0xf
  v_mov_b32 v25, v17 row_newbcast:12 row_mask:0xf bank_mask:0xf
  v_mov_b32 v26, v18 row_newbcast:12 row_mask:0xf bank_mask:0xf
  v_mov_b32 v27, v19 row_newbcast:12 row_mask:0xf bank_mask:0xf
  v_mfma_f32_16x16x32_bf16 v[32:35], v[28:31], v[108:111], v[32:35]
  v_mfma_f32_16x16x32_bf16 v[36:39], v[28:31], v[172:175], v[36:39]
  v_mov_b32 v28, v16 row_newbcast:13 row_mask:0xf bank_mask:0xf
  v_mov_b32 v29, v17 row_newbcast:13 row_mask:0xf bank_mask:0xf
  v_mov_b32 v30, v18 row_newbcast:13 row_mask:0xf bank_mask:0xf
  v_mov_b32 v31, v19 row_newbcast:13 row_mask:0xf bank_mask:0xf
  v_mfma_f32_16x16x32_bf16 v[32:35], v[24:27], v[112:115], v[32:35]
  v_mfma_f32_16x16x32_bf16 v[36:39], v[24:27], v[176:179], v[36:39]
  v_mov_b32 v24, v16 row_newbcast:14 row_mask:0xf bank_mask:0xf
  v_mov_b32 v25, v17 row_newbcast:14 row_mask:0xf bank_mask:0xf
  v_mov_b32 v26, v18 row_newbcast:14 row_mask:0xf bank_mask:0xf
  v_mov_b32 v27, v19 row_newbcast:14 row_mask:0xf bank_mask:0xf
  v_mfma_f32_16x16x32_bf16 v[32:35], v[28:31], v[116:119], v[32:35]
  v_mfma_f32_16x16x32_bf16 v[36:39], v[28:31], v[180:183], v[36:39]
  v_mov_b32 v28, v16 row_newbcast:15 row_mask:0xf bank_mask:0xf
  v_mov_b32 v29, v17 row_newbcast:15 row_mask:0xf bank_mask:0xf
  v_mov_b32 v30, v18 row_newbcast:15 row_mask:0xf bank_mask:0xf
  v_mov_b32 v31, v19 row_newbcast:15 row_mask:0xf bank_mask:0xf
  v_mfma_f32_16x16x32_bf16 v[32:35], v[24:27], v[120:123], v[32:35]
  v_mfma_f32_16x16x32_bf16 v[36:39], v[24:27], v[184:187], v[36:39]
  v_mfma_f32_16x16x32_bf16 v[32:35], v[28:31], v[124:127], v[32:35]
  v_mfma_f32_16x16x32_bf16 v[36:39], v[28:31], v[188:191], v[36:39]
  s_mov_b32 s38, 0
  s_add_u32 s36, s32, s62
  s_add_u32 s28, s36, 1
  v_mov_b32 v18, s28
  s_mov_b32 s28, 0x00010001
  s_mov_b32 s29, 0x00100010
  s_nop 0
  v_and_or_b32 v14, v32, -4, v18
  v_and_or_b32 v15, v36, -4, v18
  ds_write_b64 v10, v[14:15]
.g2_kernel_d_x:
  ds_read_b64 v[16:17], v11
  s_add_u32 s38, s38, 1
  s_waitcnt lgkmcnt(0)
  v_and_b32 v18, 3, v16
  v_and_b32 v19, 3, v17
  v_min_u32 v18, v18, v19
  v_cmp_ge_u32 vcc, s36, v18
  s_cbranch_vccz .g2_kernel_d_xd
  s_cmp_lt_u32 s38, 524288
  s_cbranch_scc1 .g2_kernel_d_x
.g2_kernel_d_xd:
  v_add_f32 v16, v16, v14
  v_add_f32 v17, v17, v15
  v_mul_f32 v18, -1.4426950408889634, v16
  v_exp_f32 v18, v18
  v_mul_f32 v16, v16, v17
  v_add_f32 v18, 1.0, v18
  v_rcp_f32 v18, v18
  s_nop 0
  v_mul_f32 v16, v16, v18
  s_nop 1
  v_mov_b32 v17, v16 quad_perm:[1,0,3,2] row_mask:0xf bank_mask:0xf
  v_cvt_pk_bf16_f32 v16, v16, v17
  s_nop 1
  v_mov_b32 v20, v16 row_newbcast:0 row_mask:0x5 bank_mask:0xf
  v_mov_b32 v21, v16 row_newbcast:2 row_mask:0x5 bank_mask:0xf
  v_mov_b32 v22, v16 row_newbcast:4 row_mask:0x5 bank_mask:0xf
  v_mov_b32 v23, v16 row_newbcast:6 row_mask:0x5 bank_mask:0xf
  v_mov_b32 v20, v16 row_newbcast:8 row_mask:0xa bank_mask:0xf
  v_mov_b32 v21, v16 row_newbcast:10 row_mask:0xa bank_mask:0xf
  v_mov_b32 v22, v16 row_newbcast:12 row_mask:0xa bank_mask:0xf
  v_mov_b32 v23, v16 row_newbcast:14 row_mask:0xa bank_mask:0xf
  v_cndmask_b32 v24, 0, v20, s[28:29]
  v_cndmask_b32 v25, 0, v21, s[28:29]
  v_cndmask_b32 v26, 0, v22, s[28:29]
  v_cndmask_b32 v27, 0, v23, s[28:29]
  s_lshl_b64 s[28:29], s[28:29], 1
  s_nop 0
  v_mfma_f32_16x16x32_bf16 v[40:43], v[24:27], v[192:195], 0
  v_mfma_f32_16x16x32_bf16 v[44:47], v[24:27], v[208:211], 0
  v_mfma_f32_16x16x32_bf16 v[48:51], v[24:27], v[224:227], 0
  v_mfma_f32_16x16x32_bf16 v[52:55], v[24:27], v[240:243], 0
  v_cndmask_b32 v28, 0, v20, s[28:29]
  v_cndmask_b32 v29, 0, v21, s[28:29]
  v_cndmask_b32 v30, 0, v22, s[28:29]
  v_cndmask_b32 v31, 0, v23, s[28:29]
  s_lshl_b64 s[28:29], s[28:29], 1
  s_nop 0
  v_mfma_f32_16x16x32_bf16 v[40:43], v[28:31], v[196:199], v[40:43]
  v_mfma_f32_16x16x32_bf16 v[44:47], v[28:31], v[212:215], v[44:47]
  v_mfma_f32_16x16x32_bf16 v[48:51], v[28:31], v[228:231], v[48:51]
  v_mfma_f32_16x16x32_bf16 v[52:55], v[28:31], v[244:247], v[52:55]
  v_cndmask_b32 v32, 0, v20, s[28:29]
  v_cndmask_b32 v33, 0, v21, s[28:29]
  v_cndmask_b32 v34, 0, v22, s[28:29]
  v_cndmask_b32 v35, 0, v23, s[28:29]
  s_lshl_b64 s[28:29], s[28:29], 1
  s_nop 0
  v_mfma_f32_16x16x32_bf16 v[40:43], v[32:35], v[200:203], v[40:43]
  v_mfma_f32_16x16x32_bf16 v[44:47], v[32:35], v[216:219], v[44:47]
  v_mfma_f32_16x16x32_bf16 v[48:51], v[32:35], v[232:235], v[48:51]
  v_mfma_f32_16x16x32_bf16 v[52:55], v[32:35], v[248:251], v[52:55]
  v_cndmask_b32 v36, 0, v20, s[28:29]
  v_cndmask_b32 v37, 0, v21, s[28:29]
  v_cndmask_b32 v38, 0, v22, s[28:29]
  v_cndmask_b32 v39, 0, v23, s[28:29]
  s_lshl_b64 s[28:29], s[28:29], 1
  s_nop 0
  v_mfma_f32_16x16x32_bf16 v[40:43], v[36:39], v[204:207], v[40:43]
  v_mfma_f32_16x16x32_bf16 v[44:47], v[36:39], v[220:223], v[44:47]
  v_mfma_f32_16x16x32_bf16 v[48:51], v[36:39], v[236:239], v[48:51]
  v_mfma_f32_16x16x32_bf16 v[52:55], v[36:39], v[252:255], v[52:55]
  s_mov_b32 exec_hi, 0
  s_nop 3
  v_or_b32 v40, 1, v40
  v_or_b32 v42, 1, v42
  buffer_store_dwordx4 v[40:43], v3, s[4:7], s26 offen offset:0 sc1
  v_or_b32 v44, 1, v44
  v_or_b32 v46, 1, v46
  buffer_store_dwordx4 v[44:47], v3, s[4:7], s26 offen offset:512 sc1
  v_or_b32 v48, 1, v48
  v_or_b32 v50, 1, v50
  buffer_store_dwordx4 v[48:51], v3, s[4:7], s26 offen offset:1024 sc1
  v_or_b32 v52, 1, v52
  v_or_b32 v54, 1, v54
  buffer_store_dwordx4 v[52:55], v3, s[4:7], s26 offen offset:1536 sc1
  s_mov_b64 exec, -1
  s_branch .g2_kernel_d_e
.g2_kernel_d_none:
  s_sleep 24
.g2_kernel_d_e:
  s_add_u32 m0, s71, 112
  s_mov_b32 s29, .g2_kernel_tab-.g2_kernel_pc+4
  s_mov_b64 exec, 1
  buffer_load_dword off, s[64:67], s29 lds
  s_mov_b64 exec, -1
  s_cmp_lg_u32 s62, 0
  s_cbranch_scc1 .g2_kernel_d_t
  s_mov_b32 s62, 1
  s_mov_b32 s63, 0x1800000
  s_mov_b32 s70, 2
  s_mov_b32 s71, 155776
  s_branch .g2_kernel_v
.g2_kernel_d_t:
  s_cmp_lg_u32 s20, 0
  s_cbranch_scc1 .g2_kernel_d_t1
  v_mov_b32 v62, -1.4426950408889634
  v_mul_f32 v62, s27, v62
  v_exp_f32 v62, v62
  v_lshlrev_b32 v14, 12, v2
  v_min_u32 v15, 126976, v14
  s_lshl_b32 s21, s17, 4
  s_add_u32 s21, s21, s18
  s_lshl_b32 s21, s21, 4
  s_mul_i32 s22, s32, 0x270000
  s_add_u32 s21, s21, s22
  s_add_u32 s21, s21, 0x2890000
  s_add_u32 s22, s21, 262144
  s_add_u32 s24, s21, 524288
  s_add_u32 s25, s21, 786432
  v_add_f32 v62, 1.0, v62
  v_rcp_f32 v62, v62
  v_lshlrev_b32 v56, 16, v56
  v_fma_f32 v56, v56, v61, -v60
  v_lshlrev_b32 v57, 16, v57
  v_fma_f32 v57, v57, v61, -v60
  v_lshlrev_b32 v58, 16, v58
  v_fma_f32 v58, v58, v61, -v60
  v_lshlrev_b32 v59, 16, v59
  v_fma_f32 v59, v59, v61, -v60
  s_sleep 8
  s_mov_b32 s38, 0
.g2_kernel_gx65:
  buffer_load_dwordx4 v[16:19], v14, s[4:7], s21 offen sc1
  buffer_load_dwordx4 v[20:23], v14, s[4:7], s22 offen sc1
  buffer_load_dwordx4 v[24:27], v14, s[4:7], s24 offen sc1
  buffer_load_dwordx4 v[28:31], v15, s[4:7], s25 offen sc1
  s_add_u32 s38, s38, 1
  s_waitcnt vmcnt(0)
  v_min3_u32 v6, v16, v18, v20
  v_min3_u32 v6, v6, v22, v24
  v_min3_u32 v6, v6, v26, v28
  v_min_u32 v6, v6, v30
  v_cmp_eq_u32 vcc, 0, v6
  s_cbranch_vccz .g2_kernel_gx65d
  s_mov_b64 exec, vcc
  s_cmp_lt_u32 s38, 131072
  s_cbranch_scc1 .g2_kernel_gx65
.g2_kernel_gx65d:
  s_mov_b64 exec, -1
  v_add_f32 v16, v16, v20
  v_add_f32 v17, v17, v21
  v_add_f32 v18, v18, v22
  v_add_f32 v19, v19, v23
  s_mov_b32 exec_hi, 0
  v_add_f32 v24, v24, v28
  v_add_f32 v25, v25, v29
  v_add_f32 v26, v26, v30
  v_add_f32 v27, v27, v31
  s_mov_b64 exec, -1
  v_add_f32 v16, v16, v24
  v_add_f32 v17, v17, v25
  v_add_f32 v18, v18, v26
  v_add_f32 v19, v19, v27
  v_add_f32 v16, v16, v16 row_ror:8 row_mask:0xf bank_mask:0xf
  v_add_f32 v17, v17, v17 row_ror:8 row_mask:0xf bank_mask:0xf
  v_add_f32 v18, v18, v18 row_ror:8 row_mask:0xf bank_mask:0xf
  v_add_f32 v19, v19, v19 row_ror:8 row_mask:0xf bank_mask:0xf
  v_add_f32 v16, v16, v16 row_ror:4 row_mask:0xf bank_mask:0xf
  v_add_f32 v17, v17, v17 row_ror:4 row_mask:0xf bank_mask:0xf
  v_add_f32 v18, v18, v18 row_ror:4 row_mask:0xf bank_mask:0xf
  v_add_f32 v19, v19, v19 row_ror:4 row_mask:0xf bank_mask:0xf
  v_add_f32 v16, v16, v16 row_ror:2 row_mask:0xf bank_mask:0xf
  v_add_f32 v17, v17, v17 row_ror:2 row_mask:0xf bank_mask:0xf
  v_add_f32 v18, v18, v18 row_ror:2 row_mask:0xf bank_mask:0xf
  v_add_f32 v19, v19, v19 row_ror:2 row_mask:0xf bank_mask:0xf
  v_add_f32 v16, v16, v16 row_ror:1 row_mask:0xf bank_mask:0xf
  v_add_f32 v17, v17, v17 row_ror:1 row_mask:0xf bank_mask:0xf
  v_add_f32 v18, v18, v18 row_ror:1 row_mask:0xf bank_mask:0xf
  v_add_f32 v19, v19, v19 row_ror:1 row_mask:0xf bank_mask:0xf
  v_add_f32 v16, v16, v16 row_bcast:15 row_mask:0xa bank_mask:0xf
  v_add_f32 v17, v17, v17 row_bcast:15 row_mask:0xa bank_mask:0xf
  v_add_f32 v18, v18, v18 row_bcast:15 row_mask:0xa bank_mask:0xf
  v_add_f32 v19, v19, v19 row_bcast:15 row_mask:0xa bank_mask:0xf
  v_add_f32 v16, v16, v16 row_bcast:31 row_mask:0xc bank_mask:0xf
  v_add_f32 v17, v17, v17 row_bcast:31 row_mask:0xc bank_mask:0xf
  v_add_f32 v18, v18, v18 row_bcast:31 row_mask:0xc bank_mask:0xf
  v_add_f32 v19, v19, v19 row_bcast:31 row_mask:0xc bank_mask:0xf
  s_lshl_b32 s24, s77, 11
  s_lshl_b32 s25, s17, 7
  s_add_u32 s24, s24, s25
  s_lshl_b32 s25, s18, 1
  s_add_u32 s24, s24, s25
.g2_kernel_d_t1:
  v_mov_b32 v6, s71
  s_mov_b32 s38, 0
.g2_kernel_wg66:
  ds_read_b32 v7, v6 offset:88
  s_add_u32 s38, s38, 1
  s_waitcnt lgkmcnt(0)
  v_cmp_gt_u32 vcc, 1, v7
  s_cbranch_vccz .g2_kernel_wg66d
  s_cmp_lt_u32 s38, 524288
  s_cbranch_scc1 .g2_kernel_wg66
.g2_kernel_wg66d:
  ds_read_b32 v6, v6 offset:92
  v_readfirstlane_b32 s33, v7
  s_cmp_lg_u32 s32, 0
  s_cselect_b32 s33, 1, s33
  s_cmp_lg_u32 s20, 0
  s_cbranch_scc1 .g2_kernel_d_t2
  s_cmp_lg_u32 s33, 1
  s_cbranch_scc1 .g2_kernel_d_t4
  v_fmac_f32 v56, v16, v62
  v_fmac_f32 v57, v17, v62
  v_fmac_f32 v58, v18, v62
  v_fmac_f32 v59, v19, v62
.g2_kernel_d_t4:
  s_mov_b32 s28, s56
  s_mov_b32 s29, s57
  s_mov_b32 s30, 0x400000
  s_mov_b32 s31, 0x00020000
  v_cvt_pk_bf16_f32 v56, v56, v57
  v_cvt_pk_bf16_f32 v58, v58, v59
  s_mov_b32 exec_lo, 0
  s_mov_b32 exec_hi, 0x80000000
  buffer_store_short v56, v4, s[28:31], s24 offen
  buffer_store_short_d16_hi v56, v4, s[28:31], s24 offen offset:32
  buffer_store_short v58, v4, s[28:31], s24 offen offset:64
  buffer_store_short_d16_hi v58, v4, s[28:31], s24 offen offset:96
  s_mov_b64 exec, -1
.g2_kernel_d_t2:
  s_cmp_eq_u32 s33, 1
  s_cbranch_scc1 .g2_kernel_fin
  s_waitcnt vmcnt(0) lgkmcnt(0)
  v_readfirstlane_b32 s27, v6
  s_sub_u32 s77, s33, 2
  s_mov_b32 s32, 1
  s_add_u32 s26, s26, 0x270000
  s_branch .g2_kernel_d_r
.g2_kernel_fin1:
.g2_kernel_fin:
.g2_kernel_end:
  s_endpgm
.g2_kernel_q_i2:
  v_mov_b32 v6, 155648
  s_mov_b32 s38, 0
.g2_kernel_wg1:
  ds_read_b32 v7, v6 offset:20
  s_add_u32 s38, s38, 1
  s_waitcnt lgkmcnt(0)
  v_cmp_gt_u32 vcc, 4, v7
  s_cbranch_vccz .g2_kernel_wg1d
  s_cmp_lt_u32 s38, 524288
  s_cbranch_scc1 .g2_kernel_wg1
.g2_kernel_wg1d:
  s_branch .g2_kernel_q_i3
.g2_kernel_q_spin:
  s_mov_b32 s38, 0
.g2_kernel_q_spinl:
  ds_read_b32 v151, v150
  s_add_u32 s38, s38, 1
  s_waitcnt lgkmcnt(0)
  v_cmp_lt_i32 vcc, s33, v151
  s_cbranch_vccnz .g2_kernel_q_spinr
  s_cmp_lt_u32 s38, 524288
  s_cbranch_scc1 .g2_kernel_q_spinl
.g2_kernel_q_spinr:
  s_setpc_b64 s[68:69]
.g2_kernel_q_wf:
  s_call_b64 s[68:69], .g2_kernel_q_spin
  s_branch .g2_kernel_q_backf
.g2_kernel_q_w7:
  s_call_b64 s[68:69], .g2_kernel_q_spin
  s_branch .g2_kernel_q_back7
.g2_kernel_q_w0:
  s_call_b64 s[68:69], .g2_kernel_q_spin
  s_branch .g2_kernel_q_back0
.g2_kernel_q_w1:
  s_call_b64 s[68:69], .g2_kernel_q_spin
  s_branch .g2_kernel_q_back1
.g2_kernel_q_w2:
  s_call_b64 s[68:69], .g2_kernel_q_spin
  s_branch .g2_kernel_q_back2
.g2_kernel_q_w3:
  s_call_b64 s[68:69], .g2_kernel_q_spin
  s_branch .g2_kernel_q_back3
.g2_kernel_q_w4:
  s_call_b64 s[68:69], .g2_kernel_q_spin
  s_branch .g2_kernel_q_back4
.g2_kernel_q_w5:
  s_call_b64 s[68:69], .g2_kernel_q_spin
  s_branch .g2_kernel_q_back5
.g2_kernel_q_w6:
  s_call_b64 s[68:69], .g2_kernel_q_spin
  s_branch .g2_kernel_q_back6
.g2_kernel_q_cons2:
  s_lshr_b32 s26, s16, 1
  s_lshl_b32 s26, s26, 13
  v_add_u32 v144, s26, v3
  v_add_u32 v145, 1024, v144
  s_branch .g2_kernel_q_cs
.g2_kernel_q_wl:
  s_call_b64 s[68:69], .g2_kernel_q_spin
  s_branch .g2_kernel_q_bl
.g2_kernel_q_v0ew:
  v_mov_b32 v6, s71
  s_mov_b32 s38, 0
.g2_kernel_wg2:
  ds_read_b32 v7, v6 offset:0
  s_add_u32 s38, s38, 1
  s_waitcnt lgkmcnt(0)
  v_cmp_gt_u32 vcc, 2, v7
  s_cbranch_vccz .g2_kernel_wg2d
  s_cmp_lt_u32 s38, 524288
  s_cbranch_scc1 .g2_kernel_wg2
.g2_kernel_wg2d:
  ds_read_b32 v57, v13 offset:24
  ds_read_b128 v[40:43], v52 offset:5120
  ds_read_b128 v[44:47], v52 offset:5184
  ds_read_b32 v24, v50 offset:2816
  ds_read_b32 v25, v50 offset:3328
  ds_read_b32 v26, v50 offset:2880
  ds_read_b32 v27, v50 offset:3392
  ds_read_b32 v28, v50 offset:2944
  ds_read_b32 v29, v50 offset:3456
  ds_read_b32 v30, v50 offset:3008
  ds_read_b32 v31, v50 offset:3520
  s_waitcnt lgkmcnt(0)
  s_branch .g2_kernel_q_v0eb
.g2_kernel_q_v0p:
  v_readfirstlane_b32 s35, v57
  s_sub_u32 s28, s35, 1
  s_lshr_b32 s29, s28, 6
  s_lshr_b32 s30, s16, 1
  s_add_u32 s35, s35, 0x100
  s_cmp_lg_u32 s29, s30
  s_cbranch_scc1 .g2_kernel_q_v0pb
  s_add_u32 s35, s35, 0x100
  s_and_b32 s29, s28, 15
  s_mov_b32 s14, 0x00010001
  s_mov_b32 s15, 0x00010001
  s_lshl_b64 s[14:15], s[14:15], s29
  s_and_b32 s29, s28, 12
  s_lshl_b32 s29, s29, 2
  s_lshl_b64 s[30:31], 0xffff, s29
  s_bfe_u32 s29, s28, 0x20004
  s_branch .g2_kernel_q_v0s
.g2_kernel_q_v0s:
  v_subrev_u32 v6, 155648, v53
  v_lshlrev_b32 v6, 2, v6
  v_add_u32 v6, 155648, v6
  s_cmp_lg_u32 s29, 0
  s_cbranch_scc1 .g2_kernel_q_v0s1
  s_mov_b64 exec, s[14:15]
  ds_write_b128 v52, v[192:195] offset:5888
  ds_write_b128 v52, v[208:211] offset:5952
  s_mov_b64 exec, -1
  s_waitcnt lgkmcnt(0)
  s_branch .g2_kernel_q_v0pb
.g2_kernel_q_v0s1:
  s_cmp_lg_u32 s29, 1
  s_cbranch_scc1 .g2_kernel_q_v0s2
  s_mov_b64 exec, s[14:15]
  ds_write_b128 v52, v[196:199] offset:5888
  ds_write_b128 v52, v[212:215] offset:5952
  s_mov_b64 exec, -1
  s_waitcnt lgkmcnt(0)
  s_branch .g2_kernel_q_v0pb
.g2_kernel_q_v0s2:
  s_cmp_lg_u32 s29, 2
  s_cbranch_scc1 .g2_kernel_q_v0s3
  s_mov_b64 exec, s[14:15]
  ds_write_b128 v52, v[200:203] offset:5888
  ds_write_b128 v52, v[216:219] offset:5952
  s_mov_b64 exec, -1
  s_waitcnt lgkmcnt(0)
  s_branch .g2_kernel_q_v0pb
.g2_kernel_q_v0s3:
  s_mov_b64 exec, s[14:15]
  ds_write_b128 v52, v[204:207] offset:5888
  ds_write_b128 v52, v[220:223] offset:5952
  s_mov_b64 exec, -1
  s_waitcnt lgkmcnt(0)
  s_branch .g2_kernel_q_v0pb
.g2_kernel_q_v0f:
  s_mov_b64 exec, 1
  s_cmp_ge_u32 s35, 0x200
  s_cbranch_scc1 .g2_kernel_q_v0f1
  buffer_store_dword v15, v4, s[4:7], s37 offen sc1
  s_mov_b64 exec, -1
  s_branch .g2_kernel_q_v0fb
.g2_kernel_q_v0f1:
  ds_add_u32 v13, v5 offset:56
  s_mov_b64 exec, -1
  s_branch .g2_kernel_q_v0fb
.g2_kernel_q_v0fw:
  s_mov_b32 s38, 0
.g2_kernel_q_v0fl:
  ds_read_b32 v63, v58
  s_add_u32 s38, s38, 1
  s_waitcnt lgkmcnt(0)
  v_cmp_gt_u32 vcc, s12, v63
  s_cbranch_vccz .g2_kernel_q_v0fc
  s_cmp_lt_u32 s38, 524288
  s_cbranch_scc1 .g2_kernel_q_v0fl
  s_branch .g2_kernel_q_v0fc
.g2_kernel_q_v0r:
  v_subrev_u32 v6, 155648, v53
  v_lshlrev_b32 v6, 2, v6
  v_add_u32 v6, 155648, v6
  s_cmp_lg_u32 s29, 0
  s_cbranch_scc1 .g2_kernel_q_v0r1
  s_mov_b64 exec, s[14:15]
  ds_write_b128 v52, v[160:163] offset:5632
  ds_write_b128 v52, v[176:179] offset:5696
  s_mov_b64 exec, s[30:31]
  ds_write_b128 v6, v[224:227] offset:6144
  ds_write_b128 v6, v[240:243] offset:6400
  s_mov_b64 exec, -1
  s_waitcnt lgkmcnt(0)
  s_branch .g2_kernel_q_v0rb
.g2_kernel_q_v0r1:
  s_cmp_lg_u32 s29, 1
  s_cbranch_scc1 .g2_kernel_q_v0r2
  s_mov_b64 exec, s[14:15]
  ds_write_b128 v52, v[164:167] offset:5632
  ds_write_b128 v52, v[180:183] offset:5696
  s_mov_b64 exec, s[30:31]
  ds_write_b128 v6, v[228:231] offset:6144
  ds_write_b128 v6, v[244:247] offset:6400
  s_mov_b64 exec, -1
  s_waitcnt lgkmcnt(0)
  s_branch .g2_kernel_q_v0rb
.g2_kernel_q_v0r2:
  s_cmp_lg_u32 s29, 2
  s_cbranch_scc1 .g2_kernel_q_v0r3
  s_mov_b64 exec, s[14:15]
  ds_write_b128 v52, v[168:171] offset:5632
  ds_write_b128 v52, v[184:187] offset:5696
  s_mov_b64 exec, s[30:31]
  ds_write_b128 v6, v[232:235] offset:6144
  ds_write_b128 v6, v[248:251] offset:6400
  s_mov_b64 exec, -1
  s_waitcnt lgkmcnt(0)
  s_branch .g2_kernel_q_v0rb
.g2_kernel_q_v0r3:
  s_mov_b64 exec, s[14:15]
  ds_write_b128 v52, v[172:175] offset:5632
  ds_write_b128 v52, v[188:191] offset:5696
  s_mov_b64 exec, s[30:31]
  ds_write_b128 v6, v[236:239] offset:6144
  ds_write_b128 v6, v[252:255] offset:6400
  s_mov_b64 exec, -1
  s_waitcnt lgkmcnt(0)
  s_branch .g2_kernel_q_v0rb
.g2_kernel_q_v1ew:
  v_mov_b32 v6, s71
  s_mov_b32 s38, 0
.g2_kernel_wg3:
  ds_read_b32 v7, v6 offset:0
  s_add_u32 s38, s38, 1
  s_waitcnt lgkmcnt(0)
  v_cmp_gt_u32 vcc, 2, v7
  s_cbranch_vccz .g2_kernel_wg3d
  s_cmp_lt_u32 s38, 524288
  s_cbranch_scc1 .g2_kernel_wg3
.g2_kernel_wg3d:
  ds_read_b32 v57, v13 offset:24
  ds_read_b128 v[24:27], v51 offset:2816
  ds_read_b128 v[32:35], v51 offset:3328
  ds_read_b128 v[28:31], v51 offset:2880
  ds_read_b128 v[36:39], v51 offset:3392
  ds_read_b128 v[40:43], v51 offset:2944
  ds_read_b128 v[88:91], v51 offset:3456
  ds_read_b128 v[44:47], v51 offset:3008
  ds_read_b128 v[92:95], v51 offset:3520
  ds_read_b32 v48, v53 offset:5376
  ds_read_b32 v49, v53 offset:5440
  s_waitcnt lgkmcnt(0)
  s_branch .g2_kernel_q_v1eb
.g2_kernel_q_v1p:
  v_readfirstlane_b32 s35, v57
  s_sub_u32 s28, s35, 1
  s_lshr_b32 s29, s28, 6
  s_lshr_b32 s30, s16, 1
  s_add_u32 s35, s35, 0x100
  s_cmp_lg_u32 s29, s30
  s_cbranch_scc1 .g2_kernel_q_v1pb
  s_add_u32 s35, s35, 0x100
  s_and_b32 s29, s28, 15
  s_mov_b32 s14, 0x00010001
  s_mov_b32 s15, 0x00010001
  s_lshl_b64 s[14:15], s[14:15], s29
  s_and_b32 s29, s28, 12
  s_lshl_b32 s29, s29, 2
  s_lshl_b64 s[30:31], 0xffff, s29
  s_bfe_u32 s29, s28, 0x20004
  s_branch .g2_kernel_q_v1s
.g2_kernel_q_v1s:
  v_subrev_u32 v6, 155648, v53
  v_lshlrev_b32 v6, 2, v6
  v_add_u32 v6, 155648, v6
  s_cmp_lg_u32 s29, 0
  s_cbranch_scc1 .g2_kernel_q_v1s1
  s_mov_b64 exec, s[30:31]
  ds_write_b128 v6, v[224:227] offset:6144
  ds_write_b128 v6, v[240:243] offset:6400
  s_mov_b64 exec, -1
  s_waitcnt lgkmcnt(0)
  s_branch .g2_kernel_q_v1pb
.g2_kernel_q_v1s1:
  s_cmp_lg_u32 s29, 1
  s_cbranch_scc1 .g2_kernel_q_v1s2
  s_mov_b64 exec, s[30:31]
  ds_write_b128 v6, v[228:231] offset:6144
  ds_write_b128 v6, v[244:247] offset:6400
  s_mov_b64 exec, -1
  s_waitcnt lgkmcnt(0)
  s_branch .g2_kernel_q_v1pb
.g2_kernel_q_v1s2:
  s_cmp_lg_u32 s29, 2
  s_cbranch_scc1 .g2_kernel_q_v1s3
  s_mov_b64 exec, s[30:31]
  ds_write_b128 v6, v[232:235] offset:6144
  ds_write_b128 v6, v[248:251] offset:6400
  s_mov_b64 exec, -1
  s_waitcnt lgkmcnt(0)
  s_branch .g2_kernel_q_v1pb
.g2_kernel_q_v1s3:
  s_mov_b64 exec, s[30:31]
  ds_write_b128 v6, v[236:239] offset:6144
  ds_write_b128 v6, v[252:255] offset:6400
  s_mov_b64 exec, -1
  s_waitcnt lgkmcnt(0)
  s_branch .g2_kernel_q_v1pb
.g2_kernel_q_v1f:
  s_mov_b64 exec, 1
  s_cmp_ge_u32 s35, 0x200
  s_cbranch_scc1 .g2_kernel_q_v1f1
  buffer_store_dword v15, v4, s[4:7], s37 offen sc1
  s_mov_b64 exec, -1
  s_branch .g2_kernel_q_v1fb
.g2_kernel_q_v1f1:
  ds_add_u32 v13, v5 offset:56
  s_mov_b64 exec, -1
  s_branch .g2_kernel_q_v1fb
.g2_kernel_q_v1fw:
  s_mov_b32 s38, 0
.g2_kernel_q_v1fl:
  ds_read_b32 v63, v58
  s_add_u32 s38, s38, 1
  s_waitcnt lgkmcnt(0)
  v_cmp_gt_u32 vcc, s12, v63
  s_cbranch_vccz .g2_kernel_q_v1fc
  s_cmp_lt_u32 s38, 524288
  s_cbranch_scc1 .g2_kernel_q_v1fl
  s_branch .g2_kernel_q_v1fc
.g2_kernel_q_v1r:
  v_subrev_u32 v6, 155648, v53
  v_lshlrev_b32 v6, 2, v6
  v_add_u32 v6, 155648, v6
  s_cmp_lg_u32 s29, 0
  s_cbranch_scc1 .g2_kernel_q_v1r1
  s_mov_b64 exec, s[14:15]
  ds_write_b128 v52, v[160:163] offset:5632
  ds_write_b128 v52, v[176:179] offset:5696
  s_mov_b64 exec, s[14:15]
  ds_write_b128 v52, v[192:195] offset:5888
  ds_write_b128 v52, v[208:211] offset:5952
  s_mov_b64 exec, -1
  s_waitcnt lgkmcnt(0)
  s_branch .g2_kernel_q_v1rb
.g2_kernel_q_v1r1:
  s_cmp_lg_u32 s29, 1
  s_cbranch_scc1 .g2_kernel_q_v1r2
  s_mov_b64 exec, s[14:15]
  ds_write_b128 v52, v[164:167] offset:5632
  ds_write_b128 v52, v[180:183] offset:5696
  s_mov_b64 exec, s[14:15]
  ds_write_b128 v52, v[196:199] offset:5888
  ds_write_b128 v52, v[212:215] offset:5952
  s_mov_b64 exec, -1
  s_waitcnt lgkmcnt(0)
  s_branch .g2_kernel_q_v1rb
.g2_kernel_q_v1r2:
  s_cmp_lg_u32 s29, 2
  s_cbranch_scc1 .g2_kernel_q_v1r3
  s_mov_b64 exec, s[14:15]
  ds_write_b128 v52, v[168:171] offset:5632
  ds_write_b128 v52, v[184:187] offset:5696
  s_mov_b64 exec, s[14:15]
  ds_write_b128 v52, v[200:203] offset:5888
  ds_write_b128 v52, v[216:219] offset:5952
  s_mov_b64 exec, -1
  s_waitcnt lgkmcnt(0)
  s_branch .g2_kernel_q_v1rb
.g2_kernel_q_v1r3:
  s_mov_b64 exec, s[14:15]
  ds_write_b128 v52, v[172:175] offset:5632
  ds_write_b128 v52, v[188:191] offset:5696
  s_mov_b64 exec, s[14:15]
  ds_write_b128 v52, v[204:207] offset:5888
  ds_write_b128 v52, v[220:223] offset:5952
  s_mov_b64 exec, -1
  s_waitcnt lgkmcnt(0)
  s_branch .g2_kernel_q_v1rb
.g2_kernel_q_v1:
  v_mfma_f32_16x16x32_bf16 v[224:227], v[64:67], v[96:99], v[224:227]
  ds_read_b64_tr_b16 v[80:81], v148 offset:45056
  ds_read_b64_tr_b16 v[82:83], v148 offset:45568
  ds_read_b128 v[128:131], v145 offset:49152
  v_mfma_f32_16x16x32_bf16 v[228:231], v[68:71], v[96:99], v[228:231]
  ds_read_b128 v[132:135], v145 offset:51200
  ds_read_b128 v[136:139], v145 offset:53248
  ds_read_b128 v[140:143], v145 offset:55296
  v_mfma_f32_16x16x32_bf16 v[232:235], v[72:75], v[96:99], v[232:235]
  ds_read_b64_tr_b16 v[84:85], v149 offset:45056
  ds_read_b64_tr_b16 v[86:87], v149 offset:45568
  ds_read_b32 v63, v13 offset:0
  v_mfma_f32_16x16x32_bf16 v[236:239], v[76:79], v[96:99], v[236:239]
  ds_read_b32 v57, v13 offset:24
  ds_read_b128 v[24:27], v51 offset:2816
  ds_read_b128 v[32:35], v51 offset:3328
  v_mfma_f32_16x16x32_bf16 v[252:255], v[76:79], v[100:103], v[252:255]
  ds_read_b128 v[28:31], v51 offset:2880
  ds_read_b128 v[36:39], v51 offset:3392
  ds_read_b128 v[40:43], v51 offset:2944
  v_mfma_f32_16x16x32_bf16 v[248:251], v[72:75], v[100:103], v[248:251]
  ds_read_b128 v[88:91], v51 offset:3456
  ds_read_b128 v[44:47], v51 offset:3008
  ds_read_b128 v[92:95], v51 offset:3520
  v_mfma_f32_16x16x32_bf16 v[244:247], v[68:71], v[100:103], v[244:247]
  ds_read_b32 v48, v53 offset:5376
  ds_read_b32 v49, v53 offset:5440
  v_mfma_f32_16x16x32_bf16 v[240:243], v[64:67], v[100:103], v[240:243]
  s_waitcnt lgkmcnt(12)
  v_mfma_f32_16x16x32_bf16 v[224:227], v[128:131], v[80:83], v[224:227]
  v_mfma_f32_16x16x32_bf16 v[228:231], v[132:135], v[80:83], v[228:231]
  v_mfma_f32_16x16x32_bf16 v[232:235], v[136:139], v[80:83], v[232:235]
  v_mfma_f32_16x16x32_bf16 v[236:239], v[140:143], v[80:83], v[236:239]
  v_mfma_f32_16x16x32_bf16 v[252:255], v[140:143], v[84:87], v[252:255]
  v_mfma_f32_16x16x32_bf16 v[248:251], v[136:139], v[84:87], v[248:251]
  v_mfma_f32_16x16x32_bf16 v[244:247], v[132:135], v[84:87], v[244:247]
  v_mfma_f32_16x16x32_bf16 v[240:243], v[128:131], v[84:87], v[240:243]
  s_waitcnt lgkmcnt(0)
  v_cmp_gt_u32 vcc, 2, v63
  s_cbranch_vccnz .g2_kernel_q_v1ew
.g2_kernel_q_v1eb:
  ds_read_b64_tr_b16 v[120:121], v148 offset:24576
  ds_read_b64_tr_b16 v[122:123], v148 offset:25088
  ds_read_b128 v[104:107], v144 offset:49152
  ds_read_b128 v[108:111], v144 offset:51200
  ds_read_b128 v[112:115], v144 offset:53248
  ds_read_b128 v[116:119], v144 offset:55296
  ds_read_b64_tr_b16 v[124:125], v149 offset:24576
  ds_read_b64_tr_b16 v[126:127], v149 offset:25088
  ds_read_b64_tr_b16 v[128:129], v148 offset:28672
  ds_read_b64_tr_b16 v[130:131], v148 offset:29184
  ds_read_b64_tr_b16 v[132:133], v149 offset:28672
  ds_read_b64_tr_b16 v[134:135], v149 offset:29184
  v_cmp_ne_u32 vcc, 0, v57
  s_cbranch_vccnz .g2_kernel_q_v1p
.g2_kernel_q_v1pb:
  v_pk_mul_f32 v[152:153], v[32:33], v[48:49] op_sel:[0,0] op_sel_hi:[1,0]
  v_pk_mul_f32 v[154:155], v[34:35], v[48:49] op_sel:[0,0] op_sel_hi:[1,0]
  v_pk_mul_f32 v[156:157], v[36:37], v[48:49] op_sel:[0,0] op_sel_hi:[1,0]
  v_pk_mul_f32 v[158:159], v[38:39], v[48:49] op_sel:[0,0] op_sel_hi:[1,0]
  v_pk_fma_f32 v[224:225], v[224:225], v[24:25], v[152:153]
  v_pk_fma_f32 v[226:227], v[226:227], v[26:27], v[154:155]
  v_pk_fma_f32 v[228:229], v[228:229], v[28:29], v[156:157]
  v_pk_fma_f32 v[230:231], v[230:231], v[30:31], v[158:159]
  v_cvt_pk_bf16_f32 v224, v224, v225
  v_cvt_pk_bf16_f32 v225, v226, v227
  v_cvt_pk_bf16_f32 v226, v228, v229
  v_cvt_pk_bf16_f32 v227, v230, v231
  buffer_store_dwordx4 v[224:227], v55, s[4:7], s8 offen offset:2048 sc1
  v_pk_mul_f32 v[152:153], v[32:33], v[48:49] op_sel:[0,1] op_sel_hi:[1,1]
  v_pk_mul_f32 v[154:155], v[34:35], v[48:49] op_sel:[0,1] op_sel_hi:[1,1]
  v_pk_mul_f32 v[156:157], v[36:37], v[48:49] op_sel:[0,1] op_sel_hi:[1,1]
  v_pk_mul_f32 v[158:159], v[38:39], v[48:49] op_sel:[0,1] op_sel_hi:[1,1]
  v_pk_fma_f32 v[240:241], v[240:241], v[24:25], v[152:153]
  v_pk_fma_f32 v[242:243], v[242:243], v[26:27], v[154:155]
  v_pk_fma_f32 v[244:245], v[244:245], v[28:29], v[156:157]
  v_pk_fma_f32 v[246:247], v[246:247], v[30:31], v[158:159]
  v_cvt_pk_bf16_f32 v240, v240, v241
  v_cvt_pk_bf16_f32 v241, v242, v243
  v_cvt_pk_bf16_f32 v242, v244, v245
  v_cvt_pk_bf16_f32 v243, v246, v247
  buffer_store_dwordx4 v[240:243], v55, s[4:7], s8 offen offset:2304 sc1
  v_pk_mul_f32 v[152:153], v[88:89], v[48:49] op_sel:[0,0] op_sel_hi:[1,0]
  v_pk_mul_f32 v[154:155], v[90:91], v[48:49] op_sel:[0,0] op_sel_hi:[1,0]
  v_pk_mul_f32 v[156:157], v[92:93], v[48:49] op_sel:[0,0] op_sel_hi:[1,0]
  v_pk_mul_f32 v[158:159], v[94:95], v[48:49] op_sel:[0,0] op_sel_hi:[1,0]
  v_pk_fma_f32 v[232:233], v[232:233], v[40:41], v[152:153]
  v_pk_fma_f32 v[234:235], v[234:235], v[42:43], v[154:155]
  v_pk_fma_f32 v[236:237], v[236:237], v[44:45], v[156:157]
  v_pk_fma_f32 v[238:239], v[238:239], v[46:47], v[158:159]
  v_cvt_pk_bf16_f32 v232, v232, v233
  v_cvt_pk_bf16_f32 v233, v234, v235
  v_cvt_pk_bf16_f32 v234, v236, v237
  v_cvt_pk_bf16_f32 v235, v238, v239
  buffer_store_dwordx4 v[232:235], v55, s[4:7], s9 offen offset:2048 sc1
  v_pk_mul_f32 v[152:153], v[88:89], v[48:49] op_sel:[0,1] op_sel_hi:[1,1]
  v_pk_mul_f32 v[154:155], v[90:91], v[48:49] op_sel:[0,1] op_sel_hi:[1,1]
  v_pk_mul_f32 v[156:157], v[92:93], v[48:49] op_sel:[0,1] op_sel_hi:[1,1]
  v_pk_mul_f32 v[158:159], v[94:95], v[48:49] op_sel:[0,1] op_sel_hi:[1,1]
  v_pk_fma_f32 v[248:249], v[248:249], v[40:41], v[152:153]
  v_pk_fma_f32 v[250:251], v[250:251], v[42:43], v[154:155]
  v_pk_fma_f32 v[252:253], v[252:253], v[44:45], v[156:157]
  v_pk_fma_f32 v[254:255], v[254:255], v[46:47], v[158:159]
  v_cvt_pk_bf16_f32 v248, v248, v249
  v_cvt_pk_bf16_f32 v249, v250, v251
  v_cvt_pk_bf16_f32 v250, v252, v253
  v_cvt_pk_bf16_f32 v251, v254, v255
  buffer_store_dwordx4 v[248:251], v55, s[4:7], s9 offen offset:2304 sc1
  s_waitcnt lgkmcnt(0)
  v_mfma_f32_16x16x32_bf16 v[160:163], v[120:123], v[104:107], v[160:163]
  ds_read_b64_tr_b16 v[80:81], v148 offset:36864
  ds_read_b64_tr_b16 v[82:83], v148 offset:37376
  v_mfma_f32_16x16x32_bf16 v[164:167], v[120:123], v[108:111], v[164:167]
  ds_read_b128 v[64:67], v145 offset:49152
  ds_read_b128 v[68:71], v145 offset:51200
  v_mfma_f32_16x16x32_bf16 v[168:171], v[120:123], v[112:115], v[168:171]
  ds_read_b128 v[72:75], v145 offset:53248
  ds_read_b128 v[76:79], v145 offset:55296
  v_mfma_f32_16x16x32_bf16 v[172:175], v[120:123], v[116:119], v[172:175]
  ds_read_b64_tr_b16 v[84:85], v149 offset:36864
  ds_read_b64_tr_b16 v[86:87], v149 offset:37376
  v_mfma_f32_16x16x32_bf16 v[188:191], v[124:127], v[116:119], v[188:191]
  ds_read_b64_tr_b16 v[88:89], v148 offset:40960
  ds_read_b64_tr_b16 v[90:91], v148 offset:41472
  v_mfma_f32_16x16x32_bf16 v[184:187], v[124:127], v[112:115], v[184:187]
  ds_read_b64_tr_b16 v[92:93], v149 offset:40960
  ds_read_b64_tr_b16 v[94:95], v149 offset:41472
  v_mfma_f32_16x16x32_bf16 v[180:183], v[124:127], v[108:111], v[180:183]
  ds_read_b128 v[32:35], v52 offset:4864
  ds_read_b128 v[36:39], v52 offset:4928
  v_mfma_f32_16x16x32_bf16 v[176:179], v[124:127], v[104:107], v[176:179]
  ds_read_b128 v[40:43], v52 offset:5120
  ds_read_b128 v[44:47], v52 offset:5184
  v_mfma_f32_16x16x32_bf16 v[192:195], v[128:131], v[104:107], v[192:195]
  v_mfma_f32_16x16x32_bf16 v[196:199], v[128:131], v[108:111], v[196:199]
  v_mfma_f32_16x16x32_bf16 v[200:203], v[128:131], v[112:115], v[200:203]
  v_mfma_f32_16x16x32_bf16 v[204:207], v[128:131], v[116:119], v[204:207]
  v_mfma_f32_16x16x32_bf16 v[220:223], v[132:135], v[116:119], v[220:223]
  v_mfma_f32_16x16x32_bf16 v[216:219], v[132:135], v[112:115], v[216:219]
  v_mfma_f32_16x16x32_bf16 v[212:215], v[132:135], v[108:111], v[212:215]
  v_mfma_f32_16x16x32_bf16 v[208:211], v[132:135], v[104:107], v[208:211]
  s_waitcnt lgkmcnt(0)
  v_mfma_f32_16x16x32_bf16 v[160:163], v[80:83], v[64:67], v[160:163]
  ds_read_b32 v63, v58
  ds_read_b32 v24, v50 offset:2816
  v_mfma_f32_16x16x32_bf16 v[164:167], v[80:83], v[68:71], v[164:167]
  ds_read_b32 v25, v50 offset:3328
  ds_read_b32 v26, v50 offset:2880
  v_mfma_f32_16x16x32_bf16 v[168:171], v[80:83], v[72:75], v[168:171]
  ds_read_b32 v27, v50 offset:3392
  ds_read_b32 v28, v50 offset:2944
  v_mfma_f32_16x16x32_bf16 v[172:175], v[80:83], v[76:79], v[172:175]
  ds_read_b32 v29, v50 offset:3456
  ds_read_b32 v30, v50 offset:3008
  v_mfma_f32_16x16x32_bf16 v[188:191], v[84:87], v[76:79], v[188:191]
  ds_read_b32 v31, v50 offset:3520
  v_mfma_f32_16x16x32_bf16 v[184:187], v[84:87], v[72:75], v[184:187]
  v_mfma_f32_16x16x32_bf16 v[180:183], v[84:87], v[68:71], v[180:183]
  v_mfma_f32_16x16x32_bf16 v[176:179], v[84:87], v[64:67], v[176:179]
  v_mfma_f32_16x16x32_bf16 v[192:195], v[88:91], v[64:67], v[192:195]
  v_mfma_f32_16x16x32_bf16 v[196:199], v[88:91], v[68:71], v[196:199]
  v_mfma_f32_16x16x32_bf16 v[200:203], v[88:91], v[72:75], v[200:203]
  v_mfma_f32_16x16x32_bf16 v[204:207], v[88:91], v[76:79], v[204:207]
  v_mfma_f32_16x16x32_bf16 v[220:223], v[92:95], v[76:79], v[220:223]
  v_mfma_f32_16x16x32_bf16 v[216:219], v[92:95], v[72:75], v[216:219]
  v_mfma_f32_16x16x32_bf16 v[212:215], v[92:95], v[68:71], v[212:215]
  v_mfma_f32_16x16x32_bf16 v[208:211], v[92:95], v[64:67], v[208:211]
  s_waitcnt lgkmcnt(0)
  v_cmp_gt_u32 vcc, s12, v63
  s_cbranch_vccnz .g2_kernel_q_v1fw
.g2_kernel_q_v1fc:
  s_cmp_ge_u32 s35, 0x200
  s_cbranch_scc1 .g2_kernel_q_v1r
.g2_kernel_q_v1rb:
  ds_write_b128 v60, v[224:227] offset:2048
  v_pk_mul_f32 v[152:153], v[40:41], v[24:25] op_sel:[0,1] op_sel_hi:[1,1]
  v_pk_mul_f32 v[154:155], v[42:43], v[24:25] op_sel:[0,1] op_sel_hi:[1,1]
  v_pk_mul_f32 v[156:157], v[44:45], v[24:25] op_sel:[0,1] op_sel_hi:[1,1]
  v_pk_mul_f32 v[158:159], v[46:47], v[24:25] op_sel:[0,1] op_sel_hi:[1,1]
  v_pk_fma_f32 v[192:193], v[192:193], v[24:25], v[152:153] op_sel_hi:[1,0,1]
  v_pk_fma_f32 v[194:195], v[194:195], v[24:25], v[154:155] op_sel_hi:[1,0,1]
  v_pk_fma_f32 v[208:209], v[208:209], v[24:25], v[156:157] op_sel_hi:[1,0,1]
  v_pk_fma_f32 v[210:211], v[210:211], v[24:25], v[158:159] op_sel_hi:[1,0,1]
  v_cvt_pk_bf16_f32 v192, v192, v193
  v_cvt_pk_bf16_f32 v193, v194, v195
  v_cvt_pk_bf16_f32 v194, v208, v209
  v_cvt_pk_bf16_f32 v195, v210, v211
  ds_write_b128 v59, v[192:195] offset:0
  ds_write_b128 v60, v[240:243] offset:2304
  v_pk_mul_f32 v[152:153], v[40:41], v[26:27] op_sel:[0,1] op_sel_hi:[1,1]
  v_pk_mul_f32 v[154:155], v[42:43], v[26:27] op_sel:[0,1] op_sel_hi:[1,1]
  v_pk_mul_f32 v[156:157], v[44:45], v[26:27] op_sel:[0,1] op_sel_hi:[1,1]
  v_pk_mul_f32 v[158:159], v[46:47], v[26:27] op_sel:[0,1] op_sel_hi:[1,1]
  v_pk_fma_f32 v[196:197], v[196:197], v[26:27], v[152:153] op_sel_hi:[1,0,1]
  v_pk_fma_f32 v[198:199], v[198:199], v[26:27], v[154:155] op_sel_hi:[1,0,1]
  v_pk_fma_f32 v[212:213], v[212:213], v[26:27], v[156:157] op_sel_hi:[1,0,1]
  v_pk_fma_f32 v[214:215], v[214:215], v[26:27], v[158:159] op_sel_hi:[1,0,1]
  v_cvt_pk_bf16_f32 v196, v196, v197
  v_cvt_pk_bf16_f32 v197, v198, v199
  v_cvt_pk_bf16_f32 v198, v212, v213
  v_cvt_pk_bf16_f32 v199, v214, v215
  ds_write_b128 v59, v[196:199] offset:128
  ds_write_b128 v60, v[232:235] offset:6144
  v_pk_mul_f32 v[152:153], v[40:41], v[28:29] op_sel:[0,1] op_sel_hi:[1,1]
  v_pk_mul_f32 v[154:155], v[42:43], v[28:29] op_sel:[0,1] op_sel_hi:[1,1]
  v_pk_mul_f32 v[156:157], v[44:45], v[28:29] op_sel:[0,1] op_sel_hi:[1,1]
  v_pk_mul_f32 v[158:159], v[46:47], v[28:29] op_sel:[0,1] op_sel_hi:[1,1]
  v_pk_fma_f32 v[200:201], v[200:201], v[28:29], v[152:153] op_sel_hi:[1,0,1]
  v_pk_fma_f32 v[202:203], v[202:203], v[28:29], v[154:155] op_sel_hi:[1,0,1]
  v_pk_fma_f32 v[216:217], v[216:217], v[28:29], v[156:157] op_sel_hi:[1,0,1]
  v_pk_fma_f32 v[218:219], v[218:219], v[28:29], v[158:159] op_sel_hi:[1,0,1]
  v_cvt_pk_bf16_f32 v200, v200, v201
  v_cvt_pk_bf16_f32 v201, v202, v203
  v_cvt_pk_bf16_f32 v202, v216, v217
  v_cvt_pk_bf16_f32 v203, v218, v219
  ds_write_b128 v59, v[200:203] offset:4096
  s_waitcnt vmcnt(0)
  s_mov_b64 exec, 1
  ds_add_rtn_u32 v7, v62, v5 offset:120
  s_mov_b64 exec, -1
  ds_write_b128 v60, v[248:251] offset:6400
  v_pk_mul_f32 v[152:153], v[40:41], v[30:31] op_sel:[0,1] op_sel_hi:[1,1]
  v_pk_mul_f32 v[154:155], v[42:43], v[30:31] op_sel:[0,1] op_sel_hi:[1,1]
  v_pk_mul_f32 v[156:157], v[44:45], v[30:31] op_sel:[0,1] op_sel_hi:[1,1]
  v_pk_mul_f32 v[158:159], v[46:47], v[30:31] op_sel:[0,1] op_sel_hi:[1,1]
  v_pk_fma_f32 v[204:205], v[204:205], v[30:31], v[152:153] op_sel_hi:[1,0,1]
  v_pk_fma_f32 v[206:207], v[206:207], v[30:31], v[154:155] op_sel_hi:[1,0,1]
  v_pk_fma_f32 v[220:221], v[220:221], v[30:31], v[156:157] op_sel_hi:[1,0,1]
  v_pk_fma_f32 v[222:223], v[222:223], v[30:31], v[158:159] op_sel_hi:[1,0,1]
  v_cvt_pk_bf16_f32 v204, v204, v205
  v_cvt_pk_bf16_f32 v205, v206, v207
  v_cvt_pk_bf16_f32 v206, v220, v221
  v_cvt_pk_bf16_f32 v207, v222, v223
  s_waitcnt lgkmcnt(1)
  v_readfirstlane_b32 s28, v7
  s_cmp_eq_u32 s28, 1
  s_cbranch_scc1 .g2_kernel_q_v1f
.g2_kernel_q_v1fb:
  ds_write_b128 v59, v[204:207] offset:4224
  v_pk_mul_f32 v[24:25], v[24:25], v[56:57] op_sel_hi:[1,0]
  v_pk_mul_f32 v[26:27], v[26:27], v[56:57] op_sel_hi:[1,0]
  v_pk_mul_f32 v[28:29], v[28:29], v[56:57] op_sel_hi:[1,0]
  v_pk_mul_f32 v[30:31], v[30:31], v[56:57] op_sel_hi:[1,0]
  v_pk_mul_f32 v[152:153], v[32:33], v[24:25] op_sel:[0,1] op_sel_hi:[1,1]
  v_pk_mul_f32 v[154:155], v[34:35], v[24:25] op_sel:[0,1] op_sel_hi:[1,1]
  v_pk_mul_f32 v[156:157], v[36:37], v[24:25] op_sel:[0,1] op_sel_hi:[1,1]
  v_pk_mul_f32 v[158:159], v[38:39], v[24:25] op_sel:[0,1] op_sel_hi:[1,1]
  v_pk_fma_f32 v[160:161], v[160:161], v[24:25], v[152:153] op_sel_hi:[1,0,1]
  v_pk_fma_f32 v[162:163], v[162:163], v[24:25], v[154:155] op_sel_hi:[1,0,1]
  v_pk_fma_f32 v[176:177], v[176:177], v[24:25], v[156:157] op_sel_hi:[1,0,1]
  v_pk_fma_f32 v[178:179], v[178:179], v[24:25], v[158:159] op_sel_hi:[1,0,1]
  v_cvt_pk_bf16_f32 v160, v160, v161
  v_cvt_pk_bf16_f32 v161, v162, v163
  v_cvt_pk_bf16_f32 v162, v176, v177
  v_cvt_pk_bf16_f32 v163, v178, v179
  ds_write_b128 v61, v[160:163] offset:0
  v_pk_mul_f32 v[152:153], v[32:33], v[26:27] op_sel:[0,1] op_sel_hi:[1,1]
  v_pk_mul_f32 v[154:155], v[34:35], v[26:27] op_sel:[0,1] op_sel_hi:[1,1]
  v_pk_mul_f32 v[156:157], v[36:37], v[26:27] op_sel:[0,1] op_sel_hi:[1,1]
  v_pk_mul_f32 v[158:159], v[38:39], v[26:27] op_sel:[0,1] op_sel_hi:[1,1]
  v_pk_fma_f32 v[164:165], v[164:165], v[26:27], v[152:153] op_sel_hi:[1,0,1]
  v_pk_fma_f32 v[166:167], v[166:167], v[26:27], v[154:155] op_sel_hi:[1,0,1]
  v_pk_fma_f32 v[180:181], v[180:181], v[26:27], v[156:157] op_sel_hi:[1,0,1]
  v_pk_fma_f32 v[182:183], v[182:183], v[26:27], v[158:159] op_sel_hi:[1,0,1]
  v_cvt_pk_bf16_f32 v164, v164, v165
  v_cvt_pk_bf16_f32 v165, v166, v167
  v_cvt_pk_bf16_f32 v166, v180, v181
  v_cvt_pk_bf16_f32 v167, v182, v183
  ds_write_b128 v61, v[164:167] offset:256
  v_pk_mul_f32 v[152:153], v[32:33], v[28:29] op_sel:[0,1] op_sel_hi:[1,1]
  v_pk_mul_f32 v[154:155], v[34:35], v[28:29] op_sel:[0,1] op_sel_hi:[1,1]
  v_pk_mul_f32 v[156:157], v[36:37], v[28:29] op_sel:[0,1] op_sel_hi:[1,1]
  v_pk_mul_f32 v[158:159], v[38:39], v[28:29] op_sel:[0,1] op_sel_hi:[1,1]
  v_pk_fma_f32 v[168:169], v[168:169], v[28:29], v[152:153] op_sel_hi:[1,0,1]
  v_pk_fma_f32 v[170:171], v[170:171], v[28:29], v[154:155] op_sel_hi:[1,0,1]
  v_pk_fma_f32 v[184:185], v[184:185], v[28:29], v[156:157] op_sel_hi:[1,0,1]
  v_pk_fma_f32 v[186:187], v[186:187], v[28:29], v[158:159] op_sel_hi:[1,0,1]
  v_cvt_pk_bf16_f32 v168, v168, v169
  v_cvt_pk_bf16_f32 v169, v170, v171
  v_cvt_pk_bf16_f32 v170, v184, v185
  v_cvt_pk_bf16_f32 v171, v186, v187
  ds_write_b128 v61, v[168:171] offset:2048
  v_pk_mul_f32 v[152:153], v[32:33], v[30:31] op_sel:[0,1] op_sel_hi:[1,1]
  v_pk_mul_f32 v[154:155], v[34:35], v[30:31] op_sel:[0,1] op_sel_hi:[1,1]
  v_pk_mul_f32 v[156:157], v[36:37], v[30:31] op_sel:[0,1] op_sel_hi:[1,1]
  v_pk_mul_f32 v[158:159], v[38:39], v[30:31] op_sel:[0,1] op_sel_hi:[1,1]
  v_pk_fma_f32 v[172:173], v[172:173], v[30:31], v[152:153] op_sel_hi:[1,0,1]
  v_pk_fma_f32 v[174:175], v[174:175], v[30:31], v[154:155] op_sel_hi:[1,0,1]
  v_pk_fma_f32 v[188:189], v[188:189], v[30:31], v[156:157] op_sel_hi:[1,0,1]
  v_pk_fma_f32 v[190:191], v[190:191], v[30:31], v[158:159] op_sel_hi:[1,0,1]
  v_cvt_pk_bf16_f32 v172, v172, v173
  v_cvt_pk_bf16_f32 v173, v174, v175
  v_cvt_pk_bf16_f32 v174, v188, v189
  v_cvt_pk_bf16_f32 v175, v190, v191
  ds_write_b128 v61, v[172:175] offset:2304
  s_branch .g2_kernel_q_kd
.g2_kernel_r2:
  buffer_load_dwordx4 v[240:243], v22, s[4:7], s13 offen offset:0
  buffer_load_dwordx4 v[244:247], v22, s[4:7], s13 offen offset:512
  buffer_load_dwordx4 v[248:251], v22, s[4:7], s13 offen offset:1024
  buffer_load_dwordx4 v[252:255], v22, s[4:7], s13 offen offset:1536
  s_branch .g2_kernel_r3
.g2_kernel_a_t1c:
  s_call_b64 s[68:69], .g2_kernel_a_pick
  s_branch .g2_kernel_a_t1b
.g2_kernel_a_t2c:
  s_call_b64 s[68:69], .g2_kernel_a_pick
  s_branch .g2_kernel_a_t2b
.g2_kernel_a_t3c:
  s_call_b64 s[68:69], .g2_kernel_a_pick
  s_branch .g2_kernel_a_t3b
.g2_kernel_a_three:
  s_andn2_b32 s33, s36, s34
  s_cbranch_scc0 .g2_kernel_a_t1c
.g2_kernel_a_t1b:
  s_ff1_i32_b32 s33, s33
  s_bitset1_b32 s34, s33
  s_xor_b32 s33, s33, s24
  s_lshl_b32 s33, s33, s25
  s_add_u32 s22, s20, s33
  s_addc_u32 s23, s21, 0
  global_load_dwordx4 v[192:195], v3, s[22:23] offset:0
  global_load_dwordx4 v[196:199], v3, s[22:23] offset:1024
  global_load_dwordx4 v[200:203], v3, s[22:23] offset:2048
  global_load_dwordx4 v[204:207], v3, s[22:23] offset:3072
  s_andn2_b32 s33, s36, s34
  s_cbranch_scc0 .g2_kernel_a_t2c
.g2_kernel_a_t2b:
  s_ff1_i32_b32 s33, s33
  s_bitset1_b32 s34, s33
  s_xor_b32 s33, s33, s24
  s_lshl_b32 s33, s33, s25
  s_add_u32 s22, s20, s33
  s_addc_u32 s23, s21, 0
  global_load_dwordx4 v[208:211], v3, s[22:23] offset:0
  global_load_dwordx4 v[212:215], v3, s[22:23] offset:1024
  global_load_dwordx4 v[216:219], v3, s[22:23] offset:2048
  global_load_dwordx4 v[220:223], v3, s[22:23] offset:3072
  s_andn2_b32 s33, s36, s34
  s_cbranch_scc0 .g2_kernel_a_t3c
.g2_kernel_a_t3b:
  s_ff1_i32_b32 s33, s33
  s_bitset1_b32 s34, s33
  s_xor_b32 s33, s33, s24
  s_lshl_b32 s33, s33, s25
  s_add_u32 s22, s20, s33
  s_addc_u32 s23, s21, 0
  global_load_dwordx4 v[224:227], v3, s[22:23] offset:0
  global_load_dwordx4 v[228:231], v3, s[22:23] offset:1024
  global_load_dwordx4 v[232:235], v3, s[22:23] offset:2048
  global_load_dwordx4 v[236:239], v3, s[22:23] offset:3072
  s_setpc_b64 s[72:73]
.g2_kernel_a_o0c:
  s_call_b64 s[68:69], .g2_kernel_a_pick
  s_branch .g2_kernel_a_o0b
.g2_kernel_a_o1c:
  s_call_b64 s[68:69], .g2_kernel_a_pick
  s_branch .g2_kernel_a_o1b
.g2_kernel_a_o2c:
  s_call_b64 s[68:69], .g2_kernel_a_pick
  s_branch .g2_kernel_a_o2b
.g2_kernel_a_o3c:
  s_call_b64 s[68:69], .g2_kernel_a_pick
  s_branch .g2_kernel_a_o3b
.g2_kernel_a_r0c:
  s_call_b64 s[68:69], .g2_kernel_a_pick
  s_branch .g2_kernel_a_r0b
.g2_kernel_a_r1c:
  s_call_b64 s[68:69], .g2_kernel_a_pick
  s_branch .g2_kernel_a_r1b
.g2_kernel_a_r2c:
  s_call_b64 s[68:69], .g2_kernel_a_pick
  s_branch .g2_kernel_a_r2b
.g2_kernel_a_own:
  s_waitcnt lgkmcnt(0)
  s_mov_b32 s14, 0
  s_andn2_b32 s33, s36, s34
  s_cbranch_scc0 .g2_kernel_a_o0c
.g2_kernel_a_o0b:
  s_ff1_i32_b32 s33, s33
  s_bitset1_b32 s34, s33
  s_lshl_b32 s28, s33, 0
  s_or_b32 s14, s14, s28
  s_xor_b32 s33, s33, s24
  s_lshl_b32 s33, s33, s25
  s_add_u32 s22, s20, s33
  s_addc_u32 s23, s21, 0
  global_load_dwordx4 v[176:179], v3, s[22:23] offset:0
  global_load_dwordx4 v[180:183], v3, s[22:23] offset:1024
  global_load_dwordx4 v[184:187], v3, s[22:23] offset:2048
  global_load_dwordx4 v[188:191], v3, s[22:23] offset:3072
  s_andn2_b32 s33, s36, s34
  s_cbranch_scc0 .g2_kernel_a_o1c
.g2_kernel_a_o1b:
  s_ff1_i32_b32 s33, s33
  s_bitset1_b32 s34, s33
  s_lshl_b32 s28, s33, 8
  s_or_b32 s14, s14, s28
  s_xor_b32 s33, s33, s24
  s_lshl_b32 s33, s33, s25
  s_add_u32 s22, s20, s33
  s_addc_u32 s23, s21, 0
  global_load_dwordx4 v[192:195], v3, s[22:23] offset:0
  global_load_dwordx4 v[196:199], v3, s[22:23] offset:1024
  global_load_dwordx4 v[200:203], v3, s[22:23] offset:2048
  global_load_dwordx4 v[204:207], v3, s[22:23] offset:3072
  s_andn2_b32 s33, s36, s34
  s_cbranch_scc0 .g2_kernel_a_o2c
.g2_kernel_a_o2b:
  s_ff1_i32_b32 s33, s33
  s_bitset1_b32 s34, s33
  s_lshl_b32 s28, s33, 16
  s_or_b32 s14, s14, s28
  s_xor_b32 s33, s33, s24
  s_lshl_b32 s33, s33, s25
  s_add_u32 s22, s20, s33
  s_addc_u32 s23, s21, 0
  global_load_dwordx4 v[208:211], v3, s[22:23] offset:0
  global_load_dwordx4 v[212:215], v3, s[22:23] offset:1024
  global_load_dwordx4 v[216:219], v3, s[22:23] offset:2048
  global_load_dwordx4 v[220:223], v3, s[22:23] offset:3072
  s_andn2_b32 s33, s36, s34
  s_cbranch_scc0 .g2_kernel_a_o3c
.g2_kernel_a_o3b:
  s_ff1_i32_b32 s33, s33
  s_bitset1_b32 s34, s33
  s_lshl_b32 s28, s33, 24
  s_or_b32 s14, s14, s28
  s_xor_b32 s33, s33, s24
  s_lshl_b32 s33, s33, s25
  s_add_u32 s22, s20, s33
  s_addc_u32 s23, s21, 0
  global_load_dwordx4 v[224:227], v3, s[22:23] offset:0
  global_load_dwordx4 v[228:231], v3, s[22:23] offset:1024
  global_load_dwordx4 v[232:235], v3, s[22:23] offset:2048
  global_load_dwordx4 v[236:239], v3, s[22:23] offset:3072
  s_and_b32 s15, s34, -2
  s_mov_b32 s34, -1
  s_mov_b32 s26, -1
  s_waitcnt vmcnt(12)
  s_branch .g2_kernel_a_ob
.g2_kernel_a_redo:
  v_mfma_f32_32x32x16_bf16 v[104:119], v[236:239], v[172:175], v[104:119]
  v_smfmac_f32_16x16x64_bf16 v[132:135], v[16:19], v[168:175], v20
  v_mov_b32 v6, s71
  s_mov_b32 s38, 0
.g2_kernel_wg5:
  ds_read_b32 v7, v6 offset:60
  s_add_u32 s38, s38, 1
  s_waitcnt lgkmcnt(0)
  v_cmp_gt_u32 vcc, 1, v7
  s_cbranch_vccz .g2_kernel_wg5d
  s_sleep 1
  s_cmp_lt_u32 s38, 524288
  s_cbranch_scc1 .g2_kernel_wg5
.g2_kernel_wg5d:
  ds_read_b32 v7, v8
  s_mov_b32 s34, s15
  s_mov_b32 s26, 0
  s_waitcnt lgkmcnt(0)
  v_cmp_lt_u32 vcc, s62, v7
  s_mov_b32 s36, vcc_lo
  s_sub_u32 s28, s35, 1
  s_bfe_u32 s28, s28, 0x20005
  s_mov_b32 s35, 0
  s_waitcnt vmcnt(0)
  s_cmp_lg_u32 s28, 0
  s_cbranch_scc1 .g2_kernel_a_rd1
  ds_read_b128 v[24:27], v14 offset:8192
  ds_read_b128 v[28:31], v14 offset:9216
  v_mov_b32 v120, 0
  v_mov_b32 v121, 0
  s_waitcnt lgkmcnt(0)
  v_mfma_f32_32x32x16_bf16 v[136:151], v[176:179], v[24:27], 0
  v_mfma_f32_32x32x16_bf16 v[136:151], v[180:183], v[28:31], v[136:151]
  v_mfma_f32_32x32x16_bf16 v[152:167], v[192:195], v[24:27], 0
  s_nop 10
  v_exp_f32 v136, v136
  v_exp_f32 v137, v137
  v_exp_f32 v138, v138
  v_exp_f32 v139, v139
  v_exp_f32 v140, v140
  v_exp_f32 v141, v141
  v_exp_f32 v142, v142
  v_exp_f32 v143, v143
  v_mfma_f32_32x32x16_bf16 v[152:167], v[196:199], v[28:31], v[152:167]
  v_cvt_pk_bf16_f32 v168, v136, v137
  v_cvt_pk_bf16_f32 v169, v138, v139
  v_cvt_pk_bf16_f32 v170, v140, v141
  v_cvt_pk_bf16_f32 v171, v142, v143
  v_exp_f32 v144, v144
  v_exp_f32 v145, v145
  v_exp_f32 v146, v146
  v_exp_f32 v147, v147
  v_mfma_f32_32x32x16_bf16 v[56:71], v[184:187], v[168:171], 0
  v_exp_f32 v148, v148
  v_exp_f32 v149, v149
  v_exp_f32 v150, v150
  v_exp_f32 v151, v151
  v_cvt_pk_bf16_f32 v172, v144, v145
  v_cvt_pk_bf16_f32 v173, v146, v147
  v_cvt_pk_bf16_f32 v174, v148, v149
  v_cvt_pk_bf16_f32 v175, v150, v151
  v_mfma_f32_32x32x16_bf16 v[136:151], v[208:211], v[24:27], 0
  v_exp_f32 v152, v152
  v_exp_f32 v153, v153
  v_exp_f32 v154, v154
  v_mfma_f32_32x32x16_bf16 v[56:71], v[188:191], v[172:175], v[56:71]
  s_call_b64 s[72:73], .g2_kernel_a_ld0
  v_exp_f32 v155, v155
  v_exp_f32 v156, v156
  v_exp_f32 v157, v157
  v_smfmac_f32_16x16x64_bf16 v[120:123], v[16:19], v[168:175], v20
  v_exp_f32 v158, v158
  v_exp_f32 v159, v159
  v_mfma_f32_32x32x16_bf16 v[136:151], v[212:215], v[28:31], v[136:151]
  v_cvt_pk_bf16_f32 v168, v152, v153
  v_cvt_pk_bf16_f32 v169, v154, v155
  v_cvt_pk_bf16_f32 v170, v156, v157
  v_cvt_pk_bf16_f32 v171, v158, v159
  v_exp_f32 v160, v160
  v_exp_f32 v161, v161
  v_exp_f32 v162, v162
  v_exp_f32 v163, v163
  v_mfma_f32_32x32x16_bf16 v[56:71], v[200:203], v[168:171], v[56:71]
  v_exp_f32 v164, v164
  v_exp_f32 v165, v165
  v_exp_f32 v166, v166
  v_exp_f32 v167, v167
  v_cvt_pk_bf16_f32 v172, v160, v161
  v_cvt_pk_bf16_f32 v173, v162, v163
  v_cvt_pk_bf16_f32 v174, v164, v165
  v_cvt_pk_bf16_f32 v175, v166, v167
  v_mfma_f32_32x32x16_bf16 v[152:167], v[224:227], v[24:27], 0
  v_exp_f32 v136, v136
  v_exp_f32 v137, v137
  v_exp_f32 v138, v138
  v_mfma_f32_32x32x16_bf16 v[56:71], v[204:207], v[172:175], v[56:71]
  s_call_b64 s[72:73], .g2_kernel_a_ld1
  v_exp_f32 v139, v139
  v_exp_f32 v140, v140
  v_exp_f32 v141, v141
  v_smfmac_f32_16x16x64_bf16 v[120:123], v[16:19], v[168:175], v20
  v_exp_f32 v142, v142
  v_exp_f32 v143, v143
  v_mfma_f32_32x32x16_bf16 v[152:167], v[228:231], v[28:31], v[152:167]
  v_cvt_pk_bf16_f32 v168, v136, v137
  v_cvt_pk_bf16_f32 v169, v138, v139
  v_cvt_pk_bf16_f32 v170, v140, v141
  v_cvt_pk_bf16_f32 v171, v142, v143
  v_exp_f32 v144, v144
  v_exp_f32 v145, v145
  v_exp_f32 v146, v146
  v_exp_f32 v147, v147
  v_mfma_f32_32x32x16_bf16 v[56:71], v[216:219], v[168:171], v[56:71]
  v_exp_f32 v148, v148
  v_exp_f32 v149, v149
  v_exp_f32 v150, v150
  v_exp_f32 v151, v151
  v_cvt_pk_bf16_f32 v172, v144, v145
  v_cvt_pk_bf16_f32 v173, v146, v147
  v_cvt_pk_bf16_f32 v174, v148, v149
  v_cvt_pk_bf16_f32 v175, v150, v151
  v_exp_f32 v152, v152
  v_exp_f32 v153, v153
  v_exp_f32 v154, v154
  v_mfma_f32_32x32x16_bf16 v[56:71], v[220:223], v[172:175], v[56:71]
  s_call_b64 s[72:73], .g2_kernel_a_ld2
  v_exp_f32 v155, v155
  v_exp_f32 v156, v156
  v_exp_f32 v157, v157
  v_smfmac_f32_16x16x64_bf16 v[120:123], v[16:19], v[168:175], v20
  v_exp_f32 v158, v158
  v_exp_f32 v159, v159
  v_cvt_pk_bf16_f32 v168, v152, v153
  v_cvt_pk_bf16_f32 v169, v154, v155
  v_cvt_pk_bf16_f32 v170, v156, v157
  v_cvt_pk_bf16_f32 v171, v158, v159
  v_exp_f32 v160, v160
  v_exp_f32 v161, v161
  v_exp_f32 v162, v162
  v_exp_f32 v163, v163
  v_mfma_f32_32x32x16_bf16 v[56:71], v[232:235], v[168:171], v[56:71]
  v_exp_f32 v164, v164
  v_exp_f32 v165, v165
  v_exp_f32 v166, v166
  v_exp_f32 v167, v167
  v_cvt_pk_bf16_f32 v172, v160, v161
  v_cvt_pk_bf16_f32 v173, v162, v163
  v_cvt_pk_bf16_f32 v174, v164, v165
  v_cvt_pk_bf16_f32 v175, v166, v167
  s_nop 1
  v_mfma_f32_32x32x16_bf16 v[56:71], v[236:239], v[172:175], v[56:71]
  v_smfmac_f32_16x16x64_bf16 v[120:123], v[16:19], v[168:175], v20
  s_branch .g2_kernel_a_rde
.g2_kernel_a_rd1:
  s_cmp_lg_u32 s28, 1
  s_cbranch_scc1 .g2_kernel_a_rd2
  ds_read_b128 v[32:35], v14 offset:10240
  ds_read_b128 v[36:39], v14 offset:11264
  v_mov_b32 v124, 0
  v_mov_b32 v125, 0
  s_waitcnt lgkmcnt(0)
  v_mfma_f32_32x32x16_bf16 v[136:151], v[176:179], v[32:35], 0
  v_mfma_f32_32x32x16_bf16 v[136:151], v[180:183], v[36:39], v[136:151]
  v_mfma_f32_32x32x16_bf16 v[152:167], v[192:195], v[32:35], 0
  s_nop 10
  v_exp_f32 v136, v136
  v_exp_f32 v137, v137
  v_exp_f32 v138, v138
  v_exp_f32 v139, v139
  v_exp_f32 v140, v140
  v_exp_f32 v141, v141
  v_exp_f32 v142, v142
  v_exp_f32 v143, v143
  v_mfma_f32_32x32x16_bf16 v[152:167], v[196:199], v[36:39], v[152:167]
  v_cvt_pk_bf16_f32 v168, v136, v137
  v_cvt_pk_bf16_f32 v169, v138, v139
  v_cvt_pk_bf16_f32 v170, v140, v141
  v_cvt_pk_bf16_f32 v171, v142, v143
  v_exp_f32 v144, v144
  v_exp_f32 v145, v145
  v_exp_f32 v146, v146
  v_exp_f32 v147, v147
  v_mfma_f32_32x32x16_bf16 v[72:87], v[184:187], v[168:171], 0
  v_exp_f32 v148, v148
  v_exp_f32 v149, v149
  v_exp_f32 v150, v150
  v_exp_f32 v151, v151
  v_cvt_pk_bf16_f32 v172, v144, v145
  v_cvt_pk_bf16_f32 v173, v146, v147
  v_cvt_pk_bf16_f32 v174, v148, v149
  v_cvt_pk_bf16_f32 v175, v150, v151
  v_mfma_f32_32x32x16_bf16 v[136:151], v[208:211], v[32:35], 0
  v_exp_f32 v152, v152
  v_exp_f32 v153, v153
  v_exp_f32 v154, v154
  v_mfma_f32_32x32x16_bf16 v[72:87], v[188:191], v[172:175], v[72:87]
  s_call_b64 s[72:73], .g2_kernel_a_ld0
  v_exp_f32 v155, v155
  v_exp_f32 v156, v156
  v_exp_f32 v157, v157
  v_smfmac_f32_16x16x64_bf16 v[124:127], v[16:19], v[168:175], v20
  v_exp_f32 v158, v158
  v_exp_f32 v159, v159
  v_mfma_f32_32x32x16_bf16 v[136:151], v[212:215], v[36:39], v[136:151]
  v_cvt_pk_bf16_f32 v168, v152, v153
  v_cvt_pk_bf16_f32 v169, v154, v155
  v_cvt_pk_bf16_f32 v170, v156, v157
  v_cvt_pk_bf16_f32 v171, v158, v159
  v_exp_f32 v160, v160
  v_exp_f32 v161, v161
  v_exp_f32 v162, v162
  v_exp_f32 v163, v163
  v_mfma_f32_32x32x16_bf16 v[72:87], v[200:203], v[168:171], v[72:87]
  v_exp_f32 v164, v164
  v_exp_f32 v165, v165
  v_exp_f32 v166, v166
  v_exp_f32 v167, v167
  v_cvt_pk_bf16_f32 v172, v160, v161
  v_cvt_pk_bf16_f32 v173, v162, v163
  v_cvt_pk_bf16_f32 v174, v164, v165
  v_cvt_pk_bf16_f32 v175, v166, v167
  v_mfma_f32_32x32x16_bf16 v[152:167], v[224:227], v[32:35], 0
  v_exp_f32 v136, v136
  v_exp_f32 v137, v137
  v_exp_f32 v138, v138
  v_mfma_f32_32x32x16_bf16 v[72:87], v[204:207], v[172:175], v[72:87]
  s_call_b64 s[72:73], .g2_kernel_a_ld1
  v_exp_f32 v139, v139
  v_exp_f32 v140, v140
  v_exp_f32 v141, v141
  v_smfmac_f32_16x16x64_bf16 v[124:127], v[16:19], v[168:175], v20
  v_exp_f32 v142, v142
  v_exp_f32 v143, v143
  v_mfma_f32_32x32x16_bf16 v[152:167], v[228:231], v[36:39], v[152:167]
  v_cvt_pk_bf16_f32 v168, v136, v137
  v_cvt_pk_bf16_f32 v169, v138, v139
  v_cvt_pk_bf16_f32 v170, v140, v141
  v_cvt_pk_bf16_f32 v171, v142, v143
  v_exp_f32 v144, v144
  v_exp_f32 v145, v145
  v_exp_f32 v146, v146
  v_exp_f32 v147, v147
  v_mfma_f32_32x32x16_bf16 v[72:87], v[216:219], v[168:171], v[72:87]
  v_exp_f32 v148, v148
  v_exp_f32 v149, v149
  v_exp_f32 v150, v150
  v_exp_f32 v151, v151
  v_cvt_pk_bf16_f32 v172, v144, v145
  v_cvt_pk_bf16_f32 v173, v146, v147
  v_cvt_pk_bf16_f32 v174, v148, v149
  v_cvt_pk_bf16_f32 v175, v150, v151
  v_exp_f32 v152, v152
  v_exp_f32 v153, v153
  v_exp_f32 v154, v154
  v_mfma_f32_32x32x16_bf16 v[72:87], v[220:223], v[172:175], v[72:87]
  s_call_b64 s[72:73], .g2_kernel_a_ld2
  v_exp_f32 v155, v155
  v_exp_f32 v156, v156
  v_exp_f32 v157, v157
  v_smfmac_f32_16x16x64_bf16 v[124:127], v[16:19], v[168:175], v20
  v_exp_f32 v158, v158
  v_exp_f32 v159, v159
  v_cvt_pk_bf16_f32 v168, v152, v153
  v_cvt_pk_bf16_f32 v169, v154, v155
  v_cvt_pk_bf16_f32 v170, v156, v157
  v_cvt_pk_bf16_f32 v171, v158, v159
  v_exp_f32 v160, v160
  v_exp_f32 v161, v161
  v_exp_f32 v162, v162
  v_exp_f32 v163, v163
  v_mfma_f32_32x32x16_bf16 v[72:87], v[232:235], v[168:171], v[72:87]
  v_exp_f32 v164, v164
  v_exp_f32 v165, v165
  v_exp_f32 v166, v166
  v_exp_f32 v167, v167
  v_cvt_pk_bf16_f32 v172, v160, v161
  v_cvt_pk_bf16_f32 v173, v162, v163
  v_cvt_pk_bf16_f32 v174, v164, v165
  v_cvt_pk_bf16_f32 v175, v166, v167
  s_nop 1
  v_mfma_f32_32x32x16_bf16 v[72:87], v[236:239], v[172:175], v[72:87]
  v_smfmac_f32_16x16x64_bf16 v[124:127], v[16:19], v[168:175], v20
  s_branch .g2_kernel_a_rde
.g2_kernel_a_rd2:
  s_cmp_lg_u32 s28, 2
  s_cbranch_scc1 .g2_kernel_a_rd3
  ds_read_b128 v[40:43], v14 offset:12288
  ds_read_b128 v[44:47], v14 offset:13312
  v_mov_b32 v128, 0
  v_mov_b32 v129, 0
  s_waitcnt lgkmcnt(0)
  v_mfma_f32_32x32x16_bf16 v[136:151], v[176:179], v[40:43], 0
  v_mfma_f32_32x32x16_bf16 v[136:151], v[180:183], v[44:47], v[136:151]
  v_mfma_f32_32x32x16_bf16 v[152:167], v[192:195], v[40:43], 0
  s_nop 10
  v_exp_f32 v136, v136
  v_exp_f32 v137, v137
  v_exp_f32 v138, v138
  v_exp_f32 v139, v139
  v_exp_f32 v140, v140
  v_exp_f32 v141, v141
  v_exp_f32 v142, v142
  v_exp_f32 v143, v143
  v_mfma_f32_32x32x16_bf16 v[152:167], v[196:199], v[44:47], v[152:167]
  v_cvt_pk_bf16_f32 v168, v136, v137
  v_cvt_pk_bf16_f32 v169, v138, v139
  v_cvt_pk_bf16_f32 v170, v140, v141
  v_cvt_pk_bf16_f32 v171, v142, v143
  v_exp_f32 v144, v144
  v_exp_f32 v145, v145
  v_exp_f32 v146, v146
  v_exp_f32 v147, v147
  v_mfma_f32_32x32x16_bf16 v[88:103], v[184:187], v[168:171], 0
  v_exp_f32 v148, v148
  v_exp_f32 v149, v149
  v_exp_f32 v150, v150
  v_exp_f32 v151, v151
  v_cvt_pk_bf16_f32 v172, v144, v145
  v_cvt_pk_bf16_f32 v173, v146, v147
  v_cvt_pk_bf16_f32 v174, v148, v149
  v_cvt_pk_bf16_f32 v175, v150, v151
  v_mfma_f32_32x32x16_bf16 v[136:151], v[208:211], v[40:43], 0
  v_exp_f32 v152, v152
  v_exp_f32 v153, v153
  v_exp_f32 v154, v154
  v_mfma_f32_32x32x16_bf16 v[88:103], v[188:191], v[172:175], v[88:103]
  s_call_b64 s[72:73], .g2_kernel_a_ld0
  v_exp_f32 v155, v155
  v_exp_f32 v156, v156
  v_exp_f32 v157, v157
  v_smfmac_f32_16x16x64_bf16 v[128:131], v[16:19], v[168:175], v20
  v_exp_f32 v158, v158
  v_exp_f32 v159, v159
  v_mfma_f32_32x32x16_bf16 v[136:151], v[212:215], v[44:47], v[136:151]
  v_cvt_pk_bf16_f32 v168, v152, v153
  v_cvt_pk_bf16_f32 v169, v154, v155
  v_cvt_pk_bf16_f32 v170, v156, v157
  v_cvt_pk_bf16_f32 v171, v158, v159
  v_exp_f32 v160, v160
  v_exp_f32 v161, v161
  v_exp_f32 v162, v162
  v_exp_f32 v163, v163
  v_mfma_f32_32x32x16_bf16 v[88:103], v[200:203], v[168:171], v[88:103]
  v_exp_f32 v164, v164
  v_exp_f32 v165, v165
  v_exp_f32 v166, v166
  v_exp_f32 v167, v167
  v_cvt_pk_bf16_f32 v172, v160, v161
  v_cvt_pk_bf16_f32 v173, v162, v163
  v_cvt_pk_bf16_f32 v174, v164, v165
  v_cvt_pk_bf16_f32 v175, v166, v167
  v_mfma_f32_32x32x16_bf16 v[152:167], v[224:227], v[40:43], 0
  v_exp_f32 v136, v136
  v_exp_f32 v137, v137
  v_exp_f32 v138, v138
  v_mfma_f32_32x32x16_bf16 v[88:103], v[204:207], v[172:175], v[88:103]
  s_call_b64 s[72:73], .g2_kernel_a_ld1
  v_exp_f32 v139, v139
  v_exp_f32 v140, v140
  v_exp_f32 v141, v141
  v_smfmac_f32_16x16x64_bf16 v[128:131], v[16:19], v[168:175], v20
  v_exp_f32 v142, v142
  v_exp_f32 v143, v143
  v_mfma_f32_32x32x16_bf16 v[152:167], v[228:231], v[44:47], v[152:167]
  v_cvt_pk_bf16_f32 v168, v136, v137
  v_cvt_pk_bf16_f32 v169, v138, v139
  v_cvt_pk_bf16_f32 v170, v140, v141
  v_cvt_pk_bf16_f32 v171, v142, v143
  v_exp_f32 v144, v144
  v_exp_f32 v145, v145
  v_exp_f32 v146, v146
  v_exp_f32 v147, v147
  v_mfma_f32_32x32x16_bf16 v[88:103], v[216:219], v[168:171], v[88:103]
  v_exp_f32 v148, v148
  v_exp_f32 v149, v149
  v_exp_f32 v150, v150
  v_exp_f32 v151, v151
  v_cvt_pk_bf16_f32 v172, v144, v145
  v_cvt_pk_bf16_f32 v173, v146, v147
  v_cvt_pk_bf16_f32 v174, v148, v149
  v_cvt_pk_bf16_f32 v175, v150, v151
  v_exp_f32 v152, v152
  v_exp_f32 v153, v153
  v_exp_f32 v154, v154
  v_mfma_f32_32x32x16_bf16 v[88:103], v[220:223], v[172:175], v[88:103]
  s_call_b64 s[72:73], .g2_kernel_a_ld2
  v_exp_f32 v155, v155
  v_exp_f32 v156, v156
  v_exp_f32 v157, v157
  v_smfmac_f32_16x16x64_bf16 v[128:131], v[16:19], v[168:175], v20
  v_exp_f32 v158, v158
  v_exp_f32 v159, v159
  v_cvt_pk_bf16_f32 v168, v152, v153
  v_cvt_pk_bf16_f32 v169, v154, v155
  v_cvt_pk_bf16_f32 v170, v156, v157
  v_cvt_pk_bf16_f32 v171, v158, v159
  v_exp_f32 v160, v160
  v_exp_f32 v161, v161
  v_exp_f32 v162, v162
  v_exp_f32 v163, v163
  v_mfma_f32_32x32x16_bf16 v[88:103], v[232:235], v[168:171], v[88:103]
  v_exp_f32 v164, v164
  v_exp_f32 v165, v165
  v_exp_f32 v166, v166
  v_exp_f32 v167, v167
  v_cvt_pk_bf16_f32 v172, v160, v161
  v_cvt_pk_bf16_f32 v173, v162, v163
  v_cvt_pk_bf16_f32 v174, v164, v165
  v_cvt_pk_bf16_f32 v175, v166, v167
  s_nop 1
  v_mfma_f32_32x32x16_bf16 v[88:103], v[236:239], v[172:175], v[88:103]
  v_smfmac_f32_16x16x64_bf16 v[128:131], v[16:19], v[168:175], v20
  s_branch .g2_kernel_a_rde
.g2_kernel_a_rd3:
  ds_read_b128 v[48:51], v14 offset:14336
  ds_read_b128 v[52:55], v14 offset:15360
  v_mov_b32 v132, 0
  v_mov_b32 v133, 0
  s_waitcnt lgkmcnt(0)
  v_mfma_f32_32x32x16_bf16 v[136:151], v[176:179], v[48:51], 0
  v_mfma_f32_32x32x16_bf16 v[136:151], v[180:183], v[52:55], v[136:151]
  v_mfma_f32_32x32x16_bf16 v[152:167], v[192:195], v[48:51], 0
  s_nop 10
  v_exp_f32 v136, v136
  v_exp_f32 v137, v137
  v_exp_f32 v138, v138
  v_exp_f32 v139, v139
  v_exp_f32 v140, v140
  v_exp_f32 v141, v141
  v_exp_f32 v142, v142
  v_exp_f32 v143, v143
  v_mfma_f32_32x32x16_bf16 v[152:167], v[196:199], v[52:55], v[152:167]
  v_cvt_pk_bf16_f32 v168, v136, v137
  v_cvt_pk_bf16_f32 v169, v138, v139
  v_cvt_pk_bf16_f32 v170, v140, v141
  v_cvt_pk_bf16_f32 v171, v142, v143
  v_exp_f32 v144, v144
  v_exp_f32 v145, v145
  v_exp_f32 v146, v146
  v_exp_f32 v147, v147
  v_mfma_f32_32x32x16_bf16 v[104:119], v[184:187], v[168:171], 0
  v_exp_f32 v148, v148
  v_exp_f32 v149, v149
  v_exp_f32 v150, v150
  v_exp_f32 v151, v151
  v_cvt_pk_bf16_f32 v172, v144, v145
  v_cvt_pk_bf16_f32 v173, v146, v147
  v_cvt_pk_bf16_f32 v174, v148, v149
  v_cvt_pk_bf16_f32 v175, v150, v151
  v_mfma_f32_32x32x16_bf16 v[136:151], v[208:211], v[48:51], 0
  v_exp_f32 v152, v152
  v_exp_f32 v153, v153
  v_exp_f32 v154, v154
  v_mfma_f32_32x32x16_bf16 v[104:119], v[188:191], v[172:175], v[104:119]
  s_call_b64 s[72:73], .g2_kernel_a_ld0
  v_exp_f32 v155, v155
  v_exp_f32 v156, v156
  v_exp_f32 v157, v157
  v_smfmac_f32_16x16x64_bf16 v[132:135], v[16:19], v[168:175], v20
  v_exp_f32 v158, v158
  v_exp_f32 v159, v159
  v_mfma_f32_32x32x16_bf16 v[136:151], v[212:215], v[52:55], v[136:151]
  v_cvt_pk_bf16_f32 v168, v152, v153
  v_cvt_pk_bf16_f32 v169, v154, v155
  v_cvt_pk_bf16_f32 v170, v156, v157
  v_cvt_pk_bf16_f32 v171, v158, v159
  v_exp_f32 v160, v160
  v_exp_f32 v161, v161
  v_exp_f32 v162, v162
  v_exp_f32 v163, v163
  v_mfma_f32_32x32x16_bf16 v[104:119], v[200:203], v[168:171], v[104:119]
  v_exp_f32 v164, v164
  v_exp_f32 v165, v165
  v_exp_f32 v166, v166
  v_exp_f32 v167, v167
  v_cvt_pk_bf16_f32 v172, v160, v161
  v_cvt_pk_bf16_f32 v173, v162, v163
  v_cvt_pk_bf16_f32 v174, v164, v165
  v_cvt_pk_bf16_f32 v175, v166, v167
  v_mfma_f32_32x32x16_bf16 v[152:167], v[224:227], v[48:51], 0
  v_exp_f32 v136, v136
  v_exp_f32 v137, v137
  v_exp_f32 v138, v138
  v_mfma_f32_32x32x16_bf16 v[104:119], v[204:207], v[172:175], v[104:119]
  s_call_b64 s[72:73], .g2_kernel_a_ld1
  v_exp_f32 v139, v139
  v_exp_f32 v140, v140
  v_exp_f32 v141, v141
  v_smfmac_f32_16x16x64_bf16 v[132:135], v[16:19], v[168:175], v20
  v_exp_f32 v142, v142
  v_exp_f32 v143, v143
  v_mfma_f32_32x32x16_bf16 v[152:167], v[228:231], v[52:55], v[152:167]
  v_cvt_pk_bf16_f32 v168, v136, v137
  v_cvt_pk_bf16_f32 v169, v138, v139
  v_cvt_pk_bf16_f32 v170, v140, v141
  v_cvt_pk_bf16_f32 v171, v142, v143
  v_exp_f32 v144, v144
  v_exp_f32 v145, v145
  v_exp_f32 v146, v146
  v_exp_f32 v147, v147
  v_mfma_f32_32x32x16_bf16 v[104:119], v[216:219], v[168:171], v[104:119]
  v_exp_f32 v148, v148
  v_exp_f32 v149, v149
  v_exp_f32 v150, v150
  v_exp_f32 v151, v151
  v_cvt_pk_bf16_f32 v172, v144, v145
  v_cvt_pk_bf16_f32 v173, v146, v147
  v_cvt_pk_bf16_f32 v174, v148, v149
  v_cvt_pk_bf16_f32 v175, v150, v151
  v_exp_f32 v152, v152
  v_exp_f32 v153, v153
  v_exp_f32 v154, v154
  v_mfma_f32_32x32x16_bf16 v[104:119], v[220:223], v[172:175], v[104:119]
  s_call_b64 s[72:73], .g2_kernel_a_ld2
  v_exp_f32 v155, v155
  v_exp_f32 v156, v156
  v_exp_f32 v157, v157
  v_smfmac_f32_16x16x64_bf16 v[132:135], v[16:19], v[168:175], v20
  v_exp_f32 v158, v158
  v_exp_f32 v159, v159
  v_cvt_pk_bf16_f32 v168, v152, v153
  v_cvt_pk_bf16_f32 v169, v154, v155
  v_cvt_pk_bf16_f32 v170, v156, v157
  v_cvt_pk_bf16_f32 v171, v158, v159
  v_exp_f32 v160, v160
  v_exp_f32 v161, v161
  v_exp_f32 v162, v162
  v_exp_f32 v163, v163
  v_mfma_f32_32x32x16_bf16 v[104:119], v[232:235], v[168:171], v[104:119]
  v_exp_f32 v164, v164
  v_exp_f32 v165, v165
  v_exp_f32 v166, v166
  v_exp_f32 v167, v167
  v_cvt_pk_bf16_f32 v172, v160, v161
  v_cvt_pk_bf16_f32 v173, v162, v163
  v_cvt_pk_bf16_f32 v174, v164, v165
  v_cvt_pk_bf16_f32 v175, v166, v167
  s_nop 1
  v_mfma_f32_32x32x16_bf16 v[104:119], v[236:239], v[172:175], v[104:119]
  v_smfmac_f32_16x16x64_bf16 v[132:135], v[16:19], v[168:175], v20
  s_branch .g2_kernel_a_rde
.g2_kernel_a_rd4:
.g2_kernel_a_rde:
  v_mov_b32 v168, 0
  v_mov_b32 v169, 0
  v_mov_b32 v170, 0
  v_mov_b32 v171, 0
  v_mov_b32 v172, 0
  v_mov_b32 v173, 0
  v_mov_b32 v174, 0
  v_mov_b32 v175, 0
  s_waitcnt vmcnt(8)
  v_mfma_f32_32x32x16_bf16 v[136:151], v[176:179], v[24:27], 0
  v_mfma_f32_32x32x16_bf16 v[136:151], v[180:183], v[28:31], v[136:151]
  s_nop 10
  s_branch .g2_kernel_a_loop
.g2_kernel_a_ld0:
  s_andn2_b32 s33, s36, s34
  s_cbranch_scc0 .g2_kernel_a_r0c
.g2_kernel_a_r0b:
  s_ff1_i32_b32 s33, s33
  s_bitset1_b32 s34, s33
  s_xor_b32 s33, s33, s24
  s_lshl_b32 s33, s33, s25
  s_add_u32 s22, s20, s33
  s_addc_u32 s23, s21, 0
  global_load_dwordx4 v[176:179], v3, s[22:23] offset:0
  global_load_dwordx4 v[180:183], v3, s[22:23] offset:1024
  global_load_dwordx4 v[184:187], v3, s[22:23] offset:2048
  global_load_dwordx4 v[188:191], v3, s[22:23] offset:3072
  s_setpc_b64 s[72:73]
.g2_kernel_a_ld1:
  s_andn2_b32 s33, s36, s34
  s_cbranch_scc0 .g2_kernel_a_r1c
.g2_kernel_a_r1b:
  s_ff1_i32_b32 s33, s33
  s_bitset1_b32 s34, s33
  s_xor_b32 s33, s33, s24
  s_lshl_b32 s33, s33, s25
  s_add_u32 s22, s20, s33
  s_addc_u32 s23, s21, 0
  global_load_dwordx4 v[192:195], v3, s[22:23] offset:0
  global_load_dwordx4 v[196:199], v3, s[22:23] offset:1024
  global_load_dwordx4 v[200:203], v3, s[22:23] offset:2048
  global_load_dwordx4 v[204:207], v3, s[22:23] offset:3072
  s_setpc_b64 s[72:73]
.g2_kernel_a_ld2:
  s_andn2_b32 s33, s36, s34
  s_cbranch_scc0 .g2_kernel_a_r2c
.g2_kernel_a_r2b:
  s_ff1_i32_b32 s33, s33
  s_bitset1_b32 s34, s33
  s_xor_b32 s33, s33, s24
  s_lshl_b32 s33, s33, s25
  s_add_u32 s22, s20, s33
  s_addc_u32 s23, s21, 0
  global_load_dwordx4 v[208:211], v3, s[22:23] offset:0
  global_load_dwordx4 v[212:215], v3, s[22:23] offset:1024
  global_load_dwordx4 v[216:219], v3, s[22:23] offset:2048
  global_load_dwordx4 v[220:223], v3, s[22:23] offset:3072
  s_setpc_b64 s[72:73]
.g2_kernel_a_N0c:
  s_call_b64 s[68:69], .g2_kernel_a_pick
  s_branch .g2_kernel_a_N0b
.g2_kernel_a_N1c:
  s_call_b64 s[68:69], .g2_kernel_a_pick
  s_branch .g2_kernel_a_N1b
.g2_kernel_a_N2c:
  s_call_b64 s[68:69], .g2_kernel_a_pick
  s_branch .g2_kernel_a_N2b
.g2_kernel_a_N3c:
  s_call_b64 s[68:69], .g2_kernel_a_pick
  s_branch .g2_kernel_a_N3b
.g2_kernel_a_L3c:
  s_call_b64 s[68:69], .g2_kernel_a_pick
  s_branch .g2_kernel_a_L3b
.g2_kernel_a_G0c:
  s_call_b64 s[68:69], .g2_kernel_a_pick
  s_branch .g2_kernel_a_G0b
.g2_kernel_a_L3g:
  s_mov_b32 s38, 0
.g2_kernel_a_L3gl:
  ds_read_b32 v7, v13 offset:8
  s_add_u32 s38, s38, 1
  s_waitcnt lgkmcnt(0)
  v_cmp_gt_u32 vcc, s27, v7
  s_cbranch_vccz .g2_kernel_a_L3h
  s_cmp_lt_u32 s38, 524288
  s_cbranch_scc1 .g2_kernel_a_L3gl
  s_branch .g2_kernel_a_L3h
.g2_kernel_a_hold:
  s_lshl_b32 s33, 1, s14
  s_lshr_b32 s14, s14, 8
  s_setpc_b64 s[68:69]
.g2_kernel_a_pick:
  s_cmp_lg_u32 s34, -1
  s_cbranch_scc1 .g2_kernel_a_pk1
  s_cmp_eq_u32 s26, -1
  s_cbranch_scc1 .g2_kernel_a_hold
  s_add_u32 s26, s26, 1
  s_mov_b32 s34, 0xffff
  s_cmp_eq_u32 s26, 1
  s_cbranch_scc1 .g2_kernel_a_pk0
  v_and_b32 v8, 15, v2
  s_lshl_b32 s28, s16, 6
  s_add_u32 s28, s28, 157696
  v_lshl_add_u32 v8, v8, 2, s28
  s_lshl_b32 s28, s17, 2
  s_add_u32 s28, s28, s16
  s_lshl_b32 s28, s28, 16
  s_add_u32 s28, s28, s63
  s_add_u32 s28, s28, 0x800000
  s_add_u32 s20, s60, s28
  s_addc_u32 s21, s61, 0
  s_lshl_b32 s24, s18, 1
  s_and_b32 s24, s24, 6
  s_mov_b32 s25, 12
  s_mov_b32 s34, 0
  s_mov_b32 s36, 0xff
  s_mov_b32 s33, 0xff
  s_mov_b32 s38, 0
.g2_kernel_a_pk2:
  ds_read_b32 v7, v8
  s_add_u32 s38, s38, 1
  s_waitcnt lgkmcnt(0)
  v_cmp_ge_u32 vcc, s62, v7
  s_cbranch_vccz .g2_kernel_a_pkr
  s_cmp_lt_u32 s38, 524288
  s_cbranch_scc1 .g2_kernel_a_pk2
  s_branch .g2_kernel_a_pkr
.g2_kernel_a_pk0:
  s_andn2_b32 s33, s36, s34
  s_cbranch_scc1 .g2_kernel_a_pkr
.g2_kernel_a_pk1:
  s_mov_b32 s38, 0
.g2_kernel_a_pkl:
  ds_read_b32 v7, v8
  s_add_u32 s38, s38, 1
  s_waitcnt lgkmcnt(0)
  v_cmp_lt_u32 vcc, s62, v7
  s_mov_b32 s36, vcc_lo
  s_andn2_b32 s33, s36, s34
  s_cbranch_scc1 .g2_kernel_a_pkr
  s_cmp_lt_u32 s38, 524288
  s_cbranch_scc1 .g2_kernel_a_pkl
  s_not_b32 s33, s34
.g2_kernel_a_pkr:
  s_setpc_b64 s[68:69]
.g2_kernel_w_aw:
  v_mov_b32 v6, s71
  s_mov_b32 s38, 0
.g2_kernel_wg6:
  ds_read_b32 v7, v6 offset:52
  s_add_u32 s38, s38, 1
  s_waitcnt lgkmcnt(0)
  v_cmp_gt_u32 vcc, 4, v7
  s_cbranch_vccz .g2_kernel_wg6d
  s_sleep 1
  s_cmp_lt_u32 s38, 524288
  s_cbranch_scc1 .g2_kernel_wg6
.g2_kernel_wg6d:
  s_branch .g2_kernel_w_ab
.g2_kernel_w_pt:
  v_lshlrev_b32 v7, 5, v17
  v_add_u32 v7, 155648, v7
  s_mov_b64 exec, vcc
  ds_read_b128 v[240:243], v7 offset:7680
  ds_read_b128 v[244:247], v7 offset:7696
  ds_read_b128 v[248:251], v7 offset:7744
  ds_read_b128 v[252:255], v7 offset:7760
  s_waitcnt lgkmcnt(0)
  v_pk_add_f32 v[24:25], v[24:25], v[240:241]
  v_pk_add_f32 v[26:27], v[26:27], v[242:243]
  v_pk_add_f32 v[28:29], v[28:29], v[244:245]
  v_pk_add_f32 v[30:31], v[30:31], v[246:247]
  v_pk_add_f32 v[32:33], v[32:33], v[248:249]
  v_pk_add_f32 v[34:35], v[34:35], v[250:251]
  v_pk_add_f32 v[36:37], v[36:37], v[252:253]
  v_pk_add_f32 v[38:39], v[38:39], v[254:255]
  ds_read_b128 v[240:243], v7 offset:7808
  ds_read_b128 v[244:247], v7 offset:7824
  ds_read_b128 v[248:251], v7 offset:7872
  ds_read_b128 v[252:255], v7 offset:7888
  s_waitcnt lgkmcnt(0)
  v_pk_add_f32 v[40:41], v[40:41], v[240:241]
  v_pk_add_f32 v[42:43], v[42:43], v[242:243]
  v_pk_add_f32 v[44:45], v[44:45], v[244:245]
  v_pk_add_f32 v[46:47], v[46:47], v[246:247]
  v_pk_add_f32 v[48:49], v[48:49], v[248:249]
  v_pk_add_f32 v[50:51], v[50:51], v[250:251]
  v_pk_add_f32 v[52:53], v[52:53], v[252:253]
  v_pk_add_f32 v[54:55], v[54:55], v[254:255]
  s_mov_b64 exec, -1
  s_branch .g2_kernel_w_pb
.g2_kernel_w_i8c:
  s_mov_b32 s38, 0
  s_call_b64 s[68:69], .g2_kernel_w_pkl
  s_branch .g2_kernel_w_i8b
.g2_kernel_w_i9c:
  s_mov_b32 s38, 0
  s_call_b64 s[68:69], .g2_kernel_w_pkl
  s_branch .g2_kernel_w_i9b
.g2_kernel_w_i10c:
  s_mov_b32 s38, 0
  s_call_b64 s[68:69], .g2_kernel_w_pkl
  s_branch .g2_kernel_w_i10b
.g2_kernel_w_i11c:
  s_mov_b32 s38, 0
  s_call_b64 s[68:69], .g2_kernel_w_pkl
  s_branch .g2_kernel_w_i11b
.g2_kernel_w_v8:
  s_cmp_ge_u32 s8, 139264
  s_cselect_b32 s28, 139264, 0
  s_sub_u32 s28, s8, s28
  s_lshr_b32 s28, s28, 1
  s_add_u32 s28, s28, 32768
  s_add_u32 s22, s20, s28
  s_addc_u32 s23, s21, 0
  s_mov_b32 s38, 0
.g2_kernel_w_vl8:
  global_load_dwordx4 v[88:91], v3, s[22:23] offset:0 sc1
  global_load_dwordx4 v[92:95], v3, s[22:23] offset:1024 sc1
  global_load_dwordx4 v[96:99], v3, s[22:23] offset:2048 sc1
  global_load_dwordx4 v[100:103], v3, s[22:23] offset:3072 sc1
  s_add_u32 s38, s38, 1
  s_waitcnt vmcnt(0)
  v_min3_u32 v6, v88, v90, v92
  v_min3_u32 v7, v94, v96, v98
  v_min3_u32 v6, v6, v100, v102
  v_min_u32 v6, v6, v7
  v_cmp_eq_u32 vcc, 0, v6
  s_cbranch_vccz .g2_kernel_w_vb8
  s_cmp_lt_u32 s38, 131072
  s_cbranch_scc1 .g2_kernel_w_vl8
  s_branch .g2_kernel_w_vb8
.g2_kernel_w_i12c:
  s_mov_b32 s38, 0
  s_call_b64 s[68:69], .g2_kernel_w_pkl
  s_branch .g2_kernel_w_i12b
.g2_kernel_w_v9:
  s_cmp_ge_u32 s9, 139264
  s_cselect_b32 s28, 139264, 0
  s_sub_u32 s28, s9, s28
  s_lshr_b32 s28, s28, 1
  s_add_u32 s28, s28, 32768
  s_add_u32 s22, s20, s28
  s_addc_u32 s23, s21, 0
  s_mov_b32 s38, 0
.g2_kernel_w_vl9:
  global_load_dwordx4 v[176:179], v3, s[22:23] offset:0 sc1
  global_load_dwordx4 v[180:183], v3, s[22:23] offset:1024 sc1
  global_load_dwordx4 v[184:187], v3, s[22:23] offset:2048 sc1
  global_load_dwordx4 v[188:191], v3, s[22:23] offset:3072 sc1
  s_add_u32 s38, s38, 1
  s_waitcnt vmcnt(0)
  v_min3_u32 v6, v176, v178, v180
  v_min3_u32 v7, v182, v184, v186
  v_min3_u32 v6, v6, v188, v190
  v_min_u32 v6, v6, v7
  v_cmp_eq_u32 vcc, 0, v6
  s_cbranch_vccz .g2_kernel_w_vb9
  s_cmp_lt_u32 s38, 131072
  s_cbranch_scc1 .g2_kernel_w_vl9
  s_branch .g2_kernel_w_vb9
.g2_kernel_w_i13c:
  s_mov_b32 s38, 0
  s_call_b64 s[68:69], .g2_kernel_w_pkl
  s_branch .g2_kernel_w_i13b
.g2_kernel_w_v10:
  s_cmp_ge_u32 s10, 139264
  s_cselect_b32 s28, 139264, 0
  s_sub_u32 s28, s10, s28
  s_lshr_b32 s28, s28, 1
  s_add_u32 s28, s28, 32768
  s_add_u32 s22, s20, s28
  s_addc_u32 s23, s21, 0
  s_mov_b32 s38, 0
.g2_kernel_w_vl10:
  global_load_dwordx4 v[192:195], v3, s[22:23] offset:0 sc1
  global_load_dwordx4 v[196:199], v3, s[22:23] offset:1024 sc1
  global_load_dwordx4 v[200:203], v3, s[22:23] offset:2048 sc1
  global_load_dwordx4 v[204:207], v3, s[22:23] offset:3072 sc1
  s_add_u32 s38, s38, 1
  s_waitcnt vmcnt(0)
  v_min3_u32 v6, v192, v194, v196
  v_min3_u32 v7, v198, v200, v202
  v_min3_u32 v6, v6, v204, v206
  v_min_u32 v6, v6, v7
  v_cmp_eq_u32 vcc, 0, v6
  s_cbranch_vccz .g2_kernel_w_vb10
  s_cmp_lt_u32 s38, 131072
  s_cbranch_scc1 .g2_kernel_w_vl10
  s_branch .g2_kernel_w_vb10
.g2_kernel_w_i14c:
  s_mov_b32 s38, 524288
  s_call_b64 s[68:69], .g2_kernel_w_pkl
  s_branch .g2_kernel_w_i14b
.g2_kernel_w_v11:
  s_cmp_ge_u32 s11, 139264
  s_cselect_b32 s28, 139264, 0
  s_sub_u32 s28, s11, s28
  s_lshr_b32 s28, s28, 1
  s_add_u32 s28, s28, 32768
  s_add_u32 s22, s20, s28
  s_addc_u32 s23, s21, 0
  s_mov_b32 s38, 0
.g2_kernel_w_vl11:
  global_load_dwordx4 v[208:211], v3, s[22:23] offset:0 sc1
  global_load_dwordx4 v[212:215], v3, s[22:23] offset:1024 sc1
  global_load_dwordx4 v[216:219], v3, s[22:23] offset:2048 sc1
  global_load_dwordx4 v[220:223], v3, s[22:23] offset:3072 sc1
  s_add_u32 s38, s38, 1
  s_waitcnt vmcnt(0)
  v_min3_u32 v6, v208, v210, v212
  v_min3_u32 v7, v214, v216, v218
  v_min3_u32 v6, v6, v220, v222
  v_min_u32 v6, v6, v7
  v_cmp_eq_u32 vcc, 0, v6
  s_cbranch_vccz .g2_kernel_w_vb11
  s_cmp_lt_u32 s38, 131072
  s_cbranch_scc1 .g2_kernel_w_vl11
  s_branch .g2_kernel_w_vb11
.g2_kernel_w_i15c:
  s_mov_b32 s38, 524288
  s_call_b64 s[68:69], .g2_kernel_w_pkl
  s_branch .g2_kernel_w_i15b
.g2_kernel_w_v12:
  s_cmp_ge_u32 s12, 139264
  s_cselect_b32 s28, 139264, 0
  s_sub_u32 s28, s12, s28
  s_lshr_b32 s28, s28, 1
  s_add_u32 s28, s28, 32768
  s_add_u32 s22, s20, s28
  s_addc_u32 s23, s21, 0
  s_mov_b32 s38, 0
.g2_kernel_w_vl12:
  global_load_dwordx4 v[224:227], v3, s[22:23] offset:0 sc1
  global_load_dwordx4 v[228:231], v3, s[22:23] offset:1024 sc1
  global_load_dwordx4 v[232:235], v3, s[22:23] offset:2048 sc1
  global_load_dwordx4 v[236:239], v3, s[22:23] offset:3072 sc1
  s_add_u32 s38, s38, 1
  s_waitcnt vmcnt(0)
  v_min3_u32 v6, v224, v226, v228
  v_min3_u32 v7, v230, v232, v234
  v_min3_u32 v6, v6, v236, v238
  v_min_u32 v6, v6, v7
  v_cmp_eq_u32 vcc, 0, v6
  s_cbranch_vccz .g2_kernel_w_vb12
  s_cmp_lt_u32 s38, 131072
  s_cbranch_scc1 .g2_kernel_w_vl12
  s_branch .g2_kernel_w_vb12
.g2_kernel_w_v13:
  s_cmp_ge_u32 s13, 139264
  s_cselect_b32 s28, 139264, 0
  s_sub_u32 s28, s13, s28
  s_lshr_b32 s28, s28, 1
  s_add_u32 s28, s28, 32768
  s_add_u32 s22, s20, s28
  s_addc_u32 s23, s21, 0
  s_mov_b32 s38, 0
.g2_kernel_w_vl13:
  global_load_dwordx4 v[136:139], v3, s[22:23] offset:0 sc1
  global_load_dwordx4 v[140:143], v3, s[22:23] offset:1024 sc1
  global_load_dwordx4 v[144:147], v3, s[22:23] offset:2048 sc1
  global_load_dwordx4 v[148:151], v3, s[22:23] offset:3072 sc1
  s_add_u32 s38, s38, 1
  s_waitcnt vmcnt(0)
  v_min3_u32 v6, v136, v138, v140
  v_min3_u32 v7, v142, v144, v146
  v_min3_u32 v6, v6, v148, v150
  v_min_u32 v6, v6, v7
  v_cmp_eq_u32 vcc, 0, v6
  s_cbranch_vccz .g2_kernel_w_vb13
  s_cmp_lt_u32 s38, 131072
  s_cbranch_scc1 .g2_kernel_w_vl13
  s_branch .g2_kernel_w_vb13
.g2_kernel_w_v14:
  s_cmp_ge_u32 s14, 139264
  s_cselect_b32 s28, 139264, 0
  s_sub_u32 s28, s14, s28
  s_lshr_b32 s28, s28, 1
  s_add_u32 s28, s28, 32768
  s_add_u32 s22, s20, s28
  s_addc_u32 s23, s21, 0
  s_mov_b32 s38, 0
.g2_kernel_w_vl14:
  global_load_dwordx4 v[152:155], v3, s[22:23] offset:0 sc1
  global_load_dwordx4 v[156:159], v3, s[22:23] offset:1024 sc1
  global_load_dwordx4 v[160:163], v3, s[22:23] offset:2048 sc1
  global_load_dwordx4 v[164:167], v3, s[22:23] offset:3072 sc1
  s_add_u32 s38, s38, 1
  s_waitcnt vmcnt(0)
  v_min3_u32 v6, v152, v154, v156
  v_min3_u32 v7, v158, v160, v162
  v_min3_u32 v6, v6, v164, v166
  v_min_u32 v6, v6, v7
  v_cmp_eq_u32 vcc, 0, v6
  s_cbranch_vccz .g2_kernel_w_vb14
  s_cmp_lt_u32 s38, 131072
  s_cbranch_scc1 .g2_kernel_w_vl14
  s_branch .g2_kernel_w_vb14
.g2_kernel_w_v15:
  s_cmp_ge_u32 s15, 139264
  s_cselect_b32 s28, 139264, 0
  s_sub_u32 s28, s15, s28
  s_lshr_b32 s28, s28, 1
  s_add_u32 s28, s28, 32768
  s_add_u32 s22, s20, s28
  s_addc_u32 s23, s21, 0
  s_mov_b32 s38, 0
.g2_kernel_w_vl15:
  global_load_dwordx4 v[56:59], v3, s[22:23] offset:0 sc1
  global_load_dwordx4 v[60:63], v3, s[22:23] offset:1024 sc1
  global_load_dwordx4 v[64:67], v3, s[22:23] offset:2048 sc1
  global_load_dwordx4 v[68:71], v3, s[22:23] offset:3072 sc1
  s_add_u32 s38, s38, 1
  s_waitcnt vmcnt(0)
  v_min3_u32 v6, v56, v58, v60
  v_min3_u32 v7, v62, v64, v66
  v_min3_u32 v6, v6, v68, v70
  v_min_u32 v6, v6, v7
  v_cmp_eq_u32 vcc, 0, v6
  s_cbranch_vccz .g2_kernel_w_vb15
  s_cmp_lt_u32 s38, 131072
  s_cbranch_scc1 .g2_kernel_w_vl15
  s_branch .g2_kernel_w_vb15
.g2_kernel_w_bw:
  s_mov_b32 s38, 0
.g2_kernel_w_bwl:
  ds_read_b32 v16, v20 offset:12
  s_add_u32 s38, s38, 1
  s_waitcnt lgkmcnt(0)
  v_cmp_gt_u32 vcc, 4, v16
  s_cbranch_vccz .g2_kernel_w_bb
  s_cmp_lt_u32 s38, 524288
  s_cbranch_scc1 .g2_kernel_w_bwl
  s_branch .g2_kernel_w_bb
.g2_kernel_w_pick:
  s_mov_b32 s38, 0
.g2_kernel_w_pkl:
  ds_read_b64 v[6:7], v21
  s_add_u32 s38, s38, 1
  s_waitcnt lgkmcnt(0)
  v_min_u32 v6, v6, v7
  v_cmp_lt_u32 vcc, s62, v6
  s_and_b32 s36, vcc_lo, 0xff00
  s_andn2_b32 s33, s36, s34
  s_cbranch_scc1 .g2_kernel_w_pkr
  s_cmp_lt_u32 s38, 524288
  s_cbranch_scc1 .g2_kernel_w_pkl
  s_andn2_b32 s33, 0xff00, s34
.g2_kernel_w_pkr:
  s_setpc_b64 s[68:69]
.g2_kernel_p_spin:
  s_mov_b32 s38, 0
.g2_kernel_p_spinl:
  ds_read_b32 v10, v9
  s_add_u32 s38, s38, 1
  s_waitcnt lgkmcnt(0)
  v_cmp_gt_i32 vcc, s34, v10
  s_cbranch_vccz .g2_kernel_p_spinr
  s_sleep 1
  s_cmp_lt_u32 s38, 524288
  s_cbranch_scc1 .g2_kernel_p_spinl
.g2_kernel_p_spinr:
  s_setpc_b64 s[68:69]
.g2_kernel_p1_aw:
  s_call_b64 s[68:69], .g2_kernel_p_spin
  s_branch .g2_kernel_p1_ai
.g2_kernel_p1_bw:
  s_call_b64 s[68:69], .g2_kernel_p_spin
  s_branch .g2_kernel_p1_bi
.g2_kernel_v_3a:
  s_and_b32 s31, s76, 0xffffe000
  s_add_u32 s31, s31, 0
  v_and_b32 v6, 15, v2
  v_lshlrev_b32 v6, 9, v6
  v_lshrrev_b32 v7, 4, v2
  v_lshl_add_u32 v6, v7, 7, v6
  v_lshlrev_b32 v7, 2, v2
  v_add_u32 v7, 157440, v7
  s_mov_b32 m0, 157440
  s_mov_b32 s38, 0
  s_mov_b32 exec_lo, 0xffff0000
  s_mov_b32 exec_hi, 0xffff0000
.g2_kernel_pa25:
  buffer_load_dword v6, s[4:7], s31 offen sc1 lds
  s_add_u32 s38, s38, 1
  s_waitcnt vmcnt(0)
  ds_read_b32 v8, v7
  s_waitcnt lgkmcnt(0)
  v_cmp_ge_u32 vcc, s62, v8
  s_cbranch_vccz .g2_kernel_pa25d
  s_mov_b64 exec, vcc
  s_sleep 16
  s_cmp_lt_u32 s38, 131072
  s_cbranch_scc1 .g2_kernel_pa25
.g2_kernel_pa25d:
  s_mov_b64 exec, -1
  s_branch .g2_kernel_v_3
.g2_kernel_v_may:
  s_cmp_lg_u32 s39, 0
  s_cbranch_scc1 .g2_kernel_v_mr
  s_and_b32 s28, s16, 3
  s_lshl_b32 s28, s28, 4
  s_add_u32 s28, s28, 155968
  v_mov_b32 v6, s28
  ds_read_b32 v7, v6
  s_waitcnt lgkmcnt(0)
  v_cmp_ne_u32 vcc, 0, v7
  s_cbranch_vccz .g2_kernel_v_mr
.g2_kernel_v_do:
  s_mov_b32 s39, 1
  s_mov_b32 s29, 0
  s_call_b64 s[68:69], .g2_kernel_v_cmb
  s_waitcnt vmcnt(0)
  v_mov_b32 v6, s71
  s_mov_b64 exec, 1
  ds_add_u32 v6, v5 offset:8
  s_mov_b64 exec, -1
  s_and_b32 s33, s16, 3
  s_lshl_b32 s33, s33, 7
  s_lshl_b32 s28, s29, 2
  s_add_u32 s33, s33, s28
  s_add_u32 s31, s19, s33
  v_mov_b32 v6, s70
  s_mov_b64 exec, 1
  buffer_store_dword v6, v4, s[4:7], s31 offen offset:0 sc1
  s_mov_b64 exec, -1
.g2_kernel_v_mr:
  s_setpc_b64 s[26:27]
.g2_kernel_v_w23:
  ds_write_b128 v3, v[128:131] offset:32768
  ds_write_b128 v3, v[132:135] offset:33792
  ds_write_b128 v3, v[136:139] offset:34816
  ds_write_b128 v3, v[140:143] offset:35840
  ds_write_b128 v3, v[144:147] offset:36864
  ds_write_b128 v3, v[148:151] offset:37888
  ds_write_b128 v3, v[152:155] offset:38912
  ds_write_b128 v3, v[156:159] offset:39936
  ds_write_b128 v3, v[160:163] offset:40960
  ds_write_b128 v3, v[164:167] offset:41984
  ds_write_b128 v3, v[168:171] offset:43008
  ds_write_b128 v3, v[172:175] offset:44032
  ds_write_b128 v3, v[176:179] offset:45056
  ds_write_b128 v3, v[180:183] offset:46080
  ds_write_b128 v3, v[184:187] offset:47104
  ds_write_b128 v3, v[188:191] offset:48128
  ds_write_b128 v3, v[192:195] offset:49152
  ds_write_b128 v3, v[196:199] offset:50176
  ds_write_b128 v3, v[200:203] offset:51200
  ds_write_b128 v3, v[204:207] offset:52224
  ds_write_b128 v3, v[208:211] offset:53248
  ds_write_b128 v3, v[212:215] offset:54272
  ds_write_b128 v3, v[216:219] offset:55296
  ds_write_b128 v3, v[220:223] offset:56320
  ds_write_b128 v3, v[224:227] offset:57344
  ds_write_b128 v3, v[228:231] offset:58368
  ds_write_b128 v3, v[232:235] offset:59392
  ds_write_b128 v3, v[236:239] offset:60416
  ds_write_b128 v3, v[240:243] offset:61440
  ds_write_b128 v3, v[244:247] offset:62464
  ds_write_b128 v3, v[248:251] offset:63488
  ds_write_b128 v3, v[252:255] offset:64512
  s_setpc_b64 s[68:69]
.g2_kernel_v_wo:
  s_mov_b32 s8, s44
  s_mov_b32 s9, s45
  s_mov_b32 s10, 0x200000
  s_mov_b32 s11, 0x00020000
  v_lshrrev_b32 v6, 3, v2
  v_and_b32 v7, 7, v2
  v_bfe_u32 v8, v2, 4, 1
  v_lshlrev_b32 v8, 2, v8
  v_xor_b32 v7, v7, v8
  v_lshlrev_b32 v7, 4, v7
  v_lshl_add_u32 v6, v6, 11, v7
  s_lshl_b32 s31, s32, 3
  s_add_u32 s31, s31, s29
  s_lshl_b32 s31, s31, 16
  s_lshl_b32 s33, s18, 7
  s_add_u32 s31, s31, s33
  s_mov_b32 m0, s30
  s_nop 0
  buffer_load_dwordx4 v6, s[8:11], s31 offen lds
  s_add_u32 m0, m0, 1024
  s_add_u32 s31, s31, 16384
  s_sleep 1
  buffer_load_dwordx4 v6, s[8:11], s31 offen lds
  s_add_u32 m0, m0, 1024
  s_add_u32 s31, s31, 16384
  s_sleep 1
  buffer_load_dwordx4 v6, s[8:11], s31 offen lds
  s_add_u32 m0, m0, 1024
  s_add_u32 s31, s31, 16384
  s_sleep 1
  buffer_load_dwordx4 v6, s[8:11], s31 offen lds
  s_add_u32 m0, m0, 1024
  s_add_u32 s31, s31, 81920
  s_sleep 1
  buffer_load_dwordx4 v6, s[8:11], s31 offen lds
  s_add_u32 m0, m0, 1024
  s_add_u32 s31, s31, 16384
  s_sleep 1
  buffer_load_dwordx4 v6, s[8:11], s31 offen lds
  s_add_u32 m0, m0, 1024
  s_add_u32 s31, s31, 16384
  s_sleep 1
  buffer_load_dwordx4 v6, s[8:11], s31 offen lds
  s_add_u32 m0, m0, 1024
  s_add_u32 s31, s31, 16384
  s_sleep 1
  buffer_load_dwordx4 v6, s[8:11], s31 offen lds
  s_add_u32 m0, m0, 1024
  s_add_u32 s31, s31, 81920
  s_sleep 1
  buffer_load_dwordx4 v6, s[8:11], s31 offen lds
  s_add_u32 m0, m0, 1024
  s_add_u32 s31, s31, 16384
  s_sleep 1
  buffer_load_dwordx4 v6, s[8:11], s31 offen lds
  s_add_u32 m0, m0, 1024
  s_add_u32 s31, s31, 16384
  s_sleep 1
  buffer_load_dwordx4 v6, s[8:11], s31 offen lds
  s_add_u32 m0, m0, 1024
  s_add_u32 s31, s31, 16384
  s_sleep 1
  buffer_load_dwordx4 v6, s[8:11], s31 offen lds
  s_add_u32 m0, m0, 1024
  s_add_u32 s31, s31, 81920
  s_sleep 1
  buffer_load_dwordx4 v6, s[8:11], s31 offen lds
  s_add_u32 m0, m0, 1024
  s_add_u32 s31, s31, 16384
  s_sleep 1
  buffer_load_dwordx4 v6, s[8:11], s31 offen lds
  s_add_u32 m0, m0, 1024
  s_add_u32 s31, s31, 16384
  s_sleep 1
  buffer_load_dwordx4 v6, s[8:11], s31 offen lds
  s_add_u32 m0, m0, 1024
  s_add_u32 s31, s31, 16384
  s_sleep 1
  buffer_load_dwordx4 v6, s[8:11], s31 offen lds
  s_setpc_b64 s[68:69]
.g2_kernel_v_cmb:
  s_and_b32 s28, s16, 3
  s_lshl_b32 s30, s28, 2
  s_lshl_b32 s34, 15, s30
  s_lshr_b32 s32, s34, 4
  s_or_b32 s32, s32, s34
  s_mul_i32 s32, s32, s29
  v_and_b32 v6, 15, v2
  v_lshlrev_b32 v6, 2, v6
  v_add_u32 v6, 155968, v6
  s_mov_b32 s30, .g2_kernel_sel-.g2_kernel_pc
  buffer_load_dwordx4 v[8:11], v3, s[64:67], s30 offen
  buffer_load_dwordx4 v[12:15], v3, s[64:67], s30 offen offset:1024
  s_lshl_b32 s30, s28, 13
  v_add_u32 v0, s30, v3
  v_and_b32 v4, 31, v2
  s_lshl_b32 s31, s28, 9
  s_add_u32 s31, s31, 161280
  v_lshl_add_u32 v4, v4, 2, s31
  s_lshl_b32 s33, s62, 1
  s_add_u32 s33, s33, s29
  s_lshl_b32 s31, s17, 2
  s_add_u32 s31, s31, s28
  s_lshl_b32 s31, s31, 1
  s_add_u32 s31, s31, s29
  s_lshl_b32 s31, s31, 4
  s_add_u32 s31, s31, s18
  s_lshl_b32 s31, s31, 11
  s_add_u32 s31, s31, s63
  s_add_u32 s35, s31, 0x800000
  s_mov_b32 s38, 0
  s_waitcnt vmcnt(0)
.g2_kernel_v_cmbw:
  ds_read_b32 v7, v6
  s_add_u32 s38, s38, 1
  s_waitcnt lgkmcnt(0)
  v_cmp_ge_u32 vcc, s33, v7
  s_and_b32 s30, vcc_lo, s34
  s_cbranch_scc0 .g2_kernel_v_cmbd
  s_orn2_b32 s30, vcc_lo, s32
  s_cmp_lg_u32 s30, -1
  s_cbranch_scc1 .g2_kernel_v_cmbq
  s_sleep 6
.g2_kernel_v_cmbq:
  s_sleep 1
  s_cmp_lt_u32 s38, 524288
  s_cbranch_scc1 .g2_kernel_v_cmbw
.g2_kernel_v_cmbd:
  s_setprio 3
  ds_read_b128 v[32:35], v0 offset:0
  ds_read_b128 v[36:39], v0 offset:1024
  ds_read_b128 v[40:43], v0 offset:2048
  ds_read_b128 v[44:47], v0 offset:3072
  ds_read_b128 v[48:51], v0 offset:4096
  ds_read_b128 v[52:55], v0 offset:5120
  ds_read_b128 v[56:59], v0 offset:6144
  ds_read_b128 v[60:63], v0 offset:7168
  ds_read2_b32 v[6:7], v4 offset0:64 offset1:96
  ds_read2_b32 v[4:5], v4 offset0:0 offset1:32
  s_lshl_b32 s30, s28, 2
  s_add_u32 s30, s30, s71
  s_waitcnt lgkmcnt(9)
  v_mfma_f32_32x32x16_bf16 v[16:31], v[8:11], v[32:35], 0
  s_waitcnt lgkmcnt(8)
  v_mfma_f32_32x32x16_bf16 v[16:31], v[12:15], v[36:39], v[16:31]
  s_waitcnt lgkmcnt(7)
  v_mfma_f32_32x32x16_bf16 v[16:31], v[8:11], v[40:43], v[16:31]
  s_waitcnt lgkmcnt(6)
  v_mfma_f32_32x32x16_bf16 v[16:31], v[12:15], v[44:47], v[16:31]
  s_waitcnt lgkmcnt(5)
  v_mfma_f32_32x32x16_bf16 v[16:31], v[8:11], v[48:51], v[16:31]
  s_waitcnt lgkmcnt(4)
  v_mfma_f32_32x32x16_bf16 v[16:31], v[12:15], v[52:55], v[16:31]
  s_waitcnt lgkmcnt(3)
  v_mfma_f32_32x32x16_bf16 v[16:31], v[8:11], v[56:59], v[16:31]
  s_waitcnt lgkmcnt(2)
  v_mfma_f32_32x32x16_bf16 v[16:31], v[12:15], v[60:63], v[16:31]
  v_mov_b32 v0, s30
  s_waitcnt lgkmcnt(0)
  v_add_f32 v6, v6, v4
  v_add_f32 v7, v7, v5
  v_mov_b32 v4, 0
  v_mov_b32 v5, s29
  ds_write_b32 v0, v5 offset:64
  v_add_f32 v9, v6, v7
  s_mov_b32 s30, 8.673617379884035e-19
  s_mov_b32 s31, 1.152921504606847e+18
  v_rcp_f32 v10, v9
  v_cmp_le_f32 vcc, s30, v9
  v_cmp_ge_f32 s[36:37], s31, v9
  v_mov_b32 v5, 1
  v_mul_f32 v10, 4.0, v10
  s_and_b64 s[36:37], s[36:37], vcc
  v_cmp_o_f32 vcc, v16, v16
  s_and_b64 vcc, vcc, s[36:37]
  s_cmp_eq_u64 vcc, -1
  s_cbranch_scc0 .g2_kernel_v_cmbslow
.g2_kernel_v_cmbfin:
  v_mul_f32 v16, v16, v10
  v_mul_f32 v17, v17, v10
  v_mul_f32 v18, v18, v10
  v_mul_f32 v19, v19, v10
  v_mul_f32 v20, v20, v10
  v_mul_f32 v21, v21, v10
  v_mul_f32 v22, v22, v10
  v_mul_f32 v23, v23, v10
  v_cvt_pk_bf16_f32 v32, v16, v17
  v_cvt_pk_bf16_f32 v33, v18, v19
  v_cvt_pk_bf16_f32 v34, v20, v21
  v_cvt_pk_bf16_f32 v35, v22, v23
  v_max_u32 v32, 1, v32
  v_max_u32 v34, 1, v34
  buffer_store_dwordx4 v[32:35], v3, s[4:7], s35 offen offset:0 sc1
  v_mul_f32 v24, v24, v10
  v_mul_f32 v25, v25, v10
  v_mul_f32 v26, v26, v10
  v_mul_f32 v27, v27, v10
  v_mul_f32 v28, v28, v10
  v_mul_f32 v29, v29, v10
  v_mul_f32 v30, v30, v10
  v_mul_f32 v31, v31, v10
  v_cvt_pk_bf16_f32 v36, v24, v25
  v_cvt_pk_bf16_f32 v37, v26, v27
  v_cvt_pk_bf16_f32 v38, v28, v29
  v_cvt_pk_bf16_f32 v39, v30, v31
  v_max_u32 v36, 1, v36
  v_max_u32 v38, 1, v38
  buffer_store_dwordx4 v[36:39], v3, s[4:7], s35 offen offset:1024 sc1
  s_setprio 3
  s_setpc_b64 s[68:69]
.g2_kernel_v_cmbslow:
  s_setprio 0
  s_lshl_b32 s30, s28, 11
  s_mul_i32 s31, s29, -8192
  s_add_u32 s30, s30, s31
  s_add_u32 s30, s30, 139264
  v_add_u32 v6, s30, v3
  ds_read_b128 v[48:51], v6
  ds_read_b128 v[52:55], v6 offset:1024
  s_lshl_b32 s36, s18, 1
  s_add_u32 s36, s36, s29
  s_lshl_b32 s36, s36, 18
  s_add_u32 s36, s36, s63
  s_mov_b32 s30, s36
  s_mov_b32 s33, 64
  v_mov_b32 v10, 0xff800000
  s_waitcnt lgkmcnt(0)
.g2_kernel_v_cmbs1:
  buffer_load_dwordx4 v[56:59], v3, s[4:7], s30 offen offset:0
  buffer_load_dwordx4 v[60:63], v3, s[4:7], s30 offen offset:1024
  s_waitcnt vmcnt(0)
  v_mfma_f32_32x32x16_bf16 v[32:47], v[56:59], v[48:51], 0
  v_mfma_f32_32x32x16_bf16 v[32:47], v[60:63], v[52:55], v[32:47]
  s_nop 11
  v_max3_f32 v10, v10, v32, v33
  v_max3_f32 v10, v10, v34, v35
  v_max3_f32 v10, v10, v36, v37
  v_max3_f32 v10, v10, v38, v39
  v_max3_f32 v10, v10, v40, v41
  v_max3_f32 v10, v10, v42, v43
  v_max3_f32 v10, v10, v44, v45
  v_max3_f32 v10, v10, v46, v47
  s_add_u32 s30, s30, 4096
  s_sub_u32 s33, s33, 1
  s_cmp_lg_u32 s33, 0
  s_cbranch_scc1 .g2_kernel_v_cmbs1
  v_mov_b32 v11, v10
  s_nop 1
  v_permlane32_swap_b32 v11, v10
  v_max_f32 v10, v10, v11
  v_mov_b32 v9, 0
  v_mov_b32 v16, 0
  v_mov_b32 v17, 0
  v_mov_b32 v18, 0
  v_mov_b32 v19, 0
  v_mov_b32 v20, 0
  v_mov_b32 v21, 0
  v_mov_b32 v22, 0
  v_mov_b32 v23, 0
  v_mov_b32 v24, 0
  v_mov_b32 v25, 0
  v_mov_b32 v26, 0
  v_mov_b32 v27, 0
  v_mov_b32 v28, 0
  v_mov_b32 v29, 0
  v_mov_b32 v30, 0
  v_mov_b32 v31, 0
  s_mov_b32 s30, s36
  s_mov_b32 s33, 64
.g2_kernel_v_cmbs2:
  buffer_load_dwordx4 v[56:59], v3, s[4:7], s30 offen offset:0
  buffer_load_dwordx4 v[60:63], v3, s[4:7], s30 offen offset:1024
  s_waitcnt vmcnt(0)
  v_mfma_f32_32x32x16_bf16 v[32:47], v[56:59], v[48:51], 0
  v_mfma_f32_32x32x16_bf16 v[32:47], v[60:63], v[52:55], v[32:47]
  s_nop 11
  v_sub_f32 v32, v32, v10
  v_sub_f32 v33, v33, v10
  v_sub_f32 v34, v34, v10
  v_sub_f32 v35, v35, v10
  v_sub_f32 v36, v36, v10
  v_sub_f32 v37, v37, v10
  v_sub_f32 v38, v38, v10
  v_sub_f32 v39, v39, v10
  v_sub_f32 v40, v40, v10
  v_sub_f32 v41, v41, v10
  v_sub_f32 v42, v42, v10
  v_sub_f32 v43, v43, v10
  v_sub_f32 v44, v44, v10
  v_sub_f32 v45, v45, v10
  v_sub_f32 v46, v46, v10
  v_sub_f32 v47, v47, v10
  buffer_load_dwordx4 v[56:59], v3, s[4:7], s30 offen offset:2048
  buffer_load_dwordx4 v[60:63], v3, s[4:7], s30 offen offset:3072
  v_exp_f32 v32, v32
  v_exp_f32 v33, v33
  v_exp_f32 v34, v34
  v_exp_f32 v35, v35
  v_exp_f32 v36, v36
  v_exp_f32 v37, v37
  v_exp_f32 v38, v38
  v_exp_f32 v39, v39
  v_exp_f32 v40, v40
  v_exp_f32 v41, v41
  v_exp_f32 v42, v42
  v_exp_f32 v43, v43
  v_exp_f32 v44, v44
  v_exp_f32 v45, v45
  v_exp_f32 v46, v46
  v_exp_f32 v47, v47
  v_add_f32 v9, v9, v32
  v_add_f32 v9, v9, v33
  v_add_f32 v9, v9, v34
  v_add_f32 v9, v9, v35
  v_add_f32 v9, v9, v36
  v_add_f32 v9, v9, v37
  v_add_f32 v9, v9, v38
  v_add_f32 v9, v9, v39
  v_add_f32 v9, v9, v40
  v_add_f32 v9, v9, v41
  v_add_f32 v9, v9, v42
  v_add_f32 v9, v9, v43
  v_add_f32 v9, v9, v44
  v_add_f32 v9, v9, v45
  v_add_f32 v9, v9, v46
  v_add_f32 v9, v9, v47
  v_cvt_pk_bf16_f32 v32, v32, v33
  v_cvt_pk_bf16_f32 v33, v34, v35
  v_cvt_pk_bf16_f32 v34, v36, v37
  v_cvt_pk_bf16_f32 v35, v38, v39
  v_cvt_pk_bf16_f32 v36, v40, v41
  v_cvt_pk_bf16_f32 v37, v42, v43
  v_cvt_pk_bf16_f32 v38, v44, v45
  v_cvt_pk_bf16_f32 v39, v46, v47
  s_waitcnt vmcnt(0)
  v_mfma_f32_32x32x16_bf16 v[16:31], v[56:59], v[32:35], v[16:31]
  v_mfma_f32_32x32x16_bf16 v[16:31], v[60:63], v[36:39], v[16:31]
  s_nop 15
  s_add_u32 s30, s30, 4096
  s_sub_u32 s33, s33, 1
  s_cmp_lg_u32 s33, 0
  s_cbranch_scc1 .g2_kernel_v_cmbs2
  v_mov_b32 v11, v9
  s_nop 1
  v_permlane32_swap_b32 v11, v9
  v_add_f32 v9, v9, v11
  v_rcp_f32 v10, v9
  s_branch .g2_kernel_v_cmbfin
.g2_kernel_p2_xw:
  s_mov_b32 s38, 0
.g2_kernel_p2_xwl:
  ds_read_b32 v12, v11
  s_add_u32 s38, s38, 1
  s_waitcnt lgkmcnt(0)
  v_cmp_ne_u32 vcc, 0, v12
  s_and_b32 s37, vcc_lo, vcc_hi
  s_lshr_b32 s33, s37, 16
  s_and_b32 s37, s37, s33
  s_bitcmp1_b32 s37, s28
  s_cbranch_scc1 .g2_kernel_p2_xwr
  s_sleep 1
  s_cmp_lt_u32 s38, 524288
  s_cbranch_scc1 .g2_kernel_p2_xwl
.g2_kernel_p2_xwr:
  s_setpc_b64 s[68:69]
.g2_kernel_p2_x0w:
  s_call_b64 s[68:69], .g2_kernel_p2_xw
  s_branch .g2_kernel_p2_x0b
.g2_kernel_p2_x1w:
  s_call_b64 s[68:69], .g2_kernel_p2_xw
  s_branch .g2_kernel_p2_x1b
.g2_kernel_p2_x2w:
  s_call_b64 s[68:69], .g2_kernel_p2_xw
  s_branch .g2_kernel_p2_x2b
.g2_kernel_p2_aw:
  s_call_b64 s[68:69], .g2_kernel_p_spin
  s_branch .g2_kernel_p2_ai
.g2_kernel_p2_x3w:
  s_call_b64 s[68:69], .g2_kernel_p2_xw
  s_branch .g2_kernel_p2_x3b
.g2_kernel_p2_bw:
  s_call_b64 s[68:69], .g2_kernel_p_spin
  s_branch .g2_kernel_p2_bi
.g2_kernel_amax:
  v_mov_b32 v16, 0xff7fffff
  v_lshlrev_b32 v7, 7, v2
  s_mov_b32 s38, 0
  s_mov_b64 exec, s[8:9]
.g2_kernel_amaxl:
  buffer_load_dwordx2 v[16:17], v7, s[4:7], s23 offen sc1
  s_add_u32 s38, s38, 1
  s_waitcnt vmcnt(0)
  v_cmp_eq_u32 vcc, 0, v17
  s_cbranch_vccz .g2_kernel_amaxd
  s_mov_b64 exec, vcc
  s_sleep 4
  s_cmp_lg_u32 s62, 0
  s_cbranch_scc1 .g2_kernel_nap58
  s_sleep 8
.g2_kernel_nap58:
  s_cmp_eq_u32 s39, 1
  s_cbranch_scc0 .g2_kernel_amaxz
  s_sleep 8
.g2_kernel_amaxz:
  s_cmp_lt_u32 s38, 131072
  s_cbranch_scc1 .g2_kernel_amaxl
.g2_kernel_amaxd:
  s_mov_b64 exec, -1
  v_mov_b32 v6, v16
  s_nop 1
  v_max_f32 v7, v6, v6 row_ror:8 row_mask:0xf bank_mask:0xf
  s_nop 1
  v_max_f32 v7, v7, v7 row_ror:4 row_mask:0xf bank_mask:0xf
  s_nop 1
  v_max_f32 v7, v7, v7 row_ror:2 row_mask:0xf bank_mask:0xf
  s_nop 1
  v_max_f32 v7, v7, v7 row_ror:1 row_mask:0xf bank_mask:0xf
  s_nop 1
  v_max_f32 v7, v7, v7 row_bcast:15 row_mask:0xa bank_mask:0xf
  s_nop 1
  v_max_f32 v7, v7, v7 row_bcast:31 row_mask:0xc bank_mask:0xf
  s_nop 0
  v_readlane_b32 s27, v7, 63
  s_nop 1
  v_cmp_eq_u32 vcc, s27, v6
  s_ff1_i32_b64 s77, vcc
  s_lshl_b32 s77, s77, 5
  s_and_b32 s28, s27, 31
  s_add_u32 s77, s77, s28
  s_and_b32 s77, s77, 2047
  s_setpc_b64 s[68:69]
  .p2align 8
.g2_kernel_tab:
  .long 0, 1, 2, 3, 4, 5, 6, 7
  .long 8, 9, 10, 11, 12, 13, 14, 15
  .long 16, 17, 18, 19, 20, 21, 22, 23
  .long 24, 25, 26, 27, 28, 29, 30, 31
  .long 32, 33, 34, 35, 36, 37, 38, 39
  .long 40, 41, 42, 43, 44, 45, 46, 47
  .long 48, 49, 50, 51, 52, 53, 54, 55
  .long 56, 57, 58, 59, 60, 61, 62, 63
  .long 64, 65, 66, 67, 68, 69, 70, 71
  .p2align 4
.g2_kernel_sel:
  .long 0x3e80, 0x0, 0x0, 0x0
  .long 0x3e800000, 0x0, 0x0, 0x0
  .long 0x0, 0x3e80, 0x0, 0x0
  .long 0x0, 0x3e800000, 0x0, 0x0
  .long 0x0, 0x0, 0x0, 0x0
  .long 0x0, 0x0, 0x0, 0x0
  .long 0x0, 0x0, 0x0, 0x0
  .long 0x0, 0x0, 0x0, 0x0
  .long 0x0, 0x0, 0x3e80, 0x0
  .long 0x0, 0x0, 0x3e800000, 0x0
  .long 0x0, 0x0, 0x0, 0x3e80
  .long 0x0, 0x0, 0x0, 0x3e800000
  .long 0x0, 0x0, 0x0, 0x0
  .long 0x0, 0x0, 0x0, 0x0
  .long 0x0, 0x0, 0x0, 0x0
  .long 0x0, 0x0, 0x0, 0x0
  .long 0x0, 0x0, 0x0, 0x0
  .long 0x0, 0x0, 0x0, 0x0
  .long 0x0, 0x0, 0x0, 0x0
  .long 0x0, 0x0, 0x0, 0x0
  .long 0x0, 0x0, 0x0, 0x0
  .long 0x0, 0x0, 0x0, 0x0
  .long 0x0, 0x0, 0x0, 0x0
  .long 0x0, 0x0, 0x0, 0x0
  .long 0x0, 0x0, 0x0, 0x0
  .long 0x0, 0x0, 0x0, 0x0
  .long 0x0, 0x0, 0x0, 0x0
  .long 0x0, 0x0, 0x0, 0x0
  .long 0x0, 0x0, 0x0, 0x0
  .long 0x0, 0x0, 0x0, 0x0
  .long 0x0, 0x0, 0x0, 0x0
  .long 0x0, 0x0, 0x0, 0x0
  .long 0x0, 0x0, 0x0, 0x0
  .long 0x0, 0x0, 0x0, 0x0
  .long 0x0, 0x0, 0x0, 0x0
  .long 0x0, 0x0, 0x0, 0x0
  .long 0x3e80, 0x0, 0x0, 0x0
  .long 0x3e800000, 0x0, 0x0, 0x0
  .long 0x0, 0x3e80, 0x0, 0x0
  .long 0x0, 0x3e800000, 0x0, 0x0
  .long 0x0, 0x0, 0x0, 0x0
  .long 0x0, 0x0, 0x0, 0x0
  .long 0x0, 0x0, 0x0, 0x0
  .long 0x0, 0x0, 0x0, 0x0
  .long 0x0, 0x0, 0x3e80, 0x0
  .long 0x0, 0x0, 0x3e800000, 0x0
  .long 0x0, 0x0, 0x0, 0x3e80
  .long 0x0, 0x0, 0x0, 0x3e800000
  .long 0x0, 0x0, 0x0, 0x0
  .long 0x0, 0x0, 0x0, 0x0
  .long 0x0, 0x0, 0x0, 0x0
  .long 0x0, 0x0, 0x0, 0x0
  .long 0x0, 0x0, 0x0, 0x0
  .long 0x0, 0x0, 0x0, 0x0
  .long 0x0, 0x0, 0x0, 0x0
  .long 0x0, 0x0, 0x0, 0x0
  .long 0x0, 0x0, 0x0, 0x0
  .long 0x0, 0x0, 0x0, 0x0
  .long 0x0, 0x0, 0x0, 0x0
  .long 0x0, 0x0, 0x0, 0x0
  .long 0x0, 0x0, 0x0, 0x0
  .long 0x0, 0x0, 0x0, 0x0
  .long 0x0, 0x0, 0x0, 0x0
  .long 0x0, 0x0, 0x0, 0x0
  .long 0x0, 0x0, 0x0, 0x0
  .long 0x0, 0x0, 0x0, 0x0
  .long 0x0, 0x0, 0x0, 0x0
  .long 0x0, 0x0, 0x0, 0x0
  .long 0x0, 0x0, 0x0, 0x0
  .long 0x0, 0x0, 0x0, 0x0
  .long 0x0, 0x0, 0x0, 0x0
  .long 0x0, 0x0, 0x0, 0x0
  .long 0x0, 0x0, 0x0, 0x0
  .long 0x0, 0x0, 0x0, 0x0
  .long 0x0, 0x0, 0x0, 0x0
  .long 0x0, 0x0, 0x0, 0x0
  .long 0x0, 0x0, 0x0, 0x0
  .long 0x0, 0x0, 0x0, 0x0
  .long 0x0, 0x0, 0x0, 0x0
  .long 0x0, 0x0, 0x0, 0x0
  .long 0x3e80, 0x0, 0x0, 0x0
  .long 0x3e800000, 0x0, 0x0, 0x0
  .long 0x0, 0x3e80, 0x0, 0x0
  .long 0x0, 0x3e800000, 0x0, 0x0
  .long 0x0, 0x0, 0x0, 0x0
  .long 0x0, 0x0, 0x0, 0x0
  .long 0x0, 0x0, 0x0, 0x0
  .long 0x0, 0x0, 0x0, 0x0
  .long 0x0, 0x0, 0x3e80, 0x0
  .long 0x0, 0x0, 0x3e800000, 0x0
  .long 0x0, 0x0, 0x0, 0x3e80
  .long 0x0, 0x0, 0x0, 0x3e800000
  .long 0x0, 0x0, 0x0, 0x0
  .long 0x0, 0x0, 0x0, 0x0
  .long 0x0, 0x0, 0x0, 0x0
  .long 0x0, 0x0, 0x0, 0x0
  .long 0x0, 0x0, 0x0, 0x0
  .long 0x0, 0x0, 0x0, 0x0
  .long 0x0, 0x0, 0x0, 0x0
  .long 0x0, 0x0, 0x0, 0x0
  .long 0x0, 0x0, 0x0, 0x0
  .long 0x0, 0x0, 0x0, 0x0
  .long 0x0, 0x0, 0x0, 0x0
  .long 0x0, 0x0, 0x0, 0x0
  .long 0x0, 0x0, 0x0, 0x0
  .long 0x0, 0x0, 0x0, 0x0
  .long 0x0, 0x0, 0x0, 0x0
  .long 0x0, 0x0, 0x0, 0x0
  .long 0x0, 0x0, 0x0, 0x0
  .long 0x0, 0x0, 0x0, 0x0
  .long 0x0, 0x0, 0x0, 0x0
  .long 0x0, 0x0, 0x0, 0x0
  .long 0x0, 0x0, 0x0, 0x0
  .long 0x0, 0x0, 0x0, 0x0
  .long 0x0, 0x0, 0x0, 0x0
  .long 0x0, 0x0, 0x0, 0x0
  .long 0x3e80, 0x0, 0x0, 0x0
  .long 0x3e800000, 0x0, 0x0, 0x0
  .long 0x0, 0x3e80, 0x0, 0x0
  .long 0x0, 0x3e800000, 0x0, 0x0
  .long 0x0, 0x0, 0x0, 0x0
  .long 0x0, 0x0, 0x0, 0x0
  .long 0x0, 0x0, 0x0, 0x0
  .long 0x0, 0x0, 0x0, 0x0
  .long 0x0, 0x0, 0x3e80, 0x0
  .long 0x0, 0x0, 0x3e800000, 0x0
  .long 0x0, 0x0, 0x0, 0x3e80
  .long 0x0, 0x0, 0x0, 0x3e800000
.g2_kernel_cend:

.section .rodata,"a"
.p2align 6
.amdhsa_kernel g2_kernel
  .amdhsa_next_free_vgpr 256
  .amdhsa_next_free_sgpr 102
  .amdhsa_accum_offset 256
  .amdhsa_group_segment_fixed_size 0
  .amdhsa_kernarg_size 88
  .amdhsa_user_sgpr_count 2
  .amdhsa_user_sgpr_kernarg_segment_ptr 1
  .amdhsa_system_sgpr_workgroup_id_x 1
.end_amdhsa_kernel
```

```asm
; @launch kernel=g2_kernel grid=(256,1,1) block=(512,1,1) lds=163840
.amdgcn_target "amdgcn-amd-amdhsa--gfx950"
.text
.globl g2_kernel
.p2align 8
.type g2_kernel,@function
g2_kernel:
  s_cmp_ge_u32 s2, 256
  s_cbranch_scc1 .g2_kernel_end
  s_load_dwordx16 s[40:55], s[0:1], 0
  s_load_dwordx4 s[56:59], s[0:1], 64
  s_load_dwordx2 s[60:61], s[0:1], 80
  s_getpc_b64 s[64:65]
.g2_kernel_pc:
  s_mov_b32 s66, .g2_kernel_cend-.g2_kernel_pc
  s_mov_b32 s67, 0x00020000
  s_lshl_b32 s12, s2, 10
  s_and_b32 s12, s12, 0xe000
  v_lshrrev_b32 v3, 3, v0
  v_and_b32 v2, 7, v0
  v_and_b32 v3, 0x38, v3
  v_add_lshl_u32 v3, v3, v2, 7
  s_mov_b64 exec, 0xff
  buffer_load_dword v1, v3, s[64:67], s12 offen
  s_mov_b64 exec, -1
  v_lshrrev_b32 v3, 6, v0
  v_and_b32 v2, 63, v0
  v_readfirstlane_b32 s16, v3
  s_and_b32 s21, s2, 7
  s_lshr_b32 s22, s2, 3
  s_and_b32 s23, s21, 3
  s_lshl_b32 s23, s23, 2
  s_and_b32 s24, s22, 3
  s_add_u32 s18, s23, s24
  s_lshr_b32 s24, s21, 2
  s_lshl_b32 s24, s24, 3
  s_lshr_b32 s25, s22, 2
  s_add_u32 s17, s24, s25
  s_lshl_b32 s19, s17, 4
  s_add_u32 s19, s19, s18
  s_lshl_b32 s19, s19, 9
  s_add_u32 s19, s19, 0x3000000
  s_lshl_b32 s76, s18, 4
  s_add_u32 s76, s76, s17
  s_lshl_b32 s76, s76, 9
  s_add_u32 s76, s76, 0x3020000
  v_lshlrev_b32 v3, 4, v2
  v_mov_b32 v4, 0
  v_mov_b32 v5, 1
  s_mov_b32 s62, 0
  s_mov_b32 s63, 0
  s_mov_b32 s70, 1
  s_mov_b32 s71, 155648
  s_waitcnt lgkmcnt(0)
  s_mov_b32 s4, s60
  s_mov_b32 s5, s61
  s_mov_b32 s6, 0x3300000
  s_mov_b32 s7, 0x00020000
  s_cmp_ge_u32 s16, 4
  s_cbranch_scc1 .g2_kernel_svc
  v_mov_b32 v20, 0
  v_mov_b32 v21, 0
  v_mov_b32 v22, 0
  v_mov_b32 v23, 0
  v_lshlrev_b32 v24, 4, v0
  v_cmp_gt_u32 vcc, 2816, v24
  v_add_u32 v24, 155648, v24
  s_and_saveexec_b64 s[20:21], vcc
  s_cbranch_execz .g2_kernel_q_nz
  ds_write_b128 v24, v[20:23]
.g2_kernel_q_nz:
  s_mov_b64 exec, -1
  v_and_b32 v20, 15, v2
  v_lshrrev_b32 v21, 4, v2
  v_lshrrev_b32 v22, 1, v20
  v_xor_b32 v22, v22, v21
  v_lshlrev_b32 v22, 4, v22
  v_lshl_add_u32 v22, v20, 7, v22
  s_lshr_b32 s26, s16, 1
  s_lshl_b32 s26, s26, 13
  v_add_u32 v144, s26, v22
  v_xor_b32 v145, 64, v144
.g2_kernel_q_cs:
  s_and_b32 s27, s16, 1
  s_lshr_b32 s26, s16, 1
  v_bfe_u32 v20, v2, 2, 2
  v_lshrrev_b32 v49, 4, v2
  v_lshl_add_u32 v22, v49, 3, v20
  v_lshlrev_b32 v22, 7, v22
  v_lshrrev_b32 v23, 1, v20
  v_and_b32 v21, 1, v49
  v_xor_b32 v21, s27, v21
  v_lshl_add_u32 v23, v21, 1, v23
  v_lshl_add_u32 v22, v23, 5, v22
  v_and_b32 v23, 3, v2
  v_lshl_add_u32 v22, v23, 3, v22
  v_add_u32 v148, 65536, v22
  v_xor_b32 v149, 32, v148
  v_mov_b32 v146, v148
  v_mov_b32 v147, v149
  v_mov_b32 v150, 156160
  v_and_b32 v48, 15, v2
  s_lshl_b32 s28, s26, 8
  s_add_u32 s28, s28, 155648
  v_lshl_add_u32 v50, v48, 2, s28
  v_lshl_add_u32 v51, v49, 4, s28
  s_lshl_b32 s28, s27, 7
  s_add_u32 s28, s28, 155648
  v_lshl_add_u32 v52, v49, 4, s28
  s_xor_b32 s28, s28, 128
  v_lshl_add_u32 v53, v48, 2, s28
  v_lshlrev_b32 v54, 9, v49
  v_lshl_add_u32 v55, v48, 4, v54
  v_and_b32 v56, 8, v48
  v_lshl_add_u32 v54, v56, 4, v55
  v_mov_b32 v56, 0.25503486164919736
  v_lshlrev_b32 v58, 2, v2
  v_and_b32 v58, 12, v58
  v_add_u32 v58, 156416, v58
  s_lshl_b32 s8, s18, 7
  s_lshl_b32 s9, s17, 2
  s_add_u32 s8, s8, s9
  s_lshl_b32 s9, s26, 1
  s_add_u32 s8, s8, s9
  s_lshl_b32 s8, s8, 12
  s_add_u32 s8, s8, s63
  s_add_u32 s9, s8, 4096
  s_lshl_b32 s28, s26, 13
  s_lshl_b32 s10, s27, 14
  s_add_u32 s28, s28, s10
  v_add_u32 v59, s28, v54
  s_xor_b32 s28, s28, 16384
  v_add_u32 v60, s28, v55
  s_lshl_b32 s28, s26, 12
  s_mul_i32 s10, s27, -8192
  s_add_u32 s28, s28, s10
  s_add_u32 s28, s28, 139264
  v_add_u32 v61, s28, v55
  s_mov_b32 s10, s27
  s_lshl_b32 s28, s26, 2
  s_add_u32 s28, s28, s71
  v_mov_b32 v62, s28
  s_lshl_b32 s12, s62, 5
  s_add_u32 s12, s12, 28
  v_and_b32 v6, 15, v2
  v_xor_b32 v6, s17, v6
  v_and_b32 v7, 16, v2
  v_add_u32 v6, v6, v7
  s_lshr_b32 s28, s16, 1
  s_lshl_b32 s28, s28, 7
  s_add_u32 s28, s28, 157440
  v_lshl_add_u32 v8, v6, 2, s28
  s_lshl_b32 s28, s16, 12
  v_add_u32 v9, s28, v3
  v_and_b32 v6, 31, v2
  s_lshl_b32 s28, s16, 7
  s_add_u32 s28, s28, 161280
  v_lshl_add_u32 v10, v6, 2, s28
  s_lshl_b32 s28, s16, 2
  s_add_u32 s28, s28, 155968
  v_mov_b32 v11, s28
  s_lshl_b32 s28, s62, 1
  s_add_u32 s28, s28, 1
  v_mov_b32 v12, s28
  v_mov_b32 v13, s71
  v_add_u32 v14, 131072, v3
  v_and_b32 v6, 4, v2
  v_cmp_eq_u32 vcc, 0, v6
  v_mov_b32 v7, 0x3f803f80
  v_and_b32 v6, 1, v2
  v_cndmask_b32 v16, 0, v7, vcc
  v_cndmask_b32 v17, 0, v7, vcc
  v_cndmask_b32 v18, v7, 0, vcc
  v_cndmask_b32 v19, v7, 0, vcc
  v_mul_u32_u24 v20, 0xaaaa, v6
  v_add_u32 v20, 0x4444, v20
  s_lshl_b32 s28, s18, 7
  s_add_u32 s28, s28, s16
  s_lshl_b32 s28, s28, 12
  s_add_u32 s28, s28, s63
  s_add_u32 s20, s60, s28
  s_addc_u32 s21, s61, 0
  s_mov_b32 s24, s17
  s_mov_b32 s25, 14
  s_mov_b32 s26, 0
  s_mov_b32 s27, 6
  s_mov_b32 s34, 0xffff0001
  s_mov_b32 s35, 0
  s_mov_b32 s36, 0
  s_mov_b32 s39, 0
  s_and_b32 s28, s16, 2
  s_lshl_b32 s28, s28, 7
  s_add_u32 s37, s76, s28
  v_mov_b32 v15, s70
  v_lshrrev_b32 v6, 5, v2
  v_and_b32 v7, 15, v2
  v_lshlrev_b32 v22, 4, v7
  v_lshl_add_u32 v22, v6, 8, v22
  v_and_b32 v7, 16, v2
  v_lshl_add_u32 v22, v7, 7, v22
  v_and_b32 v7, 31, v2
  v_lshlrev_b32 v23, 4, v6
  v_lshl_add_u32 v23, v7, 11, v23
  s_lshl_b32 s28, s17, 2
  s_add_u32 s28, s28, s16
  s_lshl_b32 s28, s28, 16
  s_lshl_b32 s29, s18, 7
  s_add_u32 s28, s28, s29
  s_add_u32 s74, s40, s28
  s_addc_u32 s75, s41, 0
  s_lshl_b32 s13, s17, 4
  s_add_u32 s13, s13, s18
  s_lshl_b32 s13, s13, 2
  s_add_u32 s13, s13, s16
  s_lshl_b32 s13, s13, 12
  s_add_u32 s13, s13, 0xc00000
  s_lshl_b32 s28, s16, 2
  s_add_u32 m0, s28, 156416
  s_lshl_b32 s33, s62, 5
  s_lshl_b32 s31, s33, 2
  s_add_u32 s31, s31, .g2_kernel_tab-.g2_kernel_pc+4
  s_mov_b32 s29, 0
  s_cmp_lg_u32 s62, 0
  s_cbranch_scc1 .g2_kernel_q_i2
  s_waitcnt lgkmcnt(0)
  s_barrier
.g2_kernel_q_i3:
  s_call_b64 s[68:69], .g2_kernel_q_spin
  ds_read_b64_tr_b16 v[80:81], v146 offset:0
  ds_read_b64_tr_b16 v[82:83], v146 offset:512
  ds_read_b128 v[64:67], v144 offset:0
  ds_read_b128 v[68:71], v144 offset:2048
  ds_read_b128 v[72:75], v144 offset:4096
  ds_read_b128 v[76:79], v144 offset:6144
  ds_read_b64_tr_b16 v[84:85], v147 offset:0
  ds_read_b64_tr_b16 v[86:87], v147 offset:512
  ds_read_b64_tr_b16 v[88:89], v146 offset:4096
  ds_read_b64_tr_b16 v[90:91], v146 offset:4608
  ds_read_b64_tr_b16 v[92:93], v147 offset:4096
  ds_read_b64_tr_b16 v[94:95], v147 offset:4608
  ds_read_b64_tr_b16 v[96:97], v146 offset:8192
  ds_read_b64_tr_b16 v[98:99], v146 offset:8704
  ds_read_b64_tr_b16 v[100:101], v147 offset:8192
  ds_read_b64_tr_b16 v[102:103], v147 offset:8704
  s_mov_b32 s30, 12288
  s_add_u32 s33, s33, 1
  v_add_u32 v146, s30, v148
  v_add_u32 v147, s30, v149
  s_waitcnt lgkmcnt(0)
  v_mfma_f32_16x16x32_bf16 v[160:163], v[80:83], v[64:67], 0
  v_cmp_lt_i32 vcc, s33, v151
  v_mfma_f32_16x16x32_bf16 v[164:167], v[80:83], v[68:71], 0
  s_cbranch_vccz .g2_kernel_q_wf
.g2_kernel_q_backf:
  v_mfma_f32_16x16x32_bf16 v[168:171], v[80:83], v[72:75], 0
  ds_read_b64_tr_b16 v[120:121], v146 offset:0
  v_mfma_f32_16x16x32_bf16 v[172:175], v[80:83], v[76:79], 0
  ds_read_b64_tr_b16 v[122:123], v146 offset:512
  v_mfma_f32_16x16x32_bf16 v[188:191], v[84:87], v[76:79], 0
  ds_read_b128 v[104:107], v145 offset:0
  v_mfma_f32_16x16x32_bf16 v[184:187], v[84:87], v[72:75], 0
  ds_read_b128 v[108:111], v145 offset:2048
  v_mfma_f32_16x16x32_bf16 v[180:183], v[84:87], v[68:71], 0
  ds_read_b128 v[112:115], v145 offset:4096
  v_mfma_f32_16x16x32_bf16 v[176:179], v[84:87], v[64:67], 0
  ds_read_b128 v[116:119], v145 offset:6144
  v_mfma_f32_16x16x32_bf16 v[192:195], v[88:91], v[64:67], 0
  ds_read_b64_tr_b16 v[124:125], v147 offset:0
  v_mfma_f32_16x16x32_bf16 v[196:199], v[88:91], v[68:71], 0
  ds_read_b64_tr_b16 v[126:127], v147 offset:512
  v_mfma_f32_16x16x32_bf16 v[200:203], v[88:91], v[72:75], 0
  ds_read_b64_tr_b16 v[128:129], v146 offset:4096
  v_mfma_f32_16x16x32_bf16 v[204:207], v[88:91], v[76:79], 0
  ds_read_b64_tr_b16 v[130:131], v146 offset:4608
  v_mfma_f32_16x16x32_bf16 v[220:223], v[92:95], v[76:79], 0
  ds_read_b64_tr_b16 v[132:133], v147 offset:4096
  v_mfma_f32_16x16x32_bf16 v[216:219], v[92:95], v[72:75], 0
  ds_read_b64_tr_b16 v[134:135], v147 offset:4608
  v_mfma_f32_16x16x32_bf16 v[212:215], v[92:95], v[68:71], 0
  ds_read_b64_tr_b16 v[136:137], v146 offset:8192
  v_mfma_f32_16x16x32_bf16 v[208:211], v[92:95], v[64:67], 0
  ds_read_b64_tr_b16 v[138:139], v146 offset:8704
  v_mfma_f32_16x16x32_bf16 v[224:227], v[64:67], v[96:99], 0
  ds_read_b64_tr_b16 v[140:141], v147 offset:8192
  v_mfma_f32_16x16x32_bf16 v[228:231], v[68:71], v[96:99], 0
  ds_read_b64_tr_b16 v[142:143], v147 offset:8704
  v_mfma_f32_16x16x32_bf16 v[232:235], v[72:75], v[96:99], 0
  ds_read_b32 v151, v150
  s_add_u32 s30, s30, 12288
  v_mfma_f32_16x16x32_bf16 v[236:239], v[76:79], v[96:99], 0
  s_mov_b64 exec, 1
  buffer_load_dword off, s[64:67], s31 lds
  s_mov_b64 exec, -1
  s_cmp_eq_u32 s30, 86016
  v_mfma_f32_16x16x32_bf16 v[252:255], v[76:79], v[100:103], 0
  s_cselect_b32 s30, 0, s30
  s_add_u32 s31, s31, 4
  v_mfma_f32_16x16x32_bf16 v[248:251], v[72:75], v[100:103], 0
  v_add_u32 v146, s30, v148
  s_add_u32 s33, s33, 1
  v_mfma_f32_16x16x32_bf16 v[244:247], v[68:71], v[100:103], 0
  v_add_u32 v147, s30, v149
  v_mfma_f32_16x16x32_bf16 v[240:243], v[64:67], v[100:103], 0
  s_branch .g2_kernel_q_s1
  .p2align 6
.g2_kernel_q_loop:
  s_waitcnt lgkmcnt(0)
  v_mfma_f32_16x16x32_bf16 v[160:163], v[120:123], v[104:107], v[160:163]
  v_cmp_lt_i32 vcc, s33, v151
  v_mfma_f32_16x16x32_bf16 v[164:167], v[120:123], v[108:111], v[164:167]
  s_cbranch_vccz .g2_kernel_q_w7
.g2_kernel_q_back7:
  v_mfma_f32_16x16x32_bf16 v[168:171], v[120:123], v[112:115], v[168:171]
  ds_read_b64_tr_b16 v[80:81], v146 offset:0
  v_mfma_f32_16x16x32_bf16 v[172:175], v[120:123], v[116:119], v[172:175]
  ds_read_b64_tr_b16 v[82:83], v146 offset:512
  v_mfma_f32_16x16x32_bf16 v[188:191], v[124:127], v[116:119], v[188:191]
  ds_read_b128 v[64:67], v144 offset:0
  v_mfma_f32_16x16x32_bf16 v[184:187], v[124:127], v[112:115], v[184:187]
  ds_read_b128 v[68:71], v144 offset:2048
  v_mfma_f32_16x16x32_bf16 v[180:183], v[124:127], v[108:111], v[180:183]
  ds_read_b128 v[72:75], v144 offset:4096
  v_mfma_f32_16x16x32_bf16 v[176:179], v[124:127], v[104:107], v[176:179]
  ds_read_b128 v[76:79], v144 offset:6144
  v_mfma_f32_16x16x32_bf16 v[192:195], v[128:131], v[104:107], v[192:195]
  ds_read_b64_tr_b16 v[84:85], v147 offset:0
  v_mfma_f32_16x16x32_bf16 v[196:199], v[128:131], v[108:111], v[196:199]
  ds_read_b64_tr_b16 v[86:87], v147 offset:512
  v_mfma_f32_16x16x32_bf16 v[200:203], v[128:131], v[112:115], v[200:203]
  ds_read_b64_tr_b16 v[88:89], v146 offset:4096
  v_mfma_f32_16x16x32_bf16 v[204:207], v[128:131], v[116:119], v[204:207]
  ds_read_b64_tr_b16 v[90:91], v146 offset:4608
  v_mfma_f32_16x16x32_bf16 v[220:223], v[132:135], v[116:119], v[220:223]
  ds_read_b64_tr_b16 v[92:93], v147 offset:4096
  v_mfma_f32_16x16x32_bf16 v[216:219], v[132:135], v[112:115], v[216:219]
  ds_read_b64_tr_b16 v[94:95], v147 offset:4608
  v_mfma_f32_16x16x32_bf16 v[212:215], v[132:135], v[108:111], v[212:215]
  ds_read_b64_tr_b16 v[96:97], v146 offset:8192
  v_mfma_f32_16x16x32_bf16 v[208:211], v[132:135], v[104:107], v[208:211]
  ds_read_b64_tr_b16 v[98:99], v146 offset:8704
  v_mfma_f32_16x16x32_bf16 v[224:227], v[104:107], v[136:139], v[224:227]
  ds_read_b64_tr_b16 v[100:101], v147 offset:8192
  v_mfma_f32_16x16x32_bf16 v[228:231], v[108:111], v[136:139], v[228:231]
  ds_read_b64_tr_b16 v[102:103], v147 offset:8704
  v_mfma_f32_16x16x32_bf16 v[232:235], v[112:115], v[136:139], v[232:235]
  ds_read_b32 v151, v150
  s_add_u32 s30, s30, 12288
  v_mfma_f32_16x16x32_bf16 v[236:239], v[116:119], v[136:139], v[236:239]
  s_mov_b64 exec, 1
  buffer_load_dword off, s[64:67], s31 lds
  s_mov_b64 exec, -1
  s_cmp_eq_u32 s30, 86016
  v_mfma_f32_16x16x32_bf16 v[252:255], v[116:119], v[140:143], v[252:255]
  s_cselect_b32 s30, 0, s30
  s_add_u32 s31, s31, 4
  v_mfma_f32_16x16x32_bf16 v[248:251], v[112:115], v[140:143], v[248:251]
  v_add_u32 v146, s30, v148
  s_add_u32 s33, s33, 1
  v_mfma_f32_16x16x32_bf16 v[244:247], v[108:111], v[140:143], v[244:247]
  v_add_u32 v147, s30, v149
  v_mfma_f32_16x16x32_bf16 v[240:243], v[104:107], v[140:143], v[240:243]
  s_waitcnt lgkmcnt(0)
  v_mfma_f32_16x16x32_bf16 v[160:163], v[80:83], v[64:67], v[160:163]
  v_cmp_lt_i32 vcc, s33, v151
  v_mfma_f32_16x16x32_bf16 v[164:167], v[80:83], v[68:71], v[164:167]
  s_cbranch_vccz .g2_kernel_q_w0
.g2_kernel_q_back0:
  v_mfma_f32_16x16x32_bf16 v[168:171], v[80:83], v[72:75], v[168:171]
  ds_read_b64_tr_b16 v[120:121], v146 offset:0
  v_mfma_f32_16x16x32_bf16 v[172:175], v[80:83], v[76:79], v[172:175]
  ds_read_b64_tr_b16 v[122:123], v146 offset:512
  v_mfma_f32_16x16x32_bf16 v[188:191], v[84:87], v[76:79], v[188:191]
  ds_read_b128 v[104:107], v145 offset:0
  v_mfma_f32_16x16x32_bf16 v[184:187], v[84:87], v[72:75], v[184:187]
  ds_read_b128 v[108:111], v145 offset:2048
  v_mfma_f32_16x16x32_bf16 v[180:183], v[84:87], v[68:71], v[180:183]
  ds_read_b128 v[112:115], v145 offset:4096
  v_mfma_f32_16x16x32_bf16 v[176:179], v[84:87], v[64:67], v[176:179]
  ds_read_b128 v[116:119], v145 offset:6144
  v_mfma_f32_16x16x32_bf16 v[192:195], v[88:91], v[64:67], v[192:195]
  ds_read_b64_tr_b16 v[124:125], v147 offset:0
  v_mfma_f32_16x16x32_bf16 v[196:199], v[88:91], v[68:71], v[196:199]
  ds_read_b64_tr_b16 v[126:127], v147 offset:512
  v_mfma_f32_16x16x32_bf16 v[200:203], v[88:91], v[72:75], v[200:203]
  ds_read_b64_tr_b16 v[128:129], v146 offset:4096
  v_mfma_f32_16x16x32_bf16 v[204:207], v[88:91], v[76:79], v[204:207]
  ds_read_b64_tr_b16 v[130:131], v146 offset:4608
  v_mfma_f32_16x16x32_bf16 v[220:223], v[92:95], v[76:79], v[220:223]
  ds_read_b64_tr_b16 v[132:133], v147 offset:4096
  v_mfma_f32_16x16x32_bf16 v[216:219], v[92:95], v[72:75], v[216:219]
  ds_read_b64_tr_b16 v[134:135], v147 offset:4608
  v_mfma_f32_16x16x32_bf16 v[212:215], v[92:95], v[68:71], v[212:215]
  ds_read_b64_tr_b16 v[136:137], v146 offset:8192
  v_mfma_f32_16x16x32_bf16 v[208:211], v[92:95], v[64:67], v[208:211]
  ds_read_b64_tr_b16 v[138:139], v146 offset:8704
  v_mfma_f32_16x16x32_bf16 v[224:227], v[64:67], v[96:99], v[224:227]
  ds_read_b64_tr_b16 v[140:141], v147 offset:8192
  v_mfma_f32_16x16x32_bf16 v[228:231], v[68:71], v[96:99], v[228:231]
  ds_read_b64_tr_b16 v[142:143], v147 offset:8704
  v_mfma_f32_16x16x32_bf16 v[232:235], v[72:75], v[96:99], v[232:235]
  ds_read_b32 v151, v150
  s_add_u32 s30, s30, 12288
  v_mfma_f32_16x16x32_bf16 v[236:239], v[76:79], v[96:99], v[236:239]
  s_mov_b64 exec, 1
  buffer_load_dword off, s[64:67], s31 lds
  s_mov_b64 exec, -1
  s_cmp_eq_u32 s30, 86016
  v_mfma_f32_16x16x32_bf16 v[252:255], v[76:79], v[100:103], v[252:255]
  s_cselect_b32 s30, 0, s30
  s_add_u32 s31, s31, 4
  v_mfma_f32_16x16x32_bf16 v[248:251], v[72:75], v[100:103], v[248:251]
  v_add_u32 v146, s30, v148
  s_add_u32 s33, s33, 1
  v_mfma_f32_16x16x32_bf16 v[244:247], v[68:71], v[100:103], v[244:247]
  v_add_u32 v147, s30, v149
  v_mfma_f32_16x16x32_bf16 v[240:243], v[64:67], v[100:103], v[240:243]
.g2_kernel_q_s1:
  s_waitcnt lgkmcnt(0)
  v_mfma_f32_16x16x32_bf16 v[160:163], v[120:123], v[104:107], v[160:163]
  v_cmp_lt_i32 vcc, s33, v151
  v_mfma_f32_16x16x32_bf16 v[164:167], v[120:123], v[108:111], v[164:167]
  s_cbranch_vccz .g2_kernel_q_w1
.g2_kernel_q_back1:
  v_mfma_f32_16x16x32_bf16 v[168:171], v[120:123], v[112:115], v[168:171]
  ds_read_b64_tr_b16 v[80:81], v146 offset:0
  v_mfma_f32_16x16x32_bf16 v[172:175], v[120:123], v[116:119], v[172:175]
  ds_read_b64_tr_b16 v[82:83], v146 offset:512
  v_mfma_f32_16x16x32_bf16 v[188:191], v[124:127], v[116:119], v[188:191]
  ds_read_b128 v[64:67], v144 offset:16384
  v_mfma_f32_16x16x32_bf16 v[184:187], v[124:127], v[112:115], v[184:187]
  ds_read_b128 v[68:71], v144 offset:18432
  v_mfma_f32_16x16x32_bf16 v[180:183], v[124:127], v[108:111], v[180:183]
  ds_read_b128 v[72:75], v144 offset:20480
  v_mfma_f32_16x16x32_bf16 v[176:179], v[124:127], v[104:107], v[176:179]
  ds_read_b128 v[76:79], v144 offset:22528
  v_mfma_f32_16x16x32_bf16 v[192:195], v[128:131], v[104:107], v[192:195]
  ds_read_b64_tr_b16 v[84:85], v147 offset:0
  v_mfma_f32_16x16x32_bf16 v[196:199], v[128:131], v[108:111], v[196:199]
  ds_read_b64_tr_b16 v[86:87], v147 offset:512
  v_mfma_f32_16x16x32_bf16 v[200:203], v[128:131], v[112:115], v[200:203]
  ds_read_b64_tr_b16 v[88:89], v146 offset:4096
  v_mfma_f32_16x16x32_bf16 v[204:207], v[128:131], v[116:119], v[204:207]
  ds_read_b64_tr_b16 v[90:91], v146 offset:4608
  v_mfma_f32_16x16x32_bf16 v[220:223], v[132:135], v[116:119], v[220:223]
  ds_read_b64_tr_b16 v[92:93], v147 offset:4096
  v_mfma_f32_16x16x32_bf16 v[216:219], v[132:135], v[112:115], v[216:219]
  ds_read_b64_tr_b16 v[94:95], v147 offset:4608
  v_mfma_f32_16x16x32_bf16 v[212:215], v[132:135], v[108:111], v[212:215]
  ds_read_b64_tr_b16 v[96:97], v146 offset:8192
  v_mfma_f32_16x16x32_bf16 v[208:211], v[132:135], v[104:107], v[208:211]
  ds_read_b64_tr_b16 v[98:99], v146 offset:8704
  v_mfma_f32_16x16x32_bf16 v[224:227], v[104:107], v[136:139], v[224:227]
  ds_read_b64_tr_b16 v[100:101], v147 offset:8192
  v_mfma_f32_16x16x32_bf16 v[228:231], v[108:111], v[136:139], v[228:231]
  ds_read_b64_tr_b16 v[102:103], v147 offset:8704
  v_mfma_f32_16x16x32_bf16 v[232:235], v[112:115], v[136:139], v[232:235]
  ds_read_b32 v151, v150
  s_add_u32 s30, s30, 12288
  v_mfma_f32_16x16x32_bf16 v[236:239], v[116:119], v[136:139], v[236:239]
  s_mov_b64 exec, 1
  buffer_load_dword off, s[64:67], s31 lds
  s_mov_b64 exec, -1
  s_cmp_eq_u32 s30, 86016
  v_mfma_f32_16x16x32_bf16 v[252:255], v[116:119], v[140:143], v[252:255]
  s_cselect_b32 s30, 0, s30
  s_add_u32 s31, s31, 4
  v_mfma_f32_16x16x32_bf16 v[248:251], v[112:115], v[140:143], v[248:251]
  v_add_u32 v146, s30, v148
  s_add_u32 s33, s33, 1
  v_mfma_f32_16x16x32_bf16 v[244:247], v[108:111], v[140:143], v[244:247]
  v_add_u32 v147, s30, v149
  v_mfma_f32_16x16x32_bf16 v[240:243], v[104:107], v[140:143], v[240:243]
  s_waitcnt lgkmcnt(0)
  v_mfma_f32_16x16x32_bf16 v[160:163], v[80:83], v[64:67], v[160:163]
  v_cmp_lt_i32 vcc, s33, v151
  v_mfma_f32_16x16x32_bf16 v[164:167], v[80:83], v[68:71], v[164:167]
  s_cbranch_vccz .g2_kernel_q_w2
.g2_kernel_q_back2:
  v_mfma_f32_16x16x32_bf16 v[168:171], v[80:83], v[72:75], v[168:171]
  ds_read_b64_tr_b16 v[120:121], v146 offset:0
  v_mfma_f32_16x16x32_bf16 v[172:175], v[80:83], v[76:79], v[172:175]
  ds_read_b64_tr_b16 v[122:123], v146 offset:512
  v_mfma_f32_16x16x32_bf16 v[188:191], v[84:87], v[76:79], v[188:191]
  ds_read_b128 v[104:107], v145 offset:16384
  v_mfma_f32_16x16x32_bf16 v[184:187], v[84:87], v[72:75], v[184:187]
  ds_read_b128 v[108:111], v145 offset:18432
  v_mfma_f32_16x16x32_bf16 v[180:183], v[84:87], v[68:71], v[180:183]
  ds_read_b128 v[112:115], v145 offset:20480
  v_mfma_f32_16x16x32_bf16 v[176:179], v[84:87], v[64:67], v[176:179]
  ds_read_b128 v[116:119], v145 offset:22528
  v_mfma_f32_16x16x32_bf16 v[192:195], v[88:91], v[64:67], v[192:195]
  ds_read_b64_tr_b16 v[124:125], v147 offset:0
  v_mfma_f32_16x16x32_bf16 v[196:199], v[88:91], v[68:71], v[196:199]
  ds_read_b64_tr_b16 v[126:127], v147 offset:512
  v_mfma_f32_16x16x32_bf16 v[200:203], v[88:91], v[72:75], v[200:203]
  ds_read_b64_tr_b16 v[128:129], v146 offset:4096
  v_mfma_f32_16x16x32_bf16 v[204:207], v[88:91], v[76:79], v[204:207]
  ds_read_b64_tr_b16 v[130:131], v146 offset:4608
  v_mfma_f32_16x16x32_bf16 v[220:223], v[92:95], v[76:79], v[220:223]
  ds_read_b64_tr_b16 v[132:133], v147 offset:4096
  v_mfma_f32_16x16x32_bf16 v[216:219], v[92:95], v[72:75], v[216:219]
  ds_read_b64_tr_b16 v[134:135], v147 offset:4608
  v_mfma_f32_16x16x32_bf16 v[212:215], v[92:95], v[68:71], v[212:215]
  ds_read_b64_tr_b16 v[136:137], v146 offset:8192
  v_mfma_f32_16x16x32_bf16 v[208:211], v[92:95], v[64:67], v[208:211]
  ds_read_b64_tr_b16 v[138:139], v146 offset:8704
  v_mfma_f32_16x16x32_bf16 v[224:227], v[64:67], v[96:99], v[224:227]
  ds_read_b64_tr_b16 v[140:141], v147 offset:8192
  v_mfma_f32_16x16x32_bf16 v[228:231], v[68:71], v[96:99], v[228:231]
  ds_read_b64_tr_b16 v[142:143], v147 offset:8704
  v_mfma_f32_16x16x32_bf16 v[232:235], v[72:75], v[96:99], v[232:235]
  ds_read_b32 v151, v150
  s_add_u32 s30, s30, 12288
  v_mfma_f32_16x16x32_bf16 v[236:239], v[76:79], v[96:99], v[236:239]
  s_mov_b64 exec, 1
  buffer_load_dword off, s[64:67], s31 lds
  s_mov_b64 exec, -1
  s_cmp_eq_u32 s30, 86016
  v_mfma_f32_16x16x32_bf16 v[252:255], v[76:79], v[100:103], v[252:255]
  s_cselect_b32 s30, 0, s30
  s_add_u32 s31, s31, 4
  v_mfma_f32_16x16x32_bf16 v[248:251], v[72:75], v[100:103], v[248:251]
  v_add_u32 v146, s30, v148
  s_add_u32 s33, s33, 1
  v_mfma_f32_16x16x32_bf16 v[244:247], v[68:71], v[100:103], v[244:247]
  v_add_u32 v147, s30, v149
  v_mfma_f32_16x16x32_bf16 v[240:243], v[64:67], v[100:103], v[240:243]
  s_waitcnt lgkmcnt(0)
  v_mfma_f32_16x16x32_bf16 v[160:163], v[120:123], v[104:107], v[160:163]
  v_cmp_lt_i32 vcc, s33, v151
  v_mfma_f32_16x16x32_bf16 v[164:167], v[120:123], v[108:111], v[164:167]
  s_cbranch_vccz .g2_kernel_q_w3
.g2_kernel_q_back3:
  v_mfma_f32_16x16x32_bf16 v[168:171], v[120:123], v[112:115], v[168:171]
  ds_read_b64_tr_b16 v[80:81], v146 offset:0
  v_mfma_f32_16x16x32_bf16 v[172:175], v[120:123], v[116:119], v[172:175]
  ds_read_b64_tr_b16 v[82:83], v146 offset:512
  v_mfma_f32_16x16x32_bf16 v[188:191], v[124:127], v[116:119], v[188:191]
  ds_read_b128 v[64:67], v144 offset:32768
  v_mfma_f32_16x16x32_bf16 v[184:187], v[124:127], v[112:115], v[184:187]
  ds_read_b128 v[68:71], v144 offset:34816
  v_mfma_f32_16x16x32_bf16 v[180:183], v[124:127], v[108:111], v[180:183]
  ds_read_b128 v[72:75], v144 offset:36864
  v_mfma_f32_16x16x32_bf16 v[176:179], v[124:127], v[104:107], v[176:179]
  ds_read_b128 v[76:79], v144 offset:38912
  v_mfma_f32_16x16x32_bf16 v[192:195], v[128:131], v[104:107], v[192:195]
  ds_read_b64_tr_b16 v[84:85], v147 offset:0
  v_mfma_f32_16x16x32_bf16 v[196:199], v[128:131], v[108:111], v[196:199]
  ds_read_b64_tr_b16 v[86:87], v147 offset:512
  v_mfma_f32_16x16x32_bf16 v[200:203], v[128:131], v[112:115], v[200:203]
  ds_read_b64_tr_b16 v[88:89], v146 offset:4096
  v_mfma_f32_16x16x32_bf16 v[204:207], v[128:131], v[116:119], v[204:207]
  ds_read_b64_tr_b16 v[90:91], v146 offset:4608
  v_mfma_f32_16x16x32_bf16 v[220:223], v[132:135], v[116:119], v[220:223]
  ds_read_b64_tr_b16 v[92:93], v147 offset:4096
  v_mfma_f32_16x16x32_bf16 v[216:219], v[132:135], v[112:115], v[216:219]
  ds_read_b64_tr_b16 v[94:95], v147 offset:4608
  v_mfma_f32_16x16x32_bf16 v[212:215], v[132:135], v[108:111], v[212:215]
  ds_read_b64_tr_b16 v[96:97], v146 offset:8192
  v_mfma_f32_16x16x32_bf16 v[208:211], v[132:135], v[104:107], v[208:211]
  ds_read_b64_tr_b16 v[98:99], v146 offset:8704
  v_mfma_f32_16x16x32_bf16 v[224:227], v[104:107], v[136:139], v[224:227]
  ds_read_b64_tr_b16 v[100:101], v147 offset:8192
  v_mfma_f32_16x16x32_bf16 v[228:231], v[108:111], v[136:139], v[228:231]
  ds_read_b64_tr_b16 v[102:103], v147 offset:8704
  v_mfma_f32_16x16x32_bf16 v[232:235], v[112:115], v[136:139], v[232:235]
  ds_read_b32 v151, v150
  s_add_u32 s30, s30, 12288
  v_mfma_f32_16x16x32_bf16 v[236:239], v[116:119], v[136:139], v[236:239]
  s_mov_b64 exec, 1
  buffer_load_dword off, s[64:67], s31 lds
  s_mov_b64 exec, -1
  s_cmp_eq_u32 s30, 86016
  v_mfma_f32_16x16x32_bf16 v[252:255], v[116:119], v[140:143], v[252:255]
  s_cselect_b32 s30, 0, s30
  s_add_u32 s31, s31, 4
  v_mfma_f32_16x16x32_bf16 v[248:251], v[112:115], v[140:143], v[248:251]
  v_add_u32 v146, s30, v148
  s_add_u32 s33, s33, 1
  v_mfma_f32_16x16x32_bf16 v[244:247], v[108:111], v[140:143], v[244:247]
  v_add_u32 v147, s30, v149
  v_mfma_f32_16x16x32_bf16 v[240:243], v[104:107], v[140:143], v[240:243]
  s_waitcnt lgkmcnt(0)
  v_mfma_f32_16x16x32_bf16 v[160:163], v[80:83], v[64:67], v[160:163]
  v_cmp_lt_i32 vcc, s33, v151
  v_mfma_f32_16x16x32_bf16 v[164:167], v[80:83], v[68:71], v[164:167]
  s_cbranch_vccz .g2_kernel_q_w4
.g2_kernel_q_back4:
  v_mfma_f32_16x16x32_bf16 v[168:171], v[80:83], v[72:75], v[168:171]
  ds_read_b64_tr_b16 v[120:121], v146 offset:0
  v_mfma_f32_16x16x32_bf16 v[172:175], v[80:83], v[76:79], v[172:175]
  ds_read_b64_tr_b16 v[122:123], v146 offset:512
  v_mfma_f32_16x16x32_bf16 v[188:191], v[84:87], v[76:79], v[188:191]
  ds_read_b128 v[104:107], v145 offset:32768
  v_mfma_f32_16x16x32_bf16 v[184:187], v[84:87], v[72:75], v[184:187]
  ds_read_b128 v[108:111], v145 offset:34816
  v_mfma_f32_16x16x32_bf16 v[180:183], v[84:87], v[68:71], v[180:183]
  ds_read_b128 v[112:115], v145 offset:36864
  v_mfma_f32_16x16x32_bf16 v[176:179], v[84:87], v[64:67], v[176:179]
  ds_read_b128 v[116:119], v145 offset:38912
  v_mfma_f32_16x16x32_bf16 v[192:195], v[88:91], v[64:67], v[192:195]
  ds_read_b64_tr_b16 v[124:125], v147 offset:0
  v_mfma_f32_16x16x32_bf16 v[196:199], v[88:91], v[68:71], v[196:199]
  ds_read_b64_tr_b16 v[126:127], v147 offset:512
  v_mfma_f32_16x16x32_bf16 v[200:203], v[88:91], v[72:75], v[200:203]
  ds_read_b64_tr_b16 v[128:129], v146 offset:4096
  v_mfma_f32_16x16x32_bf16 v[204:207], v[88:91], v[76:79], v[204:207]
  ds_read_b64_tr_b16 v[130:131], v146 offset:4608
  v_mfma_f32_16x16x32_bf16 v[220:223], v[92:95], v[76:79], v[220:223]
  ds_read_b64_tr_b16 v[132:133], v147 offset:4096
  v_mfma_f32_16x16x32_bf16 v[216:219], v[92:95], v[72:75], v[216:219]
  ds_read_b64_tr_b16 v[134:135], v147 offset:4608
  v_mfma_f32_16x16x32_bf16 v[212:215], v[92:95], v[68:71], v[212:215]
  ds_read_b64_tr_b16 v[136:137], v146 offset:8192
  v_mfma_f32_16x16x32_bf16 v[208:211], v[92:95], v[64:67], v[208:211]
  ds_read_b64_tr_b16 v[138:139], v146 offset:8704
  v_mfma_f32_16x16x32_bf16 v[224:227], v[64:67], v[96:99], v[224:227]
  ds_read_b64_tr_b16 v[140:141], v147 offset:8192
  v_mfma_f32_16x16x32_bf16 v[228:231], v[68:71], v[96:99], v[228:231]
  ds_read_b64_tr_b16 v[142:143], v147 offset:8704
  v_mfma_f32_16x16x32_bf16 v[232:235], v[72:75], v[96:99], v[232:235]
  ds_read_b32 v151, v150
  s_add_u32 s30, s30, 12288
  v_mfma_f32_16x16x32_bf16 v[236:239], v[76:79], v[96:99], v[236:239]
  s_mov_b64 exec, 1
  buffer_load_dword off, s[64:67], s31 lds
  s_mov_b64 exec, -1
  s_cmp_eq_u32 s30, 86016
  v_mfma_f32_16x16x32_bf16 v[252:255], v[76:79], v[100:103], v[252:255]
  s_cselect_b32 s30, 0, s30
  s_add_u32 s31, s31, 4
  v_mfma_f32_16x16x32_bf16 v[248:251], v[72:75], v[100:103], v[248:251]
  v_add_u32 v146, s30, v148
  s_add_u32 s33, s33, 1
  v_mfma_f32_16x16x32_bf16 v[244:247], v[68:71], v[100:103], v[244:247]
  v_add_u32 v147, s30, v149
  v_mfma_f32_16x16x32_bf16 v[240:243], v[64:67], v[100:103], v[240:243]
  s_waitcnt lgkmcnt(0)
  v_mfma_f32_16x16x32_bf16 v[160:163], v[120:123], v[104:107], v[160:163]
  v_cmp_lt_i32 vcc, s33, v151
  v_mfma_f32_16x16x32_bf16 v[164:167], v[120:123], v[108:111], v[164:167]
  s_cbranch_vccz .g2_kernel_q_w5
.g2_kernel_q_back5:
  v_mfma_f32_16x16x32_bf16 v[168:171], v[120:123], v[112:115], v[168:171]
  ds_read_b64_tr_b16 v[80:81], v146 offset:0
  v_mfma_f32_16x16x32_bf16 v[172:175], v[120:123], v[116:119], v[172:175]
  ds_read_b64_tr_b16 v[82:83], v146 offset:512
  v_mfma_f32_16x16x32_bf16 v[188:191], v[124:127], v[116:119], v[188:191]
  ds_read_b128 v[64:67], v144 offset:49152
  v_mfma_f32_16x16x32_bf16 v[184:187], v[124:127], v[112:115], v[184:187]
  ds_read_b128 v[68:71], v144 offset:51200
  v_mfma_f32_16x16x32_bf16 v[180:183], v[124:127], v[108:111], v[180:183]
  ds_read_b128 v[72:75], v144 offset:53248
  v_mfma_f32_16x16x32_bf16 v[176:179], v[124:127], v[104:107], v[176:179]
  ds_read_b128 v[76:79], v144 offset:55296
  v_mfma_f32_16x16x32_bf16 v[192:195], v[128:131], v[104:107], v[192:195]
  ds_read_b64_tr_b16 v[84:85], v147 offset:0
  v_mfma_f32_16x16x32_bf16 v[196:199], v[128:131], v[108:111], v[196:199]
  ds_read_b64_tr_b16 v[86:87], v147 offset:512
  v_mfma_f32_16x16x32_bf16 v[200:203], v[128:131], v[112:115], v[200:203]
  ds_read_b64_tr_b16 v[88:89], v146 offset:4096
  v_mfma_f32_16x16x32_bf16 v[204:207], v[128:131], v[116:119], v[204:207]
  ds_read_b64_tr_b16 v[90:91], v146 offset:4608
  v_mfma_f32_16x16x32_bf16 v[220:223], v[132:135], v[116:119], v[220:223]
  ds_read_b64_tr_b16 v[92:93], v147 offset:4096
  v_mfma_f32_16x16x32_bf16 v[216:219], v[132:135], v[112:115], v[216:219]
  ds_read_b64_tr_b16 v[94:95], v147 offset:4608
  v_mfma_f32_16x16x32_bf16 v[212:215], v[132:135], v[108:111], v[212:215]
  ds_read_b64_tr_b16 v[96:97], v146 offset:8192
  v_mfma_f32_16x16x32_bf16 v[208:211], v[132:135], v[104:107], v[208:211]
  ds_read_b64_tr_b16 v[98:99], v146 offset:8704
  v_mfma_f32_16x16x32_bf16 v[224:227], v[104:107], v[136:139], v[224:227]
  ds_read_b64_tr_b16 v[100:101], v147 offset:8192
  v_mfma_f32_16x16x32_bf16 v[228:231], v[108:111], v[136:139], v[228:231]
  ds_read_b64_tr_b16 v[102:103], v147 offset:8704
  v_mfma_f32_16x16x32_bf16 v[232:235], v[112:115], v[136:139], v[232:235]
  ds_read_b32 v151, v150
  s_add_u32 s30, s30, 12288
  v_mfma_f32_16x16x32_bf16 v[236:239], v[116:119], v[136:139], v[236:239]
  s_mov_b64 exec, 1
  buffer_load_dword off, s[64:67], s31 lds
  s_mov_b64 exec, -1
  s_cmp_eq_u32 s30, 86016
  v_mfma_f32_16x16x32_bf16 v[252:255], v[116:119], v[140:143], v[252:255]
  s_cselect_b32 s30, 0, s30
  s_add_u32 s31, s31, 4
  v_mfma_f32_16x16x32_bf16 v[248:251], v[112:115], v[140:143], v[248:251]
  v_add_u32 v146, s30, v148
  s_add_u32 s33, s33, 1
  v_mfma_f32_16x16x32_bf16 v[244:247], v[108:111], v[140:143], v[244:247]
  v_add_u32 v147, s30, v149
  v_mfma_f32_16x16x32_bf16 v[240:243], v[104:107], v[140:143], v[240:243]
  s_cmp_eq_u32 s29, 3
  s_cbranch_scc1 .g2_kernel_q_out
  s_waitcnt lgkmcnt(0)
  v_mfma_f32_16x16x32_bf16 v[160:163], v[80:83], v[64:67], v[160:163]
  v_cmp_lt_i32 vcc, s33, v151
  v_mfma_f32_16x16x32_bf16 v[164:167], v[80:83], v[68:71], v[164:167]
  s_cbranch_vccz .g2_kernel_q_w6
.g2_kernel_q_back6:
  v_mfma_f32_16x16x32_bf16 v[168:171], v[80:83], v[72:75], v[168:171]
  ds_read_b64_tr_b16 v[120:121], v146 offset:0
  v_mfma_f32_16x16x32_bf16 v[172:175], v[80:83], v[76:79], v[172:175]
  ds_read_b64_tr_b16 v[122:123], v146 offset:512
  v_mfma_f32_16x16x32_bf16 v[188:191], v[84:87], v[76:79], v[188:191]
  ds_read_b128 v[104:107], v145 offset:49152
  v_mfma_f32_16x16x32_bf16 v[184:187], v[84:87], v[72:75], v[184:187]
  ds_read_b128 v[108:111], v145 offset:51200
  v_mfma_f32_16x16x32_bf16 v[180:183], v[84:87], v[68:71], v[180:183]
  ds_read_b128 v[112:115], v145 offset:53248
  v_mfma_f32_16x16x32_bf16 v[176:179], v[84:87], v[64:67], v[176:179]
  ds_read_b128 v[116:119], v145 offset:55296
  v_mfma_f32_16x16x32_bf16 v[192:195], v[88:91], v[64:67], v[192:195]
  ds_read_b64_tr_b16 v[124:125], v147 offset:0
  v_mfma_f32_16x16x32_bf16 v[196:199], v[88:91], v[68:71], v[196:199]
  ds_read_b64_tr_b16 v[126:127], v147 offset:512
  v_mfma_f32_16x16x32_bf16 v[200:203], v[88:91], v[72:75], v[200:203]
  ds_read_b64_tr_b16 v[128:129], v146 offset:4096
  v_mfma_f32_16x16x32_bf16 v[204:207], v[88:91], v[76:79], v[204:207]
  ds_read_b64_tr_b16 v[130:131], v146 offset:4608
  v_mfma_f32_16x16x32_bf16 v[220:223], v[92:95], v[76:79], v[220:223]
  ds_read_b64_tr_b16 v[132:133], v147 offset:4096
  v_mfma_f32_16x16x32_bf16 v[216:219], v[92:95], v[72:75], v[216:219]
  ds_read_b64_tr_b16 v[134:135], v147 offset:4608
  v_mfma_f32_16x16x32_bf16 v[212:215], v[92:95], v[68:71], v[212:215]
  ds_read_b64_tr_b16 v[136:137], v146 offset:8192
  v_mfma_f32_16x16x32_bf16 v[208:211], v[92:95], v[64:67], v[208:211]
  ds_read_b64_tr_b16 v[138:139], v146 offset:8704
  v_mfma_f32_16x16x32_bf16 v[224:227], v[64:67], v[96:99], v[224:227]
  ds_read_b64_tr_b16 v[140:141], v147 offset:8192
  v_mfma_f32_16x16x32_bf16 v[228:231], v[68:71], v[96:99], v[228:231]
  ds_read_b64_tr_b16 v[142:143], v147 offset:8704
  v_mfma_f32_16x16x32_bf16 v[232:235], v[72:75], v[96:99], v[232:235]
  ds_read_b32 v151, v150
  s_add_u32 s30, s30, 12288
  v_mfma_f32_16x16x32_bf16 v[236:239], v[76:79], v[96:99], v[236:239]
  s_mov_b64 exec, 1
  buffer_load_dword off, s[64:67], s31 lds
  s_mov_b64 exec, -1
  s_cmp_eq_u32 s30, 86016
  v_mfma_f32_16x16x32_bf16 v[252:255], v[76:79], v[100:103], v[252:255]
  s_cselect_b32 s30, 0, s30
  s_add_u32 s31, s31, 4
  v_mfma_f32_16x16x32_bf16 v[248:251], v[72:75], v[100:103], v[248:251]
  v_add_u32 v146, s30, v148
  s_add_u32 s33, s33, 1
  v_mfma_f32_16x16x32_bf16 v[244:247], v[68:71], v[100:103], v[244:247]
  v_add_u32 v147, s30, v149
  s_add_u32 s29, s29, 1
  v_mfma_f32_16x16x32_bf16 v[240:243], v[64:67], v[100:103], v[240:243]
  s_branch .g2_kernel_q_loop
.g2_kernel_q_out:
  s_add_u32 s33, s33, 0
  s_waitcnt lgkmcnt(0)
  v_cmp_lt_i32 vcc, s33, v151
  s_cbranch_vccz .g2_kernel_q_wl
.g2_kernel_q_bl:
  s_cmp_lg_u32 s10, 0
  s_cbranch_scc1 .g2_kernel_q_v1
  v_mfma_f32_16x16x32_bf16 v[192:195], v[88:91], v[64:67], v[192:195]
  ds_read_b64_tr_b16 v[80:81], v148 offset:40960
  ds_read_b64_tr_b16 v[82:83], v148 offset:41472
  ds_read_b128 v[128:131], v145 offset:49152
  v_mfma_f32_16x16x32_bf16 v[196:199], v[88:91], v[68:71], v[196:199]
  ds_read_b128 v[132:135], v145 offset:51200
  ds_read_b128 v[136:139], v145 offset:53248
  ds_read_b128 v[140:143], v145 offset:55296
  v_mfma_f32_16x16x32_bf16 v[200:203], v[88:91], v[72:75], v[200:203]
  ds_read_b64_tr_b16 v[84:85], v149 offset:40960
  ds_read_b64_tr_b16 v[86:87], v149 offset:41472
  ds_read_b32 v63, v13 offset:0
  v_mfma_f32_16x16x32_bf16 v[204:207], v[88:91], v[76:79], v[204:207]
  ds_read_b32 v57, v13 offset:24
  ds_read_b128 v[40:43], v52 offset:5120
  ds_read_b128 v[44:47], v52 offset:5184
  v_mfma_f32_16x16x32_bf16 v[220:223], v[92:95], v[76:79], v[220:223]
  ds_read_b32 v24, v50 offset:2816
  ds_read_b32 v25, v50 offset:3328
  ds_read_b32 v26, v50 offset:2880
  v_mfma_f32_16x16x32_bf16 v[216:219], v[92:95], v[72:75], v[216:219]
  ds_read_b32 v27, v50 offset:3392
  ds_read_b32 v28, v50 offset:2944
  ds_read_b32 v29, v50 offset:3456
  v_mfma_f32_16x16x32_bf16 v[212:215], v[92:95], v[68:71], v[212:215]
  ds_read_b32 v30, v50 offset:3008
  ds_read_b32 v31, v50 offset:3520
  v_mfma_f32_16x16x32_bf16 v[208:211], v[92:95], v[64:67], v[208:211]
  s_waitcnt lgkmcnt(12)
  v_mfma_f32_16x16x32_bf16 v[192:195], v[80:83], v[128:131], v[192:195]
  v_mfma_f32_16x16x32_bf16 v[196:199], v[80:83], v[132:135], v[196:199]
  v_mfma_f32_16x16x32_bf16 v[200:203], v[80:83], v[136:139], v[200:203]
  v_mfma_f32_16x16x32_bf16 v[204:207], v[80:83], v[140:143], v[204:207]
  v_mfma_f32_16x16x32_bf16 v[220:223], v[84:87], v[140:143], v[220:223]
  v_mfma_f32_16x16x32_bf16 v[216:219], v[84:87], v[136:139], v[216:219]
  v_mfma_f32_16x16x32_bf16 v[212:215], v[84:87], v[132:135], v[212:215]
  v_mfma_f32_16x16x32_bf16 v[208:211], v[84:87], v[128:131], v[208:211]
  s_waitcnt lgkmcnt(0)
  v_cmp_gt_u32 vcc, 2, v63
  s_cbranch_vccnz .g2_kernel_q_v0ew
.g2_kernel_q_v0eb:
  ds_read_b64_tr_b16 v[120:121], v148 offset:24576
  ds_read_b64_tr_b16 v[122:123], v148 offset:25088
  ds_read_b128 v[104:107], v144 offset:49152
  ds_read_b128 v[108:111], v144 offset:51200
  ds_read_b128 v[112:115], v144 offset:53248
  ds_read_b128 v[116:119], v144 offset:55296
  ds_read_b64_tr_b16 v[124:125], v149 offset:24576
  ds_read_b64_tr_b16 v[126:127], v149 offset:25088
  ds_read_b64_tr_b16 v[128:129], v148 offset:32768
  ds_read_b64_tr_b16 v[130:131], v148 offset:33280
  ds_read_b64_tr_b16 v[132:133], v149 offset:32768
  ds_read_b64_tr_b16 v[134:135], v149 offset:33280
  v_cmp_ne_u32 vcc, 0, v57
  s_cbranch_vccnz .g2_kernel_q_v0p
.g2_kernel_q_v0pb:
  v_pk_mul_f32 v[152:153], v[40:41], v[24:25] op_sel:[0,1] op_sel_hi:[1,1]
  v_pk_mul_f32 v[154:155], v[42:43], v[24:25] op_sel:[0,1] op_sel_hi:[1,1]
  v_pk_mul_f32 v[156:157], v[44:45], v[24:25] op_sel:[0,1] op_sel_hi:[1,1]
  v_pk_mul_f32 v[158:159], v[46:47], v[24:25] op_sel:[0,1] op_sel_hi:[1,1]
  v_pk_fma_f32 v[192:193], v[192:193], v[24:25], v[152:153] op_sel_hi:[1,0,1]
  v_pk_fma_f32 v[194:195], v[194:195], v[24:25], v[154:155] op_sel_hi:[1,0,1]
  v_pk_fma_f32 v[208:209], v[208:209], v[24:25], v[156:157] op_sel_hi:[1,0,1]
  v_pk_fma_f32 v[210:211], v[210:211], v[24:25], v[158:159] op_sel_hi:[1,0,1]
  v_cvt_pk_bf16_f32 v192, v192, v193
  v_cvt_pk_bf16_f32 v193, v194, v195
  v_cvt_pk_bf16_f32 v194, v208, v209
  v_cvt_pk_bf16_f32 v195, v210, v211
  buffer_store_dwordx4 v[192:195], v54, s[4:7], s8 offen offset:0 sc1
  v_pk_mul_f32 v[152:153], v[40:41], v[26:27] op_sel:[0,1] op_sel_hi:[1,1]
  v_pk_mul_f32 v[154:155], v[42:43], v[26:27] op_sel:[0,1] op_sel_hi:[1,1]
  v_pk_mul_f32 v[156:157], v[44:45], v[26:27] op_sel:[0,1] op_sel_hi:[1,1]
  v_pk_mul_f32 v[158:159], v[46:47], v[26:27] op_sel:[0,1] op_sel_hi:[1,1]
  v_pk_fma_f32 v[196:197], v[196:197], v[26:27], v[152:153] op_sel_hi:[1,0,1]
  v_pk_fma_f32 v[198:199], v[198:199], v[26:27], v[154:155] op_sel_hi:[1,0,1]
  v_pk_fma_f32 v[212:213], v[212:213], v[26:27], v[156:157] op_sel_hi:[1,0,1]
  v_pk_fma_f32 v[214:215], v[214:215], v[26:27], v[158:159] op_sel_hi:[1,0,1]
  v_cvt_pk_bf16_f32 v196, v196, v197
  v_cvt_pk_bf16_f32 v197, v198, v199
  v_cvt_pk_bf16_f32 v198, v212, v213
  v_cvt_pk_bf16_f32 v199, v214, v215
  buffer_store_dwordx4 v[196:199], v54, s[4:7], s8 offen offset:128 sc1
  v_pk_mul_f32 v[152:153], v[40:41], v[28:29] op_sel:[0,1] op_sel_hi:[1,1]
  v_pk_mul_f32 v[154:155], v[42:43], v[28:29] op_sel:[0,1] op_sel_hi:[1,1]
  v_pk_mul_f32 v[156:157], v[44:45], v[28:29] op_sel:[0,1] op_sel_hi:[1,1]
  v_pk_mul_f32 v[158:159], v[46:47], v[28:29] op_sel:[0,1] op_sel_hi:[1,1]
  v_pk_fma_f32 v[200:201], v[200:201], v[28:29], v[152:153] op_sel_hi:[1,0,1]
  v_pk_fma_f32 v[202:203], v[202:203], v[28:29], v[154:155] op_sel_hi:[1,0,1]
  v_pk_fma_f32 v[216:217], v[216:217], v[28:29], v[156:157] op_sel_hi:[1,0,1]
  v_pk_fma_f32 v[218:219], v[218:219], v[28:29], v[158:159] op_sel_hi:[1,0,1]
  v_cvt_pk_bf16_f32 v200, v200, v201
  v_cvt_pk_bf16_f32 v201, v202, v203
  v_cvt_pk_bf16_f32 v202, v216, v217
  v_cvt_pk_bf16_f32 v203, v218, v219
  buffer_store_dwordx4 v[200:203], v54, s[4:7], s9 offen offset:0 sc1
  v_pk_mul_f32 v[152:153], v[40:41], v[30:31] op_sel:[0,1] op_sel_hi:[1,1]
  v_pk_mul_f32 v[154:155], v[42:43], v[30:31] op_sel:[0,1] op_sel_hi:[1,1]
  v_pk_mul_f32 v[156:157], v[44:45], v[30:31] op_sel:[0,1] op_sel_hi:[1,1]
  v_pk_mul_f32 v[158:159], v[46:47], v[30:31] op_sel:[0,1] op_sel_hi:[1,1]
  v_pk_fma_f32 v[204:205], v[204:205], v[30:31], v[152:153] op_sel_hi:[1,0,1]
  v_pk_fma_f32 v[206:207], v[206:207], v[30:31], v[154:155] op_sel_hi:[1,0,1]
  v_pk_fma_f32 v[220:221], v[220:221], v[30:31], v[156:157] op_sel_hi:[1,0,1]
  v_pk_fma_f32 v[222:223], v[222:223], v[30:31], v[158:159] op_sel_hi:[1,0,1]
  v_cvt_pk_bf16_f32 v204, v204, v205
  v_cvt_pk_bf16_f32 v205, v206, v207
  v_cvt_pk_bf16_f32 v206, v220, v221
  v_cvt_pk_bf16_f32 v207, v222, v223
  buffer_store_dwordx4 v[204:207], v54, s[4:7], s9 offen offset:128 sc1
  s_waitcnt lgkmcnt(0)
  v_mfma_f32_16x16x32_bf16 v[160:163], v[120:123], v[104:107], v[160:163]
  ds_read_b64_tr_b16 v[80:81], v148 offset:36864
  ds_read_b64_tr_b16 v[82:83], v148 offset:37376
  v_mfma_f32_16x16x32_bf16 v[164:167], v[120:123], v[108:111], v[164:167]
  ds_read_b128 v[64:67], v145 offset:49152
  ds_read_b128 v[68:71], v145 offset:51200
  v_mfma_f32_16x16x32_bf16 v[168:171], v[120:123], v[112:115], v[168:171]
  ds_read_b128 v[72:75], v145 offset:53248
  ds_read_b128 v[76:79], v145 offset:55296
  v_mfma_f32_16x16x32_bf16 v[172:175], v[120:123], v[116:119], v[172:175]
  ds_read_b64_tr_b16 v[84:85], v149 offset:36864
  ds_read_b64_tr_b16 v[86:87], v149 offset:37376
  v_mfma_f32_16x16x32_bf16 v[188:191], v[124:127], v[116:119], v[188:191]
  ds_read_b64_tr_b16 v[88:89], v148 offset:45056
  ds_read_b64_tr_b16 v[90:91], v148 offset:45568
  v_mfma_f32_16x16x32_bf16 v[184:187], v[124:127], v[112:115], v[184:187]
  ds_read_b64_tr_b16 v[92:93], v149 offset:45056
  ds_read_b64_tr_b16 v[94:95], v149 offset:45568
  v_mfma_f32_16x16x32_bf16 v[180:183], v[124:127], v[108:111], v[180:183]
  v_mfma_f32_16x16x32_bf16 v[176:179], v[124:127], v[104:107], v[176:179]
  v_mfma_f32_16x16x32_bf16 v[224:227], v[104:107], v[128:131], v[224:227]
  v_mfma_f32_16x16x32_bf16 v[228:231], v[108:111], v[128:131], v[228:231]
  v_mfma_f32_16x16x32_bf16 v[232:235], v[112:115], v[128:131], v[232:235]
  v_mfma_f32_16x16x32_bf16 v[236:239], v[116:119], v[128:131], v[236:239]
  v_mfma_f32_16x16x32_bf16 v[252:255], v[116:119], v[132:135], v[252:255]
  v_mfma_f32_16x16x32_bf16 v[248:251], v[112:115], v[132:135], v[248:251]
  v_mfma_f32_16x16x32_bf16 v[244:247], v[108:111], v[132:135], v[244:247]
  v_mfma_f32_16x16x32_bf16 v[240:243], v[104:107], v[132:135], v[240:243]
  s_waitcnt lgkmcnt(0)
  v_mfma_f32_16x16x32_bf16 v[160:163], v[80:83], v[64:67], v[160:163]
  ds_read_b32 v63, v58
  ds_read_b128 v[32:35], v52 offset:4864
  v_mfma_f32_16x16x32_bf16 v[164:167], v[80:83], v[68:71], v[164:167]
  ds_read_b128 v[36:39], v52 offset:4928
  ds_read_b128 v[104:107], v51 offset:2816
  v_mfma_f32_16x16x32_bf16 v[168:171], v[80:83], v[72:75], v[168:171]
  ds_read_b128 v[120:123], v51 offset:3328
  ds_read_b128 v[108:111], v51 offset:2880
  v_mfma_f32_16x16x32_bf16 v[172:175], v[80:83], v[76:79], v[172:175]
  ds_read_b128 v[124:127], v51 offset:3392
  ds_read_b128 v[112:115], v51 offset:2944
  v_mfma_f32_16x16x32_bf16 v[188:191], v[84:87], v[76:79], v[188:191]
  ds_read_b128 v[128:131], v51 offset:3456
  ds_read_b128 v[116:119], v51 offset:3008
  v_mfma_f32_16x16x32_bf16 v[184:187], v[84:87], v[72:75], v[184:187]
  ds_read_b128 v[132:135], v51 offset:3520
  ds_read_b32 v48, v53 offset:5376
  v_mfma_f32_16x16x32_bf16 v[180:183], v[84:87], v[68:71], v[180:183]
  ds_read_b32 v49, v53 offset:5440
  v_mfma_f32_16x16x32_bf16 v[176:179], v[84:87], v[64:67], v[176:179]
  v_mfma_f32_16x16x32_bf16 v[224:227], v[64:67], v[88:91], v[224:227]
  v_mfma_f32_16x16x32_bf16 v[228:231], v[68:71], v[88:91], v[228:231]
  v_mfma_f32_16x16x32_bf16 v[232:235], v[72:75], v[88:91], v[232:235]
  v_mfma_f32_16x16x32_bf16 v[236:239], v[76:79], v[88:91], v[236:239]
  v_mfma_f32_16x16x32_bf16 v[252:255], v[76:79], v[92:95], v[252:255]
  v_mfma_f32_16x16x32_bf16 v[248:251], v[72:75], v[92:95], v[248:251]
  v_mfma_f32_16x16x32_bf16 v[244:247], v[68:71], v[92:95], v[244:247]
  v_mfma_f32_16x16x32_bf16 v[240:243], v[64:67], v[92:95], v[240:243]
  s_waitcnt lgkmcnt(0)
  v_cmp_gt_u32 vcc, s12, v63
  s_cbranch_vccnz .g2_kernel_q_v0fw
.g2_kernel_q_v0fc:
  s_cmp_ge_u32 s35, 0x200
  s_cbranch_scc1 .g2_kernel_q_v0r
.g2_kernel_q_v0rb:
  v_pk_mul_f32 v[24:25], v[24:25], v[56:57] op_sel_hi:[1,0]
  v_pk_mul_f32 v[26:27], v[26:27], v[56:57] op_sel_hi:[1,0]
  v_pk_mul_f32 v[28:29], v[28:29], v[56:57] op_sel_hi:[1,0]
  v_pk_mul_f32 v[30:31], v[30:31], v[56:57] op_sel_hi:[1,0]
  ds_write_b128 v59, v[192:195] offset:0
  v_pk_mul_f32 v[152:153], v[32:33], v[24:25] op_sel:[0,1] op_sel_hi:[1,1]
  v_pk_mul_f32 v[154:155], v[34:35], v[24:25] op_sel:[0,1] op_sel_hi:[1,1]
  v_pk_mul_f32 v[156:157], v[36:37], v[24:25] op_sel:[0,1] op_sel_hi:[1,1]
  v_pk_mul_f32 v[158:159], v[38:39], v[24:25] op_sel:[0,1] op_sel_hi:[1,1]
  v_pk_fma_f32 v[160:161], v[160:161], v[24:25], v[152:153] op_sel_hi:[1,0,1]
  v_pk_fma_f32 v[162:163], v[162:163], v[24:25], v[154:155] op_sel_hi:[1,0,1]
  v_pk_fma_f32 v[176:177], v[176:177], v[24:25], v[156:157] op_sel_hi:[1,0,1]
  v_pk_fma_f32 v[178:179], v[178:179], v[24:25], v[158:159] op_sel_hi:[1,0,1]
  v_cvt_pk_bf16_f32 v160, v160, v161
  v_cvt_pk_bf16_f32 v161, v162, v163
  v_cvt_pk_bf16_f32 v162, v176, v177
  v_cvt_pk_bf16_f32 v163, v178, v179
  ds_write_b128 v61, v[160:163] offset:0
  ds_write_b128 v59, v[196:199] offset:128
  v_pk_mul_f32 v[152:153], v[32:33], v[26:27] op_sel:[0,1] op_sel_hi:[1,1]
  v_pk_mul_f32 v[154:155], v[34:35], v[26:27] op_sel:[0,1] op_sel_hi:[1,1]
  v_pk_mul_f32 v[156:157], v[36:37], v[26:27] op_sel:[0,1] op_sel_hi:[1,1]
  v_pk_mul_f32 v[158:159], v[38:39], v[26:27] op_sel:[0,1] op_sel_hi:[1,1]
  v_pk_fma_f32 v[164:165], v[164:165], v[26:27], v[152:153] op_sel_hi:[1,0,1]
  v_pk_fma_f32 v[166:167], v[166:167], v[26:27], v[154:155] op_sel_hi:[1,0,1]
  v_pk_fma_f32 v[180:181], v[180:181], v[26:27], v[156:157] op_sel_hi:[1,0,1]
  v_pk_fma_f32 v[182:183], v[182:183], v[26:27], v[158:159] op_sel_hi:[1,0,1]
  v_cvt_pk_bf16_f32 v164, v164, v165
  v_cvt_pk_bf16_f32 v165, v166, v167
  v_cvt_pk_bf16_f32 v166, v180, v181
  v_cvt_pk_bf16_f32 v167, v182, v183
  ds_write_b128 v61, v[164:167] offset:256
  ds_write_b128 v59, v[200:203] offset:4096
  v_pk_mul_f32 v[152:153], v[32:33], v[28:29] op_sel:[0,1] op_sel_hi:[1,1]
  v_pk_mul_f32 v[154:155], v[34:35], v[28:29] op_sel:[0,1] op_sel_hi:[1,1]
  v_pk_mul_f32 v[156:157], v[36:37], v[28:29] op_sel:[0,1] op_sel_hi:[1,1]
  v_pk_mul_f32 v[158:159], v[38:39], v[28:29] op_sel:[0,1] op_sel_hi:[1,1]
  v_pk_fma_f32 v[168:169], v[168:169], v[28:29], v[152:153] op_sel_hi:[1,0,1]
  v_pk_fma_f32 v[170:171], v[170:171], v[28:29], v[154:155] op_sel_hi:[1,0,1]
  v_pk_fma_f32 v[184:185], v[184:185], v[28:29], v[156:157] op_sel_hi:[1,0,1]
  v_pk_fma_f32 v[186:187], v[186:187], v[28:29], v[158:159] op_sel_hi:[1,0,1]
  v_cvt_pk_bf16_f32 v168, v168, v169
  v_cvt_pk_bf16_f32 v169, v170, v171
  v_cvt_pk_bf16_f32 v170, v184, v185
  v_cvt_pk_bf16_f32 v171, v186, v187
  ds_write_b128 v61, v[168:171] offset:2048
  s_waitcnt vmcnt(0)
  s_mov_b64 exec, 1
  ds_add_rtn_u32 v7, v62, v5 offset:120
  s_mov_b64 exec, -1
  ds_write_b128 v59, v[204:207] offset:4224
  v_pk_mul_f32 v[152:153], v[32:33], v[30:31] op_sel:[0,1] op_sel_hi:[1,1]
  v_pk_mul_f32 v[154:155], v[34:35], v[30:31] op_sel:[0,1] op_sel_hi:[1,1]
  v_pk_mul_f32 v[156:157], v[36:37], v[30:31] op_sel:[0,1] op_sel_hi:[1,1]
  v_pk_mul_f32 v[158:159], v[38:39], v[30:31] op_sel:[0,1] op_sel_hi:[1,1]
  v_pk_fma_f32 v[172:173], v[172:173], v[30:31], v[152:153] op_sel_hi:[1,0,1]
  v_pk_fma_f32 v[174:175], v[174:175], v[30:31], v[154:155] op_sel_hi:[1,0,1]
  v_pk_fma_f32 v[188:189], v[188:189], v[30:31], v[156:157] op_sel_hi:[1,0,1]
  v_pk_fma_f32 v[190:191], v[190:191], v[30:31], v[158:159] op_sel_hi:[1,0,1]
  v_cvt_pk_bf16_f32 v172, v172, v173
  v_cvt_pk_bf16_f32 v173, v174, v175
  v_cvt_pk_bf16_f32 v174, v188, v189
  v_cvt_pk_bf16_f32 v175, v190, v191
  s_waitcnt lgkmcnt(1)
  v_readfirstlane_b32 s28, v7
  s_cmp_eq_u32 s28, 1
  s_cbranch_scc1 .g2_kernel_q_v0f
.g2_kernel_q_v0fb:
  ds_write_b128 v61, v[172:175] offset:2304
  v_pk_mul_f32 v[152:153], v[120:121], v[48:49] op_sel:[0,0] op_sel_hi:[1,0]
  v_pk_mul_f32 v[154:155], v[122:123], v[48:49] op_sel:[0,0] op_sel_hi:[1,0]
  v_pk_mul_f32 v[156:157], v[124:125], v[48:49] op_sel:[0,0] op_sel_hi:[1,0]
  v_pk_mul_f32 v[158:159], v[126:127], v[48:49] op_sel:[0,0] op_sel_hi:[1,0]
  v_pk_fma_f32 v[224:225], v[224:225], v[104:105], v[152:153]
  v_pk_fma_f32 v[226:227], v[226:227], v[106:107], v[154:155]
  v_pk_fma_f32 v[228:229], v[228:229], v[108:109], v[156:157]
  v_pk_fma_f32 v[230:231], v[230:231], v[110:111], v[158:159]
  v_cvt_pk_bf16_f32 v224, v224, v225
  v_cvt_pk_bf16_f32 v225, v226, v227
  v_cvt_pk_bf16_f32 v226, v228, v229
  v_cvt_pk_bf16_f32 v227, v230, v231
  ds_write_b128 v60, v[224:227] offset:2048
  v_pk_mul_f32 v[152:153], v[120:121], v[48:49] op_sel:[0,1] op_sel_hi:[1,1]
  v_pk_mul_f32 v[154:155], v[122:123], v[48:49] op_sel:[0,1] op_sel_hi:[1,1]
  v_pk_mul_f32 v[156:157], v[124:125], v[48:49] op_sel:[0,1] op_sel_hi:[1,1]
  v_pk_mul_f32 v[158:159], v[126:127], v[48:49] op_sel:[0,1] op_sel_hi:[1,1]
  v_pk_fma_f32 v[240:241], v[240:241], v[104:105], v[152:153]
  v_pk_fma_f32 v[242:243], v[242:243], v[106:107], v[154:155]
  v_pk_fma_f32 v[244:245], v[244:245], v[108:109], v[156:157]
  v_pk_fma_f32 v[246:247], v[246:247], v[110:111], v[158:159]
  v_cvt_pk_bf16_f32 v240, v240, v241
  v_cvt_pk_bf16_f32 v241, v242, v243
  v_cvt_pk_bf16_f32 v242, v244, v245
  v_cvt_pk_bf16_f32 v243, v246, v247
  ds_write_b128 v60, v[240:243] offset:2304
  v_pk_mul_f32 v[152:153], v[128:129], v[48:49] op_sel:[0,0] op_sel_hi:[1,0]
  v_pk_mul_f32 v[154:155], v[130:131], v[48:49] op_sel:[0,0] op_sel_hi:[1,0]
  v_pk_mul_f32 v[156:157], v[132:133], v[48:49] op_sel:[0,0] op_sel_hi:[1,0]
  v_pk_mul_f32 v[158:159], v[134:135], v[48:49] op_sel:[0,0] op_sel_hi:[1,0]
  v_pk_fma_f32 v[232:233], v[232:233], v[112:113], v[152:153]
  v_pk_fma_f32 v[234:235], v[234:235], v[114:115], v[154:155]
  v_pk_fma_f32 v[236:237], v[236:237], v[116:117], v[156:157]
  v_pk_fma_f32 v[238:239], v[238:239], v[118:119], v[158:159]
  v_cvt_pk_bf16_f32 v232, v232, v233
  v_cvt_pk_bf16_f32 v233, v234, v235
  v_cvt_pk_bf16_f32 v234, v236, v237
  v_cvt_pk_bf16_f32 v235, v238, v239
  ds_write_b128 v60, v[232:235] offset:6144
  v_pk_mul_f32 v[152:153], v[128:129], v[48:49] op_sel:[0,1] op_sel_hi:[1,1]
  v_pk_mul_f32 v[154:155], v[130:131], v[48:49] op_sel:[0,1] op_sel_hi:[1,1]
  v_pk_mul_f32 v[156:157], v[132:133], v[48:49] op_sel:[0,1] op_sel_hi:[1,1]
  v_pk_mul_f32 v[158:159], v[134:135], v[48:49] op_sel:[0,1] op_sel_hi:[1,1]
  v_pk_fma_f32 v[248:249], v[248:249], v[112:113], v[152:153]
  v_pk_fma_f32 v[250:251], v[250:251], v[114:115], v[154:155]
  v_pk_fma_f32 v[252:253], v[252:253], v[116:117], v[156:157]
  v_pk_fma_f32 v[254:255], v[254:255], v[118:119], v[158:159]
  v_cvt_pk_bf16_f32 v248, v248, v249
  v_cvt_pk_bf16_f32 v249, v250, v251
  v_cvt_pk_bf16_f32 v250, v252, v253
  v_cvt_pk_bf16_f32 v251, v254, v255
  ds_write_b128 v60, v[248:251] offset:6400
.g2_kernel_q_kd:
  s_mov_b64 exec, 1
  ds_add_u32 v13, v5 offset:4
  s_mov_b64 exec, -1
  v_mov_b32 v120, 0
  v_mov_b32 v121, 0
  v_mov_b32 v124, 0
  v_mov_b32 v125, 0
  v_mov_b32 v128, 0
  v_mov_b32 v129, 0
  v_mov_b32 v132, 0
  v_mov_b32 v133, 0
  s_cmp_lg_u32 s62, 0
  s_cbranch_scc1 .g2_kernel_r2
  global_load_dwordx4 v[240:243], v23, s[74:75] offset:0
  global_load_dwordx4 v[244:247], v23, s[74:75] offset:32
  global_load_dwordx4 v[248:251], v23, s[74:75] offset:64
  global_load_dwordx4 v[252:255], v23, s[74:75] offset:96
.g2_kernel_r3:
  v_mov_b32 v6, s71
  s_mov_b32 s38, 0
.g2_kernel_wg4:
  ds_read_b32 v7, v6 offset:4
  s_add_u32 s38, s38, 1
  s_waitcnt lgkmcnt(0)
  v_cmp_gt_u32 vcc, 4, v7
  s_cbranch_vccz .g2_kernel_wg4d
  s_cmp_lt_u32 s38, 524288
  s_cbranch_scc1 .g2_kernel_wg4
.g2_kernel_wg4d:
  ds_read_b128 v[176:179], v9 offset:0
  ds_read_b128 v[180:183], v9 offset:1024
  ds_read_b128 v[24:27], v14 offset:8192
  ds_read_b128 v[28:31], v14 offset:9216
  ds_read_b128 v[184:187], v9 offset:2048
  ds_read_b128 v[188:191], v9 offset:3072
  ds_read_b128 v[32:35], v14 offset:10240
  ds_read_b128 v[36:39], v14 offset:11264
  ds_read_b128 v[40:43], v14 offset:12288
  ds_read_b128 v[44:47], v14 offset:13312
  ds_read_b128 v[48:51], v14 offset:14336
  ds_read_b128 v[52:55], v14 offset:15360
  s_cmp_lg_u32 s35, 0
  s_cbranch_scc1 .g2_kernel_a_own
  s_waitcnt lgkmcnt(8)
.g2_kernel_a_ob:
  v_mfma_f32_32x32x16_bf16 v[136:151], v[176:179], v[24:27], 0
  v_mfma_f32_32x32x16_bf16 v[136:151], v[180:183], v[28:31], v[136:151]
  s_waitcnt lgkmcnt(0)
  s_nop 7
  v_mfma_f32_32x32x16_bf16 v[152:167], v[176:179], v[32:35], 0
  ds_read_b32 v7, v8
  s_nop 0
  v_exp_f32 v136, v136
  v_exp_f32 v137, v137
  v_exp_f32 v138, v138
  v_exp_f32 v139, v139
  v_exp_f32 v140, v140
  v_exp_f32 v141, v141
  v_exp_f32 v142, v142
  v_exp_f32 v143, v143
  v_mfma_f32_32x32x16_bf16 v[152:167], v[180:183], v[36:39], v[152:167]
  s_mov_b64 exec, 1
  ds_add_u32 v13, v5 offset:8
  s_mov_b64 exec, -1
  s_waitcnt lgkmcnt(0)
  v_cmp_lt_u32 vcc, s62, v7
  v_cvt_pk_bf16_f32 v168, v136, v137
  v_cvt_pk_bf16_f32 v169, v138, v139
  v_cvt_pk_bf16_f32 v170, v140, v141
  v_cvt_pk_bf16_f32 v171, v142, v143
  v_exp_f32 v144, v144
  v_exp_f32 v145, v145
  v_exp_f32 v146, v146
  v_exp_f32 v147, v147
  v_mfma_f32_32x32x16_bf16 v[56:71], v[184:187], v[168:171], 0
  s_mov_b32 s36, vcc_lo
  s_andn2_b32 s33, s36, s34
  v_exp_f32 v148, v148
  v_exp_f32 v149, v149
  v_exp_f32 v150, v150
  v_exp_f32 v151, v151
  v_cvt_pk_bf16_f32 v172, v144, v145
  v_cvt_pk_bf16_f32 v173, v146, v147
  v_cvt_pk_bf16_f32 v174, v148, v149
  v_cvt_pk_bf16_f32 v175, v150, v151
  v_mfma_f32_32x32x16_bf16 v[136:151], v[176:179], v[40:43], 0
  v_exp_f32 v152, v152
  v_exp_f32 v153, v153
  v_exp_f32 v154, v154
  v_mfma_f32_32x32x16_bf16 v[56:71], v[188:191], v[172:175], v[56:71]
  s_bcnt1_i32_b32 s33, s33
  s_sub_u32 s33, s33, s39
  s_cmp_lt_i32 s33, 3
  v_exp_f32 v155, v155
  v_exp_f32 v156, v156
  v_exp_f32 v157, v157
  v_smfmac_f32_16x16x64_bf16 v[120:123], v[16:19], v[168:175], v20
  s_cbranch_scc1 .g2_kernel_a_F0n0
  s_mov_b32 s39, 64
  s_call_b64 s[72:73], .g2_kernel_a_three
.g2_kernel_a_F0n0:
  v_exp_f32 v158, v158
  v_exp_f32 v159, v159
  v_mfma_f32_32x32x16_bf16 v[136:151], v[180:183], v[44:47], v[136:151]
  v_cvt_pk_bf16_f32 v168, v152, v153
  v_cvt_pk_bf16_f32 v169, v154, v155
  v_cvt_pk_bf16_f32 v170, v156, v157
  v_cvt_pk_bf16_f32 v171, v158, v159
  v_exp_f32 v160, v160
  v_exp_f32 v161, v161
  v_exp_f32 v162, v162
  v_exp_f32 v163, v163
  v_mfma_f32_32x32x16_bf16 v[72:87], v[184:187], v[168:171], 0
  v_exp_f32 v164, v164
  v_exp_f32 v165, v165
  v_exp_f32 v166, v166
  v_exp_f32 v167, v167
  v_cvt_pk_bf16_f32 v172, v160, v161
  v_cvt_pk_bf16_f32 v173, v162, v163
  v_cvt_pk_bf16_f32 v174, v164, v165
  v_cvt_pk_bf16_f32 v175, v166, v167
  v_mfma_f32_32x32x16_bf16 v[152:167], v[176:179], v[48:51], 0
  ds_read_b32 v7, v8
  v_exp_f32 v136, v136
  v_exp_f32 v137, v137
  v_exp_f32 v138, v138
  v_mfma_f32_32x32x16_bf16 v[72:87], v[188:191], v[172:175], v[72:87]
  s_lshl_b32 s28, s16, 11
  v_exp_f32 v139, v139
  v_exp_f32 v140, v140
  v_exp_f32 v141, v141
  v_smfmac_f32_16x16x64_bf16 v[124:127], v[16:19], v[168:175], v20
  v_add_u32 v9, s28, v3
  v_exp_f32 v142, v142
  v_exp_f32 v143, v143
  v_mfma_f32_32x32x16_bf16 v[152:167], v[180:183], v[52:55], v[152:167]
  s_waitcnt lgkmcnt(0)
  v_cmp_lt_u32 vcc, s62, v7
  v_cvt_pk_bf16_f32 v168, v136, v137
  v_cvt_pk_bf16_f32 v169, v138, v139
  v_cvt_pk_bf16_f32 v170, v140, v141
  v_cvt_pk_bf16_f32 v171, v142, v143
  v_exp_f32 v144, v144
  v_exp_f32 v145, v145
  v_exp_f32 v146, v146
  v_exp_f32 v147, v147
  v_mfma_f32_32x32x16_bf16 v[88:103], v[184:187], v[168:171], 0
  s_mov_b32 s36, vcc_lo
  s_andn2_b32 s33, s36, s34
  v_exp_f32 v148, v148
  v_exp_f32 v149, v149
  v_exp_f32 v150, v150
  v_exp_f32 v151, v151
  v_cvt_pk_bf16_f32 v172, v144, v145
  v_cvt_pk_bf16_f32 v173, v146, v147
  v_cvt_pk_bf16_f32 v174, v148, v149
  v_cvt_pk_bf16_f32 v175, v150, v151
  v_exp_f32 v152, v152
  v_exp_f32 v153, v153
  v_exp_f32 v154, v154
  v_mfma_f32_32x32x16_bf16 v[88:103], v[188:191], v[172:175], v[88:103]
  s_bcnt1_i32_b32 s33, s33
  s_sub_u32 s33, s33, s39
  s_cmp_lt_i32 s33, 3
  v_exp_f32 v155, v155
  v_exp_f32 v156, v156
  v_exp_f32 v157, v157
  v_smfmac_f32_16x16x64_bf16 v[128:131], v[16:19], v[168:175], v20
  s_cbranch_scc1 .g2_kernel_a_F0n2
  s_mov_b32 s39, 64
  s_call_b64 s[72:73], .g2_kernel_a_three
.g2_kernel_a_F0n2:
  v_exp_f32 v158, v158
  v_exp_f32 v159, v159
  v_cvt_pk_bf16_f32 v168, v152, v153
  v_cvt_pk_bf16_f32 v169, v154, v155
  v_cvt_pk_bf16_f32 v170, v156, v157
  v_cvt_pk_bf16_f32 v171, v158, v159
  v_exp_f32 v160, v160
  v_exp_f32 v161, v161
  v_exp_f32 v162, v162
  v_exp_f32 v163, v163
  v_mfma_f32_32x32x16_bf16 v[104:119], v[184:187], v[168:171], 0
  v_exp_f32 v164, v164
  v_exp_f32 v165, v165
  v_exp_f32 v166, v166
  v_exp_f32 v167, v167
  v_cvt_pk_bf16_f32 v172, v160, v161
  v_cvt_pk_bf16_f32 v173, v162, v163
  v_cvt_pk_bf16_f32 v174, v164, v165
  v_cvt_pk_bf16_f32 v175, v166, v167
  s_add_u32 s39, s39, s35
  s_cmp_ge_u32 s39, 3
  s_cbranch_scc1 .g2_kernel_a_p1
  s_call_b64 s[72:73], .g2_kernel_a_three
.g2_kernel_a_p1:
  s_waitcnt vmcnt(10)
  v_mfma_f32_32x32x16_bf16 v[136:151], v[192:195], v[24:27], 0
  v_mfma_f32_32x32x16_bf16 v[136:151], v[196:199], v[28:31], v[136:151]
  s_waitcnt vmcnt(8)
  s_mov_b32 s32, 0
  s_nop 8
  s_branch .g2_kernel_a_n1
  .p2align 6
.g2_kernel_a_loop:
  v_mfma_f32_32x32x16_bf16 v[152:167], v[176:179], v[32:35], 0
  s_andn2_b32 s33, s36, s34
  v_exp_f32 v136, v136
  v_exp_f32 v137, v137
  v_exp_f32 v138, v138
  v_mfma_f32_32x32x16_bf16 v[104:119], v[236:239], v[172:175], v[104:119]
  s_cbranch_scc0 .g2_kernel_a_N0c
.g2_kernel_a_N0b:
  v_exp_f32 v139, v139
  v_exp_f32 v140, v140
  v_exp_f32 v141, v141
  v_smfmac_f32_16x16x64_bf16 v[132:135], v[16:19], v[168:175], v20
  s_ff1_i32_b32 s33, s33
  v_exp_f32 v142, v142
  v_exp_f32 v143, v143
  v_mfma_f32_32x32x16_bf16 v[152:167], v[180:183], v[36:39], v[152:167]
  s_bitset1_b32 s34, s33
  v_cvt_pk_bf16_f32 v168, v136, v137
  v_cvt_pk_bf16_f32 v169, v138, v139
  v_cvt_pk_bf16_f32 v170, v140, v141
  v_cvt_pk_bf16_f32 v171, v142, v143
  v_exp_f32 v144, v144
  v_exp_f32 v145, v145
  v_exp_f32 v146, v146
  v_exp_f32 v147, v147
  v_mfma_f32_32x32x16_bf16 v[56:71], v[184:187], v[168:171], v[56:71]
  s_xor_b32 s33, s33, s24
  v_exp_f32 v148, v148
  v_exp_f32 v149, v149
  v_exp_f32 v150, v150
  v_exp_f32 v151, v151
  v_cvt_pk_bf16_f32 v172, v144, v145
  v_cvt_pk_bf16_f32 v173, v146, v147
  v_cvt_pk_bf16_f32 v174, v148, v149
  v_cvt_pk_bf16_f32 v175, v150, v151
  v_mfma_f32_32x32x16_bf16 v[136:151], v[176:179], v[40:43], 0
  s_lshl_b32 s33, s33, s25
  v_exp_f32 v152, v152
  v_exp_f32 v153, v153
  v_exp_f32 v154, v154
  v_mfma_f32_32x32x16_bf16 v[56:71], v[188:191], v[172:175], v[56:71]
  s_add_u32 s22, s20, s33
  v_exp_f32 v155, v155
  v_exp_f32 v156, v156
  v_exp_f32 v157, v157
  v_smfmac_f32_16x16x64_bf16 v[120:123], v[16:19], v[168:175], v20
  s_addc_u32 s23, s21, 0
  v_exp_f32 v158, v158
  v_exp_f32 v159, v159
  v_mfma_f32_32x32x16_bf16 v[136:151], v[180:183], v[44:47], v[136:151]
  v_cvt_pk_bf16_f32 v168, v152, v153
  v_cvt_pk_bf16_f32 v169, v154, v155
  v_cvt_pk_bf16_f32 v170, v156, v157
  v_cvt_pk_bf16_f32 v171, v158, v159
  v_exp_f32 v160, v160
  v_exp_f32 v161, v161
  v_exp_f32 v162, v162
  v_exp_f32 v163, v163
  v_mfma_f32_32x32x16_bf16 v[72:87], v[184:187], v[168:171], v[72:87]
  v_exp_f32 v164, v164
  v_exp_f32 v165, v165
  v_exp_f32 v166, v166
  v_exp_f32 v167, v167
  v_cvt_pk_bf16_f32 v172, v160, v161
  v_cvt_pk_bf16_f32 v173, v162, v163
  v_cvt_pk_bf16_f32 v174, v164, v165
  v_cvt_pk_bf16_f32 v175, v166, v167
  v_mfma_f32_32x32x16_bf16 v[152:167], v[176:179], v[48:51], 0
  ds_read_b32 v7, v8
  v_exp_f32 v136, v136
  v_exp_f32 v137, v137
  v_exp_f32 v138, v138
  v_mfma_f32_32x32x16_bf16 v[72:87], v[188:191], v[172:175], v[72:87]
  v_exp_f32 v139, v139
  v_exp_f32 v140, v140
  v_exp_f32 v141, v141
  v_smfmac_f32_16x16x64_bf16 v[124:127], v[16:19], v[168:175], v20
  global_load_dwordx4 v[224:227], v3, s[22:23] offset:0
  global_load_dwordx4 v[228:231], v3, s[22:23] offset:1024
  global_load_dwordx4 v[232:235], v3, s[22:23] offset:2048
  global_load_dwordx4 v[236:239], v3, s[22:23] offset:3072
  v_exp_f32 v142, v142
  v_exp_f32 v143, v143
  v_mfma_f32_32x32x16_bf16 v[152:167], v[180:183], v[52:55], v[152:167]
  v_cvt_pk_bf16_f32 v168, v136, v137
  v_cvt_pk_bf16_f32 v169, v138, v139
  v_cvt_pk_bf16_f32 v170, v140, v141
  v_cvt_pk_bf16_f32 v171, v142, v143
  v_exp_f32 v144, v144
  v_exp_f32 v145, v145
  v_exp_f32 v146, v146
  v_exp_f32 v147, v147
  v_mfma_f32_32x32x16_bf16 v[88:103], v[184:187], v[168:171], v[88:103]
  s_waitcnt vmcnt(8)
  v_exp_f32 v148, v148
  v_exp_f32 v149, v149
  v_exp_f32 v150, v150
  v_exp_f32 v151, v151
  v_cvt_pk_bf16_f32 v172, v144, v145
  v_cvt_pk_bf16_f32 v173, v146, v147
  v_cvt_pk_bf16_f32 v174, v148, v149
  v_cvt_pk_bf16_f32 v175, v150, v151
  v_mfma_f32_32x32x16_bf16 v[136:151], v[192:195], v[24:27], 0
  s_waitcnt lgkmcnt(0)
  v_cmp_lt_u32 vcc, s62, v7
  v_exp_f32 v152, v152
  v_exp_f32 v153, v153
  v_exp_f32 v154, v154
  v_mfma_f32_32x32x16_bf16 v[88:103], v[188:191], v[172:175], v[88:103]
  s_mov_b32 s36, vcc_lo
  v_exp_f32 v155, v155
  v_exp_f32 v156, v156
  v_exp_f32 v157, v157
  v_smfmac_f32_16x16x64_bf16 v[128:131], v[16:19], v[168:175], v20
  v_exp_f32 v158, v158
  v_exp_f32 v159, v159
  v_mfma_f32_32x32x16_bf16 v[136:151], v[196:199], v[28:31], v[136:151]
  v_cvt_pk_bf16_f32 v168, v152, v153
  v_cvt_pk_bf16_f32 v169, v154, v155
  v_cvt_pk_bf16_f32 v170, v156, v157
  v_cvt_pk_bf16_f32 v171, v158, v159
  v_exp_f32 v160, v160
  v_exp_f32 v161, v161
  v_exp_f32 v162, v162
  v_exp_f32 v163, v163
  v_mfma_f32_32x32x16_bf16 v[104:119], v[184:187], v[168:171], v[104:119]
  v_exp_f32 v164, v164
  v_exp_f32 v165, v165
  v_exp_f32 v166, v166
  v_exp_f32 v167, v167
  v_cvt_pk_bf16_f32 v172, v160, v161
  v_cvt_pk_bf16_f32 v173, v162, v163
  v_cvt_pk_bf16_f32 v174, v164, v165
  v_cvt_pk_bf16_f32 v175, v166, v167
.g2_kernel_a_n1:
  v_mfma_f32_32x32x16_bf16 v[152:167], v[192:195], v[32:35], 0
  s_andn2_b32 s33, s36, s34
  v_exp_f32 v136, v136
  v_exp_f32 v137, v137
  v_exp_f32 v138, v138
  v_mfma_f32_32x32x16_bf16 v[104:119], v[188:191], v[172:175], v[104:119]
  s_cbranch_scc0 .g2_kernel_a_N1c
.g2_kernel_a_N1b:
  v_exp_f32 v139, v139
  v_exp_f32 v140, v140
  v_exp_f32 v141, v141
  v_smfmac_f32_16x16x64_bf16 v[132:135], v[16:19], v[168:175], v20
  s_ff1_i32_b32 s33, s33
  v_exp_f32 v142, v142
  v_exp_f32 v143, v143
  v_mfma_f32_32x32x16_bf16 v[152:167], v[196:199], v[36:39], v[152:167]
  s_bitset1_b32 s34, s33
  v_cvt_pk_bf16_f32 v168, v136, v137
  v_cvt_pk_bf16_f32 v169, v138, v139
  v_cvt_pk_bf16_f32 v170, v140, v141
  v_cvt_pk_bf16_f32 v171, v142, v143
  v_exp_f32 v144, v144
  v_exp_f32 v145, v145
  v_exp_f32 v146, v146
  v_exp_f32 v147, v147
  v_mfma_f32_32x32x16_bf16 v[56:71], v[200:203], v[168:171], v[56:71]
  s_xor_b32 s33, s33, s24
  v_exp_f32 v148, v148
  v_exp_f32 v149, v149
  v_exp_f32 v150, v150
  v_exp_f32 v151, v151
  v_cvt_pk_bf16_f32 v172, v144, v145
  v_cvt_pk_bf16_f32 v173, v146, v147
  v_cvt_pk_bf16_f32 v174, v148, v149
  v_cvt_pk_bf16_f32 v175, v150, v151
  v_mfma_f32_32x32x16_bf16 v[136:151], v[192:195], v[40:43], 0
  s_lshl_b32 s33, s33, s25
  v_exp_f32 v152, v152
  v_exp_f32 v153, v153
  v_exp_f32 v154, v154
  v_mfma_f32_32x32x16_bf16 v[56:71], v[204:207], v[172:175], v[56:71]
  s_add_u32 s22, s20, s33
  v_exp_f32 v155, v155
  v_exp_f32 v156, v156
  v_exp_f32 v157, v157
  v_smfmac_f32_16x16x64_bf16 v[120:123], v[16:19], v[168:175], v20
  s_addc_u32 s23, s21, 0
  v_exp_f32 v158, v158
  v_exp_f32 v159, v159
  v_mfma_f32_32x32x16_bf16 v[136:151], v[196:199], v[44:47], v[136:151]
  v_cvt_pk_bf16_f32 v168, v152, v153
  v_cvt_pk_bf16_f32 v169, v154, v155
  v_cvt_pk_bf16_f32 v170, v156, v157
  v_cvt_pk_bf16_f32 v171, v158, v159
  v_exp_f32 v160, v160
  v_exp_f32 v161, v161
  v_exp_f32 v162, v162
  v_exp_f32 v163, v163
  v_mfma_f32_32x32x16_bf16 v[72:87], v[200:203], v[168:171], v[72:87]
  v_exp_f32 v164, v164
  v_exp_f32 v165, v165
  v_exp_f32 v166, v166
  v_exp_f32 v167, v167
  v_cvt_pk_bf16_f32 v172, v160, v161
  v_cvt_pk_bf16_f32 v173, v162, v163
  v_cvt_pk_bf16_f32 v174, v164, v165
  v_cvt_pk_bf16_f32 v175, v166, v167
  v_mfma_f32_32x32x16_bf16 v[152:167], v[192:195], v[48:51], 0
  v_exp_f32 v136, v136
  v_exp_f32 v137, v137
  v_exp_f32 v138, v138
  v_mfma_f32_32x32x16_bf16 v[72:87], v[204:207], v[172:175], v[72:87]
  v_exp_f32 v139, v139
  v_exp_f32 v140, v140
  v_exp_f32 v141, v141
  v_smfmac_f32_16x16x64_bf16 v[124:127], v[16:19], v[168:175], v20
  global_load_dwordx4 v[176:179], v3, s[22:23] offset:0
  global_load_dwordx4 v[180:183], v3, s[22:23] offset:1024
  global_load_dwordx4 v[184:187], v3, s[22:23] offset:2048
  global_load_dwordx4 v[188:191], v3, s[22:23] offset:3072
  v_exp_f32 v142, v142
  v_exp_f32 v143, v143
  v_mfma_f32_32x32x16_bf16 v[152:167], v[196:199], v[52:55], v[152:167]
  v_cvt_pk_bf16_f32 v168, v136, v137
  v_cvt_pk_bf16_f32 v169, v138, v139
  v_cvt_pk_bf16_f32 v170, v140, v141
  v_cvt_pk_bf16_f32 v171, v142, v143
  v_exp_f32 v144, v144
  v_exp_f32 v145, v145
  v_exp_f32 v146, v146
  v_exp_f32 v147, v147
  v_mfma_f32_32x32x16_bf16 v[88:103], v[200:203], v[168:171], v[88:103]
  s_waitcnt vmcnt(8)
  v_exp_f32 v148, v148
  v_exp_f32 v149, v149
  v_exp_f32 v150, v150
  v_exp_f32 v151, v151
  v_cvt_pk_bf16_f32 v172, v144, v145
  v_cvt_pk_bf16_f32 v173, v146, v147
  v_cvt_pk_bf16_f32 v174, v148, v149
  v_cvt_pk_bf16_f32 v175, v150, v151
  v_mfma_f32_32x32x16_bf16 v[136:151], v[208:211], v[24:27], 0
  v_exp_f32 v152, v152
  v_exp_f32 v153, v153
  v_exp_f32 v154, v154
  v_mfma_f32_32x32x16_bf16 v[88:103], v[204:207], v[172:175], v[88:103]
  v_exp_f32 v155, v155
  v_exp_f32 v156, v156
  v_exp_f32 v157, v157
  v_smfmac_f32_16x16x64_bf16 v[128:131], v[16:19], v[168:175], v20
  v_exp_f32 v158, v158
  v_exp_f32 v159, v159
  v_mfma_f32_32x32x16_bf16 v[136:151], v[212:215], v[28:31], v[136:151]
  v_cvt_pk_bf16_f32 v168, v152, v153
  v_cvt_pk_bf16_f32 v169, v154, v155
  v_cvt_pk_bf16_f32 v170, v156, v157
  v_cvt_pk_bf16_f32 v171, v158, v159
  v_exp_f32 v160, v160
  v_exp_f32 v161, v161
  v_exp_f32 v162, v162
  v_exp_f32 v163, v163
  v_mfma_f32_32x32x16_bf16 v[104:119], v[200:203], v[168:171], v[104:119]
  v_exp_f32 v164, v164
  v_exp_f32 v165, v165
  v_exp_f32 v166, v166
  v_exp_f32 v167, v167
  v_cvt_pk_bf16_f32 v172, v160, v161
  v_cvt_pk_bf16_f32 v173, v162, v163
  v_cvt_pk_bf16_f32 v174, v164, v165
  v_cvt_pk_bf16_f32 v175, v166, v167
  v_mfma_f32_32x32x16_bf16 v[152:167], v[208:211], v[32:35], 0
  s_andn2_b32 s33, s36, s34
  v_exp_f32 v136, v136
  v_exp_f32 v137, v137
  v_exp_f32 v138, v138
  v_mfma_f32_32x32x16_bf16 v[104:119], v[204:207], v[172:175], v[104:119]
  s_cbranch_scc0 .g2_kernel_a_N2c
.g2_kernel_a_N2b:
  v_exp_f32 v139, v139
  v_exp_f32 v140, v140
  v_exp_f32 v141, v141
  v_smfmac_f32_16x16x64_bf16 v[132:135], v[16:19], v[168:175], v20
  s_ff1_i32_b32 s33, s33
  v_exp_f32 v142, v142
  v_exp_f32 v143, v143
  v_mfma_f32_32x32x16_bf16 v[152:167], v[212:215], v[36:39], v[152:167]
  s_bitset1_b32 s34, s33
  v_cvt_pk_bf16_f32 v168, v136, v137
  v_cvt_pk_bf16_f32 v169, v138, v139
  v_cvt_pk_bf16_f32 v170, v140, v141
  v_cvt_pk_bf16_f32 v171, v142, v143
  v_exp_f32 v144, v144
  v_exp_f32 v145, v145
  v_exp_f32 v146, v146
  v_exp_f32 v147, v147
  v_mfma_f32_32x32x16_bf16 v[56:71], v[216:219], v[168:171], v[56:71]
  s_xor_b32 s33, s33, s24
  v_exp_f32 v148, v148
  v_exp_f32 v149, v149
  v_exp_f32 v150, v150
  v_exp_f32 v151, v151
  v_cvt_pk_bf16_f32 v172, v144, v145
  v_cvt_pk_bf16_f32 v173, v146, v147
  v_cvt_pk_bf16_f32 v174, v148, v149
  v_cvt_pk_bf16_f32 v175, v150, v151
  v_mfma_f32_32x32x16_bf16 v[136:151], v[208:211], v[40:43], 0
  s_lshl_b32 s33, s33, s25
  v_exp_f32 v152, v152
  v_exp_f32 v153, v153
  v_exp_f32 v154, v154
  v_mfma_f32_32x32x16_bf16 v[56:71], v[220:223], v[172:175], v[56:71]
  s_add_u32 s22, s20, s33
  v_exp_f32 v155, v155
  v_exp_f32 v156, v156
  v_exp_f32 v157, v157
  v_smfmac_f32_16x16x64_bf16 v[120:123], v[16:19], v[168:175], v20
  s_addc_u32 s23, s21, 0
  v_exp_f32 v158, v158
  v_exp_f32 v159, v159
  v_mfma_f32_32x32x16_bf16 v[136:151], v[212:215], v[44:47], v[136:151]
  v_cvt_pk_bf16_f32 v168, v152, v153
  v_cvt_pk_bf16_f32 v169, v154, v155
  v_cvt_pk_bf16_f32 v170, v156, v157
  v_cvt_pk_bf16_f32 v171, v158, v159
  v_exp_f32 v160, v160
  v_exp_f32 v161, v161
  v_exp_f32 v162, v162
  v_exp_f32 v163, v163
  v_mfma_f32_32x32x16_bf16 v[72:87], v[216:219], v[168:171], v[72:87]
  v_exp_f32 v164, v164
  v_exp_f32 v165, v165
  v_exp_f32 v166, v166
  v_exp_f32 v167, v167
  v_cvt_pk_bf16_f32 v172, v160, v161
  v_cvt_pk_bf16_f32 v173, v162, v163
  v_cvt_pk_bf16_f32 v174, v164, v165
  v_cvt_pk_bf16_f32 v175, v166, v167
  v_mfma_f32_32x32x16_bf16 v[152:167], v[208:211], v[48:51], 0
  v_exp_f32 v136, v136
  v_exp_f32 v137, v137
  v_exp_f32 v138, v138
  v_mfma_f32_32x32x16_bf16 v[72:87], v[220:223], v[172:175], v[72:87]
  v_exp_f32 v139, v139
  v_exp_f32 v140, v140
  v_exp_f32 v141, v141
  v_smfmac_f32_16x16x64_bf16 v[124:127], v[16:19], v[168:175], v20
  global_load_dwordx4 v[192:195], v3, s[22:23] offset:0
  global_load_dwordx4 v[196:199], v3, s[22:23] offset:1024
  global_load_dwordx4 v[200:203], v3, s[22:23] offset:2048
  global_load_dwordx4 v[204:207], v3, s[22:23] offset:3072
  v_exp_f32 v142, v142
  v_exp_f32 v143, v143
  v_mfma_f32_32x32x16_bf16 v[152:167], v[212:215], v[52:55], v[152:167]
  v_cvt_pk_bf16_f32 v168, v136, v137
  v_cvt_pk_bf16_f32 v169, v138, v139
  v_cvt_pk_bf16_f32 v170, v140, v141
  v_cvt_pk_bf16_f32 v171, v142, v143
  v_exp_f32 v144, v144
  v_exp_f32 v145, v145
  v_exp_f32 v146, v146
  v_exp_f32 v147, v147
  v_mfma_f32_32x32x16_bf16 v[88:103], v[216:219], v[168:171], v[88:103]
  s_waitcnt vmcnt(8)
  v_exp_f32 v148, v148
  v_exp_f32 v149, v149
  v_exp_f32 v150, v150
  v_exp_f32 v151, v151
  v_cvt_pk_bf16_f32 v172, v144, v145
  v_cvt_pk_bf16_f32 v173, v146, v147
  v_cvt_pk_bf16_f32 v174, v148, v149
  v_cvt_pk_bf16_f32 v175, v150, v151
  v_mfma_f32_32x32x16_bf16 v[136:151], v[224:227], v[24:27], 0
  v_exp_f32 v152, v152
  v_exp_f32 v153, v153
  v_exp_f32 v154, v154
  v_mfma_f32_32x32x16_bf16 v[88:103], v[220:223], v[172:175], v[88:103]
  v_exp_f32 v155, v155
  v_exp_f32 v156, v156
  v_exp_f32 v157, v157
  v_smfmac_f32_16x16x64_bf16 v[128:131], v[16:19], v[168:175], v20
  v_exp_f32 v158, v158
  v_exp_f32 v159, v159
  v_mfma_f32_32x32x16_bf16 v[136:151], v[228:231], v[28:31], v[136:151]
  s_and_b32 s28, s32, 3
  v_cvt_pk_bf16_f32 v168, v152, v153
  v_cvt_pk_bf16_f32 v169, v154, v155
  v_cvt_pk_bf16_f32 v170, v156, v157
  v_cvt_pk_bf16_f32 v171, v158, v159
  v_exp_f32 v160, v160
  v_exp_f32 v161, v161
  v_exp_f32 v162, v162
  v_exp_f32 v163, v163
  v_mfma_f32_32x32x16_bf16 v[104:119], v[216:219], v[168:171], v[104:119]
  s_cmp_eq_u32 s28, 3
  v_exp_f32 v164, v164
  v_exp_f32 v165, v165
  v_exp_f32 v166, v166
  v_exp_f32 v167, v167
  v_cvt_pk_bf16_f32 v172, v160, v161
  v_cvt_pk_bf16_f32 v173, v162, v163
  v_cvt_pk_bf16_f32 v174, v164, v165
  v_cvt_pk_bf16_f32 v175, v166, v167
  s_cbranch_scc1 .g2_kernel_a_last
  v_mfma_f32_32x32x16_bf16 v[152:167], v[224:227], v[32:35], 0
  s_andn2_b32 s33, s36, s34
  v_exp_f32 v136, v136
  v_exp_f32 v137, v137
  v_exp_f32 v138, v138
  v_mfma_f32_32x32x16_bf16 v[104:119], v[220:223], v[172:175], v[104:119]
  s_cbranch_scc0 .g2_kernel_a_N3c
.g2_kernel_a_N3b:
  v_exp_f32 v139, v139
  v_exp_f32 v140, v140
  v_exp_f32 v141, v141
  v_smfmac_f32_16x16x64_bf16 v[132:135], v[16:19], v[168:175], v20
  s_ff1_i32_b32 s33, s33
  v_exp_f32 v142, v142
  v_exp_f32 v143, v143
  v_mfma_f32_32x32x16_bf16 v[152:167], v[228:231], v[36:39], v[152:167]
  s_bitset1_b32 s34, s33
  v_cvt_pk_bf16_f32 v168, v136, v137
  v_cvt_pk_bf16_f32 v169, v138, v139
  v_cvt_pk_bf16_f32 v170, v140, v141
  v_cvt_pk_bf16_f32 v171, v142, v143
  v_exp_f32 v144, v144
  v_exp_f32 v145, v145
  v_exp_f32 v146, v146
  v_exp_f32 v147, v147
  v_mfma_f32_32x32x16_bf16 v[56:71], v[232:235], v[168:171], v[56:71]
  s_xor_b32 s33, s33, s24
  v_exp_f32 v148, v148
  v_exp_f32 v149, v149
  v_exp_f32 v150, v150
  v_exp_f32 v151, v151
  v_cvt_pk_bf16_f32 v172, v144, v145
  v_cvt_pk_bf16_f32 v173, v146, v147
  v_cvt_pk_bf16_f32 v174, v148, v149
  v_cvt_pk_bf16_f32 v175, v150, v151
  v_mfma_f32_32x32x16_bf16 v[136:151], v[224:227], v[40:43], 0
  s_lshl_b32 s33, s33, s25
  v_exp_f32 v152, v152
  v_exp_f32 v153, v153
  v_exp_f32 v154, v154
  v_mfma_f32_32x32x16_bf16 v[56:71], v[236:239], v[172:175], v[56:71]
  s_add_u32 s22, s20, s33
  v_exp_f32 v155, v155
  v_exp_f32 v156, v156
  v_exp_f32 v157, v157
  v_smfmac_f32_16x16x64_bf16 v[120:123], v[16:19], v[168:175], v20
  s_addc_u32 s23, s21, 0
  v_exp_f32 v158, v158
  v_exp_f32 v159, v159
  v_mfma_f32_32x32x16_bf16 v[136:151], v[228:231], v[44:47], v[136:151]
  v_cvt_pk_bf16_f32 v168, v152, v153
  v_cvt_pk_bf16_f32 v169, v154, v155
  v_cvt_pk_bf16_f32 v170, v156, v157
  v_cvt_pk_bf16_f32 v171, v158, v159
  v_exp_f32 v160, v160
  v_exp_f32 v161, v161
  v_exp_f32 v162, v162
  v_exp_f32 v163, v163
  v_mfma_f32_32x32x16_bf16 v[72:87], v[232:235], v[168:171], v[72:87]
  v_exp_f32 v164, v164
  v_exp_f32 v165, v165
  v_exp_f32 v166, v166
  v_exp_f32 v167, v167
  v_cvt_pk_bf16_f32 v172, v160, v161
  v_cvt_pk_bf16_f32 v173, v162, v163
  v_cvt_pk_bf16_f32 v174, v164, v165
  v_cvt_pk_bf16_f32 v175, v166, v167
  v_mfma_f32_32x32x16_bf16 v[152:167], v[224:227], v[48:51], 0
  v_exp_f32 v136, v136
  v_exp_f32 v137, v137
  v_exp_f32 v138, v138
  v_mfma_f32_32x32x16_bf16 v[72:87], v[236:239], v[172:175], v[72:87]
  v_exp_f32 v139, v139
  v_exp_f32 v140, v140
  v_exp_f32 v141, v141
  v_smfmac_f32_16x16x64_bf16 v[124:127], v[16:19], v[168:175], v20
  global_load_dwordx4 v[208:211], v3, s[22:23] offset:0
  global_load_dwordx4 v[212:215], v3, s[22:23] offset:1024
  global_load_dwordx4 v[216:219], v3, s[22:23] offset:2048
  global_load_dwordx4 v[220:223], v3, s[22:23] offset:3072
  v_exp_f32 v142, v142
  v_exp_f32 v143, v143
  v_mfma_f32_32x32x16_bf16 v[152:167], v[228:231], v[52:55], v[152:167]
  v_cvt_pk_bf16_f32 v168, v136, v137
  v_cvt_pk_bf16_f32 v169, v138, v139
  v_cvt_pk_bf16_f32 v170, v140, v141
  v_cvt_pk_bf16_f32 v171, v142, v143
  v_exp_f32 v144, v144
  v_exp_f32 v145, v145
  v_exp_f32 v146, v146
  v_exp_f32 v147, v147
  v_mfma_f32_32x32x16_bf16 v[88:103], v[232:235], v[168:171], v[88:103]
  s_waitcnt vmcnt(8)
  v_exp_f32 v148, v148
  v_exp_f32 v149, v149
  v_exp_f32 v150, v150
  v_exp_f32 v151, v151
  v_cvt_pk_bf16_f32 v172, v144, v145
  v_cvt_pk_bf16_f32 v173, v146, v147
  v_cvt_pk_bf16_f32 v174, v148, v149
  v_cvt_pk_bf16_f32 v175, v150, v151
  v_mfma_f32_32x32x16_bf16 v[136:151], v[176:179], v[24:27], 0
  v_exp_f32 v152, v152
  v_exp_f32 v153, v153
  v_exp_f32 v154, v154
  v_mfma_f32_32x32x16_bf16 v[88:103], v[236:239], v[172:175], v[88:103]
  v_exp_f32 v155, v155
  v_exp_f32 v156, v156
  v_exp_f32 v157, v157
  v_smfmac_f32_16x16x64_bf16 v[128:131], v[16:19], v[168:175], v20
  v_exp_f32 v158, v158
  v_exp_f32 v159, v159
  v_mfma_f32_32x32x16_bf16 v[136:151], v[180:183], v[28:31], v[136:151]
  s_add_u32 s32, s32, 1
  v_cvt_pk_bf16_f32 v168, v152, v153
  v_cvt_pk_bf16_f32 v169, v154, v155
  v_cvt_pk_bf16_f32 v170, v156, v157
  v_cvt_pk_bf16_f32 v171, v158, v159
  v_exp_f32 v160, v160
  v_exp_f32 v161, v161
  v_exp_f32 v162, v162
  v_exp_f32 v163, v163
  v_mfma_f32_32x32x16_bf16 v[104:119], v[232:235], v[168:171], v[104:119]
  s_cmp_eq_u32 s35, 0
  v_exp_f32 v164, v164
  v_exp_f32 v165, v165
  v_exp_f32 v166, v166
  v_exp_f32 v167, v167
  v_cvt_pk_bf16_f32 v172, v160, v161
  v_cvt_pk_bf16_f32 v173, v162, v163
  v_cvt_pk_bf16_f32 v174, v164, v165
  v_cvt_pk_bf16_f32 v175, v166, v167
  s_cbranch_scc1 .g2_kernel_a_loop
  s_branch .g2_kernel_a_redo
.g2_kernel_a_last:
  v_mfma_f32_32x32x16_bf16 v[152:167], v[224:227], v[32:35], 0
  ds_read_b32 v21, v13 offset:8
  s_andn2_b32 s33, s36, s34
  v_exp_f32 v136, v136
  v_exp_f32 v137, v137
  v_exp_f32 v138, v138
  v_mfma_f32_32x32x16_bf16 v[104:119], v[220:223], v[172:175], v[104:119]
  s_cbranch_scc0 .g2_kernel_a_L3c
.g2_kernel_a_L3b:
  v_exp_f32 v139, v139
  v_exp_f32 v140, v140
  v_exp_f32 v141, v141
  v_smfmac_f32_16x16x64_bf16 v[132:135], v[16:19], v[168:175], v20
  s_ff1_i32_b32 s33, s33
  v_exp_f32 v142, v142
  v_exp_f32 v143, v143
  v_mfma_f32_32x32x16_bf16 v[152:167], v[228:231], v[36:39], v[152:167]
  s_bitset1_b32 s34, s33
  ds_read_b128 v[24:27], v14 offset:0
  v_cvt_pk_bf16_f32 v168, v136, v137
  v_cvt_pk_bf16_f32 v169, v138, v139
  v_cvt_pk_bf16_f32 v170, v140, v141
  v_cvt_pk_bf16_f32 v171, v142, v143
  v_exp_f32 v144, v144
  v_exp_f32 v145, v145
  v_exp_f32 v146, v146
  v_exp_f32 v147, v147
  v_mfma_f32_32x32x16_bf16 v[56:71], v[232:235], v[168:171], v[56:71]
  s_xor_b32 s33, s33, s24
  ds_read_b128 v[28:31], v14 offset:1024
  v_exp_f32 v148, v148
  v_exp_f32 v149, v149
  v_exp_f32 v150, v150
  v_exp_f32 v151, v151
  v_cvt_pk_bf16_f32 v172, v144, v145
  v_cvt_pk_bf16_f32 v173, v146, v147
  v_cvt_pk_bf16_f32 v174, v148, v149
  v_cvt_pk_bf16_f32 v175, v150, v151
  v_mfma_f32_32x32x16_bf16 v[136:151], v[224:227], v[40:43], 0
  s_waitcnt lgkmcnt(2)
  s_lshl_b32 s33, s33, s25
  v_exp_f32 v152, v152
  v_exp_f32 v153, v153
  v_exp_f32 v154, v154
  v_mfma_f32_32x32x16_bf16 v[56:71], v[236:239], v[172:175], v[56:71]
  v_cmp_gt_u32 vcc, s27, v21
  s_add_u32 s22, s20, s33
  v_exp_f32 v155, v155
  v_exp_f32 v156, v156
  v_exp_f32 v157, v157
  v_smfmac_f32_16x16x64_bf16 v[120:123], v[16:19], v[168:175], v20
  s_addc_u32 s23, s21, 0
  v_exp_f32 v158, v158
  v_exp_f32 v159, v159
  v_mfma_f32_32x32x16_bf16 v[136:151], v[228:231], v[44:47], v[136:151]
  v_cvt_pk_bf16_f32 v168, v152, v153
  v_cvt_pk_bf16_f32 v169, v154, v155
  v_cvt_pk_bf16_f32 v170, v156, v157
  v_cvt_pk_bf16_f32 v171, v158, v159
  v_exp_f32 v160, v160
  v_exp_f32 v161, v161
  v_exp_f32 v162, v162
  v_exp_f32 v163, v163
  v_mfma_f32_32x32x16_bf16 v[72:87], v[232:235], v[168:171], v[72:87]
  s_cbranch_vccnz .g2_kernel_a_L3g
.g2_kernel_a_L3h:
  ds_read_b128 v[32:35], v14 offset:2048
  ds_read_b128 v[36:39], v14 offset:3072
  v_cvt_pk_bf16_f32 v56, v56, v57
  v_cvt_pk_bf16_f32 v57, v58, v59
  v_cvt_pk_bf16_f32 v58, v60, v61
  v_cvt_pk_bf16_f32 v59, v62, v63
  v_add_f32 v6, v120, v121
  v_exp_f32 v164, v164
  v_exp_f32 v165, v165
  v_exp_f32 v166, v166
  v_exp_f32 v167, v167
  v_cvt_pk_bf16_f32 v172, v160, v161
  v_cvt_pk_bf16_f32 v173, v162, v163
  v_cvt_pk_bf16_f32 v174, v164, v165
  v_cvt_pk_bf16_f32 v175, v166, v167
  v_mfma_f32_32x32x16_bf16 v[152:167], v[224:227], v[48:51], 0
  ds_write_b128 v9, v[56:59] offset:0
  v_cvt_pk_bf16_f32 v60, v64, v65
  v_cvt_pk_bf16_f32 v61, v66, v67
  v_cvt_pk_bf16_f32 v62, v68, v69
  v_cvt_pk_bf16_f32 v63, v70, v71
  v_exp_f32 v136, v136
  v_exp_f32 v137, v137
  v_exp_f32 v138, v138
  v_mfma_f32_32x32x16_bf16 v[72:87], v[236:239], v[172:175], v[72:87]
  ds_write_b128 v9, v[60:63] offset:1024
  v_mov_b32 v120, 0
  v_mov_b32 v121, 0
  v_exp_f32 v139, v139
  v_exp_f32 v140, v140
  v_exp_f32 v141, v141
  v_smfmac_f32_16x16x64_bf16 v[124:127], v[16:19], v[168:175], v20
  global_load_dwordx4 v[208:211], v3, s[22:23] offset:0
  global_load_dwordx4 v[212:215], v3, s[22:23] offset:1024
  global_load_dwordx4 v[216:219], v3, s[22:23] offset:2048
  global_load_dwordx4 v[220:223], v3, s[22:23] offset:3072
  ds_write_b32 v10, v6 offset:0
  ds_write_b32 v11, v12 offset:0
  v_exp_f32 v142, v142
  v_exp_f32 v143, v143
  v_mfma_f32_32x32x16_bf16 v[152:167], v[228:231], v[52:55], v[152:167]
  ds_read_b128 v[40:43], v14 offset:4096
  s_wakeup
  v_cvt_pk_bf16_f32 v168, v136, v137
  v_cvt_pk_bf16_f32 v169, v138, v139
  v_cvt_pk_bf16_f32 v170, v140, v141
  v_cvt_pk_bf16_f32 v171, v142, v143
  v_exp_f32 v144, v144
  v_exp_f32 v145, v145
  v_exp_f32 v146, v146
  v_exp_f32 v147, v147
  v_mfma_f32_32x32x16_bf16 v[88:103], v[232:235], v[168:171], v[88:103]
  s_waitcnt vmcnt(8)
  ds_read_b128 v[44:47], v14 offset:5120
  v_cvt_pk_bf16_f32 v72, v72, v73
  v_cvt_pk_bf16_f32 v73, v74, v75
  v_cvt_pk_bf16_f32 v74, v76, v77
  v_cvt_pk_bf16_f32 v75, v78, v79
  v_add_f32 v6, v124, v125
  v_exp_f32 v148, v148
  v_exp_f32 v149, v149
  v_exp_f32 v150, v150
  v_exp_f32 v151, v151
  v_cvt_pk_bf16_f32 v172, v144, v145
  v_cvt_pk_bf16_f32 v173, v146, v147
  v_cvt_pk_bf16_f32 v174, v148, v149
  v_cvt_pk_bf16_f32 v175, v150, v151
  s_waitcnt lgkmcnt(8)
  v_mfma_f32_32x32x16_bf16 v[136:151], v[176:179], v[24:27], 0
  ds_write_b128 v9, v[72:75] offset:8192
  v_cvt_pk_bf16_f32 v76, v80, v81
  v_cvt_pk_bf16_f32 v77, v82, v83
  v_cvt_pk_bf16_f32 v78, v84, v85
  v_cvt_pk_bf16_f32 v79, v86, v87
  v_exp_f32 v152, v152
  v_exp_f32 v153, v153
  v_exp_f32 v154, v154
  v_mfma_f32_32x32x16_bf16 v[88:103], v[236:239], v[172:175], v[88:103]
  ds_write_b128 v9, v[76:79] offset:9216
  v_mov_b32 v124, 0
  v_mov_b32 v125, 0
  v_exp_f32 v155, v155
  v_exp_f32 v156, v156
  v_exp_f32 v157, v157
  v_smfmac_f32_16x16x64_bf16 v[128:131], v[16:19], v[168:175], v20
  ds_write_b32 v10, v6 offset:512
  ds_write_b32 v11, v12 offset:16
  v_exp_f32 v158, v158
  v_exp_f32 v159, v159
  v_mfma_f32_32x32x16_bf16 v[136:151], v[180:183], v[28:31], v[136:151]
  ds_read_b128 v[48:51], v14 offset:6144
  s_wakeup
  v_cvt_pk_bf16_f32 v168, v152, v153
  v_cvt_pk_bf16_f32 v169, v154, v155
  v_cvt_pk_bf16_f32 v170, v156, v157
  v_cvt_pk_bf16_f32 v171, v158, v159
  v_exp_f32 v160, v160
  v_exp_f32 v161, v161
  v_exp_f32 v162, v162
  v_exp_f32 v163, v163
  v_mfma_f32_32x32x16_bf16 v[104:119], v[232:235], v[168:171], v[104:119]
  ds_read_b128 v[52:55], v14 offset:7168
  v_cvt_pk_bf16_f32 v88, v88, v89
  v_cvt_pk_bf16_f32 v89, v90, v91
  v_cvt_pk_bf16_f32 v90, v92, v93
  v_cvt_pk_bf16_f32 v91, v94, v95
  v_add_f32 v6, v128, v129
  ds_write_b128 v9, v[88:91] offset:16384
  v_cvt_pk_bf16_f32 v92, v96, v97
  v_cvt_pk_bf16_f32 v93, v98, v99
  v_cvt_pk_bf16_f32 v94, v100, v101
  v_cvt_pk_bf16_f32 v95, v102, v103
  ds_write_b128 v9, v[92:95] offset:17408
  v_mov_b32 v128, 0
  v_mov_b32 v129, 0
  ds_write_b32 v10, v6 offset:1024
  ds_write_b32 v11, v12 offset:32
  s_add_u32 s32, s32, 1
  v_exp_f32 v164, v164
  v_exp_f32 v165, v165
  v_exp_f32 v166, v166
  v_exp_f32 v167, v167
  v_cvt_pk_bf16_f32 v172, v160, v161
  v_cvt_pk_bf16_f32 v173, v162, v163
  v_cvt_pk_bf16_f32 v174, v164, v165
  v_cvt_pk_bf16_f32 v175, v166, v167
  s_cmp_eq_u32 s32, 8
  s_cbranch_scc1 .g2_kernel_a_end
  s_waitcnt lgkmcnt(15)
  v_mfma_f32_32x32x16_bf16 v[152:167], v[176:179], v[32:35], 0
  s_andn2_b32 s33, s36, s34
  v_exp_f32 v136, v136
  v_exp_f32 v137, v137
  v_exp_f32 v138, v138
  v_mfma_f32_32x32x16_bf16 v[104:119], v[236:239], v[172:175], v[104:119]
  s_cbranch_scc0 .g2_kernel_a_G0c
.g2_kernel_a_G0b:
  v_exp_f32 v139, v139
  v_exp_f32 v140, v140
  v_exp_f32 v141, v141
  v_smfmac_f32_16x16x64_bf16 v[132:135], v[16:19], v[168:175], v20
  s_ff1_i32_b32 s33, s33
  v_exp_f32 v142, v142
  v_exp_f32 v143, v143
  v_mfma_f32_32x32x16_bf16 v[152:167], v[180:183], v[36:39], v[152:167]
  s_bitset1_b32 s34, s33
  v_cvt_pk_bf16_f32 v168, v136, v137
  v_cvt_pk_bf16_f32 v169, v138, v139
  v_cvt_pk_bf16_f32 v170, v140, v141
  v_cvt_pk_bf16_f32 v171, v142, v143
  v_exp_f32 v144, v144
  v_exp_f32 v145, v145
  v_exp_f32 v146, v146
  v_exp_f32 v147, v147
  s_waitcnt lgkmcnt(14)
  v_mfma_f32_32x32x16_bf16 v[56:71], v[184:187], v[168:171], 0
  s_xor_b32 s33, s33, s24
  v_cvt_pk_bf16_f32 v104, v104, v105
  v_cvt_pk_bf16_f32 v105, v106, v107
  v_cvt_pk_bf16_f32 v106, v108, v109
  v_cvt_pk_bf16_f32 v107, v110, v111
  v_add_f32 v6, v132, v133
  v_exp_f32 v148, v148
  v_exp_f32 v149, v149
  v_exp_f32 v150, v150
  v_exp_f32 v151, v151
  v_cvt_pk_bf16_f32 v172, v144, v145
  v_cvt_pk_bf16_f32 v173, v146, v147
  v_cvt_pk_bf16_f32 v174, v148, v149
  v_cvt_pk_bf16_f32 v175, v150, v151
  s_waitcnt lgkmcnt(10)
  v_mfma_f32_32x32x16_bf16 v[136:151], v[176:179], v[40:43], 0
  s_lshl_b32 s33, s33, s25
  ds_write_b128 v9, v[104:107] offset:24576
  v_cvt_pk_bf16_f32 v108, v112, v113
  v_cvt_pk_bf16_f32 v109, v114, v115
  v_cvt_pk_bf16_f32 v110, v116, v117
  v_cvt_pk_bf16_f32 v111, v118, v119
  v_exp_f32 v152, v152
  v_exp_f32 v153, v153
  v_exp_f32 v154, v154
  v_mfma_f32_32x32x16_bf16 v[56:71], v[188:191], v[172:175], v[56:71]
  s_add_u32 s22, s20, s33
  ds_write_b128 v9, v[108:111] offset:25600
  v_mov_b32 v132, 0
  v_mov_b32 v133, 0
  v_exp_f32 v155, v155
  v_exp_f32 v156, v156
  v_exp_f32 v157, v157
  v_smfmac_f32_16x16x64_bf16 v[120:123], v[16:19], v[168:175], v20
  s_addc_u32 s23, s21, 0
  ds_write_b32 v10, v6 offset:1536
  v_exp_f32 v158, v158
  v_exp_f32 v159, v159
  v_mfma_f32_32x32x16_bf16 v[136:151], v[180:183], v[44:47], v[136:151]
  v_cvt_pk_bf16_f32 v168, v152, v153
  v_cvt_pk_bf16_f32 v169, v154, v155
  v_cvt_pk_bf16_f32 v170, v156, v157
  v_cvt_pk_bf16_f32 v171, v158, v159
  v_exp_f32 v160, v160
  v_exp_f32 v161, v161
  v_exp_f32 v162, v162
  v_exp_f32 v163, v163
  s_waitcnt lgkmcnt(11)
  v_mfma_f32_32x32x16_bf16 v[72:87], v[184:187], v[168:171], 0
  ds_write_b32 v11, v12 offset:48
  v_exp_f32 v164, v164
  v_exp_f32 v165, v165
  v_exp_f32 v166, v166
  v_exp_f32 v167, v167
  v_cvt_pk_bf16_f32 v172, v160, v161
  v_cvt_pk_bf16_f32 v173, v162, v163
  v_cvt_pk_bf16_f32 v174, v164, v165
  v_cvt_pk_bf16_f32 v175, v166, v167
  s_waitcnt lgkmcnt(8)
  v_mfma_f32_32x32x16_bf16 v[152:167], v[176:179], v[48:51], 0
  v_add_u32 v12, 1, v12
  v_exp_f32 v136, v136
  v_exp_f32 v137, v137
  v_exp_f32 v138, v138
  v_mfma_f32_32x32x16_bf16 v[72:87], v[188:191], v[172:175], v[72:87]
  v_exp_f32 v139, v139
  v_exp_f32 v140, v140
  v_exp_f32 v141, v141
  v_smfmac_f32_16x16x64_bf16 v[124:127], v[16:19], v[168:175], v20
  global_load_dwordx4 v[224:227], v3, s[22:23] offset:0
  global_load_dwordx4 v[228:231], v3, s[22:23] offset:1024
  global_load_dwordx4 v[232:235], v3, s[22:23] offset:2048
  global_load_dwordx4 v[236:239], v3, s[22:23] offset:3072
  s_add_u32 s27, s27, 4
  v_exp_f32 v142, v142
  v_exp_f32 v143, v143
  v_mfma_f32_32x32x16_bf16 v[152:167], v[180:183], v[52:55], v[152:167]
  v_cvt_pk_bf16_f32 v168, v136, v137
  v_cvt_pk_bf16_f32 v169, v138, v139
  v_cvt_pk_bf16_f32 v170, v140, v141
  v_cvt_pk_bf16_f32 v171, v142, v143
  v_exp_f32 v144, v144
  v_exp_f32 v145, v145
  v_exp_f32 v146, v146
  v_exp_f32 v147, v147
  s_waitcnt lgkmcnt(6)
  v_mfma_f32_32x32x16_bf16 v[88:103], v[184:187], v[168:171], 0
  s_waitcnt vmcnt(8)
  v_exp_f32 v148, v148
  v_exp_f32 v149, v149
  v_exp_f32 v150, v150
  v_exp_f32 v151, v151
  v_cvt_pk_bf16_f32 v172, v144, v145
  v_cvt_pk_bf16_f32 v173, v146, v147
  v_cvt_pk_bf16_f32 v174, v148, v149
  v_cvt_pk_bf16_f32 v175, v150, v151
  v_mfma_f32_32x32x16_bf16 v[136:151], v[192:195], v[24:27], 0
  v_exp_f32 v152, v152
  v_exp_f32 v153, v153
  v_exp_f32 v154, v154
  v_mfma_f32_32x32x16_bf16 v[88:103], v[188:191], v[172:175], v[88:103]
  v_exp_f32 v155, v155
  v_exp_f32 v156, v156
  v_exp_f32 v157, v157
  v_smfmac_f32_16x16x64_bf16 v[128:131], v[16:19], v[168:175], v20
  v_exp_f32 v158, v158
  v_exp_f32 v159, v159
  v_mfma_f32_32x32x16_bf16 v[136:151], v[196:199], v[28:31], v[136:151]
  v_cvt_pk_bf16_f32 v168, v152, v153
  v_cvt_pk_bf16_f32 v169, v154, v155
  v_cvt_pk_bf16_f32 v170, v156, v157
  v_cvt_pk_bf16_f32 v171, v158, v159
  v_exp_f32 v160, v160
  v_exp_f32 v161, v161
  v_exp_f32 v162, v162
  v_exp_f32 v163, v163
  s_waitcnt lgkmcnt(2)
  v_mfma_f32_32x32x16_bf16 v[104:119], v[184:187], v[168:171], 0
  v_exp_f32 v164, v164
  v_exp_f32 v165, v165
  v_exp_f32 v166, v166
  v_exp_f32 v167, v167
  v_cvt_pk_bf16_f32 v172, v160, v161
  v_cvt_pk_bf16_f32 v173, v162, v163
  v_cvt_pk_bf16_f32 v174, v164, v165
  v_cvt_pk_bf16_f32 v175, v166, v167
  s_branch .g2_kernel_a_n1
.g2_kernel_a_end:
  v_mfma_f32_32x32x16_bf16 v[104:119], v[236:239], v[172:175], v[104:119]
  v_smfmac_f32_16x16x64_bf16 v[132:135], v[16:19], v[168:175], v20
  s_wakeup
  s_nop 9
  v_cvt_pk_bf16_f32 v104, v104, v105
  v_cvt_pk_bf16_f32 v105, v106, v107
  v_cvt_pk_bf16_f32 v106, v108, v109
  v_cvt_pk_bf16_f32 v107, v110, v111
  v_add_f32 v6, v132, v133
  ds_write_b128 v9, v[104:107] offset:24576
  v_cvt_pk_bf16_f32 v108, v112, v113
  v_cvt_pk_bf16_f32 v109, v114, v115
  v_cvt_pk_bf16_f32 v110, v116, v117
  v_cvt_pk_bf16_f32 v111, v118, v119
  ds_write_b128 v9, v[108:111] offset:25600
  v_mov_b32 v132, 0
  v_mov_b32 v133, 0
  ds_write_b32 v10, v6 offset:1536
  ds_write_b32 v11, v12 offset:48
  s_waitcnt lgkmcnt(4)
  v_mov_b32 v20, s71
  v_lshrrev_b32 v17, 5, v2
  v_and_b32 v18, 31, v2
  s_lshl_b32 s28, s16, 5
  v_add_u32 v19, s28, v18
  v_lshlrev_b32 v7, 2, v19
  v_add_u32 v7, 155648, v7
  ds_read_b32 v8, v7 offset:3840
  ds_read_b32 v9, v7 offset:4352
  ds_read_b32 v16, v20 offset:24
  ds_read_b32 v6, v20 offset:52
  v_add_u32 v19, 1, v19
  v_bfe_u32 v7, v2, 2, 2
  v_lshl_add_u32 v14, v17, 2, v7
  v_lshlrev_b32 v14, 7, v14
  v_lshrrev_b32 v7, 1, v7
  v_lshl_add_u32 v14, v7, 6, v14
  v_bfe_u32 v7, v2, 4, 1
  v_lshl_add_u32 v14, v7, 5, v14
  v_and_b32 v7, 1, v2
  v_lshl_add_u32 v14, v7, 4, v14
  v_bfe_u32 v7, v2, 1, 1
  v_lshl_add_u32 v14, v7, 3, v14
  v_xor_b32 v15, 64, v14
  v_and_b32 v7, 7, v2
  v_xor_b32 v7, s24, v7
  s_mov_b32 s28, 192
  s_add_u32 s28, s28, 157952
  v_lshl_add_u32 v21, v7, 3, s28
  v_lshlrev_b32 v24, 16, v240
  v_and_b32 v25, 0xffff0000, v240
  v_lshlrev_b32 v26, 16, v241
  v_and_b32 v27, 0xffff0000, v241
  v_lshlrev_b32 v28, 16, v242
  v_and_b32 v29, 0xffff0000, v242
  v_lshlrev_b32 v30, 16, v243
  v_and_b32 v31, 0xffff0000, v243
  v_lshlrev_b32 v32, 16, v244
  v_and_b32 v33, 0xffff0000, v244
  v_lshlrev_b32 v34, 16, v245
  v_and_b32 v35, 0xffff0000, v245
  v_lshlrev_b32 v36, 16, v246
  v_and_b32 v37, 0xffff0000, v246
  v_lshlrev_b32 v38, 16, v247
  v_and_b32 v39, 0xffff0000, v247
  v_lshlrev_b32 v40, 16, v248
  v_and_b32 v41, 0xffff0000, v248
  v_lshlrev_b32 v42, 16, v249
  v_and_b32 v43, 0xffff0000, v249
  v_lshlrev_b32 v44, 16, v250
  v_and_b32 v45, 0xffff0000, v250
  v_lshlrev_b32 v46, 16, v251
  v_and_b32 v47, 0xffff0000, v251
  v_lshlrev_b32 v48, 16, v252
  v_and_b32 v49, 0xffff0000, v252
  v_lshlrev_b32 v50, 16, v253
  v_and_b32 v51, 0xffff0000, v253
  v_lshlrev_b32 v52, 16, v254
  v_and_b32 v53, 0xffff0000, v254
  v_lshlrev_b32 v54, 16, v255
  v_and_b32 v55, 0xffff0000, v255
  s_waitcnt lgkmcnt(0)
  v_cmp_gt_u32 vcc, 4, v6
  s_cbranch_vccnz .g2_kernel_w_aw
.g2_kernel_w_ab:
  s_xor_b32 s28, s24, 0
  s_lshl_b32 s28, s28, 13
  s_add_u32 s28, s28, 65536
  v_add_u32 v10, s28, v14
  v_add_u32 v11, s28, v15
  ds_read_b64_tr_b16 v[104:105], v10 offset:0
  ds_read_b64_tr_b16 v[106:107], v10 offset:1024
  ds_read_b64_tr_b16 v[108:109], v11 offset:0
  ds_read_b64_tr_b16 v[110:111], v11 offset:1024
  ds_read_b64_tr_b16 v[112:113], v10 offset:2048
  ds_read_b64_tr_b16 v[114:115], v10 offset:3072
  ds_read_b64_tr_b16 v[116:117], v11 offset:2048
  ds_read_b64_tr_b16 v[118:119], v11 offset:3072
  ds_read_b64_tr_b16 v[120:121], v10 offset:4096
  ds_read_b64_tr_b16 v[122:123], v10 offset:5120
  ds_read_b64_tr_b16 v[124:125], v11 offset:4096
  ds_read_b64_tr_b16 v[126:127], v11 offset:5120
  s_andn2_b32 s33, s36, s34
  s_ff1_i32_b32 s33, s33
  s_bitset1_b32 s34, s33
  s_xor_b32 s33, s33, s24
  s_lshl_b32 s33, s33, 12
  s_add_u32 s22, s20, s33
  s_addc_u32 s23, s21, 0
  global_load_dwordx4 v[224:227], v3, s[22:23] offset:0
  global_load_dwordx4 v[228:231], v3, s[22:23] offset:1024
  global_load_dwordx4 v[232:235], v3, s[22:23] offset:2048
  global_load_dwordx4 v[236:239], v3, s[22:23] offset:3072
  v_pk_fma_f32 v[24:25], v[24:25], v[8:9], v[8:9] op_sel:[0,0,1] op_sel_hi:[1,0,1]
  v_pk_fma_f32 v[26:27], v[26:27], v[8:9], v[8:9] op_sel:[0,0,1] op_sel_hi:[1,0,1]
  v_pk_fma_f32 v[28:29], v[28:29], v[8:9], v[8:9] op_sel:[0,0,1] op_sel_hi:[1,0,1]
  v_pk_fma_f32 v[30:31], v[30:31], v[8:9], v[8:9] op_sel:[0,0,1] op_sel_hi:[1,0,1]
  v_pk_fma_f32 v[32:33], v[32:33], v[8:9], v[8:9] op_sel:[0,0,1] op_sel_hi:[1,0,1]
  v_pk_fma_f32 v[34:35], v[34:35], v[8:9], v[8:9] op_sel:[0,0,1] op_sel_hi:[1,0,1]
  v_pk_fma_f32 v[36:37], v[36:37], v[8:9], v[8:9] op_sel:[0,0,1] op_sel_hi:[1,0,1]
  v_pk_fma_f32 v[38:39], v[38:39], v[8:9], v[8:9] op_sel:[0,0,1] op_sel_hi:[1,0,1]
  v_pk_fma_f32 v[40:41], v[40:41], v[8:9], v[8:9] op_sel:[0,0,1] op_sel_hi:[1,0,1]
  v_pk_fma_f32 v[42:43], v[42:43], v[8:9], v[8:9] op_sel:[0,0,1] op_sel_hi:[1,0,1]
  v_pk_fma_f32 v[44:45], v[44:45], v[8:9], v[8:9] op_sel:[0,0,1] op_sel_hi:[1,0,1]
  v_pk_fma_f32 v[46:47], v[46:47], v[8:9], v[8:9] op_sel:[0,0,1] op_sel_hi:[1,0,1]
  v_pk_fma_f32 v[48:49], v[48:49], v[8:9], v[8:9] op_sel:[0,0,1] op_sel_hi:[1,0,1]
  v_pk_fma_f32 v[50:51], v[50:51], v[8:9], v[8:9] op_sel:[0,0,1] op_sel_hi:[1,0,1]
  v_pk_fma_f32 v[52:53], v[52:53], v[8:9], v[8:9] op_sel:[0,0,1] op_sel_hi:[1,0,1]
  v_pk_fma_f32 v[54:55], v[54:55], v[8:9], v[8:9] op_sel:[0,0,1] op_sel_hi:[1,0,1]
  v_cmp_eq_u32 vcc, v16, v19
  s_cbranch_vccnz .g2_kernel_w_pt
.g2_kernel_w_pb:
  s_mov_b32 s72, s48
  s_mov_b32 s73, s49
  s_mov_b32 s74, 0x800
  s_mov_b32 s75, 0x00020000
  s_waitcnt vmcnt(15) lgkmcnt(8)
  v_mfma_f32_32x32x16_bf16 v[24:39], v[104:107], v[176:179], v[24:39]
  s_xor_b32 s28, s24, 1
  s_lshl_b32 s28, s28, 13
  s_add_u32 s28, s28, 65536
  ds_read_b64_tr_b16 v[128:129], v10 offset:6144
  ds_read_b64_tr_b16 v[130:131], v10 offset:7168
  v_mfma_f32_32x32x16_bf16 v[40:55], v[108:111], v[176:179], v[40:55]
  v_add_u32 v12, s28, v14
  v_add_u32 v13, s28, v15
  s_andn2_b32 s33, s36, s34
  ds_read_b64_tr_b16 v[132:133], v11 offset:6144
  ds_read_b64_tr_b16 v[134:135], v11 offset:7168
  s_waitcnt vmcnt(14) lgkmcnt(8)
  v_mfma_f32_32x32x16_bf16 v[24:39], v[112:115], v[180:183], v[24:39]
  s_ff1_i32_b32 s33, s33
  s_bitset1_b32 s34, s33
  s_xor_b32 s33, s33, s24
  ds_read_b64_tr_b16 v[104:105], v12 offset:0
  ds_read_b64_tr_b16 v[106:107], v12 offset:1024
  v_mfma_f32_32x32x16_bf16 v[40:55], v[116:119], v[180:183], v[40:55]
  s_lshl_b32 s33, s33, 12
  s_add_u32 s22, s20, s33
  s_addc_u32 s23, s21, 0
  ds_read_b64_tr_b16 v[108:109], v13 offset:0
  ds_read_b64_tr_b16 v[110:111], v13 offset:1024
  s_waitcnt vmcnt(13) lgkmcnt(8)
  v_mfma_f32_32x32x16_bf16 v[24:39], v[120:123], v[184:187], v[24:39]
  global_load_dwordx4 v[136:139], v3, s[22:23] offset:0
  global_load_dwordx4 v[140:143], v3, s[22:23] offset:1024
  global_load_dwordx4 v[144:147], v3, s[22:23] offset:2048
  ds_read_b64_tr_b16 v[112:113], v12 offset:2048
  ds_read_b64_tr_b16 v[114:115], v12 offset:3072
  v_mfma_f32_32x32x16_bf16 v[40:55], v[124:127], v[184:187], v[40:55]
  global_load_dwordx4 v[148:151], v3, s[22:23] offset:3072
  ds_read_b64_tr_b16 v[116:117], v13 offset:2048
  ds_read_b64_tr_b16 v[118:119], v13 offset:3072
  s_waitcnt vmcnt(16) lgkmcnt(8)
  v_mfma_f32_32x32x16_bf16 v[24:39], v[128:131], v[188:191], v[24:39]
  ds_read_b64_tr_b16 v[120:121], v12 offset:4096
  ds_read_b64_tr_b16 v[122:123], v12 offset:5120
  v_mfma_f32_32x32x16_bf16 v[40:55], v[132:135], v[188:191], v[40:55]
  ds_read_b64_tr_b16 v[124:125], v13 offset:4096
  ds_read_b64_tr_b16 v[126:127], v13 offset:5120
  s_waitcnt vmcnt(15) lgkmcnt(8)
  v_mfma_f32_32x32x16_bf16 v[24:39], v[104:107], v[192:195], v[24:39]
  s_xor_b32 s28, s24, 2
  s_lshl_b32 s28, s28, 13
  s_add_u32 s28, s28, 65536
  ds_read_b64_tr_b16 v[128:129], v12 offset:6144
  ds_read_b64_tr_b16 v[130:131], v12 offset:7168
  v_mfma_f32_32x32x16_bf16 v[40:55], v[108:111], v[192:195], v[40:55]
  v_add_u32 v10, s28, v14
  v_add_u32 v11, s28, v15
  s_andn2_b32 s33, s36, s34
  ds_read_b64_tr_b16 v[132:133], v13 offset:6144
  ds_read_b64_tr_b16 v[134:135], v13 offset:7168
  s_waitcnt vmcnt(14) lgkmcnt(8)
  v_mfma_f32_32x32x16_bf16 v[24:39], v[112:115], v[196:199], v[24:39]
  s_ff1_i32_b32 s33, s33
  s_bitset1_b32 s34, s33
  s_xor_b32 s33, s33, s24
  ds_read_b64_tr_b16 v[104:105], v10 offset:0
  ds_read_b64_tr_b16 v[106:107], v10 offset:1024
  v_mfma_f32_32x32x16_bf16 v[40:55], v[116:119], v[196:199], v[40:55]
  s_lshl_b32 s33, s33, 12
  s_add_u32 s22, s20, s33
  s_addc_u32 s23, s21, 0
  ds_read_b64_tr_b16 v[108:109], v11 offset:0
  ds_read_b64_tr_b16 v[110:111], v11 offset:1024
  s_waitcnt vmcnt(13) lgkmcnt(8)
  v_mfma_f32_32x32x16_bf16 v[24:39], v[120:123], v[200:203], v[24:39]
  global_load_dwordx4 v[152:155], v3, s[22:23] offset:0
  global_load_dwordx4 v[156:159], v3, s[22:23] offset:1024
  global_load_dwordx4 v[160:163], v3, s[22:23] offset:2048
  ds_read_b64_tr_b16 v[112:113], v10 offset:2048
  ds_read_b64_tr_b16 v[114:115], v10 offset:3072
  v_mfma_f32_32x32x16_bf16 v[40:55], v[124:127], v[200:203], v[40:55]
  global_load_dwordx4 v[164:167], v3, s[22:23] offset:3072
  ds_read_b64_tr_b16 v[116:117], v11 offset:2048
  ds_read_b64_tr_b16 v[118:119], v11 offset:3072
  s_waitcnt vmcnt(16) lgkmcnt(8)
  v_mfma_f32_32x32x16_bf16 v[24:39], v[128:131], v[204:207], v[24:39]
  ds_read_b64_tr_b16 v[120:121], v10 offset:4096
  ds_read_b64_tr_b16 v[122:123], v10 offset:5120
  v_mfma_f32_32x32x16_bf16 v[40:55], v[132:135], v[204:207], v[40:55]
  ds_read_b64_tr_b16 v[124:125], v11 offset:4096
  ds_read_b64_tr_b16 v[126:127], v11 offset:5120
  s_waitcnt vmcnt(15) lgkmcnt(8)
  v_mfma_f32_32x32x16_bf16 v[24:39], v[104:107], v[208:211], v[24:39]
  s_xor_b32 s28, s24, 3
  s_lshl_b32 s28, s28, 13
  s_add_u32 s28, s28, 65536
  ds_read_b64_tr_b16 v[128:129], v10 offset:6144
  ds_read_b64_tr_b16 v[130:131], v10 offset:7168
  v_mfma_f32_32x32x16_bf16 v[40:55], v[108:111], v[208:211], v[40:55]
  v_add_u32 v12, s28, v14
  v_add_u32 v13, s28, v15
  s_andn2_b32 s33, s36, s34
  ds_read_b64_tr_b16 v[132:133], v11 offset:6144
  ds_read_b64_tr_b16 v[134:135], v11 offset:7168
  s_waitcnt vmcnt(14) lgkmcnt(8)
  v_mfma_f32_32x32x16_bf16 v[24:39], v[112:115], v[212:215], v[24:39]
  s_ff1_i32_b32 s33, s33
  s_bitset1_b32 s34, s33
  s_xor_b32 s33, s33, s24
  ds_read_b64_tr_b16 v[104:105], v12 offset:0
  ds_read_b64_tr_b16 v[106:107], v12 offset:1024
  v_mfma_f32_32x32x16_bf16 v[40:55], v[116:119], v[212:215], v[40:55]
  s_lshl_b32 s33, s33, 12
  s_add_u32 s22, s20, s33
  s_addc_u32 s23, s21, 0
  ds_read_b64_tr_b16 v[108:109], v13 offset:0
  ds_read_b64_tr_b16 v[110:111], v13 offset:1024
  s_waitcnt vmcnt(13) lgkmcnt(8)
  v_mfma_f32_32x32x16_bf16 v[24:39], v[120:123], v[216:219], v[24:39]
  global_load_dwordx4 v[56:59], v3, s[22:23] offset:0
  global_load_dwordx4 v[60:63], v3, s[22:23] offset:1024
  global_load_dwordx4 v[64:67], v3, s[22:23] offset:2048
  ds_read_b64_tr_b16 v[112:113], v12 offset:2048
  ds_read_b64_tr_b16 v[114:115], v12 offset:3072
  v_mfma_f32_32x32x16_bf16 v[40:55], v[124:127], v[216:219], v[40:55]
  global_load_dwordx4 v[68:71], v3, s[22:23] offset:3072
  ds_read_b64_tr_b16 v[116:117], v13 offset:2048
  ds_read_b64_tr_b16 v[118:119], v13 offset:3072
  s_waitcnt vmcnt(16) lgkmcnt(8)
  v_mfma_f32_32x32x16_bf16 v[24:39], v[128:131], v[220:223], v[24:39]
  ds_read_b64_tr_b16 v[120:121], v12 offset:4096
  ds_read_b64_tr_b16 v[122:123], v12 offset:5120
  v_mfma_f32_32x32x16_bf16 v[40:55], v[132:135], v[220:223], v[40:55]
  ds_read_b64_tr_b16 v[124:125], v13 offset:4096
  ds_read_b64_tr_b16 v[126:127], v13 offset:5120
  s_waitcnt vmcnt(15) lgkmcnt(8)
  v_mfma_f32_32x32x16_bf16 v[24:39], v[104:107], v[224:227], v[24:39]
  s_xor_b32 s28, s24, 4
  s_lshl_b32 s28, s28, 13
  s_add_u32 s28, s28, 65536
  ds_read_b64_tr_b16 v[128:129], v12 offset:6144
  ds_read_b64_tr_b16 v[130:131], v12 offset:7168
  v_mfma_f32_32x32x16_bf16 v[40:55], v[108:111], v[224:227], v[40:55]
  v_add_u32 v10, s28, v14
  v_add_u32 v11, s28, v15
  s_andn2_b32 s33, s36, s34
  ds_read_b64_tr_b16 v[132:133], v13 offset:6144
  ds_read_b64_tr_b16 v[134:135], v13 offset:7168
  s_waitcnt vmcnt(14) lgkmcnt(8)
  v_mfma_f32_32x32x16_bf16 v[24:39], v[112:115], v[228:231], v[24:39]
  s_ff1_i32_b32 s33, s33
  s_bitset1_b32 s34, s33
  s_xor_b32 s33, s33, s24
  ds_read_b64_tr_b16 v[104:105], v10 offset:0
  ds_read_b64_tr_b16 v[106:107], v10 offset:1024
  v_mfma_f32_32x32x16_bf16 v[40:55], v[116:119], v[228:231], v[40:55]
  s_lshl_b32 s33, s33, 12
  s_add_u32 s22, s20, s33
  s_addc_u32 s23, s21, 0
  ds_read_b64_tr_b16 v[108:109], v11 offset:0
  ds_read_b64_tr_b16 v[110:111], v11 offset:1024
  s_waitcnt vmcnt(13) lgkmcnt(8)
  v_mfma_f32_32x32x16_bf16 v[24:39], v[120:123], v[232:235], v[24:39]
  global_load_dwordx4 v[72:75], v3, s[22:23] offset:0
  global_load_dwordx4 v[76:79], v3, s[22:23] offset:1024
  global_load_dwordx4 v[80:83], v3, s[22:23] offset:2048
  ds_read_b64_tr_b16 v[112:113], v10 offset:2048
  ds_read_b64_tr_b16 v[114:115], v10 offset:3072
  v_mfma_f32_32x32x16_bf16 v[40:55], v[124:127], v[232:235], v[40:55]
  global_load_dwordx4 v[84:87], v3, s[22:23] offset:3072
  ds_read_b64_tr_b16 v[116:117], v11 offset:2048
  ds_read_b64_tr_b16 v[118:119], v11 offset:3072
  s_waitcnt vmcnt(16) lgkmcnt(8)
  v_mfma_f32_32x32x16_bf16 v[24:39], v[128:131], v[236:239], v[24:39]
  ds_read_b64_tr_b16 v[120:121], v10 offset:4096
  ds_read_b64_tr_b16 v[122:123], v10 offset:5120
  v_mfma_f32_32x32x16_bf16 v[40:55], v[132:135], v[236:239], v[40:55]
  ds_read_b64_tr_b16 v[124:125], v11 offset:4096
  ds_read_b64_tr_b16 v[126:127], v11 offset:5120
  s_waitcnt vmcnt(15) lgkmcnt(8)
  v_mfma_f32_32x32x16_bf16 v[24:39], v[104:107], v[136:139], v[24:39]
  s_xor_b32 s28, s24, 5
  s_lshl_b32 s28, s28, 13
  s_add_u32 s28, s28, 65536
  v_add_u32 v12, s28, v14
  ds_read_b64_tr_b16 v[128:129], v10 offset:6144
  ds_read_b64_tr_b16 v[130:131], v10 offset:7168
  v_mfma_f32_32x32x16_bf16 v[40:55], v[108:111], v[136:139], v[40:55]
  v_add_u32 v13, s28, v15
  s_andn2_b32 s33, s36, s34
  s_cbranch_scc0 .g2_kernel_w_i8c
.g2_kernel_w_i8b:
  s_ff1_i32_b32 s33, s33
  ds_read_b64_tr_b16 v[132:133], v11 offset:6144
  ds_read_b64_tr_b16 v[134:135], v11 offset:7168
  s_waitcnt vmcnt(14) lgkmcnt(8)
  v_mfma_f32_32x32x16_bf16 v[24:39], v[112:115], v[140:143], v[24:39]
  s_bitset1_b32 s34, s33
  s_xor_b32 s33, s33, s24
  s_and_b32 s8, s33, 7
  s_cmp_lt_u32 s8, 2
  ds_read_b64_tr_b16 v[104:105], v12 offset:0
  ds_read_b64_tr_b16 v[106:107], v12 offset:1024
  v_mfma_f32_32x32x16_bf16 v[40:55], v[116:119], v[140:143], v[40:55]
  s_cselect_b32 s28, 139264, 0
  s_lshl_b32 s8, s8, 13
  s_add_u32 s8, s8, s28
  s_lshl_b32 s33, s33, 12
  ds_read_b64_tr_b16 v[108:109], v13 offset:0
  ds_read_b64_tr_b16 v[110:111], v13 offset:1024
  s_waitcnt vmcnt(13) lgkmcnt(8)
  v_mfma_f32_32x32x16_bf16 v[24:39], v[120:123], v[144:147], v[24:39]
  s_add_u32 s22, s20, s33
  s_addc_u32 s23, s21, 0
  global_load_dwordx4 v[88:91], v3, s[22:23] offset:0
  global_load_dwordx4 v[92:95], v3, s[22:23] offset:1024
  ds_read_b64_tr_b16 v[112:113], v12 offset:2048
  ds_read_b64_tr_b16 v[114:115], v12 offset:3072
  v_mfma_f32_32x32x16_bf16 v[40:55], v[124:127], v[144:147], v[40:55]
  global_load_dwordx4 v[96:99], v3, s[22:23] offset:2048
  global_load_dwordx4 v[100:103], v3, s[22:23] offset:3072
  ds_read_b64_tr_b16 v[116:117], v13 offset:2048
  ds_read_b64_tr_b16 v[118:119], v13 offset:3072
  s_waitcnt vmcnt(16) lgkmcnt(8)
  v_mfma_f32_32x32x16_bf16 v[24:39], v[128:131], v[148:151], v[24:39]
  ds_read_b64_tr_b16 v[120:121], v12 offset:4096
  ds_read_b64_tr_b16 v[122:123], v12 offset:5120
  v_mfma_f32_32x32x16_bf16 v[40:55], v[132:135], v[148:151], v[40:55]
  ds_read_b64_tr_b16 v[124:125], v13 offset:4096
  ds_read_b64_tr_b16 v[126:127], v13 offset:5120
  s_waitcnt vmcnt(15) lgkmcnt(8)
  v_mfma_f32_32x32x16_bf16 v[24:39], v[104:107], v[152:155], v[24:39]
  s_xor_b32 s28, s24, 6
  s_lshl_b32 s28, s28, 13
  s_add_u32 s28, s28, 65536
  v_add_u32 v10, s28, v14
  v_add_u32 v11, s28, v15
  ds_read_b64_tr_b16 v[128:129], v12 offset:6144
  ds_read_b64_tr_b16 v[130:131], v12 offset:7168
  v_mfma_f32_32x32x16_bf16 v[40:55], v[108:111], v[152:155], v[40:55]
  s_andn2_b32 s33, s36, s34
  s_cbranch_scc0 .g2_kernel_w_i9c
.g2_kernel_w_i9b:
  s_ff1_i32_b32 s33, s33
  s_bitset1_b32 s34, s33
  s_xor_b32 s33, s33, s24
  ds_read_b64_tr_b16 v[132:133], v13 offset:6144
  ds_read_b64_tr_b16 v[134:135], v13 offset:7168
  s_waitcnt vmcnt(14) lgkmcnt(8)
  v_mfma_f32_32x32x16_bf16 v[24:39], v[112:115], v[156:159], v[24:39]
  s_and_b32 s9, s33, 7
  s_cmp_lt_u32 s9, 2
  s_cselect_b32 s28, 139264, 0
  s_lshl_b32 s9, s9, 13
  s_add_u32 s9, s9, s28
  ds_read_b64_tr_b16 v[104:105], v10 offset:0
  ds_read_b64_tr_b16 v[106:107], v10 offset:1024
  v_mfma_f32_32x32x16_bf16 v[40:55], v[116:119], v[156:159], v[40:55]
  s_lshl_b32 s33, s33, 12
  s_add_u32 s22, s20, s33
  s_addc_u32 s23, s21, 0
  global_load_dwordx4 v[176:179], v3, s[22:23] offset:0
  global_load_dwordx4 v[180:183], v3, s[22:23] offset:1024
  ds_read_b64_tr_b16 v[108:109], v11 offset:0
  ds_read_b64_tr_b16 v[110:111], v11 offset:1024
  s_waitcnt vmcnt(15) lgkmcnt(8)
  v_mfma_f32_32x32x16_bf16 v[24:39], v[120:123], v[160:163], v[24:39]
  global_load_dwordx4 v[184:187], v3, s[22:23] offset:2048
  global_load_dwordx4 v[188:191], v3, s[22:23] offset:3072
  v_lshlrev_b32 v16, 4, v17
  s_lshl_b32 s29, s18, 7
  buffer_load_dwordx4 v[240:243], v16, s[72:75], s29 offen offset:0
  ds_read_b64_tr_b16 v[112:113], v10 offset:2048
  ds_read_b64_tr_b16 v[114:115], v10 offset:3072
  v_mfma_f32_32x32x16_bf16 v[40:55], v[124:127], v[160:163], v[40:55]
  buffer_load_dwordx4 v[244:247], v16, s[72:75], s29 offen offset:32
  buffer_load_dwordx4 v[248:251], v16, s[72:75], s29 offen offset:64
  buffer_load_dwordx4 v[252:255], v16, s[72:75], s29 offen offset:96
  ds_read_b64_tr_b16 v[116:117], v11 offset:2048
  ds_read_b64_tr_b16 v[118:119], v11 offset:3072
  s_waitcnt vmcnt(20) lgkmcnt(8)
  v_mfma_f32_32x32x16_bf16 v[24:39], v[128:131], v[164:167], v[24:39]
  ds_read_b64_tr_b16 v[120:121], v10 offset:4096
  ds_read_b64_tr_b16 v[122:123], v10 offset:5120
  v_mfma_f32_32x32x16_bf16 v[40:55], v[132:135], v[164:167], v[40:55]
  ds_read_b64_tr_b16 v[124:125], v11 offset:4096
  ds_read_b64_tr_b16 v[126:127], v11 offset:5120
  s_waitcnt vmcnt(19) lgkmcnt(8)
  v_mfma_f32_32x32x16_bf16 v[24:39], v[104:107], v[56:59], v[24:39]
  s_xor_b32 s28, s24, 7
  s_lshl_b32 s28, s28, 13
  s_add_u32 s28, s28, 65536
  v_add_u32 v12, s28, v14
  ds_read_b64_tr_b16 v[128:129], v10 offset:6144
  ds_read_b64_tr_b16 v[130:131], v10 offset:7168
  v_mfma_f32_32x32x16_bf16 v[40:55], v[108:111], v[56:59], v[40:55]
  v_add_u32 v13, s28, v15
  s_andn2_b32 s33, s36, s34
  s_cbranch_scc0 .g2_kernel_w_i10c
.g2_kernel_w_i10b:
  s_ff1_i32_b32 s33, s33
  ds_read_b64_tr_b16 v[132:133], v11 offset:6144
  ds_read_b64_tr_b16 v[134:135], v11 offset:7168
  s_waitcnt vmcnt(18) lgkmcnt(8)
  v_mfma_f32_32x32x16_bf16 v[24:39], v[112:115], v[60:63], v[24:39]
  s_bitset1_b32 s34, s33
  s_xor_b32 s33, s33, s24
  s_and_b32 s10, s33, 7
  s_cmp_lt_u32 s10, 2
  ds_read_b64_tr_b16 v[104:105], v12 offset:0
  ds_read_b64_tr_b16 v[106:107], v12 offset:1024
  v_mfma_f32_32x32x16_bf16 v[40:55], v[116:119], v[60:63], v[40:55]
  s_cselect_b32 s28, 139264, 0
  s_lshl_b32 s10, s10, 13
  s_add_u32 s10, s10, s28
  s_lshl_b32 s33, s33, 12
  ds_read_b64_tr_b16 v[108:109], v13 offset:0
  ds_read_b64_tr_b16 v[110:111], v13 offset:1024
  s_waitcnt vmcnt(17) lgkmcnt(8)
  v_mfma_f32_32x32x16_bf16 v[24:39], v[120:123], v[64:67], v[24:39]
  s_add_u32 s22, s20, s33
  s_addc_u32 s23, s21, 0
  global_load_dwordx4 v[192:195], v3, s[22:23] offset:0
  global_load_dwordx4 v[196:199], v3, s[22:23] offset:1024
  ds_read_b64_tr_b16 v[112:113], v12 offset:2048
  ds_read_b64_tr_b16 v[114:115], v12 offset:3072
  v_mfma_f32_32x32x16_bf16 v[40:55], v[124:127], v[64:67], v[40:55]
  global_load_dwordx4 v[200:203], v3, s[22:23] offset:2048
  global_load_dwordx4 v[204:207], v3, s[22:23] offset:3072
  ds_read_b64_tr_b16 v[116:117], v13 offset:2048
  ds_read_b64_tr_b16 v[118:119], v13 offset:3072
  s_waitcnt vmcnt(20) lgkmcnt(8)
  v_mfma_f32_32x32x16_bf16 v[24:39], v[128:131], v[68:71], v[24:39]
  ds_read_b64_tr_b16 v[120:121], v12 offset:4096
  ds_read_b64_tr_b16 v[122:123], v12 offset:5120
  v_mfma_f32_32x32x16_bf16 v[40:55], v[132:135], v[68:71], v[40:55]
  ds_read_b64_tr_b16 v[124:125], v13 offset:4096
  ds_read_b64_tr_b16 v[126:127], v13 offset:5120
  s_waitcnt vmcnt(19) lgkmcnt(8)
  v_mfma_f32_32x32x16_bf16 v[24:39], v[104:107], v[72:75], v[24:39]
  s_andn2_b32 s33, s36, s34
  s_cbranch_scc0 .g2_kernel_w_i11c
.g2_kernel_w_i11b:
  s_ff1_i32_b32 s33, s33
  ds_read_b64_tr_b16 v[128:129], v12 offset:6144
  ds_read_b64_tr_b16 v[130:131], v12 offset:7168
  v_mfma_f32_32x32x16_bf16 v[40:55], v[108:111], v[72:75], v[40:55]
  s_bitset1_b32 s34, s33
  s_xor_b32 s33, s33, s24
  s_and_b32 s11, s33, 7
  ds_read_b64_tr_b16 v[132:133], v13 offset:6144
  ds_read_b64_tr_b16 v[134:135], v13 offset:7168
  s_waitcnt vmcnt(18) lgkmcnt(8)
  v_mfma_f32_32x32x16_bf16 v[24:39], v[112:115], v[76:79], v[24:39]
  s_cmp_lt_u32 s11, 2
  s_cselect_b32 s28, 139264, 0
  s_lshl_b32 s11, s11, 13
  v_mfma_f32_32x32x16_bf16 v[40:55], v[116:119], v[76:79], v[40:55]
  s_add_u32 s11, s11, s28
  s_lshl_b32 s33, s33, 12
  s_add_u32 s22, s20, s33
  s_waitcnt vmcnt(17) lgkmcnt(4)
  v_mfma_f32_32x32x16_bf16 v[24:39], v[120:123], v[80:83], v[24:39]
  s_addc_u32 s23, s21, 0
  global_load_dwordx4 v[208:211], v3, s[22:23] offset:0
  global_load_dwordx4 v[212:215], v3, s[22:23] offset:1024
  v_mfma_f32_32x32x16_bf16 v[40:55], v[124:127], v[80:83], v[40:55]
  global_load_dwordx4 v[216:219], v3, s[22:23] offset:2048
  global_load_dwordx4 v[220:223], v3, s[22:23] offset:3072
  s_waitcnt vmcnt(20) lgkmcnt(0)
  v_mfma_f32_32x32x16_bf16 v[24:39], v[128:131], v[84:87], v[24:39]
  v_mfma_f32_32x32x16_bf16 v[40:55], v[132:135], v[84:87], v[40:55]
  ds_read_b32 v16, v20 offset:12
  v_add_u32 v10, s8, v14
  v_add_u32 v11, s8, v15
  s_waitcnt lgkmcnt(0)
  v_cmp_gt_u32 vcc, 4, v16
  s_cbranch_vccnz .g2_kernel_w_bw
.g2_kernel_w_bb:
  ds_read_b64_tr_b16 v[104:105], v10 offset:0
  ds_read_b64_tr_b16 v[106:107], v10 offset:1024
  ds_read_b64_tr_b16 v[108:109], v11 offset:0
  ds_read_b64_tr_b16 v[110:111], v11 offset:1024
  ds_read_b64_tr_b16 v[112:113], v10 offset:2048
  ds_read_b64_tr_b16 v[114:115], v10 offset:3072
  ds_read_b64_tr_b16 v[116:117], v11 offset:2048
  ds_read_b64_tr_b16 v[118:119], v11 offset:3072
  ds_read_b64_tr_b16 v[120:121], v10 offset:4096
  ds_read_b64_tr_b16 v[122:123], v10 offset:5120
  ds_read_b64_tr_b16 v[124:125], v11 offset:4096
  ds_read_b64_tr_b16 v[126:127], v11 offset:5120
  s_waitcnt vmcnt(16)
  v_min3_u32 v6, v88, v90, v92
  v_min3_u32 v7, v94, v96, v98
  v_min3_u32 v6, v6, v100, v102
  v_min_u32 v6, v6, v7
  v_cmp_eq_u32 vcc, 0, v6
  s_cbranch_vccnz .g2_kernel_w_v8
.g2_kernel_w_vb8:
  s_waitcnt lgkmcnt(8)
  v_mfma_f32_32x32x16_bf16 v[24:39], v[104:107], v[88:91], v[24:39]
  v_add_u32 v12, s9, v14
  v_add_u32 v13, s9, v15
  s_andn2_b32 s33, s36, s34
  s_cbranch_scc0 .g2_kernel_w_i12c
.g2_kernel_w_i12b:
  ds_read_b64_tr_b16 v[128:129], v10 offset:6144
  ds_read_b64_tr_b16 v[130:131], v10 offset:7168
  v_mfma_f32_32x32x16_bf16 v[40:55], v[108:111], v[88:91], v[40:55]
  s_ff1_i32_b32 s33, s33
  s_bitset1_b32 s34, s33
  s_xor_b32 s33, s33, s24
  s_and_b32 s12, s33, 7
  ds_read_b64_tr_b16 v[132:133], v11 offset:6144
  ds_read_b64_tr_b16 v[134:135], v11 offset:7168
  s_waitcnt lgkmcnt(8)
  v_mfma_f32_32x32x16_bf16 v[24:39], v[112:115], v[92:95], v[24:39]
  s_cmp_lt_u32 s12, 2
  s_cselect_b32 s28, 139264, 0
  s_lshl_b32 s12, s12, 13
  s_add_u32 s12, s12, s28
  ds_read_b64_tr_b16 v[104:105], v12 offset:0
  ds_read_b64_tr_b16 v[106:107], v12 offset:1024
  v_mfma_f32_32x32x16_bf16 v[40:55], v[116:119], v[92:95], v[40:55]
  s_lshl_b32 s33, s33, 12
  s_add_u32 s22, s20, s33
  s_addc_u32 s23, s21, 0
  global_load_dwordx4 v[224:227], v3, s[22:23] offset:0
  ds_read_b64_tr_b16 v[108:109], v13 offset:0
  ds_read_b64_tr_b16 v[110:111], v13 offset:1024
  s_waitcnt lgkmcnt(8)
  v_mfma_f32_32x32x16_bf16 v[24:39], v[120:123], v[96:99], v[24:39]
  global_load_dwordx4 v[228:231], v3, s[22:23] offset:1024
  global_load_dwordx4 v[232:235], v3, s[22:23] offset:2048
  global_load_dwordx4 v[236:239], v3, s[22:23] offset:3072
  ds_read_b64_tr_b16 v[112:113], v12 offset:2048
  ds_read_b64_tr_b16 v[114:115], v12 offset:3072
  v_mfma_f32_32x32x16_bf16 v[40:55], v[124:127], v[96:99], v[40:55]
  ds_read_b64_tr_b16 v[116:117], v13 offset:2048
  ds_read_b64_tr_b16 v[118:119], v13 offset:3072
  s_waitcnt lgkmcnt(8)
  v_mfma_f32_32x32x16_bf16 v[24:39], v[128:131], v[100:103], v[24:39]
  ds_read_b64_tr_b16 v[120:121], v12 offset:4096
  ds_read_b64_tr_b16 v[122:123], v12 offset:5120
  s_waitcnt vmcnt(16)
  v_min3_u32 v6, v176, v178, v180
  v_min3_u32 v7, v182, v184, v186
  v_min3_u32 v6, v6, v188, v190
  v_min_u32 v6, v6, v7
  v_cmp_eq_u32 vcc, 0, v6
  v_mfma_f32_32x32x16_bf16 v[40:55], v[132:135], v[100:103], v[40:55]
  ds_read_b64_tr_b16 v[124:125], v13 offset:4096
  ds_read_b64_tr_b16 v[126:127], v13 offset:5120
  s_cbranch_vccnz .g2_kernel_w_v9
.g2_kernel_w_vb9:
  s_waitcnt lgkmcnt(8)
  v_mfma_f32_32x32x16_bf16 v[24:39], v[104:107], v[176:179], v[24:39]
  v_add_u32 v10, s10, v14
  v_add_u32 v11, s10, v15
  s_andn2_b32 s33, s36, s34
  s_cbranch_scc0 .g2_kernel_w_i13c
.g2_kernel_w_i13b:
  ds_read_b64_tr_b16 v[128:129], v12 offset:6144
  ds_read_b64_tr_b16 v[130:131], v12 offset:7168
  v_mfma_f32_32x32x16_bf16 v[40:55], v[108:111], v[176:179], v[40:55]
  s_ff1_i32_b32 s33, s33
  s_bitset1_b32 s34, s33
  s_xor_b32 s33, s33, s24
  s_and_b32 s13, s33, 7
  ds_read_b64_tr_b16 v[132:133], v13 offset:6144
  ds_read_b64_tr_b16 v[134:135], v13 offset:7168
  s_waitcnt lgkmcnt(8)
  v_mfma_f32_32x32x16_bf16 v[24:39], v[112:115], v[180:183], v[24:39]
  s_cmp_lt_u32 s13, 2
  s_cselect_b32 s28, 139264, 0
  s_lshl_b32 s13, s13, 13
  s_add_u32 s13, s13, s28
  ds_read_b64_tr_b16 v[104:105], v10 offset:0
  ds_read_b64_tr_b16 v[106:107], v10 offset:1024
  v_mfma_f32_32x32x16_bf16 v[40:55], v[116:119], v[180:183], v[40:55]
  s_lshl_b32 s33, s33, 12
  s_add_u32 s22, s20, s33
  s_addc_u32 s23, s21, 0
  global_load_dwordx4 v[136:139], v3, s[22:23] offset:0
  ds_read_b64_tr_b16 v[108:109], v11 offset:0
  ds_read_b64_tr_b16 v[110:111], v11 offset:1024
  s_waitcnt lgkmcnt(8)
  v_mfma_f32_32x32x16_bf16 v[24:39], v[120:123], v[184:187], v[24:39]
  global_load_dwordx4 v[140:143], v3, s[22:23] offset:1024
  global_load_dwordx4 v[144:147], v3, s[22:23] offset:2048
  global_load_dwordx4 v[148:151], v3, s[22:23] offset:3072
  ds_read_b64_tr_b16 v[112:113], v10 offset:2048
  ds_read_b64_tr_b16 v[114:115], v10 offset:3072
  v_mfma_f32_32x32x16_bf16 v[40:55], v[124:127], v[184:187], v[40:55]
  ds_read_b64_tr_b16 v[116:117], v11 offset:2048
  ds_read_b64_tr_b16 v[118:119], v11 offset:3072
  s_waitcnt lgkmcnt(8)
  v_mfma_f32_32x32x16_bf16 v[24:39], v[128:131], v[188:191], v[24:39]
  ds_read_b64_tr_b16 v[120:121], v10 offset:4096
  ds_read_b64_tr_b16 v[122:123], v10 offset:5120
  s_waitcnt vmcnt(12)
  v_min3_u32 v6, v192, v194, v196
  v_min3_u32 v7, v198, v200, v202
  v_min3_u32 v6, v6, v204, v206
  v_min_u32 v6, v6, v7
  v_cmp_eq_u32 vcc, 0, v6
  v_mfma_f32_32x32x16_bf16 v[40:55], v[132:135], v[188:191], v[40:55]
  ds_read_b64_tr_b16 v[124:125], v11 offset:4096
  ds_read_b64_tr_b16 v[126:127], v11 offset:5120
  s_cbranch_vccnz .g2_kernel_w_v10
.g2_kernel_w_vb10:
  s_waitcnt lgkmcnt(8)
  v_mfma_f32_32x32x16_bf16 v[24:39], v[104:107], v[192:195], v[24:39]
  v_add_u32 v12, s11, v14
  v_add_u32 v13, s11, v15
  s_andn2_b32 s33, s36, s34
  s_cbranch_scc0 .g2_kernel_w_i14c
.g2_kernel_w_i14b:
  ds_read_b64_tr_b16 v[128:129], v10 offset:6144
  ds_read_b64_tr_b16 v[130:131], v10 offset:7168
  v_mfma_f32_32x32x16_bf16 v[40:55], v[108:111], v[192:195], v[40:55]
  s_ff1_i32_b32 s33, s33
  s_bitset1_b32 s34, s33
  s_xor_b32 s33, s33, s24
  s_and_b32 s14, s33, 7
  ds_read_b64_tr_b16 v[132:133], v11 offset:6144
  ds_read_b64_tr_b16 v[134:135], v11 offset:7168
  s_waitcnt lgkmcnt(8)
  v_mfma_f32_32x32x16_bf16 v[24:39], v[112:115], v[196:199], v[24:39]
  s_cmp_lt_u32 s14, 2
  s_cselect_b32 s28, 139264, 0
  s_lshl_b32 s14, s14, 13
  s_add_u32 s14, s14, s28
  ds_read_b64_tr_b16 v[104:105], v12 offset:0
  ds_read_b64_tr_b16 v[106:107], v12 offset:1024
  v_mfma_f32_32x32x16_bf16 v[40:55], v[116:119], v[196:199], v[40:55]
  s_lshl_b32 s33, s33, 12
  s_add_u32 s22, s20, s33
  s_addc_u32 s23, s21, 0
  global_load_dwordx4 v[152:155], v3, s[22:23] offset:0 sc1
  ds_read_b64_tr_b16 v[108:109], v13 offset:0
  ds_read_b64_tr_b16 v[110:111], v13 offset:1024
  s_waitcnt lgkmcnt(8)
  v_mfma_f32_32x32x16_bf16 v[24:39], v[120:123], v[200:203], v[24:39]
  global_load_dwordx4 v[156:159], v3, s[22:23] offset:1024 sc1
  global_load_dwordx4 v[160:163], v3, s[22:23] offset:2048 sc1
  global_load_dwordx4 v[164:167], v3, s[22:23] offset:3072 sc1
  ds_read_b64_tr_b16 v[112:113], v12 offset:2048
  ds_read_b64_tr_b16 v[114:115], v12 offset:3072
  v_mfma_f32_32x32x16_bf16 v[40:55], v[124:127], v[200:203], v[40:55]
  ds_read_b64_tr_b16 v[116:117], v13 offset:2048
  ds_read_b64_tr_b16 v[118:119], v13 offset:3072
  s_waitcnt lgkmcnt(8)
  v_mfma_f32_32x32x16_bf16 v[24:39], v[128:131], v[204:207], v[24:39]
  ds_read_b64_tr_b16 v[120:121], v12 offset:4096
  ds_read_b64_tr_b16 v[122:123], v12 offset:5120
  s_waitcnt vmcnt(12)
  v_min3_u32 v6, v208, v210, v212
  v_min3_u32 v7, v214, v216, v218
  v_min3_u32 v6, v6, v220, v222
  v_min_u32 v6, v6, v7
  v_cmp_eq_u32 vcc, 0, v6
  v_mfma_f32_32x32x16_bf16 v[40:55], v[132:135], v[204:207], v[40:55]
  ds_read_b64_tr_b16 v[124:125], v13 offset:4096
  ds_read_b64_tr_b16 v[126:127], v13 offset:5120
  s_cbranch_vccnz .g2_kernel_w_v11
.g2_kernel_w_vb11:
  s_mov_b64 exec, 1
  ds_add_u32 v20, v5 offset:16
  s_mov_b64 exec, -1
  s_waitcnt lgkmcnt(8)
  v_mfma_f32_32x32x16_bf16 v[24:39], v[104:107], v[208:211], v[24:39]
  v_add_u32 v10, s12, v14
  v_add_u32 v11, s12, v15
  s_andn2_b32 s33, s36, s34
  s_cbranch_scc0 .g2_kernel_w_i15c
.g2_kernel_w_i15b:
  ds_read_b64_tr_b16 v[128:129], v12 offset:6144
  ds_read_b64_tr_b16 v[130:131], v12 offset:7168
  v_mfma_f32_32x32x16_bf16 v[40:55], v[108:111], v[208:211], v[40:55]
  s_ff1_i32_b32 s33, s33
  s_bitset1_b32 s34, s33
  s_xor_b32 s33, s33, s24
  s_and_b32 s15, s33, 7
  ds_read_b64_tr_b16 v[132:133], v13 offset:6144
  ds_read_b64_tr_b16 v[134:135], v13 offset:7168
  s_waitcnt lgkmcnt(8)
  v_mfma_f32_32x32x16_bf16 v[24:39], v[112:115], v[212:215], v[24:39]
  s_cmp_lt_u32 s15, 2
  s_cselect_b32 s28, 139264, 0
  s_lshl_b32 s15, s15, 13
  s_add_u32 s15, s15, s28
  ds_read_b64_tr_b16 v[104:105], v10 offset:0
  ds_read_b64_tr_b16 v[106:107], v10 offset:1024
  v_mfma_f32_32x32x16_bf16 v[40:55], v[116:119], v[212:215], v[40:55]
  s_lshl_b32 s33, s33, 12
  s_add_u32 s22, s20, s33
  s_addc_u32 s23, s21, 0
  global_load_dwordx4 v[56:59], v3, s[22:23] offset:0 sc1
  ds_read_b64_tr_b16 v[108:109], v11 offset:0
  ds_read_b64_tr_b16 v[110:111], v11 offset:1024
  s_waitcnt lgkmcnt(8)
  v_mfma_f32_32x32x16_bf16 v[24:39], v[120:123], v[216:219], v[24:39]
  global_load_dwordx4 v[60:63], v3, s[22:23] offset:1024 sc1
  global_load_dwordx4 v[64:67], v3, s[22:23] offset:2048 sc1
  global_load_dwordx4 v[68:71], v3, s[22:23] offset:3072 sc1
  ds_read_b64_tr_b16 v[112:113], v10 offset:2048
  ds_read_b64_tr_b16 v[114:115], v10 offset:3072
  v_mfma_f32_32x32x16_bf16 v[40:55], v[124:127], v[216:219], v[40:55]
  ds_read_b64_tr_b16 v[116:117], v11 offset:2048
  ds_read_b64_tr_b16 v[118:119], v11 offset:3072
  s_waitcnt lgkmcnt(8)
  v_mfma_f32_32x32x16_bf16 v[24:39], v[128:131], v[220:223], v[24:39]
  ds_read_b64_tr_b16 v[120:121], v10 offset:4096
  ds_read_b64_tr_b16 v[122:123], v10 offset:5120
  s_waitcnt vmcnt(12)
  v_min3_u32 v6, v224, v226, v228
  v_min3_u32 v7, v230, v232, v234
  v_min3_u32 v6, v6, v236, v238
  v_min_u32 v6, v6, v7
  v_cmp_eq_u32 vcc, 0, v6
  v_mfma_f32_32x32x16_bf16 v[40:55], v[132:135], v[220:223], v[40:55]
  ds_read_b64_tr_b16 v[124:125], v11 offset:4096
  ds_read_b64_tr_b16 v[126:127], v11 offset:5120
  s_cbranch_vccnz .g2_kernel_w_v12
.g2_kernel_w_vb12:
  s_waitcnt lgkmcnt(8)
  v_mfma_f32_32x32x16_bf16 v[24:39], v[104:107], v[224:227], v[24:39]
  v_add_u32 v12, s13, v14
  v_add_u32 v13, s13, v15
  ds_read_b64_tr_b16 v[128:129], v10 offset:6144
  ds_read_b64_tr_b16 v[130:131], v10 offset:7168
  v_mfma_f32_32x32x16_bf16 v[40:55], v[108:111], v[224:227], v[40:55]
  ds_read_b64_tr_b16 v[132:133], v11 offset:6144
  ds_read_b64_tr_b16 v[134:135], v11 offset:7168
  s_waitcnt lgkmcnt(8)
  v_mfma_f32_32x32x16_bf16 v[24:39], v[112:115], v[228:231], v[24:39]
  ds_read_b64_tr_b16 v[104:105], v12 offset:0
  ds_read_b64_tr_b16 v[106:107], v12 offset:1024
  v_mfma_f32_32x32x16_bf16 v[40:55], v[116:119], v[228:231], v[40:55]
  ds_read_b64_tr_b16 v[108:109], v13 offset:0
  ds_read_b64_tr_b16 v[110:111], v13 offset:1024
  s_waitcnt lgkmcnt(8)
  v_mfma_f32_32x32x16_bf16 v[24:39], v[120:123], v[232:235], v[24:39]
  ds_read_b64_tr_b16 v[112:113], v12 offset:2048
  ds_read_b64_tr_b16 v[114:115], v12 offset:3072
  v_mfma_f32_32x32x16_bf16 v[40:55], v[124:127], v[232:235], v[40:55]
  ds_read_b64_tr_b16 v[116:117], v13 offset:2048
  ds_read_b64_tr_b16 v[118:119], v13 offset:3072
  s_waitcnt lgkmcnt(8)
  v_mfma_f32_32x32x16_bf16 v[24:39], v[128:131], v[236:239], v[24:39]
  ds_read_b64_tr_b16 v[120:121], v12 offset:4096
  ds_read_b64_tr_b16 v[122:123], v12 offset:5120
  s_waitcnt vmcnt(8)
  v_min3_u32 v6, v136, v138, v140
  v_min3_u32 v7, v142, v144, v146
  v_min3_u32 v6, v6, v148, v150
  v_min_u32 v6, v6, v7
  v_cmp_eq_u32 vcc, 0, v6
  v_mfma_f32_32x32x16_bf16 v[40:55], v[132:135], v[236:239], v[40:55]
  ds_read_b64_tr_b16 v[124:125], v13 offset:4096
  ds_read_b64_tr_b16 v[126:127], v13 offset:5120
  s_cbranch_vccnz .g2_kernel_w_v13
.g2_kernel_w_vb13:
  s_waitcnt lgkmcnt(8)
  v_mfma_f32_32x32x16_bf16 v[24:39], v[104:107], v[136:139], v[24:39]
  v_add_u32 v10, s14, v14
  v_add_u32 v11, s14, v15
  ds_read_b64_tr_b16 v[128:129], v12 offset:6144
  ds_read_b64_tr_b16 v[130:131], v12 offset:7168
  v_mfma_f32_32x32x16_bf16 v[40:55], v[108:111], v[136:139], v[40:55]
  ds_read_b64_tr_b16 v[132:133], v13 offset:6144
  ds_read_b64_tr_b16 v[134:135], v13 offset:7168
  s_waitcnt lgkmcnt(8)
  v_mfma_f32_32x32x16_bf16 v[24:39], v[112:115], v[140:143], v[24:39]
  ds_read_b64_tr_b16 v[104:105], v10 offset:0
  ds_read_b64_tr_b16 v[106:107], v10 offset:1024
  v_mfma_f32_32x32x16_bf16 v[40:55], v[116:119], v[140:143], v[40:55]
  ds_read_b64_tr_b16 v[108:109], v11 offset:0
  ds_read_b64_tr_b16 v[110:111], v11 offset:1024
  s_waitcnt lgkmcnt(8)
  v_mfma_f32_32x32x16_bf16 v[24:39], v[120:123], v[144:147], v[24:39]
  ds_read_b64_tr_b16 v[112:113], v10 offset:2048
  ds_read_b64_tr_b16 v[114:115], v10 offset:3072
  v_mfma_f32_32x32x16_bf16 v[40:55], v[124:127], v[144:147], v[40:55]
  ds_read_b64_tr_b16 v[116:117], v11 offset:2048
  ds_read_b64_tr_b16 v[118:119], v11 offset:3072
  s_waitcnt lgkmcnt(8)
  v_mfma_f32_32x32x16_bf16 v[24:39], v[128:131], v[148:151], v[24:39]
  ds_read_b64_tr_b16 v[120:121], v10 offset:4096
  ds_read_b64_tr_b16 v[122:123], v10 offset:5120
  s_waitcnt vmcnt(4)
  v_min3_u32 v6, v152, v154, v156
  v_min3_u32 v7, v158, v160, v162
  v_min3_u32 v6, v6, v164, v166
  v_min_u32 v6, v6, v7
  v_cmp_eq_u32 vcc, 0, v6
  v_mfma_f32_32x32x16_bf16 v[40:55], v[132:135], v[148:151], v[40:55]
  ds_read_b64_tr_b16 v[124:125], v11 offset:4096
  ds_read_b64_tr_b16 v[126:127], v11 offset:5120
  s_cbranch_vccnz .g2_kernel_w_v14
.g2_kernel_w_vb14:
  s_waitcnt lgkmcnt(8)
  v_mfma_f32_32x32x16_bf16 v[24:39], v[104:107], v[152:155], v[24:39]
  v_add_u32 v12, s15, v14
  v_add_u32 v13, s15, v15
  ds_read_b64_tr_b16 v[128:129], v10 offset:6144
  ds_read_b64_tr_b16 v[130:131], v10 offset:7168
  v_mfma_f32_32x32x16_bf16 v[40:55], v[108:111], v[152:155], v[40:55]
  ds_read_b64_tr_b16 v[132:133], v11 offset:6144
  ds_read_b64_tr_b16 v[134:135], v11 offset:7168
  s_waitcnt lgkmcnt(8)
  v_mfma_f32_32x32x16_bf16 v[24:39], v[112:115], v[156:159], v[24:39]
  ds_read_b64_tr_b16 v[104:105], v12 offset:0
  ds_read_b64_tr_b16 v[106:107], v12 offset:1024
  v_mfma_f32_32x32x16_bf16 v[40:55], v[116:119], v[156:159], v[40:55]
  ds_read_b64_tr_b16 v[108:109], v13 offset:0
  ds_read_b64_tr_b16 v[110:111], v13 offset:1024
  s_waitcnt lgkmcnt(8)
  v_mfma_f32_32x32x16_bf16 v[24:39], v[120:123], v[160:163], v[24:39]
  ds_read_b64_tr_b16 v[112:113], v12 offset:2048
  ds_read_b64_tr_b16 v[114:115], v12 offset:3072
  v_mfma_f32_32x32x16_bf16 v[40:55], v[124:127], v[160:163], v[40:55]
  ds_read_b64_tr_b16 v[116:117], v13 offset:2048
  ds_read_b64_tr_b16 v[118:119], v13 offset:3072
  s_waitcnt lgkmcnt(8)
  v_mfma_f32_32x32x16_bf16 v[24:39], v[128:131], v[164:167], v[24:39]
  ds_read_b64_tr_b16 v[120:121], v12 offset:4096
  ds_read_b64_tr_b16 v[122:123], v12 offset:5120
  s_waitcnt vmcnt(0)
  v_min3_u32 v6, v56, v58, v60
  v_min3_u32 v7, v62, v64, v66
  v_min3_u32 v6, v6, v68, v70
  v_min_u32 v6, v6, v7
  v_cmp_eq_u32 vcc, 0, v6
  v_mfma_f32_32x32x16_bf16 v[40:55], v[132:135], v[164:167], v[40:55]
  ds_read_b64_tr_b16 v[124:125], v13 offset:4096
  ds_read_b64_tr_b16 v[126:127], v13 offset:5120
  s_cbranch_vccnz .g2_kernel_w_v15
.g2_kernel_w_vb15:
  s_waitcnt lgkmcnt(8)
  v_mfma_f32_32x32x16_bf16 v[24:39], v[104:107], v[56:59], v[24:39]
  ds_read_b64_tr_b16 v[128:129], v12 offset:6144
  ds_read_b64_tr_b16 v[130:131], v12 offset:7168
  v_mfma_f32_32x32x16_bf16 v[40:55], v[108:111], v[56:59], v[40:55]
  ds_read_b64_tr_b16 v[132:133], v13 offset:6144
  ds_read_b64_tr_b16 v[134:135], v13 offset:7168
  s_waitcnt lgkmcnt(8)
  v_mfma_f32_32x32x16_bf16 v[24:39], v[112:115], v[60:63], v[24:39]
  v_mfma_f32_32x32x16_bf16 v[40:55], v[116:119], v[60:63], v[40:55]
  s_waitcnt lgkmcnt(4)
  v_mfma_f32_32x32x16_bf16 v[24:39], v[120:123], v[64:67], v[24:39]
  v_mfma_f32_32x32x16_bf16 v[40:55], v[124:127], v[64:67], v[40:55]
  s_waitcnt lgkmcnt(0)
  v_mfma_f32_32x32x16_bf16 v[24:39], v[128:131], v[68:71], v[24:39]
  v_mfma_f32_32x32x16_bf16 v[40:55], v[132:135], v[68:71], v[40:55]
  s_lshl_b32 s28, s17, 4
  s_add_u32 s28, s28, s18
  s_lshl_b32 s28, s28, 2
  s_add_u32 s28, s28, s16
  s_lshl_b32 s28, s28, 12
  s_add_u32 s28, s28, s63
  s_add_u32 s28, s28, 0xc00000
  s_lshl_b32 s29, s16, 12
  v_add_u32 v6, s29, v22
  s_mov_b32 s36, 0x3f803f80
  v_mov_b32 v8, 0
  v_mov_b32 v9, 0
  v_mov_b32 v10, 0
  v_cvt_pk_bf16_f32 v56, v24, v25
  v_cvt_pk_bf16_f32 v57, v26, v27
  v_cvt_pk_bf16_f32 v58, v28, v29
  v_cvt_pk_bf16_f32 v59, v30, v31
  buffer_store_dwordx4 v[56:59], v22, s[4:7], s28 offen offset:0 sc1
  v_cvt_pk_bf16_f32 v60, v32, v33
  v_cvt_pk_bf16_f32 v61, v34, v35
  v_cvt_pk_bf16_f32 v62, v36, v37
  v_cvt_pk_bf16_f32 v63, v38, v39
  buffer_store_dwordx4 v[60:63], v22, s[4:7], s28 offen offset:512 sc1
  v_cvt_pk_bf16_f32 v64, v40, v41
  v_cvt_pk_bf16_f32 v65, v42, v43
  v_cvt_pk_bf16_f32 v66, v44, v45
  v_cvt_pk_bf16_f32 v67, v46, v47
  buffer_store_dwordx4 v[64:67], v22, s[4:7], s28 offen offset:1024 sc1
  v_cvt_pk_bf16_f32 v68, v48, v49
  v_cvt_pk_bf16_f32 v69, v50, v51
  v_cvt_pk_bf16_f32 v70, v52, v53
  v_cvt_pk_bf16_f32 v71, v54, v55
  buffer_store_dwordx4 v[68:71], v22, s[4:7], s28 offen offset:1536 sc1
  ds_write_b128 v6, v[56:59] offset:0
  ds_write_b128 v6, v[60:63] offset:512
  ds_write_b128 v6, v[64:67] offset:1024
  ds_write_b128 v6, v[68:71] offset:1536
  s_mov_b64 exec, 1
  ds_add_u32 v20, v5 offset:20
  s_mov_b64 exec, -1
  s_lshl_b32 s28, s17, 2
  s_add_u32 s28, s28, s16
  s_lshl_b32 s28, s28, 13
  s_lshl_b32 s29, s18, 9
  s_add_u32 s28, s28, s29
  s_add_u32 s28, s28, s63
  s_add_u32 s28, s28, 0x1000000
  v_dot2c_f32_bf16 v8, s36, v56
  v_dot2c_f32_bf16 v9, v56, v56
  v_dot2c_f32_bf16 v10, v56, v240
  v_dot2c_f32_bf16 v8, s36, v57
  v_dot2c_f32_bf16 v9, v57, v57
  v_dot2c_f32_bf16 v10, v57, v241
  v_dot2c_f32_bf16 v8, s36, v58
  v_dot2c_f32_bf16 v9, v58, v58
  v_dot2c_f32_bf16 v10, v58, v242
  v_dot2c_f32_bf16 v8, s36, v59
  v_dot2c_f32_bf16 v9, v59, v59
  v_dot2c_f32_bf16 v10, v59, v243
  v_dot2c_f32_bf16 v8, s36, v60
  v_dot2c_f32_bf16 v9, v60, v60
  v_dot2c_f32_bf16 v10, v60, v244
  v_dot2c_f32_bf16 v8, s36, v61
  v_dot2c_f32_bf16 v9, v61, v61
  v_dot2c_f32_bf16 v10, v61, v245
  v_dot2c_f32_bf16 v8, s36, v62
  v_dot2c_f32_bf16 v9, v62, v62
  v_dot2c_f32_bf16 v10, v62, v246
  v_dot2c_f32_bf16 v8, s36, v63
  v_dot2c_f32_bf16 v9, v63, v63
  v_dot2c_f32_bf16 v10, v63, v247
  v_dot2c_f32_bf16 v8, s36, v64
  v_dot2c_f32_bf16 v9, v64, v64
  v_dot2c_f32_bf16 v10, v64, v248
  v_dot2c_f32_bf16 v8, s36, v65
  v_dot2c_f32_bf16 v9, v65, v65
  v_dot2c_f32_bf16 v10, v65, v249
  v_dot2c_f32_bf16 v8, s36, v66
  v_dot2c_f32_bf16 v9, v66, v66
  v_dot2c_f32_bf16 v10, v66, v250
  v_dot2c_f32_bf16 v8, s36, v67
  v_dot2c_f32_bf16 v9, v67, v67
  v_dot2c_f32_bf16 v10, v67, v251
  v_dot2c_f32_bf16 v8, s36, v68
  v_dot2c_f32_bf16 v9, v68, v68
  v_dot2c_f32_bf16 v10, v68, v252
  v_dot2c_f32_bf16 v8, s36, v69
  v_dot2c_f32_bf16 v9, v69, v69
  v_dot2c_f32_bf16 v10, v69, v253
  v_dot2c_f32_bf16 v8, s36, v70
  v_dot2c_f32_bf16 v9, v70, v70
  v_dot2c_f32_bf16 v10, v70, v254
  v_dot2c_f32_bf16 v8, s36, v71
  v_dot2c_f32_bf16 v9, v71, v71
  v_dot2c_f32_bf16 v10, v71, v255
  s_lshl_b32 s29, s16, 7
  s_add_u32 s37, s19, s29
  v_mov_b32 v24, v8
  v_mov_b32 v25, v9
  v_mov_b32 v26, v10
  v_mov_b32 v11, 1
  v_permlane32_swap_b32 v8, v24
  v_permlane32_swap_b32 v9, v25
  v_permlane32_swap_b32 v10, v26
  v_add_f32 v8, v8, v24
  v_add_f32 v9, v9, v25
  v_add_f32 v10, v10, v26
  v_or_b32 v8, 1, v8
  v_mov_b32 v16, s70
  s_mov_b32 exec_hi, 0
  s_waitcnt vmcnt(0)
  buffer_store_dwordx4 v[8:11], v3, s[4:7], s28 offen sc1
  s_mov_b64 exec, 1
  buffer_store_dword v16, v4, s[4:7], s37 offen offset:8 sc1
  s_mov_b64 exec, -1
  s_cmp_lg_u32 s62, 0
  s_cbranch_scc1 .g2_kernel_tail
  s_mov_b32 s62, 1
  s_mov_b32 s63, 0x1800000
  s_mov_b32 s70, 2
  s_mov_b32 s71, 155776
  s_branch .g2_kernel_q_cons2
.g2_kernel_tail:
  s_mov_b32 s28, s56
  s_mov_b32 s29, s57
  s_mov_b32 s30, 0x400000
  s_mov_b32 s31, 0x00020000
  v_lshrrev_b32 v8, 3, v2
  v_and_b32 v9, 7, v2
  v_lshlrev_b32 v10, 8, v9
  v_lshl_add_u32 v10, v8, 4, v10
  s_lshl_b32 s32, s16, 12
  v_add_u32 v10, s32, v10
  ds_read_b128 v[56:59], v10 offset:0
  ds_read_b128 v[60:63], v10 offset:128
  ds_read_b128 v[64:67], v10 offset:2048
  ds_read_b128 v[68:71], v10 offset:2176
  v_lshlrev_b32 v23, 11, v8
  v_lshl_add_u32 v23, v9, 4, v23
  s_lshl_b32 s32, s16, 5
  v_add_u32 v19, s32, v8
  v_lshlrev_b32 v10, 2, v19
  v_add_u32 v10, 155648, v10
  s_lshl_b32 s32, s17, 2
  s_add_u32 s32, s32, s16
  s_lshl_b32 s32, s32, 16
  s_lshl_b32 s33, s18, 7
  s_add_u32 s32, s32, s33
  s_waitcnt lgkmcnt(0)
  v_lshlrev_b32 v24, 16, v56
  v_and_b32 v25, 0xffff0000, v56
  v_lshlrev_b32 v26, 16, v57
  v_and_b32 v27, 0xffff0000, v57
  v_lshlrev_b32 v28, 16, v58
  v_and_b32 v29, 0xffff0000, v58
  v_lshlrev_b32 v30, 16, v59
  v_and_b32 v31, 0xffff0000, v59
  v_lshlrev_b32 v32, 16, v60
  v_and_b32 v33, 0xffff0000, v60
  v_lshlrev_b32 v34, 16, v61
  v_and_b32 v35, 0xffff0000, v61
  v_lshlrev_b32 v36, 16, v62
  v_and_b32 v37, 0xffff0000, v62
  v_lshlrev_b32 v38, 16, v63
  v_and_b32 v39, 0xffff0000, v63
  v_lshlrev_b32 v40, 16, v64
  v_and_b32 v41, 0xffff0000, v64
  v_lshlrev_b32 v42, 16, v65
  v_and_b32 v43, 0xffff0000, v65
  v_lshlrev_b32 v44, 16, v66
  v_and_b32 v45, 0xffff0000, v66
  v_lshlrev_b32 v46, 16, v67
  v_and_b32 v47, 0xffff0000, v67
  v_lshlrev_b32 v48, 16, v68
  v_and_b32 v49, 0xffff0000, v68
  v_lshlrev_b32 v50, 16, v69
  v_and_b32 v51, 0xffff0000, v69
  v_lshlrev_b32 v52, 16, v70
  v_and_b32 v53, 0xffff0000, v70
  v_lshlrev_b32 v54, 16, v71
  v_and_b32 v55, 0xffff0000, v71
  s_lshl_b32 s33, s16, 2
  s_add_u32 s33, s33, 155920
  v_mov_b32 v17, s33
  v_mov_b32 v6, s71
  s_mov_b32 s38, 0
.g2_kernel_wg7:
  ds_read_b32 v7, v6 offset:28
  s_add_u32 s38, s38, 1
  s_waitcnt lgkmcnt(0)
  v_cmp_gt_u32 vcc, 1, v7
  s_cbranch_vccz .g2_kernel_wg7d
  s_sleep 2
  s_cmp_lt_u32 s38, 524288
  s_cbranch_scc1 .g2_kernel_wg7
.g2_kernel_wg7d:
  ds_read_b32 v17, v20 offset:32
  ds_read_b32 v72, v10 offset:3840
  ds_read_b32 v73, v10 offset:4352
  ds_read_b32 v74, v10 offset:3872
  ds_read_b32 v75, v10 offset:4384
  ds_read_b32 v76, v10 offset:3904
  ds_read_b32 v77, v10 offset:4416
  ds_read_b32 v78, v10 offset:3936
  ds_read_b32 v79, v10 offset:4448
  s_waitcnt lgkmcnt(0)
  v_sub_u32 v16, v17, v19
  v_pk_fma_f32 v[24:25], v[24:25], v[72:73], v[72:73] op_sel:[0,0,1] op_sel_hi:[1,0,1]
  v_pk_fma_f32 v[26:27], v[26:27], v[72:73], v[72:73] op_sel:[0,0,1] op_sel_hi:[1,0,1]
  v_pk_fma_f32 v[28:29], v[28:29], v[72:73], v[72:73] op_sel:[0,0,1] op_sel_hi:[1,0,1]
  v_pk_fma_f32 v[30:31], v[30:31], v[72:73], v[72:73] op_sel:[0,0,1] op_sel_hi:[1,0,1]
  v_cvt_pk_bf16_f32 v56, v24, v25
  v_cvt_pk_bf16_f32 v57, v26, v27
  v_cvt_pk_bf16_f32 v58, v28, v29
  v_cvt_pk_bf16_f32 v59, v30, v31
  v_cmp_ne_u32 vcc, 1, v16
  s_mov_b64 exec, vcc
  buffer_store_dwordx4 v[56:59], v23, s[28:31], s32 offen sc1
  s_mov_b64 exec, -1
  s_add_u32 s32, s32, 16384
  v_pk_fma_f32 v[32:33], v[32:33], v[74:75], v[74:75] op_sel:[0,0,1] op_sel_hi:[1,0,1]
  v_pk_fma_f32 v[34:35], v[34:35], v[74:75], v[74:75] op_sel:[0,0,1] op_sel_hi:[1,0,1]
  v_pk_fma_f32 v[36:37], v[36:37], v[74:75], v[74:75] op_sel:[0,0,1] op_sel_hi:[1,0,1]
  v_pk_fma_f32 v[38:39], v[38:39], v[74:75], v[74:75] op_sel:[0,0,1] op_sel_hi:[1,0,1]
  v_cvt_pk_bf16_f32 v60, v32, v33
  v_cvt_pk_bf16_f32 v61, v34, v35
  v_cvt_pk_bf16_f32 v62, v36, v37
  v_cvt_pk_bf16_f32 v63, v38, v39
  v_cmp_ne_u32 vcc, 9, v16
  s_mov_b64 exec, vcc
  buffer_store_dwordx4 v[60:63], v23, s[28:31], s32 offen sc1
  s_mov_b64 exec, -1
  s_add_u32 s32, s32, 16384
  v_pk_fma_f32 v[40:41], v[40:41], v[76:77], v[76:77] op_sel:[0,0,1] op_sel_hi:[1,0,1]
  v_pk_fma_f32 v[42:43], v[42:43], v[76:77], v[76:77] op_sel:[0,0,1] op_sel_hi:[1,0,1]
  v_pk_fma_f32 v[44:45], v[44:45], v[76:77], v[76:77] op_sel:[0,0,1] op_sel_hi:[1,0,1]
  v_pk_fma_f32 v[46:47], v[46:47], v[76:77], v[76:77] op_sel:[0,0,1] op_sel_hi:[1,0,1]
  v_cvt_pk_bf16_f32 v64, v40, v41
  v_cvt_pk_bf16_f32 v65, v42, v43
  v_cvt_pk_bf16_f32 v66, v44, v45
  v_cvt_pk_bf16_f32 v67, v46, v47
  v_cmp_ne_u32 vcc, 17, v16
  s_mov_b64 exec, vcc
  buffer_store_dwordx4 v[64:67], v23, s[28:31], s32 offen sc1
  s_mov_b64 exec, -1
  s_add_u32 s32, s32, 16384
  v_pk_fma_f32 v[48:49], v[48:49], v[78:79], v[78:79] op_sel:[0,0,1] op_sel_hi:[1,0,1]
  v_pk_fma_f32 v[50:51], v[50:51], v[78:79], v[78:79] op_sel:[0,0,1] op_sel_hi:[1,0,1]
  v_pk_fma_f32 v[52:53], v[52:53], v[78:79], v[78:79] op_sel:[0,0,1] op_sel_hi:[1,0,1]
  v_pk_fma_f32 v[54:55], v[54:55], v[78:79], v[78:79] op_sel:[0,0,1] op_sel_hi:[1,0,1]
  v_cvt_pk_bf16_f32 v68, v48, v49
  v_cvt_pk_bf16_f32 v69, v50, v51
  v_cvt_pk_bf16_f32 v70, v52, v53
  v_cvt_pk_bf16_f32 v71, v54, v55
  v_cmp_ne_u32 vcc, 25, v16
  s_mov_b64 exec, vcc
  buffer_store_dwordx4 v[68:71], v23, s[28:31], s32 offen sc1
  s_mov_b64 exec, -1
  s_add_u32 s32, s32, 16384
  s_branch .g2_kernel_fin
.g2_kernel_svc:
  s_cmp_eq_u32 s16, 5
  s_cbranch_scc1 .g2_kernel_s1
  s_cmp_eq_u32 s16, 6
  s_cbranch_scc1 .g2_kernel_s2
  s_cmp_eq_u32 s16, 7
  s_cbranch_scc1 .g2_kernel_s3
  s_mov_b32 s8, s40
  s_mov_b32 s9, s41
  s_mov_b32 s10, 0x400000
  s_mov_b32 s11, 0x00020000
  s_setprio 3
  v_lshrrev_b32 v20, 3, v2
  v_and_b32 v21, 7, v2
  v_lshrrev_b32 v22, 4, v2
  v_xor_b32 v23, v21, v22
  v_lshlrev_b32 v23, 4, v23
  v_lshl_add_u32 v24, v20, 11, v23
  v_xor_b32 v25, 64, v24
  s_lshl_b32 s32, s17, 18
  v_add_u32 v32, 0, v24
  v_add_u32 v33, 15360, v25
  v_add_u32 v34, 30720, v24
  v_add_u32 v35, 46080, v25
  v_add_u32 v36, 65536, v24
  v_add_u32 v37, 80896, v25
  v_add_u32 v38, 96256, v24
  v_add_u32 v39, 111616, v25
  v_add_u32 v40, 131072, v24
  v_add_u32 v41, 146432, v25
  v_add_u32 v42, 161792, v24
  v_add_u32 v43, 177152, v25
  v_add_u32 v44, 196608, v24
  v_add_u32 v45, 211968, v25
  v_add_u32 v46, 227328, v24
  v_add_u32 v47, 242688, v25
  s_mov_b32 s29, 0
  s_add_u32 m0, s29, 0
  s_waitcnt vmcnt(63)
  buffer_load_dwordx4 v32, s[8:11], s32 offen offset:0 lds
  buffer_load_dwordx4 v33, s[8:11], s32 offen offset:1024 lds
  buffer_load_dwordx4 v34, s[8:11], s32 offen offset:2048 lds
  buffer_load_dwordx4 v35, s[8:11], s32 offen offset:3072 lds
  s_add_u32 m0, s29, 4096
  s_waitcnt vmcnt(63)
  buffer_load_dwordx4 v36, s[8:11], s32 offen offset:0 lds
  buffer_load_dwordx4 v37, s[8:11], s32 offen offset:1024 lds
  buffer_load_dwordx4 v38, s[8:11], s32 offen offset:2048 lds
  buffer_load_dwordx4 v39, s[8:11], s32 offen offset:3072 lds
  s_add_u32 m0, s29, 8192
  s_waitcnt vmcnt(63)
  buffer_load_dwordx4 v40, s[8:11], s32 offen offset:0 lds
  buffer_load_dwordx4 v41, s[8:11], s32 offen offset:1024 lds
  buffer_load_dwordx4 v42, s[8:11], s32 offen offset:2048 lds
  buffer_load_dwordx4 v43, s[8:11], s32 offen offset:3072 lds
  s_add_u32 m0, s29, 12288
  s_waitcnt vmcnt(63)
  buffer_load_dwordx4 v44, s[8:11], s32 offen offset:0 lds
  buffer_load_dwordx4 v45, s[8:11], s32 offen offset:1024 lds
  buffer_load_dwordx4 v46, s[8:11], s32 offen offset:2048 lds
  buffer_load_dwordx4 v47, s[8:11], s32 offen offset:3072 lds
  s_add_u32 s32, s32, 128
  s_mov_b32 s12, s42
  s_mov_b32 s13, s43
  s_mov_b32 s14, 0x600000
  s_mov_b32 s15, 0x00020000
  v_lshrrev_b32 v28, 3, v2
  v_and_b32 v29, 7, v2
  v_bfe_u32 v30, v2, 4, 1
  v_lshlrev_b32 v30, 1, v30
  v_xor_b32 v31, v29, v30
  v_lshlrev_b32 v31, 4, v31
  v_mul_u32_u24 v28, 6144, v28
  v_add_u32 v28, v28, v31
  v_xor_b32 v29, 64, v28
  v_lshlrev_b32 v9, 2, v2
  v_and_b32 v9, 12, v9
  v_add_u32 v9, 156416, v9
  v_add_u32 v48, 0, v28
  v_add_u32 v49, 48128, v29
  v_add_u32 v50, 96256, v28
  v_add_u32 v51, 144384, v29
  v_add_u32 v52, 2048, v28
  v_add_u32 v53, 50176, v29
  v_add_u32 v54, 98304, v28
  v_add_u32 v55, 146432, v29
  v_add_u32 v56, 4096, v29
  v_add_u32 v57, 52224, v28
  v_add_u32 v58, 100352, v29
  v_add_u32 v59, 148480, v28
  s_lshl_b32 s36, s18, 7
  s_mov_b32 s30, 0
  s_add_u32 m0, s30, 65536
  s_waitcnt vmcnt(63)
  buffer_load_dwordx4 v48, s[12:15], s36 offen offset:0 lds
  buffer_load_dwordx4 v49, s[12:15], s36 offen offset:1024 lds
  buffer_load_dwordx4 v50, s[12:15], s36 offen offset:2048 lds
  buffer_load_dwordx4 v51, s[12:15], s36 offen offset:3072 lds
  s_add_u32 m0, s30, 69632
  s_waitcnt vmcnt(63)
  buffer_load_dwordx4 v52, s[12:15], s36 offen offset:0 lds
  buffer_load_dwordx4 v53, s[12:15], s36 offen offset:1024 lds
  buffer_load_dwordx4 v54, s[12:15], s36 offen offset:2048 lds
  buffer_load_dwordx4 v55, s[12:15], s36 offen offset:3072 lds
  s_add_u32 m0, s30, 73728
  s_waitcnt vmcnt(63)
  buffer_load_dwordx4 v56, s[12:15], s36 offen offset:0 lds
  buffer_load_dwordx4 v57, s[12:15], s36 offen offset:1024 lds
  buffer_load_dwordx4 v58, s[12:15], s36 offen offset:2048 lds
  buffer_load_dwordx4 v59, s[12:15], s36 offen offset:3072 lds
  s_add_u32 s30, s30, 12288
  s_cmp_eq_u32 s30, 86016
  s_cselect_b32 s30, 0, s30
  s_barrier
  s_mov_b32 s35, .g2_kernel_tab-.g2_kernel_pc+4
  s_mov_b32 s34, -5
  v_mov_b32 v10, 0
  s_mov_b32 m0, 156160
  s_add_u32 s36, s36, 196608
  s_mov_b64 exec, 1
  buffer_load_dword off, s[64:67], s35 lds
  s_mov_b64 exec, -1
  s_add_u32 s35, s35, 4
  s_branch .g2_kernel_p1_o
  .p2align 6
.g2_kernel_p1_l:
  s_waitcnt lgkmcnt(0)
  v_cmp_gt_i32 vcc, s34, v10
  s_cbranch_vccnz .g2_kernel_p1_aw
.g2_kernel_p1_ai:
  s_add_u32 s29, s29, 16384
  s_and_b32 s29, s29, 0xffff
  s_add_u32 m0, s29, 0
  s_waitcnt vmcnt(63)
  buffer_load_dwordx4 v32, s[8:11], s32 offen offset:0 lds
  buffer_load_dwordx4 v33, s[8:11], s32 offen offset:1024 lds
  buffer_load_dwordx4 v34, s[8:11], s32 offen offset:2048 lds
  buffer_load_dwordx4 v35, s[8:11], s32 offen offset:3072 lds
  s_add_u32 m0, s29, 4096
  s_waitcnt vmcnt(63)
  buffer_load_dwordx4 v36, s[8:11], s32 offen offset:0 lds
  buffer_load_dwordx4 v37, s[8:11], s32 offen offset:1024 lds
  buffer_load_dwordx4 v38, s[8:11], s32 offen offset:2048 lds
  buffer_load_dwordx4 v39, s[8:11], s32 offen offset:3072 lds
  s_add_u32 m0, s29, 8192
  s_waitcnt vmcnt(63)
  buffer_load_dwordx4 v40, s[8:11], s32 offen offset:0 lds
  buffer_load_dwordx4 v41, s[8:11], s32 offen offset:1024 lds
  buffer_load_dwordx4 v42, s[8:11], s32 offen offset:2048 lds
  buffer_load_dwordx4 v43, s[8:11], s32 offen offset:3072 lds
  s_add_u32 m0, s29, 12288
  s_waitcnt vmcnt(63)
  buffer_load_dwordx4 v44, s[8:11], s32 offen offset:0 lds
  buffer_load_dwordx4 v45, s[8:11], s32 offen offset:1024 lds
  buffer_load_dwordx4 v46, s[8:11], s32 offen offset:2048 lds
  buffer_load_dwordx4 v47, s[8:11], s32 offen offset:3072 lds
  s_add_u32 s32, s32, 128
  s_add_u32 m0, s30, 65536
  s_waitcnt vmcnt(63)
  buffer_load_dwordx4 v48, s[12:15], s36 offen offset:0 lds
  buffer_load_dwordx4 v49, s[12:15], s36 offen offset:1024 lds
  buffer_load_dwordx4 v50, s[12:15], s36 offen offset:2048 lds
  buffer_load_dwordx4 v51, s[12:15], s36 offen offset:3072 lds
  s_add_u32 m0, s30, 69632
  s_waitcnt vmcnt(63)
  buffer_load_dwordx4 v52, s[12:15], s36 offen offset:0 lds
  buffer_load_dwordx4 v53, s[12:15], s36 offen offset:1024 lds
  buffer_load_dwordx4 v54, s[12:15], s36 offen offset:2048 lds
  buffer_load_dwordx4 v55, s[12:15], s36 offen offset:3072 lds
  s_add_u32 m0, s30, 73728
  s_waitcnt vmcnt(63)
  buffer_load_dwordx4 v56, s[12:15], s36 offen offset:0 lds
  buffer_load_dwordx4 v57, s[12:15], s36 offen offset:1024 lds
  buffer_load_dwordx4 v58, s[12:15], s36 offen offset:2048 lds
  buffer_load_dwordx4 v59, s[12:15], s36 offen offset:3072 lds
  s_add_u32 s30, s30, 12288
  s_cmp_eq_u32 s30, 86016
  s_cselect_b32 s30, 0, s30
  ds_read_b32 v10, v9
  s_mov_b32 m0, 156160
  s_add_u32 s34, s34, 1
  s_mov_b64 exec, 1
  buffer_load_dword off, s[64:67], s35 lds
  s_mov_b64 exec, -1
  s_add_u32 s35, s35, 4
  s_add_u32 s36, s36, 196608
.g2_kernel_p1_o:
  s_waitcnt lgkmcnt(0)
  v_cmp_gt_i32 vcc, s34, v10
  s_cbranch_vccnz .g2_kernel_p1_bw
.g2_kernel_p1_bi:
  s_add_u32 m0, s30, 65536
  s_waitcnt vmcnt(63)
  buffer_load_dwordx4 v48, s[12:15], s36 offen offset:0 lds
  buffer_load_dwordx4 v49, s[12:15], s36 offen offset:1024 lds
  buffer_load_dwordx4 v50, s[12:15], s36 offen offset:2048 lds
  buffer_load_dwordx4 v51, s[12:15], s36 offen offset:3072 lds
  s_add_u32 m0, s30, 69632
  s_waitcnt vmcnt(63)
  buffer_load_dwordx4 v52, s[12:15], s36 offen offset:0 lds
  buffer_load_dwordx4 v53, s[12:15], s36 offen offset:1024 lds
  buffer_load_dwordx4 v54, s[12:15], s36 offen offset:2048 lds
  buffer_load_dwordx4 v55, s[12:15], s36 offen offset:3072 lds
  s_add_u32 m0, s30, 73728
  s_waitcnt vmcnt(63)
  buffer_load_dwordx4 v56, s[12:15], s36 offen offset:0 lds
  buffer_load_dwordx4 v57, s[12:15], s36 offen offset:1024 lds
  buffer_load_dwordx4 v58, s[12:15], s36 offen offset:2048 lds
  buffer_load_dwordx4 v59, s[12:15], s36 offen offset:3072 lds
  s_add_u32 s30, s30, 12288
  s_cmp_eq_u32 s30, 86016
  s_cselect_b32 s30, 0, s30
  ds_read_b32 v10, v9
  s_mov_b32 m0, 156160
  s_add_u32 s34, s34, 1
  s_mov_b64 exec, 1
  buffer_load_dword off, s[64:67], s35 lds
  s_mov_b64 exec, -1
  s_add_u32 s35, s35, 4
  s_add_u32 s36, s36, 196608
  s_cmp_lt_i32 s34, 26
  s_cbranch_scc1 .g2_kernel_p1_l
  s_branch .g2_kernel_v
.g2_kernel_s1:
  s_mov_b32 s8, s40
  s_mov_b32 s9, s41
  s_mov_b32 s10, 0x400000
  s_mov_b32 s11, 0x00020000
  v_lshrrev_b32 v20, 3, v2
  v_and_b32 v21, 7, v2
  v_lshlrev_b32 v21, 4, v21
  v_lshl_add_u32 v21, v20, 11, v21
  s_lshl_b32 s30, s17, 4
  s_add_u32 s30, s30, s18
  s_lshl_b32 s33, s30, 5
  s_lshl_b32 s30, s30, 14
  s_barrier
  s_sleep 30
  buffer_load_dwordx4 v[64:67], v21, s[8:11], s30 offen offset:0
  buffer_load_dwordx4 v[68:71], v21, s[8:11], s30 offen offset:128
  buffer_load_dwordx4 v[72:75], v21, s[8:11], s30 offen offset:256
  buffer_load_dwordx4 v[76:79], v21, s[8:11], s30 offen offset:384
  buffer_load_dwordx4 v[80:83], v21, s[8:11], s30 offen offset:512
  buffer_load_dwordx4 v[84:87], v21, s[8:11], s30 offen offset:640
  buffer_load_dwordx4 v[88:91], v21, s[8:11], s30 offen offset:768
  buffer_load_dwordx4 v[92:95], v21, s[8:11], s30 offen offset:896
  buffer_load_dwordx4 v[96:99], v21, s[8:11], s30 offen offset:1024
  buffer_load_dwordx4 v[100:103], v21, s[8:11], s30 offen offset:1152
  buffer_load_dwordx4 v[104:107], v21, s[8:11], s30 offen offset:1280
  buffer_load_dwordx4 v[108:111], v21, s[8:11], s30 offen offset:1408
  buffer_load_dwordx4 v[112:115], v21, s[8:11], s30 offen offset:1536
  buffer_load_dwordx4 v[116:119], v21, s[8:11], s30 offen offset:1664
  buffer_load_dwordx4 v[120:123], v21, s[8:11], s30 offen offset:1792
  buffer_load_dwordx4 v[124:127], v21, s[8:11], s30 offen offset:1920
  v_mov_b32 v24, 0
  v_mov_b32 v25, 0
  v_mov_b32 v26, 0
  v_mov_b32 v27, 0
  s_waitcnt vmcnt(15)
  v_lshlrev_b32 v22, 16, v64
  v_and_b32 v64, 0xffff0000, v64
  v_add_f32 v24, v24, v22
  v_fmac_f32 v25, v22, v22
  v_add_f32 v26, v26, v64
  v_fmac_f32 v27, v64, v64
  v_lshlrev_b32 v22, 16, v65
  v_and_b32 v65, 0xffff0000, v65
  v_add_f32 v24, v24, v22
  v_fmac_f32 v25, v22, v22
  v_add_f32 v26, v26, v65
  v_fmac_f32 v27, v65, v65
  v_lshlrev_b32 v22, 16, v66
  v_and_b32 v66, 0xffff0000, v66
  v_add_f32 v24, v24, v22
  v_fmac_f32 v25, v22, v22
  v_add_f32 v26, v26, v66
  v_fmac_f32 v27, v66, v66
  v_lshlrev_b32 v22, 16, v67
  v_and_b32 v67, 0xffff0000, v67
  v_add_f32 v24, v24, v22
  v_fmac_f32 v25, v22, v22
  v_add_f32 v26, v26, v67
  v_fmac_f32 v27, v67, v67
  s_waitcnt vmcnt(14)
  v_lshlrev_b32 v22, 16, v68
  v_and_b32 v68, 0xffff0000, v68
  v_add_f32 v24, v24, v22
  v_fmac_f32 v25, v22, v22
  v_add_f32 v26, v26, v68
  v_fmac_f32 v27, v68, v68
  v_lshlrev_b32 v22, 16, v69
  v_and_b32 v69, 0xffff0000, v69
  v_add_f32 v24, v24, v22
  v_fmac_f32 v25, v22, v22
  v_add_f32 v26, v26, v69
  v_fmac_f32 v27, v69, v69
  v_lshlrev_b32 v22, 16, v70
  v_and_b32 v70, 0xffff0000, v70
  v_add_f32 v24, v24, v22
  v_fmac_f32 v25, v22, v22
  v_add_f32 v26, v26, v70
  v_fmac_f32 v27, v70, v70
  v_lshlrev_b32 v22, 16, v71
  v_and_b32 v71, 0xffff0000, v71
  v_add_f32 v24, v24, v22
  v_fmac_f32 v25, v22, v22
  v_add_f32 v26, v26, v71
  v_fmac_f32 v27, v71, v71
  s_waitcnt vmcnt(13)
  v_lshlrev_b32 v22, 16, v72
  v_and_b32 v72, 0xffff0000, v72
  v_add_f32 v24, v24, v22
  v_fmac_f32 v25, v22, v22
  v_add_f32 v26, v26, v72
  v_fmac_f32 v27, v72, v72
  v_lshlrev_b32 v22, 16, v73
  v_and_b32 v73, 0xffff0000, v73
  v_add_f32 v24, v24, v22
  v_fmac_f32 v25, v22, v22
  v_add_f32 v26, v26, v73
  v_fmac_f32 v27, v73, v73
  v_lshlrev_b32 v22, 16, v74
  v_and_b32 v74, 0xffff0000, v74
  v_add_f32 v24, v24, v22
  v_fmac_f32 v25, v22, v22
  v_add_f32 v26, v26, v74
  v_fmac_f32 v27, v74, v74
  v_lshlrev_b32 v22, 16, v75
  v_and_b32 v75, 0xffff0000, v75
  v_add_f32 v24, v24, v22
  v_fmac_f32 v25, v22, v22
  v_add_f32 v26, v26, v75
  v_fmac_f32 v27, v75, v75
  s_waitcnt vmcnt(12)
  v_lshlrev_b32 v22, 16, v76
  v_and_b32 v76, 0xffff0000, v76
  v_add_f32 v24, v24, v22
  v_fmac_f32 v25, v22, v22
  v_add_f32 v26, v26, v76
  v_fmac_f32 v27, v76, v76
  v_lshlrev_b32 v22, 16, v77
  v_and_b32 v77, 0xffff0000, v77
  v_add_f32 v24, v24, v22
  v_fmac_f32 v25, v22, v22
  v_add_f32 v26, v26, v77
  v_fmac_f32 v27, v77, v77
  v_lshlrev_b32 v22, 16, v78
  v_and_b32 v78, 0xffff0000, v78
  v_add_f32 v24, v24, v22
  v_fmac_f32 v25, v22, v22
  v_add_f32 v26, v26, v78
  v_fmac_f32 v27, v78, v78
  v_lshlrev_b32 v22, 16, v79
  v_and_b32 v79, 0xffff0000, v79
  v_add_f32 v24, v24, v22
  v_fmac_f32 v25, v22, v22
  v_add_f32 v26, v26, v79
  v_fmac_f32 v27, v79, v79
  s_waitcnt vmcnt(11)
  v_lshlrev_b32 v22, 16, v80
  v_and_b32 v80, 0xffff0000, v80
  v_add_f32 v24, v24, v22
  v_fmac_f32 v25, v22, v22
  v_add_f32 v26, v26, v80
  v_fmac_f32 v27, v80, v80
  v_lshlrev_b32 v22, 16, v81
  v_and_b32 v81, 0xffff0000, v81
  v_add_f32 v24, v24, v22
  v_fmac_f32 v25, v22, v22
  v_add_f32 v26, v26, v81
  v_fmac_f32 v27, v81, v81
  v_lshlrev_b32 v22, 16, v82
  v_and_b32 v82, 0xffff0000, v82
  v_add_f32 v24, v24, v22
  v_fmac_f32 v25, v22, v22
  v_add_f32 v26, v26, v82
  v_fmac_f32 v27, v82, v82
  v_lshlrev_b32 v22, 16, v83
  v_and_b32 v83, 0xffff0000, v83
  v_add_f32 v24, v24, v22
  v_fmac_f32 v25, v22, v22
  v_add_f32 v26, v26, v83
  v_fmac_f32 v27, v83, v83
  s_waitcnt vmcnt(10)
  v_lshlrev_b32 v22, 16, v84
  v_and_b32 v84, 0xffff0000, v84
  v_add_f32 v24, v24, v22
  v_fmac_f32 v25, v22, v22
  v_add_f32 v26, v26, v84
  v_fmac_f32 v27, v84, v84
  v_lshlrev_b32 v22, 16, v85
  v_and_b32 v85, 0xffff0000, v85
  v_add_f32 v24, v24, v22
  v_fmac_f32 v25, v22, v22
  v_add_f32 v26, v26, v85
  v_fmac_f32 v27, v85, v85
  v_lshlrev_b32 v22, 16, v86
  v_and_b32 v86, 0xffff0000, v86
  v_add_f32 v24, v24, v22
  v_fmac_f32 v25, v22, v22
  v_add_f32 v26, v26, v86
  v_fmac_f32 v27, v86, v86
  v_lshlrev_b32 v22, 16, v87
  v_and_b32 v87, 0xffff0000, v87
  v_add_f32 v24, v24, v22
  v_fmac_f32 v25, v22, v22
  v_add_f32 v26, v26, v87
  v_fmac_f32 v27, v87, v87
  s_waitcnt vmcnt(9)
  v_lshlrev_b32 v22, 16, v88
  v_and_b32 v88, 0xffff0000, v88
  v_add_f32 v24, v24, v22
  v_fmac_f32 v25, v22, v22
  v_add_f32 v26, v26, v88
  v_fmac_f32 v27, v88, v88
  v_lshlrev_b32 v22, 16, v89
  v_and_b32 v89, 0xffff0000, v89
  v_add_f32 v24, v24, v22
  v_fmac_f32 v25, v22, v22
  v_add_f32 v26, v26, v89
  v_fmac_f32 v27, v89, v89
  v_lshlrev_b32 v22, 16, v90
  v_and_b32 v90, 0xffff0000, v90
  v_add_f32 v24, v24, v22
  v_fmac_f32 v25, v22, v22
  v_add_f32 v26, v26, v90
  v_fmac_f32 v27, v90, v90
  v_lshlrev_b32 v22, 16, v91
  v_and_b32 v91, 0xffff0000, v91
  v_add_f32 v24, v24, v22
  v_fmac_f32 v25, v22, v22
  v_add_f32 v26, v26, v91
  v_fmac_f32 v27, v91, v91
  s_waitcnt vmcnt(8)
  v_lshlrev_b32 v22, 16, v92
  v_and_b32 v92, 0xffff0000, v92
  v_add_f32 v24, v24, v22
  v_fmac_f32 v25, v22, v22
  v_add_f32 v26, v26, v92
  v_fmac_f32 v27, v92, v92
  v_lshlrev_b32 v22, 16, v93
  v_and_b32 v93, 0xffff0000, v93
  v_add_f32 v24, v24, v22
  v_fmac_f32 v25, v22, v22
  v_add_f32 v26, v26, v93
  v_fmac_f32 v27, v93, v93
  v_lshlrev_b32 v22, 16, v94
  v_and_b32 v94, 0xffff0000, v94
  v_add_f32 v24, v24, v22
  v_fmac_f32 v25, v22, v22
  v_add_f32 v26, v26, v94
  v_fmac_f32 v27, v94, v94
  v_lshlrev_b32 v22, 16, v95
  v_and_b32 v95, 0xffff0000, v95
  v_add_f32 v24, v24, v22
  v_fmac_f32 v25, v22, v22
  v_add_f32 v26, v26, v95
  v_fmac_f32 v27, v95, v95
  s_waitcnt vmcnt(7)
  v_lshlrev_b32 v22, 16, v96
  v_and_b32 v96, 0xffff0000, v96
  v_add_f32 v24, v24, v22
  v_fmac_f32 v25, v22, v22
  v_add_f32 v26, v26, v96
  v_fmac_f32 v27, v96, v96
  v_lshlrev_b32 v22, 16, v97
  v_and_b32 v97, 0xffff0000, v97
  v_add_f32 v24, v24, v22
  v_fmac_f32 v25, v22, v22
  v_add_f32 v26, v26, v97
  v_fmac_f32 v27, v97, v97
  v_lshlrev_b32 v22, 16, v98
  v_and_b32 v98, 0xffff0000, v98
  v_add_f32 v24, v24, v22
  v_fmac_f32 v25, v22, v22
  v_add_f32 v26, v26, v98
  v_fmac_f32 v27, v98, v98
  v_lshlrev_b32 v22, 16, v99
  v_and_b32 v99, 0xffff0000, v99
  v_add_f32 v24, v24, v22
  v_fmac_f32 v25, v22, v22
  v_add_f32 v26, v26, v99
  v_fmac_f32 v27, v99, v99
  s_waitcnt vmcnt(6)
  v_lshlrev_b32 v22, 16, v100
  v_and_b32 v100, 0xffff0000, v100
  v_add_f32 v24, v24, v22
  v_fmac_f32 v25, v22, v22
  v_add_f32 v26, v26, v100
  v_fmac_f32 v27, v100, v100
  v_lshlrev_b32 v22, 16, v101
  v_and_b32 v101, 0xffff0000, v101
  v_add_f32 v24, v24, v22
  v_fmac_f32 v25, v22, v22
  v_add_f32 v26, v26, v101
  v_fmac_f32 v27, v101, v101
  v_lshlrev_b32 v22, 16, v102
  v_and_b32 v102, 0xffff0000, v102
  v_add_f32 v24, v24, v22
  v_fmac_f32 v25, v22, v22
  v_add_f32 v26, v26, v102
  v_fmac_f32 v27, v102, v102
  v_lshlrev_b32 v22, 16, v103
  v_and_b32 v103, 0xffff0000, v103
  v_add_f32 v24, v24, v22
  v_fmac_f32 v25, v22, v22
  v_add_f32 v26, v26, v103
  v_fmac_f32 v27, v103, v103
  s_waitcnt vmcnt(5)
  v_lshlrev_b32 v22, 16, v104
  v_and_b32 v104, 0xffff0000, v104
  v_add_f32 v24, v24, v22
  v_fmac_f32 v25, v22, v22
  v_add_f32 v26, v26, v104
  v_fmac_f32 v27, v104, v104
  v_lshlrev_b32 v22, 16, v105
  v_and_b32 v105, 0xffff0000, v105
  v_add_f32 v24, v24, v22
  v_fmac_f32 v25, v22, v22
  v_add_f32 v26, v26, v105
  v_fmac_f32 v27, v105, v105
  v_lshlrev_b32 v22, 16, v106
  v_and_b32 v106, 0xffff0000, v106
  v_add_f32 v24, v24, v22
  v_fmac_f32 v25, v22, v22
  v_add_f32 v26, v26, v106
  v_fmac_f32 v27, v106, v106
  v_lshlrev_b32 v22, 16, v107
  v_and_b32 v107, 0xffff0000, v107
  v_add_f32 v24, v24, v22
  v_fmac_f32 v25, v22, v22
  v_add_f32 v26, v26, v107
  v_fmac_f32 v27, v107, v107
  s_waitcnt vmcnt(4)
  v_lshlrev_b32 v22, 16, v108
  v_and_b32 v108, 0xffff0000, v108
  v_add_f32 v24, v24, v22
  v_fmac_f32 v25, v22, v22
  v_add_f32 v26, v26, v108
  v_fmac_f32 v27, v108, v108
  v_lshlrev_b32 v22, 16, v109
  v_and_b32 v109, 0xffff0000, v109
  v_add_f32 v24, v24, v22
  v_fmac_f32 v25, v22, v22
  v_add_f32 v26, v26, v109
  v_fmac_f32 v27, v109, v109
  v_lshlrev_b32 v22, 16, v110
  v_and_b32 v110, 0xffff0000, v110
  v_add_f32 v24, v24, v22
  v_fmac_f32 v25, v22, v22
  v_add_f32 v26, v26, v110
  v_fmac_f32 v27, v110, v110
  v_lshlrev_b32 v22, 16, v111
  v_and_b32 v111, 0xffff0000, v111
  v_add_f32 v24, v24, v22
  v_fmac_f32 v25, v22, v22
  v_add_f32 v26, v26, v111
  v_fmac_f32 v27, v111, v111
  s_waitcnt vmcnt(3)
  v_lshlrev_b32 v22, 16, v112
  v_and_b32 v112, 0xffff0000, v112
  v_add_f32 v24, v24, v22
  v_fmac_f32 v25, v22, v22
  v_add_f32 v26, v26, v112
  v_fmac_f32 v27, v112, v112
  v_lshlrev_b32 v22, 16, v113
  v_and_b32 v113, 0xffff0000, v113
  v_add_f32 v24, v24, v22
  v_fmac_f32 v25, v22, v22
  v_add_f32 v26, v26, v113
  v_fmac_f32 v27, v113, v113
  v_lshlrev_b32 v22, 16, v114
  v_and_b32 v114, 0xffff0000, v114
  v_add_f32 v24, v24, v22
  v_fmac_f32 v25, v22, v22
  v_add_f32 v26, v26, v114
  v_fmac_f32 v27, v114, v114
  v_lshlrev_b32 v22, 16, v115
  v_and_b32 v115, 0xffff0000, v115
  v_add_f32 v24, v24, v22
  v_fmac_f32 v25, v22, v22
  v_add_f32 v26, v26, v115
  v_fmac_f32 v27, v115, v115
  s_waitcnt vmcnt(2)
  v_lshlrev_b32 v22, 16, v116
  v_and_b32 v116, 0xffff0000, v116
  v_add_f32 v24, v24, v22
  v_fmac_f32 v25, v22, v22
  v_add_f32 v26, v26, v116
  v_fmac_f32 v27, v116, v116
  v_lshlrev_b32 v22, 16, v117
  v_and_b32 v117, 0xffff0000, v117
  v_add_f32 v24, v24, v22
  v_fmac_f32 v25, v22, v22
  v_add_f32 v26, v26, v117
  v_fmac_f32 v27, v117, v117
  v_lshlrev_b32 v22, 16, v118
  v_and_b32 v118, 0xffff0000, v118
  v_add_f32 v24, v24, v22
  v_fmac_f32 v25, v22, v22
  v_add_f32 v26, v26, v118
  v_fmac_f32 v27, v118, v118
  v_lshlrev_b32 v22, 16, v119
  v_and_b32 v119, 0xffff0000, v119
  v_add_f32 v24, v24, v22
  v_fmac_f32 v25, v22, v22
  v_add_f32 v26, v26, v119
  v_fmac_f32 v27, v119, v119
  s_waitcnt vmcnt(1)
  v_lshlrev_b32 v22, 16, v120
  v_and_b32 v120, 0xffff0000, v120
  v_add_f32 v24, v24, v22
  v_fmac_f32 v25, v22, v22
  v_add_f32 v26, v26, v120
  v_fmac_f32 v27, v120, v120
  v_lshlrev_b32 v22, 16, v121
  v_and_b32 v121, 0xffff0000, v121
  v_add_f32 v24, v24, v22
  v_fmac_f32 v25, v22, v22
  v_add_f32 v26, v26, v121
  v_fmac_f32 v27, v121, v121
  v_lshlrev_b32 v22, 16, v122
  v_and_b32 v122, 0xffff0000, v122
  v_add_f32 v24, v24, v22
  v_fmac_f32 v25, v22, v22
  v_add_f32 v26, v26, v122
  v_fmac_f32 v27, v122, v122
  v_lshlrev_b32 v22, 16, v123
  v_and_b32 v123, 0xffff0000, v123
  v_add_f32 v24, v24, v22
  v_fmac_f32 v25, v22, v22
  v_add_f32 v26, v26, v123
  v_fmac_f32 v27, v123, v123
  s_waitcnt vmcnt(0)
  v_lshlrev_b32 v22, 16, v124
  v_and_b32 v124, 0xffff0000, v124
  v_add_f32 v24, v24, v22
  v_fmac_f32 v25, v22, v22
  v_add_f32 v26, v26, v124
  v_fmac_f32 v27, v124, v124
  v_lshlrev_b32 v22, 16, v125
  v_and_b32 v125, 0xffff0000, v125
  v_add_f32 v24, v24, v22
  v_fmac_f32 v25, v22, v22
  v_add_f32 v26, v26, v125
  v_fmac_f32 v27, v125, v125
  v_lshlrev_b32 v22, 16, v126
  v_and_b32 v126, 0xffff0000, v126
  v_add_f32 v24, v24, v22
  v_fmac_f32 v25, v22, v22
  v_add_f32 v26, v26, v126
  v_fmac_f32 v27, v126, v126
  v_lshlrev_b32 v22, 16, v127
  v_and_b32 v127, 0xffff0000, v127
  v_add_f32 v24, v24, v22
  v_fmac_f32 v25, v22, v22
  v_add_f32 v26, v26, v127
  v_fmac_f32 v27, v127, v127
  v_add_f32 v24, v24, v26
  v_add_f32 v25, v25, v27
  s_nop 0
  v_add_f32 v24, v24, v24 quad_perm:[1,0,3,2] row_mask:0xf bank_mask:0xf
  v_add_f32 v25, v25, v25 quad_perm:[1,0,3,2] row_mask:0xf bank_mask:0xf
  s_nop 0
  v_add_f32 v24, v24, v24 quad_perm:[2,3,0,1] row_mask:0xf bank_mask:0xf
  v_add_f32 v25, v25, v25 quad_perm:[2,3,0,1] row_mask:0xf bank_mask:0xf
  s_nop 0
  v_add_f32 v24, v24, v24 row_half_mirror row_mask:0xf bank_mask:0xf
  v_add_f32 v25, v25, v25 row_half_mirror row_mask:0xf bank_mask:0xf
  v_mov_b32 v26, 0.0009765625
  v_mul_f32 v24, v26, v24
  v_mul_f32 v27, v24, v24
  v_fma_f32 v25, v25, v26, -v27
  v_max_f32 v25, 0, v25
  v_add_f32 v25, 1e-05, v25
  v_rsq_f32 v25, v25
  v_lshlrev_b32 v20, 2, v20
  v_mul_f32 v24, v24, v25
  v_sub_f32 v24, 0, v24
  s_add_u32 s33, s33, 0x3070000
  s_add_u32 s34, s33, 0x2000
  s_mov_b32 exec_lo, 0x01010101
  s_mov_b32 exec_hi, 0x01010101
  buffer_store_dword v25, v20, s[4:7], s33 offen sc1
  buffer_store_dword v24, v20, s[4:7], s34 offen sc1
  s_mov_b64 exec, -1
  s_mov_b32 s12, s58
  s_mov_b32 s13, s59
  s_mov_b32 s14, 0x100
  s_mov_b32 s15, 0x00020000
  s_mov_b32 s38, 0
  s_mov_b64 exec, 1
.g2_kernel_gt8:
  buffer_load_dword v6, v4, s[12:15], 0 offen sc1
  s_add_u32 s38, s38, 1
  s_waitcnt vmcnt(0)
  v_cmp_eq_u32 vcc, 0x60, v6
  s_cbranch_vccnz .g2_kernel_gt8d
  s_sleep 8
  s_cmp_lt_u32 s38, 131072
  s_cbranch_scc1 .g2_kernel_gt8
.g2_kernel_gt8d:
  s_mov_b64 exec, -1
  v_mov_b32 v6, s70
  s_mov_b64 exec, 1
  buffer_store_dword v6, v4, s[4:7], s19 offen offset:12 sc1
  s_mov_b64 exec, -1
  v_mov_b32 v6, 155648
  s_mov_b32 s38, 0
.g2_kernel_wg9:
  ds_read_b32 v7, v6 offset:512
  s_add_u32 s38, s38, 1
  s_waitcnt lgkmcnt(0)
  v_cmp_gt_u32 vcc, 22, v7
  s_cbranch_vccz .g2_kernel_wg9d
  s_sleep 4
  s_cmp_lt_u32 s38, 524288
  s_cbranch_scc1 .g2_kernel_wg9
.g2_kernel_wg9d:
  s_and_b32 s31, s19, 0xffffe000
  s_add_u32 s31, s31, 12
  v_and_b32 v6, 15, v2
  v_lshlrev_b32 v6, 9, v6
  v_lshrrev_b32 v7, 4, v2
  v_lshl_add_u32 v6, v7, 7, v6
  v_lshlrev_b32 v7, 2, v2
  v_add_u32 v7, 157952, v7
  s_mov_b32 m0, 157952
  s_mov_b32 s38, 0
  s_bfm_b64 exec, 16, 0
.g2_kernel_pa10:
  buffer_load_dword v6, s[4:7], s31 offen sc1 lds
  s_add_u32 s38, s38, 1
  s_waitcnt vmcnt(0)
  ds_read_b32 v8, v7
  s_waitcnt lgkmcnt(0)
  v_cmp_ge_u32 vcc, s62, v8
  s_cbranch_vccz .g2_kernel_pa10d
  s_mov_b64 exec, vcc
  s_sleep 16
  s_cmp_lt_u32 s38, 131072
  s_cbranch_scc1 .g2_kernel_pa10
.g2_kernel_pa10d:
  s_mov_b64 exec, -1
  s_lshl_b32 s33, s17, 9
  s_add_u32 s33, s33, 0x3070000
  s_add_u32 s34, s33, 0x2000
  s_mov_b32 exec_hi, 0
  s_mov_b32 m0, 158464
  s_nop 0
  buffer_load_dwordx4 v3, s[4:7], s33 offen sc1 lds
  s_mov_b32 m0, 158976
  s_nop 0
  buffer_load_dwordx4 v3, s[4:7], s34 offen sc1 lds
  s_mov_b64 exec, -1
  v_mov_b32 v20, 1.0
  v_mov_b32 v21, 1.0
  v_mov_b32 v22, 0
  v_mov_b32 v23, 0
  v_lshlrev_b32 v24, 3, v2
  v_add_u32 v24, 155648, v24
  v_mov_b32 v6, 155648
  s_mov_b32 s38, 0
.g2_kernel_wg11:
  ds_read_b32 v7, v6 offset:512
  s_add_u32 s38, s38, 1
  s_waitcnt lgkmcnt(0)
  v_cmp_gt_u32 vcc, 32, v7
  s_cbranch_vccz .g2_kernel_wg11d
  s_sleep 2
  s_cmp_lt_u32 s38, 524288
  s_cbranch_scc1 .g2_kernel_wg11
.g2_kernel_wg11d:
  ds_write_b64 v24, v[20:21] offset:3840
  ds_write_b64 v24, v[22:23] offset:4352
  v_lshlrev_b32 v24, 2, v2
  v_add_u32 v24, 155648, v24
  ds_write_b32 v24, v4 offset:2304
  s_waitcnt vmcnt(0)
  v_mov_b32 v6, s71
  s_mov_b64 exec, 1
  ds_add_u32 v6, v5 offset:0
  s_mov_b64 exec, -1
  s_branch .g2_kernel_v
.g2_kernel_s2:
  s_mov_b32 s8, s42
  s_mov_b32 s9, s43
  s_mov_b32 s10, 0x600000
  s_mov_b32 s11, 0x00020000
  v_lshrrev_b32 v20, 3, v2
  v_and_b32 v21, 7, v2
  v_mul_u32_u24 v20, 6144, v20
  v_lshl_add_u32 v20, v21, 4, v20
  s_mul_i32 s30, s17, 393216
  s_lshl_b32 s31, s18, 7
  s_add_u32 s30, s30, s31
  s_add_u32 s31, s30, 4096
  s_barrier
  s_sleep 30
  buffer_load_dwordx4 v[64:67], v20, s[8:11], s30 offen
  buffer_load_dwordx4 v[68:71], v20, s[8:11], s30 offen offset:2048
  buffer_load_dwordx4 v[72:75], v20, s[8:11], s31 offen
  s_add_u32 s30, s30, 49152
  s_add_u32 s31, s31, 49152
  buffer_load_dwordx4 v[76:79], v20, s[8:11], s30 offen
  buffer_load_dwordx4 v[80:83], v20, s[8:11], s30 offen offset:2048
  buffer_load_dwordx4 v[84:87], v20, s[8:11], s31 offen
  s_add_u32 s30, s30, 49152
  s_add_u32 s31, s31, 49152
  buffer_load_dwordx4 v[88:91], v20, s[8:11], s30 offen
  buffer_load_dwordx4 v[92:95], v20, s[8:11], s30 offen offset:2048
  buffer_load_dwordx4 v[96:99], v20, s[8:11], s31 offen
  s_add_u32 s30, s30, 49152
  s_add_u32 s31, s31, 49152
  buffer_load_dwordx4 v[100:103], v20, s[8:11], s30 offen
  buffer_load_dwordx4 v[104:107], v20, s[8:11], s30 offen offset:2048
  buffer_load_dwordx4 v[108:111], v20, s[8:11], s31 offen
  s_add_u32 s30, s30, 49152
  s_add_u32 s31, s31, 49152
  buffer_load_dwordx4 v[112:115], v20, s[8:11], s30 offen
  buffer_load_dwordx4 v[116:119], v20, s[8:11], s30 offen offset:2048
  buffer_load_dwordx4 v[120:123], v20, s[8:11], s31 offen
  s_add_u32 s30, s30, 49152
  s_add_u32 s31, s31, 49152
  buffer_load_dwordx4 v[124:127], v20, s[8:11], s30 offen
  buffer_load_dwordx4 v[128:131], v20, s[8:11], s30 offen offset:2048
  buffer_load_dwordx4 v[132:135], v20, s[8:11], s31 offen
  s_add_u32 s30, s30, 49152
  s_add_u32 s31, s31, 49152
  buffer_load_dwordx4 v[136:139], v20, s[8:11], s30 offen
  buffer_load_dwordx4 v[140:143], v20, s[8:11], s30 offen offset:2048
  buffer_load_dwordx4 v[144:147], v20, s[8:11], s31 offen
  s_add_u32 s30, s30, 49152
  s_add_u32 s31, s31, 49152
  buffer_load_dwordx4 v[148:151], v20, s[8:11], s30 offen
  buffer_load_dwordx4 v[152:155], v20, s[8:11], s30 offen offset:2048
  buffer_load_dwordx4 v[156:159], v20, s[8:11], s31 offen
  s_add_u32 s30, s30, 49152
  s_add_u32 s31, s31, 49152
  v_lshlrev_b32 v21, 5, v21
  v_lshrrev_b32 v22, 5, v2
  v_lshl_add_u32 v21, v22, 4, v21
  v_bfe_u32 v22, v2, 4, 1
  v_lshl_add_u32 v21, v22, 3, v21
  s_lshl_b32 s30, s18, 4
  s_add_u32 s30, s30, s17
  s_mul_i32 s30, s30, 768
  s_add_u32 s30, s30, 0x3080000
  s_waitcnt vmcnt(23)
  v_lshlrev_b32 v160, 16, v64
  v_and_b32 v161, 0xffff0000, v64
  v_lshlrev_b32 v162, 16, v65
  v_and_b32 v163, 0xffff0000, v65
  v_lshlrev_b32 v164, 16, v66
  v_and_b32 v165, 0xffff0000, v66
  v_lshlrev_b32 v166, 16, v67
  v_and_b32 v167, 0xffff0000, v67
  s_waitcnt vmcnt(22)
  v_lshlrev_b32 v168, 16, v68
  v_and_b32 v169, 0xffff0000, v68
  v_lshlrev_b32 v170, 16, v69
  v_and_b32 v171, 0xffff0000, v69
  v_lshlrev_b32 v172, 16, v70
  v_and_b32 v173, 0xffff0000, v70
  v_lshlrev_b32 v174, 16, v71
  v_and_b32 v175, 0xffff0000, v71
  s_waitcnt vmcnt(21)
  v_lshlrev_b32 v176, 16, v72
  v_and_b32 v177, 0xffff0000, v72
  v_lshlrev_b32 v178, 16, v73
  v_and_b32 v179, 0xffff0000, v73
  v_lshlrev_b32 v180, 16, v74
  v_and_b32 v181, 0xffff0000, v74
  v_lshlrev_b32 v182, 16, v75
  v_and_b32 v183, 0xffff0000, v75
  s_waitcnt vmcnt(20)
  v_lshlrev_b32 v184, 16, v76
  v_and_b32 v185, 0xffff0000, v76
  v_lshlrev_b32 v186, 16, v77
  v_and_b32 v187, 0xffff0000, v77
  v_lshlrev_b32 v188, 16, v78
  v_and_b32 v189, 0xffff0000, v78
  v_lshlrev_b32 v190, 16, v79
  v_and_b32 v191, 0xffff0000, v79
  v_add_f32 v160, v160, v184
  v_add_f32 v161, v161, v185
  v_add_f32 v162, v162, v186
  v_add_f32 v163, v163, v187
  v_add_f32 v164, v164, v188
  v_add_f32 v165, v165, v189
  v_add_f32 v166, v166, v190
  v_add_f32 v167, v167, v191
  s_waitcnt vmcnt(19)
  v_lshlrev_b32 v184, 16, v80
  v_and_b32 v185, 0xffff0000, v80
  v_lshlrev_b32 v186, 16, v81
  v_and_b32 v187, 0xffff0000, v81
  v_lshlrev_b32 v188, 16, v82
  v_and_b32 v189, 0xffff0000, v82
  v_lshlrev_b32 v190, 16, v83
  v_and_b32 v191, 0xffff0000, v83
  v_add_f32 v168, v168, v184
  v_add_f32 v169, v169, v185
  v_add_f32 v170, v170, v186
  v_add_f32 v171, v171, v187
  v_add_f32 v172, v172, v188
  v_add_f32 v173, v173, v189
  v_add_f32 v174, v174, v190
  v_add_f32 v175, v175, v191
  s_waitcnt vmcnt(18)
  v_lshlrev_b32 v184, 16, v84
  v_and_b32 v185, 0xffff0000, v84
  v_lshlrev_b32 v186, 16, v85
  v_and_b32 v187, 0xffff0000, v85
  v_lshlrev_b32 v188, 16, v86
  v_and_b32 v189, 0xffff0000, v86
  v_lshlrev_b32 v190, 16, v87
  v_and_b32 v191, 0xffff0000, v87
  v_add_f32 v176, v176, v184
  v_add_f32 v177, v177, v185
  v_add_f32 v178, v178, v186
  v_add_f32 v179, v179, v187
  v_add_f32 v180, v180, v188
  v_add_f32 v181, v181, v189
  v_add_f32 v182, v182, v190
  v_add_f32 v183, v183, v191
  s_waitcnt vmcnt(17)
  v_lshlrev_b32 v184, 16, v88
  v_and_b32 v185, 0xffff0000, v88
  v_lshlrev_b32 v186, 16, v89
  v_and_b32 v187, 0xffff0000, v89
  v_lshlrev_b32 v188, 16, v90
  v_and_b32 v189, 0xffff0000, v90
  v_lshlrev_b32 v190, 16, v91
  v_and_b32 v191, 0xffff0000, v91
  v_add_f32 v160, v160, v184
  v_add_f32 v161, v161, v185
  v_add_f32 v162, v162, v186
  v_add_f32 v163, v163, v187
  v_add_f32 v164, v164, v188
  v_add_f32 v165, v165, v189
  v_add_f32 v166, v166, v190
  v_add_f32 v167, v167, v191
  s_waitcnt vmcnt(16)
  v_lshlrev_b32 v184, 16, v92
  v_and_b32 v185, 0xffff0000, v92
  v_lshlrev_b32 v186, 16, v93
  v_and_b32 v187, 0xffff0000, v93
  v_lshlrev_b32 v188, 16, v94
  v_and_b32 v189, 0xffff0000, v94
  v_lshlrev_b32 v190, 16, v95
  v_and_b32 v191, 0xffff0000, v95
  v_add_f32 v168, v168, v184
  v_add_f32 v169, v169, v185
  v_add_f32 v170, v170, v186
  v_add_f32 v171, v171, v187
  v_add_f32 v172, v172, v188
  v_add_f32 v173, v173, v189
  v_add_f32 v174, v174, v190
  v_add_f32 v175, v175, v191
  s_waitcnt vmcnt(15)
  v_lshlrev_b32 v184, 16, v96
  v_and_b32 v185, 0xffff0000, v96
  v_lshlrev_b32 v186, 16, v97
  v_and_b32 v187, 0xffff0000, v97
  v_lshlrev_b32 v188, 16, v98
  v_and_b32 v189, 0xffff0000, v98
  v_lshlrev_b32 v190, 16, v99
  v_and_b32 v191, 0xffff0000, v99
  v_add_f32 v176, v176, v184
  v_add_f32 v177, v177, v185
  v_add_f32 v178, v178, v186
  v_add_f32 v179, v179, v187
  v_add_f32 v180, v180, v188
  v_add_f32 v181, v181, v189
  v_add_f32 v182, v182, v190
  v_add_f32 v183, v183, v191
  s_waitcnt vmcnt(14)
  v_lshlrev_b32 v184, 16, v100
  v_and_b32 v185, 0xffff0000, v100
  v_lshlrev_b32 v186, 16, v101
  v_and_b32 v187, 0xffff0000, v101
  v_lshlrev_b32 v188, 16, v102
  v_and_b32 v189, 0xffff0000, v102
  v_lshlrev_b32 v190, 16, v103
  v_and_b32 v191, 0xffff0000, v103
  v_add_f32 v160, v160, v184
  v_add_f32 v161, v161, v185
  v_add_f32 v162, v162, v186
  v_add_f32 v163, v163, v187
  v_add_f32 v164, v164, v188
  v_add_f32 v165, v165, v189
  v_add_f32 v166, v166, v190
  v_add_f32 v167, v167, v191
  s_waitcnt vmcnt(13)
  v_lshlrev_b32 v184, 16, v104
  v_and_b32 v185, 0xffff0000, v104
  v_lshlrev_b32 v186, 16, v105
  v_and_b32 v187, 0xffff0000, v105
  v_lshlrev_b32 v188, 16, v106
  v_and_b32 v189, 0xffff0000, v106
  v_lshlrev_b32 v190, 16, v107
  v_and_b32 v191, 0xffff0000, v107
  v_add_f32 v168, v168, v184
  v_add_f32 v169, v169, v185
  v_add_f32 v170, v170, v186
  v_add_f32 v171, v171, v187
  v_add_f32 v172, v172, v188
  v_add_f32 v173, v173, v189
  v_add_f32 v174, v174, v190
  v_add_f32 v175, v175, v191
  s_waitcnt vmcnt(12)
  v_lshlrev_b32 v184, 16, v108
  v_and_b32 v185, 0xffff0000, v108
  v_lshlrev_b32 v186, 16, v109
  v_and_b32 v187, 0xffff0000, v109
  v_lshlrev_b32 v188, 16, v110
  v_and_b32 v189, 0xffff0000, v110
  v_lshlrev_b32 v190, 16, v111
  v_and_b32 v191, 0xffff0000, v111
  v_add_f32 v176, v176, v184
  v_add_f32 v177, v177, v185
  v_add_f32 v178, v178, v186
  v_add_f32 v179, v179, v187
  v_add_f32 v180, v180, v188
  v_add_f32 v181, v181, v189
  v_add_f32 v182, v182, v190
  v_add_f32 v183, v183, v191
  s_waitcnt vmcnt(11)
  v_lshlrev_b32 v184, 16, v112
  v_and_b32 v185, 0xffff0000, v112
  v_lshlrev_b32 v186, 16, v113
  v_and_b32 v187, 0xffff0000, v113
  v_lshlrev_b32 v188, 16, v114
  v_and_b32 v189, 0xffff0000, v114
  v_lshlrev_b32 v190, 16, v115
  v_and_b32 v191, 0xffff0000, v115
  v_add_f32 v160, v160, v184
  v_add_f32 v161, v161, v185
  v_add_f32 v162, v162, v186
  v_add_f32 v163, v163, v187
  v_add_f32 v164, v164, v188
  v_add_f32 v165, v165, v189
  v_add_f32 v166, v166, v190
  v_add_f32 v167, v167, v191
  s_waitcnt vmcnt(10)
  v_lshlrev_b32 v184, 16, v116
  v_and_b32 v185, 0xffff0000, v116
  v_lshlrev_b32 v186, 16, v117
  v_and_b32 v187, 0xffff0000, v117
  v_lshlrev_b32 v188, 16, v118
  v_and_b32 v189, 0xffff0000, v118
  v_lshlrev_b32 v190, 16, v119
  v_and_b32 v191, 0xffff0000, v119
  v_add_f32 v168, v168, v184
  v_add_f32 v169, v169, v185
  v_add_f32 v170, v170, v186
  v_add_f32 v171, v171, v187
  v_add_f32 v172, v172, v188
  v_add_f32 v173, v173, v189
  v_add_f32 v174, v174, v190
  v_add_f32 v175, v175, v191
  s_waitcnt vmcnt(9)
  v_lshlrev_b32 v184, 16, v120
  v_and_b32 v185, 0xffff0000, v120
  v_lshlrev_b32 v186, 16, v121
  v_and_b32 v187, 0xffff0000, v121
  v_lshlrev_b32 v188, 16, v122
  v_and_b32 v189, 0xffff0000, v122
  v_lshlrev_b32 v190, 16, v123
  v_and_b32 v191, 0xffff0000, v123
  v_add_f32 v176, v176, v184
  v_add_f32 v177, v177, v185
  v_add_f32 v178, v178, v186
  v_add_f32 v179, v179, v187
  v_add_f32 v180, v180, v188
  v_add_f32 v181, v181, v189
  v_add_f32 v182, v182, v190
  v_add_f32 v183, v183, v191
  s_waitcnt vmcnt(8)
  v_lshlrev_b32 v184, 16, v124
  v_and_b32 v185, 0xffff0000, v124
  v_lshlrev_b32 v186, 16, v125
  v_and_b32 v187, 0xffff0000, v125
  v_lshlrev_b32 v188, 16, v126
  v_and_b32 v189, 0xffff0000, v126
  v_lshlrev_b32 v190, 16, v127
  v_and_b32 v191, 0xffff0000, v127
  v_add_f32 v160, v160, v184
  v_add_f32 v161, v161, v185
  v_add_f32 v162, v162, v186
  v_add_f32 v163, v163, v187
  v_add_f32 v164, v164, v188
  v_add_f32 v165, v165, v189
  v_add_f32 v166, v166, v190
  v_add_f32 v167, v167, v191
  s_waitcnt vmcnt(7)
  v_lshlrev_b32 v184, 16, v128
  v_and_b32 v185, 0xffff0000, v128
  v_lshlrev_b32 v186, 16, v129
  v_and_b32 v187, 0xffff0000, v129
  v_lshlrev_b32 v188, 16, v130
  v_and_b32 v189, 0xffff0000, v130
  v_lshlrev_b32 v190, 16, v131
  v_and_b32 v191, 0xffff0000, v131
  v_add_f32 v168, v168, v184
  v_add_f32 v169, v169, v185
  v_add_f32 v170, v170, v186
  v_add_f32 v171, v171, v187
  v_add_f32 v172, v172, v188
  v_add_f32 v173, v173, v189
  v_add_f32 v174, v174, v190
  v_add_f32 v175, v175, v191
  s_waitcnt vmcnt(6)
  v_lshlrev_b32 v184, 16, v132
  v_and_b32 v185, 0xffff0000, v132
  v_lshlrev_b32 v186, 16, v133
  v_and_b32 v187, 0xffff0000, v133
  v_lshlrev_b32 v188, 16, v134
  v_and_b32 v189, 0xffff0000, v134
  v_lshlrev_b32 v190, 16, v135
  v_and_b32 v191, 0xffff0000, v135
  v_add_f32 v176, v176, v184
  v_add_f32 v177, v177, v185
  v_add_f32 v178, v178, v186
  v_add_f32 v179, v179, v187
  v_add_f32 v180, v180, v188
  v_add_f32 v181, v181, v189
  v_add_f32 v182, v182, v190
  v_add_f32 v183, v183, v191
  s_waitcnt vmcnt(5)
  v_lshlrev_b32 v184, 16, v136
  v_and_b32 v185, 0xffff0000, v136
  v_lshlrev_b32 v186, 16, v137
  v_and_b32 v187, 0xffff0000, v137
  v_lshlrev_b32 v188, 16, v138
  v_and_b32 v189, 0xffff0000, v138
  v_lshlrev_b32 v190, 16, v139
  v_and_b32 v191, 0xffff0000, v139
  v_add_f32 v160, v160, v184
  v_add_f32 v161, v161, v185
  v_add_f32 v162, v162, v186
  v_add_f32 v163, v163, v187
  v_add_f32 v164, v164, v188
  v_add_f32 v165, v165, v189
  v_add_f32 v166, v166, v190
  v_add_f32 v167, v167, v191
  s_waitcnt vmcnt(4)
  v_lshlrev_b32 v184, 16, v140
  v_and_b32 v185, 0xffff0000, v140
  v_lshlrev_b32 v186, 16, v141
  v_and_b32 v187, 0xffff0000, v141
  v_lshlrev_b32 v188, 16, v142
  v_and_b32 v189, 0xffff0000, v142
  v_lshlrev_b32 v190, 16, v143
  v_and_b32 v191, 0xffff0000, v143
  v_add_f32 v168, v168, v184
  v_add_f32 v169, v169, v185
  v_add_f32 v170, v170, v186
  v_add_f32 v171, v171, v187
  v_add_f32 v172, v172, v188
  v_add_f32 v173, v173, v189
  v_add_f32 v174, v174, v190
  v_add_f32 v175, v175, v191
  s_waitcnt vmcnt(3)
  v_lshlrev_b32 v184, 16, v144
  v_and_b32 v185, 0xffff0000, v144
  v_lshlrev_b32 v186, 16, v145
  v_and_b32 v187, 0xffff0000, v145
  v_lshlrev_b32 v188, 16, v146
  v_and_b32 v189, 0xffff0000, v146
  v_lshlrev_b32 v190, 16, v147
  v_and_b32 v191, 0xffff0000, v147
  v_add_f32 v176, v176, v184
  v_add_f32 v177, v177, v185
  v_add_f32 v178, v178, v186
  v_add_f32 v179, v179, v187
  v_add_f32 v180, v180, v188
  v_add_f32 v181, v181, v189
  v_add_f32 v182, v182, v190
  v_add_f32 v183, v183, v191
  s_waitcnt vmcnt(2)
  v_lshlrev_b32 v184, 16, v148
  v_and_b32 v185, 0xffff0000, v148
  v_lshlrev_b32 v186, 16, v149
  v_and_b32 v187, 0xffff0000, v149
  v_lshlrev_b32 v188, 16, v150
  v_and_b32 v189, 0xffff0000, v150
  v_lshlrev_b32 v190, 16, v151
  v_and_b32 v191, 0xffff0000, v151
  v_add_f32 v160, v160, v184
  v_add_f32 v161, v161, v185
  v_add_f32 v162, v162, v186
  v_add_f32 v163, v163, v187
  v_add_f32 v164, v164, v188
  v_add_f32 v165, v165, v189
  v_add_f32 v166, v166, v190
  v_add_f32 v167, v167, v191
  s_waitcnt vmcnt(1)
  v_lshlrev_b32 v184, 16, v152
  v_and_b32 v185, 0xffff0000, v152
  v_lshlrev_b32 v186, 16, v153
  v_and_b32 v187, 0xffff0000, v153
  v_lshlrev_b32 v188, 16, v154
  v_and_b32 v189, 0xffff0000, v154
  v_lshlrev_b32 v190, 16, v155
  v_and_b32 v191, 0xffff0000, v155
  v_add_f32 v168, v168, v184
  v_add_f32 v169, v169, v185
  v_add_f32 v170, v170, v186
  v_add_f32 v171, v171, v187
  v_add_f32 v172, v172, v188
  v_add_f32 v173, v173, v189
  v_add_f32 v174, v174, v190
  v_add_f32 v175, v175, v191
  s_waitcnt vmcnt(0)
  v_lshlrev_b32 v184, 16, v156
  v_and_b32 v185, 0xffff0000, v156
  v_lshlrev_b32 v186, 16, v157
  v_and_b32 v187, 0xffff0000, v157
  v_lshlrev_b32 v188, 16, v158
  v_and_b32 v189, 0xffff0000, v158
  v_lshlrev_b32 v190, 16, v159
  v_and_b32 v191, 0xffff0000, v159
  v_add_f32 v176, v176, v184
  v_add_f32 v177, v177, v185
  v_add_f32 v178, v178, v186
  v_add_f32 v179, v179, v187
  v_add_f32 v180, v180, v188
  v_add_f32 v181, v181, v189
  v_add_f32 v182, v182, v190
  v_add_f32 v183, v183, v191
  v_permlane32_swap_b32 v160, v164
  v_permlane32_swap_b32 v161, v165
  v_permlane32_swap_b32 v162, v166
  v_permlane32_swap_b32 v163, v167
  v_add_f32 v160, v160, v164
  v_add_f32 v161, v161, v165
  v_add_f32 v162, v162, v166
  v_add_f32 v163, v163, v167
  s_nop 0
  v_permlane16_swap_b32 v160, v162
  v_permlane16_swap_b32 v161, v163
  v_add_f32 v160, v160, v162
  v_add_f32 v161, v161, v163
  s_nop 0
  v_add_f32 v160, v160, v160 row_ror:8 row_mask:0xf bank_mask:0xf
  v_add_f32 v161, v161, v161 row_ror:8 row_mask:0xf bank_mask:0xf
  v_permlane32_swap_b32 v168, v172
  v_permlane32_swap_b32 v169, v173
  v_permlane32_swap_b32 v170, v174
  v_permlane32_swap_b32 v171, v175
  v_add_f32 v168, v168, v172
  v_add_f32 v169, v169, v173
  v_add_f32 v170, v170, v174
  v_add_f32 v171, v171, v175
  s_nop 0
  v_permlane16_swap_b32 v168, v170
  v_permlane16_swap_b32 v169, v171
  v_add_f32 v168, v168, v170
  v_add_f32 v169, v169, v171
  s_nop 0
  v_add_f32 v168, v168, v168 row_ror:8 row_mask:0xf bank_mask:0xf
  v_add_f32 v169, v169, v169 row_ror:8 row_mask:0xf bank_mask:0xf
  v_permlane32_swap_b32 v176, v180
  v_permlane32_swap_b32 v177, v181
  v_permlane32_swap_b32 v178, v182
  v_permlane32_swap_b32 v179, v183
  v_add_f32 v176, v176, v180
  v_add_f32 v177, v177, v181
  v_add_f32 v178, v178, v182
  v_add_f32 v179, v179, v183
  s_nop 0
  v_permlane16_swap_b32 v176, v178
  v_permlane16_swap_b32 v177, v179
  v_add_f32 v176, v176, v178
  v_add_f32 v177, v177, v179
  s_nop 0
  v_add_f32 v176, v176, v176 row_ror:8 row_mask:0xf bank_mask:0xf
  v_add_f32 v177, v177, v177 row_ror:8 row_mask:0xf bank_mask:0xf
  s_mov_b32 exec_lo, 0x00ff00ff
  s_mov_b32 exec_hi, 0x00ff00ff
  buffer_store_dwordx2 v[160:161], v21, s[4:7], s30 offen offset:0 sc1
  buffer_store_dwordx2 v[168:169], v21, s[4:7], s30 offen offset:256 sc1
  buffer_store_dwordx2 v[176:177], v21, s[4:7], s30 offen offset:512 sc1
  s_mov_b64 exec, -1
  s_mov_b32 s12, s58
  s_mov_b32 s13, s59
  s_mov_b32 s14, 0x100
  s_mov_b32 s15, 0x00020000
  s_mov_b32 s38, 0
  s_mov_b64 exec, 1
.g2_kernel_gt12:
  buffer_load_dword v6, v4, s[12:15], 0 offen sc1
  s_add_u32 s38, s38, 1
  s_waitcnt vmcnt(0)
  v_cmp_eq_u32 vcc, 0x60, v6
  s_cbranch_vccnz .g2_kernel_gt12d
  s_sleep 8
  s_cmp_lt_u32 s38, 131072
  s_cbranch_scc1 .g2_kernel_gt12
.g2_kernel_gt12d:
  s_mov_b64 exec, -1
  v_mov_b32 v6, s70
  s_mov_b64 exec, 1
  buffer_store_dword v6, v4, s[4:7], s76 offen offset:4 sc1
  s_mov_b64 exec, -1
  v_mov_b32 v6, 155648
  s_mov_b32 s38, 0
.g2_kernel_wg13:
  ds_read_b32 v7, v6 offset:512
  s_add_u32 s38, s38, 1
  s_waitcnt lgkmcnt(0)
  v_cmp_gt_u32 vcc, 22, v7
  s_cbranch_vccz .g2_kernel_wg13d
  s_sleep 4
  s_cmp_lt_u32 s38, 524288
  s_cbranch_scc1 .g2_kernel_wg13
.g2_kernel_wg13d:
  s_and_b32 s31, s76, 0xffffe000
  s_add_u32 s31, s31, 4
  v_and_b32 v6, 15, v2
  v_lshlrev_b32 v6, 9, v6
  v_lshrrev_b32 v7, 4, v2
  v_lshl_add_u32 v6, v7, 7, v6
  v_lshlrev_b32 v7, 2, v2
  v_add_u32 v7, 157696, v7
  s_mov_b32 m0, 157696
  s_mov_b32 s38, 0
  s_bfm_b64 exec, 16, 0
.g2_kernel_pa14:
  buffer_load_dword v6, s[4:7], s31 offen sc1 lds
  s_add_u32 s38, s38, 1
  s_waitcnt vmcnt(0)
  ds_read_b32 v8, v7
  s_waitcnt lgkmcnt(0)
  v_cmp_ge_u32 vcc, s62, v8
  s_cbranch_vccz .g2_kernel_pa14d
  s_mov_b64 exec, vcc
  s_sleep 16
  s_cmp_lt_u32 s38, 131072
  s_cbranch_scc1 .g2_kernel_pa14
.g2_kernel_pa14d:
  s_mov_b64 exec, -1
  s_mul_i32 s30, s18, 12288
  s_add_u32 s30, s30, 0x3080000
  s_mov_b32 exec_hi, 0xffff
  buffer_load_dwordx4 v[64:67], v3, s[4:7], s30 offen offset:0 sc1
  buffer_load_dwordx4 v[68:71], v3, s[4:7], s30 offen offset:768 sc1
  buffer_load_dwordx4 v[72:75], v3, s[4:7], s30 offen offset:1536 sc1
  buffer_load_dwordx4 v[76:79], v3, s[4:7], s30 offen offset:2304 sc1
  s_add_u32 s30, s30, 3072
  buffer_load_dwordx4 v[80:83], v3, s[4:7], s30 offen offset:0 sc1
  buffer_load_dwordx4 v[84:87], v3, s[4:7], s30 offen offset:768 sc1
  buffer_load_dwordx4 v[88:91], v3, s[4:7], s30 offen offset:1536 sc1
  buffer_load_dwordx4 v[92:95], v3, s[4:7], s30 offen offset:2304 sc1
  s_add_u32 s30, s30, 3072
  buffer_load_dwordx4 v[96:99], v3, s[4:7], s30 offen offset:0 sc1
  buffer_load_dwordx4 v[100:103], v3, s[4:7], s30 offen offset:768 sc1
  buffer_load_dwordx4 v[104:107], v3, s[4:7], s30 offen offset:1536 sc1
  buffer_load_dwordx4 v[108:111], v3, s[4:7], s30 offen offset:2304 sc1
  s_add_u32 s30, s30, 3072
  buffer_load_dwordx4 v[112:115], v3, s[4:7], s30 offen offset:0 sc1
  buffer_load_dwordx4 v[116:119], v3, s[4:7], s30 offen offset:768 sc1
  buffer_load_dwordx4 v[120:123], v3, s[4:7], s30 offen offset:1536 sc1
  buffer_load_dwordx4 v[124:127], v3, s[4:7], s30 offen offset:2304 sc1
  s_add_u32 s30, s30, 3072
  s_waitcnt vmcnt(14)
  v_add_f32 v64, v64, v68
  v_add_f32 v65, v65, v69
  v_add_f32 v66, v66, v70
  v_add_f32 v67, v67, v71
  s_waitcnt vmcnt(13)
  v_add_f32 v64, v64, v72
  v_add_f32 v65, v65, v73
  v_add_f32 v66, v66, v74
  v_add_f32 v67, v67, v75
  s_waitcnt vmcnt(12)
  v_add_f32 v64, v64, v76
  v_add_f32 v65, v65, v77
  v_add_f32 v66, v66, v78
  v_add_f32 v67, v67, v79
  s_waitcnt vmcnt(11)
  v_add_f32 v64, v64, v80
  v_add_f32 v65, v65, v81
  v_add_f32 v66, v66, v82
  v_add_f32 v67, v67, v83
  s_waitcnt vmcnt(10)
  v_add_f32 v64, v64, v84
  v_add_f32 v65, v65, v85
  v_add_f32 v66, v66, v86
  v_add_f32 v67, v67, v87
  s_waitcnt vmcnt(9)
  v_add_f32 v64, v64, v88
  v_add_f32 v65, v65, v89
  v_add_f32 v66, v66, v90
  v_add_f32 v67, v67, v91
  s_waitcnt vmcnt(8)
  v_add_f32 v64, v64, v92
  v_add_f32 v65, v65, v93
  v_add_f32 v66, v66, v94
  v_add_f32 v67, v67, v95
  s_waitcnt vmcnt(7)
  v_add_f32 v64, v64, v96
  v_add_f32 v65, v65, v97
  v_add_f32 v66, v66, v98
  v_add_f32 v67, v67, v99
  s_waitcnt vmcnt(6)
  v_add_f32 v64, v64, v100
  v_add_f32 v65, v65, v101
  v_add_f32 v66, v66, v102
  v_add_f32 v67, v67, v103
  s_waitcnt vmcnt(5)
  v_add_f32 v64, v64, v104
  v_add_f32 v65, v65, v105
  v_add_f32 v66, v66, v106
  v_add_f32 v67, v67, v107
  s_waitcnt vmcnt(4)
  v_add_f32 v64, v64, v108
  v_add_f32 v65, v65, v109
  v_add_f32 v66, v66, v110
  v_add_f32 v67, v67, v111
  s_waitcnt vmcnt(3)
  v_add_f32 v64, v64, v112
  v_add_f32 v65, v65, v113
  v_add_f32 v66, v66, v114
  v_add_f32 v67, v67, v115
  s_waitcnt vmcnt(2)
  v_add_f32 v64, v64, v116
  v_add_f32 v65, v65, v117
  v_add_f32 v66, v66, v118
  v_add_f32 v67, v67, v119
  s_waitcnt vmcnt(1)
  v_add_f32 v64, v64, v120
  v_add_f32 v65, v65, v121
  v_add_f32 v66, v66, v122
  v_add_f32 v67, v67, v123
  s_waitcnt vmcnt(0)
  v_add_f32 v64, v64, v124
  v_add_f32 v65, v65, v125
  v_add_f32 v66, v66, v126
  v_add_f32 v67, v67, v127
  s_mov_b64 exec, -1
  v_mov_b32 v6, 155648
  s_mov_b32 s38, 0
.g2_kernel_wg15:
  ds_read_b32 v7, v6 offset:512
  s_add_u32 s38, s38, 1
  s_waitcnt lgkmcnt(0)
  v_cmp_gt_u32 vcc, 32, v7
  s_cbranch_vccz .g2_kernel_wg15d
  s_sleep 2
  s_cmp_lt_u32 s38, 524288
  s_cbranch_scc1 .g2_kernel_wg15
.g2_kernel_wg15d:
  v_lshlrev_b32 v24, 2, v2
  v_add_u32 v24, 155648, v24
  ds_write_b32 v24, v4 offset:2048
  v_add_u32 v24, 155648, v3
  s_mov_b32 exec_hi, 0xffff
  ds_write_b128 v24, v[64:67] offset:4864
  s_mov_b64 exec, -1
  v_mov_b32 v6, s71
  s_mov_b64 exec, 1
  ds_add_u32 v6, v5 offset:0
  s_mov_b64 exec, -1
  s_branch .g2_kernel_v
.g2_kernel_s3:
  s_mov_b32 s12, s58
  s_mov_b32 s13, s59
  s_mov_b32 s14, 0x100
  s_mov_b32 s15, 0x00020000
  s_mov_b32 s20, s48
  s_mov_b32 s21, s49
  s_mov_b32 s22, 0x800
  s_mov_b32 s23, 0x00020000
  v_mov_b32 v12, 0
  v_mov_b32 v13, 0
  v_mov_b32 v14, 0
  v_mov_b32 v15, 0
  s_cmp_ge_u32 s2, 96
  s_cbranch_scc1 .g2_kernel_zm16
  s_lshl_b32 s36, s2, 12
  s_add_u32 s36, s36, 0x3000000
  buffer_store_dwordx4 v[12:15], v3, s[4:7], s36 offen sc1
  buffer_store_dwordx4 v[12:15], v3, s[4:7], s36 offen offset:1024 sc1
  buffer_store_dwordx4 v[12:15], v3, s[4:7], s36 offen offset:2048 sc1
  buffer_store_dwordx4 v[12:15], v3, s[4:7], s36 offen offset:3072 sc1
.g2_kernel_zm16:
  s_barrier
  s_cbranch_scc1 .g2_kernel_zm16b
  s_mov_b64 exec, 1
  s_waitcnt vmcnt(0)
  buffer_atomic_add v5, v4, s[12:15], 0 offen sc1
  s_mov_b64 exec, -1
.g2_kernel_zm16b:
  s_and_b32 s36, s18, 7
  s_cmp_ge_u32 s36, 3
  s_cbranch_scc1 .g2_kernel_c317
  s_mov_b32 s24, s42
  s_mov_b32 s25, s43
  s_mov_b32 s26, 0x600000
  s_mov_b32 s27, 0x00020000
  v_mul_u32_u24 v7, 6144, v2
  s_lshl_b32 s36, s36, 11
  s_or_b32 s37, s18, 3
  s_lshl_b32 s37, s37, 7
  s_add_u32 s36, s36, s37
  s_and_b32 s37, s17, 7
  s_mul_i32 s37, s37, 393216
  s_add_u32 s36, s36, s37
  s_add_u32 s37, s36, 3145728
  s_sleep 0
  buffer_load_dword v1, v7, s[24:27], s36 offen
  s_sleep 30
  buffer_load_dword v1, v7, s[24:27], s37 offen
.g2_kernel_c317:
  v_lshlrev_b32 v20, 5, v2
  buffer_load_dwordx4 v[24:27], v20, s[20:23], 0 offen
  buffer_load_dwordx4 v[28:31], v20, s[20:23], 0 offen offset:16
  v_mov_b32 v20, 0
  s_waitcnt vmcnt(0)
  v_lshlrev_b32 v21, 16, v24
  v_and_b32 v22, 0xffff0000, v24
  v_add_f32 v20, v20, v21
  v_add_f32 v20, v20, v22
  v_lshlrev_b32 v21, 16, v25
  v_and_b32 v22, 0xffff0000, v25
  v_add_f32 v20, v20, v21
  v_add_f32 v20, v20, v22
  v_lshlrev_b32 v21, 16, v26
  v_and_b32 v22, 0xffff0000, v26
  v_add_f32 v20, v20, v21
  v_add_f32 v20, v20, v22
  v_lshlrev_b32 v21, 16, v27
  v_and_b32 v22, 0xffff0000, v27
  v_add_f32 v20, v20, v21
  v_add_f32 v20, v20, v22
  v_lshlrev_b32 v21, 16, v28
  v_and_b32 v22, 0xffff0000, v28
  v_add_f32 v20, v20, v21
  v_add_f32 v20, v20, v22
  v_lshlrev_b32 v21, 16, v29
  v_and_b32 v22, 0xffff0000, v29
  v_add_f32 v20, v20, v21
  v_add_f32 v20, v20, v22
  v_lshlrev_b32 v21, 16, v30
  v_and_b32 v22, 0xffff0000, v30
  v_add_f32 v20, v20, v21
  v_add_f32 v20, v20, v22
  v_lshlrev_b32 v21, 16, v31
  v_and_b32 v22, 0xffff0000, v31
  v_add_f32 v20, v20, v21
  v_add_f32 v20, v20, v22
  s_nop 1
  v_add_f32 v20, v20, v20 quad_perm:[1,0,3,2] row_mask:0xf bank_mask:0xf
  s_nop 1
  v_add_f32 v20, v20, v20 quad_perm:[2,3,0,1] row_mask:0xf bank_mask:0xf
  s_nop 1
  v_add_f32 v20, v20, v20 row_half_mirror row_mask:0xf bank_mask:0xf
  s_nop 1
  v_add_f32 v20, v20, v20 row_mirror row_mask:0xf bank_mask:0xf
  s_nop 0
  v_readlane_b32 s20, v20, 16
  v_readlane_b32 s21, v20, 32
  v_readlane_b32 s22, v20, 48
  v_add_f32 v20, s20, v20
  v_add_f32 v20, s21, v20
  v_add_f32 v20, s22, v20
  v_mul_f32 v20, 0x3a800000, v20
  v_mov_b32 v6, 155648
  s_mov_b32 s38, 0
.g2_kernel_wg18:
  ds_read_b32 v7, v6 offset:512
  s_add_u32 s38, s38, 1
  s_waitcnt lgkmcnt(0)
  v_cmp_gt_u32 vcc, 32, v7
  s_cbranch_vccz .g2_kernel_wg18d
  s_sleep 2
  s_cmp_lt_u32 s38, 524288
  s_cbranch_scc1 .g2_kernel_wg18
.g2_kernel_wg18d:
  v_mov_b32 v21, 155648
  s_mov_b64 exec, 1
  ds_write_b32 v21, v20 offset:256
  s_mov_b64 exec, -1
.g2_kernel_v:
  s_setprio 3
  s_cmp_lg_u32 s16, 4
  s_cbranch_scc1 .g2_kernel_v_1
  v_mov_b32 v6, s71
  s_mov_b32 s38, 0
.g2_kernel_wg19:
  ds_read_b32 v7, v6 offset:120
  s_add_u32 s38, s38, 1
  s_waitcnt lgkmcnt(0)
  v_cmp_gt_u32 vcc, 2, v7
  s_cbranch_vccz .g2_kernel_wg19d
  s_sleep 1
  s_cmp_lt_u32 s38, 524288
  s_cbranch_scc1 .g2_kernel_wg19
.g2_kernel_wg19d:
  s_sleep 4
  s_and_b32 s31, s76, 0xffffe000
  s_add_u32 s31, s31, 0
  v_and_b32 v6, 15, v2
  v_lshlrev_b32 v6, 9, v6
  v_lshrrev_b32 v7, 4, v2
  v_lshl_add_u32 v6, v7, 7, v6
  v_lshlrev_b32 v7, 2, v2
  v_add_u32 v7, 157440, v7
  s_mov_b32 m0, 157440
  s_mov_b32 s38, 0
  s_mov_b32 exec_lo, 0xffff
  s_mov_b32 exec_hi, 0xffff
.g2_kernel_pa20:
  buffer_load_dword v6, s[4:7], s31 offen sc1 lds
  s_add_u32 s38, s38, 1
  s_waitcnt vmcnt(0)
  ds_read_b32 v8, v7
  s_waitcnt lgkmcnt(0)
  v_cmp_ge_u32 vcc, s62, v8
  s_cbranch_vccz .g2_kernel_pa20d
  s_mov_b64 exec, vcc
  s_sleep 2
  s_cmp_lt_u32 s38, 131072
  s_cbranch_scc1 .g2_kernel_pa20
.g2_kernel_pa20d:
  s_mov_b64 exec, -1
  v_mov_b32 v6, s71
  s_mov_b32 s38, 0
.g2_kernel_wg21:
  ds_read_b32 v7, v6 offset:4
  s_add_u32 s38, s38, 1
  s_waitcnt lgkmcnt(0)
  v_cmp_gt_u32 vcc, 4, v7
  s_cbranch_vccz .g2_kernel_wg21d
  s_sleep 2
  s_cmp_lt_u32 s38, 524288
  s_cbranch_scc1 .g2_kernel_wg21
.g2_kernel_wg21d:
  v_mov_b32 v6, s71
  s_mov_b64 exec, 1
  ds_add_u32 v6, v5 offset:80
  s_mov_b64 exec, -1
.g2_kernel_v_1:
  s_cmp_lt_u32 s16, 6
  s_cbranch_scc1 .g2_kernel_v_2
  v_mov_b32 v6, s71
  s_mov_b32 s38, 0
.g2_kernel_wg22:
  ds_read_b32 v7, v6 offset:4
  s_add_u32 s38, s38, 1
  s_waitcnt lgkmcnt(0)
  v_cmp_gt_u32 vcc, 4, v7
  s_cbranch_vccz .g2_kernel_wg22d
  s_sleep 4
  s_cmp_lt_u32 s38, 524288
  s_cbranch_scc1 .g2_kernel_wg22
.g2_kernel_wg22d:
  s_and_b32 s28, s16, 1
  s_lshl_b32 s30, s28, 13
  s_add_u32 s31, s30, 16384
  v_add_u32 v8, s31, v3
  ds_read_b32 v9, v6 offset:24
  ds_read_b128 v[16:19], v8 offset:0
  ds_read_b128 v[20:23], v8 offset:1024
  ds_read_b128 v[24:27], v8 offset:2048
  ds_read_b128 v[28:31], v8 offset:3072
  ds_read_b128 v[32:35], v8 offset:4096
  ds_read_b128 v[36:39], v8 offset:5120
  ds_read_b128 v[40:43], v8 offset:6144
  ds_read_b128 v[44:47], v8 offset:7168
  s_lshl_b32 s31, s18, 5
  s_add_u32 s31, s31, s17
  s_add_u32 s31, s31, 16
  s_lshl_b32 s31, s31, 14
  s_add_u32 s30, s30, s31
  s_add_u32 s30, s30, s63
  s_add_u32 s31, s30, 4096
  s_lshl_b32 s33, s28, 8
  s_add_u32 s33, s33, 128
  s_waitcnt lgkmcnt(0)
  v_readfirstlane_b32 s29, v9
  v_mov_b32 v6, s71
  s_mov_b64 exec, 1
  ds_add_u32 v6, v5 offset:8
  s_mov_b64 exec, -1
  s_sleep 40
  buffer_store_dwordx4 v[16:19], v3, s[4:7], s30 offen offset:0 sc1
  s_sleep 4
  buffer_store_dwordx4 v[20:23], v3, s[4:7], s30 offen offset:1024 sc1
  s_sleep 4
  buffer_store_dwordx4 v[24:27], v3, s[4:7], s30 offen offset:2048 sc1
  s_sleep 4
  buffer_store_dwordx4 v[28:31], v3, s[4:7], s30 offen offset:3072 sc1
  s_sleep 4
  buffer_store_dwordx4 v[32:35], v3, s[4:7], s31 offen offset:0 sc1
  s_sleep 4
  buffer_store_dwordx4 v[36:39], v3, s[4:7], s31 offen offset:1024 sc1
  s_sleep 4
  buffer_store_dwordx4 v[40:43], v3, s[4:7], s31 offen offset:2048 sc1
  s_sleep 4
  buffer_store_dwordx4 v[44:47], v3, s[4:7], s31 offen offset:3072 sc1
  s_sleep 4
  s_sub_u32 s29, s29, 1
  s_lshr_b32 s29, s29, 6
  s_waitcnt vmcnt(0)
  s_cmp_eq_u32 s29, s28
  s_cbranch_scc1 .g2_kernel_v_1h
  s_add_u32 s31, s76, s33
  v_mov_b32 v6, s70
  s_mov_b64 exec, 1
  buffer_store_dword v6, v4, s[4:7], s31 offen offset:0 sc1
  s_mov_b64 exec, -1
  s_branch .g2_kernel_v_2
.g2_kernel_v_1h:
  v_mov_b32 v6, s71
  s_mov_b64 exec, 1
  ds_add_u32 v6, v5 offset:56
  s_mov_b64 exec, -1
.g2_kernel_v_2:
  v_mov_b32 v6, s71
  s_mov_b32 s38, 0
.g2_kernel_wg23:
  ds_read_b32 v7, v6 offset:80
  s_add_u32 s38, s38, 1
  s_waitcnt lgkmcnt(0)
  v_cmp_gt_u32 vcc, 1, v7
  s_cbranch_vccz .g2_kernel_wg23d
  s_sleep 8
  s_cmp_lt_u32 s38, 524288
  s_cbranch_scc1 .g2_kernel_wg23
.g2_kernel_wg23d:
  s_sleep 20
  s_mov_b32 s39, 0
  v_mov_b32 v12, 0
  v_mov_b32 v13, 0
  v_mov_b32 v14, 0
  v_mov_b32 v15, 0
  s_lshl_b32 s30, s17, 2
  s_and_b32 s31, s16, 3
  s_add_u32 s30, s30, s31
  s_lshl_b32 s30, s30, 4
  s_add_u32 s30, s30, s18
  s_lshl_b32 s30, s30, 9
  s_add_u32 s30, s30, s63
  s_add_u32 s30, s30, 0x1000000
  s_mov_b32 exec_hi, 0
  s_sleep 6
  buffer_store_dwordx4 v[12:15], v3, s[4:7], s30 offen sc1
  s_mov_b64 exec, -1
  s_lshl_b32 s30, s17, 2
  s_add_u32 s30, s30, s31
  s_lshl_b32 s30, s30, 5
  s_add_u32 s30, s30, s18
  s_lshl_b32 s30, s30, 11
  s_add_u32 s30, s30, s63
  s_add_u32 s30, s30, 0x808000
  s_sleep 6
  buffer_store_dwordx4 v[12:15], v3, s[4:7], s30 offen sc1
  s_sleep 6
  buffer_store_dwordx4 v[12:15], v3, s[4:7], s30 offen offset:1024 sc1
  s_cmp_lg_u32 s62, 5
  s_cbranch_scc1 .g2_kernel_zs24k
  s_lshl_b32 s30, s18, 4
  s_add_u32 s30, s30, s17
  s_lshl_b32 s30, s30, 2
  s_add_u32 s30, s30, s31
  s_lshl_b32 s30, s30, 12
  s_add_u32 s30, s30, 0x2c00000
  s_sleep 6
  buffer_store_dwordx4 v[12:15], v3, s[4:7], s30 offen sc1
  s_sleep 6
  buffer_store_dwordx4 v[12:15], v3, s[4:7], s30 offen offset:1024 sc1
  s_sleep 6
  buffer_store_dwordx4 v[12:15], v3, s[4:7], s30 offen offset:2048 sc1
  s_sleep 6
  buffer_store_dwordx4 v[12:15], v3, s[4:7], s30 offen offset:3072 sc1
.g2_kernel_zs24k:
  s_lshl_b32 s30, s17, 4
  s_add_u32 s30, s30, s18
  s_cmp_gt_u32 s16, 5
  s_cbranch_scc1 .g2_kernel_zs24
  s_cmp_eq_u32 s16, 5
  s_cbranch_scc1 .g2_kernel_zs24a
  s_cmp_lg_u32 s62, 0
  s_cbranch_scc1 .g2_kernel_zs24
  s_lshl_b32 s30, s30, 12
  s_add_u32 s31, s30, 0x1090000
  s_sleep 6
  buffer_store_dwordx4 v[12:15], v3, s[4:7], s31 offen offset:0 sc1
  s_sleep 6
  buffer_store_dwordx4 v[12:15], v3, s[4:7], s31 offen offset:1024 sc1
  s_sleep 6
  buffer_store_dwordx4 v[12:15], v3, s[4:7], s31 offen offset:2048 sc1
  s_sleep 6
  buffer_store_dwordx4 v[12:15], v3, s[4:7], s31 offen offset:3072 sc1
  s_add_u32 s31, s30, 0x2890000
  s_sleep 6
  buffer_store_dwordx4 v[12:15], v3, s[4:7], s31 offen offset:0 sc1
  s_sleep 6
  buffer_store_dwordx4 v[12:15], v3, s[4:7], s31 offen offset:1024 sc1
  s_sleep 6
  buffer_store_dwordx4 v[12:15], v3, s[4:7], s31 offen offset:2048 sc1
  s_sleep 6
  buffer_store_dwordx4 v[12:15], v3, s[4:7], s31 offen offset:3072 sc1
  s_add_u32 s31, s30, 0x2b00000
  s_sleep 6
  buffer_store_dwordx4 v[12:15], v3, s[4:7], s31 offen offset:0 sc1
  s_sleep 6
  buffer_store_dwordx4 v[12:15], v3, s[4:7], s31 offen offset:1024 sc1
  s_sleep 6
  buffer_store_dwordx4 v[12:15], v3, s[4:7], s31 offen offset:2048 sc1
  s_sleep 6
  buffer_store_dwordx4 v[12:15], v3, s[4:7], s31 offen offset:3072 sc1
  s_branch .g2_kernel_zs24
.g2_kernel_zs24a:
  s_xor_b32 s31, s17, s18
  s_and_b32 s31, s31, 3
  s_cbranch_scc1 .g2_kernel_zs24b
  s_lshr_b32 s30, s30, 2
  s_lshl_b32 s30, s30, 8
  s_add_u32 s30, s30, s63
  s_add_u32 s30, s30, 0x1080000
  s_mov_b64 exec, 0xffff
  s_sleep 6
  buffer_store_dwordx4 v[12:15], v3, s[4:7], s30 offen sc1
  s_mov_b64 exec, -1
.g2_kernel_zs24b:
  s_and_b32 s30, s18, 14
  s_lshl_b32 s30, s30, 4
  s_add_u32 s30, s30, s17
  s_lshl_b32 s30, s30, 1
  s_and_b32 s31, s18, 1
  s_add_u32 s30, s30, s31
  s_lshl_b32 s30, s30, 10
  s_add_u32 s30, s30, s63
  s_add_u32 s30, s30, 0x1190000
  s_add_u32 s31, s30, 32768
  s_sleep 6
  buffer_store_dwordx4 v[12:15], v3, s[4:7], s30 offen sc1
  s_sleep 6
  buffer_store_dwordx4 v[12:15], v3, s[4:7], s31 offen sc1
.g2_kernel_zs24:
  s_cmp_eq_u32 s16, 4
  s_cbranch_scc1 .g2_kernel_v_3a
  s_cmp_lg_u32 s62, 0
  s_cbranch_scc1 .g2_kernel_g_e
  s_and_b32 s22, s16, 3
  s_lshl_b32 s22, s22, 14
  s_cmp_eq_u32 s16, 5
  s_cselect_b32 s28, 65536, 0
  s_add_u32 s22, s22, s28
  v_bfe_u32 v8, v2, 2, 2
  v_lshrrev_b32 v9, 4, v2
  v_and_b32 v10, 3, v2
  v_lshlrev_b32 v10, 3, v10
  v_add_u32 v10, s22, v10
  s_cmp_eq_u32 s16, 5
  s_cbranch_scc1 .g2_kernel_g_p
  s_lshl_b32 s74, s17, 4
  s_add_u32 s74, s74, s18
  s_cmp_ge_u32 s74, 224
  s_cbranch_scc1 .g2_kernel_g_e
  v_lshrrev_b32 v6, 1, v2
  v_mul_u32_u24 v6, 7168, v6
  v_and_b32 v7, 1, v2
  v_lshl_add_u32 v250, v7, 4, v6
  v_lshl_add_u32 v11, v9, 3, v8
  v_lshl_add_u32 v251, v11, 5, v10
  v_and_b32 v11, 1, v9
  v_lshl_add_u32 v11, v11, 3, v8
  v_lshl_add_u32 v11, v11, 10, v10
  v_lshrrev_b32 v7, 1, v9
  v_lshl_add_u32 v252, v7, 7, v11
  s_mov_b32 s24, s74
  s_and_b32 s25, s16, 1
  s_mov_b32 s12, s50
  s_mov_b32 s13, s51
  s_mov_b32 s14, 0x700000
  s_mov_b32 s15, 0x00020000
  s_mul_i32 s20, s25, 3670016
  s_lshl_b32 s31, s24, 5
  s_add_u32 s20, s20, s31
  s_lshl_b32 s31, s18, 2
  s_mov_b32 s23, s31
  s_mov_b32 s21, 16
.g2_kernel_gl26:
  s_and_b32 s30, s21, 3
  s_cbranch_scc1 .g2_kernel_gl26m
  s_call_b64 s[26:27], .g2_kernel_v_may
.g2_kernel_gl26m:
  s_and_b32 s23, s23, 15
  s_lshl_b32 s30, s23, 10
  s_add_u32 s30, s30, 0
  s_add_u32 m0, s30, s22
  s_mul_i32 s30, s23, 229376
  s_add_u32 s30, s30, s20
  buffer_load_dwordx4 v250, s[12:15], s30 offen lds
  s_add_u32 s23, s23, 1
  s_sub_u32 s21, s21, 1
  s_sleep 3
  s_waitcnt vmcnt(2)
  s_cmp_lg_u32 s21, 0
  s_cbranch_scc1 .g2_kernel_gl26
  s_waitcnt vmcnt(0)
  ds_read_b64_tr_b16 v[64:65], v251 offset:0
  ds_read_b64_tr_b16 v[66:67], v251 offset:128
  ds_read_b64_tr_b16 v[68:69], v251 offset:1024
  ds_read_b64_tr_b16 v[70:71], v251 offset:1152
  ds_read_b64_tr_b16 v[72:73], v251 offset:2048
  ds_read_b64_tr_b16 v[74:75], v251 offset:2176
  ds_read_b64_tr_b16 v[76:77], v251 offset:3072
  ds_read_b64_tr_b16 v[78:79], v251 offset:3200
  ds_read_b64_tr_b16 v[80:81], v251 offset:4096
  ds_read_b64_tr_b16 v[82:83], v251 offset:4224
  ds_read_b64_tr_b16 v[84:85], v251 offset:5120
  ds_read_b64_tr_b16 v[86:87], v251 offset:5248
  ds_read_b64_tr_b16 v[88:89], v251 offset:6144
  ds_read_b64_tr_b16 v[90:91], v251 offset:6272
  ds_read_b64_tr_b16 v[92:93], v251 offset:7168
  ds_read_b64_tr_b16 v[94:95], v251 offset:7296
  ds_read_b64_tr_b16 v[96:97], v251 offset:8192
  ds_read_b64_tr_b16 v[98:99], v251 offset:8320
  ds_read_b64_tr_b16 v[100:101], v251 offset:9216
  ds_read_b64_tr_b16 v[102:103], v251 offset:9344
  ds_read_b64_tr_b16 v[104:105], v251 offset:10240
  ds_read_b64_tr_b16 v[106:107], v251 offset:10368
  ds_read_b64_tr_b16 v[108:109], v251 offset:11264
  ds_read_b64_tr_b16 v[110:111], v251 offset:11392
  ds_read_b64_tr_b16 v[112:113], v251 offset:12288
  ds_read_b64_tr_b16 v[114:115], v251 offset:12416
  ds_read_b64_tr_b16 v[116:117], v251 offset:13312
  ds_read_b64_tr_b16 v[118:119], v251 offset:13440
  ds_read_b64_tr_b16 v[120:121], v251 offset:14336
  ds_read_b64_tr_b16 v[122:123], v251 offset:14464
  ds_read_b64_tr_b16 v[124:125], v251 offset:15360
  ds_read_b64_tr_b16 v[126:127], v251 offset:15488
  s_waitcnt lgkmcnt(0)
  s_mov_b32 s12, s52
  s_mov_b32 s13, s53
  s_mov_b32 s14, 0x700000
  s_mov_b32 s15, 0x00020000
  s_mul_i32 s20, s25, 3670016
  s_lshl_b32 s31, s24, 5
  s_add_u32 s20, s20, s31
  s_lshl_b32 s31, s18, 2
  s_mov_b32 s23, s31
  s_mov_b32 s21, 16
.g2_kernel_gl27:
  s_and_b32 s30, s21, 3
  s_cbranch_scc1 .g2_kernel_gl27m
  s_call_b64 s[26:27], .g2_kernel_v_may
.g2_kernel_gl27m:
  s_and_b32 s23, s23, 15
  s_lshl_b32 s30, s23, 10
  s_add_u32 s30, s30, 0
  s_add_u32 m0, s30, s22
  s_mul_i32 s30, s23, 229376
  s_add_u32 s30, s30, s20
  buffer_load_dwordx4 v250, s[12:15], s30 offen lds
  s_add_u32 s23, s23, 1
  s_sub_u32 s21, s21, 1
  s_sleep 3
  s_waitcnt vmcnt(2)
  s_cmp_lg_u32 s21, 0
  s_cbranch_scc1 .g2_kernel_gl27
  s_waitcnt vmcnt(0)
  ds_read_b64_tr_b16 v[128:129], v251 offset:0
  ds_read_b64_tr_b16 v[130:131], v251 offset:128
  ds_read_b64_tr_b16 v[132:133], v251 offset:1024
  ds_read_b64_tr_b16 v[134:135], v251 offset:1152
  ds_read_b64_tr_b16 v[136:137], v251 offset:2048
  ds_read_b64_tr_b16 v[138:139], v251 offset:2176
  ds_read_b64_tr_b16 v[140:141], v251 offset:3072
  ds_read_b64_tr_b16 v[142:143], v251 offset:3200
  ds_read_b64_tr_b16 v[144:145], v251 offset:4096
  ds_read_b64_tr_b16 v[146:147], v251 offset:4224
  ds_read_b64_tr_b16 v[148:149], v251 offset:5120
  ds_read_b64_tr_b16 v[150:151], v251 offset:5248
  ds_read_b64_tr_b16 v[152:153], v251 offset:6144
  ds_read_b64_tr_b16 v[154:155], v251 offset:6272
  ds_read_b64_tr_b16 v[156:157], v251 offset:7168
  ds_read_b64_tr_b16 v[158:159], v251 offset:7296
  ds_read_b64_tr_b16 v[160:161], v251 offset:8192
  ds_read_b64_tr_b16 v[162:163], v251 offset:8320
  ds_read_b64_tr_b16 v[164:165], v251 offset:9216
  ds_read_b64_tr_b16 v[166:167], v251 offset:9344
  ds_read_b64_tr_b16 v[168:169], v251 offset:10240
  ds_read_b64_tr_b16 v[170:171], v251 offset:10368
  ds_read_b64_tr_b16 v[172:173], v251 offset:11264
  ds_read_b64_tr_b16 v[174:175], v251 offset:11392
  ds_read_b64_tr_b16 v[176:177], v251 offset:12288
  ds_read_b64_tr_b16 v[178:179], v251 offset:12416
  ds_read_b64_tr_b16 v[180:181], v251 offset:13312
  ds_read_b64_tr_b16 v[182:183], v251 offset:13440
  ds_read_b64_tr_b16 v[184:185], v251 offset:14336
  ds_read_b64_tr_b16 v[186:187], v251 offset:14464
  ds_read_b64_tr_b16 v[188:189], v251 offset:15360
  ds_read_b64_tr_b16 v[190:191], v251 offset:15488
  s_waitcnt lgkmcnt(0)
  s_mov_b32 s12, s54
  s_mov_b32 s13, s55
  s_mov_b32 s14, 0x700000
  s_mov_b32 s15, 0x00020000
  s_lshl_b32 s20, s24, 15
  s_lshl_b32 s31, s25, 10
  s_add_u32 s20, s20, s31
  s_mov_b32 s23, 0
  s_mov_b32 s21, 16
.g2_kernel_gl28:
  s_and_b32 s30, s21, 3
  s_cbranch_scc1 .g2_kernel_gl28m
  s_call_b64 s[26:27], .g2_kernel_v_may
.g2_kernel_gl28m:
  s_and_b32 s23, s23, 15
  s_lshl_b32 s30, s23, 10
  s_add_u32 s30, s30, 0
  s_add_u32 m0, s30, s22
  s_mul_i32 s30, s23, 2048
  s_add_u32 s30, s30, s20
  buffer_load_dwordx4 v3, s[12:15], s30 offen lds
  s_add_u32 s23, s23, 1
  s_sub_u32 s21, s21, 1
  s_sleep 2
  s_waitcnt vmcnt(2)
  s_cmp_lg_u32 s21, 0
  s_cbranch_scc1 .g2_kernel_gl28
  v_mov_b32 v11, v252
  s_waitcnt vmcnt(0)
  ds_read_b64_tr_b16 v[192:193], v11 offset:0
  ds_read_b64_tr_b16 v[194:195], v11 offset:4096
  ds_read_b64_tr_b16 v[196:197], v11 offset:32
  ds_read_b64_tr_b16 v[198:199], v11 offset:4128
  ds_read_b64_tr_b16 v[200:201], v11 offset:64
  ds_read_b64_tr_b16 v[202:203], v11 offset:4160
  ds_read_b64_tr_b16 v[204:205], v11 offset:96
  ds_read_b64_tr_b16 v[206:207], v11 offset:4192
  ds_read_b64_tr_b16 v[208:209], v11 offset:256
  ds_read_b64_tr_b16 v[210:211], v11 offset:4352
  ds_read_b64_tr_b16 v[212:213], v11 offset:288
  ds_read_b64_tr_b16 v[214:215], v11 offset:4384
  ds_read_b64_tr_b16 v[216:217], v11 offset:320
  ds_read_b64_tr_b16 v[218:219], v11 offset:4416
  ds_read_b64_tr_b16 v[220:221], v11 offset:352
  ds_read_b64_tr_b16 v[222:223], v11 offset:4448
  ds_read_b64_tr_b16 v[224:225], v11 offset:512
  ds_read_b64_tr_b16 v[226:227], v11 offset:4608
  ds_read_b64_tr_b16 v[228:229], v11 offset:544
  ds_read_b64_tr_b16 v[230:231], v11 offset:4640
  ds_read_b64_tr_b16 v[232:233], v11 offset:576
  ds_read_b64_tr_b16 v[234:235], v11 offset:4672
  ds_read_b64_tr_b16 v[236:237], v11 offset:608
  ds_read_b64_tr_b16 v[238:239], v11 offset:4704
  ds_read_b64_tr_b16 v[240:241], v11 offset:768
  ds_read_b64_tr_b16 v[242:243], v11 offset:4864
  ds_read_b64_tr_b16 v[244:245], v11 offset:800
  ds_read_b64_tr_b16 v[246:247], v11 offset:4896
  ds_read_b64_tr_b16 v[248:249], v11 offset:832
  ds_read_b64_tr_b16 v[250:251], v11 offset:4928
  ds_read_b64_tr_b16 v[252:253], v11 offset:864
  ds_read_b64_tr_b16 v[254:255], v11 offset:4960
  s_waitcnt lgkmcnt(0)
  s_branch .g2_kernel_g_e
.g2_kernel_g_p:
  s_mov_b32 s12, s42
  s_mov_b32 s13, s43
  s_mov_b32 s14, 0x600000
  s_mov_b32 s15, 0x00020000
  v_mul_u32_u24 v6, 6144, v9
  v_and_b32 v7, 15, v2
  v_lshl_add_u32 v250, v7, 4, v6
  v_lshl_add_u32 v11, v8, 2, v9
  v_lshl_add_u32 v251, v11, 9, v10
  s_lshl_b32 s20, s17, 3
  s_and_b32 s31, s18, 1
  s_add_u32 s20, s20, s31
  s_mul_i32 s20, s20, 49152
  s_and_b32 s31, s18, 14
  s_lshl_b32 s31, s31, 7
  s_add_u32 s20, s20, s31
  s_mov_b32 s23, 0
  s_mov_b32 s21, 8
.g2_kernel_gl29:
  s_and_b32 s30, s21, 3
  s_cbranch_scc1 .g2_kernel_gl29m
  s_call_b64 s[26:27], .g2_kernel_v_may
.g2_kernel_gl29m:
  s_and_b32 s23, s23, 7
  s_lshl_b32 s30, s23, 10
  s_add_u32 s30, s30, 0
  s_add_u32 m0, s30, s22
  s_mul_i32 s30, s23, 49152
  s_add_u32 s30, s30, s20
  s_and_b32 s31, s23, 1
  s_mul_i32 s31, s31, -24576
  s_add_u32 s30, s30, s31
  buffer_load_dwordx4 v250, s[12:15], s30 offen lds
  s_add_u32 s23, s23, 1
  s_sub_u32 s21, s21, 1
  s_sleep 2
  s_waitcnt vmcnt(2)
  s_cmp_lg_u32 s21, 0
  s_cbranch_scc1 .g2_kernel_gl29
  s_add_u32 s20, s20, 2048
  s_mov_b32 s23, 0
  s_mov_b32 s21, 8
.g2_kernel_gl30:
  s_and_b32 s30, s21, 3
  s_cbranch_scc1 .g2_kernel_gl30m
  s_call_b64 s[26:27], .g2_kernel_v_may
.g2_kernel_gl30m:
  s_and_b32 s23, s23, 7
  s_lshl_b32 s30, s23, 10
  s_add_u32 s30, s30, 8192
  s_add_u32 m0, s30, s22
  s_mul_i32 s30, s23, 49152
  s_add_u32 s30, s30, s20
  s_and_b32 s31, s23, 1
  s_mul_i32 s31, s31, -24576
  s_add_u32 s30, s30, s31
  buffer_load_dwordx4 v250, s[12:15], s30 offen lds
  s_add_u32 s23, s23, 1
  s_sub_u32 s21, s21, 1
  s_sleep 2
  s_waitcnt vmcnt(2)
  s_cmp_lg_u32 s21, 0
  s_cbranch_scc1 .g2_kernel_gl30
  s_add_u32 s20, s20, 2048
  s_waitcnt vmcnt(0)
  ds_read_b64_tr_b16 v[64:65], v251 offset:0
  ds_read_b64_tr_b16 v[66:67], v251 offset:256
  ds_read_b64_tr_b16 v[68:69], v251 offset:32
  ds_read_b64_tr_b16 v[70:71], v251 offset:288
  ds_read_b64_tr_b16 v[72:73], v251 offset:64
  ds_read_b64_tr_b16 v[74:75], v251 offset:320
  ds_read_b64_tr_b16 v[76:77], v251 offset:96
  ds_read_b64_tr_b16 v[78:79], v251 offset:352
  ds_read_b64_tr_b16 v[80:81], v251 offset:128
  ds_read_b64_tr_b16 v[82:83], v251 offset:384
  ds_read_b64_tr_b16 v[84:85], v251 offset:160
  ds_read_b64_tr_b16 v[86:87], v251 offset:416
  ds_read_b64_tr_b16 v[88:89], v251 offset:192
  ds_read_b64_tr_b16 v[90:91], v251 offset:448
  ds_read_b64_tr_b16 v[92:93], v251 offset:224
  ds_read_b64_tr_b16 v[94:95], v251 offset:480
  ds_read_b64_tr_b16 v[96:97], v251 offset:8192
  ds_read_b64_tr_b16 v[98:99], v251 offset:8448
  ds_read_b64_tr_b16 v[100:101], v251 offset:8224
  ds_read_b64_tr_b16 v[102:103], v251 offset:8480
  ds_read_b64_tr_b16 v[104:105], v251 offset:8256
  ds_read_b64_tr_b16 v[106:107], v251 offset:8512
  ds_read_b64_tr_b16 v[108:109], v251 offset:8288
  ds_read_b64_tr_b16 v[110:111], v251 offset:8544
  ds_read_b64_tr_b16 v[112:113], v251 offset:8320
  ds_read_b64_tr_b16 v[114:115], v251 offset:8576
  ds_read_b64_tr_b16 v[116:117], v251 offset:8352
  ds_read_b64_tr_b16 v[118:119], v251 offset:8608
  ds_read_b64_tr_b16 v[120:121], v251 offset:8384
  ds_read_b64_tr_b16 v[122:123], v251 offset:8640
  ds_read_b64_tr_b16 v[124:125], v251 offset:8416
  ds_read_b64_tr_b16 v[126:127], v251 offset:8672
  s_waitcnt lgkmcnt(0)
  s_mov_b32 s23, 0
  s_mov_b32 s21, 8
.g2_kernel_gl31:
  s_and_b32 s30, s21, 3
  s_cbranch_scc1 .g2_kernel_gl31m
  s_call_b64 s[26:27], .g2_kernel_v_may
.g2_kernel_gl31m:
  s_and_b32 s23, s23, 7
  s_lshl_b32 s30, s23, 10
  s_add_u32 s30, s30, 0
  s_add_u32 m0, s30, s22
  s_mul_i32 s30, s23, 49152
  s_add_u32 s30, s30, s20
  s_and_b32 s31, s23, 1
  s_mul_i32 s31, s31, -24576
  s_add_u32 s30, s30, s31
  buffer_load_dwordx4 v250, s[12:15], s30 offen lds
  s_add_u32 s23, s23, 1
  s_sub_u32 s21, s21, 1
  s_sleep 2
  s_waitcnt vmcnt(2)
  s_cmp_lg_u32 s21, 0
  s_cbranch_scc1 .g2_kernel_gl31
  s_add_u32 s20, s20, 2048
  s_waitcnt vmcnt(0)
  ds_read_b64_tr_b16 v[128:129], v251 offset:0
  ds_read_b64_tr_b16 v[130:131], v251 offset:256
  ds_read_b64_tr_b16 v[132:133], v251 offset:32
  ds_read_b64_tr_b16 v[134:135], v251 offset:288
  ds_read_b64_tr_b16 v[136:137], v251 offset:64
  ds_read_b64_tr_b16 v[138:139], v251 offset:320
  ds_read_b64_tr_b16 v[140:141], v251 offset:96
  ds_read_b64_tr_b16 v[142:143], v251 offset:352
  ds_read_b64_tr_b16 v[144:145], v251 offset:128
  ds_read_b64_tr_b16 v[146:147], v251 offset:384
  ds_read_b64_tr_b16 v[148:149], v251 offset:160
  ds_read_b64_tr_b16 v[150:151], v251 offset:416
  ds_read_b64_tr_b16 v[152:153], v251 offset:192
  ds_read_b64_tr_b16 v[154:155], v251 offset:448
  ds_read_b64_tr_b16 v[156:157], v251 offset:224
  ds_read_b64_tr_b16 v[158:159], v251 offset:480
  s_waitcnt lgkmcnt(0)
.g2_kernel_g_e:
  s_cmp_lt_u32 s16, 6
  s_cbranch_scc1 .g2_kernel_v_3
  v_mov_b32 v6, s71
  s_mov_b64 exec, 1
  ds_add_u32 v6, v5 offset:116
  s_mov_b64 exec, -1
  s_branch .g2_kernel_v_3c
.g2_kernel_v_3:
  s_mov_b32 s29, 0
  s_and_b32 s32, s16, 3
  s_lshl_b32 s30, s32, 14
  s_add_u32 s30, s30, 65536
  s_call_b64 s[68:69], .g2_kernel_v_wo
  s_cmp_lg_u32 s16, 4
  s_cbranch_scc1 .g2_kernel_v_3d
  s_mov_b32 s32, 2
  s_mov_b32 s30, 98304
  s_call_b64 s[68:69], .g2_kernel_v_wo
  s_mov_b32 s32, 3
  s_mov_b32 s30, 114688
  s_call_b64 s[68:69], .g2_kernel_v_wo
.g2_kernel_v_3d:
  s_waitcnt vmcnt(0)
  v_mov_b32 v8, 2
  v_mov_b32 v6, s71
  s_mov_b64 exec, 1
  ds_add_u32 v6, v8 offset:52
  s_mov_b64 exec, -1
.g2_kernel_v_3c:
  s_cmp_lg_u32 s39, 0
  s_cbranch_scc1 .g2_kernel_v_3b
  s_call_b64 s[26:27], .g2_kernel_v_do
.g2_kernel_v_3b:
  s_cmp_lg_u32 s16, 4
  s_cbranch_scc1 .g2_kernel_v_4
  v_mov_b32 v6, s71
  s_mov_b32 s38, 0
.g2_kernel_wg32:
  ds_read_b32 v7, v6 offset:8
  s_add_u32 s38, s38, 1
  s_waitcnt lgkmcnt(0)
  v_cmp_gt_u32 vcc, 10, v7
  s_cbranch_vccz .g2_kernel_wg32d
  s_sleep 8
  s_cmp_lt_u32 s38, 524288
  s_cbranch_scc1 .g2_kernel_wg32
.g2_kernel_wg32d:
  s_mov_b32 s29, 1
  s_mov_b32 s32, 0
  s_mov_b32 s30, 139264
  s_call_b64 s[68:69], .g2_kernel_v_wo
  s_add_u32 s31, s31, 81920
  s_sleep 6
  s_waitcnt vmcnt(4)
  buffer_load_dwordx4 v[64:67], v6, s[8:11], s31 offen
  s_add_u32 s31, s31, 16384
  buffer_load_dwordx4 v[68:71], v6, s[8:11], s31 offen
  s_add_u32 s31, s31, 16384
  buffer_load_dwordx4 v[72:75], v6, s[8:11], s31 offen
  s_add_u32 s31, s31, 16384
  buffer_load_dwordx4 v[76:79], v6, s[8:11], s31 offen
  s_add_u32 s31, s31, 81920
  s_sleep 6
  s_waitcnt vmcnt(4)
  buffer_load_dwordx4 v[80:83], v6, s[8:11], s31 offen
  s_add_u32 s31, s31, 16384
  buffer_load_dwordx4 v[84:87], v6, s[8:11], s31 offen
  s_add_u32 s31, s31, 16384
  buffer_load_dwordx4 v[88:91], v6, s[8:11], s31 offen
  s_add_u32 s31, s31, 16384
  buffer_load_dwordx4 v[92:95], v6, s[8:11], s31 offen
  s_add_u32 s31, s31, 81920
  s_sleep 6
  s_waitcnt vmcnt(4)
  buffer_load_dwordx4 v[96:99], v6, s[8:11], s31 offen
  s_add_u32 s31, s31, 16384
  buffer_load_dwordx4 v[100:103], v6, s[8:11], s31 offen
  s_add_u32 s31, s31, 16384
  buffer_load_dwordx4 v[104:107], v6, s[8:11], s31 offen
  s_add_u32 s31, s31, 16384
  buffer_load_dwordx4 v[108:111], v6, s[8:11], s31 offen
  s_add_u32 s31, s31, 81920
  s_sleep 6
  s_waitcnt vmcnt(4)
  buffer_load_dwordx4 v[112:115], v6, s[8:11], s31 offen
  s_add_u32 s31, s31, 16384
  buffer_load_dwordx4 v[116:119], v6, s[8:11], s31 offen
  s_add_u32 s31, s31, 16384
  buffer_load_dwordx4 v[120:123], v6, s[8:11], s31 offen
  s_add_u32 s31, s31, 16384
  buffer_load_dwordx4 v[124:127], v6, s[8:11], s31 offen
  s_add_u32 s31, s31, 81920
  s_sleep 6
  s_waitcnt vmcnt(4)
  buffer_load_dwordx4 v[128:131], v6, s[8:11], s31 offen
  s_add_u32 s31, s31, 16384
  buffer_load_dwordx4 v[132:135], v6, s[8:11], s31 offen
  s_add_u32 s31, s31, 16384
  buffer_load_dwordx4 v[136:139], v6, s[8:11], s31 offen
  s_add_u32 s31, s31, 16384
  buffer_load_dwordx4 v[140:143], v6, s[8:11], s31 offen
  s_add_u32 s31, s31, 81920
  s_sleep 6
  s_waitcnt vmcnt(4)
  buffer_load_dwordx4 v[144:147], v6, s[8:11], s31 offen
  s_add_u32 s31, s31, 16384
  buffer_load_dwordx4 v[148:151], v6, s[8:11], s31 offen
  s_add_u32 s31, s31, 16384
  buffer_load_dwordx4 v[152:155], v6, s[8:11], s31 offen
  s_add_u32 s31, s31, 16384
  buffer_load_dwordx4 v[156:159], v6, s[8:11], s31 offen
  s_add_u32 s31, s31, 81920
  s_sleep 6
  s_waitcnt vmcnt(4)
  buffer_load_dwordx4 v[160:163], v6, s[8:11], s31 offen
  s_add_u32 s31, s31, 16384
  buffer_load_dwordx4 v[164:167], v6, s[8:11], s31 offen
  s_add_u32 s31, s31, 16384
  buffer_load_dwordx4 v[168:171], v6, s[8:11], s31 offen
  s_add_u32 s31, s31, 16384
  buffer_load_dwordx4 v[172:175], v6, s[8:11], s31 offen
  s_add_u32 s31, s31, 81920
  s_sleep 6
  s_waitcnt vmcnt(4)
  buffer_load_dwordx4 v[176:179], v6, s[8:11], s31 offen
  s_add_u32 s31, s31, 16384
  buffer_load_dwordx4 v[180:183], v6, s[8:11], s31 offen
  s_add_u32 s31, s31, 16384
  buffer_load_dwordx4 v[184:187], v6, s[8:11], s31 offen
  s_add_u32 s31, s31, 16384
  buffer_load_dwordx4 v[188:191], v6, s[8:11], s31 offen
  s_add_u32 s31, s31, 81920
  s_sleep 6
  s_waitcnt vmcnt(4)
  buffer_load_dwordx4 v[192:195], v6, s[8:11], s31 offen
  s_add_u32 s31, s31, 16384
  buffer_load_dwordx4 v[196:199], v6, s[8:11], s31 offen
  s_add_u32 s31, s31, 16384
  buffer_load_dwordx4 v[200:203], v6, s[8:11], s31 offen
  s_add_u32 s31, s31, 16384
  buffer_load_dwordx4 v[204:207], v6, s[8:11], s31 offen
  s_add_u32 s31, s31, 81920
  s_sleep 6
  s_waitcnt vmcnt(4)
  buffer_load_dwordx4 v[208:211], v6, s[8:11], s31 offen
  s_add_u32 s31, s31, 16384
  buffer_load_dwordx4 v[212:215], v6, s[8:11], s31 offen
  s_add_u32 s31, s31, 16384
  buffer_load_dwordx4 v[216:219], v6, s[8:11], s31 offen
  s_add_u32 s31, s31, 16384
  buffer_load_dwordx4 v[220:223], v6, s[8:11], s31 offen
  s_add_u32 s31, s31, 81920
  s_sleep 6
  s_waitcnt vmcnt(4)
  buffer_load_dwordx4 v[224:227], v6, s[8:11], s31 offen
  s_add_u32 s31, s31, 16384
  buffer_load_dwordx4 v[228:231], v6, s[8:11], s31 offen
  s_add_u32 s31, s31, 16384
  buffer_load_dwordx4 v[232:235], v6, s[8:11], s31 offen
  s_add_u32 s31, s31, 16384
  buffer_load_dwordx4 v[236:239], v6, s[8:11], s31 offen
  s_add_u32 s31, s31, 81920
  s_sleep 6
  s_waitcnt vmcnt(4)
  buffer_load_dwordx4 v[240:243], v6, s[8:11], s31 offen
  s_add_u32 s31, s31, 16384
  buffer_load_dwordx4 v[244:247], v6, s[8:11], s31 offen
  s_add_u32 s31, s31, 16384
  buffer_load_dwordx4 v[248:251], v6, s[8:11], s31 offen
  s_add_u32 s31, s31, 16384
  buffer_load_dwordx4 v[252:255], v6, s[8:11], s31 offen
  s_cmp_eq_u32 s62, 0
  s_cbranch_scc1 .g2_kernel_v_4
  v_mov_b32 v8, s71
  s_mov_b32 s38, 0
.g2_kernel_wg33:
  ds_read_b32 v9, v8 offset:116
  s_add_u32 s38, s38, 1
  s_waitcnt lgkmcnt(0)
  v_cmp_gt_u32 vcc, 2, v9
  s_cbranch_vccz .g2_kernel_wg33d
  s_sleep 4
  s_cmp_lt_u32 s38, 524288
  s_cbranch_scc1 .g2_kernel_wg33
.g2_kernel_wg33d:
  s_waitcnt vmcnt(0)
  s_call_b64 s[68:69], .g2_kernel_v_w23
.g2_kernel_v_4:
  s_cmp_lg_u32 s16, 5
  s_cbranch_scc1 .g2_kernel_v_5
  s_sleep 48
  s_and_b32 s31, s19, 0xffffe000
  s_add_u32 s31, s31, 0
  v_and_b32 v6, 15, v2
  v_lshlrev_b32 v6, 9, v6
  v_lshrrev_b32 v7, 4, v2
  v_lshl_add_u32 v6, v7, 7, v6
  v_lshlrev_b32 v7, 2, v2
  v_add_u32 v7, 157696, v7
  s_mov_b32 m0, 157696
  s_mov_b32 s38, 0
.g2_kernel_pa34:
  buffer_load_dword v6, s[4:7], s31 offen sc1 lds
  s_add_u32 s38, s38, 1
  s_waitcnt vmcnt(0)
  ds_read_b32 v8, v7
  s_waitcnt lgkmcnt(0)
  v_cmp_ge_u32 vcc, s62, v8
  s_cbranch_vccz .g2_kernel_pa34d
  s_mov_b64 exec, vcc
  s_sleep 32
  s_cmp_lt_u32 s38, 131072
  s_cbranch_scc1 .g2_kernel_pa34
.g2_kernel_pa34d:
  s_mov_b64 exec, -1
  v_lshlrev_b32 v6, 7, v2
  s_lshl_b32 s30, s17, 2
  s_and_b32 s31, s18, 3
  s_add_u32 s30, s30, s31
  s_lshl_b32 s30, s30, 16
  s_add_u32 s30, s30, s63
  s_add_u32 s30, s30, 0x800000
  s_sleep 8
  buffer_load_dword v1, v6, s[4:7], s30 offen
  s_add_u32 s30, s30, 8192
  s_sleep 8
  buffer_load_dword v1, v6, s[4:7], s30 offen
  s_add_u32 s30, s30, 8192
  s_sleep 8
  buffer_load_dword v1, v6, s[4:7], s30 offen
  s_add_u32 s30, s30, 8192
  s_sleep 8
  buffer_load_dword v1, v6, s[4:7], s30 offen
  s_add_u32 s30, s30, 8192
  s_lshl_b32 s28, s2, 10
  s_and_b32 s28, s28, 0xe000
  v_lshlrev_b32 v7, 7, v2
  buffer_load_dword v1, v7, s[64:67], s28 offen
.g2_kernel_v_5:
  s_mov_b32 s29, 1
  s_call_b64 s[68:69], .g2_kernel_v_cmb
  s_cmp_lg_u32 s16, 7
  s_cbranch_scc1 .g2_kernel_v_7
  s_and_b32 s33, s16, 3
  s_lshl_b32 s33, s33, 7
  s_lshl_b32 s28, s29, 2
  s_add_u32 s33, s33, s28
  s_add_u32 s31, s19, s33
  v_mov_b32 v6, s70
  s_mov_b64 exec, 1
  buffer_store_dword v6, v4, s[4:7], s31 offen offset:0 sc1
  s_mov_b64 exec, -1
.g2_kernel_v_7:
  s_cmp_lg_u32 s16, 4
  s_cbranch_scc1 .g2_kernel_v_8
  s_waitcnt vmcnt(2)
  v_mov_b32 v6, s71
  s_mov_b32 s38, 0
.g2_kernel_wg35:
  ds_read_b32 v7, v6 offset:76
  s_add_u32 s38, s38, 1
  s_waitcnt lgkmcnt(0)
  v_cmp_gt_u32 vcc, 1, v7
  s_cbranch_vccz .g2_kernel_wg35d
  s_sleep 1
  s_cmp_lt_u32 s38, 524288
  s_cbranch_scc1 .g2_kernel_wg35
.g2_kernel_wg35d:
  v_mov_b32 v6, s71
  s_mov_b32 s38, 0
.g2_kernel_wg36:
  ds_read_b32 v7, v6 offset:72
  s_add_u32 s38, s38, 1
  s_waitcnt lgkmcnt(0)
  v_cmp_gt_u32 vcc, 1, v7
  s_cbranch_vccz .g2_kernel_wg36d
  s_sleep 1
  s_cmp_lt_u32 s38, 524288
  s_cbranch_scc1 .g2_kernel_wg36
.g2_kernel_wg36d:
  v_mov_b32 v6, s71
  s_mov_b32 s38, 0
.g2_kernel_wg37:
  ds_read_b32 v7, v6 offset:68
  s_add_u32 s38, s38, 1
  s_waitcnt lgkmcnt(0)
  v_cmp_gt_u32 vcc, 1, v7
  s_cbranch_vccz .g2_kernel_wg37d
  s_sleep 1
  s_cmp_lt_u32 s38, 524288
  s_cbranch_scc1 .g2_kernel_wg37
.g2_kernel_wg37d:
  ds_write_b128 v3, v[64:67] offset:16384
  ds_write_b128 v3, v[68:71] offset:17408
  ds_write_b128 v3, v[72:75] offset:18432
  ds_write_b128 v3, v[76:79] offset:19456
  ds_write_b128 v3, v[80:83] offset:20480
  ds_write_b128 v3, v[84:87] offset:21504
  ds_write_b128 v3, v[88:91] offset:22528
  ds_write_b128 v3, v[92:95] offset:23552
  ds_write_b128 v3, v[96:99] offset:24576
  ds_write_b128 v3, v[100:103] offset:25600
  ds_write_b128 v3, v[104:107] offset:26624
  ds_write_b128 v3, v[108:111] offset:27648
  ds_write_b128 v3, v[112:115] offset:28672
  ds_write_b128 v3, v[116:119] offset:29696
  ds_write_b128 v3, v[120:123] offset:30720
  ds_write_b128 v3, v[124:127] offset:31744
  s_cmp_lg_u32 s62, 0
  s_cbranch_scc1 .g2_kernel_v_9
  s_call_b64 s[68:69], .g2_kernel_v_w23
.g2_kernel_v_9:
  v_mov_b32 v8, 4
  ds_write_b32 v6, v8 offset:12
.g2_kernel_v_8:
  s_cmp_eq_u32 s16, 5
  s_cbranch_scc1 .g2_kernel_c1
  s_cmp_lg_u32 s16, 4
  s_cbranch_scc1 .g2_kernel_c2
  s_cmp_lg_u32 s62, 0
  s_cbranch_scc1 .g2_kernel_fin1
  s_setprio 3
  s_mov_b32 s12, s42
  s_mov_b32 s13, s43
  s_mov_b32 s14, 0x600000
  s_mov_b32 s15, 0x00020000
  v_lshrrev_b32 v28, 3, v2
  v_and_b32 v29, 7, v2
  v_bfe_u32 v30, v2, 4, 1
  v_lshlrev_b32 v30, 1, v30
  v_xor_b32 v31, v29, v30
  v_lshlrev_b32 v31, 4, v31
  v_mul_u32_u24 v28, 6144, v28
  v_add_u32 v28, v28, v31
  v_xor_b32 v29, 64, v28
  v_lshlrev_b32 v9, 2, v2
  v_and_b32 v9, 12, v9
  v_add_u32 v9, 156416, v9
  v_add_u32 v48, 0, v28
  v_add_u32 v49, 48128, v29
  v_add_u32 v50, 96256, v28
  v_add_u32 v51, 144384, v29
  v_add_u32 v52, 2048, v28
  v_add_u32 v53, 50176, v29
  v_add_u32 v54, 98304, v28
  v_add_u32 v55, 146432, v29
  v_add_u32 v56, 4096, v29
  v_add_u32 v57, 52224, v28
  v_add_u32 v58, 100352, v29
  v_add_u32 v59, 148480, v28
  v_and_b32 v11, 15, v2
  v_xor_b32 v11, s18, v11
  v_and_b32 v12, 48, v2
  v_add_u32 v11, v11, v12
  v_lshlrev_b32 v11, 2, v11
  v_add_u32 v11, 158208, v11
  s_lshl_b32 s39, s18, 7
  s_lshl_b32 s32, s17, 18
  s_add_u32 s32, s32, 0xc00000
  s_mov_b32 s30, 0
  s_mov_b32 s29, 0
  s_mov_b32 s37, 0
  v_mov_b32 v6, s71
  s_mov_b32 s38, 0
.g2_kernel_wg38:
  ds_read_b32 v7, v6 offset:16
  s_add_u32 s38, s38, 1
  s_waitcnt lgkmcnt(0)
  v_cmp_gt_u32 vcc, 4, v7
  s_cbranch_vccz .g2_kernel_wg38d
  s_sleep 2
  s_cmp_lt_u32 s38, 524288
  s_cbranch_scc1 .g2_kernel_wg38
.g2_kernel_wg38d:
  s_xor_b32 s36, s18, 0
  s_mul_i32 s36, s36, 393216
  s_add_u32 s36, s36, s39
  s_add_u32 m0, s30, 65536
  s_waitcnt vmcnt(63)
  buffer_load_dwordx4 v48, s[12:15], s36 offen offset:0 lds
  buffer_load_dwordx4 v49, s[12:15], s36 offen offset:1024 lds
  buffer_load_dwordx4 v50, s[12:15], s36 offen offset:2048 lds
  buffer_load_dwordx4 v51, s[12:15], s36 offen offset:3072 lds
  s_add_u32 m0, s30, 69632
  s_waitcnt vmcnt(63)
  buffer_load_dwordx4 v52, s[12:15], s36 offen offset:0 lds
  buffer_load_dwordx4 v53, s[12:15], s36 offen offset:1024 lds
  buffer_load_dwordx4 v54, s[12:15], s36 offen offset:2048 lds
  buffer_load_dwordx4 v55, s[12:15], s36 offen offset:3072 lds
  s_add_u32 m0, s30, 73728
  s_waitcnt vmcnt(63)
  buffer_load_dwordx4 v56, s[12:15], s36 offen offset:0 lds
  buffer_load_dwordx4 v57, s[12:15], s36 offen offset:1024 lds
  buffer_load_dwordx4 v58, s[12:15], s36 offen offset:2048 lds
  buffer_load_dwordx4 v59, s[12:15], s36 offen offset:3072 lds
  s_add_u32 s30, s30, 12288
  s_cmp_eq_u32 s30, 86016
  s_cselect_b32 s30, 0, s30
  s_xor_b32 s36, s18, 0
  s_mul_i32 s36, s36, 393216
  s_add_u32 s36, s36, s39
  s_add_u32 s36, s36, 196608
  s_add_u32 m0, s30, 65536
  s_waitcnt vmcnt(63)
  buffer_load_dwordx4 v48, s[12:15], s36 offen offset:0 lds
  buffer_load_dwordx4 v49, s[12:15], s36 offen offset:1024 lds
  buffer_load_dwordx4 v50, s[12:15], s36 offen offset:2048 lds
  buffer_load_dwordx4 v51, s[12:15], s36 offen offset:3072 lds
  s_add_u32 m0, s30, 69632
  s_waitcnt vmcnt(63)
  buffer_load_dwordx4 v52, s[12:15], s36 offen offset:0 lds
  buffer_load_dwordx4 v53, s[12:15], s36 offen offset:1024 lds
  buffer_load_dwordx4 v54, s[12:15], s36 offen offset:2048 lds
  buffer_load_dwordx4 v55, s[12:15], s36 offen offset:3072 lds
  s_add_u32 m0, s30, 73728
  s_waitcnt vmcnt(63)
  buffer_load_dwordx4 v56, s[12:15], s36 offen offset:0 lds
  buffer_load_dwordx4 v57, s[12:15], s36 offen offset:1024 lds
  buffer_load_dwordx4 v58, s[12:15], s36 offen offset:2048 lds
  buffer_load_dwordx4 v59, s[12:15], s36 offen offset:3072 lds
  s_add_u32 s30, s30, 12288
  s_cmp_eq_u32 s30, 86016
  s_cselect_b32 s30, 0, s30
  s_mov_b32 m0, 156160
  s_mov_b32 s35, .g2_kernel_tab-.g2_kernel_pc+136
  s_mov_b64 exec, 1
  buffer_load_dword off, s[64:67], s35 lds
  s_mov_b64 exec, -1
  s_xor_b32 s36, s18, 1
  s_mul_i32 s36, s36, 393216
  s_add_u32 s36, s36, s39
  s_add_u32 m0, s30, 65536
  s_waitcnt vmcnt(63)
  buffer_load_dwordx4 v48, s[12:15], s36 offen offset:0 lds
  buffer_load_dwordx4 v49, s[12:15], s36 offen offset:1024 lds
  buffer_load_dwordx4 v50, s[12:15], s36 offen offset:2048 lds
  buffer_load_dwordx4 v51, s[12:15], s36 offen offset:3072 lds
  s_add_u32 m0, s30, 69632
  s_waitcnt vmcnt(63)
  buffer_load_dwordx4 v52, s[12:15], s36 offen offset:0 lds
  buffer_load_dwordx4 v53, s[12:15], s36 offen offset:1024 lds
  buffer_load_dwordx4 v54, s[12:15], s36 offen offset:2048 lds
  buffer_load_dwordx4 v55, s[12:15], s36 offen offset:3072 lds
  s_add_u32 m0, s30, 73728
  s_waitcnt vmcnt(63)
  buffer_load_dwordx4 v56, s[12:15], s36 offen offset:0 lds
  buffer_load_dwordx4 v57, s[12:15], s36 offen offset:1024 lds
  buffer_load_dwordx4 v58, s[12:15], s36 offen offset:2048 lds
  buffer_load_dwordx4 v59, s[12:15], s36 offen offset:3072 lds
  s_add_u32 s30, s30, 12288
  s_cmp_eq_u32 s30, 86016
  s_cselect_b32 s30, 0, s30
  s_xor_b32 s36, s18, 1
  s_mul_i32 s36, s36, 393216
  s_add_u32 s36, s36, s39
  s_add_u32 s36, s36, 196608
  s_add_u32 m0, s30, 65536
  s_waitcnt vmcnt(63)
  buffer_load_dwordx4 v48, s[12:15], s36 offen offset:0 lds
  buffer_load_dwordx4 v49, s[12:15], s36 offen offset:1024 lds
  buffer_load_dwordx4 v50, s[12:15], s36 offen offset:2048 lds
  buffer_load_dwordx4 v51, s[12:15], s36 offen offset:3072 lds
  s_add_u32 m0, s30, 69632
  s_waitcnt vmcnt(63)
  buffer_load_dwordx4 v52, s[12:15], s36 offen offset:0 lds
  buffer_load_dwordx4 v53, s[12:15], s36 offen offset:1024 lds
  buffer_load_dwordx4 v54, s[12:15], s36 offen offset:2048 lds
  buffer_load_dwordx4 v55, s[12:15], s36 offen offset:3072 lds
  s_add_u32 m0, s30, 73728
  s_waitcnt vmcnt(63)
  buffer_load_dwordx4 v56, s[12:15], s36 offen offset:0 lds
  buffer_load_dwordx4 v57, s[12:15], s36 offen offset:1024 lds
  buffer_load_dwordx4 v58, s[12:15], s36 offen offset:2048 lds
  buffer_load_dwordx4 v59, s[12:15], s36 offen offset:3072 lds
  s_add_u32 s30, s30, 12288
  s_cmp_eq_u32 s30, 86016
  s_cselect_b32 s30, 0, s30
  s_xor_b32 s36, s18, 2
  s_mul_i32 s36, s36, 393216
  s_add_u32 s36, s36, s39
  s_add_u32 m0, s30, 65536
  s_waitcnt vmcnt(63)
  buffer_load_dwordx4 v48, s[12:15], s36 offen offset:0 lds
  buffer_load_dwordx4 v49, s[12:15], s36 offen offset:1024 lds
  buffer_load_dwordx4 v50, s[12:15], s36 offen offset:2048 lds
  buffer_load_dwordx4 v51, s[12:15], s36 offen offset:3072 lds
  s_add_u32 m0, s30, 69632
  s_waitcnt vmcnt(63)
  buffer_load_dwordx4 v52, s[12:15], s36 offen offset:0 lds
  buffer_load_dwordx4 v53, s[12:15], s36 offen offset:1024 lds
  buffer_load_dwordx4 v54, s[12:15], s36 offen offset:2048 lds
  buffer_load_dwordx4 v55, s[12:15], s36 offen offset:3072 lds
  s_add_u32 m0, s30, 73728
  s_waitcnt vmcnt(63)
  buffer_load_dwordx4 v56, s[12:15], s36 offen offset:0 lds
  buffer_load_dwordx4 v57, s[12:15], s36 offen offset:1024 lds
  buffer_load_dwordx4 v58, s[12:15], s36 offen offset:2048 lds
  buffer_load_dwordx4 v59, s[12:15], s36 offen offset:3072 lds
  s_add_u32 s30, s30, 12288
  s_cmp_eq_u32 s30, 86016
  s_cselect_b32 s30, 0, s30
  v_mov_b32 v6, s71
  s_mov_b32 s38, 0
.g2_kernel_wg39:
  ds_read_b32 v7, v6 offset:20
  s_add_u32 s38, s38, 1
  s_waitcnt lgkmcnt(0)
  v_cmp_gt_u32 vcc, 4, v7
  s_cbranch_vccz .g2_kernel_wg39d
  s_sleep 1
  s_cmp_lt_u32 s38, 524288
  s_cbranch_scc1 .g2_kernel_wg39
.g2_kernel_wg39d:
  s_mov_b32 s62, 1
  s_mov_b32 s63, 0x1800000
  s_mov_b32 s70, 2
  s_mov_b32 s71, 155776
  s_xor_b32 s36, s18, 2
  s_mul_i32 s36, s36, 393216
  s_add_u32 s36, s36, s39
  s_add_u32 s36, s36, 196608
  s_add_u32 m0, s30, 65536
  s_waitcnt vmcnt(63)
  buffer_load_dwordx4 v48, s[12:15], s36 offen offset:0 lds
  buffer_load_dwordx4 v49, s[12:15], s36 offen offset:1024 lds
  buffer_load_dwordx4 v50, s[12:15], s36 offen offset:2048 lds
  buffer_load_dwordx4 v51, s[12:15], s36 offen offset:3072 lds
  s_add_u32 m0, s30, 69632
  s_waitcnt vmcnt(63)
  buffer_load_dwordx4 v52, s[12:15], s36 offen offset:0 lds
  buffer_load_dwordx4 v53, s[12:15], s36 offen offset:1024 lds
  buffer_load_dwordx4 v54, s[12:15], s36 offen offset:2048 lds
  buffer_load_dwordx4 v55, s[12:15], s36 offen offset:3072 lds
  s_add_u32 m0, s30, 73728
  s_waitcnt vmcnt(63)
  buffer_load_dwordx4 v56, s[12:15], s36 offen offset:0 lds
  buffer_load_dwordx4 v57, s[12:15], s36 offen offset:1024 lds
  buffer_load_dwordx4 v58, s[12:15], s36 offen offset:2048 lds
  buffer_load_dwordx4 v59, s[12:15], s36 offen offset:3072 lds
  s_add_u32 s30, s30, 12288
  s_cmp_eq_u32 s30, 86016
  s_cselect_b32 s30, 0, s30
  s_xor_b32 s36, s18, 3
  s_mul_i32 s36, s36, 393216
  s_add_u32 s36, s36, s39
  s_add_u32 m0, s30, 65536
  s_waitcnt vmcnt(63)
  buffer_load_dwordx4 v48, s[12:15], s36 offen offset:0 lds
  buffer_load_dwordx4 v49, s[12:15], s36 offen offset:1024 lds
  buffer_load_dwordx4 v50, s[12:15], s36 offen offset:2048 lds
  buffer_load_dwordx4 v51, s[12:15], s36 offen offset:3072 lds
  s_add_u32 m0, s30, 69632
  s_waitcnt vmcnt(63)
  buffer_load_dwordx4 v52, s[12:15], s36 offen offset:0 lds
  buffer_load_dwordx4 v53, s[12:15], s36 offen offset:1024 lds
  buffer_load_dwordx4 v54, s[12:15], s36 offen offset:2048 lds
  buffer_load_dwordx4 v55, s[12:15], s36 offen offset:3072 lds
  s_add_u32 m0, s30, 73728
  s_waitcnt vmcnt(63)
  buffer_load_dwordx4 v56, s[12:15], s36 offen offset:0 lds
  buffer_load_dwordx4 v57, s[12:15], s36 offen offset:1024 lds
  buffer_load_dwordx4 v58, s[12:15], s36 offen offset:2048 lds
  buffer_load_dwordx4 v59, s[12:15], s36 offen offset:3072 lds
  s_add_u32 s30, s30, 12288
  s_cmp_eq_u32 s30, 86016
  s_cselect_b32 s30, 0, s30
  s_mov_b32 s28, 1
  s_mov_b32 s29, 16384
  s_bitcmp1_b32 s37, s28
  s_cbranch_scc0 .g2_kernel_p2_x0w
.g2_kernel_p2_x0b:
  s_xor_b32 s33, s28, s18
  s_lshl_b32 s33, s33, 14
  s_add_u32 s33, s33, s32
  s_add_u32 m0, s29, 0
  s_waitcnt vmcnt(63)
  buffer_load_dwordx4 v3, s[4:7], s33 offen offset:0 lds
  buffer_load_dwordx4 v3, s[4:7], s33 offen offset:1024 lds
  buffer_load_dwordx4 v3, s[4:7], s33 offen offset:2048 lds
  buffer_load_dwordx4 v3, s[4:7], s33 offen offset:3072 lds
  s_add_u32 m0, s29, 4096
  s_waitcnt vmcnt(63)
  s_add_u32 s33, s33, 4096
  buffer_load_dwordx4 v3, s[4:7], s33 offen offset:0 lds
  buffer_load_dwordx4 v3, s[4:7], s33 offen offset:1024 lds
  buffer_load_dwordx4 v3, s[4:7], s33 offen offset:2048 lds
  buffer_load_dwordx4 v3, s[4:7], s33 offen offset:3072 lds
  s_add_u32 m0, s29, 8192
  s_waitcnt vmcnt(63)
  s_add_u32 s33, s33, 4096
  buffer_load_dwordx4 v3, s[4:7], s33 offen offset:0 lds
  buffer_load_dwordx4 v3, s[4:7], s33 offen offset:1024 lds
  buffer_load_dwordx4 v3, s[4:7], s33 offen offset:2048 lds
  buffer_load_dwordx4 v3, s[4:7], s33 offen offset:3072 lds
  s_add_u32 m0, s29, 12288
  s_waitcnt vmcnt(63)
  s_add_u32 s33, s33, 4096
  buffer_load_dwordx4 v3, s[4:7], s33 offen offset:0 lds
  buffer_load_dwordx4 v3, s[4:7], s33 offen offset:1024 lds
  buffer_load_dwordx4 v3, s[4:7], s33 offen offset:2048 lds
  buffer_load_dwordx4 v3, s[4:7], s33 offen offset:3072 lds
  s_mov_b32 m0, 156160
  s_mov_b32 s35, .g2_kernel_tab-.g2_kernel_pc+144
  s_mov_b64 exec, 1
  buffer_load_dword off, s[64:67], s35 lds
  s_mov_b64 exec, -1
  s_mov_b32 s28, 2
  s_mov_b32 s29, 32768
  s_bitcmp1_b32 s37, s28
  s_cbranch_scc0 .g2_kernel_p2_x1w
.g2_kernel_p2_x1b:
  s_xor_b32 s33, s28, s18
  s_lshl_b32 s33, s33, 14
  s_add_u32 s33, s33, s32
  s_add_u32 m0, s29, 0
  s_waitcnt vmcnt(63)
  buffer_load_dwordx4 v3, s[4:7], s33 offen offset:0 lds
  buffer_load_dwordx4 v3, s[4:7], s33 offen offset:1024 lds
  buffer_load_dwordx4 v3, s[4:7], s33 offen offset:2048 lds
  buffer_load_dwordx4 v3, s[4:7], s33 offen offset:3072 lds
  s_add_u32 m0, s29, 4096
  s_waitcnt vmcnt(63)
  s_add_u32 s33, s33, 4096
  buffer_load_dwordx4 v3, s[4:7], s33 offen offset:0 lds
  buffer_load_dwordx4 v3, s[4:7], s33 offen offset:1024 lds
  buffer_load_dwordx4 v3, s[4:7], s33 offen offset:2048 lds
  buffer_load_dwordx4 v3, s[4:7], s33 offen offset:3072 lds
  s_add_u32 m0, s29, 8192
  s_waitcnt vmcnt(63)
  s_add_u32 s33, s33, 4096
  buffer_load_dwordx4 v3, s[4:7], s33 offen offset:0 lds
  buffer_load_dwordx4 v3, s[4:7], s33 offen offset:1024 lds
  buffer_load_dwordx4 v3, s[4:7], s33 offen offset:2048 lds
  buffer_load_dwordx4 v3, s[4:7], s33 offen offset:3072 lds
  s_add_u32 m0, s29, 12288
  s_waitcnt vmcnt(63)
  s_add_u32 s33, s33, 4096
  buffer_load_dwordx4 v3, s[4:7], s33 offen offset:0 lds
  buffer_load_dwordx4 v3, s[4:7], s33 offen offset:1024 lds
  buffer_load_dwordx4 v3, s[4:7], s33 offen offset:2048 lds
  buffer_load_dwordx4 v3, s[4:7], s33 offen offset:3072 lds
  s_mov_b32 m0, 156160
  s_mov_b32 s35, .g2_kernel_tab-.g2_kernel_pc+152
  s_mov_b64 exec, 1
  buffer_load_dword off, s[64:67], s35 lds
  s_mov_b64 exec, -1
  s_mov_b32 s28, 3
  s_mov_b32 s29, 49152
  s_bitcmp1_b32 s37, s28
  s_cbranch_scc0 .g2_kernel_p2_x2w
.g2_kernel_p2_x2b:
  s_xor_b32 s33, s28, s18
  s_lshl_b32 s33, s33, 14
  s_add_u32 s33, s33, s32
  s_add_u32 m0, s29, 0
  s_waitcnt vmcnt(63)
  buffer_load_dwordx4 v3, s[4:7], s33 offen offset:0 lds
  buffer_load_dwordx4 v3, s[4:7], s33 offen offset:1024 lds
  buffer_load_dwordx4 v3, s[4:7], s33 offen offset:2048 lds
  buffer_load_dwordx4 v3, s[4:7], s33 offen offset:3072 lds
  s_add_u32 m0, s29, 4096
  s_waitcnt vmcnt(63)
  s_add_u32 s33, s33, 4096
  buffer_load_dwordx4 v3, s[4:7], s33 offen offset:0 lds
  buffer_load_dwordx4 v3, s[4:7], s33 offen offset:1024 lds
  buffer_load_dwordx4 v3, s[4:7], s33 offen offset:2048 lds
  buffer_load_dwordx4 v3, s[4:7], s33 offen offset:3072 lds
  s_add_u32 m0, s29, 8192
  s_waitcnt vmcnt(63)
  s_add_u32 s33, s33, 4096
  buffer_load_dwordx4 v3, s[4:7], s33 offen offset:0 lds
  buffer_load_dwordx4 v3, s[4:7], s33 offen offset:1024 lds
  buffer_load_dwordx4 v3, s[4:7], s33 offen offset:2048 lds
  buffer_load_dwordx4 v3, s[4:7], s33 offen offset:3072 lds
  s_add_u32 m0, s29, 12288
  s_waitcnt vmcnt(63)
  s_add_u32 s33, s33, 4096
  buffer_load_dwordx4 v3, s[4:7], s33 offen offset:0 lds
  buffer_load_dwordx4 v3, s[4:7], s33 offen offset:1024 lds
  buffer_load_dwordx4 v3, s[4:7], s33 offen offset:2048 lds
  buffer_load_dwordx4 v3, s[4:7], s33 offen offset:3072 lds
  s_mov_b32 m0, 156160
  s_mov_b32 s35, .g2_kernel_tab-.g2_kernel_pc+156
  s_mov_b64 exec, 1
  buffer_load_dword off, s[64:67], s35 lds
  s_mov_b64 exec, -1
  s_xor_b32 s36, s18, 3
  s_mul_i32 s36, s36, 393216
  s_add_u32 s36, s36, s39
  s_add_u32 s36, s36, 196608
  ds_read_b32 v10, v9
  s_mov_b32 s34, 33
  s_mov_b32 s35, .g2_kernel_tab-.g2_kernel_pc+160
  s_branch .g2_kernel_p2_o
  .p2align 6
.g2_kernel_p2_l:
  s_waitcnt lgkmcnt(0)
  v_cmp_gt_i32 vcc, s34, v10
  s_cbranch_vccnz .g2_kernel_p2_aw
.g2_kernel_p2_ai:
  s_add_u32 s29, s29, 16384
  s_and_b32 s29, s29, 0xffff
  s_bitcmp1_b32 s37, s28
  s_cbranch_scc0 .g2_kernel_p2_x3w
.g2_kernel_p2_x3b:
  s_xor_b32 s33, s28, s18
  s_lshl_b32 s33, s33, 14
  s_add_u32 s33, s33, s32
  s_add_u32 m0, s29, 0
  s_waitcnt vmcnt(63)
  buffer_load_dwordx4 v3, s[4:7], s33 offen offset:0 lds
  buffer_load_dwordx4 v3, s[4:7], s33 offen offset:1024 lds
  buffer_load_dwordx4 v3, s[4:7], s33 offen offset:2048 lds
  buffer_load_dwordx4 v3, s[4:7], s33 offen offset:3072 lds
  s_add_u32 m0, s29, 4096
  s_waitcnt vmcnt(63)
  s_add_u32 s33, s33, 4096
  buffer_load_dwordx4 v3, s[4:7], s33 offen offset:0 lds
  buffer_load_dwordx4 v3, s[4:7], s33 offen offset:1024 lds
  buffer_load_dwordx4 v3, s[4:7], s33 offen offset:2048 lds
  buffer_load_dwordx4 v3, s[4:7], s33 offen offset:3072 lds
  s_add_u32 m0, s29, 8192
  s_waitcnt vmcnt(63)
  s_add_u32 s33, s33, 4096
  buffer_load_dwordx4 v3, s[4:7], s33 offen offset:0 lds
  buffer_load_dwordx4 v3, s[4:7], s33 offen offset:1024 lds
  buffer_load_dwordx4 v3, s[4:7], s33 offen offset:2048 lds
  buffer_load_dwordx4 v3, s[4:7], s33 offen offset:3072 lds
  s_add_u32 m0, s29, 12288
  s_waitcnt vmcnt(63)
  s_add_u32 s33, s33, 4096
  buffer_load_dwordx4 v3, s[4:7], s33 offen offset:0 lds
  buffer_load_dwordx4 v3, s[4:7], s33 offen offset:1024 lds
  buffer_load_dwordx4 v3, s[4:7], s33 offen offset:2048 lds
  buffer_load_dwordx4 v3, s[4:7], s33 offen offset:3072 lds
  s_add_u32 m0, s30, 65536
  s_waitcnt vmcnt(63)
  buffer_load_dwordx4 v48, s[12:15], s36 offen offset:0 lds
  buffer_load_dwordx4 v49, s[12:15], s36 offen offset:1024 lds
  buffer_load_dwordx4 v50, s[12:15], s36 offen offset:2048 lds
  buffer_load_dwordx4 v51, s[12:15], s36 offen offset:3072 lds
  s_add_u32 m0, s30, 69632
  s_waitcnt vmcnt(63)
  buffer_load_dwordx4 v52, s[12:15], s36 offen offset:0 lds
  buffer_load_dwordx4 v53, s[12:15], s36 offen offset:1024 lds
  buffer_load_dwordx4 v54, s[12:15], s36 offen offset:2048 lds
  buffer_load_dwordx4 v55, s[12:15], s36 offen offset:3072 lds
  s_add_u32 m0, s30, 73728
  s_waitcnt vmcnt(63)
  buffer_load_dwordx4 v56, s[12:15], s36 offen offset:0 lds
  buffer_load_dwordx4 v57, s[12:15], s36 offen offset:1024 lds
  buffer_load_dwordx4 v58, s[12:15], s36 offen offset:2048 lds
  buffer_load_dwordx4 v59, s[12:15], s36 offen offset:3072 lds
  s_add_u32 s30, s30, 12288
  s_cmp_eq_u32 s30, 86016
  s_cselect_b32 s30, 0, s30
  ds_read_b32 v10, v9
  s_mov_b32 m0, 156160
  s_add_u32 s34, s34, 1
  s_mov_b64 exec, 1
  buffer_load_dword off, s[64:67], s35 lds
  s_mov_b64 exec, -1
  s_add_u32 s35, s35, 4
  s_add_u32 s36, s36, 196608
.g2_kernel_p2_o:
  s_waitcnt lgkmcnt(0)
  v_cmp_gt_i32 vcc, s34, v10
  s_cbranch_vccnz .g2_kernel_p2_bw
.g2_kernel_p2_bi:
  s_add_u32 m0, s30, 65536
  s_waitcnt vmcnt(63)
  buffer_load_dwordx4 v48, s[12:15], s36 offen offset:0 lds
  buffer_load_dwordx4 v49, s[12:15], s36 offen offset:1024 lds
  buffer_load_dwordx4 v50, s[12:15], s36 offen offset:2048 lds
  buffer_load_dwordx4 v51, s[12:15], s36 offen offset:3072 lds
  s_add_u32 m0, s30, 69632
  s_waitcnt vmcnt(63)
  buffer_load_dwordx4 v52, s[12:15], s36 offen offset:0 lds
  buffer_load_dwordx4 v53, s[12:15], s36 offen offset:1024 lds
  buffer_load_dwordx4 v54, s[12:15], s36 offen offset:2048 lds
  buffer_load_dwordx4 v55, s[12:15], s36 offen offset:3072 lds
  s_add_u32 m0, s30, 73728
  s_waitcnt vmcnt(63)
  buffer_load_dwordx4 v56, s[12:15], s36 offen offset:0 lds
  buffer_load_dwordx4 v57, s[12:15], s36 offen offset:1024 lds
  buffer_load_dwordx4 v58, s[12:15], s36 offen offset:2048 lds
  buffer_load_dwordx4 v59, s[12:15], s36 offen offset:3072 lds
  s_add_u32 s30, s30, 12288
  s_cmp_eq_u32 s30, 86016
  s_cselect_b32 s30, 0, s30
  ds_read_b32 v10, v9
  s_mov_b32 m0, 156160
  s_add_u32 s34, s34, 1
  s_mov_b64 exec, 1
  buffer_load_dword off, s[64:67], s35 lds
  s_mov_b64 exec, -1
  s_add_u32 s35, s35, 4
  s_add_u32 s28, s28, 1
  s_xor_b32 s36, s18, s28
  s_mul_i32 s36, s36, 393216
  s_add_u32 s36, s36, s39
  s_cmp_lt_i32 s34, 58
  s_cbranch_scc1 .g2_kernel_p2_l
  s_branch .g2_kernel_v
.g2_kernel_c1:
  v_mov_b32 v6, s71
  s_mov_b32 s38, 0
.g2_kernel_wg40:
  ds_read_b32 v7, v6 offset:76
  s_add_u32 s38, s38, 1
  s_waitcnt lgkmcnt(0)
  v_cmp_gt_u32 vcc, 1, v7
  s_cbranch_vccz .g2_kernel_wg40d
  s_sleep 1
  s_cmp_lt_u32 s38, 524288
  s_cbranch_scc1 .g2_kernel_wg40
.g2_kernel_wg40d:
  s_sleep 4
  s_and_b32 s31, s19, 0xffffe000
  s_add_u32 s31, s31, 4
  v_and_b32 v6, 15, v2
  v_lshlrev_b32 v6, 9, v6
  v_lshrrev_b32 v7, 4, v2
  v_lshl_add_u32 v6, v7, 7, v6
  v_lshlrev_b32 v7, 2, v2
  v_add_u32 v7, 157952, v7
  s_mov_b32 m0, 157952
  s_mov_b32 s38, 0
  s_bfm_b64 exec, 16, 48
.g2_kernel_pa41:
  buffer_load_dword v6, s[4:7], s31 offen sc1 lds
  s_add_u32 s38, s38, 1
  s_waitcnt vmcnt(0)
  ds_read_b32 v8, v7
  s_waitcnt lgkmcnt(0)
  v_cmp_ge_u32 vcc, s62, v8
  s_cbranch_vccz .g2_kernel_pa41d
  s_mov_b64 exec, vcc
  s_sleep 4
  s_cmp_lt_u32 s38, 131072
  s_cbranch_scc1 .g2_kernel_pa41
.g2_kernel_pa41d:
  s_mov_b64 exec, -1
  s_setprio 2
  s_mov_b32 s39, 0
  s_lshl_b32 s30, s17, 2
  s_lshr_b32 s28, s18, 2
  s_add_u32 s30, s30, s28
  s_lshl_b32 s20, s30, 13
  s_add_u32 s20, s20, s63
  s_add_u32 s20, s20, 0x1000000
  s_add_u32 s24, s20, 4096
  s_lshl_b32 s21, s30, 8
  s_add_u32 s21, s21, s63
  s_add_u32 s21, s21, 0x1080000
  s_lshl_b32 s23, s62, 16
  s_add_u32 s23, s23, 0x3040000
  s_lshl_b32 s22, s30, 7
  s_add_u32 s22, s22, s23
  s_and_b32 s28, s2, 7
  s_lshl_b32 s28, s28, 13
  s_add_u32 s23, s23, s28
  v_mov_b32 v9, 155648
  ds_read_b32 v26, v9 offset:256
  v_and_b32 v24, 31, v2
  v_lshlrev_b32 v25, 3, v2
  v_lshlrev_b32 v27, 13, v2
  v_mov_b32 v28, 0.0009765625
  v_mov_b32 v30, 1e-05
  v_mov_b32 v6, s71
  s_mov_b32 s38, 0
.g2_kernel_wg43:
  ds_read_b32 v7, v6 offset:20
  s_add_u32 s38, s38, 1
  s_waitcnt lgkmcnt(0)
  v_cmp_gt_u32 vcc, 4, v7
  s_cbranch_vccz .g2_kernel_wg43d
  s_sleep 1
  s_cmp_lt_u32 s38, 524288
  s_cbranch_scc1 .g2_kernel_wg43
.g2_kernel_wg43d:
  s_sleep 12
  s_cmp_lg_u32 s62, 0
  s_cbranch_scc1 .g2_kernel_nap44
  s_sleep 12
.g2_kernel_nap44:
  s_xor_b32 s28, s17, s18
  s_and_b32 s28, s28, 3
  s_cbranch_scc1 .g2_kernel_c_l1
  s_mov_b32 s38, 0
.g2_kernel_gx45:
  buffer_load_dwordx4 v[32:35], v3, s[4:7], s20 offen offset:0 sc1
  buffer_load_dwordx4 v[36:39], v3, s[4:7], s20 offen offset:1024 sc1
  buffer_load_dwordx4 v[40:43], v3, s[4:7], s20 offen offset:2048 sc1
  buffer_load_dwordx4 v[44:47], v3, s[4:7], s20 offen offset:3072 sc1
  buffer_load_dwordx4 v[48:51], v3, s[4:7], s24 offen offset:0 sc1
  buffer_load_dwordx4 v[52:55], v3, s[4:7], s24 offen offset:1024 sc1
  buffer_load_dwordx4 v[56:59], v3, s[4:7], s24 offen offset:2048 sc1
  buffer_load_dwordx4 v[60:63], v3, s[4:7], s24 offen offset:3072 sc1
  s_add_u32 s38, s38, 1
  s_waitcnt vmcnt(0)
  v_min3_u32 v6, v32, v35, v36
  v_min3_u32 v6, v6, v39, v40
  v_min3_u32 v6, v6, v43, v44
  v_min3_u32 v6, v6, v47, v48
  v_min3_u32 v6, v6, v51, v52
  v_min3_u32 v6, v6, v55, v56
  v_min3_u32 v6, v6, v59, v60
  v_min_u32 v6, v6, v63
  v_cmp_eq_u32 vcc, 0, v6
  s_cbranch_vccz .g2_kernel_gx45d
  s_mov_b64 exec, vcc
  s_sleep 1
  s_cmp_lg_u32 s62, 0
  s_cbranch_scc1 .g2_kernel_nap46
  s_sleep 9
.g2_kernel_nap46:
  s_cmp_lt_u32 s38, 131072
  s_cbranch_scc1 .g2_kernel_gx45
.g2_kernel_gx45d:
  s_mov_b64 exec, -1
  v_add_f32 v32, v32, v48
  v_add_f32 v33, v33, v49
  v_add_f32 v34, v34, v50
  v_add_f32 v36, v36, v52
  v_add_f32 v37, v37, v53
  v_add_f32 v38, v38, v54
  v_add_f32 v40, v40, v56
  v_add_f32 v41, v41, v57
  v_add_f32 v42, v42, v58
  v_add_f32 v44, v44, v60
  v_add_f32 v45, v45, v61
  v_add_f32 v46, v46, v62
  v_add_f32 v32, v32, v40
  v_add_f32 v33, v33, v41
  v_add_f32 v34, v34, v42
  v_add_f32 v36, v36, v44
  v_add_f32 v37, v37, v45
  v_add_f32 v38, v38, v46
  v_add_f32 v32, v32, v36
  v_add_f32 v33, v33, v37
  v_add_f32 v34, v34, v38
  v_mov_b32 v16, v32
  v_mov_b32 v17, v33
  v_mov_b32 v18, v34
  s_mov_b32 s28, -32
  v_permlane32_swap_b32 v16, v32
  v_permlane32_swap_b32 v17, v33
  v_permlane32_swap_b32 v18, v34
  v_add_f32 v16, v16, v32
  v_add_f32 v17, v17, v33
  v_add_f32 v18, v18, v34
  v_fma_f32 v18, -v16, v26, v18
  v_mul_f32 v16, v28, v16
  v_mul_f32 v19, v16, v16
  v_fma_f32 v17, v17, v28, -v19
  v_max_f32 v17, 0, v17
  v_add_f32 v17, v30, v17
  v_rsq_f32 v19, v17
  v_mov_b32 v11, 1
  v_mul_f32 v18, v18, v19
  v_and_or_b32 v10, v18, s28, v24
  s_nop 1
  v_max_f32 v10, v10, v10 row_ror:8 row_mask:0xf bank_mask:0xf
  s_nop 1
  v_max_f32 v10, v10, v10 row_ror:4 row_mask:0xf bank_mask:0xf
  s_nop 1
  v_max_f32 v10, v10, v10 row_ror:2 row_mask:0xf bank_mask:0xf
  s_nop 1
  v_max_f32 v10, v10, v10 row_ror:1 row_mask:0xf bank_mask:0xf
  s_nop 1
  v_max_f32 v10, v10, v10 row_bcast:15 row_mask:0xa bank_mask:0xf
  s_nop 0
  v_readlane_b32 s28, v10, 31
  s_nop 1
  v_mov_b32 v10, s28
  s_mov_b64 exec, 0xff
  buffer_store_dwordx2 v[10:11], v27, s[4:7], s22 offen sc1
  s_mov_b32 exec_lo, -1
  buffer_store_dwordx2 v[16:17], v25, s[4:7], s21 offen sc1
  s_mov_b64 exec, -1
.g2_kernel_c_l1:
  s_cmp_lg_u32 s62, 0
  s_cbranch_scc1 .g2_kernel_c_t3
  s_sleep 30
  s_mov_b64 s[8:9], -1
  s_call_b64 s[68:69], .g2_kernel_amax
  s_lshr_b32 s28, s77, 5
  s_add_u32 m0, s71, 104
  s_lshl_b32 s29, s28, 2
  s_add_u32 s29, s29, .g2_kernel_tab-.g2_kernel_pc
  s_mov_b64 exec, 1
  buffer_load_dword off, s[64:67], s29 lds
  s_mov_b64 exec, -1
  s_and_b32 s28, s77, 31
  s_add_u32 s28, s28, 1
  s_add_u32 m0, s71, 36
  s_lshl_b32 s29, s28, 2
  s_add_u32 s29, s29, .g2_kernel_tab-.g2_kernel_pc
  s_mov_b64 exec, 1
  buffer_load_dword off, s[64:67], s29 lds
  s_mov_b64 exec, -1
  s_lshr_b32 s24, s77, 7
  s_lshl_b32 s24, s24, 18
  s_bfe_u32 s28, s77, 0x30004
  s_lshl_b32 s28, s28, 11
  s_add_u32 s24, s24, s28
  s_and_b32 s28, s77, 15
  s_lshl_b32 s28, s28, 4
  s_add_u32 s24, s24, s28
  s_add_u32 s24, s24, s63
  s_add_u32 s24, s24, 0xc00000
  s_lshl_b32 s28, s17, 14
  s_add_u32 s24, s24, s28
  s_and_b32 s28, s18, 1
  s_lshl_b32 s28, s28, 8
  s_add_u32 s24, s24, s28
  v_lshrrev_b32 v12, 3, v2
  v_lshlrev_b32 v13, 1, v12
  buffer_load_ushort v56, v13, s[4:7], s24 offen offset:0
  buffer_load_ushort v57, v13, s[4:7], s24 offen offset:512
  buffer_load_ushort v58, v13, s[4:7], s24 offen offset:1024
  buffer_load_ushort v59, v13, s[4:7], s24 offen offset:1536
  s_lshl_b32 s25, s77, 3
  s_add_u32 s25, s25, s63
  s_add_u32 s25, s25, 0x1080000
  s_lshl_b32 s21, s17, 10
  s_add_u32 s21, s21, s63
  s_add_u32 s21, s21, 0x1080000
  s_mov_b32 s38, 0
.g2_kernel_gx47:
  buffer_load_dwordx4 v[16:19], v3, s[4:7], s21 offen sc1
  buffer_load_dwordx2 v[20:21], v4, s[4:7], s25 offen sc1
  s_add_u32 s38, s38, 1
  s_waitcnt vmcnt(0)
  v_min3_u32 v6, v17, v19, v21
  v_cmp_eq_u32 vcc, 0, v6
  s_cbranch_vccz .g2_kernel_gx47d
  s_mov_b64 exec, vcc
  s_sleep 1
  s_cmp_lt_u32 s38, 131072
  s_cbranch_scc1 .g2_kernel_gx47
.g2_kernel_gx47d:
  s_mov_b64 exec, -1
  s_lshr_b32 s28, s77, 7
  s_and_b32 s79, s77, 127
  s_add_u32 s79, s79, 1
  s_cmp_eq_u32 s28, s17
  s_cselect_b32 s79, s79, 0
  v_rsq_f32 v22, v17
  v_rsq_f32 v23, v19
  v_rsq_f32 v21, v21
  v_mov_b32 v62, -1.4426950408889634
  v_mul_f32 v62, s27, v62
  v_exp_f32 v62, v62
  v_lshlrev_b32 v14, 3, v2
  v_add_u32 v14, 155648, v14
  v_mov_b32 v15, s79
  v_add_f32 v52, 1.0, v22
  v_mul_f32 v54, v16, v22
  v_sub_f32 v54, 0, v54
  v_add_f32 v53, 1.0, v23
  v_mul_f32 v55, v18, v23
  v_sub_f32 v55, 0, v55
  v_add_f32 v62, 1.0, v62
  v_rcp_f32 v62, v62
  v_add_f32 v60, 1.0, v21
  v_mul_f32 v61, v20, v21
  v_sub_f32 v61, 0, v61
  v_sub_f32 v17, v17, v30
  v_mul_f32 v48, v52, v52
  v_fma_f32 v48, v48, v17, v30
  v_rsq_f32 v48, v48
  s_nop 0
  v_mul_f32 v48, v48, v52
  v_mul_f32 v50, v48, v16
  v_sub_f32 v50, 0, v50
  v_sub_f32 v19, v19, v30
  v_mul_f32 v49, v53, v53
  v_fma_f32 v49, v49, v19, v30
  v_rsq_f32 v49, v49
  s_nop 0
  v_mul_f32 v49, v49, v53
  v_mul_f32 v51, v49, v18
  v_sub_f32 v51, 0, v51
  v_lshlrev_b32 v56, 16, v56
  v_fma_f32 v56, v56, v60, v61
  v_lshlrev_b32 v57, 16, v57
  v_fma_f32 v57, v57, v60, v61
  v_lshlrev_b32 v58, 16, v58
  v_fma_f32 v58, v58, v60, v61
  v_lshlrev_b32 v59, 16, v59
  v_fma_f32 v59, v59, v60, v61
  v_and_b32 v10, 7, v2
  v_lshlrev_b32 v10, 12, v10
  v_lshl_add_u32 v10, v12, 4, v10
  s_lshl_b32 s20, s17, 1
  s_and_b32 s28, s18, 1
  s_add_u32 s20, s20, s28
  s_lshl_b32 s20, s20, 7
  s_add_u32 s20, s20, s63
  s_add_u32 s20, s20, 0x1090000
  s_and_b32 s26, s18, 14
  s_lshl_b32 s26, s26, 4
  s_add_u32 s26, s26, s17
  s_lshl_b32 s26, s26, 1
  s_and_b32 s28, s18, 1
  s_add_u32 s26, s26, s28
  s_lshl_b32 s26, s26, 10
  s_add_u32 s26, s26, s63
  s_add_u32 s26, s26, 0x1190000
  s_add_u32 s25, s26, 32768
  s_lshl_b32 s21, s2, 12
  s_add_u32 s21, s21, 0x3200000
  v_lshlrev_b32 v14, 3, v2
  buffer_store_dwordx2 v[48:49], v14, s[4:7], s21 offen
  buffer_store_dwordx2 v[50:51], v14, s[4:7], s21 offen offset:512
  buffer_store_dwordx2 v[52:53], v14, s[4:7], s21 offen offset:1024
  buffer_store_dwordx2 v[54:55], v14, s[4:7], s21 offen offset:1536
  buffer_store_dword v15, v4, s[4:7], s21 offen offset:2048
  s_mov_b32 m0, 158464
  s_add_u32 s22, s21, 2048
  s_waitcnt vmcnt(0)
  buffer_load_dwordx4 v3, s[4:7], s21 offen lds
  buffer_load_dwordx4 v3, s[4:7], s21 offen offset:1024 lds
  s_mov_b32 m0, 155800
  s_mov_b64 exec, 1
  buffer_load_dword v4, s[4:7], s22 offen lds
  s_mov_b64 exec, -1
  s_add_u32 m0, s71, 128
  s_mov_b32 s29, .g2_kernel_tab-.g2_kernel_pc+8
  s_mov_b64 exec, 1
  buffer_load_dword off, s[64:67], s29 lds
  s_mov_b64 exec, -1
  s_lshl_b32 s28, s2, 10
  s_and_b32 s28, s28, 0xe000
  v_lshlrev_b32 v7, 7, v2
  buffer_load_dword v1, v7, s[64:67], s28 offen
  v_mov_b32 v6, s71
  s_mov_b32 s38, 0
.g2_kernel_wg48:
  ds_read_b32 v7, v6 offset:112
  s_add_u32 s38, s38, 1
  s_waitcnt lgkmcnt(0)
  v_cmp_gt_u32 vcc, 1, v7
  s_cbranch_vccz .g2_kernel_wg48d
  s_sleep 2
  s_cmp_lt_u32 s38, 524288
  s_cbranch_scc1 .g2_kernel_wg48
.g2_kernel_wg48d:
  s_sleep 8
  s_cmp_lg_u32 s62, 0
  s_cbranch_scc1 .g2_kernel_nap49
  s_sleep 22
.g2_kernel_nap49:
  s_mov_b32 s38, 0
.g2_kernel_gx50:
  s_mov_b32 s21, s20
  buffer_load_dwordx4 v[160:163], v10, s[4:7], s21 offen sc1
  s_add_u32 s21, s21, 32768
  buffer_load_dwordx4 v[164:167], v10, s[4:7], s21 offen sc1
  s_add_u32 s21, s21, 32768
  buffer_load_dwordx4 v[168:171], v10, s[4:7], s21 offen sc1
  s_add_u32 s21, s21, 32768
  buffer_load_dwordx4 v[172:175], v10, s[4:7], s21 offen sc1
  s_add_u32 s21, s21, 32768
  buffer_load_dwordx4 v[176:179], v10, s[4:7], s21 offen sc1
  s_add_u32 s21, s21, 32768
  buffer_load_dwordx4 v[180:183], v10, s[4:7], s21 offen sc1
  s_add_u32 s21, s21, 32768
  buffer_load_dwordx4 v[184:187], v10, s[4:7], s21 offen sc1
  s_add_u32 s21, s21, 32768
  buffer_load_dwordx4 v[188:191], v10, s[4:7], s21 offen sc1
  s_add_u32 s21, s21, 32768
  buffer_load_dwordx4 v[192:195], v10, s[4:7], s21 offen sc1
  s_add_u32 s21, s21, 32768
  buffer_load_dwordx4 v[196:199], v10, s[4:7], s21 offen sc1
  s_add_u32 s21, s21, 32768
  buffer_load_dwordx4 v[200:203], v10, s[4:7], s21 offen sc1
  s_add_u32 s21, s21, 32768
  buffer_load_dwordx4 v[204:207], v10, s[4:7], s21 offen sc1
  s_add_u32 s21, s21, 32768
  buffer_load_dwordx4 v[208:211], v10, s[4:7], s21 offen sc1
  s_add_u32 s21, s21, 32768
  buffer_load_dwordx4 v[212:215], v10, s[4:7], s21 offen sc1
  s_add_u32 s21, s21, 32768
  buffer_load_dwordx4 v[216:219], v10, s[4:7], s21 offen sc1
  s_add_u32 s21, s21, 32768
  buffer_load_dwordx4 v[220:223], v10, s[4:7], s21 offen sc1
  s_add_u32 s21, s21, 32768
  buffer_load_dwordx4 v[224:227], v10, s[4:7], s21 offen sc1
  s_add_u32 s21, s21, 32768
  buffer_load_dwordx4 v[228:231], v10, s[4:7], s21 offen sc1
  s_add_u32 s21, s21, 32768
  buffer_load_dwordx4 v[232:235], v10, s[4:7], s21 offen sc1
  s_add_u32 s21, s21, 32768
  buffer_load_dwordx4 v[236:239], v10, s[4:7], s21 offen sc1
  s_add_u32 s21, s21, 32768
  buffer_load_dwordx4 v[240:243], v10, s[4:7], s21 offen sc1
  s_add_u32 s21, s21, 32768
  buffer_load_dwordx4 v[244:247], v10, s[4:7], s21 offen sc1
  s_add_u32 s21, s21, 32768
  buffer_load_dwordx4 v[248:251], v10, s[4:7], s21 offen sc1
  s_add_u32 s21, s21, 32768
  buffer_load_dwordx4 v[252:255], v10, s[4:7], s21 offen sc1
  s_add_u32 s21, s21, 32768
  buffer_load_dwordx4 v[16:19], v10, s[4:7], s21 offen sc1
  s_add_u32 s21, s21, 32768
  buffer_load_dwordx4 v[20:23], v10, s[4:7], s21 offen sc1
  s_add_u32 s21, s21, 32768
  buffer_load_dwordx4 v[24:27], v10, s[4:7], s21 offen sc1
  s_add_u32 s21, s21, 32768
  buffer_load_dwordx4 v[28:31], v10, s[4:7], s21 offen sc1
  s_add_u32 s21, s21, 32768
  s_add_u32 s38, s38, 1
  s_waitcnt vmcnt(0)
  v_min3_u32 v6, v160, v162, v164
  v_min3_u32 v6, v6, v166, v168
  v_min3_u32 v6, v6, v170, v172
  v_min3_u32 v6, v6, v174, v176
  v_min3_u32 v6, v6, v178, v180
  v_min3_u32 v6, v6, v182, v184
  v_min3_u32 v6, v6, v186, v188
  v_min3_u32 v6, v6, v190, v192
  v_min3_u32 v6, v6, v194, v196
  v_min3_u32 v6, v6, v198, v200
  v_min3_u32 v6, v6, v202, v204
  v_min3_u32 v6, v6, v206, v208
  v_min3_u32 v6, v6, v210, v212
  v_min3_u32 v6, v6, v214, v216
  v_min3_u32 v6, v6, v218, v220
  v_min3_u32 v6, v6, v222, v224
  v_min3_u32 v6, v6, v226, v228
  v_min3_u32 v6, v6, v230, v232
  v_min3_u32 v6, v6, v234, v236
  v_min3_u32 v6, v6, v238, v240
  v_min3_u32 v6, v6, v242, v244
  v_min3_u32 v6, v6, v246, v248
  v_min3_u32 v6, v6, v250, v252
  v_min3_u32 v6, v6, v254, v16
  v_min3_u32 v6, v6, v18, v20
  v_min3_u32 v6, v6, v22, v24
  v_min3_u32 v6, v6, v26, v28
  v_min_u32 v6, v6, v30
  v_cmp_eq_u32 vcc, 0, v6
  s_cbranch_vccz .g2_kernel_gx50d
  s_mov_b64 exec, vcc
  s_sleep 1
  s_cmp_lg_u32 s62, 0
  s_cbranch_scc1 .g2_kernel_nap51
  s_sleep 11
.g2_kernel_nap51:
  s_cmp_lt_u32 s38, 131072
  s_cbranch_scc1 .g2_kernel_gx50
.g2_kernel_gx50d:
  s_mov_b64 exec, -1
  v_add_f32 v164, v164, v160
  v_add_f32 v165, v165, v161
  v_add_f32 v166, v166, v162
  v_add_f32 v167, v167, v163
  v_add_f32 v172, v172, v168
  v_add_f32 v173, v173, v169
  v_add_f32 v174, v174, v170
  v_add_f32 v175, v175, v171
  v_add_f32 v180, v180, v176
  v_add_f32 v181, v181, v177
  v_add_f32 v182, v182, v178
  v_add_f32 v183, v183, v179
  v_add_f32 v188, v188, v184
  v_add_f32 v189, v189, v185
  v_add_f32 v190, v190, v186
  v_add_f32 v191, v191, v187
  v_add_f32 v196, v196, v192
  v_add_f32 v197, v197, v193
  v_add_f32 v198, v198, v194
  v_add_f32 v199, v199, v195
  v_add_f32 v204, v204, v200
  v_add_f32 v205, v205, v201
  v_add_f32 v206, v206, v202
  v_add_f32 v207, v207, v203
  v_add_f32 v212, v212, v208
  v_add_f32 v213, v213, v209
  v_add_f32 v214, v214, v210
  v_add_f32 v215, v215, v211
  v_add_f32 v220, v220, v216
  v_add_f32 v221, v221, v217
  v_add_f32 v222, v222, v218
  v_add_f32 v223, v223, v219
  v_add_f32 v228, v228, v224
  v_add_f32 v229, v229, v225
  v_add_f32 v230, v230, v226
  v_add_f32 v231, v231, v227
  v_add_f32 v236, v236, v232
  v_add_f32 v237, v237, v233
  v_add_f32 v238, v238, v234
  v_add_f32 v239, v239, v235
  v_add_f32 v244, v244, v240
  v_add_f32 v245, v245, v241
  v_add_f32 v246, v246, v242
  v_add_f32 v247, v247, v243
  v_add_f32 v252, v252, v248
  v_add_f32 v253, v253, v249
  v_add_f32 v254, v254, v250
  v_add_f32 v255, v255, v251
  v_add_f32 v20, v20, v16
  v_add_f32 v21, v21, v17
  v_add_f32 v22, v22, v18
  v_add_f32 v23, v23, v19
  v_add_f32 v28, v28, v24
  v_add_f32 v29, v29, v25
  v_add_f32 v30, v30, v26
  v_add_f32 v31, v31, v27
  v_add_f32 v172, v172, v164
  v_add_f32 v173, v173, v165
  v_add_f32 v174, v174, v166
  v_add_f32 v175, v175, v167
  v_add_f32 v188, v188, v180
  v_add_f32 v189, v189, v181
  v_add_f32 v190, v190, v182
  v_add_f32 v191, v191, v183
  v_add_f32 v204, v204, v196
  v_add_f32 v205, v205, v197
  v_add_f32 v206, v206, v198
  v_add_f32 v207, v207, v199
  v_add_f32 v220, v220, v212
  v_add_f32 v221, v221, v213
  v_add_f32 v222, v222, v214
  v_add_f32 v223, v223, v215
  v_add_f32 v236, v236, v228
  v_add_f32 v237, v237, v229
  v_add_f32 v238, v238, v230
  v_add_f32 v239, v239, v231
  v_add_f32 v252, v252, v244
  v_add_f32 v253, v253, v245
  v_add_f32 v254, v254, v246
  v_add_f32 v255, v255, v247
  v_add_f32 v28, v28, v20
  v_add_f32 v29, v29, v21
  v_add_f32 v30, v30, v22
  v_add_f32 v31, v31, v23
  v_add_f32 v188, v188, v172
  v_add_f32 v189, v189, v173
  v_add_f32 v190, v190, v174
  v_add_f32 v191, v191, v175
  v_add_f32 v220, v220, v204
  v_add_f32 v221, v221, v205
  v_add_f32 v222, v222, v206
  v_add_f32 v223, v223, v207
  v_add_f32 v252, v252, v236
  v_add_f32 v253, v253, v237
  v_add_f32 v254, v254, v238
  v_add_f32 v255, v255, v239
  v_add_f32 v220, v220, v188
  v_add_f32 v221, v221, v189
  v_add_f32 v222, v222, v190
  v_add_f32 v223, v223, v191
  v_add_f32 v28, v28, v252
  v_add_f32 v29, v29, v253
  v_add_f32 v30, v30, v254
  v_add_f32 v31, v31, v255
  v_add_f32 v28, v28, v220
  v_add_f32 v29, v29, v221
  v_add_f32 v30, v30, v222
  v_add_f32 v31, v31, v223
  v_add_f32 v28, v28, v28 quad_perm:[1,0,3,2] row_mask:0xf bank_mask:0xf
  v_add_f32 v29, v29, v29 quad_perm:[1,0,3,2] row_mask:0xf bank_mask:0xf
  v_add_f32 v30, v30, v30 quad_perm:[1,0,3,2] row_mask:0xf bank_mask:0xf
  v_add_f32 v31, v31, v31 quad_perm:[1,0,3,2] row_mask:0xf bank_mask:0xf
  v_add_f32 v28, v28, v28 quad_perm:[2,3,0,1] row_mask:0xf bank_mask:0xf
  v_add_f32 v29, v29, v29 quad_perm:[2,3,0,1] row_mask:0xf bank_mask:0xf
  v_add_f32 v30, v30, v30 quad_perm:[2,3,0,1] row_mask:0xf bank_mask:0xf
  v_add_f32 v31, v31, v31 quad_perm:[2,3,0,1] row_mask:0xf bank_mask:0xf
  v_add_f32 v28, v28, v28 row_half_mirror row_mask:0xf bank_mask:0xf
  v_add_f32 v29, v29, v29 row_half_mirror row_mask:0xf bank_mask:0xf
  v_add_f32 v30, v30, v30 row_half_mirror row_mask:0xf bank_mask:0xf
  v_add_f32 v31, v31, v31 row_half_mirror row_mask:0xf bank_mask:0xf
  v_mul_f32 v28, v28, v62
  v_mul_f32 v29, v29, v62
  v_mul_f32 v30, v30, v62
  v_mul_f32 v31, v31, v62
  v_cvt_pk_bf16_f32 v16, v28, v29
  v_cvt_pk_bf16_f32 v17, v30, v31
  s_mov_b32 s28, 0x00010001
  s_mov_b32 s29, 0x00010001
  v_mov_b32 v18, v16 row_ror:8 row_mask:0xf bank_mask:0xf
  v_mov_b32 v19, v17 row_ror:8 row_mask:0xf bank_mask:0xf
  v_lshlrev_b32 v28, 16, v16
  v_and_b32 v29, 0xffff0000, v16
  v_lshlrev_b32 v30, 16, v17
  v_and_b32 v31, 0xffff0000, v17
  v_cndmask_b32 v32, 0, v16, s[28:29]
  v_cndmask_b32 v33, 0, v17, s[28:29]
  v_cndmask_b32 v34, 0, v18, s[28:29]
  v_cndmask_b32 v35, 0, v19, s[28:29]
  s_lshl_b64 s[28:29], s[28:29], 1
  s_nop 0
  v_mfma_f32_16x16x32_bf16 v[160:163], v[32:35], v[64:67], 0
  v_mfma_f32_16x16x32_bf16 v[164:167], v[32:35], v[80:83], 0
  v_mfma_f32_16x16x32_bf16 v[168:171], v[32:35], v[96:99], 0
  v_mfma_f32_16x16x32_bf16 v[172:175], v[32:35], v[112:115], 0
  v_mfma_f32_16x16x32_bf16 v[176:179], v[32:35], v[128:131], 0
  v_mfma_f32_16x16x32_bf16 v[180:183], v[32:35], v[144:147], 0
  v_cndmask_b32 v36, 0, v16, s[28:29]
  v_cndmask_b32 v37, 0, v17, s[28:29]
  v_cndmask_b32 v38, 0, v18, s[28:29]
  v_cndmask_b32 v39, 0, v19, s[28:29]
  s_lshl_b64 s[28:29], s[28:29], 1
  s_nop 0
  v_mfma_f32_16x16x32_bf16 v[160:163], v[36:39], v[68:71], v[160:163]
  v_mfma_f32_16x16x32_bf16 v[164:167], v[36:39], v[84:87], v[164:167]
  v_mfma_f32_16x16x32_bf16 v[168:171], v[36:39], v[100:103], v[168:171]
  v_mfma_f32_16x16x32_bf16 v[172:175], v[36:39], v[116:119], v[172:175]
  v_mfma_f32_16x16x32_bf16 v[176:179], v[36:39], v[132:135], v[176:179]
  v_mfma_f32_16x16x32_bf16 v[180:183], v[36:39], v[148:151], v[180:183]
  v_cndmask_b32 v40, 0, v16, s[28:29]
  v_cndmask_b32 v41, 0, v17, s[28:29]
  v_cndmask_b32 v42, 0, v18, s[28:29]
  v_cndmask_b32 v43, 0, v19, s[28:29]
  s_lshl_b64 s[28:29], s[28:29], 1
  s_nop 0
  v_mfma_f32_16x16x32_bf16 v[160:163], v[40:43], v[72:75], v[160:163]
  v_mfma_f32_16x16x32_bf16 v[164:167], v[40:43], v[88:91], v[164:167]
  v_mfma_f32_16x16x32_bf16 v[168:171], v[40:43], v[104:107], v[168:171]
  v_mfma_f32_16x16x32_bf16 v[172:175], v[40:43], v[120:123], v[172:175]
  v_mfma_f32_16x16x32_bf16 v[176:179], v[40:43], v[136:139], v[176:179]
  v_mfma_f32_16x16x32_bf16 v[180:183], v[40:43], v[152:155], v[180:183]
  v_cndmask_b32 v44, 0, v16, s[28:29]
  v_cndmask_b32 v45, 0, v17, s[28:29]
  v_cndmask_b32 v46, 0, v18, s[28:29]
  v_cndmask_b32 v47, 0, v19, s[28:29]
  s_lshl_b64 s[28:29], s[28:29], 1
  s_nop 0
  v_mfma_f32_16x16x32_bf16 v[160:163], v[44:47], v[76:79], v[160:163]
  v_mfma_f32_16x16x32_bf16 v[164:167], v[44:47], v[92:95], v[164:167]
  v_mfma_f32_16x16x32_bf16 v[168:171], v[44:47], v[108:111], v[168:171]
  v_mfma_f32_16x16x32_bf16 v[172:175], v[44:47], v[124:127], v[172:175]
  v_mfma_f32_16x16x32_bf16 v[176:179], v[44:47], v[140:143], v[176:179]
  v_mfma_f32_16x16x32_bf16 v[180:183], v[44:47], v[156:159], v[180:183]
  v_add_f32 v56, v56, v28
  v_add_f32 v57, v57, v29
  v_add_f32 v58, v58, v30
  v_add_f32 v59, v59, v31
  v_add_f32 v20, v56, v57
  v_mul_f32 v22, v56, v56
  v_add_f32 v21, v58, v59
  v_fmac_f32 v22, v57, v57
  v_add_f32 v20, v20, v21
  v_fmac_f32 v22, v58, v58
  v_fmac_f32 v22, v59, v59
  v_or_b32 v28, 1, v28
  v_or_b32 v30, 1, v30
  v_add_f32 v20, v20, v20 row_ror:8 row_mask:0xf bank_mask:0xf
  v_add_f32 v22, v22, v22 row_ror:8 row_mask:0xf bank_mask:0xf
  v_lshlrev_b32 v11, 4, v12
  v_add_f32 v20, v20, v20 row_bcast:15 row_mask:0xa bank_mask:0xf
  v_add_f32 v22, v22, v22 row_bcast:15 row_mask:0xa bank_mask:0xf
  s_mov_b32 exec_lo, 0x01010101
  s_mov_b32 exec_hi, 0x01010101
  buffer_store_dwordx4 v[28:31], v11, s[4:7], s26 offen offset:768 sc1
  buffer_store_dwordx4 v[28:31], v11, s[4:7], s25 offen offset:768 sc1
  s_mov_b64 exec, -1
  v_add_f32 v20, v20, v20 row_bcast:31 row_mask:0xc bank_mask:0xf
  v_add_f32 v22, v22, v22 row_bcast:31 row_mask:0xc bank_mask:0xf
  v_or_b32 v20, 1, v20
  v_or_b32 v22, 1, v22
  s_mov_b32 exec_lo, 0
  s_mov_b32 exec_hi, 0x80000000
  buffer_store_dwordx4 v[20:23], v4, s[4:7], s26 offen offset:896 sc1
  buffer_store_dwordx4 v[20:23], v4, s[4:7], s25 offen offset:896 sc1
  s_mov_b64 exec, 0xffff
  v_or_b32 v160, 1, v160
  v_or_b32 v162, 1, v162
  buffer_store_dwordx4 v[160:163], v3, s[4:7], s26 offen offset:0 sc1
  v_or_b32 v164, 1, v164
  v_or_b32 v166, 1, v166
  buffer_store_dwordx4 v[164:167], v3, s[4:7], s25 offen offset:0 sc1
  v_or_b32 v168, 1, v168
  v_or_b32 v170, 1, v170
  buffer_store_dwordx4 v[168:171], v3, s[4:7], s26 offen offset:256 sc1
  v_or_b32 v172, 1, v172
  v_or_b32 v174, 1, v174
  buffer_store_dwordx4 v[172:175], v3, s[4:7], s25 offen offset:256 sc1
  v_or_b32 v176, 1, v176
  v_or_b32 v178, 1, v178
  buffer_store_dwordx4 v[176:179], v3, s[4:7], s26 offen offset:512 sc1
  v_or_b32 v180, 1, v180
  v_or_b32 v182, 1, v182
  buffer_store_dwordx4 v[180:183], v3, s[4:7], s25 offen offset:512 sc1
  s_mov_b64 exec, -1
  s_cmp_eq_u32 s79, 0
  s_cbranch_scc1 .g2_kernel_c_no
  s_lshl_b32 s20, s18, 15
  s_add_u32 s20, s20, 0x1190000
  s_lshl_b32 s22, s18, 11
  s_add_u32 s22, s22, s20
  v_lshlrev_b32 v16, 10, v2
  s_sleep 16
  s_mov_b32 s38, 0
  s_mov_b32 exec_hi, 0
.g2_kernel_gx52:
  buffer_load_dword v17, v16, s[4:7], s20 offen offset:752 sc1
  s_add_u32 s38, s38, 1
  s_waitcnt vmcnt(0)
  v_min_u32 v6, v17, v17
  v_cmp_eq_u32 vcc, 0, v6
  s_cbranch_vccz .g2_kernel_gx52d
  s_mov_b64 exec, vcc
  s_sleep 6
  s_cmp_lt_u32 s38, 131072
  s_cbranch_scc1 .g2_kernel_gx52
.g2_kernel_gx52d:
  s_mov_b64 exec, -1
  s_mov_b32 s38, 0
  s_bfm_b64 exec, 57, 0
.g2_kernel_gx53:
  s_mov_b32 s21, s20
  buffer_load_dwordx4 v[64:67], v3, s[4:7], s21 offen offset:0 sc1
  buffer_load_dwordx4 v[68:71], v3, s[4:7], s21 offen offset:1024 sc1
  buffer_load_dwordx4 v[72:75], v3, s[4:7], s21 offen offset:2048 sc1
  buffer_load_dwordx4 v[76:79], v3, s[4:7], s21 offen offset:3072 sc1
  s_add_u32 s21, s21, 4096
  buffer_load_dwordx4 v[80:83], v3, s[4:7], s21 offen offset:0 sc1
  buffer_load_dwordx4 v[84:87], v3, s[4:7], s21 offen offset:1024 sc1
  buffer_load_dwordx4 v[88:91], v3, s[4:7], s21 offen offset:2048 sc1
  buffer_load_dwordx4 v[92:95], v3, s[4:7], s21 offen offset:3072 sc1
  s_add_u32 s21, s21, 4096
  buffer_load_dwordx4 v[96:99], v3, s[4:7], s21 offen offset:0 sc1
  buffer_load_dwordx4 v[100:103], v3, s[4:7], s21 offen offset:1024 sc1
  buffer_load_dwordx4 v[104:107], v3, s[4:7], s21 offen offset:2048 sc1
  buffer_load_dwordx4 v[108:111], v3, s[4:7], s21 offen offset:3072 sc1
  s_add_u32 s21, s21, 4096
  buffer_load_dwordx4 v[112:115], v3, s[4:7], s21 offen offset:0 sc1
  buffer_load_dwordx4 v[116:119], v3, s[4:7], s21 offen offset:1024 sc1
  buffer_load_dwordx4 v[120:123], v3, s[4:7], s21 offen offset:2048 sc1
  buffer_load_dwordx4 v[124:127], v3, s[4:7], s21 offen offset:3072 sc1
  s_add_u32 s21, s21, 4096
  buffer_load_dwordx4 v[128:131], v3, s[4:7], s21 offen offset:0 sc1
  buffer_load_dwordx4 v[132:135], v3, s[4:7], s21 offen offset:1024 sc1
  buffer_load_dwordx4 v[136:139], v3, s[4:7], s21 offen offset:2048 sc1
  buffer_load_dwordx4 v[140:143], v3, s[4:7], s21 offen offset:3072 sc1
  s_add_u32 s21, s21, 4096
  buffer_load_dwordx4 v[144:147], v3, s[4:7], s21 offen offset:0 sc1
  buffer_load_dwordx4 v[148:151], v3, s[4:7], s21 offen offset:1024 sc1
  buffer_load_dwordx4 v[152:155], v3, s[4:7], s21 offen offset:2048 sc1
  buffer_load_dwordx4 v[156:159], v3, s[4:7], s21 offen offset:3072 sc1
  s_add_u32 s21, s21, 4096
  buffer_load_dwordx4 v[160:163], v3, s[4:7], s21 offen offset:0 sc1
  buffer_load_dwordx4 v[164:167], v3, s[4:7], s21 offen offset:1024 sc1
  buffer_load_dwordx4 v[168:171], v3, s[4:7], s21 offen offset:2048 sc1
  buffer_load_dwordx4 v[172:175], v3, s[4:7], s21 offen offset:3072 sc1
  s_add_u32 s21, s21, 4096
  buffer_load_dwordx4 v[176:179], v3, s[4:7], s21 offen offset:0 sc1
  buffer_load_dwordx4 v[180:183], v3, s[4:7], s21 offen offset:1024 sc1
  buffer_load_dwordx4 v[184:187], v3, s[4:7], s21 offen offset:2048 sc1
  buffer_load_dwordx4 v[188:191], v3, s[4:7], s21 offen offset:3072 sc1
  s_add_u32 s21, s21, 4096
  buffer_load_dwordx4 v[192:195], v3, s[4:7], s22 offen offset:0 sc1
  buffer_load_dwordx4 v[196:199], v3, s[4:7], s22 offen offset:1024 sc1
  s_add_u32 s38, s38, 1
  s_waitcnt vmcnt(0)
  v_min3_u32 v6, v64, v66, v68
  v_min3_u32 v6, v6, v70, v72
  v_min3_u32 v6, v6, v74, v76
  v_min3_u32 v6, v6, v78, v80
  v_min3_u32 v6, v6, v82, v84
  v_min3_u32 v6, v6, v86, v88
  v_min3_u32 v6, v6, v90, v92
  v_min3_u32 v6, v6, v94, v96
  v_min3_u32 v6, v6, v98, v100
  v_min3_u32 v6, v6, v102, v104
  v_min3_u32 v6, v6, v106, v108
  v_min3_u32 v6, v6, v110, v112
  v_min3_u32 v6, v6, v114, v116
  v_min3_u32 v6, v6, v118, v120
  v_min3_u32 v6, v6, v122, v124
  v_min3_u32 v6, v6, v126, v128
  v_min3_u32 v6, v6, v130, v132
  v_min3_u32 v6, v6, v134, v136
  v_min3_u32 v6, v6, v138, v140
  v_min3_u32 v6, v6, v142, v144
  v_min3_u32 v6, v6, v146, v148
  v_min3_u32 v6, v6, v150, v152
  v_min3_u32 v6, v6, v154, v156
  v_min3_u32 v6, v6, v158, v160
  v_min3_u32 v6, v6, v162, v164
  v_min3_u32 v6, v6, v166, v168
  v_min3_u32 v6, v6, v170, v172
  v_min3_u32 v6, v6, v174, v176
  v_min3_u32 v6, v6, v178, v180
  v_min3_u32 v6, v6, v182, v184
  v_min3_u32 v6, v6, v186, v188
  v_min3_u32 v6, v6, v190, v192
  v_min3_u32 v6, v6, v194, v196
  v_min_u32 v6, v6, v198
  v_cmp_eq_u32 vcc, 0, v6
  s_cbranch_vccz .g2_kernel_gx53d
  s_mov_b64 exec, vcc
  s_sleep 2
  s_cmp_lt_u32 s38, 131072
  s_cbranch_scc1 .g2_kernel_gx53
.g2_kernel_gx53d:
  s_mov_b64 exec, -1
  v_add_f32 v64, v64, v128
  v_add_f32 v65, v65, v129
  v_add_f32 v66, v66, v130
  v_add_f32 v67, v67, v131
  v_add_f32 v68, v68, v132
  v_add_f32 v69, v69, v133
  v_add_f32 v70, v70, v134
  v_add_f32 v71, v71, v135
  v_add_f32 v72, v72, v136
  v_add_f32 v73, v73, v137
  v_add_f32 v74, v74, v138
  v_add_f32 v75, v75, v139
  v_add_f32 v76, v76, v140
  v_add_f32 v77, v77, v141
  v_add_f32 v78, v78, v142
  v_add_f32 v79, v79, v143
  v_add_f32 v80, v80, v144
  v_add_f32 v81, v81, v145
  v_add_f32 v82, v82, v146
  v_add_f32 v83, v83, v147
  v_add_f32 v84, v84, v148
  v_add_f32 v85, v85, v149
  v_add_f32 v86, v86, v150
  v_add_f32 v87, v87, v151
  v_add_f32 v88, v88, v152
  v_add_f32 v89, v89, v153
  v_add_f32 v90, v90, v154
  v_add_f32 v91, v91, v155
  v_add_f32 v92, v92, v156
  v_add_f32 v93, v93, v157
  v_add_f32 v94, v94, v158
  v_add_f32 v95, v95, v159
  v_add_f32 v96, v96, v160
  v_add_f32 v97, v97, v161
  v_add_f32 v98, v98, v162
  v_add_f32 v99, v99, v163
  v_add_f32 v100, v100, v164
  v_add_f32 v101, v101, v165
  v_add_f32 v102, v102, v166
  v_add_f32 v103, v103, v167
  v_add_f32 v104, v104, v168
  v_add_f32 v105, v105, v169
  v_add_f32 v106, v106, v170
  v_add_f32 v107, v107, v171
  v_add_f32 v108, v108, v172
  v_add_f32 v109, v109, v173
  v_add_f32 v110, v110, v174
  v_add_f32 v111, v111, v175
  v_add_f32 v112, v112, v176
  v_add_f32 v113, v113, v177
  v_add_f32 v114, v114, v178
  v_add_f32 v115, v115, v179
  v_add_f32 v116, v116, v180
  v_add_f32 v117, v117, v181
  v_add_f32 v118, v118, v182
  v_add_f32 v119, v119, v183
  v_add_f32 v120, v120, v184
  v_add_f32 v121, v121, v185
  v_add_f32 v122, v122, v186
  v_add_f32 v123, v123, v187
  v_add_f32 v124, v124, v188
  v_add_f32 v125, v125, v189
  v_add_f32 v126, v126, v190
  v_add_f32 v127, v127, v191
  v_add_f32 v64, v64, v96
  v_add_f32 v65, v65, v97
  v_add_f32 v66, v66, v98
  v_add_f32 v67, v67, v99
  v_add_f32 v68, v68, v100
  v_add_f32 v69, v69, v101
  v_add_f32 v70, v70, v102
  v_add_f32 v71, v71, v103
  v_add_f32 v72, v72, v104
  v_add_f32 v73, v73, v105
  v_add_f32 v74, v74, v106
  v_add_f32 v75, v75, v107
  v_add_f32 v76, v76, v108
  v_add_f32 v77, v77, v109
  v_add_f32 v78, v78, v110
  v_add_f32 v79, v79, v111
  v_add_f32 v80, v80, v112
  v_add_f32 v81, v81, v113
  v_add_f32 v82, v82, v114
  v_add_f32 v83, v83, v115
  v_add_f32 v84, v84, v116
  v_add_f32 v85, v85, v117
  v_add_f32 v86, v86, v118
  v_add_f32 v87, v87, v119
  v_add_f32 v88, v88, v120
  v_add_f32 v89, v89, v121
  v_add_f32 v90, v90, v122
  v_add_f32 v91, v91, v123
  v_add_f32 v92, v92, v124
  v_add_f32 v93, v93, v125
  v_add_f32 v94, v94, v126
  v_add_f32 v95, v95, v127
  v_add_f32 v64, v64, v80
  v_add_f32 v65, v65, v81
  v_add_f32 v66, v66, v82
  v_add_f32 v67, v67, v83
  v_add_f32 v68, v68, v84
  v_add_f32 v69, v69, v85
  v_add_f32 v70, v70, v86
  v_add_f32 v71, v71, v87
  v_add_f32 v72, v72, v88
  v_add_f32 v73, v73, v89
  v_add_f32 v74, v74, v90
  v_add_f32 v75, v75, v91
  v_add_f32 v76, v76, v92
  v_add_f32 v77, v77, v93
  v_add_f32 v78, v78, v94
  v_add_f32 v79, v79, v95
  v_add_f32 v64, v64, v72
  v_add_f32 v65, v65, v73
  v_add_f32 v66, v66, v74
  v_add_f32 v67, v67, v75
  v_add_f32 v68, v68, v76
  v_add_f32 v69, v69, v77
  v_add_f32 v70, v70, v78
  v_add_f32 v71, v71, v79
  v_add_f32 v64, v64, v68
  v_add_f32 v65, v65, v69
  v_add_f32 v66, v66, v70
  v_add_f32 v67, v67, v71
  v_mov_b32 v28, 0.0009765625
  v_mov_b32 v30, 1e-05
  v_readlane_b32 s21, v64, 56
  v_readlane_b32 s22, v66, 56
  s_nop 0
  v_mul_f32 v20, s21, v28
  v_fma_f32 v21, s22, v28, v30
  v_fma_f32 v21, -v20, v20, v21
  v_rsq_f32 v21, abs(v21)
  v_sub_f32 v20, v61, v20
  v_mul_f32 v22, v21, v60
  v_mul_f32 v23, v21, v20
  v_and_b32 v10, 15, v2
  v_lshrrev_b32 v11, 4, v2
  v_lshlrev_b32 v16, 2, v10
  v_lshl_add_u32 v16, v11, 8, v16
  v_add_u32 v16, 155648, v16
  s_sub_u32 s20, s79, 1
  s_and_b32 s21, s20, 3
  s_lshl_b32 s21, s21, 2
  s_add_u32 s21, s21, 156160
  v_lshl_add_u32 v17, v10, 4, s21
  v_cmp_eq_u32 vcc, 2, v11
  v_mov_b32 v18, 64
  v_mov_b32 v19, 256
  v_cndmask_b32 v17, v16, v17, vcc
  v_cndmask_b32 v18, v18, v19, vcc
  v_lshrrev_b32 v24, 2, v10
  v_lshlrev_b32 v24, 9, v24
  v_and_b32 v25, 3, v10
  v_lshl_add_u32 v24, v25, 1, v24
  s_and_b32 s21, s20, 31
  s_lshl_b32 s22, s21, 4
  s_lshr_b32 s23, s20, 5
  s_lshl_b32 s24, s23, 11
  s_add_u32 s22, s22, s24
  s_add_u32 s22, s22, 131072
  v_add_u32 v26, s22, v24
  s_and_b32 s22, s21, 7
  s_and_b32 s24, s21, 8
  s_lshl_b32 s24, s24, 1
  s_add_u32 s22, s22, s24
  s_and_b32 s24, s21, 16
  s_lshr_b32 s24, s24, 1
  s_add_u32 s22, s22, s24
  s_lshl_b32 s22, s22, 4
  v_add_u32 v24, s22, v24
  s_bfe_u32 s22, s21, 0x20002
  s_lshl_b32 s22, s22, 9
  s_add_u32 s22, s22, s24
  s_and_b32 s24, s21, 3
  s_lshl_b32 s24, s24, 1
  s_add_u32 s22, s22, s24
  s_add_u32 s22, s22, 2048
  v_lshl_add_u32 v25, v10, 4, s22
  v_cndmask_b32 v24, v24, v25, vcc
  v_cndmask_b32 v19, 8, v19, vcc
  v_add_u32 v25, v24, v19
  s_lshl_b32 s22, s18, 7
  s_lshl_b32 s24, s17, 2
  s_add_u32 s22, s22, s24
  s_add_u32 s22, s22, s23
  s_lshl_b32 s22, s22, 12
  s_add_u32 s22, s22, 0x1800000
  s_add_u32 s23, s22, 262144
  s_lshr_b32 s24, s20, 6
  s_lshl_b32 s24, s24, 8
  s_add_u32 s24, s24, s76
  v_cmp_eq_u32 vcc, 0, v11
  v_mov_b32 v27, 0.25503486164919736
  s_nop 0
  v_cndmask_b32 v27, 1.0, v27, vcc
  v_mul_f32 v21, v21, v27
  v_mul_f32 v22, v22, v27
  v_mul_f32 v23, v23, v27
  s_mov_b32 s62, 1
  s_mov_b32 s63, 0x1800000
  s_mov_b32 s70, 2
  s_mov_b32 s71, 155776
  v_mov_b32 v6, s71
  s_mov_b32 s38, 0
.g2_kernel_wg54:
  ds_read_b32 v7, v6 offset:56
  s_add_u32 s38, s38, 1
  s_waitcnt lgkmcnt(0)
  v_cmp_gt_u32 vcc, 2, v7
  s_cbranch_vccz .g2_kernel_wg54d
  s_sleep 1
  s_cmp_lt_u32 s38, 524288
  s_cbranch_scc1 .g2_kernel_wg54
.g2_kernel_wg54d:
  ds_read_b32 v32, v17 offset:5632
  ds_read_b32 v36, v16 offset:4864
  v_add_u32 v17, v17, v18
  ds_read_b32 v33, v17 offset:5632
  ds_read_b32 v37, v16 offset:4928
  v_add_u32 v17, v17, v18
  ds_read_b32 v34, v17 offset:5632
  ds_read_b32 v38, v16 offset:4992
  v_add_u32 v17, v17, v18
  ds_read_b32 v35, v17 offset:5632
  ds_read_b32 v39, v16 offset:5056
  s_waitcnt lgkmcnt(0)
  v_mul_f32 v32, v32, v22
  v_fmac_f32 v32, v64, v21
  v_fmac_f32 v32, v36, v23
  v_mul_f32 v33, v33, v22
  v_fmac_f32 v33, v65, v21
  v_fmac_f32 v33, v37, v23
  v_mul_f32 v34, v34, v22
  v_fmac_f32 v34, v66, v21
  v_fmac_f32 v34, v38, v23
  v_mul_f32 v35, v35, v22
  v_fmac_f32 v35, v67, v21
  v_fmac_f32 v35, v39, v23
  v_cvt_pk_bf16_f32 v32, v32, v33
  v_cvt_pk_bf16_f32 v34, v34, v35
  v_mov_b32 v9, s71
  v_mov_b32 v8, 2
  s_mov_b32 exec_lo, 0xffff0000
  s_mov_b32 exec_hi, 0xffff
  buffer_store_short v32, v24, s[4:7], s22 offen sc1
  buffer_store_short_d16_hi v32, v25, s[4:7], s22 offen sc1
  buffer_store_short v34, v24, s[4:7], s23 offen sc1
  buffer_store_short_d16_hi v34, v25, s[4:7], s23 offen sc1
  s_mov_b64 exec, 0xffff
  ds_write_b16 v26, v32 offset:8192
  ds_write_b16_d16_hi v26, v32 offset:8200
  ds_write_b16 v26, v34
  ds_write_b16_d16_hi v26, v34 offset:8
  ds_write_b32 v9, v5 offset:60
  s_mov_b32 exec_lo, 0
  s_mov_b32 exec_hi, 0xff0000
  ds_write_b32 v16, v192 offset:6912
  ds_write_b32 v16, v193 offset:6976
  ds_write_b32 v16, v194 offset:7040
  ds_write_b32 v16, v195 offset:7104
  ds_write_b32 v16, v196 offset:6944
  ds_write_b32 v16, v197 offset:7008
  ds_write_b32 v16, v198 offset:7072
  ds_write_b32 v16, v199 offset:7136
  s_mov_b64 exec, 1
  s_waitcnt vmcnt(0)
  buffer_store_dword v8, v4, s[4:7], s24 offen sc1
  buffer_store_dword v8, v4, s[4:7], s24 offen offset:128 sc1
  s_mov_b64 exec, -1
  s_branch .g2_kernel_v
.g2_kernel_c_no:
  s_mov_b32 s62, 1
  s_mov_b32 s63, 0x1800000
  s_mov_b32 s70, 2
  s_mov_b32 s71, 155776
  s_branch .g2_kernel_v
.g2_kernel_c_t3:
  s_lshr_b32 s33, s77, 7
  s_lshl_b32 s28, s33, 2
  s_lshl_b64 s[8:9], 15, s28
  s_lshl_b32 s21, s17, 10
  s_add_u32 s21, s21, 0x2880000
  v_lshlrev_b32 v14, 3, v2
  v_add_u32 v14, 155648, v14
  v_mov_b32 v9, s71
  s_cmp_eq_u32 s33, s17
  s_cbranch_scc0 .g2_kernel_c_u1
  s_sleep 6
  s_call_b64 s[72:73], .g2_kernel_c_ph2
  s_branch .g2_kernel_c_u2
.g2_kernel_c_u1:
  v_mov_b32 v6, s71
  s_mov_b32 s38, 0
.g2_kernel_wg55:
  ds_read_b32 v7, v6 offset:36
  s_add_u32 s38, s38, 1
  s_waitcnt lgkmcnt(0)
  v_cmp_gt_u32 vcc, 1, v7
  s_cbranch_vccz .g2_kernel_wg55d
  s_sleep 1
  s_cmp_lt_u32 s38, 524288
  s_cbranch_scc1 .g2_kernel_wg55
.g2_kernel_wg55d:
  ds_read_b32 v7, v6 offset:36
  ds_read_b32 v6, v6 offset:104
  s_waitcnt lgkmcnt(0)
  v_readfirstlane_b32 s77, v7
  v_readfirstlane_b32 s29, v6
  s_lshl_b32 s29, s29, 5
  s_add_u32 s77, s77, s29
  s_sub_u32 s77, s77, 1
.g2_kernel_c_u2:
  s_mov_b32 s38, 0
.g2_kernel_gx56:
  buffer_load_dwordx4 v[16:19], v3, s[4:7], s21 offen sc1
  s_add_u32 s38, s38, 1
  s_waitcnt vmcnt(0)
  v_min_u32 v6, v17, v19
  v_cmp_eq_u32 vcc, 0, v6
  s_cbranch_vccz .g2_kernel_gx56d
  s_mov_b64 exec, vcc
  s_cmp_lt_u32 s38, 131072
  s_cbranch_scc1 .g2_kernel_gx56
.g2_kernel_gx56d:
  s_mov_b64 exec, -1
  v_rsq_f32 v22, v17
  v_rsq_f32 v23, v19
  v_add_f32 v52, 1.0, v22
  v_mul_f32 v54, v16, v22
  v_sub_f32 v54, 0, v54
  v_add_f32 v53, 1.0, v23
  v_mul_f32 v55, v18, v23
  v_sub_f32 v55, 0, v55
  ds_write_b64 v14, v[52:53] offset:3840
  ds_write_b64 v14, v[54:55] offset:4352
  s_lshr_b32 s28, s77, 7
  s_and_b32 s79, s77, 127
  s_add_u32 s79, s79, 1
  s_cmp_eq_u32 s28, s17
  s_cselect_b32 s79, s79, 0
  v_mov_b32 v15, s79
  v_mov_b32 v8, 2
  ds_write_b32 v9, v15 offset:32
  ds_write_b32 v9, v8 offset:28
  s_cmp_eq_u32 s33, s17
  s_cbranch_scc1 .g2_kernel_fin
  s_sleep 28
  s_mov_b32 s39, 1
  s_call_b64 s[72:73], .g2_kernel_c_ph2
  s_branch .g2_kernel_fin
.g2_kernel_c_ph2:
  s_call_b64 s[68:69], .g2_kernel_amax
  v_mov_b32 v6, s71
  s_mov_b32 s38, 0
.g2_kernel_wg57:
  ds_read_b32 v7, v6 offset:36
  s_add_u32 s38, s38, 1
  s_waitcnt lgkmcnt(0)
  v_cmp_gt_u32 vcc, 1, v7
  s_cbranch_vccz .g2_kernel_wg57d
  s_cmp_lt_u32 s38, 524288
  s_cbranch_scc1 .g2_kernel_wg57
.g2_kernel_wg57d:
  ds_read_b32 v8, v9 offset:96
  ds_read_b32 v7, v6 offset:36
  ds_read_b32 v6, v6 offset:104
  s_waitcnt lgkmcnt(0)
  v_readfirstlane_b32 s28, v7
  v_readfirstlane_b32 s29, v6
  s_lshl_b32 s29, s29, 5
  s_add_u32 s28, s28, s29
  s_sub_u32 s28, s28, 1
  s_add_u32 s29, s77, 2
  s_waitcnt lgkmcnt(0)
  v_cmp_gt_f32 vcc, s27, v8
  s_cmp_lg_u64 vcc, 0
  s_cselect_b32 s77, s77, s28
  s_cselect_b32 s29, s29, 1
  v_mov_b32 v10, s29
  v_mov_b32 v11, s27
  ds_write_b64 v9, v[10:11] offset:88
  s_setpc_b64 s[72:73]
.g2_kernel_c2:
  s_cmp_lg_u32 s62, 0
  s_cbranch_scc1 .g2_kernel_d_a
  s_cmp_lg_u32 s16, 7
  s_cbranch_scc1 .g2_kernel_d_a
  v_mov_b32 v6, s71
  s_mov_b32 s38, 0
.g2_kernel_wg60:
  ds_read_b32 v7, v6 offset:20
  s_add_u32 s38, s38, 1
  s_waitcnt lgkmcnt(0)
  v_cmp_gt_u32 vcc, 4, v7
  s_cbranch_vccz .g2_kernel_wg60d
  s_sleep 2
  s_cmp_lt_u32 s38, 524288
  s_cbranch_scc1 .g2_kernel_wg60
.g2_kernel_wg60d:
  s_sleep 20
  s_and_b32 s31, s19, 0xffffe000
  s_add_u32 s31, s31, 8
  v_and_b32 v6, 15, v2
  v_lshlrev_b32 v6, 9, v6
  v_lshrrev_b32 v7, 4, v2
  v_lshl_add_u32 v6, v7, 7, v6
  v_lshlrev_b32 v7, 2, v2
  v_add_u32 v7, 158208, v7
  s_mov_b32 m0, 158208
  s_mov_b32 s38, 0
.g2_kernel_pa61:
  buffer_load_dword v6, s[4:7], s31 offen sc1 lds
  s_add_u32 s38, s38, 1
  s_waitcnt vmcnt(0)
  ds_read_b32 v8, v7
  s_waitcnt lgkmcnt(0)
  v_cmp_ge_u32 vcc, s62, v8
  s_cbranch_vccz .g2_kernel_pa61d
  s_mov_b64 exec, vcc
  s_sleep 10
  s_cmp_lt_u32 s38, 131072
  s_cbranch_scc1 .g2_kernel_pa61
.g2_kernel_pa61d:
  s_mov_b64 exec, -1
.g2_kernel_d_a:
  s_setprio 2
  s_and_b32 s20, s16, 1
  v_bfe_u32 v8, v2, 1, 3
  v_lshlrev_b32 v8, 14, v8
  v_and_b32 v9, 1, v2
  v_lshl_add_u32 v8, v9, 10, v8
  v_lshrrev_b32 v9, 4, v2
  v_lshl_add_u32 v8, v9, 8, v8
  v_and_b32 v9, 15, v2
  v_lshlrev_b32 v9, 4, v9
  s_lshl_b32 s28, s20, 8
  s_add_u32 s28, s28, 156672
  v_add_u32 v10, s28, v9
  v_xor_b32 v11, 256, v10
  s_lshl_b32 s28, s20, 2
  s_add_u32 s28, s28, s71
  v_mov_b32 v12, s28
  v_xor_b32 v13, 4, v12
  s_lshl_b32 s26, s74, 1
  s_add_u32 s26, s26, s20
  s_lshl_b32 s26, s26, 11
  s_add_u32 s26, s26, s63
  s_add_u32 s26, s26, 0x1090000
  s_mov_b32 s32, 0
  s_mov_b32 s39, 0
  s_lshl_b32 s28, s62, 3
  s_add_u32 s28, s28, s16
  s_cmp_lg_u32 s28, 14
  s_cbranch_scc1 .g2_kernel_d_w
  s_lshr_b32 s33, s77, 7
  s_lshl_b32 s28, s33, 2
  s_lshl_b64 s[8:9], 15, s28
  s_not_b64 s[8:9], s[8:9]
  s_and_b32 s28, s2, 7
  s_lshl_b32 s28, s28, 13
  s_add_u32 s23, s28, 0x3050000
  s_cmp_eq_u32 s33, s17
  s_cbranch_scc1 .g2_kernel_d_v
  v_mov_b32 v6, s71
  s_mov_b32 s38, 0
.g2_kernel_wg62:
  ds_read_b32 v7, v6 offset:20
  s_add_u32 s38, s38, 1
  s_waitcnt lgkmcnt(0)
  v_cmp_gt_u32 vcc, 4, v7
  s_cbranch_vccz .g2_kernel_wg62d
  s_sleep 1
  s_cmp_lt_u32 s38, 524288
  s_cbranch_scc1 .g2_kernel_wg62
.g2_kernel_wg62d:
.g2_kernel_d_v:
  s_sleep 60
  s_call_b64 s[68:69], .g2_kernel_amax
  s_add_u32 s28, s77, 1
  v_mov_b32 v6, s27
  v_mov_b32 v7, s28
  ds_write_b32 v12, v6 offset:96
  ds_write_b32 v12, v7 offset:36
  s_waitcnt lgkmcnt(0)
  s_wakeup
  s_branch .g2_kernel_d_r
.g2_kernel_d_w:
  v_mov_b32 v6, s71
  s_mov_b32 s38, 0
.g2_kernel_wg63:
  ds_read_b32 v7, v6 offset:36
  s_add_u32 s38, s38, 1
  s_waitcnt lgkmcnt(0)
  v_cmp_gt_u32 vcc, 1, v7
  s_cbranch_vccz .g2_kernel_wg63d
  s_sleep 4
  s_cmp_lt_u32 s38, 524288
  s_cbranch_scc1 .g2_kernel_wg63
.g2_kernel_wg63d:
  ds_read_b32 v7, v6 offset:36
  ds_read_b32 v6, v6 offset:104
  s_waitcnt lgkmcnt(0)
  v_readfirstlane_b32 s77, v7
  v_readfirstlane_b32 s29, v6
  s_lshl_b32 s29, s29, 5
  s_add_u32 s77, s77, s29
  s_sub_u32 s77, s77, 1
.g2_kernel_d_r:
  s_and_b32 s77, s77, 2047
  s_lshr_b32 s24, s77, 7
  s_lshl_b32 s24, s24, 18
  s_bfe_u32 s28, s77, 0x30004
  s_lshl_b32 s28, s28, 11
  s_add_u32 s24, s24, s28
  s_and_b32 s28, s77, 15
  s_lshl_b32 s28, s28, 4
  s_add_u32 s24, s24, s28
  s_add_u32 s24, s24, s63
  s_add_u32 s24, s24, 0xc00000
  s_lshl_b32 s28, s17, 14
  s_add_u32 s21, s24, s28
  s_and_b32 s28, s18, 8
  s_lshl_b32 s28, s28, 5
  s_add_u32 s21, s21, s28
  s_and_b32 s28, s18, 7
  s_lshl_b32 s28, s28, 1
  s_add_u32 s21, s21, s28
  s_lshl_b32 s28, s20, 17
  s_add_u32 s24, s24, s28
  buffer_load_dwordx4 v[16:19], v8, s[4:7], s24 offen
  buffer_load_ushort v56, v4, s[4:7], s21 offen
  buffer_load_ushort v57, v4, s[4:7], s21 offen offset:512
  buffer_load_ushort v58, v4, s[4:7], s21 offen offset:1024
  buffer_load_ushort v59, v4, s[4:7], s21 offen offset:1536
  s_lshl_b32 s25, s77, 3
  s_add_u32 s25, s25, s63
  s_add_u32 s25, s25, 0x1080000
  s_mov_b32 s38, 0
.g2_kernel_gx64:
  buffer_load_dwordx2 v[20:21], v4, s[4:7], s25 offen sc1
  s_add_u32 s38, s38, 1
  s_waitcnt vmcnt(0)
  v_min_u32 v6, v21, v21
  v_cmp_eq_u32 vcc, 0, v6
  s_cbranch_vccz .g2_kernel_gx64d
  s_mov_b64 exec, vcc
  s_sleep 1
  s_cmp_lt_u32 s38, 131072
  s_cbranch_scc1 .g2_kernel_gx64
.g2_kernel_gx64d:
  s_mov_b64 exec, -1
  v_rsq_f32 v21, v21
  v_lshlrev_b32 v24, 16, v16
  v_and_b32 v25, 0xffff0000, v16
  v_lshlrev_b32 v26, 16, v17
  v_and_b32 v27, 0xffff0000, v17
  v_lshlrev_b32 v28, 16, v18
  v_and_b32 v29, 0xffff0000, v18
  v_lshlrev_b32 v30, 16, v19
  v_and_b32 v31, 0xffff0000, v19
  v_mul_f32 v20, v20, v21
  v_mov_b32 v60, v20
  v_add_f32 v61, 1.0, v21
  s_cmp_ge_u32 s74, 224
  s_cbranch_scc1 .g2_kernel_d_none
  v_fma_f32 v24, v24, v21, -v20
  v_fma_f32 v25, v25, v21, -v20
  v_fma_f32 v26, v26, v21, -v20
  v_fma_f32 v27, v27, v21, -v20
  v_fma_f32 v28, v28, v21, -v20
  v_fma_f32 v29, v29, v21, -v20
  v_fma_f32 v30, v30, v21, -v20
  v_fma_f32 v31, v31, v21, -v20
  v_cvt_pk_bf16_f32 v16, v24, v25
  v_cvt_pk_bf16_f32 v17, v26, v27
  v_cvt_pk_bf16_f32 v18, v28, v29
  v_cvt_pk_bf16_f32 v19, v30, v31
  v_mov_b32 v24, v16 row_newbcast:0 row_mask:0xf bank_mask:0xf
  v_mov_b32 v25, v17 row_newbcast:0 row_mask:0xf bank_mask:0xf
  v_mov_b32 v26, v18 row_newbcast:0 row_mask:0xf bank_mask:0xf
  v_mov_b32 v27, v19 row_newbcast:0 row_mask:0xf bank_mask:0xf
  v_mov_b32 v28, v16 row_newbcast:1 row_mask:0xf bank_mask:0xf
  v_mov_b32 v29, v17 row_newbcast:1 row_mask:0xf bank_mask:0xf
  v_mov_b32 v30, v18 row_newbcast:1 row_mask:0xf bank_mask:0xf
  v_mov_b32 v31, v19 row_newbcast:1 row_mask:0xf bank_mask:0xf
  v_mfma_f32_16x16x32_bf16 v[32:35], v[24:27], v[64:67], 0
  v_mfma_f32_16x16x32_bf16 v[36:39], v[24:27], v[128:131], 0
  v_mov_b32 v24, v16 row_newbcast:2 row_mask:0xf bank_mask:0xf
  v_mov_b32 v25, v17 row_newbcast:2 row_mask:0xf bank_mask:0xf
  v_mov_b32 v26, v18 row_newbcast:2 row_mask:0xf bank_mask:0xf
  v_mov_b32 v27, v19 row_newbcast:2 row_mask:0xf bank_mask:0xf
  v_mfma_f32_16x16x32_bf16 v[32:35], v[28:31], v[68:71], v[32:35]
  v_mfma_f32_16x16x32_bf16 v[36:39], v[28:31], v[132:135], v[36:39]
  v_mov_b32 v28, v16 row_newbcast:3 row_mask:0xf bank_mask:0xf
  v_mov_b32 v29, v17 row_newbcast:3 row_mask:0xf bank_mask:0xf
  v_mov_b32 v30, v18 row_newbcast:3 row_mask:0xf bank_mask:0xf
  v_mov_b32 v31, v19 row_newbcast:3 row_mask:0xf bank_mask:0xf
  v_mfma_f32_16x16x32_bf16 v[32:35], v[24:27], v[72:75], v[32:35]
  v_mfma_f32_16x16x32_bf16 v[36:39], v[24:27], v[136:139], v[36:39]
  v_mov_b32 v24, v16 row_newbcast:4 row_mask:0xf bank_mask:0xf
  v_mov_b32 v25, v17 row_newbcast:4 row_mask:0xf bank_mask:0xf
  v_mov_b32 v26, v18 row_newbcast:4 row_mask:0xf bank_mask:0xf
  v_mov_b32 v27, v19 row_newbcast:4 row_mask:0xf bank_mask:0xf
  v_mfma_f32_16x16x32_bf16 v[32:35], v[28:31], v[76:79], v[32:35]
  v_mfma_f32_16x16x32_bf16 v[36:39], v[28:31], v[140:143], v[36:39]
  v_mov_b32 v28, v16 row_newbcast:5 row_mask:0xf bank_mask:0xf
  v_mov_b32 v29, v17 row_newbcast:5 row_mask:0xf bank_mask:0xf
  v_mov_b32 v30, v18 row_newbcast:5 row_mask:0xf bank_mask:0xf
  v_mov_b32 v31, v19 row_newbcast:5 row_mask:0xf bank_mask:0xf
  v_mfma_f32_16x16x32_bf16 v[32:35], v[24:27], v[80:83], v[32:35]
  v_mfma_f32_16x16x32_bf16 v[36:39], v[24:27], v[144:147], v[36:39]
  v_mov_b32 v24, v16 row_newbcast:6 row_mask:0xf bank_mask:0xf
  v_mov_b32 v25, v17 row_newbcast:6 row_mask:0xf bank_mask:0xf
  v_mov_b32 v26, v18 row_newbcast:6 row_mask:0xf bank_mask:0xf
  v_mov_b32 v27, v19 row_newbcast:6 row_mask:0xf bank_mask:0xf
  v_mfma_f32_16x16x32_bf16 v[32:35], v[28:31], v[84:87], v[32:35]
  v_mfma_f32_16x16x32_bf16 v[36:39], v[28:31], v[148:151], v[36:39]
  v_mov_b32 v28, v16 row_newbcast:7 row_mask:0xf bank_mask:0xf
  v_mov_b32 v29, v17 row_newbcast:7 row_mask:0xf bank_mask:0xf
  v_mov_b32 v30, v18 row_newbcast:7 row_mask:0xf bank_mask:0xf
  v_mov_b32 v31, v19 row_newbcast:7 row_mask:0xf bank_mask:0xf
  v_mfma_f32_16x16x32_bf16 v[32:35], v[24:27], v[88:91], v[32:35]
  v_mfma_f32_16x16x32_bf16 v[36:39], v[24:27], v[152:155], v[36:39]
  v_mov_b32 v24, v16 row_newbcast:8 row_mask:0xf bank_mask:0xf
  v_mov_b32 v25, v17 row_newbcast:8 row_mask:0xf bank_mask:0xf
  v_mov_b32 v26, v18 row_newbcast:8 row_mask:0xf bank_mask:0xf
  v_mov_b32 v27, v19 row_newbcast:8 row_mask:0xf bank_mask:0xf
  v_mfma_f32_16x16x32_bf16 v[32:35], v[28:31], v[92:95], v[32:35]
  v_mfma_f32_16x16x32_bf16 v[36:39], v[28:31], v[156:159], v[36:39]
  v_mov_b32 v28, v16 row_newbcast:9 row_mask:0xf bank_mask:0xf
  v_mov_b32 v29, v17 row_newbcast:9 row_mask:0xf bank_mask:0xf
  v_mov_b32 v30, v18 row_newbcast:9 row_mask:0xf bank_mask:0xf
  v_mov_b32 v31, v19 row_newbcast:9 row_mask:0xf bank_mask:0xf
  v_mfma_f32_16x16x32_bf16 v[32:35], v[24:27], v[96:99], v[32:35]
  v_mfma_f32_16x16x32_bf16 v[36:39], v[24:27], v[160:163], v[36:39]
  v_mov_b32 v24, v16 row_newbcast:10 row_mask:0xf bank_mask:0xf
  v_mov_b32 v25, v17 row_newbcast:10 row_mask:0xf bank_mask:0xf
  v_mov_b32 v26, v18 row_newbcast:10 row_mask:0xf bank_mask:0xf
  v_mov_b32 v27, v19 row_newbcast:10 row_mask:0xf bank_mask:0xf
  v_mfma_f32_16x16x32_bf16 v[32:35], v[28:31], v[100:103], v[32:35]
  v_mfma_f32_16x16x32_bf16 v[36:39], v[28:31], v[164:167], v[36:39]
  v_mov_b32 v28, v16 row_newbcast:11 row_mask:0xf bank_mask:0xf
  v_mov_b32 v29, v17 row_newbcast:11 row_mask:0xf bank_mask:0xf
  v_mov_b32 v30, v18 row_newbcast:11 row_mask:0xf bank_mask:0xf
  v_mov_b32 v31, v19 row_newbcast:11 row_mask:0xf bank_mask:0xf
  v_mfma_f32_16x16x32_bf16 v[32:35], v[24:27], v[104:107], v[32:35]
  v_mfma_f32_16x16x32_bf16 v[36:39], v[24:27], v[168:171], v[36:39]
  v_mov_b32 v24, v16 row_newbcast:12 row_mask:0xf bank_mask:0xf
  v_mov_b32 v25, v17 row_newbcast:12 row_mask:0xf bank_mask:0xf
  v_mov_b32 v26, v18 row_newbcast:12 row_mask:0xf bank_mask:0xf
  v_mov_b32 v27, v19 row_newbcast:12 row_mask:0xf bank_mask:0xf
  v_mfma_f32_16x16x32_bf16 v[32:35], v[28:31], v[108:111], v[32:35]
  v_mfma_f32_16x16x32_bf16 v[36:39], v[28:31], v[172:175], v[36:39]
  v_mov_b32 v28, v16 row_newbcast:13 row_mask:0xf bank_mask:0xf
  v_mov_b32 v29, v17 row_newbcast:13 row_mask:0xf bank_mask:0xf
  v_mov_b32 v30, v18 row_newbcast:13 row_mask:0xf bank_mask:0xf
  v_mov_b32 v31, v19 row_newbcast:13 row_mask:0xf bank_mask:0xf
  v_mfma_f32_16x16x32_bf16 v[32:35], v[24:27], v[112:115], v[32:35]
  v_mfma_f32_16x16x32_bf16 v[36:39], v[24:27], v[176:179], v[36:39]
  v_mov_b32 v24, v16 row_newbcast:14 row_mask:0xf bank_mask:0xf
  v_mov_b32 v25, v17 row_newbcast:14 row_mask:0xf bank_mask:0xf
  v_mov_b32 v26, v18 row_newbcast:14 row_mask:0xf bank_mask:0xf
  v_mov_b32 v27, v19 row_newbcast:14 row_mask:0xf bank_mask:0xf
  v_mfma_f32_16x16x32_bf16 v[32:35], v[28:31], v[116:119], v[32:35]
  v_mfma_f32_16x16x32_bf16 v[36:39], v[28:31], v[180:183], v[36:39]
  v_mov_b32 v28, v16 row_newbcast:15 row_mask:0xf bank_mask:0xf
  v_mov_b32 v29, v17 row_newbcast:15 row_mask:0xf bank_mask:0xf
  v_mov_b32 v30, v18 row_newbcast:15 row_mask:0xf bank_mask:0xf
  v_mov_b32 v31, v19 row_newbcast:15 row_mask:0xf bank_mask:0xf
  v_mfma_f32_16x16x32_bf16 v[32:35], v[24:27], v[120:123], v[32:35]
  v_mfma_f32_16x16x32_bf16 v[36:39], v[24:27], v[184:187], v[36:39]
  v_mfma_f32_16x16x32_bf16 v[32:35], v[28:31], v[124:127], v[32:35]
  v_mfma_f32_16x16x32_bf16 v[36:39], v[28:31], v[188:191], v[36:39]
  s_mov_b32 s38, 0
  s_add_u32 s36, s32, s62
  s_add_u32 s28, s36, 1
  v_mov_b32 v18, s28
  s_mov_b32 s28, 0x00010001
  s_mov_b32 s29, 0x00100010
  s_nop 0
  v_and_or_b32 v14, v32, -4, v18
  v_and_or_b32 v15, v36, -4, v18
  ds_write_b64 v10, v[14:15]
.g2_kernel_d_x:
  ds_read_b64 v[16:17], v11
  s_add_u32 s38, s38, 1
  s_waitcnt lgkmcnt(0)
  v_and_b32 v18, 3, v16
  v_and_b32 v19, 3, v17
  v_min_u32 v18, v18, v19
  v_cmp_ge_u32 vcc, s36, v18
  s_cbranch_vccz .g2_kernel_d_xd
  s_cmp_lt_u32 s38, 524288
  s_cbranch_scc1 .g2_kernel_d_x
.g2_kernel_d_xd:
  v_add_f32 v16, v16, v14
  v_add_f32 v17, v17, v15
  v_mul_f32 v18, -1.4426950408889634, v16
  v_exp_f32 v18, v18
  v_mul_f32 v16, v16, v17
  v_add_f32 v18, 1.0, v18
  v_rcp_f32 v18, v18
  s_nop 0
  v_mul_f32 v16, v16, v18
  s_nop 1
  v_mov_b32 v17, v16 quad_perm:[1,0,3,2] row_mask:0xf bank_mask:0xf
  v_cvt_pk_bf16_f32 v16, v16, v17
  s_nop 1
  v_mov_b32 v20, v16 row_newbcast:0 row_mask:0x5 bank_mask:0xf
  v_mov_b32 v21, v16 row_newbcast:2 row_mask:0x5 bank_mask:0xf
  v_mov_b32 v22, v16 row_newbcast:4 row_mask:0x5 bank_mask:0xf
  v_mov_b32 v23, v16 row_newbcast:6 row_mask:0x5 bank_mask:0xf
  v_mov_b32 v20, v16 row_newbcast:8 row_mask:0xa bank_mask:0xf
  v_mov_b32 v21, v16 row_newbcast:10 row_mask:0xa bank_mask:0xf
  v_mov_b32 v22, v16 row_newbcast:12 row_mask:0xa bank_mask:0xf
  v_mov_b32 v23, v16 row_newbcast:14 row_mask:0xa bank_mask:0xf
  v_cndmask_b32 v24, 0, v20, s[28:29]
  v_cndmask_b32 v25, 0, v21, s[28:29]
  v_cndmask_b32 v26, 0, v22, s[28:29]
  v_cndmask_b32 v27, 0, v23, s[28:29]
  s_lshl_b64 s[28:29], s[28:29], 1
  s_nop 0
  v_mfma_f32_16x16x32_bf16 v[40:43], v[24:27], v[192:195], 0
  v_mfma_f32_16x16x32_bf16 v[44:47], v[24:27], v[208:211], 0
  v_mfma_f32_16x16x32_bf16 v[48:51], v[24:27], v[224:227], 0
  v_mfma_f32_16x16x32_bf16 v[52:55], v[24:27], v[240:243], 0
  v_cndmask_b32 v28, 0, v20, s[28:29]
  v_cndmask_b32 v29, 0, v21, s[28:29]
  v_cndmask_b32 v30, 0, v22, s[28:29]
  v_cndmask_b32 v31, 0, v23, s[28:29]
  s_lshl_b64 s[28:29], s[28:29], 1
  s_nop 0
  v_mfma_f32_16x16x32_bf16 v[40:43], v[28:31], v[196:199], v[40:43]
  v_mfma_f32_16x16x32_bf16 v[44:47], v[28:31], v[212:215], v[44:47]
  v_mfma_f32_16x16x32_bf16 v[48:51], v[28:31], v[228:231], v[48:51]
  v_mfma_f32_16x16x32_bf16 v[52:55], v[28:31], v[244:247], v[52:55]
  v_cndmask_b32 v32, 0, v20, s[28:29]
  v_cndmask_b32 v33, 0, v21, s[28:29]
  v_cndmask_b32 v34, 0, v22, s[28:29]
  v_cndmask_b32 v35, 0, v23, s[28:29]
  s_lshl_b64 s[28:29], s[28:29], 1
  s_nop 0
  v_mfma_f32_16x16x32_bf16 v[40:43], v[32:35], v[200:203], v[40:43]
  v_mfma_f32_16x16x32_bf16 v[44:47], v[32:35], v[216:219], v[44:47]
  v_mfma_f32_16x16x32_bf16 v[48:51], v[32:35], v[232:235], v[48:51]
  v_mfma_f32_16x16x32_bf16 v[52:55], v[32:35], v[248:251], v[52:55]
  v_cndmask_b32 v36, 0, v20, s[28:29]
  v_cndmask_b32 v37, 0, v21, s[28:29]
  v_cndmask_b32 v38, 0, v22, s[28:29]
  v_cndmask_b32 v39, 0, v23, s[28:29]
  s_lshl_b64 s[28:29], s[28:29], 1
  s_nop 0
  v_mfma_f32_16x16x32_bf16 v[40:43], v[36:39], v[204:207], v[40:43]
  v_mfma_f32_16x16x32_bf16 v[44:47], v[36:39], v[220:223], v[44:47]
  v_mfma_f32_16x16x32_bf16 v[48:51], v[36:39], v[236:239], v[48:51]
  v_mfma_f32_16x16x32_bf16 v[52:55], v[36:39], v[252:255], v[52:55]
  s_mov_b32 exec_hi, 0
  s_nop 3
  v_or_b32 v40, 1, v40
  v_or_b32 v42, 1, v42
  buffer_store_dwordx4 v[40:43], v3, s[4:7], s26 offen offset:0 sc1
  v_or_b32 v44, 1, v44
  v_or_b32 v46, 1, v46
  buffer_store_dwordx4 v[44:47], v3, s[4:7], s26 offen offset:512 sc1
  v_or_b32 v48, 1, v48
  v_or_b32 v50, 1, v50
  buffer_store_dwordx4 v[48:51], v3, s[4:7], s26 offen offset:1024 sc1
  v_or_b32 v52, 1, v52
  v_or_b32 v54, 1, v54
  buffer_store_dwordx4 v[52:55], v3, s[4:7], s26 offen offset:1536 sc1
  s_mov_b64 exec, -1
  s_branch .g2_kernel_d_e
.g2_kernel_d_none:
  s_sleep 24
.g2_kernel_d_e:
  s_add_u32 m0, s71, 112
  s_mov_b32 s29, .g2_kernel_tab-.g2_kernel_pc+4
  s_mov_b64 exec, 1
  buffer_load_dword off, s[64:67], s29 lds
  s_mov_b64 exec, -1
  s_cmp_lg_u32 s62, 0
  s_cbranch_scc1 .g2_kernel_d_t
  s_mov_b32 s62, 1
  s_mov_b32 s63, 0x1800000
  s_mov_b32 s70, 2
  s_mov_b32 s71, 155776
  s_branch .g2_kernel_v
.g2_kernel_d_t:
  s_cmp_lg_u32 s20, 0
  s_cbranch_scc1 .g2_kernel_d_t1
  v_mov_b32 v62, -1.4426950408889634
  v_mul_f32 v62, s27, v62
  v_exp_f32 v62, v62
  v_lshlrev_b32 v14, 12, v2
  v_min_u32 v15, 126976, v14
  s_lshl_b32 s21, s17, 4
  s_add_u32 s21, s21, s18
  s_lshl_b32 s21, s21, 4
  s_mul_i32 s22, s32, 0x270000
  s_add_u32 s21, s21, s22
  s_add_u32 s21, s21, 0x2890000
  s_add_u32 s22, s21, 262144
  s_add_u32 s24, s21, 524288
  s_add_u32 s25, s21, 786432
  v_add_f32 v62, 1.0, v62
  v_rcp_f32 v62, v62
  v_lshlrev_b32 v56, 16, v56
  v_fma_f32 v56, v56, v61, -v60
  v_lshlrev_b32 v57, 16, v57
  v_fma_f32 v57, v57, v61, -v60
  v_lshlrev_b32 v58, 16, v58
  v_fma_f32 v58, v58, v61, -v60
  v_lshlrev_b32 v59, 16, v59
  v_fma_f32 v59, v59, v61, -v60
  s_sleep 8
  s_mov_b32 s38, 0
.g2_kernel_gx65:
  buffer_load_dwordx4 v[16:19], v14, s[4:7], s21 offen sc1
  buffer_load_dwordx4 v[20:23], v14, s[4:7], s22 offen sc1
  buffer_load_dwordx4 v[24:27], v14, s[4:7], s24 offen sc1
  buffer_load_dwordx4 v[28:31], v15, s[4:7], s25 offen sc1
  s_add_u32 s38, s38, 1
  s_waitcnt vmcnt(0)
  v_min3_u32 v6, v16, v18, v20
  v_min3_u32 v6, v6, v22, v24
  v_min3_u32 v6, v6, v26, v28
  v_min_u32 v6, v6, v30
  v_cmp_eq_u32 vcc, 0, v6
  s_cbranch_vccz .g2_kernel_gx65d
  s_mov_b64 exec, vcc
  s_cmp_lt_u32 s38, 131072
  s_cbranch_scc1 .g2_kernel_gx65
.g2_kernel_gx65d:
  s_mov_b64 exec, -1
  v_add_f32 v16, v16, v20
  v_add_f32 v17, v17, v21
  v_add_f32 v18, v18, v22
  v_add_f32 v19, v19, v23
  s_mov_b32 exec_hi, 0
  v_add_f32 v24, v24, v28
  v_add_f32 v25, v25, v29
  v_add_f32 v26, v26, v30
  v_add_f32 v27, v27, v31
  s_mov_b64 exec, -1
  v_add_f32 v16, v16, v24
  v_add_f32 v17, v17, v25
  v_add_f32 v18, v18, v26
  v_add_f32 v19, v19, v27
  v_add_f32 v16, v16, v16 row_ror:8 row_mask:0xf bank_mask:0xf
  v_add_f32 v17, v17, v17 row_ror:8 row_mask:0xf bank_mask:0xf
  v_add_f32 v18, v18, v18 row_ror:8 row_mask:0xf bank_mask:0xf
  v_add_f32 v19, v19, v19 row_ror:8 row_mask:0xf bank_mask:0xf
  v_add_f32 v16, v16, v16 row_ror:4 row_mask:0xf bank_mask:0xf
  v_add_f32 v17, v17, v17 row_ror:4 row_mask:0xf bank_mask:0xf
  v_add_f32 v18, v18, v18 row_ror:4 row_mask:0xf bank_mask:0xf
  v_add_f32 v19, v19, v19 row_ror:4 row_mask:0xf bank_mask:0xf
  v_add_f32 v16, v16, v16 row_ror:2 row_mask:0xf bank_mask:0xf
  v_add_f32 v17, v17, v17 row_ror:2 row_mask:0xf bank_mask:0xf
  v_add_f32 v18, v18, v18 row_ror:2 row_mask:0xf bank_mask:0xf
  v_add_f32 v19, v19, v19 row_ror:2 row_mask:0xf bank_mask:0xf
  v_add_f32 v16, v16, v16 row_ror:1 row_mask:0xf bank_mask:0xf
  v_add_f32 v17, v17, v17 row_ror:1 row_mask:0xf bank_mask:0xf
  v_add_f32 v18, v18, v18 row_ror:1 row_mask:0xf bank_mask:0xf
  v_add_f32 v19, v19, v19 row_ror:1 row_mask:0xf bank_mask:0xf
  v_add_f32 v16, v16, v16 row_bcast:15 row_mask:0xa bank_mask:0xf
  v_add_f32 v17, v17, v17 row_bcast:15 row_mask:0xa bank_mask:0xf
  v_add_f32 v18, v18, v18 row_bcast:15 row_mask:0xa bank_mask:0xf
  v_add_f32 v19, v19, v19 row_bcast:15 row_mask:0xa bank_mask:0xf
  v_add_f32 v16, v16, v16 row_bcast:31 row_mask:0xc bank_mask:0xf
  v_add_f32 v17, v17, v17 row_bcast:31 row_mask:0xc bank_mask:0xf
  v_add_f32 v18, v18, v18 row_bcast:31 row_mask:0xc bank_mask:0xf
  v_add_f32 v19, v19, v19 row_bcast:31 row_mask:0xc bank_mask:0xf
  s_lshl_b32 s24, s77, 11
  s_lshl_b32 s25, s17, 7
  s_add_u32 s24, s24, s25
  s_lshl_b32 s25, s18, 1
  s_add_u32 s24, s24, s25
.g2_kernel_d_t1:
  v_mov_b32 v6, s71
  s_mov_b32 s38, 0
.g2_kernel_wg66:
  ds_read_b32 v7, v6 offset:88
  s_add_u32 s38, s38, 1
  s_waitcnt lgkmcnt(0)
  v_cmp_gt_u32 vcc, 1, v7
  s_cbranch_vccz .g2_kernel_wg66d
  s_cmp_lt_u32 s38, 524288
  s_cbranch_scc1 .g2_kernel_wg66
.g2_kernel_wg66d:
  ds_read_b32 v6, v6 offset:92
  v_readfirstlane_b32 s33, v7
  s_cmp_lg_u32 s32, 0
  s_cselect_b32 s33, 1, s33
  s_cmp_lg_u32 s20, 0
  s_cbranch_scc1 .g2_kernel_d_t2
  s_cmp_lg_u32 s33, 1
  s_cbranch_scc1 .g2_kernel_d_t4
  v_fmac_f32 v56, v16, v62
  v_fmac_f32 v57, v17, v62
  v_fmac_f32 v58, v18, v62
  v_fmac_f32 v59, v19, v62
.g2_kernel_d_t4:
  s_mov_b32 s28, s56
  s_mov_b32 s29, s57
  s_mov_b32 s30, 0x400000
  s_mov_b32 s31, 0x00020000
  v_cvt_pk_bf16_f32 v56, v56, v57
  v_cvt_pk_bf16_f32 v58, v58, v59
  s_mov_b32 exec_lo, 0
  s_mov_b32 exec_hi, 0x80000000
  buffer_store_short v56, v4, s[28:31], s24 offen
  buffer_store_short_d16_hi v56, v4, s[28:31], s24 offen offset:32
  buffer_store_short v58, v4, s[28:31], s24 offen offset:64
  buffer_store_short_d16_hi v58, v4, s[28:31], s24 offen offset:96
  s_mov_b64 exec, -1
.g2_kernel_d_t2:
  s_cmp_eq_u32 s33, 1
  s_cbranch_scc1 .g2_kernel_fin
  s_waitcnt vmcnt(0) lgkmcnt(0)
  v_readfirstlane_b32 s27, v6
  s_sub_u32 s77, s33, 2
  s_mov_b32 s32, 1
  s_add_u32 s26, s26, 0x270000
  s_branch .g2_kernel_d_r
.g2_kernel_fin1:
.g2_kernel_fin:
.g2_kernel_end:
  s_endpgm
.g2_kernel_q_i2:
  v_mov_b32 v6, 155648
  s_mov_b32 s38, 0
.g2_kernel_wg1:
  ds_read_b32 v7, v6 offset:20
  s_add_u32 s38, s38, 1
  s_waitcnt lgkmcnt(0)
  v_cmp_gt_u32 vcc, 4, v7
  s_cbranch_vccz .g2_kernel_wg1d
  s_cmp_lt_u32 s38, 524288
  s_cbranch_scc1 .g2_kernel_wg1
.g2_kernel_wg1d:
  s_branch .g2_kernel_q_i3
.g2_kernel_q_spin:
  s_mov_b32 s38, 0
.g2_kernel_q_spinl:
  ds_read_b32 v151, v150
  s_add_u32 s38, s38, 1
  s_waitcnt lgkmcnt(0)
  v_cmp_lt_i32 vcc, s33, v151
  s_cbranch_vccnz .g2_kernel_q_spinr
  s_cmp_lt_u32 s38, 524288
  s_cbranch_scc1 .g2_kernel_q_spinl
.g2_kernel_q_spinr:
  s_setpc_b64 s[68:69]
.g2_kernel_q_wf:
  s_call_b64 s[68:69], .g2_kernel_q_spin
  s_branch .g2_kernel_q_backf
.g2_kernel_q_w7:
  s_call_b64 s[68:69], .g2_kernel_q_spin
  s_branch .g2_kernel_q_back7
.g2_kernel_q_w0:
  s_call_b64 s[68:69], .g2_kernel_q_spin
  s_branch .g2_kernel_q_back0
.g2_kernel_q_w1:
  s_call_b64 s[68:69], .g2_kernel_q_spin
  s_branch .g2_kernel_q_back1
.g2_kernel_q_w2:
  s_call_b64 s[68:69], .g2_kernel_q_spin
  s_branch .g2_kernel_q_back2
.g2_kernel_q_w3:
  s_call_b64 s[68:69], .g2_kernel_q_spin
  s_branch .g2_kernel_q_back3
.g2_kernel_q_w4:
  s_call_b64 s[68:69], .g2_kernel_q_spin
  s_branch .g2_kernel_q_back4
.g2_kernel_q_w5:
  s_call_b64 s[68:69], .g2_kernel_q_spin
  s_branch .g2_kernel_q_back5
.g2_kernel_q_w6:
  s_call_b64 s[68:69], .g2_kernel_q_spin
  s_branch .g2_kernel_q_back6
.g2_kernel_q_cons2:
  s_lshr_b32 s26, s16, 1
  s_lshl_b32 s26, s26, 13
  v_add_u32 v144, s26, v3
  v_add_u32 v145, 1024, v144
  s_branch .g2_kernel_q_cs
.g2_kernel_q_wl:
  s_call_b64 s[68:69], .g2_kernel_q_spin
  s_branch .g2_kernel_q_bl
.g2_kernel_q_v0ew:
  v_mov_b32 v6, s71
  s_mov_b32 s38, 0
.g2_kernel_wg2:
  ds_read_b32 v7, v6 offset:0
  s_add_u32 s38, s38, 1
  s_waitcnt lgkmcnt(0)
  v_cmp_gt_u32 vcc, 2, v7
  s_cbranch_vccz .g2_kernel_wg2d
  s_cmp_lt_u32 s38, 524288
  s_cbranch_scc1 .g2_kernel_wg2
.g2_kernel_wg2d:
  ds_read_b32 v57, v13 offset:24
  ds_read_b128 v[40:43], v52 offset:5120
  ds_read_b128 v[44:47], v52 offset:5184
  ds_read_b32 v24, v50 offset:2816
  ds_read_b32 v25, v50 offset:3328
  ds_read_b32 v26, v50 offset:2880
  ds_read_b32 v27, v50 offset:3392
  ds_read_b32 v28, v50 offset:2944
  ds_read_b32 v29, v50 offset:3456
  ds_read_b32 v30, v50 offset:3008
  ds_read_b32 v31, v50 offset:3520
  s_waitcnt lgkmcnt(0)
  s_branch .g2_kernel_q_v0eb
.g2_kernel_q_v0p:
  v_readfirstlane_b32 s35, v57
  s_sub_u32 s28, s35, 1
  s_lshr_b32 s29, s28, 6
  s_lshr_b32 s30, s16, 1
  s_add_u32 s35, s35, 0x100
  s_cmp_lg_u32 s29, s30
  s_cbranch_scc1 .g2_kernel_q_v0pb
  s_add_u32 s35, s35, 0x100
  s_and_b32 s29, s28, 15
  s_mov_b32 s14, 0x00010001
  s_mov_b32 s15, 0x00010001
  s_lshl_b64 s[14:15], s[14:15], s29
  s_and_b32 s29, s28, 12
  s_lshl_b32 s29, s29, 2
  s_lshl_b64 s[30:31], 0xffff, s29
  s_bfe_u32 s29, s28, 0x20004
  s_branch .g2_kernel_q_v0s
.g2_kernel_q_v0s:
  v_subrev_u32 v6, 155648, v53
  v_lshlrev_b32 v6, 2, v6
  v_add_u32 v6, 155648, v6
  s_cmp_lg_u32 s29, 0
  s_cbranch_scc1 .g2_kernel_q_v0s1
  s_mov_b64 exec, s[14:15]
  ds_write_b128 v52, v[192:195] offset:5888
  ds_write_b128 v52, v[208:211] offset:5952
  s_mov_b64 exec, -1
  s_waitcnt lgkmcnt(0)
  s_branch .g2_kernel_q_v0pb
.g2_kernel_q_v0s1:
  s_cmp_lg_u32 s29, 1
  s_cbranch_scc1 .g2_kernel_q_v0s2
  s_mov_b64 exec, s[14:15]
  ds_write_b128 v52, v[196:199] offset:5888
  ds_write_b128 v52, v[212:215] offset:5952
  s_mov_b64 exec, -1
  s_waitcnt lgkmcnt(0)
  s_branch .g2_kernel_q_v0pb
.g2_kernel_q_v0s2:
  s_cmp_lg_u32 s29, 2
  s_cbranch_scc1 .g2_kernel_q_v0s3
  s_mov_b64 exec, s[14:15]
  ds_write_b128 v52, v[200:203] offset:5888
  ds_write_b128 v52, v[216:219] offset:5952
  s_mov_b64 exec, -1
  s_waitcnt lgkmcnt(0)
  s_branch .g2_kernel_q_v0pb
.g2_kernel_q_v0s3:
  s_mov_b64 exec, s[14:15]
  ds_write_b128 v52, v[204:207] offset:5888
  ds_write_b128 v52, v[220:223] offset:5952
  s_mov_b64 exec, -1
  s_waitcnt lgkmcnt(0)
  s_branch .g2_kernel_q_v0pb
.g2_kernel_q_v0f:
  s_mov_b64 exec, 1
  s_cmp_ge_u32 s35, 0x200
  s_cbranch_scc1 .g2_kernel_q_v0f1
  buffer_store_dword v15, v4, s[4:7], s37 offen sc1
  s_mov_b64 exec, -1
  s_branch .g2_kernel_q_v0fb
.g2_kernel_q_v0f1:
  ds_add_u32 v13, v5 offset:56
  s_mov_b64 exec, -1
  s_branch .g2_kernel_q_v0fb
.g2_kernel_q_v0fw:
  s_mov_b32 s38, 0
.g2_kernel_q_v0fl:
  ds_read_b32 v63, v58
  s_add_u32 s38, s38, 1
  s_waitcnt lgkmcnt(0)
  v_cmp_gt_u32 vcc, s12, v63
  s_cbranch_vccz .g2_kernel_q_v0fc
  s_cmp_lt_u32 s38, 524288
  s_cbranch_scc1 .g2_kernel_q_v0fl
  s_branch .g2_kernel_q_v0fc
.g2_kernel_q_v0r:
  v_subrev_u32 v6, 155648, v53
  v_lshlrev_b32 v6, 2, v6
  v_add_u32 v6, 155648, v6
  s_cmp_lg_u32 s29, 0
  s_cbranch_scc1 .g2_kernel_q_v0r1
  s_mov_b64 exec, s[14:15]
  ds_write_b128 v52, v[160:163] offset:5632
  ds_write_b128 v52, v[176:179] offset:5696
  s_mov_b64 exec, s[30:31]
  ds_write_b128 v6, v[224:227] offset:6144
  ds_write_b128 v6, v[240:243] offset:6400
  s_mov_b64 exec, -1
  s_waitcnt lgkmcnt(0)
  s_branch .g2_kernel_q_v0rb
.g2_kernel_q_v0r1:
  s_cmp_lg_u32 s29, 1
  s_cbranch_scc1 .g2_kernel_q_v0r2
  s_mov_b64 exec, s[14:15]
  ds_write_b128 v52, v[164:167] offset:5632
  ds_write_b128 v52, v[180:183] offset:5696
  s_mov_b64 exec, s[30:31]
  ds_write_b128 v6, v[228:231] offset:6144
  ds_write_b128 v6, v[244:247] offset:6400
  s_mov_b64 exec, -1
  s_waitcnt lgkmcnt(0)
  s_branch .g2_kernel_q_v0rb
.g2_kernel_q_v0r2:
  s_cmp_lg_u32 s29, 2
  s_cbranch_scc1 .g2_kernel_q_v0r3
  s_mov_b64 exec, s[14:15]
  ds_write_b128 v52, v[168:171] offset:5632
  ds_write_b128 v52, v[184:187] offset:5696
  s_mov_b64 exec, s[30:31]
  ds_write_b128 v6, v[232:235] offset:6144
  ds_write_b128 v6, v[248:251] offset:6400
  s_mov_b64 exec, -1
  s_waitcnt lgkmcnt(0)
  s_branch .g2_kernel_q_v0rb
.g2_kernel_q_v0r3:
  s_mov_b64 exec, s[14:15]
  ds_write_b128 v52, v[172:175] offset:5632
  ds_write_b128 v52, v[188:191] offset:5696
  s_mov_b64 exec, s[30:31]
  ds_write_b128 v6, v[236:239] offset:6144
  ds_write_b128 v6, v[252:255] offset:6400
  s_mov_b64 exec, -1
  s_waitcnt lgkmcnt(0)
  s_branch .g2_kernel_q_v0rb
.g2_kernel_q_v1ew:
  v_mov_b32 v6, s71
  s_mov_b32 s38, 0
.g2_kernel_wg3:
  ds_read_b32 v7, v6 offset:0
  s_add_u32 s38, s38, 1
  s_waitcnt lgkmcnt(0)
  v_cmp_gt_u32 vcc, 2, v7
  s_cbranch_vccz .g2_kernel_wg3d
  s_cmp_lt_u32 s38, 524288
  s_cbranch_scc1 .g2_kernel_wg3
.g2_kernel_wg3d:
  ds_read_b32 v57, v13 offset:24
  ds_read_b128 v[24:27], v51 offset:2816
  ds_read_b128 v[32:35], v51 offset:3328
  ds_read_b128 v[28:31], v51 offset:2880
  ds_read_b128 v[36:39], v51 offset:3392
  ds_read_b128 v[40:43], v51 offset:2944
  ds_read_b128 v[88:91], v51 offset:3456
  ds_read_b128 v[44:47], v51 offset:3008
  ds_read_b128 v[92:95], v51 offset:3520
  ds_read_b32 v48, v53 offset:5376
  ds_read_b32 v49, v53 offset:5440
  s_waitcnt lgkmcnt(0)
  s_branch .g2_kernel_q_v1eb
.g2_kernel_q_v1p:
  v_readfirstlane_b32 s35, v57
  s_sub_u32 s28, s35, 1
  s_lshr_b32 s29, s28, 6
  s_lshr_b32 s30, s16, 1
  s_add_u32 s35, s35, 0x100
  s_cmp_lg_u32 s29, s30
  s_cbranch_scc1 .g2_kernel_q_v1pb
  s_add_u32 s35, s35, 0x100
  s_and_b32 s29, s28, 15
  s_mov_b32 s14, 0x00010001
  s_mov_b32 s15, 0x00010001
  s_lshl_b64 s[14:15], s[14:15], s29
  s_and_b32 s29, s28, 12
  s_lshl_b32 s29, s29, 2
  s_lshl_b64 s[30:31], 0xffff, s29
  s_bfe_u32 s29, s28, 0x20004
  s_branch .g2_kernel_q_v1s
.g2_kernel_q_v1s:
  v_subrev_u32 v6, 155648, v53
  v_lshlrev_b32 v6, 2, v6
  v_add_u32 v6, 155648, v6
  s_cmp_lg_u32 s29, 0
  s_cbranch_scc1 .g2_kernel_q_v1s1
  s_mov_b64 exec, s[30:31]
  ds_write_b128 v6, v[224:227] offset:6144
  ds_write_b128 v6, v[240:243] offset:6400
  s_mov_b64 exec, -1
  s_waitcnt lgkmcnt(0)
  s_branch .g2_kernel_q_v1pb
.g2_kernel_q_v1s1:
  s_cmp_lg_u32 s29, 1
  s_cbranch_scc1 .g2_kernel_q_v1s2
  s_mov_b64 exec, s[30:31]
  ds_write_b128 v6, v[228:231] offset:6144
  ds_write_b128 v6, v[244:247] offset:6400
  s_mov_b64 exec, -1
  s_waitcnt lgkmcnt(0)
  s_branch .g2_kernel_q_v1pb
.g2_kernel_q_v1s2:
  s_cmp_lg_u32 s29, 2
  s_cbranch_scc1 .g2_kernel_q_v1s3
  s_mov_b64 exec, s[30:31]
  ds_write_b128 v6, v[232:235] offset:6144
  ds_write_b128 v6, v[248:251] offset:6400
  s_mov_b64 exec, -1
  s_waitcnt lgkmcnt(0)
  s_branch .g2_kernel_q_v1pb
.g2_kernel_q_v1s3:
  s_mov_b64 exec, s[30:31]
  ds_write_b128 v6, v[236:239] offset:6144
  ds_write_b128 v6, v[252:255] offset:6400
  s_mov_b64 exec, -1
  s_waitcnt lgkmcnt(0)
  s_branch .g2_kernel_q_v1pb
.g2_kernel_q_v1f:
  s_mov_b64 exec, 1
  s_cmp_ge_u32 s35, 0x200
  s_cbranch_scc1 .g2_kernel_q_v1f1
  buffer_store_dword v15, v4, s[4:7], s37 offen sc1
  s_mov_b64 exec, -1
  s_branch .g2_kernel_q_v1fb
.g2_kernel_q_v1f1:
  ds_add_u32 v13, v5 offset:56
  s_mov_b64 exec, -1
  s_branch .g2_kernel_q_v1fb
.g2_kernel_q_v1fw:
  s_mov_b32 s38, 0
.g2_kernel_q_v1fl:
  ds_read_b32 v63, v58
  s_add_u32 s38, s38, 1
  s_waitcnt lgkmcnt(0)
  v_cmp_gt_u32 vcc, s12, v63
  s_cbranch_vccz .g2_kernel_q_v1fc
  s_cmp_lt_u32 s38, 524288
  s_cbranch_scc1 .g2_kernel_q_v1fl
  s_branch .g2_kernel_q_v1fc
.g2_kernel_q_v1r:
  v_subrev_u32 v6, 155648, v53
  v_lshlrev_b32 v6, 2, v6
  v_add_u32 v6, 155648, v6
  s_cmp_lg_u32 s29, 0
  s_cbranch_scc1 .g2_kernel_q_v1r1
  s_mov_b64 exec, s[14:15]
  ds_write_b128 v52, v[160:163] offset:5632
  ds_write_b128 v52, v[176:179] offset:5696
  s_mov_b64 exec, s[14:15]
  ds_write_b128 v52, v[192:195] offset:5888
  ds_write_b128 v52, v[208:211] offset:5952
  s_mov_b64 exec, -1
  s_waitcnt lgkmcnt(0)
  s_branch .g2_kernel_q_v1rb
.g2_kernel_q_v1r1:
  s_cmp_lg_u32 s29, 1
  s_cbranch_scc1 .g2_kernel_q_v1r2
  s_mov_b64 exec, s[14:15]
  ds_write_b128 v52, v[164:167] offset:5632
  ds_write_b128 v52, v[180:183] offset:5696
  s_mov_b64 exec, s[14:15]
  ds_write_b128 v52, v[196:199] offset:5888
  ds_write_b128 v52, v[212:215] offset:5952
  s_mov_b64 exec, -1
  s_waitcnt lgkmcnt(0)
  s_branch .g2_kernel_q_v1rb
.g2_kernel_q_v1r2:
  s_cmp_lg_u32 s29, 2
  s_cbranch_scc1 .g2_kernel_q_v1r3
  s_mov_b64 exec, s[14:15]
  ds_write_b128 v52, v[168:171] offset:5632
  ds_write_b128 v52, v[184:187] offset:5696
  s_mov_b64 exec, s[14:15]
  ds_write_b128 v52, v[200:203] offset:5888
  ds_write_b128 v52, v[216:219] offset:5952
  s_mov_b64 exec, -1
  s_waitcnt lgkmcnt(0)
  s_branch .g2_kernel_q_v1rb
.g2_kernel_q_v1r3:
  s_mov_b64 exec, s[14:15]
  ds_write_b128 v52, v[172:175] offset:5632
  ds_write_b128 v52, v[188:191] offset:5696
  s_mov_b64 exec, s[14:15]
  ds_write_b128 v52, v[204:207] offset:5888
  ds_write_b128 v52, v[220:223] offset:5952
  s_mov_b64 exec, -1
  s_waitcnt lgkmcnt(0)
  s_branch .g2_kernel_q_v1rb
.g2_kernel_q_v1:
  v_mfma_f32_16x16x32_bf16 v[224:227], v[64:67], v[96:99], v[224:227]
  ds_read_b64_tr_b16 v[80:81], v148 offset:45056
  ds_read_b64_tr_b16 v[82:83], v148 offset:45568
  ds_read_b128 v[128:131], v145 offset:49152
  v_mfma_f32_16x16x32_bf16 v[228:231], v[68:71], v[96:99], v[228:231]
  ds_read_b128 v[132:135], v145 offset:51200
  ds_read_b128 v[136:139], v145 offset:53248
  ds_read_b128 v[140:143], v145 offset:55296
  v_mfma_f32_16x16x32_bf16 v[232:235], v[72:75], v[96:99], v[232:235]
  ds_read_b64_tr_b16 v[84:85], v149 offset:45056
  ds_read_b64_tr_b16 v[86:87], v149 offset:45568
  ds_read_b32 v63, v13 offset:0
  v_mfma_f32_16x16x32_bf16 v[236:239], v[76:79], v[96:99], v[236:239]
  ds_read_b32 v57, v13 offset:24
  ds_read_b128 v[24:27], v51 offset:2816
  ds_read_b128 v[32:35], v51 offset:3328
  v_mfma_f32_16x16x32_bf16 v[252:255], v[76:79], v[100:103], v[252:255]
  ds_read_b128 v[28:31], v51 offset:2880
  ds_read_b128 v[36:39], v51 offset:3392
  ds_read_b128 v[40:43], v51 offset:2944
  v_mfma_f32_16x16x32_bf16 v[248:251], v[72:75], v[100:103], v[248:251]
  ds_read_b128 v[88:91], v51 offset:3456
  ds_read_b128 v[44:47], v51 offset:3008
  ds_read_b128 v[92:95], v51 offset:3520
  v_mfma_f32_16x16x32_bf16 v[244:247], v[68:71], v[100:103], v[244:247]
  ds_read_b32 v48, v53 offset:5376
  ds_read_b32 v49, v53 offset:5440
  v_mfma_f32_16x16x32_bf16 v[240:243], v[64:67], v[100:103], v[240:243]
  s_waitcnt lgkmcnt(12)
  v_mfma_f32_16x16x32_bf16 v[224:227], v[128:131], v[80:83], v[224:227]
  v_mfma_f32_16x16x32_bf16 v[228:231], v[132:135], v[80:83], v[228:231]
  v_mfma_f32_16x16x32_bf16 v[232:235], v[136:139], v[80:83], v[232:235]
  v_mfma_f32_16x16x32_bf16 v[236:239], v[140:143], v[80:83], v[236:239]
  v_mfma_f32_16x16x32_bf16 v[252:255], v[140:143], v[84:87], v[252:255]
  v_mfma_f32_16x16x32_bf16 v[248:251], v[136:139], v[84:87], v[248:251]
  v_mfma_f32_16x16x32_bf16 v[244:247], v[132:135], v[84:87], v[244:247]
  v_mfma_f32_16x16x32_bf16 v[240:243], v[128:131], v[84:87], v[240:243]
  s_waitcnt lgkmcnt(0)
  v_cmp_gt_u32 vcc, 2, v63
  s_cbranch_vccnz .g2_kernel_q_v1ew
.g2_kernel_q_v1eb:
  ds_read_b64_tr_b16 v[120:121], v148 offset:24576
  ds_read_b64_tr_b16 v[122:123], v148 offset:25088
  ds_read_b128 v[104:107], v144 offset:49152
  ds_read_b128 v[108:111], v144 offset:51200
  ds_read_b128 v[112:115], v144 offset:53248
  ds_read_b128 v[116:119], v144 offset:55296
  ds_read_b64_tr_b16 v[124:125], v149 offset:24576
  ds_read_b64_tr_b16 v[126:127], v149 offset:25088
  ds_read_b64_tr_b16 v[128:129], v148 offset:28672
  ds_read_b64_tr_b16 v[130:131], v148 offset:29184
  ds_read_b64_tr_b16 v[132:133], v149 offset:28672
  ds_read_b64_tr_b16 v[134:135], v149 offset:29184
  v_cmp_ne_u32 vcc, 0, v57
  s_cbranch_vccnz .g2_kernel_q_v1p
.g2_kernel_q_v1pb:
  v_pk_mul_f32 v[152:153], v[32:33], v[48:49] op_sel:[0,0] op_sel_hi:[1,0]
  v_pk_mul_f32 v[154:155], v[34:35], v[48:49] op_sel:[0,0] op_sel_hi:[1,0]
  v_pk_mul_f32 v[156:157], v[36:37], v[48:49] op_sel:[0,0] op_sel_hi:[1,0]
  v_pk_mul_f32 v[158:159], v[38:39], v[48:49] op_sel:[0,0] op_sel_hi:[1,0]
  v_pk_fma_f32 v[224:225], v[224:225], v[24:25], v[152:153]
  v_pk_fma_f32 v[226:227], v[226:227], v[26:27], v[154:155]
  v_pk_fma_f32 v[228:229], v[228:229], v[28:29], v[156:157]
  v_pk_fma_f32 v[230:231], v[230:231], v[30:31], v[158:159]
  v_cvt_pk_bf16_f32 v224, v224, v225
  v_cvt_pk_bf16_f32 v225, v226, v227
  v_cvt_pk_bf16_f32 v226, v228, v229
  v_cvt_pk_bf16_f32 v227, v230, v231
  buffer_store_dwordx4 v[224:227], v55, s[4:7], s8 offen offset:2048 sc1
  v_pk_mul_f32 v[152:153], v[32:33], v[48:49] op_sel:[0,1] op_sel_hi:[1,1]
  v_pk_mul_f32 v[154:155], v[34:35], v[48:49] op_sel:[0,1] op_sel_hi:[1,1]
  v_pk_mul_f32 v[156:157], v[36:37], v[48:49] op_sel:[0,1] op_sel_hi:[1,1]
  v_pk_mul_f32 v[158:159], v[38:39], v[48:49] op_sel:[0,1] op_sel_hi:[1,1]
  v_pk_fma_f32 v[240:241], v[240:241], v[24:25], v[152:153]
  v_pk_fma_f32 v[242:243], v[242:243], v[26:27], v[154:155]
  v_pk_fma_f32 v[244:245], v[244:245], v[28:29], v[156:157]
  v_pk_fma_f32 v[246:247], v[246:247], v[30:31], v[158:159]
  v_cvt_pk_bf16_f32 v240, v240, v241
  v_cvt_pk_bf16_f32 v241, v242, v243
  v_cvt_pk_bf16_f32 v242, v244, v245
  v_cvt_pk_bf16_f32 v243, v246, v247
  buffer_store_dwordx4 v[240:243], v55, s[4:7], s8 offen offset:2304 sc1
  v_pk_mul_f32 v[152:153], v[88:89], v[48:49] op_sel:[0,0] op_sel_hi:[1,0]
  v_pk_mul_f32 v[154:155], v[90:91], v[48:49] op_sel:[0,0] op_sel_hi:[1,0]
  v_pk_mul_f32 v[156:157], v[92:93], v[48:49] op_sel:[0,0] op_sel_hi:[1,0]
  v_pk_mul_f32 v[158:159], v[94:95], v[48:49] op_sel:[0,0] op_sel_hi:[1,0]
  v_pk_fma_f32 v[232:233], v[232:233], v[40:41], v[152:153]
  v_pk_fma_f32 v[234:235], v[234:235], v[42:43], v[154:155]
  v_pk_fma_f32 v[236:237], v[236:237], v[44:45], v[156:157]
  v_pk_fma_f32 v[238:239], v[238:239], v[46:47], v[158:159]
  v_cvt_pk_bf16_f32 v232, v232, v233
  v_cvt_pk_bf16_f32 v233, v234, v235
  v_cvt_pk_bf16_f32 v234, v236, v237
  v_cvt_pk_bf16_f32 v235, v238, v239
  buffer_store_dwordx4 v[232:235], v55, s[4:7], s9 offen offset:2048 sc1
  v_pk_mul_f32 v[152:153], v[88:89], v[48:49] op_sel:[0,1] op_sel_hi:[1,1]
  v_pk_mul_f32 v[154:155], v[90:91], v[48:49] op_sel:[0,1] op_sel_hi:[1,1]
  v_pk_mul_f32 v[156:157], v[92:93], v[48:49] op_sel:[0,1] op_sel_hi:[1,1]
  v_pk_mul_f32 v[158:159], v[94:95], v[48:49] op_sel:[0,1] op_sel_hi:[1,1]
  v_pk_fma_f32 v[248:249], v[248:249], v[40:41], v[152:153]
  v_pk_fma_f32 v[250:251], v[250:251], v[42:43], v[154:155]
  v_pk_fma_f32 v[252:253], v[252:253], v[44:45], v[156:157]
  v_pk_fma_f32 v[254:255], v[254:255], v[46:47], v[158:159]
  v_cvt_pk_bf16_f32 v248, v248, v249
  v_cvt_pk_bf16_f32 v249, v250, v251
  v_cvt_pk_bf16_f32 v250, v252, v253
  v_cvt_pk_bf16_f32 v251, v254, v255
  buffer_store_dwordx4 v[248:251], v55, s[4:7], s9 offen offset:2304 sc1
  s_waitcnt lgkmcnt(0)
  v_mfma_f32_16x16x32_bf16 v[160:163], v[120:123], v[104:107], v[160:163]
  ds_read_b64_tr_b16 v[80:81], v148 offset:36864
  ds_read_b64_tr_b16 v[82:83], v148 offset:37376
  v_mfma_f32_16x16x32_bf16 v[164:167], v[120:123], v[108:111], v[164:167]
  ds_read_b128 v[64:67], v145 offset:49152
  ds_read_b128 v[68:71], v145 offset:51200
  v_mfma_f32_16x16x32_bf16 v[168:171], v[120:123], v[112:115], v[168:171]
  ds_read_b128 v[72:75], v145 offset:53248
  ds_read_b128 v[76:79], v145 offset:55296
  v_mfma_f32_16x16x32_bf16 v[172:175], v[120:123], v[116:119], v[172:175]
  ds_read_b64_tr_b16 v[84:85], v149 offset:36864
  ds_read_b64_tr_b16 v[86:87], v149 offset:37376
  v_mfma_f32_16x16x32_bf16 v[188:191], v[124:127], v[116:119], v[188:191]
  ds_read_b64_tr_b16 v[88:89], v148 offset:40960
  ds_read_b64_tr_b16 v[90:91], v148 offset:41472
  v_mfma_f32_16x16x32_bf16 v[184:187], v[124:127], v[112:115], v[184:187]
  ds_read_b64_tr_b16 v[92:93], v149 offset:40960
  ds_read_b64_tr_b16 v[94:95], v149 offset:41472
  v_mfma_f32_16x16x32_bf16 v[180:183], v[124:127], v[108:111], v[180:183]
  ds_read_b128 v[32:35], v52 offset:4864
  ds_read_b128 v[36:39], v52 offset:4928
  v_mfma_f32_16x16x32_bf16 v[176:179], v[124:127], v[104:107], v[176:179]
  ds_read_b128 v[40:43], v52 offset:5120
  ds_read_b128 v[44:47], v52 offset:5184
  v_mfma_f32_16x16x32_bf16 v[192:195], v[128:131], v[104:107], v[192:195]
  v_mfma_f32_16x16x32_bf16 v[196:199], v[128:131], v[108:111], v[196:199]
  v_mfma_f32_16x16x32_bf16 v[200:203], v[128:131], v[112:115], v[200:203]
  v_mfma_f32_16x16x32_bf16 v[204:207], v[128:131], v[116:119], v[204:207]
  v_mfma_f32_16x16x32_bf16 v[220:223], v[132:135], v[116:119], v[220:223]
  v_mfma_f32_16x16x32_bf16 v[216:219], v[132:135], v[112:115], v[216:219]
  v_mfma_f32_16x16x32_bf16 v[212:215], v[132:135], v[108:111], v[212:215]
  v_mfma_f32_16x16x32_bf16 v[208:211], v[132:135], v[104:107], v[208:211]
  s_waitcnt lgkmcnt(0)
  v_mfma_f32_16x16x32_bf16 v[160:163], v[80:83], v[64:67], v[160:163]
  ds_read_b32 v63, v58
  ds_read_b32 v24, v50 offset:2816
  v_mfma_f32_16x16x32_bf16 v[164:167], v[80:83], v[68:71], v[164:167]
  ds_read_b32 v25, v50 offset:3328
  ds_read_b32 v26, v50 offset:2880
  v_mfma_f32_16x16x32_bf16 v[168:171], v[80:83], v[72:75], v[168:171]
  ds_read_b32 v27, v50 offset:3392
  ds_read_b32 v28, v50 offset:2944
  v_mfma_f32_16x16x32_bf16 v[172:175], v[80:83], v[76:79], v[172:175]
  ds_read_b32 v29, v50 offset:3456
  ds_read_b32 v30, v50 offset:3008
  v_mfma_f32_16x16x32_bf16 v[188:191], v[84:87], v[76:79], v[188:191]
  ds_read_b32 v31, v50 offset:3520
  v_mfma_f32_16x16x32_bf16 v[184:187], v[84:87], v[72:75], v[184:187]
  v_mfma_f32_16x16x32_bf16 v[180:183], v[84:87], v[68:71], v[180:183]
  v_mfma_f32_16x16x32_bf16 v[176:179], v[84:87], v[64:67], v[176:179]
  v_mfma_f32_16x16x32_bf16 v[192:195], v[88:91], v[64:67], v[192:195]
  v_mfma_f32_16x16x32_bf16 v[196:199], v[88:91], v[68:71], v[196:199]
  v_mfma_f32_16x16x32_bf16 v[200:203], v[88:91], v[72:75], v[200:203]
  v_mfma_f32_16x16x32_bf16 v[204:207], v[88:91], v[76:79], v[204:207]
  v_mfma_f32_16x16x32_bf16 v[220:223], v[92:95], v[76:79], v[220:223]
  v_mfma_f32_16x16x32_bf16 v[216:219], v[92:95], v[72:75], v[216:219]
  v_mfma_f32_16x16x32_bf16 v[212:215], v[92:95], v[68:71], v[212:215]
  v_mfma_f32_16x16x32_bf16 v[208:211], v[92:95], v[64:67], v[208:211]
  s_waitcnt lgkmcnt(0)
  v_cmp_gt_u32 vcc, s12, v63
  s_cbranch_vccnz .g2_kernel_q_v1fw
.g2_kernel_q_v1fc:
  s_cmp_ge_u32 s35, 0x200
  s_cbranch_scc1 .g2_kernel_q_v1r
.g2_kernel_q_v1rb:
  ds_write_b128 v60, v[224:227] offset:2048
  v_pk_mul_f32 v[152:153], v[40:41], v[24:25] op_sel:[0,1] op_sel_hi:[1,1]
  v_pk_mul_f32 v[154:155], v[42:43], v[24:25] op_sel:[0,1] op_sel_hi:[1,1]
  v_pk_mul_f32 v[156:157], v[44:45], v[24:25] op_sel:[0,1] op_sel_hi:[1,1]
  v_pk_mul_f32 v[158:159], v[46:47], v[24:25] op_sel:[0,1] op_sel_hi:[1,1]
  v_pk_fma_f32 v[192:193], v[192:193], v[24:25], v[152:153] op_sel_hi:[1,0,1]
  v_pk_fma_f32 v[194:195], v[194:195], v[24:25], v[154:155] op_sel_hi:[1,0,1]
  v_pk_fma_f32 v[208:209], v[208:209], v[24:25], v[156:157] op_sel_hi:[1,0,1]
  v_pk_fma_f32 v[210:211], v[210:211], v[24:25], v[158:159] op_sel_hi:[1,0,1]
  v_cvt_pk_bf16_f32 v192, v192, v193
  v_cvt_pk_bf16_f32 v193, v194, v195
  v_cvt_pk_bf16_f32 v194, v208, v209
  v_cvt_pk_bf16_f32 v195, v210, v211
  ds_write_b128 v59, v[192:195] offset:0
  ds_write_b128 v60, v[240:243] offset:2304
  v_pk_mul_f32 v[152:153], v[40:41], v[26:27] op_sel:[0,1] op_sel_hi:[1,1]
  v_pk_mul_f32 v[154:155], v[42:43], v[26:27] op_sel:[0,1] op_sel_hi:[1,1]
  v_pk_mul_f32 v[156:157], v[44:45], v[26:27] op_sel:[0,1] op_sel_hi:[1,1]
  v_pk_mul_f32 v[158:159], v[46:47], v[26:27] op_sel:[0,1] op_sel_hi:[1,1]
  v_pk_fma_f32 v[196:197], v[196:197], v[26:27], v[152:153] op_sel_hi:[1,0,1]
  v_pk_fma_f32 v[198:199], v[198:199], v[26:27], v[154:155] op_sel_hi:[1,0,1]
  v_pk_fma_f32 v[212:213], v[212:213], v[26:27], v[156:157] op_sel_hi:[1,0,1]
  v_pk_fma_f32 v[214:215], v[214:215], v[26:27], v[158:159] op_sel_hi:[1,0,1]
  v_cvt_pk_bf16_f32 v196, v196, v197
  v_cvt_pk_bf16_f32 v197, v198, v199
  v_cvt_pk_bf16_f32 v198, v212, v213
  v_cvt_pk_bf16_f32 v199, v214, v215
  ds_write_b128 v59, v[196:199] offset:128
  ds_write_b128 v60, v[232:235] offset:6144
  v_pk_mul_f32 v[152:153], v[40:41], v[28:29] op_sel:[0,1] op_sel_hi:[1,1]
  v_pk_mul_f32 v[154:155], v[42:43], v[28:29] op_sel:[0,1] op_sel_hi:[1,1]
  v_pk_mul_f32 v[156:157], v[44:45], v[28:29] op_sel:[0,1] op_sel_hi:[1,1]
  v_pk_mul_f32 v[158:159], v[46:47], v[28:29] op_sel:[0,1] op_sel_hi:[1,1]
  v_pk_fma_f32 v[200:201], v[200:201], v[28:29], v[152:153] op_sel_hi:[1,0,1]
  v_pk_fma_f32 v[202:203], v[202:203], v[28:29], v[154:155] op_sel_hi:[1,0,1]
  v_pk_fma_f32 v[216:217], v[216:217], v[28:29], v[156:157] op_sel_hi:[1,0,1]
  v_pk_fma_f32 v[218:219], v[218:219], v[28:29], v[158:159] op_sel_hi:[1,0,1]
  v_cvt_pk_bf16_f32 v200, v200, v201
  v_cvt_pk_bf16_f32 v201, v202, v203
  v_cvt_pk_bf16_f32 v202, v216, v217
  v_cvt_pk_bf16_f32 v203, v218, v219
  ds_write_b128 v59, v[200:203] offset:4096
  s_waitcnt vmcnt(0)
  s_mov_b64 exec, 1
  ds_add_rtn_u32 v7, v62, v5 offset:120
  s_mov_b64 exec, -1
  ds_write_b128 v60, v[248:251] offset:6400
  v_pk_mul_f32 v[152:153], v[40:41], v[30:31] op_sel:[0,1] op_sel_hi:[1,1]
  v_pk_mul_f32 v[154:155], v[42:43], v[30:31] op_sel:[0,1] op_sel_hi:[1,1]
  v_pk_mul_f32 v[156:157], v[44:45], v[30:31] op_sel:[0,1] op_sel_hi:[1,1]
  v_pk_mul_f32 v[158:159], v[46:47], v[30:31] op_sel:[0,1] op_sel_hi:[1,1]
  v_pk_fma_f32 v[204:205], v[204:205], v[30:31], v[152:153] op_sel_hi:[1,0,1]
  v_pk_fma_f32 v[206:207], v[206:207], v[30:31], v[154:155] op_sel_hi:[1,0,1]
  v_pk_fma_f32 v[220:221], v[220:221], v[30:31], v[156:157] op_sel_hi:[1,0,1]
  v_pk_fma_f32 v[222:223], v[222:223], v[30:31], v[158:159] op_sel_hi:[1,0,1]
  v_cvt_pk_bf16_f32 v204, v204, v205
  v_cvt_pk_bf16_f32 v205, v206, v207
  v_cvt_pk_bf16_f32 v206, v220, v221
  v_cvt_pk_bf16_f32 v207, v222, v223
  s_waitcnt lgkmcnt(1)
  v_readfirstlane_b32 s28, v7
  s_cmp_eq_u32 s28, 1
  s_cbranch_scc1 .g2_kernel_q_v1f
.g2_kernel_q_v1fb:
  ds_write_b128 v59, v[204:207] offset:4224
  v_pk_mul_f32 v[24:25], v[24:25], v[56:57] op_sel_hi:[1,0]
  v_pk_mul_f32 v[26:27], v[26:27], v[56:57] op_sel_hi:[1,0]
  v_pk_mul_f32 v[28:29], v[28:29], v[56:57] op_sel_hi:[1,0]
  v_pk_mul_f32 v[30:31], v[30:31], v[56:57] op_sel_hi:[1,0]
  v_pk_mul_f32 v[152:153], v[32:33], v[24:25] op_sel:[0,1] op_sel_hi:[1,1]
  v_pk_mul_f32 v[154:155], v[34:35], v[24:25] op_sel:[0,1] op_sel_hi:[1,1]
  v_pk_mul_f32 v[156:157], v[36:37], v[24:25] op_sel:[0,1] op_sel_hi:[1,1]
  v_pk_mul_f32 v[158:159], v[38:39], v[24:25] op_sel:[0,1] op_sel_hi:[1,1]
  v_pk_fma_f32 v[160:161], v[160:161], v[24:25], v[152:153] op_sel_hi:[1,0,1]
  v_pk_fma_f32 v[162:163], v[162:163], v[24:25], v[154:155] op_sel_hi:[1,0,1]
  v_pk_fma_f32 v[176:177], v[176:177], v[24:25], v[156:157] op_sel_hi:[1,0,1]
  v_pk_fma_f32 v[178:179], v[178:179], v[24:25], v[158:159] op_sel_hi:[1,0,1]
  v_cvt_pk_bf16_f32 v160, v160, v161
  v_cvt_pk_bf16_f32 v161, v162, v163
  v_cvt_pk_bf16_f32 v162, v176, v177
  v_cvt_pk_bf16_f32 v163, v178, v179
  ds_write_b128 v61, v[160:163] offset:0
  v_pk_mul_f32 v[152:153], v[32:33], v[26:27] op_sel:[0,1] op_sel_hi:[1,1]
  v_pk_mul_f32 v[154:155], v[34:35], v[26:27] op_sel:[0,1] op_sel_hi:[1,1]
  v_pk_mul_f32 v[156:157], v[36:37], v[26:27] op_sel:[0,1] op_sel_hi:[1,1]
  v_pk_mul_f32 v[158:159], v[38:39], v[26:27] op_sel:[0,1] op_sel_hi:[1,1]
  v_pk_fma_f32 v[164:165], v[164:165], v[26:27], v[152:153] op_sel_hi:[1,0,1]
  v_pk_fma_f32 v[166:167], v[166:167], v[26:27], v[154:155] op_sel_hi:[1,0,1]
  v_pk_fma_f32 v[180:181], v[180:181], v[26:27], v[156:157] op_sel_hi:[1,0,1]
  v_pk_fma_f32 v[182:183], v[182:183], v[26:27], v[158:159] op_sel_hi:[1,0,1]
  v_cvt_pk_bf16_f32 v164, v164, v165
  v_cvt_pk_bf16_f32 v165, v166, v167
  v_cvt_pk_bf16_f32 v166, v180, v181
  v_cvt_pk_bf16_f32 v167, v182, v183
  ds_write_b128 v61, v[164:167] offset:256
  v_pk_mul_f32 v[152:153], v[32:33], v[28:29] op_sel:[0,1] op_sel_hi:[1,1]
  v_pk_mul_f32 v[154:155], v[34:35], v[28:29] op_sel:[0,1] op_sel_hi:[1,1]
  v_pk_mul_f32 v[156:157], v[36:37], v[28:29] op_sel:[0,1] op_sel_hi:[1,1]
  v_pk_mul_f32 v[158:159], v[38:39], v[28:29] op_sel:[0,1] op_sel_hi:[1,1]
  v_pk_fma_f32 v[168:169], v[168:169], v[28:29], v[152:153] op_sel_hi:[1,0,1]
  v_pk_fma_f32 v[170:171], v[170:171], v[28:29], v[154:155] op_sel_hi:[1,0,1]
  v_pk_fma_f32 v[184:185], v[184:185], v[28:29], v[156:157] op_sel_hi:[1,0,1]
  v_pk_fma_f32 v[186:187], v[186:187], v[28:29], v[158:159] op_sel_hi:[1,0,1]
  v_cvt_pk_bf16_f32 v168, v168, v169
  v_cvt_pk_bf16_f32 v169, v170, v171
  v_cvt_pk_bf16_f32 v170, v184, v185
  v_cvt_pk_bf16_f32 v171, v186, v187
  ds_write_b128 v61, v[168:171] offset:2048
  v_pk_mul_f32 v[152:153], v[32:33], v[30:31] op_sel:[0,1] op_sel_hi:[1,1]
  v_pk_mul_f32 v[154:155], v[34:35], v[30:31] op_sel:[0,1] op_sel_hi:[1,1]
  v_pk_mul_f32 v[156:157], v[36:37], v[30:31] op_sel:[0,1] op_sel_hi:[1,1]
  v_pk_mul_f32 v[158:159], v[38:39], v[30:31] op_sel:[0,1] op_sel_hi:[1,1]
  v_pk_fma_f32 v[172:173], v[172:173], v[30:31], v[152:153] op_sel_hi:[1,0,1]
  v_pk_fma_f32 v[174:175], v[174:175], v[30:31], v[154:155] op_sel_hi:[1,0,1]
  v_pk_fma_f32 v[188:189], v[188:189], v[30:31], v[156:157] op_sel_hi:[1,0,1]
  v_pk_fma_f32 v[190:191], v[190:191], v[30:31], v[158:159] op_sel_hi:[1,0,1]
  v_cvt_pk_bf16_f32 v172, v172, v173
  v_cvt_pk_bf16_f32 v173, v174, v175
  v_cvt_pk_bf16_f32 v174, v188, v189
  v_cvt_pk_bf16_f32 v175, v190, v191
  ds_write_b128 v61, v[172:175] offset:2304
  s_branch .g2_kernel_q_kd
.g2_kernel_r2:
  buffer_load_dwordx4 v[240:243], v22, s[4:7], s13 offen offset:0
  buffer_load_dwordx4 v[244:247], v22, s[4:7], s13 offen offset:512
  buffer_load_dwordx4 v[248:251], v22, s[4:7], s13 offen offset:1024
  buffer_load_dwordx4 v[252:255], v22, s[4:7], s13 offen offset:1536
  s_branch .g2_kernel_r3
.g2_kernel_a_t1c:
  s_call_b64 s[68:69], .g2_kernel_a_pick
  s_branch .g2_kernel_a_t1b
.g2_kernel_a_t2c:
  s_call_b64 s[68:69], .g2_kernel_a_pick
  s_branch .g2_kernel_a_t2b
.g2_kernel_a_t3c:
  s_call_b64 s[68:69], .g2_kernel_a_pick
  s_branch .g2_kernel_a_t3b
.g2_kernel_a_three:
  s_andn2_b32 s33, s36, s34
  s_cbranch_scc0 .g2_kernel_a_t1c
.g2_kernel_a_t1b:
  s_ff1_i32_b32 s33, s33
  s_bitset1_b32 s34, s33
  s_xor_b32 s33, s33, s24
  s_lshl_b32 s33, s33, s25
  s_add_u32 s22, s20, s33
  s_addc_u32 s23, s21, 0
  global_load_dwordx4 v[192:195], v3, s[22:23] offset:0
  global_load_dwordx4 v[196:199], v3, s[22:23] offset:1024
  global_load_dwordx4 v[200:203], v3, s[22:23] offset:2048
  global_load_dwordx4 v[204:207], v3, s[22:23] offset:3072
  s_andn2_b32 s33, s36, s34
  s_cbranch_scc0 .g2_kernel_a_t2c
.g2_kernel_a_t2b:
  s_ff1_i32_b32 s33, s33
  s_bitset1_b32 s34, s33
  s_xor_b32 s33, s33, s24
  s_lshl_b32 s33, s33, s25
  s_add_u32 s22, s20, s33
  s_addc_u32 s23, s21, 0
  global_load_dwordx4 v[208:211], v3, s[22:23] offset:0
  global_load_dwordx4 v[212:215], v3, s[22:23] offset:1024
  global_load_dwordx4 v[216:219], v3, s[22:23] offset:2048
  global_load_dwordx4 v[220:223], v3, s[22:23] offset:3072
  s_andn2_b32 s33, s36, s34
  s_cbranch_scc0 .g2_kernel_a_t3c
.g2_kernel_a_t3b:
  s_ff1_i32_b32 s33, s33
  s_bitset1_b32 s34, s33
  s_xor_b32 s33, s33, s24
  s_lshl_b32 s33, s33, s25
  s_add_u32 s22, s20, s33
  s_addc_u32 s23, s21, 0
  global_load_dwordx4 v[224:227], v3, s[22:23] offset:0
  global_load_dwordx4 v[228:231], v3, s[22:23] offset:1024
  global_load_dwordx4 v[232:235], v3, s[22:23] offset:2048
  global_load_dwordx4 v[236:239], v3, s[22:23] offset:3072
  s_setpc_b64 s[72:73]
.g2_kernel_a_o0c:
  s_call_b64 s[68:69], .g2_kernel_a_pick
  s_branch .g2_kernel_a_o0b
.g2_kernel_a_o1c:
  s_call_b64 s[68:69], .g2_kernel_a_pick
  s_branch .g2_kernel_a_o1b
.g2_kernel_a_o2c:
  s_call_b64 s[68:69], .g2_kernel_a_pick
  s_branch .g2_kernel_a_o2b
.g2_kernel_a_o3c:
  s_call_b64 s[68:69], .g2_kernel_a_pick
  s_branch .g2_kernel_a_o3b
.g2_kernel_a_r0c:
  s_call_b64 s[68:69], .g2_kernel_a_pick
  s_branch .g2_kernel_a_r0b
.g2_kernel_a_r1c:
  s_call_b64 s[68:69], .g2_kernel_a_pick
  s_branch .g2_kernel_a_r1b
.g2_kernel_a_r2c:
  s_call_b64 s[68:69], .g2_kernel_a_pick
  s_branch .g2_kernel_a_r2b
.g2_kernel_a_own:
  s_waitcnt lgkmcnt(0)
  s_mov_b32 s14, 0
  s_andn2_b32 s33, s36, s34
  s_cbranch_scc0 .g2_kernel_a_o0c
.g2_kernel_a_o0b:
  s_ff1_i32_b32 s33, s33
  s_bitset1_b32 s34, s33
  s_lshl_b32 s28, s33, 0
  s_or_b32 s14, s14, s28
  s_xor_b32 s33, s33, s24
  s_lshl_b32 s33, s33, s25
  s_add_u32 s22, s20, s33
  s_addc_u32 s23, s21, 0
  global_load_dwordx4 v[176:179], v3, s[22:23] offset:0
  global_load_dwordx4 v[180:183], v3, s[22:23] offset:1024
  global_load_dwordx4 v[184:187], v3, s[22:23] offset:2048
  global_load_dwordx4 v[188:191], v3, s[22:23] offset:3072
  s_andn2_b32 s33, s36, s34
  s_cbranch_scc0 .g2_kernel_a_o1c
.g2_kernel_a_o1b:
  s_ff1_i32_b32 s33, s33
  s_bitset1_b32 s34, s33
  s_lshl_b32 s28, s33, 8
  s_or_b32 s14, s14, s28
  s_xor_b32 s33, s33, s24
  s_lshl_b32 s33, s33, s25
  s_add_u32 s22, s20, s33
  s_addc_u32 s23, s21, 0
  global_load_dwordx4 v[192:195], v3, s[22:23] offset:0
  global_load_dwordx4 v[196:199], v3, s[22:23] offset:1024
  global_load_dwordx4 v[200:203], v3, s[22:23] offset:2048
  global_load_dwordx4 v[204:207], v3, s[22:23] offset:3072
  s_andn2_b32 s33, s36, s34
  s_cbranch_scc0 .g2_kernel_a_o2c
.g2_kernel_a_o2b:
  s_ff1_i32_b32 s33, s33
  s_bitset1_b32 s34, s33
  s_lshl_b32 s28, s33, 16
  s_or_b32 s14, s14, s28
  s_xor_b32 s33, s33, s24
  s_lshl_b32 s33, s33, s25
  s_add_u32 s22, s20, s33
  s_addc_u32 s23, s21, 0
  global_load_dwordx4 v[208:211], v3, s[22:23] offset:0
  global_load_dwordx4 v[212:215], v3, s[22:23] offset:1024
  global_load_dwordx4 v[216:219], v3, s[22:23] offset:2048
  global_load_dwordx4 v[220:223], v3, s[22:23] offset:3072
  s_andn2_b32 s33, s36, s34
  s_cbranch_scc0 .g2_kernel_a_o3c
.g2_kernel_a_o3b:
  s_ff1_i32_b32 s33, s33
  s_bitset1_b32 s34, s33
  s_lshl_b32 s28, s33, 24
  s_or_b32 s14, s14, s28
  s_xor_b32 s33, s33, s24
  s_lshl_b32 s33, s33, s25
  s_add_u32 s22, s20, s33
  s_addc_u32 s23, s21, 0
  global_load_dwordx4 v[224:227], v3, s[22:23] offset:0
  global_load_dwordx4 v[228:231], v3, s[22:23] offset:1024
  global_load_dwordx4 v[232:235], v3, s[22:23] offset:2048
  global_load_dwordx4 v[236:239], v3, s[22:23] offset:3072
  s_and_b32 s15, s34, -2
  s_mov_b32 s34, -1
  s_mov_b32 s26, -1
  s_waitcnt vmcnt(12)
  s_branch .g2_kernel_a_ob
.g2_kernel_a_redo:
  v_mfma_f32_32x32x16_bf16 v[104:119], v[236:239], v[172:175], v[104:119]
  v_smfmac_f32_16x16x64_bf16 v[132:135], v[16:19], v[168:175], v20
  v_mov_b32 v6, s71
  s_mov_b32 s38, 0
.g2_kernel_wg5:
  ds_read_b32 v7, v6 offset:60
  s_add_u32 s38, s38, 1
  s_waitcnt lgkmcnt(0)
  v_cmp_gt_u32 vcc, 1, v7
  s_cbranch_vccz .g2_kernel_wg5d
  s_sleep 1
  s_cmp_lt_u32 s38, 524288
  s_cbranch_scc1 .g2_kernel_wg5
.g2_kernel_wg5d:
  ds_read_b32 v7, v8
  s_mov_b32 s34, s15
  s_mov_b32 s26, 0
  s_waitcnt lgkmcnt(0)
  v_cmp_lt_u32 vcc, s62, v7
  s_mov_b32 s36, vcc_lo
  s_sub_u32 s28, s35, 1
  s_bfe_u32 s28, s28, 0x20005
  s_mov_b32 s35, 0
  s_waitcnt vmcnt(0)
  s_cmp_lg_u32 s28, 0
  s_cbranch_scc1 .g2_kernel_a_rd1
  ds_read_b128 v[24:27], v14 offset:8192
  ds_read_b128 v[28:31], v14 offset:9216
  v_mov_b32 v120, 0
  v_mov_b32 v121, 0
  s_waitcnt lgkmcnt(0)
  v_mfma_f32_32x32x16_bf16 v[136:151], v[176:179], v[24:27], 0
  v_mfma_f32_32x32x16_bf16 v[136:151], v[180:183], v[28:31], v[136:151]
  v_mfma_f32_32x32x16_bf16 v[152:167], v[192:195], v[24:27], 0
  s_nop 10
  v_exp_f32 v136, v136
  v_exp_f32 v137, v137
  v_exp_f32 v138, v138
  v_exp_f32 v139, v139
  v_exp_f32 v140, v140
  v_exp_f32 v141, v141
  v_exp_f32 v142, v142
  v_exp_f32 v143, v143
  v_mfma_f32_32x32x16_bf16 v[152:167], v[196:199], v[28:31], v[152:167]
  v_cvt_pk_bf16_f32 v168, v136, v137
  v_cvt_pk_bf16_f32 v169, v138, v139
  v_cvt_pk_bf16_f32 v170, v140, v141
  v_cvt_pk_bf16_f32 v171, v142, v143
  v_exp_f32 v144, v144
  v_exp_f32 v145, v145
  v_exp_f32 v146, v146
  v_exp_f32 v147, v147
  v_mfma_f32_32x32x16_bf16 v[56:71], v[184:187], v[168:171], 0
  v_exp_f32 v148, v148
  v_exp_f32 v149, v149
  v_exp_f32 v150, v150
  v_exp_f32 v151, v151
  v_cvt_pk_bf16_f32 v172, v144, v145
  v_cvt_pk_bf16_f32 v173, v146, v147
  v_cvt_pk_bf16_f32 v174, v148, v149
  v_cvt_pk_bf16_f32 v175, v150, v151
  v_mfma_f32_32x32x16_bf16 v[136:151], v[208:211], v[24:27], 0
  v_exp_f32 v152, v152
  v_exp_f32 v153, v153
  v_exp_f32 v154, v154
  v_mfma_f32_32x32x16_bf16 v[56:71], v[188:191], v[172:175], v[56:71]
  s_call_b64 s[72:73], .g2_kernel_a_ld0
  v_exp_f32 v155, v155
  v_exp_f32 v156, v156
  v_exp_f32 v157, v157
  v_smfmac_f32_16x16x64_bf16 v[120:123], v[16:19], v[168:175], v20
  v_exp_f32 v158, v158
  v_exp_f32 v159, v159
  v_mfma_f32_32x32x16_bf16 v[136:151], v[212:215], v[28:31], v[136:151]
  v_cvt_pk_bf16_f32 v168, v152, v153
  v_cvt_pk_bf16_f32 v169, v154, v155
  v_cvt_pk_bf16_f32 v170, v156, v157
  v_cvt_pk_bf16_f32 v171, v158, v159
  v_exp_f32 v160, v160
  v_exp_f32 v161, v161
  v_exp_f32 v162, v162
  v_exp_f32 v163, v163
  v_mfma_f32_32x32x16_bf16 v[56:71], v[200:203], v[168:171], v[56:71]
  v_exp_f32 v164, v164
  v_exp_f32 v165, v165
  v_exp_f32 v166, v166
  v_exp_f32 v167, v167
  v_cvt_pk_bf16_f32 v172, v160, v161
  v_cvt_pk_bf16_f32 v173, v162, v163
  v_cvt_pk_bf16_f32 v174, v164, v165
  v_cvt_pk_bf16_f32 v175, v166, v167
  v_mfma_f32_32x32x16_bf16 v[152:167], v[224:227], v[24:27], 0
  v_exp_f32 v136, v136
  v_exp_f32 v137, v137
  v_exp_f32 v138, v138
  v_mfma_f32_32x32x16_bf16 v[56:71], v[204:207], v[172:175], v[56:71]
  s_call_b64 s[72:73], .g2_kernel_a_ld1
  v_exp_f32 v139, v139
  v_exp_f32 v140, v140
  v_exp_f32 v141, v141
  v_smfmac_f32_16x16x64_bf16 v[120:123], v[16:19], v[168:175], v20
  v_exp_f32 v142, v142
  v_exp_f32 v143, v143
  v_mfma_f32_32x32x16_bf16 v[152:167], v[228:231], v[28:31], v[152:167]
  v_cvt_pk_bf16_f32 v168, v136, v137
  v_cvt_pk_bf16_f32 v169, v138, v139
  v_cvt_pk_bf16_f32 v170, v140, v141
  v_cvt_pk_bf16_f32 v171, v142, v143
  v_exp_f32 v144, v144
  v_exp_f32 v145, v145
  v_exp_f32 v146, v146
  v_exp_f32 v147, v147
  v_mfma_f32_32x32x16_bf16 v[56:71], v[216:219], v[168:171], v[56:71]
  v_exp_f32 v148, v148
  v_exp_f32 v149, v149
  v_exp_f32 v150, v150
  v_exp_f32 v151, v151
  v_cvt_pk_bf16_f32 v172, v144, v145
  v_cvt_pk_bf16_f32 v173, v146, v147
  v_cvt_pk_bf16_f32 v174, v148, v149
  v_cvt_pk_bf16_f32 v175, v150, v151
  v_exp_f32 v152, v152
  v_exp_f32 v153, v153
  v_exp_f32 v154, v154
  v_mfma_f32_32x32x16_bf16 v[56:71], v[220:223], v[172:175], v[56:71]
  s_call_b64 s[72:73], .g2_kernel_a_ld2
  v_exp_f32 v155, v155
  v_exp_f32 v156, v156
  v_exp_f32 v157, v157
  v_smfmac_f32_16x16x64_bf16 v[120:123], v[16:19], v[168:175], v20
  v_exp_f32 v158, v158
  v_exp_f32 v159, v159
  v_cvt_pk_bf16_f32 v168, v152, v153
  v_cvt_pk_bf16_f32 v169, v154, v155
  v_cvt_pk_bf16_f32 v170, v156, v157
  v_cvt_pk_bf16_f32 v171, v158, v159
  v_exp_f32 v160, v160
  v_exp_f32 v161, v161
  v_exp_f32 v162, v162
  v_exp_f32 v163, v163
  v_mfma_f32_32x32x16_bf16 v[56:71], v[232:235], v[168:171], v[56:71]
  v_exp_f32 v164, v164
  v_exp_f32 v165, v165
  v_exp_f32 v166, v166
  v_exp_f32 v167, v167
  v_cvt_pk_bf16_f32 v172, v160, v161
  v_cvt_pk_bf16_f32 v173, v162, v163
  v_cvt_pk_bf16_f32 v174, v164, v165
  v_cvt_pk_bf16_f32 v175, v166, v167
  s_nop 1
  v_mfma_f32_32x32x16_bf16 v[56:71], v[236:239], v[172:175], v[56:71]
  v_smfmac_f32_16x16x64_bf16 v[120:123], v[16:19], v[168:175], v20
  s_branch .g2_kernel_a_rde
.g2_kernel_a_rd1:
  s_cmp_lg_u32 s28, 1
  s_cbranch_scc1 .g2_kernel_a_rd2
  ds_read_b128 v[32:35], v14 offset:10240
  ds_read_b128 v[36:39], v14 offset:11264
  v_mov_b32 v124, 0
  v_mov_b32 v125, 0
  s_waitcnt lgkmcnt(0)
  v_mfma_f32_32x32x16_bf16 v[136:151], v[176:179], v[32:35], 0
  v_mfma_f32_32x32x16_bf16 v[136:151], v[180:183], v[36:39], v[136:151]
  v_mfma_f32_32x32x16_bf16 v[152:167], v[192:195], v[32:35], 0
  s_nop 10
  v_exp_f32 v136, v136
  v_exp_f32 v137, v137
  v_exp_f32 v138, v138
  v_exp_f32 v139, v139
  v_exp_f32 v140, v140
  v_exp_f32 v141, v141
  v_exp_f32 v142, v142
  v_exp_f32 v143, v143
  v_mfma_f32_32x32x16_bf16 v[152:167], v[196:199], v[36:39], v[152:167]
  v_cvt_pk_bf16_f32 v168, v136, v137
  v_cvt_pk_bf16_f32 v169, v138, v139
  v_cvt_pk_bf16_f32 v170, v140, v141
  v_cvt_pk_bf16_f32 v171, v142, v143
  v_exp_f32 v144, v144
  v_exp_f32 v145, v145
  v_exp_f32 v146, v146
  v_exp_f32 v147, v147
  v_mfma_f32_32x32x16_bf16 v[72:87], v[184:187], v[168:171], 0
  v_exp_f32 v148, v148
  v_exp_f32 v149, v149
  v_exp_f32 v150, v150
  v_exp_f32 v151, v151
  v_cvt_pk_bf16_f32 v172, v144, v145
  v_cvt_pk_bf16_f32 v173, v146, v147
  v_cvt_pk_bf16_f32 v174, v148, v149
  v_cvt_pk_bf16_f32 v175, v150, v151
  v_mfma_f32_32x32x16_bf16 v[136:151], v[208:211], v[32:35], 0
  v_exp_f32 v152, v152
  v_exp_f32 v153, v153
  v_exp_f32 v154, v154
  v_mfma_f32_32x32x16_bf16 v[72:87], v[188:191], v[172:175], v[72:87]
  s_call_b64 s[72:73], .g2_kernel_a_ld0
  v_exp_f32 v155, v155
  v_exp_f32 v156, v156
  v_exp_f32 v157, v157
  v_smfmac_f32_16x16x64_bf16 v[124:127], v[16:19], v[168:175], v20
  v_exp_f32 v158, v158
  v_exp_f32 v159, v159
  v_mfma_f32_32x32x16_bf16 v[136:151], v[212:215], v[36:39], v[136:151]
  v_cvt_pk_bf16_f32 v168, v152, v153
  v_cvt_pk_bf16_f32 v169, v154, v155
  v_cvt_pk_bf16_f32 v170, v156, v157
  v_cvt_pk_bf16_f32 v171, v158, v159
  v_exp_f32 v160, v160
  v_exp_f32 v161, v161
  v_exp_f32 v162, v162
  v_exp_f32 v163, v163
  v_mfma_f32_32x32x16_bf16 v[72:87], v[200:203], v[168:171], v[72:87]
  v_exp_f32 v164, v164
  v_exp_f32 v165, v165
  v_exp_f32 v166, v166
  v_exp_f32 v167, v167
  v_cvt_pk_bf16_f32 v172, v160, v161
  v_cvt_pk_bf16_f32 v173, v162, v163
  v_cvt_pk_bf16_f32 v174, v164, v165
  v_cvt_pk_bf16_f32 v175, v166, v167
  v_mfma_f32_32x32x16_bf16 v[152:167], v[224:227], v[32:35], 0
  v_exp_f32 v136, v136
  v_exp_f32 v137, v137
  v_exp_f32 v138, v138
  v_mfma_f32_32x32x16_bf16 v[72:87], v[204:207], v[172:175], v[72:87]
  s_call_b64 s[72:73], .g2_kernel_a_ld1
  v_exp_f32 v139, v139
  v_exp_f32 v140, v140
  v_exp_f32 v141, v141
  v_smfmac_f32_16x16x64_bf16 v[124:127], v[16:19], v[168:175], v20
  v_exp_f32 v142, v142
  v_exp_f32 v143, v143
  v_mfma_f32_32x32x16_bf16 v[152:167], v[228:231], v[36:39], v[152:167]
  v_cvt_pk_bf16_f32 v168, v136, v137
  v_cvt_pk_bf16_f32 v169, v138, v139
  v_cvt_pk_bf16_f32 v170, v140, v141
  v_cvt_pk_bf16_f32 v171, v142, v143
  v_exp_f32 v144, v144
  v_exp_f32 v145, v145
  v_exp_f32 v146, v146
  v_exp_f32 v147, v147
  v_mfma_f32_32x32x16_bf16 v[72:87], v[216:219], v[168:171], v[72:87]
  v_exp_f32 v148, v148
  v_exp_f32 v149, v149
  v_exp_f32 v150, v150
  v_exp_f32 v151, v151
  v_cvt_pk_bf16_f32 v172, v144, v145
  v_cvt_pk_bf16_f32 v173, v146, v147
  v_cvt_pk_bf16_f32 v174, v148, v149
  v_cvt_pk_bf16_f32 v175, v150, v151
  v_exp_f32 v152, v152
  v_exp_f32 v153, v153
  v_exp_f32 v154, v154
  v_mfma_f32_32x32x16_bf16 v[72:87], v[220:223], v[172:175], v[72:87]
  s_call_b64 s[72:73], .g2_kernel_a_ld2
  v_exp_f32 v155, v155
  v_exp_f32 v156, v156
  v_exp_f32 v157, v157
  v_smfmac_f32_16x16x64_bf16 v[124:127], v[16:19], v[168:175], v20
  v_exp_f32 v158, v158
  v_exp_f32 v159, v159
  v_cvt_pk_bf16_f32 v168, v152, v153
  v_cvt_pk_bf16_f32 v169, v154, v155
  v_cvt_pk_bf16_f32 v170, v156, v157
  v_cvt_pk_bf16_f32 v171, v158, v159
  v_exp_f32 v160, v160
  v_exp_f32 v161, v161
  v_exp_f32 v162, v162
  v_exp_f32 v163, v163
  v_mfma_f32_32x32x16_bf16 v[72:87], v[232:235], v[168:171], v[72:87]
  v_exp_f32 v164, v164
  v_exp_f32 v165, v165
  v_exp_f32 v166, v166
  v_exp_f32 v167, v167
  v_cvt_pk_bf16_f32 v172, v160, v161
  v_cvt_pk_bf16_f32 v173, v162, v163
  v_cvt_pk_bf16_f32 v174, v164, v165
  v_cvt_pk_bf16_f32 v175, v166, v167
  s_nop 1
  v_mfma_f32_32x32x16_bf16 v[72:87], v[236:239], v[172:175], v[72:87]
  v_smfmac_f32_16x16x64_bf16 v[124:127], v[16:19], v[168:175], v20
  s_branch .g2_kernel_a_rde
.g2_kernel_a_rd2:
  s_cmp_lg_u32 s28, 2
  s_cbranch_scc1 .g2_kernel_a_rd3
  ds_read_b128 v[40:43], v14 offset:12288
  ds_read_b128 v[44:47], v14 offset:13312
  v_mov_b32 v128, 0
  v_mov_b32 v129, 0
  s_waitcnt lgkmcnt(0)
  v_mfma_f32_32x32x16_bf16 v[136:151], v[176:179], v[40:43], 0
  v_mfma_f32_32x32x16_bf16 v[136:151], v[180:183], v[44:47], v[136:151]
  v_mfma_f32_32x32x16_bf16 v[152:167], v[192:195], v[40:43], 0
  s_nop 10
  v_exp_f32 v136, v136
  v_exp_f32 v137, v137
  v_exp_f32 v138, v138
  v_exp_f32 v139, v139
  v_exp_f32 v140, v140
  v_exp_f32 v141, v141
  v_exp_f32 v142, v142
  v_exp_f32 v143, v143
  v_mfma_f32_32x32x16_bf16 v[152:167], v[196:199], v[44:47], v[152:167]
  v_cvt_pk_bf16_f32 v168, v136, v137
  v_cvt_pk_bf16_f32 v169, v138, v139
  v_cvt_pk_bf16_f32 v170, v140, v141
  v_cvt_pk_bf16_f32 v171, v142, v143
  v_exp_f32 v144, v144
  v_exp_f32 v145, v145
  v_exp_f32 v146, v146
  v_exp_f32 v147, v147
  v_mfma_f32_32x32x16_bf16 v[88:103], v[184:187], v[168:171], 0
  v_exp_f32 v148, v148
  v_exp_f32 v149, v149
  v_exp_f32 v150, v150
  v_exp_f32 v151, v151
  v_cvt_pk_bf16_f32 v172, v144, v145
  v_cvt_pk_bf16_f32 v173, v146, v147
  v_cvt_pk_bf16_f32 v174, v148, v149
  v_cvt_pk_bf16_f32 v175, v150, v151
  v_mfma_f32_32x32x16_bf16 v[136:151], v[208:211], v[40:43], 0
  v_exp_f32 v152, v152
  v_exp_f32 v153, v153
  v_exp_f32 v154, v154
  v_mfma_f32_32x32x16_bf16 v[88:103], v[188:191], v[172:175], v[88:103]
  s_call_b64 s[72:73], .g2_kernel_a_ld0
  v_exp_f32 v155, v155
  v_exp_f32 v156, v156
  v_exp_f32 v157, v157
  v_smfmac_f32_16x16x64_bf16 v[128:131], v[16:19], v[168:175], v20
  v_exp_f32 v158, v158
  v_exp_f32 v159, v159
  v_mfma_f32_32x32x16_bf16 v[136:151], v[212:215], v[44:47], v[136:151]
  v_cvt_pk_bf16_f32 v168, v152, v153
  v_cvt_pk_bf16_f32 v169, v154, v155
  v_cvt_pk_bf16_f32 v170, v156, v157
  v_cvt_pk_bf16_f32 v171, v158, v159
  v_exp_f32 v160, v160
  v_exp_f32 v161, v161
  v_exp_f32 v162, v162
  v_exp_f32 v163, v163
  v_mfma_f32_32x32x16_bf16 v[88:103], v[200:203], v[168:171], v[88:103]
  v_exp_f32 v164, v164
  v_exp_f32 v165, v165
  v_exp_f32 v166, v166
  v_exp_f32 v167, v167
  v_cvt_pk_bf16_f32 v172, v160, v161
  v_cvt_pk_bf16_f32 v173, v162, v163
  v_cvt_pk_bf16_f32 v174, v164, v165
  v_cvt_pk_bf16_f32 v175, v166, v167
  v_mfma_f32_32x32x16_bf16 v[152:167], v[224:227], v[40:43], 0
  v_exp_f32 v136, v136
  v_exp_f32 v137, v137
  v_exp_f32 v138, v138
  v_mfma_f32_32x32x16_bf16 v[88:103], v[204:207], v[172:175], v[88:103]
  s_call_b64 s[72:73], .g2_kernel_a_ld1
  v_exp_f32 v139, v139
  v_exp_f32 v140, v140
  v_exp_f32 v141, v141
  v_smfmac_f32_16x16x64_bf16 v[128:131], v[16:19], v[168:175], v20
  v_exp_f32 v142, v142
  v_exp_f32 v143, v143
  v_mfma_f32_32x32x16_bf16 v[152:167], v[228:231], v[44:47], v[152:167]
  v_cvt_pk_bf16_f32 v168, v136, v137
  v_cvt_pk_bf16_f32 v169, v138, v139
  v_cvt_pk_bf16_f32 v170, v140, v141
  v_cvt_pk_bf16_f32 v171, v142, v143
  v_exp_f32 v144, v144
  v_exp_f32 v145, v145
  v_exp_f32 v146, v146
  v_exp_f32 v147, v147
  v_mfma_f32_32x32x16_bf16 v[88:103], v[216:219], v[168:171], v[88:103]
  v_exp_f32 v148, v148
  v_exp_f32 v149, v149
  v_exp_f32 v150, v150
  v_exp_f32 v151, v151
  v_cvt_pk_bf16_f32 v172, v144, v145
  v_cvt_pk_bf16_f32 v173, v146, v147
  v_cvt_pk_bf16_f32 v174, v148, v149
  v_cvt_pk_bf16_f32 v175, v150, v151
  v_exp_f32 v152, v152
  v_exp_f32 v153, v153
  v_exp_f32 v154, v154
  v_mfma_f32_32x32x16_bf16 v[88:103], v[220:223], v[172:175], v[88:103]
  s_call_b64 s[72:73], .g2_kernel_a_ld2
  v_exp_f32 v155, v155
  v_exp_f32 v156, v156
  v_exp_f32 v157, v157
  v_smfmac_f32_16x16x64_bf16 v[128:131], v[16:19], v[168:175], v20
  v_exp_f32 v158, v158
  v_exp_f32 v159, v159
  v_cvt_pk_bf16_f32 v168, v152, v153
  v_cvt_pk_bf16_f32 v169, v154, v155
  v_cvt_pk_bf16_f32 v170, v156, v157
  v_cvt_pk_bf16_f32 v171, v158, v159
  v_exp_f32 v160, v160
  v_exp_f32 v161, v161
  v_exp_f32 v162, v162
  v_exp_f32 v163, v163
  v_mfma_f32_32x32x16_bf16 v[88:103], v[232:235], v[168:171], v[88:103]
  v_exp_f32 v164, v164
  v_exp_f32 v165, v165
  v_exp_f32 v166, v166
  v_exp_f32 v167, v167
  v_cvt_pk_bf16_f32 v172, v160, v161
  v_cvt_pk_bf16_f32 v173, v162, v163
  v_cvt_pk_bf16_f32 v174, v164, v165
  v_cvt_pk_bf16_f32 v175, v166, v167
  s_nop 1
  v_mfma_f32_32x32x16_bf16 v[88:103], v[236:239], v[172:175], v[88:103]
  v_smfmac_f32_16x16x64_bf16 v[128:131], v[16:19], v[168:175], v20
  s_branch .g2_kernel_a_rde
.g2_kernel_a_rd3:
  ds_read_b128 v[48:51], v14 offset:14336
  ds_read_b128 v[52:55], v14 offset:15360
  v_mov_b32 v132, 0
  v_mov_b32 v133, 0
  s_waitcnt lgkmcnt(0)
  v_mfma_f32_32x32x16_bf16 v[136:151], v[176:179], v[48:51], 0
  v_mfma_f32_32x32x16_bf16 v[136:151], v[180:183], v[52:55], v[136:151]
  v_mfma_f32_32x32x16_bf16 v[152:167], v[192:195], v[48:51], 0
  s_nop 10
  v_exp_f32 v136, v136
  v_exp_f32 v137, v137
  v_exp_f32 v138, v138
  v_exp_f32 v139, v139
  v_exp_f32 v140, v140
  v_exp_f32 v141, v141
  v_exp_f32 v142, v142
  v_exp_f32 v143, v143
  v_mfma_f32_32x32x16_bf16 v[152:167], v[196:199], v[52:55], v[152:167]
  v_cvt_pk_bf16_f32 v168, v136, v137
  v_cvt_pk_bf16_f32 v169, v138, v139
  v_cvt_pk_bf16_f32 v170, v140, v141
  v_cvt_pk_bf16_f32 v171, v142, v143
  v_exp_f32 v144, v144
  v_exp_f32 v145, v145
  v_exp_f32 v146, v146
  v_exp_f32 v147, v147
  v_mfma_f32_32x32x16_bf16 v[104:119], v[184:187], v[168:171], 0
  v_exp_f32 v148, v148
  v_exp_f32 v149, v149
  v_exp_f32 v150, v150
  v_exp_f32 v151, v151
  v_cvt_pk_bf16_f32 v172, v144, v145
  v_cvt_pk_bf16_f32 v173, v146, v147
  v_cvt_pk_bf16_f32 v174, v148, v149
  v_cvt_pk_bf16_f32 v175, v150, v151
  v_mfma_f32_32x32x16_bf16 v[136:151], v[208:211], v[48:51], 0
  v_exp_f32 v152, v152
  v_exp_f32 v153, v153
  v_exp_f32 v154, v154
  v_mfma_f32_32x32x16_bf16 v[104:119], v[188:191], v[172:175], v[104:119]
  s_call_b64 s[72:73], .g2_kernel_a_ld0
  v_exp_f32 v155, v155
  v_exp_f32 v156, v156
  v_exp_f32 v157, v157
  v_smfmac_f32_16x16x64_bf16 v[132:135], v[16:19], v[168:175], v20
  v_exp_f32 v158, v158
  v_exp_f32 v159, v159
  v_mfma_f32_32x32x16_bf16 v[136:151], v[212:215], v[52:55], v[136:151]
  v_cvt_pk_bf16_f32 v168, v152, v153
  v_cvt_pk_bf16_f32 v169, v154, v155
  v_cvt_pk_bf16_f32 v170, v156, v157
  v_cvt_pk_bf16_f32 v171, v158, v159
  v_exp_f32 v160, v160
  v_exp_f32 v161, v161
  v_exp_f32 v162, v162
  v_exp_f32 v163, v163
  v_mfma_f32_32x32x16_bf16 v[104:119], v[200:203], v[168:171], v[104:119]
  v_exp_f32 v164, v164
  v_exp_f32 v165, v165
  v_exp_f32 v166, v166
  v_exp_f32 v167, v167
  v_cvt_pk_bf16_f32 v172, v160, v161
  v_cvt_pk_bf16_f32 v173, v162, v163
  v_cvt_pk_bf16_f32 v174, v164, v165
  v_cvt_pk_bf16_f32 v175, v166, v167
  v_mfma_f32_32x32x16_bf16 v[152:167], v[224:227], v[48:51], 0
  v_exp_f32 v136, v136
  v_exp_f32 v137, v137
  v_exp_f32 v138, v138
  v_mfma_f32_32x32x16_bf16 v[104:119], v[204:207], v[172:175], v[104:119]
  s_call_b64 s[72:73], .g2_kernel_a_ld1
  v_exp_f32 v139, v139
  v_exp_f32 v140, v140
  v_exp_f32 v141, v141
  v_smfmac_f32_16x16x64_bf16 v[132:135], v[16:19], v[168:175], v20
  v_exp_f32 v142, v142
  v_exp_f32 v143, v143
  v_mfma_f32_32x32x16_bf16 v[152:167], v[228:231], v[52:55], v[152:167]
  v_cvt_pk_bf16_f32 v168, v136, v137
  v_cvt_pk_bf16_f32 v169, v138, v139
  v_cvt_pk_bf16_f32 v170, v140, v141
  v_cvt_pk_bf16_f32 v171, v142, v143
  v_exp_f32 v144, v144
  v_exp_f32 v145, v145
  v_exp_f32 v146, v146
  v_exp_f32 v147, v147
  v_mfma_f32_32x32x16_bf16 v[104:119], v[216:219], v[168:171], v[104:119]
  v_exp_f32 v148, v148
  v_exp_f32 v149, v149
  v_exp_f32 v150, v150
  v_exp_f32 v151, v151
  v_cvt_pk_bf16_f32 v172, v144, v145
  v_cvt_pk_bf16_f32 v173, v146, v147
  v_cvt_pk_bf16_f32 v174, v148, v149
  v_cvt_pk_bf16_f32 v175, v150, v151
  v_exp_f32 v152, v152
  v_exp_f32 v153, v153
  v_exp_f32 v154, v154
  v_mfma_f32_32x32x16_bf16 v[104:119], v[220:223], v[172:175], v[104:119]
  s_call_b64 s[72:73], .g2_kernel_a_ld2
  v_exp_f32 v155, v155
  v_exp_f32 v156, v156
  v_exp_f32 v157, v157
  v_smfmac_f32_16x16x64_bf16 v[132:135], v[16:19], v[168:175], v20
  v_exp_f32 v158, v158
  v_exp_f32 v159, v159
  v_cvt_pk_bf16_f32 v168, v152, v153
  v_cvt_pk_bf16_f32 v169, v154, v155
  v_cvt_pk_bf16_f32 v170, v156, v157
  v_cvt_pk_bf16_f32 v171, v158, v159
  v_exp_f32 v160, v160
  v_exp_f32 v161, v161
  v_exp_f32 v162, v162
  v_exp_f32 v163, v163
  v_mfma_f32_32x32x16_bf16 v[104:119], v[232:235], v[168:171], v[104:119]
  v_exp_f32 v164, v164
  v_exp_f32 v165, v165
  v_exp_f32 v166, v166
  v_exp_f32 v167, v167
  v_cvt_pk_bf16_f32 v172, v160, v161
  v_cvt_pk_bf16_f32 v173, v162, v163
  v_cvt_pk_bf16_f32 v174, v164, v165
  v_cvt_pk_bf16_f32 v175, v166, v167
  s_nop 1
  v_mfma_f32_32x32x16_bf16 v[104:119], v[236:239], v[172:175], v[104:119]
  v_smfmac_f32_16x16x64_bf16 v[132:135], v[16:19], v[168:175], v20
  s_branch .g2_kernel_a_rde
.g2_kernel_a_rd4:
.g2_kernel_a_rde:
  v_mov_b32 v168, 0
  v_mov_b32 v169, 0
  v_mov_b32 v170, 0
  v_mov_b32 v171, 0
  v_mov_b32 v172, 0
  v_mov_b32 v173, 0
  v_mov_b32 v174, 0
  v_mov_b32 v175, 0
  s_waitcnt vmcnt(8)
  v_mfma_f32_32x32x16_bf16 v[136:151], v[176:179], v[24:27], 0
  v_mfma_f32_32x32x16_bf16 v[136:151], v[180:183], v[28:31], v[136:151]
  s_nop 10
  s_branch .g2_kernel_a_loop
.g2_kernel_a_ld0:
  s_andn2_b32 s33, s36, s34
  s_cbranch_scc0 .g2_kernel_a_r0c
.g2_kernel_a_r0b:
  s_ff1_i32_b32 s33, s33
  s_bitset1_b32 s34, s33
  s_xor_b32 s33, s33, s24
  s_lshl_b32 s33, s33, s25
  s_add_u32 s22, s20, s33
  s_addc_u32 s23, s21, 0
  global_load_dwordx4 v[176:179], v3, s[22:23] offset:0
  global_load_dwordx4 v[180:183], v3, s[22:23] offset:1024
  global_load_dwordx4 v[184:187], v3, s[22:23] offset:2048
  global_load_dwordx4 v[188:191], v3, s[22:23] offset:3072
  s_setpc_b64 s[72:73]
.g2_kernel_a_ld1:
  s_andn2_b32 s33, s36, s34
  s_cbranch_scc0 .g2_kernel_a_r1c
.g2_kernel_a_r1b:
  s_ff1_i32_b32 s33, s33
  s_bitset1_b32 s34, s33
  s_xor_b32 s33, s33, s24
  s_lshl_b32 s33, s33, s25
  s_add_u32 s22, s20, s33
  s_addc_u32 s23, s21, 0
  global_load_dwordx4 v[192:195], v3, s[22:23] offset:0
  global_load_dwordx4 v[196:199], v3, s[22:23] offset:1024
  global_load_dwordx4 v[200:203], v3, s[22:23] offset:2048
  global_load_dwordx4 v[204:207], v3, s[22:23] offset:3072
  s_setpc_b64 s[72:73]
.g2_kernel_a_ld2:
  s_andn2_b32 s33, s36, s34
  s_cbranch_scc0 .g2_kernel_a_r2c
.g2_kernel_a_r2b:
  s_ff1_i32_b32 s33, s33
  s_bitset1_b32 s34, s33
  s_xor_b32 s33, s33, s24
  s_lshl_b32 s33, s33, s25
  s_add_u32 s22, s20, s33
  s_addc_u32 s23, s21, 0
  global_load_dwordx4 v[208:211], v3, s[22:23] offset:0
  global_load_dwordx4 v[212:215], v3, s[22:23] offset:1024
  global_load_dwordx4 v[216:219], v3, s[22:23] offset:2048
  global_load_dwordx4 v[220:223], v3, s[22:23] offset:3072
  s_setpc_b64 s[72:73]
.g2_kernel_a_N0c:
  s_call_b64 s[68:69], .g2_kernel_a_pick
  s_branch .g2_kernel_a_N0b
.g2_kernel_a_N1c:
  s_call_b64 s[68:69], .g2_kernel_a_pick
  s_branch .g2_kernel_a_N1b
.g2_kernel_a_N2c:
  s_call_b64 s[68:69], .g2_kernel_a_pick
  s_branch .g2_kernel_a_N2b
.g2_kernel_a_N3c:
  s_call_b64 s[68:69], .g2_kernel_a_pick
  s_branch .g2_kernel_a_N3b
.g2_kernel_a_L3c:
  s_call_b64 s[68:69], .g2_kernel_a_pick
  s_branch .g2_kernel_a_L3b
.g2_kernel_a_G0c:
  s_call_b64 s[68:69], .g2_kernel_a_pick
  s_branch .g2_kernel_a_G0b
.g2_kernel_a_L3g:
  s_mov_b32 s38, 0
.g2_kernel_a_L3gl:
  ds_read_b32 v7, v13 offset:8
  s_add_u32 s38, s38, 1
  s_waitcnt lgkmcnt(0)
  v_cmp_gt_u32 vcc, s27, v7
  s_cbranch_vccz .g2_kernel_a_L3h
  s_cmp_lt_u32 s38, 524288
  s_cbranch_scc1 .g2_kernel_a_L3gl
  s_branch .g2_kernel_a_L3h
.g2_kernel_a_hold:
  s_lshl_b32 s33, 1, s14
  s_lshr_b32 s14, s14, 8
  s_setpc_b64 s[68:69]
.g2_kernel_a_pick:
  s_cmp_lg_u32 s34, -1
  s_cbranch_scc1 .g2_kernel_a_pk1
  s_cmp_eq_u32 s26, -1
  s_cbranch_scc1 .g2_kernel_a_hold
  s_add_u32 s26, s26, 1
  s_mov_b32 s34, 0xffff
  s_cmp_eq_u32 s26, 1
  s_cbranch_scc1 .g2_kernel_a_pk0
  v_and_b32 v8, 15, v2
  s_lshl_b32 s28, s16, 6
  s_add_u32 s28, s28, 157696
  v_lshl_add_u32 v8, v8, 2, s28
  s_lshl_b32 s28, s17, 2
  s_add_u32 s28, s28, s16
  s_lshl_b32 s28, s28, 16
  s_add_u32 s28, s28, s63
  s_add_u32 s28, s28, 0x800000
  s_add_u32 s20, s60, s28
  s_addc_u32 s21, s61, 0
  s_lshl_b32 s24, s18, 1
  s_and_b32 s24, s24, 6
  s_mov_b32 s25, 12
  s_mov_b32 s34, 0
  s_mov_b32 s36, 0xff
  s_mov_b32 s33, 0xff
  s_mov_b32 s38, 0
.g2_kernel_a_pk2:
  ds_read_b32 v7, v8
  s_add_u32 s38, s38, 1
  s_waitcnt lgkmcnt(0)
  v_cmp_ge_u32 vcc, s62, v7
  s_cbranch_vccz .g2_kernel_a_pkr
  s_cmp_lt_u32 s38, 524288
  s_cbranch_scc1 .g2_kernel_a_pk2
  s_branch .g2_kernel_a_pkr
.g2_kernel_a_pk0:
  s_andn2_b32 s33, s36, s34
  s_cbranch_scc1 .g2_kernel_a_pkr
.g2_kernel_a_pk1:
  s_mov_b32 s38, 0
.g2_kernel_a_pkl:
  ds_read_b32 v7, v8
  s_add_u32 s38, s38, 1
  s_waitcnt lgkmcnt(0)
  v_cmp_lt_u32 vcc, s62, v7
  s_mov_b32 s36, vcc_lo
  s_andn2_b32 s33, s36, s34
  s_cbranch_scc1 .g2_kernel_a_pkr
  s_cmp_lt_u32 s38, 524288
  s_cbranch_scc1 .g2_kernel_a_pkl
  s_not_b32 s33, s34
.g2_kernel_a_pkr:
  s_setpc_b64 s[68:69]
.g2_kernel_w_aw:
  v_mov_b32 v6, s71
  s_mov_b32 s38, 0
.g2_kernel_wg6:
  ds_read_b32 v7, v6 offset:52
  s_add_u32 s38, s38, 1
  s_waitcnt lgkmcnt(0)
  v_cmp_gt_u32 vcc, 4, v7
  s_cbranch_vccz .g2_kernel_wg6d
  s_sleep 1
  s_cmp_lt_u32 s38, 524288
  s_cbranch_scc1 .g2_kernel_wg6
.g2_kernel_wg6d:
  s_branch .g2_kernel_w_ab
.g2_kernel_w_pt:
  v_lshlrev_b32 v7, 5, v17
  v_add_u32 v7, 155648, v7
  s_mov_b64 exec, vcc
  ds_read_b128 v[240:243], v7 offset:7680
  ds_read_b128 v[244:247], v7 offset:7696
  ds_read_b128 v[248:251], v7 offset:7744
  ds_read_b128 v[252:255], v7 offset:7760
  s_waitcnt lgkmcnt(0)
  v_pk_add_f32 v[24:25], v[24:25], v[240:241]
  v_pk_add_f32 v[26:27], v[26:27], v[242:243]
  v_pk_add_f32 v[28:29], v[28:29], v[244:245]
  v_pk_add_f32 v[30:31], v[30:31], v[246:247]
  v_pk_add_f32 v[32:33], v[32:33], v[248:249]
  v_pk_add_f32 v[34:35], v[34:35], v[250:251]
  v_pk_add_f32 v[36:37], v[36:37], v[252:253]
  v_pk_add_f32 v[38:39], v[38:39], v[254:255]
  ds_read_b128 v[240:243], v7 offset:7808
  ds_read_b128 v[244:247], v7 offset:7824
  ds_read_b128 v[248:251], v7 offset:7872
  ds_read_b128 v[252:255], v7 offset:7888
  s_waitcnt lgkmcnt(0)
  v_pk_add_f32 v[40:41], v[40:41], v[240:241]
  v_pk_add_f32 v[42:43], v[42:43], v[242:243]
  v_pk_add_f32 v[44:45], v[44:45], v[244:245]
  v_pk_add_f32 v[46:47], v[46:47], v[246:247]
  v_pk_add_f32 v[48:49], v[48:49], v[248:249]
  v_pk_add_f32 v[50:51], v[50:51], v[250:251]
  v_pk_add_f32 v[52:53], v[52:53], v[252:253]
  v_pk_add_f32 v[54:55], v[54:55], v[254:255]
  s_mov_b64 exec, -1
  s_branch .g2_kernel_w_pb
.g2_kernel_w_i8c:
  s_mov_b32 s38, 0
  s_call_b64 s[68:69], .g2_kernel_w_pkl
  s_branch .g2_kernel_w_i8b
.g2_kernel_w_i9c:
  s_mov_b32 s38, 0
  s_call_b64 s[68:69], .g2_kernel_w_pkl
  s_branch .g2_kernel_w_i9b
.g2_kernel_w_i10c:
  s_mov_b32 s38, 0
  s_call_b64 s[68:69], .g2_kernel_w_pkl
  s_branch .g2_kernel_w_i10b
.g2_kernel_w_i11c:
  s_mov_b32 s38, 0
  s_call_b64 s[68:69], .g2_kernel_w_pkl
  s_branch .g2_kernel_w_i11b
.g2_kernel_w_v8:
  s_cmp_ge_u32 s8, 139264
  s_cselect_b32 s28, 139264, 0
  s_sub_u32 s28, s8, s28
  s_lshr_b32 s28, s28, 1
  s_add_u32 s28, s28, 32768
  s_add_u32 s22, s20, s28
  s_addc_u32 s23, s21, 0
  s_mov_b32 s38, 0
.g2_kernel_w_vl8:
  global_load_dwordx4 v[88:91], v3, s[22:23] offset:0 sc1
  global_load_dwordx4 v[92:95], v3, s[22:23] offset:1024 sc1
  global_load_dwordx4 v[96:99], v3, s[22:23] offset:2048 sc1
  global_load_dwordx4 v[100:103], v3, s[22:23] offset:3072 sc1
  s_add_u32 s38, s38, 1
  s_waitcnt vmcnt(0)
  v_min3_u32 v6, v88, v90, v92
  v_min3_u32 v7, v94, v96, v98
  v_min3_u32 v6, v6, v100, v102
  v_min_u32 v6, v6, v7
  v_cmp_eq_u32 vcc, 0, v6
  s_cbranch_vccz .g2_kernel_w_vb8
  s_cmp_lt_u32 s38, 131072
  s_cbranch_scc1 .g2_kernel_w_vl8
  s_branch .g2_kernel_w_vb8
.g2_kernel_w_i12c:
  s_mov_b32 s38, 0
  s_call_b64 s[68:69], .g2_kernel_w_pkl
  s_branch .g2_kernel_w_i12b
.g2_kernel_w_v9:
  s_cmp_ge_u32 s9, 139264
  s_cselect_b32 s28, 139264, 0
  s_sub_u32 s28, s9, s28
  s_lshr_b32 s28, s28, 1
  s_add_u32 s28, s28, 32768
  s_add_u32 s22, s20, s28
  s_addc_u32 s23, s21, 0
  s_mov_b32 s38, 0
.g2_kernel_w_vl9:
  global_load_dwordx4 v[176:179], v3, s[22:23] offset:0 sc1
  global_load_dwordx4 v[180:183], v3, s[22:23] offset:1024 sc1
  global_load_dwordx4 v[184:187], v3, s[22:23] offset:2048 sc1
  global_load_dwordx4 v[188:191], v3, s[22:23] offset:3072 sc1
  s_add_u32 s38, s38, 1
  s_waitcnt vmcnt(0)
  v_min3_u32 v6, v176, v178, v180
  v_min3_u32 v7, v182, v184, v186
  v_min3_u32 v6, v6, v188, v190
  v_min_u32 v6, v6, v7
  v_cmp_eq_u32 vcc, 0, v6
  s_cbranch_vccz .g2_kernel_w_vb9
  s_cmp_lt_u32 s38, 131072
  s_cbranch_scc1 .g2_kernel_w_vl9
  s_branch .g2_kernel_w_vb9
.g2_kernel_w_i13c:
  s_mov_b32 s38, 0
  s_call_b64 s[68:69], .g2_kernel_w_pkl
  s_branch .g2_kernel_w_i13b
.g2_kernel_w_v10:
  s_cmp_ge_u32 s10, 139264
  s_cselect_b32 s28, 139264, 0
  s_sub_u32 s28, s10, s28
  s_lshr_b32 s28, s28, 1
  s_add_u32 s28, s28, 32768
  s_add_u32 s22, s20, s28
  s_addc_u32 s23, s21, 0
  s_mov_b32 s38, 0
.g2_kernel_w_vl10:
  global_load_dwordx4 v[192:195], v3, s[22:23] offset:0 sc1
  global_load_dwordx4 v[196:199], v3, s[22:23] offset:1024 sc1
  global_load_dwordx4 v[200:203], v3, s[22:23] offset:2048 sc1
  global_load_dwordx4 v[204:207], v3, s[22:23] offset:3072 sc1
  s_add_u32 s38, s38, 1
  s_waitcnt vmcnt(0)
  v_min3_u32 v6, v192, v194, v196
  v_min3_u32 v7, v198, v200, v202
  v_min3_u32 v6, v6, v204, v206
  v_min_u32 v6, v6, v7
  v_cmp_eq_u32 vcc, 0, v6
  s_cbranch_vccz .g2_kernel_w_vb10
  s_cmp_lt_u32 s38, 131072
  s_cbranch_scc1 .g2_kernel_w_vl10
  s_branch .g2_kernel_w_vb10
.g2_kernel_w_i14c:
  s_mov_b32 s38, 524288
  s_call_b64 s[68:69], .g2_kernel_w_pkl
  s_branch .g2_kernel_w_i14b
.g2_kernel_w_v11:
  s_cmp_ge_u32 s11, 139264
  s_cselect_b32 s28, 139264, 0
  s_sub_u32 s28, s11, s28
  s_lshr_b32 s28, s28, 1
  s_add_u32 s28, s28, 32768
  s_add_u32 s22, s20, s28
  s_addc_u32 s23, s21, 0
  s_mov_b32 s38, 0
.g2_kernel_w_vl11:
  global_load_dwordx4 v[208:211], v3, s[22:23] offset:0 sc1
  global_load_dwordx4 v[212:215], v3, s[22:23] offset:1024 sc1
  global_load_dwordx4 v[216:219], v3, s[22:23] offset:2048 sc1
  global_load_dwordx4 v[220:223], v3, s[22:23] offset:3072 sc1
  s_add_u32 s38, s38, 1
  s_waitcnt vmcnt(0)
  v_min3_u32 v6, v208, v210, v212
  v_min3_u32 v7, v214, v216, v218
  v_min3_u32 v6, v6, v220, v222
  v_min_u32 v6, v6, v7
  v_cmp_eq_u32 vcc, 0, v6
  s_cbranch_vccz .g2_kernel_w_vb11
  s_cmp_lt_u32 s38, 131072
  s_cbranch_scc1 .g2_kernel_w_vl11
  s_branch .g2_kernel_w_vb11
.g2_kernel_w_i15c:
  s_mov_b32 s38, 524288
  s_call_b64 s[68:69], .g2_kernel_w_pkl
  s_branch .g2_kernel_w_i15b
.g2_kernel_w_v12:
  s_cmp_ge_u32 s12, 139264
  s_cselect_b32 s28, 139264, 0
  s_sub_u32 s28, s12, s28
  s_lshr_b32 s28, s28, 1
  s_add_u32 s28, s28, 32768
  s_add_u32 s22, s20, s28
  s_addc_u32 s23, s21, 0
  s_mov_b32 s38, 0
.g2_kernel_w_vl12:
  global_load_dwordx4 v[224:227], v3, s[22:23] offset:0 sc1
  global_load_dwordx4 v[228:231], v3, s[22:23] offset:1024 sc1
  global_load_dwordx4 v[232:235], v3, s[22:23] offset:2048 sc1
  global_load_dwordx4 v[236:239], v3, s[22:23] offset:3072 sc1
  s_add_u32 s38, s38, 1
  s_waitcnt vmcnt(0)
  v_min3_u32 v6, v224, v226, v228
  v_min3_u32 v7, v230, v232, v234
  v_min3_u32 v6, v6, v236, v238
  v_min_u32 v6, v6, v7
  v_cmp_eq_u32 vcc, 0, v6
  s_cbranch_vccz .g2_kernel_w_vb12
  s_cmp_lt_u32 s38, 131072
  s_cbranch_scc1 .g2_kernel_w_vl12
  s_branch .g2_kernel_w_vb12
.g2_kernel_w_v13:
  s_cmp_ge_u32 s13, 139264
  s_cselect_b32 s28, 139264, 0
  s_sub_u32 s28, s13, s28
  s_lshr_b32 s28, s28, 1
  s_add_u32 s28, s28, 32768
  s_add_u32 s22, s20, s28
  s_addc_u32 s23, s21, 0
  s_mov_b32 s38, 0
.g2_kernel_w_vl13:
  global_load_dwordx4 v[136:139], v3, s[22:23] offset:0 sc1
  global_load_dwordx4 v[140:143], v3, s[22:23] offset:1024 sc1
  global_load_dwordx4 v[144:147], v3, s[22:23] offset:2048 sc1
  global_load_dwordx4 v[148:151], v3, s[22:23] offset:3072 sc1
  s_add_u32 s38, s38, 1
  s_waitcnt vmcnt(0)
  v_min3_u32 v6, v136, v138, v140
  v_min3_u32 v7, v142, v144, v146
  v_min3_u32 v6, v6, v148, v150
  v_min_u32 v6, v6, v7
  v_cmp_eq_u32 vcc, 0, v6
  s_cbranch_vccz .g2_kernel_w_vb13
  s_cmp_lt_u32 s38, 131072
  s_cbranch_scc1 .g2_kernel_w_vl13
  s_branch .g2_kernel_w_vb13
.g2_kernel_w_v14:
  s_cmp_ge_u32 s14, 139264
  s_cselect_b32 s28, 139264, 0
  s_sub_u32 s28, s14, s28
  s_lshr_b32 s28, s28, 1
  s_add_u32 s28, s28, 32768
  s_add_u32 s22, s20, s28
  s_addc_u32 s23, s21, 0
  s_mov_b32 s38, 0
.g2_kernel_w_vl14:
  global_load_dwordx4 v[152:155], v3, s[22:23] offset:0 sc1
  global_load_dwordx4 v[156:159], v3, s[22:23] offset:1024 sc1
  global_load_dwordx4 v[160:163], v3, s[22:23] offset:2048 sc1
  global_load_dwordx4 v[164:167], v3, s[22:23] offset:3072 sc1
  s_add_u32 s38, s38, 1
  s_waitcnt vmcnt(0)
  v_min3_u32 v6, v152, v154, v156
  v_min3_u32 v7, v158, v160, v162
  v_min3_u32 v6, v6, v164, v166
  v_min_u32 v6, v6, v7
  v_cmp_eq_u32 vcc, 0, v6
  s_cbranch_vccz .g2_kernel_w_vb14
  s_cmp_lt_u32 s38, 131072
  s_cbranch_scc1 .g2_kernel_w_vl14
  s_branch .g2_kernel_w_vb14
.g2_kernel_w_v15:
  s_cmp_ge_u32 s15, 139264
  s_cselect_b32 s28, 139264, 0
  s_sub_u32 s28, s15, s28
  s_lshr_b32 s28, s28, 1
  s_add_u32 s28, s28, 32768
  s_add_u32 s22, s20, s28
  s_addc_u32 s23, s21, 0
  s_mov_b32 s38, 0
.g2_kernel_w_vl15:
  global_load_dwordx4 v[56:59], v3, s[22:23] offset:0 sc1
  global_load_dwordx4 v[60:63], v3, s[22:23] offset:1024 sc1
  global_load_dwordx4 v[64:67], v3, s[22:23] offset:2048 sc1
  global_load_dwordx4 v[68:71], v3, s[22:23] offset:3072 sc1
  s_add_u32 s38, s38, 1
  s_waitcnt vmcnt(0)
  v_min3_u32 v6, v56, v58, v60
  v_min3_u32 v7, v62, v64, v66
  v_min3_u32 v6, v6, v68, v70
  v_min_u32 v6, v6, v7
  v_cmp_eq_u32 vcc, 0, v6
  s_cbranch_vccz .g2_kernel_w_vb15
  s_cmp_lt_u32 s38, 131072
  s_cbranch_scc1 .g2_kernel_w_vl15
  s_branch .g2_kernel_w_vb15
.g2_kernel_w_bw:
  s_mov_b32 s38, 0
.g2_kernel_w_bwl:
  ds_read_b32 v16, v20 offset:12
  s_add_u32 s38, s38, 1
  s_waitcnt lgkmcnt(0)
  v_cmp_gt_u32 vcc, 4, v16
  s_cbranch_vccz .g2_kernel_w_bb
  s_cmp_lt_u32 s38, 524288
  s_cbranch_scc1 .g2_kernel_w_bwl
  s_branch .g2_kernel_w_bb
.g2_kernel_w_pick:
  s_mov_b32 s38, 0
.g2_kernel_w_pkl:
  ds_read_b64 v[6:7], v21
  s_add_u32 s38, s38, 1
  s_waitcnt lgkmcnt(0)
  v_min_u32 v6, v6, v7
  v_cmp_lt_u32 vcc, s62, v6
  s_and_b32 s36, vcc_lo, 0xff00
  s_andn2_b32 s33, s36, s34
  s_cbranch_scc1 .g2_kernel_w_pkr
  s_cmp_lt_u32 s38, 524288
  s_cbranch_scc1 .g2_kernel_w_pkl
  s_andn2_b32 s33, 0xff00, s34
.g2_kernel_w_pkr:
  s_setpc_b64 s[68:69]
.g2_kernel_p_spin:
  s_mov_b32 s38, 0
.g2_kernel_p_spinl:
  ds_read_b32 v10, v9
  s_add_u32 s38, s38, 1
  s_waitcnt lgkmcnt(0)
  v_cmp_gt_i32 vcc, s34, v10
  s_cbranch_vccz .g2_kernel_p_spinr
  s_sleep 1
  s_cmp_lt_u32 s38, 524288
  s_cbranch_scc1 .g2_kernel_p_spinl
.g2_kernel_p_spinr:
  s_setpc_b64 s[68:69]
.g2_kernel_p1_aw:
  s_call_b64 s[68:69], .g2_kernel_p_spin
  s_branch .g2_kernel_p1_ai
.g2_kernel_p1_bw:
  s_call_b64 s[68:69], .g2_kernel_p_spin
  s_branch .g2_kernel_p1_bi
.g2_kernel_v_3a:
  s_and_b32 s31, s76, 0xffffe000
  s_add_u32 s31, s31, 0
  v_and_b32 v6, 15, v2
  v_lshlrev_b32 v6, 9, v6
  v_lshrrev_b32 v7, 4, v2
  v_lshl_add_u32 v6, v7, 7, v6
  v_lshlrev_b32 v7, 2, v2
  v_add_u32 v7, 157440, v7
  s_mov_b32 m0, 157440
  s_mov_b32 s38, 0
  s_mov_b32 exec_lo, 0xffff0000
  s_mov_b32 exec_hi, 0xffff0000
.g2_kernel_pa25:
  buffer_load_dword v6, s[4:7], s31 offen sc1 lds
  s_add_u32 s38, s38, 1
  s_waitcnt vmcnt(0)
  ds_read_b32 v8, v7
  s_waitcnt lgkmcnt(0)
  v_cmp_ge_u32 vcc, s62, v8
  s_cbranch_vccz .g2_kernel_pa25d
  s_mov_b64 exec, vcc
  s_sleep 16
  s_cmp_lt_u32 s38, 131072
  s_cbranch_scc1 .g2_kernel_pa25
.g2_kernel_pa25d:
  s_mov_b64 exec, -1
  s_branch .g2_kernel_v_3
.g2_kernel_v_may:
  s_cmp_lg_u32 s39, 0
  s_cbranch_scc1 .g2_kernel_v_mr
  s_and_b32 s28, s16, 3
  s_lshl_b32 s28, s28, 4
  s_add_u32 s28, s28, 155968
  v_mov_b32 v6, s28
  ds_read_b32 v7, v6
  s_waitcnt lgkmcnt(0)
  v_cmp_ne_u32 vcc, 0, v7
  s_cbranch_vccz .g2_kernel_v_mr
.g2_kernel_v_do:
  s_mov_b32 s39, 1
  s_mov_b32 s29, 0
  s_call_b64 s[68:69], .g2_kernel_v_cmb
  s_waitcnt vmcnt(0)
  v_mov_b32 v6, s71
  s_mov_b64 exec, 1
  ds_add_u32 v6, v5 offset:8
  s_mov_b64 exec, -1
  s_and_b32 s33, s16, 3
  s_lshl_b32 s33, s33, 7
  s_lshl_b32 s28, s29, 2
  s_add_u32 s33, s33, s28
  s_add_u32 s31, s19, s33
  v_mov_b32 v6, s70
  s_mov_b64 exec, 1
  buffer_store_dword v6, v4, s[4:7], s31 offen offset:0 sc1
  s_mov_b64 exec, -1
.g2_kernel_v_mr:
  s_setpc_b64 s[26:27]
.g2_kernel_v_w23:
  ds_write_b128 v3, v[128:131] offset:32768
  ds_write_b128 v3, v[132:135] offset:33792
  ds_write_b128 v3, v[136:139] offset:34816
  ds_write_b128 v3, v[140:143] offset:35840
  ds_write_b128 v3, v[144:147] offset:36864
  ds_write_b128 v3, v[148:151] offset:37888
  ds_write_b128 v3, v[152:155] offset:38912
  ds_write_b128 v3, v[156:159] offset:39936
  ds_write_b128 v3, v[160:163] offset:40960
  ds_write_b128 v3, v[164:167] offset:41984
  ds_write_b128 v3, v[168:171] offset:43008
  ds_write_b128 v3, v[172:175] offset:44032
  ds_write_b128 v3, v[176:179] offset:45056
  ds_write_b128 v3, v[180:183] offset:46080
  ds_write_b128 v3, v[184:187] offset:47104
  ds_write_b128 v3, v[188:191] offset:48128
  ds_write_b128 v3, v[192:195] offset:49152
  ds_write_b128 v3, v[196:199] offset:50176
  ds_write_b128 v3, v[200:203] offset:51200
  ds_write_b128 v3, v[204:207] offset:52224
  ds_write_b128 v3, v[208:211] offset:53248
  ds_write_b128 v3, v[212:215] offset:54272
  ds_write_b128 v3, v[216:219] offset:55296
  ds_write_b128 v3, v[220:223] offset:56320
  ds_write_b128 v3, v[224:227] offset:57344
  ds_write_b128 v3, v[228:231] offset:58368
  ds_write_b128 v3, v[232:235] offset:59392
  ds_write_b128 v3, v[236:239] offset:60416
  ds_write_b128 v3, v[240:243] offset:61440
  ds_write_b128 v3, v[244:247] offset:62464
  ds_write_b128 v3, v[248:251] offset:63488
  ds_write_b128 v3, v[252:255] offset:64512
  s_setpc_b64 s[68:69]
.g2_kernel_v_wo:
  s_mov_b32 s8, s44
  s_mov_b32 s9, s45
  s_mov_b32 s10, 0x200000
  s_mov_b32 s11, 0x00020000
  v_lshrrev_b32 v6, 3, v2
  v_and_b32 v7, 7, v2
  v_bfe_u32 v8, v2, 4, 1
  v_lshlrev_b32 v8, 2, v8
  v_xor_b32 v7, v7, v8
  v_lshlrev_b32 v7, 4, v7
  v_lshl_add_u32 v6, v6, 11, v7
  s_lshl_b32 s31, s32, 3
  s_add_u32 s31, s31, s29
  s_lshl_b32 s31, s31, 16
  s_lshl_b32 s33, s18, 7
  s_add_u32 s31, s31, s33
  s_mov_b32 m0, s30
  s_nop 0
  buffer_load_dwordx4 v6, s[8:11], s31 offen lds
  s_add_u32 m0, m0, 1024
  s_add_u32 s31, s31, 16384
  s_sleep 1
  buffer_load_dwordx4 v6, s[8:11], s31 offen lds
  s_add_u32 m0, m0, 1024
  s_add_u32 s31, s31, 16384
  s_sleep 1
  buffer_load_dwordx4 v6, s[8:11], s31 offen lds
  s_add_u32 m0, m0, 1024
  s_add_u32 s31, s31, 16384
  s_sleep 1
  buffer_load_dwordx4 v6, s[8:11], s31 offen lds
  s_add_u32 m0, m0, 1024
  s_add_u32 s31, s31, 81920
  s_sleep 1
  buffer_load_dwordx4 v6, s[8:11], s31 offen lds
  s_add_u32 m0, m0, 1024
  s_add_u32 s31, s31, 16384
  s_sleep 1
  buffer_load_dwordx4 v6, s[8:11], s31 offen lds
  s_add_u32 m0, m0, 1024
  s_add_u32 s31, s31, 16384
  s_sleep 1
  buffer_load_dwordx4 v6, s[8:11], s31 offen lds
  s_add_u32 m0, m0, 1024
  s_add_u32 s31, s31, 16384
  s_sleep 1
  buffer_load_dwordx4 v6, s[8:11], s31 offen lds
  s_add_u32 m0, m0, 1024
  s_add_u32 s31, s31, 81920
  s_sleep 1
  buffer_load_dwordx4 v6, s[8:11], s31 offen lds
  s_add_u32 m0, m0, 1024
  s_add_u32 s31, s31, 16384
  s_sleep 1
  buffer_load_dwordx4 v6, s[8:11], s31 offen lds
  s_add_u32 m0, m0, 1024
  s_add_u32 s31, s31, 16384
  s_sleep 1
  buffer_load_dwordx4 v6, s[8:11], s31 offen lds
  s_add_u32 m0, m0, 1024
  s_add_u32 s31, s31, 16384
  s_sleep 1
  buffer_load_dwordx4 v6, s[8:11], s31 offen lds
  s_add_u32 m0, m0, 1024
  s_add_u32 s31, s31, 81920
  s_sleep 1
  buffer_load_dwordx4 v6, s[8:11], s31 offen lds
  s_add_u32 m0, m0, 1024
  s_add_u32 s31, s31, 16384
  s_sleep 1
  buffer_load_dwordx4 v6, s[8:11], s31 offen lds
  s_add_u32 m0, m0, 1024
  s_add_u32 s31, s31, 16384
  s_sleep 1
  buffer_load_dwordx4 v6, s[8:11], s31 offen lds
  s_add_u32 m0, m0, 1024
  s_add_u32 s31, s31, 16384
  s_sleep 1
  buffer_load_dwordx4 v6, s[8:11], s31 offen lds
  s_setpc_b64 s[68:69]
.g2_kernel_v_cmb:
  s_and_b32 s28, s16, 3
  s_lshl_b32 s30, s28, 2
  s_lshl_b32 s34, 15, s30
  s_lshr_b32 s32, s34, 4
  s_or_b32 s32, s32, s34
  s_mul_i32 s32, s32, s29
  v_and_b32 v6, 15, v2
  v_lshlrev_b32 v6, 2, v6
  v_add_u32 v6, 155968, v6
  s_mov_b32 s30, .g2_kernel_sel-.g2_kernel_pc
  buffer_load_dwordx4 v[8:11], v3, s[64:67], s30 offen
  buffer_load_dwordx4 v[12:15], v3, s[64:67], s30 offen offset:1024
  s_lshl_b32 s30, s28, 13
  v_add_u32 v0, s30, v3
  v_and_b32 v4, 31, v2
  s_lshl_b32 s31, s28, 9
  s_add_u32 s31, s31, 161280
  v_lshl_add_u32 v4, v4, 2, s31
  s_lshl_b32 s33, s62, 1
  s_add_u32 s33, s33, s29
  s_lshl_b32 s31, s17, 2
  s_add_u32 s31, s31, s28
  s_lshl_b32 s31, s31, 1
  s_add_u32 s31, s31, s29
  s_lshl_b32 s31, s31, 4
  s_add_u32 s31, s31, s18
  s_lshl_b32 s31, s31, 11
  s_add_u32 s31, s31, s63
  s_add_u32 s35, s31, 0x800000
  s_mov_b32 s38, 0
  s_waitcnt vmcnt(0)
.g2_kernel_v_cmbw:
  ds_read_b32 v7, v6
  s_add_u32 s38, s38, 1
  s_waitcnt lgkmcnt(0)
  v_cmp_ge_u32 vcc, s33, v7
  s_and_b32 s30, vcc_lo, s34
  s_cbranch_scc0 .g2_kernel_v_cmbd
  s_orn2_b32 s30, vcc_lo, s32
  s_cmp_lg_u32 s30, -1
  s_cbranch_scc1 .g2_kernel_v_cmbq
  s_sleep 6
.g2_kernel_v_cmbq:
  s_sleep 1
  s_cmp_lt_u32 s38, 524288
  s_cbranch_scc1 .g2_kernel_v_cmbw
.g2_kernel_v_cmbd:
  s_setprio 3
  ds_read_b128 v[32:35], v0 offset:0
  ds_read_b128 v[36:39], v0 offset:1024
  ds_read_b128 v[40:43], v0 offset:2048
  ds_read_b128 v[44:47], v0 offset:3072
  ds_read_b128 v[48:51], v0 offset:4096
  ds_read_b128 v[52:55], v0 offset:5120
  ds_read_b128 v[56:59], v0 offset:6144
  ds_read_b128 v[60:63], v0 offset:7168
  ds_read2_b32 v[6:7], v4 offset0:64 offset1:96
  ds_read2_b32 v[4:5], v4 offset0:0 offset1:32
  s_lshl_b32 s30, s28, 2
  s_add_u32 s30, s30, s71
  s_waitcnt lgkmcnt(9)
  v_mfma_f32_32x32x16_bf16 v[16:31], v[8:11], v[32:35], 0
  s_waitcnt lgkmcnt(8)
  v_mfma_f32_32x32x16_bf16 v[16:31], v[12:15], v[36:39], v[16:31]
  s_waitcnt lgkmcnt(7)
  v_mfma_f32_32x32x16_bf16 v[16:31], v[8:11], v[40:43], v[16:31]
  s_waitcnt lgkmcnt(6)
  v_mfma_f32_32x32x16_bf16 v[16:31], v[12:15], v[44:47], v[16:31]
  s_waitcnt lgkmcnt(5)
  v_mfma_f32_32x32x16_bf16 v[16:31], v[8:11], v[48:51], v[16:31]
  s_waitcnt lgkmcnt(4)
  v_mfma_f32_32x32x16_bf16 v[16:31], v[12:15], v[52:55], v[16:31]
  s_waitcnt lgkmcnt(3)
  v_mfma_f32_32x32x16_bf16 v[16:31], v[8:11], v[56:59], v[16:31]
  s_waitcnt lgkmcnt(2)
  v_mfma_f32_32x32x16_bf16 v[16:31], v[12:15], v[60:63], v[16:31]
  v_mov_b32 v0, s30
  s_waitcnt lgkmcnt(0)
  v_add_f32 v6, v6, v4
  v_add_f32 v7, v7, v5
  v_mov_b32 v4, 0
  v_mov_b32 v5, s29
  ds_write_b32 v0, v5 offset:64
  v_add_f32 v9, v6, v7
  s_mov_b32 s30, 8.673617379884035e-19
  s_mov_b32 s31, 1.152921504606847e+18
  v_rcp_f32 v10, v9
  v_cmp_le_f32 vcc, s30, v9
  v_cmp_ge_f32 s[36:37], s31, v9
  v_mov_b32 v5, 1
  v_mul_f32 v10, 4.0, v10
  s_and_b64 s[36:37], s[36:37], vcc
  v_cmp_o_f32 vcc, v16, v16
  s_and_b64 vcc, vcc, s[36:37]
  s_cmp_eq_u64 vcc, -1
  s_cbranch_scc0 .g2_kernel_v_cmbslow
.g2_kernel_v_cmbfin:
  v_mul_f32 v16, v16, v10
  v_mul_f32 v17, v17, v10
  v_mul_f32 v18, v18, v10
  v_mul_f32 v19, v19, v10
  v_mul_f32 v20, v20, v10
  v_mul_f32 v21, v21, v10
  v_mul_f32 v22, v22, v10
  v_mul_f32 v23, v23, v10
  v_cvt_pk_bf16_f32 v32, v16, v17
  v_cvt_pk_bf16_f32 v33, v18, v19
  v_cvt_pk_bf16_f32 v34, v20, v21
  v_cvt_pk_bf16_f32 v35, v22, v23
  v_max_u32 v32, 1, v32
  v_max_u32 v34, 1, v34
  buffer_store_dwordx4 v[32:35], v3, s[4:7], s35 offen offset:0 sc1
  v_mul_f32 v24, v24, v10
  v_mul_f32 v25, v25, v10
  v_mul_f32 v26, v26, v10
  v_mul_f32 v27, v27, v10
  v_mul_f32 v28, v28, v10
  v_mul_f32 v29, v29, v10
  v_mul_f32 v30, v30, v10
  v_mul_f32 v31, v31, v10
  v_cvt_pk_bf16_f32 v36, v24, v25
  v_cvt_pk_bf16_f32 v37, v26, v27
  v_cvt_pk_bf16_f32 v38, v28, v29
  v_cvt_pk_bf16_f32 v39, v30, v31
  v_max_u32 v36, 1, v36
  v_max_u32 v38, 1, v38
  buffer_store_dwordx4 v[36:39], v3, s[4:7], s35 offen offset:1024 sc1
  s_setprio 3
  s_setpc_b64 s[68:69]
.g2_kernel_v_cmbslow:
  s_setprio 0
  s_lshl_b32 s30, s28, 11
  s_mul_i32 s31, s29, -8192
  s_add_u32 s30, s30, s31
  s_add_u32 s30, s30, 139264
  v_add_u32 v6, s30, v3
  ds_read_b128 v[48:51], v6
  ds_read_b128 v[52:55], v6 offset:1024
  s_lshl_b32 s36, s18, 1
  s_add_u32 s36, s36, s29
  s_lshl_b32 s36, s36, 18
  s_add_u32 s36, s36, s63
  s_mov_b32 s30, s36
  s_mov_b32 s33, 64
  v_mov_b32 v10, 0xff800000
  s_waitcnt lgkmcnt(0)
.g2_kernel_v_cmbs1:
  buffer_load_dwordx4 v[56:59], v3, s[4:7], s30 offen offset:0
  buffer_load_dwordx4 v[60:63], v3, s[4:7], s30 offen offset:1024
  s_waitcnt vmcnt(0)
  v_mfma_f32_32x32x16_bf16 v[32:47], v[56:59], v[48:51], 0
  v_mfma_f32_32x32x16_bf16 v[32:47], v[60:63], v[52:55], v[32:47]
  s_nop 11
  v_max3_f32 v10, v10, v32, v33
  v_max3_f32 v10, v10, v34, v35
  v_max3_f32 v10, v10, v36, v37
  v_max3_f32 v10, v10, v38, v39
  v_max3_f32 v10, v10, v40, v41
  v_max3_f32 v10, v10, v42, v43
  v_max3_f32 v10, v10, v44, v45
  v_max3_f32 v10, v10, v46, v47
  s_add_u32 s30, s30, 4096
  s_sub_u32 s33, s33, 1
  s_cmp_lg_u32 s33, 0
  s_cbranch_scc1 .g2_kernel_v_cmbs1
  v_mov_b32 v11, v10
  s_nop 1
  v_permlane32_swap_b32 v11, v10
  v_max_f32 v10, v10, v11
  v_mov_b32 v9, 0
  v_mov_b32 v16, 0
  v_mov_b32 v17, 0
  v_mov_b32 v18, 0
  v_mov_b32 v19, 0
  v_mov_b32 v20, 0
  v_mov_b32 v21, 0
  v_mov_b32 v22, 0
  v_mov_b32 v23, 0
  v_mov_b32 v24, 0
  v_mov_b32 v25, 0
  v_mov_b32 v26, 0
  v_mov_b32 v27, 0
  v_mov_b32 v28, 0
  v_mov_b32 v29, 0
  v_mov_b32 v30, 0
  v_mov_b32 v31, 0
  s_mov_b32 s30, s36
  s_mov_b32 s33, 64
.g2_kernel_v_cmbs2:
  buffer_load_dwordx4 v[56:59], v3, s[4:7], s30 offen offset:0
  buffer_load_dwordx4 v[60:63], v3, s[4:7], s30 offen offset:1024
  s_waitcnt vmcnt(0)
  v_mfma_f32_32x32x16_bf16 v[32:47], v[56:59], v[48:51], 0
  v_mfma_f32_32x32x16_bf16 v[32:47], v[60:63], v[52:55], v[32:47]
  s_nop 11
  v_sub_f32 v32, v32, v10
  v_sub_f32 v33, v33, v10
  v_sub_f32 v34, v34, v10
  v_sub_f32 v35, v35, v10
  v_sub_f32 v36, v36, v10
  v_sub_f32 v37, v37, v10
  v_sub_f32 v38, v38, v10
  v_sub_f32 v39, v39, v10
  v_sub_f32 v40, v40, v10
  v_sub_f32 v41, v41, v10
  v_sub_f32 v42, v42, v10
  v_sub_f32 v43, v43, v10
  v_sub_f32 v44, v44, v10
  v_sub_f32 v45, v45, v10
  v_sub_f32 v46, v46, v10
  v_sub_f32 v47, v47, v10
  buffer_load_dwordx4 v[56:59], v3, s[4:7], s30 offen offset:2048
  buffer_load_dwordx4 v[60:63], v3, s[4:7], s30 offen offset:3072
  v_exp_f32 v32, v32
  v_exp_f32 v33, v33
  v_exp_f32 v34, v34
  v_exp_f32 v35, v35
  v_exp_f32 v36, v36
  v_exp_f32 v37, v37
  v_exp_f32 v38, v38
  v_exp_f32 v39, v39
  v_exp_f32 v40, v40
  v_exp_f32 v41, v41
  v_exp_f32 v42, v42
  v_exp_f32 v43, v43
  v_exp_f32 v44, v44
  v_exp_f32 v45, v45
  v_exp_f32 v46, v46
  v_exp_f32 v47, v47
  v_add_f32 v9, v9, v32
  v_add_f32 v9, v9, v33
  v_add_f32 v9, v9, v34
  v_add_f32 v9, v9, v35
  v_add_f32 v9, v9, v36
  v_add_f32 v9, v9, v37
  v_add_f32 v9, v9, v38
  v_add_f32 v9, v9, v39
  v_add_f32 v9, v9, v40
  v_add_f32 v9, v9, v41
  v_add_f32 v9, v9, v42
  v_add_f32 v9, v9, v43
  v_add_f32 v9, v9, v44
  v_add_f32 v9, v9, v45
  v_add_f32 v9, v9, v46
  v_add_f32 v9, v9, v47
  v_cvt_pk_bf16_f32 v32, v32, v33
  v_cvt_pk_bf16_f32 v33, v34, v35
  v_cvt_pk_bf16_f32 v34, v36, v37
  v_cvt_pk_bf16_f32 v35, v38, v39
  v_cvt_pk_bf16_f32 v36, v40, v41
  v_cvt_pk_bf16_f32 v37, v42, v43
  v_cvt_pk_bf16_f32 v38, v44, v45
  v_cvt_pk_bf16_f32 v39, v46, v47
  s_waitcnt vmcnt(0)
  v_mfma_f32_32x32x16_bf16 v[16:31], v[56:59], v[32:35], v[16:31]
  v_mfma_f32_32x32x16_bf16 v[16:31], v[60:63], v[36:39], v[16:31]
  s_nop 15
  s_add_u32 s30, s30, 4096
  s_sub_u32 s33, s33, 1
  s_cmp_lg_u32 s33, 0
  s_cbranch_scc1 .g2_kernel_v_cmbs2
  v_mov_b32 v11, v9
  s_nop 1
  v_permlane32_swap_b32 v11, v9
  v_add_f32 v9, v9, v11
  v_rcp_f32 v10, v9
  s_branch .g2_kernel_v_cmbfin
.g2_kernel_p2_xw:
  s_mov_b32 s38, 0
.g2_kernel_p2_xwl:
  ds_read_b32 v12, v11
  s_add_u32 s38, s38, 1
  s_waitcnt lgkmcnt(0)
  v_cmp_ne_u32 vcc, 0, v12
  s_and_b32 s37, vcc_lo, vcc_hi
  s_lshr_b32 s33, s37, 16
  s_and_b32 s37, s37, s33
  s_bitcmp1_b32 s37, s28
  s_cbranch_scc1 .g2_kernel_p2_xwr
  s_sleep 1
  s_cmp_lt_u32 s38, 524288
  s_cbranch_scc1 .g2_kernel_p2_xwl
.g2_kernel_p2_xwr:
  s_setpc_b64 s[68:69]
.g2_kernel_p2_x0w:
  s_call_b64 s[68:69], .g2_kernel_p2_xw
  s_branch .g2_kernel_p2_x0b
.g2_kernel_p2_x1w:
  s_call_b64 s[68:69], .g2_kernel_p2_xw
  s_branch .g2_kernel_p2_x1b
.g2_kernel_p2_x2w:
  s_call_b64 s[68:69], .g2_kernel_p2_xw
  s_branch .g2_kernel_p2_x2b
.g2_kernel_p2_aw:
  s_call_b64 s[68:69], .g2_kernel_p_spin
  s_branch .g2_kernel_p2_ai
.g2_kernel_p2_x3w:
  s_call_b64 s[68:69], .g2_kernel_p2_xw
  s_branch .g2_kernel_p2_x3b
.g2_kernel_p2_bw:
  s_call_b64 s[68:69], .g2_kernel_p_spin
  s_branch .g2_kernel_p2_bi
.g2_kernel_amax:
  v_mov_b32 v16, 0xff7fffff
  v_lshlrev_b32 v7, 7, v2
  s_mov_b32 s38, 0
  s_mov_b64 exec, s[8:9]
.g2_kernel_amaxl:
  buffer_load_dwordx2 v[16:17], v7, s[4:7], s23 offen sc1
  s_add_u32 s38, s38, 1
  s_waitcnt vmcnt(0)
  v_cmp_eq_u32 vcc, 0, v17
  s_cbranch_vccz .g2_kernel_amaxd
  s_mov_b64 exec, vcc
  s_sleep 4
  s_cmp_lg_u32 s62, 0
  s_cbranch_scc1 .g2_kernel_nap58
  s_sleep 8
.g2_kernel_nap58:
  s_cmp_eq_u32 s39, 1
  s_cbranch_scc0 .g2_kernel_amaxz
  s_sleep 8
.g2_kernel_amaxz:
  s_cmp_lt_u32 s38, 131072
  s_cbranch_scc1 .g2_kernel_amaxl
.g2_kernel_amaxd:
  s_mov_b64 exec, -1
  v_mov_b32 v6, v16
  s_nop 1
  v_max_f32 v7, v6, v6 row_ror:8 row_mask:0xf bank_mask:0xf
  s_nop 1
  v_max_f32 v7, v7, v7 row_ror:4 row_mask:0xf bank_mask:0xf
  s_nop 1
  v_max_f32 v7, v7, v7 row_ror:2 row_mask:0xf bank_mask:0xf
  s_nop 1
  v_max_f32 v7, v7, v7 row_ror:1 row_mask:0xf bank_mask:0xf
  s_nop 1
  v_max_f32 v7, v7, v7 row_bcast:15 row_mask:0xa bank_mask:0xf
  s_nop 1
  v_max_f32 v7, v7, v7 row_bcast:31 row_mask:0xc bank_mask:0xf
  s_nop 0
  v_readlane_b32 s27, v7, 63
  s_nop 1
  v_cmp_eq_u32 vcc, s27, v6
  s_ff1_i32_b64 s77, vcc
  s_lshl_b32 s77, s77, 5
  s_and_b32 s28, s27, 31
  s_add_u32 s77, s77, s28
  s_and_b32 s77, s77, 2047
  s_setpc_b64 s[68:69]
  .p2align 8
.g2_kernel_tab:
  .long 0, 1, 2, 3, 4, 5, 6, 7
  .long 8, 9, 10, 11, 12, 13, 14, 15
  .long 16, 17, 18, 19, 20, 21, 22, 23
  .long 24, 25, 26, 27, 28, 29, 30, 31
  .long 32, 33, 34, 35, 36, 37, 38, 39
  .long 40, 41, 42, 43, 44, 45, 46, 47
  .long 48, 49, 50, 51, 52, 53, 54, 55
  .long 56, 57, 58, 59, 60, 61, 62, 63
  .long 64, 65, 66, 67, 68, 69, 70, 71
  .p2align 4
.g2_kernel_sel:
  .long 0x3e80, 0x0, 0x0, 0x0
  .long 0x3e800000, 0x0, 0x0, 0x0
  .long 0x0, 0x3e80, 0x0, 0x0
  .long 0x0, 0x3e800000, 0x0, 0x0
  .long 0x0, 0x0, 0x0, 0x0
  .long 0x0, 0x0, 0x0, 0x0
  .long 0x0, 0x0, 0x0, 0x0
  .long 0x0, 0x0, 0x0, 0x0
  .long 0x0, 0x0, 0x3e80, 0x0
  .long 0x0, 0x0, 0x3e800000, 0x0
  .long 0x0, 0x0, 0x0, 0x3e80
  .long 0x0, 0x0, 0x0, 0x3e800000
  .long 0x0, 0x0, 0x0, 0x0
  .long 0x0, 0x0, 0x0, 0x0
  .long 0x0, 0x0, 0x0, 0x0
  .long 0x0, 0x0, 0x0, 0x0
  .long 0x0, 0x0, 0x0, 0x0
  .long 0x0, 0x0, 0x0, 0x0
  .long 0x0, 0x0, 0x0, 0x0
  .long 0x0, 0x0, 0x0, 0x0
  .long 0x0, 0x0, 0x0, 0x0
  .long 0x0, 0x0, 0x0, 0x0
  .long 0x0, 0x0, 0x0, 0x0
  .long 0x0, 0x0, 0x0, 0x0
  .long 0x0, 0x0, 0x0, 0x0
  .long 0x0, 0x0, 0x0, 0x0
  .long 0x0, 0x0, 0x0, 0x0
  .long 0x0, 0x0, 0x0, 0x0
  .long 0x0, 0x0, 0x0, 0x0
  .long 0x0, 0x0, 0x0, 0x0
  .long 0x0, 0x0, 0x0, 0x0
  .long 0x0, 0x0, 0x0, 0x0
  .long 0x0, 0x0, 0x0, 0x0
  .long 0x0, 0x0, 0x0, 0x0
  .long 0x0, 0x0, 0x0, 0x0
  .long 0x0, 0x0, 0x0, 0x0
  .long 0x3e80, 0x0, 0x0, 0x0
  .long 0x3e800000, 0x0, 0x0, 0x0
  .long 0x0, 0x3e80, 0x0, 0x0
  .long 0x0, 0x3e800000, 0x0, 0x0
  .long 0x0, 0x0, 0x0, 0x0
  .long 0x0, 0x0, 0x0, 0x0
  .long 0x0, 0x0, 0x0, 0x0
  .long 0x0, 0x0, 0x0, 0x0
  .long 0x0, 0x0, 0x3e80, 0x0
  .long 0x0, 0x0, 0x3e800000, 0x0
  .long 0x0, 0x0, 0x0, 0x3e80
  .long 0x0, 0x0, 0x0, 0x3e800000
  .long 0x0, 0x0, 0x0, 0x0
  .long 0x0, 0x0, 0x0, 0x0
  .long 0x0, 0x0, 0x0, 0x0
  .long 0x0, 0x0, 0x0, 0x0
  .long 0x0, 0x0, 0x0, 0x0
  .long 0x0, 0x0, 0x0, 0x0
  .long 0x0, 0x0, 0x0, 0x0
  .long 0x0, 0x0, 0x0, 0x0
  .long 0x0, 0x0, 0x0, 0x0
  .long 0x0, 0x0, 0x0, 0x0
  .long 0x0, 0x0, 0x0, 0x0
  .long 0x0, 0x0, 0x0, 0x0
  .long 0x0, 0x0, 0x0, 0x0
  .long 0x0, 0x0, 0x0, 0x0
  .long 0x0, 0x0, 0x0, 0x0
  .long 0x0, 0x0, 0x0, 0x0
  .long 0x0, 0x0, 0x0, 0x0
  .long 0x0, 0x0, 0x0, 0x0
  .long 0x0, 0x0, 0x0, 0x0
  .long 0x0, 0x0, 0x0, 0x0
  .long 0x0, 0x0, 0x0, 0x0
  .long 0x0, 0x0, 0x0, 0x0
  .long 0x0, 0x0, 0x0, 0x0
  .long 0x0, 0x0, 0x0, 0x0
  .long 0x0, 0x0, 0x0, 0x0
  .long 0x0, 0x0, 0x0, 0x0
  .long 0x0, 0x0, 0x0, 0x0
  .long 0x0, 0x0, 0x0, 0x0
  .long 0x0, 0x0, 0x0, 0x0
  .long 0x0, 0x0, 0x0, 0x0
  .long 0x0, 0x0, 0x0, 0x0
  .long 0x0, 0x0, 0x0, 0x0
  .long 0x3e80, 0x0, 0x0, 0x0
  .long 0x3e800000, 0x0, 0x0, 0x0
  .long 0x0, 0x3e80, 0x0, 0x0
  .long 0x0, 0x3e800000, 0x0, 0x0
  .long 0x0, 0x0, 0x0, 0x0
  .long 0x0, 0x0, 0x0, 0x0
  .long 0x0, 0x0, 0x0, 0x0
  .long 0x0, 0x0, 0x0, 0x0
  .long 0x0, 0x0, 0x3e80, 0x0
  .long 0x0, 0x0, 0x3e800000, 0x0
  .long 0x0, 0x0, 0x0, 0x3e80
  .long 0x0, 0x0, 0x0, 0x3e800000
  .long 0x0, 0x0, 0x0, 0x0
  .long 0x0, 0x0, 0x0, 0x0
  .long 0x0, 0x0, 0x0, 0x0
  .long 0x0, 0x0, 0x0, 0x0
  .long 0x0, 0x0, 0x0, 0x0
  .long 0x0, 0x0, 0x0, 0x0
  .long 0x0, 0x0, 0x0, 0x0
  .long 0x0, 0x0, 0x0, 0x0
  .long 0x0, 0x0, 0x0, 0x0
  .long 0x0, 0x0, 0x0, 0x0
  .long 0x0, 0x0, 0x0, 0x0
  .long 0x0, 0x0, 0x0, 0x0
  .long 0x0, 0x0, 0x0, 0x0
  .long 0x0, 0x0, 0x0, 0x0
  .long 0x0, 0x0, 0x0, 0x0
  .long 0x0, 0x0, 0x0, 0x0
  .long 0x0, 0x0, 0x0, 0x0
  .long 0x0, 0x0, 0x0, 0x0
  .long 0x0, 0x0, 0x0, 0x0
  .long 0x0, 0x0, 0x0, 0x0
  .long 0x0, 0x0, 0x0, 0x0
  .long 0x0, 0x0, 0x0, 0x0
  .long 0x0, 0x0, 0x0, 0x0
  .long 0x0, 0x0, 0x0, 0x0
  .long 0x3e80, 0x0, 0x0, 0x0
  .long 0x3e800000, 0x0, 0x0, 0x0
  .long 0x0, 0x3e80, 0x0, 0x0
  .long 0x0, 0x3e800000, 0x0, 0x0
  .long 0x0, 0x0, 0x0, 0x0
  .long 0x0, 0x0, 0x0, 0x0
  .long 0x0, 0x0, 0x0, 0x0
  .long 0x0, 0x0, 0x0, 0x0
  .long 0x0, 0x0, 0x3e80, 0x0
  .long 0x0, 0x0, 0x3e800000, 0x0
  .long 0x0, 0x0, 0x0, 0x3e80
  .long 0x0, 0x0, 0x0, 0x3e800000
.g2_kernel_cend:

.section .rodata,"a"
.p2align 6
.amdhsa_kernel g2_kernel
  .amdhsa_next_free_vgpr 256
  .amdhsa_next_free_sgpr 102
  .amdhsa_accum_offset 256
  .amdhsa_group_segment_fixed_size 0
  .amdhsa_kernarg_size 88
  .amdhsa_user_sgpr_count 2
  .amdhsa_user_sgpr_kernarg_segment_ptr 1
  .amdhsa_system_sgpr_workgroup_id_x 1
.end_amdhsa_kernel
```

```asm
; @launch kernel=g2_kernel grid=(256,1,1) block=(512,1,1) lds=163840
.amdgcn_target "amdgcn-amd-amdhsa--gfx950"
.text
.globl g2_kernel
.p2align 8
.type g2_kernel,@function
g2_kernel:
  s_cmp_ge_u32 s2, 256
  s_cbranch_scc1 .g2_kernel_end
  s_load_dwordx16 s[40:55], s[0:1], 0
  s_load_dwordx4 s[56:59], s[0:1], 64
  s_load_dwordx2 s[60:61], s[0:1], 80
  s_getpc_b64 s[64:65]
.g2_kernel_pc:
  s_mov_b32 s66, .g2_kernel_cend-.g2_kernel_pc
  s_mov_b32 s67, 0x00020000
  s_lshl_b32 s12, s2, 10
  s_and_b32 s12, s12, 0xe000
  v_lshrrev_b32 v3, 3, v0
  v_and_b32 v2, 7, v0
  v_and_b32 v3, 0x38, v3
  v_add_lshl_u32 v3, v3, v2, 7
  s_mov_b64 exec, 0xff
  buffer_load_dword v1, v3, s[64:67], s12 offen
  s_mov_b64 exec, -1
  v_lshrrev_b32 v3, 6, v0
  v_and_b32 v2, 63, v0
  v_readfirstlane_b32 s16, v3
  s_and_b32 s21, s2, 7
  s_lshr_b32 s22, s2, 3
  s_and_b32 s23, s21, 3
  s_lshl_b32 s23, s23, 2
  s_and_b32 s24, s22, 3
  s_add_u32 s18, s23, s24
  s_lshr_b32 s24, s21, 2
  s_lshl_b32 s24, s24, 3
  s_lshr_b32 s25, s22, 2
  s_add_u32 s17, s24, s25
  s_lshl_b32 s19, s17, 4
  s_add_u32 s19, s19, s18
  s_lshl_b32 s19, s19, 9
  s_add_u32 s19, s19, 0x3000000
  s_lshl_b32 s76, s18, 4
  s_add_u32 s76, s76, s17
  s_lshl_b32 s76, s76, 9
  s_add_u32 s76, s76, 0x3020000
  v_lshlrev_b32 v3, 4, v2
  v_mov_b32 v4, 0
  v_mov_b32 v5, 1
  s_mov_b32 s62, 0
  s_mov_b32 s63, 0
  s_mov_b32 s70, 1
  s_mov_b32 s71, 155648
  s_waitcnt lgkmcnt(0)
  s_mov_b32 s4, s60
  s_mov_b32 s5, s61
  s_mov_b32 s6, 0x3300000
  s_mov_b32 s7, 0x00020000
  s_cmp_ge_u32 s16, 4
  s_cbranch_scc1 .g2_kernel_svc
  v_mov_b32 v20, 0
  v_mov_b32 v21, 0
  v_mov_b32 v22, 0
  v_mov_b32 v23, 0
  v_lshlrev_b32 v24, 4, v0
  v_cmp_gt_u32 vcc, 2816, v24
  v_add_u32 v24, 155648, v24
  s_and_saveexec_b64 s[20:21], vcc
  s_cbranch_execz .g2_kernel_q_nz
  ds_write_b128 v24, v[20:23]
.g2_kernel_q_nz:
  s_mov_b64 exec, -1
  v_and_b32 v20, 15, v2
  v_lshrrev_b32 v21, 4, v2
  v_lshrrev_b32 v22, 1, v20
  v_xor_b32 v22, v22, v21
  v_lshlrev_b32 v22, 4, v22
  v_lshl_add_u32 v22, v20, 7, v22
  s_lshr_b32 s26, s16, 1
  s_lshl_b32 s26, s26, 13
  v_add_u32 v144, s26, v22
  v_xor_b32 v145, 64, v144
.g2_kernel_q_cs:
  s_and_b32 s27, s16, 1
  s_lshr_b32 s26, s16, 1
  v_bfe_u32 v20, v2, 2, 2
  v_lshrrev_b32 v49, 4, v2
  v_lshl_add_u32 v22, v49, 3, v20
  v_lshlrev_b32 v22, 7, v22
  v_lshrrev_b32 v23, 1, v20
  v_and_b32 v21, 1, v49
  v_xor_b32 v21, s27, v21
  v_lshl_add_u32 v23, v21, 1, v23
  v_lshl_add_u32 v22, v23, 5, v22
  v_and_b32 v23, 3, v2
  v_lshl_add_u32 v22, v23, 3, v22
  v_add_u32 v148, 65536, v22
  v_xor_b32 v149, 32, v148
  v_mov_b32 v146, v148
  v_mov_b32 v147, v149
  v_mov_b32 v150, 156160
  v_and_b32 v48, 15, v2
  s_lshl_b32 s28, s26, 8
  s_add_u32 s28, s28, 155648
  v_lshl_add_u32 v50, v48, 2, s28
  v_lshl_add_u32 v51, v49, 4, s28
  s_lshl_b32 s28, s27, 7
  s_add_u32 s28, s28, 155648
  v_lshl_add_u32 v52, v49, 4, s28
  s_xor_b32 s28, s28, 128
  v_lshl_add_u32 v53, v48, 2, s28
  v_lshlrev_b32 v54, 9, v49
  v_lshl_add_u32 v55, v48, 4, v54
  v_and_b32 v56, 8, v48
  v_lshl_add_u32 v54, v56, 4, v55
  v_mov_b32 v56, 0.25503486164919736
  v_lshlrev_b32 v58, 2, v2
  v_and_b32 v58, 12, v58
  v_add_u32 v58, 156416, v58
  s_lshl_b32 s8, s18, 7
  s_lshl_b32 s9, s17, 2
  s_add_u32 s8, s8, s9
  s_lshl_b32 s9, s26, 1
  s_add_u32 s8, s8, s9
  s_lshl_b32 s8, s8, 12
  s_add_u32 s8, s8, s63
  s_add_u32 s9, s8, 4096
  s_lshl_b32 s28, s26, 13
  s_lshl_b32 s10, s27, 14
  s_add_u32 s28, s28, s10
  v_add_u32 v59, s28, v54
  s_xor_b32 s28, s28, 16384
  v_add_u32 v60, s28, v55
  s_lshl_b32 s28, s26, 12
  s_mul_i32 s10, s27, -8192
  s_add_u32 s28, s28, s10
  s_add_u32 s28, s28, 139264
  v_add_u32 v61, s28, v55
  s_mov_b32 s10, s27
  s_lshl_b32 s28, s26, 2
  s_add_u32 s28, s28, s71
  v_mov_b32 v62, s28
  s_lshl_b32 s12, s62, 5
  s_add_u32 s12, s12, 28
  v_and_b32 v6, 15, v2
  v_xor_b32 v6, s17, v6
  v_and_b32 v7, 16, v2
  v_add_u32 v6, v6, v7
  s_lshr_b32 s28, s16, 1
  s_lshl_b32 s28, s28, 7
  s_add_u32 s28, s28, 157440
  v_lshl_add_u32 v8, v6, 2, s28
  s_lshl_b32 s28, s16, 12
  v_add_u32 v9, s28, v3
  v_and_b32 v6, 31, v2
  s_lshl_b32 s28, s16, 7
  s_add_u32 s28, s28, 161280
  v_lshl_add_u32 v10, v6, 2, s28
  s_lshl_b32 s28, s16, 2
  s_add_u32 s28, s28, 155968
  v_mov_b32 v11, s28
  s_lshl_b32 s28, s62, 1
  s_add_u32 s28, s28, 1
  v_mov_b32 v12, s28
  v_mov_b32 v13, s71
  v_add_u32 v14, 131072, v3
  v_and_b32 v6, 4, v2
  v_cmp_eq_u32 vcc, 0, v6
  v_mov_b32 v7, 0x3f803f80
  v_and_b32 v6, 1, v2
  v_cndmask_b32 v16, 0, v7, vcc
  v_cndmask_b32 v17, 0, v7, vcc
  v_cndmask_b32 v18, v7, 0, vcc
  v_cndmask_b32 v19, v7, 0, vcc
  v_mul_u32_u24 v20, 0xaaaa, v6
  v_add_u32 v20, 0x4444, v20
  s_lshl_b32 s28, s18, 7
  s_add_u32 s28, s28, s16
  s_lshl_b32 s28, s28, 12
  s_add_u32 s28, s28, s63
  s_add_u32 s20, s60, s28
  s_addc_u32 s21, s61, 0
  s_mov_b32 s24, s17
  s_mov_b32 s25, 14
  s_mov_b32 s26, 0
  s_mov_b32 s27, 6
  s_mov_b32 s34, 0xffff0001
  s_mov_b32 s35, 0
  s_mov_b32 s36, 0
  s_mov_b32 s39, 0
  s_and_b32 s28, s16, 2
  s_lshl_b32 s28, s28, 7
  s_add_u32 s37, s76, s28
  v_mov_b32 v15, s70
  v_lshrrev_b32 v6, 5, v2
  v_and_b32 v7, 15, v2
  v_lshlrev_b32 v22, 4, v7
  v_lshl_add_u32 v22, v6, 8, v22
  v_and_b32 v7, 16, v2
  v_lshl_add_u32 v22, v7, 7, v22
  v_and_b32 v7, 31, v2
  v_lshlrev_b32 v23, 4, v6
  v_lshl_add_u32 v23, v7, 11, v23
  s_lshl_b32 s28, s17, 2
  s_add_u32 s28, s28, s16
  s_lshl_b32 s28, s28, 16
  s_lshl_b32 s29, s18, 7
  s_add_u32 s28, s28, s29
  s_add_u32 s74, s40, s28
  s_addc_u32 s75, s41, 0
  s_lshl_b32 s13, s17, 4
  s_add_u32 s13, s13, s18
  s_lshl_b32 s13, s13, 2
  s_add_u32 s13, s13, s16
  s_lshl_b32 s13, s13, 12
  s_add_u32 s13, s13, 0xc00000
  s_lshl_b32 s28, s16, 2
  s_add_u32 m0, s28, 156416
  s_lshl_b32 s33, s62, 5
  s_lshl_b32 s31, s33, 2
  s_add_u32 s31, s31, .g2_kernel_tab-.g2_kernel_pc+4
  s_mov_b32 s29, 0
  s_cmp_lg_u32 s62, 0
  s_cbranch_scc1 .g2_kernel_q_i2
  s_waitcnt lgkmcnt(0)
  s_barrier
.g2_kernel_q_i3:
  s_call_b64 s[68:69], .g2_kernel_q_spin
  ds_read_b64_tr_b16 v[80:81], v146 offset:0
  ds_read_b64_tr_b16 v[82:83], v146 offset:512
  ds_read_b128 v[64:67], v144 offset:0
  ds_read_b128 v[68:71], v144 offset:2048
  ds_read_b128 v[72:75], v144 offset:4096
  ds_read_b128 v[76:79], v144 offset:6144
  ds_read_b64_tr_b16 v[84:85], v147 offset:0
  ds_read_b64_tr_b16 v[86:87], v147 offset:512
  ds_read_b64_tr_b16 v[88:89], v146 offset:4096
  ds_read_b64_tr_b16 v[90:91], v146 offset:4608
  ds_read_b64_tr_b16 v[92:93], v147 offset:4096
  ds_read_b64_tr_b16 v[94:95], v147 offset:4608
  ds_read_b64_tr_b16 v[96:97], v146 offset:8192
  ds_read_b64_tr_b16 v[98:99], v146 offset:8704
  ds_read_b64_tr_b16 v[100:101], v147 offset:8192
  ds_read_b64_tr_b16 v[102:103], v147 offset:8704
  s_mov_b32 s30, 12288
  s_add_u32 s33, s33, 1
  v_add_u32 v146, s30, v148
  v_add_u32 v147, s30, v149
  s_waitcnt lgkmcnt(0)
  v_mfma_f32_16x16x32_bf16 v[160:163], v[80:83], v[64:67], 0
  v_cmp_lt_i32 vcc, s33, v151
  v_mfma_f32_16x16x32_bf16 v[164:167], v[80:83], v[68:71], 0
  s_cbranch_vccz .g2_kernel_q_wf
.g2_kernel_q_backf:
  v_mfma_f32_16x16x32_bf16 v[168:171], v[80:83], v[72:75], 0
  ds_read_b64_tr_b16 v[120:121], v146 offset:0
  v_mfma_f32_16x16x32_bf16 v[172:175], v[80:83], v[76:79], 0
  ds_read_b64_tr_b16 v[122:123], v146 offset:512
  v_mfma_f32_16x16x32_bf16 v[188:191], v[84:87], v[76:79], 0
  ds_read_b128 v[104:107], v145 offset:0
  v_mfma_f32_16x16x32_bf16 v[184:187], v[84:87], v[72:75], 0
  ds_read_b128 v[108:111], v145 offset:2048
  v_mfma_f32_16x16x32_bf16 v[180:183], v[84:87], v[68:71], 0
  ds_read_b128 v[112:115], v145 offset:4096
  v_mfma_f32_16x16x32_bf16 v[176:179], v[84:87], v[64:67], 0
  ds_read_b128 v[116:119], v145 offset:6144
  v_mfma_f32_16x16x32_bf16 v[192:195], v[88:91], v[64:67], 0
  ds_read_b64_tr_b16 v[124:125], v147 offset:0
  v_mfma_f32_16x16x32_bf16 v[196:199], v[88:91], v[68:71], 0
  ds_read_b64_tr_b16 v[126:127], v147 offset:512
  v_mfma_f32_16x16x32_bf16 v[200:203], v[88:91], v[72:75], 0
  ds_read_b64_tr_b16 v[128:129], v146 offset:4096
  v_mfma_f32_16x16x32_bf16 v[204:207], v[88:91], v[76:79], 0
  ds_read_b64_tr_b16 v[130:131], v146 offset:4608
  v_mfma_f32_16x16x32_bf16 v[220:223], v[92:95], v[76:79], 0
  ds_read_b64_tr_b16 v[132:133], v147 offset:4096
  v_mfma_f32_16x16x32_bf16 v[216:219], v[92:95], v[72:75], 0
  ds_read_b64_tr_b16 v[134:135], v147 offset:4608
  v_mfma_f32_16x16x32_bf16 v[212:215], v[92:95], v[68:71], 0
  ds_read_b64_tr_b16 v[136:137], v146 offset:8192
  v_mfma_f32_16x16x32_bf16 v[208:211], v[92:95], v[64:67], 0
  ds_read_b64_tr_b16 v[138:139], v146 offset:8704
  v_mfma_f32_16x16x32_bf16 v[224:227], v[64:67], v[96:99], 0
  ds_read_b64_tr_b16 v[140:141], v147 offset:8192
  v_mfma_f32_16x16x32_bf16 v[228:231], v[68:71], v[96:99], 0
  ds_read_b64_tr_b16 v[142:143], v147 offset:8704
  v_mfma_f32_16x16x32_bf16 v[232:235], v[72:75], v[96:99], 0
  ds_read_b32 v151, v150
  s_add_u32 s30, s30, 12288
  v_mfma_f32_16x16x32_bf16 v[236:239], v[76:79], v[96:99], 0
  s_mov_b64 exec, 1
  buffer_load_dword off, s[64:67], s31 lds
  s_mov_b64 exec, -1
  s_cmp_eq_u32 s30, 86016
  v_mfma_f32_16x16x32_bf16 v[252:255], v[76:79], v[100:103], 0
  s_cselect_b32 s30, 0, s30
  s_add_u32 s31, s31, 4
  v_mfma_f32_16x16x32_bf16 v[248:251], v[72:75], v[100:103], 0
  v_add_u32 v146, s30, v148
  s_add_u32 s33, s33, 1
  v_mfma_f32_16x16x32_bf16 v[244:247], v[68:71], v[100:103], 0
  v_add_u32 v147, s30, v149
  v_mfma_f32_16x16x32_bf16 v[240:243], v[64:67], v[100:103], 0
  s_branch .g2_kernel_q_s1
  .p2align 6
.g2_kernel_q_loop:
  s_waitcnt lgkmcnt(0)
  v_mfma_f32_16x16x32_bf16 v[160:163], v[120:123], v[104:107], v[160:163]
  v_cmp_lt_i32 vcc, s33, v151
  v_mfma_f32_16x16x32_bf16 v[164:167], v[120:123], v[108:111], v[164:167]
  s_cbranch_vccz .g2_kernel_q_w7
.g2_kernel_q_back7:
  v_mfma_f32_16x16x32_bf16 v[168:171], v[120:123], v[112:115], v[168:171]
  ds_read_b64_tr_b16 v[80:81], v146 offset:0
  v_mfma_f32_16x16x32_bf16 v[172:175], v[120:123], v[116:119], v[172:175]
  ds_read_b64_tr_b16 v[82:83], v146 offset:512
  v_mfma_f32_16x16x32_bf16 v[188:191], v[124:127], v[116:119], v[188:191]
  ds_read_b128 v[64:67], v144 offset:0
  v_mfma_f32_16x16x32_bf16 v[184:187], v[124:127], v[112:115], v[184:187]
  ds_read_b128 v[68:71], v144 offset:2048
  v_mfma_f32_16x16x32_bf16 v[180:183], v[124:127], v[108:111], v[180:183]
  ds_read_b128 v[72:75], v144 offset:4096
  v_mfma_f32_16x16x32_bf16 v[176:179], v[124:127], v[104:107], v[176:179]
  ds_read_b128 v[76:79], v144 offset:6144
  v_mfma_f32_16x16x32_bf16 v[192:195], v[128:131], v[104:107], v[192:195]
  ds_read_b64_tr_b16 v[84:85], v147 offset:0
  v_mfma_f32_16x16x32_bf16 v[196:199], v[128:131], v[108:111], v[196:199]
  ds_read_b64_tr_b16 v[86:87], v147 offset:512
  v_mfma_f32_16x16x32_bf16 v[200:203], v[128:131], v[112:115], v[200:203]
  ds_read_b64_tr_b16 v[88:89], v146 offset:4096
  v_mfma_f32_16x16x32_bf16 v[204:207], v[128:131], v[116:119], v[204:207]
  ds_read_b64_tr_b16 v[90:91], v146 offset:4608
  v_mfma_f32_16x16x32_bf16 v[220:223], v[132:135], v[116:119], v[220:223]
  ds_read_b64_tr_b16 v[92:93], v147 offset:4096
  v_mfma_f32_16x16x32_bf16 v[216:219], v[132:135], v[112:115], v[216:219]
  ds_read_b64_tr_b16 v[94:95], v147 offset:4608
  v_mfma_f32_16x16x32_bf16 v[212:215], v[132:135], v[108:111], v[212:215]
  ds_read_b64_tr_b16 v[96:97], v146 offset:8192
  v_mfma_f32_16x16x32_bf16 v[208:211], v[132:135], v[104:107], v[208:211]
  ds_read_b64_tr_b16 v[98:99], v146 offset:8704
  v_mfma_f32_16x16x32_bf16 v[224:227], v[104:107], v[136:139], v[224:227]
  ds_read_b64_tr_b16 v[100:101], v147 offset:8192
  v_mfma_f32_16x16x32_bf16 v[228:231], v[108:111], v[136:139], v[228:231]
  ds_read_b64_tr_b16 v[102:103], v147 offset:8704
  v_mfma_f32_16x16x32_bf16 v[232:235], v[112:115], v[136:139], v[232:235]
  ds_read_b32 v151, v150
  s_add_u32 s30, s30, 12288
  v_mfma_f32_16x16x32_bf16 v[236:239], v[116:119], v[136:139], v[236:239]
  s_mov_b64 exec, 1
  buffer_load_dword off, s[64:67], s31 lds
  s_mov_b64 exec, -1
  s_cmp_eq_u32 s30, 86016
  v_mfma_f32_16x16x32_bf16 v[252:255], v[116:119], v[140:143], v[252:255]
  s_cselect_b32 s30, 0, s30
  s_add_u32 s31, s31, 4
  v_mfma_f32_16x16x32_bf16 v[248:251], v[112:115], v[140:143], v[248:251]
  v_add_u32 v146, s30, v148
  s_add_u32 s33, s33, 1
  v_mfma_f32_16x16x32_bf16 v[244:247], v[108:111], v[140:143], v[244:247]
  v_add_u32 v147, s30, v149
  v_mfma_f32_16x16x32_bf16 v[240:243], v[104:107], v[140:143], v[240:243]
  s_waitcnt lgkmcnt(0)
  v_mfma_f32_16x16x32_bf16 v[160:163], v[80:83], v[64:67], v[160:163]
  v_cmp_lt_i32 vcc, s33, v151
  v_mfma_f32_16x16x32_bf16 v[164:167], v[80:83], v[68:71], v[164:167]
  s_cbranch_vccz .g2_kernel_q_w0
.g2_kernel_q_back0:
  v_mfma_f32_16x16x32_bf16 v[168:171], v[80:83], v[72:75], v[168:171]
  ds_read_b64_tr_b16 v[120:121], v146 offset:0
  v_mfma_f32_16x16x32_bf16 v[172:175], v[80:83], v[76:79], v[172:175]
  ds_read_b64_tr_b16 v[122:123], v146 offset:512
  v_mfma_f32_16x16x32_bf16 v[188:191], v[84:87], v[76:79], v[188:191]
  ds_read_b128 v[104:107], v145 offset:0
  v_mfma_f32_16x16x32_bf16 v[184:187], v[84:87], v[72:75], v[184:187]
  ds_read_b128 v[108:111], v145 offset:2048
  v_mfma_f32_16x16x32_bf16 v[180:183], v[84:87], v[68:71], v[180:183]
  ds_read_b128 v[112:115], v145 offset:4096
  v_mfma_f32_16x16x32_bf16 v[176:179], v[84:87], v[64:67], v[176:179]
  ds_read_b128 v[116:119], v145 offset:6144
  v_mfma_f32_16x16x32_bf16 v[192:195], v[88:91], v[64:67], v[192:195]
  ds_read_b64_tr_b16 v[124:125], v147 offset:0
  v_mfma_f32_16x16x32_bf16 v[196:199], v[88:91], v[68:71], v[196:199]
  ds_read_b64_tr_b16 v[126:127], v147 offset:512
  v_mfma_f32_16x16x32_bf16 v[200:203], v[88:91], v[72:75], v[200:203]
  ds_read_b64_tr_b16 v[128:129], v146 offset:4096
  v_mfma_f32_16x16x32_bf16 v[204:207], v[88:91], v[76:79], v[204:207]
  ds_read_b64_tr_b16 v[130:131], v146 offset:4608
  v_mfma_f32_16x16x32_bf16 v[220:223], v[92:95], v[76:79], v[220:223]
  ds_read_b64_tr_b16 v[132:133], v147 offset:4096
  v_mfma_f32_16x16x32_bf16 v[216:219], v[92:95], v[72:75], v[216:219]
  ds_read_b64_tr_b16 v[134:135], v147 offset:4608
  v_mfma_f32_16x16x32_bf16 v[212:215], v[92:95], v[68:71], v[212:215]
  ds_read_b64_tr_b16 v[136:137], v146 offset:8192
  v_mfma_f32_16x16x32_bf16 v[208:211], v[92:95], v[64:67], v[208:211]
  ds_read_b64_tr_b16 v[138:139], v146 offset:8704
  v_mfma_f32_16x16x32_bf16 v[224:227], v[64:67], v[96:99], v[224:227]
  ds_read_b64_tr_b16 v[140:141], v147 offset:8192
  v_mfma_f32_16x16x32_bf16 v[228:231], v[68:71], v[96:99], v[228:231]
  ds_read_b64_tr_b16 v[142:143], v147 offset:8704
  v_mfma_f32_16x16x32_bf16 v[232:235], v[72:75], v[96:99], v[232:235]
  ds_read_b32 v151, v150
  s_add_u32 s30, s30, 12288
  v_mfma_f32_16x16x32_bf16 v[236:239], v[76:79], v[96:99], v[236:239]
  s_mov_b64 exec, 1
  buffer_load_dword off, s[64:67], s31 lds
  s_mov_b64 exec, -1
  s_cmp_eq_u32 s30, 86016
  v_mfma_f32_16x16x32_bf16 v[252:255], v[76:79], v[100:103], v[252:255]
  s_cselect_b32 s30, 0, s30
  s_add_u32 s31, s31, 4
  v_mfma_f32_16x16x32_bf16 v[248:251], v[72:75], v[100:103], v[248:251]
  v_add_u32 v146, s30, v148
  s_add_u32 s33, s33, 1
  v_mfma_f32_16x16x32_bf16 v[244:247], v[68:71], v[100:103], v[244:247]
  v_add_u32 v147, s30, v149
  v_mfma_f32_16x16x32_bf16 v[240:243], v[64:67], v[100:103], v[240:243]
.g2_kernel_q_s1:
  s_waitcnt lgkmcnt(0)
  v_mfma_f32_16x16x32_bf16 v[160:163], v[120:123], v[104:107], v[160:163]
  v_cmp_lt_i32 vcc, s33, v151
  v_mfma_f32_16x16x32_bf16 v[164:167], v[120:123], v[108:111], v[164:167]
  s_cbranch_vccz .g2_kernel_q_w1
.g2_kernel_q_back1:
  v_mfma_f32_16x16x32_bf16 v[168:171], v[120:123], v[112:115], v[168:171]
  ds_read_b64_tr_b16 v[80:81], v146 offset:0
  v_mfma_f32_16x16x32_bf16 v[172:175], v[120:123], v[116:119], v[172:175]
  ds_read_b64_tr_b16 v[82:83], v146 offset:512
  v_mfma_f32_16x16x32_bf16 v[188:191], v[124:127], v[116:119], v[188:191]
  ds_read_b128 v[64:67], v144 offset:16384
  v_mfma_f32_16x16x32_bf16 v[184:187], v[124:127], v[112:115], v[184:187]
  ds_read_b128 v[68:71], v144 offset:18432
  v_mfma_f32_16x16x32_bf16 v[180:183], v[124:127], v[108:111], v[180:183]
  ds_read_b128 v[72:75], v144 offset:20480
  v_mfma_f32_16x16x32_bf16 v[176:179], v[124:127], v[104:107], v[176:179]
  ds_read_b128 v[76:79], v144 offset:22528
  v_mfma_f32_16x16x32_bf16 v[192:195], v[128:131], v[104:107], v[192:195]
  ds_read_b64_tr_b16 v[84:85], v147 offset:0
  v_mfma_f32_16x16x32_bf16 v[196:199], v[128:131], v[108:111], v[196:199]
  ds_read_b64_tr_b16 v[86:87], v147 offset:512
  v_mfma_f32_16x16x32_bf16 v[200:203], v[128:131], v[112:115], v[200:203]
  ds_read_b64_tr_b16 v[88:89], v146 offset:4096
  v_mfma_f32_16x16x32_bf16 v[204:207], v[128:131], v[116:119], v[204:207]
  ds_read_b64_tr_b16 v[90:91], v146 offset:4608
  v_mfma_f32_16x16x32_bf16 v[220:223], v[132:135], v[116:119], v[220:223]
  ds_read_b64_tr_b16 v[92:93], v147 offset:4096
  v_mfma_f32_16x16x32_bf16 v[216:219], v[132:135], v[112:115], v[216:219]
  ds_read_b64_tr_b16 v[94:95], v147 offset:4608
  v_mfma_f32_16x16x32_bf16 v[212:215], v[132:135], v[108:111], v[212:215]
  ds_read_b64_tr_b16 v[96:97], v146 offset:8192
  v_mfma_f32_16x16x32_bf16 v[208:211], v[132:135], v[104:107], v[208:211]
  ds_read_b64_tr_b16 v[98:99], v146 offset:8704
  v_mfma_f32_16x16x32_bf16 v[224:227], v[104:107], v[136:139], v[224:227]
  ds_read_b64_tr_b16 v[100:101], v147 offset:8192
  v_mfma_f32_16x16x32_bf16 v[228:231], v[108:111], v[136:139], v[228:231]
  ds_read_b64_tr_b16 v[102:103], v147 offset:8704
  v_mfma_f32_16x16x32_bf16 v[232:235], v[112:115], v[136:139], v[232:235]
  ds_read_b32 v151, v150
  s_add_u32 s30, s30, 12288
  v_mfma_f32_16x16x32_bf16 v[236:239], v[116:119], v[136:139], v[236:239]
  s_mov_b64 exec, 1
  buffer_load_dword off, s[64:67], s31 lds
  s_mov_b64 exec, -1
  s_cmp_eq_u32 s30, 86016
  v_mfma_f32_16x16x32_bf16 v[252:255], v[116:119], v[140:143], v[252:255]
  s_cselect_b32 s30, 0, s30
  s_add_u32 s31, s31, 4
  v_mfma_f32_16x16x32_bf16 v[248:251], v[112:115], v[140:143], v[248:251]
  v_add_u32 v146, s30, v148
  s_add_u32 s33, s33, 1
  v_mfma_f32_16x16x32_bf16 v[244:247], v[108:111], v[140:143], v[244:247]
  v_add_u32 v147, s30, v149
  v_mfma_f32_16x16x32_bf16 v[240:243], v[104:107], v[140:143], v[240:243]
  s_waitcnt lgkmcnt(0)
  v_mfma_f32_16x16x32_bf16 v[160:163], v[80:83], v[64:67], v[160:163]
  v_cmp_lt_i32 vcc, s33, v151
  v_mfma_f32_16x16x32_bf16 v[164:167], v[80:83], v[68:71], v[164:167]
  s_cbranch_vccz .g2_kernel_q_w2
.g2_kernel_q_back2:
  v_mfma_f32_16x16x32_bf16 v[168:171], v[80:83], v[72:75], v[168:171]
  ds_read_b64_tr_b16 v[120:121], v146 offset:0
  v_mfma_f32_16x16x32_bf16 v[172:175], v[80:83], v[76:79], v[172:175]
  ds_read_b64_tr_b16 v[122:123], v146 offset:512
  v_mfma_f32_16x16x32_bf16 v[188:191], v[84:87], v[76:79], v[188:191]
  ds_read_b128 v[104:107], v145 offset:16384
  v_mfma_f32_16x16x32_bf16 v[184:187], v[84:87], v[72:75], v[184:187]
  ds_read_b128 v[108:111], v145 offset:18432
  v_mfma_f32_16x16x32_bf16 v[180:183], v[84:87], v[68:71], v[180:183]
  ds_read_b128 v[112:115], v145 offset:20480
  v_mfma_f32_16x16x32_bf16 v[176:179], v[84:87], v[64:67], v[176:179]
  ds_read_b128 v[116:119], v145 offset:22528
  v_mfma_f32_16x16x32_bf16 v[192:195], v[88:91], v[64:67], v[192:195]
  ds_read_b64_tr_b16 v[124:125], v147 offset:0
  v_mfma_f32_16x16x32_bf16 v[196:199], v[88:91], v[68:71], v[196:199]
  ds_read_b64_tr_b16 v[126:127], v147 offset:512
  v_mfma_f32_16x16x32_bf16 v[200:203], v[88:91], v[72:75], v[200:203]
  ds_read_b64_tr_b16 v[128:129], v146 offset:4096
  v_mfma_f32_16x16x32_bf16 v[204:207], v[88:91], v[76:79], v[204:207]
  ds_read_b64_tr_b16 v[130:131], v146 offset:4608
  v_mfma_f32_16x16x32_bf16 v[220:223], v[92:95], v[76:79], v[220:223]
  ds_read_b64_tr_b16 v[132:133], v147 offset:4096
  v_mfma_f32_16x16x32_bf16 v[216:219], v[92:95], v[72:75], v[216:219]
  ds_read_b64_tr_b16 v[134:135], v147 offset:4608
  v_mfma_f32_16x16x32_bf16 v[212:215], v[92:95], v[68:71], v[212:215]
  ds_read_b64_tr_b16 v[136:137], v146 offset:8192
  v_mfma_f32_16x16x32_bf16 v[208:211], v[92:95], v[64:67], v[208:211]
  ds_read_b64_tr_b16 v[138:139], v146 offset:8704
  v_mfma_f32_16x16x32_bf16 v[224:227], v[64:67], v[96:99], v[224:227]
  ds_read_b64_tr_b16 v[140:141], v147 offset:8192
  v_mfma_f32_16x16x32_bf16 v[228:231], v[68:71], v[96:99], v[228:231]
  ds_read_b64_tr_b16 v[142:143], v147 offset:8704
  v_mfma_f32_16x16x32_bf16 v[232:235], v[72:75], v[96:99], v[232:235]
  ds_read_b32 v151, v150
  s_add_u32 s30, s30, 12288
  v_mfma_f32_16x16x32_bf16 v[236:239], v[76:79], v[96:99], v[236:239]
  s_mov_b64 exec, 1
  buffer_load_dword off, s[64:67], s31 lds
  s_mov_b64 exec, -1
  s_cmp_eq_u32 s30, 86016
  v_mfma_f32_16x16x32_bf16 v[252:255], v[76:79], v[100:103], v[252:255]
  s_cselect_b32 s30, 0, s30
  s_add_u32 s31, s31, 4
  v_mfma_f32_16x16x32_bf16 v[248:251], v[72:75], v[100:103], v[248:251]
  v_add_u32 v146, s30, v148
  s_add_u32 s33, s33, 1
  v_mfma_f32_16x16x32_bf16 v[244:247], v[68:71], v[100:103], v[244:247]
  v_add_u32 v147, s30, v149
  v_mfma_f32_16x16x32_bf16 v[240:243], v[64:67], v[100:103], v[240:243]
  s_waitcnt lgkmcnt(0)
  v_mfma_f32_16x16x32_bf16 v[160:163], v[120:123], v[104:107], v[160:163]
  v_cmp_lt_i32 vcc, s33, v151
  v_mfma_f32_16x16x32_bf16 v[164:167], v[120:123], v[108:111], v[164:167]
  s_cbranch_vccz .g2_kernel_q_w3
.g2_kernel_q_back3:
  v_mfma_f32_16x16x32_bf16 v[168:171], v[120:123], v[112:115], v[168:171]
  ds_read_b64_tr_b16 v[80:81], v146 offset:0
  v_mfma_f32_16x16x32_bf16 v[172:175], v[120:123], v[116:119], v[172:175]
  ds_read_b64_tr_b16 v[82:83], v146 offset:512
  v_mfma_f32_16x16x32_bf16 v[188:191], v[124:127], v[116:119], v[188:191]
  ds_read_b128 v[64:67], v144 offset:32768
  v_mfma_f32_16x16x32_bf16 v[184:187], v[124:127], v[112:115], v[184:187]
  ds_read_b128 v[68:71], v144 offset:34816
  v_mfma_f32_16x16x32_bf16 v[180:183], v[124:127], v[108:111], v[180:183]
  ds_read_b128 v[72:75], v144 offset:36864
  v_mfma_f32_16x16x32_bf16 v[176:179], v[124:127], v[104:107], v[176:179]
  ds_read_b128 v[76:79], v144 offset:38912
  v_mfma_f32_16x16x32_bf16 v[192:195], v[128:131], v[104:107], v[192:195]
  ds_read_b64_tr_b16 v[84:85], v147 offset:0
  v_mfma_f32_16x16x32_bf16 v[196:199], v[128:131], v[108:111], v[196:199]
  ds_read_b64_tr_b16 v[86:87], v147 offset:512
  v_mfma_f32_16x16x32_bf16 v[200:203], v[128:131], v[112:115], v[200:203]
  ds_read_b64_tr_b16 v[88:89], v146 offset:4096
  v_mfma_f32_16x16x32_bf16 v[204:207], v[128:131], v[116:119], v[204:207]
  ds_read_b64_tr_b16 v[90:91], v146 offset:4608
  v_mfma_f32_16x16x32_bf16 v[220:223], v[132:135], v[116:119], v[220:223]
  ds_read_b64_tr_b16 v[92:93], v147 offset:4096
  v_mfma_f32_16x16x32_bf16 v[216:219], v[132:135], v[112:115], v[216:219]
  ds_read_b64_tr_b16 v[94:95], v147 offset:4608
  v_mfma_f32_16x16x32_bf16 v[212:215], v[132:135], v[108:111], v[212:215]
  ds_read_b64_tr_b16 v[96:97], v146 offset:8192
  v_mfma_f32_16x16x32_bf16 v[208:211], v[132:135], v[104:107], v[208:211]
  ds_read_b64_tr_b16 v[98:99], v146 offset:8704
  v_mfma_f32_16x16x32_bf16 v[224:227], v[104:107], v[136:139], v[224:227]
  ds_read_b64_tr_b16 v[100:101], v147 offset:8192
  v_mfma_f32_16x16x32_bf16 v[228:231], v[108:111], v[136:139], v[228:231]
  ds_read_b64_tr_b16 v[102:103], v147 offset:8704
  v_mfma_f32_16x16x32_bf16 v[232:235], v[112:115], v[136:139], v[232:235]
  ds_read_b32 v151, v150
  s_add_u32 s30, s30, 12288
  v_mfma_f32_16x16x32_bf16 v[236:239], v[116:119], v[136:139], v[236:239]
  s_mov_b64 exec, 1
  buffer_load_dword off, s[64:67], s31 lds
  s_mov_b64 exec, -1
  s_cmp_eq_u32 s30, 86016
  v_mfma_f32_16x16x32_bf16 v[252:255], v[116:119], v[140:143], v[252:255]
  s_cselect_b32 s30, 0, s30
  s_add_u32 s31, s31, 4
  v_mfma_f32_16x16x32_bf16 v[248:251], v[112:115], v[140:143], v[248:251]
  v_add_u32 v146, s30, v148
  s_add_u32 s33, s33, 1
  v_mfma_f32_16x16x32_bf16 v[244:247], v[108:111], v[140:143], v[244:247]
  v_add_u32 v147, s30, v149
  v_mfma_f32_16x16x32_bf16 v[240:243], v[104:107], v[140:143], v[240:243]
  s_waitcnt lgkmcnt(0)
  v_mfma_f32_16x16x32_bf16 v[160:163], v[80:83], v[64:67], v[160:163]
  v_cmp_lt_i32 vcc, s33, v151
  v_mfma_f32_16x16x32_bf16 v[164:167], v[80:83], v[68:71], v[164:167]
  s_cbranch_vccz .g2_kernel_q_w4
.g2_kernel_q_back4:
  v_mfma_f32_16x16x32_bf16 v[168:171], v[80:83], v[72:75], v[168:171]
  ds_read_b64_tr_b16 v[120:121], v146 offset:0
  v_mfma_f32_16x16x32_bf16 v[172:175], v[80:83], v[76:79], v[172:175]
  ds_read_b64_tr_b16 v[122:123], v146 offset:512
  v_mfma_f32_16x16x32_bf16 v[188:191], v[84:87], v[76:79], v[188:191]
  ds_read_b128 v[104:107], v145 offset:32768
  v_mfma_f32_16x16x32_bf16 v[184:187], v[84:87], v[72:75], v[184:187]
  ds_read_b128 v[108:111], v145 offset:34816
  v_mfma_f32_16x16x32_bf16 v[180:183], v[84:87], v[68:71], v[180:183]
  ds_read_b128 v[112:115], v145 offset:36864
  v_mfma_f32_16x16x32_bf16 v[176:179], v[84:87], v[64:67], v[176:179]
  ds_read_b128 v[116:119], v145 offset:38912
  v_mfma_f32_16x16x32_bf16 v[192:195], v[88:91], v[64:67], v[192:195]
  ds_read_b64_tr_b16 v[124:125], v147 offset:0
  v_mfma_f32_16x16x32_bf16 v[196:199], v[88:91], v[68:71], v[196:199]
  ds_read_b64_tr_b16 v[126:127], v147 offset:512
  v_mfma_f32_16x16x32_bf16 v[200:203], v[88:91], v[72:75], v[200:203]
  ds_read_b64_tr_b16 v[128:129], v146 offset:4096
  v_mfma_f32_16x16x32_bf16 v[204:207], v[88:91], v[76:79], v[204:207]
  ds_read_b64_tr_b16 v[130:131], v146 offset:4608
  v_mfma_f32_16x16x32_bf16 v[220:223], v[92:95], v[76:79], v[220:223]
  ds_read_b64_tr_b16 v[132:133], v147 offset:4096
  v_mfma_f32_16x16x32_bf16 v[216:219], v[92:95], v[72:75], v[216:219]
  ds_read_b64_tr_b16 v[134:135], v147 offset:4608
  v_mfma_f32_16x16x32_bf16 v[212:215], v[92:95], v[68:71], v[212:215]
  ds_read_b64_tr_b16 v[136:137], v146 offset:8192
  v_mfma_f32_16x16x32_bf16 v[208:211], v[92:95], v[64:67], v[208:211]
  ds_read_b64_tr_b16 v[138:139], v146 offset:8704
  v_mfma_f32_16x16x32_bf16 v[224:227], v[64:67], v[96:99], v[224:227]
  ds_read_b64_tr_b16 v[140:141], v147 offset:8192
  v_mfma_f32_16x16x32_bf16 v[228:231], v[68:71], v[96:99], v[228:231]
  ds_read_b64_tr_b16 v[142:143], v147 offset:8704
  v_mfma_f32_16x16x32_bf16 v[232:235], v[72:75], v[96:99], v[232:235]
  ds_read_b32 v151, v150
  s_add_u32 s30, s30, 12288
  v_mfma_f32_16x16x32_bf16 v[236:239], v[76:79], v[96:99], v[236:239]
  s_mov_b64 exec, 1
  buffer_load_dword off, s[64:67], s31 lds
  s_mov_b64 exec, -1
  s_cmp_eq_u32 s30, 86016
  v_mfma_f32_16x16x32_bf16 v[252:255], v[76:79], v[100:103], v[252:255]
  s_cselect_b32 s30, 0, s30
  s_add_u32 s31, s31, 4
  v_mfma_f32_16x16x32_bf16 v[248:251], v[72:75], v[100:103], v[248:251]
  v_add_u32 v146, s30, v148
  s_add_u32 s33, s33, 1
  v_mfma_f32_16x16x32_bf16 v[244:247], v[68:71], v[100:103], v[244:247]
  v_add_u32 v147, s30, v149
  v_mfma_f32_16x16x32_bf16 v[240:243], v[64:67], v[100:103], v[240:243]
  s_waitcnt lgkmcnt(0)
  v_mfma_f32_16x16x32_bf16 v[160:163], v[120:123], v[104:107], v[160:163]
  v_cmp_lt_i32 vcc, s33, v151
  v_mfma_f32_16x16x32_bf16 v[164:167], v[120:123], v[108:111], v[164:167]
  s_cbranch_vccz .g2_kernel_q_w5
.g2_kernel_q_back5:
  v_mfma_f32_16x16x32_bf16 v[168:171], v[120:123], v[112:115], v[168:171]
  ds_read_b64_tr_b16 v[80:81], v146 offset:0
  v_mfma_f32_16x16x32_bf16 v[172:175], v[120:123], v[116:119], v[172:175]
  ds_read_b64_tr_b16 v[82:83], v146 offset:512
  v_mfma_f32_16x16x32_bf16 v[188:191], v[124:127], v[116:119], v[188:191]
  ds_read_b128 v[64:67], v144 offset:49152
  v_mfma_f32_16x16x32_bf16 v[184:187], v[124:127], v[112:115], v[184:187]
  ds_read_b128 v[68:71], v144 offset:51200
  v_mfma_f32_16x16x32_bf16 v[180:183], v[124:127], v[108:111], v[180:183]
  ds_read_b128 v[72:75], v144 offset:53248
  v_mfma_f32_16x16x32_bf16 v[176:179], v[124:127], v[104:107], v[176:179]
  ds_read_b128 v[76:79], v144 offset:55296
  v_mfma_f32_16x16x32_bf16 v[192:195], v[128:131], v[104:107], v[192:195]
  ds_read_b64_tr_b16 v[84:85], v147 offset:0
  v_mfma_f32_16x16x32_bf16 v[196:199], v[128:131], v[108:111], v[196:199]
  ds_read_b64_tr_b16 v[86:87], v147 offset:512
  v_mfma_f32_16x16x32_bf16 v[200:203], v[128:131], v[112:115], v[200:203]
  ds_read_b64_tr_b16 v[88:89], v146 offset:4096
  v_mfma_f32_16x16x32_bf16 v[204:207], v[128:131], v[116:119], v[204:207]
  ds_read_b64_tr_b16 v[90:91], v146 offset:4608
  v_mfma_f32_16x16x32_bf16 v[220:223], v[132:135], v[116:119], v[220:223]
  ds_read_b64_tr_b16 v[92:93], v147 offset:4096
  v_mfma_f32_16x16x32_bf16 v[216:219], v[132:135], v[112:115], v[216:219]
  ds_read_b64_tr_b16 v[94:95], v147 offset:4608
  v_mfma_f32_16x16x32_bf16 v[212:215], v[132:135], v[108:111], v[212:215]
  ds_read_b64_tr_b16 v[96:97], v146 offset:8192
  v_mfma_f32_16x16x32_bf16 v[208:211], v[132:135], v[104:107], v[208:211]
  ds_read_b64_tr_b16 v[98:99], v146 offset:8704
  v_mfma_f32_16x16x32_bf16 v[224:227], v[104:107], v[136:139], v[224:227]
  ds_read_b64_tr_b16 v[100:101], v147 offset:8192
  v_mfma_f32_16x16x32_bf16 v[228:231], v[108:111], v[136:139], v[228:231]
  ds_read_b64_tr_b16 v[102:103], v147 offset:8704
  v_mfma_f32_16x16x32_bf16 v[232:235], v[112:115], v[136:139], v[232:235]
  ds_read_b32 v151, v150
  s_add_u32 s30, s30, 12288
  v_mfma_f32_16x16x32_bf16 v[236:239], v[116:119], v[136:139], v[236:239]
  s_mov_b64 exec, 1
  buffer_load_dword off, s[64:67], s31 lds
  s_mov_b64 exec, -1
  s_cmp_eq_u32 s30, 86016
  v_mfma_f32_16x16x32_bf16 v[252:255], v[116:119], v[140:143], v[252:255]
  s_cselect_b32 s30, 0, s30
  s_add_u32 s31, s31, 4
  v_mfma_f32_16x16x32_bf16 v[248:251], v[112:115], v[140:143], v[248:251]
  v_add_u32 v146, s30, v148
  s_add_u32 s33, s33, 1
  v_mfma_f32_16x16x32_bf16 v[244:247], v[108:111], v[140:143], v[244:247]
  v_add_u32 v147, s30, v149
  v_mfma_f32_16x16x32_bf16 v[240:243], v[104:107], v[140:143], v[240:243]
  s_cmp_eq_u32 s29, 3
  s_cbranch_scc1 .g2_kernel_q_out
  s_waitcnt lgkmcnt(0)
  v_mfma_f32_16x16x32_bf16 v[160:163], v[80:83], v[64:67], v[160:163]
  v_cmp_lt_i32 vcc, s33, v151
  v_mfma_f32_16x16x32_bf16 v[164:167], v[80:83], v[68:71], v[164:167]
  s_cbranch_vccz .g2_kernel_q_w6
.g2_kernel_q_back6:
  v_mfma_f32_16x16x32_bf16 v[168:171], v[80:83], v[72:75], v[168:171]
  ds_read_b64_tr_b16 v[120:121], v146 offset:0
  v_mfma_f32_16x16x32_bf16 v[172:175], v[80:83], v[76:79], v[172:175]
  ds_read_b64_tr_b16 v[122:123], v146 offset:512
  v_mfma_f32_16x16x32_bf16 v[188:191], v[84:87], v[76:79], v[188:191]
  ds_read_b128 v[104:107], v145 offset:49152
  v_mfma_f32_16x16x32_bf16 v[184:187], v[84:87], v[72:75], v[184:187]
  ds_read_b128 v[108:111], v145 offset:51200
  v_mfma_f32_16x16x32_bf16 v[180:183], v[84:87], v[68:71], v[180:183]
  ds_read_b128 v[112:115], v145 offset:53248
  v_mfma_f32_16x16x32_bf16 v[176:179], v[84:87], v[64:67], v[176:179]
  ds_read_b128 v[116:119], v145 offset:55296
  v_mfma_f32_16x16x32_bf16 v[192:195], v[88:91], v[64:67], v[192:195]
  ds_read_b64_tr_b16 v[124:125], v147 offset:0
  v_mfma_f32_16x16x32_bf16 v[196:199], v[88:91], v[68:71], v[196:199]
  ds_read_b64_tr_b16 v[126:127], v147 offset:512
  v_mfma_f32_16x16x32_bf16 v[200:203], v[88:91], v[72:75], v[200:203]
  ds_read_b64_tr_b16 v[128:129], v146 offset:4096
  v_mfma_f32_16x16x32_bf16 v[204:207], v[88:91], v[76:79], v[204:207]
  ds_read_b64_tr_b16 v[130:131], v146 offset:4608
  v_mfma_f32_16x16x32_bf16 v[220:223], v[92:95], v[76:79], v[220:223]
  ds_read_b64_tr_b16 v[132:133], v147 offset:4096
  v_mfma_f32_16x16x32_bf16 v[216:219], v[92:95], v[72:75], v[216:219]
  ds_read_b64_tr_b16 v[134:135], v147 offset:4608
  v_mfma_f32_16x16x32_bf16 v[212:215], v[92:95], v[68:71], v[212:215]
  ds_read_b64_tr_b16 v[136:137], v146 offset:8192
  v_mfma_f32_16x16x32_bf16 v[208:211], v[92:95], v[64:67], v[208:211]
  ds_read_b64_tr_b16 v[138:139], v146 offset:8704
  v_mfma_f32_16x16x32_bf16 v[224:227], v[64:67], v[96:99], v[224:227]
  ds_read_b64_tr_b16 v[140:141], v147 offset:8192
  v_mfma_f32_16x16x32_bf16 v[228:231], v[68:71], v[96:99], v[228:231]
  ds_read_b64_tr_b16 v[142:143], v147 offset:8704
  v_mfma_f32_16x16x32_bf16 v[232:235], v[72:75], v[96:99], v[232:235]
  ds_read_b32 v151, v150
  s_add_u32 s30, s30, 12288
  v_mfma_f32_16x16x32_bf16 v[236:239], v[76:79], v[96:99], v[236:239]
  s_mov_b64 exec, 1
  buffer_load_dword off, s[64:67], s31 lds
  s_mov_b64 exec, -1
  s_cmp_eq_u32 s30, 86016
  v_mfma_f32_16x16x32_bf16 v[252:255], v[76:79], v[100:103], v[252:255]
  s_cselect_b32 s30, 0, s30
  s_add_u32 s31, s31, 4
  v_mfma_f32_16x16x32_bf16 v[248:251], v[72:75], v[100:103], v[248:251]
  v_add_u32 v146, s30, v148
  s_add_u32 s33, s33, 1
  v_mfma_f32_16x16x32_bf16 v[244:247], v[68:71], v[100:103], v[244:247]
  v_add_u32 v147, s30, v149
  s_add_u32 s29, s29, 1
  v_mfma_f32_16x16x32_bf16 v[240:243], v[64:67], v[100:103], v[240:243]
  s_branch .g2_kernel_q_loop
.g2_kernel_q_out:
  s_add_u32 s33, s33, 0
  s_waitcnt lgkmcnt(0)
  v_cmp_lt_i32 vcc, s33, v151
  s_cbranch_vccz .g2_kernel_q_wl
.g2_kernel_q_bl:
  s_cmp_lg_u32 s10, 0
  s_cbranch_scc1 .g2_kernel_q_v1
  v_mfma_f32_16x16x32_bf16 v[192:195], v[88:91], v[64:67], v[192:195]
  ds_read_b64_tr_b16 v[80:81], v148 offset:40960
  ds_read_b64_tr_b16 v[82:83], v148 offset:41472
  ds_read_b128 v[128:131], v145 offset:49152
  v_mfma_f32_16x16x32_bf16 v[196:199], v[88:91], v[68:71], v[196:199]
  ds_read_b128 v[132:135], v145 offset:51200
  ds_read_b128 v[136:139], v145 offset:53248
  ds_read_b128 v[140:143], v145 offset:55296
  v_mfma_f32_16x16x32_bf16 v[200:203], v[88:91], v[72:75], v[200:203]
  ds_read_b64_tr_b16 v[84:85], v149 offset:40960
  ds_read_b64_tr_b16 v[86:87], v149 offset:41472
  ds_read_b32 v63, v13 offset:0
  v_mfma_f32_16x16x32_bf16 v[204:207], v[88:91], v[76:79], v[204:207]
  ds_read_b32 v57, v13 offset:24
  ds_read_b128 v[40:43], v52 offset:5120
  ds_read_b128 v[44:47], v52 offset:5184
  v_mfma_f32_16x16x32_bf16 v[220:223], v[92:95], v[76:79], v[220:223]
  ds_read_b32 v24, v50 offset:2816
  ds_read_b32 v25, v50 offset:3328
  ds_read_b32 v26, v50 offset:2880
  v_mfma_f32_16x16x32_bf16 v[216:219], v[92:95], v[72:75], v[216:219]
  ds_read_b32 v27, v50 offset:3392
  ds_read_b32 v28, v50 offset:2944
  ds_read_b32 v29, v50 offset:3456
  v_mfma_f32_16x16x32_bf16 v[212:215], v[92:95], v[68:71], v[212:215]
  ds_read_b32 v30, v50 offset:3008
  ds_read_b32 v31, v50 offset:3520
  v_mfma_f32_16x16x32_bf16 v[208:211], v[92:95], v[64:67], v[208:211]
  s_waitcnt lgkmcnt(12)
  v_mfma_f32_16x16x32_bf16 v[192:195], v[80:83], v[128:131], v[192:195]
  v_mfma_f32_16x16x32_bf16 v[196:199], v[80:83], v[132:135], v[196:199]
  v_mfma_f32_16x16x32_bf16 v[200:203], v[80:83], v[136:139], v[200:203]
  v_mfma_f32_16x16x32_bf16 v[204:207], v[80:83], v[140:143], v[204:207]
  v_mfma_f32_16x16x32_bf16 v[220:223], v[84:87], v[140:143], v[220:223]
  v_mfma_f32_16x16x32_bf16 v[216:219], v[84:87], v[136:139], v[216:219]
  v_mfma_f32_16x16x32_bf16 v[212:215], v[84:87], v[132:135], v[212:215]
  v_mfma_f32_16x16x32_bf16 v[208:211], v[84:87], v[128:131], v[208:211]
  s_waitcnt lgkmcnt(0)
  v_cmp_gt_u32 vcc, 2, v63
  s_cbranch_vccnz .g2_kernel_q_v0ew
.g2_kernel_q_v0eb:
  ds_read_b64_tr_b16 v[120:121], v148 offset:24576
  ds_read_b64_tr_b16 v[122:123], v148 offset:25088
  ds_read_b128 v[104:107], v144 offset:49152
  ds_read_b128 v[108:111], v144 offset:51200
  ds_read_b128 v[112:115], v144 offset:53248
  ds_read_b128 v[116:119], v144 offset:55296
  ds_read_b64_tr_b16 v[124:125], v149 offset:24576
  ds_read_b64_tr_b16 v[126:127], v149 offset:25088
  ds_read_b64_tr_b16 v[128:129], v148 offset:32768
  ds_read_b64_tr_b16 v[130:131], v148 offset:33280
  ds_read_b64_tr_b16 v[132:133], v149 offset:32768
  ds_read_b64_tr_b16 v[134:135], v149 offset:33280
  v_cmp_ne_u32 vcc, 0, v57
  s_cbranch_vccnz .g2_kernel_q_v0p
.g2_kernel_q_v0pb:
  v_pk_mul_f32 v[152:153], v[40:41], v[24:25] op_sel:[0,1] op_sel_hi:[1,1]
  v_pk_mul_f32 v[154:155], v[42:43], v[24:25] op_sel:[0,1] op_sel_hi:[1,1]
  v_pk_mul_f32 v[156:157], v[44:45], v[24:25] op_sel:[0,1] op_sel_hi:[1,1]
  v_pk_mul_f32 v[158:159], v[46:47], v[24:25] op_sel:[0,1] op_sel_hi:[1,1]
  v_pk_fma_f32 v[192:193], v[192:193], v[24:25], v[152:153] op_sel_hi:[1,0,1]
  v_pk_fma_f32 v[194:195], v[194:195], v[24:25], v[154:155] op_sel_hi:[1,0,1]
  v_pk_fma_f32 v[208:209], v[208:209], v[24:25], v[156:157] op_sel_hi:[1,0,1]
  v_pk_fma_f32 v[210:211], v[210:211], v[24:25], v[158:159] op_sel_hi:[1,0,1]
  v_cvt_pk_bf16_f32 v192, v192, v193
  v_cvt_pk_bf16_f32 v193, v194, v195
  v_cvt_pk_bf16_f32 v194, v208, v209
  v_cvt_pk_bf16_f32 v195, v210, v211
  buffer_store_dwordx4 v[192:195], v54, s[4:7], s8 offen offset:0 sc1
  v_pk_mul_f32 v[152:153], v[40:41], v[26:27] op_sel:[0,1] op_sel_hi:[1,1]
  v_pk_mul_f32 v[154:155], v[42:43], v[26:27] op_sel:[0,1] op_sel_hi:[1,1]
  v_pk_mul_f32 v[156:157], v[44:45], v[26:27] op_sel:[0,1] op_sel_hi:[1,1]
  v_pk_mul_f32 v[158:159], v[46:47], v[26:27] op_sel:[0,1] op_sel_hi:[1,1]
  v_pk_fma_f32 v[196:197], v[196:197], v[26:27], v[152:153] op_sel_hi:[1,0,1]
  v_pk_fma_f32 v[198:199], v[198:199], v[26:27], v[154:155] op_sel_hi:[1,0,1]
  v_pk_fma_f32 v[212:213], v[212:213], v[26:27], v[156:157] op_sel_hi:[1,0,1]
  v_pk_fma_f32 v[214:215], v[214:215], v[26:27], v[158:159] op_sel_hi:[1,0,1]
  v_cvt_pk_bf16_f32 v196, v196, v197
  v_cvt_pk_bf16_f32 v197, v198, v199
  v_cvt_pk_bf16_f32 v198, v212, v213
  v_cvt_pk_bf16_f32 v199, v214, v215
  buffer_store_dwordx4 v[196:199], v54, s[4:7], s8 offen offset:128 sc1
  v_pk_mul_f32 v[152:153], v[40:41], v[28:29] op_sel:[0,1] op_sel_hi:[1,1]
  v_pk_mul_f32 v[154:155], v[42:43], v[28:29] op_sel:[0,1] op_sel_hi:[1,1]
  v_pk_mul_f32 v[156:157], v[44:45], v[28:29] op_sel:[0,1] op_sel_hi:[1,1]
  v_pk_mul_f32 v[158:159], v[46:47], v[28:29] op_sel:[0,1] op_sel_hi:[1,1]
  v_pk_fma_f32 v[200:201], v[200:201], v[28:29], v[152:153] op_sel_hi:[1,0,1]
  v_pk_fma_f32 v[202:203], v[202:203], v[28:29], v[154:155] op_sel_hi:[1,0,1]
  v_pk_fma_f32 v[216:217], v[216:217], v[28:29], v[156:157] op_sel_hi:[1,0,1]
  v_pk_fma_f32 v[218:219], v[218:219], v[28:29], v[158:159] op_sel_hi:[1,0,1]
  v_cvt_pk_bf16_f32 v200, v200, v201
  v_cvt_pk_bf16_f32 v201, v202, v203
  v_cvt_pk_bf16_f32 v202, v216, v217
  v_cvt_pk_bf16_f32 v203, v218, v219
  buffer_store_dwordx4 v[200:203], v54, s[4:7], s9 offen offset:0 sc1
  v_pk_mul_f32 v[152:153], v[40:41], v[30:31] op_sel:[0,1] op_sel_hi:[1,1]
  v_pk_mul_f32 v[154:155], v[42:43], v[30:31] op_sel:[0,1] op_sel_hi:[1,1]
  v_pk_mul_f32 v[156:157], v[44:45], v[30:31] op_sel:[0,1] op_sel_hi:[1,1]
  v_pk_mul_f32 v[158:159], v[46:47], v[30:31] op_sel:[0,1] op_sel_hi:[1,1]
  v_pk_fma_f32 v[204:205], v[204:205], v[30:31], v[152:153] op_sel_hi:[1,0,1]
  v_pk_fma_f32 v[206:207], v[206:207], v[30:31], v[154:155] op_sel_hi:[1,0,1]
  v_pk_fma_f32 v[220:221], v[220:221], v[30:31], v[156:157] op_sel_hi:[1,0,1]
  v_pk_fma_f32 v[222:223], v[222:223], v[30:31], v[158:159] op_sel_hi:[1,0,1]
  v_cvt_pk_bf16_f32 v204, v204, v205
  v_cvt_pk_bf16_f32 v205, v206, v207
  v_cvt_pk_bf16_f32 v206, v220, v221
  v_cvt_pk_bf16_f32 v207, v222, v223
  buffer_store_dwordx4 v[204:207], v54, s[4:7], s9 offen offset:128 sc1
  s_waitcnt lgkmcnt(0)
  v_mfma_f32_16x16x32_bf16 v[160:163], v[120:123], v[104:107], v[160:163]
  ds_read_b64_tr_b16 v[80:81], v148 offset:36864
  ds_read_b64_tr_b16 v[82:83], v148 offset:37376
  v_mfma_f32_16x16x32_bf16 v[164:167], v[120:123], v[108:111], v[164:167]
  ds_read_b128 v[64:67], v145 offset:49152
  ds_read_b128 v[68:71], v145 offset:51200
  v_mfma_f32_16x16x32_bf16 v[168:171], v[120:123], v[112:115], v[168:171]
  ds_read_b128 v[72:75], v145 offset:53248
  ds_read_b128 v[76:79], v145 offset:55296
  v_mfma_f32_16x16x32_bf16 v[172:175], v[120:123], v[116:119], v[172:175]
  ds_read_b64_tr_b16 v[84:85], v149 offset:36864
  ds_read_b64_tr_b16 v[86:87], v149 offset:37376
  v_mfma_f32_16x16x32_bf16 v[188:191], v[124:127], v[116:119], v[188:191]
  ds_read_b64_tr_b16 v[88:89], v148 offset:45056
  ds_read_b64_tr_b16 v[90:91], v148 offset:45568
  v_mfma_f32_16x16x32_bf16 v[184:187], v[124:127], v[112:115], v[184:187]
  ds_read_b64_tr_b16 v[92:93], v149 offset:45056
  ds_read_b64_tr_b16 v[94:95], v149 offset:45568
  v_mfma_f32_16x16x32_bf16 v[180:183], v[124:127], v[108:111], v[180:183]
  v_mfma_f32_16x16x32_bf16 v[176:179], v[124:127], v[104:107], v[176:179]
  v_mfma_f32_16x16x32_bf16 v[224:227], v[104:107], v[128:131], v[224:227]
  v_mfma_f32_16x16x32_bf16 v[228:231], v[108:111], v[128:131], v[228:231]
  v_mfma_f32_16x16x32_bf16 v[232:235], v[112:115], v[128:131], v[232:235]
  v_mfma_f32_16x16x32_bf16 v[236:239], v[116:119], v[128:131], v[236:239]
  v_mfma_f32_16x16x32_bf16 v[252:255], v[116:119], v[132:135], v[252:255]
  v_mfma_f32_16x16x32_bf16 v[248:251], v[112:115], v[132:135], v[248:251]
  v_mfma_f32_16x16x32_bf16 v[244:247], v[108:111], v[132:135], v[244:247]
  v_mfma_f32_16x16x32_bf16 v[240:243], v[104:107], v[132:135], v[240:243]
  s_waitcnt lgkmcnt(0)
  v_mfma_f32_16x16x32_bf16 v[160:163], v[80:83], v[64:67], v[160:163]
  ds_read_b32 v63, v58
  ds_read_b128 v[32:35], v52 offset:4864
  v_mfma_f32_16x16x32_bf16 v[164:167], v[80:83], v[68:71], v[164:167]
  ds_read_b128 v[36:39], v52 offset:4928
  ds_read_b128 v[104:107], v51 offset:2816
  v_mfma_f32_16x16x32_bf16 v[168:171], v[80:83], v[72:75], v[168:171]
  ds_read_b128 v[120:123], v51 offset:3328
  ds_read_b128 v[108:111], v51 offset:2880
  v_mfma_f32_16x16x32_bf16 v[172:175], v[80:83], v[76:79], v[172:175]
  ds_read_b128 v[124:127], v51 offset:3392
  ds_read_b128 v[112:115], v51 offset:2944
  v_mfma_f32_16x16x32_bf16 v[188:191], v[84:87], v[76:79], v[188:191]
  ds_read_b128 v[128:131], v51 offset:3456
  ds_read_b128 v[116:119], v51 offset:3008
  v_mfma_f32_16x16x32_bf16 v[184:187], v[84:87], v[72:75], v[184:187]
  ds_read_b128 v[132:135], v51 offset:3520
  ds_read_b32 v48, v53 offset:5376
  v_mfma_f32_16x16x32_bf16 v[180:183], v[84:87], v[68:71], v[180:183]
  ds_read_b32 v49, v53 offset:5440
  v_mfma_f32_16x16x32_bf16 v[176:179], v[84:87], v[64:67], v[176:179]
  v_mfma_f32_16x16x32_bf16 v[224:227], v[64:67], v[88:91], v[224:227]
  v_mfma_f32_16x16x32_bf16 v[228:231], v[68:71], v[88:91], v[228:231]
  v_mfma_f32_16x16x32_bf16 v[232:235], v[72:75], v[88:91], v[232:235]
  v_mfma_f32_16x16x32_bf16 v[236:239], v[76:79], v[88:91], v[236:239]
  v_mfma_f32_16x16x32_bf16 v[252:255], v[76:79], v[92:95], v[252:255]
  v_mfma_f32_16x16x32_bf16 v[248:251], v[72:75], v[92:95], v[248:251]
  v_mfma_f32_16x16x32_bf16 v[244:247], v[68:71], v[92:95], v[244:247]
  v_mfma_f32_16x16x32_bf16 v[240:243], v[64:67], v[92:95], v[240:243]
  s_waitcnt lgkmcnt(0)
  v_cmp_gt_u32 vcc, s12, v63
  s_cbranch_vccnz .g2_kernel_q_v0fw
.g2_kernel_q_v0fc:
  s_cmp_ge_u32 s35, 0x200
  s_cbranch_scc1 .g2_kernel_q_v0r
.g2_kernel_q_v0rb:
  v_pk_mul_f32 v[24:25], v[24:25], v[56:57] op_sel_hi:[1,0]
  v_pk_mul_f32 v[26:27], v[26:27], v[56:57] op_sel_hi:[1,0]
  v_pk_mul_f32 v[28:29], v[28:29], v[56:57] op_sel_hi:[1,0]
  v_pk_mul_f32 v[30:31], v[30:31], v[56:57] op_sel_hi:[1,0]
  ds_write_b128 v59, v[192:195] offset:0
  v_pk_mul_f32 v[152:153], v[32:33], v[24:25] op_sel:[0,1] op_sel_hi:[1,1]
  v_pk_mul_f32 v[154:155], v[34:35], v[24:25] op_sel:[0,1] op_sel_hi:[1,1]
  v_pk_mul_f32 v[156:157], v[36:37], v[24:25] op_sel:[0,1] op_sel_hi:[1,1]
  v_pk_mul_f32 v[158:159], v[38:39], v[24:25] op_sel:[0,1] op_sel_hi:[1,1]
  v_pk_fma_f32 v[160:161], v[160:161], v[24:25], v[152:153] op_sel_hi:[1,0,1]
  v_pk_fma_f32 v[162:163], v[162:163], v[24:25], v[154:155] op_sel_hi:[1,0,1]
  v_pk_fma_f32 v[176:177], v[176:177], v[24:25], v[156:157] op_sel_hi:[1,0,1]
  v_pk_fma_f32 v[178:179], v[178:179], v[24:25], v[158:159] op_sel_hi:[1,0,1]
  v_cvt_pk_bf16_f32 v160, v160, v161
  v_cvt_pk_bf16_f32 v161, v162, v163
  v_cvt_pk_bf16_f32 v162, v176, v177
  v_cvt_pk_bf16_f32 v163, v178, v179
  ds_write_b128 v61, v[160:163] offset:0
  ds_write_b128 v59, v[196:199] offset:128
  v_pk_mul_f32 v[152:153], v[32:33], v[26:27] op_sel:[0,1] op_sel_hi:[1,1]
  v_pk_mul_f32 v[154:155], v[34:35], v[26:27] op_sel:[0,1] op_sel_hi:[1,1]
  v_pk_mul_f32 v[156:157], v[36:37], v[26:27] op_sel:[0,1] op_sel_hi:[1,1]
  v_pk_mul_f32 v[158:159], v[38:39], v[26:27] op_sel:[0,1] op_sel_hi:[1,1]
  v_pk_fma_f32 v[164:165], v[164:165], v[26:27], v[152:153] op_sel_hi:[1,0,1]
  v_pk_fma_f32 v[166:167], v[166:167], v[26:27], v[154:155] op_sel_hi:[1,0,1]
  v_pk_fma_f32 v[180:181], v[180:181], v[26:27], v[156:157] op_sel_hi:[1,0,1]
  v_pk_fma_f32 v[182:183], v[182:183], v[26:27], v[158:159] op_sel_hi:[1,0,1]
  v_cvt_pk_bf16_f32 v164, v164, v165
  v_cvt_pk_bf16_f32 v165, v166, v167
  v_cvt_pk_bf16_f32 v166, v180, v181
  v_cvt_pk_bf16_f32 v167, v182, v183
  ds_write_b128 v61, v[164:167] offset:256
  ds_write_b128 v59, v[200:203] offset:4096
  v_pk_mul_f32 v[152:153], v[32:33], v[28:29] op_sel:[0,1] op_sel_hi:[1,1]
  v_pk_mul_f32 v[154:155], v[34:35], v[28:29] op_sel:[0,1] op_sel_hi:[1,1]
  v_pk_mul_f32 v[156:157], v[36:37], v[28:29] op_sel:[0,1] op_sel_hi:[1,1]
  v_pk_mul_f32 v[158:159], v[38:39], v[28:29] op_sel:[0,1] op_sel_hi:[1,1]
  v_pk_fma_f32 v[168:169], v[168:169], v[28:29], v[152:153] op_sel_hi:[1,0,1]
  v_pk_fma_f32 v[170:171], v[170:171], v[28:29], v[154:155] op_sel_hi:[1,0,1]
  v_pk_fma_f32 v[184:185], v[184:185], v[28:29], v[156:157] op_sel_hi:[1,0,1]
  v_pk_fma_f32 v[186:187], v[186:187], v[28:29], v[158:159] op_sel_hi:[1,0,1]
  v_cvt_pk_bf16_f32 v168, v168, v169
  v_cvt_pk_bf16_f32 v169, v170, v171
  v_cvt_pk_bf16_f32 v170, v184, v185
  v_cvt_pk_bf16_f32 v171, v186, v187
  ds_write_b128 v61, v[168:171] offset:2048
  s_waitcnt vmcnt(0)
  s_mov_b64 exec, 1
  ds_add_rtn_u32 v7, v62, v5 offset:120
  s_mov_b64 exec, -1
  ds_write_b128 v59, v[204:207] offset:4224
  v_pk_mul_f32 v[152:153], v[32:33], v[30:31] op_sel:[0,1] op_sel_hi:[1,1]
  v_pk_mul_f32 v[154:155], v[34:35], v[30:31] op_sel:[0,1] op_sel_hi:[1,1]
  v_pk_mul_f32 v[156:157], v[36:37], v[30:31] op_sel:[0,1] op_sel_hi:[1,1]
  v_pk_mul_f32 v[158:159], v[38:39], v[30:31] op_sel:[0,1] op_sel_hi:[1,1]
  v_pk_fma_f32 v[172:173], v[172:173], v[30:31], v[152:153] op_sel_hi:[1,0,1]
  v_pk_fma_f32 v[174:175], v[174:175], v[30:31], v[154:155] op_sel_hi:[1,0,1]
  v_pk_fma_f32 v[188:189], v[188:189], v[30:31], v[156:157] op_sel_hi:[1,0,1]
  v_pk_fma_f32 v[190:191], v[190:191], v[30:31], v[158:159] op_sel_hi:[1,0,1]
  v_cvt_pk_bf16_f32 v172, v172, v173
  v_cvt_pk_bf16_f32 v173, v174, v175
  v_cvt_pk_bf16_f32 v174, v188, v189
  v_cvt_pk_bf16_f32 v175, v190, v191
  s_waitcnt lgkmcnt(1)
  v_readfirstlane_b32 s28, v7
  s_cmp_eq_u32 s28, 1
  s_cbranch_scc1 .g2_kernel_q_v0f
.g2_kernel_q_v0fb:
  ds_write_b128 v61, v[172:175] offset:2304
  v_pk_mul_f32 v[152:153], v[120:121], v[48:49] op_sel:[0,0] op_sel_hi:[1,0]
  v_pk_mul_f32 v[154:155], v[122:123], v[48:49] op_sel:[0,0] op_sel_hi:[1,0]
  v_pk_mul_f32 v[156:157], v[124:125], v[48:49] op_sel:[0,0] op_sel_hi:[1,0]
  v_pk_mul_f32 v[158:159], v[126:127], v[48:49] op_sel:[0,0] op_sel_hi:[1,0]
  v_pk_fma_f32 v[224:225], v[224:225], v[104:105], v[152:153]
  v_pk_fma_f32 v[226:227], v[226:227], v[106:107], v[154:155]
  v_pk_fma_f32 v[228:229], v[228:229], v[108:109], v[156:157]
  v_pk_fma_f32 v[230:231], v[230:231], v[110:111], v[158:159]
  v_cvt_pk_bf16_f32 v224, v224, v225
  v_cvt_pk_bf16_f32 v225, v226, v227
  v_cvt_pk_bf16_f32 v226, v228, v229
  v_cvt_pk_bf16_f32 v227, v230, v231
  ds_write_b128 v60, v[224:227] offset:2048
  v_pk_mul_f32 v[152:153], v[120:121], v[48:49] op_sel:[0,1] op_sel_hi:[1,1]
  v_pk_mul_f32 v[154:155], v[122:123], v[48:49] op_sel:[0,1] op_sel_hi:[1,1]
  v_pk_mul_f32 v[156:157], v[124:125], v[48:49] op_sel:[0,1] op_sel_hi:[1,1]
  v_pk_mul_f32 v[158:159], v[126:127], v[48:49] op_sel:[0,1] op_sel_hi:[1,1]
  v_pk_fma_f32 v[240:241], v[240:241], v[104:105], v[152:153]
  v_pk_fma_f32 v[242:243], v[242:243], v[106:107], v[154:155]
  v_pk_fma_f32 v[244:245], v[244:245], v[108:109], v[156:157]
  v_pk_fma_f32 v[246:247], v[246:247], v[110:111], v[158:159]
  v_cvt_pk_bf16_f32 v240, v240, v241
  v_cvt_pk_bf16_f32 v241, v242, v243
  v_cvt_pk_bf16_f32 v242, v244, v245
  v_cvt_pk_bf16_f32 v243, v246, v247
  ds_write_b128 v60, v[240:243] offset:2304
  v_pk_mul_f32 v[152:153], v[128:129], v[48:49] op_sel:[0,0] op_sel_hi:[1,0]
  v_pk_mul_f32 v[154:155], v[130:131], v[48:49] op_sel:[0,0] op_sel_hi:[1,0]
  v_pk_mul_f32 v[156:157], v[132:133], v[48:49] op_sel:[0,0] op_sel_hi:[1,0]
  v_pk_mul_f32 v[158:159], v[134:135], v[48:49] op_sel:[0,0] op_sel_hi:[1,0]
  v_pk_fma_f32 v[232:233], v[232:233], v[112:113], v[152:153]
  v_pk_fma_f32 v[234:235], v[234:235], v[114:115], v[154:155]
  v_pk_fma_f32 v[236:237], v[236:237], v[116:117], v[156:157]
  v_pk_fma_f32 v[238:239], v[238:239], v[118:119], v[158:159]
  v_cvt_pk_bf16_f32 v232, v232, v233
  v_cvt_pk_bf16_f32 v233, v234, v235
  v_cvt_pk_bf16_f32 v234, v236, v237
  v_cvt_pk_bf16_f32 v235, v238, v239
  ds_write_b128 v60, v[232:235] offset:6144
  v_pk_mul_f32 v[152:153], v[128:129], v[48:49] op_sel:[0,1] op_sel_hi:[1,1]
  v_pk_mul_f32 v[154:155], v[130:131], v[48:49] op_sel:[0,1] op_sel_hi:[1,1]
  v_pk_mul_f32 v[156:157], v[132:133], v[48:49] op_sel:[0,1] op_sel_hi:[1,1]
  v_pk_mul_f32 v[158:159], v[134:135], v[48:49] op_sel:[0,1] op_sel_hi:[1,1]
  v_pk_fma_f32 v[248:249], v[248:249], v[112:113], v[152:153]
  v_pk_fma_f32 v[250:251], v[250:251], v[114:115], v[154:155]
  v_pk_fma_f32 v[252:253], v[252:253], v[116:117], v[156:157]
  v_pk_fma_f32 v[254:255], v[254:255], v[118:119], v[158:159]
  v_cvt_pk_bf16_f32 v248, v248, v249
  v_cvt_pk_bf16_f32 v249, v250, v251
  v_cvt_pk_bf16_f32 v250, v252, v253
  v_cvt_pk_bf16_f32 v251, v254, v255
  ds_write_b128 v60, v[248:251] offset:6400
.g2_kernel_q_kd:
  s_mov_b64 exec, 1
  ds_add_u32 v13, v5 offset:4
  s_mov_b64 exec, -1
  v_mov_b32 v120, 0
  v_mov_b32 v121, 0
  v_mov_b32 v124, 0
  v_mov_b32 v125, 0
  v_mov_b32 v128, 0
  v_mov_b32 v129, 0
  v_mov_b32 v132, 0
  v_mov_b32 v133, 0
  s_cmp_lg_u32 s62, 0
  s_cbranch_scc1 .g2_kernel_r2
  global_load_dwordx4 v[240:243], v23, s[74:75] offset:0
  global_load_dwordx4 v[244:247], v23, s[74:75] offset:32
  global_load_dwordx4 v[248:251], v23, s[74:75] offset:64
  global_load_dwordx4 v[252:255], v23, s[74:75] offset:96
.g2_kernel_r3:
  v_mov_b32 v6, s71
  s_mov_b32 s38, 0
.g2_kernel_wg4:
  ds_read_b32 v7, v6 offset:4
  s_add_u32 s38, s38, 1
  s_waitcnt lgkmcnt(0)
  v_cmp_gt_u32 vcc, 4, v7
  s_cbranch_vccz .g2_kernel_wg4d
  s_cmp_lt_u32 s38, 524288
  s_cbranch_scc1 .g2_kernel_wg4
.g2_kernel_wg4d:
  ds_read_b128 v[176:179], v9 offset:0
  ds_read_b128 v[180:183], v9 offset:1024
  ds_read_b128 v[24:27], v14 offset:8192
  ds_read_b128 v[28:31], v14 offset:9216
  ds_read_b128 v[184:187], v9 offset:2048
  ds_read_b128 v[188:191], v9 offset:3072
  ds_read_b128 v[32:35], v14 offset:10240
  ds_read_b128 v[36:39], v14 offset:11264
  ds_read_b128 v[40:43], v14 offset:12288
  ds_read_b128 v[44:47], v14 offset:13312
  ds_read_b128 v[48:51], v14 offset:14336
  ds_read_b128 v[52:55], v14 offset:15360
  s_cmp_lg_u32 s35, 0
  s_cbranch_scc1 .g2_kernel_a_own
  s_waitcnt lgkmcnt(8)
.g2_kernel_a_ob:
  v_mfma_f32_32x32x16_bf16 v[136:151], v[176:179], v[24:27], 0
  v_mfma_f32_32x32x16_bf16 v[136:151], v[180:183], v[28:31], v[136:151]
  s_waitcnt lgkmcnt(0)
  s_nop 7
  v_mfma_f32_32x32x16_bf16 v[152:167], v[176:179], v[32:35], 0
  ds_read_b32 v7, v8
  s_nop 0
  v_exp_f32 v136, v136
  v_exp_f32 v137, v137
  v_exp_f32 v138, v138
  v_exp_f32 v139, v139
  v_exp_f32 v140, v140
  v_exp_f32 v141, v141
  v_exp_f32 v142, v142
  v_exp_f32 v143, v143
  v_mfma_f32_32x32x16_bf16 v[152:167], v[180:183], v[36:39], v[152:167]
  s_mov_b64 exec, 1
  ds_add_u32 v13, v5 offset:8
  s_mov_b64 exec, -1
  s_waitcnt lgkmcnt(0)
  v_cmp_lt_u32 vcc, s62, v7
  v_cvt_pk_bf16_f32 v168, v136, v137
  v_cvt_pk_bf16_f32 v169, v138, v139
  v_cvt_pk_bf16_f32 v170, v140, v141
  v_cvt_pk_bf16_f32 v171, v142, v143
  v_exp_f32 v144, v144
  v_exp_f32 v145, v145
  v_exp_f32 v146, v146
  v_exp_f32 v147, v147
  v_mfma_f32_32x32x16_bf16 v[56:71], v[184:187], v[168:171], 0
  s_mov_b32 s36, vcc_lo
  s_andn2_b32 s33, s36, s34
  v_exp_f32 v148, v148
  v_exp_f32 v149, v149
  v_exp_f32 v150, v150
  v_exp_f32 v151, v151
  v_cvt_pk_bf16_f32 v172, v144, v145
  v_cvt_pk_bf16_f32 v173, v146, v147
  v_cvt_pk_bf16_f32 v174, v148, v149
  v_cvt_pk_bf16_f32 v175, v150, v151
  v_mfma_f32_32x32x16_bf16 v[136:151], v[176:179], v[40:43], 0
  v_exp_f32 v152, v152
  v_exp_f32 v153, v153
  v_exp_f32 v154, v154
  v_mfma_f32_32x32x16_bf16 v[56:71], v[188:191], v[172:175], v[56:71]
  s_bcnt1_i32_b32 s33, s33
  s_sub_u32 s33, s33, s39
  s_cmp_lt_i32 s33, 3
  v_exp_f32 v155, v155
  v_exp_f32 v156, v156
  v_exp_f32 v157, v157
  v_smfmac_f32_16x16x64_bf16 v[120:123], v[16:19], v[168:175], v20
  s_cbranch_scc1 .g2_kernel_a_F0n0
  s_mov_b32 s39, 64
  s_call_b64 s[72:73], .g2_kernel_a_three
.g2_kernel_a_F0n0:
  v_exp_f32 v158, v158
  v_exp_f32 v159, v159
  v_mfma_f32_32x32x16_bf16 v[136:151], v[180:183], v[44:47], v[136:151]
  v_cvt_pk_bf16_f32 v168, v152, v153
  v_cvt_pk_bf16_f32 v169, v154, v155
  v_cvt_pk_bf16_f32 v170, v156, v157
  v_cvt_pk_bf16_f32 v171, v158, v159
  v_exp_f32 v160, v160
  v_exp_f32 v161, v161
  v_exp_f32 v162, v162
  v_exp_f32 v163, v163
  v_mfma_f32_32x32x16_bf16 v[72:87], v[184:187], v[168:171], 0
  v_exp_f32 v164, v164
  v_exp_f32 v165, v165
  v_exp_f32 v166, v166
  v_exp_f32 v167, v167
  v_cvt_pk_bf16_f32 v172, v160, v161
  v_cvt_pk_bf16_f32 v173, v162, v163
  v_cvt_pk_bf16_f32 v174, v164, v165
  v_cvt_pk_bf16_f32 v175, v166, v167
  v_mfma_f32_32x32x16_bf16 v[152:167], v[176:179], v[48:51], 0
  ds_read_b32 v7, v8
  v_exp_f32 v136, v136
  v_exp_f32 v137, v137
  v_exp_f32 v138, v138
  v_mfma_f32_32x32x16_bf16 v[72:87], v[188:191], v[172:175], v[72:87]
  s_lshl_b32 s28, s16, 11
  v_exp_f32 v139, v139
  v_exp_f32 v140, v140
  v_exp_f32 v141, v141
  v_smfmac_f32_16x16x64_bf16 v[124:127], v[16:19], v[168:175], v20
  v_add_u32 v9, s28, v3
  v_exp_f32 v142, v142
  v_exp_f32 v143, v143
  v_mfma_f32_32x32x16_bf16 v[152:167], v[180:183], v[52:55], v[152:167]
  s_waitcnt lgkmcnt(0)
  v_cmp_lt_u32 vcc, s62, v7
  v_cvt_pk_bf16_f32 v168, v136, v137
  v_cvt_pk_bf16_f32 v169, v138, v139
  v_cvt_pk_bf16_f32 v170, v140, v141
  v_cvt_pk_bf16_f32 v171, v142, v143
  v_exp_f32 v144, v144
  v_exp_f32 v145, v145
  v_exp_f32 v146, v146
  v_exp_f32 v147, v147
  v_mfma_f32_32x32x16_bf16 v[88:103], v[184:187], v[168:171], 0
  s_mov_b32 s36, vcc_lo
  s_andn2_b32 s33, s36, s34
  v_exp_f32 v148, v148
  v_exp_f32 v149, v149
  v_exp_f32 v150, v150
  v_exp_f32 v151, v151
  v_cvt_pk_bf16_f32 v172, v144, v145
  v_cvt_pk_bf16_f32 v173, v146, v147
  v_cvt_pk_bf16_f32 v174, v148, v149
  v_cvt_pk_bf16_f32 v175, v150, v151
  v_exp_f32 v152, v152
  v_exp_f32 v153, v153
  v_exp_f32 v154, v154
  v_mfma_f32_32x32x16_bf16 v[88:103], v[188:191], v[172:175], v[88:103]
  s_bcnt1_i32_b32 s33, s33
  s_sub_u32 s33, s33, s39
  s_cmp_lt_i32 s33, 3
  v_exp_f32 v155, v155
  v_exp_f32 v156, v156
  v_exp_f32 v157, v157
  v_smfmac_f32_16x16x64_bf16 v[128:131], v[16:19], v[168:175], v20
  s_cbranch_scc1 .g2_kernel_a_F0n2
  s_mov_b32 s39, 64
  s_call_b64 s[72:73], .g2_kernel_a_three
.g2_kernel_a_F0n2:
  v_exp_f32 v158, v158
  v_exp_f32 v159, v159
  v_cvt_pk_bf16_f32 v168, v152, v153
  v_cvt_pk_bf16_f32 v169, v154, v155
  v_cvt_pk_bf16_f32 v170, v156, v157
  v_cvt_pk_bf16_f32 v171, v158, v159
  v_exp_f32 v160, v160
  v_exp_f32 v161, v161
  v_exp_f32 v162, v162
  v_exp_f32 v163, v163
  v_mfma_f32_32x32x16_bf16 v[104:119], v[184:187], v[168:171], 0
  v_exp_f32 v164, v164
  v_exp_f32 v165, v165
  v_exp_f32 v166, v166
  v_exp_f32 v167, v167
  v_cvt_pk_bf16_f32 v172, v160, v161
  v_cvt_pk_bf16_f32 v173, v162, v163
  v_cvt_pk_bf16_f32 v174, v164, v165
  v_cvt_pk_bf16_f32 v175, v166, v167
  s_add_u32 s39, s39, s35
  s_cmp_ge_u32 s39, 3
  s_cbranch_scc1 .g2_kernel_a_p1
  s_call_b64 s[72:73], .g2_kernel_a_three
.g2_kernel_a_p1:
  s_waitcnt vmcnt(10)
  v_mfma_f32_32x32x16_bf16 v[136:151], v[192:195], v[24:27], 0
  v_mfma_f32_32x32x16_bf16 v[136:151], v[196:199], v[28:31], v[136:151]
  s_waitcnt vmcnt(8)
  s_mov_b32 s32, 0
  s_nop 8
  s_branch .g2_kernel_a_n1
  .p2align 6
.g2_kernel_a_loop:
  v_exp_f32 v136, v136
  v_exp_f32 v137, v137
  v_exp_f32 v138, v138
  v_mfma_f32_32x32x16_bf16 v[104:119], v[236:239], v[172:175], v[104:119]
  s_andn2_b32 s33, s36, s34
  v_exp_f32 v139, v139
  v_exp_f32 v140, v140
  v_exp_f32 v141, v141
  v_smfmac_f32_16x16x64_bf16 v[132:135], v[16:19], v[168:175], v20
  s_cbranch_scc0 .g2_kernel_a_N0c
.g2_kernel_a_N0b:
  v_exp_f32 v142, v142
  v_exp_f32 v143, v143
  v_mfma_f32_32x32x16_bf16 v[152:167], v[180:183], v[36:39], v[152:167]
  s_ff1_i32_b32 s33, s33
  v_cvt_pk_bf16_f32 v168, v136, v137
  v_cvt_pk_bf16_f32 v169, v138, v139
  v_cvt_pk_bf16_f32 v170, v140, v141
  v_cvt_pk_bf16_f32 v171, v142, v143
  v_exp_f32 v144, v144
  v_exp_f32 v145, v145
  v_exp_f32 v146, v146
  v_exp_f32 v147, v147
  v_mfma_f32_32x32x16_bf16 v[56:71], v[184:187], v[168:171], v[56:71]
  s_bitset1_b32 s34, s33
  v_exp_f32 v148, v148
  v_exp_f32 v149, v149
  v_exp_f32 v150, v150
  v_exp_f32 v151, v151
  v_cvt_pk_bf16_f32 v172, v144, v145
  v_cvt_pk_bf16_f32 v173, v146, v147
  v_cvt_pk_bf16_f32 v174, v148, v149
  v_cvt_pk_bf16_f32 v175, v150, v151
  v_mfma_f32_32x32x16_bf16 v[136:151], v[176:179], v[40:43], 0
  s_xor_b32 s33, s33, s24
  v_exp_f32 v152, v152
  v_exp_f32 v153, v153
  v_exp_f32 v154, v154
  v_mfma_f32_32x32x16_bf16 v[56:71], v[188:191], v[172:175], v[56:71]
  s_lshl_b32 s33, s33, s25
  v_exp_f32 v155, v155
  v_exp_f32 v156, v156
  v_exp_f32 v157, v157
  v_smfmac_f32_16x16x64_bf16 v[120:123], v[16:19], v[168:175], v20
  s_add_u32 s22, s20, s33
  v_exp_f32 v158, v158
  v_exp_f32 v159, v159
  v_mfma_f32_32x32x16_bf16 v[136:151], v[180:183], v[44:47], v[136:151]
  s_addc_u32 s23, s21, 0
  v_cvt_pk_bf16_f32 v168, v152, v153
  v_cvt_pk_bf16_f32 v169, v154, v155
  v_cvt_pk_bf16_f32 v170, v156, v157
  v_cvt_pk_bf16_f32 v171, v158, v159
  v_exp_f32 v160, v160
  v_exp_f32 v161, v161
  v_exp_f32 v162, v162
  v_exp_f32 v163, v163
  v_mfma_f32_32x32x16_bf16 v[72:87], v[184:187], v[168:171], v[72:87]
  v_exp_f32 v164, v164
  v_exp_f32 v165, v165
  v_exp_f32 v166, v166
  v_exp_f32 v167, v167
  v_cvt_pk_bf16_f32 v172, v160, v161
  v_cvt_pk_bf16_f32 v173, v162, v163
  v_cvt_pk_bf16_f32 v174, v164, v165
  v_cvt_pk_bf16_f32 v175, v166, v167
  v_mfma_f32_32x32x16_bf16 v[152:167], v[176:179], v[48:51], 0
  ds_read_b32 v7, v8
  v_exp_f32 v136, v136
  v_exp_f32 v137, v137
  v_exp_f32 v138, v138
  v_mfma_f32_32x32x16_bf16 v[72:87], v[188:191], v[172:175], v[72:87]
  v_exp_f32 v139, v139
  v_exp_f32 v140, v140
  v_exp_f32 v141, v141
  v_smfmac_f32_16x16x64_bf16 v[124:127], v[16:19], v[168:175], v20
  global_load_dwordx4 v[224:227], v3, s[22:23] offset:0
  global_load_dwordx4 v[228:231], v3, s[22:23] offset:1024
  global_load_dwordx4 v[232:235], v3, s[22:23] offset:2048
  global_load_dwordx4 v[236:239], v3, s[22:23] offset:3072
  v_exp_f32 v142, v142
  v_exp_f32 v143, v143
  v_mfma_f32_32x32x16_bf16 v[152:167], v[180:183], v[52:55], v[152:167]
  v_cvt_pk_bf16_f32 v168, v136, v137
  v_cvt_pk_bf16_f32 v169, v138, v139
  v_cvt_pk_bf16_f32 v170, v140, v141
  v_cvt_pk_bf16_f32 v171, v142, v143
  v_exp_f32 v144, v144
  v_exp_f32 v145, v145
  v_exp_f32 v146, v146
  v_exp_f32 v147, v147
  v_mfma_f32_32x32x16_bf16 v[88:103], v[184:187], v[168:171], v[88:103]
  s_waitcnt vmcnt(8)
  v_exp_f32 v148, v148
  v_exp_f32 v149, v149
  v_exp_f32 v150, v150
  v_exp_f32 v151, v151
  v_cvt_pk_bf16_f32 v172, v144, v145
  v_cvt_pk_bf16_f32 v173, v146, v147
  v_cvt_pk_bf16_f32 v174, v148, v149
  v_cvt_pk_bf16_f32 v175, v150, v151
  v_mfma_f32_32x32x16_bf16 v[136:151], v[192:195], v[24:27], 0
  s_waitcnt lgkmcnt(0)
  v_cmp_lt_u32 vcc, s62, v7
  v_exp_f32 v152, v152
  v_exp_f32 v153, v153
  v_exp_f32 v154, v154
  v_mfma_f32_32x32x16_bf16 v[88:103], v[188:191], v[172:175], v[88:103]
  s_mov_b32 s36, vcc_lo
  v_exp_f32 v155, v155
  v_exp_f32 v156, v156
  v_exp_f32 v157, v157
  v_smfmac_f32_16x16x64_bf16 v[128:131], v[16:19], v[168:175], v20
  v_exp_f32 v158, v158
  v_exp_f32 v159, v159
  v_mfma_f32_32x32x16_bf16 v[136:151], v[196:199], v[28:31], v[136:151]
  v_cvt_pk_bf16_f32 v168, v152, v153
  v_cvt_pk_bf16_f32 v169, v154, v155
  v_cvt_pk_bf16_f32 v170, v156, v157
  v_cvt_pk_bf16_f32 v171, v158, v159
  v_exp_f32 v160, v160
  v_exp_f32 v161, v161
  v_exp_f32 v162, v162
  v_exp_f32 v163, v163
  v_mfma_f32_32x32x16_bf16 v[104:119], v[184:187], v[168:171], v[104:119]
  v_exp_f32 v164, v164
  v_exp_f32 v165, v165
  v_exp_f32 v166, v166
  v_exp_f32 v167, v167
  v_cvt_pk_bf16_f32 v172, v160, v161
  v_cvt_pk_bf16_f32 v173, v162, v163
  v_cvt_pk_bf16_f32 v174, v164, v165
  v_cvt_pk_bf16_f32 v175, v166, v167
.g2_kernel_a_n1:
  v_mfma_f32_32x32x16_bf16 v[152:167], v[192:195], v[32:35], 0
  s_andn2_b32 s33, s36, s34
  v_exp_f32 v136, v136
  v_exp_f32 v137, v137
  v_exp_f32 v138, v138
  v_mfma_f32_32x32x16_bf16 v[104:119], v[188:191], v[172:175], v[104:119]
  s_cbranch_scc0 .g2_kernel_a_N1c
.g2_kernel_a_N1b:
  v_exp_f32 v139, v139
  v_exp_f32 v140, v140
  v_exp_f32 v141, v141
  v_smfmac_f32_16x16x64_bf16 v[132:135], v[16:19], v[168:175], v20
  s_ff1_i32_b32 s33, s33
  v_exp_f32 v142, v142
  v_exp_f32 v143, v143
  v_mfma_f32_32x32x16_bf16 v[152:167], v[196:199], v[36:39], v[152:167]
  s_bitset1_b32 s34, s33
  v_cvt_pk_bf16_f32 v168, v136, v137
  v_cvt_pk_bf16_f32 v169, v138, v139
  v_cvt_pk_bf16_f32 v170, v140, v141
  v_cvt_pk_bf16_f32 v171, v142, v143
  v_exp_f32 v144, v144
  v_exp_f32 v145, v145
  v_exp_f32 v146, v146
  v_exp_f32 v147, v147
  v_mfma_f32_32x32x16_bf16 v[56:71], v[200:203], v[168:171], v[56:71]
  s_xor_b32 s33, s33, s24
  v_exp_f32 v148, v148
  v_exp_f32 v149, v149
  v_exp_f32 v150, v150
  v_exp_f32 v151, v151
  v_cvt_pk_bf16_f32 v172, v144, v145
  v_cvt_pk_bf16_f32 v173, v146, v147
  v_cvt_pk_bf16_f32 v174, v148, v149
  v_cvt_pk_bf16_f32 v175, v150, v151
  v_mfma_f32_32x32x16_bf16 v[136:151], v[192:195], v[40:43], 0
  s_lshl_b32 s33, s33, s25
  v_exp_f32 v152, v152
  v_exp_f32 v153, v153
  v_exp_f32 v154, v154
  v_mfma_f32_32x32x16_bf16 v[56:71], v[204:207], v[172:175], v[56:71]
  s_add_u32 s22, s20, s33
  v_exp_f32 v155, v155
  v_exp_f32 v156, v156
  v_exp_f32 v157, v157
  v_smfmac_f32_16x16x64_bf16 v[120:123], v[16:19], v[168:175], v20
  s_addc_u32 s23, s21, 0
  v_exp_f32 v158, v158
  v_exp_f32 v159, v159
  v_mfma_f32_32x32x16_bf16 v[136:151], v[196:199], v[44:47], v[136:151]
  v_cvt_pk_bf16_f32 v168, v152, v153
  v_cvt_pk_bf16_f32 v169, v154, v155
  v_cvt_pk_bf16_f32 v170, v156, v157
  v_cvt_pk_bf16_f32 v171, v158, v159
  v_exp_f32 v160, v160
  v_exp_f32 v161, v161
  v_exp_f32 v162, v162
  v_exp_f32 v163, v163
  v_mfma_f32_32x32x16_bf16 v[72:87], v[200:203], v[168:171], v[72:87]
  v_exp_f32 v164, v164
  v_exp_f32 v165, v165
  v_exp_f32 v166, v166
  v_exp_f32 v167, v167
  v_cvt_pk_bf16_f32 v172, v160, v161
  v_cvt_pk_bf16_f32 v173, v162, v163
  v_cvt_pk_bf16_f32 v174, v164, v165
  v_cvt_pk_bf16_f32 v175, v166, v167
  v_mfma_f32_32x32x16_bf16 v[152:167], v[192:195], v[48:51], 0
  v_exp_f32 v136, v136
  v_exp_f32 v137, v137
  v_exp_f32 v138, v138
  v_mfma_f32_32x32x16_bf16 v[72:87], v[204:207], v[172:175], v[72:87]
  v_exp_f32 v139, v139
  v_exp_f32 v140, v140
  v_exp_f32 v141, v141
  v_smfmac_f32_16x16x64_bf16 v[124:127], v[16:19], v[168:175], v20
  global_load_dwordx4 v[176:179], v3, s[22:23] offset:0
  global_load_dwordx4 v[180:183], v3, s[22:23] offset:1024
  global_load_dwordx4 v[184:187], v3, s[22:23] offset:2048
  global_load_dwordx4 v[188:191], v3, s[22:23] offset:3072
  v_exp_f32 v142, v142
  v_exp_f32 v143, v143
  v_mfma_f32_32x32x16_bf16 v[152:167], v[196:199], v[52:55], v[152:167]
  v_cvt_pk_bf16_f32 v168, v136, v137
  v_cvt_pk_bf16_f32 v169, v138, v139
  v_cvt_pk_bf16_f32 v170, v140, v141
  v_cvt_pk_bf16_f32 v171, v142, v143
  v_exp_f32 v144, v144
  v_exp_f32 v145, v145
  v_exp_f32 v146, v146
  v_exp_f32 v147, v147
  v_mfma_f32_32x32x16_bf16 v[88:103], v[200:203], v[168:171], v[88:103]
  s_waitcnt vmcnt(8)
  v_exp_f32 v148, v148
  v_exp_f32 v149, v149
  v_exp_f32 v150, v150
  v_exp_f32 v151, v151
  v_cvt_pk_bf16_f32 v172, v144, v145
  v_cvt_pk_bf16_f32 v173, v146, v147
  v_cvt_pk_bf16_f32 v174, v148, v149
  v_cvt_pk_bf16_f32 v175, v150, v151
  v_mfma_f32_32x32x16_bf16 v[136:151], v[208:211], v[24:27], 0
  v_exp_f32 v152, v152
  v_exp_f32 v153, v153
  v_exp_f32 v154, v154
  v_mfma_f32_32x32x16_bf16 v[88:103], v[204:207], v[172:175], v[88:103]
  v_exp_f32 v155, v155
  v_exp_f32 v156, v156
  v_exp_f32 v157, v157
  v_smfmac_f32_16x16x64_bf16 v[128:131], v[16:19], v[168:175], v20
  v_exp_f32 v158, v158
  v_exp_f32 v159, v159
  v_mfma_f32_32x32x16_bf16 v[136:151], v[212:215], v[28:31], v[136:151]
  v_cvt_pk_bf16_f32 v168, v152, v153
  v_cvt_pk_bf16_f32 v169, v154, v155
  v_cvt_pk_bf16_f32 v170, v156, v157
  v_cvt_pk_bf16_f32 v171, v158, v159
  v_exp_f32 v160, v160
  v_exp_f32 v161, v161
  v_exp_f32 v162, v162
  v_exp_f32 v163, v163
  v_mfma_f32_32x32x16_bf16 v[104:119], v[200:203], v[168:171], v[104:119]
  v_exp_f32 v164, v164
  v_exp_f32 v165, v165
  v_exp_f32 v166, v166
  v_exp_f32 v167, v167
  v_cvt_pk_bf16_f32 v172, v160, v161
  v_cvt_pk_bf16_f32 v173, v162, v163
  v_cvt_pk_bf16_f32 v174, v164, v165
  v_cvt_pk_bf16_f32 v175, v166, v167
  v_mfma_f32_32x32x16_bf16 v[152:167], v[208:211], v[32:35], 0
  s_andn2_b32 s33, s36, s34
  v_exp_f32 v136, v136
  v_exp_f32 v137, v137
  v_exp_f32 v138, v138
  v_mfma_f32_32x32x16_bf16 v[104:119], v[204:207], v[172:175], v[104:119]
  s_cbranch_scc0 .g2_kernel_a_N2c
.g2_kernel_a_N2b:
  v_exp_f32 v139, v139
  v_exp_f32 v140, v140
  v_exp_f32 v141, v141
  v_smfmac_f32_16x16x64_bf16 v[132:135], v[16:19], v[168:175], v20
  s_ff1_i32_b32 s33, s33
  v_exp_f32 v142, v142
  v_exp_f32 v143, v143
  v_mfma_f32_32x32x16_bf16 v[152:167], v[212:215], v[36:39], v[152:167]
  s_bitset1_b32 s34, s33
  v_cvt_pk_bf16_f32 v168, v136, v137
  v_cvt_pk_bf16_f32 v169, v138, v139
  v_cvt_pk_bf16_f32 v170, v140, v141
  v_cvt_pk_bf16_f32 v171, v142, v143
  v_exp_f32 v144, v144
  v_exp_f32 v145, v145
  v_exp_f32 v146, v146
  v_exp_f32 v147, v147
  v_mfma_f32_32x32x16_bf16 v[56:71], v[216:219], v[168:171], v[56:71]
  s_xor_b32 s33, s33, s24
  v_exp_f32 v148, v148
  v_exp_f32 v149, v149
  v_exp_f32 v150, v150
  v_exp_f32 v151, v151
  v_cvt_pk_bf16_f32 v172, v144, v145
  v_cvt_pk_bf16_f32 v173, v146, v147
  v_cvt_pk_bf16_f32 v174, v148, v149
  v_cvt_pk_bf16_f32 v175, v150, v151
  v_mfma_f32_32x32x16_bf16 v[136:151], v[208:211], v[40:43], 0
  s_lshl_b32 s33, s33, s25
  v_exp_f32 v152, v152
  v_exp_f32 v153, v153
  v_exp_f32 v154, v154
  v_mfma_f32_32x32x16_bf16 v[56:71], v[220:223], v[172:175], v[56:71]
  s_add_u32 s22, s20, s33
  v_exp_f32 v155, v155
  v_exp_f32 v156, v156
  v_exp_f32 v157, v157
  v_smfmac_f32_16x16x64_bf16 v[120:123], v[16:19], v[168:175], v20
  s_addc_u32 s23, s21, 0
  v_exp_f32 v158, v158
  v_exp_f32 v159, v159
  v_mfma_f32_32x32x16_bf16 v[136:151], v[212:215], v[44:47], v[136:151]
  v_cvt_pk_bf16_f32 v168, v152, v153
  v_cvt_pk_bf16_f32 v169, v154, v155
  v_cvt_pk_bf16_f32 v170, v156, v157
  v_cvt_pk_bf16_f32 v171, v158, v159
  v_exp_f32 v160, v160
  v_exp_f32 v161, v161
  v_exp_f32 v162, v162
  v_exp_f32 v163, v163
  v_mfma_f32_32x32x16_bf16 v[72:87], v[216:219], v[168:171], v[72:87]
  v_exp_f32 v164, v164
  v_exp_f32 v165, v165
  v_exp_f32 v166, v166
  v_exp_f32 v167, v167
  v_cvt_pk_bf16_f32 v172, v160, v161
  v_cvt_pk_bf16_f32 v173, v162, v163
  v_cvt_pk_bf16_f32 v174, v164, v165
  v_cvt_pk_bf16_f32 v175, v166, v167
  v_mfma_f32_32x32x16_bf16 v[152:167], v[208:211], v[48:51], 0
  v_exp_f32 v136, v136
  v_exp_f32 v137, v137
  v_exp_f32 v138, v138
  v_mfma_f32_32x32x16_bf16 v[72:87], v[220:223], v[172:175], v[72:87]
  v_exp_f32 v139, v139
  v_exp_f32 v140, v140
  v_exp_f32 v141, v141
  v_smfmac_f32_16x16x64_bf16 v[124:127], v[16:19], v[168:175], v20
  global_load_dwordx4 v[192:195], v3, s[22:23] offset:0
  global_load_dwordx4 v[196:199], v3, s[22:23] offset:1024
  global_load_dwordx4 v[200:203], v3, s[22:23] offset:2048
  global_load_dwordx4 v[204:207], v3, s[22:23] offset:3072
  v_exp_f32 v142, v142
  v_exp_f32 v143, v143
  v_mfma_f32_32x32x16_bf16 v[152:167], v[212:215], v[52:55], v[152:167]
  v_cvt_pk_bf16_f32 v168, v136, v137
  v_cvt_pk_bf16_f32 v169, v138, v139
  v_cvt_pk_bf16_f32 v170, v140, v141
  v_cvt_pk_bf16_f32 v171, v142, v143
  v_exp_f32 v144, v144
  v_exp_f32 v145, v145
  v_exp_f32 v146, v146
  v_exp_f32 v147, v147
  v_mfma_f32_32x32x16_bf16 v[88:103], v[216:219], v[168:171], v[88:103]
  s_waitcnt vmcnt(8)
  v_exp_f32 v148, v148
  v_exp_f32 v149, v149
  v_exp_f32 v150, v150
  v_exp_f32 v151, v151
  v_cvt_pk_bf16_f32 v172, v144, v145
  v_cvt_pk_bf16_f32 v173, v146, v147
  v_cvt_pk_bf16_f32 v174, v148, v149
  v_cvt_pk_bf16_f32 v175, v150, v151
  v_mfma_f32_32x32x16_bf16 v[136:151], v[224:227], v[24:27], 0
  v_exp_f32 v152, v152
  v_exp_f32 v153, v153
  v_exp_f32 v154, v154
  v_mfma_f32_32x32x16_bf16 v[88:103], v[220:223], v[172:175], v[88:103]
  v_exp_f32 v155, v155
  v_exp_f32 v156, v156
  v_exp_f32 v157, v157
  v_smfmac_f32_16x16x64_bf16 v[128:131], v[16:19], v[168:175], v20
  v_exp_f32 v158, v158
  v_exp_f32 v159, v159
  v_mfma_f32_32x32x16_bf16 v[136:151], v[228:231], v[28:31], v[136:151]
  s_and_b32 s28, s32, 3
  v_cvt_pk_bf16_f32 v168, v152, v153
  v_cvt_pk_bf16_f32 v169, v154, v155
  v_cvt_pk_bf16_f32 v170, v156, v157
  v_cvt_pk_bf16_f32 v171, v158, v159
  v_exp_f32 v160, v160
  v_exp_f32 v161, v161
  v_exp_f32 v162, v162
  v_exp_f32 v163, v163
  v_mfma_f32_32x32x16_bf16 v[104:119], v[216:219], v[168:171], v[104:119]
  s_cmp_eq_u32 s28, 3
  v_exp_f32 v164, v164
  v_exp_f32 v165, v165
  v_exp_f32 v166, v166
  v_exp_f32 v167, v167
  v_cvt_pk_bf16_f32 v172, v160, v161
  v_cvt_pk_bf16_f32 v173, v162, v163
  v_cvt_pk_bf16_f32 v174, v164, v165
  v_cvt_pk_bf16_f32 v175, v166, v167
  v_mfma_f32_32x32x16_bf16 v[152:167], v[224:227], v[32:35], 0
  s_cbranch_scc1 .g2_kernel_a_last
  v_exp_f32 v136, v136
  v_exp_f32 v137, v137
  v_exp_f32 v138, v138
  v_mfma_f32_32x32x16_bf16 v[104:119], v[220:223], v[172:175], v[104:119]
  s_andn2_b32 s33, s36, s34
  v_exp_f32 v139, v139
  v_exp_f32 v140, v140
  v_exp_f32 v141, v141
  v_smfmac_f32_16x16x64_bf16 v[132:135], v[16:19], v[168:175], v20
  s_cbranch_scc0 .g2_kernel_a_N3c
.g2_kernel_a_N3b:
  v_exp_f32 v142, v142
  v_exp_f32 v143, v143
  v_mfma_f32_32x32x16_bf16 v[152:167], v[228:231], v[36:39], v[152:167]
  s_ff1_i32_b32 s33, s33
  v_cvt_pk_bf16_f32 v168, v136, v137
  v_cvt_pk_bf16_f32 v169, v138, v139
  v_cvt_pk_bf16_f32 v170, v140, v141
  v_cvt_pk_bf16_f32 v171, v142, v143
  v_exp_f32 v144, v144
  v_exp_f32 v145, v145
  v_exp_f32 v146, v146
  v_exp_f32 v147, v147
  v_mfma_f32_32x32x16_bf16 v[56:71], v[232:235], v[168:171], v[56:71]
  s_bitset1_b32 s34, s33
  v_exp_f32 v148, v148
  v_exp_f32 v149, v149
  v_exp_f32 v150, v150
  v_exp_f32 v151, v151
  v_cvt_pk_bf16_f32 v172, v144, v145
  v_cvt_pk_bf16_f32 v173, v146, v147
  v_cvt_pk_bf16_f32 v174, v148, v149
  v_cvt_pk_bf16_f32 v175, v150, v151
  v_mfma_f32_32x32x16_bf16 v[136:151], v[224:227], v[40:43], 0
  s_xor_b32 s33, s33, s24
  v_exp_f32 v152, v152
  v_exp_f32 v153, v153
  v_exp_f32 v154, v154
  v_mfma_f32_32x32x16_bf16 v[56:71], v[236:239], v[172:175], v[56:71]
  s_lshl_b32 s33, s33, s25
  v_exp_f32 v155, v155
  v_exp_f32 v156, v156
  v_exp_f32 v157, v157
  v_smfmac_f32_16x16x64_bf16 v[120:123], v[16:19], v[168:175], v20
  s_add_u32 s22, s20, s33
  v_exp_f32 v158, v158
  v_exp_f32 v159, v159
  v_mfma_f32_32x32x16_bf16 v[136:151], v[228:231], v[44:47], v[136:151]
  s_addc_u32 s23, s21, 0
  v_cvt_pk_bf16_f32 v168, v152, v153
  v_cvt_pk_bf16_f32 v169, v154, v155
  v_cvt_pk_bf16_f32 v170, v156, v157
  v_cvt_pk_bf16_f32 v171, v158, v159
  v_exp_f32 v160, v160
  v_exp_f32 v161, v161
  v_exp_f32 v162, v162
  v_exp_f32 v163, v163
  v_mfma_f32_32x32x16_bf16 v[72:87], v[232:235], v[168:171], v[72:87]
  v_exp_f32 v164, v164
  v_exp_f32 v165, v165
  v_exp_f32 v166, v166
  v_exp_f32 v167, v167
  v_cvt_pk_bf16_f32 v172, v160, v161
  v_cvt_pk_bf16_f32 v173, v162, v163
  v_cvt_pk_bf16_f32 v174, v164, v165
  v_cvt_pk_bf16_f32 v175, v166, v167
  v_mfma_f32_32x32x16_bf16 v[152:167], v[224:227], v[48:51], 0
  v_exp_f32 v136, v136
  v_exp_f32 v137, v137
  v_exp_f32 v138, v138
  v_mfma_f32_32x32x16_bf16 v[72:87], v[236:239], v[172:175], v[72:87]
  v_exp_f32 v139, v139
  v_exp_f32 v140, v140
  v_exp_f32 v141, v141
  v_smfmac_f32_16x16x64_bf16 v[124:127], v[16:19], v[168:175], v20
  global_load_dwordx4 v[208:211], v3, s[22:23] offset:0
  global_load_dwordx4 v[212:215], v3, s[22:23] offset:1024
  global_load_dwordx4 v[216:219], v3, s[22:23] offset:2048
  global_load_dwordx4 v[220:223], v3, s[22:23] offset:3072
  v_exp_f32 v142, v142
  v_exp_f32 v143, v143
  v_mfma_f32_32x32x16_bf16 v[152:167], v[228:231], v[52:55], v[152:167]
  v_cvt_pk_bf16_f32 v168, v136, v137
  v_cvt_pk_bf16_f32 v169, v138, v139
  v_cvt_pk_bf16_f32 v170, v140, v141
  v_cvt_pk_bf16_f32 v171, v142, v143
  v_exp_f32 v144, v144
  v_exp_f32 v145, v145
  v_exp_f32 v146, v146
  v_exp_f32 v147, v147
  v_mfma_f32_32x32x16_bf16 v[88:103], v[232:235], v[168:171], v[88:103]
  s_waitcnt vmcnt(8)
  v_exp_f32 v148, v148
  v_exp_f32 v149, v149
  v_exp_f32 v150, v150
  v_exp_f32 v151, v151
  v_cvt_pk_bf16_f32 v172, v144, v145
  v_cvt_pk_bf16_f32 v173, v146, v147
  v_cvt_pk_bf16_f32 v174, v148, v149
  v_cvt_pk_bf16_f32 v175, v150, v151
  v_mfma_f32_32x32x16_bf16 v[136:151], v[176:179], v[24:27], 0
  v_exp_f32 v152, v152
  v_exp_f32 v153, v153
  v_exp_f32 v154, v154
  v_mfma_f32_32x32x16_bf16 v[88:103], v[236:239], v[172:175], v[88:103]
  v_exp_f32 v155, v155
  v_exp_f32 v156, v156
  v_exp_f32 v157, v157
  v_smfmac_f32_16x16x64_bf16 v[128:131], v[16:19], v[168:175], v20
  v_exp_f32 v158, v158
  v_exp_f32 v159, v159
  v_mfma_f32_32x32x16_bf16 v[136:151], v[180:183], v[28:31], v[136:151]
  s_add_u32 s32, s32, 1
  v_cvt_pk_bf16_f32 v168, v152, v153
  v_cvt_pk_bf16_f32 v169, v154, v155
  v_cvt_pk_bf16_f32 v170, v156, v157
  v_cvt_pk_bf16_f32 v171, v158, v159
  v_exp_f32 v160, v160
  v_exp_f32 v161, v161
  v_exp_f32 v162, v162
  v_exp_f32 v163, v163
  v_mfma_f32_32x32x16_bf16 v[104:119], v[232:235], v[168:171], v[104:119]
  s_cmp_eq_u32 s35, 0
  v_exp_f32 v164, v164
  v_exp_f32 v165, v165
  v_exp_f32 v166, v166
  v_exp_f32 v167, v167
  v_cvt_pk_bf16_f32 v172, v160, v161
  v_cvt_pk_bf16_f32 v173, v162, v163
  v_cvt_pk_bf16_f32 v174, v164, v165
  v_cvt_pk_bf16_f32 v175, v166, v167
  v_mfma_f32_32x32x16_bf16 v[152:167], v[176:179], v[32:35], 0
  s_cbranch_scc1 .g2_kernel_a_loop
  s_branch .g2_kernel_a_redo
.g2_kernel_a_last:
  ds_read_b32 v21, v13 offset:8
  v_exp_f32 v136, v136
  v_exp_f32 v137, v137
  v_exp_f32 v138, v138
  v_mfma_f32_32x32x16_bf16 v[104:119], v[220:223], v[172:175], v[104:119]
  s_andn2_b32 s33, s36, s34
  v_exp_f32 v139, v139
  v_exp_f32 v140, v140
  v_exp_f32 v141, v141
  v_smfmac_f32_16x16x64_bf16 v[132:135], v[16:19], v[168:175], v20
  s_cbranch_scc0 .g2_kernel_a_L3c
.g2_kernel_a_L3b:
  v_exp_f32 v142, v142
  v_exp_f32 v143, v143
  v_mfma_f32_32x32x16_bf16 v[152:167], v[228:231], v[36:39], v[152:167]
  s_ff1_i32_b32 s33, s33
  ds_read_b128 v[24:27], v14 offset:0
  v_cvt_pk_bf16_f32 v168, v136, v137
  v_cvt_pk_bf16_f32 v169, v138, v139
  v_cvt_pk_bf16_f32 v170, v140, v141
  v_cvt_pk_bf16_f32 v171, v142, v143
  v_exp_f32 v144, v144
  v_exp_f32 v145, v145
  v_exp_f32 v146, v146
  v_exp_f32 v147, v147
  v_mfma_f32_32x32x16_bf16 v[56:71], v[232:235], v[168:171], v[56:71]
  s_bitset1_b32 s34, s33
  ds_read_b128 v[28:31], v14 offset:1024
  v_exp_f32 v148, v148
  v_exp_f32 v149, v149
  v_exp_f32 v150, v150
  v_exp_f32 v151, v151
  v_cvt_pk_bf16_f32 v172, v144, v145
  v_cvt_pk_bf16_f32 v173, v146, v147
  v_cvt_pk_bf16_f32 v174, v148, v149
  v_cvt_pk_bf16_f32 v175, v150, v151
  v_mfma_f32_32x32x16_bf16 v[136:151], v[224:227], v[40:43], 0
  s_waitcnt lgkmcnt(2)
  s_xor_b32 s33, s33, s24
  v_exp_f32 v152, v152
  v_exp_f32 v153, v153
  v_exp_f32 v154, v154
  v_mfma_f32_32x32x16_bf16 v[56:71], v[236:239], v[172:175], v[56:71]
  v_cmp_gt_u32 vcc, s27, v21
  s_lshl_b32 s33, s33, s25
  v_exp_f32 v155, v155
  v_exp_f32 v156, v156
  v_exp_f32 v157, v157
  v_smfmac_f32_16x16x64_bf16 v[120:123], v[16:19], v[168:175], v20
  s_add_u32 s22, s20, s33
  v_exp_f32 v158, v158
  v_exp_f32 v159, v159
  v_mfma_f32_32x32x16_bf16 v[136:151], v[228:231], v[44:47], v[136:151]
  s_addc_u32 s23, s21, 0
  v_cvt_pk_bf16_f32 v168, v152, v153
  v_cvt_pk_bf16_f32 v169, v154, v155
  v_cvt_pk_bf16_f32 v170, v156, v157
  v_cvt_pk_bf16_f32 v171, v158, v159
  v_exp_f32 v160, v160
  v_exp_f32 v161, v161
  v_exp_f32 v162, v162
  v_exp_f32 v163, v163
  v_mfma_f32_32x32x16_bf16 v[72:87], v[232:235], v[168:171], v[72:87]
  s_cbranch_vccnz .g2_kernel_a_L3g
.g2_kernel_a_L3h:
  ds_read_b128 v[32:35], v14 offset:2048
  ds_read_b128 v[36:39], v14 offset:3072
  v_cvt_pk_bf16_f32 v56, v56, v57
  v_cvt_pk_bf16_f32 v57, v58, v59
  v_cvt_pk_bf16_f32 v58, v60, v61
  v_cvt_pk_bf16_f32 v59, v62, v63
  v_add_f32 v6, v120, v121
  v_exp_f32 v164, v164
  v_exp_f32 v165, v165
  v_exp_f32 v166, v166
  v_exp_f32 v167, v167
  v_cvt_pk_bf16_f32 v172, v160, v161
  v_cvt_pk_bf16_f32 v173, v162, v163
  v_cvt_pk_bf16_f32 v174, v164, v165
  v_cvt_pk_bf16_f32 v175, v166, v167
  v_mfma_f32_32x32x16_bf16 v[152:167], v[224:227], v[48:51], 0
  ds_write_b128 v9, v[56:59] offset:0
  v_cvt_pk_bf16_f32 v60, v64, v65
  v_cvt_pk_bf16_f32 v61, v66, v67
  v_cvt_pk_bf16_f32 v62, v68, v69
  v_cvt_pk_bf16_f32 v63, v70, v71
  v_exp_f32 v136, v136
  v_exp_f32 v137, v137
  v_exp_f32 v138, v138
  v_mfma_f32_32x32x16_bf16 v[72:87], v[236:239], v[172:175], v[72:87]
  ds_write_b128 v9, v[60:63] offset:1024
  v_mov_b32 v120, 0
  v_mov_b32 v121, 0
  v_exp_f32 v139, v139
  v_exp_f32 v140, v140
  v_exp_f32 v141, v141
  v_smfmac_f32_16x16x64_bf16 v[124:127], v[16:19], v[168:175], v20
  global_load_dwordx4 v[208:211], v3, s[22:23] offset:0
  global_load_dwordx4 v[212:215], v3, s[22:23] offset:1024
  global_load_dwordx4 v[216:219], v3, s[22:23] offset:2048
  global_load_dwordx4 v[220:223], v3, s[22:23] offset:3072
  ds_write_b32 v10, v6 offset:0
  ds_write_b32 v11, v12 offset:0
  v_exp_f32 v142, v142
  v_exp_f32 v143, v143
  v_mfma_f32_32x32x16_bf16 v[152:167], v[228:231], v[52:55], v[152:167]
  ds_read_b128 v[40:43], v14 offset:4096
  s_wakeup
  v_cvt_pk_bf16_f32 v168, v136, v137
  v_cvt_pk_bf16_f32 v169, v138, v139
  v_cvt_pk_bf16_f32 v170, v140, v141
  v_cvt_pk_bf16_f32 v171, v142, v143
  v_exp_f32 v144, v144
  v_exp_f32 v145, v145
  v_exp_f32 v146, v146
  v_exp_f32 v147, v147
  v_mfma_f32_32x32x16_bf16 v[88:103], v[232:235], v[168:171], v[88:103]
  s_waitcnt vmcnt(8)
  ds_read_b128 v[44:47], v14 offset:5120
  v_cvt_pk_bf16_f32 v72, v72, v73
  v_cvt_pk_bf16_f32 v73, v74, v75
  v_cvt_pk_bf16_f32 v74, v76, v77
  v_cvt_pk_bf16_f32 v75, v78, v79
  v_add_f32 v6, v124, v125
  v_exp_f32 v148, v148
  v_exp_f32 v149, v149
  v_exp_f32 v150, v150
  v_exp_f32 v151, v151
  v_cvt_pk_bf16_f32 v172, v144, v145
  v_cvt_pk_bf16_f32 v173, v146, v147
  v_cvt_pk_bf16_f32 v174, v148, v149
  v_cvt_pk_bf16_f32 v175, v150, v151
  s_waitcnt lgkmcnt(8)
  v_mfma_f32_32x32x16_bf16 v[136:151], v[176:179], v[24:27], 0
  ds_write_b128 v9, v[72:75] offset:8192
  v_cvt_pk_bf16_f32 v76, v80, v81
  v_cvt_pk_bf16_f32 v77, v82, v83
  v_cvt_pk_bf16_f32 v78, v84, v85
  v_cvt_pk_bf16_f32 v79, v86, v87
  v_exp_f32 v152, v152
  v_exp_f32 v153, v153
  v_exp_f32 v154, v154
  v_mfma_f32_32x32x16_bf16 v[88:103], v[236:239], v[172:175], v[88:103]
  ds_write_b128 v9, v[76:79] offset:9216
  v_mov_b32 v124, 0
  v_mov_b32 v125, 0
  v_exp_f32 v155, v155
  v_exp_f32 v156, v156
  v_exp_f32 v157, v157
  v_smfmac_f32_16x16x64_bf16 v[128:131], v[16:19], v[168:175], v20
  ds_write_b32 v10, v6 offset:512
  ds_write_b32 v11, v12 offset:16
  v_exp_f32 v158, v158
  v_exp_f32 v159, v159
  v_mfma_f32_32x32x16_bf16 v[136:151], v[180:183], v[28:31], v[136:151]
  ds_read_b128 v[48:51], v14 offset:6144
  s_wakeup
  v_cvt_pk_bf16_f32 v168, v152, v153
  v_cvt_pk_bf16_f32 v169, v154, v155
  v_cvt_pk_bf16_f32 v170, v156, v157
  v_cvt_pk_bf16_f32 v171, v158, v159
  v_exp_f32 v160, v160
  v_exp_f32 v161, v161
  v_exp_f32 v162, v162
  v_exp_f32 v163, v163
  v_mfma_f32_32x32x16_bf16 v[104:119], v[232:235], v[168:171], v[104:119]
  ds_read_b128 v[52:55], v14 offset:7168
  v_cvt_pk_bf16_f32 v88, v88, v89
  v_cvt_pk_bf16_f32 v89, v90, v91
  v_cvt_pk_bf16_f32 v90, v92, v93
  v_cvt_pk_bf16_f32 v91, v94, v95
  v_add_f32 v6, v128, v129
  ds_write_b128 v9, v[88:91] offset:16384
  v_cvt_pk_bf16_f32 v92, v96, v97
  v_cvt_pk_bf16_f32 v93, v98, v99
  v_cvt_pk_bf16_f32 v94, v100, v101
  v_cvt_pk_bf16_f32 v95, v102, v103
  ds_write_b128 v9, v[92:95] offset:17408
  v_mov_b32 v128, 0
  v_mov_b32 v129, 0
  ds_write_b32 v10, v6 offset:1024
  ds_write_b32 v11, v12 offset:32
  s_add_u32 s32, s32, 1
  v_exp_f32 v164, v164
  v_exp_f32 v165, v165
  v_exp_f32 v166, v166
  v_exp_f32 v167, v167
  v_cvt_pk_bf16_f32 v172, v160, v161
  v_cvt_pk_bf16_f32 v173, v162, v163
  v_cvt_pk_bf16_f32 v174, v164, v165
  v_cvt_pk_bf16_f32 v175, v166, v167
  s_cmp_eq_u32 s32, 8
  s_cbranch_scc1 .g2_kernel_a_end
  s_waitcnt lgkmcnt(15)
  v_mfma_f32_32x32x16_bf16 v[152:167], v[176:179], v[32:35], 0
  s_andn2_b32 s33, s36, s34
  v_exp_f32 v136, v136
  v_exp_f32 v137, v137
  v_exp_f32 v138, v138
  v_mfma_f32_32x32x16_bf16 v[104:119], v[236:239], v[172:175], v[104:119]
  s_cbranch_scc0 .g2_kernel_a_G0c
.g2_kernel_a_G0b:
  v_exp_f32 v139, v139
  v_exp_f32 v140, v140
  v_exp_f32 v141, v141
  v_smfmac_f32_16x16x64_bf16 v[132:135], v[16:19], v[168:175], v20
  s_ff1_i32_b32 s33, s33
  v_exp_f32 v142, v142
  v_exp_f32 v143, v143
  v_mfma_f32_32x32x16_bf16 v[152:167], v[180:183], v[36:39], v[152:167]
  s_bitset1_b32 s34, s33
  v_cvt_pk_bf16_f32 v168, v136, v137
  v_cvt_pk_bf16_f32 v169, v138, v139
  v_cvt_pk_bf16_f32 v170, v140, v141
  v_cvt_pk_bf16_f32 v171, v142, v143
  v_exp_f32 v144, v144
  v_exp_f32 v145, v145
  v_exp_f32 v146, v146
  v_exp_f32 v147, v147
  s_waitcnt lgkmcnt(14)
  v_mfma_f32_32x32x16_bf16 v[56:71], v[184:187], v[168:171], 0
  s_xor_b32 s33, s33, s24
  v_cvt_pk_bf16_f32 v104, v104, v105
  v_cvt_pk_bf16_f32 v105, v106, v107
  v_cvt_pk_bf16_f32 v106, v108, v109
  v_cvt_pk_bf16_f32 v107, v110, v111
  v_add_f32 v6, v132, v133
  v_exp_f32 v148, v148
  v_exp_f32 v149, v149
  v_exp_f32 v150, v150
  v_exp_f32 v151, v151
  v_cvt_pk_bf16_f32 v172, v144, v145
  v_cvt_pk_bf16_f32 v173, v146, v147
  v_cvt_pk_bf16_f32 v174, v148, v149
  v_cvt_pk_bf16_f32 v175, v150, v151
  s_waitcnt lgkmcnt(10)
  v_mfma_f32_32x32x16_bf16 v[136:151], v[176:179], v[40:43], 0
  s_lshl_b32 s33, s33, s25
  ds_write_b128 v9, v[104:107] offset:24576
  v_cvt_pk_bf16_f32 v108, v112, v113
  v_cvt_pk_bf16_f32 v109, v114, v115
  v_cvt_pk_bf16_f32 v110, v116, v117
  v_cvt_pk_bf16_f32 v111, v118, v119
  v_exp_f32 v152, v152
  v_exp_f32 v153, v153
  v_exp_f32 v154, v154
  v_mfma_f32_32x32x16_bf16 v[56:71], v[188:191], v[172:175], v[56:71]
  s_add_u32 s22, s20, s33
  ds_write_b128 v9, v[108:111] offset:25600
  v_mov_b32 v132, 0
  v_mov_b32 v133, 0
  v_exp_f32 v155, v155
  v_exp_f32 v156, v156
  v_exp_f32 v157, v157
  v_smfmac_f32_16x16x64_bf16 v[120:123], v[16:19], v[168:175], v20
  s_addc_u32 s23, s21, 0
  ds_write_b32 v10, v6 offset:1536
  v_exp_f32 v158, v158
  v_exp_f32 v159, v159
  v_mfma_f32_32x32x16_bf16 v[136:151], v[180:183], v[44:47], v[136:151]
  v_cvt_pk_bf16_f32 v168, v152, v153
  v_cvt_pk_bf16_f32 v169, v154, v155
  v_cvt_pk_bf16_f32 v170, v156, v157
  v_cvt_pk_bf16_f32 v171, v158, v159
  v_exp_f32 v160, v160
  v_exp_f32 v161, v161
  v_exp_f32 v162, v162
  v_exp_f32 v163, v163
  s_waitcnt lgkmcnt(11)
  v_mfma_f32_32x32x16_bf16 v[72:87], v[184:187], v[168:171], 0
  ds_write_b32 v11, v12 offset:48
  v_exp_f32 v164, v164
  v_exp_f32 v165, v165
  v_exp_f32 v166, v166
  v_exp_f32 v167, v167
  v_cvt_pk_bf16_f32 v172, v160, v161
  v_cvt_pk_bf16_f32 v173, v162, v163
  v_cvt_pk_bf16_f32 v174, v164, v165
  v_cvt_pk_bf16_f32 v175, v166, v167
  s_waitcnt lgkmcnt(8)
  v_mfma_f32_32x32x16_bf16 v[152:167], v[176:179], v[48:51], 0
  v_add_u32 v12, 1, v12
  v_exp_f32 v136, v136
  v_exp_f32 v137, v137
  v_exp_f32 v138, v138
  v_mfma_f32_32x32x16_bf16 v[72:87], v[188:191], v[172:175], v[72:87]
  v_exp_f32 v139, v139
  v_exp_f32 v140, v140
  v_exp_f32 v141, v141
  v_smfmac_f32_16x16x64_bf16 v[124:127], v[16:19], v[168:175], v20
  global_load_dwordx4 v[224:227], v3, s[22:23] offset:0
  global_load_dwordx4 v[228:231], v3, s[22:23] offset:1024
  global_load_dwordx4 v[232:235], v3, s[22:23] offset:2048
  global_load_dwordx4 v[236:239], v3, s[22:23] offset:3072
  s_add_u32 s27, s27, 4
  v_exp_f32 v142, v142
  v_exp_f32 v143, v143
  v_mfma_f32_32x32x16_bf16 v[152:167], v[180:183], v[52:55], v[152:167]
  v_cvt_pk_bf16_f32 v168, v136, v137
  v_cvt_pk_bf16_f32 v169, v138, v139
  v_cvt_pk_bf16_f32 v170, v140, v141
  v_cvt_pk_bf16_f32 v171, v142, v143
  v_exp_f32 v144, v144
  v_exp_f32 v145, v145
  v_exp_f32 v146, v146
  v_exp_f32 v147, v147
  s_waitcnt lgkmcnt(6)
  v_mfma_f32_32x32x16_bf16 v[88:103], v[184:187], v[168:171], 0
  s_waitcnt vmcnt(8)
  v_exp_f32 v148, v148
  v_exp_f32 v149, v149
  v_exp_f32 v150, v150
  v_exp_f32 v151, v151
  v_cvt_pk_bf16_f32 v172, v144, v145
  v_cvt_pk_bf16_f32 v173, v146, v147
  v_cvt_pk_bf16_f32 v174, v148, v149
  v_cvt_pk_bf16_f32 v175, v150, v151
  v_mfma_f32_32x32x16_bf16 v[136:151], v[192:195], v[24:27], 0
  v_exp_f32 v152, v152
  v_exp_f32 v153, v153
  v_exp_f32 v154, v154
  v_mfma_f32_32x32x16_bf16 v[88:103], v[188:191], v[172:175], v[88:103]
  v_exp_f32 v155, v155
  v_exp_f32 v156, v156
  v_exp_f32 v157, v157
  v_smfmac_f32_16x16x64_bf16 v[128:131], v[16:19], v[168:175], v20
  v_exp_f32 v158, v158
  v_exp_f32 v159, v159
  v_mfma_f32_32x32x16_bf16 v[136:151], v[196:199], v[28:31], v[136:151]
  v_cvt_pk_bf16_f32 v168, v152, v153
  v_cvt_pk_bf16_f32 v169, v154, v155
  v_cvt_pk_bf16_f32 v170, v156, v157
  v_cvt_pk_bf16_f32 v171, v158, v159
  v_exp_f32 v160, v160
  v_exp_f32 v161, v161
  v_exp_f32 v162, v162
  v_exp_f32 v163, v163
  s_waitcnt lgkmcnt(2)
  v_mfma_f32_32x32x16_bf16 v[104:119], v[184:187], v[168:171], 0
  v_exp_f32 v164, v164
  v_exp_f32 v165, v165
  v_exp_f32 v166, v166
  v_exp_f32 v167, v167
  v_cvt_pk_bf16_f32 v172, v160, v161
  v_cvt_pk_bf16_f32 v173, v162, v163
  v_cvt_pk_bf16_f32 v174, v164, v165
  v_cvt_pk_bf16_f32 v175, v166, v167
  s_branch .g2_kernel_a_n1
.g2_kernel_a_end:
  v_mfma_f32_32x32x16_bf16 v[104:119], v[236:239], v[172:175], v[104:119]
  v_smfmac_f32_16x16x64_bf16 v[132:135], v[16:19], v[168:175], v20
  s_wakeup
  s_nop 9
  v_cvt_pk_bf16_f32 v104, v104, v105
  v_cvt_pk_bf16_f32 v105, v106, v107
  v_cvt_pk_bf16_f32 v106, v108, v109
  v_cvt_pk_bf16_f32 v107, v110, v111
  v_add_f32 v6, v132, v133
  ds_write_b128 v9, v[104:107] offset:24576
  v_cvt_pk_bf16_f32 v108, v112, v113
  v_cvt_pk_bf16_f32 v109, v114, v115
  v_cvt_pk_bf16_f32 v110, v116, v117
  v_cvt_pk_bf16_f32 v111, v118, v119
  ds_write_b128 v9, v[108:111] offset:25600
  v_mov_b32 v132, 0
  v_mov_b32 v133, 0
  ds_write_b32 v10, v6 offset:1536
  ds_write_b32 v11, v12 offset:48
  s_waitcnt lgkmcnt(4)
  v_mov_b32 v20, s71
  v_lshrrev_b32 v17, 5, v2
  v_and_b32 v18, 31, v2
  s_lshl_b32 s28, s16, 5
  v_add_u32 v19, s28, v18
  v_lshlrev_b32 v7, 2, v19
  v_add_u32 v7, 155648, v7
  ds_read_b32 v8, v7 offset:3840
  ds_read_b32 v9, v7 offset:4352
  ds_read_b32 v16, v20 offset:24
  ds_read_b32 v6, v20 offset:52
  v_add_u32 v19, 1, v19
  v_bfe_u32 v7, v2, 2, 2
  v_lshl_add_u32 v14, v17, 2, v7
  v_lshlrev_b32 v14, 7, v14
  v_lshrrev_b32 v7, 1, v7
  v_lshl_add_u32 v14, v7, 6, v14
  v_bfe_u32 v7, v2, 4, 1
  v_lshl_add_u32 v14, v7, 5, v14
  v_and_b32 v7, 1, v2
  v_lshl_add_u32 v14, v7, 4, v14
  v_bfe_u32 v7, v2, 1, 1
  v_lshl_add_u32 v14, v7, 3, v14
  v_xor_b32 v15, 64, v14
  v_and_b32 v7, 7, v2
  v_xor_b32 v7, s24, v7
  s_mov_b32 s28, 192
  s_add_u32 s28, s28, 157952
  v_lshl_add_u32 v21, v7, 3, s28
  v_lshlrev_b32 v24, 16, v240
  v_and_b32 v25, 0xffff0000, v240
  v_lshlrev_b32 v26, 16, v241
  v_and_b32 v27, 0xffff0000, v241
  v_lshlrev_b32 v28, 16, v242
  v_and_b32 v29, 0xffff0000, v242
  v_lshlrev_b32 v30, 16, v243
  v_and_b32 v31, 0xffff0000, v243
  v_lshlrev_b32 v32, 16, v244
  v_and_b32 v33, 0xffff0000, v244
  v_lshlrev_b32 v34, 16, v245
  v_and_b32 v35, 0xffff0000, v245
  v_lshlrev_b32 v36, 16, v246
  v_and_b32 v37, 0xffff0000, v246
  v_lshlrev_b32 v38, 16, v247
  v_and_b32 v39, 0xffff0000, v247
  v_lshlrev_b32 v40, 16, v248
  v_and_b32 v41, 0xffff0000, v248
  v_lshlrev_b32 v42, 16, v249
  v_and_b32 v43, 0xffff0000, v249
  v_lshlrev_b32 v44, 16, v250
  v_and_b32 v45, 0xffff0000, v250
  v_lshlrev_b32 v46, 16, v251
  v_and_b32 v47, 0xffff0000, v251
  v_lshlrev_b32 v48, 16, v252
  v_and_b32 v49, 0xffff0000, v252
  v_lshlrev_b32 v50, 16, v253
  v_and_b32 v51, 0xffff0000, v253
  v_lshlrev_b32 v52, 16, v254
  v_and_b32 v53, 0xffff0000, v254
  v_lshlrev_b32 v54, 16, v255
  v_and_b32 v55, 0xffff0000, v255
  s_waitcnt lgkmcnt(0)
  v_cmp_gt_u32 vcc, 4, v6
  s_cbranch_vccnz .g2_kernel_w_aw
.g2_kernel_w_ab:
  s_xor_b32 s28, s24, 0
  s_lshl_b32 s28, s28, 13
  s_add_u32 s28, s28, 65536
  v_add_u32 v10, s28, v14
  v_add_u32 v11, s28, v15
  ds_read_b64_tr_b16 v[104:105], v10 offset:0
  ds_read_b64_tr_b16 v[106:107], v10 offset:1024
  ds_read_b64_tr_b16 v[108:109], v11 offset:0
  ds_read_b64_tr_b16 v[110:111], v11 offset:1024
  ds_read_b64_tr_b16 v[112:113], v10 offset:2048
  ds_read_b64_tr_b16 v[114:115], v10 offset:3072
  ds_read_b64_tr_b16 v[116:117], v11 offset:2048
  ds_read_b64_tr_b16 v[118:119], v11 offset:3072
  ds_read_b64_tr_b16 v[120:121], v10 offset:4096
  ds_read_b64_tr_b16 v[122:123], v10 offset:5120
  ds_read_b64_tr_b16 v[124:125], v11 offset:4096
  ds_read_b64_tr_b16 v[126:127], v11 offset:5120
  s_andn2_b32 s33, s36, s34
  s_ff1_i32_b32 s33, s33
  s_bitset1_b32 s34, s33
  s_xor_b32 s33, s33, s24
  s_lshl_b32 s33, s33, 12
  s_add_u32 s22, s20, s33
  s_addc_u32 s23, s21, 0
  global_load_dwordx4 v[224:227], v3, s[22:23] offset:0
  global_load_dwordx4 v[228:231], v3, s[22:23] offset:1024
  global_load_dwordx4 v[232:235], v3, s[22:23] offset:2048
  global_load_dwordx4 v[236:239], v3, s[22:23] offset:3072
  v_pk_fma_f32 v[24:25], v[24:25], v[8:9], v[8:9] op_sel:[0,0,1] op_sel_hi:[1,0,1]
  v_pk_fma_f32 v[26:27], v[26:27], v[8:9], v[8:9] op_sel:[0,0,1] op_sel_hi:[1,0,1]
  v_pk_fma_f32 v[28:29], v[28:29], v[8:9], v[8:9] op_sel:[0,0,1] op_sel_hi:[1,0,1]
  v_pk_fma_f32 v[30:31], v[30:31], v[8:9], v[8:9] op_sel:[0,0,1] op_sel_hi:[1,0,1]
  v_pk_fma_f32 v[32:33], v[32:33], v[8:9], v[8:9] op_sel:[0,0,1] op_sel_hi:[1,0,1]
  v_pk_fma_f32 v[34:35], v[34:35], v[8:9], v[8:9] op_sel:[0,0,1] op_sel_hi:[1,0,1]
  v_pk_fma_f32 v[36:37], v[36:37], v[8:9], v[8:9] op_sel:[0,0,1] op_sel_hi:[1,0,1]
  v_pk_fma_f32 v[38:39], v[38:39], v[8:9], v[8:9] op_sel:[0,0,1] op_sel_hi:[1,0,1]
  v_pk_fma_f32 v[40:41], v[40:41], v[8:9], v[8:9] op_sel:[0,0,1] op_sel_hi:[1,0,1]
  v_pk_fma_f32 v[42:43], v[42:43], v[8:9], v[8:9] op_sel:[0,0,1] op_sel_hi:[1,0,1]
  v_pk_fma_f32 v[44:45], v[44:45], v[8:9], v[8:9] op_sel:[0,0,1] op_sel_hi:[1,0,1]
  v_pk_fma_f32 v[46:47], v[46:47], v[8:9], v[8:9] op_sel:[0,0,1] op_sel_hi:[1,0,1]
  v_pk_fma_f32 v[48:49], v[48:49], v[8:9], v[8:9] op_sel:[0,0,1] op_sel_hi:[1,0,1]
  v_pk_fma_f32 v[50:51], v[50:51], v[8:9], v[8:9] op_sel:[0,0,1] op_sel_hi:[1,0,1]
  v_pk_fma_f32 v[52:53], v[52:53], v[8:9], v[8:9] op_sel:[0,0,1] op_sel_hi:[1,0,1]
  v_pk_fma_f32 v[54:55], v[54:55], v[8:9], v[8:9] op_sel:[0,0,1] op_sel_hi:[1,0,1]
  v_cmp_eq_u32 vcc, v16, v19
  s_cbranch_vccnz .g2_kernel_w_pt
.g2_kernel_w_pb:
  s_mov_b32 s72, s48
  s_mov_b32 s73, s49
  s_mov_b32 s74, 0x800
  s_mov_b32 s75, 0x00020000
  s_waitcnt vmcnt(15) lgkmcnt(8)
  v_mfma_f32_32x32x16_bf16 v[24:39], v[104:107], v[176:179], v[24:39]
  s_xor_b32 s28, s24, 1
  s_lshl_b32 s28, s28, 13
  s_add_u32 s28, s28, 65536
  ds_read_b64_tr_b16 v[128:129], v10 offset:6144
  ds_read_b64_tr_b16 v[130:131], v10 offset:7168
  v_mfma_f32_32x32x16_bf16 v[40:55], v[108:111], v[176:179], v[40:55]
  v_add_u32 v12, s28, v14
  v_add_u32 v13, s28, v15
  s_andn2_b32 s33, s36, s34
  ds_read_b64_tr_b16 v[132:133], v11 offset:6144
  ds_read_b64_tr_b16 v[134:135], v11 offset:7168
  s_waitcnt vmcnt(14) lgkmcnt(8)
  v_mfma_f32_32x32x16_bf16 v[24:39], v[112:115], v[180:183], v[24:39]
  s_ff1_i32_b32 s33, s33
  s_bitset1_b32 s34, s33
  s_xor_b32 s33, s33, s24
  ds_read_b64_tr_b16 v[104:105], v12 offset:0
  ds_read_b64_tr_b16 v[106:107], v12 offset:1024
  v_mfma_f32_32x32x16_bf16 v[40:55], v[116:119], v[180:183], v[40:55]
  s_lshl_b32 s33, s33, 12
  s_add_u32 s22, s20, s33
  s_addc_u32 s23, s21, 0
  ds_read_b64_tr_b16 v[108:109], v13 offset:0
  ds_read_b64_tr_b16 v[110:111], v13 offset:1024
  s_waitcnt vmcnt(13) lgkmcnt(8)
  v_mfma_f32_32x32x16_bf16 v[24:39], v[120:123], v[184:187], v[24:39]
  global_load_dwordx4 v[136:139], v3, s[22:23] offset:0
  global_load_dwordx4 v[140:143], v3, s[22:23] offset:1024
  global_load_dwordx4 v[144:147], v3, s[22:23] offset:2048
  ds_read_b64_tr_b16 v[112:113], v12 offset:2048
  ds_read_b64_tr_b16 v[114:115], v12 offset:3072
  v_mfma_f32_32x32x16_bf16 v[40:55], v[124:127], v[184:187], v[40:55]
  global_load_dwordx4 v[148:151], v3, s[22:23] offset:3072
  ds_read_b64_tr_b16 v[116:117], v13 offset:2048
  ds_read_b64_tr_b16 v[118:119], v13 offset:3072
  s_waitcnt vmcnt(16) lgkmcnt(8)
  v_mfma_f32_32x32x16_bf16 v[24:39], v[128:131], v[188:191], v[24:39]
  ds_read_b64_tr_b16 v[120:121], v12 offset:4096
  ds_read_b64_tr_b16 v[122:123], v12 offset:5120
  v_mfma_f32_32x32x16_bf16 v[40:55], v[132:135], v[188:191], v[40:55]
  ds_read_b64_tr_b16 v[124:125], v13 offset:4096
  ds_read_b64_tr_b16 v[126:127], v13 offset:5120
  s_waitcnt vmcnt(15) lgkmcnt(8)
  v_mfma_f32_32x32x16_bf16 v[24:39], v[104:107], v[192:195], v[24:39]
  s_xor_b32 s28, s24, 2
  s_lshl_b32 s28, s28, 13
  s_add_u32 s28, s28, 65536
  ds_read_b64_tr_b16 v[128:129], v12 offset:6144
  ds_read_b64_tr_b16 v[130:131], v12 offset:7168
  v_mfma_f32_32x32x16_bf16 v[40:55], v[108:111], v[192:195], v[40:55]
  v_add_u32 v10, s28, v14
  v_add_u32 v11, s28, v15
  s_andn2_b32 s33, s36, s34
  ds_read_b64_tr_b16 v[132:133], v13 offset:6144
  ds_read_b64_tr_b16 v[134:135], v13 offset:7168
  s_waitcnt vmcnt(14) lgkmcnt(8)
  v_mfma_f32_32x32x16_bf16 v[24:39], v[112:115], v[196:199], v[24:39]
  s_ff1_i32_b32 s33, s33
  s_bitset1_b32 s34, s33
  s_xor_b32 s33, s33, s24
  ds_read_b64_tr_b16 v[104:105], v10 offset:0
  ds_read_b64_tr_b16 v[106:107], v10 offset:1024
  v_mfma_f32_32x32x16_bf16 v[40:55], v[116:119], v[196:199], v[40:55]
  s_lshl_b32 s33, s33, 12
  s_add_u32 s22, s20, s33
  s_addc_u32 s23, s21, 0
  ds_read_b64_tr_b16 v[108:109], v11 offset:0
  ds_read_b64_tr_b16 v[110:111], v11 offset:1024
  s_waitcnt vmcnt(13) lgkmcnt(8)
  v_mfma_f32_32x32x16_bf16 v[24:39], v[120:123], v[200:203], v[24:39]
  global_load_dwordx4 v[152:155], v3, s[22:23] offset:0
  global_load_dwordx4 v[156:159], v3, s[22:23] offset:1024
  global_load_dwordx4 v[160:163], v3, s[22:23] offset:2048
  ds_read_b64_tr_b16 v[112:113], v10 offset:2048
  ds_read_b64_tr_b16 v[114:115], v10 offset:3072
  v_mfma_f32_32x32x16_bf16 v[40:55], v[124:127], v[200:203], v[40:55]
  global_load_dwordx4 v[164:167], v3, s[22:23] offset:3072
  ds_read_b64_tr_b16 v[116:117], v11 offset:2048
  ds_read_b64_tr_b16 v[118:119], v11 offset:3072
  s_waitcnt vmcnt(16) lgkmcnt(8)
  v_mfma_f32_32x32x16_bf16 v[24:39], v[128:131], v[204:207], v[24:39]
  ds_read_b64_tr_b16 v[120:121], v10 offset:4096
  ds_read_b64_tr_b16 v[122:123], v10 offset:5120
  v_mfma_f32_32x32x16_bf16 v[40:55], v[132:135], v[204:207], v[40:55]
  ds_read_b64_tr_b16 v[124:125], v11 offset:4096
  ds_read_b64_tr_b16 v[126:127], v11 offset:5120
  s_waitcnt vmcnt(15) lgkmcnt(8)
  v_mfma_f32_32x32x16_bf16 v[24:39], v[104:107], v[208:211], v[24:39]
  s_xor_b32 s28, s24, 3
  s_lshl_b32 s28, s28, 13
  s_add_u32 s28, s28, 65536
  ds_read_b64_tr_b16 v[128:129], v10 offset:6144
  ds_read_b64_tr_b16 v[130:131], v10 offset:7168
  v_mfma_f32_32x32x16_bf16 v[40:55], v[108:111], v[208:211], v[40:55]
  v_add_u32 v12, s28, v14
  v_add_u32 v13, s28, v15
  s_andn2_b32 s33, s36, s34
  ds_read_b64_tr_b16 v[132:133], v11 offset:6144
  ds_read_b64_tr_b16 v[134:135], v11 offset:7168
  s_waitcnt vmcnt(14) lgkmcnt(8)
  v_mfma_f32_32x32x16_bf16 v[24:39], v[112:115], v[212:215], v[24:39]
  s_ff1_i32_b32 s33, s33
  s_bitset1_b32 s34, s33
  s_xor_b32 s33, s33, s24
  ds_read_b64_tr_b16 v[104:105], v12 offset:0
  ds_read_b64_tr_b16 v[106:107], v12 offset:1024
  v_mfma_f32_32x32x16_bf16 v[40:55], v[116:119], v[212:215], v[40:55]
  s_lshl_b32 s33, s33, 12
  s_add_u32 s22, s20, s33
  s_addc_u32 s23, s21, 0
  ds_read_b64_tr_b16 v[108:109], v13 offset:0
  ds_read_b64_tr_b16 v[110:111], v13 offset:1024
  s_waitcnt vmcnt(13) lgkmcnt(8)
  v_mfma_f32_32x32x16_bf16 v[24:39], v[120:123], v[216:219], v[24:39]
  global_load_dwordx4 v[56:59], v3, s[22:23] offset:0
  global_load_dwordx4 v[60:63], v3, s[22:23] offset:1024
  global_load_dwordx4 v[64:67], v3, s[22:23] offset:2048
  ds_read_b64_tr_b16 v[112:113], v12 offset:2048
  ds_read_b64_tr_b16 v[114:115], v12 offset:3072
  v_mfma_f32_32x32x16_bf16 v[40:55], v[124:127], v[216:219], v[40:55]
  global_load_dwordx4 v[68:71], v3, s[22:23] offset:3072
  ds_read_b64_tr_b16 v[116:117], v13 offset:2048
  ds_read_b64_tr_b16 v[118:119], v13 offset:3072
  s_waitcnt vmcnt(16) lgkmcnt(8)
  v_mfma_f32_32x32x16_bf16 v[24:39], v[128:131], v[220:223], v[24:39]
  ds_read_b64_tr_b16 v[120:121], v12 offset:4096
  ds_read_b64_tr_b16 v[122:123], v12 offset:5120
  v_mfma_f32_32x32x16_bf16 v[40:55], v[132:135], v[220:223], v[40:55]
  ds_read_b64_tr_b16 v[124:125], v13 offset:4096
  ds_read_b64_tr_b16 v[126:127], v13 offset:5120
  s_waitcnt vmcnt(15) lgkmcnt(8)
  v_mfma_f32_32x32x16_bf16 v[24:39], v[104:107], v[224:227], v[24:39]
  s_xor_b32 s28, s24, 4
  s_lshl_b32 s28, s28, 13
  s_add_u32 s28, s28, 65536
  ds_read_b64_tr_b16 v[128:129], v12 offset:6144
  ds_read_b64_tr_b16 v[130:131], v12 offset:7168
  v_mfma_f32_32x32x16_bf16 v[40:55], v[108:111], v[224:227], v[40:55]
  v_add_u32 v10, s28, v14
  v_add_u32 v11, s28, v15
  s_andn2_b32 s33, s36, s34
  ds_read_b64_tr_b16 v[132:133], v13 offset:6144
  ds_read_b64_tr_b16 v[134:135], v13 offset:7168
  s_waitcnt vmcnt(14) lgkmcnt(8)
  v_mfma_f32_32x32x16_bf16 v[24:39], v[112:115], v[228:231], v[24:39]
  s_ff1_i32_b32 s33, s33
  s_bitset1_b32 s34, s33
  s_xor_b32 s33, s33, s24
  ds_read_b64_tr_b16 v[104:105], v10 offset:0
  ds_read_b64_tr_b16 v[106:107], v10 offset:1024
  v_mfma_f32_32x32x16_bf16 v[40:55], v[116:119], v[228:231], v[40:55]
  s_lshl_b32 s33, s33, 12
  s_add_u32 s22, s20, s33
  s_addc_u32 s23, s21, 0
  ds_read_b64_tr_b16 v[108:109], v11 offset:0
  ds_read_b64_tr_b16 v[110:111], v11 offset:1024
  s_waitcnt vmcnt(13) lgkmcnt(8)
  v_mfma_f32_32x32x16_bf16 v[24:39], v[120:123], v[232:235], v[24:39]
  global_load_dwordx4 v[72:75], v3, s[22:23] offset:0
  global_load_dwordx4 v[76:79], v3, s[22:23] offset:1024
  global_load_dwordx4 v[80:83], v3, s[22:23] offset:2048
  ds_read_b64_tr_b16 v[112:113], v10 offset:2048
  ds_read_b64_tr_b16 v[114:115], v10 offset:3072
  v_mfma_f32_32x32x16_bf16 v[40:55], v[124:127], v[232:235], v[40:55]
  global_load_dwordx4 v[84:87], v3, s[22:23] offset:3072
  ds_read_b64_tr_b16 v[116:117], v11 offset:2048
  ds_read_b64_tr_b16 v[118:119], v11 offset:3072
  s_waitcnt vmcnt(16) lgkmcnt(8)
  v_mfma_f32_32x32x16_bf16 v[24:39], v[128:131], v[236:239], v[24:39]
  ds_read_b64_tr_b16 v[120:121], v10 offset:4096
  ds_read_b64_tr_b16 v[122:123], v10 offset:5120
  v_mfma_f32_32x32x16_bf16 v[40:55], v[132:135], v[236:239], v[40:55]
  ds_read_b64_tr_b16 v[124:125], v11 offset:4096
  ds_read_b64_tr_b16 v[126:127], v11 offset:5120
  s_waitcnt vmcnt(15) lgkmcnt(8)
  v_mfma_f32_32x32x16_bf16 v[24:39], v[104:107], v[136:139], v[24:39]
  s_xor_b32 s28, s24, 5
  s_lshl_b32 s28, s28, 13
  s_add_u32 s28, s28, 65536
  v_add_u32 v12, s28, v14
  ds_read_b64_tr_b16 v[128:129], v10 offset:6144
  ds_read_b64_tr_b16 v[130:131], v10 offset:7168
  v_mfma_f32_32x32x16_bf16 v[40:55], v[108:111], v[136:139], v[40:55]
  v_add_u32 v13, s28, v15
  s_andn2_b32 s33, s36, s34
  s_cbranch_scc0 .g2_kernel_w_i8c
.g2_kernel_w_i8b:
  s_ff1_i32_b32 s33, s33
  ds_read_b64_tr_b16 v[132:133], v11 offset:6144
  ds_read_b64_tr_b16 v[134:135], v11 offset:7168
  s_waitcnt vmcnt(14) lgkmcnt(8)
  v_mfma_f32_32x32x16_bf16 v[24:39], v[112:115], v[140:143], v[24:39]
  s_bitset1_b32 s34, s33
  s_xor_b32 s33, s33, s24
  s_and_b32 s8, s33, 7
  s_cmp_lt_u32 s8, 2
  ds_read_b64_tr_b16 v[104:105], v12 offset:0
  ds_read_b64_tr_b16 v[106:107], v12 offset:1024
  v_mfma_f32_32x32x16_bf16 v[40:55], v[116:119], v[140:143], v[40:55]
  s_cselect_b32 s28, 139264, 0
  s_lshl_b32 s8, s8, 13
  s_add_u32 s8, s8, s28
  s_lshl_b32 s33, s33, 12
  ds_read_b64_tr_b16 v[108:109], v13 offset:0
  ds_read_b64_tr_b16 v[110:111], v13 offset:1024
  s_waitcnt vmcnt(13) lgkmcnt(8)
  v_mfma_f32_32x32x16_bf16 v[24:39], v[120:123], v[144:147], v[24:39]
  s_add_u32 s22, s20, s33
  s_addc_u32 s23, s21, 0
  global_load_dwordx4 v[88:91], v3, s[22:23] offset:0
  global_load_dwordx4 v[92:95], v3, s[22:23] offset:1024
  ds_read_b64_tr_b16 v[112:113], v12 offset:2048
  ds_read_b64_tr_b16 v[114:115], v12 offset:3072
  v_mfma_f32_32x32x16_bf16 v[40:55], v[124:127], v[144:147], v[40:55]
  global_load_dwordx4 v[96:99], v3, s[22:23] offset:2048
  global_load_dwordx4 v[100:103], v3, s[22:23] offset:3072
  ds_read_b64_tr_b16 v[116:117], v13 offset:2048
  ds_read_b64_tr_b16 v[118:119], v13 offset:3072
  s_waitcnt vmcnt(16) lgkmcnt(8)
  v_mfma_f32_32x32x16_bf16 v[24:39], v[128:131], v[148:151], v[24:39]
  ds_read_b64_tr_b16 v[120:121], v12 offset:4096
  ds_read_b64_tr_b16 v[122:123], v12 offset:5120
  v_mfma_f32_32x32x16_bf16 v[40:55], v[132:135], v[148:151], v[40:55]
  ds_read_b64_tr_b16 v[124:125], v13 offset:4096
  ds_read_b64_tr_b16 v[126:127], v13 offset:5120
  s_waitcnt vmcnt(15) lgkmcnt(8)
  v_mfma_f32_32x32x16_bf16 v[24:39], v[104:107], v[152:155], v[24:39]
  s_xor_b32 s28, s24, 6
  s_lshl_b32 s28, s28, 13
  s_add_u32 s28, s28, 65536
  v_add_u32 v10, s28, v14
  v_add_u32 v11, s28, v15
  ds_read_b64_tr_b16 v[128:129], v12 offset:6144
  ds_read_b64_tr_b16 v[130:131], v12 offset:7168
  v_mfma_f32_32x32x16_bf16 v[40:55], v[108:111], v[152:155], v[40:55]
  s_andn2_b32 s33, s36, s34
  s_cbranch_scc0 .g2_kernel_w_i9c
.g2_kernel_w_i9b:
  s_ff1_i32_b32 s33, s33
  s_bitset1_b32 s34, s33
  s_xor_b32 s33, s33, s24
  ds_read_b64_tr_b16 v[132:133], v13 offset:6144
  ds_read_b64_tr_b16 v[134:135], v13 offset:7168
  s_waitcnt vmcnt(14) lgkmcnt(8)
  v_mfma_f32_32x32x16_bf16 v[24:39], v[112:115], v[156:159], v[24:39]
  s_and_b32 s9, s33, 7
  s_cmp_lt_u32 s9, 2
  s_cselect_b32 s28, 139264, 0
  s_lshl_b32 s9, s9, 13
  s_add_u32 s9, s9, s28
  ds_read_b64_tr_b16 v[104:105], v10 offset:0
  ds_read_b64_tr_b16 v[106:107], v10 offset:1024
  v_mfma_f32_32x32x16_bf16 v[40:55], v[116:119], v[156:159], v[40:55]
  s_lshl_b32 s33, s33, 12
  s_add_u32 s22, s20, s33
  s_addc_u32 s23, s21, 0
  global_load_dwordx4 v[176:179], v3, s[22:23] offset:0
  global_load_dwordx4 v[180:183], v3, s[22:23] offset:1024
  ds_read_b64_tr_b16 v[108:109], v11 offset:0
  ds_read_b64_tr_b16 v[110:111], v11 offset:1024
  s_waitcnt vmcnt(15) lgkmcnt(8)
  v_mfma_f32_32x32x16_bf16 v[24:39], v[120:123], v[160:163], v[24:39]
  global_load_dwordx4 v[184:187], v3, s[22:23] offset:2048
  global_load_dwordx4 v[188:191], v3, s[22:23] offset:3072
  v_lshlrev_b32 v16, 4, v17
  s_lshl_b32 s29, s18, 7
  buffer_load_dwordx4 v[240:243], v16, s[72:75], s29 offen offset:0
  ds_read_b64_tr_b16 v[112:113], v10 offset:2048
  ds_read_b64_tr_b16 v[114:115], v10 offset:3072
  v_mfma_f32_32x32x16_bf16 v[40:55], v[124:127], v[160:163], v[40:55]
  buffer_load_dwordx4 v[244:247], v16, s[72:75], s29 offen offset:32
  buffer_load_dwordx4 v[248:251], v16, s[72:75], s29 offen offset:64
  buffer_load_dwordx4 v[252:255], v16, s[72:75], s29 offen offset:96
  ds_read_b64_tr_b16 v[116:117], v11 offset:2048
  ds_read_b64_tr_b16 v[118:119], v11 offset:3072
  s_waitcnt vmcnt(20) lgkmcnt(8)
  v_mfma_f32_32x32x16_bf16 v[24:39], v[128:131], v[164:167], v[24:39]
  ds_read_b64_tr_b16 v[120:121], v10 offset:4096
  ds_read_b64_tr_b16 v[122:123], v10 offset:5120
  v_mfma_f32_32x32x16_bf16 v[40:55], v[132:135], v[164:167], v[40:55]
  ds_read_b64_tr_b16 v[124:125], v11 offset:4096
  ds_read_b64_tr_b16 v[126:127], v11 offset:5120
  s_waitcnt vmcnt(19) lgkmcnt(8)
  v_mfma_f32_32x32x16_bf16 v[24:39], v[104:107], v[56:59], v[24:39]
  s_xor_b32 s28, s24, 7
  s_lshl_b32 s28, s28, 13
  s_add_u32 s28, s28, 65536
  v_add_u32 v12, s28, v14
  ds_read_b64_tr_b16 v[128:129], v10 offset:6144
  ds_read_b64_tr_b16 v[130:131], v10 offset:7168
  v_mfma_f32_32x32x16_bf16 v[40:55], v[108:111], v[56:59], v[40:55]
  v_add_u32 v13, s28, v15
  s_andn2_b32 s33, s36, s34
  s_cbranch_scc0 .g2_kernel_w_i10c
.g2_kernel_w_i10b:
  s_ff1_i32_b32 s33, s33
  ds_read_b64_tr_b16 v[132:133], v11 offset:6144
  ds_read_b64_tr_b16 v[134:135], v11 offset:7168
  s_waitcnt vmcnt(18) lgkmcnt(8)
  v_mfma_f32_32x32x16_bf16 v[24:39], v[112:115], v[60:63], v[24:39]
  s_bitset1_b32 s34, s33
  s_xor_b32 s33, s33, s24
  s_and_b32 s10, s33, 7
  s_cmp_lt_u32 s10, 2
  ds_read_b64_tr_b16 v[104:105], v12 offset:0
  ds_read_b64_tr_b16 v[106:107], v12 offset:1024
  v_mfma_f32_32x32x16_bf16 v[40:55], v[116:119], v[60:63], v[40:55]
  s_cselect_b32 s28, 139264, 0
  s_lshl_b32 s10, s10, 13
  s_add_u32 s10, s10, s28
  s_lshl_b32 s33, s33, 12
  ds_read_b64_tr_b16 v[108:109], v13 offset:0
  ds_read_b64_tr_b16 v[110:111], v13 offset:1024
  s_waitcnt vmcnt(17) lgkmcnt(8)
  v_mfma_f32_32x32x16_bf16 v[24:39], v[120:123], v[64:67], v[24:39]
  s_add_u32 s22, s20, s33
  s_addc_u32 s23, s21, 0
  global_load_dwordx4 v[192:195], v3, s[22:23] offset:0
  global_load_dwordx4 v[196:199], v3, s[22:23] offset:1024
  ds_read_b64_tr_b16 v[112:113], v12 offset:2048
  ds_read_b64_tr_b16 v[114:115], v12 offset:3072
  v_mfma_f32_32x32x16_bf16 v[40:55], v[124:127], v[64:67], v[40:55]
  global_load_dwordx4 v[200:203], v3, s[22:23] offset:2048
  global_load_dwordx4 v[204:207], v3, s[22:23] offset:3072
  ds_read_b64_tr_b16 v[116:117], v13 offset:2048
  ds_read_b64_tr_b16 v[118:119], v13 offset:3072
  s_waitcnt vmcnt(20) lgkmcnt(8)
  v_mfma_f32_32x32x16_bf16 v[24:39], v[128:131], v[68:71], v[24:39]
  ds_read_b64_tr_b16 v[120:121], v12 offset:4096
  ds_read_b64_tr_b16 v[122:123], v12 offset:5120
  v_mfma_f32_32x32x16_bf16 v[40:55], v[132:135], v[68:71], v[40:55]
  ds_read_b64_tr_b16 v[124:125], v13 offset:4096
  ds_read_b64_tr_b16 v[126:127], v13 offset:5120
  s_waitcnt vmcnt(19) lgkmcnt(8)
  v_mfma_f32_32x32x16_bf16 v[24:39], v[104:107], v[72:75], v[24:39]
  s_andn2_b32 s33, s36, s34
  s_cbranch_scc0 .g2_kernel_w_i11c
.g2_kernel_w_i11b:
  s_ff1_i32_b32 s33, s33
  ds_read_b64_tr_b16 v[128:129], v12 offset:6144
  ds_read_b64_tr_b16 v[130:131], v12 offset:7168
  v_mfma_f32_32x32x16_bf16 v[40:55], v[108:111], v[72:75], v[40:55]
  s_bitset1_b32 s34, s33
  s_xor_b32 s33, s33, s24
  s_and_b32 s11, s33, 7
  ds_read_b64_tr_b16 v[132:133], v13 offset:6144
  ds_read_b64_tr_b16 v[134:135], v13 offset:7168
  s_waitcnt vmcnt(18) lgkmcnt(8)
  v_mfma_f32_32x32x16_bf16 v[24:39], v[112:115], v[76:79], v[24:39]
  s_cmp_lt_u32 s11, 2
  s_cselect_b32 s28, 139264, 0
  s_lshl_b32 s11, s11, 13
  v_mfma_f32_32x32x16_bf16 v[40:55], v[116:119], v[76:79], v[40:55]
  s_add_u32 s11, s11, s28
  s_lshl_b32 s33, s33, 12
  s_add_u32 s22, s20, s33
  s_waitcnt vmcnt(17) lgkmcnt(4)
  v_mfma_f32_32x32x16_bf16 v[24:39], v[120:123], v[80:83], v[24:39]
  s_addc_u32 s23, s21, 0
  global_load_dwordx4 v[208:211], v3, s[22:23] offset:0
  global_load_dwordx4 v[212:215], v3, s[22:23] offset:1024
  v_mfma_f32_32x32x16_bf16 v[40:55], v[124:127], v[80:83], v[40:55]
  global_load_dwordx4 v[216:219], v3, s[22:23] offset:2048
  global_load_dwordx4 v[220:223], v3, s[22:23] offset:3072
  s_waitcnt vmcnt(20) lgkmcnt(0)
  v_mfma_f32_32x32x16_bf16 v[24:39], v[128:131], v[84:87], v[24:39]
  v_mfma_f32_32x32x16_bf16 v[40:55], v[132:135], v[84:87], v[40:55]
  ds_read_b32 v16, v20 offset:12
  v_add_u32 v10, s8, v14
  v_add_u32 v11, s8, v15
  s_waitcnt lgkmcnt(0)
  v_cmp_gt_u32 vcc, 4, v16
  s_cbranch_vccnz .g2_kernel_w_bw
.g2_kernel_w_bb:
  ds_read_b64_tr_b16 v[104:105], v10 offset:0
  ds_read_b64_tr_b16 v[106:107], v10 offset:1024
  ds_read_b64_tr_b16 v[108:109], v11 offset:0
  ds_read_b64_tr_b16 v[110:111], v11 offset:1024
  ds_read_b64_tr_b16 v[112:113], v10 offset:2048
  ds_read_b64_tr_b16 v[114:115], v10 offset:3072
  ds_read_b64_tr_b16 v[116:117], v11 offset:2048
  ds_read_b64_tr_b16 v[118:119], v11 offset:3072
  ds_read_b64_tr_b16 v[120:121], v10 offset:4096
  ds_read_b64_tr_b16 v[122:123], v10 offset:5120
  ds_read_b64_tr_b16 v[124:125], v11 offset:4096
  ds_read_b64_tr_b16 v[126:127], v11 offset:5120
  s_waitcnt vmcnt(16)
  v_min3_u32 v6, v88, v90, v92
  v_min3_u32 v7, v94, v96, v98
  v_min3_u32 v6, v6, v100, v102
  v_min_u32 v6, v6, v7
  v_cmp_eq_u32 vcc, 0, v6
  s_cbranch_vccnz .g2_kernel_w_v8
.g2_kernel_w_vb8:
  s_waitcnt lgkmcnt(8)
  v_mfma_f32_32x32x16_bf16 v[24:39], v[104:107], v[88:91], v[24:39]
  v_add_u32 v12, s9, v14
  v_add_u32 v13, s9, v15
  s_andn2_b32 s33, s36, s34
  s_cbranch_scc0 .g2_kernel_w_i12c
.g2_kernel_w_i12b:
  ds_read_b64_tr_b16 v[128:129], v10 offset:6144
  ds_read_b64_tr_b16 v[130:131], v10 offset:7168
  v_mfma_f32_32x32x16_bf16 v[40:55], v[108:111], v[88:91], v[40:55]
  s_ff1_i32_b32 s33, s33
  s_bitset1_b32 s34, s33
  s_xor_b32 s33, s33, s24
  s_and_b32 s12, s33, 7
  ds_read_b64_tr_b16 v[132:133], v11 offset:6144
  ds_read_b64_tr_b16 v[134:135], v11 offset:7168
  s_waitcnt lgkmcnt(8)
  v_mfma_f32_32x32x16_bf16 v[24:39], v[112:115], v[92:95], v[24:39]
  s_cmp_lt_u32 s12, 2
  s_cselect_b32 s28, 139264, 0
  s_lshl_b32 s12, s12, 13
  s_add_u32 s12, s12, s28
  ds_read_b64_tr_b16 v[104:105], v12 offset:0
  ds_read_b64_tr_b16 v[106:107], v12 offset:1024
  v_mfma_f32_32x32x16_bf16 v[40:55], v[116:119], v[92:95], v[40:55]
  s_lshl_b32 s33, s33, 12
  s_add_u32 s22, s20, s33
  s_addc_u32 s23, s21, 0
  global_load_dwordx4 v[224:227], v3, s[22:23] offset:0
  ds_read_b64_tr_b16 v[108:109], v13 offset:0
  ds_read_b64_tr_b16 v[110:111], v13 offset:1024
  s_waitcnt lgkmcnt(8)
  v_mfma_f32_32x32x16_bf16 v[24:39], v[120:123], v[96:99], v[24:39]
  global_load_dwordx4 v[228:231], v3, s[22:23] offset:1024
  global_load_dwordx4 v[232:235], v3, s[22:23] offset:2048
  global_load_dwordx4 v[236:239], v3, s[22:23] offset:3072
  ds_read_b64_tr_b16 v[112:113], v12 offset:2048
  ds_read_b64_tr_b16 v[114:115], v12 offset:3072
  v_mfma_f32_32x32x16_bf16 v[40:55], v[124:127], v[96:99], v[40:55]
  ds_read_b64_tr_b16 v[116:117], v13 offset:2048
  ds_read_b64_tr_b16 v[118:119], v13 offset:3072
  s_waitcnt lgkmcnt(8)
  v_mfma_f32_32x32x16_bf16 v[24:39], v[128:131], v[100:103], v[24:39]
  ds_read_b64_tr_b16 v[120:121], v12 offset:4096
  ds_read_b64_tr_b16 v[122:123], v12 offset:5120
  s_waitcnt vmcnt(16)
  v_min3_u32 v6, v176, v178, v180
  v_min3_u32 v7, v182, v184, v186
  v_min3_u32 v6, v6, v188, v190
  v_min_u32 v6, v6, v7
  v_cmp_eq_u32 vcc, 0, v6
  v_mfma_f32_32x32x16_bf16 v[40:55], v[132:135], v[100:103], v[40:55]
  ds_read_b64_tr_b16 v[124:125], v13 offset:4096
  ds_read_b64_tr_b16 v[126:127], v13 offset:5120
  s_cbranch_vccnz .g2_kernel_w_v9
.g2_kernel_w_vb9:
  s_waitcnt lgkmcnt(8)
  v_mfma_f32_32x32x16_bf16 v[24:39], v[104:107], v[176:179], v[24:39]
  v_add_u32 v10, s10, v14
  v_add_u32 v11, s10, v15
  s_andn2_b32 s33, s36, s34
  s_cbranch_scc0 .g2_kernel_w_i13c
.g2_kernel_w_i13b:
  ds_read_b64_tr_b16 v[128:129], v12 offset:6144
  ds_read_b64_tr_b16 v[130:131], v12 offset:7168
  v_mfma_f32_32x32x16_bf16 v[40:55], v[108:111], v[176:179], v[40:55]
  s_ff1_i32_b32 s33, s33
  s_bitset1_b32 s34, s33
  s_xor_b32 s33, s33, s24
  s_and_b32 s13, s33, 7
  ds_read_b64_tr_b16 v[132:133], v13 offset:6144
  ds_read_b64_tr_b16 v[134:135], v13 offset:7168
  s_waitcnt lgkmcnt(8)
  v_mfma_f32_32x32x16_bf16 v[24:39], v[112:115], v[180:183], v[24:39]
  s_cmp_lt_u32 s13, 2
  s_cselect_b32 s28, 139264, 0
  s_lshl_b32 s13, s13, 13
  s_add_u32 s13, s13, s28
  ds_read_b64_tr_b16 v[104:105], v10 offset:0
  ds_read_b64_tr_b16 v[106:107], v10 offset:1024
  v_mfma_f32_32x32x16_bf16 v[40:55], v[116:119], v[180:183], v[40:55]
  s_lshl_b32 s33, s33, 12
  s_add_u32 s22, s20, s33
  s_addc_u32 s23, s21, 0
  global_load_dwordx4 v[136:139], v3, s[22:23] offset:0
  ds_read_b64_tr_b16 v[108:109], v11 offset:0
  ds_read_b64_tr_b16 v[110:111], v11 offset:1024
  s_waitcnt lgkmcnt(8)
  v_mfma_f32_32x32x16_bf16 v[24:39], v[120:123], v[184:187], v[24:39]
  global_load_dwordx4 v[140:143], v3, s[22:23] offset:1024
  global_load_dwordx4 v[144:147], v3, s[22:23] offset:2048
  global_load_dwordx4 v[148:151], v3, s[22:23] offset:3072
  ds_read_b64_tr_b16 v[112:113], v10 offset:2048
  ds_read_b64_tr_b16 v[114:115], v10 offset:3072
  v_mfma_f32_32x32x16_bf16 v[40:55], v[124:127], v[184:187], v[40:55]
  ds_read_b64_tr_b16 v[116:117], v11 offset:2048
  ds_read_b64_tr_b16 v[118:119], v11 offset:3072
  s_waitcnt lgkmcnt(8)
  v_mfma_f32_32x32x16_bf16 v[24:39], v[128:131], v[188:191], v[24:39]
  ds_read_b64_tr_b16 v[120:121], v10 offset:4096
  ds_read_b64_tr_b16 v[122:123], v10 offset:5120
  s_waitcnt vmcnt(12)
  v_min3_u32 v6, v192, v194, v196
  v_min3_u32 v7, v198, v200, v202
  v_min3_u32 v6, v6, v204, v206
  v_min_u32 v6, v6, v7
  v_cmp_eq_u32 vcc, 0, v6
  v_mfma_f32_32x32x16_bf16 v[40:55], v[132:135], v[188:191], v[40:55]
  ds_read_b64_tr_b16 v[124:125], v11 offset:4096
  ds_read_b64_tr_b16 v[126:127], v11 offset:5120
  s_cbranch_vccnz .g2_kernel_w_v10
.g2_kernel_w_vb10:
  s_waitcnt lgkmcnt(8)
  v_mfma_f32_32x32x16_bf16 v[24:39], v[104:107], v[192:195], v[24:39]
  v_add_u32 v12, s11, v14
  v_add_u32 v13, s11, v15
  s_andn2_b32 s33, s36, s34
  s_cbranch_scc0 .g2_kernel_w_i14c
.g2_kernel_w_i14b:
  ds_read_b64_tr_b16 v[128:129], v10 offset:6144
  ds_read_b64_tr_b16 v[130:131], v10 offset:7168
  v_mfma_f32_32x32x16_bf16 v[40:55], v[108:111], v[192:195], v[40:55]
  s_ff1_i32_b32 s33, s33
  s_bitset1_b32 s34, s33
  s_xor_b32 s33, s33, s24
  s_and_b32 s14, s33, 7
  ds_read_b64_tr_b16 v[132:133], v11 offset:6144
  ds_read_b64_tr_b16 v[134:135], v11 offset:7168
  s_waitcnt lgkmcnt(8)
  v_mfma_f32_32x32x16_bf16 v[24:39], v[112:115], v[196:199], v[24:39]
  s_cmp_lt_u32 s14, 2
  s_cselect_b32 s28, 139264, 0
  s_lshl_b32 s14, s14, 13
  s_add_u32 s14, s14, s28
  ds_read_b64_tr_b16 v[104:105], v12 offset:0
  ds_read_b64_tr_b16 v[106:107], v12 offset:1024
  v_mfma_f32_32x32x16_bf16 v[40:55], v[116:119], v[196:199], v[40:55]
  s_lshl_b32 s33, s33, 12
  s_add_u32 s22, s20, s33
  s_addc_u32 s23, s21, 0
  global_load_dwordx4 v[152:155], v3, s[22:23] offset:0 sc1
  ds_read_b64_tr_b16 v[108:109], v13 offset:0
  ds_read_b64_tr_b16 v[110:111], v13 offset:1024
  s_waitcnt lgkmcnt(8)
  v_mfma_f32_32x32x16_bf16 v[24:39], v[120:123], v[200:203], v[24:39]
  global_load_dwordx4 v[156:159], v3, s[22:23] offset:1024 sc1
  global_load_dwordx4 v[160:163], v3, s[22:23] offset:2048 sc1
  global_load_dwordx4 v[164:167], v3, s[22:23] offset:3072 sc1
  ds_read_b64_tr_b16 v[112:113], v12 offset:2048
  ds_read_b64_tr_b16 v[114:115], v12 offset:3072
  v_mfma_f32_32x32x16_bf16 v[40:55], v[124:127], v[200:203], v[40:55]
  ds_read_b64_tr_b16 v[116:117], v13 offset:2048
  ds_read_b64_tr_b16 v[118:119], v13 offset:3072
  s_waitcnt lgkmcnt(8)
  v_mfma_f32_32x32x16_bf16 v[24:39], v[128:131], v[204:207], v[24:39]
  ds_read_b64_tr_b16 v[120:121], v12 offset:4096
  ds_read_b64_tr_b16 v[122:123], v12 offset:5120
  s_waitcnt vmcnt(12)
  v_min3_u32 v6, v208, v210, v212
  v_min3_u32 v7, v214, v216, v218
  v_min3_u32 v6, v6, v220, v222
  v_min_u32 v6, v6, v7
  v_cmp_eq_u32 vcc, 0, v6
  v_mfma_f32_32x32x16_bf16 v[40:55], v[132:135], v[204:207], v[40:55]
  ds_read_b64_tr_b16 v[124:125], v13 offset:4096
  ds_read_b64_tr_b16 v[126:127], v13 offset:5120
  s_cbranch_vccnz .g2_kernel_w_v11
.g2_kernel_w_vb11:
  s_mov_b64 exec, 1
  ds_add_u32 v20, v5 offset:16
  s_mov_b64 exec, -1
  s_waitcnt lgkmcnt(8)
  v_mfma_f32_32x32x16_bf16 v[24:39], v[104:107], v[208:211], v[24:39]
  v_add_u32 v10, s12, v14
  v_add_u32 v11, s12, v15
  s_andn2_b32 s33, s36, s34
  s_cbranch_scc0 .g2_kernel_w_i15c
.g2_kernel_w_i15b:
  ds_read_b64_tr_b16 v[128:129], v12 offset:6144
  ds_read_b64_tr_b16 v[130:131], v12 offset:7168
  v_mfma_f32_32x32x16_bf16 v[40:55], v[108:111], v[208:211], v[40:55]
  s_ff1_i32_b32 s33, s33
  s_bitset1_b32 s34, s33
  s_xor_b32 s33, s33, s24
  s_and_b32 s15, s33, 7
  ds_read_b64_tr_b16 v[132:133], v13 offset:6144
  ds_read_b64_tr_b16 v[134:135], v13 offset:7168
  s_waitcnt lgkmcnt(8)
  v_mfma_f32_32x32x16_bf16 v[24:39], v[112:115], v[212:215], v[24:39]
  s_cmp_lt_u32 s15, 2
  s_cselect_b32 s28, 139264, 0
  s_lshl_b32 s15, s15, 13
  s_add_u32 s15, s15, s28
  ds_read_b64_tr_b16 v[104:105], v10 offset:0
  ds_read_b64_tr_b16 v[106:107], v10 offset:1024
  v_mfma_f32_32x32x16_bf16 v[40:55], v[116:119], v[212:215], v[40:55]
  s_lshl_b32 s33, s33, 12
  s_add_u32 s22, s20, s33
  s_addc_u32 s23, s21, 0
  global_load_dwordx4 v[56:59], v3, s[22:23] offset:0 sc1
  ds_read_b64_tr_b16 v[108:109], v11 offset:0
  ds_read_b64_tr_b16 v[110:111], v11 offset:1024
  s_waitcnt lgkmcnt(8)
  v_mfma_f32_32x32x16_bf16 v[24:39], v[120:123], v[216:219], v[24:39]
  global_load_dwordx4 v[60:63], v3, s[22:23] offset:1024 sc1
  global_load_dwordx4 v[64:67], v3, s[22:23] offset:2048 sc1
  global_load_dwordx4 v[68:71], v3, s[22:23] offset:3072 sc1
  ds_read_b64_tr_b16 v[112:113], v10 offset:2048
  ds_read_b64_tr_b16 v[114:115], v10 offset:3072
  v_mfma_f32_32x32x16_bf16 v[40:55], v[124:127], v[216:219], v[40:55]
  ds_read_b64_tr_b16 v[116:117], v11 offset:2048
  ds_read_b64_tr_b16 v[118:119], v11 offset:3072
  s_waitcnt lgkmcnt(8)
  v_mfma_f32_32x32x16_bf16 v[24:39], v[128:131], v[220:223], v[24:39]
  ds_read_b64_tr_b16 v[120:121], v10 offset:4096
  ds_read_b64_tr_b16 v[122:123], v10 offset:5120
  s_waitcnt vmcnt(12)
  v_min3_u32 v6, v224, v226, v228
  v_min3_u32 v7, v230, v232, v234
  v_min3_u32 v6, v6, v236, v238
  v_min_u32 v6, v6, v7
  v_cmp_eq_u32 vcc, 0, v6
  v_mfma_f32_32x32x16_bf16 v[40:55], v[132:135], v[220:223], v[40:55]
  ds_read_b64_tr_b16 v[124:125], v11 offset:4096
  ds_read_b64_tr_b16 v[126:127], v11 offset:5120
  s_cbranch_vccnz .g2_kernel_w_v12
.g2_kernel_w_vb12:
  s_waitcnt lgkmcnt(8)
  v_mfma_f32_32x32x16_bf16 v[24:39], v[104:107], v[224:227], v[24:39]
  v_add_u32 v12, s13, v14
  v_add_u32 v13, s13, v15
  ds_read_b64_tr_b16 v[128:129], v10 offset:6144
  ds_read_b64_tr_b16 v[130:131], v10 offset:7168
  v_mfma_f32_32x32x16_bf16 v[40:55], v[108:111], v[224:227], v[40:55]
  ds_read_b64_tr_b16 v[132:133], v11 offset:6144
  ds_read_b64_tr_b16 v[134:135], v11 offset:7168
  s_waitcnt lgkmcnt(8)
  v_mfma_f32_32x32x16_bf16 v[24:39], v[112:115], v[228:231], v[24:39]
  ds_read_b64_tr_b16 v[104:105], v12 offset:0
  ds_read_b64_tr_b16 v[106:107], v12 offset:1024
  v_mfma_f32_32x32x16_bf16 v[40:55], v[116:119], v[228:231], v[40:55]
  ds_read_b64_tr_b16 v[108:109], v13 offset:0
  ds_read_b64_tr_b16 v[110:111], v13 offset:1024
  s_waitcnt lgkmcnt(8)
  v_mfma_f32_32x32x16_bf16 v[24:39], v[120:123], v[232:235], v[24:39]
  ds_read_b64_tr_b16 v[112:113], v12 offset:2048
  ds_read_b64_tr_b16 v[114:115], v12 offset:3072
  v_mfma_f32_32x32x16_bf16 v[40:55], v[124:127], v[232:235], v[40:55]
  ds_read_b64_tr_b16 v[116:117], v13 offset:2048
  ds_read_b64_tr_b16 v[118:119], v13 offset:3072
  s_waitcnt lgkmcnt(8)
  v_mfma_f32_32x32x16_bf16 v[24:39], v[128:131], v[236:239], v[24:39]
  ds_read_b64_tr_b16 v[120:121], v12 offset:4096
  ds_read_b64_tr_b16 v[122:123], v12 offset:5120
  s_waitcnt vmcnt(8)
  v_min3_u32 v6, v136, v138, v140
  v_min3_u32 v7, v142, v144, v146
  v_min3_u32 v6, v6, v148, v150
  v_min_u32 v6, v6, v7
  v_cmp_eq_u32 vcc, 0, v6
  v_mfma_f32_32x32x16_bf16 v[40:55], v[132:135], v[236:239], v[40:55]
  ds_read_b64_tr_b16 v[124:125], v13 offset:4096
  ds_read_b64_tr_b16 v[126:127], v13 offset:5120
  s_cbranch_vccnz .g2_kernel_w_v13
.g2_kernel_w_vb13:
  s_waitcnt lgkmcnt(8)
  v_mfma_f32_32x32x16_bf16 v[24:39], v[104:107], v[136:139], v[24:39]
  v_add_u32 v10, s14, v14
  v_add_u32 v11, s14, v15
  ds_read_b64_tr_b16 v[128:129], v12 offset:6144
  ds_read_b64_tr_b16 v[130:131], v12 offset:7168
  v_mfma_f32_32x32x16_bf16 v[40:55], v[108:111], v[136:139], v[40:55]
  ds_read_b64_tr_b16 v[132:133], v13 offset:6144
  ds_read_b64_tr_b16 v[134:135], v13 offset:7168
  s_waitcnt lgkmcnt(8)
  v_mfma_f32_32x32x16_bf16 v[24:39], v[112:115], v[140:143], v[24:39]
  ds_read_b64_tr_b16 v[104:105], v10 offset:0
  ds_read_b64_tr_b16 v[106:107], v10 offset:1024
  v_mfma_f32_32x32x16_bf16 v[40:55], v[116:119], v[140:143], v[40:55]
  ds_read_b64_tr_b16 v[108:109], v11 offset:0
  ds_read_b64_tr_b16 v[110:111], v11 offset:1024
  s_waitcnt lgkmcnt(8)
  v_mfma_f32_32x32x16_bf16 v[24:39], v[120:123], v[144:147], v[24:39]
  ds_read_b64_tr_b16 v[112:113], v10 offset:2048
  ds_read_b64_tr_b16 v[114:115], v10 offset:3072
  v_mfma_f32_32x32x16_bf16 v[40:55], v[124:127], v[144:147], v[40:55]
  ds_read_b64_tr_b16 v[116:117], v11 offset:2048
  ds_read_b64_tr_b16 v[118:119], v11 offset:3072
  s_waitcnt lgkmcnt(8)
  v_mfma_f32_32x32x16_bf16 v[24:39], v[128:131], v[148:151], v[24:39]
  ds_read_b64_tr_b16 v[120:121], v10 offset:4096
  ds_read_b64_tr_b16 v[122:123], v10 offset:5120
  s_waitcnt vmcnt(4)
  v_min3_u32 v6, v152, v154, v156
  v_min3_u32 v7, v158, v160, v162
  v_min3_u32 v6, v6, v164, v166
  v_min_u32 v6, v6, v7
  v_cmp_eq_u32 vcc, 0, v6
  v_mfma_f32_32x32x16_bf16 v[40:55], v[132:135], v[148:151], v[40:55]
  ds_read_b64_tr_b16 v[124:125], v11 offset:4096
  ds_read_b64_tr_b16 v[126:127], v11 offset:5120
  s_cbranch_vccnz .g2_kernel_w_v14
.g2_kernel_w_vb14:
  s_waitcnt lgkmcnt(8)
  v_mfma_f32_32x32x16_bf16 v[24:39], v[104:107], v[152:155], v[24:39]
  v_add_u32 v12, s15, v14
  v_add_u32 v13, s15, v15
  ds_read_b64_tr_b16 v[128:129], v10 offset:6144
  ds_read_b64_tr_b16 v[130:131], v10 offset:7168
  v_mfma_f32_32x32x16_bf16 v[40:55], v[108:111], v[152:155], v[40:55]
  ds_read_b64_tr_b16 v[132:133], v11 offset:6144
  ds_read_b64_tr_b16 v[134:135], v11 offset:7168
  s_waitcnt lgkmcnt(8)
  v_mfma_f32_32x32x16_bf16 v[24:39], v[112:115], v[156:159], v[24:39]
  ds_read_b64_tr_b16 v[104:105], v12 offset:0
  ds_read_b64_tr_b16 v[106:107], v12 offset:1024
  v_mfma_f32_32x32x16_bf16 v[40:55], v[116:119], v[156:159], v[40:55]
  ds_read_b64_tr_b16 v[108:109], v13 offset:0
  ds_read_b64_tr_b16 v[110:111], v13 offset:1024
  s_waitcnt lgkmcnt(8)
  v_mfma_f32_32x32x16_bf16 v[24:39], v[120:123], v[160:163], v[24:39]
  ds_read_b64_tr_b16 v[112:113], v12 offset:2048
  ds_read_b64_tr_b16 v[114:115], v12 offset:3072
  v_mfma_f32_32x32x16_bf16 v[40:55], v[124:127], v[160:163], v[40:55]
  ds_read_b64_tr_b16 v[116:117], v13 offset:2048
  ds_read_b64_tr_b16 v[118:119], v13 offset:3072
  s_waitcnt lgkmcnt(8)
  v_mfma_f32_32x32x16_bf16 v[24:39], v[128:131], v[164:167], v[24:39]
  ds_read_b64_tr_b16 v[120:121], v12 offset:4096
  ds_read_b64_tr_b16 v[122:123], v12 offset:5120
  s_waitcnt vmcnt(0)
  v_min3_u32 v6, v56, v58, v60
  v_min3_u32 v7, v62, v64, v66
  v_min3_u32 v6, v6, v68, v70
  v_min_u32 v6, v6, v7
  v_cmp_eq_u32 vcc, 0, v6
  v_mfma_f32_32x32x16_bf16 v[40:55], v[132:135], v[164:167], v[40:55]
  ds_read_b64_tr_b16 v[124:125], v13 offset:4096
  ds_read_b64_tr_b16 v[126:127], v13 offset:5120
  s_cbranch_vccnz .g2_kernel_w_v15
.g2_kernel_w_vb15:
  s_waitcnt lgkmcnt(8)
  v_mfma_f32_32x32x16_bf16 v[24:39], v[104:107], v[56:59], v[24:39]
  ds_read_b64_tr_b16 v[128:129], v12 offset:6144
  ds_read_b64_tr_b16 v[130:131], v12 offset:7168
  v_mfma_f32_32x32x16_bf16 v[40:55], v[108:111], v[56:59], v[40:55]
  ds_read_b64_tr_b16 v[132:133], v13 offset:6144
  ds_read_b64_tr_b16 v[134:135], v13 offset:7168
  s_waitcnt lgkmcnt(8)
  v_mfma_f32_32x32x16_bf16 v[24:39], v[112:115], v[60:63], v[24:39]
  v_mfma_f32_32x32x16_bf16 v[40:55], v[116:119], v[60:63], v[40:55]
  s_waitcnt lgkmcnt(4)
  v_mfma_f32_32x32x16_bf16 v[24:39], v[120:123], v[64:67], v[24:39]
  v_mfma_f32_32x32x16_bf16 v[40:55], v[124:127], v[64:67], v[40:55]
  s_waitcnt lgkmcnt(0)
  v_mfma_f32_32x32x16_bf16 v[24:39], v[128:131], v[68:71], v[24:39]
  v_mfma_f32_32x32x16_bf16 v[40:55], v[132:135], v[68:71], v[40:55]
  s_lshl_b32 s28, s17, 4
  s_add_u32 s28, s28, s18
  s_lshl_b32 s28, s28, 2
  s_add_u32 s28, s28, s16
  s_lshl_b32 s28, s28, 12
  s_add_u32 s28, s28, s63
  s_add_u32 s28, s28, 0xc00000
  s_lshl_b32 s29, s16, 12
  v_add_u32 v6, s29, v22
  s_mov_b32 s36, 0x3f803f80
  v_mov_b32 v8, 0
  v_mov_b32 v9, 0
  v_mov_b32 v10, 0
  v_cvt_pk_bf16_f32 v56, v24, v25
  v_cvt_pk_bf16_f32 v57, v26, v27
  v_cvt_pk_bf16_f32 v58, v28, v29
  v_cvt_pk_bf16_f32 v59, v30, v31
  buffer_store_dwordx4 v[56:59], v22, s[4:7], s28 offen offset:0 sc1
  v_cvt_pk_bf16_f32 v60, v32, v33
  v_cvt_pk_bf16_f32 v61, v34, v35
  v_cvt_pk_bf16_f32 v62, v36, v37
  v_cvt_pk_bf16_f32 v63, v38, v39
  buffer_store_dwordx4 v[60:63], v22, s[4:7], s28 offen offset:512 sc1
  v_cvt_pk_bf16_f32 v64, v40, v41
  v_cvt_pk_bf16_f32 v65, v42, v43
  v_cvt_pk_bf16_f32 v66, v44, v45
  v_cvt_pk_bf16_f32 v67, v46, v47
  buffer_store_dwordx4 v[64:67], v22, s[4:7], s28 offen offset:1024 sc1
  v_cvt_pk_bf16_f32 v68, v48, v49
  v_cvt_pk_bf16_f32 v69, v50, v51
  v_cvt_pk_bf16_f32 v70, v52, v53
  v_cvt_pk_bf16_f32 v71, v54, v55
  buffer_store_dwordx4 v[68:71], v22, s[4:7], s28 offen offset:1536 sc1
  ds_write_b128 v6, v[56:59] offset:0
  ds_write_b128 v6, v[60:63] offset:512
  ds_write_b128 v6, v[64:67] offset:1024
  ds_write_b128 v6, v[68:71] offset:1536
  s_mov_b64 exec, 1
  ds_add_u32 v20, v5 offset:20
  s_mov_b64 exec, -1
  s_lshl_b32 s28, s17, 2
  s_add_u32 s28, s28, s16
  s_lshl_b32 s28, s28, 13
  s_lshl_b32 s29, s18, 9
  s_add_u32 s28, s28, s29
  s_add_u32 s28, s28, s63
  s_add_u32 s28, s28, 0x1000000
  v_dot2c_f32_bf16 v8, s36, v56
  v_dot2c_f32_bf16 v9, v56, v56
  v_dot2c_f32_bf16 v10, v56, v240
  v_dot2c_f32_bf16 v8, s36, v57
  v_dot2c_f32_bf16 v9, v57, v57
  v_dot2c_f32_bf16 v10, v57, v241
  v_dot2c_f32_bf16 v8, s36, v58
  v_dot2c_f32_bf16 v9, v58, v58
  v_dot2c_f32_bf16 v10, v58, v242
  v_dot2c_f32_bf16 v8, s36, v59
  v_dot2c_f32_bf16 v9, v59, v59
  v_dot2c_f32_bf16 v10, v59, v243
  v_dot2c_f32_bf16 v8, s36, v60
  v_dot2c_f32_bf16 v9, v60, v60
  v_dot2c_f32_bf16 v10, v60, v244
  v_dot2c_f32_bf16 v8, s36, v61
  v_dot2c_f32_bf16 v9, v61, v61
  v_dot2c_f32_bf16 v10, v61, v245
  v_dot2c_f32_bf16 v8, s36, v62
  v_dot2c_f32_bf16 v9, v62, v62
  v_dot2c_f32_bf16 v10, v62, v246
  v_dot2c_f32_bf16 v8, s36, v63
  v_dot2c_f32_bf16 v9, v63, v63
  v_dot2c_f32_bf16 v10, v63, v247
  v_dot2c_f32_bf16 v8, s36, v64
  v_dot2c_f32_bf16 v9, v64, v64
  v_dot2c_f32_bf16 v10, v64, v248
  v_dot2c_f32_bf16 v8, s36, v65
  v_dot2c_f32_bf16 v9, v65, v65
  v_dot2c_f32_bf16 v10, v65, v249
  v_dot2c_f32_bf16 v8, s36, v66
  v_dot2c_f32_bf16 v9, v66, v66
  v_dot2c_f32_bf16 v10, v66, v250
  v_dot2c_f32_bf16 v8, s36, v67
  v_dot2c_f32_bf16 v9, v67, v67
  v_dot2c_f32_bf16 v10, v67, v251
  v_dot2c_f32_bf16 v8, s36, v68
  v_dot2c_f32_bf16 v9, v68, v68
  v_dot2c_f32_bf16 v10, v68, v252
  v_dot2c_f32_bf16 v8, s36, v69
  v_dot2c_f32_bf16 v9, v69, v69
  v_dot2c_f32_bf16 v10, v69, v253
  v_dot2c_f32_bf16 v8, s36, v70
  v_dot2c_f32_bf16 v9, v70, v70
  v_dot2c_f32_bf16 v10, v70, v254
  v_dot2c_f32_bf16 v8, s36, v71
  v_dot2c_f32_bf16 v9, v71, v71
  v_dot2c_f32_bf16 v10, v71, v255
  s_lshl_b32 s29, s16, 7
  s_add_u32 s37, s19, s29
  v_mov_b32 v24, v8
  v_mov_b32 v25, v9
  v_mov_b32 v26, v10
  v_mov_b32 v11, 1
  v_permlane32_swap_b32 v8, v24
  v_permlane32_swap_b32 v9, v25
  v_permlane32_swap_b32 v10, v26
  v_add_f32 v8, v8, v24
  v_add_f32 v9, v9, v25
  v_add_f32 v10, v10, v26
  v_or_b32 v8, 1, v8
  v_mov_b32 v16, s70
  s_mov_b32 exec_hi, 0
  s_waitcnt vmcnt(0)
  buffer_store_dwordx4 v[8:11], v3, s[4:7], s28 offen sc1
  s_mov_b64 exec, 1
  buffer_store_dword v16, v4, s[4:7], s37 offen offset:8 sc1
  s_mov_b64 exec, -1
  s_cmp_lg_u32 s62, 0
  s_cbranch_scc1 .g2_kernel_tail
  s_mov_b32 s62, 1
  s_mov_b32 s63, 0x1800000
  s_mov_b32 s70, 2
  s_mov_b32 s71, 155776
  s_branch .g2_kernel_q_cons2
.g2_kernel_tail:
  s_mov_b32 s28, s56
  s_mov_b32 s29, s57
  s_mov_b32 s30, 0x400000
  s_mov_b32 s31, 0x00020000
  v_lshrrev_b32 v8, 3, v2
  v_and_b32 v9, 7, v2
  v_lshlrev_b32 v10, 8, v9
  v_lshl_add_u32 v10, v8, 4, v10
  s_lshl_b32 s32, s16, 12
  v_add_u32 v10, s32, v10
  ds_read_b128 v[56:59], v10 offset:0
  ds_read_b128 v[60:63], v10 offset:128
  ds_read_b128 v[64:67], v10 offset:2048
  ds_read_b128 v[68:71], v10 offset:2176
  v_lshlrev_b32 v23, 11, v8
  v_lshl_add_u32 v23, v9, 4, v23
  s_lshl_b32 s32, s16, 5
  v_add_u32 v19, s32, v8
  v_lshlrev_b32 v10, 2, v19
  v_add_u32 v10, 155648, v10
  s_lshl_b32 s32, s17, 2
  s_add_u32 s32, s32, s16
  s_lshl_b32 s32, s32, 16
  s_lshl_b32 s33, s18, 7
  s_add_u32 s32, s32, s33
  s_waitcnt lgkmcnt(0)
  v_lshlrev_b32 v24, 16, v56
  v_and_b32 v25, 0xffff0000, v56
  v_lshlrev_b32 v26, 16, v57
  v_and_b32 v27, 0xffff0000, v57
  v_lshlrev_b32 v28, 16, v58
  v_and_b32 v29, 0xffff0000, v58
  v_lshlrev_b32 v30, 16, v59
  v_and_b32 v31, 0xffff0000, v59
  v_lshlrev_b32 v32, 16, v60
  v_and_b32 v33, 0xffff0000, v60
  v_lshlrev_b32 v34, 16, v61
  v_and_b32 v35, 0xffff0000, v61
  v_lshlrev_b32 v36, 16, v62
  v_and_b32 v37, 0xffff0000, v62
  v_lshlrev_b32 v38, 16, v63
  v_and_b32 v39, 0xffff0000, v63
  v_lshlrev_b32 v40, 16, v64
  v_and_b32 v41, 0xffff0000, v64
  v_lshlrev_b32 v42, 16, v65
  v_and_b32 v43, 0xffff0000, v65
  v_lshlrev_b32 v44, 16, v66
  v_and_b32 v45, 0xffff0000, v66
  v_lshlrev_b32 v46, 16, v67
  v_and_b32 v47, 0xffff0000, v67
  v_lshlrev_b32 v48, 16, v68
  v_and_b32 v49, 0xffff0000, v68
  v_lshlrev_b32 v50, 16, v69
  v_and_b32 v51, 0xffff0000, v69
  v_lshlrev_b32 v52, 16, v70
  v_and_b32 v53, 0xffff0000, v70
  v_lshlrev_b32 v54, 16, v71
  v_and_b32 v55, 0xffff0000, v71
  s_lshl_b32 s33, s16, 2
  s_add_u32 s33, s33, 155920
  v_mov_b32 v17, s33
  v_mov_b32 v6, s71
  s_mov_b32 s38, 0
.g2_kernel_wg7:
  ds_read_b32 v7, v6 offset:28
  s_add_u32 s38, s38, 1
  s_waitcnt lgkmcnt(0)
  v_cmp_gt_u32 vcc, 1, v7
  s_cbranch_vccz .g2_kernel_wg7d
  s_sleep 2
  s_cmp_lt_u32 s38, 524288
  s_cbranch_scc1 .g2_kernel_wg7
.g2_kernel_wg7d:
  ds_read_b32 v17, v20 offset:32
  ds_read_b32 v72, v10 offset:3840
  ds_read_b32 v73, v10 offset:4352
  ds_read_b32 v74, v10 offset:3872
  ds_read_b32 v75, v10 offset:4384
  ds_read_b32 v76, v10 offset:3904
  ds_read_b32 v77, v10 offset:4416
  ds_read_b32 v78, v10 offset:3936
  ds_read_b32 v79, v10 offset:4448
  s_waitcnt lgkmcnt(0)
  v_sub_u32 v16, v17, v19
  v_pk_fma_f32 v[24:25], v[24:25], v[72:73], v[72:73] op_sel:[0,0,1] op_sel_hi:[1,0,1]
  v_pk_fma_f32 v[26:27], v[26:27], v[72:73], v[72:73] op_sel:[0,0,1] op_sel_hi:[1,0,1]
  v_pk_fma_f32 v[28:29], v[28:29], v[72:73], v[72:73] op_sel:[0,0,1] op_sel_hi:[1,0,1]
  v_pk_fma_f32 v[30:31], v[30:31], v[72:73], v[72:73] op_sel:[0,0,1] op_sel_hi:[1,0,1]
  v_cvt_pk_bf16_f32 v56, v24, v25
  v_cvt_pk_bf16_f32 v57, v26, v27
  v_cvt_pk_bf16_f32 v58, v28, v29
  v_cvt_pk_bf16_f32 v59, v30, v31
  v_cmp_ne_u32 vcc, 1, v16
  s_mov_b64 exec, vcc
  buffer_store_dwordx4 v[56:59], v23, s[28:31], s32 offen sc1
  s_mov_b64 exec, -1
  s_add_u32 s32, s32, 16384
  v_pk_fma_f32 v[32:33], v[32:33], v[74:75], v[74:75] op_sel:[0,0,1] op_sel_hi:[1,0,1]
  v_pk_fma_f32 v[34:35], v[34:35], v[74:75], v[74:75] op_sel:[0,0,1] op_sel_hi:[1,0,1]
  v_pk_fma_f32 v[36:37], v[36:37], v[74:75], v[74:75] op_sel:[0,0,1] op_sel_hi:[1,0,1]
  v_pk_fma_f32 v[38:39], v[38:39], v[74:75], v[74:75] op_sel:[0,0,1] op_sel_hi:[1,0,1]
  v_cvt_pk_bf16_f32 v60, v32, v33
  v_cvt_pk_bf16_f32 v61, v34, v35
  v_cvt_pk_bf16_f32 v62, v36, v37
  v_cvt_pk_bf16_f32 v63, v38, v39
  v_cmp_ne_u32 vcc, 9, v16
  s_mov_b64 exec, vcc
  buffer_store_dwordx4 v[60:63], v23, s[28:31], s32 offen sc1
  s_mov_b64 exec, -1
  s_add_u32 s32, s32, 16384
  v_pk_fma_f32 v[40:41], v[40:41], v[76:77], v[76:77] op_sel:[0,0,1] op_sel_hi:[1,0,1]
  v_pk_fma_f32 v[42:43], v[42:43], v[76:77], v[76:77] op_sel:[0,0,1] op_sel_hi:[1,0,1]
  v_pk_fma_f32 v[44:45], v[44:45], v[76:77], v[76:77] op_sel:[0,0,1] op_sel_hi:[1,0,1]
  v_pk_fma_f32 v[46:47], v[46:47], v[76:77], v[76:77] op_sel:[0,0,1] op_sel_hi:[1,0,1]
  v_cvt_pk_bf16_f32 v64, v40, v41
  v_cvt_pk_bf16_f32 v65, v42, v43
  v_cvt_pk_bf16_f32 v66, v44, v45
  v_cvt_pk_bf16_f32 v67, v46, v47
  v_cmp_ne_u32 vcc, 17, v16
  s_mov_b64 exec, vcc
  buffer_store_dwordx4 v[64:67], v23, s[28:31], s32 offen sc1
  s_mov_b64 exec, -1
  s_add_u32 s32, s32, 16384
  v_pk_fma_f32 v[48:49], v[48:49], v[78:79], v[78:79] op_sel:[0,0,1] op_sel_hi:[1,0,1]
  v_pk_fma_f32 v[50:51], v[50:51], v[78:79], v[78:79] op_sel:[0,0,1] op_sel_hi:[1,0,1]
  v_pk_fma_f32 v[52:53], v[52:53], v[78:79], v[78:79] op_sel:[0,0,1] op_sel_hi:[1,0,1]
  v_pk_fma_f32 v[54:55], v[54:55], v[78:79], v[78:79] op_sel:[0,0,1] op_sel_hi:[1,0,1]
  v_cvt_pk_bf16_f32 v68, v48, v49
  v_cvt_pk_bf16_f32 v69, v50, v51
  v_cvt_pk_bf16_f32 v70, v52, v53
  v_cvt_pk_bf16_f32 v71, v54, v55
  v_cmp_ne_u32 vcc, 25, v16
  s_mov_b64 exec, vcc
  buffer_store_dwordx4 v[68:71], v23, s[28:31], s32 offen sc1
  s_mov_b64 exec, -1
  s_add_u32 s32, s32, 16384
  s_branch .g2_kernel_fin
.g2_kernel_svc:
  s_cmp_eq_u32 s16, 5
  s_cbranch_scc1 .g2_kernel_s1
  s_cmp_eq_u32 s16, 6
  s_cbranch_scc1 .g2_kernel_s2
  s_cmp_eq_u32 s16, 7
  s_cbranch_scc1 .g2_kernel_s3
  s_mov_b32 s8, s40
  s_mov_b32 s9, s41
  s_mov_b32 s10, 0x400000
  s_mov_b32 s11, 0x00020000
  s_setprio 3
  v_lshrrev_b32 v20, 3, v2
  v_and_b32 v21, 7, v2
  v_lshrrev_b32 v22, 4, v2
  v_xor_b32 v23, v21, v22
  v_lshlrev_b32 v23, 4, v23
  v_lshl_add_u32 v24, v20, 11, v23
  v_xor_b32 v25, 64, v24
  s_lshl_b32 s32, s17, 18
  v_add_u32 v32, 0, v24
  v_add_u32 v33, 15360, v25
  v_add_u32 v34, 30720, v24
  v_add_u32 v35, 46080, v25
  v_add_u32 v36, 65536, v24
  v_add_u32 v37, 80896, v25
  v_add_u32 v38, 96256, v24
  v_add_u32 v39, 111616, v25
  v_add_u32 v40, 131072, v24
  v_add_u32 v41, 146432, v25
  v_add_u32 v42, 161792, v24
  v_add_u32 v43, 177152, v25
  v_add_u32 v44, 196608, v24
  v_add_u32 v45, 211968, v25
  v_add_u32 v46, 227328, v24
  v_add_u32 v47, 242688, v25
  s_mov_b32 s29, 0
  s_add_u32 m0, s29, 0
  s_waitcnt vmcnt(63)
  buffer_load_dwordx4 v32, s[8:11], s32 offen offset:0 lds
  buffer_load_dwordx4 v33, s[8:11], s32 offen offset:1024 lds
  buffer_load_dwordx4 v34, s[8:11], s32 offen offset:2048 lds
  buffer_load_dwordx4 v35, s[8:11], s32 offen offset:3072 lds
  s_add_u32 m0, s29, 4096
  s_waitcnt vmcnt(63)
  buffer_load_dwordx4 v36, s[8:11], s32 offen offset:0 lds
  buffer_load_dwordx4 v37, s[8:11], s32 offen offset:1024 lds
  buffer_load_dwordx4 v38, s[8:11], s32 offen offset:2048 lds
  buffer_load_dwordx4 v39, s[8:11], s32 offen offset:3072 lds
  s_add_u32 m0, s29, 8192
  s_waitcnt vmcnt(63)
  buffer_load_dwordx4 v40, s[8:11], s32 offen offset:0 lds
  buffer_load_dwordx4 v41, s[8:11], s32 offen offset:1024 lds
  buffer_load_dwordx4 v42, s[8:11], s32 offen offset:2048 lds
  buffer_load_dwordx4 v43, s[8:11], s32 offen offset:3072 lds
  s_add_u32 m0, s29, 12288
  s_waitcnt vmcnt(63)
  buffer_load_dwordx4 v44, s[8:11], s32 offen offset:0 lds
  buffer_load_dwordx4 v45, s[8:11], s32 offen offset:1024 lds
  buffer_load_dwordx4 v46, s[8:11], s32 offen offset:2048 lds
  buffer_load_dwordx4 v47, s[8:11], s32 offen offset:3072 lds
  s_add_u32 s32, s32, 128
  s_mov_b32 s12, s42
  s_mov_b32 s13, s43
  s_mov_b32 s14, 0x600000
  s_mov_b32 s15, 0x00020000
  v_lshrrev_b32 v28, 3, v2
  v_and_b32 v29, 7, v2
  v_bfe_u32 v30, v2, 4, 1
  v_lshlrev_b32 v30, 1, v30
  v_xor_b32 v31, v29, v30
  v_lshlrev_b32 v31, 4, v31
  v_mul_u32_u24 v28, 6144, v28
  v_add_u32 v28, v28, v31
  v_xor_b32 v29, 64, v28
  v_lshlrev_b32 v9, 2, v2
  v_and_b32 v9, 12, v9
  v_add_u32 v9, 156416, v9
  v_add_u32 v48, 0, v28
  v_add_u32 v49, 48128, v29
  v_add_u32 v50, 96256, v28
  v_add_u32 v51, 144384, v29
  v_add_u32 v52, 2048, v28
  v_add_u32 v53, 50176, v29
  v_add_u32 v54, 98304, v28
  v_add_u32 v55, 146432, v29
  v_add_u32 v56, 4096, v29
  v_add_u32 v57, 52224, v28
  v_add_u32 v58, 100352, v29
  v_add_u32 v59, 148480, v28
  s_lshl_b32 s36, s18, 7
  s_mov_b32 s30, 0
  s_add_u32 m0, s30, 65536
  s_waitcnt vmcnt(63)
  buffer_load_dwordx4 v48, s[12:15], s36 offen offset:0 lds
  buffer_load_dwordx4 v49, s[12:15], s36 offen offset:1024 lds
  buffer_load_dwordx4 v50, s[12:15], s36 offen offset:2048 lds
  buffer_load_dwordx4 v51, s[12:15], s36 offen offset:3072 lds
  s_add_u32 m0, s30, 69632
  s_waitcnt vmcnt(63)
  buffer_load_dwordx4 v52, s[12:15], s36 offen offset:0 lds
  buffer_load_dwordx4 v53, s[12:15], s36 offen offset:1024 lds
  buffer_load_dwordx4 v54, s[12:15], s36 offen offset:2048 lds
  buffer_load_dwordx4 v55, s[12:15], s36 offen offset:3072 lds
  s_add_u32 m0, s30, 73728
  s_waitcnt vmcnt(63)
  buffer_load_dwordx4 v56, s[12:15], s36 offen offset:0 lds
  buffer_load_dwordx4 v57, s[12:15], s36 offen offset:1024 lds
  buffer_load_dwordx4 v58, s[12:15], s36 offen offset:2048 lds
  buffer_load_dwordx4 v59, s[12:15], s36 offen offset:3072 lds
  s_add_u32 s30, s30, 12288
  s_cmp_eq_u32 s30, 86016
  s_cselect_b32 s30, 0, s30
  s_barrier
  s_mov_b32 s35, .g2_kernel_tab-.g2_kernel_pc+4
  s_mov_b32 s34, -5
  v_mov_b32 v10, 0
  s_mov_b32 m0, 156160
  s_add_u32 s36, s36, 196608
  s_mov_b64 exec, 1
  buffer_load_dword off, s[64:67], s35 lds
  s_mov_b64 exec, -1
  s_add_u32 s35, s35, 4
  s_branch .g2_kernel_p1_o
  .p2align 6
.g2_kernel_p1_l:
  s_waitcnt lgkmcnt(0)
  v_cmp_gt_i32 vcc, s34, v10
  s_cbranch_vccnz .g2_kernel_p1_aw
.g2_kernel_p1_ai:
  s_add_u32 s29, s29, 16384
  s_and_b32 s29, s29, 0xffff
  s_add_u32 m0, s29, 0
  s_waitcnt vmcnt(63)
  buffer_load_dwordx4 v32, s[8:11], s32 offen offset:0 lds
  buffer_load_dwordx4 v33, s[8:11], s32 offen offset:1024 lds
  buffer_load_dwordx4 v34, s[8:11], s32 offen offset:2048 lds
  buffer_load_dwordx4 v35, s[8:11], s32 offen offset:3072 lds
  s_add_u32 m0, s29, 4096
  s_waitcnt vmcnt(63)
  buffer_load_dwordx4 v36, s[8:11], s32 offen offset:0 lds
  buffer_load_dwordx4 v37, s[8:11], s32 offen offset:1024 lds
  buffer_load_dwordx4 v38, s[8:11], s32 offen offset:2048 lds
  buffer_load_dwordx4 v39, s[8:11], s32 offen offset:3072 lds
  s_add_u32 m0, s29, 8192
  s_waitcnt vmcnt(63)
  buffer_load_dwordx4 v40, s[8:11], s32 offen offset:0 lds
  buffer_load_dwordx4 v41, s[8:11], s32 offen offset:1024 lds
  buffer_load_dwordx4 v42, s[8:11], s32 offen offset:2048 lds
  buffer_load_dwordx4 v43, s[8:11], s32 offen offset:3072 lds
  s_add_u32 m0, s29, 12288
  s_waitcnt vmcnt(63)
  buffer_load_dwordx4 v44, s[8:11], s32 offen offset:0 lds
  buffer_load_dwordx4 v45, s[8:11], s32 offen offset:1024 lds
  buffer_load_dwordx4 v46, s[8:11], s32 offen offset:2048 lds
  buffer_load_dwordx4 v47, s[8:11], s32 offen offset:3072 lds
  s_add_u32 s32, s32, 128
  s_add_u32 m0, s30, 65536
  s_waitcnt vmcnt(63)
  buffer_load_dwordx4 v48, s[12:15], s36 offen offset:0 lds
  buffer_load_dwordx4 v49, s[12:15], s36 offen offset:1024 lds
  buffer_load_dwordx4 v50, s[12:15], s36 offen offset:2048 lds
  buffer_load_dwordx4 v51, s[12:15], s36 offen offset:3072 lds
  s_add_u32 m0, s30, 69632
  s_waitcnt vmcnt(63)
  buffer_load_dwordx4 v52, s[12:15], s36 offen offset:0 lds
  buffer_load_dwordx4 v53, s[12:15], s36 offen offset:1024 lds
  buffer_load_dwordx4 v54, s[12:15], s36 offen offset:2048 lds
  buffer_load_dwordx4 v55, s[12:15], s36 offen offset:3072 lds
  s_add_u32 m0, s30, 73728
  s_waitcnt vmcnt(63)
  buffer_load_dwordx4 v56, s[12:15], s36 offen offset:0 lds
  buffer_load_dwordx4 v57, s[12:15], s36 offen offset:1024 lds
  buffer_load_dwordx4 v58, s[12:15], s36 offen offset:2048 lds
  buffer_load_dwordx4 v59, s[12:15], s36 offen offset:3072 lds
  s_add_u32 s30, s30, 12288
  s_cmp_eq_u32 s30, 86016
  s_cselect_b32 s30, 0, s30
  ds_read_b32 v10, v9
  s_mov_b32 m0, 156160
  s_add_u32 s34, s34, 1
  s_mov_b64 exec, 1
  buffer_load_dword off, s[64:67], s35 lds
  s_mov_b64 exec, -1
  s_add_u32 s35, s35, 4
  s_add_u32 s36, s36, 196608
.g2_kernel_p1_o:
  s_waitcnt lgkmcnt(0)
  v_cmp_gt_i32 vcc, s34, v10
  s_cbranch_vccnz .g2_kernel_p1_bw
.g2_kernel_p1_bi:
  s_add_u32 m0, s30, 65536
  s_waitcnt vmcnt(63)
  buffer_load_dwordx4 v48, s[12:15], s36 offen offset:0 lds
  buffer_load_dwordx4 v49, s[12:15], s36 offen offset:1024 lds
  buffer_load_dwordx4 v50, s[12:15], s36 offen offset:2048 lds
  buffer_load_dwordx4 v51, s[12:15], s36 offen offset:3072 lds
  s_add_u32 m0, s30, 69632
  s_waitcnt vmcnt(63)
  buffer_load_dwordx4 v52, s[12:15], s36 offen offset:0 lds
  buffer_load_dwordx4 v53, s[12:15], s36 offen offset:1024 lds
  buffer_load_dwordx4 v54, s[12:15], s36 offen offset:2048 lds
  buffer_load_dwordx4 v55, s[12:15], s36 offen offset:3072 lds
  s_add_u32 m0, s30, 73728
  s_waitcnt vmcnt(63)
  buffer_load_dwordx4 v56, s[12:15], s36 offen offset:0 lds
  buffer_load_dwordx4 v57, s[12:15], s36 offen offset:1024 lds
  buffer_load_dwordx4 v58, s[12:15], s36 offen offset:2048 lds
  buffer_load_dwordx4 v59, s[12:15], s36 offen offset:3072 lds
  s_add_u32 s30, s30, 12288
  s_cmp_eq_u32 s30, 86016
  s_cselect_b32 s30, 0, s30
  ds_read_b32 v10, v9
  s_mov_b32 m0, 156160
  s_add_u32 s34, s34, 1
  s_mov_b64 exec, 1
  buffer_load_dword off, s[64:67], s35 lds
  s_mov_b64 exec, -1
  s_add_u32 s35, s35, 4
  s_add_u32 s36, s36, 196608
  s_cmp_lt_i32 s34, 26
  s_cbranch_scc1 .g2_kernel_p1_l
  s_branch .g2_kernel_v
.g2_kernel_s1:
  s_mov_b32 s8, s40
  s_mov_b32 s9, s41
  s_mov_b32 s10, 0x400000
  s_mov_b32 s11, 0x00020000
  v_lshrrev_b32 v20, 3, v2
  v_and_b32 v21, 7, v2
  v_lshlrev_b32 v21, 4, v21
  v_lshl_add_u32 v21, v20, 11, v21
  s_lshl_b32 s30, s17, 4
  s_add_u32 s30, s30, s18
  s_lshl_b32 s33, s30, 5
  s_lshl_b32 s30, s30, 14
  s_barrier
  s_sleep 30
  buffer_load_dwordx4 v[64:67], v21, s[8:11], s30 offen offset:0
  buffer_load_dwordx4 v[68:71], v21, s[8:11], s30 offen offset:128
  buffer_load_dwordx4 v[72:75], v21, s[8:11], s30 offen offset:256
  buffer_load_dwordx4 v[76:79], v21, s[8:11], s30 offen offset:384
  buffer_load_dwordx4 v[80:83], v21, s[8:11], s30 offen offset:512
  buffer_load_dwordx4 v[84:87], v21, s[8:11], s30 offen offset:640
  buffer_load_dwordx4 v[88:91], v21, s[8:11], s30 offen offset:768
  buffer_load_dwordx4 v[92:95], v21, s[8:11], s30 offen offset:896
  buffer_load_dwordx4 v[96:99], v21, s[8:11], s30 offen offset:1024
  buffer_load_dwordx4 v[100:103], v21, s[8:11], s30 offen offset:1152
  buffer_load_dwordx4 v[104:107], v21, s[8:11], s30 offen offset:1280
  buffer_load_dwordx4 v[108:111], v21, s[8:11], s30 offen offset:1408
  buffer_load_dwordx4 v[112:115], v21, s[8:11], s30 offen offset:1536
  buffer_load_dwordx4 v[116:119], v21, s[8:11], s30 offen offset:1664
  buffer_load_dwordx4 v[120:123], v21, s[8:11], s30 offen offset:1792
  buffer_load_dwordx4 v[124:127], v21, s[8:11], s30 offen offset:1920
  v_mov_b32 v24, 0
  v_mov_b32 v25, 0
  v_mov_b32 v26, 0
  v_mov_b32 v27, 0
  s_waitcnt vmcnt(15)
  v_lshlrev_b32 v22, 16, v64
  v_and_b32 v64, 0xffff0000, v64
  v_add_f32 v24, v24, v22
  v_fmac_f32 v25, v22, v22
  v_add_f32 v26, v26, v64
  v_fmac_f32 v27, v64, v64
  v_lshlrev_b32 v22, 16, v65
  v_and_b32 v65, 0xffff0000, v65
  v_add_f32 v24, v24, v22
  v_fmac_f32 v25, v22, v22
  v_add_f32 v26, v26, v65
  v_fmac_f32 v27, v65, v65
  v_lshlrev_b32 v22, 16, v66
  v_and_b32 v66, 0xffff0000, v66
  v_add_f32 v24, v24, v22
  v_fmac_f32 v25, v22, v22
  v_add_f32 v26, v26, v66
  v_fmac_f32 v27, v66, v66
  v_lshlrev_b32 v22, 16, v67
  v_and_b32 v67, 0xffff0000, v67
  v_add_f32 v24, v24, v22
  v_fmac_f32 v25, v22, v22
  v_add_f32 v26, v26, v67
  v_fmac_f32 v27, v67, v67
  s_waitcnt vmcnt(14)
  v_lshlrev_b32 v22, 16, v68
  v_and_b32 v68, 0xffff0000, v68
  v_add_f32 v24, v24, v22
  v_fmac_f32 v25, v22, v22
  v_add_f32 v26, v26, v68
  v_fmac_f32 v27, v68, v68
  v_lshlrev_b32 v22, 16, v69
  v_and_b32 v69, 0xffff0000, v69
  v_add_f32 v24, v24, v22
  v_fmac_f32 v25, v22, v22
  v_add_f32 v26, v26, v69
  v_fmac_f32 v27, v69, v69
  v_lshlrev_b32 v22, 16, v70
  v_and_b32 v70, 0xffff0000, v70
  v_add_f32 v24, v24, v22
  v_fmac_f32 v25, v22, v22
  v_add_f32 v26, v26, v70
  v_fmac_f32 v27, v70, v70
  v_lshlrev_b32 v22, 16, v71
  v_and_b32 v71, 0xffff0000, v71
  v_add_f32 v24, v24, v22
  v_fmac_f32 v25, v22, v22
  v_add_f32 v26, v26, v71
  v_fmac_f32 v27, v71, v71
  s_waitcnt vmcnt(13)
  v_lshlrev_b32 v22, 16, v72
  v_and_b32 v72, 0xffff0000, v72
  v_add_f32 v24, v24, v22
  v_fmac_f32 v25, v22, v22
  v_add_f32 v26, v26, v72
  v_fmac_f32 v27, v72, v72
  v_lshlrev_b32 v22, 16, v73
  v_and_b32 v73, 0xffff0000, v73
  v_add_f32 v24, v24, v22
  v_fmac_f32 v25, v22, v22
  v_add_f32 v26, v26, v73
  v_fmac_f32 v27, v73, v73
  v_lshlrev_b32 v22, 16, v74
  v_and_b32 v74, 0xffff0000, v74
  v_add_f32 v24, v24, v22
  v_fmac_f32 v25, v22, v22
  v_add_f32 v26, v26, v74
  v_fmac_f32 v27, v74, v74
  v_lshlrev_b32 v22, 16, v75
  v_and_b32 v75, 0xffff0000, v75
  v_add_f32 v24, v24, v22
  v_fmac_f32 v25, v22, v22
  v_add_f32 v26, v26, v75
  v_fmac_f32 v27, v75, v75
  s_waitcnt vmcnt(12)
  v_lshlrev_b32 v22, 16, v76
  v_and_b32 v76, 0xffff0000, v76
  v_add_f32 v24, v24, v22
  v_fmac_f32 v25, v22, v22
  v_add_f32 v26, v26, v76
  v_fmac_f32 v27, v76, v76
  v_lshlrev_b32 v22, 16, v77
  v_and_b32 v77, 0xffff0000, v77
  v_add_f32 v24, v24, v22
  v_fmac_f32 v25, v22, v22
  v_add_f32 v26, v26, v77
  v_fmac_f32 v27, v77, v77
  v_lshlrev_b32 v22, 16, v78
  v_and_b32 v78, 0xffff0000, v78
  v_add_f32 v24, v24, v22
  v_fmac_f32 v25, v22, v22
  v_add_f32 v26, v26, v78
  v_fmac_f32 v27, v78, v78
  v_lshlrev_b32 v22, 16, v79
  v_and_b32 v79, 0xffff0000, v79
  v_add_f32 v24, v24, v22
  v_fmac_f32 v25, v22, v22
  v_add_f32 v26, v26, v79
  v_fmac_f32 v27, v79, v79
  s_waitcnt vmcnt(11)
  v_lshlrev_b32 v22, 16, v80
  v_and_b32 v80, 0xffff0000, v80
  v_add_f32 v24, v24, v22
  v_fmac_f32 v25, v22, v22
  v_add_f32 v26, v26, v80
  v_fmac_f32 v27, v80, v80
  v_lshlrev_b32 v22, 16, v81
  v_and_b32 v81, 0xffff0000, v81
  v_add_f32 v24, v24, v22
  v_fmac_f32 v25, v22, v22
  v_add_f32 v26, v26, v81
  v_fmac_f32 v27, v81, v81
  v_lshlrev_b32 v22, 16, v82
  v_and_b32 v82, 0xffff0000, v82
  v_add_f32 v24, v24, v22
  v_fmac_f32 v25, v22, v22
  v_add_f32 v26, v26, v82
  v_fmac_f32 v27, v82, v82
  v_lshlrev_b32 v22, 16, v83
  v_and_b32 v83, 0xffff0000, v83
  v_add_f32 v24, v24, v22
  v_fmac_f32 v25, v22, v22
  v_add_f32 v26, v26, v83
  v_fmac_f32 v27, v83, v83
  s_waitcnt vmcnt(10)
  v_lshlrev_b32 v22, 16, v84
  v_and_b32 v84, 0xffff0000, v84
  v_add_f32 v24, v24, v22
  v_fmac_f32 v25, v22, v22
  v_add_f32 v26, v26, v84
  v_fmac_f32 v27, v84, v84
  v_lshlrev_b32 v22, 16, v85
  v_and_b32 v85, 0xffff0000, v85
  v_add_f32 v24, v24, v22
  v_fmac_f32 v25, v22, v22
  v_add_f32 v26, v26, v85
  v_fmac_f32 v27, v85, v85
  v_lshlrev_b32 v22, 16, v86
  v_and_b32 v86, 0xffff0000, v86
  v_add_f32 v24, v24, v22
  v_fmac_f32 v25, v22, v22
  v_add_f32 v26, v26, v86
  v_fmac_f32 v27, v86, v86
  v_lshlrev_b32 v22, 16, v87
  v_and_b32 v87, 0xffff0000, v87
  v_add_f32 v24, v24, v22
  v_fmac_f32 v25, v22, v22
  v_add_f32 v26, v26, v87
  v_fmac_f32 v27, v87, v87
  s_waitcnt vmcnt(9)
  v_lshlrev_b32 v22, 16, v88
  v_and_b32 v88, 0xffff0000, v88
  v_add_f32 v24, v24, v22
  v_fmac_f32 v25, v22, v22
  v_add_f32 v26, v26, v88
  v_fmac_f32 v27, v88, v88
  v_lshlrev_b32 v22, 16, v89
  v_and_b32 v89, 0xffff0000, v89
  v_add_f32 v24, v24, v22
  v_fmac_f32 v25, v22, v22
  v_add_f32 v26, v26, v89
  v_fmac_f32 v27, v89, v89
  v_lshlrev_b32 v22, 16, v90
  v_and_b32 v90, 0xffff0000, v90
  v_add_f32 v24, v24, v22
  v_fmac_f32 v25, v22, v22
  v_add_f32 v26, v26, v90
  v_fmac_f32 v27, v90, v90
  v_lshlrev_b32 v22, 16, v91
  v_and_b32 v91, 0xffff0000, v91
  v_add_f32 v24, v24, v22
  v_fmac_f32 v25, v22, v22
  v_add_f32 v26, v26, v91
  v_fmac_f32 v27, v91, v91
  s_waitcnt vmcnt(8)
  v_lshlrev_b32 v22, 16, v92
  v_and_b32 v92, 0xffff0000, v92
  v_add_f32 v24, v24, v22
  v_fmac_f32 v25, v22, v22
  v_add_f32 v26, v26, v92
  v_fmac_f32 v27, v92, v92
  v_lshlrev_b32 v22, 16, v93
  v_and_b32 v93, 0xffff0000, v93
  v_add_f32 v24, v24, v22
  v_fmac_f32 v25, v22, v22
  v_add_f32 v26, v26, v93
  v_fmac_f32 v27, v93, v93
  v_lshlrev_b32 v22, 16, v94
  v_and_b32 v94, 0xffff0000, v94
  v_add_f32 v24, v24, v22
  v_fmac_f32 v25, v22, v22
  v_add_f32 v26, v26, v94
  v_fmac_f32 v27, v94, v94
  v_lshlrev_b32 v22, 16, v95
  v_and_b32 v95, 0xffff0000, v95
  v_add_f32 v24, v24, v22
  v_fmac_f32 v25, v22, v22
  v_add_f32 v26, v26, v95
  v_fmac_f32 v27, v95, v95
  s_waitcnt vmcnt(7)
  v_lshlrev_b32 v22, 16, v96
  v_and_b32 v96, 0xffff0000, v96
  v_add_f32 v24, v24, v22
  v_fmac_f32 v25, v22, v22
  v_add_f32 v26, v26, v96
  v_fmac_f32 v27, v96, v96
  v_lshlrev_b32 v22, 16, v97
  v_and_b32 v97, 0xffff0000, v97
  v_add_f32 v24, v24, v22
  v_fmac_f32 v25, v22, v22
  v_add_f32 v26, v26, v97
  v_fmac_f32 v27, v97, v97
  v_lshlrev_b32 v22, 16, v98
  v_and_b32 v98, 0xffff0000, v98
  v_add_f32 v24, v24, v22
  v_fmac_f32 v25, v22, v22
  v_add_f32 v26, v26, v98
  v_fmac_f32 v27, v98, v98
  v_lshlrev_b32 v22, 16, v99
  v_and_b32 v99, 0xffff0000, v99
  v_add_f32 v24, v24, v22
  v_fmac_f32 v25, v22, v22
  v_add_f32 v26, v26, v99
  v_fmac_f32 v27, v99, v99
  s_waitcnt vmcnt(6)
  v_lshlrev_b32 v22, 16, v100
  v_and_b32 v100, 0xffff0000, v100
  v_add_f32 v24, v24, v22
  v_fmac_f32 v25, v22, v22
  v_add_f32 v26, v26, v100
  v_fmac_f32 v27, v100, v100
  v_lshlrev_b32 v22, 16, v101
  v_and_b32 v101, 0xffff0000, v101
  v_add_f32 v24, v24, v22
  v_fmac_f32 v25, v22, v22
  v_add_f32 v26, v26, v101
  v_fmac_f32 v27, v101, v101
  v_lshlrev_b32 v22, 16, v102
  v_and_b32 v102, 0xffff0000, v102
  v_add_f32 v24, v24, v22
  v_fmac_f32 v25, v22, v22
  v_add_f32 v26, v26, v102
  v_fmac_f32 v27, v102, v102
  v_lshlrev_b32 v22, 16, v103
  v_and_b32 v103, 0xffff0000, v103
  v_add_f32 v24, v24, v22
  v_fmac_f32 v25, v22, v22
  v_add_f32 v26, v26, v103
  v_fmac_f32 v27, v103, v103
  s_waitcnt vmcnt(5)
  v_lshlrev_b32 v22, 16, v104
  v_and_b32 v104, 0xffff0000, v104
  v_add_f32 v24, v24, v22
  v_fmac_f32 v25, v22, v22
  v_add_f32 v26, v26, v104
  v_fmac_f32 v27, v104, v104
  v_lshlrev_b32 v22, 16, v105
  v_and_b32 v105, 0xffff0000, v105
  v_add_f32 v24, v24, v22
  v_fmac_f32 v25, v22, v22
  v_add_f32 v26, v26, v105
  v_fmac_f32 v27, v105, v105
  v_lshlrev_b32 v22, 16, v106
  v_and_b32 v106, 0xffff0000, v106
  v_add_f32 v24, v24, v22
  v_fmac_f32 v25, v22, v22
  v_add_f32 v26, v26, v106
  v_fmac_f32 v27, v106, v106
  v_lshlrev_b32 v22, 16, v107
  v_and_b32 v107, 0xffff0000, v107
  v_add_f32 v24, v24, v22
  v_fmac_f32 v25, v22, v22
  v_add_f32 v26, v26, v107
  v_fmac_f32 v27, v107, v107
  s_waitcnt vmcnt(4)
  v_lshlrev_b32 v22, 16, v108
  v_and_b32 v108, 0xffff0000, v108
  v_add_f32 v24, v24, v22
  v_fmac_f32 v25, v22, v22
  v_add_f32 v26, v26, v108
  v_fmac_f32 v27, v108, v108
  v_lshlrev_b32 v22, 16, v109
  v_and_b32 v109, 0xffff0000, v109
  v_add_f32 v24, v24, v22
  v_fmac_f32 v25, v22, v22
  v_add_f32 v26, v26, v109
  v_fmac_f32 v27, v109, v109
  v_lshlrev_b32 v22, 16, v110
  v_and_b32 v110, 0xffff0000, v110
  v_add_f32 v24, v24, v22
  v_fmac_f32 v25, v22, v22
  v_add_f32 v26, v26, v110
  v_fmac_f32 v27, v110, v110
  v_lshlrev_b32 v22, 16, v111
  v_and_b32 v111, 0xffff0000, v111
  v_add_f32 v24, v24, v22
  v_fmac_f32 v25, v22, v22
  v_add_f32 v26, v26, v111
  v_fmac_f32 v27, v111, v111
  s_waitcnt vmcnt(3)
  v_lshlrev_b32 v22, 16, v112
  v_and_b32 v112, 0xffff0000, v112
  v_add_f32 v24, v24, v22
  v_fmac_f32 v25, v22, v22
  v_add_f32 v26, v26, v112
  v_fmac_f32 v27, v112, v112
  v_lshlrev_b32 v22, 16, v113
  v_and_b32 v113, 0xffff0000, v113
  v_add_f32 v24, v24, v22
  v_fmac_f32 v25, v22, v22
  v_add_f32 v26, v26, v113
  v_fmac_f32 v27, v113, v113
  v_lshlrev_b32 v22, 16, v114
  v_and_b32 v114, 0xffff0000, v114
  v_add_f32 v24, v24, v22
  v_fmac_f32 v25, v22, v22
  v_add_f32 v26, v26, v114
  v_fmac_f32 v27, v114, v114
  v_lshlrev_b32 v22, 16, v115
  v_and_b32 v115, 0xffff0000, v115
  v_add_f32 v24, v24, v22
  v_fmac_f32 v25, v22, v22
  v_add_f32 v26, v26, v115
  v_fmac_f32 v27, v115, v115
  s_waitcnt vmcnt(2)
  v_lshlrev_b32 v22, 16, v116
  v_and_b32 v116, 0xffff0000, v116
  v_add_f32 v24, v24, v22
  v_fmac_f32 v25, v22, v22
  v_add_f32 v26, v26, v116
  v_fmac_f32 v27, v116, v116
  v_lshlrev_b32 v22, 16, v117
  v_and_b32 v117, 0xffff0000, v117
  v_add_f32 v24, v24, v22
  v_fmac_f32 v25, v22, v22
  v_add_f32 v26, v26, v117
  v_fmac_f32 v27, v117, v117
  v_lshlrev_b32 v22, 16, v118
  v_and_b32 v118, 0xffff0000, v118
  v_add_f32 v24, v24, v22
  v_fmac_f32 v25, v22, v22
  v_add_f32 v26, v26, v118
  v_fmac_f32 v27, v118, v118
  v_lshlrev_b32 v22, 16, v119
  v_and_b32 v119, 0xffff0000, v119
  v_add_f32 v24, v24, v22
  v_fmac_f32 v25, v22, v22
  v_add_f32 v26, v26, v119
  v_fmac_f32 v27, v119, v119
  s_waitcnt vmcnt(1)
  v_lshlrev_b32 v22, 16, v120
  v_and_b32 v120, 0xffff0000, v120
  v_add_f32 v24, v24, v22
  v_fmac_f32 v25, v22, v22
  v_add_f32 v26, v26, v120
  v_fmac_f32 v27, v120, v120
  v_lshlrev_b32 v22, 16, v121
  v_and_b32 v121, 0xffff0000, v121
  v_add_f32 v24, v24, v22
  v_fmac_f32 v25, v22, v22
  v_add_f32 v26, v26, v121
  v_fmac_f32 v27, v121, v121
  v_lshlrev_b32 v22, 16, v122
  v_and_b32 v122, 0xffff0000, v122
  v_add_f32 v24, v24, v22
  v_fmac_f32 v25, v22, v22
  v_add_f32 v26, v26, v122
  v_fmac_f32 v27, v122, v122
  v_lshlrev_b32 v22, 16, v123
  v_and_b32 v123, 0xffff0000, v123
  v_add_f32 v24, v24, v22
  v_fmac_f32 v25, v22, v22
  v_add_f32 v26, v26, v123
  v_fmac_f32 v27, v123, v123
  s_waitcnt vmcnt(0)
  v_lshlrev_b32 v22, 16, v124
  v_and_b32 v124, 0xffff0000, v124
  v_add_f32 v24, v24, v22
  v_fmac_f32 v25, v22, v22
  v_add_f32 v26, v26, v124
  v_fmac_f32 v27, v124, v124
  v_lshlrev_b32 v22, 16, v125
  v_and_b32 v125, 0xffff0000, v125
  v_add_f32 v24, v24, v22
  v_fmac_f32 v25, v22, v22
  v_add_f32 v26, v26, v125
  v_fmac_f32 v27, v125, v125
  v_lshlrev_b32 v22, 16, v126
  v_and_b32 v126, 0xffff0000, v126
  v_add_f32 v24, v24, v22
  v_fmac_f32 v25, v22, v22
  v_add_f32 v26, v26, v126
  v_fmac_f32 v27, v126, v126
  v_lshlrev_b32 v22, 16, v127
  v_and_b32 v127, 0xffff0000, v127
  v_add_f32 v24, v24, v22
  v_fmac_f32 v25, v22, v22
  v_add_f32 v26, v26, v127
  v_fmac_f32 v27, v127, v127
  v_add_f32 v24, v24, v26
  v_add_f32 v25, v25, v27
  s_nop 0
  v_add_f32 v24, v24, v24 quad_perm:[1,0,3,2] row_mask:0xf bank_mask:0xf
  v_add_f32 v25, v25, v25 quad_perm:[1,0,3,2] row_mask:0xf bank_mask:0xf
  s_nop 0
  v_add_f32 v24, v24, v24 quad_perm:[2,3,0,1] row_mask:0xf bank_mask:0xf
  v_add_f32 v25, v25, v25 quad_perm:[2,3,0,1] row_mask:0xf bank_mask:0xf
  s_nop 0
  v_add_f32 v24, v24, v24 row_half_mirror row_mask:0xf bank_mask:0xf
  v_add_f32 v25, v25, v25 row_half_mirror row_mask:0xf bank_mask:0xf
  v_mov_b32 v26, 0.0009765625
  v_mul_f32 v24, v26, v24
  v_mul_f32 v27, v24, v24
  v_fma_f32 v25, v25, v26, -v27
  v_max_f32 v25, 0, v25
  v_add_f32 v25, 1e-05, v25
  v_rsq_f32 v25, v25
  v_lshlrev_b32 v20, 2, v20
  v_mul_f32 v24, v24, v25
  v_sub_f32 v24, 0, v24
  s_add_u32 s33, s33, 0x3070000
  s_add_u32 s34, s33, 0x2000
  s_mov_b32 exec_lo, 0x01010101
  s_mov_b32 exec_hi, 0x01010101
  buffer_store_dword v25, v20, s[4:7], s33 offen sc1
  buffer_store_dword v24, v20, s[4:7], s34 offen sc1
  s_mov_b64 exec, -1
  s_mov_b32 s12, s58
  s_mov_b32 s13, s59
  s_mov_b32 s14, 0x100
  s_mov_b32 s15, 0x00020000
  s_mov_b32 s38, 0
  s_mov_b64 exec, 1
.g2_kernel_gt8:
  buffer_load_dword v6, v4, s[12:15], 0 offen sc1
  s_add_u32 s38, s38, 1
  s_waitcnt vmcnt(0)
  v_cmp_eq_u32 vcc, 0x60, v6
  s_cbranch_vccnz .g2_kernel_gt8d
  s_sleep 8
  s_cmp_lt_u32 s38, 131072
  s_cbranch_scc1 .g2_kernel_gt8
.g2_kernel_gt8d:
  s_mov_b64 exec, -1
  v_mov_b32 v6, s70
  s_mov_b64 exec, 1
  buffer_store_dword v6, v4, s[4:7], s19 offen offset:12 sc1
  s_mov_b64 exec, -1
  v_mov_b32 v6, 155648
  s_mov_b32 s38, 0
.g2_kernel_wg9:
  ds_read_b32 v7, v6 offset:512
  s_add_u32 s38, s38, 1
  s_waitcnt lgkmcnt(0)
  v_cmp_gt_u32 vcc, 22, v7
  s_cbranch_vccz .g2_kernel_wg9d
  s_sleep 4
  s_cmp_lt_u32 s38, 524288
  s_cbranch_scc1 .g2_kernel_wg9
.g2_kernel_wg9d:
  s_and_b32 s31, s19, 0xffffe000
  s_add_u32 s31, s31, 12
  v_and_b32 v6, 15, v2
  v_lshlrev_b32 v6, 9, v6
  v_lshrrev_b32 v7, 4, v2
  v_lshl_add_u32 v6, v7, 7, v6
  v_lshlrev_b32 v7, 2, v2
  v_add_u32 v7, 157952, v7
  s_mov_b32 m0, 157952
  s_mov_b32 s38, 0
  s_bfm_b64 exec, 16, 0
.g2_kernel_pa10:
  buffer_load_dword v6, s[4:7], s31 offen sc1 lds
  s_add_u32 s38, s38, 1
  s_waitcnt vmcnt(0)
  ds_read_b32 v8, v7
  s_waitcnt lgkmcnt(0)
  v_cmp_ge_u32 vcc, s62, v8
  s_cbranch_vccz .g2_kernel_pa10d
  s_mov_b64 exec, vcc
  s_sleep 16
  s_cmp_lt_u32 s38, 131072
  s_cbranch_scc1 .g2_kernel_pa10
.g2_kernel_pa10d:
  s_mov_b64 exec, -1
  s_lshl_b32 s33, s17, 9
  s_add_u32 s33, s33, 0x3070000
  s_add_u32 s34, s33, 0x2000
  s_mov_b32 exec_hi, 0
  s_mov_b32 m0, 158464
  s_nop 0
  buffer_load_dwordx4 v3, s[4:7], s33 offen sc1 lds
  s_mov_b32 m0, 158976
  s_nop 0
  buffer_load_dwordx4 v3, s[4:7], s34 offen sc1 lds
  s_mov_b64 exec, -1
  v_mov_b32 v20, 1.0
  v_mov_b32 v21, 1.0
  v_mov_b32 v22, 0
  v_mov_b32 v23, 0
  v_lshlrev_b32 v24, 3, v2
  v_add_u32 v24, 155648, v24
  v_mov_b32 v6, 155648
  s_mov_b32 s38, 0
.g2_kernel_wg11:
  ds_read_b32 v7, v6 offset:512
  s_add_u32 s38, s38, 1
  s_waitcnt lgkmcnt(0)
  v_cmp_gt_u32 vcc, 32, v7
  s_cbranch_vccz .g2_kernel_wg11d
  s_sleep 2
  s_cmp_lt_u32 s38, 524288
  s_cbranch_scc1 .g2_kernel_wg11
.g2_kernel_wg11d:
  ds_write_b64 v24, v[20:21] offset:3840
  ds_write_b64 v24, v[22:23] offset:4352
  v_lshlrev_b32 v24, 2, v2
  v_add_u32 v24, 155648, v24
  ds_write_b32 v24, v4 offset:2304
  s_waitcnt vmcnt(0)
  v_mov_b32 v6, s71
  s_mov_b64 exec, 1
  ds_add_u32 v6, v5 offset:0
  s_mov_b64 exec, -1
  s_branch .g2_kernel_v
.g2_kernel_s2:
  s_mov_b32 s8, s42
  s_mov_b32 s9, s43
  s_mov_b32 s10, 0x600000
  s_mov_b32 s11, 0x00020000
  v_lshrrev_b32 v20, 3, v2
  v_and_b32 v21, 7, v2
  v_mul_u32_u24 v20, 6144, v20
  v_lshl_add_u32 v20, v21, 4, v20
  s_mul_i32 s30, s17, 393216
  s_lshl_b32 s31, s18, 7
  s_add_u32 s30, s30, s31
  s_add_u32 s31, s30, 4096
  s_barrier
  s_sleep 30
  buffer_load_dwordx4 v[64:67], v20, s[8:11], s30 offen
  buffer_load_dwordx4 v[68:71], v20, s[8:11], s30 offen offset:2048
  buffer_load_dwordx4 v[72:75], v20, s[8:11], s31 offen
  s_add_u32 s30, s30, 49152
  s_add_u32 s31, s31, 49152
  buffer_load_dwordx4 v[76:79], v20, s[8:11], s30 offen
  buffer_load_dwordx4 v[80:83], v20, s[8:11], s30 offen offset:2048
  buffer_load_dwordx4 v[84:87], v20, s[8:11], s31 offen
  s_add_u32 s30, s30, 49152
  s_add_u32 s31, s31, 49152
  buffer_load_dwordx4 v[88:91], v20, s[8:11], s30 offen
  buffer_load_dwordx4 v[92:95], v20, s[8:11], s30 offen offset:2048
  buffer_load_dwordx4 v[96:99], v20, s[8:11], s31 offen
  s_add_u32 s30, s30, 49152
  s_add_u32 s31, s31, 49152
  buffer_load_dwordx4 v[100:103], v20, s[8:11], s30 offen
  buffer_load_dwordx4 v[104:107], v20, s[8:11], s30 offen offset:2048
  buffer_load_dwordx4 v[108:111], v20, s[8:11], s31 offen
  s_add_u32 s30, s30, 49152
  s_add_u32 s31, s31, 49152
  buffer_load_dwordx4 v[112:115], v20, s[8:11], s30 offen
  buffer_load_dwordx4 v[116:119], v20, s[8:11], s30 offen offset:2048
  buffer_load_dwordx4 v[120:123], v20, s[8:11], s31 offen
  s_add_u32 s30, s30, 49152
  s_add_u32 s31, s31, 49152
  buffer_load_dwordx4 v[124:127], v20, s[8:11], s30 offen
  buffer_load_dwordx4 v[128:131], v20, s[8:11], s30 offen offset:2048
  buffer_load_dwordx4 v[132:135], v20, s[8:11], s31 offen
  s_add_u32 s30, s30, 49152
  s_add_u32 s31, s31, 49152
  buffer_load_dwordx4 v[136:139], v20, s[8:11], s30 offen
  buffer_load_dwordx4 v[140:143], v20, s[8:11], s30 offen offset:2048
  buffer_load_dwordx4 v[144:147], v20, s[8:11], s31 offen
  s_add_u32 s30, s30, 49152
  s_add_u32 s31, s31, 49152
  buffer_load_dwordx4 v[148:151], v20, s[8:11], s30 offen
  buffer_load_dwordx4 v[152:155], v20, s[8:11], s30 offen offset:2048
  buffer_load_dwordx4 v[156:159], v20, s[8:11], s31 offen
  s_add_u32 s30, s30, 49152
  s_add_u32 s31, s31, 49152
  v_lshlrev_b32 v21, 5, v21
  v_lshrrev_b32 v22, 5, v2
  v_lshl_add_u32 v21, v22, 4, v21
  v_bfe_u32 v22, v2, 4, 1
  v_lshl_add_u32 v21, v22, 3, v21
  s_lshl_b32 s30, s18, 4
  s_add_u32 s30, s30, s17
  s_mul_i32 s30, s30, 768
  s_add_u32 s30, s30, 0x3080000
  s_waitcnt vmcnt(23)
  v_lshlrev_b32 v160, 16, v64
  v_and_b32 v161, 0xffff0000, v64
  v_lshlrev_b32 v162, 16, v65
  v_and_b32 v163, 0xffff0000, v65
  v_lshlrev_b32 v164, 16, v66
  v_and_b32 v165, 0xffff0000, v66
  v_lshlrev_b32 v166, 16, v67
  v_and_b32 v167, 0xffff0000, v67
  s_waitcnt vmcnt(22)
  v_lshlrev_b32 v168, 16, v68
  v_and_b32 v169, 0xffff0000, v68
  v_lshlrev_b32 v170, 16, v69
  v_and_b32 v171, 0xffff0000, v69
  v_lshlrev_b32 v172, 16, v70
  v_and_b32 v173, 0xffff0000, v70
  v_lshlrev_b32 v174, 16, v71
  v_and_b32 v175, 0xffff0000, v71
  s_waitcnt vmcnt(21)
  v_lshlrev_b32 v176, 16, v72
  v_and_b32 v177, 0xffff0000, v72
  v_lshlrev_b32 v178, 16, v73
  v_and_b32 v179, 0xffff0000, v73
  v_lshlrev_b32 v180, 16, v74
  v_and_b32 v181, 0xffff0000, v74
  v_lshlrev_b32 v182, 16, v75
  v_and_b32 v183, 0xffff0000, v75
  s_waitcnt vmcnt(20)
  v_lshlrev_b32 v184, 16, v76
  v_and_b32 v185, 0xffff0000, v76
  v_lshlrev_b32 v186, 16, v77
  v_and_b32 v187, 0xffff0000, v77
  v_lshlrev_b32 v188, 16, v78
  v_and_b32 v189, 0xffff0000, v78
  v_lshlrev_b32 v190, 16, v79
  v_and_b32 v191, 0xffff0000, v79
  v_add_f32 v160, v160, v184
  v_add_f32 v161, v161, v185
  v_add_f32 v162, v162, v186
  v_add_f32 v163, v163, v187
  v_add_f32 v164, v164, v188
  v_add_f32 v165, v165, v189
  v_add_f32 v166, v166, v190
  v_add_f32 v167, v167, v191
  s_waitcnt vmcnt(19)
  v_lshlrev_b32 v184, 16, v80
  v_and_b32 v185, 0xffff0000, v80
  v_lshlrev_b32 v186, 16, v81
  v_and_b32 v187, 0xffff0000, v81
  v_lshlrev_b32 v188, 16, v82
  v_and_b32 v189, 0xffff0000, v82
  v_lshlrev_b32 v190, 16, v83
  v_and_b32 v191, 0xffff0000, v83
  v_add_f32 v168, v168, v184
  v_add_f32 v169, v169, v185
  v_add_f32 v170, v170, v186
  v_add_f32 v171, v171, v187
  v_add_f32 v172, v172, v188
  v_add_f32 v173, v173, v189
  v_add_f32 v174, v174, v190
  v_add_f32 v175, v175, v191
  s_waitcnt vmcnt(18)
  v_lshlrev_b32 v184, 16, v84
  v_and_b32 v185, 0xffff0000, v84
  v_lshlrev_b32 v186, 16, v85
  v_and_b32 v187, 0xffff0000, v85
  v_lshlrev_b32 v188, 16, v86
  v_and_b32 v189, 0xffff0000, v86
  v_lshlrev_b32 v190, 16, v87
  v_and_b32 v191, 0xffff0000, v87
  v_add_f32 v176, v176, v184
  v_add_f32 v177, v177, v185
  v_add_f32 v178, v178, v186
  v_add_f32 v179, v179, v187
  v_add_f32 v180, v180, v188
  v_add_f32 v181, v181, v189
  v_add_f32 v182, v182, v190
  v_add_f32 v183, v183, v191
  s_waitcnt vmcnt(17)
  v_lshlrev_b32 v184, 16, v88
  v_and_b32 v185, 0xffff0000, v88
  v_lshlrev_b32 v186, 16, v89
  v_and_b32 v187, 0xffff0000, v89
  v_lshlrev_b32 v188, 16, v90
  v_and_b32 v189, 0xffff0000, v90
  v_lshlrev_b32 v190, 16, v91
  v_and_b32 v191, 0xffff0000, v91
  v_add_f32 v160, v160, v184
  v_add_f32 v161, v161, v185
  v_add_f32 v162, v162, v186
  v_add_f32 v163, v163, v187
  v_add_f32 v164, v164, v188
  v_add_f32 v165, v165, v189
  v_add_f32 v166, v166, v190
  v_add_f32 v167, v167, v191
  s_waitcnt vmcnt(16)
  v_lshlrev_b32 v184, 16, v92
  v_and_b32 v185, 0xffff0000, v92
  v_lshlrev_b32 v186, 16, v93
  v_and_b32 v187, 0xffff0000, v93
  v_lshlrev_b32 v188, 16, v94
  v_and_b32 v189, 0xffff0000, v94
  v_lshlrev_b32 v190, 16, v95
  v_and_b32 v191, 0xffff0000, v95
  v_add_f32 v168, v168, v184
  v_add_f32 v169, v169, v185
  v_add_f32 v170, v170, v186
  v_add_f32 v171, v171, v187
  v_add_f32 v172, v172, v188
  v_add_f32 v173, v173, v189
  v_add_f32 v174, v174, v190
  v_add_f32 v175, v175, v191
  s_waitcnt vmcnt(15)
  v_lshlrev_b32 v184, 16, v96
  v_and_b32 v185, 0xffff0000, v96
  v_lshlrev_b32 v186, 16, v97
  v_and_b32 v187, 0xffff0000, v97
  v_lshlrev_b32 v188, 16, v98
  v_and_b32 v189, 0xffff0000, v98
  v_lshlrev_b32 v190, 16, v99
  v_and_b32 v191, 0xffff0000, v99
  v_add_f32 v176, v176, v184
  v_add_f32 v177, v177, v185
  v_add_f32 v178, v178, v186
  v_add_f32 v179, v179, v187
  v_add_f32 v180, v180, v188
  v_add_f32 v181, v181, v189
  v_add_f32 v182, v182, v190
  v_add_f32 v183, v183, v191
  s_waitcnt vmcnt(14)
  v_lshlrev_b32 v184, 16, v100
  v_and_b32 v185, 0xffff0000, v100
  v_lshlrev_b32 v186, 16, v101
  v_and_b32 v187, 0xffff0000, v101
  v_lshlrev_b32 v188, 16, v102
  v_and_b32 v189, 0xffff0000, v102
  v_lshlrev_b32 v190, 16, v103
  v_and_b32 v191, 0xffff0000, v103
  v_add_f32 v160, v160, v184
  v_add_f32 v161, v161, v185
  v_add_f32 v162, v162, v186
  v_add_f32 v163, v163, v187
  v_add_f32 v164, v164, v188
  v_add_f32 v165, v165, v189
  v_add_f32 v166, v166, v190
  v_add_f32 v167, v167, v191
  s_waitcnt vmcnt(13)
  v_lshlrev_b32 v184, 16, v104
  v_and_b32 v185, 0xffff0000, v104
  v_lshlrev_b32 v186, 16, v105
  v_and_b32 v187, 0xffff0000, v105
  v_lshlrev_b32 v188, 16, v106
  v_and_b32 v189, 0xffff0000, v106
  v_lshlrev_b32 v190, 16, v107
  v_and_b32 v191, 0xffff0000, v107
  v_add_f32 v168, v168, v184
  v_add_f32 v169, v169, v185
  v_add_f32 v170, v170, v186
  v_add_f32 v171, v171, v187
  v_add_f32 v172, v172, v188
  v_add_f32 v173, v173, v189
  v_add_f32 v174, v174, v190
  v_add_f32 v175, v175, v191
  s_waitcnt vmcnt(12)
  v_lshlrev_b32 v184, 16, v108
  v_and_b32 v185, 0xffff0000, v108
  v_lshlrev_b32 v186, 16, v109
  v_and_b32 v187, 0xffff0000, v109
  v_lshlrev_b32 v188, 16, v110
  v_and_b32 v189, 0xffff0000, v110
  v_lshlrev_b32 v190, 16, v111
  v_and_b32 v191, 0xffff0000, v111
  v_add_f32 v176, v176, v184
  v_add_f32 v177, v177, v185
  v_add_f32 v178, v178, v186
  v_add_f32 v179, v179, v187
  v_add_f32 v180, v180, v188
  v_add_f32 v181, v181, v189
  v_add_f32 v182, v182, v190
  v_add_f32 v183, v183, v191
  s_waitcnt vmcnt(11)
  v_lshlrev_b32 v184, 16, v112
  v_and_b32 v185, 0xffff0000, v112
  v_lshlrev_b32 v186, 16, v113
  v_and_b32 v187, 0xffff0000, v113
  v_lshlrev_b32 v188, 16, v114
  v_and_b32 v189, 0xffff0000, v114
  v_lshlrev_b32 v190, 16, v115
  v_and_b32 v191, 0xffff0000, v115
  v_add_f32 v160, v160, v184
  v_add_f32 v161, v161, v185
  v_add_f32 v162, v162, v186
  v_add_f32 v163, v163, v187
  v_add_f32 v164, v164, v188
  v_add_f32 v165, v165, v189
  v_add_f32 v166, v166, v190
  v_add_f32 v167, v167, v191
  s_waitcnt vmcnt(10)
  v_lshlrev_b32 v184, 16, v116
  v_and_b32 v185, 0xffff0000, v116
  v_lshlrev_b32 v186, 16, v117
  v_and_b32 v187, 0xffff0000, v117
  v_lshlrev_b32 v188, 16, v118
  v_and_b32 v189, 0xffff0000, v118
  v_lshlrev_b32 v190, 16, v119
  v_and_b32 v191, 0xffff0000, v119
  v_add_f32 v168, v168, v184
  v_add_f32 v169, v169, v185
  v_add_f32 v170, v170, v186
  v_add_f32 v171, v171, v187
  v_add_f32 v172, v172, v188
  v_add_f32 v173, v173, v189
  v_add_f32 v174, v174, v190
  v_add_f32 v175, v175, v191
  s_waitcnt vmcnt(9)
  v_lshlrev_b32 v184, 16, v120
  v_and_b32 v185, 0xffff0000, v120
  v_lshlrev_b32 v186, 16, v121
  v_and_b32 v187, 0xffff0000, v121
  v_lshlrev_b32 v188, 16, v122
  v_and_b32 v189, 0xffff0000, v122
  v_lshlrev_b32 v190, 16, v123
  v_and_b32 v191, 0xffff0000, v123
  v_add_f32 v176, v176, v184
  v_add_f32 v177, v177, v185
  v_add_f32 v178, v178, v186
  v_add_f32 v179, v179, v187
  v_add_f32 v180, v180, v188
  v_add_f32 v181, v181, v189
  v_add_f32 v182, v182, v190
  v_add_f32 v183, v183, v191
  s_waitcnt vmcnt(8)
  v_lshlrev_b32 v184, 16, v124
  v_and_b32 v185, 0xffff0000, v124
  v_lshlrev_b32 v186, 16, v125
  v_and_b32 v187, 0xffff0000, v125
  v_lshlrev_b32 v188, 16, v126
  v_and_b32 v189, 0xffff0000, v126
  v_lshlrev_b32 v190, 16, v127
  v_and_b32 v191, 0xffff0000, v127
  v_add_f32 v160, v160, v184
  v_add_f32 v161, v161, v185
  v_add_f32 v162, v162, v186
  v_add_f32 v163, v163, v187
  v_add_f32 v164, v164, v188
  v_add_f32 v165, v165, v189
  v_add_f32 v166, v166, v190
  v_add_f32 v167, v167, v191
  s_waitcnt vmcnt(7)
  v_lshlrev_b32 v184, 16, v128
  v_and_b32 v185, 0xffff0000, v128
  v_lshlrev_b32 v186, 16, v129
  v_and_b32 v187, 0xffff0000, v129
  v_lshlrev_b32 v188, 16, v130
  v_and_b32 v189, 0xffff0000, v130
  v_lshlrev_b32 v190, 16, v131
  v_and_b32 v191, 0xffff0000, v131
  v_add_f32 v168, v168, v184
  v_add_f32 v169, v169, v185
  v_add_f32 v170, v170, v186
  v_add_f32 v171, v171, v187
  v_add_f32 v172, v172, v188
  v_add_f32 v173, v173, v189
  v_add_f32 v174, v174, v190
  v_add_f32 v175, v175, v191
  s_waitcnt vmcnt(6)
  v_lshlrev_b32 v184, 16, v132
  v_and_b32 v185, 0xffff0000, v132
  v_lshlrev_b32 v186, 16, v133
  v_and_b32 v187, 0xffff0000, v133
  v_lshlrev_b32 v188, 16, v134
  v_and_b32 v189, 0xffff0000, v134
  v_lshlrev_b32 v190, 16, v135
  v_and_b32 v191, 0xffff0000, v135
  v_add_f32 v176, v176, v184
  v_add_f32 v177, v177, v185
  v_add_f32 v178, v178, v186
  v_add_f32 v179, v179, v187
  v_add_f32 v180, v180, v188
  v_add_f32 v181, v181, v189
  v_add_f32 v182, v182, v190
  v_add_f32 v183, v183, v191
  s_waitcnt vmcnt(5)
  v_lshlrev_b32 v184, 16, v136
  v_and_b32 v185, 0xffff0000, v136
  v_lshlrev_b32 v186, 16, v137
  v_and_b32 v187, 0xffff0000, v137
  v_lshlrev_b32 v188, 16, v138
  v_and_b32 v189, 0xffff0000, v138
  v_lshlrev_b32 v190, 16, v139
  v_and_b32 v191, 0xffff0000, v139
  v_add_f32 v160, v160, v184
  v_add_f32 v161, v161, v185
  v_add_f32 v162, v162, v186
  v_add_f32 v163, v163, v187
  v_add_f32 v164, v164, v188
  v_add_f32 v165, v165, v189
  v_add_f32 v166, v166, v190
  v_add_f32 v167, v167, v191
  s_waitcnt vmcnt(4)
  v_lshlrev_b32 v184, 16, v140
  v_and_b32 v185, 0xffff0000, v140
  v_lshlrev_b32 v186, 16, v141
  v_and_b32 v187, 0xffff0000, v141
  v_lshlrev_b32 v188, 16, v142
  v_and_b32 v189, 0xffff0000, v142
  v_lshlrev_b32 v190, 16, v143
  v_and_b32 v191, 0xffff0000, v143
  v_add_f32 v168, v168, v184
  v_add_f32 v169, v169, v185
  v_add_f32 v170, v170, v186
  v_add_f32 v171, v171, v187
  v_add_f32 v172, v172, v188
  v_add_f32 v173, v173, v189
  v_add_f32 v174, v174, v190
  v_add_f32 v175, v175, v191
  s_waitcnt vmcnt(3)
  v_lshlrev_b32 v184, 16, v144
  v_and_b32 v185, 0xffff0000, v144
  v_lshlrev_b32 v186, 16, v145
  v_and_b32 v187, 0xffff0000, v145
  v_lshlrev_b32 v188, 16, v146
  v_and_b32 v189, 0xffff0000, v146
  v_lshlrev_b32 v190, 16, v147
  v_and_b32 v191, 0xffff0000, v147
  v_add_f32 v176, v176, v184
  v_add_f32 v177, v177, v185
  v_add_f32 v178, v178, v186
  v_add_f32 v179, v179, v187
  v_add_f32 v180, v180, v188
  v_add_f32 v181, v181, v189
  v_add_f32 v182, v182, v190
  v_add_f32 v183, v183, v191
  s_waitcnt vmcnt(2)
  v_lshlrev_b32 v184, 16, v148
  v_and_b32 v185, 0xffff0000, v148
  v_lshlrev_b32 v186, 16, v149
  v_and_b32 v187, 0xffff0000, v149
  v_lshlrev_b32 v188, 16, v150
  v_and_b32 v189, 0xffff0000, v150
  v_lshlrev_b32 v190, 16, v151
  v_and_b32 v191, 0xffff0000, v151
  v_add_f32 v160, v160, v184
  v_add_f32 v161, v161, v185
  v_add_f32 v162, v162, v186
  v_add_f32 v163, v163, v187
  v_add_f32 v164, v164, v188
  v_add_f32 v165, v165, v189
  v_add_f32 v166, v166, v190
  v_add_f32 v167, v167, v191
  s_waitcnt vmcnt(1)
  v_lshlrev_b32 v184, 16, v152
  v_and_b32 v185, 0xffff0000, v152
  v_lshlrev_b32 v186, 16, v153
  v_and_b32 v187, 0xffff0000, v153
  v_lshlrev_b32 v188, 16, v154
  v_and_b32 v189, 0xffff0000, v154
  v_lshlrev_b32 v190, 16, v155
  v_and_b32 v191, 0xffff0000, v155
  v_add_f32 v168, v168, v184
  v_add_f32 v169, v169, v185
  v_add_f32 v170, v170, v186
  v_add_f32 v171, v171, v187
  v_add_f32 v172, v172, v188
  v_add_f32 v173, v173, v189
  v_add_f32 v174, v174, v190
  v_add_f32 v175, v175, v191
  s_waitcnt vmcnt(0)
  v_lshlrev_b32 v184, 16, v156
  v_and_b32 v185, 0xffff0000, v156
  v_lshlrev_b32 v186, 16, v157
  v_and_b32 v187, 0xffff0000, v157
  v_lshlrev_b32 v188, 16, v158
  v_and_b32 v189, 0xffff0000, v158
  v_lshlrev_b32 v190, 16, v159
  v_and_b32 v191, 0xffff0000, v159
  v_add_f32 v176, v176, v184
  v_add_f32 v177, v177, v185
  v_add_f32 v178, v178, v186
  v_add_f32 v179, v179, v187
  v_add_f32 v180, v180, v188
  v_add_f32 v181, v181, v189
  v_add_f32 v182, v182, v190
  v_add_f32 v183, v183, v191
  v_permlane32_swap_b32 v160, v164
  v_permlane32_swap_b32 v161, v165
  v_permlane32_swap_b32 v162, v166
  v_permlane32_swap_b32 v163, v167
  v_add_f32 v160, v160, v164
  v_add_f32 v161, v161, v165
  v_add_f32 v162, v162, v166
  v_add_f32 v163, v163, v167
  s_nop 0
  v_permlane16_swap_b32 v160, v162
  v_permlane16_swap_b32 v161, v163
  v_add_f32 v160, v160, v162
  v_add_f32 v161, v161, v163
  s_nop 0
  v_add_f32 v160, v160, v160 row_ror:8 row_mask:0xf bank_mask:0xf
  v_add_f32 v161, v161, v161 row_ror:8 row_mask:0xf bank_mask:0xf
  v_permlane32_swap_b32 v168, v172
  v_permlane32_swap_b32 v169, v173
  v_permlane32_swap_b32 v170, v174
  v_permlane32_swap_b32 v171, v175
  v_add_f32 v168, v168, v172
  v_add_f32 v169, v169, v173
  v_add_f32 v170, v170, v174
  v_add_f32 v171, v171, v175
  s_nop 0
  v_permlane16_swap_b32 v168, v170
  v_permlane16_swap_b32 v169, v171
  v_add_f32 v168, v168, v170
  v_add_f32 v169, v169, v171
  s_nop 0
  v_add_f32 v168, v168, v168 row_ror:8 row_mask:0xf bank_mask:0xf
  v_add_f32 v169, v169, v169 row_ror:8 row_mask:0xf bank_mask:0xf
  v_permlane32_swap_b32 v176, v180
  v_permlane32_swap_b32 v177, v181
  v_permlane32_swap_b32 v178, v182
  v_permlane32_swap_b32 v179, v183
  v_add_f32 v176, v176, v180
  v_add_f32 v177, v177, v181
  v_add_f32 v178, v178, v182
  v_add_f32 v179, v179, v183
  s_nop 0
  v_permlane16_swap_b32 v176, v178
  v_permlane16_swap_b32 v177, v179
  v_add_f32 v176, v176, v178
  v_add_f32 v177, v177, v179
  s_nop 0
  v_add_f32 v176, v176, v176 row_ror:8 row_mask:0xf bank_mask:0xf
  v_add_f32 v177, v177, v177 row_ror:8 row_mask:0xf bank_mask:0xf
  s_mov_b32 exec_lo, 0x00ff00ff
  s_mov_b32 exec_hi, 0x00ff00ff
  buffer_store_dwordx2 v[160:161], v21, s[4:7], s30 offen offset:0 sc1
  buffer_store_dwordx2 v[168:169], v21, s[4:7], s30 offen offset:256 sc1
  buffer_store_dwordx2 v[176:177], v21, s[4:7], s30 offen offset:512 sc1
  s_mov_b64 exec, -1
  s_mov_b32 s12, s58
  s_mov_b32 s13, s59
  s_mov_b32 s14, 0x100
  s_mov_b32 s15, 0x00020000
  s_mov_b32 s38, 0
  s_mov_b64 exec, 1
.g2_kernel_gt12:
  buffer_load_dword v6, v4, s[12:15], 0 offen sc1
  s_add_u32 s38, s38, 1
  s_waitcnt vmcnt(0)
  v_cmp_eq_u32 vcc, 0x60, v6
  s_cbranch_vccnz .g2_kernel_gt12d
  s_sleep 8
  s_cmp_lt_u32 s38, 131072
  s_cbranch_scc1 .g2_kernel_gt12
.g2_kernel_gt12d:
  s_mov_b64 exec, -1
  v_mov_b32 v6, s70
  s_mov_b64 exec, 1
  buffer_store_dword v6, v4, s[4:7], s76 offen offset:4 sc1
  s_mov_b64 exec, -1
  v_mov_b32 v6, 155648
  s_mov_b32 s38, 0
.g2_kernel_wg13:
  ds_read_b32 v7, v6 offset:512
  s_add_u32 s38, s38, 1
  s_waitcnt lgkmcnt(0)
  v_cmp_gt_u32 vcc, 22, v7
  s_cbranch_vccz .g2_kernel_wg13d
  s_sleep 4
  s_cmp_lt_u32 s38, 524288
  s_cbranch_scc1 .g2_kernel_wg13
.g2_kernel_wg13d:
  s_and_b32 s31, s76, 0xffffe000
  s_add_u32 s31, s31, 4
  v_and_b32 v6, 15, v2
  v_lshlrev_b32 v6, 9, v6
  v_lshrrev_b32 v7, 4, v2
  v_lshl_add_u32 v6, v7, 7, v6
  v_lshlrev_b32 v7, 2, v2
  v_add_u32 v7, 157696, v7
  s_mov_b32 m0, 157696
  s_mov_b32 s38, 0
  s_bfm_b64 exec, 16, 0
.g2_kernel_pa14:
  buffer_load_dword v6, s[4:7], s31 offen sc1 lds
  s_add_u32 s38, s38, 1
  s_waitcnt vmcnt(0)
  ds_read_b32 v8, v7
  s_waitcnt lgkmcnt(0)
  v_cmp_ge_u32 vcc, s62, v8
  s_cbranch_vccz .g2_kernel_pa14d
  s_mov_b64 exec, vcc
  s_sleep 16
  s_cmp_lt_u32 s38, 131072
  s_cbranch_scc1 .g2_kernel_pa14
.g2_kernel_pa14d:
  s_mov_b64 exec, -1
  s_mul_i32 s30, s18, 12288
  s_add_u32 s30, s30, 0x3080000
  s_mov_b32 exec_hi, 0xffff
  buffer_load_dwordx4 v[64:67], v3, s[4:7], s30 offen offset:0 sc1
  buffer_load_dwordx4 v[68:71], v3, s[4:7], s30 offen offset:768 sc1
  buffer_load_dwordx4 v[72:75], v3, s[4:7], s30 offen offset:1536 sc1
  buffer_load_dwordx4 v[76:79], v3, s[4:7], s30 offen offset:2304 sc1
  s_add_u32 s30, s30, 3072
  buffer_load_dwordx4 v[80:83], v3, s[4:7], s30 offen offset:0 sc1
  buffer_load_dwordx4 v[84:87], v3, s[4:7], s30 offen offset:768 sc1
  buffer_load_dwordx4 v[88:91], v3, s[4:7], s30 offen offset:1536 sc1
  buffer_load_dwordx4 v[92:95], v3, s[4:7], s30 offen offset:2304 sc1
  s_add_u32 s30, s30, 3072
  buffer_load_dwordx4 v[96:99], v3, s[4:7], s30 offen offset:0 sc1
  buffer_load_dwordx4 v[100:103], v3, s[4:7], s30 offen offset:768 sc1
  buffer_load_dwordx4 v[104:107], v3, s[4:7], s30 offen offset:1536 sc1
  buffer_load_dwordx4 v[108:111], v3, s[4:7], s30 offen offset:2304 sc1
  s_add_u32 s30, s30, 3072
  buffer_load_dwordx4 v[112:115], v3, s[4:7], s30 offen offset:0 sc1
  buffer_load_dwordx4 v[116:119], v3, s[4:7], s30 offen offset:768 sc1
  buffer_load_dwordx4 v[120:123], v3, s[4:7], s30 offen offset:1536 sc1
  buffer_load_dwordx4 v[124:127], v3, s[4:7], s30 offen offset:2304 sc1
  s_add_u32 s30, s30, 3072
  s_waitcnt vmcnt(14)
  v_add_f32 v64, v64, v68
  v_add_f32 v65, v65, v69
  v_add_f32 v66, v66, v70
  v_add_f32 v67, v67, v71
  s_waitcnt vmcnt(13)
  v_add_f32 v64, v64, v72
  v_add_f32 v65, v65, v73
  v_add_f32 v66, v66, v74
  v_add_f32 v67, v67, v75
  s_waitcnt vmcnt(12)
  v_add_f32 v64, v64, v76
  v_add_f32 v65, v65, v77
  v_add_f32 v66, v66, v78
  v_add_f32 v67, v67, v79
  s_waitcnt vmcnt(11)
  v_add_f32 v64, v64, v80
  v_add_f32 v65, v65, v81
  v_add_f32 v66, v66, v82
  v_add_f32 v67, v67, v83
  s_waitcnt vmcnt(10)
  v_add_f32 v64, v64, v84
  v_add_f32 v65, v65, v85
  v_add_f32 v66, v66, v86
  v_add_f32 v67, v67, v87
  s_waitcnt vmcnt(9)
  v_add_f32 v64, v64, v88
  v_add_f32 v65, v65, v89
  v_add_f32 v66, v66, v90
  v_add_f32 v67, v67, v91
  s_waitcnt vmcnt(8)
  v_add_f32 v64, v64, v92
  v_add_f32 v65, v65, v93
  v_add_f32 v66, v66, v94
  v_add_f32 v67, v67, v95
  s_waitcnt vmcnt(7)
  v_add_f32 v64, v64, v96
  v_add_f32 v65, v65, v97
  v_add_f32 v66, v66, v98
  v_add_f32 v67, v67, v99
  s_waitcnt vmcnt(6)
  v_add_f32 v64, v64, v100
  v_add_f32 v65, v65, v101
  v_add_f32 v66, v66, v102
  v_add_f32 v67, v67, v103
  s_waitcnt vmcnt(5)
  v_add_f32 v64, v64, v104
  v_add_f32 v65, v65, v105
  v_add_f32 v66, v66, v106
  v_add_f32 v67, v67, v107
  s_waitcnt vmcnt(4)
  v_add_f32 v64, v64, v108
  v_add_f32 v65, v65, v109
  v_add_f32 v66, v66, v110
  v_add_f32 v67, v67, v111
  s_waitcnt vmcnt(3)
  v_add_f32 v64, v64, v112
  v_add_f32 v65, v65, v113
  v_add_f32 v66, v66, v114
  v_add_f32 v67, v67, v115
  s_waitcnt vmcnt(2)
  v_add_f32 v64, v64, v116
  v_add_f32 v65, v65, v117
  v_add_f32 v66, v66, v118
  v_add_f32 v67, v67, v119
  s_waitcnt vmcnt(1)
  v_add_f32 v64, v64, v120
  v_add_f32 v65, v65, v121
  v_add_f32 v66, v66, v122
  v_add_f32 v67, v67, v123
  s_waitcnt vmcnt(0)
  v_add_f32 v64, v64, v124
  v_add_f32 v65, v65, v125
  v_add_f32 v66, v66, v126
  v_add_f32 v67, v67, v127
  s_mov_b64 exec, -1
  v_mov_b32 v6, 155648
  s_mov_b32 s38, 0
.g2_kernel_wg15:
  ds_read_b32 v7, v6 offset:512
  s_add_u32 s38, s38, 1
  s_waitcnt lgkmcnt(0)
  v_cmp_gt_u32 vcc, 32, v7
  s_cbranch_vccz .g2_kernel_wg15d
  s_sleep 2
  s_cmp_lt_u32 s38, 524288
  s_cbranch_scc1 .g2_kernel_wg15
.g2_kernel_wg15d:
  v_lshlrev_b32 v24, 2, v2
  v_add_u32 v24, 155648, v24
  ds_write_b32 v24, v4 offset:2048
  v_add_u32 v24, 155648, v3
  s_mov_b32 exec_hi, 0xffff
  ds_write_b128 v24, v[64:67] offset:4864
  s_mov_b64 exec, -1
  v_mov_b32 v6, s71
  s_mov_b64 exec, 1
  ds_add_u32 v6, v5 offset:0
  s_mov_b64 exec, -1
  s_branch .g2_kernel_v
.g2_kernel_s3:
  s_mov_b32 s12, s58
  s_mov_b32 s13, s59
  s_mov_b32 s14, 0x100
  s_mov_b32 s15, 0x00020000
  s_mov_b32 s20, s48
  s_mov_b32 s21, s49
  s_mov_b32 s22, 0x800
  s_mov_b32 s23, 0x00020000
  v_mov_b32 v12, 0
  v_mov_b32 v13, 0
  v_mov_b32 v14, 0
  v_mov_b32 v15, 0
  s_cmp_ge_u32 s2, 96
  s_cbranch_scc1 .g2_kernel_zm16
  s_lshl_b32 s36, s2, 12
  s_add_u32 s36, s36, 0x3000000
  buffer_store_dwordx4 v[12:15], v3, s[4:7], s36 offen sc1
  buffer_store_dwordx4 v[12:15], v3, s[4:7], s36 offen offset:1024 sc1
  buffer_store_dwordx4 v[12:15], v3, s[4:7], s36 offen offset:2048 sc1
  buffer_store_dwordx4 v[12:15], v3, s[4:7], s36 offen offset:3072 sc1
.g2_kernel_zm16:
  s_barrier
  s_cbranch_scc1 .g2_kernel_zm16b
  s_mov_b64 exec, 1
  s_waitcnt vmcnt(0)
  buffer_atomic_add v5, v4, s[12:15], 0 offen sc1
  s_mov_b64 exec, -1
.g2_kernel_zm16b:
  s_and_b32 s36, s18, 7
  s_cmp_ge_u32 s36, 3
  s_cbranch_scc1 .g2_kernel_c317
  s_mov_b32 s24, s42
  s_mov_b32 s25, s43
  s_mov_b32 s26, 0x600000
  s_mov_b32 s27, 0x00020000
  v_mul_u32_u24 v7, 6144, v2
  s_lshl_b32 s36, s36, 11
  s_or_b32 s37, s18, 3
  s_lshl_b32 s37, s37, 7
  s_add_u32 s36, s36, s37
  s_and_b32 s37, s17, 7
  s_mul_i32 s37, s37, 393216
  s_add_u32 s36, s36, s37
  s_add_u32 s37, s36, 3145728
  s_sleep 0
  buffer_load_dword v1, v7, s[24:27], s36 offen
  s_sleep 30
  buffer_load_dword v1, v7, s[24:27], s37 offen
.g2_kernel_c317:
  v_lshlrev_b32 v20, 5, v2
  buffer_load_dwordx4 v[24:27], v20, s[20:23], 0 offen
  buffer_load_dwordx4 v[28:31], v20, s[20:23], 0 offen offset:16
  v_mov_b32 v20, 0
  s_waitcnt vmcnt(0)
  v_lshlrev_b32 v21, 16, v24
  v_and_b32 v22, 0xffff0000, v24
  v_add_f32 v20, v20, v21
  v_add_f32 v20, v20, v22
  v_lshlrev_b32 v21, 16, v25
  v_and_b32 v22, 0xffff0000, v25
  v_add_f32 v20, v20, v21
  v_add_f32 v20, v20, v22
  v_lshlrev_b32 v21, 16, v26
  v_and_b32 v22, 0xffff0000, v26
  v_add_f32 v20, v20, v21
  v_add_f32 v20, v20, v22
  v_lshlrev_b32 v21, 16, v27
  v_and_b32 v22, 0xffff0000, v27
  v_add_f32 v20, v20, v21
  v_add_f32 v20, v20, v22
  v_lshlrev_b32 v21, 16, v28
  v_and_b32 v22, 0xffff0000, v28
  v_add_f32 v20, v20, v21
  v_add_f32 v20, v20, v22
  v_lshlrev_b32 v21, 16, v29
  v_and_b32 v22, 0xffff0000, v29
  v_add_f32 v20, v20, v21
  v_add_f32 v20, v20, v22
  v_lshlrev_b32 v21, 16, v30
  v_and_b32 v22, 0xffff0000, v30
  v_add_f32 v20, v20, v21
  v_add_f32 v20, v20, v22
  v_lshlrev_b32 v21, 16, v31
  v_and_b32 v22, 0xffff0000, v31
  v_add_f32 v20, v20, v21
  v_add_f32 v20, v20, v22
  s_nop 1
  v_add_f32 v20, v20, v20 quad_perm:[1,0,3,2] row_mask:0xf bank_mask:0xf
  s_nop 1
  v_add_f32 v20, v20, v20 quad_perm:[2,3,0,1] row_mask:0xf bank_mask:0xf
  s_nop 1
  v_add_f32 v20, v20, v20 row_half_mirror row_mask:0xf bank_mask:0xf
  s_nop 1
  v_add_f32 v20, v20, v20 row_mirror row_mask:0xf bank_mask:0xf
  s_nop 0
  v_readlane_b32 s20, v20, 16
  v_readlane_b32 s21, v20, 32
  v_readlane_b32 s22, v20, 48
  v_add_f32 v20, s20, v20
  v_add_f32 v20, s21, v20
  v_add_f32 v20, s22, v20
  v_mul_f32 v20, 0x3a800000, v20
  v_mov_b32 v6, 155648
  s_mov_b32 s38, 0
.g2_kernel_wg18:
  ds_read_b32 v7, v6 offset:512
  s_add_u32 s38, s38, 1
  s_waitcnt lgkmcnt(0)
  v_cmp_gt_u32 vcc, 32, v7
  s_cbranch_vccz .g2_kernel_wg18d
  s_sleep 2
  s_cmp_lt_u32 s38, 524288
  s_cbranch_scc1 .g2_kernel_wg18
.g2_kernel_wg18d:
  v_mov_b32 v21, 155648
  s_mov_b64 exec, 1
  ds_write_b32 v21, v20 offset:256
  s_mov_b64 exec, -1
.g2_kernel_v:
  s_setprio 3
  s_cmp_lg_u32 s16, 4
  s_cbranch_scc1 .g2_kernel_v_1
  v_mov_b32 v6, s71
  s_mov_b32 s38, 0
.g2_kernel_wg19:
  ds_read_b32 v7, v6 offset:120
  s_add_u32 s38, s38, 1
  s_waitcnt lgkmcnt(0)
  v_cmp_gt_u32 vcc, 2, v7
  s_cbranch_vccz .g2_kernel_wg19d
  s_sleep 1
  s_cmp_lt_u32 s38, 524288
  s_cbranch_scc1 .g2_kernel_wg19
.g2_kernel_wg19d:
  s_sleep 4
  s_and_b32 s31, s76, 0xffffe000
  s_add_u32 s31, s31, 0
  v_and_b32 v6, 15, v2
  v_lshlrev_b32 v6, 9, v6
  v_lshrrev_b32 v7, 4, v2
  v_lshl_add_u32 v6, v7, 7, v6
  v_lshlrev_b32 v7, 2, v2
  v_add_u32 v7, 157440, v7
  s_mov_b32 m0, 157440
  s_mov_b32 s38, 0
  s_mov_b32 exec_lo, 0xffff
  s_mov_b32 exec_hi, 0xffff
.g2_kernel_pa20:
  buffer_load_dword v6, s[4:7], s31 offen sc1 lds
  s_add_u32 s38, s38, 1
  s_waitcnt vmcnt(0)
  ds_read_b32 v8, v7
  s_waitcnt lgkmcnt(0)
  v_cmp_ge_u32 vcc, s62, v8
  s_cbranch_vccz .g2_kernel_pa20d
  s_mov_b64 exec, vcc
  s_sleep 2
  s_cmp_lt_u32 s38, 131072
  s_cbranch_scc1 .g2_kernel_pa20
.g2_kernel_pa20d:
  s_mov_b64 exec, -1
  v_mov_b32 v6, s71
  s_mov_b32 s38, 0
.g2_kernel_wg21:
  ds_read_b32 v7, v6 offset:4
  s_add_u32 s38, s38, 1
  s_waitcnt lgkmcnt(0)
  v_cmp_gt_u32 vcc, 4, v7
  s_cbranch_vccz .g2_kernel_wg21d
  s_sleep 2
  s_cmp_lt_u32 s38, 524288
  s_cbranch_scc1 .g2_kernel_wg21
.g2_kernel_wg21d:
  v_mov_b32 v6, s71
  s_mov_b64 exec, 1
  ds_add_u32 v6, v5 offset:80
  s_mov_b64 exec, -1
.g2_kernel_v_1:
  s_cmp_lt_u32 s16, 6
  s_cbranch_scc1 .g2_kernel_v_2
  v_mov_b32 v6, s71
  s_mov_b32 s38, 0
.g2_kernel_wg22:
  ds_read_b32 v7, v6 offset:4
  s_add_u32 s38, s38, 1
  s_waitcnt lgkmcnt(0)
  v_cmp_gt_u32 vcc, 4, v7
  s_cbranch_vccz .g2_kernel_wg22d
  s_sleep 4
  s_cmp_lt_u32 s38, 524288
  s_cbranch_scc1 .g2_kernel_wg22
.g2_kernel_wg22d:
  s_and_b32 s28, s16, 1
  s_lshl_b32 s30, s28, 13
  s_add_u32 s31, s30, 16384
  v_add_u32 v8, s31, v3
  ds_read_b32 v9, v6 offset:24
  ds_read_b128 v[16:19], v8 offset:0
  ds_read_b128 v[20:23], v8 offset:1024
  ds_read_b128 v[24:27], v8 offset:2048
  ds_read_b128 v[28:31], v8 offset:3072
  ds_read_b128 v[32:35], v8 offset:4096
  ds_read_b128 v[36:39], v8 offset:5120
  ds_read_b128 v[40:43], v8 offset:6144
  ds_read_b128 v[44:47], v8 offset:7168
  s_lshl_b32 s31, s18, 5
  s_add_u32 s31, s31, s17
  s_add_u32 s31, s31, 16
  s_lshl_b32 s31, s31, 14
  s_add_u32 s30, s30, s31
  s_add_u32 s30, s30, s63
  s_add_u32 s31, s30, 4096
  s_lshl_b32 s33, s28, 8
  s_add_u32 s33, s33, 128
  s_waitcnt lgkmcnt(0)
  v_readfirstlane_b32 s29, v9
  v_mov_b32 v6, s71
  s_mov_b64 exec, 1
  ds_add_u32 v6, v5 offset:8
  s_mov_b64 exec, -1
  s_sleep 40
  buffer_store_dwordx4 v[16:19], v3, s[4:7], s30 offen offset:0 sc1
  s_sleep 4
  buffer_store_dwordx4 v[20:23], v3, s[4:7], s30 offen offset:1024 sc1
  s_sleep 4
  buffer_store_dwordx4 v[24:27], v3, s[4:7], s30 offen offset:2048 sc1
  s_sleep 4
  buffer_store_dwordx4 v[28:31], v3, s[4:7], s30 offen offset:3072 sc1
  s_sleep 4
  buffer_store_dwordx4 v[32:35], v3, s[4:7], s31 offen offset:0 sc1
  s_sleep 4
  buffer_store_dwordx4 v[36:39], v3, s[4:7], s31 offen offset:1024 sc1
  s_sleep 4
  buffer_store_dwordx4 v[40:43], v3, s[4:7], s31 offen offset:2048 sc1
  s_sleep 4
  buffer_store_dwordx4 v[44:47], v3, s[4:7], s31 offen offset:3072 sc1
  s_sleep 4
  s_sub_u32 s29, s29, 1
  s_lshr_b32 s29, s29, 6
  s_waitcnt vmcnt(0)
  s_cmp_eq_u32 s29, s28
  s_cbranch_scc1 .g2_kernel_v_1h
  s_add_u32 s31, s76, s33
  v_mov_b32 v6, s70
  s_mov_b64 exec, 1
  buffer_store_dword v6, v4, s[4:7], s31 offen offset:0 sc1
  s_mov_b64 exec, -1
  s_branch .g2_kernel_v_2
.g2_kernel_v_1h:
  v_mov_b32 v6, s71
  s_mov_b64 exec, 1
  ds_add_u32 v6, v5 offset:56
  s_mov_b64 exec, -1
.g2_kernel_v_2:
  v_mov_b32 v6, s71
  s_mov_b32 s38, 0
.g2_kernel_wg23:
  ds_read_b32 v7, v6 offset:80
  s_add_u32 s38, s38, 1
  s_waitcnt lgkmcnt(0)
  v_cmp_gt_u32 vcc, 1, v7
  s_cbranch_vccz .g2_kernel_wg23d
  s_sleep 8
  s_cmp_lt_u32 s38, 524288
  s_cbranch_scc1 .g2_kernel_wg23
.g2_kernel_wg23d:
  s_sleep 20
  s_mov_b32 s39, 0
  v_mov_b32 v12, 0
  v_mov_b32 v13, 0
  v_mov_b32 v14, 0
  v_mov_b32 v15, 0
  s_lshl_b32 s30, s17, 2
  s_and_b32 s31, s16, 3
  s_add_u32 s30, s30, s31
  s_lshl_b32 s30, s30, 4
  s_add_u32 s30, s30, s18
  s_lshl_b32 s30, s30, 9
  s_add_u32 s30, s30, s63
  s_add_u32 s30, s30, 0x1000000
  s_mov_b32 exec_hi, 0
  s_sleep 6
  buffer_store_dwordx4 v[12:15], v3, s[4:7], s30 offen sc1
  s_mov_b64 exec, -1
  s_lshl_b32 s30, s17, 2
  s_add_u32 s30, s30, s31
  s_lshl_b32 s30, s30, 5
  s_add_u32 s30, s30, s18
  s_lshl_b32 s30, s30, 11
  s_add_u32 s30, s30, s63
  s_add_u32 s30, s30, 0x808000
  s_sleep 6
  buffer_store_dwordx4 v[12:15], v3, s[4:7], s30 offen sc1
  s_sleep 6
  buffer_store_dwordx4 v[12:15], v3, s[4:7], s30 offen offset:1024 sc1
  s_cmp_lg_u32 s62, 5
  s_cbranch_scc1 .g2_kernel_zs24k
  s_lshl_b32 s30, s18, 4
  s_add_u32 s30, s30, s17
  s_lshl_b32 s30, s30, 2
  s_add_u32 s30, s30, s31
  s_lshl_b32 s30, s30, 12
  s_add_u32 s30, s30, 0x2c00000
  s_sleep 6
  buffer_store_dwordx4 v[12:15], v3, s[4:7], s30 offen sc1
  s_sleep 6
  buffer_store_dwordx4 v[12:15], v3, s[4:7], s30 offen offset:1024 sc1
  s_sleep 6
  buffer_store_dwordx4 v[12:15], v3, s[4:7], s30 offen offset:2048 sc1
  s_sleep 6
  buffer_store_dwordx4 v[12:15], v3, s[4:7], s30 offen offset:3072 sc1
.g2_kernel_zs24k:
  s_lshl_b32 s30, s17, 4
  s_add_u32 s30, s30, s18
  s_cmp_gt_u32 s16, 5
  s_cbranch_scc1 .g2_kernel_zs24
  s_cmp_eq_u32 s16, 5
  s_cbranch_scc1 .g2_kernel_zs24a
  s_cmp_lg_u32 s62, 0
  s_cbranch_scc1 .g2_kernel_zs24
  s_lshl_b32 s30, s30, 12
  s_add_u32 s31, s30, 0x1090000
  s_sleep 6
  buffer_store_dwordx4 v[12:15], v3, s[4:7], s31 offen offset:0 sc1
  s_sleep 6
  buffer_store_dwordx4 v[12:15], v3, s[4:7], s31 offen offset:1024 sc1
  s_sleep 6
  buffer_store_dwordx4 v[12:15], v3, s[4:7], s31 offen offset:2048 sc1
  s_sleep 6
  buffer_store_dwordx4 v[12:15], v3, s[4:7], s31 offen offset:3072 sc1
  s_add_u32 s31, s30, 0x2890000
  s_sleep 6
  buffer_store_dwordx4 v[12:15], v3, s[4:7], s31 offen offset:0 sc1
  s_sleep 6
  buffer_store_dwordx4 v[12:15], v3, s[4:7], s31 offen offset:1024 sc1
  s_sleep 6
  buffer_store_dwordx4 v[12:15], v3, s[4:7], s31 offen offset:2048 sc1
  s_sleep 6
  buffer_store_dwordx4 v[12:15], v3, s[4:7], s31 offen offset:3072 sc1
  s_add_u32 s31, s30, 0x2b00000
  s_sleep 6
  buffer_store_dwordx4 v[12:15], v3, s[4:7], s31 offen offset:0 sc1
  s_sleep 6
  buffer_store_dwordx4 v[12:15], v3, s[4:7], s31 offen offset:1024 sc1
  s_sleep 6
  buffer_store_dwordx4 v[12:15], v3, s[4:7], s31 offen offset:2048 sc1
  s_sleep 6
  buffer_store_dwordx4 v[12:15], v3, s[4:7], s31 offen offset:3072 sc1
  s_branch .g2_kernel_zs24
.g2_kernel_zs24a:
  s_xor_b32 s31, s17, s18
  s_and_b32 s31, s31, 3
  s_cbranch_scc1 .g2_kernel_zs24b
  s_lshr_b32 s30, s30, 2
  s_lshl_b32 s30, s30, 8
  s_add_u32 s30, s30, s63
  s_add_u32 s30, s30, 0x1080000
  s_mov_b64 exec, 0xffff
  s_sleep 6
  buffer_store_dwordx4 v[12:15], v3, s[4:7], s30 offen sc1
  s_mov_b64 exec, -1
.g2_kernel_zs24b:
  s_and_b32 s30, s18, 14
  s_lshl_b32 s30, s30, 4
  s_add_u32 s30, s30, s17
  s_lshl_b32 s30, s30, 1
  s_and_b32 s31, s18, 1
  s_add_u32 s30, s30, s31
  s_lshl_b32 s30, s30, 10
  s_add_u32 s30, s30, s63
  s_add_u32 s30, s30, 0x1190000
  s_add_u32 s31, s30, 32768
  s_sleep 6
  buffer_store_dwordx4 v[12:15], v3, s[4:7], s30 offen sc1
  s_sleep 6
  buffer_store_dwordx4 v[12:15], v3, s[4:7], s31 offen sc1
.g2_kernel_zs24:
  s_cmp_eq_u32 s16, 4
  s_cbranch_scc1 .g2_kernel_v_3a
  s_cmp_lg_u32 s62, 0
  s_cbranch_scc1 .g2_kernel_g_e
  s_and_b32 s22, s16, 3
  s_lshl_b32 s22, s22, 14
  s_cmp_eq_u32 s16, 5
  s_cselect_b32 s28, 65536, 0
  s_add_u32 s22, s22, s28
  v_bfe_u32 v8, v2, 2, 2
  v_lshrrev_b32 v9, 4, v2
  v_and_b32 v10, 3, v2
  v_lshlrev_b32 v10, 3, v10
  v_add_u32 v10, s22, v10
  s_cmp_eq_u32 s16, 5
  s_cbranch_scc1 .g2_kernel_g_p
  s_lshl_b32 s74, s17, 4
  s_add_u32 s74, s74, s18
  s_cmp_ge_u32 s74, 224
  s_cbranch_scc1 .g2_kernel_g_e
  v_lshrrev_b32 v6, 1, v2
  v_mul_u32_u24 v6, 7168, v6
  v_and_b32 v7, 1, v2
  v_lshl_add_u32 v250, v7, 4, v6
  v_lshl_add_u32 v11, v9, 3, v8
  v_lshl_add_u32 v251, v11, 5, v10
  v_and_b32 v11, 1, v9
  v_lshl_add_u32 v11, v11, 3, v8
  v_lshl_add_u32 v11, v11, 10, v10
  v_lshrrev_b32 v7, 1, v9
  v_lshl_add_u32 v252, v7, 7, v11
  s_mov_b32 s24, s74
  s_and_b32 s25, s16, 1
  s_mov_b32 s12, s50
  s_mov_b32 s13, s51
  s_mov_b32 s14, 0x700000
  s_mov_b32 s15, 0x00020000
  s_mul_i32 s20, s25, 3670016
  s_lshl_b32 s31, s24, 5
  s_add_u32 s20, s20, s31
  s_lshl_b32 s31, s18, 2
  s_mov_b32 s23, s31
  s_mov_b32 s21, 16
.g2_kernel_gl26:
  s_and_b32 s30, s21, 3
  s_cbranch_scc1 .g2_kernel_gl26m
  s_call_b64 s[26:27], .g2_kernel_v_may
.g2_kernel_gl26m:
  s_and_b32 s23, s23, 15
  s_lshl_b32 s30, s23, 10
  s_add_u32 s30, s30, 0
  s_add_u32 m0, s30, s22
  s_mul_i32 s30, s23, 229376
  s_add_u32 s30, s30, s20
  buffer_load_dwordx4 v250, s[12:15], s30 offen lds
  s_add_u32 s23, s23, 1
  s_sub_u32 s21, s21, 1
  s_sleep 3
  s_waitcnt vmcnt(2)
  s_cmp_lg_u32 s21, 0
  s_cbranch_scc1 .g2_kernel_gl26
  s_waitcnt vmcnt(0)
  ds_read_b64_tr_b16 v[64:65], v251 offset:0
  ds_read_b64_tr_b16 v[66:67], v251 offset:128
  ds_read_b64_tr_b16 v[68:69], v251 offset:1024
  ds_read_b64_tr_b16 v[70:71], v251 offset:1152
  ds_read_b64_tr_b16 v[72:73], v251 offset:2048
  ds_read_b64_tr_b16 v[74:75], v251 offset:2176
  ds_read_b64_tr_b16 v[76:77], v251 offset:3072
  ds_read_b64_tr_b16 v[78:79], v251 offset:3200
  ds_read_b64_tr_b16 v[80:81], v251 offset:4096
  ds_read_b64_tr_b16 v[82:83], v251 offset:4224
  ds_read_b64_tr_b16 v[84:85], v251 offset:5120
  ds_read_b64_tr_b16 v[86:87], v251 offset:5248
  ds_read_b64_tr_b16 v[88:89], v251 offset:6144
  ds_read_b64_tr_b16 v[90:91], v251 offset:6272
  ds_read_b64_tr_b16 v[92:93], v251 offset:7168
  ds_read_b64_tr_b16 v[94:95], v251 offset:7296
  ds_read_b64_tr_b16 v[96:97], v251 offset:8192
  ds_read_b64_tr_b16 v[98:99], v251 offset:8320
  ds_read_b64_tr_b16 v[100:101], v251 offset:9216
  ds_read_b64_tr_b16 v[102:103], v251 offset:9344
  ds_read_b64_tr_b16 v[104:105], v251 offset:10240
  ds_read_b64_tr_b16 v[106:107], v251 offset:10368
  ds_read_b64_tr_b16 v[108:109], v251 offset:11264
  ds_read_b64_tr_b16 v[110:111], v251 offset:11392
  ds_read_b64_tr_b16 v[112:113], v251 offset:12288
  ds_read_b64_tr_b16 v[114:115], v251 offset:12416
  ds_read_b64_tr_b16 v[116:117], v251 offset:13312
  ds_read_b64_tr_b16 v[118:119], v251 offset:13440
  ds_read_b64_tr_b16 v[120:121], v251 offset:14336
  ds_read_b64_tr_b16 v[122:123], v251 offset:14464
  ds_read_b64_tr_b16 v[124:125], v251 offset:15360
  ds_read_b64_tr_b16 v[126:127], v251 offset:15488
  s_waitcnt lgkmcnt(0)
  s_mov_b32 s12, s52
  s_mov_b32 s13, s53
  s_mov_b32 s14, 0x700000
  s_mov_b32 s15, 0x00020000
  s_mul_i32 s20, s25, 3670016
  s_lshl_b32 s31, s24, 5
  s_add_u32 s20, s20, s31
  s_lshl_b32 s31, s18, 2
  s_mov_b32 s23, s31
  s_mov_b32 s21, 16
.g2_kernel_gl27:
  s_and_b32 s30, s21, 3
  s_cbranch_scc1 .g2_kernel_gl27m
  s_call_b64 s[26:27], .g2_kernel_v_may
.g2_kernel_gl27m:
  s_and_b32 s23, s23, 15
  s_lshl_b32 s30, s23, 10
  s_add_u32 s30, s30, 0
  s_add_u32 m0, s30, s22
  s_mul_i32 s30, s23, 229376
  s_add_u32 s30, s30, s20
  buffer_load_dwordx4 v250, s[12:15], s30 offen lds
  s_add_u32 s23, s23, 1
  s_sub_u32 s21, s21, 1
  s_sleep 3
  s_waitcnt vmcnt(2)
  s_cmp_lg_u32 s21, 0
  s_cbranch_scc1 .g2_kernel_gl27
  s_waitcnt vmcnt(0)
  ds_read_b64_tr_b16 v[128:129], v251 offset:0
  ds_read_b64_tr_b16 v[130:131], v251 offset:128
  ds_read_b64_tr_b16 v[132:133], v251 offset:1024
  ds_read_b64_tr_b16 v[134:135], v251 offset:1152
  ds_read_b64_tr_b16 v[136:137], v251 offset:2048
  ds_read_b64_tr_b16 v[138:139], v251 offset:2176
  ds_read_b64_tr_b16 v[140:141], v251 offset:3072
  ds_read_b64_tr_b16 v[142:143], v251 offset:3200
  ds_read_b64_tr_b16 v[144:145], v251 offset:4096
  ds_read_b64_tr_b16 v[146:147], v251 offset:4224
  ds_read_b64_tr_b16 v[148:149], v251 offset:5120
  ds_read_b64_tr_b16 v[150:151], v251 offset:5248
  ds_read_b64_tr_b16 v[152:153], v251 offset:6144
  ds_read_b64_tr_b16 v[154:155], v251 offset:6272
  ds_read_b64_tr_b16 v[156:157], v251 offset:7168
  ds_read_b64_tr_b16 v[158:159], v251 offset:7296
  ds_read_b64_tr_b16 v[160:161], v251 offset:8192
  ds_read_b64_tr_b16 v[162:163], v251 offset:8320
  ds_read_b64_tr_b16 v[164:165], v251 offset:9216
  ds_read_b64_tr_b16 v[166:167], v251 offset:9344
  ds_read_b64_tr_b16 v[168:169], v251 offset:10240
  ds_read_b64_tr_b16 v[170:171], v251 offset:10368
  ds_read_b64_tr_b16 v[172:173], v251 offset:11264
  ds_read_b64_tr_b16 v[174:175], v251 offset:11392
  ds_read_b64_tr_b16 v[176:177], v251 offset:12288
  ds_read_b64_tr_b16 v[178:179], v251 offset:12416
  ds_read_b64_tr_b16 v[180:181], v251 offset:13312
  ds_read_b64_tr_b16 v[182:183], v251 offset:13440
  ds_read_b64_tr_b16 v[184:185], v251 offset:14336
  ds_read_b64_tr_b16 v[186:187], v251 offset:14464
  ds_read_b64_tr_b16 v[188:189], v251 offset:15360
  ds_read_b64_tr_b16 v[190:191], v251 offset:15488
  s_waitcnt lgkmcnt(0)
  s_mov_b32 s12, s54
  s_mov_b32 s13, s55
  s_mov_b32 s14, 0x700000
  s_mov_b32 s15, 0x00020000
  s_lshl_b32 s20, s24, 15
  s_lshl_b32 s31, s25, 10
  s_add_u32 s20, s20, s31
  s_mov_b32 s23, 0
  s_mov_b32 s21, 16
.g2_kernel_gl28:
  s_and_b32 s30, s21, 3
  s_cbranch_scc1 .g2_kernel_gl28m
  s_call_b64 s[26:27], .g2_kernel_v_may
.g2_kernel_gl28m:
  s_and_b32 s23, s23, 15
  s_lshl_b32 s30, s23, 10
  s_add_u32 s30, s30, 0
  s_add_u32 m0, s30, s22
  s_mul_i32 s30, s23, 2048
  s_add_u32 s30, s30, s20
  buffer_load_dwordx4 v3, s[12:15], s30 offen lds
  s_add_u32 s23, s23, 1
  s_sub_u32 s21, s21, 1
  s_sleep 2
  s_waitcnt vmcnt(2)
  s_cmp_lg_u32 s21, 0
  s_cbranch_scc1 .g2_kernel_gl28
  v_mov_b32 v11, v252
  s_waitcnt vmcnt(0)
  ds_read_b64_tr_b16 v[192:193], v11 offset:0
  ds_read_b64_tr_b16 v[194:195], v11 offset:4096
  ds_read_b64_tr_b16 v[196:197], v11 offset:32
  ds_read_b64_tr_b16 v[198:199], v11 offset:4128
  ds_read_b64_tr_b16 v[200:201], v11 offset:64
  ds_read_b64_tr_b16 v[202:203], v11 offset:4160
  ds_read_b64_tr_b16 v[204:205], v11 offset:96
  ds_read_b64_tr_b16 v[206:207], v11 offset:4192
  ds_read_b64_tr_b16 v[208:209], v11 offset:256
  ds_read_b64_tr_b16 v[210:211], v11 offset:4352
  ds_read_b64_tr_b16 v[212:213], v11 offset:288
  ds_read_b64_tr_b16 v[214:215], v11 offset:4384
  ds_read_b64_tr_b16 v[216:217], v11 offset:320
  ds_read_b64_tr_b16 v[218:219], v11 offset:4416
  ds_read_b64_tr_b16 v[220:221], v11 offset:352
  ds_read_b64_tr_b16 v[222:223], v11 offset:4448
  ds_read_b64_tr_b16 v[224:225], v11 offset:512
  ds_read_b64_tr_b16 v[226:227], v11 offset:4608
  ds_read_b64_tr_b16 v[228:229], v11 offset:544
  ds_read_b64_tr_b16 v[230:231], v11 offset:4640
  ds_read_b64_tr_b16 v[232:233], v11 offset:576
  ds_read_b64_tr_b16 v[234:235], v11 offset:4672
  ds_read_b64_tr_b16 v[236:237], v11 offset:608
  ds_read_b64_tr_b16 v[238:239], v11 offset:4704
  ds_read_b64_tr_b16 v[240:241], v11 offset:768
  ds_read_b64_tr_b16 v[242:243], v11 offset:4864
  ds_read_b64_tr_b16 v[244:245], v11 offset:800
  ds_read_b64_tr_b16 v[246:247], v11 offset:4896
  ds_read_b64_tr_b16 v[248:249], v11 offset:832
  ds_read_b64_tr_b16 v[250:251], v11 offset:4928
  ds_read_b64_tr_b16 v[252:253], v11 offset:864
  ds_read_b64_tr_b16 v[254:255], v11 offset:4960
  s_waitcnt lgkmcnt(0)
  s_branch .g2_kernel_g_e
.g2_kernel_g_p:
  s_mov_b32 s12, s42
  s_mov_b32 s13, s43
  s_mov_b32 s14, 0x600000
  s_mov_b32 s15, 0x00020000
  v_mul_u32_u24 v6, 6144, v9
  v_and_b32 v7, 15, v2
  v_lshl_add_u32 v250, v7, 4, v6
  v_lshl_add_u32 v11, v8, 2, v9
  v_lshl_add_u32 v251, v11, 9, v10
  s_lshl_b32 s20, s17, 3
  s_and_b32 s31, s18, 1
  s_add_u32 s20, s20, s31
  s_mul_i32 s20, s20, 49152
  s_and_b32 s31, s18, 14
  s_lshl_b32 s31, s31, 7
  s_add_u32 s20, s20, s31
  s_mov_b32 s23, 0
  s_mov_b32 s21, 8
.g2_kernel_gl29:
  s_and_b32 s30, s21, 3
  s_cbranch_scc1 .g2_kernel_gl29m
  s_call_b64 s[26:27], .g2_kernel_v_may
.g2_kernel_gl29m:
  s_and_b32 s23, s23, 7
  s_lshl_b32 s30, s23, 10
  s_add_u32 s30, s30, 0
  s_add_u32 m0, s30, s22
  s_mul_i32 s30, s23, 49152
  s_add_u32 s30, s30, s20
  s_and_b32 s31, s23, 1
  s_mul_i32 s31, s31, -24576
  s_add_u32 s30, s30, s31
  buffer_load_dwordx4 v250, s[12:15], s30 offen lds
  s_add_u32 s23, s23, 1
  s_sub_u32 s21, s21, 1
  s_sleep 2
  s_waitcnt vmcnt(2)
  s_cmp_lg_u32 s21, 0
  s_cbranch_scc1 .g2_kernel_gl29
  s_add_u32 s20, s20, 2048
  s_mov_b32 s23, 0
  s_mov_b32 s21, 8
.g2_kernel_gl30:
  s_and_b32 s30, s21, 3
  s_cbranch_scc1 .g2_kernel_gl30m
  s_call_b64 s[26:27], .g2_kernel_v_may
.g2_kernel_gl30m:
  s_and_b32 s23, s23, 7
  s_lshl_b32 s30, s23, 10
  s_add_u32 s30, s30, 8192
  s_add_u32 m0, s30, s22
  s_mul_i32 s30, s23, 49152
  s_add_u32 s30, s30, s20
  s_and_b32 s31, s23, 1
  s_mul_i32 s31, s31, -24576
  s_add_u32 s30, s30, s31
  buffer_load_dwordx4 v250, s[12:15], s30 offen lds
  s_add_u32 s23, s23, 1
  s_sub_u32 s21, s21, 1
  s_sleep 2
  s_waitcnt vmcnt(2)
  s_cmp_lg_u32 s21, 0
  s_cbranch_scc1 .g2_kernel_gl30
  s_add_u32 s20, s20, 2048
  s_waitcnt vmcnt(0)
  ds_read_b64_tr_b16 v[64:65], v251 offset:0
  ds_read_b64_tr_b16 v[66:67], v251 offset:256
  ds_read_b64_tr_b16 v[68:69], v251 offset:32
  ds_read_b64_tr_b16 v[70:71], v251 offset:288
  ds_read_b64_tr_b16 v[72:73], v251 offset:64
  ds_read_b64_tr_b16 v[74:75], v251 offset:320
  ds_read_b64_tr_b16 v[76:77], v251 offset:96
  ds_read_b64_tr_b16 v[78:79], v251 offset:352
  ds_read_b64_tr_b16 v[80:81], v251 offset:128
  ds_read_b64_tr_b16 v[82:83], v251 offset:384
  ds_read_b64_tr_b16 v[84:85], v251 offset:160
  ds_read_b64_tr_b16 v[86:87], v251 offset:416
  ds_read_b64_tr_b16 v[88:89], v251 offset:192
  ds_read_b64_tr_b16 v[90:91], v251 offset:448
  ds_read_b64_tr_b16 v[92:93], v251 offset:224
  ds_read_b64_tr_b16 v[94:95], v251 offset:480
  ds_read_b64_tr_b16 v[96:97], v251 offset:8192
  ds_read_b64_tr_b16 v[98:99], v251 offset:8448
  ds_read_b64_tr_b16 v[100:101], v251 offset:8224
  ds_read_b64_tr_b16 v[102:103], v251 offset:8480
  ds_read_b64_tr_b16 v[104:105], v251 offset:8256
  ds_read_b64_tr_b16 v[106:107], v251 offset:8512
  ds_read_b64_tr_b16 v[108:109], v251 offset:8288
  ds_read_b64_tr_b16 v[110:111], v251 offset:8544
  ds_read_b64_tr_b16 v[112:113], v251 offset:8320
  ds_read_b64_tr_b16 v[114:115], v251 offset:8576
  ds_read_b64_tr_b16 v[116:117], v251 offset:8352
  ds_read_b64_tr_b16 v[118:119], v251 offset:8608
  ds_read_b64_tr_b16 v[120:121], v251 offset:8384
  ds_read_b64_tr_b16 v[122:123], v251 offset:8640
  ds_read_b64_tr_b16 v[124:125], v251 offset:8416
  ds_read_b64_tr_b16 v[126:127], v251 offset:8672
  s_waitcnt lgkmcnt(0)
  s_mov_b32 s23, 0
  s_mov_b32 s21, 8
.g2_kernel_gl31:
  s_and_b32 s30, s21, 3
  s_cbranch_scc1 .g2_kernel_gl31m
  s_call_b64 s[26:27], .g2_kernel_v_may
.g2_kernel_gl31m:
  s_and_b32 s23, s23, 7
  s_lshl_b32 s30, s23, 10
  s_add_u32 s30, s30, 0
  s_add_u32 m0, s30, s22
  s_mul_i32 s30, s23, 49152
  s_add_u32 s30, s30, s20
  s_and_b32 s31, s23, 1
  s_mul_i32 s31, s31, -24576
  s_add_u32 s30, s30, s31
  buffer_load_dwordx4 v250, s[12:15], s30 offen lds
  s_add_u32 s23, s23, 1
  s_sub_u32 s21, s21, 1
  s_sleep 2
  s_waitcnt vmcnt(2)
  s_cmp_lg_u32 s21, 0
  s_cbranch_scc1 .g2_kernel_gl31
  s_add_u32 s20, s20, 2048
  s_waitcnt vmcnt(0)
  ds_read_b64_tr_b16 v[128:129], v251 offset:0
  ds_read_b64_tr_b16 v[130:131], v251 offset:256
  ds_read_b64_tr_b16 v[132:133], v251 offset:32
  ds_read_b64_tr_b16 v[134:135], v251 offset:288
  ds_read_b64_tr_b16 v[136:137], v251 offset:64
  ds_read_b64_tr_b16 v[138:139], v251 offset:320
  ds_read_b64_tr_b16 v[140:141], v251 offset:96
  ds_read_b64_tr_b16 v[142:143], v251 offset:352
  ds_read_b64_tr_b16 v[144:145], v251 offset:128
  ds_read_b64_tr_b16 v[146:147], v251 offset:384
  ds_read_b64_tr_b16 v[148:149], v251 offset:160
  ds_read_b64_tr_b16 v[150:151], v251 offset:416
  ds_read_b64_tr_b16 v[152:153], v251 offset:192
  ds_read_b64_tr_b16 v[154:155], v251 offset:448
  ds_read_b64_tr_b16 v[156:157], v251 offset:224
  ds_read_b64_tr_b16 v[158:159], v251 offset:480
  s_waitcnt lgkmcnt(0)
.g2_kernel_g_e:
  s_cmp_lt_u32 s16, 6
  s_cbranch_scc1 .g2_kernel_v_3
  v_mov_b32 v6, s71
  s_mov_b64 exec, 1
  ds_add_u32 v6, v5 offset:116
  s_mov_b64 exec, -1
  s_branch .g2_kernel_v_3c
.g2_kernel_v_3:
  s_mov_b32 s29, 0
  s_and_b32 s32, s16, 3
  s_lshl_b32 s30, s32, 14
  s_add_u32 s30, s30, 65536
  s_call_b64 s[68:69], .g2_kernel_v_wo
  s_cmp_lg_u32 s16, 4
  s_cbranch_scc1 .g2_kernel_v_3d
  s_mov_b32 s32, 2
  s_mov_b32 s30, 98304
  s_call_b64 s[68:69], .g2_kernel_v_wo
  s_mov_b32 s32, 3
  s_mov_b32 s30, 114688
  s_call_b64 s[68:69], .g2_kernel_v_wo
.g2_kernel_v_3d:
  s_waitcnt vmcnt(0)
  v_mov_b32 v8, 2
  v_mov_b32 v6, s71
  s_mov_b64 exec, 1
  ds_add_u32 v6, v8 offset:52
  s_mov_b64 exec, -1
.g2_kernel_v_3c:
  s_cmp_lg_u32 s39, 0
  s_cbranch_scc1 .g2_kernel_v_3b
  s_call_b64 s[26:27], .g2_kernel_v_do
.g2_kernel_v_3b:
  s_cmp_lg_u32 s16, 4
  s_cbranch_scc1 .g2_kernel_v_4
  v_mov_b32 v6, s71
  s_mov_b32 s38, 0
.g2_kernel_wg32:
  ds_read_b32 v7, v6 offset:8
  s_add_u32 s38, s38, 1
  s_waitcnt lgkmcnt(0)
  v_cmp_gt_u32 vcc, 10, v7
  s_cbranch_vccz .g2_kernel_wg32d
  s_sleep 8
  s_cmp_lt_u32 s38, 524288
  s_cbranch_scc1 .g2_kernel_wg32
.g2_kernel_wg32d:
  s_mov_b32 s29, 1
  s_mov_b32 s32, 0
  s_mov_b32 s30, 139264
  s_call_b64 s[68:69], .g2_kernel_v_wo
  s_add_u32 s31, s31, 81920
  s_sleep 6
  s_waitcnt vmcnt(4)
  buffer_load_dwordx4 v[64:67], v6, s[8:11], s31 offen
  s_add_u32 s31, s31, 16384
  buffer_load_dwordx4 v[68:71], v6, s[8:11], s31 offen
  s_add_u32 s31, s31, 16384
  buffer_load_dwordx4 v[72:75], v6, s[8:11], s31 offen
  s_add_u32 s31, s31, 16384
  buffer_load_dwordx4 v[76:79], v6, s[8:11], s31 offen
  s_add_u32 s31, s31, 81920
  s_sleep 6
  s_waitcnt vmcnt(4)
  buffer_load_dwordx4 v[80:83], v6, s[8:11], s31 offen
  s_add_u32 s31, s31, 16384
  buffer_load_dwordx4 v[84:87], v6, s[8:11], s31 offen
  s_add_u32 s31, s31, 16384
  buffer_load_dwordx4 v[88:91], v6, s[8:11], s31 offen
  s_add_u32 s31, s31, 16384
  buffer_load_dwordx4 v[92:95], v6, s[8:11], s31 offen
  s_add_u32 s31, s31, 81920
  s_sleep 6
  s_waitcnt vmcnt(4)
  buffer_load_dwordx4 v[96:99], v6, s[8:11], s31 offen
  s_add_u32 s31, s31, 16384
  buffer_load_dwordx4 v[100:103], v6, s[8:11], s31 offen
  s_add_u32 s31, s31, 16384
  buffer_load_dwordx4 v[104:107], v6, s[8:11], s31 offen
  s_add_u32 s31, s31, 16384
  buffer_load_dwordx4 v[108:111], v6, s[8:11], s31 offen
  s_add_u32 s31, s31, 81920
  s_sleep 6
  s_waitcnt vmcnt(4)
  buffer_load_dwordx4 v[112:115], v6, s[8:11], s31 offen
  s_add_u32 s31, s31, 16384
  buffer_load_dwordx4 v[116:119], v6, s[8:11], s31 offen
  s_add_u32 s31, s31, 16384
  buffer_load_dwordx4 v[120:123], v6, s[8:11], s31 offen
  s_add_u32 s31, s31, 16384
  buffer_load_dwordx4 v[124:127], v6, s[8:11], s31 offen
  s_add_u32 s31, s31, 81920
  s_sleep 6
  s_waitcnt vmcnt(4)
  buffer_load_dwordx4 v[128:131], v6, s[8:11], s31 offen
  s_add_u32 s31, s31, 16384
  buffer_load_dwordx4 v[132:135], v6, s[8:11], s31 offen
  s_add_u32 s31, s31, 16384
  buffer_load_dwordx4 v[136:139], v6, s[8:11], s31 offen
  s_add_u32 s31, s31, 16384
  buffer_load_dwordx4 v[140:143], v6, s[8:11], s31 offen
  s_add_u32 s31, s31, 81920
  s_sleep 6
  s_waitcnt vmcnt(4)
  buffer_load_dwordx4 v[144:147], v6, s[8:11], s31 offen
  s_add_u32 s31, s31, 16384
  buffer_load_dwordx4 v[148:151], v6, s[8:11], s31 offen
  s_add_u32 s31, s31, 16384
  buffer_load_dwordx4 v[152:155], v6, s[8:11], s31 offen
  s_add_u32 s31, s31, 16384
  buffer_load_dwordx4 v[156:159], v6, s[8:11], s31 offen
  s_add_u32 s31, s31, 81920
  s_sleep 6
  s_waitcnt vmcnt(4)
  buffer_load_dwordx4 v[160:163], v6, s[8:11], s31 offen
  s_add_u32 s31, s31, 16384
  buffer_load_dwordx4 v[164:167], v6, s[8:11], s31 offen
  s_add_u32 s31, s31, 16384
  buffer_load_dwordx4 v[168:171], v6, s[8:11], s31 offen
  s_add_u32 s31, s31, 16384
  buffer_load_dwordx4 v[172:175], v6, s[8:11], s31 offen
  s_add_u32 s31, s31, 81920
  s_sleep 6
  s_waitcnt vmcnt(4)
  buffer_load_dwordx4 v[176:179], v6, s[8:11], s31 offen
  s_add_u32 s31, s31, 16384
  buffer_load_dwordx4 v[180:183], v6, s[8:11], s31 offen
  s_add_u32 s31, s31, 16384
  buffer_load_dwordx4 v[184:187], v6, s[8:11], s31 offen
  s_add_u32 s31, s31, 16384
  buffer_load_dwordx4 v[188:191], v6, s[8:11], s31 offen
  s_add_u32 s31, s31, 81920
  s_sleep 6
  s_waitcnt vmcnt(4)
  buffer_load_dwordx4 v[192:195], v6, s[8:11], s31 offen
  s_add_u32 s31, s31, 16384
  buffer_load_dwordx4 v[196:199], v6, s[8:11], s31 offen
  s_add_u32 s31, s31, 16384
  buffer_load_dwordx4 v[200:203], v6, s[8:11], s31 offen
  s_add_u32 s31, s31, 16384
  buffer_load_dwordx4 v[204:207], v6, s[8:11], s31 offen
  s_add_u32 s31, s31, 81920
  s_sleep 6
  s_waitcnt vmcnt(4)
  buffer_load_dwordx4 v[208:211], v6, s[8:11], s31 offen
  s_add_u32 s31, s31, 16384
  buffer_load_dwordx4 v[212:215], v6, s[8:11], s31 offen
  s_add_u32 s31, s31, 16384
  buffer_load_dwordx4 v[216:219], v6, s[8:11], s31 offen
  s_add_u32 s31, s31, 16384
  buffer_load_dwordx4 v[220:223], v6, s[8:11], s31 offen
  s_add_u32 s31, s31, 81920
  s_sleep 6
  s_waitcnt vmcnt(4)
  buffer_load_dwordx4 v[224:227], v6, s[8:11], s31 offen
  s_add_u32 s31, s31, 16384
  buffer_load_dwordx4 v[228:231], v6, s[8:11], s31 offen
  s_add_u32 s31, s31, 16384
  buffer_load_dwordx4 v[232:235], v6, s[8:11], s31 offen
  s_add_u32 s31, s31, 16384
  buffer_load_dwordx4 v[236:239], v6, s[8:11], s31 offen
  s_add_u32 s31, s31, 81920
  s_sleep 6
  s_waitcnt vmcnt(4)
  buffer_load_dwordx4 v[240:243], v6, s[8:11], s31 offen
  s_add_u32 s31, s31, 16384
  buffer_load_dwordx4 v[244:247], v6, s[8:11], s31 offen
  s_add_u32 s31, s31, 16384
  buffer_load_dwordx4 v[248:251], v6, s[8:11], s31 offen
  s_add_u32 s31, s31, 16384
  buffer_load_dwordx4 v[252:255], v6, s[8:11], s31 offen
  s_cmp_eq_u32 s62, 0
  s_cbranch_scc1 .g2_kernel_v_4
  v_mov_b32 v8, s71
  s_mov_b32 s38, 0
.g2_kernel_wg33:
  ds_read_b32 v9, v8 offset:116
  s_add_u32 s38, s38, 1
  s_waitcnt lgkmcnt(0)
  v_cmp_gt_u32 vcc, 2, v9
  s_cbranch_vccz .g2_kernel_wg33d
  s_sleep 4
  s_cmp_lt_u32 s38, 524288
  s_cbranch_scc1 .g2_kernel_wg33
.g2_kernel_wg33d:
  s_waitcnt vmcnt(0)
  s_call_b64 s[68:69], .g2_kernel_v_w23
.g2_kernel_v_4:
  s_cmp_lg_u32 s16, 5
  s_cbranch_scc1 .g2_kernel_v_5
  s_sleep 48
  s_and_b32 s31, s19, 0xffffe000
  s_add_u32 s31, s31, 0
  v_and_b32 v6, 15, v2
  v_lshlrev_b32 v6, 9, v6
  v_lshrrev_b32 v7, 4, v2
  v_lshl_add_u32 v6, v7, 7, v6
  v_lshlrev_b32 v7, 2, v2
  v_add_u32 v7, 157696, v7
  s_mov_b32 m0, 157696
  s_mov_b32 s38, 0
.g2_kernel_pa34:
  buffer_load_dword v6, s[4:7], s31 offen sc1 lds
  s_add_u32 s38, s38, 1
  s_waitcnt vmcnt(0)
  ds_read_b32 v8, v7
  s_waitcnt lgkmcnt(0)
  v_cmp_ge_u32 vcc, s62, v8
  s_cbranch_vccz .g2_kernel_pa34d
  s_mov_b64 exec, vcc
  s_sleep 32
  s_cmp_lt_u32 s38, 131072
  s_cbranch_scc1 .g2_kernel_pa34
.g2_kernel_pa34d:
  s_mov_b64 exec, -1
  s_lshl_b32 s28, s2, 10
  s_and_b32 s28, s28, 0xe000
  v_lshlrev_b32 v7, 7, v2
  buffer_load_dword v1, v7, s[64:67], s28 offen
.g2_kernel_v_5:
  s_mov_b32 s29, 1
  s_call_b64 s[68:69], .g2_kernel_v_cmb
  s_cmp_lg_u32 s16, 7
  s_cbranch_scc1 .g2_kernel_v_7
  s_and_b32 s33, s16, 3
  s_lshl_b32 s33, s33, 7
  s_lshl_b32 s28, s29, 2
  s_add_u32 s33, s33, s28
  s_add_u32 s31, s19, s33
  v_mov_b32 v6, s70
  s_mov_b64 exec, 1
  buffer_store_dword v6, v4, s[4:7], s31 offen offset:0 sc1
  s_mov_b64 exec, -1
.g2_kernel_v_7:
  s_cmp_lg_u32 s16, 4
  s_cbranch_scc1 .g2_kernel_v_8
  s_waitcnt vmcnt(2)
  v_mov_b32 v6, s71
  s_mov_b32 s38, 0
.g2_kernel_wg35:
  ds_read_b32 v7, v6 offset:76
  s_add_u32 s38, s38, 1
  s_waitcnt lgkmcnt(0)
  v_cmp_gt_u32 vcc, 1, v7
  s_cbranch_vccz .g2_kernel_wg35d
  s_sleep 1
  s_cmp_lt_u32 s38, 524288
  s_cbranch_scc1 .g2_kernel_wg35
.g2_kernel_wg35d:
  v_mov_b32 v6, s71
  s_mov_b32 s38, 0
.g2_kernel_wg36:
  ds_read_b32 v7, v6 offset:72
  s_add_u32 s38, s38, 1
  s_waitcnt lgkmcnt(0)
  v_cmp_gt_u32 vcc, 1, v7
  s_cbranch_vccz .g2_kernel_wg36d
  s_sleep 1
  s_cmp_lt_u32 s38, 524288
  s_cbranch_scc1 .g2_kernel_wg36
.g2_kernel_wg36d:
  v_mov_b32 v6, s71
  s_mov_b32 s38, 0
.g2_kernel_wg37:
  ds_read_b32 v7, v6 offset:68
  s_add_u32 s38, s38, 1
  s_waitcnt lgkmcnt(0)
  v_cmp_gt_u32 vcc, 1, v7
  s_cbranch_vccz .g2_kernel_wg37d
  s_sleep 1
  s_cmp_lt_u32 s38, 524288
  s_cbranch_scc1 .g2_kernel_wg37
.g2_kernel_wg37d:
  ds_write_b128 v3, v[64:67] offset:16384
  ds_write_b128 v3, v[68:71] offset:17408
  ds_write_b128 v3, v[72:75] offset:18432
  ds_write_b128 v3, v[76:79] offset:19456
  ds_write_b128 v3, v[80:83] offset:20480
  ds_write_b128 v3, v[84:87] offset:21504
  ds_write_b128 v3, v[88:91] offset:22528
  ds_write_b128 v3, v[92:95] offset:23552
  ds_write_b128 v3, v[96:99] offset:24576
  ds_write_b128 v3, v[100:103] offset:25600
  ds_write_b128 v3, v[104:107] offset:26624
  ds_write_b128 v3, v[108:111] offset:27648
  ds_write_b128 v3, v[112:115] offset:28672
  ds_write_b128 v3, v[116:119] offset:29696
  ds_write_b128 v3, v[120:123] offset:30720
  ds_write_b128 v3, v[124:127] offset:31744
  s_cmp_lg_u32 s62, 0
  s_cbranch_scc1 .g2_kernel_v_9
  s_call_b64 s[68:69], .g2_kernel_v_w23
.g2_kernel_v_9:
  v_mov_b32 v8, 4
  ds_write_b32 v6, v8 offset:12
.g2_kernel_v_8:
  s_cmp_eq_u32 s16, 5
  s_cbranch_scc1 .g2_kernel_c1
  s_cmp_lg_u32 s16, 4
  s_cbranch_scc1 .g2_kernel_c2
  s_cmp_lg_u32 s62, 0
  s_cbranch_scc1 .g2_kernel_fin1
  s_setprio 3
  s_mov_b32 s12, s42
  s_mov_b32 s13, s43
  s_mov_b32 s14, 0x600000
  s_mov_b32 s15, 0x00020000
  v_lshrrev_b32 v28, 3, v2
  v_and_b32 v29, 7, v2
  v_bfe_u32 v30, v2, 4, 1
  v_lshlrev_b32 v30, 1, v30
  v_xor_b32 v31, v29, v30
  v_lshlrev_b32 v31, 4, v31
  v_mul_u32_u24 v28, 6144, v28
  v_add_u32 v28, v28, v31
  v_xor_b32 v29, 64, v28
  v_lshlrev_b32 v9, 2, v2
  v_and_b32 v9, 12, v9
  v_add_u32 v9, 156416, v9
  v_add_u32 v48, 0, v28
  v_add_u32 v49, 48128, v29
  v_add_u32 v50, 96256, v28
  v_add_u32 v51, 144384, v29
  v_add_u32 v52, 2048, v28
  v_add_u32 v53, 50176, v29
  v_add_u32 v54, 98304, v28
  v_add_u32 v55, 146432, v29
  v_add_u32 v56, 4096, v29
  v_add_u32 v57, 52224, v28
  v_add_u32 v58, 100352, v29
  v_add_u32 v59, 148480, v28
  v_and_b32 v11, 15, v2
  v_xor_b32 v11, s18, v11
  v_and_b32 v12, 48, v2
  v_add_u32 v11, v11, v12
  v_lshlrev_b32 v11, 2, v11
  v_add_u32 v11, 158208, v11
  s_lshl_b32 s39, s18, 7
  s_lshl_b32 s32, s17, 18
  s_add_u32 s32, s32, 0xc00000
  s_mov_b32 s30, 0
  s_mov_b32 s29, 0
  s_mov_b32 s37, 0
  v_mov_b32 v6, s71
  s_mov_b32 s38, 0
.g2_kernel_wg38:
  ds_read_b32 v7, v6 offset:16
  s_add_u32 s38, s38, 1
  s_waitcnt lgkmcnt(0)
  v_cmp_gt_u32 vcc, 4, v7
  s_cbranch_vccz .g2_kernel_wg38d
  s_sleep 2
  s_cmp_lt_u32 s38, 524288
  s_cbranch_scc1 .g2_kernel_wg38
.g2_kernel_wg38d:
  s_xor_b32 s36, s18, 0
  s_mul_i32 s36, s36, 393216
  s_add_u32 s36, s36, s39
  s_add_u32 m0, s30, 65536
  s_waitcnt vmcnt(63)
  buffer_load_dwordx4 v48, s[12:15], s36 offen offset:0 lds
  buffer_load_dwordx4 v49, s[12:15], s36 offen offset:1024 lds
  buffer_load_dwordx4 v50, s[12:15], s36 offen offset:2048 lds
  buffer_load_dwordx4 v51, s[12:15], s36 offen offset:3072 lds
  s_add_u32 m0, s30, 69632
  s_waitcnt vmcnt(63)
  buffer_load_dwordx4 v52, s[12:15], s36 offen offset:0 lds
  buffer_load_dwordx4 v53, s[12:15], s36 offen offset:1024 lds
  buffer_load_dwordx4 v54, s[12:15], s36 offen offset:2048 lds
  buffer_load_dwordx4 v55, s[12:15], s36 offen offset:3072 lds
  s_add_u32 m0, s30, 73728
  s_waitcnt vmcnt(63)
  buffer_load_dwordx4 v56, s[12:15], s36 offen offset:0 lds
  buffer_load_dwordx4 v57, s[12:15], s36 offen offset:1024 lds
  buffer_load_dwordx4 v58, s[12:15], s36 offen offset:2048 lds
  buffer_load_dwordx4 v59, s[12:15], s36 offen offset:3072 lds
  s_add_u32 s30, s30, 12288
  s_cmp_eq_u32 s30, 86016
  s_cselect_b32 s30, 0, s30
  s_xor_b32 s36, s18, 0
  s_mul_i32 s36, s36, 393216
  s_add_u32 s36, s36, s39
  s_add_u32 s36, s36, 196608
  s_add_u32 m0, s30, 65536
  s_waitcnt vmcnt(63)
  buffer_load_dwordx4 v48, s[12:15], s36 offen offset:0 lds
  buffer_load_dwordx4 v49, s[12:15], s36 offen offset:1024 lds
  buffer_load_dwordx4 v50, s[12:15], s36 offen offset:2048 lds
  buffer_load_dwordx4 v51, s[12:15], s36 offen offset:3072 lds
  s_add_u32 m0, s30, 69632
  s_waitcnt vmcnt(63)
  buffer_load_dwordx4 v52, s[12:15], s36 offen offset:0 lds
  buffer_load_dwordx4 v53, s[12:15], s36 offen offset:1024 lds
  buffer_load_dwordx4 v54, s[12:15], s36 offen offset:2048 lds
  buffer_load_dwordx4 v55, s[12:15], s36 offen offset:3072 lds
  s_add_u32 m0, s30, 73728
  s_waitcnt vmcnt(63)
  buffer_load_dwordx4 v56, s[12:15], s36 offen offset:0 lds
  buffer_load_dwordx4 v57, s[12:15], s36 offen offset:1024 lds
  buffer_load_dwordx4 v58, s[12:15], s36 offen offset:2048 lds
  buffer_load_dwordx4 v59, s[12:15], s36 offen offset:3072 lds
  s_add_u32 s30, s30, 12288
  s_cmp_eq_u32 s30, 86016
  s_cselect_b32 s30, 0, s30
  s_mov_b32 m0, 156160
  s_mov_b32 s35, .g2_kernel_tab-.g2_kernel_pc+136
  s_mov_b64 exec, 1
  buffer_load_dword off, s[64:67], s35 lds
  s_mov_b64 exec, -1
  s_xor_b32 s36, s18, 1
  s_mul_i32 s36, s36, 393216
  s_add_u32 s36, s36, s39
  s_add_u32 m0, s30, 65536
  s_waitcnt vmcnt(63)
  buffer_load_dwordx4 v48, s[12:15], s36 offen offset:0 lds
  buffer_load_dwordx4 v49, s[12:15], s36 offen offset:1024 lds
  buffer_load_dwordx4 v50, s[12:15], s36 offen offset:2048 lds
  buffer_load_dwordx4 v51, s[12:15], s36 offen offset:3072 lds
  s_add_u32 m0, s30, 69632
  s_waitcnt vmcnt(63)
  buffer_load_dwordx4 v52, s[12:15], s36 offen offset:0 lds
  buffer_load_dwordx4 v53, s[12:15], s36 offen offset:1024 lds
  buffer_load_dwordx4 v54, s[12:15], s36 offen offset:2048 lds
  buffer_load_dwordx4 v55, s[12:15], s36 offen offset:3072 lds
  s_add_u32 m0, s30, 73728
  s_waitcnt vmcnt(63)
  buffer_load_dwordx4 v56, s[12:15], s36 offen offset:0 lds
  buffer_load_dwordx4 v57, s[12:15], s36 offen offset:1024 lds
  buffer_load_dwordx4 v58, s[12:15], s36 offen offset:2048 lds
  buffer_load_dwordx4 v59, s[12:15], s36 offen offset:3072 lds
  s_add_u32 s30, s30, 12288
  s_cmp_eq_u32 s30, 86016
  s_cselect_b32 s30, 0, s30
  s_xor_b32 s36, s18, 1
  s_mul_i32 s36, s36, 393216
  s_add_u32 s36, s36, s39
  s_add_u32 s36, s36, 196608
  s_add_u32 m0, s30, 65536
  s_waitcnt vmcnt(63)
  buffer_load_dwordx4 v48, s[12:15], s36 offen offset:0 lds
  buffer_load_dwordx4 v49, s[12:15], s36 offen offset:1024 lds
  buffer_load_dwordx4 v50, s[12:15], s36 offen offset:2048 lds
  buffer_load_dwordx4 v51, s[12:15], s36 offen offset:3072 lds
  s_add_u32 m0, s30, 69632
  s_waitcnt vmcnt(63)
  buffer_load_dwordx4 v52, s[12:15], s36 offen offset:0 lds
  buffer_load_dwordx4 v53, s[12:15], s36 offen offset:1024 lds
  buffer_load_dwordx4 v54, s[12:15], s36 offen offset:2048 lds
  buffer_load_dwordx4 v55, s[12:15], s36 offen offset:3072 lds
  s_add_u32 m0, s30, 73728
  s_waitcnt vmcnt(63)
  buffer_load_dwordx4 v56, s[12:15], s36 offen offset:0 lds
  buffer_load_dwordx4 v57, s[12:15], s36 offen offset:1024 lds
  buffer_load_dwordx4 v58, s[12:15], s36 offen offset:2048 lds
  buffer_load_dwordx4 v59, s[12:15], s36 offen offset:3072 lds
  s_add_u32 s30, s30, 12288
  s_cmp_eq_u32 s30, 86016
  s_cselect_b32 s30, 0, s30
  s_xor_b32 s36, s18, 2
  s_mul_i32 s36, s36, 393216
  s_add_u32 s36, s36, s39
  s_add_u32 m0, s30, 65536
  s_waitcnt vmcnt(63)
  buffer_load_dwordx4 v48, s[12:15], s36 offen offset:0 lds
  buffer_load_dwordx4 v49, s[12:15], s36 offen offset:1024 lds
  buffer_load_dwordx4 v50, s[12:15], s36 offen offset:2048 lds
  buffer_load_dwordx4 v51, s[12:15], s36 offen offset:3072 lds
  s_add_u32 m0, s30, 69632
  s_waitcnt vmcnt(63)
  buffer_load_dwordx4 v52, s[12:15], s36 offen offset:0 lds
  buffer_load_dwordx4 v53, s[12:15], s36 offen offset:1024 lds
  buffer_load_dwordx4 v54, s[12:15], s36 offen offset:2048 lds
  buffer_load_dwordx4 v55, s[12:15], s36 offen offset:3072 lds
  s_add_u32 m0, s30, 73728
  s_waitcnt vmcnt(63)
  buffer_load_dwordx4 v56, s[12:15], s36 offen offset:0 lds
  buffer_load_dwordx4 v57, s[12:15], s36 offen offset:1024 lds
  buffer_load_dwordx4 v58, s[12:15], s36 offen offset:2048 lds
  buffer_load_dwordx4 v59, s[12:15], s36 offen offset:3072 lds
  s_add_u32 s30, s30, 12288
  s_cmp_eq_u32 s30, 86016
  s_cselect_b32 s30, 0, s30
  v_mov_b32 v6, s71
  s_mov_b32 s38, 0
.g2_kernel_wg39:
  ds_read_b32 v7, v6 offset:20
  s_add_u32 s38, s38, 1
  s_waitcnt lgkmcnt(0)
  v_cmp_gt_u32 vcc, 4, v7
  s_cbranch_vccz .g2_kernel_wg39d
  s_sleep 1
  s_cmp_lt_u32 s38, 524288
  s_cbranch_scc1 .g2_kernel_wg39
.g2_kernel_wg39d:
  s_mov_b32 s62, 1
  s_mov_b32 s63, 0x1800000
  s_mov_b32 s70, 2
  s_mov_b32 s71, 155776
  s_xor_b32 s36, s18, 2
  s_mul_i32 s36, s36, 393216
  s_add_u32 s36, s36, s39
  s_add_u32 s36, s36, 196608
  s_add_u32 m0, s30, 65536
  s_waitcnt vmcnt(63)
  buffer_load_dwordx4 v48, s[12:15], s36 offen offset:0 lds
  buffer_load_dwordx4 v49, s[12:15], s36 offen offset:1024 lds
  buffer_load_dwordx4 v50, s[12:15], s36 offen offset:2048 lds
  buffer_load_dwordx4 v51, s[12:15], s36 offen offset:3072 lds
  s_add_u32 m0, s30, 69632
  s_waitcnt vmcnt(63)
  buffer_load_dwordx4 v52, s[12:15], s36 offen offset:0 lds
  buffer_load_dwordx4 v53, s[12:15], s36 offen offset:1024 lds
  buffer_load_dwordx4 v54, s[12:15], s36 offen offset:2048 lds
  buffer_load_dwordx4 v55, s[12:15], s36 offen offset:3072 lds
  s_add_u32 m0, s30, 73728
  s_waitcnt vmcnt(63)
  buffer_load_dwordx4 v56, s[12:15], s36 offen offset:0 lds
  buffer_load_dwordx4 v57, s[12:15], s36 offen offset:1024 lds
  buffer_load_dwordx4 v58, s[12:15], s36 offen offset:2048 lds
  buffer_load_dwordx4 v59, s[12:15], s36 offen offset:3072 lds
  s_add_u32 s30, s30, 12288
  s_cmp_eq_u32 s30, 86016
  s_cselect_b32 s30, 0, s30
  s_xor_b32 s36, s18, 3
  s_mul_i32 s36, s36, 393216
  s_add_u32 s36, s36, s39
  s_add_u32 m0, s30, 65536
  s_waitcnt vmcnt(63)
  buffer_load_dwordx4 v48, s[12:15], s36 offen offset:0 lds
  buffer_load_dwordx4 v49, s[12:15], s36 offen offset:1024 lds
  buffer_load_dwordx4 v50, s[12:15], s36 offen offset:2048 lds
  buffer_load_dwordx4 v51, s[12:15], s36 offen offset:3072 lds
  s_add_u32 m0, s30, 69632
  s_waitcnt vmcnt(63)
  buffer_load_dwordx4 v52, s[12:15], s36 offen offset:0 lds
  buffer_load_dwordx4 v53, s[12:15], s36 offen offset:1024 lds
  buffer_load_dwordx4 v54, s[12:15], s36 offen offset:2048 lds
  buffer_load_dwordx4 v55, s[12:15], s36 offen offset:3072 lds
  s_add_u32 m0, s30, 73728
  s_waitcnt vmcnt(63)
  buffer_load_dwordx4 v56, s[12:15], s36 offen offset:0 lds
  buffer_load_dwordx4 v57, s[12:15], s36 offen offset:1024 lds
  buffer_load_dwordx4 v58, s[12:15], s36 offen offset:2048 lds
  buffer_load_dwordx4 v59, s[12:15], s36 offen offset:3072 lds
  s_add_u32 s30, s30, 12288
  s_cmp_eq_u32 s30, 86016
  s_cselect_b32 s30, 0, s30
  s_mov_b32 s28, 1
  s_mov_b32 s29, 16384
  s_bitcmp1_b32 s37, s28
  s_cbranch_scc0 .g2_kernel_p2_x0w
.g2_kernel_p2_x0b:
  s_xor_b32 s33, s28, s18
  s_lshl_b32 s33, s33, 14
  s_add_u32 s33, s33, s32
  s_add_u32 m0, s29, 0
  s_waitcnt vmcnt(63)
  buffer_load_dwordx4 v3, s[4:7], s33 offen offset:0 lds
  buffer_load_dwordx4 v3, s[4:7], s33 offen offset:1024 lds
  buffer_load_dwordx4 v3, s[4:7], s33 offen offset:2048 lds
  buffer_load_dwordx4 v3, s[4:7], s33 offen offset:3072 lds
  s_add_u32 m0, s29, 4096
  s_waitcnt vmcnt(63)
  s_add_u32 s33, s33, 4096
  buffer_load_dwordx4 v3, s[4:7], s33 offen offset:0 lds
  buffer_load_dwordx4 v3, s[4:7], s33 offen offset:1024 lds
  buffer_load_dwordx4 v3, s[4:7], s33 offen offset:2048 lds
  buffer_load_dwordx4 v3, s[4:7], s33 offen offset:3072 lds
  s_add_u32 m0, s29, 8192
  s_waitcnt vmcnt(63)
  s_add_u32 s33, s33, 4096
  buffer_load_dwordx4 v3, s[4:7], s33 offen offset:0 lds
  buffer_load_dwordx4 v3, s[4:7], s33 offen offset:1024 lds
  buffer_load_dwordx4 v3, s[4:7], s33 offen offset:2048 lds
  buffer_load_dwordx4 v3, s[4:7], s33 offen offset:3072 lds
  s_add_u32 m0, s29, 12288
  s_waitcnt vmcnt(63)
  s_add_u32 s33, s33, 4096
  buffer_load_dwordx4 v3, s[4:7], s33 offen offset:0 lds
  buffer_load_dwordx4 v3, s[4:7], s33 offen offset:1024 lds
  buffer_load_dwordx4 v3, s[4:7], s33 offen offset:2048 lds
  buffer_load_dwordx4 v3, s[4:7], s33 offen offset:3072 lds
  s_mov_b32 m0, 156160
  s_mov_b32 s35, .g2_kernel_tab-.g2_kernel_pc+144
  s_mov_b64 exec, 1
  buffer_load_dword off, s[64:67], s35 lds
  s_mov_b64 exec, -1
  s_mov_b32 s28, 2
  s_mov_b32 s29, 32768
  s_bitcmp1_b32 s37, s28
  s_cbranch_scc0 .g2_kernel_p2_x1w
.g2_kernel_p2_x1b:
  s_xor_b32 s33, s28, s18
  s_lshl_b32 s33, s33, 14
  s_add_u32 s33, s33, s32
  s_add_u32 m0, s29, 0
  s_waitcnt vmcnt(63)
  buffer_load_dwordx4 v3, s[4:7], s33 offen offset:0 lds
  buffer_load_dwordx4 v3, s[4:7], s33 offen offset:1024 lds
  buffer_load_dwordx4 v3, s[4:7], s33 offen offset:2048 lds
  buffer_load_dwordx4 v3, s[4:7], s33 offen offset:3072 lds
  s_add_u32 m0, s29, 4096
  s_waitcnt vmcnt(63)
  s_add_u32 s33, s33, 4096
  buffer_load_dwordx4 v3, s[4:7], s33 offen offset:0 lds
  buffer_load_dwordx4 v3, s[4:7], s33 offen offset:1024 lds
  buffer_load_dwordx4 v3, s[4:7], s33 offen offset:2048 lds
  buffer_load_dwordx4 v3, s[4:7], s33 offen offset:3072 lds
  s_add_u32 m0, s29, 8192
  s_waitcnt vmcnt(63)
  s_add_u32 s33, s33, 4096
  buffer_load_dwordx4 v3, s[4:7], s33 offen offset:0 lds
  buffer_load_dwordx4 v3, s[4:7], s33 offen offset:1024 lds
  buffer_load_dwordx4 v3, s[4:7], s33 offen offset:2048 lds
  buffer_load_dwordx4 v3, s[4:7], s33 offen offset:3072 lds
  s_add_u32 m0, s29, 12288
  s_waitcnt vmcnt(63)
  s_add_u32 s33, s33, 4096
  buffer_load_dwordx4 v3, s[4:7], s33 offen offset:0 lds
  buffer_load_dwordx4 v3, s[4:7], s33 offen offset:1024 lds
  buffer_load_dwordx4 v3, s[4:7], s33 offen offset:2048 lds
  buffer_load_dwordx4 v3, s[4:7], s33 offen offset:3072 lds
  s_mov_b32 m0, 156160
  s_mov_b32 s35, .g2_kernel_tab-.g2_kernel_pc+152
  s_mov_b64 exec, 1
  buffer_load_dword off, s[64:67], s35 lds
  s_mov_b64 exec, -1
  s_mov_b32 s28, 3
  s_mov_b32 s29, 49152
  s_bitcmp1_b32 s37, s28
  s_cbranch_scc0 .g2_kernel_p2_x2w
.g2_kernel_p2_x2b:
  s_xor_b32 s33, s28, s18
  s_lshl_b32 s33, s33, 14
  s_add_u32 s33, s33, s32
  s_add_u32 m0, s29, 0
  s_waitcnt vmcnt(63)
  buffer_load_dwordx4 v3, s[4:7], s33 offen offset:0 lds
  buffer_load_dwordx4 v3, s[4:7], s33 offen offset:1024 lds
  buffer_load_dwordx4 v3, s[4:7], s33 offen offset:2048 lds
  buffer_load_dwordx4 v3, s[4:7], s33 offen offset:3072 lds
  s_add_u32 m0, s29, 4096
  s_waitcnt vmcnt(63)
  s_add_u32 s33, s33, 4096
  buffer_load_dwordx4 v3, s[4:7], s33 offen offset:0 lds
  buffer_load_dwordx4 v3, s[4:7], s33 offen offset:1024 lds
  buffer_load_dwordx4 v3, s[4:7], s33 offen offset:2048 lds
  buffer_load_dwordx4 v3, s[4:7], s33 offen offset:3072 lds
  s_add_u32 m0, s29, 8192
  s_waitcnt vmcnt(63)
  s_add_u32 s33, s33, 4096
  buffer_load_dwordx4 v3, s[4:7], s33 offen offset:0 lds
  buffer_load_dwordx4 v3, s[4:7], s33 offen offset:1024 lds
  buffer_load_dwordx4 v3, s[4:7], s33 offen offset:2048 lds
  buffer_load_dwordx4 v3, s[4:7], s33 offen offset:3072 lds
  s_add_u32 m0, s29, 12288
  s_waitcnt vmcnt(63)
  s_add_u32 s33, s33, 4096
  buffer_load_dwordx4 v3, s[4:7], s33 offen offset:0 lds
  buffer_load_dwordx4 v3, s[4:7], s33 offen offset:1024 lds
  buffer_load_dwordx4 v3, s[4:7], s33 offen offset:2048 lds
  buffer_load_dwordx4 v3, s[4:7], s33 offen offset:3072 lds
  s_mov_b32 m0, 156160
  s_mov_b32 s35, .g2_kernel_tab-.g2_kernel_pc+156
  s_mov_b64 exec, 1
  buffer_load_dword off, s[64:67], s35 lds
  s_mov_b64 exec, -1
  s_xor_b32 s36, s18, 3
  s_mul_i32 s36, s36, 393216
  s_add_u32 s36, s36, s39
  s_add_u32 s36, s36, 196608
  ds_read_b32 v10, v9
  s_mov_b32 s34, 33
  s_mov_b32 s35, .g2_kernel_tab-.g2_kernel_pc+160
  s_branch .g2_kernel_p2_o
  .p2align 6
.g2_kernel_p2_l:
  s_waitcnt lgkmcnt(0)
  v_cmp_gt_i32 vcc, s34, v10
  s_cbranch_vccnz .g2_kernel_p2_aw
.g2_kernel_p2_ai:
  s_add_u32 s29, s29, 16384
  s_and_b32 s29, s29, 0xffff
  s_bitcmp1_b32 s37, s28
  s_cbranch_scc0 .g2_kernel_p2_x3w
.g2_kernel_p2_x3b:
  s_xor_b32 s33, s28, s18
  s_lshl_b32 s33, s33, 14
  s_add_u32 s33, s33, s32
  s_add_u32 m0, s29, 0
  s_waitcnt vmcnt(63)
  buffer_load_dwordx4 v3, s[4:7], s33 offen offset:0 lds
  buffer_load_dwordx4 v3, s[4:7], s33 offen offset:1024 lds
  buffer_load_dwordx4 v3, s[4:7], s33 offen offset:2048 lds
  buffer_load_dwordx4 v3, s[4:7], s33 offen offset:3072 lds
  s_add_u32 m0, s29, 4096
  s_waitcnt vmcnt(63)
  s_add_u32 s33, s33, 4096
  buffer_load_dwordx4 v3, s[4:7], s33 offen offset:0 lds
  buffer_load_dwordx4 v3, s[4:7], s33 offen offset:1024 lds
  buffer_load_dwordx4 v3, s[4:7], s33 offen offset:2048 lds
  buffer_load_dwordx4 v3, s[4:7], s33 offen offset:3072 lds
  s_add_u32 m0, s29, 8192
  s_waitcnt vmcnt(63)
  s_add_u32 s33, s33, 4096
  buffer_load_dwordx4 v3, s[4:7], s33 offen offset:0 lds
  buffer_load_dwordx4 v3, s[4:7], s33 offen offset:1024 lds
  buffer_load_dwordx4 v3, s[4:7], s33 offen offset:2048 lds
  buffer_load_dwordx4 v3, s[4:7], s33 offen offset:3072 lds
  s_add_u32 m0, s29, 12288
  s_waitcnt vmcnt(63)
  s_add_u32 s33, s33, 4096
  buffer_load_dwordx4 v3, s[4:7], s33 offen offset:0 lds
  buffer_load_dwordx4 v3, s[4:7], s33 offen offset:1024 lds
  buffer_load_dwordx4 v3, s[4:7], s33 offen offset:2048 lds
  buffer_load_dwordx4 v3, s[4:7], s33 offen offset:3072 lds
  s_add_u32 m0, s30, 65536
  s_waitcnt vmcnt(63)
  buffer_load_dwordx4 v48, s[12:15], s36 offen offset:0 lds
  buffer_load_dwordx4 v49, s[12:15], s36 offen offset:1024 lds
  buffer_load_dwordx4 v50, s[12:15], s36 offen offset:2048 lds
  buffer_load_dwordx4 v51, s[12:15], s36 offen offset:3072 lds
  s_add_u32 m0, s30, 69632
  s_waitcnt vmcnt(63)
  buffer_load_dwordx4 v52, s[12:15], s36 offen offset:0 lds
  buffer_load_dwordx4 v53, s[12:15], s36 offen offset:1024 lds
  buffer_load_dwordx4 v54, s[12:15], s36 offen offset:2048 lds
  buffer_load_dwordx4 v55, s[12:15], s36 offen offset:3072 lds
  s_add_u32 m0, s30, 73728
  s_waitcnt vmcnt(63)
  buffer_load_dwordx4 v56, s[12:15], s36 offen offset:0 lds
  buffer_load_dwordx4 v57, s[12:15], s36 offen offset:1024 lds
  buffer_load_dwordx4 v58, s[12:15], s36 offen offset:2048 lds
  buffer_load_dwordx4 v59, s[12:15], s36 offen offset:3072 lds
  s_add_u32 s30, s30, 12288
  s_cmp_eq_u32 s30, 86016
  s_cselect_b32 s30, 0, s30
  ds_read_b32 v10, v9
  s_mov_b32 m0, 156160
  s_add_u32 s34, s34, 1
  s_mov_b64 exec, 1
  buffer_load_dword off, s[64:67], s35 lds
  s_mov_b64 exec, -1
  s_add_u32 s35, s35, 4
  s_add_u32 s36, s36, 196608
.g2_kernel_p2_o:
  s_waitcnt lgkmcnt(0)
  v_cmp_gt_i32 vcc, s34, v10
  s_cbranch_vccnz .g2_kernel_p2_bw
.g2_kernel_p2_bi:
  s_add_u32 m0, s30, 65536
  s_waitcnt vmcnt(63)
  buffer_load_dwordx4 v48, s[12:15], s36 offen offset:0 lds
  buffer_load_dwordx4 v49, s[12:15], s36 offen offset:1024 lds
  buffer_load_dwordx4 v50, s[12:15], s36 offen offset:2048 lds
  buffer_load_dwordx4 v51, s[12:15], s36 offen offset:3072 lds
  s_add_u32 m0, s30, 69632
  s_waitcnt vmcnt(63)
  buffer_load_dwordx4 v52, s[12:15], s36 offen offset:0 lds
  buffer_load_dwordx4 v53, s[12:15], s36 offen offset:1024 lds
  buffer_load_dwordx4 v54, s[12:15], s36 offen offset:2048 lds
  buffer_load_dwordx4 v55, s[12:15], s36 offen offset:3072 lds
  s_add_u32 m0, s30, 73728
  s_waitcnt vmcnt(63)
  buffer_load_dwordx4 v56, s[12:15], s36 offen offset:0 lds
  buffer_load_dwordx4 v57, s[12:15], s36 offen offset:1024 lds
  buffer_load_dwordx4 v58, s[12:15], s36 offen offset:2048 lds
  buffer_load_dwordx4 v59, s[12:15], s36 offen offset:3072 lds
  s_add_u32 s30, s30, 12288
  s_cmp_eq_u32 s30, 86016
  s_cselect_b32 s30, 0, s30
  ds_read_b32 v10, v9
  s_mov_b32 m0, 156160
  s_add_u32 s34, s34, 1
  s_mov_b64 exec, 1
  buffer_load_dword off, s[64:67], s35 lds
  s_mov_b64 exec, -1
  s_add_u32 s35, s35, 4
  s_add_u32 s28, s28, 1
  s_xor_b32 s36, s18, s28
  s_mul_i32 s36, s36, 393216
  s_add_u32 s36, s36, s39
  s_cmp_lt_i32 s34, 58
  s_cbranch_scc1 .g2_kernel_p2_l
  s_branch .g2_kernel_v
.g2_kernel_c1:
  v_mov_b32 v6, s71
  s_mov_b32 s38, 0
.g2_kernel_wg40:
  ds_read_b32 v7, v6 offset:76
  s_add_u32 s38, s38, 1
  s_waitcnt lgkmcnt(0)
  v_cmp_gt_u32 vcc, 1, v7
  s_cbranch_vccz .g2_kernel_wg40d
  s_sleep 1
  s_cmp_lt_u32 s38, 524288
  s_cbranch_scc1 .g2_kernel_wg40
.g2_kernel_wg40d:
  s_sleep 4
  s_and_b32 s31, s19, 0xffffe000
  s_add_u32 s31, s31, 4
  v_and_b32 v6, 15, v2
  v_lshlrev_b32 v6, 9, v6
  v_lshrrev_b32 v7, 4, v2
  v_lshl_add_u32 v6, v7, 7, v6
  v_lshlrev_b32 v7, 2, v2
  v_add_u32 v7, 157952, v7
  s_mov_b32 m0, 157952
  s_mov_b32 s38, 0
  s_bfm_b64 exec, 16, 48
.g2_kernel_pa41:
  buffer_load_dword v6, s[4:7], s31 offen sc1 lds
  s_add_u32 s38, s38, 1
  s_waitcnt vmcnt(0)
  ds_read_b32 v8, v7
  s_waitcnt lgkmcnt(0)
  v_cmp_ge_u32 vcc, s62, v8
  s_cbranch_vccz .g2_kernel_pa41d
  s_mov_b64 exec, vcc
  s_sleep 4
  s_cmp_lt_u32 s38, 131072
  s_cbranch_scc1 .g2_kernel_pa41
.g2_kernel_pa41d:
  s_mov_b64 exec, -1
  s_setprio 2
  s_mov_b32 s39, 0
  s_lshl_b32 s30, s17, 2
  s_lshr_b32 s28, s18, 2
  s_add_u32 s30, s30, s28
  s_lshl_b32 s20, s30, 13
  s_add_u32 s20, s20, s63
  s_add_u32 s20, s20, 0x1000000
  s_add_u32 s24, s20, 4096
  s_lshl_b32 s21, s30, 8
  s_add_u32 s21, s21, s63
  s_add_u32 s21, s21, 0x1080000
  s_lshl_b32 s23, s62, 16
  s_add_u32 s23, s23, 0x3040000
  s_lshl_b32 s22, s30, 7
  s_add_u32 s22, s22, s23
  s_and_b32 s28, s2, 7
  s_lshl_b32 s28, s28, 13
  s_add_u32 s23, s23, s28
  v_mov_b32 v9, 155648
  ds_read_b32 v26, v9 offset:256
  v_and_b32 v24, 31, v2
  v_lshlrev_b32 v25, 3, v2
  v_lshlrev_b32 v27, 13, v2
  v_mov_b32 v28, 0.0009765625
  v_mov_b32 v30, 1e-05
  v_mov_b32 v6, s71
  s_mov_b32 s38, 0
.g2_kernel_wg43:
  ds_read_b32 v7, v6 offset:20
  s_add_u32 s38, s38, 1
  s_waitcnt lgkmcnt(0)
  v_cmp_gt_u32 vcc, 4, v7
  s_cbranch_vccz .g2_kernel_wg43d
  s_sleep 1
  s_cmp_lt_u32 s38, 524288
  s_cbranch_scc1 .g2_kernel_wg43
.g2_kernel_wg43d:
  s_sleep 12
  s_cmp_lg_u32 s62, 0
  s_cbranch_scc1 .g2_kernel_nap44
  s_sleep 12
.g2_kernel_nap44:
  s_xor_b32 s28, s17, s18
  s_and_b32 s28, s28, 3
  s_cbranch_scc1 .g2_kernel_c_l1
  s_mov_b32 s38, 0
.g2_kernel_gx45:
  buffer_load_dwordx4 v[32:35], v3, s[4:7], s20 offen offset:0 sc1
  buffer_load_dwordx4 v[36:39], v3, s[4:7], s20 offen offset:1024 sc1
  buffer_load_dwordx4 v[40:43], v3, s[4:7], s20 offen offset:2048 sc1
  buffer_load_dwordx4 v[44:47], v3, s[4:7], s20 offen offset:3072 sc1
  buffer_load_dwordx4 v[48:51], v3, s[4:7], s24 offen offset:0 sc1
  buffer_load_dwordx4 v[52:55], v3, s[4:7], s24 offen offset:1024 sc1
  buffer_load_dwordx4 v[56:59], v3, s[4:7], s24 offen offset:2048 sc1
  buffer_load_dwordx4 v[60:63], v3, s[4:7], s24 offen offset:3072 sc1
  s_add_u32 s38, s38, 1
  s_waitcnt vmcnt(0)
  v_min3_u32 v6, v32, v35, v36
  v_min3_u32 v6, v6, v39, v40
  v_min3_u32 v6, v6, v43, v44
  v_min3_u32 v6, v6, v47, v48
  v_min3_u32 v6, v6, v51, v52
  v_min3_u32 v6, v6, v55, v56
  v_min3_u32 v6, v6, v59, v60
  v_min_u32 v6, v6, v63
  v_cmp_eq_u32 vcc, 0, v6
  s_cbranch_vccz .g2_kernel_gx45d
  s_mov_b64 exec, vcc
  s_sleep 1
  s_cmp_lg_u32 s62, 0
  s_cbranch_scc1 .g2_kernel_nap46
  s_sleep 9
.g2_kernel_nap46:
  s_cmp_lt_u32 s38, 131072
  s_cbranch_scc1 .g2_kernel_gx45
.g2_kernel_gx45d:
  s_mov_b64 exec, -1
  v_add_f32 v32, v32, v48
  v_add_f32 v33, v33, v49
  v_add_f32 v34, v34, v50
  v_add_f32 v36, v36, v52
  v_add_f32 v37, v37, v53
  v_add_f32 v38, v38, v54
  v_add_f32 v40, v40, v56
  v_add_f32 v41, v41, v57
  v_add_f32 v42, v42, v58
  v_add_f32 v44, v44, v60
  v_add_f32 v45, v45, v61
  v_add_f32 v46, v46, v62
  v_add_f32 v32, v32, v40
  v_add_f32 v33, v33, v41
  v_add_f32 v34, v34, v42
  v_add_f32 v36, v36, v44
  v_add_f32 v37, v37, v45
  v_add_f32 v38, v38, v46
  v_add_f32 v32, v32, v36
  v_add_f32 v33, v33, v37
  v_add_f32 v34, v34, v38
  v_mov_b32 v16, v32
  v_mov_b32 v17, v33
  v_mov_b32 v18, v34
  s_mov_b32 s28, -32
  v_permlane32_swap_b32 v16, v32
  v_permlane32_swap_b32 v17, v33
  v_permlane32_swap_b32 v18, v34
  v_add_f32 v16, v16, v32
  v_add_f32 v17, v17, v33
  v_add_f32 v18, v18, v34
  v_fma_f32 v18, -v16, v26, v18
  v_mul_f32 v16, v28, v16
  v_mul_f32 v19, v16, v16
  v_fma_f32 v17, v17, v28, -v19
  v_max_f32 v17, 0, v17
  v_add_f32 v17, v30, v17
  v_rsq_f32 v19, v17
  v_mov_b32 v11, 1
  v_mul_f32 v18, v18, v19
  v_and_or_b32 v10, v18, s28, v24
  s_nop 1
  v_max_f32 v10, v10, v10 row_ror:8 row_mask:0xf bank_mask:0xf
  s_nop 1
  v_max_f32 v10, v10, v10 row_ror:4 row_mask:0xf bank_mask:0xf
  s_nop 1
  v_max_f32 v10, v10, v10 row_ror:2 row_mask:0xf bank_mask:0xf
  s_nop 1
  v_max_f32 v10, v10, v10 row_ror:1 row_mask:0xf bank_mask:0xf
  s_nop 1
  v_max_f32 v10, v10, v10 row_bcast:15 row_mask:0xa bank_mask:0xf
  s_nop 0
  v_readlane_b32 s28, v10, 31
  s_nop 1
  v_mov_b32 v10, s28
  s_mov_b64 exec, 0xff
  buffer_store_dwordx2 v[10:11], v27, s[4:7], s22 offen sc1
  s_mov_b32 exec_lo, -1
  buffer_store_dwordx2 v[16:17], v25, s[4:7], s21 offen sc1
  s_mov_b64 exec, -1
.g2_kernel_c_l1:
  s_cmp_lg_u32 s62, 0
  s_cbranch_scc1 .g2_kernel_c_t3
  s_sleep 30
  s_mov_b64 s[8:9], -1
  s_call_b64 s[68:69], .g2_kernel_amax
  s_lshr_b32 s28, s77, 5
  s_add_u32 m0, s71, 104
  s_lshl_b32 s29, s28, 2
  s_add_u32 s29, s29, .g2_kernel_tab-.g2_kernel_pc
  s_mov_b64 exec, 1
  buffer_load_dword off, s[64:67], s29 lds
  s_mov_b64 exec, -1
  s_and_b32 s28, s77, 31
  s_add_u32 s28, s28, 1
  s_add_u32 m0, s71, 36
  s_lshl_b32 s29, s28, 2
  s_add_u32 s29, s29, .g2_kernel_tab-.g2_kernel_pc
  s_mov_b64 exec, 1
  buffer_load_dword off, s[64:67], s29 lds
  s_mov_b64 exec, -1
  s_lshr_b32 s24, s77, 7
  s_lshl_b32 s24, s24, 18
  s_bfe_u32 s28, s77, 0x30004
  s_lshl_b32 s28, s28, 11
  s_add_u32 s24, s24, s28
  s_and_b32 s28, s77, 15
  s_lshl_b32 s28, s28, 4
  s_add_u32 s24, s24, s28
  s_add_u32 s24, s24, s63
  s_add_u32 s24, s24, 0xc00000
  s_lshl_b32 s28, s17, 14
  s_add_u32 s24, s24, s28
  s_and_b32 s28, s18, 1
  s_lshl_b32 s28, s28, 8
  s_add_u32 s24, s24, s28
  v_lshrrev_b32 v12, 3, v2
  v_lshlrev_b32 v13, 1, v12
  buffer_load_ushort v56, v13, s[4:7], s24 offen offset:0
  buffer_load_ushort v57, v13, s[4:7], s24 offen offset:512
  buffer_load_ushort v58, v13, s[4:7], s24 offen offset:1024
  buffer_load_ushort v59, v13, s[4:7], s24 offen offset:1536
  s_lshl_b32 s25, s77, 3
  s_add_u32 s25, s25, s63
  s_add_u32 s25, s25, 0x1080000
  s_lshl_b32 s21, s17, 10
  s_add_u32 s21, s21, s63
  s_add_u32 s21, s21, 0x1080000
  s_mov_b32 s38, 0
.g2_kernel_gx47:
  buffer_load_dwordx4 v[16:19], v3, s[4:7], s21 offen sc1
  buffer_load_dwordx2 v[20:21], v4, s[4:7], s25 offen sc1
  s_add_u32 s38, s38, 1
  s_waitcnt vmcnt(0)
  v_min3_u32 v6, v17, v19, v21
  v_cmp_eq_u32 vcc, 0, v6
  s_cbranch_vccz .g2_kernel_gx47d
  s_mov_b64 exec, vcc
  s_sleep 1
  s_cmp_lt_u32 s38, 131072
  s_cbranch_scc1 .g2_kernel_gx47
.g2_kernel_gx47d:
  s_mov_b64 exec, -1
  s_lshr_b32 s28, s77, 7
  s_and_b32 s79, s77, 127
  s_add_u32 s79, s79, 1
  s_cmp_eq_u32 s28, s17
  s_cselect_b32 s79, s79, 0
  v_rsq_f32 v22, v17
  v_rsq_f32 v23, v19
  v_rsq_f32 v21, v21
  v_mov_b32 v62, -1.4426950408889634
  v_mul_f32 v62, s27, v62
  v_exp_f32 v62, v62
  v_lshlrev_b32 v14, 3, v2
  v_add_u32 v14, 155648, v14
  v_mov_b32 v15, s79
  v_add_f32 v52, 1.0, v22
  v_mul_f32 v54, v16, v22
  v_sub_f32 v54, 0, v54
  v_add_f32 v53, 1.0, v23
  v_mul_f32 v55, v18, v23
  v_sub_f32 v55, 0, v55
  v_add_f32 v62, 1.0, v62
  v_rcp_f32 v62, v62
  v_add_f32 v60, 1.0, v21
  v_mul_f32 v61, v20, v21
  v_sub_f32 v61, 0, v61
  v_sub_f32 v17, v17, v30
  v_mul_f32 v48, v52, v52
  v_fma_f32 v48, v48, v17, v30
  v_rsq_f32 v48, v48
  s_nop 0
  v_mul_f32 v48, v48, v52
  v_mul_f32 v50, v48, v16
  v_sub_f32 v50, 0, v50
  v_sub_f32 v19, v19, v30
  v_mul_f32 v49, v53, v53
  v_fma_f32 v49, v49, v19, v30
  v_rsq_f32 v49, v49
  s_nop 0
  v_mul_f32 v49, v49, v53
  v_mul_f32 v51, v49, v18
  v_sub_f32 v51, 0, v51
  v_lshlrev_b32 v56, 16, v56
  v_fma_f32 v56, v56, v60, v61
  v_lshlrev_b32 v57, 16, v57
  v_fma_f32 v57, v57, v60, v61
  v_lshlrev_b32 v58, 16, v58
  v_fma_f32 v58, v58, v60, v61
  v_lshlrev_b32 v59, 16, v59
  v_fma_f32 v59, v59, v60, v61
  v_and_b32 v10, 7, v2
  v_lshlrev_b32 v10, 12, v10
  v_lshl_add_u32 v10, v12, 4, v10
  s_lshl_b32 s20, s17, 1
  s_and_b32 s28, s18, 1
  s_add_u32 s20, s20, s28
  s_lshl_b32 s20, s20, 7
  s_add_u32 s20, s20, s63
  s_add_u32 s20, s20, 0x1090000
  s_and_b32 s26, s18, 14
  s_lshl_b32 s26, s26, 4
  s_add_u32 s26, s26, s17
  s_lshl_b32 s26, s26, 1
  s_and_b32 s28, s18, 1
  s_add_u32 s26, s26, s28
  s_lshl_b32 s26, s26, 10
  s_add_u32 s26, s26, s63
  s_add_u32 s26, s26, 0x1190000
  s_add_u32 s25, s26, 32768
  s_lshl_b32 s21, s2, 12
  s_add_u32 s21, s21, 0x3200000
  v_lshlrev_b32 v14, 3, v2
  buffer_store_dwordx2 v[48:49], v14, s[4:7], s21 offen
  buffer_store_dwordx2 v[50:51], v14, s[4:7], s21 offen offset:512
  buffer_store_dwordx2 v[52:53], v14, s[4:7], s21 offen offset:1024
  buffer_store_dwordx2 v[54:55], v14, s[4:7], s21 offen offset:1536
  buffer_store_dword v15, v4, s[4:7], s21 offen offset:2048
  s_mov_b32 m0, 158464
  s_add_u32 s22, s21, 2048
  s_waitcnt vmcnt(0)
  buffer_load_dwordx4 v3, s[4:7], s21 offen lds
  buffer_load_dwordx4 v3, s[4:7], s21 offen offset:1024 lds
  s_mov_b32 m0, 155800
  s_mov_b64 exec, 1
  buffer_load_dword v4, s[4:7], s22 offen lds
  s_mov_b64 exec, -1
  s_add_u32 m0, s71, 128
  s_mov_b32 s29, .g2_kernel_tab-.g2_kernel_pc+8
  s_mov_b64 exec, 1
  buffer_load_dword off, s[64:67], s29 lds
  s_mov_b64 exec, -1
  s_lshl_b32 s28, s2, 10
  s_and_b32 s28, s28, 0xe000
  v_lshlrev_b32 v7, 7, v2
  buffer_load_dword v1, v7, s[64:67], s28 offen
  v_mov_b32 v6, s71
  s_mov_b32 s38, 0
.g2_kernel_wg48:
  ds_read_b32 v7, v6 offset:112
  s_add_u32 s38, s38, 1
  s_waitcnt lgkmcnt(0)
  v_cmp_gt_u32 vcc, 1, v7
  s_cbranch_vccz .g2_kernel_wg48d
  s_sleep 2
  s_cmp_lt_u32 s38, 524288
  s_cbranch_scc1 .g2_kernel_wg48
.g2_kernel_wg48d:
  s_sleep 8
  s_cmp_lg_u32 s62, 0
  s_cbranch_scc1 .g2_kernel_nap49
  s_sleep 22
.g2_kernel_nap49:
  s_mov_b32 s38, 0
.g2_kernel_gx50:
  s_mov_b32 s21, s20
  buffer_load_dwordx4 v[160:163], v10, s[4:7], s21 offen sc1
  s_add_u32 s21, s21, 32768
  buffer_load_dwordx4 v[164:167], v10, s[4:7], s21 offen sc1
  s_add_u32 s21, s21, 32768
  buffer_load_dwordx4 v[168:171], v10, s[4:7], s21 offen sc1
  s_add_u32 s21, s21, 32768
  buffer_load_dwordx4 v[172:175], v10, s[4:7], s21 offen sc1
  s_add_u32 s21, s21, 32768
  buffer_load_dwordx4 v[176:179], v10, s[4:7], s21 offen sc1
  s_add_u32 s21, s21, 32768
  buffer_load_dwordx4 v[180:183], v10, s[4:7], s21 offen sc1
  s_add_u32 s21, s21, 32768
  buffer_load_dwordx4 v[184:187], v10, s[4:7], s21 offen sc1
  s_add_u32 s21, s21, 32768
  buffer_load_dwordx4 v[188:191], v10, s[4:7], s21 offen sc1
  s_add_u32 s21, s21, 32768
  buffer_load_dwordx4 v[192:195], v10, s[4:7], s21 offen sc1
  s_add_u32 s21, s21, 32768
  buffer_load_dwordx4 v[196:199], v10, s[4:7], s21 offen sc1
  s_add_u32 s21, s21, 32768
  buffer_load_dwordx4 v[200:203], v10, s[4:7], s21 offen sc1
  s_add_u32 s21, s21, 32768
  buffer_load_dwordx4 v[204:207], v10, s[4:7], s21 offen sc1
  s_add_u32 s21, s21, 32768
  buffer_load_dwordx4 v[208:211], v10, s[4:7], s21 offen sc1
  s_add_u32 s21, s21, 32768
  buffer_load_dwordx4 v[212:215], v10, s[4:7], s21 offen sc1
  s_add_u32 s21, s21, 32768
  buffer_load_dwordx4 v[216:219], v10, s[4:7], s21 offen sc1
  s_add_u32 s21, s21, 32768
  buffer_load_dwordx4 v[220:223], v10, s[4:7], s21 offen sc1
  s_add_u32 s21, s21, 32768
  buffer_load_dwordx4 v[224:227], v10, s[4:7], s21 offen sc1
  s_add_u32 s21, s21, 32768
  buffer_load_dwordx4 v[228:231], v10, s[4:7], s21 offen sc1
  s_add_u32 s21, s21, 32768
  buffer_load_dwordx4 v[232:235], v10, s[4:7], s21 offen sc1
  s_add_u32 s21, s21, 32768
  buffer_load_dwordx4 v[236:239], v10, s[4:7], s21 offen sc1
  s_add_u32 s21, s21, 32768
  buffer_load_dwordx4 v[240:243], v10, s[4:7], s21 offen sc1
  s_add_u32 s21, s21, 32768
  buffer_load_dwordx4 v[244:247], v10, s[4:7], s21 offen sc1
  s_add_u32 s21, s21, 32768
  buffer_load_dwordx4 v[248:251], v10, s[4:7], s21 offen sc1
  s_add_u32 s21, s21, 32768
  buffer_load_dwordx4 v[252:255], v10, s[4:7], s21 offen sc1
  s_add_u32 s21, s21, 32768
  buffer_load_dwordx4 v[16:19], v10, s[4:7], s21 offen sc1
  s_add_u32 s21, s21, 32768
  buffer_load_dwordx4 v[20:23], v10, s[4:7], s21 offen sc1
  s_add_u32 s21, s21, 32768
  buffer_load_dwordx4 v[24:27], v10, s[4:7], s21 offen sc1
  s_add_u32 s21, s21, 32768
  buffer_load_dwordx4 v[28:31], v10, s[4:7], s21 offen sc1
  s_add_u32 s21, s21, 32768
  s_add_u32 s38, s38, 1
  s_waitcnt vmcnt(0)
  v_min3_u32 v6, v160, v162, v164
  v_min3_u32 v6, v6, v166, v168
  v_min3_u32 v6, v6, v170, v172
  v_min3_u32 v6, v6, v174, v176
  v_min3_u32 v6, v6, v178, v180
  v_min3_u32 v6, v6, v182, v184
  v_min3_u32 v6, v6, v186, v188
  v_min3_u32 v6, v6, v190, v192
  v_min3_u32 v6, v6, v194, v196
  v_min3_u32 v6, v6, v198, v200
  v_min3_u32 v6, v6, v202, v204
  v_min3_u32 v6, v6, v206, v208
  v_min3_u32 v6, v6, v210, v212
  v_min3_u32 v6, v6, v214, v216
  v_min3_u32 v6, v6, v218, v220
  v_min3_u32 v6, v6, v222, v224
  v_min3_u32 v6, v6, v226, v228
  v_min3_u32 v6, v6, v230, v232
  v_min3_u32 v6, v6, v234, v236
  v_min3_u32 v6, v6, v238, v240
  v_min3_u32 v6, v6, v242, v244
  v_min3_u32 v6, v6, v246, v248
  v_min3_u32 v6, v6, v250, v252
  v_min3_u32 v6, v6, v254, v16
  v_min3_u32 v6, v6, v18, v20
  v_min3_u32 v6, v6, v22, v24
  v_min3_u32 v6, v6, v26, v28
  v_min_u32 v6, v6, v30
  v_cmp_eq_u32 vcc, 0, v6
  s_cbranch_vccz .g2_kernel_gx50d
  s_mov_b64 exec, vcc
  s_sleep 1
  s_cmp_lg_u32 s62, 0
  s_cbranch_scc1 .g2_kernel_nap51
  s_sleep 11
.g2_kernel_nap51:
  s_cmp_lt_u32 s38, 131072
  s_cbranch_scc1 .g2_kernel_gx50
.g2_kernel_gx50d:
  s_mov_b64 exec, -1
  v_add_f32 v164, v164, v160
  v_add_f32 v165, v165, v161
  v_add_f32 v166, v166, v162
  v_add_f32 v167, v167, v163
  v_add_f32 v172, v172, v168
  v_add_f32 v173, v173, v169
  v_add_f32 v174, v174, v170
  v_add_f32 v175, v175, v171
  v_add_f32 v180, v180, v176
  v_add_f32 v181, v181, v177
  v_add_f32 v182, v182, v178
  v_add_f32 v183, v183, v179
  v_add_f32 v188, v188, v184
  v_add_f32 v189, v189, v185
  v_add_f32 v190, v190, v186
  v_add_f32 v191, v191, v187
  v_add_f32 v196, v196, v192
  v_add_f32 v197, v197, v193
  v_add_f32 v198, v198, v194
  v_add_f32 v199, v199, v195
  v_add_f32 v204, v204, v200
  v_add_f32 v205, v205, v201
  v_add_f32 v206, v206, v202
  v_add_f32 v207, v207, v203
  v_add_f32 v212, v212, v208
  v_add_f32 v213, v213, v209
  v_add_f32 v214, v214, v210
  v_add_f32 v215, v215, v211
  v_add_f32 v220, v220, v216
  v_add_f32 v221, v221, v217
  v_add_f32 v222, v222, v218
  v_add_f32 v223, v223, v219
  v_add_f32 v228, v228, v224
  v_add_f32 v229, v229, v225
  v_add_f32 v230, v230, v226
  v_add_f32 v231, v231, v227
  v_add_f32 v236, v236, v232
  v_add_f32 v237, v237, v233
  v_add_f32 v238, v238, v234
  v_add_f32 v239, v239, v235
  v_add_f32 v244, v244, v240
  v_add_f32 v245, v245, v241
  v_add_f32 v246, v246, v242
  v_add_f32 v247, v247, v243
  v_add_f32 v252, v252, v248
  v_add_f32 v253, v253, v249
  v_add_f32 v254, v254, v250
  v_add_f32 v255, v255, v251
  v_add_f32 v20, v20, v16
  v_add_f32 v21, v21, v17
  v_add_f32 v22, v22, v18
  v_add_f32 v23, v23, v19
  v_add_f32 v28, v28, v24
  v_add_f32 v29, v29, v25
  v_add_f32 v30, v30, v26
  v_add_f32 v31, v31, v27
  v_add_f32 v172, v172, v164
  v_add_f32 v173, v173, v165
  v_add_f32 v174, v174, v166
  v_add_f32 v175, v175, v167
  v_add_f32 v188, v188, v180
  v_add_f32 v189, v189, v181
  v_add_f32 v190, v190, v182
  v_add_f32 v191, v191, v183
  v_add_f32 v204, v204, v196
  v_add_f32 v205, v205, v197
  v_add_f32 v206, v206, v198
  v_add_f32 v207, v207, v199
  v_add_f32 v220, v220, v212
  v_add_f32 v221, v221, v213
  v_add_f32 v222, v222, v214
  v_add_f32 v223, v223, v215
  v_add_f32 v236, v236, v228
  v_add_f32 v237, v237, v229
  v_add_f32 v238, v238, v230
  v_add_f32 v239, v239, v231
  v_add_f32 v252, v252, v244
  v_add_f32 v253, v253, v245
  v_add_f32 v254, v254, v246
  v_add_f32 v255, v255, v247
  v_add_f32 v28, v28, v20
  v_add_f32 v29, v29, v21
  v_add_f32 v30, v30, v22
  v_add_f32 v31, v31, v23
  v_add_f32 v188, v188, v172
  v_add_f32 v189, v189, v173
  v_add_f32 v190, v190, v174
  v_add_f32 v191, v191, v175
  v_add_f32 v220, v220, v204
  v_add_f32 v221, v221, v205
  v_add_f32 v222, v222, v206
  v_add_f32 v223, v223, v207
  v_add_f32 v252, v252, v236
  v_add_f32 v253, v253, v237
  v_add_f32 v254, v254, v238
  v_add_f32 v255, v255, v239
  v_add_f32 v220, v220, v188
  v_add_f32 v221, v221, v189
  v_add_f32 v222, v222, v190
  v_add_f32 v223, v223, v191
  v_add_f32 v28, v28, v252
  v_add_f32 v29, v29, v253
  v_add_f32 v30, v30, v254
  v_add_f32 v31, v31, v255
  v_add_f32 v28, v28, v220
  v_add_f32 v29, v29, v221
  v_add_f32 v30, v30, v222
  v_add_f32 v31, v31, v223
  v_add_f32 v28, v28, v28 quad_perm:[1,0,3,2] row_mask:0xf bank_mask:0xf
  v_add_f32 v29, v29, v29 quad_perm:[1,0,3,2] row_mask:0xf bank_mask:0xf
  v_add_f32 v30, v30, v30 quad_perm:[1,0,3,2] row_mask:0xf bank_mask:0xf
  v_add_f32 v31, v31, v31 quad_perm:[1,0,3,2] row_mask:0xf bank_mask:0xf
  v_add_f32 v28, v28, v28 quad_perm:[2,3,0,1] row_mask:0xf bank_mask:0xf
  v_add_f32 v29, v29, v29 quad_perm:[2,3,0,1] row_mask:0xf bank_mask:0xf
  v_add_f32 v30, v30, v30 quad_perm:[2,3,0,1] row_mask:0xf bank_mask:0xf
  v_add_f32 v31, v31, v31 quad_perm:[2,3,0,1] row_mask:0xf bank_mask:0xf
  v_add_f32 v28, v28, v28 row_half_mirror row_mask:0xf bank_mask:0xf
  v_add_f32 v29, v29, v29 row_half_mirror row_mask:0xf bank_mask:0xf
  v_add_f32 v30, v30, v30 row_half_mirror row_mask:0xf bank_mask:0xf
  v_add_f32 v31, v31, v31 row_half_mirror row_mask:0xf bank_mask:0xf
  v_mul_f32 v28, v28, v62
  v_mul_f32 v29, v29, v62
  v_mul_f32 v30, v30, v62
  v_mul_f32 v31, v31, v62
  v_cvt_pk_bf16_f32 v16, v28, v29
  v_cvt_pk_bf16_f32 v17, v30, v31
  s_mov_b32 s28, 0x00010001
  s_mov_b32 s29, 0x00010001
  v_mov_b32 v18, v16 row_ror:8 row_mask:0xf bank_mask:0xf
  v_mov_b32 v19, v17 row_ror:8 row_mask:0xf bank_mask:0xf
  v_lshlrev_b32 v28, 16, v16
  v_and_b32 v29, 0xffff0000, v16
  v_lshlrev_b32 v30, 16, v17
  v_and_b32 v31, 0xffff0000, v17
  v_cndmask_b32 v32, 0, v16, s[28:29]
  v_cndmask_b32 v33, 0, v17, s[28:29]
  v_cndmask_b32 v34, 0, v18, s[28:29]
  v_cndmask_b32 v35, 0, v19, s[28:29]
  s_lshl_b64 s[28:29], s[28:29], 1
  s_nop 0
  v_mfma_f32_16x16x32_bf16 v[160:163], v[32:35], v[64:67], 0
  v_mfma_f32_16x16x32_bf16 v[164:167], v[32:35], v[80:83], 0
  v_mfma_f32_16x16x32_bf16 v[168:171], v[32:35], v[96:99], 0
  v_mfma_f32_16x16x32_bf16 v[172:175], v[32:35], v[112:115], 0
  v_mfma_f32_16x16x32_bf16 v[176:179], v[32:35], v[128:131], 0
  v_mfma_f32_16x16x32_bf16 v[180:183], v[32:35], v[144:147], 0
  v_cndmask_b32 v36, 0, v16, s[28:29]
  v_cndmask_b32 v37, 0, v17, s[28:29]
  v_cndmask_b32 v38, 0, v18, s[28:29]
  v_cndmask_b32 v39, 0, v19, s[28:29]
  s_lshl_b64 s[28:29], s[28:29], 1
  s_nop 0
  v_mfma_f32_16x16x32_bf16 v[160:163], v[36:39], v[68:71], v[160:163]
  v_mfma_f32_16x16x32_bf16 v[164:167], v[36:39], v[84:87], v[164:167]
  v_mfma_f32_16x16x32_bf16 v[168:171], v[36:39], v[100:103], v[168:171]
  v_mfma_f32_16x16x32_bf16 v[172:175], v[36:39], v[116:119], v[172:175]
  v_mfma_f32_16x16x32_bf16 v[176:179], v[36:39], v[132:135], v[176:179]
  v_mfma_f32_16x16x32_bf16 v[180:183], v[36:39], v[148:151], v[180:183]
  v_cndmask_b32 v40, 0, v16, s[28:29]
  v_cndmask_b32 v41, 0, v17, s[28:29]
  v_cndmask_b32 v42, 0, v18, s[28:29]
  v_cndmask_b32 v43, 0, v19, s[28:29]
  s_lshl_b64 s[28:29], s[28:29], 1
  s_nop 0
  v_mfma_f32_16x16x32_bf16 v[160:163], v[40:43], v[72:75], v[160:163]
  v_mfma_f32_16x16x32_bf16 v[164:167], v[40:43], v[88:91], v[164:167]
  v_mfma_f32_16x16x32_bf16 v[168:171], v[40:43], v[104:107], v[168:171]
  v_mfma_f32_16x16x32_bf16 v[172:175], v[40:43], v[120:123], v[172:175]
  v_mfma_f32_16x16x32_bf16 v[176:179], v[40:43], v[136:139], v[176:179]
  v_mfma_f32_16x16x32_bf16 v[180:183], v[40:43], v[152:155], v[180:183]
  v_cndmask_b32 v44, 0, v16, s[28:29]
  v_cndmask_b32 v45, 0, v17, s[28:29]
  v_cndmask_b32 v46, 0, v18, s[28:29]
  v_cndmask_b32 v47, 0, v19, s[28:29]
  s_lshl_b64 s[28:29], s[28:29], 1
  s_nop 0
  v_mfma_f32_16x16x32_bf16 v[160:163], v[44:47], v[76:79], v[160:163]
  v_mfma_f32_16x16x32_bf16 v[164:167], v[44:47], v[92:95], v[164:167]
  v_mfma_f32_16x16x32_bf16 v[168:171], v[44:47], v[108:111], v[168:171]
  v_mfma_f32_16x16x32_bf16 v[172:175], v[44:47], v[124:127], v[172:175]
  v_mfma_f32_16x16x32_bf16 v[176:179], v[44:47], v[140:143], v[176:179]
  v_mfma_f32_16x16x32_bf16 v[180:183], v[44:47], v[156:159], v[180:183]
  v_add_f32 v56, v56, v28
  v_add_f32 v57, v57, v29
  v_add_f32 v58, v58, v30
  v_add_f32 v59, v59, v31
  v_add_f32 v20, v56, v57
  v_mul_f32 v22, v56, v56
  v_add_f32 v21, v58, v59
  v_fmac_f32 v22, v57, v57
  v_add_f32 v20, v20, v21
  v_fmac_f32 v22, v58, v58
  v_fmac_f32 v22, v59, v59
  v_or_b32 v28, 1, v28
  v_or_b32 v30, 1, v30
  v_add_f32 v20, v20, v20 row_ror:8 row_mask:0xf bank_mask:0xf
  v_add_f32 v22, v22, v22 row_ror:8 row_mask:0xf bank_mask:0xf
  v_lshlrev_b32 v11, 4, v12
  v_add_f32 v20, v20, v20 row_bcast:15 row_mask:0xa bank_mask:0xf
  v_add_f32 v22, v22, v22 row_bcast:15 row_mask:0xa bank_mask:0xf
  s_mov_b32 exec_lo, 0x01010101
  s_mov_b32 exec_hi, 0x01010101
  buffer_store_dwordx4 v[28:31], v11, s[4:7], s26 offen offset:768 sc1
  buffer_store_dwordx4 v[28:31], v11, s[4:7], s25 offen offset:768 sc1
  s_mov_b64 exec, -1
  v_add_f32 v20, v20, v20 row_bcast:31 row_mask:0xc bank_mask:0xf
  v_add_f32 v22, v22, v22 row_bcast:31 row_mask:0xc bank_mask:0xf
  v_or_b32 v20, 1, v20
  v_or_b32 v22, 1, v22
  s_mov_b32 exec_lo, 0
  s_mov_b32 exec_hi, 0x80000000
  buffer_store_dwordx4 v[20:23], v4, s[4:7], s26 offen offset:896 sc1
  buffer_store_dwordx4 v[20:23], v4, s[4:7], s25 offen offset:896 sc1
  s_mov_b64 exec, 0xffff
  v_or_b32 v160, 1, v160
  v_or_b32 v162, 1, v162
  buffer_store_dwordx4 v[160:163], v3, s[4:7], s26 offen offset:0 sc1
  v_or_b32 v164, 1, v164
  v_or_b32 v166, 1, v166
  buffer_store_dwordx4 v[164:167], v3, s[4:7], s25 offen offset:0 sc1
  v_or_b32 v168, 1, v168
  v_or_b32 v170, 1, v170
  buffer_store_dwordx4 v[168:171], v3, s[4:7], s26 offen offset:256 sc1
  v_or_b32 v172, 1, v172
  v_or_b32 v174, 1, v174
  buffer_store_dwordx4 v[172:175], v3, s[4:7], s25 offen offset:256 sc1
  v_or_b32 v176, 1, v176
  v_or_b32 v178, 1, v178
  buffer_store_dwordx4 v[176:179], v3, s[4:7], s26 offen offset:512 sc1
  v_or_b32 v180, 1, v180
  v_or_b32 v182, 1, v182
  buffer_store_dwordx4 v[180:183], v3, s[4:7], s25 offen offset:512 sc1
  s_mov_b64 exec, -1
  s_cmp_eq_u32 s79, 0
  s_cbranch_scc1 .g2_kernel_c_no
  s_lshl_b32 s20, s18, 15
  s_add_u32 s20, s20, 0x1190000
  s_lshl_b32 s22, s18, 11
  s_add_u32 s22, s22, s20
  v_lshlrev_b32 v16, 10, v2
  s_sleep 16
  s_mov_b32 s38, 0
  s_mov_b32 exec_hi, 0
.g2_kernel_gx52:
  buffer_load_dword v17, v16, s[4:7], s20 offen offset:752 sc1
  s_add_u32 s38, s38, 1
  s_waitcnt vmcnt(0)
  v_min_u32 v6, v17, v17
  v_cmp_eq_u32 vcc, 0, v6
  s_cbranch_vccz .g2_kernel_gx52d
  s_mov_b64 exec, vcc
  s_sleep 6
  s_cmp_lt_u32 s38, 131072
  s_cbranch_scc1 .g2_kernel_gx52
.g2_kernel_gx52d:
  s_mov_b64 exec, -1
  s_mov_b32 s38, 0
  s_bfm_b64 exec, 57, 0
.g2_kernel_gx53:
  s_mov_b32 s21, s20
  buffer_load_dwordx4 v[64:67], v3, s[4:7], s21 offen offset:0 sc1
  buffer_load_dwordx4 v[68:71], v3, s[4:7], s21 offen offset:1024 sc1
  buffer_load_dwordx4 v[72:75], v3, s[4:7], s21 offen offset:2048 sc1
  buffer_load_dwordx4 v[76:79], v3, s[4:7], s21 offen offset:3072 sc1
  s_add_u32 s21, s21, 4096
  buffer_load_dwordx4 v[80:83], v3, s[4:7], s21 offen offset:0 sc1
  buffer_load_dwordx4 v[84:87], v3, s[4:7], s21 offen offset:1024 sc1
  buffer_load_dwordx4 v[88:91], v3, s[4:7], s21 offen offset:2048 sc1
  buffer_load_dwordx4 v[92:95], v3, s[4:7], s21 offen offset:3072 sc1
  s_add_u32 s21, s21, 4096
  buffer_load_dwordx4 v[96:99], v3, s[4:7], s21 offen offset:0 sc1
  buffer_load_dwordx4 v[100:103], v3, s[4:7], s21 offen offset:1024 sc1
  buffer_load_dwordx4 v[104:107], v3, s[4:7], s21 offen offset:2048 sc1
  buffer_load_dwordx4 v[108:111], v3, s[4:7], s21 offen offset:3072 sc1
  s_add_u32 s21, s21, 4096
  buffer_load_dwordx4 v[112:115], v3, s[4:7], s21 offen offset:0 sc1
  buffer_load_dwordx4 v[116:119], v3, s[4:7], s21 offen offset:1024 sc1
  buffer_load_dwordx4 v[120:123], v3, s[4:7], s21 offen offset:2048 sc1
  buffer_load_dwordx4 v[124:127], v3, s[4:7], s21 offen offset:3072 sc1
  s_add_u32 s21, s21, 4096
  buffer_load_dwordx4 v[128:131], v3, s[4:7], s21 offen offset:0 sc1
  buffer_load_dwordx4 v[132:135], v3, s[4:7], s21 offen offset:1024 sc1
  buffer_load_dwordx4 v[136:139], v3, s[4:7], s21 offen offset:2048 sc1
  buffer_load_dwordx4 v[140:143], v3, s[4:7], s21 offen offset:3072 sc1
  s_add_u32 s21, s21, 4096
  buffer_load_dwordx4 v[144:147], v3, s[4:7], s21 offen offset:0 sc1
  buffer_load_dwordx4 v[148:151], v3, s[4:7], s21 offen offset:1024 sc1
  buffer_load_dwordx4 v[152:155], v3, s[4:7], s21 offen offset:2048 sc1
  buffer_load_dwordx4 v[156:159], v3, s[4:7], s21 offen offset:3072 sc1
  s_add_u32 s21, s21, 4096
  buffer_load_dwordx4 v[160:163], v3, s[4:7], s21 offen offset:0 sc1
  buffer_load_dwordx4 v[164:167], v3, s[4:7], s21 offen offset:1024 sc1
  buffer_load_dwordx4 v[168:171], v3, s[4:7], s21 offen offset:2048 sc1
  buffer_load_dwordx4 v[172:175], v3, s[4:7], s21 offen offset:3072 sc1
  s_add_u32 s21, s21, 4096
  buffer_load_dwordx4 v[176:179], v3, s[4:7], s21 offen offset:0 sc1
  buffer_load_dwordx4 v[180:183], v3, s[4:7], s21 offen offset:1024 sc1
  buffer_load_dwordx4 v[184:187], v3, s[4:7], s21 offen offset:2048 sc1
  buffer_load_dwordx4 v[188:191], v3, s[4:7], s21 offen offset:3072 sc1
  s_add_u32 s21, s21, 4096
  buffer_load_dwordx4 v[192:195], v3, s[4:7], s22 offen offset:0 sc1
  buffer_load_dwordx4 v[196:199], v3, s[4:7], s22 offen offset:1024 sc1
  s_add_u32 s38, s38, 1
  s_waitcnt vmcnt(0)
  v_min3_u32 v6, v64, v66, v68
  v_min3_u32 v6, v6, v70, v72
  v_min3_u32 v6, v6, v74, v76
  v_min3_u32 v6, v6, v78, v80
  v_min3_u32 v6, v6, v82, v84
  v_min3_u32 v6, v6, v86, v88
  v_min3_u32 v6, v6, v90, v92
  v_min3_u32 v6, v6, v94, v96
  v_min3_u32 v6, v6, v98, v100
  v_min3_u32 v6, v6, v102, v104
  v_min3_u32 v6, v6, v106, v108
  v_min3_u32 v6, v6, v110, v112
  v_min3_u32 v6, v6, v114, v116
  v_min3_u32 v6, v6, v118, v120
  v_min3_u32 v6, v6, v122, v124
  v_min3_u32 v6, v6, v126, v128
  v_min3_u32 v6, v6, v130, v132
  v_min3_u32 v6, v6, v134, v136
  v_min3_u32 v6, v6, v138, v140
  v_min3_u32 v6, v6, v142, v144
  v_min3_u32 v6, v6, v146, v148
  v_min3_u32 v6, v6, v150, v152
  v_min3_u32 v6, v6, v154, v156
  v_min3_u32 v6, v6, v158, v160
  v_min3_u32 v6, v6, v162, v164
  v_min3_u32 v6, v6, v166, v168
  v_min3_u32 v6, v6, v170, v172
  v_min3_u32 v6, v6, v174, v176
  v_min3_u32 v6, v6, v178, v180
  v_min3_u32 v6, v6, v182, v184
  v_min3_u32 v6, v6, v186, v188
  v_min3_u32 v6, v6, v190, v192
  v_min3_u32 v6, v6, v194, v196
  v_min_u32 v6, v6, v198
  v_cmp_eq_u32 vcc, 0, v6
  s_cbranch_vccz .g2_kernel_gx53d
  s_mov_b64 exec, vcc
  s_sleep 2
  s_cmp_lt_u32 s38, 131072
  s_cbranch_scc1 .g2_kernel_gx53
.g2_kernel_gx53d:
  s_mov_b64 exec, -1
  v_add_f32 v64, v64, v128
  v_add_f32 v65, v65, v129
  v_add_f32 v66, v66, v130
  v_add_f32 v67, v67, v131
  v_add_f32 v68, v68, v132
  v_add_f32 v69, v69, v133
  v_add_f32 v70, v70, v134
  v_add_f32 v71, v71, v135
  v_add_f32 v72, v72, v136
  v_add_f32 v73, v73, v137
  v_add_f32 v74, v74, v138
  v_add_f32 v75, v75, v139
  v_add_f32 v76, v76, v140
  v_add_f32 v77, v77, v141
  v_add_f32 v78, v78, v142
  v_add_f32 v79, v79, v143
  v_add_f32 v80, v80, v144
  v_add_f32 v81, v81, v145
  v_add_f32 v82, v82, v146
  v_add_f32 v83, v83, v147
  v_add_f32 v84, v84, v148
  v_add_f32 v85, v85, v149
  v_add_f32 v86, v86, v150
  v_add_f32 v87, v87, v151
  v_add_f32 v88, v88, v152
  v_add_f32 v89, v89, v153
  v_add_f32 v90, v90, v154
  v_add_f32 v91, v91, v155
  v_add_f32 v92, v92, v156
  v_add_f32 v93, v93, v157
  v_add_f32 v94, v94, v158
  v_add_f32 v95, v95, v159
  v_add_f32 v96, v96, v160
  v_add_f32 v97, v97, v161
  v_add_f32 v98, v98, v162
  v_add_f32 v99, v99, v163
  v_add_f32 v100, v100, v164
  v_add_f32 v101, v101, v165
  v_add_f32 v102, v102, v166
  v_add_f32 v103, v103, v167
  v_add_f32 v104, v104, v168
  v_add_f32 v105, v105, v169
  v_add_f32 v106, v106, v170
  v_add_f32 v107, v107, v171
  v_add_f32 v108, v108, v172
  v_add_f32 v109, v109, v173
  v_add_f32 v110, v110, v174
  v_add_f32 v111, v111, v175
  v_add_f32 v112, v112, v176
  v_add_f32 v113, v113, v177
  v_add_f32 v114, v114, v178
  v_add_f32 v115, v115, v179
  v_add_f32 v116, v116, v180
  v_add_f32 v117, v117, v181
  v_add_f32 v118, v118, v182
  v_add_f32 v119, v119, v183
  v_add_f32 v120, v120, v184
  v_add_f32 v121, v121, v185
  v_add_f32 v122, v122, v186
  v_add_f32 v123, v123, v187
  v_add_f32 v124, v124, v188
  v_add_f32 v125, v125, v189
  v_add_f32 v126, v126, v190
  v_add_f32 v127, v127, v191
  v_add_f32 v64, v64, v96
  v_add_f32 v65, v65, v97
  v_add_f32 v66, v66, v98
  v_add_f32 v67, v67, v99
  v_add_f32 v68, v68, v100
  v_add_f32 v69, v69, v101
  v_add_f32 v70, v70, v102
  v_add_f32 v71, v71, v103
  v_add_f32 v72, v72, v104
  v_add_f32 v73, v73, v105
  v_add_f32 v74, v74, v106
  v_add_f32 v75, v75, v107
  v_add_f32 v76, v76, v108
  v_add_f32 v77, v77, v109
  v_add_f32 v78, v78, v110
  v_add_f32 v79, v79, v111
  v_add_f32 v80, v80, v112
  v_add_f32 v81, v81, v113
  v_add_f32 v82, v82, v114
  v_add_f32 v83, v83, v115
  v_add_f32 v84, v84, v116
  v_add_f32 v85, v85, v117
  v_add_f32 v86, v86, v118
  v_add_f32 v87, v87, v119
  v_add_f32 v88, v88, v120
  v_add_f32 v89, v89, v121
  v_add_f32 v90, v90, v122
  v_add_f32 v91, v91, v123
  v_add_f32 v92, v92, v124
  v_add_f32 v93, v93, v125
  v_add_f32 v94, v94, v126
  v_add_f32 v95, v95, v127
  v_add_f32 v64, v64, v80
  v_add_f32 v65, v65, v81
  v_add_f32 v66, v66, v82
  v_add_f32 v67, v67, v83
  v_add_f32 v68, v68, v84
  v_add_f32 v69, v69, v85
  v_add_f32 v70, v70, v86
  v_add_f32 v71, v71, v87
  v_add_f32 v72, v72, v88
  v_add_f32 v73, v73, v89
  v_add_f32 v74, v74, v90
  v_add_f32 v75, v75, v91
  v_add_f32 v76, v76, v92
  v_add_f32 v77, v77, v93
  v_add_f32 v78, v78, v94
  v_add_f32 v79, v79, v95
  v_add_f32 v64, v64, v72
  v_add_f32 v65, v65, v73
  v_add_f32 v66, v66, v74
  v_add_f32 v67, v67, v75
  v_add_f32 v68, v68, v76
  v_add_f32 v69, v69, v77
  v_add_f32 v70, v70, v78
  v_add_f32 v71, v71, v79
  v_add_f32 v64, v64, v68
  v_add_f32 v65, v65, v69
  v_add_f32 v66, v66, v70
  v_add_f32 v67, v67, v71
  v_mov_b32 v28, 0.0009765625
  v_mov_b32 v30, 1e-05
  v_readlane_b32 s21, v64, 56
  v_readlane_b32 s22, v66, 56
  s_nop 0
  v_mul_f32 v20, s21, v28
  v_fma_f32 v21, s22, v28, v30
  v_fma_f32 v21, -v20, v20, v21
  v_rsq_f32 v21, abs(v21)
  v_sub_f32 v20, v61, v20
  v_mul_f32 v22, v21, v60
  v_mul_f32 v23, v21, v20
  v_and_b32 v10, 15, v2
  v_lshrrev_b32 v11, 4, v2
  v_lshlrev_b32 v16, 2, v10
  v_lshl_add_u32 v16, v11, 8, v16
  v_add_u32 v16, 155648, v16
  s_sub_u32 s20, s79, 1
  s_and_b32 s21, s20, 3
  s_lshl_b32 s21, s21, 2
  s_add_u32 s21, s21, 156160
  v_lshl_add_u32 v17, v10, 4, s21
  v_cmp_eq_u32 vcc, 2, v11
  v_mov_b32 v18, 64
  v_mov_b32 v19, 256
  v_cndmask_b32 v17, v16, v17, vcc
  v_cndmask_b32 v18, v18, v19, vcc
  v_lshrrev_b32 v24, 2, v10
  v_lshlrev_b32 v24, 9, v24
  v_and_b32 v25, 3, v10
  v_lshl_add_u32 v24, v25, 1, v24
  s_and_b32 s21, s20, 31
  s_lshl_b32 s22, s21, 4
  s_lshr_b32 s23, s20, 5
  s_lshl_b32 s24, s23, 11
  s_add_u32 s22, s22, s24
  s_add_u32 s22, s22, 131072
  v_add_u32 v26, s22, v24
  s_and_b32 s22, s21, 7
  s_and_b32 s24, s21, 8
  s_lshl_b32 s24, s24, 1
  s_add_u32 s22, s22, s24
  s_and_b32 s24, s21, 16
  s_lshr_b32 s24, s24, 1
  s_add_u32 s22, s22, s24
  s_lshl_b32 s22, s22, 4
  v_add_u32 v24, s22, v24
  s_bfe_u32 s22, s21, 0x20002
  s_lshl_b32 s22, s22, 9
  s_add_u32 s22, s22, s24
  s_and_b32 s24, s21, 3
  s_lshl_b32 s24, s24, 1
  s_add_u32 s22, s22, s24
  s_add_u32 s22, s22, 2048
  v_lshl_add_u32 v25, v10, 4, s22
  v_cndmask_b32 v24, v24, v25, vcc
  v_cndmask_b32 v19, 8, v19, vcc
  v_add_u32 v25, v24, v19
  s_lshl_b32 s22, s18, 7
  s_lshl_b32 s24, s17, 2
  s_add_u32 s22, s22, s24
  s_add_u32 s22, s22, s23
  s_lshl_b32 s22, s22, 12
  s_add_u32 s22, s22, 0x1800000
  s_add_u32 s23, s22, 262144
  s_lshr_b32 s24, s20, 6
  s_lshl_b32 s24, s24, 8
  s_add_u32 s24, s24, s76
  v_cmp_eq_u32 vcc, 0, v11
  v_mov_b32 v27, 0.25503486164919736
  s_nop 0
  v_cndmask_b32 v27, 1.0, v27, vcc
  v_mul_f32 v21, v21, v27
  v_mul_f32 v22, v22, v27
  v_mul_f32 v23, v23, v27
  s_mov_b32 s62, 1
  s_mov_b32 s63, 0x1800000
  s_mov_b32 s70, 2
  s_mov_b32 s71, 155776
  v_mov_b32 v6, s71
  s_mov_b32 s38, 0
.g2_kernel_wg54:
  ds_read_b32 v7, v6 offset:56
  s_add_u32 s38, s38, 1
  s_waitcnt lgkmcnt(0)
  v_cmp_gt_u32 vcc, 2, v7
  s_cbranch_vccz .g2_kernel_wg54d
  s_sleep 1
  s_cmp_lt_u32 s38, 524288
  s_cbranch_scc1 .g2_kernel_wg54
.g2_kernel_wg54d:
  ds_read_b32 v32, v17 offset:5632
  ds_read_b32 v36, v16 offset:4864
  v_add_u32 v17, v17, v18
  ds_read_b32 v33, v17 offset:5632
  ds_read_b32 v37, v16 offset:4928
  v_add_u32 v17, v17, v18
  ds_read_b32 v34, v17 offset:5632
  ds_read_b32 v38, v16 offset:4992
  v_add_u32 v17, v17, v18
  ds_read_b32 v35, v17 offset:5632
  ds_read_b32 v39, v16 offset:5056
  s_waitcnt lgkmcnt(0)
  v_mul_f32 v32, v32, v22
  v_fmac_f32 v32, v64, v21
  v_fmac_f32 v32, v36, v23
  v_mul_f32 v33, v33, v22
  v_fmac_f32 v33, v65, v21
  v_fmac_f32 v33, v37, v23
  v_mul_f32 v34, v34, v22
  v_fmac_f32 v34, v66, v21
  v_fmac_f32 v34, v38, v23
  v_mul_f32 v35, v35, v22
  v_fmac_f32 v35, v67, v21
  v_fmac_f32 v35, v39, v23
  v_cvt_pk_bf16_f32 v32, v32, v33
  v_cvt_pk_bf16_f32 v34, v34, v35
  v_mov_b32 v9, s71
  v_mov_b32 v8, 2
  s_mov_b32 exec_lo, 0xffff0000
  s_mov_b32 exec_hi, 0xffff
  buffer_store_short v32, v24, s[4:7], s22 offen sc1
  buffer_store_short_d16_hi v32, v25, s[4:7], s22 offen sc1
  buffer_store_short v34, v24, s[4:7], s23 offen sc1
  buffer_store_short_d16_hi v34, v25, s[4:7], s23 offen sc1
  s_mov_b64 exec, 0xffff
  ds_write_b16 v26, v32 offset:8192
  ds_write_b16_d16_hi v26, v32 offset:8200
  ds_write_b16 v26, v34
  ds_write_b16_d16_hi v26, v34 offset:8
  ds_write_b32 v9, v5 offset:60
  s_mov_b32 exec_lo, 0
  s_mov_b32 exec_hi, 0xff0000
  ds_write_b32 v16, v192 offset:6912
  ds_write_b32 v16, v193 offset:6976
  ds_write_b32 v16, v194 offset:7040
  ds_write_b32 v16, v195 offset:7104
  ds_write_b32 v16, v196 offset:6944
  ds_write_b32 v16, v197 offset:7008
  ds_write_b32 v16, v198 offset:7072
  ds_write_b32 v16, v199 offset:7136
  s_mov_b64 exec, 1
  s_waitcnt vmcnt(0)
  buffer_store_dword v8, v4, s[4:7], s24 offen sc1
  buffer_store_dword v8, v4, s[4:7], s24 offen offset:128 sc1
  s_mov_b64 exec, -1
  s_branch .g2_kernel_v
.g2_kernel_c_no:
  s_mov_b32 s62, 1
  s_mov_b32 s63, 0x1800000
  s_mov_b32 s70, 2
  s_mov_b32 s71, 155776
  s_branch .g2_kernel_v
.g2_kernel_c_t3:
  s_lshr_b32 s33, s77, 7
  s_lshl_b32 s28, s33, 2
  s_lshl_b64 s[8:9], 15, s28
  s_lshl_b32 s21, s17, 10
  s_add_u32 s21, s21, 0x2880000
  v_lshlrev_b32 v14, 3, v2
  v_add_u32 v14, 155648, v14
  v_mov_b32 v9, s71
  s_cmp_eq_u32 s33, s17
  s_cbranch_scc0 .g2_kernel_c_u1
  s_sleep 6
  s_call_b64 s[72:73], .g2_kernel_c_ph2
  s_branch .g2_kernel_c_u2
.g2_kernel_c_u1:
  v_mov_b32 v6, s71
  s_mov_b32 s38, 0
.g2_kernel_wg55:
  ds_read_b32 v7, v6 offset:36
  s_add_u32 s38, s38, 1
  s_waitcnt lgkmcnt(0)
  v_cmp_gt_u32 vcc, 1, v7
  s_cbranch_vccz .g2_kernel_wg55d
  s_sleep 1
  s_cmp_lt_u32 s38, 524288
  s_cbranch_scc1 .g2_kernel_wg55
.g2_kernel_wg55d:
  ds_read_b32 v7, v6 offset:36
  ds_read_b32 v6, v6 offset:104
  s_waitcnt lgkmcnt(0)
  v_readfirstlane_b32 s77, v7
  v_readfirstlane_b32 s29, v6
  s_lshl_b32 s29, s29, 5
  s_add_u32 s77, s77, s29
  s_sub_u32 s77, s77, 1
.g2_kernel_c_u2:
  s_mov_b32 s38, 0
.g2_kernel_gx56:
  buffer_load_dwordx4 v[16:19], v3, s[4:7], s21 offen sc1
  s_add_u32 s38, s38, 1
  s_waitcnt vmcnt(0)
  v_min_u32 v6, v17, v19
  v_cmp_eq_u32 vcc, 0, v6
  s_cbranch_vccz .g2_kernel_gx56d
  s_mov_b64 exec, vcc
  s_cmp_lt_u32 s38, 131072
  s_cbranch_scc1 .g2_kernel_gx56
.g2_kernel_gx56d:
  s_mov_b64 exec, -1
  v_rsq_f32 v22, v17
  v_rsq_f32 v23, v19
  v_add_f32 v52, 1.0, v22
  v_mul_f32 v54, v16, v22
  v_sub_f32 v54, 0, v54
  v_add_f32 v53, 1.0, v23
  v_mul_f32 v55, v18, v23
  v_sub_f32 v55, 0, v55
  ds_write_b64 v14, v[52:53] offset:3840
  ds_write_b64 v14, v[54:55] offset:4352
  s_lshr_b32 s28, s77, 7
  s_and_b32 s79, s77, 127
  s_add_u32 s79, s79, 1
  s_cmp_eq_u32 s28, s17
  s_cselect_b32 s79, s79, 0
  v_mov_b32 v15, s79
  v_mov_b32 v8, 2
  ds_write_b32 v9, v15 offset:32
  ds_write_b32 v9, v8 offset:28
  s_cmp_eq_u32 s33, s17
  s_cbranch_scc1 .g2_kernel_fin
  s_sleep 28
  s_mov_b32 s39, 1
  s_call_b64 s[72:73], .g2_kernel_c_ph2
  s_branch .g2_kernel_fin
.g2_kernel_c_ph2:
  s_call_b64 s[68:69], .g2_kernel_amax
  v_mov_b32 v6, s71
  s_mov_b32 s38, 0
.g2_kernel_wg57:
  ds_read_b32 v7, v6 offset:36
  s_add_u32 s38, s38, 1
  s_waitcnt lgkmcnt(0)
  v_cmp_gt_u32 vcc, 1, v7
  s_cbranch_vccz .g2_kernel_wg57d
  s_cmp_lt_u32 s38, 524288
  s_cbranch_scc1 .g2_kernel_wg57
.g2_kernel_wg57d:
  ds_read_b32 v8, v9 offset:96
  ds_read_b32 v7, v6 offset:36
  ds_read_b32 v6, v6 offset:104
  s_waitcnt lgkmcnt(0)
  v_readfirstlane_b32 s28, v7
  v_readfirstlane_b32 s29, v6
  s_lshl_b32 s29, s29, 5
  s_add_u32 s28, s28, s29
  s_sub_u32 s28, s28, 1
  s_add_u32 s29, s77, 2
  s_waitcnt lgkmcnt(0)
  v_cmp_gt_f32 vcc, s27, v8
  s_cmp_lg_u64 vcc, 0
  s_cselect_b32 s77, s77, s28
  s_cselect_b32 s29, s29, 1
  v_mov_b32 v10, s29
  v_mov_b32 v11, s27
  ds_write_b64 v9, v[10:11] offset:88
  s_setpc_b64 s[72:73]
.g2_kernel_c2:
  s_cmp_lg_u32 s62, 0
  s_cbranch_scc1 .g2_kernel_d_a
  s_cmp_lg_u32 s16, 7
  s_cbranch_scc1 .g2_kernel_d_a
  v_mov_b32 v6, s71
  s_mov_b32 s38, 0
.g2_kernel_wg60:
  ds_read_b32 v7, v6 offset:20
  s_add_u32 s38, s38, 1
  s_waitcnt lgkmcnt(0)
  v_cmp_gt_u32 vcc, 4, v7
  s_cbranch_vccz .g2_kernel_wg60d
  s_sleep 2
  s_cmp_lt_u32 s38, 524288
  s_cbranch_scc1 .g2_kernel_wg60
.g2_kernel_wg60d:
  s_sleep 20
  s_and_b32 s31, s19, 0xffffe000
  s_add_u32 s31, s31, 8
  v_and_b32 v6, 15, v2
  v_lshlrev_b32 v6, 9, v6
  v_lshrrev_b32 v7, 4, v2
  v_lshl_add_u32 v6, v7, 7, v6
  v_lshlrev_b32 v7, 2, v2
  v_add_u32 v7, 158208, v7
  s_mov_b32 m0, 158208
  s_mov_b32 s38, 0
.g2_kernel_pa61:
  buffer_load_dword v6, s[4:7], s31 offen sc1 lds
  s_add_u32 s38, s38, 1
  s_waitcnt vmcnt(0)
  ds_read_b32 v8, v7
  s_waitcnt lgkmcnt(0)
  v_cmp_ge_u32 vcc, s62, v8
  s_cbranch_vccz .g2_kernel_pa61d
  s_mov_b64 exec, vcc
  s_sleep 10
  s_cmp_lt_u32 s38, 131072
  s_cbranch_scc1 .g2_kernel_pa61
.g2_kernel_pa61d:
  s_mov_b64 exec, -1
.g2_kernel_d_a:
  s_setprio 2
  s_and_b32 s20, s16, 1
  v_bfe_u32 v8, v2, 1, 3
  v_lshlrev_b32 v8, 14, v8
  v_and_b32 v9, 1, v2
  v_lshl_add_u32 v8, v9, 10, v8
  v_lshrrev_b32 v9, 4, v2
  v_lshl_add_u32 v8, v9, 8, v8
  v_and_b32 v9, 15, v2
  v_lshlrev_b32 v9, 4, v9
  s_lshl_b32 s28, s20, 8
  s_add_u32 s28, s28, 156672
  v_add_u32 v10, s28, v9
  v_xor_b32 v11, 256, v10
  s_lshl_b32 s28, s20, 2
  s_add_u32 s28, s28, s71
  v_mov_b32 v12, s28
  v_xor_b32 v13, 4, v12
  s_lshl_b32 s26, s74, 1
  s_add_u32 s26, s26, s20
  s_lshl_b32 s26, s26, 11
  s_add_u32 s26, s26, s63
  s_add_u32 s26, s26, 0x1090000
  s_mov_b32 s32, 0
  s_mov_b32 s39, 0
  s_lshl_b32 s28, s62, 3
  s_add_u32 s28, s28, s16
  s_cmp_lg_u32 s28, 14
  s_cbranch_scc1 .g2_kernel_d_w
  s_lshr_b32 s33, s77, 7
  s_lshl_b32 s28, s33, 2
  s_lshl_b64 s[8:9], 15, s28
  s_not_b64 s[8:9], s[8:9]
  s_and_b32 s28, s2, 7
  s_lshl_b32 s28, s28, 13
  s_add_u32 s23, s28, 0x3050000
  s_cmp_eq_u32 s33, s17
  s_cbranch_scc1 .g2_kernel_d_v
  v_mov_b32 v6, s71
  s_mov_b32 s38, 0
.g2_kernel_wg62:
  ds_read_b32 v7, v6 offset:20
  s_add_u32 s38, s38, 1
  s_waitcnt lgkmcnt(0)
  v_cmp_gt_u32 vcc, 4, v7
  s_cbranch_vccz .g2_kernel_wg62d
  s_sleep 1
  s_cmp_lt_u32 s38, 524288
  s_cbranch_scc1 .g2_kernel_wg62
.g2_kernel_wg62d:
.g2_kernel_d_v:
  s_sleep 60
  s_call_b64 s[68:69], .g2_kernel_amax
  s_add_u32 s28, s77, 1
  v_mov_b32 v6, s27
  v_mov_b32 v7, s28
  ds_write_b32 v12, v6 offset:96
  ds_write_b32 v12, v7 offset:36
  s_waitcnt lgkmcnt(0)
  s_wakeup
  s_branch .g2_kernel_d_r
.g2_kernel_d_w:
  v_mov_b32 v6, s71
  s_mov_b32 s38, 0
.g2_kernel_wg63:
  ds_read_b32 v7, v6 offset:36
  s_add_u32 s38, s38, 1
  s_waitcnt lgkmcnt(0)
  v_cmp_gt_u32 vcc, 1, v7
  s_cbranch_vccz .g2_kernel_wg63d
  s_sleep 4
  s_cmp_lt_u32 s38, 524288
  s_cbranch_scc1 .g2_kernel_wg63
.g2_kernel_wg63d:
  ds_read_b32 v7, v6 offset:36
  ds_read_b32 v6, v6 offset:104
  s_waitcnt lgkmcnt(0)
  v_readfirstlane_b32 s77, v7
  v_readfirstlane_b32 s29, v6
  s_lshl_b32 s29, s29, 5
  s_add_u32 s77, s77, s29
  s_sub_u32 s77, s77, 1
.g2_kernel_d_r:
  s_and_b32 s77, s77, 2047
  s_lshr_b32 s24, s77, 7
  s_lshl_b32 s24, s24, 18
  s_bfe_u32 s28, s77, 0x30004
  s_lshl_b32 s28, s28, 11
  s_add_u32 s24, s24, s28
  s_and_b32 s28, s77, 15
  s_lshl_b32 s28, s28, 4
  s_add_u32 s24, s24, s28
  s_add_u32 s24, s24, s63
  s_add_u32 s24, s24, 0xc00000
  s_lshl_b32 s28, s17, 14
  s_add_u32 s21, s24, s28
  s_and_b32 s28, s18, 8
  s_lshl_b32 s28, s28, 5
  s_add_u32 s21, s21, s28
  s_and_b32 s28, s18, 7
  s_lshl_b32 s28, s28, 1
  s_add_u32 s21, s21, s28
  s_lshl_b32 s28, s20, 17
  s_add_u32 s24, s24, s28
  buffer_load_dwordx4 v[16:19], v8, s[4:7], s24 offen
  buffer_load_ushort v56, v4, s[4:7], s21 offen
  buffer_load_ushort v57, v4, s[4:7], s21 offen offset:512
  buffer_load_ushort v58, v4, s[4:7], s21 offen offset:1024
  buffer_load_ushort v59, v4, s[4:7], s21 offen offset:1536
  s_lshl_b32 s25, s77, 3
  s_add_u32 s25, s25, s63
  s_add_u32 s25, s25, 0x1080000
  s_mov_b32 s38, 0
.g2_kernel_gx64:
  buffer_load_dwordx2 v[20:21], v4, s[4:7], s25 offen sc1
  s_add_u32 s38, s38, 1
  s_waitcnt vmcnt(0)
  v_min_u32 v6, v21, v21
  v_cmp_eq_u32 vcc, 0, v6
  s_cbranch_vccz .g2_kernel_gx64d
  s_mov_b64 exec, vcc
  s_sleep 1
  s_cmp_lt_u32 s38, 131072
  s_cbranch_scc1 .g2_kernel_gx64
.g2_kernel_gx64d:
  s_mov_b64 exec, -1
  v_rsq_f32 v21, v21
  v_lshlrev_b32 v24, 16, v16
  v_and_b32 v25, 0xffff0000, v16
  v_lshlrev_b32 v26, 16, v17
  v_and_b32 v27, 0xffff0000, v17
  v_lshlrev_b32 v28, 16, v18
  v_and_b32 v29, 0xffff0000, v18
  v_lshlrev_b32 v30, 16, v19
  v_and_b32 v31, 0xffff0000, v19
  v_mul_f32 v20, v20, v21
  v_mov_b32 v60, v20
  v_add_f32 v61, 1.0, v21
  s_cmp_ge_u32 s74, 224
  s_cbranch_scc1 .g2_kernel_d_none
  v_fma_f32 v24, v24, v21, -v20
  v_fma_f32 v25, v25, v21, -v20
  v_fma_f32 v26, v26, v21, -v20
  v_fma_f32 v27, v27, v21, -v20
  v_fma_f32 v28, v28, v21, -v20
  v_fma_f32 v29, v29, v21, -v20
  v_fma_f32 v30, v30, v21, -v20
  v_fma_f32 v31, v31, v21, -v20
  v_cvt_pk_bf16_f32 v16, v24, v25
  v_cvt_pk_bf16_f32 v17, v26, v27
  v_cvt_pk_bf16_f32 v18, v28, v29
  v_cvt_pk_bf16_f32 v19, v30, v31
  v_mov_b32 v24, v16 row_newbcast:0 row_mask:0xf bank_mask:0xf
  v_mov_b32 v25, v17 row_newbcast:0 row_mask:0xf bank_mask:0xf
  v_mov_b32 v26, v18 row_newbcast:0 row_mask:0xf bank_mask:0xf
  v_mov_b32 v27, v19 row_newbcast:0 row_mask:0xf bank_mask:0xf
  v_mov_b32 v28, v16 row_newbcast:1 row_mask:0xf bank_mask:0xf
  v_mov_b32 v29, v17 row_newbcast:1 row_mask:0xf bank_mask:0xf
  v_mov_b32 v30, v18 row_newbcast:1 row_mask:0xf bank_mask:0xf
  v_mov_b32 v31, v19 row_newbcast:1 row_mask:0xf bank_mask:0xf
  v_mfma_f32_16x16x32_bf16 v[32:35], v[24:27], v[64:67], 0
  v_mfma_f32_16x16x32_bf16 v[36:39], v[24:27], v[128:131], 0
  v_mov_b32 v24, v16 row_newbcast:2 row_mask:0xf bank_mask:0xf
  v_mov_b32 v25, v17 row_newbcast:2 row_mask:0xf bank_mask:0xf
  v_mov_b32 v26, v18 row_newbcast:2 row_mask:0xf bank_mask:0xf
  v_mov_b32 v27, v19 row_newbcast:2 row_mask:0xf bank_mask:0xf
  v_mfma_f32_16x16x32_bf16 v[32:35], v[28:31], v[68:71], v[32:35]
  v_mfma_f32_16x16x32_bf16 v[36:39], v[28:31], v[132:135], v[36:39]
  v_mov_b32 v28, v16 row_newbcast:3 row_mask:0xf bank_mask:0xf
  v_mov_b32 v29, v17 row_newbcast:3 row_mask:0xf bank_mask:0xf
  v_mov_b32 v30, v18 row_newbcast:3 row_mask:0xf bank_mask:0xf
  v_mov_b32 v31, v19 row_newbcast:3 row_mask:0xf bank_mask:0xf
  v_mfma_f32_16x16x32_bf16 v[32:35], v[24:27], v[72:75], v[32:35]
  v_mfma_f32_16x16x32_bf16 v[36:39], v[24:27], v[136:139], v[36:39]
  v_mov_b32 v24, v16 row_newbcast:4 row_mask:0xf bank_mask:0xf
  v_mov_b32 v25, v17 row_newbcast:4 row_mask:0xf bank_mask:0xf
  v_mov_b32 v26, v18 row_newbcast:4 row_mask:0xf bank_mask:0xf
  v_mov_b32 v27, v19 row_newbcast:4 row_mask:0xf bank_mask:0xf
  v_mfma_f32_16x16x32_bf16 v[32:35], v[28:31], v[76:79], v[32:35]
  v_mfma_f32_16x16x32_bf16 v[36:39], v[28:31], v[140:143], v[36:39]
  v_mov_b32 v28, v16 row_newbcast:5 row_mask:0xf bank_mask:0xf
  v_mov_b32 v29, v17 row_newbcast:5 row_mask:0xf bank_mask:0xf
  v_mov_b32 v30, v18 row_newbcast:5 row_mask:0xf bank_mask:0xf
  v_mov_b32 v31, v19 row_newbcast:5 row_mask:0xf bank_mask:0xf
  v_mfma_f32_16x16x32_bf16 v[32:35], v[24:27], v[80:83], v[32:35]
  v_mfma_f32_16x16x32_bf16 v[36:39], v[24:27], v[144:147], v[36:39]
  v_mov_b32 v24, v16 row_newbcast:6 row_mask:0xf bank_mask:0xf
  v_mov_b32 v25, v17 row_newbcast:6 row_mask:0xf bank_mask:0xf
  v_mov_b32 v26, v18 row_newbcast:6 row_mask:0xf bank_mask:0xf
  v_mov_b32 v27, v19 row_newbcast:6 row_mask:0xf bank_mask:0xf
  v_mfma_f32_16x16x32_bf16 v[32:35], v[28:31], v[84:87], v[32:35]
  v_mfma_f32_16x16x32_bf16 v[36:39], v[28:31], v[148:151], v[36:39]
  v_mov_b32 v28, v16 row_newbcast:7 row_mask:0xf bank_mask:0xf
  v_mov_b32 v29, v17 row_newbcast:7 row_mask:0xf bank_mask:0xf
  v_mov_b32 v30, v18 row_newbcast:7 row_mask:0xf bank_mask:0xf
  v_mov_b32 v31, v19 row_newbcast:7 row_mask:0xf bank_mask:0xf
  v_mfma_f32_16x16x32_bf16 v[32:35], v[24:27], v[88:91], v[32:35]
  v_mfma_f32_16x16x32_bf16 v[36:39], v[24:27], v[152:155], v[36:39]
  v_mov_b32 v24, v16 row_newbcast:8 row_mask:0xf bank_mask:0xf
  v_mov_b32 v25, v17 row_newbcast:8 row_mask:0xf bank_mask:0xf
  v_mov_b32 v26, v18 row_newbcast:8 row_mask:0xf bank_mask:0xf
  v_mov_b32 v27, v19 row_newbcast:8 row_mask:0xf bank_mask:0xf
  v_mfma_f32_16x16x32_bf16 v[32:35], v[28:31], v[92:95], v[32:35]
  v_mfma_f32_16x16x32_bf16 v[36:39], v[28:31], v[156:159], v[36:39]
  v_mov_b32 v28, v16 row_newbcast:9 row_mask:0xf bank_mask:0xf
  v_mov_b32 v29, v17 row_newbcast:9 row_mask:0xf bank_mask:0xf
  v_mov_b32 v30, v18 row_newbcast:9 row_mask:0xf bank_mask:0xf
  v_mov_b32 v31, v19 row_newbcast:9 row_mask:0xf bank_mask:0xf
  v_mfma_f32_16x16x32_bf16 v[32:35], v[24:27], v[96:99], v[32:35]
  v_mfma_f32_16x16x32_bf16 v[36:39], v[24:27], v[160:163], v[36:39]
  v_mov_b32 v24, v16 row_newbcast:10 row_mask:0xf bank_mask:0xf
  v_mov_b32 v25, v17 row_newbcast:10 row_mask:0xf bank_mask:0xf
  v_mov_b32 v26, v18 row_newbcast:10 row_mask:0xf bank_mask:0xf
  v_mov_b32 v27, v19 row_newbcast:10 row_mask:0xf bank_mask:0xf
  v_mfma_f32_16x16x32_bf16 v[32:35], v[28:31], v[100:103], v[32:35]
  v_mfma_f32_16x16x32_bf16 v[36:39], v[28:31], v[164:167], v[36:39]
  v_mov_b32 v28, v16 row_newbcast:11 row_mask:0xf bank_mask:0xf
  v_mov_b32 v29, v17 row_newbcast:11 row_mask:0xf bank_mask:0xf
  v_mov_b32 v30, v18 row_newbcast:11 row_mask:0xf bank_mask:0xf
  v_mov_b32 v31, v19 row_newbcast:11 row_mask:0xf bank_mask:0xf
  v_mfma_f32_16x16x32_bf16 v[32:35], v[24:27], v[104:107], v[32:35]
  v_mfma_f32_16x16x32_bf16 v[36:39], v[24:27], v[168:171], v[36:39]
  v_mov_b32 v24, v16 row_newbcast:12 row_mask:0xf bank_mask:0xf
  v_mov_b32 v25, v17 row_newbcast:12 row_mask:0xf bank_mask:0xf
  v_mov_b32 v26, v18 row_newbcast:12 row_mask:0xf bank_mask:0xf
  v_mov_b32 v27, v19 row_newbcast:12 row_mask:0xf bank_mask:0xf
  v_mfma_f32_16x16x32_bf16 v[32:35], v[28:31], v[108:111], v[32:35]
  v_mfma_f32_16x16x32_bf16 v[36:39], v[28:31], v[172:175], v[36:39]
  v_mov_b32 v28, v16 row_newbcast:13 row_mask:0xf bank_mask:0xf
  v_mov_b32 v29, v17 row_newbcast:13 row_mask:0xf bank_mask:0xf
  v_mov_b32 v30, v18 row_newbcast:13 row_mask:0xf bank_mask:0xf
  v_mov_b32 v31, v19 row_newbcast:13 row_mask:0xf bank_mask:0xf
  v_mfma_f32_16x16x32_bf16 v[32:35], v[24:27], v[112:115], v[32:35]
  v_mfma_f32_16x16x32_bf16 v[36:39], v[24:27], v[176:179], v[36:39]
  v_mov_b32 v24, v16 row_newbcast:14 row_mask:0xf bank_mask:0xf
  v_mov_b32 v25, v17 row_newbcast:14 row_mask:0xf bank_mask:0xf
  v_mov_b32 v26, v18 row_newbcast:14 row_mask:0xf bank_mask:0xf
  v_mov_b32 v27, v19 row_newbcast:14 row_mask:0xf bank_mask:0xf
  v_mfma_f32_16x16x32_bf16 v[32:35], v[28:31], v[116:119], v[32:35]
  v_mfma_f32_16x16x32_bf16 v[36:39], v[28:31], v[180:183], v[36:39]
  v_mov_b32 v28, v16 row_newbcast:15 row_mask:0xf bank_mask:0xf
  v_mov_b32 v29, v17 row_newbcast:15 row_mask:0xf bank_mask:0xf
  v_mov_b32 v30, v18 row_newbcast:15 row_mask:0xf bank_mask:0xf
  v_mov_b32 v31, v19 row_newbcast:15 row_mask:0xf bank_mask:0xf
  v_mfma_f32_16x16x32_bf16 v[32:35], v[24:27], v[120:123], v[32:35]
  v_mfma_f32_16x16x32_bf16 v[36:39], v[24:27], v[184:187], v[36:39]
  v_mfma_f32_16x16x32_bf16 v[32:35], v[28:31], v[124:127], v[32:35]
  v_mfma_f32_16x16x32_bf16 v[36:39], v[28:31], v[188:191], v[36:39]
  s_mov_b32 s38, 0
  s_add_u32 s36, s32, s62
  s_add_u32 s28, s36, 1
  v_mov_b32 v18, s28
  s_mov_b32 s28, 0x00010001
  s_mov_b32 s29, 0x00100010
  s_nop 0
  v_and_or_b32 v14, v32, -4, v18
  v_and_or_b32 v15, v36, -4, v18
  ds_write_b64 v10, v[14:15]
.g2_kernel_d_x:
  ds_read_b64 v[16:17], v11
  s_add_u32 s38, s38, 1
  s_waitcnt lgkmcnt(0)
  v_and_b32 v18, 3, v16
  v_and_b32 v19, 3, v17
  v_min_u32 v18, v18, v19
  v_cmp_ge_u32 vcc, s36, v18
  s_cbranch_vccz .g2_kernel_d_xd
  s_cmp_lt_u32 s38, 524288
  s_cbranch_scc1 .g2_kernel_d_x
.g2_kernel_d_xd:
  v_add_f32 v16, v16, v14
  v_add_f32 v17, v17, v15
  v_mul_f32 v18, -1.4426950408889634, v16
  v_exp_f32 v18, v18
  v_mul_f32 v16, v16, v17
  v_add_f32 v18, 1.0, v18
  v_rcp_f32 v18, v18
  s_nop 0
  v_mul_f32 v16, v16, v18
  s_nop 1
  v_mov_b32 v17, v16 quad_perm:[1,0,3,2] row_mask:0xf bank_mask:0xf
  v_cvt_pk_bf16_f32 v16, v16, v17
  s_nop 1
  v_mov_b32 v20, v16 row_newbcast:0 row_mask:0x5 bank_mask:0xf
  v_mov_b32 v21, v16 row_newbcast:2 row_mask:0x5 bank_mask:0xf
  v_mov_b32 v22, v16 row_newbcast:4 row_mask:0x5 bank_mask:0xf
  v_mov_b32 v23, v16 row_newbcast:6 row_mask:0x5 bank_mask:0xf
  v_mov_b32 v20, v16 row_newbcast:8 row_mask:0xa bank_mask:0xf
  v_mov_b32 v21, v16 row_newbcast:10 row_mask:0xa bank_mask:0xf
  v_mov_b32 v22, v16 row_newbcast:12 row_mask:0xa bank_mask:0xf
  v_mov_b32 v23, v16 row_newbcast:14 row_mask:0xa bank_mask:0xf
  v_cndmask_b32 v24, 0, v20, s[28:29]
  v_cndmask_b32 v25, 0, v21, s[28:29]
  v_cndmask_b32 v26, 0, v22, s[28:29]
  v_cndmask_b32 v27, 0, v23, s[28:29]
  s_lshl_b64 s[28:29], s[28:29], 1
  s_nop 0
  v_mfma_f32_16x16x32_bf16 v[40:43], v[24:27], v[192:195], 0
  v_mfma_f32_16x16x32_bf16 v[44:47], v[24:27], v[208:211], 0
  v_mfma_f32_16x16x32_bf16 v[48:51], v[24:27], v[224:227], 0
  v_mfma_f32_16x16x32_bf16 v[52:55], v[24:27], v[240:243], 0
  v_cndmask_b32 v28, 0, v20, s[28:29]
  v_cndmask_b32 v29, 0, v21, s[28:29]
  v_cndmask_b32 v30, 0, v22, s[28:29]
  v_cndmask_b32 v31, 0, v23, s[28:29]
  s_lshl_b64 s[28:29], s[28:29], 1
  s_nop 0
  v_mfma_f32_16x16x32_bf16 v[40:43], v[28:31], v[196:199], v[40:43]
  v_mfma_f32_16x16x32_bf16 v[44:47], v[28:31], v[212:215], v[44:47]
  v_mfma_f32_16x16x32_bf16 v[48:51], v[28:31], v[228:231], v[48:51]
  v_mfma_f32_16x16x32_bf16 v[52:55], v[28:31], v[244:247], v[52:55]
  v_cndmask_b32 v32, 0, v20, s[28:29]
  v_cndmask_b32 v33, 0, v21, s[28:29]
  v_cndmask_b32 v34, 0, v22, s[28:29]
  v_cndmask_b32 v35, 0, v23, s[28:29]
  s_lshl_b64 s[28:29], s[28:29], 1
  s_nop 0
  v_mfma_f32_16x16x32_bf16 v[40:43], v[32:35], v[200:203], v[40:43]
  v_mfma_f32_16x16x32_bf16 v[44:47], v[32:35], v[216:219], v[44:47]
  v_mfma_f32_16x16x32_bf16 v[48:51], v[32:35], v[232:235], v[48:51]
  v_mfma_f32_16x16x32_bf16 v[52:55], v[32:35], v[248:251], v[52:55]
  v_cndmask_b32 v36, 0, v20, s[28:29]
  v_cndmask_b32 v37, 0, v21, s[28:29]
  v_cndmask_b32 v38, 0, v22, s[28:29]
  v_cndmask_b32 v39, 0, v23, s[28:29]
  s_lshl_b64 s[28:29], s[28:29], 1
  s_nop 0
  v_mfma_f32_16x16x32_bf16 v[40:43], v[36:39], v[204:207], v[40:43]
  v_mfma_f32_16x16x32_bf16 v[44:47], v[36:39], v[220:223], v[44:47]
  v_mfma_f32_16x16x32_bf16 v[48:51], v[36:39], v[236:239], v[48:51]
  v_mfma_f32_16x16x32_bf16 v[52:55], v[36:39], v[252:255], v[52:55]
  s_mov_b32 exec_hi, 0
  s_nop 3
  v_or_b32 v40, 1, v40
  v_or_b32 v42, 1, v42
  buffer_store_dwordx4 v[40:43], v3, s[4:7], s26 offen offset:0 sc1
  v_or_b32 v44, 1, v44
  v_or_b32 v46, 1, v46
  buffer_store_dwordx4 v[44:47], v3, s[4:7], s26 offen offset:512 sc1
  v_or_b32 v48, 1, v48
  v_or_b32 v50, 1, v50
  buffer_store_dwordx4 v[48:51], v3, s[4:7], s26 offen offset:1024 sc1
  v_or_b32 v52, 1, v52
  v_or_b32 v54, 1, v54
  buffer_store_dwordx4 v[52:55], v3, s[4:7], s26 offen offset:1536 sc1
  s_mov_b64 exec, -1
  s_branch .g2_kernel_d_e
.g2_kernel_d_none:
  s_sleep 24
.g2_kernel_d_e:
  s_add_u32 m0, s71, 112
  s_mov_b32 s29, .g2_kernel_tab-.g2_kernel_pc+4
  s_mov_b64 exec, 1
  buffer_load_dword off, s[64:67], s29 lds
  s_mov_b64 exec, -1
  s_cmp_lg_u32 s62, 0
  s_cbranch_scc1 .g2_kernel_d_t
  s_mov_b32 s62, 1
  s_mov_b32 s63, 0x1800000
  s_mov_b32 s70, 2
  s_mov_b32 s71, 155776
  s_branch .g2_kernel_v
.g2_kernel_d_t:
  s_cmp_lg_u32 s20, 0
  s_cbranch_scc1 .g2_kernel_d_t1
  v_mov_b32 v62, -1.4426950408889634
  v_mul_f32 v62, s27, v62
  v_exp_f32 v62, v62
  v_lshlrev_b32 v14, 12, v2
  v_min_u32 v15, 126976, v14
  s_lshl_b32 s21, s17, 4
  s_add_u32 s21, s21, s18
  s_lshl_b32 s21, s21, 4
  s_mul_i32 s22, s32, 0x270000
  s_add_u32 s21, s21, s22
  s_add_u32 s21, s21, 0x2890000
  s_add_u32 s22, s21, 262144
  s_add_u32 s24, s21, 524288
  s_add_u32 s25, s21, 786432
  v_add_f32 v62, 1.0, v62
  v_rcp_f32 v62, v62
  v_lshlrev_b32 v56, 16, v56
  v_fma_f32 v56, v56, v61, -v60
  v_lshlrev_b32 v57, 16, v57
  v_fma_f32 v57, v57, v61, -v60
  v_lshlrev_b32 v58, 16, v58
  v_fma_f32 v58, v58, v61, -v60
  v_lshlrev_b32 v59, 16, v59
  v_fma_f32 v59, v59, v61, -v60
  s_sleep 8
  s_mov_b32 s38, 0
.g2_kernel_gx65:
  buffer_load_dwordx4 v[16:19], v14, s[4:7], s21 offen sc1
  buffer_load_dwordx4 v[20:23], v14, s[4:7], s22 offen sc1
  buffer_load_dwordx4 v[24:27], v14, s[4:7], s24 offen sc1
  buffer_load_dwordx4 v[28:31], v15, s[4:7], s25 offen sc1
  s_add_u32 s38, s38, 1
  s_waitcnt vmcnt(0)
  v_min3_u32 v6, v16, v18, v20
  v_min3_u32 v6, v6, v22, v24
  v_min3_u32 v6, v6, v26, v28
  v_min_u32 v6, v6, v30
  v_cmp_eq_u32 vcc, 0, v6
  s_cbranch_vccz .g2_kernel_gx65d
  s_mov_b64 exec, vcc
  s_cmp_lt_u32 s38, 131072
  s_cbranch_scc1 .g2_kernel_gx65
.g2_kernel_gx65d:
  s_mov_b64 exec, -1
  v_add_f32 v16, v16, v20
  v_add_f32 v17, v17, v21
  v_add_f32 v18, v18, v22
  v_add_f32 v19, v19, v23
  s_mov_b32 exec_hi, 0
  v_add_f32 v24, v24, v28
  v_add_f32 v25, v25, v29
  v_add_f32 v26, v26, v30
  v_add_f32 v27, v27, v31
  s_mov_b64 exec, -1
  v_add_f32 v16, v16, v24
  v_add_f32 v17, v17, v25
  v_add_f32 v18, v18, v26
  v_add_f32 v19, v19, v27
  v_add_f32 v16, v16, v16 row_ror:8 row_mask:0xf bank_mask:0xf
  v_add_f32 v17, v17, v17 row_ror:8 row_mask:0xf bank_mask:0xf
  v_add_f32 v18, v18, v18 row_ror:8 row_mask:0xf bank_mask:0xf
  v_add_f32 v19, v19, v19 row_ror:8 row_mask:0xf bank_mask:0xf
  v_add_f32 v16, v16, v16 row_ror:4 row_mask:0xf bank_mask:0xf
  v_add_f32 v17, v17, v17 row_ror:4 row_mask:0xf bank_mask:0xf
  v_add_f32 v18, v18, v18 row_ror:4 row_mask:0xf bank_mask:0xf
  v_add_f32 v19, v19, v19 row_ror:4 row_mask:0xf bank_mask:0xf
  v_add_f32 v16, v16, v16 row_ror:2 row_mask:0xf bank_mask:0xf
  v_add_f32 v17, v17, v17 row_ror:2 row_mask:0xf bank_mask:0xf
  v_add_f32 v18, v18, v18 row_ror:2 row_mask:0xf bank_mask:0xf
  v_add_f32 v19, v19, v19 row_ror:2 row_mask:0xf bank_mask:0xf
  v_add_f32 v16, v16, v16 row_ror:1 row_mask:0xf bank_mask:0xf
  v_add_f32 v17, v17, v17 row_ror:1 row_mask:0xf bank_mask:0xf
  v_add_f32 v18, v18, v18 row_ror:1 row_mask:0xf bank_mask:0xf
  v_add_f32 v19, v19, v19 row_ror:1 row_mask:0xf bank_mask:0xf
  v_add_f32 v16, v16, v16 row_bcast:15 row_mask:0xa bank_mask:0xf
  v_add_f32 v17, v17, v17 row_bcast:15 row_mask:0xa bank_mask:0xf
  v_add_f32 v18, v18, v18 row_bcast:15 row_mask:0xa bank_mask:0xf
  v_add_f32 v19, v19, v19 row_bcast:15 row_mask:0xa bank_mask:0xf
  v_add_f32 v16, v16, v16 row_bcast:31 row_mask:0xc bank_mask:0xf
  v_add_f32 v17, v17, v17 row_bcast:31 row_mask:0xc bank_mask:0xf
  v_add_f32 v18, v18, v18 row_bcast:31 row_mask:0xc bank_mask:0xf
  v_add_f32 v19, v19, v19 row_bcast:31 row_mask:0xc bank_mask:0xf
  s_lshl_b32 s24, s77, 11
  s_lshl_b32 s25, s17, 7
  s_add_u32 s24, s24, s25
  s_lshl_b32 s25, s18, 1
  s_add_u32 s24, s24, s25
.g2_kernel_d_t1:
  v_mov_b32 v6, s71
  s_mov_b32 s38, 0
.g2_kernel_wg66:
  ds_read_b32 v7, v6 offset:88
  s_add_u32 s38, s38, 1
  s_waitcnt lgkmcnt(0)
  v_cmp_gt_u32 vcc, 1, v7
  s_cbranch_vccz .g2_kernel_wg66d
  s_cmp_lt_u32 s38, 524288
  s_cbranch_scc1 .g2_kernel_wg66
.g2_kernel_wg66d:
  ds_read_b32 v6, v6 offset:92
  v_readfirstlane_b32 s33, v7
  s_cmp_lg_u32 s32, 0
  s_cselect_b32 s33, 1, s33
  s_cmp_lg_u32 s20, 0
  s_cbranch_scc1 .g2_kernel_d_t2
  s_cmp_lg_u32 s33, 1
  s_cbranch_scc1 .g2_kernel_d_t4
  v_fmac_f32 v56, v16, v62
  v_fmac_f32 v57, v17, v62
  v_fmac_f32 v58, v18, v62
  v_fmac_f32 v59, v19, v62
.g2_kernel_d_t4:
  s_mov_b32 s28, s56
  s_mov_b32 s29, s57
  s_mov_b32 s30, 0x400000
  s_mov_b32 s31, 0x00020000
  v_cvt_pk_bf16_f32 v56, v56, v57
  v_cvt_pk_bf16_f32 v58, v58, v59
  s_mov_b32 exec_lo, 0
  s_mov_b32 exec_hi, 0x80000000
  buffer_store_short v56, v4, s[28:31], s24 offen
  buffer_store_short_d16_hi v56, v4, s[28:31], s24 offen offset:32
  buffer_store_short v58, v4, s[28:31], s24 offen offset:64
  buffer_store_short_d16_hi v58, v4, s[28:31], s24 offen offset:96
  s_mov_b64 exec, -1
.g2_kernel_d_t2:
  s_cmp_eq_u32 s33, 1
  s_cbranch_scc1 .g2_kernel_fin
  s_waitcnt vmcnt(0) lgkmcnt(0)
  v_readfirstlane_b32 s27, v6
  s_sub_u32 s77, s33, 2
  s_mov_b32 s32, 1
  s_add_u32 s26, s26, 0x270000
  s_branch .g2_kernel_d_r
.g2_kernel_fin1:
.g2_kernel_fin:
.g2_kernel_end:
  s_endpgm
.g2_kernel_q_i2:
  v_mov_b32 v6, 155648
  s_mov_b32 s38, 0
.g2_kernel_wg1:
  ds_read_b32 v7, v6 offset:20
  s_add_u32 s38, s38, 1
  s_waitcnt lgkmcnt(0)
  v_cmp_gt_u32 vcc, 4, v7
  s_cbranch_vccz .g2_kernel_wg1d
  s_cmp_lt_u32 s38, 524288
  s_cbranch_scc1 .g2_kernel_wg1
.g2_kernel_wg1d:
  s_branch .g2_kernel_q_i3
.g2_kernel_q_spin:
  s_mov_b32 s38, 0
.g2_kernel_q_spinl:
  ds_read_b32 v151, v150
  s_add_u32 s38, s38, 1
  s_waitcnt lgkmcnt(0)
  v_cmp_lt_i32 vcc, s33, v151
  s_cbranch_vccnz .g2_kernel_q_spinr
  s_cmp_lt_u32 s38, 524288
  s_cbranch_scc1 .g2_kernel_q_spinl
.g2_kernel_q_spinr:
  s_setpc_b64 s[68:69]
.g2_kernel_q_wf:
  s_call_b64 s[68:69], .g2_kernel_q_spin
  s_branch .g2_kernel_q_backf
.g2_kernel_q_w7:
  s_call_b64 s[68:69], .g2_kernel_q_spin
  s_branch .g2_kernel_q_back7
.g2_kernel_q_w0:
  s_call_b64 s[68:69], .g2_kernel_q_spin
  s_branch .g2_kernel_q_back0
.g2_kernel_q_w1:
  s_call_b64 s[68:69], .g2_kernel_q_spin
  s_branch .g2_kernel_q_back1
.g2_kernel_q_w2:
  s_call_b64 s[68:69], .g2_kernel_q_spin
  s_branch .g2_kernel_q_back2
.g2_kernel_q_w3:
  s_call_b64 s[68:69], .g2_kernel_q_spin
  s_branch .g2_kernel_q_back3
.g2_kernel_q_w4:
  s_call_b64 s[68:69], .g2_kernel_q_spin
  s_branch .g2_kernel_q_back4
.g2_kernel_q_w5:
  s_call_b64 s[68:69], .g2_kernel_q_spin
  s_branch .g2_kernel_q_back5
.g2_kernel_q_w6:
  s_call_b64 s[68:69], .g2_kernel_q_spin
  s_branch .g2_kernel_q_back6
.g2_kernel_q_cons2:
  s_lshr_b32 s26, s16, 1
  s_lshl_b32 s26, s26, 13
  v_add_u32 v144, s26, v3
  v_add_u32 v145, 1024, v144
  s_branch .g2_kernel_q_cs
.g2_kernel_q_wl:
  s_call_b64 s[68:69], .g2_kernel_q_spin
  s_branch .g2_kernel_q_bl
.g2_kernel_q_v0ew:
  v_mov_b32 v6, s71
  s_mov_b32 s38, 0
.g2_kernel_wg2:
  ds_read_b32 v7, v6 offset:0
  s_add_u32 s38, s38, 1
  s_waitcnt lgkmcnt(0)
  v_cmp_gt_u32 vcc, 2, v7
  s_cbranch_vccz .g2_kernel_wg2d
  s_cmp_lt_u32 s38, 524288
  s_cbranch_scc1 .g2_kernel_wg2
.g2_kernel_wg2d:
  ds_read_b32 v57, v13 offset:24
  ds_read_b128 v[40:43], v52 offset:5120
  ds_read_b128 v[44:47], v52 offset:5184
  ds_read_b32 v24, v50 offset:2816
  ds_read_b32 v25, v50 offset:3328
  ds_read_b32 v26, v50 offset:2880
  ds_read_b32 v27, v50 offset:3392
  ds_read_b32 v28, v50 offset:2944
  ds_read_b32 v29, v50 offset:3456
  ds_read_b32 v30, v50 offset:3008
  ds_read_b32 v31, v50 offset:3520
  s_waitcnt lgkmcnt(0)
  s_branch .g2_kernel_q_v0eb
.g2_kernel_q_v0p:
  v_readfirstlane_b32 s35, v57
  s_sub_u32 s28, s35, 1
  s_lshr_b32 s29, s28, 6
  s_lshr_b32 s30, s16, 1
  s_add_u32 s35, s35, 0x100
  s_cmp_lg_u32 s29, s30
  s_cbranch_scc1 .g2_kernel_q_v0pb
  s_add_u32 s35, s35, 0x100
  s_and_b32 s29, s28, 15
  s_mov_b32 s14, 0x00010001
  s_mov_b32 s15, 0x00010001
  s_lshl_b64 s[14:15], s[14:15], s29
  s_and_b32 s29, s28, 12
  s_lshl_b32 s29, s29, 2
  s_lshl_b64 s[30:31], 0xffff, s29
  s_bfe_u32 s29, s28, 0x20004
  s_branch .g2_kernel_q_v0s
.g2_kernel_q_v0s:
  v_subrev_u32 v6, 155648, v53
  v_lshlrev_b32 v6, 2, v6
  v_add_u32 v6, 155648, v6
  s_cmp_lg_u32 s29, 0
  s_cbranch_scc1 .g2_kernel_q_v0s1
  s_mov_b64 exec, s[14:15]
  ds_write_b128 v52, v[192:195] offset:5888
  ds_write_b128 v52, v[208:211] offset:5952
  s_mov_b64 exec, -1
  s_waitcnt lgkmcnt(0)
  s_branch .g2_kernel_q_v0pb
.g2_kernel_q_v0s1:
  s_cmp_lg_u32 s29, 1
  s_cbranch_scc1 .g2_kernel_q_v0s2
  s_mov_b64 exec, s[14:15]
  ds_write_b128 v52, v[196:199] offset:5888
  ds_write_b128 v52, v[212:215] offset:5952
  s_mov_b64 exec, -1
  s_waitcnt lgkmcnt(0)
  s_branch .g2_kernel_q_v0pb
.g2_kernel_q_v0s2:
  s_cmp_lg_u32 s29, 2
  s_cbranch_scc1 .g2_kernel_q_v0s3
  s_mov_b64 exec, s[14:15]
  ds_write_b128 v52, v[200:203] offset:5888
  ds_write_b128 v52, v[216:219] offset:5952
  s_mov_b64 exec, -1
  s_waitcnt lgkmcnt(0)
  s_branch .g2_kernel_q_v0pb
.g2_kernel_q_v0s3:
  s_mov_b64 exec, s[14:15]
  ds_write_b128 v52, v[204:207] offset:5888
  ds_write_b128 v52, v[220:223] offset:5952
  s_mov_b64 exec, -1
  s_waitcnt lgkmcnt(0)
  s_branch .g2_kernel_q_v0pb
.g2_kernel_q_v0f:
  s_mov_b64 exec, 1
  s_cmp_ge_u32 s35, 0x200
  s_cbranch_scc1 .g2_kernel_q_v0f1
  buffer_store_dword v15, v4, s[4:7], s37 offen sc1
  s_mov_b64 exec, -1
  s_branch .g2_kernel_q_v0fb
.g2_kernel_q_v0f1:
  ds_add_u32 v13, v5 offset:56
  s_mov_b64 exec, -1
  s_branch .g2_kernel_q_v0fb
.g2_kernel_q_v0fw:
  s_mov_b32 s38, 0
.g2_kernel_q_v0fl:
  ds_read_b32 v63, v58
  s_add_u32 s38, s38, 1
  s_waitcnt lgkmcnt(0)
  v_cmp_gt_u32 vcc, s12, v63
  s_cbranch_vccz .g2_kernel_q_v0fc
  s_cmp_lt_u32 s38, 524288
  s_cbranch_scc1 .g2_kernel_q_v0fl
  s_branch .g2_kernel_q_v0fc
.g2_kernel_q_v0r:
  v_subrev_u32 v6, 155648, v53
  v_lshlrev_b32 v6, 2, v6
  v_add_u32 v6, 155648, v6
  s_cmp_lg_u32 s29, 0
  s_cbranch_scc1 .g2_kernel_q_v0r1
  s_mov_b64 exec, s[14:15]
  ds_write_b128 v52, v[160:163] offset:5632
  ds_write_b128 v52, v[176:179] offset:5696
  s_mov_b64 exec, s[30:31]
  ds_write_b128 v6, v[224:227] offset:6144
  ds_write_b128 v6, v[240:243] offset:6400
  s_mov_b64 exec, -1
  s_waitcnt lgkmcnt(0)
  s_branch .g2_kernel_q_v0rb
.g2_kernel_q_v0r1:
  s_cmp_lg_u32 s29, 1
  s_cbranch_scc1 .g2_kernel_q_v0r2
  s_mov_b64 exec, s[14:15]
  ds_write_b128 v52, v[164:167] offset:5632
  ds_write_b128 v52, v[180:183] offset:5696
  s_mov_b64 exec, s[30:31]
  ds_write_b128 v6, v[228:231] offset:6144
  ds_write_b128 v6, v[244:247] offset:6400
  s_mov_b64 exec, -1
  s_waitcnt lgkmcnt(0)
  s_branch .g2_kernel_q_v0rb
.g2_kernel_q_v0r2:
  s_cmp_lg_u32 s29, 2
  s_cbranch_scc1 .g2_kernel_q_v0r3
  s_mov_b64 exec, s[14:15]
  ds_write_b128 v52, v[168:171] offset:5632
  ds_write_b128 v52, v[184:187] offset:5696
  s_mov_b64 exec, s[30:31]
  ds_write_b128 v6, v[232:235] offset:6144
  ds_write_b128 v6, v[248:251] offset:6400
  s_mov_b64 exec, -1
  s_waitcnt lgkmcnt(0)
  s_branch .g2_kernel_q_v0rb
.g2_kernel_q_v0r3:
  s_mov_b64 exec, s[14:15]
  ds_write_b128 v52, v[172:175] offset:5632
  ds_write_b128 v52, v[188:191] offset:5696
  s_mov_b64 exec, s[30:31]
  ds_write_b128 v6, v[236:239] offset:6144
  ds_write_b128 v6, v[252:255] offset:6400
  s_mov_b64 exec, -1
  s_waitcnt lgkmcnt(0)
  s_branch .g2_kernel_q_v0rb
.g2_kernel_q_v1ew:
  v_mov_b32 v6, s71
  s_mov_b32 s38, 0
.g2_kernel_wg3:
  ds_read_b32 v7, v6 offset:0
  s_add_u32 s38, s38, 1
  s_waitcnt lgkmcnt(0)
  v_cmp_gt_u32 vcc, 2, v7
  s_cbranch_vccz .g2_kernel_wg3d
  s_cmp_lt_u32 s38, 524288
  s_cbranch_scc1 .g2_kernel_wg3
.g2_kernel_wg3d:
  ds_read_b32 v57, v13 offset:24
  ds_read_b128 v[24:27], v51 offset:2816
  ds_read_b128 v[32:35], v51 offset:3328
  ds_read_b128 v[28:31], v51 offset:2880
  ds_read_b128 v[36:39], v51 offset:3392
  ds_read_b128 v[40:43], v51 offset:2944
  ds_read_b128 v[88:91], v51 offset:3456
  ds_read_b128 v[44:47], v51 offset:3008
  ds_read_b128 v[92:95], v51 offset:3520
  ds_read_b32 v48, v53 offset:5376
  ds_read_b32 v49, v53 offset:5440
  s_waitcnt lgkmcnt(0)
  s_branch .g2_kernel_q_v1eb
.g2_kernel_q_v1p:
  v_readfirstlane_b32 s35, v57
  s_sub_u32 s28, s35, 1
  s_lshr_b32 s29, s28, 6
  s_lshr_b32 s30, s16, 1
  s_add_u32 s35, s35, 0x100
  s_cmp_lg_u32 s29, s30
  s_cbranch_scc1 .g2_kernel_q_v1pb
  s_add_u32 s35, s35, 0x100
  s_and_b32 s29, s28, 15
  s_mov_b32 s14, 0x00010001
  s_mov_b32 s15, 0x00010001
  s_lshl_b64 s[14:15], s[14:15], s29
  s_and_b32 s29, s28, 12
  s_lshl_b32 s29, s29, 2
  s_lshl_b64 s[30:31], 0xffff, s29
  s_bfe_u32 s29, s28, 0x20004
  s_branch .g2_kernel_q_v1s
.g2_kernel_q_v1s:
  v_subrev_u32 v6, 155648, v53
  v_lshlrev_b32 v6, 2, v6
  v_add_u32 v6, 155648, v6
  s_cmp_lg_u32 s29, 0
  s_cbranch_scc1 .g2_kernel_q_v1s1
  s_mov_b64 exec, s[30:31]
  ds_write_b128 v6, v[224:227] offset:6144
  ds_write_b128 v6, v[240:243] offset:6400
  s_mov_b64 exec, -1
  s_waitcnt lgkmcnt(0)
  s_branch .g2_kernel_q_v1pb
.g2_kernel_q_v1s1:
  s_cmp_lg_u32 s29, 1
  s_cbranch_scc1 .g2_kernel_q_v1s2
  s_mov_b64 exec, s[30:31]
  ds_write_b128 v6, v[228:231] offset:6144
  ds_write_b128 v6, v[244:247] offset:6400
  s_mov_b64 exec, -1
  s_waitcnt lgkmcnt(0)
  s_branch .g2_kernel_q_v1pb
.g2_kernel_q_v1s2:
  s_cmp_lg_u32 s29, 2
  s_cbranch_scc1 .g2_kernel_q_v1s3
  s_mov_b64 exec, s[30:31]
  ds_write_b128 v6, v[232:235] offset:6144
  ds_write_b128 v6, v[248:251] offset:6400
  s_mov_b64 exec, -1
  s_waitcnt lgkmcnt(0)
  s_branch .g2_kernel_q_v1pb
.g2_kernel_q_v1s3:
  s_mov_b64 exec, s[30:31]
  ds_write_b128 v6, v[236:239] offset:6144
  ds_write_b128 v6, v[252:255] offset:6400
  s_mov_b64 exec, -1
  s_waitcnt lgkmcnt(0)
  s_branch .g2_kernel_q_v1pb
.g2_kernel_q_v1f:
  s_mov_b64 exec, 1
  s_cmp_ge_u32 s35, 0x200
  s_cbranch_scc1 .g2_kernel_q_v1f1
  buffer_store_dword v15, v4, s[4:7], s37 offen sc1
  s_mov_b64 exec, -1
  s_branch .g2_kernel_q_v1fb
.g2_kernel_q_v1f1:
  ds_add_u32 v13, v5 offset:56
  s_mov_b64 exec, -1
  s_branch .g2_kernel_q_v1fb
.g2_kernel_q_v1fw:
  s_mov_b32 s38, 0
.g2_kernel_q_v1fl:
  ds_read_b32 v63, v58
  s_add_u32 s38, s38, 1
  s_waitcnt lgkmcnt(0)
  v_cmp_gt_u32 vcc, s12, v63
  s_cbranch_vccz .g2_kernel_q_v1fc
  s_cmp_lt_u32 s38, 524288
  s_cbranch_scc1 .g2_kernel_q_v1fl
  s_branch .g2_kernel_q_v1fc
.g2_kernel_q_v1r:
  v_subrev_u32 v6, 155648, v53
  v_lshlrev_b32 v6, 2, v6
  v_add_u32 v6, 155648, v6
  s_cmp_lg_u32 s29, 0
  s_cbranch_scc1 .g2_kernel_q_v1r1
  s_mov_b64 exec, s[14:15]
  ds_write_b128 v52, v[160:163] offset:5632
  ds_write_b128 v52, v[176:179] offset:5696
  s_mov_b64 exec, s[14:15]
  ds_write_b128 v52, v[192:195] offset:5888
  ds_write_b128 v52, v[208:211] offset:5952
  s_mov_b64 exec, -1
  s_waitcnt lgkmcnt(0)
  s_branch .g2_kernel_q_v1rb
.g2_kernel_q_v1r1:
  s_cmp_lg_u32 s29, 1
  s_cbranch_scc1 .g2_kernel_q_v1r2
  s_mov_b64 exec, s[14:15]
  ds_write_b128 v52, v[164:167] offset:5632
  ds_write_b128 v52, v[180:183] offset:5696
  s_mov_b64 exec, s[14:15]
  ds_write_b128 v52, v[196:199] offset:5888
  ds_write_b128 v52, v[212:215] offset:5952
  s_mov_b64 exec, -1
  s_waitcnt lgkmcnt(0)
  s_branch .g2_kernel_q_v1rb
.g2_kernel_q_v1r2:
  s_cmp_lg_u32 s29, 2
  s_cbranch_scc1 .g2_kernel_q_v1r3
  s_mov_b64 exec, s[14:15]
  ds_write_b128 v52, v[168:171] offset:5632
  ds_write_b128 v52, v[184:187] offset:5696
  s_mov_b64 exec, s[14:15]
  ds_write_b128 v52, v[200:203] offset:5888
  ds_write_b128 v52, v[216:219] offset:5952
  s_mov_b64 exec, -1
  s_waitcnt lgkmcnt(0)
  s_branch .g2_kernel_q_v1rb
.g2_kernel_q_v1r3:
  s_mov_b64 exec, s[14:15]
  ds_write_b128 v52, v[172:175] offset:5632
  ds_write_b128 v52, v[188:191] offset:5696
  s_mov_b64 exec, s[14:15]
  ds_write_b128 v52, v[204:207] offset:5888
  ds_write_b128 v52, v[220:223] offset:5952
  s_mov_b64 exec, -1
  s_waitcnt lgkmcnt(0)
  s_branch .g2_kernel_q_v1rb
.g2_kernel_q_v1:
  v_mfma_f32_16x16x32_bf16 v[224:227], v[64:67], v[96:99], v[224:227]
  ds_read_b64_tr_b16 v[80:81], v148 offset:45056
  ds_read_b64_tr_b16 v[82:83], v148 offset:45568
  ds_read_b128 v[128:131], v145 offset:49152
  v_mfma_f32_16x16x32_bf16 v[228:231], v[68:71], v[96:99], v[228:231]
  ds_read_b128 v[132:135], v145 offset:51200
  ds_read_b128 v[136:139], v145 offset:53248
  ds_read_b128 v[140:143], v145 offset:55296
  v_mfma_f32_16x16x32_bf16 v[232:235], v[72:75], v[96:99], v[232:235]
  ds_read_b64_tr_b16 v[84:85], v149 offset:45056
  ds_read_b64_tr_b16 v[86:87], v149 offset:45568
  ds_read_b32 v63, v13 offset:0
  v_mfma_f32_16x16x32_bf16 v[236:239], v[76:79], v[96:99], v[236:239]
  ds_read_b32 v57, v13 offset:24
  ds_read_b128 v[24:27], v51 offset:2816
  ds_read_b128 v[32:35], v51 offset:3328
  v_mfma_f32_16x16x32_bf16 v[252:255], v[76:79], v[100:103], v[252:255]
  ds_read_b128 v[28:31], v51 offset:2880
  ds_read_b128 v[36:39], v51 offset:3392
  ds_read_b128 v[40:43], v51 offset:2944
  v_mfma_f32_16x16x32_bf16 v[248:251], v[72:75], v[100:103], v[248:251]
  ds_read_b128 v[88:91], v51 offset:3456
  ds_read_b128 v[44:47], v51 offset:3008
  ds_read_b128 v[92:95], v51 offset:3520
  v_mfma_f32_16x16x32_bf16 v[244:247], v[68:71], v[100:103], v[244:247]
  ds_read_b32 v48, v53 offset:5376
  ds_read_b32 v49, v53 offset:5440
  v_mfma_f32_16x16x32_bf16 v[240:243], v[64:67], v[100:103], v[240:243]
  s_waitcnt lgkmcnt(12)
  v_mfma_f32_16x16x32_bf16 v[224:227], v[128:131], v[80:83], v[224:227]
  v_mfma_f32_16x16x32_bf16 v[228:231], v[132:135], v[80:83], v[228:231]
  v_mfma_f32_16x16x32_bf16 v[232:235], v[136:139], v[80:83], v[232:235]
  v_mfma_f32_16x16x32_bf16 v[236:239], v[140:143], v[80:83], v[236:239]
  v_mfma_f32_16x16x32_bf16 v[252:255], v[140:143], v[84:87], v[252:255]
  v_mfma_f32_16x16x32_bf16 v[248:251], v[136:139], v[84:87], v[248:251]
  v_mfma_f32_16x16x32_bf16 v[244:247], v[132:135], v[84:87], v[244:247]
  v_mfma_f32_16x16x32_bf16 v[240:243], v[128:131], v[84:87], v[240:243]
  s_waitcnt lgkmcnt(0)
  v_cmp_gt_u32 vcc, 2, v63
  s_cbranch_vccnz .g2_kernel_q_v1ew
.g2_kernel_q_v1eb:
  ds_read_b64_tr_b16 v[120:121], v148 offset:24576
  ds_read_b64_tr_b16 v[122:123], v148 offset:25088
  ds_read_b128 v[104:107], v144 offset:49152
  ds_read_b128 v[108:111], v144 offset:51200
  ds_read_b128 v[112:115], v144 offset:53248
  ds_read_b128 v[116:119], v144 offset:55296
  ds_read_b64_tr_b16 v[124:125], v149 offset:24576
  ds_read_b64_tr_b16 v[126:127], v149 offset:25088
  ds_read_b64_tr_b16 v[128:129], v148 offset:28672
  ds_read_b64_tr_b16 v[130:131], v148 offset:29184
  ds_read_b64_tr_b16 v[132:133], v149 offset:28672
  ds_read_b64_tr_b16 v[134:135], v149 offset:29184
  v_cmp_ne_u32 vcc, 0, v57
  s_cbranch_vccnz .g2_kernel_q_v1p
.g2_kernel_q_v1pb:
  v_pk_mul_f32 v[152:153], v[32:33], v[48:49] op_sel:[0,0] op_sel_hi:[1,0]
  v_pk_mul_f32 v[154:155], v[34:35], v[48:49] op_sel:[0,0] op_sel_hi:[1,0]
  v_pk_mul_f32 v[156:157], v[36:37], v[48:49] op_sel:[0,0] op_sel_hi:[1,0]
  v_pk_mul_f32 v[158:159], v[38:39], v[48:49] op_sel:[0,0] op_sel_hi:[1,0]
  v_pk_fma_f32 v[224:225], v[224:225], v[24:25], v[152:153]
  v_pk_fma_f32 v[226:227], v[226:227], v[26:27], v[154:155]
  v_pk_fma_f32 v[228:229], v[228:229], v[28:29], v[156:157]
  v_pk_fma_f32 v[230:231], v[230:231], v[30:31], v[158:159]
  v_cvt_pk_bf16_f32 v224, v224, v225
  v_cvt_pk_bf16_f32 v225, v226, v227
  v_cvt_pk_bf16_f32 v226, v228, v229
  v_cvt_pk_bf16_f32 v227, v230, v231
  buffer_store_dwordx4 v[224:227], v55, s[4:7], s8 offen offset:2048 sc1
  v_pk_mul_f32 v[152:153], v[32:33], v[48:49] op_sel:[0,1] op_sel_hi:[1,1]
  v_pk_mul_f32 v[154:155], v[34:35], v[48:49] op_sel:[0,1] op_sel_hi:[1,1]
  v_pk_mul_f32 v[156:157], v[36:37], v[48:49] op_sel:[0,1] op_sel_hi:[1,1]
  v_pk_mul_f32 v[158:159], v[38:39], v[48:49] op_sel:[0,1] op_sel_hi:[1,1]
  v_pk_fma_f32 v[240:241], v[240:241], v[24:25], v[152:153]
  v_pk_fma_f32 v[242:243], v[242:243], v[26:27], v[154:155]
  v_pk_fma_f32 v[244:245], v[244:245], v[28:29], v[156:157]
  v_pk_fma_f32 v[246:247], v[246:247], v[30:31], v[158:159]
  v_cvt_pk_bf16_f32 v240, v240, v241
  v_cvt_pk_bf16_f32 v241, v242, v243
  v_cvt_pk_bf16_f32 v242, v244, v245
  v_cvt_pk_bf16_f32 v243, v246, v247
  buffer_store_dwordx4 v[240:243], v55, s[4:7], s8 offen offset:2304 sc1
  v_pk_mul_f32 v[152:153], v[88:89], v[48:49] op_sel:[0,0] op_sel_hi:[1,0]
  v_pk_mul_f32 v[154:155], v[90:91], v[48:49] op_sel:[0,0] op_sel_hi:[1,0]
  v_pk_mul_f32 v[156:157], v[92:93], v[48:49] op_sel:[0,0] op_sel_hi:[1,0]
  v_pk_mul_f32 v[158:159], v[94:95], v[48:49] op_sel:[0,0] op_sel_hi:[1,0]
  v_pk_fma_f32 v[232:233], v[232:233], v[40:41], v[152:153]
  v_pk_fma_f32 v[234:235], v[234:235], v[42:43], v[154:155]
  v_pk_fma_f32 v[236:237], v[236:237], v[44:45], v[156:157]
  v_pk_fma_f32 v[238:239], v[238:239], v[46:47], v[158:159]
  v_cvt_pk_bf16_f32 v232, v232, v233
  v_cvt_pk_bf16_f32 v233, v234, v235
  v_cvt_pk_bf16_f32 v234, v236, v237
  v_cvt_pk_bf16_f32 v235, v238, v239
  buffer_store_dwordx4 v[232:235], v55, s[4:7], s9 offen offset:2048 sc1
  v_pk_mul_f32 v[152:153], v[88:89], v[48:49] op_sel:[0,1] op_sel_hi:[1,1]
  v_pk_mul_f32 v[154:155], v[90:91], v[48:49] op_sel:[0,1] op_sel_hi:[1,1]
  v_pk_mul_f32 v[156:157], v[92:93], v[48:49] op_sel:[0,1] op_sel_hi:[1,1]
  v_pk_mul_f32 v[158:159], v[94:95], v[48:49] op_sel:[0,1] op_sel_hi:[1,1]
  v_pk_fma_f32 v[248:249], v[248:249], v[40:41], v[152:153]
  v_pk_fma_f32 v[250:251], v[250:251], v[42:43], v[154:155]
  v_pk_fma_f32 v[252:253], v[252:253], v[44:45], v[156:157]
  v_pk_fma_f32 v[254:255], v[254:255], v[46:47], v[158:159]
  v_cvt_pk_bf16_f32 v248, v248, v249
  v_cvt_pk_bf16_f32 v249, v250, v251
  v_cvt_pk_bf16_f32 v250, v252, v253
  v_cvt_pk_bf16_f32 v251, v254, v255
  buffer_store_dwordx4 v[248:251], v55, s[4:7], s9 offen offset:2304 sc1
  s_waitcnt lgkmcnt(0)
  v_mfma_f32_16x16x32_bf16 v[160:163], v[120:123], v[104:107], v[160:163]
  ds_read_b64_tr_b16 v[80:81], v148 offset:36864
  ds_read_b64_tr_b16 v[82:83], v148 offset:37376
  v_mfma_f32_16x16x32_bf16 v[164:167], v[120:123], v[108:111], v[164:167]
  ds_read_b128 v[64:67], v145 offset:49152
  ds_read_b128 v[68:71], v145 offset:51200
  v_mfma_f32_16x16x32_bf16 v[168:171], v[120:123], v[112:115], v[168:171]
  ds_read_b128 v[72:75], v145 offset:53248
  ds_read_b128 v[76:79], v145 offset:55296
  v_mfma_f32_16x16x32_bf16 v[172:175], v[120:123], v[116:119], v[172:175]
  ds_read_b64_tr_b16 v[84:85], v149 offset:36864
  ds_read_b64_tr_b16 v[86:87], v149 offset:37376
  v_mfma_f32_16x16x32_bf16 v[188:191], v[124:127], v[116:119], v[188:191]
  ds_read_b64_tr_b16 v[88:89], v148 offset:40960
  ds_read_b64_tr_b16 v[90:91], v148 offset:41472
  v_mfma_f32_16x16x32_bf16 v[184:187], v[124:127], v[112:115], v[184:187]
  ds_read_b64_tr_b16 v[92:93], v149 offset:40960
  ds_read_b64_tr_b16 v[94:95], v149 offset:41472
  v_mfma_f32_16x16x32_bf16 v[180:183], v[124:127], v[108:111], v[180:183]
  ds_read_b128 v[32:35], v52 offset:4864
  ds_read_b128 v[36:39], v52 offset:4928
  v_mfma_f32_16x16x32_bf16 v[176:179], v[124:127], v[104:107], v[176:179]
  ds_read_b128 v[40:43], v52 offset:5120
  ds_read_b128 v[44:47], v52 offset:5184
  v_mfma_f32_16x16x32_bf16 v[192:195], v[128:131], v[104:107], v[192:195]
  v_mfma_f32_16x16x32_bf16 v[196:199], v[128:131], v[108:111], v[196:199]
  v_mfma_f32_16x16x32_bf16 v[200:203], v[128:131], v[112:115], v[200:203]
  v_mfma_f32_16x16x32_bf16 v[204:207], v[128:131], v[116:119], v[204:207]
  v_mfma_f32_16x16x32_bf16 v[220:223], v[132:135], v[116:119], v[220:223]
  v_mfma_f32_16x16x32_bf16 v[216:219], v[132:135], v[112:115], v[216:219]
  v_mfma_f32_16x16x32_bf16 v[212:215], v[132:135], v[108:111], v[212:215]
  v_mfma_f32_16x16x32_bf16 v[208:211], v[132:135], v[104:107], v[208:211]
  s_waitcnt lgkmcnt(0)
  v_mfma_f32_16x16x32_bf16 v[160:163], v[80:83], v[64:67], v[160:163]
  ds_read_b32 v63, v58
  ds_read_b32 v24, v50 offset:2816
  v_mfma_f32_16x16x32_bf16 v[164:167], v[80:83], v[68:71], v[164:167]
  ds_read_b32 v25, v50 offset:3328
  ds_read_b32 v26, v50 offset:2880
  v_mfma_f32_16x16x32_bf16 v[168:171], v[80:83], v[72:75], v[168:171]
  ds_read_b32 v27, v50 offset:3392
  ds_read_b32 v28, v50 offset:2944
  v_mfma_f32_16x16x32_bf16 v[172:175], v[80:83], v[76:79], v[172:175]
  ds_read_b32 v29, v50 offset:3456
  ds_read_b32 v30, v50 offset:3008
  v_mfma_f32_16x16x32_bf16 v[188:191], v[84:87], v[76:79], v[188:191]
  ds_read_b32 v31, v50 offset:3520
  v_mfma_f32_16x16x32_bf16 v[184:187], v[84:87], v[72:75], v[184:187]
  v_mfma_f32_16x16x32_bf16 v[180:183], v[84:87], v[68:71], v[180:183]
  v_mfma_f32_16x16x32_bf16 v[176:179], v[84:87], v[64:67], v[176:179]
  v_mfma_f32_16x16x32_bf16 v[192:195], v[88:91], v[64:67], v[192:195]
  v_mfma_f32_16x16x32_bf16 v[196:199], v[88:91], v[68:71], v[196:199]
  v_mfma_f32_16x16x32_bf16 v[200:203], v[88:91], v[72:75], v[200:203]
  v_mfma_f32_16x16x32_bf16 v[204:207], v[88:91], v[76:79], v[204:207]
  v_mfma_f32_16x16x32_bf16 v[220:223], v[92:95], v[76:79], v[220:223]
  v_mfma_f32_16x16x32_bf16 v[216:219], v[92:95], v[72:75], v[216:219]
  v_mfma_f32_16x16x32_bf16 v[212:215], v[92:95], v[68:71], v[212:215]
  v_mfma_f32_16x16x32_bf16 v[208:211], v[92:95], v[64:67], v[208:211]
  s_waitcnt lgkmcnt(0)
  v_cmp_gt_u32 vcc, s12, v63
  s_cbranch_vccnz .g2_kernel_q_v1fw
.g2_kernel_q_v1fc:
  s_cmp_ge_u32 s35, 0x200
  s_cbranch_scc1 .g2_kernel_q_v1r
.g2_kernel_q_v1rb:
  ds_write_b128 v60, v[224:227] offset:2048
  v_pk_mul_f32 v[152:153], v[40:41], v[24:25] op_sel:[0,1] op_sel_hi:[1,1]
  v_pk_mul_f32 v[154:155], v[42:43], v[24:25] op_sel:[0,1] op_sel_hi:[1,1]
  v_pk_mul_f32 v[156:157], v[44:45], v[24:25] op_sel:[0,1] op_sel_hi:[1,1]
  v_pk_mul_f32 v[158:159], v[46:47], v[24:25] op_sel:[0,1] op_sel_hi:[1,1]
  v_pk_fma_f32 v[192:193], v[192:193], v[24:25], v[152:153] op_sel_hi:[1,0,1]
  v_pk_fma_f32 v[194:195], v[194:195], v[24:25], v[154:155] op_sel_hi:[1,0,1]
  v_pk_fma_f32 v[208:209], v[208:209], v[24:25], v[156:157] op_sel_hi:[1,0,1]
  v_pk_fma_f32 v[210:211], v[210:211], v[24:25], v[158:159] op_sel_hi:[1,0,1]
  v_cvt_pk_bf16_f32 v192, v192, v193
  v_cvt_pk_bf16_f32 v193, v194, v195
  v_cvt_pk_bf16_f32 v194, v208, v209
  v_cvt_pk_bf16_f32 v195, v210, v211
  ds_write_b128 v59, v[192:195] offset:0
  ds_write_b128 v60, v[240:243] offset:2304
  v_pk_mul_f32 v[152:153], v[40:41], v[26:27] op_sel:[0,1] op_sel_hi:[1,1]
  v_pk_mul_f32 v[154:155], v[42:43], v[26:27] op_sel:[0,1] op_sel_hi:[1,1]
  v_pk_mul_f32 v[156:157], v[44:45], v[26:27] op_sel:[0,1] op_sel_hi:[1,1]
  v_pk_mul_f32 v[158:159], v[46:47], v[26:27] op_sel:[0,1] op_sel_hi:[1,1]
  v_pk_fma_f32 v[196:197], v[196:197], v[26:27], v[152:153] op_sel_hi:[1,0,1]
  v_pk_fma_f32 v[198:199], v[198:199], v[26:27], v[154:155] op_sel_hi:[1,0,1]
  v_pk_fma_f32 v[212:213], v[212:213], v[26:27], v[156:157] op_sel_hi:[1,0,1]
  v_pk_fma_f32 v[214:215], v[214:215], v[26:27], v[158:159] op_sel_hi:[1,0,1]
  v_cvt_pk_bf16_f32 v196, v196, v197
  v_cvt_pk_bf16_f32 v197, v198, v199
  v_cvt_pk_bf16_f32 v198, v212, v213
  v_cvt_pk_bf16_f32 v199, v214, v215
  ds_write_b128 v59, v[196:199] offset:128
  ds_write_b128 v60, v[232:235] offset:6144
  v_pk_mul_f32 v[152:153], v[40:41], v[28:29] op_sel:[0,1] op_sel_hi:[1,1]
  v_pk_mul_f32 v[154:155], v[42:43], v[28:29] op_sel:[0,1] op_sel_hi:[1,1]
  v_pk_mul_f32 v[156:157], v[44:45], v[28:29] op_sel:[0,1] op_sel_hi:[1,1]
  v_pk_mul_f32 v[158:159], v[46:47], v[28:29] op_sel:[0,1] op_sel_hi:[1,1]
  v_pk_fma_f32 v[200:201], v[200:201], v[28:29], v[152:153] op_sel_hi:[1,0,1]
  v_pk_fma_f32 v[202:203], v[202:203], v[28:29], v[154:155] op_sel_hi:[1,0,1]
  v_pk_fma_f32 v[216:217], v[216:217], v[28:29], v[156:157] op_sel_hi:[1,0,1]
  v_pk_fma_f32 v[218:219], v[218:219], v[28:29], v[158:159] op_sel_hi:[1,0,1]
  v_cvt_pk_bf16_f32 v200, v200, v201
  v_cvt_pk_bf16_f32 v201, v202, v203
  v_cvt_pk_bf16_f32 v202, v216, v217
  v_cvt_pk_bf16_f32 v203, v218, v219
  ds_write_b128 v59, v[200:203] offset:4096
  s_waitcnt vmcnt(0)
  s_mov_b64 exec, 1
  ds_add_rtn_u32 v7, v62, v5 offset:120
  s_mov_b64 exec, -1
  ds_write_b128 v60, v[248:251] offset:6400
  v_pk_mul_f32 v[152:153], v[40:41], v[30:31] op_sel:[0,1] op_sel_hi:[1,1]
  v_pk_mul_f32 v[154:155], v[42:43], v[30:31] op_sel:[0,1] op_sel_hi:[1,1]
  v_pk_mul_f32 v[156:157], v[44:45], v[30:31] op_sel:[0,1] op_sel_hi:[1,1]
  v_pk_mul_f32 v[158:159], v[46:47], v[30:31] op_sel:[0,1] op_sel_hi:[1,1]
  v_pk_fma_f32 v[204:205], v[204:205], v[30:31], v[152:153] op_sel_hi:[1,0,1]
  v_pk_fma_f32 v[206:207], v[206:207], v[30:31], v[154:155] op_sel_hi:[1,0,1]
  v_pk_fma_f32 v[220:221], v[220:221], v[30:31], v[156:157] op_sel_hi:[1,0,1]
  v_pk_fma_f32 v[222:223], v[222:223], v[30:31], v[158:159] op_sel_hi:[1,0,1]
  v_cvt_pk_bf16_f32 v204, v204, v205
  v_cvt_pk_bf16_f32 v205, v206, v207
  v_cvt_pk_bf16_f32 v206, v220, v221
  v_cvt_pk_bf16_f32 v207, v222, v223
  s_waitcnt lgkmcnt(1)
  v_readfirstlane_b32 s28, v7
  s_cmp_eq_u32 s28, 1
  s_cbranch_scc1 .g2_kernel_q_v1f
.g2_kernel_q_v1fb:
  ds_write_b128 v59, v[204:207] offset:4224
  v_pk_mul_f32 v[24:25], v[24:25], v[56:57] op_sel_hi:[1,0]
  v_pk_mul_f32 v[26:27], v[26:27], v[56:57] op_sel_hi:[1,0]
  v_pk_mul_f32 v[28:29], v[28:29], v[56:57] op_sel_hi:[1,0]
  v_pk_mul_f32 v[30:31], v[30:31], v[56:57] op_sel_hi:[1,0]
  v_pk_mul_f32 v[152:153], v[32:33], v[24:25] op_sel:[0,1] op_sel_hi:[1,1]
  v_pk_mul_f32 v[154:155], v[34:35], v[24:25] op_sel:[0,1] op_sel_hi:[1,1]
  v_pk_mul_f32 v[156:157], v[36:37], v[24:25] op_sel:[0,1] op_sel_hi:[1,1]
  v_pk_mul_f32 v[158:159], v[38:39], v[24:25] op_sel:[0,1] op_sel_hi:[1,1]
  v_pk_fma_f32 v[160:161], v[160:161], v[24:25], v[152:153] op_sel_hi:[1,0,1]
  v_pk_fma_f32 v[162:163], v[162:163], v[24:25], v[154:155] op_sel_hi:[1,0,1]
  v_pk_fma_f32 v[176:177], v[176:177], v[24:25], v[156:157] op_sel_hi:[1,0,1]
  v_pk_fma_f32 v[178:179], v[178:179], v[24:25], v[158:159] op_sel_hi:[1,0,1]
  v_cvt_pk_bf16_f32 v160, v160, v161
  v_cvt_pk_bf16_f32 v161, v162, v163
  v_cvt_pk_bf16_f32 v162, v176, v177
  v_cvt_pk_bf16_f32 v163, v178, v179
  ds_write_b128 v61, v[160:163] offset:0
  v_pk_mul_f32 v[152:153], v[32:33], v[26:27] op_sel:[0,1] op_sel_hi:[1,1]
  v_pk_mul_f32 v[154:155], v[34:35], v[26:27] op_sel:[0,1] op_sel_hi:[1,1]
  v_pk_mul_f32 v[156:157], v[36:37], v[26:27] op_sel:[0,1] op_sel_hi:[1,1]
  v_pk_mul_f32 v[158:159], v[38:39], v[26:27] op_sel:[0,1] op_sel_hi:[1,1]
  v_pk_fma_f32 v[164:165], v[164:165], v[26:27], v[152:153] op_sel_hi:[1,0,1]
  v_pk_fma_f32 v[166:167], v[166:167], v[26:27], v[154:155] op_sel_hi:[1,0,1]
  v_pk_fma_f32 v[180:181], v[180:181], v[26:27], v[156:157] op_sel_hi:[1,0,1]
  v_pk_fma_f32 v[182:183], v[182:183], v[26:27], v[158:159] op_sel_hi:[1,0,1]
  v_cvt_pk_bf16_f32 v164, v164, v165
  v_cvt_pk_bf16_f32 v165, v166, v167
  v_cvt_pk_bf16_f32 v166, v180, v181
  v_cvt_pk_bf16_f32 v167, v182, v183
  ds_write_b128 v61, v[164:167] offset:256
  v_pk_mul_f32 v[152:153], v[32:33], v[28:29] op_sel:[0,1] op_sel_hi:[1,1]
  v_pk_mul_f32 v[154:155], v[34:35], v[28:29] op_sel:[0,1] op_sel_hi:[1,1]
  v_pk_mul_f32 v[156:157], v[36:37], v[28:29] op_sel:[0,1] op_sel_hi:[1,1]
  v_pk_mul_f32 v[158:159], v[38:39], v[28:29] op_sel:[0,1] op_sel_hi:[1,1]
  v_pk_fma_f32 v[168:169], v[168:169], v[28:29], v[152:153] op_sel_hi:[1,0,1]
  v_pk_fma_f32 v[170:171], v[170:171], v[28:29], v[154:155] op_sel_hi:[1,0,1]
  v_pk_fma_f32 v[184:185], v[184:185], v[28:29], v[156:157] op_sel_hi:[1,0,1]
  v_pk_fma_f32 v[186:187], v[186:187], v[28:29], v[158:159] op_sel_hi:[1,0,1]
  v_cvt_pk_bf16_f32 v168, v168, v169
  v_cvt_pk_bf16_f32 v169, v170, v171
  v_cvt_pk_bf16_f32 v170, v184, v185
  v_cvt_pk_bf16_f32 v171, v186, v187
  ds_write_b128 v61, v[168:171] offset:2048
  v_pk_mul_f32 v[152:153], v[32:33], v[30:31] op_sel:[0,1] op_sel_hi:[1,1]
  v_pk_mul_f32 v[154:155], v[34:35], v[30:31] op_sel:[0,1] op_sel_hi:[1,1]
  v_pk_mul_f32 v[156:157], v[36:37], v[30:31] op_sel:[0,1] op_sel_hi:[1,1]
  v_pk_mul_f32 v[158:159], v[38:39], v[30:31] op_sel:[0,1] op_sel_hi:[1,1]
  v_pk_fma_f32 v[172:173], v[172:173], v[30:31], v[152:153] op_sel_hi:[1,0,1]
  v_pk_fma_f32 v[174:175], v[174:175], v[30:31], v[154:155] op_sel_hi:[1,0,1]
  v_pk_fma_f32 v[188:189], v[188:189], v[30:31], v[156:157] op_sel_hi:[1,0,1]
  v_pk_fma_f32 v[190:191], v[190:191], v[30:31], v[158:159] op_sel_hi:[1,0,1]
  v_cvt_pk_bf16_f32 v172, v172, v173
  v_cvt_pk_bf16_f32 v173, v174, v175
  v_cvt_pk_bf16_f32 v174, v188, v189
  v_cvt_pk_bf16_f32 v175, v190, v191
  ds_write_b128 v61, v[172:175] offset:2304
  s_branch .g2_kernel_q_kd
.g2_kernel_r2:
  buffer_load_dwordx4 v[240:243], v22, s[4:7], s13 offen offset:0
  buffer_load_dwordx4 v[244:247], v22, s[4:7], s13 offen offset:512
  buffer_load_dwordx4 v[248:251], v22, s[4:7], s13 offen offset:1024
  buffer_load_dwordx4 v[252:255], v22, s[4:7], s13 offen offset:1536
  s_branch .g2_kernel_r3
.g2_kernel_a_t1c:
  s_call_b64 s[68:69], .g2_kernel_a_pick
  s_branch .g2_kernel_a_t1b
.g2_kernel_a_t2c:
  s_call_b64 s[68:69], .g2_kernel_a_pick
  s_branch .g2_kernel_a_t2b
.g2_kernel_a_t3c:
  s_call_b64 s[68:69], .g2_kernel_a_pick
  s_branch .g2_kernel_a_t3b
.g2_kernel_a_three:
  s_andn2_b32 s33, s36, s34
  s_cbranch_scc0 .g2_kernel_a_t1c
.g2_kernel_a_t1b:
  s_ff1_i32_b32 s33, s33
  s_bitset1_b32 s34, s33
  s_xor_b32 s33, s33, s24
  s_lshl_b32 s33, s33, s25
  s_add_u32 s22, s20, s33
  s_addc_u32 s23, s21, 0
  global_load_dwordx4 v[192:195], v3, s[22:23] offset:0
  global_load_dwordx4 v[196:199], v3, s[22:23] offset:1024
  global_load_dwordx4 v[200:203], v3, s[22:23] offset:2048
  global_load_dwordx4 v[204:207], v3, s[22:23] offset:3072
  s_andn2_b32 s33, s36, s34
  s_cbranch_scc0 .g2_kernel_a_t2c
.g2_kernel_a_t2b:
  s_ff1_i32_b32 s33, s33
  s_bitset1_b32 s34, s33
  s_xor_b32 s33, s33, s24
  s_lshl_b32 s33, s33, s25
  s_add_u32 s22, s20, s33
  s_addc_u32 s23, s21, 0
  global_load_dwordx4 v[208:211], v3, s[22:23] offset:0
  global_load_dwordx4 v[212:215], v3, s[22:23] offset:1024
  global_load_dwordx4 v[216:219], v3, s[22:23] offset:2048
  global_load_dwordx4 v[220:223], v3, s[22:23] offset:3072
  s_andn2_b32 s33, s36, s34
  s_cbranch_scc0 .g2_kernel_a_t3c
.g2_kernel_a_t3b:
  s_ff1_i32_b32 s33, s33
  s_bitset1_b32 s34, s33
  s_xor_b32 s33, s33, s24
  s_lshl_b32 s33, s33, s25
  s_add_u32 s22, s20, s33
  s_addc_u32 s23, s21, 0
  global_load_dwordx4 v[224:227], v3, s[22:23] offset:0
  global_load_dwordx4 v[228:231], v3, s[22:23] offset:1024
  global_load_dwordx4 v[232:235], v3, s[22:23] offset:2048
  global_load_dwordx4 v[236:239], v3, s[22:23] offset:3072
  s_setpc_b64 s[72:73]
.g2_kernel_a_o0c:
  s_call_b64 s[68:69], .g2_kernel_a_pick
  s_branch .g2_kernel_a_o0b
.g2_kernel_a_o1c:
  s_call_b64 s[68:69], .g2_kernel_a_pick
  s_branch .g2_kernel_a_o1b
.g2_kernel_a_o2c:
  s_call_b64 s[68:69], .g2_kernel_a_pick
  s_branch .g2_kernel_a_o2b
.g2_kernel_a_o3c:
  s_call_b64 s[68:69], .g2_kernel_a_pick
  s_branch .g2_kernel_a_o3b
.g2_kernel_a_r0c:
  s_call_b64 s[68:69], .g2_kernel_a_pick
  s_branch .g2_kernel_a_r0b
.g2_kernel_a_r1c:
  s_call_b64 s[68:69], .g2_kernel_a_pick
  s_branch .g2_kernel_a_r1b
.g2_kernel_a_r2c:
  s_call_b64 s[68:69], .g2_kernel_a_pick
  s_branch .g2_kernel_a_r2b
.g2_kernel_a_own:
  s_waitcnt lgkmcnt(0)
  s_mov_b32 s14, 0
  s_andn2_b32 s33, s36, s34
  s_cbranch_scc0 .g2_kernel_a_o0c
.g2_kernel_a_o0b:
  s_ff1_i32_b32 s33, s33
  s_bitset1_b32 s34, s33
  s_lshl_b32 s28, s33, 0
  s_or_b32 s14, s14, s28
  s_xor_b32 s33, s33, s24
  s_lshl_b32 s33, s33, s25
  s_add_u32 s22, s20, s33
  s_addc_u32 s23, s21, 0
  global_load_dwordx4 v[176:179], v3, s[22:23] offset:0
  global_load_dwordx4 v[180:183], v3, s[22:23] offset:1024
  global_load_dwordx4 v[184:187], v3, s[22:23] offset:2048
  global_load_dwordx4 v[188:191], v3, s[22:23] offset:3072
  s_andn2_b32 s33, s36, s34
  s_cbranch_scc0 .g2_kernel_a_o1c
.g2_kernel_a_o1b:
  s_ff1_i32_b32 s33, s33
  s_bitset1_b32 s34, s33
  s_lshl_b32 s28, s33, 8
  s_or_b32 s14, s14, s28
  s_xor_b32 s33, s33, s24
  s_lshl_b32 s33, s33, s25
  s_add_u32 s22, s20, s33
  s_addc_u32 s23, s21, 0
  global_load_dwordx4 v[192:195], v3, s[22:23] offset:0
  global_load_dwordx4 v[196:199], v3, s[22:23] offset:1024
  global_load_dwordx4 v[200:203], v3, s[22:23] offset:2048
  global_load_dwordx4 v[204:207], v3, s[22:23] offset:3072
  s_andn2_b32 s33, s36, s34
  s_cbranch_scc0 .g2_kernel_a_o2c
.g2_kernel_a_o2b:
  s_ff1_i32_b32 s33, s33
  s_bitset1_b32 s34, s33
  s_lshl_b32 s28, s33, 16
  s_or_b32 s14, s14, s28
  s_xor_b32 s33, s33, s24
  s_lshl_b32 s33, s33, s25
  s_add_u32 s22, s20, s33
  s_addc_u32 s23, s21, 0
  global_load_dwordx4 v[208:211], v3, s[22:23] offset:0
  global_load_dwordx4 v[212:215], v3, s[22:23] offset:1024
  global_load_dwordx4 v[216:219], v3, s[22:23] offset:2048
  global_load_dwordx4 v[220:223], v3, s[22:23] offset:3072
  s_andn2_b32 s33, s36, s34
  s_cbranch_scc0 .g2_kernel_a_o3c
.g2_kernel_a_o3b:
  s_ff1_i32_b32 s33, s33
  s_bitset1_b32 s34, s33
  s_lshl_b32 s28, s33, 24
  s_or_b32 s14, s14, s28
  s_xor_b32 s33, s33, s24
  s_lshl_b32 s33, s33, s25
  s_add_u32 s22, s20, s33
  s_addc_u32 s23, s21, 0
  global_load_dwordx4 v[224:227], v3, s[22:23] offset:0
  global_load_dwordx4 v[228:231], v3, s[22:23] offset:1024
  global_load_dwordx4 v[232:235], v3, s[22:23] offset:2048
  global_load_dwordx4 v[236:239], v3, s[22:23] offset:3072
  s_and_b32 s15, s34, -2
  s_mov_b32 s34, -1
  s_mov_b32 s26, -1
  s_waitcnt vmcnt(12)
  s_branch .g2_kernel_a_ob
.g2_kernel_a_redo:
  v_mfma_f32_32x32x16_bf16 v[104:119], v[236:239], v[172:175], v[104:119]
  v_smfmac_f32_16x16x64_bf16 v[132:135], v[16:19], v[168:175], v20
  v_mov_b32 v6, s71
  s_mov_b32 s38, 0
.g2_kernel_wg5:
  ds_read_b32 v7, v6 offset:60
  s_add_u32 s38, s38, 1
  s_waitcnt lgkmcnt(0)
  v_cmp_gt_u32 vcc, 1, v7
  s_cbranch_vccz .g2_kernel_wg5d
  s_sleep 1
  s_cmp_lt_u32 s38, 524288
  s_cbranch_scc1 .g2_kernel_wg5
.g2_kernel_wg5d:
  ds_read_b32 v7, v8
  s_mov_b32 s34, s15
  s_mov_b32 s26, 0
  s_waitcnt lgkmcnt(0)
  v_cmp_lt_u32 vcc, s62, v7
  s_mov_b32 s36, vcc_lo
  s_sub_u32 s28, s35, 1
  s_bfe_u32 s28, s28, 0x20005
  s_mov_b32 s35, 0
  s_waitcnt vmcnt(0)
  s_cmp_lg_u32 s28, 0
  s_cbranch_scc1 .g2_kernel_a_rd1
  ds_read_b128 v[24:27], v14 offset:8192
  ds_read_b128 v[28:31], v14 offset:9216
  v_mov_b32 v120, 0
  v_mov_b32 v121, 0
  s_waitcnt lgkmcnt(0)
  v_mfma_f32_32x32x16_bf16 v[136:151], v[176:179], v[24:27], 0
  v_mfma_f32_32x32x16_bf16 v[136:151], v[180:183], v[28:31], v[136:151]
  v_mfma_f32_32x32x16_bf16 v[152:167], v[192:195], v[24:27], 0
  s_nop 10
  v_exp_f32 v136, v136
  v_exp_f32 v137, v137
  v_exp_f32 v138, v138
  v_exp_f32 v139, v139
  v_exp_f32 v140, v140
  v_exp_f32 v141, v141
  v_exp_f32 v142, v142
  v_exp_f32 v143, v143
  v_mfma_f32_32x32x16_bf16 v[152:167], v[196:199], v[28:31], v[152:167]
  v_cvt_pk_bf16_f32 v168, v136, v137
  v_cvt_pk_bf16_f32 v169, v138, v139
  v_cvt_pk_bf16_f32 v170, v140, v141
  v_cvt_pk_bf16_f32 v171, v142, v143
  v_exp_f32 v144, v144
  v_exp_f32 v145, v145
  v_exp_f32 v146, v146
  v_exp_f32 v147, v147
  v_mfma_f32_32x32x16_bf16 v[56:71], v[184:187], v[168:171], 0
  v_exp_f32 v148, v148
  v_exp_f32 v149, v149
  v_exp_f32 v150, v150
  v_exp_f32 v151, v151
  v_cvt_pk_bf16_f32 v172, v144, v145
  v_cvt_pk_bf16_f32 v173, v146, v147
  v_cvt_pk_bf16_f32 v174, v148, v149
  v_cvt_pk_bf16_f32 v175, v150, v151
  v_mfma_f32_32x32x16_bf16 v[136:151], v[208:211], v[24:27], 0
  v_exp_f32 v152, v152
  v_exp_f32 v153, v153
  v_exp_f32 v154, v154
  v_mfma_f32_32x32x16_bf16 v[56:71], v[188:191], v[172:175], v[56:71]
  s_call_b64 s[72:73], .g2_kernel_a_ld0
  v_exp_f32 v155, v155
  v_exp_f32 v156, v156
  v_exp_f32 v157, v157
  v_smfmac_f32_16x16x64_bf16 v[120:123], v[16:19], v[168:175], v20
  v_exp_f32 v158, v158
  v_exp_f32 v159, v159
  v_mfma_f32_32x32x16_bf16 v[136:151], v[212:215], v[28:31], v[136:151]
  v_cvt_pk_bf16_f32 v168, v152, v153
  v_cvt_pk_bf16_f32 v169, v154, v155
  v_cvt_pk_bf16_f32 v170, v156, v157
  v_cvt_pk_bf16_f32 v171, v158, v159
  v_exp_f32 v160, v160
  v_exp_f32 v161, v161
  v_exp_f32 v162, v162
  v_exp_f32 v163, v163
  v_mfma_f32_32x32x16_bf16 v[56:71], v[200:203], v[168:171], v[56:71]
  v_exp_f32 v164, v164
  v_exp_f32 v165, v165
  v_exp_f32 v166, v166
  v_exp_f32 v167, v167
  v_cvt_pk_bf16_f32 v172, v160, v161
  v_cvt_pk_bf16_f32 v173, v162, v163
  v_cvt_pk_bf16_f32 v174, v164, v165
  v_cvt_pk_bf16_f32 v175, v166, v167
  v_mfma_f32_32x32x16_bf16 v[152:167], v[224:227], v[24:27], 0
  v_exp_f32 v136, v136
  v_exp_f32 v137, v137
  v_exp_f32 v138, v138
  v_mfma_f32_32x32x16_bf16 v[56:71], v[204:207], v[172:175], v[56:71]
  s_call_b64 s[72:73], .g2_kernel_a_ld1
  v_exp_f32 v139, v139
  v_exp_f32 v140, v140
  v_exp_f32 v141, v141
  v_smfmac_f32_16x16x64_bf16 v[120:123], v[16:19], v[168:175], v20
  v_exp_f32 v142, v142
  v_exp_f32 v143, v143
  v_mfma_f32_32x32x16_bf16 v[152:167], v[228:231], v[28:31], v[152:167]
  v_cvt_pk_bf16_f32 v168, v136, v137
  v_cvt_pk_bf16_f32 v169, v138, v139
  v_cvt_pk_bf16_f32 v170, v140, v141
  v_cvt_pk_bf16_f32 v171, v142, v143
  v_exp_f32 v144, v144
  v_exp_f32 v145, v145
  v_exp_f32 v146, v146
  v_exp_f32 v147, v147
  v_mfma_f32_32x32x16_bf16 v[56:71], v[216:219], v[168:171], v[56:71]
  v_exp_f32 v148, v148
  v_exp_f32 v149, v149
  v_exp_f32 v150, v150
  v_exp_f32 v151, v151
  v_cvt_pk_bf16_f32 v172, v144, v145
  v_cvt_pk_bf16_f32 v173, v146, v147
  v_cvt_pk_bf16_f32 v174, v148, v149
  v_cvt_pk_bf16_f32 v175, v150, v151
  v_exp_f32 v152, v152
  v_exp_f32 v153, v153
  v_exp_f32 v154, v154
  v_mfma_f32_32x32x16_bf16 v[56:71], v[220:223], v[172:175], v[56:71]
  s_call_b64 s[72:73], .g2_kernel_a_ld2
  v_exp_f32 v155, v155
  v_exp_f32 v156, v156
  v_exp_f32 v157, v157
  v_smfmac_f32_16x16x64_bf16 v[120:123], v[16:19], v[168:175], v20
  v_exp_f32 v158, v158
  v_exp_f32 v159, v159
  v_cvt_pk_bf16_f32 v168, v152, v153
  v_cvt_pk_bf16_f32 v169, v154, v155
  v_cvt_pk_bf16_f32 v170, v156, v157
  v_cvt_pk_bf16_f32 v171, v158, v159
  v_exp_f32 v160, v160
  v_exp_f32 v161, v161
  v_exp_f32 v162, v162
  v_exp_f32 v163, v163
  v_mfma_f32_32x32x16_bf16 v[56:71], v[232:235], v[168:171], v[56:71]
  v_exp_f32 v164, v164
  v_exp_f32 v165, v165
  v_exp_f32 v166, v166
  v_exp_f32 v167, v167
  v_cvt_pk_bf16_f32 v172, v160, v161
  v_cvt_pk_bf16_f32 v173, v162, v163
  v_cvt_pk_bf16_f32 v174, v164, v165
  v_cvt_pk_bf16_f32 v175, v166, v167
  s_nop 1
  v_mfma_f32_32x32x16_bf16 v[56:71], v[236:239], v[172:175], v[56:71]
  v_smfmac_f32_16x16x64_bf16 v[120:123], v[16:19], v[168:175], v20
  s_branch .g2_kernel_a_rde
.g2_kernel_a_rd1:
  s_cmp_lg_u32 s28, 1
  s_cbranch_scc1 .g2_kernel_a_rd2
  ds_read_b128 v[32:35], v14 offset:10240
  ds_read_b128 v[36:39], v14 offset:11264
  v_mov_b32 v124, 0
  v_mov_b32 v125, 0
  s_waitcnt lgkmcnt(0)
  v_mfma_f32_32x32x16_bf16 v[136:151], v[176:179], v[32:35], 0
  v_mfma_f32_32x32x16_bf16 v[136:151], v[180:183], v[36:39], v[136:151]
  v_mfma_f32_32x32x16_bf16 v[152:167], v[192:195], v[32:35], 0
  s_nop 10
  v_exp_f32 v136, v136
  v_exp_f32 v137, v137
  v_exp_f32 v138, v138
  v_exp_f32 v139, v139
  v_exp_f32 v140, v140
  v_exp_f32 v141, v141
  v_exp_f32 v142, v142
  v_exp_f32 v143, v143
  v_mfma_f32_32x32x16_bf16 v[152:167], v[196:199], v[36:39], v[152:167]
  v_cvt_pk_bf16_f32 v168, v136, v137
  v_cvt_pk_bf16_f32 v169, v138, v139
  v_cvt_pk_bf16_f32 v170, v140, v141
  v_cvt_pk_bf16_f32 v171, v142, v143
  v_exp_f32 v144, v144
  v_exp_f32 v145, v145
  v_exp_f32 v146, v146
  v_exp_f32 v147, v147
  v_mfma_f32_32x32x16_bf16 v[72:87], v[184:187], v[168:171], 0
  v_exp_f32 v148, v148
  v_exp_f32 v149, v149
  v_exp_f32 v150, v150
  v_exp_f32 v151, v151
  v_cvt_pk_bf16_f32 v172, v144, v145
  v_cvt_pk_bf16_f32 v173, v146, v147
  v_cvt_pk_bf16_f32 v174, v148, v149
  v_cvt_pk_bf16_f32 v175, v150, v151
  v_mfma_f32_32x32x16_bf16 v[136:151], v[208:211], v[32:35], 0
  v_exp_f32 v152, v152
  v_exp_f32 v153, v153
  v_exp_f32 v154, v154
  v_mfma_f32_32x32x16_bf16 v[72:87], v[188:191], v[172:175], v[72:87]
  s_call_b64 s[72:73], .g2_kernel_a_ld0
  v_exp_f32 v155, v155
  v_exp_f32 v156, v156
  v_exp_f32 v157, v157
  v_smfmac_f32_16x16x64_bf16 v[124:127], v[16:19], v[168:175], v20
  v_exp_f32 v158, v158
  v_exp_f32 v159, v159
  v_mfma_f32_32x32x16_bf16 v[136:151], v[212:215], v[36:39], v[136:151]
  v_cvt_pk_bf16_f32 v168, v152, v153
  v_cvt_pk_bf16_f32 v169, v154, v155
  v_cvt_pk_bf16_f32 v170, v156, v157
  v_cvt_pk_bf16_f32 v171, v158, v159
  v_exp_f32 v160, v160
  v_exp_f32 v161, v161
  v_exp_f32 v162, v162
  v_exp_f32 v163, v163
  v_mfma_f32_32x32x16_bf16 v[72:87], v[200:203], v[168:171], v[72:87]
  v_exp_f32 v164, v164
  v_exp_f32 v165, v165
  v_exp_f32 v166, v166
  v_exp_f32 v167, v167
  v_cvt_pk_bf16_f32 v172, v160, v161
  v_cvt_pk_bf16_f32 v173, v162, v163
  v_cvt_pk_bf16_f32 v174, v164, v165
  v_cvt_pk_bf16_f32 v175, v166, v167
  v_mfma_f32_32x32x16_bf16 v[152:167], v[224:227], v[32:35], 0
  v_exp_f32 v136, v136
  v_exp_f32 v137, v137
  v_exp_f32 v138, v138
  v_mfma_f32_32x32x16_bf16 v[72:87], v[204:207], v[172:175], v[72:87]
  s_call_b64 s[72:73], .g2_kernel_a_ld1
  v_exp_f32 v139, v139
  v_exp_f32 v140, v140
  v_exp_f32 v141, v141
  v_smfmac_f32_16x16x64_bf16 v[124:127], v[16:19], v[168:175], v20
  v_exp_f32 v142, v142
  v_exp_f32 v143, v143
  v_mfma_f32_32x32x16_bf16 v[152:167], v[228:231], v[36:39], v[152:167]
  v_cvt_pk_bf16_f32 v168, v136, v137
  v_cvt_pk_bf16_f32 v169, v138, v139
  v_cvt_pk_bf16_f32 v170, v140, v141
  v_cvt_pk_bf16_f32 v171, v142, v143
  v_exp_f32 v144, v144
  v_exp_f32 v145, v145
  v_exp_f32 v146, v146
  v_exp_f32 v147, v147
  v_mfma_f32_32x32x16_bf16 v[72:87], v[216:219], v[168:171], v[72:87]
  v_exp_f32 v148, v148
  v_exp_f32 v149, v149
  v_exp_f32 v150, v150
  v_exp_f32 v151, v151
  v_cvt_pk_bf16_f32 v172, v144, v145
  v_cvt_pk_bf16_f32 v173, v146, v147
  v_cvt_pk_bf16_f32 v174, v148, v149
  v_cvt_pk_bf16_f32 v175, v150, v151
  v_exp_f32 v152, v152
  v_exp_f32 v153, v153
  v_exp_f32 v154, v154
  v_mfma_f32_32x32x16_bf16 v[72:87], v[220:223], v[172:175], v[72:87]
  s_call_b64 s[72:73], .g2_kernel_a_ld2
  v_exp_f32 v155, v155
  v_exp_f32 v156, v156
  v_exp_f32 v157, v157
  v_smfmac_f32_16x16x64_bf16 v[124:127], v[16:19], v[168:175], v20
  v_exp_f32 v158, v158
  v_exp_f32 v159, v159
  v_cvt_pk_bf16_f32 v168, v152, v153
  v_cvt_pk_bf16_f32 v169, v154, v155
  v_cvt_pk_bf16_f32 v170, v156, v157
  v_cvt_pk_bf16_f32 v171, v158, v159
  v_exp_f32 v160, v160
  v_exp_f32 v161, v161
  v_exp_f32 v162, v162
  v_exp_f32 v163, v163
  v_mfma_f32_32x32x16_bf16 v[72:87], v[232:235], v[168:171], v[72:87]
  v_exp_f32 v164, v164
  v_exp_f32 v165, v165
  v_exp_f32 v166, v166
  v_exp_f32 v167, v167
  v_cvt_pk_bf16_f32 v172, v160, v161
  v_cvt_pk_bf16_f32 v173, v162, v163
  v_cvt_pk_bf16_f32 v174, v164, v165
  v_cvt_pk_bf16_f32 v175, v166, v167
  s_nop 1
  v_mfma_f32_32x32x16_bf16 v[72:87], v[236:239], v[172:175], v[72:87]
  v_smfmac_f32_16x16x64_bf16 v[124:127], v[16:19], v[168:175], v20
  s_branch .g2_kernel_a_rde
.g2_kernel_a_rd2:
  s_cmp_lg_u32 s28, 2
  s_cbranch_scc1 .g2_kernel_a_rd3
  ds_read_b128 v[40:43], v14 offset:12288
  ds_read_b128 v[44:47], v14 offset:13312
  v_mov_b32 v128, 0
  v_mov_b32 v129, 0
  s_waitcnt lgkmcnt(0)
  v_mfma_f32_32x32x16_bf16 v[136:151], v[176:179], v[40:43], 0
  v_mfma_f32_32x32x16_bf16 v[136:151], v[180:183], v[44:47], v[136:151]
  v_mfma_f32_32x32x16_bf16 v[152:167], v[192:195], v[40:43], 0
  s_nop 10
  v_exp_f32 v136, v136
  v_exp_f32 v137, v137
  v_exp_f32 v138, v138
  v_exp_f32 v139, v139
  v_exp_f32 v140, v140
  v_exp_f32 v141, v141
  v_exp_f32 v142, v142
  v_exp_f32 v143, v143
  v_mfma_f32_32x32x16_bf16 v[152:167], v[196:199], v[44:47], v[152:167]
  v_cvt_pk_bf16_f32 v168, v136, v137
  v_cvt_pk_bf16_f32 v169, v138, v139
  v_cvt_pk_bf16_f32 v170, v140, v141
  v_cvt_pk_bf16_f32 v171, v142, v143
  v_exp_f32 v144, v144
  v_exp_f32 v145, v145
  v_exp_f32 v146, v146
  v_exp_f32 v147, v147
  v_mfma_f32_32x32x16_bf16 v[88:103], v[184:187], v[168:171], 0
  v_exp_f32 v148, v148
  v_exp_f32 v149, v149
  v_exp_f32 v150, v150
  v_exp_f32 v151, v151
  v_cvt_pk_bf16_f32 v172, v144, v145
  v_cvt_pk_bf16_f32 v173, v146, v147
  v_cvt_pk_bf16_f32 v174, v148, v149
  v_cvt_pk_bf16_f32 v175, v150, v151
  v_mfma_f32_32x32x16_bf16 v[136:151], v[208:211], v[40:43], 0
  v_exp_f32 v152, v152
  v_exp_f32 v153, v153
  v_exp_f32 v154, v154
  v_mfma_f32_32x32x16_bf16 v[88:103], v[188:191], v[172:175], v[88:103]
  s_call_b64 s[72:73], .g2_kernel_a_ld0
  v_exp_f32 v155, v155
  v_exp_f32 v156, v156
  v_exp_f32 v157, v157
  v_smfmac_f32_16x16x64_bf16 v[128:131], v[16:19], v[168:175], v20
  v_exp_f32 v158, v158
  v_exp_f32 v159, v159
  v_mfma_f32_32x32x16_bf16 v[136:151], v[212:215], v[44:47], v[136:151]
  v_cvt_pk_bf16_f32 v168, v152, v153
  v_cvt_pk_bf16_f32 v169, v154, v155
  v_cvt_pk_bf16_f32 v170, v156, v157
  v_cvt_pk_bf16_f32 v171, v158, v159
  v_exp_f32 v160, v160
  v_exp_f32 v161, v161
  v_exp_f32 v162, v162
  v_exp_f32 v163, v163
  v_mfma_f32_32x32x16_bf16 v[88:103], v[200:203], v[168:171], v[88:103]
  v_exp_f32 v164, v164
  v_exp_f32 v165, v165
  v_exp_f32 v166, v166
  v_exp_f32 v167, v167
  v_cvt_pk_bf16_f32 v172, v160, v161
  v_cvt_pk_bf16_f32 v173, v162, v163
  v_cvt_pk_bf16_f32 v174, v164, v165
  v_cvt_pk_bf16_f32 v175, v166, v167
  v_mfma_f32_32x32x16_bf16 v[152:167], v[224:227], v[40:43], 0
  v_exp_f32 v136, v136
  v_exp_f32 v137, v137
  v_exp_f32 v138, v138
  v_mfma_f32_32x32x16_bf16 v[88:103], v[204:207], v[172:175], v[88:103]
  s_call_b64 s[72:73], .g2_kernel_a_ld1
  v_exp_f32 v139, v139
  v_exp_f32 v140, v140
  v_exp_f32 v141, v141
  v_smfmac_f32_16x16x64_bf16 v[128:131], v[16:19], v[168:175], v20
  v_exp_f32 v142, v142
  v_exp_f32 v143, v143
  v_mfma_f32_32x32x16_bf16 v[152:167], v[228:231], v[44:47], v[152:167]
  v_cvt_pk_bf16_f32 v168, v136, v137
  v_cvt_pk_bf16_f32 v169, v138, v139
  v_cvt_pk_bf16_f32 v170, v140, v141
  v_cvt_pk_bf16_f32 v171, v142, v143
  v_exp_f32 v144, v144
  v_exp_f32 v145, v145
  v_exp_f32 v146, v146
  v_exp_f32 v147, v147
  v_mfma_f32_32x32x16_bf16 v[88:103], v[216:219], v[168:171], v[88:103]
  v_exp_f32 v148, v148
  v_exp_f32 v149, v149
  v_exp_f32 v150, v150
  v_exp_f32 v151, v151
  v_cvt_pk_bf16_f32 v172, v144, v145
  v_cvt_pk_bf16_f32 v173, v146, v147
  v_cvt_pk_bf16_f32 v174, v148, v149
  v_cvt_pk_bf16_f32 v175, v150, v151
  v_exp_f32 v152, v152
  v_exp_f32 v153, v153
  v_exp_f32 v154, v154
  v_mfma_f32_32x32x16_bf16 v[88:103], v[220:223], v[172:175], v[88:103]
  s_call_b64 s[72:73], .g2_kernel_a_ld2
  v_exp_f32 v155, v155
  v_exp_f32 v156, v156
  v_exp_f32 v157, v157
  v_smfmac_f32_16x16x64_bf16 v[128:131], v[16:19], v[168:175], v20
  v_exp_f32 v158, v158
  v_exp_f32 v159, v159
  v_cvt_pk_bf16_f32 v168, v152, v153
  v_cvt_pk_bf16_f32 v169, v154, v155
  v_cvt_pk_bf16_f32 v170, v156, v157
  v_cvt_pk_bf16_f32 v171, v158, v159
  v_exp_f32 v160, v160
  v_exp_f32 v161, v161
  v_exp_f32 v162, v162
  v_exp_f32 v163, v163
  v_mfma_f32_32x32x16_bf16 v[88:103], v[232:235], v[168:171], v[88:103]
  v_exp_f32 v164, v164
  v_exp_f32 v165, v165
  v_exp_f32 v166, v166
  v_exp_f32 v167, v167
  v_cvt_pk_bf16_f32 v172, v160, v161
  v_cvt_pk_bf16_f32 v173, v162, v163
  v_cvt_pk_bf16_f32 v174, v164, v165
  v_cvt_pk_bf16_f32 v175, v166, v167
  s_nop 1
  v_mfma_f32_32x32x16_bf16 v[88:103], v[236:239], v[172:175], v[88:103]
  v_smfmac_f32_16x16x64_bf16 v[128:131], v[16:19], v[168:175], v20
  s_branch .g2_kernel_a_rde
.g2_kernel_a_rd3:
  ds_read_b128 v[48:51], v14 offset:14336
  ds_read_b128 v[52:55], v14 offset:15360
  v_mov_b32 v132, 0
  v_mov_b32 v133, 0
  s_waitcnt lgkmcnt(0)
  v_mfma_f32_32x32x16_bf16 v[136:151], v[176:179], v[48:51], 0
  v_mfma_f32_32x32x16_bf16 v[136:151], v[180:183], v[52:55], v[136:151]
  v_mfma_f32_32x32x16_bf16 v[152:167], v[192:195], v[48:51], 0
  s_nop 10
  v_exp_f32 v136, v136
  v_exp_f32 v137, v137
  v_exp_f32 v138, v138
  v_exp_f32 v139, v139
  v_exp_f32 v140, v140
  v_exp_f32 v141, v141
  v_exp_f32 v142, v142
  v_exp_f32 v143, v143
  v_mfma_f32_32x32x16_bf16 v[152:167], v[196:199], v[52:55], v[152:167]
  v_cvt_pk_bf16_f32 v168, v136, v137
  v_cvt_pk_bf16_f32 v169, v138, v139
  v_cvt_pk_bf16_f32 v170, v140, v141
  v_cvt_pk_bf16_f32 v171, v142, v143
  v_exp_f32 v144, v144
  v_exp_f32 v145, v145
  v_exp_f32 v146, v146
  v_exp_f32 v147, v147
  v_mfma_f32_32x32x16_bf16 v[104:119], v[184:187], v[168:171], 0
  v_exp_f32 v148, v148
  v_exp_f32 v149, v149
  v_exp_f32 v150, v150
  v_exp_f32 v151, v151
  v_cvt_pk_bf16_f32 v172, v144, v145
  v_cvt_pk_bf16_f32 v173, v146, v147
  v_cvt_pk_bf16_f32 v174, v148, v149
  v_cvt_pk_bf16_f32 v175, v150, v151
  v_mfma_f32_32x32x16_bf16 v[136:151], v[208:211], v[48:51], 0
  v_exp_f32 v152, v152
  v_exp_f32 v153, v153
  v_exp_f32 v154, v154
  v_mfma_f32_32x32x16_bf16 v[104:119], v[188:191], v[172:175], v[104:119]
  s_call_b64 s[72:73], .g2_kernel_a_ld0
  v_exp_f32 v155, v155
  v_exp_f32 v156, v156
  v_exp_f32 v157, v157
  v_smfmac_f32_16x16x64_bf16 v[132:135], v[16:19], v[168:175], v20
  v_exp_f32 v158, v158
  v_exp_f32 v159, v159
  v_mfma_f32_32x32x16_bf16 v[136:151], v[212:215], v[52:55], v[136:151]
  v_cvt_pk_bf16_f32 v168, v152, v153
  v_cvt_pk_bf16_f32 v169, v154, v155
  v_cvt_pk_bf16_f32 v170, v156, v157
  v_cvt_pk_bf16_f32 v171, v158, v159
  v_exp_f32 v160, v160
  v_exp_f32 v161, v161
  v_exp_f32 v162, v162
  v_exp_f32 v163, v163
  v_mfma_f32_32x32x16_bf16 v[104:119], v[200:203], v[168:171], v[104:119]
  v_exp_f32 v164, v164
  v_exp_f32 v165, v165
  v_exp_f32 v166, v166
  v_exp_f32 v167, v167
  v_cvt_pk_bf16_f32 v172, v160, v161
  v_cvt_pk_bf16_f32 v173, v162, v163
  v_cvt_pk_bf16_f32 v174, v164, v165
  v_cvt_pk_bf16_f32 v175, v166, v167
  v_mfma_f32_32x32x16_bf16 v[152:167], v[224:227], v[48:51], 0
  v_exp_f32 v136, v136
  v_exp_f32 v137, v137
  v_exp_f32 v138, v138
  v_mfma_f32_32x32x16_bf16 v[104:119], v[204:207], v[172:175], v[104:119]
  s_call_b64 s[72:73], .g2_kernel_a_ld1
  v_exp_f32 v139, v139
  v_exp_f32 v140, v140
  v_exp_f32 v141, v141
  v_smfmac_f32_16x16x64_bf16 v[132:135], v[16:19], v[168:175], v20
  v_exp_f32 v142, v142
  v_exp_f32 v143, v143
  v_mfma_f32_32x32x16_bf16 v[152:167], v[228:231], v[52:55], v[152:167]
  v_cvt_pk_bf16_f32 v168, v136, v137
  v_cvt_pk_bf16_f32 v169, v138, v139
  v_cvt_pk_bf16_f32 v170, v140, v141
  v_cvt_pk_bf16_f32 v171, v142, v143
  v_exp_f32 v144, v144
  v_exp_f32 v145, v145
  v_exp_f32 v146, v146
  v_exp_f32 v147, v147
  v_mfma_f32_32x32x16_bf16 v[104:119], v[216:219], v[168:171], v[104:119]
  v_exp_f32 v148, v148
  v_exp_f32 v149, v149
  v_exp_f32 v150, v150
  v_exp_f32 v151, v151
  v_cvt_pk_bf16_f32 v172, v144, v145
  v_cvt_pk_bf16_f32 v173, v146, v147
  v_cvt_pk_bf16_f32 v174, v148, v149
  v_cvt_pk_bf16_f32 v175, v150, v151
  v_exp_f32 v152, v152
  v_exp_f32 v153, v153
  v_exp_f32 v154, v154
  v_mfma_f32_32x32x16_bf16 v[104:119], v[220:223], v[172:175], v[104:119]
  s_call_b64 s[72:73], .g2_kernel_a_ld2
  v_exp_f32 v155, v155
  v_exp_f32 v156, v156
  v_exp_f32 v157, v157
  v_smfmac_f32_16x16x64_bf16 v[132:135], v[16:19], v[168:175], v20
  v_exp_f32 v158, v158
  v_exp_f32 v159, v159
  v_cvt_pk_bf16_f32 v168, v152, v153
  v_cvt_pk_bf16_f32 v169, v154, v155
  v_cvt_pk_bf16_f32 v170, v156, v157
  v_cvt_pk_bf16_f32 v171, v158, v159
  v_exp_f32 v160, v160
  v_exp_f32 v161, v161
  v_exp_f32 v162, v162
  v_exp_f32 v163, v163
  v_mfma_f32_32x32x16_bf16 v[104:119], v[232:235], v[168:171], v[104:119]
  v_exp_f32 v164, v164
  v_exp_f32 v165, v165
  v_exp_f32 v166, v166
  v_exp_f32 v167, v167
  v_cvt_pk_bf16_f32 v172, v160, v161
  v_cvt_pk_bf16_f32 v173, v162, v163
  v_cvt_pk_bf16_f32 v174, v164, v165
  v_cvt_pk_bf16_f32 v175, v166, v167
  s_nop 1
  v_mfma_f32_32x32x16_bf16 v[104:119], v[236:239], v[172:175], v[104:119]
  v_smfmac_f32_16x16x64_bf16 v[132:135], v[16:19], v[168:175], v20
  s_branch .g2_kernel_a_rde
.g2_kernel_a_rd4:
.g2_kernel_a_rde:
  v_mov_b32 v168, 0
  v_mov_b32 v169, 0
  v_mov_b32 v170, 0
  v_mov_b32 v171, 0
  v_mov_b32 v172, 0
  v_mov_b32 v173, 0
  v_mov_b32 v174, 0
  v_mov_b32 v175, 0
  s_waitcnt vmcnt(8)
  v_mfma_f32_32x32x16_bf16 v[136:151], v[176:179], v[24:27], 0
  v_mfma_f32_32x32x16_bf16 v[136:151], v[180:183], v[28:31], v[136:151]
  v_mfma_f32_32x32x16_bf16 v[152:167], v[176:179], v[32:35], 0
  s_nop 10
  s_branch .g2_kernel_a_loop
.g2_kernel_a_ld0:
  s_andn2_b32 s33, s36, s34
  s_cbranch_scc0 .g2_kernel_a_r0c
.g2_kernel_a_r0b:
  s_ff1_i32_b32 s33, s33
  s_bitset1_b32 s34, s33
  s_xor_b32 s33, s33, s24
  s_lshl_b32 s33, s33, s25
  s_add_u32 s22, s20, s33
  s_addc_u32 s23, s21, 0
  global_load_dwordx4 v[176:179], v3, s[22:23] offset:0
  global_load_dwordx4 v[180:183], v3, s[22:23] offset:1024
  global_load_dwordx4 v[184:187], v3, s[22:23] offset:2048
  global_load_dwordx4 v[188:191], v3, s[22:23] offset:3072
  s_setpc_b64 s[72:73]
.g2_kernel_a_ld1:
  s_andn2_b32 s33, s36, s34
  s_cbranch_scc0 .g2_kernel_a_r1c
.g2_kernel_a_r1b:
  s_ff1_i32_b32 s33, s33
  s_bitset1_b32 s34, s33
  s_xor_b32 s33, s33, s24
  s_lshl_b32 s33, s33, s25
  s_add_u32 s22, s20, s33
  s_addc_u32 s23, s21, 0
  global_load_dwordx4 v[192:195], v3, s[22:23] offset:0
  global_load_dwordx4 v[196:199], v3, s[22:23] offset:1024
  global_load_dwordx4 v[200:203], v3, s[22:23] offset:2048
  global_load_dwordx4 v[204:207], v3, s[22:23] offset:3072
  s_setpc_b64 s[72:73]
.g2_kernel_a_ld2:
  s_andn2_b32 s33, s36, s34
  s_cbranch_scc0 .g2_kernel_a_r2c
.g2_kernel_a_r2b:
  s_ff1_i32_b32 s33, s33
  s_bitset1_b32 s34, s33
  s_xor_b32 s33, s33, s24
  s_lshl_b32 s33, s33, s25
  s_add_u32 s22, s20, s33
  s_addc_u32 s23, s21, 0
  global_load_dwordx4 v[208:211], v3, s[22:23] offset:0
  global_load_dwordx4 v[212:215], v3, s[22:23] offset:1024
  global_load_dwordx4 v[216:219], v3, s[22:23] offset:2048
  global_load_dwordx4 v[220:223], v3, s[22:23] offset:3072
  s_setpc_b64 s[72:73]
.g2_kernel_a_N0c:
  s_call_b64 s[68:69], .g2_kernel_a_pick
  s_branch .g2_kernel_a_N0b
.g2_kernel_a_N1c:
  s_call_b64 s[68:69], .g2_kernel_a_pick
  s_branch .g2_kernel_a_N1b
.g2_kernel_a_N2c:
  s_call_b64 s[68:69], .g2_kernel_a_pick
  s_branch .g2_kernel_a_N2b
.g2_kernel_a_N3c:
  s_call_b64 s[68:69], .g2_kernel_a_pick
  s_branch .g2_kernel_a_N3b
.g2_kernel_a_L3c:
  s_call_b64 s[68:69], .g2_kernel_a_pick
  s_branch .g2_kernel_a_L3b
.g2_kernel_a_G0c:
  s_call_b64 s[68:69], .g2_kernel_a_pick
  s_branch .g2_kernel_a_G0b
.g2_kernel_a_L3g:
  s_mov_b32 s38, 0
.g2_kernel_a_L3gl:
  ds_read_b32 v7, v13 offset:8
  s_add_u32 s38, s38, 1
  s_waitcnt lgkmcnt(0)
  v_cmp_gt_u32 vcc, s27, v7
  s_cbranch_vccz .g2_kernel_a_L3h
  s_cmp_lt_u32 s38, 524288
  s_cbranch_scc1 .g2_kernel_a_L3gl
  s_branch .g2_kernel_a_L3h
.g2_kernel_a_hold:
  s_lshl_b32 s33, 1, s14
  s_lshr_b32 s14, s14, 8
  s_setpc_b64 s[68:69]
.g2_kernel_a_pick:
  s_cmp_lg_u32 s34, -1
  s_cbranch_scc1 .g2_kernel_a_pk1
  s_cmp_eq_u32 s26, -1
  s_cbranch_scc1 .g2_kernel_a_hold
  s_add_u32 s26, s26, 1
  s_mov_b32 s34, 0xffff
  s_cmp_eq_u32 s26, 1
  s_cbranch_scc1 .g2_kernel_a_pk0
  v_and_b32 v8, 15, v2
  s_lshl_b32 s28, s16, 6
  s_add_u32 s28, s28, 157696
  v_lshl_add_u32 v8, v8, 2, s28
  s_lshl_b32 s28, s17, 2
  s_add_u32 s28, s28, s16
  s_lshl_b32 s28, s28, 16
  s_add_u32 s28, s28, s63
  s_add_u32 s28, s28, 0x800000
  s_add_u32 s20, s60, s28
  s_addc_u32 s21, s61, 0
  s_lshl_b32 s24, s18, 1
  s_and_b32 s24, s24, 6
  s_mov_b32 s25, 12
  s_mov_b32 s34, 0
  s_mov_b32 s36, 0xff
  s_mov_b32 s33, 0xff
  s_mov_b32 s38, 0
.g2_kernel_a_pk2:
  ds_read_b32 v7, v8
  s_add_u32 s38, s38, 1
  s_waitcnt lgkmcnt(0)
  v_cmp_ge_u32 vcc, s62, v7
  s_cbranch_vccz .g2_kernel_a_pkr
  s_cmp_lt_u32 s38, 524288
  s_cbranch_scc1 .g2_kernel_a_pk2
  s_branch .g2_kernel_a_pkr
.g2_kernel_a_pk0:
  s_andn2_b32 s33, s36, s34
  s_cbranch_scc1 .g2_kernel_a_pkr
.g2_kernel_a_pk1:
  s_mov_b32 s38, 0
.g2_kernel_a_pkl:
  ds_read_b32 v7, v8
  s_add_u32 s38, s38, 1
  s_waitcnt lgkmcnt(0)
  v_cmp_lt_u32 vcc, s62, v7
  s_mov_b32 s36, vcc_lo
  s_andn2_b32 s33, s36, s34
  s_cbranch_scc1 .g2_kernel_a_pkr
  s_cmp_lt_u32 s38, 524288
  s_cbranch_scc1 .g2_kernel_a_pkl
  s_not_b32 s33, s34
.g2_kernel_a_pkr:
  s_setpc_b64 s[68:69]
.g2_kernel_w_aw:
  v_mov_b32 v6, s71
  s_mov_b32 s38, 0
.g2_kernel_wg6:
  ds_read_b32 v7, v6 offset:52
  s_add_u32 s38, s38, 1
  s_waitcnt lgkmcnt(0)
  v_cmp_gt_u32 vcc, 4, v7
  s_cbranch_vccz .g2_kernel_wg6d
  s_sleep 1
  s_cmp_lt_u32 s38, 524288
  s_cbranch_scc1 .g2_kernel_wg6
.g2_kernel_wg6d:
  s_branch .g2_kernel_w_ab
.g2_kernel_w_pt:
  v_lshlrev_b32 v7, 5, v17
  v_add_u32 v7, 155648, v7
  s_mov_b64 exec, vcc
  ds_read_b128 v[240:243], v7 offset:7680
  ds_read_b128 v[244:247], v7 offset:7696
  ds_read_b128 v[248:251], v7 offset:7744
  ds_read_b128 v[252:255], v7 offset:7760
  s_waitcnt lgkmcnt(0)
  v_pk_add_f32 v[24:25], v[24:25], v[240:241]
  v_pk_add_f32 v[26:27], v[26:27], v[242:243]
  v_pk_add_f32 v[28:29], v[28:29], v[244:245]
  v_pk_add_f32 v[30:31], v[30:31], v[246:247]
  v_pk_add_f32 v[32:33], v[32:33], v[248:249]
  v_pk_add_f32 v[34:35], v[34:35], v[250:251]
  v_pk_add_f32 v[36:37], v[36:37], v[252:253]
  v_pk_add_f32 v[38:39], v[38:39], v[254:255]
  ds_read_b128 v[240:243], v7 offset:7808
  ds_read_b128 v[244:247], v7 offset:7824
  ds_read_b128 v[248:251], v7 offset:7872
  ds_read_b128 v[252:255], v7 offset:7888
  s_waitcnt lgkmcnt(0)
  v_pk_add_f32 v[40:41], v[40:41], v[240:241]
  v_pk_add_f32 v[42:43], v[42:43], v[242:243]
  v_pk_add_f32 v[44:45], v[44:45], v[244:245]
  v_pk_add_f32 v[46:47], v[46:47], v[246:247]
  v_pk_add_f32 v[48:49], v[48:49], v[248:249]
  v_pk_add_f32 v[50:51], v[50:51], v[250:251]
  v_pk_add_f32 v[52:53], v[52:53], v[252:253]
  v_pk_add_f32 v[54:55], v[54:55], v[254:255]
  s_mov_b64 exec, -1
  s_branch .g2_kernel_w_pb
.g2_kernel_w_i8c:
  s_mov_b32 s38, 0
  s_call_b64 s[68:69], .g2_kernel_w_pkl
  s_branch .g2_kernel_w_i8b
.g2_kernel_w_i9c:
  s_mov_b32 s38, 0
  s_call_b64 s[68:69], .g2_kernel_w_pkl
  s_branch .g2_kernel_w_i9b
.g2_kernel_w_i10c:
  s_mov_b32 s38, 0
  s_call_b64 s[68:69], .g2_kernel_w_pkl
  s_branch .g2_kernel_w_i10b
.g2_kernel_w_i11c:
  s_mov_b32 s38, 0
  s_call_b64 s[68:69], .g2_kernel_w_pkl
  s_branch .g2_kernel_w_i11b
.g2_kernel_w_v8:
  s_cmp_ge_u32 s8, 139264
  s_cselect_b32 s28, 139264, 0
  s_sub_u32 s28, s8, s28
  s_lshr_b32 s28, s28, 1
  s_add_u32 s28, s28, 32768
  s_add_u32 s22, s20, s28
  s_addc_u32 s23, s21, 0
  s_mov_b32 s38, 0
.g2_kernel_w_vl8:
  global_load_dwordx4 v[88:91], v3, s[22:23] offset:0 sc1
  global_load_dwordx4 v[92:95], v3, s[22:23] offset:1024 sc1
  global_load_dwordx4 v[96:99], v3, s[22:23] offset:2048 sc1
  global_load_dwordx4 v[100:103], v3, s[22:23] offset:3072 sc1
  s_add_u32 s38, s38, 1
  s_waitcnt vmcnt(0)
  v_min3_u32 v6, v88, v90, v92
  v_min3_u32 v7, v94, v96, v98
  v_min3_u32 v6, v6, v100, v102
  v_min_u32 v6, v6, v7
  v_cmp_eq_u32 vcc, 0, v6
  s_cbranch_vccz .g2_kernel_w_vb8
  s_cmp_lt_u32 s38, 131072
  s_cbranch_scc1 .g2_kernel_w_vl8
  s_branch .g2_kernel_w_vb8
.g2_kernel_w_i12c:
  s_mov_b32 s38, 0
  s_call_b64 s[68:69], .g2_kernel_w_pkl
  s_branch .g2_kernel_w_i12b
.g2_kernel_w_v9:
  s_cmp_ge_u32 s9, 139264
  s_cselect_b32 s28, 139264, 0
  s_sub_u32 s28, s9, s28
  s_lshr_b32 s28, s28, 1
  s_add_u32 s28, s28, 32768
  s_add_u32 s22, s20, s28
  s_addc_u32 s23, s21, 0
  s_mov_b32 s38, 0
.g2_kernel_w_vl9:
  global_load_dwordx4 v[176:179], v3, s[22:23] offset:0 sc1
  global_load_dwordx4 v[180:183], v3, s[22:23] offset:1024 sc1
  global_load_dwordx4 v[184:187], v3, s[22:23] offset:2048 sc1
  global_load_dwordx4 v[188:191], v3, s[22:23] offset:3072 sc1
  s_add_u32 s38, s38, 1
  s_waitcnt vmcnt(0)
  v_min3_u32 v6, v176, v178, v180
  v_min3_u32 v7, v182, v184, v186
  v_min3_u32 v6, v6, v188, v190
  v_min_u32 v6, v6, v7
  v_cmp_eq_u32 vcc, 0, v6
  s_cbranch_vccz .g2_kernel_w_vb9
  s_cmp_lt_u32 s38, 131072
  s_cbranch_scc1 .g2_kernel_w_vl9
  s_branch .g2_kernel_w_vb9
.g2_kernel_w_i13c:
  s_mov_b32 s38, 0
  s_call_b64 s[68:69], .g2_kernel_w_pkl
  s_branch .g2_kernel_w_i13b
.g2_kernel_w_v10:
  s_cmp_ge_u32 s10, 139264
  s_cselect_b32 s28, 139264, 0
  s_sub_u32 s28, s10, s28
  s_lshr_b32 s28, s28, 1
  s_add_u32 s28, s28, 32768
  s_add_u32 s22, s20, s28
  s_addc_u32 s23, s21, 0
  s_mov_b32 s38, 0
.g2_kernel_w_vl10:
  global_load_dwordx4 v[192:195], v3, s[22:23] offset:0 sc1
  global_load_dwordx4 v[196:199], v3, s[22:23] offset:1024 sc1
  global_load_dwordx4 v[200:203], v3, s[22:23] offset:2048 sc1
  global_load_dwordx4 v[204:207], v3, s[22:23] offset:3072 sc1
  s_add_u32 s38, s38, 1
  s_waitcnt vmcnt(0)
  v_min3_u32 v6, v192, v194, v196
  v_min3_u32 v7, v198, v200, v202
  v_min3_u32 v6, v6, v204, v206
  v_min_u32 v6, v6, v7
  v_cmp_eq_u32 vcc, 0, v6
  s_cbranch_vccz .g2_kernel_w_vb10
  s_cmp_lt_u32 s38, 131072
  s_cbranch_scc1 .g2_kernel_w_vl10
  s_branch .g2_kernel_w_vb10
.g2_kernel_w_i14c:
  s_mov_b32 s38, 524288
  s_call_b64 s[68:69], .g2_kernel_w_pkl
  s_branch .g2_kernel_w_i14b
.g2_kernel_w_v11:
  s_cmp_ge_u32 s11, 139264
  s_cselect_b32 s28, 139264, 0
  s_sub_u32 s28, s11, s28
  s_lshr_b32 s28, s28, 1
  s_add_u32 s28, s28, 32768
  s_add_u32 s22, s20, s28
  s_addc_u32 s23, s21, 0
  s_mov_b32 s38, 0
.g2_kernel_w_vl11:
  global_load_dwordx4 v[208:211], v3, s[22:23] offset:0 sc1
  global_load_dwordx4 v[212:215], v3, s[22:23] offset:1024 sc1
  global_load_dwordx4 v[216:219], v3, s[22:23] offset:2048 sc1
  global_load_dwordx4 v[220:223], v3, s[22:23] offset:3072 sc1
  s_add_u32 s38, s38, 1
  s_waitcnt vmcnt(0)
  v_min3_u32 v6, v208, v210, v212
  v_min3_u32 v7, v214, v216, v218
  v_min3_u32 v6, v6, v220, v222
  v_min_u32 v6, v6, v7
  v_cmp_eq_u32 vcc, 0, v6
  s_cbranch_vccz .g2_kernel_w_vb11
  s_cmp_lt_u32 s38, 131072
  s_cbranch_scc1 .g2_kernel_w_vl11
  s_branch .g2_kernel_w_vb11
.g2_kernel_w_i15c:
  s_mov_b32 s38, 524288
  s_call_b64 s[68:69], .g2_kernel_w_pkl
  s_branch .g2_kernel_w_i15b
.g2_kernel_w_v12:
  s_cmp_ge_u32 s12, 139264
  s_cselect_b32 s28, 139264, 0
  s_sub_u32 s28, s12, s28
  s_lshr_b32 s28, s28, 1
  s_add_u32 s28, s28, 32768
  s_add_u32 s22, s20, s28
  s_addc_u32 s23, s21, 0
  s_mov_b32 s38, 0
.g2_kernel_w_vl12:
  global_load_dwordx4 v[224:227], v3, s[22:23] offset:0 sc1
  global_load_dwordx4 v[228:231], v3, s[22:23] offset:1024 sc1
  global_load_dwordx4 v[232:235], v3, s[22:23] offset:2048 sc1
  global_load_dwordx4 v[236:239], v3, s[22:23] offset:3072 sc1
  s_add_u32 s38, s38, 1
  s_waitcnt vmcnt(0)
  v_min3_u32 v6, v224, v226, v228
  v_min3_u32 v7, v230, v232, v234
  v_min3_u32 v6, v6, v236, v238
  v_min_u32 v6, v6, v7
  v_cmp_eq_u32 vcc, 0, v6
  s_cbranch_vccz .g2_kernel_w_vb12
  s_cmp_lt_u32 s38, 131072
  s_cbranch_scc1 .g2_kernel_w_vl12
  s_branch .g2_kernel_w_vb12
.g2_kernel_w_v13:
  s_cmp_ge_u32 s13, 139264
  s_cselect_b32 s28, 139264, 0
  s_sub_u32 s28, s13, s28
  s_lshr_b32 s28, s28, 1
  s_add_u32 s28, s28, 32768
  s_add_u32 s22, s20, s28
  s_addc_u32 s23, s21, 0
  s_mov_b32 s38, 0
.g2_kernel_w_vl13:
  global_load_dwordx4 v[136:139], v3, s[22:23] offset:0 sc1
  global_load_dwordx4 v[140:143], v3, s[22:23] offset:1024 sc1
  global_load_dwordx4 v[144:147], v3, s[22:23] offset:2048 sc1
  global_load_dwordx4 v[148:151], v3, s[22:23] offset:3072 sc1
  s_add_u32 s38, s38, 1
  s_waitcnt vmcnt(0)
  v_min3_u32 v6, v136, v138, v140
  v_min3_u32 v7, v142, v144, v146
  v_min3_u32 v6, v6, v148, v150
  v_min_u32 v6, v6, v7
  v_cmp_eq_u32 vcc, 0, v6
  s_cbranch_vccz .g2_kernel_w_vb13
  s_cmp_lt_u32 s38, 131072
  s_cbranch_scc1 .g2_kernel_w_vl13
  s_branch .g2_kernel_w_vb13
.g2_kernel_w_v14:
  s_cmp_ge_u32 s14, 139264
  s_cselect_b32 s28, 139264, 0
  s_sub_u32 s28, s14, s28
  s_lshr_b32 s28, s28, 1
  s_add_u32 s28, s28, 32768
  s_add_u32 s22, s20, s28
  s_addc_u32 s23, s21, 0
  s_mov_b32 s38, 0
.g2_kernel_w_vl14:
  global_load_dwordx4 v[152:155], v3, s[22:23] offset:0 sc1
  global_load_dwordx4 v[156:159], v3, s[22:23] offset:1024 sc1
  global_load_dwordx4 v[160:163], v3, s[22:23] offset:2048 sc1
  global_load_dwordx4 v[164:167], v3, s[22:23] offset:3072 sc1
  s_add_u32 s38, s38, 1
  s_waitcnt vmcnt(0)
  v_min3_u32 v6, v152, v154, v156
  v_min3_u32 v7, v158, v160, v162
  v_min3_u32 v6, v6, v164, v166
  v_min_u32 v6, v6, v7
  v_cmp_eq_u32 vcc, 0, v6
  s_cbranch_vccz .g2_kernel_w_vb14
  s_cmp_lt_u32 s38, 131072
  s_cbranch_scc1 .g2_kernel_w_vl14
  s_branch .g2_kernel_w_vb14
.g2_kernel_w_v15:
  s_cmp_ge_u32 s15, 139264
  s_cselect_b32 s28, 139264, 0
  s_sub_u32 s28, s15, s28
  s_lshr_b32 s28, s28, 1
  s_add_u32 s28, s28, 32768
  s_add_u32 s22, s20, s28
  s_addc_u32 s23, s21, 0
  s_mov_b32 s38, 0
.g2_kernel_w_vl15:
  global_load_dwordx4 v[56:59], v3, s[22:23] offset:0 sc1
  global_load_dwordx4 v[60:63], v3, s[22:23] offset:1024 sc1
  global_load_dwordx4 v[64:67], v3, s[22:23] offset:2048 sc1
  global_load_dwordx4 v[68:71], v3, s[22:23] offset:3072 sc1
  s_add_u32 s38, s38, 1
  s_waitcnt vmcnt(0)
  v_min3_u32 v6, v56, v58, v60
  v_min3_u32 v7, v62, v64, v66
  v_min3_u32 v6, v6, v68, v70
  v_min_u32 v6, v6, v7
  v_cmp_eq_u32 vcc, 0, v6
  s_cbranch_vccz .g2_kernel_w_vb15
  s_cmp_lt_u32 s38, 131072
  s_cbranch_scc1 .g2_kernel_w_vl15
  s_branch .g2_kernel_w_vb15
.g2_kernel_w_bw:
  s_mov_b32 s38, 0
.g2_kernel_w_bwl:
  ds_read_b32 v16, v20 offset:12
  s_add_u32 s38, s38, 1
  s_waitcnt lgkmcnt(0)
  v_cmp_gt_u32 vcc, 4, v16
  s_cbranch_vccz .g2_kernel_w_bb
  s_cmp_lt_u32 s38, 524288
  s_cbranch_scc1 .g2_kernel_w_bwl
  s_branch .g2_kernel_w_bb
.g2_kernel_w_pick:
  s_mov_b32 s38, 0
.g2_kernel_w_pkl:
  ds_read_b64 v[6:7], v21
  s_add_u32 s38, s38, 1
  s_waitcnt lgkmcnt(0)
  v_min_u32 v6, v6, v7
  v_cmp_lt_u32 vcc, s62, v6
  s_and_b32 s36, vcc_lo, 0xff00
  s_andn2_b32 s33, s36, s34
  s_cbranch_scc1 .g2_kernel_w_pkr
  s_cmp_lt_u32 s38, 524288
  s_cbranch_scc1 .g2_kernel_w_pkl
  s_andn2_b32 s33, 0xff00, s34
.g2_kernel_w_pkr:
  s_setpc_b64 s[68:69]
.g2_kernel_p_spin:
  s_mov_b32 s38, 0
.g2_kernel_p_spinl:
  ds_read_b32 v10, v9
  s_add_u32 s38, s38, 1
  s_waitcnt lgkmcnt(0)
  v_cmp_gt_i32 vcc, s34, v10
  s_cbranch_vccz .g2_kernel_p_spinr
  s_sleep 1
  s_cmp_lt_u32 s38, 524288
  s_cbranch_scc1 .g2_kernel_p_spinl
.g2_kernel_p_spinr:
  s_setpc_b64 s[68:69]
.g2_kernel_p1_aw:
  s_call_b64 s[68:69], .g2_kernel_p_spin
  s_branch .g2_kernel_p1_ai
.g2_kernel_p1_bw:
  s_call_b64 s[68:69], .g2_kernel_p_spin
  s_branch .g2_kernel_p1_bi
.g2_kernel_v_3a:
  s_and_b32 s31, s76, 0xffffe000
  s_add_u32 s31, s31, 0
  v_and_b32 v6, 15, v2
  v_lshlrev_b32 v6, 9, v6
  v_lshrrev_b32 v7, 4, v2
  v_lshl_add_u32 v6, v7, 7, v6
  v_lshlrev_b32 v7, 2, v2
  v_add_u32 v7, 157440, v7
  s_mov_b32 m0, 157440
  s_mov_b32 s38, 0
  s_mov_b32 exec_lo, 0xffff0000
  s_mov_b32 exec_hi, 0xffff0000
.g2_kernel_pa25:
  buffer_load_dword v6, s[4:7], s31 offen sc1 lds
  s_add_u32 s38, s38, 1
  s_waitcnt vmcnt(0)
  ds_read_b32 v8, v7
  s_waitcnt lgkmcnt(0)
  v_cmp_ge_u32 vcc, s62, v8
  s_cbranch_vccz .g2_kernel_pa25d
  s_mov_b64 exec, vcc
  s_sleep 16
  s_cmp_lt_u32 s38, 131072
  s_cbranch_scc1 .g2_kernel_pa25
.g2_kernel_pa25d:
  s_mov_b64 exec, -1
  s_branch .g2_kernel_v_3
.g2_kernel_v_may:
  s_cmp_lg_u32 s39, 0
  s_cbranch_scc1 .g2_kernel_v_mr
  s_and_b32 s28, s16, 3
  s_lshl_b32 s28, s28, 4
  s_add_u32 s28, s28, 155968
  v_mov_b32 v6, s28
  ds_read_b32 v7, v6
  s_waitcnt lgkmcnt(0)
  v_cmp_ne_u32 vcc, 0, v7
  s_cbranch_vccz .g2_kernel_v_mr
.g2_kernel_v_do:
  s_mov_b32 s39, 1
  s_mov_b32 s29, 0
  s_call_b64 s[68:69], .g2_kernel_v_cmb
  s_waitcnt vmcnt(0)
  v_mov_b32 v6, s71
  s_mov_b64 exec, 1
  ds_add_u32 v6, v5 offset:8
  s_mov_b64 exec, -1
  s_and_b32 s33, s16, 3
  s_lshl_b32 s33, s33, 7
  s_lshl_b32 s28, s29, 2
  s_add_u32 s33, s33, s28
  s_add_u32 s31, s19, s33
  v_mov_b32 v6, s70
  s_mov_b64 exec, 1
  buffer_store_dword v6, v4, s[4:7], s31 offen offset:0 sc1
  s_mov_b64 exec, -1
.g2_kernel_v_mr:
  s_setpc_b64 s[26:27]
.g2_kernel_v_w23:
  ds_write_b128 v3, v[128:131] offset:32768
  ds_write_b128 v3, v[132:135] offset:33792
  ds_write_b128 v3, v[136:139] offset:34816
  ds_write_b128 v3, v[140:143] offset:35840
  ds_write_b128 v3, v[144:147] offset:36864
  ds_write_b128 v3, v[148:151] offset:37888
  ds_write_b128 v3, v[152:155] offset:38912
  ds_write_b128 v3, v[156:159] offset:39936
  ds_write_b128 v3, v[160:163] offset:40960
  ds_write_b128 v3, v[164:167] offset:41984
  ds_write_b128 v3, v[168:171] offset:43008
  ds_write_b128 v3, v[172:175] offset:44032
  ds_write_b128 v3, v[176:179] offset:45056
  ds_write_b128 v3, v[180:183] offset:46080
  ds_write_b128 v3, v[184:187] offset:47104
  ds_write_b128 v3, v[188:191] offset:48128
  ds_write_b128 v3, v[192:195] offset:49152
  ds_write_b128 v3, v[196:199] offset:50176
  ds_write_b128 v3, v[200:203] offset:51200
  ds_write_b128 v3, v[204:207] offset:52224
  ds_write_b128 v3, v[208:211] offset:53248
  ds_write_b128 v3, v[212:215] offset:54272
  ds_write_b128 v3, v[216:219] offset:55296
  ds_write_b128 v3, v[220:223] offset:56320
  ds_write_b128 v3, v[224:227] offset:57344
  ds_write_b128 v3, v[228:231] offset:58368
  ds_write_b128 v3, v[232:235] offset:59392
  ds_write_b128 v3, v[236:239] offset:60416
  ds_write_b128 v3, v[240:243] offset:61440
  ds_write_b128 v3, v[244:247] offset:62464
  ds_write_b128 v3, v[248:251] offset:63488
  ds_write_b128 v3, v[252:255] offset:64512
  s_setpc_b64 s[68:69]
.g2_kernel_v_wo:
  s_mov_b32 s8, s44
  s_mov_b32 s9, s45
  s_mov_b32 s10, 0x200000
  s_mov_b32 s11, 0x00020000
  v_lshrrev_b32 v6, 3, v2
  v_and_b32 v7, 7, v2
  v_bfe_u32 v8, v2, 4, 1
  v_lshlrev_b32 v8, 2, v8
  v_xor_b32 v7, v7, v8
  v_lshlrev_b32 v7, 4, v7
  v_lshl_add_u32 v6, v6, 11, v7
  s_lshl_b32 s31, s32, 3
  s_add_u32 s31, s31, s29
  s_lshl_b32 s31, s31, 16
  s_lshl_b32 s33, s18, 7
  s_add_u32 s31, s31, s33
  s_mov_b32 m0, s30
  s_nop 0
  buffer_load_dwordx4 v6, s[8:11], s31 offen lds
  s_add_u32 m0, m0, 1024
  s_add_u32 s31, s31, 16384
  s_sleep 1
  buffer_load_dwordx4 v6, s[8:11], s31 offen lds
  s_add_u32 m0, m0, 1024
  s_add_u32 s31, s31, 16384
  s_sleep 1
  buffer_load_dwordx4 v6, s[8:11], s31 offen lds
  s_add_u32 m0, m0, 1024
  s_add_u32 s31, s31, 16384
  s_sleep 1
  buffer_load_dwordx4 v6, s[8:11], s31 offen lds
  s_add_u32 m0, m0, 1024
  s_add_u32 s31, s31, 81920
  s_sleep 1
  buffer_load_dwordx4 v6, s[8:11], s31 offen lds
  s_add_u32 m0, m0, 1024
  s_add_u32 s31, s31, 16384
  s_sleep 1
  buffer_load_dwordx4 v6, s[8:11], s31 offen lds
  s_add_u32 m0, m0, 1024
  s_add_u32 s31, s31, 16384
  s_sleep 1
  buffer_load_dwordx4 v6, s[8:11], s31 offen lds
  s_add_u32 m0, m0, 1024
  s_add_u32 s31, s31, 16384
  s_sleep 1
  buffer_load_dwordx4 v6, s[8:11], s31 offen lds
  s_add_u32 m0, m0, 1024
  s_add_u32 s31, s31, 81920
  s_sleep 1
  buffer_load_dwordx4 v6, s[8:11], s31 offen lds
  s_add_u32 m0, m0, 1024
  s_add_u32 s31, s31, 16384
  s_sleep 1
  buffer_load_dwordx4 v6, s[8:11], s31 offen lds
  s_add_u32 m0, m0, 1024
  s_add_u32 s31, s31, 16384
  s_sleep 1
  buffer_load_dwordx4 v6, s[8:11], s31 offen lds
  s_add_u32 m0, m0, 1024
  s_add_u32 s31, s31, 16384
  s_sleep 1
  buffer_load_dwordx4 v6, s[8:11], s31 offen lds
  s_add_u32 m0, m0, 1024
  s_add_u32 s31, s31, 81920
  s_sleep 1
  buffer_load_dwordx4 v6, s[8:11], s31 offen lds
  s_add_u32 m0, m0, 1024
  s_add_u32 s31, s31, 16384
  s_sleep 1
  buffer_load_dwordx4 v6, s[8:11], s31 offen lds
  s_add_u32 m0, m0, 1024
  s_add_u32 s31, s31, 16384
  s_sleep 1
  buffer_load_dwordx4 v6, s[8:11], s31 offen lds
  s_add_u32 m0, m0, 1024
  s_add_u32 s31, s31, 16384
  s_sleep 1
  buffer_load_dwordx4 v6, s[8:11], s31 offen lds
  s_setpc_b64 s[68:69]
.g2_kernel_v_cmb:
  s_and_b32 s28, s16, 3
  s_lshl_b32 s30, s28, 2
  s_lshl_b32 s34, 15, s30
  s_lshr_b32 s32, s34, 4
  s_or_b32 s32, s32, s34
  s_mul_i32 s32, s32, s29
  v_and_b32 v6, 15, v2
  v_lshlrev_b32 v6, 2, v6
  v_add_u32 v6, 155968, v6
  s_mov_b32 s30, .g2_kernel_sel-.g2_kernel_pc
  buffer_load_dwordx4 v[8:11], v3, s[64:67], s30 offen
  buffer_load_dwordx4 v[12:15], v3, s[64:67], s30 offen offset:1024
  s_lshl_b32 s30, s28, 13
  v_add_u32 v0, s30, v3
  v_and_b32 v4, 31, v2
  s_lshl_b32 s31, s28, 9
  s_add_u32 s31, s31, 161280
  v_lshl_add_u32 v4, v4, 2, s31
  s_lshl_b32 s33, s62, 1
  s_add_u32 s33, s33, s29
  s_lshl_b32 s31, s17, 2
  s_add_u32 s31, s31, s28
  s_lshl_b32 s31, s31, 1
  s_add_u32 s31, s31, s29
  s_lshl_b32 s31, s31, 4
  s_add_u32 s31, s31, s18
  s_lshl_b32 s31, s31, 11
  s_add_u32 s31, s31, s63
  s_add_u32 s35, s31, 0x800000
  s_mov_b32 s38, 0
  s_waitcnt vmcnt(0)
.g2_kernel_v_cmbw:
  ds_read_b32 v7, v6
  s_add_u32 s38, s38, 1
  s_waitcnt lgkmcnt(0)
  v_cmp_ge_u32 vcc, s33, v7
  s_and_b32 s30, vcc_lo, s34
  s_cbranch_scc0 .g2_kernel_v_cmbd
  s_orn2_b32 s30, vcc_lo, s32
  s_cmp_lg_u32 s30, -1
  s_cbranch_scc1 .g2_kernel_v_cmbq
  s_sleep 6
.g2_kernel_v_cmbq:
  s_sleep 1
  s_cmp_lt_u32 s38, 524288
  s_cbranch_scc1 .g2_kernel_v_cmbw
.g2_kernel_v_cmbd:
  s_setprio 3
  ds_read_b128 v[32:35], v0 offset:0
  ds_read_b128 v[36:39], v0 offset:1024
  ds_read_b128 v[40:43], v0 offset:2048
  ds_read_b128 v[44:47], v0 offset:3072
  ds_read_b128 v[48:51], v0 offset:4096
  ds_read_b128 v[52:55], v0 offset:5120
  ds_read_b128 v[56:59], v0 offset:6144
  ds_read_b128 v[60:63], v0 offset:7168
  ds_read2_b32 v[6:7], v4 offset0:64 offset1:96
  ds_read2_b32 v[4:5], v4 offset0:0 offset1:32
  s_lshl_b32 s30, s28, 2
  s_add_u32 s30, s30, s71
  s_waitcnt lgkmcnt(9)
  v_mfma_f32_32x32x16_bf16 v[16:31], v[8:11], v[32:35], 0
  s_waitcnt lgkmcnt(8)
  v_mfma_f32_32x32x16_bf16 v[16:31], v[12:15], v[36:39], v[16:31]
  s_waitcnt lgkmcnt(7)
  v_mfma_f32_32x32x16_bf16 v[16:31], v[8:11], v[40:43], v[16:31]
  s_waitcnt lgkmcnt(6)
  v_mfma_f32_32x32x16_bf16 v[16:31], v[12:15], v[44:47], v[16:31]
  s_waitcnt lgkmcnt(5)
  v_mfma_f32_32x32x16_bf16 v[16:31], v[8:11], v[48:51], v[16:31]
  s_waitcnt lgkmcnt(4)
  v_mfma_f32_32x32x16_bf16 v[16:31], v[12:15], v[52:55], v[16:31]
  s_waitcnt lgkmcnt(3)
  v_mfma_f32_32x32x16_bf16 v[16:31], v[8:11], v[56:59], v[16:31]
  s_waitcnt lgkmcnt(2)
  v_mfma_f32_32x32x16_bf16 v[16:31], v[12:15], v[60:63], v[16:31]
  v_mov_b32 v0, s30
  s_waitcnt lgkmcnt(0)
  v_add_f32 v6, v6, v4
  v_add_f32 v7, v7, v5
  v_mov_b32 v4, 0
  v_mov_b32 v5, s29
  ds_write_b32 v0, v5 offset:64
  v_add_f32 v9, v6, v7
  s_mov_b32 s30, 8.673617379884035e-19
  s_mov_b32 s31, 1.152921504606847e+18
  v_rcp_f32 v10, v9
  v_cmp_le_f32 vcc, s30, v9
  v_cmp_ge_f32 s[36:37], s31, v9
  v_mov_b32 v5, 1
  v_mul_f32 v10, 4.0, v10
  s_and_b64 s[36:37], s[36:37], vcc
  v_cmp_o_f32 vcc, v16, v16
  s_and_b64 vcc, vcc, s[36:37]
  s_cmp_eq_u64 vcc, -1
  s_cbranch_scc0 .g2_kernel_v_cmbslow
.g2_kernel_v_cmbfin:
  v_mul_f32 v16, v16, v10
  v_mul_f32 v17, v17, v10
  v_mul_f32 v18, v18, v10
  v_mul_f32 v19, v19, v10
  v_mul_f32 v20, v20, v10
  v_mul_f32 v21, v21, v10
  v_mul_f32 v22, v22, v10
  v_mul_f32 v23, v23, v10
  v_cvt_pk_bf16_f32 v32, v16, v17
  v_cvt_pk_bf16_f32 v33, v18, v19
  v_cvt_pk_bf16_f32 v34, v20, v21
  v_cvt_pk_bf16_f32 v35, v22, v23
  v_max_u32 v32, 1, v32
  v_max_u32 v34, 1, v34
  buffer_store_dwordx4 v[32:35], v3, s[4:7], s35 offen offset:0 sc1
  v_mul_f32 v24, v24, v10
  v_mul_f32 v25, v25, v10
  v_mul_f32 v26, v26, v10
  v_mul_f32 v27, v27, v10
  v_mul_f32 v28, v28, v10
  v_mul_f32 v29, v29, v10
  v_mul_f32 v30, v30, v10
  v_mul_f32 v31, v31, v10
  v_cvt_pk_bf16_f32 v36, v24, v25
  v_cvt_pk_bf16_f32 v37, v26, v27
  v_cvt_pk_bf16_f32 v38, v28, v29
  v_cvt_pk_bf16_f32 v39, v30, v31
  v_max_u32 v36, 1, v36
  v_max_u32 v38, 1, v38
  buffer_store_dwordx4 v[36:39], v3, s[4:7], s35 offen offset:1024 sc1
  s_setprio 3
  s_setpc_b64 s[68:69]
.g2_kernel_v_cmbslow:
  s_setprio 0
  s_lshl_b32 s30, s28, 11
  s_mul_i32 s31, s29, -8192
  s_add_u32 s30, s30, s31
  s_add_u32 s30, s30, 139264
  v_add_u32 v6, s30, v3
  ds_read_b128 v[48:51], v6
  ds_read_b128 v[52:55], v6 offset:1024
  s_lshl_b32 s36, s18, 1
  s_add_u32 s36, s36, s29
  s_lshl_b32 s36, s36, 18
  s_add_u32 s36, s36, s63
  s_mov_b32 s30, s36
  s_mov_b32 s33, 64
  v_mov_b32 v10, 0xff800000
  s_waitcnt lgkmcnt(0)
.g2_kernel_v_cmbs1:
  buffer_load_dwordx4 v[56:59], v3, s[4:7], s30 offen offset:0
  buffer_load_dwordx4 v[60:63], v3, s[4:7], s30 offen offset:1024
  s_waitcnt vmcnt(0)
  v_mfma_f32_32x32x16_bf16 v[32:47], v[56:59], v[48:51], 0
  v_mfma_f32_32x32x16_bf16 v[32:47], v[60:63], v[52:55], v[32:47]
  s_nop 11
  v_max3_f32 v10, v10, v32, v33
  v_max3_f32 v10, v10, v34, v35
  v_max3_f32 v10, v10, v36, v37
  v_max3_f32 v10, v10, v38, v39
  v_max3_f32 v10, v10, v40, v41
  v_max3_f32 v10, v10, v42, v43
  v_max3_f32 v10, v10, v44, v45
  v_max3_f32 v10, v10, v46, v47
  s_add_u32 s30, s30, 4096
  s_sub_u32 s33, s33, 1
  s_cmp_lg_u32 s33, 0
  s_cbranch_scc1 .g2_kernel_v_cmbs1
  v_mov_b32 v11, v10
  s_nop 1
  v_permlane32_swap_b32 v11, v10
  v_max_f32 v10, v10, v11
  v_mov_b32 v9, 0
  v_mov_b32 v16, 0
  v_mov_b32 v17, 0
  v_mov_b32 v18, 0
  v_mov_b32 v19, 0
  v_mov_b32 v20, 0
  v_mov_b32 v21, 0
  v_mov_b32 v22, 0
  v_mov_b32 v23, 0
  v_mov_b32 v24, 0
  v_mov_b32 v25, 0
  v_mov_b32 v26, 0
  v_mov_b32 v27, 0
  v_mov_b32 v28, 0
  v_mov_b32 v29, 0
  v_mov_b32 v30, 0
  v_mov_b32 v31, 0
  s_mov_b32 s30, s36
  s_mov_b32 s33, 64
.g2_kernel_v_cmbs2:
  buffer_load_dwordx4 v[56:59], v3, s[4:7], s30 offen offset:0
  buffer_load_dwordx4 v[60:63], v3, s[4:7], s30 offen offset:1024
  s_waitcnt vmcnt(0)
  v_mfma_f32_32x32x16_bf16 v[32:47], v[56:59], v[48:51], 0
  v_mfma_f32_32x32x16_bf16 v[32:47], v[60:63], v[52:55], v[32:47]
  s_nop 11
  v_sub_f32 v32, v32, v10
  v_sub_f32 v33, v33, v10
  v_sub_f32 v34, v34, v10
  v_sub_f32 v35, v35, v10
  v_sub_f32 v36, v36, v10
  v_sub_f32 v37, v37, v10
  v_sub_f32 v38, v38, v10
  v_sub_f32 v39, v39, v10
  v_sub_f32 v40, v40, v10
  v_sub_f32 v41, v41, v10
  v_sub_f32 v42, v42, v10
  v_sub_f32 v43, v43, v10
  v_sub_f32 v44, v44, v10
  v_sub_f32 v45, v45, v10
  v_sub_f32 v46, v46, v10
  v_sub_f32 v47, v47, v10
  buffer_load_dwordx4 v[56:59], v3, s[4:7], s30 offen offset:2048
  buffer_load_dwordx4 v[60:63], v3, s[4:7], s30 offen offset:3072
  v_exp_f32 v32, v32
  v_exp_f32 v33, v33
  v_exp_f32 v34, v34
  v_exp_f32 v35, v35
  v_exp_f32 v36, v36
  v_exp_f32 v37, v37
  v_exp_f32 v38, v38
  v_exp_f32 v39, v39
  v_exp_f32 v40, v40
  v_exp_f32 v41, v41
  v_exp_f32 v42, v42
  v_exp_f32 v43, v43
  v_exp_f32 v44, v44
  v_exp_f32 v45, v45
  v_exp_f32 v46, v46
  v_exp_f32 v47, v47
  v_add_f32 v9, v9, v32
  v_add_f32 v9, v9, v33
  v_add_f32 v9, v9, v34
  v_add_f32 v9, v9, v35
  v_add_f32 v9, v9, v36
  v_add_f32 v9, v9, v37
  v_add_f32 v9, v9, v38
  v_add_f32 v9, v9, v39
  v_add_f32 v9, v9, v40
  v_add_f32 v9, v9, v41
  v_add_f32 v9, v9, v42
  v_add_f32 v9, v9, v43
  v_add_f32 v9, v9, v44
  v_add_f32 v9, v9, v45
  v_add_f32 v9, v9, v46
  v_add_f32 v9, v9, v47
  v_cvt_pk_bf16_f32 v32, v32, v33
  v_cvt_pk_bf16_f32 v33, v34, v35
  v_cvt_pk_bf16_f32 v34, v36, v37
  v_cvt_pk_bf16_f32 v35, v38, v39
  v_cvt_pk_bf16_f32 v36, v40, v41
  v_cvt_pk_bf16_f32 v37, v42, v43
  v_cvt_pk_bf16_f32 v38, v44, v45
  v_cvt_pk_bf16_f32 v39, v46, v47
  s_waitcnt vmcnt(0)
  v_mfma_f32_32x32x16_bf16 v[16:31], v[56:59], v[32:35], v[16:31]
  v_mfma_f32_32x32x16_bf16 v[16:31], v[60:63], v[36:39], v[16:31]
  s_nop 15
  s_add_u32 s30, s30, 4096
  s_sub_u32 s33, s33, 1
  s_cmp_lg_u32 s33, 0
  s_cbranch_scc1 .g2_kernel_v_cmbs2
  v_mov_b32 v11, v9
  s_nop 1
  v_permlane32_swap_b32 v11, v9
  v_add_f32 v9, v9, v11
  v_rcp_f32 v10, v9
  s_branch .g2_kernel_v_cmbfin
.g2_kernel_p2_xw:
  s_mov_b32 s38, 0
.g2_kernel_p2_xwl:
  ds_read_b32 v12, v11
  s_add_u32 s38, s38, 1
  s_waitcnt lgkmcnt(0)
  v_cmp_ne_u32 vcc, 0, v12
  s_and_b32 s37, vcc_lo, vcc_hi
  s_lshr_b32 s33, s37, 16
  s_and_b32 s37, s37, s33
  s_bitcmp1_b32 s37, s28
  s_cbranch_scc1 .g2_kernel_p2_xwr
  s_sleep 1
  s_cmp_lt_u32 s38, 524288
  s_cbranch_scc1 .g2_kernel_p2_xwl
.g2_kernel_p2_xwr:
  s_setpc_b64 s[68:69]
.g2_kernel_p2_x0w:
  s_call_b64 s[68:69], .g2_kernel_p2_xw
  s_branch .g2_kernel_p2_x0b
.g2_kernel_p2_x1w:
  s_call_b64 s[68:69], .g2_kernel_p2_xw
  s_branch .g2_kernel_p2_x1b
.g2_kernel_p2_x2w:
  s_call_b64 s[68:69], .g2_kernel_p2_xw
  s_branch .g2_kernel_p2_x2b
.g2_kernel_p2_aw:
  s_call_b64 s[68:69], .g2_kernel_p_spin
  s_branch .g2_kernel_p2_ai
.g2_kernel_p2_x3w:
  s_call_b64 s[68:69], .g2_kernel_p2_xw
  s_branch .g2_kernel_p2_x3b
.g2_kernel_p2_bw:
  s_call_b64 s[68:69], .g2_kernel_p_spin
  s_branch .g2_kernel_p2_bi
.g2_kernel_amax:
  v_mov_b32 v16, 0xff7fffff
  v_lshlrev_b32 v7, 7, v2
  s_mov_b32 s38, 0
  s_mov_b64 exec, s[8:9]
.g2_kernel_amaxl:
  buffer_load_dwordx2 v[16:17], v7, s[4:7], s23 offen sc1
  s_add_u32 s38, s38, 1
  s_waitcnt vmcnt(0)
  v_cmp_eq_u32 vcc, 0, v17
  s_cbranch_vccz .g2_kernel_amaxd
  s_mov_b64 exec, vcc
  s_sleep 4
  s_cmp_lg_u32 s62, 0
  s_cbranch_scc1 .g2_kernel_nap58
  s_sleep 8
.g2_kernel_nap58:
  s_cmp_eq_u32 s39, 1
  s_cbranch_scc0 .g2_kernel_amaxz
  s_sleep 8
.g2_kernel_amaxz:
  s_cmp_lt_u32 s38, 131072
  s_cbranch_scc1 .g2_kernel_amaxl
.g2_kernel_amaxd:
  s_mov_b64 exec, -1
  v_mov_b32 v6, v16
  s_nop 1
  v_max_f32 v7, v6, v6 row_ror:8 row_mask:0xf bank_mask:0xf
  s_nop 1
  v_max_f32 v7, v7, v7 row_ror:4 row_mask:0xf bank_mask:0xf
  s_nop 1
  v_max_f32 v7, v7, v7 row_ror:2 row_mask:0xf bank_mask:0xf
  s_nop 1
  v_max_f32 v7, v7, v7 row_ror:1 row_mask:0xf bank_mask:0xf
  s_nop 1
  v_max_f32 v7, v7, v7 row_bcast:15 row_mask:0xa bank_mask:0xf
  s_nop 1
  v_max_f32 v7, v7, v7 row_bcast:31 row_mask:0xc bank_mask:0xf
  s_nop 0
  v_readlane_b32 s27, v7, 63
  s_nop 1
  v_cmp_eq_u32 vcc, s27, v6
  s_ff1_i32_b64 s77, vcc
  s_lshl_b32 s77, s77, 5
  s_and_b32 s28, s27, 31
  s_add_u32 s77, s77, s28
  s_and_b32 s77, s77, 2047
  s_setpc_b64 s[68:69]
  .p2align 8
.g2_kernel_tab:
  .long 0, 1, 2, 3, 4, 5, 6, 7
  .long 8, 9, 10, 11, 12, 13, 14, 15
  .long 16, 17, 18, 19, 20, 21, 22, 23
  .long 24, 25, 26, 27, 28, 29, 30, 31
  .long 32, 33, 34, 35, 36, 37, 38, 39
  .long 40, 41, 42, 43, 44, 45, 46, 47
  .long 48, 49, 50, 51, 52, 53, 54, 55
  .long 56, 57, 58, 59, 60, 61, 62, 63
  .long 64, 65, 66, 67, 68, 69, 70, 71
  .p2align 4
.g2_kernel_sel:
  .long 0x3e80, 0x0, 0x0, 0x0
  .long 0x3e800000, 0x0, 0x0, 0x0
  .long 0x0, 0x3e80, 0x0, 0x0
  .long 0x0, 0x3e800000, 0x0, 0x0
  .long 0x0, 0x0, 0x0, 0x0
  .long 0x0, 0x0, 0x0, 0x0
  .long 0x0, 0x0, 0x0, 0x0
  .long 0x0, 0x0, 0x0, 0x0
  .long 0x0, 0x0, 0x3e80, 0x0
  .long 0x0, 0x0, 0x3e800000, 0x0
  .long 0x0, 0x0, 0x0, 0x3e80
  .long 0x0, 0x0, 0x0, 0x3e800000
  .long 0x0, 0x0, 0x0, 0x0
  .long 0x0, 0x0, 0x0, 0x0
  .long 0x0, 0x0, 0x0, 0x0
  .long 0x0, 0x0, 0x0, 0x0
  .long 0x0, 0x0, 0x0, 0x0
  .long 0x0, 0x0, 0x0, 0x0
  .long 0x0, 0x0, 0x0, 0x0
  .long 0x0, 0x0, 0x0, 0x0
  .long 0x0, 0x0, 0x0, 0x0
  .long 0x0, 0x0, 0x0, 0x0
  .long 0x0, 0x0, 0x0, 0x0
  .long 0x0, 0x0, 0x0, 0x0
  .long 0x0, 0x0, 0x0, 0x0
  .long 0x0, 0x0, 0x0, 0x0
  .long 0x0, 0x0, 0x0, 0x0
  .long 0x0, 0x0, 0x0, 0x0
  .long 0x0, 0x0, 0x0, 0x0
  .long 0x0, 0x0, 0x0, 0x0
  .long 0x0, 0x0, 0x0, 0x0
  .long 0x0, 0x0, 0x0, 0x0
  .long 0x0, 0x0, 0x0, 0x0
  .long 0x0, 0x0, 0x0, 0x0
  .long 0x0, 0x0, 0x0, 0x0
  .long 0x0, 0x0, 0x0, 0x0
  .long 0x3e80, 0x0, 0x0, 0x0
  .long 0x3e800000, 0x0, 0x0, 0x0
  .long 0x0, 0x3e80, 0x0, 0x0
  .long 0x0, 0x3e800000, 0x0, 0x0
  .long 0x0, 0x0, 0x0, 0x0
  .long 0x0, 0x0, 0x0, 0x0
  .long 0x0, 0x0, 0x0, 0x0
  .long 0x0, 0x0, 0x0, 0x0
  .long 0x0, 0x0, 0x3e80, 0x0
  .long 0x0, 0x0, 0x3e800000, 0x0
  .long 0x0, 0x0, 0x0, 0x3e80
  .long 0x0, 0x0, 0x0, 0x3e800000
  .long 0x0, 0x0, 0x0, 0x0
  .long 0x0, 0x0, 0x0, 0x0
  .long 0x0, 0x0, 0x0, 0x0
  .long 0x0, 0x0, 0x0, 0x0
  .long 0x0, 0x0, 0x0, 0x0
  .long 0x0, 0x0, 0x0, 0x0
  .long 0x0, 0x0, 0x0, 0x0
  .long 0x0, 0x0, 0x0, 0x0
  .long 0x0, 0x0, 0x0, 0x0
  .long 0x0, 0x0, 0x0, 0x0
  .long 0x0, 0x0, 0x0, 0x0
  .long 0x0, 0x0, 0x0, 0x0
  .long 0x0, 0x0, 0x0, 0x0
  .long 0x0, 0x0, 0x0, 0x0
  .long 0x0, 0x0, 0x0, 0x0
  .long 0x0, 0x0, 0x0, 0x0
  .long 0x0, 0x0, 0x0, 0x0
  .long 0x0, 0x0, 0x0, 0x0
  .long 0x0, 0x0, 0x0, 0x0
  .long 0x0, 0x0, 0x0, 0x0
  .long 0x0, 0x0, 0x0, 0x0
  .long 0x0, 0x0, 0x0, 0x0
  .long 0x0, 0x0, 0x0, 0x0
  .long 0x0, 0x0, 0x0, 0x0
  .long 0x0, 0x0, 0x0, 0x0
  .long 0x0, 0x0, 0x0, 0x0
  .long 0x0, 0x0, 0x0, 0x0
  .long 0x0, 0x0, 0x0, 0x0
  .long 0x0, 0x0, 0x0, 0x0
  .long 0x0, 0x0, 0x0, 0x0
  .long 0x0, 0x0, 0x0, 0x0
  .long 0x0, 0x0, 0x0, 0x0
  .long 0x3e80, 0x0, 0x0, 0x0
  .long 0x3e800000, 0x0, 0x0, 0x0
  .long 0x0, 0x3e80, 0x0, 0x0
  .long 0x0, 0x3e800000, 0x0, 0x0
  .long 0x0, 0x0, 0x0, 0x0
  .long 0x0, 0x0, 0x0, 0x0
  .long 0x0, 0x0, 0x0, 0x0
  .long 0x0, 0x0, 0x0, 0x0
  .long 0x0, 0x0, 0x3e80, 0x0
  .long 0x0, 0x0, 0x3e800000, 0x0
  .long 0x0, 0x0, 0x0, 0x3e80
  .long 0x0, 0x0, 0x0, 0x3e800000
  .long 0x0, 0x0, 0x0, 0x0
  .long 0x0, 0x0, 0x0, 0x0
  .long 0x0, 0x0, 0x0, 0x0
  .long 0x0, 0x0, 0x0, 0x0
  .long 0x0, 0x0, 0x0, 0x0
  .long 0x0, 0x0, 0x0, 0x0
  .long 0x0, 0x0, 0x0, 0x0
  .long 0x0, 0x0, 0x0, 0x0
  .long 0x0, 0x0, 0x0, 0x0
  .long 0x0, 0x0, 0x0, 0x0
  .long 0x0, 0x0, 0x0, 0x0
  .long 0x0, 0x0, 0x0, 0x0
  .long 0x0, 0x0, 0x0, 0x0
  .long 0x0, 0x0, 0x0, 0x0
  .long 0x0, 0x0, 0x0, 0x0
  .long 0x0, 0x0, 0x0, 0x0
  .long 0x0, 0x0, 0x0, 0x0
  .long 0x0, 0x0, 0x0, 0x0
  .long 0x0, 0x0, 0x0, 0x0
  .long 0x0, 0x0, 0x0, 0x0
  .long 0x0, 0x0, 0x0, 0x0
  .long 0x0, 0x0, 0x0, 0x0
  .long 0x0, 0x0, 0x0, 0x0
  .long 0x0, 0x0, 0x0, 0x0
  .long 0x3e80, 0x0, 0x0, 0x0
  .long 0x3e800000, 0x0, 0x0, 0x0
  .long 0x0, 0x3e80, 0x0, 0x0
  .long 0x0, 0x3e800000, 0x0, 0x0
  .long 0x0, 0x0, 0x0, 0x0
  .long 0x0, 0x0, 0x0, 0x0
  .long 0x0, 0x0, 0x0, 0x0
  .long 0x0, 0x0, 0x0, 0x0
  .long 0x0, 0x0, 0x3e80, 0x0
  .long 0x0, 0x0, 0x3e800000, 0x0
  .long 0x0, 0x0, 0x0, 0x3e80
  .long 0x0, 0x0, 0x0, 0x3e800000
.g2_kernel_cend:

.section .rodata,"a"
.p2align 6
.amdhsa_kernel g2_kernel
  .amdhsa_next_free_vgpr 256
  .amdhsa_next_free_sgpr 102
  .amdhsa_accum_offset 256
  .amdhsa_group_segment_fixed_size 0
  .amdhsa_kernarg_size 88
  .amdhsa_user_sgpr_count 2
  .amdhsa_user_sgpr_kernarg_segment_ptr 1
  .amdhsa_system_sgpr_workgroup_id_x 1
.end_amdhsa_kernel
```

```asm
; @launch kernel=g2_kernel grid=(256,1,1) block=(512,1,1) lds=163840
.amdgcn_target "amdgcn-amd-amdhsa--gfx950"
.text
.globl g2_kernel
.p2align 8
.type g2_kernel,@function
g2_kernel:
  s_cmp_ge_u32 s2, 256
  s_cbranch_scc1 .g2_kernel_end
  s_load_dwordx16 s[40:55], s[0:1], 0
  s_load_dwordx4 s[56:59], s[0:1], 64
  s_load_dwordx2 s[60:61], s[0:1], 80
  s_getpc_b64 s[64:65]
.g2_kernel_pc:
  s_mov_b32 s66, .g2_kernel_cend-.g2_kernel_pc
  s_mov_b32 s67, 0x00020000
  s_lshl_b32 s12, s2, 10
  s_and_b32 s12, s12, 0xe000
  v_lshrrev_b32 v3, 3, v0
  v_and_b32 v2, 7, v0
  v_and_b32 v3, 0x38, v3
  v_add_lshl_u32 v3, v3, v2, 7
  s_mov_b64 exec, 0xff
  buffer_load_dword v1, v3, s[64:67], s12 offen
  s_mov_b64 exec, -1
  v_lshrrev_b32 v3, 6, v0
  v_and_b32 v2, 63, v0
  v_readfirstlane_b32 s16, v3
  s_and_b32 s21, s2, 7
  s_lshr_b32 s22, s2, 3
  s_and_b32 s23, s21, 3
  s_lshl_b32 s23, s23, 2
  s_and_b32 s24, s22, 3
  s_add_u32 s18, s23, s24
  s_lshr_b32 s24, s21, 2
  s_lshl_b32 s24, s24, 3
  s_lshr_b32 s25, s22, 2
  s_add_u32 s17, s24, s25
  s_lshl_b32 s19, s17, 4
  s_add_u32 s19, s19, s18
  s_lshl_b32 s19, s19, 9
  s_add_u32 s19, s19, 0x3000000
  s_lshl_b32 s76, s18, 4
  s_add_u32 s76, s76, s17
  s_lshl_b32 s76, s76, 9
  s_add_u32 s76, s76, 0x3020000
  v_lshlrev_b32 v3, 4, v2
  v_mov_b32 v4, 0
  v_mov_b32 v5, 1
  s_mov_b32 s62, 0
  s_mov_b32 s63, 0
  s_mov_b32 s70, 1
  s_mov_b32 s71, 155648
  s_waitcnt lgkmcnt(0)
  s_mov_b32 s4, s60
  s_mov_b32 s5, s61
  s_mov_b32 s6, 0x3300000
  s_mov_b32 s7, 0x00020000
  s_cmp_ge_u32 s16, 4
  s_cbranch_scc1 .g2_kernel_svc
  v_mov_b32 v20, 0
  v_mov_b32 v21, 0
  v_mov_b32 v22, 0
  v_mov_b32 v23, 0
  v_lshlrev_b32 v24, 4, v0
  v_cmp_gt_u32 vcc, 2816, v24
  v_add_u32 v24, 155648, v24
  s_and_saveexec_b64 s[20:21], vcc
  s_cbranch_execz .g2_kernel_q_nz
  ds_write_b128 v24, v[20:23]
.g2_kernel_q_nz:
  s_mov_b64 exec, -1
  v_and_b32 v20, 15, v2
  v_lshrrev_b32 v21, 4, v2
  v_lshrrev_b32 v22, 1, v20
  v_xor_b32 v22, v22, v21
  v_lshlrev_b32 v22, 4, v22
  v_lshl_add_u32 v22, v20, 7, v22
  s_lshr_b32 s26, s16, 1
  s_lshl_b32 s26, s26, 13
  v_add_u32 v144, s26, v22
  v_xor_b32 v145, 64, v144
.g2_kernel_q_cs:
  s_and_b32 s27, s16, 1
  s_lshr_b32 s26, s16, 1
  v_bfe_u32 v20, v2, 2, 2
  v_lshrrev_b32 v49, 4, v2
  v_lshl_add_u32 v22, v49, 3, v20
  v_lshlrev_b32 v22, 7, v22
  v_lshrrev_b32 v23, 1, v20
  v_and_b32 v21, 1, v49
  v_xor_b32 v21, s27, v21
  v_lshl_add_u32 v23, v21, 1, v23
  v_lshl_add_u32 v22, v23, 5, v22
  v_and_b32 v23, 3, v2
  v_lshl_add_u32 v22, v23, 3, v22
  v_add_u32 v148, 65536, v22
  v_xor_b32 v149, 32, v148
  v_mov_b32 v146, v148
  v_mov_b32 v147, v149
  v_mov_b32 v150, 156160
  v_and_b32 v48, 15, v2
  s_lshl_b32 s28, s26, 8
  s_add_u32 s28, s28, 155648
  v_lshl_add_u32 v50, v48, 2, s28
  v_lshl_add_u32 v51, v49, 4, s28
  s_lshl_b32 s28, s27, 7
  s_add_u32 s28, s28, 155648
  v_lshl_add_u32 v52, v49, 4, s28
  s_xor_b32 s28, s28, 128
  v_lshl_add_u32 v53, v48, 2, s28
  v_lshlrev_b32 v54, 9, v49
  v_lshl_add_u32 v55, v48, 4, v54
  v_and_b32 v56, 8, v48
  v_lshl_add_u32 v54, v56, 4, v55
  v_mov_b32 v56, 0.25503486164919736
  v_lshlrev_b32 v58, 2, v2
  v_and_b32 v58, 12, v58
  v_add_u32 v58, 156416, v58
  s_lshl_b32 s8, s18, 7
  s_lshl_b32 s9, s17, 2
  s_add_u32 s8, s8, s9
  s_lshl_b32 s9, s26, 1
  s_add_u32 s8, s8, s9
  s_lshl_b32 s8, s8, 12
  s_add_u32 s8, s8, s63
  s_add_u32 s9, s8, 4096
  s_lshl_b32 s28, s26, 13
  s_lshl_b32 s10, s27, 14
  s_add_u32 s28, s28, s10
  v_add_u32 v59, s28, v54
  s_xor_b32 s28, s28, 16384
  v_add_u32 v60, s28, v55
  s_lshl_b32 s28, s26, 12
  s_mul_i32 s10, s27, -8192
  s_add_u32 s28, s28, s10
  s_add_u32 s28, s28, 139264
  v_add_u32 v61, s28, v55
  s_mov_b32 s10, s27
  s_lshl_b32 s28, s26, 2
  s_add_u32 s28, s28, s71
  v_mov_b32 v62, s28
  s_lshl_b32 s12, s62, 5
  s_add_u32 s12, s12, 28
  v_and_b32 v6, 15, v2
  v_xor_b32 v6, s17, v6
  v_and_b32 v7, 16, v2
  v_add_u32 v6, v6, v7
  s_lshr_b32 s28, s16, 1
  s_lshl_b32 s28, s28, 7
  s_add_u32 s28, s28, 157440
  v_lshl_add_u32 v8, v6, 2, s28
  s_lshl_b32 s28, s16, 12
  v_add_u32 v9, s28, v3
  v_and_b32 v6, 31, v2
  s_lshl_b32 s28, s16, 7
  s_add_u32 s28, s28, 161280
  v_lshl_add_u32 v10, v6, 2, s28
  s_lshl_b32 s28, s16, 2
  s_add_u32 s28, s28, 155968
  v_mov_b32 v11, s28
  s_lshl_b32 s28, s62, 1
  s_add_u32 s28, s28, 1
  v_mov_b32 v12, s28
  v_mov_b32 v13, s71
  v_add_u32 v14, 131072, v3
  v_and_b32 v6, 4, v2
  v_cmp_eq_u32 vcc, 0, v6
  v_mov_b32 v7, 0x3f803f80
  v_and_b32 v6, 1, v2
  v_cndmask_b32 v16, 0, v7, vcc
  v_cndmask_b32 v17, 0, v7, vcc
  v_cndmask_b32 v18, v7, 0, vcc
  v_cndmask_b32 v19, v7, 0, vcc
  v_mul_u32_u24 v20, 0xaaaa, v6
  v_add_u32 v20, 0x4444, v20
  s_lshl_b32 s28, s18, 7
  s_add_u32 s28, s28, s16
  s_lshl_b32 s28, s28, 12
  s_add_u32 s28, s28, s63
  s_add_u32 s20, s60, s28
  s_addc_u32 s21, s61, 0
  s_mov_b32 s24, s17
  s_mov_b32 s25, 14
  s_mov_b32 s26, 0
  s_mov_b32 s27, 6
  s_mov_b32 s34, 0xffff0001
  s_mov_b32 s35, 0
  s_mov_b32 s36, 0
  s_mov_b32 s39, 0
  s_and_b32 s28, s16, 2
  s_lshl_b32 s28, s28, 7
  s_add_u32 s37, s76, s28
  v_mov_b32 v15, s70
  v_lshrrev_b32 v6, 5, v2
  v_and_b32 v7, 15, v2
  v_lshlrev_b32 v22, 4, v7
  v_lshl_add_u32 v22, v6, 8, v22
  v_and_b32 v7, 16, v2
  v_lshl_add_u32 v22, v7, 7, v22
  v_and_b32 v7, 31, v2
  v_lshlrev_b32 v23, 4, v6
  v_lshl_add_u32 v23, v7, 11, v23
  s_lshl_b32 s28, s17, 2
  s_add_u32 s28, s28, s16
  s_lshl_b32 s28, s28, 16
  s_lshl_b32 s29, s18, 7
  s_add_u32 s28, s28, s29
  s_add_u32 s74, s40, s28
  s_addc_u32 s75, s41, 0
  s_lshl_b32 s13, s17, 4
  s_add_u32 s13, s13, s18
  s_lshl_b32 s13, s13, 2
  s_add_u32 s13, s13, s16
  s_lshl_b32 s13, s13, 12
  s_add_u32 s13, s13, 0xc00000
  s_lshl_b32 s28, s16, 2
  s_add_u32 m0, s28, 156416
  s_lshl_b32 s33, s62, 5
  s_lshl_b32 s31, s33, 2
  s_add_u32 s31, s31, .g2_kernel_tab-.g2_kernel_pc+4
  s_mov_b32 s29, 0
  s_cmp_lg_u32 s62, 0
  s_cbranch_scc1 .g2_kernel_q_i2
  s_waitcnt lgkmcnt(0)
  s_barrier
.g2_kernel_q_i3:
  s_call_b64 s[68:69], .g2_kernel_q_spin
  ds_read_b64_tr_b16 v[80:81], v146 offset:0
  ds_read_b64_tr_b16 v[82:83], v146 offset:512
  ds_read_b128 v[64:67], v144 offset:0
  ds_read_b128 v[68:71], v144 offset:2048
  ds_read_b128 v[72:75], v144 offset:4096
  ds_read_b128 v[76:79], v144 offset:6144
  ds_read_b64_tr_b16 v[84:85], v147 offset:0
  ds_read_b64_tr_b16 v[86:87], v147 offset:512
  ds_read_b64_tr_b16 v[88:89], v146 offset:4096
  ds_read_b64_tr_b16 v[90:91], v146 offset:4608
  ds_read_b64_tr_b16 v[92:93], v147 offset:4096
  ds_read_b64_tr_b16 v[94:95], v147 offset:4608
  ds_read_b64_tr_b16 v[96:97], v146 offset:8192
  ds_read_b64_tr_b16 v[98:99], v146 offset:8704
  ds_read_b64_tr_b16 v[100:101], v147 offset:8192
  ds_read_b64_tr_b16 v[102:103], v147 offset:8704
  s_mov_b32 s30, 12288
  s_add_u32 s33, s33, 1
  v_add_u32 v146, s30, v148
  v_add_u32 v147, s30, v149
  s_waitcnt lgkmcnt(0)
  v_mfma_f32_16x16x32_bf16 v[160:163], v[80:83], v[64:67], 0
  v_cmp_lt_i32 vcc, s33, v151
  v_mfma_f32_16x16x32_bf16 v[164:167], v[80:83], v[68:71], 0
  s_cbranch_vccz .g2_kernel_q_wf
.g2_kernel_q_backf:
  v_mfma_f32_16x16x32_bf16 v[168:171], v[80:83], v[72:75], 0
  ds_read_b64_tr_b16 v[120:121], v146 offset:0
  v_mfma_f32_16x16x32_bf16 v[172:175], v[80:83], v[76:79], 0
  ds_read_b64_tr_b16 v[122:123], v146 offset:512
  v_mfma_f32_16x16x32_bf16 v[188:191], v[84:87], v[76:79], 0
  ds_read_b128 v[104:107], v145 offset:0
  v_mfma_f32_16x16x32_bf16 v[184:187], v[84:87], v[72:75], 0
  ds_read_b128 v[108:111], v145 offset:2048
  v_mfma_f32_16x16x32_bf16 v[180:183], v[84:87], v[68:71], 0
  ds_read_b128 v[112:115], v145 offset:4096
  v_mfma_f32_16x16x32_bf16 v[176:179], v[84:87], v[64:67], 0
  ds_read_b128 v[116:119], v145 offset:6144
  v_mfma_f32_16x16x32_bf16 v[192:195], v[88:91], v[64:67], 0
  ds_read_b64_tr_b16 v[124:125], v147 offset:0
  v_mfma_f32_16x16x32_bf16 v[196:199], v[88:91], v[68:71], 0
  ds_read_b64_tr_b16 v[126:127], v147 offset:512
  v_mfma_f32_16x16x32_bf16 v[200:203], v[88:91], v[72:75], 0
  ds_read_b64_tr_b16 v[128:129], v146 offset:4096
  v_mfma_f32_16x16x32_bf16 v[204:207], v[88:91], v[76:79], 0
  ds_read_b64_tr_b16 v[130:131], v146 offset:4608
  v_mfma_f32_16x16x32_bf16 v[220:223], v[92:95], v[76:79], 0
  ds_read_b64_tr_b16 v[132:133], v147 offset:4096
  v_mfma_f32_16x16x32_bf16 v[216:219], v[92:95], v[72:75], 0
  ds_read_b64_tr_b16 v[134:135], v147 offset:4608
  v_mfma_f32_16x16x32_bf16 v[212:215], v[92:95], v[68:71], 0
  ds_read_b64_tr_b16 v[136:137], v146 offset:8192
  v_mfma_f32_16x16x32_bf16 v[208:211], v[92:95], v[64:67], 0
  ds_read_b64_tr_b16 v[138:139], v146 offset:8704
  v_mfma_f32_16x16x32_bf16 v[224:227], v[64:67], v[96:99], 0
  ds_read_b64_tr_b16 v[140:141], v147 offset:8192
  v_mfma_f32_16x16x32_bf16 v[228:231], v[68:71], v[96:99], 0
  ds_read_b64_tr_b16 v[142:143], v147 offset:8704
  v_mfma_f32_16x16x32_bf16 v[232:235], v[72:75], v[96:99], 0
  ds_read_b32 v151, v150
  s_add_u32 s30, s30, 12288
  v_mfma_f32_16x16x32_bf16 v[236:239], v[76:79], v[96:99], 0
  s_mov_b64 exec, 1
  buffer_load_dword off, s[64:67], s31 lds
  s_mov_b64 exec, -1
  s_cmp_eq_u32 s30, 86016
  v_mfma_f32_16x16x32_bf16 v[252:255], v[76:79], v[100:103], 0
  s_cselect_b32 s30, 0, s30
  s_add_u32 s31, s31, 4
  v_mfma_f32_16x16x32_bf16 v[248:251], v[72:75], v[100:103], 0
  v_add_u32 v146, s30, v148
  s_add_u32 s33, s33, 1
  v_mfma_f32_16x16x32_bf16 v[244:247], v[68:71], v[100:103], 0
  v_add_u32 v147, s30, v149
  v_mfma_f32_16x16x32_bf16 v[240:243], v[64:67], v[100:103], 0
  s_branch .g2_kernel_q_s1
  .p2align 6
.g2_kernel_q_loop:
  s_waitcnt lgkmcnt(0)
  v_mfma_f32_16x16x32_bf16 v[160:163], v[120:123], v[104:107], v[160:163]
  v_cmp_lt_i32 vcc, s33, v151
  v_mfma_f32_16x16x32_bf16 v[164:167], v[120:123], v[108:111], v[164:167]
  s_cbranch_vccz .g2_kernel_q_w7
.g2_kernel_q_back7:
  v_mfma_f32_16x16x32_bf16 v[168:171], v[120:123], v[112:115], v[168:171]
  ds_read_b64_tr_b16 v[80:81], v146 offset:0
  v_mfma_f32_16x16x32_bf16 v[172:175], v[120:123], v[116:119], v[172:175]
  ds_read_b64_tr_b16 v[82:83], v146 offset:512
  v_mfma_f32_16x16x32_bf16 v[188:191], v[124:127], v[116:119], v[188:191]
  ds_read_b128 v[64:67], v144 offset:0
  v_mfma_f32_16x16x32_bf16 v[184:187], v[124:127], v[112:115], v[184:187]
  ds_read_b128 v[68:71], v144 offset:2048
  v_mfma_f32_16x16x32_bf16 v[180:183], v[124:127], v[108:111], v[180:183]
  ds_read_b128 v[72:75], v144 offset:4096
  v_mfma_f32_16x16x32_bf16 v[176:179], v[124:127], v[104:107], v[176:179]
  ds_read_b128 v[76:79], v144 offset:6144
  v_mfma_f32_16x16x32_bf16 v[192:195], v[128:131], v[104:107], v[192:195]
  ds_read_b64_tr_b16 v[84:85], v147 offset:0
  v_mfma_f32_16x16x32_bf16 v[196:199], v[128:131], v[108:111], v[196:199]
  ds_read_b64_tr_b16 v[86:87], v147 offset:512
  v_mfma_f32_16x16x32_bf16 v[200:203], v[128:131], v[112:115], v[200:203]
  ds_read_b64_tr_b16 v[88:89], v146 offset:4096
  v_mfma_f32_16x16x32_bf16 v[204:207], v[128:131], v[116:119], v[204:207]
  ds_read_b64_tr_b16 v[90:91], v146 offset:4608
  v_mfma_f32_16x16x32_bf16 v[220:223], v[132:135], v[116:119], v[220:223]
  ds_read_b64_tr_b16 v[92:93], v147 offset:4096
  v_mfma_f32_16x16x32_bf16 v[216:219], v[132:135], v[112:115], v[216:219]
  ds_read_b64_tr_b16 v[94:95], v147 offset:4608
  v_mfma_f32_16x16x32_bf16 v[212:215], v[132:135], v[108:111], v[212:215]
  ds_read_b64_tr_b16 v[96:97], v146 offset:8192
  v_mfma_f32_16x16x32_bf16 v[208:211], v[132:135], v[104:107], v[208:211]
  ds_read_b64_tr_b16 v[98:99], v146 offset:8704
  v_mfma_f32_16x16x32_bf16 v[224:227], v[104:107], v[136:139], v[224:227]
  ds_read_b64_tr_b16 v[100:101], v147 offset:8192
  v_mfma_f32_16x16x32_bf16 v[228:231], v[108:111], v[136:139], v[228:231]
  ds_read_b64_tr_b16 v[102:103], v147 offset:8704
  v_mfma_f32_16x16x32_bf16 v[232:235], v[112:115], v[136:139], v[232:235]
  ds_read_b32 v151, v150
  s_add_u32 s30, s30, 12288
  v_mfma_f32_16x16x32_bf16 v[236:239], v[116:119], v[136:139], v[236:239]
  s_mov_b64 exec, 1
  buffer_load_dword off, s[64:67], s31 lds
  s_mov_b64 exec, -1
  s_cmp_eq_u32 s30, 86016
  v_mfma_f32_16x16x32_bf16 v[252:255], v[116:119], v[140:143], v[252:255]
  s_cselect_b32 s30, 0, s30
  s_add_u32 s31, s31, 4
  v_mfma_f32_16x16x32_bf16 v[248:251], v[112:115], v[140:143], v[248:251]
  v_add_u32 v146, s30, v148
  s_add_u32 s33, s33, 1
  v_mfma_f32_16x16x32_bf16 v[244:247], v[108:111], v[140:143], v[244:247]
  v_add_u32 v147, s30, v149
  v_mfma_f32_16x16x32_bf16 v[240:243], v[104:107], v[140:143], v[240:243]
  s_waitcnt lgkmcnt(0)
  v_mfma_f32_16x16x32_bf16 v[160:163], v[80:83], v[64:67], v[160:163]
  v_cmp_lt_i32 vcc, s33, v151
  v_mfma_f32_16x16x32_bf16 v[164:167], v[80:83], v[68:71], v[164:167]
  s_cbranch_vccz .g2_kernel_q_w0
.g2_kernel_q_back0:
  v_mfma_f32_16x16x32_bf16 v[168:171], v[80:83], v[72:75], v[168:171]
  ds_read_b64_tr_b16 v[120:121], v146 offset:0
  v_mfma_f32_16x16x32_bf16 v[172:175], v[80:83], v[76:79], v[172:175]
  ds_read_b64_tr_b16 v[122:123], v146 offset:512
  v_mfma_f32_16x16x32_bf16 v[188:191], v[84:87], v[76:79], v[188:191]
  ds_read_b128 v[104:107], v145 offset:0
  v_mfma_f32_16x16x32_bf16 v[184:187], v[84:87], v[72:75], v[184:187]
  ds_read_b128 v[108:111], v145 offset:2048
  v_mfma_f32_16x16x32_bf16 v[180:183], v[84:87], v[68:71], v[180:183]
  ds_read_b128 v[112:115], v145 offset:4096
  v_mfma_f32_16x16x32_bf16 v[176:179], v[84:87], v[64:67], v[176:179]
  ds_read_b128 v[116:119], v145 offset:6144
  v_mfma_f32_16x16x32_bf16 v[192:195], v[88:91], v[64:67], v[192:195]
  ds_read_b64_tr_b16 v[124:125], v147 offset:0
  v_mfma_f32_16x16x32_bf16 v[196:199], v[88:91], v[68:71], v[196:199]
  ds_read_b64_tr_b16 v[126:127], v147 offset:512
  v_mfma_f32_16x16x32_bf16 v[200:203], v[88:91], v[72:75], v[200:203]
  ds_read_b64_tr_b16 v[128:129], v146 offset:4096
  v_mfma_f32_16x16x32_bf16 v[204:207], v[88:91], v[76:79], v[204:207]
  ds_read_b64_tr_b16 v[130:131], v146 offset:4608
  v_mfma_f32_16x16x32_bf16 v[220:223], v[92:95], v[76:79], v[220:223]
  ds_read_b64_tr_b16 v[132:133], v147 offset:4096
  v_mfma_f32_16x16x32_bf16 v[216:219], v[92:95], v[72:75], v[216:219]
  ds_read_b64_tr_b16 v[134:135], v147 offset:4608
  v_mfma_f32_16x16x32_bf16 v[212:215], v[92:95], v[68:71], v[212:215]
  ds_read_b64_tr_b16 v[136:137], v146 offset:8192
  v_mfma_f32_16x16x32_bf16 v[208:211], v[92:95], v[64:67], v[208:211]
  ds_read_b64_tr_b16 v[138:139], v146 offset:8704
  v_mfma_f32_16x16x32_bf16 v[224:227], v[64:67], v[96:99], v[224:227]
  ds_read_b64_tr_b16 v[140:141], v147 offset:8192
  v_mfma_f32_16x16x32_bf16 v[228:231], v[68:71], v[96:99], v[228:231]
  ds_read_b64_tr_b16 v[142:143], v147 offset:8704
  v_mfma_f32_16x16x32_bf16 v[232:235], v[72:75], v[96:99], v[232:235]
  ds_read_b32 v151, v150
  s_add_u32 s30, s30, 12288
  v_mfma_f32_16x16x32_bf16 v[236:239], v[76:79], v[96:99], v[236:239]
  s_mov_b64 exec, 1
  buffer_load_dword off, s[64:67], s31 lds
  s_mov_b64 exec, -1
  s_cmp_eq_u32 s30, 86016
  v_mfma_f32_16x16x32_bf16 v[252:255], v[76:79], v[100:103], v[252:255]
  s_cselect_b32 s30, 0, s30
  s_add_u32 s31, s31, 4
  v_mfma_f32_16x16x32_bf16 v[248:251], v[72:75], v[100:103], v[248:251]
  v_add_u32 v146, s30, v148
  s_add_u32 s33, s33, 1
  v_mfma_f32_16x16x32_bf16 v[244:247], v[68:71], v[100:103], v[244:247]
  v_add_u32 v147, s30, v149
  v_mfma_f32_16x16x32_bf16 v[240:243], v[64:67], v[100:103], v[240:243]
.g2_kernel_q_s1:
  s_waitcnt lgkmcnt(0)
  v_mfma_f32_16x16x32_bf16 v[160:163], v[120:123], v[104:107], v[160:163]
  v_cmp_lt_i32 vcc, s33, v151
  v_mfma_f32_16x16x32_bf16 v[164:167], v[120:123], v[108:111], v[164:167]
  s_cbranch_vccz .g2_kernel_q_w1
.g2_kernel_q_back1:
  v_mfma_f32_16x16x32_bf16 v[168:171], v[120:123], v[112:115], v[168:171]
  ds_read_b64_tr_b16 v[80:81], v146 offset:0
  v_mfma_f32_16x16x32_bf16 v[172:175], v[120:123], v[116:119], v[172:175]
  ds_read_b64_tr_b16 v[82:83], v146 offset:512
  v_mfma_f32_16x16x32_bf16 v[188:191], v[124:127], v[116:119], v[188:191]
  ds_read_b128 v[64:67], v144 offset:16384
  v_mfma_f32_16x16x32_bf16 v[184:187], v[124:127], v[112:115], v[184:187]
  ds_read_b128 v[68:71], v144 offset:18432
  v_mfma_f32_16x16x32_bf16 v[180:183], v[124:127], v[108:111], v[180:183]
  ds_read_b128 v[72:75], v144 offset:20480
  v_mfma_f32_16x16x32_bf16 v[176:179], v[124:127], v[104:107], v[176:179]
  ds_read_b128 v[76:79], v144 offset:22528
  v_mfma_f32_16x16x32_bf16 v[192:195], v[128:131], v[104:107], v[192:195]
  ds_read_b64_tr_b16 v[84:85], v147 offset:0
  v_mfma_f32_16x16x32_bf16 v[196:199], v[128:131], v[108:111], v[196:199]
  ds_read_b64_tr_b16 v[86:87], v147 offset:512
  v_mfma_f32_16x16x32_bf16 v[200:203], v[128:131], v[112:115], v[200:203]
  ds_read_b64_tr_b16 v[88:89], v146 offset:4096
  v_mfma_f32_16x16x32_bf16 v[204:207], v[128:131], v[116:119], v[204:207]
  ds_read_b64_tr_b16 v[90:91], v146 offset:4608
  v_mfma_f32_16x16x32_bf16 v[220:223], v[132:135], v[116:119], v[220:223]
  ds_read_b64_tr_b16 v[92:93], v147 offset:4096
  v_mfma_f32_16x16x32_bf16 v[216:219], v[132:135], v[112:115], v[216:219]
  ds_read_b64_tr_b16 v[94:95], v147 offset:4608
  v_mfma_f32_16x16x32_bf16 v[212:215], v[132:135], v[108:111], v[212:215]
  ds_read_b64_tr_b16 v[96:97], v146 offset:8192
  v_mfma_f32_16x16x32_bf16 v[208:211], v[132:135], v[104:107], v[208:211]
  ds_read_b64_tr_b16 v[98:99], v146 offset:8704
  v_mfma_f32_16x16x32_bf16 v[224:227], v[104:107], v[136:139], v[224:227]
  ds_read_b64_tr_b16 v[100:101], v147 offset:8192
  v_mfma_f32_16x16x32_bf16 v[228:231], v[108:111], v[136:139], v[228:231]
  ds_read_b64_tr_b16 v[102:103], v147 offset:8704
  v_mfma_f32_16x16x32_bf16 v[232:235], v[112:115], v[136:139], v[232:235]
  ds_read_b32 v151, v150
  s_add_u32 s30, s30, 12288
  v_mfma_f32_16x16x32_bf16 v[236:239], v[116:119], v[136:139], v[236:239]
  s_mov_b64 exec, 1
  buffer_load_dword off, s[64:67], s31 lds
  s_mov_b64 exec, -1
  s_cmp_eq_u32 s30, 86016
  v_mfma_f32_16x16x32_bf16 v[252:255], v[116:119], v[140:143], v[252:255]
  s_cselect_b32 s30, 0, s30
  s_add_u32 s31, s31, 4
  v_mfma_f32_16x16x32_bf16 v[248:251], v[112:115], v[140:143], v[248:251]
  v_add_u32 v146, s30, v148
  s_add_u32 s33, s33, 1
  v_mfma_f32_16x16x32_bf16 v[244:247], v[108:111], v[140:143], v[244:247]
  v_add_u32 v147, s30, v149
  v_mfma_f32_16x16x32_bf16 v[240:243], v[104:107], v[140:143], v[240:243]
  s_waitcnt lgkmcnt(0)
  v_mfma_f32_16x16x32_bf16 v[160:163], v[80:83], v[64:67], v[160:163]
  v_cmp_lt_i32 vcc, s33, v151
  v_mfma_f32_16x16x32_bf16 v[164:167], v[80:83], v[68:71], v[164:167]
  s_cbranch_vccz .g2_kernel_q_w2
.g2_kernel_q_back2:
  v_mfma_f32_16x16x32_bf16 v[168:171], v[80:83], v[72:75], v[168:171]
  ds_read_b64_tr_b16 v[120:121], v146 offset:0
  v_mfma_f32_16x16x32_bf16 v[172:175], v[80:83], v[76:79], v[172:175]
  ds_read_b64_tr_b16 v[122:123], v146 offset:512
  v_mfma_f32_16x16x32_bf16 v[188:191], v[84:87], v[76:79], v[188:191]
  ds_read_b128 v[104:107], v145 offset:16384
  v_mfma_f32_16x16x32_bf16 v[184:187], v[84:87], v[72:75], v[184:187]
  ds_read_b128 v[108:111], v145 offset:18432
  v_mfma_f32_16x16x32_bf16 v[180:183], v[84:87], v[68:71], v[180:183]
  ds_read_b128 v[112:115], v145 offset:20480
  v_mfma_f32_16x16x32_bf16 v[176:179], v[84:87], v[64:67], v[176:179]
  ds_read_b128 v[116:119], v145 offset:22528
  v_mfma_f32_16x16x32_bf16 v[192:195], v[88:91], v[64:67], v[192:195]
  ds_read_b64_tr_b16 v[124:125], v147 offset:0
  v_mfma_f32_16x16x32_bf16 v[196:199], v[88:91], v[68:71], v[196:199]
  ds_read_b64_tr_b16 v[126:127], v147 offset:512
  v_mfma_f32_16x16x32_bf16 v[200:203], v[88:91], v[72:75], v[200:203]
  ds_read_b64_tr_b16 v[128:129], v146 offset:4096
  v_mfma_f32_16x16x32_bf16 v[204:207], v[88:91], v[76:79], v[204:207]
  ds_read_b64_tr_b16 v[130:131], v146 offset:4608
  v_mfma_f32_16x16x32_bf16 v[220:223], v[92:95], v[76:79], v[220:223]
  ds_read_b64_tr_b16 v[132:133], v147 offset:4096
  v_mfma_f32_16x16x32_bf16 v[216:219], v[92:95], v[72:75], v[216:219]
  ds_read_b64_tr_b16 v[134:135], v147 offset:4608
  v_mfma_f32_16x16x32_bf16 v[212:215], v[92:95], v[68:71], v[212:215]
  ds_read_b64_tr_b16 v[136:137], v146 offset:8192
  v_mfma_f32_16x16x32_bf16 v[208:211], v[92:95], v[64:67], v[208:211]
  ds_read_b64_tr_b16 v[138:139], v146 offset:8704
  v_mfma_f32_16x16x32_bf16 v[224:227], v[64:67], v[96:99], v[224:227]
  ds_read_b64_tr_b16 v[140:141], v147 offset:8192
  v_mfma_f32_16x16x32_bf16 v[228:231], v[68:71], v[96:99], v[228:231]
  ds_read_b64_tr_b16 v[142:143], v147 offset:8704
  v_mfma_f32_16x16x32_bf16 v[232:235], v[72:75], v[96:99], v[232:235]
  ds_read_b32 v151, v150
  s_add_u32 s30, s30, 12288
  v_mfma_f32_16x16x32_bf16 v[236:239], v[76:79], v[96:99], v[236:239]
  s_mov_b64 exec, 1
  buffer_load_dword off, s[64:67], s31 lds
  s_mov_b64 exec, -1
  s_cmp_eq_u32 s30, 86016
  v_mfma_f32_16x16x32_bf16 v[252:255], v[76:79], v[100:103], v[252:255]
  s_cselect_b32 s30, 0, s30
  s_add_u32 s31, s31, 4
  v_mfma_f32_16x16x32_bf16 v[248:251], v[72:75], v[100:103], v[248:251]
  v_add_u32 v146, s30, v148
  s_add_u32 s33, s33, 1
  v_mfma_f32_16x16x32_bf16 v[244:247], v[68:71], v[100:103], v[244:247]
  v_add_u32 v147, s30, v149
  v_mfma_f32_16x16x32_bf16 v[240:243], v[64:67], v[100:103], v[240:243]
  s_waitcnt lgkmcnt(0)
  v_mfma_f32_16x16x32_bf16 v[160:163], v[120:123], v[104:107], v[160:163]
  v_cmp_lt_i32 vcc, s33, v151
  v_mfma_f32_16x16x32_bf16 v[164:167], v[120:123], v[108:111], v[164:167]
  s_cbranch_vccz .g2_kernel_q_w3
.g2_kernel_q_back3:
  v_mfma_f32_16x16x32_bf16 v[168:171], v[120:123], v[112:115], v[168:171]
  ds_read_b64_tr_b16 v[80:81], v146 offset:0
  v_mfma_f32_16x16x32_bf16 v[172:175], v[120:123], v[116:119], v[172:175]
  ds_read_b64_tr_b16 v[82:83], v146 offset:512
  v_mfma_f32_16x16x32_bf16 v[188:191], v[124:127], v[116:119], v[188:191]
  ds_read_b128 v[64:67], v144 offset:32768
  v_mfma_f32_16x16x32_bf16 v[184:187], v[124:127], v[112:115], v[184:187]
  ds_read_b128 v[68:71], v144 offset:34816
  v_mfma_f32_16x16x32_bf16 v[180:183], v[124:127], v[108:111], v[180:183]
  ds_read_b128 v[72:75], v144 offset:36864
  v_mfma_f32_16x16x32_bf16 v[176:179], v[124:127], v[104:107], v[176:179]
  ds_read_b128 v[76:79], v144 offset:38912
  v_mfma_f32_16x16x32_bf16 v[192:195], v[128:131], v[104:107], v[192:195]
  ds_read_b64_tr_b16 v[84:85], v147 offset:0
  v_mfma_f32_16x16x32_bf16 v[196:199], v[128:131], v[108:111], v[196:199]
  ds_read_b64_tr_b16 v[86:87], v147 offset:512
  v_mfma_f32_16x16x32_bf16 v[200:203], v[128:131], v[112:115], v[200:203]
  ds_read_b64_tr_b16 v[88:89], v146 offset:4096
  v_mfma_f32_16x16x32_bf16 v[204:207], v[128:131], v[116:119], v[204:207]
  ds_read_b64_tr_b16 v[90:91], v146 offset:4608
  v_mfma_f32_16x16x32_bf16 v[220:223], v[132:135], v[116:119], v[220:223]
  ds_read_b64_tr_b16 v[92:93], v147 offset:4096
  v_mfma_f32_16x16x32_bf16 v[216:219], v[132:135], v[112:115], v[216:219]
  ds_read_b64_tr_b16 v[94:95], v147 offset:4608
  v_mfma_f32_16x16x32_bf16 v[212:215], v[132:135], v[108:111], v[212:215]
  ds_read_b64_tr_b16 v[96:97], v146 offset:8192
  v_mfma_f32_16x16x32_bf16 v[208:211], v[132:135], v[104:107], v[208:211]
  ds_read_b64_tr_b16 v[98:99], v146 offset:8704
  v_mfma_f32_16x16x32_bf16 v[224:227], v[104:107], v[136:139], v[224:227]
  ds_read_b64_tr_b16 v[100:101], v147 offset:8192
  v_mfma_f32_16x16x32_bf16 v[228:231], v[108:111], v[136:139], v[228:231]
  ds_read_b64_tr_b16 v[102:103], v147 offset:8704
  v_mfma_f32_16x16x32_bf16 v[232:235], v[112:115], v[136:139], v[232:235]
  ds_read_b32 v151, v150
  s_add_u32 s30, s30, 12288
  v_mfma_f32_16x16x32_bf16 v[236:239], v[116:119], v[136:139], v[236:239]
  s_mov_b64 exec, 1
  buffer_load_dword off, s[64:67], s31 lds
  s_mov_b64 exec, -1
  s_cmp_eq_u32 s30, 86016
  v_mfma_f32_16x16x32_bf16 v[252:255], v[116:119], v[140:143], v[252:255]
  s_cselect_b32 s30, 0, s30
  s_add_u32 s31, s31, 4
  v_mfma_f32_16x16x32_bf16 v[248:251], v[112:115], v[140:143], v[248:251]
  v_add_u32 v146, s30, v148
  s_add_u32 s33, s33, 1
  v_mfma_f32_16x16x32_bf16 v[244:247], v[108:111], v[140:143], v[244:247]
  v_add_u32 v147, s30, v149
  v_mfma_f32_16x16x32_bf16 v[240:243], v[104:107], v[140:143], v[240:243]
  s_waitcnt lgkmcnt(0)
  v_mfma_f32_16x16x32_bf16 v[160:163], v[80:83], v[64:67], v[160:163]
  v_cmp_lt_i32 vcc, s33, v151
  v_mfma_f32_16x16x32_bf16 v[164:167], v[80:83], v[68:71], v[164:167]
  s_cbranch_vccz .g2_kernel_q_w4
.g2_kernel_q_back4:
  v_mfma_f32_16x16x32_bf16 v[168:171], v[80:83], v[72:75], v[168:171]
  ds_read_b64_tr_b16 v[120:121], v146 offset:0
  v_mfma_f32_16x16x32_bf16 v[172:175], v[80:83], v[76:79], v[172:175]
  ds_read_b64_tr_b16 v[122:123], v146 offset:512
  v_mfma_f32_16x16x32_bf16 v[188:191], v[84:87], v[76:79], v[188:191]
  ds_read_b128 v[104:107], v145 offset:32768
  v_mfma_f32_16x16x32_bf16 v[184:187], v[84:87], v[72:75], v[184:187]
  ds_read_b128 v[108:111], v145 offset:34816
  v_mfma_f32_16x16x32_bf16 v[180:183], v[84:87], v[68:71], v[180:183]
  ds_read_b128 v[112:115], v145 offset:36864
  v_mfma_f32_16x16x32_bf16 v[176:179], v[84:87], v[64:67], v[176:179]
  ds_read_b128 v[116:119], v145 offset:38912
  v_mfma_f32_16x16x32_bf16 v[192:195], v[88:91], v[64:67], v[192:195]
  ds_read_b64_tr_b16 v[124:125], v147 offset:0
  v_mfma_f32_16x16x32_bf16 v[196:199], v[88:91], v[68:71], v[196:199]
  ds_read_b64_tr_b16 v[126:127], v147 offset:512
  v_mfma_f32_16x16x32_bf16 v[200:203], v[88:91], v[72:75], v[200:203]
  ds_read_b64_tr_b16 v[128:129], v146 offset:4096
  v_mfma_f32_16x16x32_bf16 v[204:207], v[88:91], v[76:79], v[204:207]
  ds_read_b64_tr_b16 v[130:131], v146 offset:4608
  v_mfma_f32_16x16x32_bf16 v[220:223], v[92:95], v[76:79], v[220:223]
  ds_read_b64_tr_b16 v[132:133], v147 offset:4096
  v_mfma_f32_16x16x32_bf16 v[216:219], v[92:95], v[72:75], v[216:219]
  ds_read_b64_tr_b16 v[134:135], v147 offset:4608
  v_mfma_f32_16x16x32_bf16 v[212:215], v[92:95], v[68:71], v[212:215]
  ds_read_b64_tr_b16 v[136:137], v146 offset:8192
  v_mfma_f32_16x16x32_bf16 v[208:211], v[92:95], v[64:67], v[208:211]
  ds_read_b64_tr_b16 v[138:139], v146 offset:8704
  v_mfma_f32_16x16x32_bf16 v[224:227], v[64:67], v[96:99], v[224:227]
  ds_read_b64_tr_b16 v[140:141], v147 offset:8192
  v_mfma_f32_16x16x32_bf16 v[228:231], v[68:71], v[96:99], v[228:231]
  ds_read_b64_tr_b16 v[142:143], v147 offset:8704
  v_mfma_f32_16x16x32_bf16 v[232:235], v[72:75], v[96:99], v[232:235]
  ds_read_b32 v151, v150
  s_add_u32 s30, s30, 12288
  v_mfma_f32_16x16x32_bf16 v[236:239], v[76:79], v[96:99], v[236:239]
  s_mov_b64 exec, 1
  buffer_load_dword off, s[64:67], s31 lds
  s_mov_b64 exec, -1
  s_cmp_eq_u32 s30, 86016
  v_mfma_f32_16x16x32_bf16 v[252:255], v[76:79], v[100:103], v[252:255]
  s_cselect_b32 s30, 0, s30
  s_add_u32 s31, s31, 4
  v_mfma_f32_16x16x32_bf16 v[248:251], v[72:75], v[100:103], v[248:251]
  v_add_u32 v146, s30, v148
  s_add_u32 s33, s33, 1
  v_mfma_f32_16x16x32_bf16 v[244:247], v[68:71], v[100:103], v[244:247]
  v_add_u32 v147, s30, v149
  v_mfma_f32_16x16x32_bf16 v[240:243], v[64:67], v[100:103], v[240:243]
  s_waitcnt lgkmcnt(0)
  v_mfma_f32_16x16x32_bf16 v[160:163], v[120:123], v[104:107], v[160:163]
  v_cmp_lt_i32 vcc, s33, v151
  v_mfma_f32_16x16x32_bf16 v[164:167], v[120:123], v[108:111], v[164:167]
  s_cbranch_vccz .g2_kernel_q_w5
.g2_kernel_q_back5:
  v_mfma_f32_16x16x32_bf16 v[168:171], v[120:123], v[112:115], v[168:171]
  ds_read_b64_tr_b16 v[80:81], v146 offset:0
  v_mfma_f32_16x16x32_bf16 v[172:175], v[120:123], v[116:119], v[172:175]
  ds_read_b64_tr_b16 v[82:83], v146 offset:512
  v_mfma_f32_16x16x32_bf16 v[188:191], v[124:127], v[116:119], v[188:191]
  ds_read_b128 v[64:67], v144 offset:49152
  v_mfma_f32_16x16x32_bf16 v[184:187], v[124:127], v[112:115], v[184:187]
  ds_read_b128 v[68:71], v144 offset:51200
  v_mfma_f32_16x16x32_bf16 v[180:183], v[124:127], v[108:111], v[180:183]
  ds_read_b128 v[72:75], v144 offset:53248
  v_mfma_f32_16x16x32_bf16 v[176:179], v[124:127], v[104:107], v[176:179]
  ds_read_b128 v[76:79], v144 offset:55296
  v_mfma_f32_16x16x32_bf16 v[192:195], v[128:131], v[104:107], v[192:195]
  ds_read_b64_tr_b16 v[84:85], v147 offset:0
  v_mfma_f32_16x16x32_bf16 v[196:199], v[128:131], v[108:111], v[196:199]
  ds_read_b64_tr_b16 v[86:87], v147 offset:512
  v_mfma_f32_16x16x32_bf16 v[200:203], v[128:131], v[112:115], v[200:203]
  ds_read_b64_tr_b16 v[88:89], v146 offset:4096
  v_mfma_f32_16x16x32_bf16 v[204:207], v[128:131], v[116:119], v[204:207]
  ds_read_b64_tr_b16 v[90:91], v146 offset:4608
  v_mfma_f32_16x16x32_bf16 v[220:223], v[132:135], v[116:119], v[220:223]
  ds_read_b64_tr_b16 v[92:93], v147 offset:4096
  v_mfma_f32_16x16x32_bf16 v[216:219], v[132:135], v[112:115], v[216:219]
  ds_read_b64_tr_b16 v[94:95], v147 offset:4608
  v_mfma_f32_16x16x32_bf16 v[212:215], v[132:135], v[108:111], v[212:215]
  ds_read_b64_tr_b16 v[96:97], v146 offset:8192
  v_mfma_f32_16x16x32_bf16 v[208:211], v[132:135], v[104:107], v[208:211]
  ds_read_b64_tr_b16 v[98:99], v146 offset:8704
  v_mfma_f32_16x16x32_bf16 v[224:227], v[104:107], v[136:139], v[224:227]
  ds_read_b64_tr_b16 v[100:101], v147 offset:8192
  v_mfma_f32_16x16x32_bf16 v[228:231], v[108:111], v[136:139], v[228:231]
  ds_read_b64_tr_b16 v[102:103], v147 offset:8704
  v_mfma_f32_16x16x32_bf16 v[232:235], v[112:115], v[136:139], v[232:235]
  ds_read_b32 v151, v150
  s_add_u32 s30, s30, 12288
  v_mfma_f32_16x16x32_bf16 v[236:239], v[116:119], v[136:139], v[236:239]
  s_mov_b64 exec, 1
  buffer_load_dword off, s[64:67], s31 lds
  s_mov_b64 exec, -1
  s_cmp_eq_u32 s30, 86016
  v_mfma_f32_16x16x32_bf16 v[252:255], v[116:119], v[140:143], v[252:255]
  s_cselect_b32 s30, 0, s30
  s_add_u32 s31, s31, 4
  v_mfma_f32_16x16x32_bf16 v[248:251], v[112:115], v[140:143], v[248:251]
  v_add_u32 v146, s30, v148
  s_add_u32 s33, s33, 1
  v_mfma_f32_16x16x32_bf16 v[244:247], v[108:111], v[140:143], v[244:247]
  v_add_u32 v147, s30, v149
  v_mfma_f32_16x16x32_bf16 v[240:243], v[104:107], v[140:143], v[240:243]
  s_cmp_eq_u32 s29, 3
  s_cbranch_scc1 .g2_kernel_q_out
  s_waitcnt lgkmcnt(0)
  v_mfma_f32_16x16x32_bf16 v[160:163], v[80:83], v[64:67], v[160:163]
  v_cmp_lt_i32 vcc, s33, v151
  v_mfma_f32_16x16x32_bf16 v[164:167], v[80:83], v[68:71], v[164:167]
  s_cbranch_vccz .g2_kernel_q_w6
.g2_kernel_q_back6:
  v_mfma_f32_16x16x32_bf16 v[168:171], v[80:83], v[72:75], v[168:171]
  ds_read_b64_tr_b16 v[120:121], v146 offset:0
  v_mfma_f32_16x16x32_bf16 v[172:175], v[80:83], v[76:79], v[172:175]
  ds_read_b64_tr_b16 v[122:123], v146 offset:512
  v_mfma_f32_16x16x32_bf16 v[188:191], v[84:87], v[76:79], v[188:191]
  ds_read_b128 v[104:107], v145 offset:49152
  v_mfma_f32_16x16x32_bf16 v[184:187], v[84:87], v[72:75], v[184:187]
  ds_read_b128 v[108:111], v145 offset:51200
  v_mfma_f32_16x16x32_bf16 v[180:183], v[84:87], v[68:71], v[180:183]
  ds_read_b128 v[112:115], v145 offset:53248
  v_mfma_f32_16x16x32_bf16 v[176:179], v[84:87], v[64:67], v[176:179]
  ds_read_b128 v[116:119], v145 offset:55296
  v_mfma_f32_16x16x32_bf16 v[192:195], v[88:91], v[64:67], v[192:195]
  ds_read_b64_tr_b16 v[124:125], v147 offset:0
  v_mfma_f32_16x16x32_bf16 v[196:199], v[88:91], v[68:71], v[196:199]
  ds_read_b64_tr_b16 v[126:127], v147 offset:512
  v_mfma_f32_16x16x32_bf16 v[200:203], v[88:91], v[72:75], v[200:203]
  ds_read_b64_tr_b16 v[128:129], v146 offset:4096
  v_mfma_f32_16x16x32_bf16 v[204:207], v[88:91], v[76:79], v[204:207]
  ds_read_b64_tr_b16 v[130:131], v146 offset:4608
  v_mfma_f32_16x16x32_bf16 v[220:223], v[92:95], v[76:79], v[220:223]
  ds_read_b64_tr_b16 v[132:133], v147 offset:4096
  v_mfma_f32_16x16x32_bf16 v[216:219], v[92:95], v[72:75], v[216:219]
  ds_read_b64_tr_b16 v[134:135], v147 offset:4608
  v_mfma_f32_16x16x32_bf16 v[212:215], v[92:95], v[68:71], v[212:215]
  ds_read_b64_tr_b16 v[136:137], v146 offset:8192
  v_mfma_f32_16x16x32_bf16 v[208:211], v[92:95], v[64:67], v[208:211]
  ds_read_b64_tr_b16 v[138:139], v146 offset:8704
  v_mfma_f32_16x16x32_bf16 v[224:227], v[64:67], v[96:99], v[224:227]
  ds_read_b64_tr_b16 v[140:141], v147 offset:8192
  v_mfma_f32_16x16x32_bf16 v[228:231], v[68:71], v[96:99], v[228:231]
  ds_read_b64_tr_b16 v[142:143], v147 offset:8704
  v_mfma_f32_16x16x32_bf16 v[232:235], v[72:75], v[96:99], v[232:235]
  ds_read_b32 v151, v150
  s_add_u32 s30, s30, 12288
  v_mfma_f32_16x16x32_bf16 v[236:239], v[76:79], v[96:99], v[236:239]
  s_mov_b64 exec, 1
  buffer_load_dword off, s[64:67], s31 lds
  s_mov_b64 exec, -1
  s_cmp_eq_u32 s30, 86016
  v_mfma_f32_16x16x32_bf16 v[252:255], v[76:79], v[100:103], v[252:255]
  s_cselect_b32 s30, 0, s30
  s_add_u32 s31, s31, 4
  v_mfma_f32_16x16x32_bf16 v[248:251], v[72:75], v[100:103], v[248:251]
  v_add_u32 v146, s30, v148
  s_add_u32 s33, s33, 1
  v_mfma_f32_16x16x32_bf16 v[244:247], v[68:71], v[100:103], v[244:247]
  v_add_u32 v147, s30, v149
  s_add_u32 s29, s29, 1
  v_mfma_f32_16x16x32_bf16 v[240:243], v[64:67], v[100:103], v[240:243]
  s_branch .g2_kernel_q_loop
.g2_kernel_q_out:
  s_add_u32 s33, s33, 0
  s_waitcnt lgkmcnt(0)
  v_cmp_lt_i32 vcc, s33, v151
  s_cbranch_vccz .g2_kernel_q_wl
.g2_kernel_q_bl:
  s_cmp_lg_u32 s10, 0
  s_cbranch_scc1 .g2_kernel_q_v1
  v_mfma_f32_16x16x32_bf16 v[192:195], v[88:91], v[64:67], v[192:195]
  ds_read_b64_tr_b16 v[80:81], v148 offset:40960
  ds_read_b64_tr_b16 v[82:83], v148 offset:41472
  ds_read_b128 v[128:131], v145 offset:49152
  v_mfma_f32_16x16x32_bf16 v[196:199], v[88:91], v[68:71], v[196:199]
  ds_read_b128 v[132:135], v145 offset:51200
  ds_read_b128 v[136:139], v145 offset:53248
  ds_read_b128 v[140:143], v145 offset:55296
  v_mfma_f32_16x16x32_bf16 v[200:203], v[88:91], v[72:75], v[200:203]
  ds_read_b64_tr_b16 v[84:85], v149 offset:40960
  ds_read_b64_tr_b16 v[86:87], v149 offset:41472
  ds_read_b32 v63, v13 offset:0
  v_mfma_f32_16x16x32_bf16 v[204:207], v[88:91], v[76:79], v[204:207]
  ds_read_b32 v57, v13 offset:24
  ds_read_b128 v[40:43], v52 offset:5120
  ds_read_b128 v[44:47], v52 offset:5184
  v_mfma_f32_16x16x32_bf16 v[220:223], v[92:95], v[76:79], v[220:223]
  ds_read_b32 v24, v50 offset:2816
  ds_read_b32 v25, v50 offset:3328
  ds_read_b32 v26, v50 offset:2880
  v_mfma_f32_16x16x32_bf16 v[216:219], v[92:95], v[72:75], v[216:219]
  ds_read_b32 v27, v50 offset:3392
  ds_read_b32 v28, v50 offset:2944
  ds_read_b32 v29, v50 offset:3456
  v_mfma_f32_16x16x32_bf16 v[212:215], v[92:95], v[68:71], v[212:215]
  ds_read_b32 v30, v50 offset:3008
  ds_read_b32 v31, v50 offset:3520
  v_mfma_f32_16x16x32_bf16 v[208:211], v[92:95], v[64:67], v[208:211]
  s_waitcnt lgkmcnt(12)
  v_mfma_f32_16x16x32_bf16 v[192:195], v[80:83], v[128:131], v[192:195]
  v_mfma_f32_16x16x32_bf16 v[196:199], v[80:83], v[132:135], v[196:199]
  v_mfma_f32_16x16x32_bf16 v[200:203], v[80:83], v[136:139], v[200:203]
  v_mfma_f32_16x16x32_bf16 v[204:207], v[80:83], v[140:143], v[204:207]
  v_mfma_f32_16x16x32_bf16 v[220:223], v[84:87], v[140:143], v[220:223]
  v_mfma_f32_16x16x32_bf16 v[216:219], v[84:87], v[136:139], v[216:219]
  v_mfma_f32_16x16x32_bf16 v[212:215], v[84:87], v[132:135], v[212:215]
  v_mfma_f32_16x16x32_bf16 v[208:211], v[84:87], v[128:131], v[208:211]
  s_waitcnt lgkmcnt(0)
  v_cmp_gt_u32 vcc, 2, v63
  s_cbranch_vccnz .g2_kernel_q_v0ew
.g2_kernel_q_v0eb:
  ds_read_b64_tr_b16 v[120:121], v148 offset:24576
  ds_read_b64_tr_b16 v[122:123], v148 offset:25088
  ds_read_b128 v[104:107], v144 offset:49152
  ds_read_b128 v[108:111], v144 offset:51200
  ds_read_b128 v[112:115], v144 offset:53248
  ds_read_b128 v[116:119], v144 offset:55296
  ds_read_b64_tr_b16 v[124:125], v149 offset:24576
  ds_read_b64_tr_b16 v[126:127], v149 offset:25088
  ds_read_b64_tr_b16 v[128:129], v148 offset:32768
  ds_read_b64_tr_b16 v[130:131], v148 offset:33280
  ds_read_b64_tr_b16 v[132:133], v149 offset:32768
  ds_read_b64_tr_b16 v[134:135], v149 offset:33280
  v_cmp_ne_u32 vcc, 0, v57
  s_cbranch_vccnz .g2_kernel_q_v0p
.g2_kernel_q_v0pb:
  v_pk_mul_f32 v[152:153], v[40:41], v[24:25] op_sel:[0,1] op_sel_hi:[1,1]
  v_pk_mul_f32 v[154:155], v[42:43], v[24:25] op_sel:[0,1] op_sel_hi:[1,1]
  v_pk_mul_f32 v[156:157], v[44:45], v[24:25] op_sel:[0,1] op_sel_hi:[1,1]
  v_pk_mul_f32 v[158:159], v[46:47], v[24:25] op_sel:[0,1] op_sel_hi:[1,1]
  v_pk_fma_f32 v[192:193], v[192:193], v[24:25], v[152:153] op_sel_hi:[1,0,1]
  v_pk_fma_f32 v[194:195], v[194:195], v[24:25], v[154:155] op_sel_hi:[1,0,1]
  v_pk_fma_f32 v[208:209], v[208:209], v[24:25], v[156:157] op_sel_hi:[1,0,1]
  v_pk_fma_f32 v[210:211], v[210:211], v[24:25], v[158:159] op_sel_hi:[1,0,1]
  v_cvt_pk_bf16_f32 v192, v192, v193
  v_cvt_pk_bf16_f32 v193, v194, v195
  v_cvt_pk_bf16_f32 v194, v208, v209
  v_cvt_pk_bf16_f32 v195, v210, v211
  buffer_store_dwordx4 v[192:195], v54, s[4:7], s8 offen offset:0 sc1
  v_pk_mul_f32 v[152:153], v[40:41], v[26:27] op_sel:[0,1] op_sel_hi:[1,1]
  v_pk_mul_f32 v[154:155], v[42:43], v[26:27] op_sel:[0,1] op_sel_hi:[1,1]
  v_pk_mul_f32 v[156:157], v[44:45], v[26:27] op_sel:[0,1] op_sel_hi:[1,1]
  v_pk_mul_f32 v[158:159], v[46:47], v[26:27] op_sel:[0,1] op_sel_hi:[1,1]
  v_pk_fma_f32 v[196:197], v[196:197], v[26:27], v[152:153] op_sel_hi:[1,0,1]
  v_pk_fma_f32 v[198:199], v[198:199], v[26:27], v[154:155] op_sel_hi:[1,0,1]
  v_pk_fma_f32 v[212:213], v[212:213], v[26:27], v[156:157] op_sel_hi:[1,0,1]
  v_pk_fma_f32 v[214:215], v[214:215], v[26:27], v[158:159] op_sel_hi:[1,0,1]
  v_cvt_pk_bf16_f32 v196, v196, v197
  v_cvt_pk_bf16_f32 v197, v198, v199
  v_cvt_pk_bf16_f32 v198, v212, v213
  v_cvt_pk_bf16_f32 v199, v214, v215
  buffer_store_dwordx4 v[196:199], v54, s[4:7], s8 offen offset:128 sc1
  v_pk_mul_f32 v[152:153], v[40:41], v[28:29] op_sel:[0,1] op_sel_hi:[1,1]
  v_pk_mul_f32 v[154:155], v[42:43], v[28:29] op_sel:[0,1] op_sel_hi:[1,1]
  v_pk_mul_f32 v[156:157], v[44:45], v[28:29] op_sel:[0,1] op_sel_hi:[1,1]
  v_pk_mul_f32 v[158:159], v[46:47], v[28:29] op_sel:[0,1] op_sel_hi:[1,1]
  v_pk_fma_f32 v[200:201], v[200:201], v[28:29], v[152:153] op_sel_hi:[1,0,1]
  v_pk_fma_f32 v[202:203], v[202:203], v[28:29], v[154:155] op_sel_hi:[1,0,1]
  v_pk_fma_f32 v[216:217], v[216:217], v[28:29], v[156:157] op_sel_hi:[1,0,1]
  v_pk_fma_f32 v[218:219], v[218:219], v[28:29], v[158:159] op_sel_hi:[1,0,1]
  v_cvt_pk_bf16_f32 v200, v200, v201
  v_cvt_pk_bf16_f32 v201, v202, v203
  v_cvt_pk_bf16_f32 v202, v216, v217
  v_cvt_pk_bf16_f32 v203, v218, v219
  buffer_store_dwordx4 v[200:203], v54, s[4:7], s9 offen offset:0 sc1
  v_pk_mul_f32 v[152:153], v[40:41], v[30:31] op_sel:[0,1] op_sel_hi:[1,1]
  v_pk_mul_f32 v[154:155], v[42:43], v[30:31] op_sel:[0,1] op_sel_hi:[1,1]
  v_pk_mul_f32 v[156:157], v[44:45], v[30:31] op_sel:[0,1] op_sel_hi:[1,1]
  v_pk_mul_f32 v[158:159], v[46:47], v[30:31] op_sel:[0,1] op_sel_hi:[1,1]
  v_pk_fma_f32 v[204:205], v[204:205], v[30:31], v[152:153] op_sel_hi:[1,0,1]
  v_pk_fma_f32 v[206:207], v[206:207], v[30:31], v[154:155] op_sel_hi:[1,0,1]
  v_pk_fma_f32 v[220:221], v[220:221], v[30:31], v[156:157] op_sel_hi:[1,0,1]
  v_pk_fma_f32 v[222:223], v[222:223], v[30:31], v[158:159] op_sel_hi:[1,0,1]
  v_cvt_pk_bf16_f32 v204, v204, v205
  v_cvt_pk_bf16_f32 v205, v206, v207
  v_cvt_pk_bf16_f32 v206, v220, v221
  v_cvt_pk_bf16_f32 v207, v222, v223
  buffer_store_dwordx4 v[204:207], v54, s[4:7], s9 offen offset:128 sc1
  s_waitcnt lgkmcnt(0)
  v_mfma_f32_16x16x32_bf16 v[160:163], v[120:123], v[104:107], v[160:163]
  ds_read_b64_tr_b16 v[80:81], v148 offset:36864
  ds_read_b64_tr_b16 v[82:83], v148 offset:37376
  v_mfma_f32_16x16x32_bf16 v[164:167], v[120:123], v[108:111], v[164:167]
  ds_read_b128 v[64:67], v145 offset:49152
  ds_read_b128 v[68:71], v145 offset:51200
  v_mfma_f32_16x16x32_bf16 v[168:171], v[120:123], v[112:115], v[168:171]
  ds_read_b128 v[72:75], v145 offset:53248
  ds_read_b128 v[76:79], v145 offset:55296
  v_mfma_f32_16x16x32_bf16 v[172:175], v[120:123], v[116:119], v[172:175]
  ds_read_b64_tr_b16 v[84:85], v149 offset:36864
  ds_read_b64_tr_b16 v[86:87], v149 offset:37376
  v_mfma_f32_16x16x32_bf16 v[188:191], v[124:127], v[116:119], v[188:191]
  ds_read_b64_tr_b16 v[88:89], v148 offset:45056
  ds_read_b64_tr_b16 v[90:91], v148 offset:45568
  v_mfma_f32_16x16x32_bf16 v[184:187], v[124:127], v[112:115], v[184:187]
  ds_read_b64_tr_b16 v[92:93], v149 offset:45056
  ds_read_b64_tr_b16 v[94:95], v149 offset:45568
  v_mfma_f32_16x16x32_bf16 v[180:183], v[124:127], v[108:111], v[180:183]
  v_mfma_f32_16x16x32_bf16 v[176:179], v[124:127], v[104:107], v[176:179]
  v_mfma_f32_16x16x32_bf16 v[224:227], v[104:107], v[128:131], v[224:227]
  v_mfma_f32_16x16x32_bf16 v[228:231], v[108:111], v[128:131], v[228:231]
  v_mfma_f32_16x16x32_bf16 v[232:235], v[112:115], v[128:131], v[232:235]
  v_mfma_f32_16x16x32_bf16 v[236:239], v[116:119], v[128:131], v[236:239]
  v_mfma_f32_16x16x32_bf16 v[252:255], v[116:119], v[132:135], v[252:255]
  v_mfma_f32_16x16x32_bf16 v[248:251], v[112:115], v[132:135], v[248:251]
  v_mfma_f32_16x16x32_bf16 v[244:247], v[108:111], v[132:135], v[244:247]
  v_mfma_f32_16x16x32_bf16 v[240:243], v[104:107], v[132:135], v[240:243]
  s_waitcnt lgkmcnt(0)
  v_mfma_f32_16x16x32_bf16 v[160:163], v[80:83], v[64:67], v[160:163]
  ds_read_b32 v63, v58
  ds_read_b128 v[32:35], v52 offset:4864
  v_mfma_f32_16x16x32_bf16 v[164:167], v[80:83], v[68:71], v[164:167]
  ds_read_b128 v[36:39], v52 offset:4928
  ds_read_b128 v[104:107], v51 offset:2816
  v_mfma_f32_16x16x32_bf16 v[168:171], v[80:83], v[72:75], v[168:171]
  ds_read_b128 v[120:123], v51 offset:3328
  ds_read_b128 v[108:111], v51 offset:2880
  v_mfma_f32_16x16x32_bf16 v[172:175], v[80:83], v[76:79], v[172:175]
  ds_read_b128 v[124:127], v51 offset:3392
  ds_read_b128 v[112:115], v51 offset:2944
  v_mfma_f32_16x16x32_bf16 v[188:191], v[84:87], v[76:79], v[188:191]
  ds_read_b128 v[128:131], v51 offset:3456
  ds_read_b128 v[116:119], v51 offset:3008
  v_mfma_f32_16x16x32_bf16 v[184:187], v[84:87], v[72:75], v[184:187]
  ds_read_b128 v[132:135], v51 offset:3520
  ds_read_b32 v48, v53 offset:5376
  v_mfma_f32_16x16x32_bf16 v[180:183], v[84:87], v[68:71], v[180:183]
  ds_read_b32 v49, v53 offset:5440
  v_mfma_f32_16x16x32_bf16 v[176:179], v[84:87], v[64:67], v[176:179]
  v_mfma_f32_16x16x32_bf16 v[224:227], v[64:67], v[88:91], v[224:227]
  v_mfma_f32_16x16x32_bf16 v[228:231], v[68:71], v[88:91], v[228:231]
  v_mfma_f32_16x16x32_bf16 v[232:235], v[72:75], v[88:91], v[232:235]
  v_mfma_f32_16x16x32_bf16 v[236:239], v[76:79], v[88:91], v[236:239]
  v_mfma_f32_16x16x32_bf16 v[252:255], v[76:79], v[92:95], v[252:255]
  v_mfma_f32_16x16x32_bf16 v[248:251], v[72:75], v[92:95], v[248:251]
  v_mfma_f32_16x16x32_bf16 v[244:247], v[68:71], v[92:95], v[244:247]
  v_mfma_f32_16x16x32_bf16 v[240:243], v[64:67], v[92:95], v[240:243]
  s_waitcnt lgkmcnt(0)
  v_cmp_gt_u32 vcc, s12, v63
  s_cbranch_vccnz .g2_kernel_q_v0fw
.g2_kernel_q_v0fc:
  s_cmp_ge_u32 s35, 0x200
  s_cbranch_scc1 .g2_kernel_q_v0r
.g2_kernel_q_v0rb:
  v_pk_mul_f32 v[24:25], v[24:25], v[56:57] op_sel_hi:[1,0]
  v_pk_mul_f32 v[26:27], v[26:27], v[56:57] op_sel_hi:[1,0]
  v_pk_mul_f32 v[28:29], v[28:29], v[56:57] op_sel_hi:[1,0]
  v_pk_mul_f32 v[30:31], v[30:31], v[56:57] op_sel_hi:[1,0]
  ds_write_b128 v59, v[192:195] offset:0
  v_pk_mul_f32 v[152:153], v[32:33], v[24:25] op_sel:[0,1] op_sel_hi:[1,1]
  v_pk_mul_f32 v[154:155], v[34:35], v[24:25] op_sel:[0,1] op_sel_hi:[1,1]
  v_pk_mul_f32 v[156:157], v[36:37], v[24:25] op_sel:[0,1] op_sel_hi:[1,1]
  v_pk_mul_f32 v[158:159], v[38:39], v[24:25] op_sel:[0,1] op_sel_hi:[1,1]
  v_pk_fma_f32 v[160:161], v[160:161], v[24:25], v[152:153] op_sel_hi:[1,0,1]
  v_pk_fma_f32 v[162:163], v[162:163], v[24:25], v[154:155] op_sel_hi:[1,0,1]
  v_pk_fma_f32 v[176:177], v[176:177], v[24:25], v[156:157] op_sel_hi:[1,0,1]
  v_pk_fma_f32 v[178:179], v[178:179], v[24:25], v[158:159] op_sel_hi:[1,0,1]
  v_cvt_pk_bf16_f32 v160, v160, v161
  v_cvt_pk_bf16_f32 v161, v162, v163
  v_cvt_pk_bf16_f32 v162, v176, v177
  v_cvt_pk_bf16_f32 v163, v178, v179
  ds_write_b128 v61, v[160:163] offset:0
  ds_write_b128 v59, v[196:199] offset:128
  v_pk_mul_f32 v[152:153], v[32:33], v[26:27] op_sel:[0,1] op_sel_hi:[1,1]
  v_pk_mul_f32 v[154:155], v[34:35], v[26:27] op_sel:[0,1] op_sel_hi:[1,1]
  v_pk_mul_f32 v[156:157], v[36:37], v[26:27] op_sel:[0,1] op_sel_hi:[1,1]
  v_pk_mul_f32 v[158:159], v[38:39], v[26:27] op_sel:[0,1] op_sel_hi:[1,1]
  v_pk_fma_f32 v[164:165], v[164:165], v[26:27], v[152:153] op_sel_hi:[1,0,1]
  v_pk_fma_f32 v[166:167], v[166:167], v[26:27], v[154:155] op_sel_hi:[1,0,1]
  v_pk_fma_f32 v[180:181], v[180:181], v[26:27], v[156:157] op_sel_hi:[1,0,1]
  v_pk_fma_f32 v[182:183], v[182:183], v[26:27], v[158:159] op_sel_hi:[1,0,1]
  v_cvt_pk_bf16_f32 v164, v164, v165
  v_cvt_pk_bf16_f32 v165, v166, v167
  v_cvt_pk_bf16_f32 v166, v180, v181
  v_cvt_pk_bf16_f32 v167, v182, v183
  ds_write_b128 v61, v[164:167] offset:256
  ds_write_b128 v59, v[200:203] offset:4096
  v_pk_mul_f32 v[152:153], v[32:33], v[28:29] op_sel:[0,1] op_sel_hi:[1,1]
  v_pk_mul_f32 v[154:155], v[34:35], v[28:29] op_sel:[0,1] op_sel_hi:[1,1]
  v_pk_mul_f32 v[156:157], v[36:37], v[28:29] op_sel:[0,1] op_sel_hi:[1,1]
  v_pk_mul_f32 v[158:159], v[38:39], v[28:29] op_sel:[0,1] op_sel_hi:[1,1]
  v_pk_fma_f32 v[168:169], v[168:169], v[28:29], v[152:153] op_sel_hi:[1,0,1]
  v_pk_fma_f32 v[170:171], v[170:171], v[28:29], v[154:155] op_sel_hi:[1,0,1]
  v_pk_fma_f32 v[184:185], v[184:185], v[28:29], v[156:157] op_sel_hi:[1,0,1]
  v_pk_fma_f32 v[186:187], v[186:187], v[28:29], v[158:159] op_sel_hi:[1,0,1]
  v_cvt_pk_bf16_f32 v168, v168, v169
  v_cvt_pk_bf16_f32 v169, v170, v171
  v_cvt_pk_bf16_f32 v170, v184, v185
  v_cvt_pk_bf16_f32 v171, v186, v187
  ds_write_b128 v61, v[168:171] offset:2048
  s_waitcnt vmcnt(0)
  s_mov_b64 exec, 1
  ds_add_rtn_u32 v7, v62, v5 offset:120
  s_mov_b64 exec, -1
  ds_write_b128 v59, v[204:207] offset:4224
  v_pk_mul_f32 v[152:153], v[32:33], v[30:31] op_sel:[0,1] op_sel_hi:[1,1]
  v_pk_mul_f32 v[154:155], v[34:35], v[30:31] op_sel:[0,1] op_sel_hi:[1,1]
  v_pk_mul_f32 v[156:157], v[36:37], v[30:31] op_sel:[0,1] op_sel_hi:[1,1]
  v_pk_mul_f32 v[158:159], v[38:39], v[30:31] op_sel:[0,1] op_sel_hi:[1,1]
  v_pk_fma_f32 v[172:173], v[172:173], v[30:31], v[152:153] op_sel_hi:[1,0,1]
  v_pk_fma_f32 v[174:175], v[174:175], v[30:31], v[154:155] op_sel_hi:[1,0,1]
  v_pk_fma_f32 v[188:189], v[188:189], v[30:31], v[156:157] op_sel_hi:[1,0,1]
  v_pk_fma_f32 v[190:191], v[190:191], v[30:31], v[158:159] op_sel_hi:[1,0,1]
  v_cvt_pk_bf16_f32 v172, v172, v173
  v_cvt_pk_bf16_f32 v173, v174, v175
  v_cvt_pk_bf16_f32 v174, v188, v189
  v_cvt_pk_bf16_f32 v175, v190, v191
  s_waitcnt lgkmcnt(1)
  v_readfirstlane_b32 s28, v7
  s_cmp_eq_u32 s28, 1
  s_cbranch_scc1 .g2_kernel_q_v0f
.g2_kernel_q_v0fb:
  ds_write_b128 v61, v[172:175] offset:2304
  v_pk_mul_f32 v[152:153], v[120:121], v[48:49] op_sel:[0,0] op_sel_hi:[1,0]
  v_pk_mul_f32 v[154:155], v[122:123], v[48:49] op_sel:[0,0] op_sel_hi:[1,0]
  v_pk_mul_f32 v[156:157], v[124:125], v[48:49] op_sel:[0,0] op_sel_hi:[1,0]
  v_pk_mul_f32 v[158:159], v[126:127], v[48:49] op_sel:[0,0] op_sel_hi:[1,0]
  v_pk_fma_f32 v[224:225], v[224:225], v[104:105], v[152:153]
  v_pk_fma_f32 v[226:227], v[226:227], v[106:107], v[154:155]
  v_pk_fma_f32 v[228:229], v[228:229], v[108:109], v[156:157]
  v_pk_fma_f32 v[230:231], v[230:231], v[110:111], v[158:159]
  v_cvt_pk_bf16_f32 v224, v224, v225
  v_cvt_pk_bf16_f32 v225, v226, v227
  v_cvt_pk_bf16_f32 v226, v228, v229
  v_cvt_pk_bf16_f32 v227, v230, v231
  ds_write_b128 v60, v[224:227] offset:2048
  v_pk_mul_f32 v[152:153], v[120:121], v[48:49] op_sel:[0,1] op_sel_hi:[1,1]
  v_pk_mul_f32 v[154:155], v[122:123], v[48:49] op_sel:[0,1] op_sel_hi:[1,1]
  v_pk_mul_f32 v[156:157], v[124:125], v[48:49] op_sel:[0,1] op_sel_hi:[1,1]
  v_pk_mul_f32 v[158:159], v[126:127], v[48:49] op_sel:[0,1] op_sel_hi:[1,1]
  v_pk_fma_f32 v[240:241], v[240:241], v[104:105], v[152:153]
  v_pk_fma_f32 v[242:243], v[242:243], v[106:107], v[154:155]
  v_pk_fma_f32 v[244:245], v[244:245], v[108:109], v[156:157]
  v_pk_fma_f32 v[246:247], v[246:247], v[110:111], v[158:159]
  v_cvt_pk_bf16_f32 v240, v240, v241
  v_cvt_pk_bf16_f32 v241, v242, v243
  v_cvt_pk_bf16_f32 v242, v244, v245
  v_cvt_pk_bf16_f32 v243, v246, v247
  ds_write_b128 v60, v[240:243] offset:2304
  v_pk_mul_f32 v[152:153], v[128:129], v[48:49] op_sel:[0,0] op_sel_hi:[1,0]
  v_pk_mul_f32 v[154:155], v[130:131], v[48:49] op_sel:[0,0] op_sel_hi:[1,0]
  v_pk_mul_f32 v[156:157], v[132:133], v[48:49] op_sel:[0,0] op_sel_hi:[1,0]
  v_pk_mul_f32 v[158:159], v[134:135], v[48:49] op_sel:[0,0] op_sel_hi:[1,0]
  v_pk_fma_f32 v[232:233], v[232:233], v[112:113], v[152:153]
  v_pk_fma_f32 v[234:235], v[234:235], v[114:115], v[154:155]
  v_pk_fma_f32 v[236:237], v[236:237], v[116:117], v[156:157]
  v_pk_fma_f32 v[238:239], v[238:239], v[118:119], v[158:159]
  v_cvt_pk_bf16_f32 v232, v232, v233
  v_cvt_pk_bf16_f32 v233, v234, v235
  v_cvt_pk_bf16_f32 v234, v236, v237
  v_cvt_pk_bf16_f32 v235, v238, v239
  ds_write_b128 v60, v[232:235] offset:6144
  v_pk_mul_f32 v[152:153], v[128:129], v[48:49] op_sel:[0,1] op_sel_hi:[1,1]
  v_pk_mul_f32 v[154:155], v[130:131], v[48:49] op_sel:[0,1] op_sel_hi:[1,1]
  v_pk_mul_f32 v[156:157], v[132:133], v[48:49] op_sel:[0,1] op_sel_hi:[1,1]
  v_pk_mul_f32 v[158:159], v[134:135], v[48:49] op_sel:[0,1] op_sel_hi:[1,1]
  v_pk_fma_f32 v[248:249], v[248:249], v[112:113], v[152:153]
  v_pk_fma_f32 v[250:251], v[250:251], v[114:115], v[154:155]
  v_pk_fma_f32 v[252:253], v[252:253], v[116:117], v[156:157]
  v_pk_fma_f32 v[254:255], v[254:255], v[118:119], v[158:159]
  v_cvt_pk_bf16_f32 v248, v248, v249
  v_cvt_pk_bf16_f32 v249, v250, v251
  v_cvt_pk_bf16_f32 v250, v252, v253
  v_cvt_pk_bf16_f32 v251, v254, v255
  ds_write_b128 v60, v[248:251] offset:6400
.g2_kernel_q_kd:
  s_mov_b64 exec, 1
  ds_add_u32 v13, v5 offset:4
  s_mov_b64 exec, -1
  v_mov_b32 v120, 0
  v_mov_b32 v121, 0
  v_mov_b32 v124, 0
  v_mov_b32 v125, 0
  v_mov_b32 v128, 0
  v_mov_b32 v129, 0
  v_mov_b32 v132, 0
  v_mov_b32 v133, 0
  s_cmp_lg_u32 s62, 0
  s_cbranch_scc1 .g2_kernel_r2
  global_load_dwordx4 v[240:243], v23, s[74:75] offset:0
  global_load_dwordx4 v[244:247], v23, s[74:75] offset:32
  global_load_dwordx4 v[248:251], v23, s[74:75] offset:64
  global_load_dwordx4 v[252:255], v23, s[74:75] offset:96
.g2_kernel_r3:
  v_mov_b32 v6, s71
  s_mov_b32 s38, 0
.g2_kernel_wg4:
  ds_read_b32 v7, v6 offset:4
  s_add_u32 s38, s38, 1
  s_waitcnt lgkmcnt(0)
  v_cmp_gt_u32 vcc, 4, v7
  s_cbranch_vccz .g2_kernel_wg4d
  s_cmp_lt_u32 s38, 524288
  s_cbranch_scc1 .g2_kernel_wg4
.g2_kernel_wg4d:
  ds_read_b128 v[176:179], v9 offset:0
  ds_read_b128 v[180:183], v9 offset:1024
  ds_read_b128 v[24:27], v14 offset:8192
  ds_read_b128 v[28:31], v14 offset:9216
  ds_read_b128 v[184:187], v9 offset:2048
  ds_read_b128 v[188:191], v9 offset:3072
  ds_read_b128 v[32:35], v14 offset:10240
  ds_read_b128 v[36:39], v14 offset:11264
  ds_read_b128 v[40:43], v14 offset:12288
  ds_read_b128 v[44:47], v14 offset:13312
  ds_read_b128 v[48:51], v14 offset:14336
  ds_read_b128 v[52:55], v14 offset:15360
  s_cmp_lg_u32 s35, 0
  s_cbranch_scc1 .g2_kernel_a_own
  s_waitcnt lgkmcnt(8)
.g2_kernel_a_ob:
  v_mfma_f32_32x32x16_bf16 v[136:151], v[176:179], v[24:27], 0
  v_mfma_f32_32x32x16_bf16 v[136:151], v[180:183], v[28:31], v[136:151]
  s_waitcnt lgkmcnt(0)
  s_nop 7
  v_mfma_f32_32x32x16_bf16 v[152:167], v[176:179], v[32:35], 0
  ds_read_b32 v7, v8
  s_nop 0
  v_exp_f32 v136, v136
  v_exp_f32 v137, v137
  v_exp_f32 v138, v138
  v_exp_f32 v139, v139
  v_exp_f32 v140, v140
  v_exp_f32 v141, v141
  v_exp_f32 v142, v142
  v_exp_f32 v143, v143
  v_mfma_f32_32x32x16_bf16 v[152:167], v[180:183], v[36:39], v[152:167]
  s_mov_b64 exec, 1
  ds_add_u32 v13, v5 offset:8
  s_mov_b64 exec, -1
  s_waitcnt lgkmcnt(0)
  v_cmp_lt_u32 vcc, s62, v7
  v_cvt_pk_bf16_f32 v168, v136, v137
  v_cvt_pk_bf16_f32 v169, v138, v139
  v_cvt_pk_bf16_f32 v170, v140, v141
  v_cvt_pk_bf16_f32 v171, v142, v143
  v_exp_f32 v144, v144
  v_exp_f32 v145, v145
  v_exp_f32 v146, v146
  v_exp_f32 v147, v147
  v_mfma_f32_32x32x16_bf16 v[56:71], v[184:187], v[168:171], 0
  s_mov_b32 s36, vcc_lo
  s_andn2_b32 s33, s36, s34
  v_exp_f32 v148, v148
  v_exp_f32 v149, v149
  v_exp_f32 v150, v150
  v_exp_f32 v151, v151
  v_cvt_pk_bf16_f32 v172, v144, v145
  v_cvt_pk_bf16_f32 v173, v146, v147
  v_cvt_pk_bf16_f32 v174, v148, v149
  v_cvt_pk_bf16_f32 v175, v150, v151
  v_mfma_f32_32x32x16_bf16 v[136:151], v[176:179], v[40:43], 0
  v_exp_f32 v152, v152
  v_exp_f32 v153, v153
  v_exp_f32 v154, v154
  v_mfma_f32_32x32x16_bf16 v[56:71], v[188:191], v[172:175], v[56:71]
  s_bcnt1_i32_b32 s33, s33
  s_sub_u32 s33, s33, s39
  s_cmp_lt_i32 s33, 3
  v_exp_f32 v155, v155
  v_exp_f32 v156, v156
  v_exp_f32 v157, v157
  v_smfmac_f32_16x16x64_bf16 v[120:123], v[16:19], v[168:175], v20
  s_cbranch_scc1 .g2_kernel_a_F0n0
  s_mov_b32 s39, 64
  s_call_b64 s[72:73], .g2_kernel_a_three
.g2_kernel_a_F0n0:
  v_exp_f32 v158, v158
  v_exp_f32 v159, v159
  v_mfma_f32_32x32x16_bf16 v[136:151], v[180:183], v[44:47], v[136:151]
  v_cvt_pk_bf16_f32 v168, v152, v153
  v_cvt_pk_bf16_f32 v169, v154, v155
  v_cvt_pk_bf16_f32 v170, v156, v157
  v_cvt_pk_bf16_f32 v171, v158, v159
  v_exp_f32 v160, v160
  v_exp_f32 v161, v161
  v_exp_f32 v162, v162
  v_exp_f32 v163, v163
  v_mfma_f32_32x32x16_bf16 v[72:87], v[184:187], v[168:171], 0
  v_exp_f32 v164, v164
  v_exp_f32 v165, v165
  v_exp_f32 v166, v166
  v_exp_f32 v167, v167
  v_cvt_pk_bf16_f32 v172, v160, v161
  v_cvt_pk_bf16_f32 v173, v162, v163
  v_cvt_pk_bf16_f32 v174, v164, v165
  v_cvt_pk_bf16_f32 v175, v166, v167
  v_mfma_f32_32x32x16_bf16 v[152:167], v[176:179], v[48:51], 0
  ds_read_b32 v7, v8
  v_exp_f32 v136, v136
  v_exp_f32 v137, v137
  v_exp_f32 v138, v138
  v_mfma_f32_32x32x16_bf16 v[72:87], v[188:191], v[172:175], v[72:87]
  s_lshl_b32 s28, s16, 11
  v_exp_f32 v139, v139
  v_exp_f32 v140, v140
  v_exp_f32 v141, v141
  v_smfmac_f32_16x16x64_bf16 v[124:127], v[16:19], v[168:175], v20
  v_add_u32 v9, s28, v3
  v_exp_f32 v142, v142
  v_exp_f32 v143, v143
  v_mfma_f32_32x32x16_bf16 v[152:167], v[180:183], v[52:55], v[152:167]
  s_waitcnt lgkmcnt(0)
  v_cmp_lt_u32 vcc, s62, v7
  v_cvt_pk_bf16_f32 v168, v136, v137
  v_cvt_pk_bf16_f32 v169, v138, v139
  v_cvt_pk_bf16_f32 v170, v140, v141
  v_cvt_pk_bf16_f32 v171, v142, v143
  v_exp_f32 v144, v144
  v_exp_f32 v145, v145
  v_exp_f32 v146, v146
  v_exp_f32 v147, v147
  v_mfma_f32_32x32x16_bf16 v[88:103], v[184:187], v[168:171], 0
  s_mov_b32 s36, vcc_lo
  s_andn2_b32 s33, s36, s34
  v_exp_f32 v148, v148
  v_exp_f32 v149, v149
  v_exp_f32 v150, v150
  v_exp_f32 v151, v151
  v_cvt_pk_bf16_f32 v172, v144, v145
  v_cvt_pk_bf16_f32 v173, v146, v147
  v_cvt_pk_bf16_f32 v174, v148, v149
  v_cvt_pk_bf16_f32 v175, v150, v151
  v_exp_f32 v152, v152
  v_exp_f32 v153, v153
  v_exp_f32 v154, v154
  v_mfma_f32_32x32x16_bf16 v[88:103], v[188:191], v[172:175], v[88:103]
  s_bcnt1_i32_b32 s33, s33
  s_sub_u32 s33, s33, s39
  s_cmp_lt_i32 s33, 3
  v_exp_f32 v155, v155
  v_exp_f32 v156, v156
  v_exp_f32 v157, v157
  v_smfmac_f32_16x16x64_bf16 v[128:131], v[16:19], v[168:175], v20
  s_cbranch_scc1 .g2_kernel_a_F0n2
  s_mov_b32 s39, 64
  s_call_b64 s[72:73], .g2_kernel_a_three
.g2_kernel_a_F0n2:
  v_exp_f32 v158, v158
  v_exp_f32 v159, v159
  v_cvt_pk_bf16_f32 v168, v152, v153
  v_cvt_pk_bf16_f32 v169, v154, v155
  v_cvt_pk_bf16_f32 v170, v156, v157
  v_cvt_pk_bf16_f32 v171, v158, v159
  v_exp_f32 v160, v160
  v_exp_f32 v161, v161
  v_exp_f32 v162, v162
  v_exp_f32 v163, v163
  v_mfma_f32_32x32x16_bf16 v[104:119], v[184:187], v[168:171], 0
  v_exp_f32 v164, v164
  v_exp_f32 v165, v165
  v_exp_f32 v166, v166
  v_exp_f32 v167, v167
  v_cvt_pk_bf16_f32 v172, v160, v161
  v_cvt_pk_bf16_f32 v173, v162, v163
  v_cvt_pk_bf16_f32 v174, v164, v165
  v_cvt_pk_bf16_f32 v175, v166, v167
  s_add_u32 s39, s39, s35
  s_cmp_ge_u32 s39, 3
  s_cbranch_scc1 .g2_kernel_a_p1
  s_call_b64 s[72:73], .g2_kernel_a_three
.g2_kernel_a_p1:
  s_waitcnt vmcnt(10)
  v_mfma_f32_32x32x16_bf16 v[136:151], v[192:195], v[24:27], 0
  v_mfma_f32_32x32x16_bf16 v[136:151], v[196:199], v[28:31], v[136:151]
  s_waitcnt vmcnt(8)
  s_mov_b32 s32, 0
  s_nop 8
  s_branch .g2_kernel_a_n1
  .p2align 6
.g2_kernel_a_loop:
  v_exp_f32 v136, v136
  v_exp_f32 v137, v137
  v_exp_f32 v138, v138
  v_mfma_f32_32x32x16_bf16 v[104:119], v[236:239], v[172:175], v[104:119]
  s_andn2_b32 s33, s36, s34
  v_exp_f32 v139, v139
  v_exp_f32 v140, v140
  v_exp_f32 v141, v141
  v_smfmac_f32_16x16x64_bf16 v[132:135], v[16:19], v[168:175], v20
  s_cbranch_scc0 .g2_kernel_a_N0c
.g2_kernel_a_N0b:
  v_exp_f32 v142, v142
  v_exp_f32 v143, v143
  v_mfma_f32_32x32x16_bf16 v[152:167], v[180:183], v[36:39], v[152:167]
  s_ff1_i32_b32 s33, s33
  v_cvt_pk_bf16_f32 v168, v136, v137
  v_cvt_pk_bf16_f32 v169, v138, v139
  v_cvt_pk_bf16_f32 v170, v140, v141
  v_cvt_pk_bf16_f32 v171, v142, v143
  v_exp_f32 v144, v144
  v_exp_f32 v145, v145
  v_exp_f32 v146, v146
  v_exp_f32 v147, v147
  v_mfma_f32_32x32x16_bf16 v[56:71], v[184:187], v[168:171], v[56:71]
  s_bitset1_b32 s34, s33
  v_exp_f32 v148, v148
  v_exp_f32 v149, v149
  v_exp_f32 v150, v150
  v_exp_f32 v151, v151
  v_cvt_pk_bf16_f32 v172, v144, v145
  v_cvt_pk_bf16_f32 v173, v146, v147
  v_cvt_pk_bf16_f32 v174, v148, v149
  v_cvt_pk_bf16_f32 v175, v150, v151
  v_mfma_f32_32x32x16_bf16 v[136:151], v[176:179], v[40:43], 0
  s_xor_b32 s33, s33, s24
  v_exp_f32 v152, v152
  v_exp_f32 v153, v153
  v_exp_f32 v154, v154
  v_mfma_f32_32x32x16_bf16 v[56:71], v[188:191], v[172:175], v[56:71]
  s_lshl_b32 s33, s33, s25
  v_exp_f32 v155, v155
  v_exp_f32 v156, v156
  v_exp_f32 v157, v157
  v_smfmac_f32_16x16x64_bf16 v[120:123], v[16:19], v[168:175], v20
  s_add_u32 s22, s20, s33
  v_exp_f32 v158, v158
  v_exp_f32 v159, v159
  v_mfma_f32_32x32x16_bf16 v[136:151], v[180:183], v[44:47], v[136:151]
  s_addc_u32 s23, s21, 0
  v_cvt_pk_bf16_f32 v168, v152, v153
  v_cvt_pk_bf16_f32 v169, v154, v155
  v_cvt_pk_bf16_f32 v170, v156, v157
  v_cvt_pk_bf16_f32 v171, v158, v159
  v_exp_f32 v160, v160
  v_exp_f32 v161, v161
  v_exp_f32 v162, v162
  v_exp_f32 v163, v163
  v_mfma_f32_32x32x16_bf16 v[72:87], v[184:187], v[168:171], v[72:87]
  v_exp_f32 v164, v164
  v_exp_f32 v165, v165
  v_exp_f32 v166, v166
  v_exp_f32 v167, v167
  v_cvt_pk_bf16_f32 v172, v160, v161
  v_cvt_pk_bf16_f32 v173, v162, v163
  v_cvt_pk_bf16_f32 v174, v164, v165
  v_cvt_pk_bf16_f32 v175, v166, v167
  v_mfma_f32_32x32x16_bf16 v[152:167], v[176:179], v[48:51], 0
  ds_read_b32 v7, v8
  v_exp_f32 v136, v136
  v_exp_f32 v137, v137
  v_exp_f32 v138, v138
  v_mfma_f32_32x32x16_bf16 v[72:87], v[188:191], v[172:175], v[72:87]
  v_exp_f32 v139, v139
  v_exp_f32 v140, v140
  v_exp_f32 v141, v141
  v_smfmac_f32_16x16x64_bf16 v[124:127], v[16:19], v[168:175], v20
  global_load_dwordx4 v[224:227], v3, s[22:23] offset:0
  global_load_dwordx4 v[228:231], v3, s[22:23] offset:1024
  global_load_dwordx4 v[232:235], v3, s[22:23] offset:2048
  global_load_dwordx4 v[236:239], v3, s[22:23] offset:3072
  v_exp_f32 v142, v142
  v_exp_f32 v143, v143
  v_mfma_f32_32x32x16_bf16 v[152:167], v[180:183], v[52:55], v[152:167]
  v_cvt_pk_bf16_f32 v168, v136, v137
  v_cvt_pk_bf16_f32 v169, v138, v139
  v_cvt_pk_bf16_f32 v170, v140, v141
  v_cvt_pk_bf16_f32 v171, v142, v143
  v_exp_f32 v144, v144
  v_exp_f32 v145, v145
  v_exp_f32 v146, v146
  v_exp_f32 v147, v147
  v_mfma_f32_32x32x16_bf16 v[88:103], v[184:187], v[168:171], v[88:103]
  s_waitcnt vmcnt(8)
  v_exp_f32 v148, v148
  v_exp_f32 v149, v149
  v_exp_f32 v150, v150
  v_exp_f32 v151, v151
  v_cvt_pk_bf16_f32 v172, v144, v145
  v_cvt_pk_bf16_f32 v173, v146, v147
  v_cvt_pk_bf16_f32 v174, v148, v149
  v_cvt_pk_bf16_f32 v175, v150, v151
  v_mfma_f32_32x32x16_bf16 v[136:151], v[192:195], v[24:27], 0
  s_waitcnt lgkmcnt(0)
  v_cmp_lt_u32 vcc, s62, v7
  v_exp_f32 v152, v152
  v_exp_f32 v153, v153
  v_exp_f32 v154, v154
  v_mfma_f32_32x32x16_bf16 v[88:103], v[188:191], v[172:175], v[88:103]
  s_mov_b32 s36, vcc_lo
  v_exp_f32 v155, v155
  v_exp_f32 v156, v156
  v_exp_f32 v157, v157
  v_smfmac_f32_16x16x64_bf16 v[128:131], v[16:19], v[168:175], v20
  v_exp_f32 v158, v158
  v_exp_f32 v159, v159
  v_mfma_f32_32x32x16_bf16 v[136:151], v[196:199], v[28:31], v[136:151]
  v_cvt_pk_bf16_f32 v168, v152, v153
  v_cvt_pk_bf16_f32 v169, v154, v155
  v_cvt_pk_bf16_f32 v170, v156, v157
  v_cvt_pk_bf16_f32 v171, v158, v159
  v_exp_f32 v160, v160
  v_exp_f32 v161, v161
  v_exp_f32 v162, v162
  v_exp_f32 v163, v163
  v_mfma_f32_32x32x16_bf16 v[104:119], v[184:187], v[168:171], v[104:119]
  v_exp_f32 v164, v164
  v_exp_f32 v165, v165
  v_exp_f32 v166, v166
  v_exp_f32 v167, v167
  v_cvt_pk_bf16_f32 v172, v160, v161
  v_cvt_pk_bf16_f32 v173, v162, v163
  v_cvt_pk_bf16_f32 v174, v164, v165
  v_cvt_pk_bf16_f32 v175, v166, v167
.g2_kernel_a_n1:
  v_mfma_f32_32x32x16_bf16 v[152:167], v[192:195], v[32:35], 0
  s_andn2_b32 s33, s36, s34
  v_exp_f32 v136, v136
  v_exp_f32 v137, v137
  v_exp_f32 v138, v138
  v_mfma_f32_32x32x16_bf16 v[104:119], v[188:191], v[172:175], v[104:119]
  s_cbranch_scc0 .g2_kernel_a_N1c
.g2_kernel_a_N1b:
  v_exp_f32 v139, v139
  v_exp_f32 v140, v140
  v_exp_f32 v141, v141
  v_smfmac_f32_16x16x64_bf16 v[132:135], v[16:19], v[168:175], v20
  s_ff1_i32_b32 s33, s33
  v_exp_f32 v142, v142
  v_exp_f32 v143, v143
  v_mfma_f32_32x32x16_bf16 v[152:167], v[196:199], v[36:39], v[152:167]
  s_bitset1_b32 s34, s33
  v_cvt_pk_bf16_f32 v168, v136, v137
  v_cvt_pk_bf16_f32 v169, v138, v139
  v_cvt_pk_bf16_f32 v170, v140, v141
  v_cvt_pk_bf16_f32 v171, v142, v143
  v_exp_f32 v144, v144
  v_exp_f32 v145, v145
  v_exp_f32 v146, v146
  v_exp_f32 v147, v147
  v_mfma_f32_32x32x16_bf16 v[56:71], v[200:203], v[168:171], v[56:71]
  s_xor_b32 s33, s33, s24
  v_exp_f32 v148, v148
  v_exp_f32 v149, v149
  v_exp_f32 v150, v150
  v_exp_f32 v151, v151
  v_cvt_pk_bf16_f32 v172, v144, v145
  v_cvt_pk_bf16_f32 v173, v146, v147
  v_cvt_pk_bf16_f32 v174, v148, v149
  v_cvt_pk_bf16_f32 v175, v150, v151
  v_mfma_f32_32x32x16_bf16 v[136:151], v[192:195], v[40:43], 0
  s_lshl_b32 s33, s33, s25
  v_exp_f32 v152, v152
  v_exp_f32 v153, v153
  v_exp_f32 v154, v154
  v_mfma_f32_32x32x16_bf16 v[56:71], v[204:207], v[172:175], v[56:71]
  s_add_u32 s22, s20, s33
  v_exp_f32 v155, v155
  v_exp_f32 v156, v156
  v_exp_f32 v157, v157
  v_smfmac_f32_16x16x64_bf16 v[120:123], v[16:19], v[168:175], v20
  s_addc_u32 s23, s21, 0
  v_exp_f32 v158, v158
  v_exp_f32 v159, v159
  v_mfma_f32_32x32x16_bf16 v[136:151], v[196:199], v[44:47], v[136:151]
  v_cvt_pk_bf16_f32 v168, v152, v153
  v_cvt_pk_bf16_f32 v169, v154, v155
  v_cvt_pk_bf16_f32 v170, v156, v157
  v_cvt_pk_bf16_f32 v171, v158, v159
  v_exp_f32 v160, v160
  v_exp_f32 v161, v161
  v_exp_f32 v162, v162
  v_exp_f32 v163, v163
  v_mfma_f32_32x32x16_bf16 v[72:87], v[200:203], v[168:171], v[72:87]
  v_exp_f32 v164, v164
  v_exp_f32 v165, v165
  v_exp_f32 v166, v166
  v_exp_f32 v167, v167
  v_cvt_pk_bf16_f32 v172, v160, v161
  v_cvt_pk_bf16_f32 v173, v162, v163
  v_cvt_pk_bf16_f32 v174, v164, v165
  v_cvt_pk_bf16_f32 v175, v166, v167
  v_mfma_f32_32x32x16_bf16 v[152:167], v[192:195], v[48:51], 0
  v_exp_f32 v136, v136
  v_exp_f32 v137, v137
  v_exp_f32 v138, v138
  v_mfma_f32_32x32x16_bf16 v[72:87], v[204:207], v[172:175], v[72:87]
  v_exp_f32 v139, v139
  v_exp_f32 v140, v140
  v_exp_f32 v141, v141
  v_smfmac_f32_16x16x64_bf16 v[124:127], v[16:19], v[168:175], v20
  global_load_dwordx4 v[176:179], v3, s[22:23] offset:0
  global_load_dwordx4 v[180:183], v3, s[22:23] offset:1024
  global_load_dwordx4 v[184:187], v3, s[22:23] offset:2048
  global_load_dwordx4 v[188:191], v3, s[22:23] offset:3072
  v_exp_f32 v142, v142
  v_exp_f32 v143, v143
  v_mfma_f32_32x32x16_bf16 v[152:167], v[196:199], v[52:55], v[152:167]
  v_cvt_pk_bf16_f32 v168, v136, v137
  v_cvt_pk_bf16_f32 v169, v138, v139
  v_cvt_pk_bf16_f32 v170, v140, v141
  v_cvt_pk_bf16_f32 v171, v142, v143
  v_exp_f32 v144, v144
  v_exp_f32 v145, v145
  v_exp_f32 v146, v146
  v_exp_f32 v147, v147
  v_mfma_f32_32x32x16_bf16 v[88:103], v[200:203], v[168:171], v[88:103]
  s_waitcnt vmcnt(8)
  v_exp_f32 v148, v148
  v_exp_f32 v149, v149
  v_exp_f32 v150, v150
  v_exp_f32 v151, v151
  v_cvt_pk_bf16_f32 v172, v144, v145
  v_cvt_pk_bf16_f32 v173, v146, v147
  v_cvt_pk_bf16_f32 v174, v148, v149
  v_cvt_pk_bf16_f32 v175, v150, v151
  v_mfma_f32_32x32x16_bf16 v[136:151], v[208:211], v[24:27], 0
  v_exp_f32 v152, v152
  v_exp_f32 v153, v153
  v_exp_f32 v154, v154
  v_mfma_f32_32x32x16_bf16 v[88:103], v[204:207], v[172:175], v[88:103]
  v_exp_f32 v155, v155
  v_exp_f32 v156, v156
  v_exp_f32 v157, v157
  v_smfmac_f32_16x16x64_bf16 v[128:131], v[16:19], v[168:175], v20
  v_exp_f32 v158, v158
  v_exp_f32 v159, v159
  v_mfma_f32_32x32x16_bf16 v[136:151], v[212:215], v[28:31], v[136:151]
  v_cvt_pk_bf16_f32 v168, v152, v153
  v_cvt_pk_bf16_f32 v169, v154, v155
  v_cvt_pk_bf16_f32 v170, v156, v157
  v_cvt_pk_bf16_f32 v171, v158, v159
  v_exp_f32 v160, v160
  v_exp_f32 v161, v161
  v_exp_f32 v162, v162
  v_exp_f32 v163, v163
  v_mfma_f32_32x32x16_bf16 v[104:119], v[200:203], v[168:171], v[104:119]
  v_exp_f32 v164, v164
  v_exp_f32 v165, v165
  v_exp_f32 v166, v166
  v_exp_f32 v167, v167
  v_cvt_pk_bf16_f32 v172, v160, v161
  v_cvt_pk_bf16_f32 v173, v162, v163
  v_cvt_pk_bf16_f32 v174, v164, v165
  v_cvt_pk_bf16_f32 v175, v166, v167
  v_mfma_f32_32x32x16_bf16 v[152:167], v[208:211], v[32:35], 0
  s_andn2_b32 s33, s36, s34
  v_exp_f32 v136, v136
  v_exp_f32 v137, v137
  v_exp_f32 v138, v138
  v_mfma_f32_32x32x16_bf16 v[104:119], v[204:207], v[172:175], v[104:119]
  s_cbranch_scc0 .g2_kernel_a_N2c
.g2_kernel_a_N2b:
  v_exp_f32 v139, v139
  v_exp_f32 v140, v140
  v_exp_f32 v141, v141
  v_smfmac_f32_16x16x64_bf16 v[132:135], v[16:19], v[168:175], v20
  s_ff1_i32_b32 s33, s33
  v_exp_f32 v142, v142
  v_exp_f32 v143, v143
  v_mfma_f32_32x32x16_bf16 v[152:167], v[212:215], v[36:39], v[152:167]
  s_bitset1_b32 s34, s33
  v_cvt_pk_bf16_f32 v168, v136, v137
  v_cvt_pk_bf16_f32 v169, v138, v139
  v_cvt_pk_bf16_f32 v170, v140, v141
  v_cvt_pk_bf16_f32 v171, v142, v143
  v_exp_f32 v144, v144
  v_exp_f32 v145, v145
  v_exp_f32 v146, v146
  v_exp_f32 v147, v147
  v_mfma_f32_32x32x16_bf16 v[56:71], v[216:219], v[168:171], v[56:71]
  s_xor_b32 s33, s33, s24
  v_exp_f32 v148, v148
  v_exp_f32 v149, v149
  v_exp_f32 v150, v150
  v_exp_f32 v151, v151
  v_cvt_pk_bf16_f32 v172, v144, v145
  v_cvt_pk_bf16_f32 v173, v146, v147
  v_cvt_pk_bf16_f32 v174, v148, v149
  v_cvt_pk_bf16_f32 v175, v150, v151
  v_mfma_f32_32x32x16_bf16 v[136:151], v[208:211], v[40:43], 0
  s_lshl_b32 s33, s33, s25
  v_exp_f32 v152, v152
  v_exp_f32 v153, v153
  v_exp_f32 v154, v154
  v_mfma_f32_32x32x16_bf16 v[56:71], v[220:223], v[172:175], v[56:71]
  s_add_u32 s22, s20, s33
  v_exp_f32 v155, v155
  v_exp_f32 v156, v156
  v_exp_f32 v157, v157
  v_smfmac_f32_16x16x64_bf16 v[120:123], v[16:19], v[168:175], v20
  s_addc_u32 s23, s21, 0
  v_exp_f32 v158, v158
  v_exp_f32 v159, v159
  v_mfma_f32_32x32x16_bf16 v[136:151], v[212:215], v[44:47], v[136:151]
  v_cvt_pk_bf16_f32 v168, v152, v153
  v_cvt_pk_bf16_f32 v169, v154, v155
  v_cvt_pk_bf16_f32 v170, v156, v157
  v_cvt_pk_bf16_f32 v171, v158, v159
  v_exp_f32 v160, v160
  v_exp_f32 v161, v161
  v_exp_f32 v162, v162
  v_exp_f32 v163, v163
  v_mfma_f32_32x32x16_bf16 v[72:87], v[216:219], v[168:171], v[72:87]
  v_exp_f32 v164, v164
  v_exp_f32 v165, v165
  v_exp_f32 v166, v166
  v_exp_f32 v167, v167
  v_cvt_pk_bf16_f32 v172, v160, v161
  v_cvt_pk_bf16_f32 v173, v162, v163
  v_cvt_pk_bf16_f32 v174, v164, v165
  v_cvt_pk_bf16_f32 v175, v166, v167
  v_mfma_f32_32x32x16_bf16 v[152:167], v[208:211], v[48:51], 0
  v_exp_f32 v136, v136
  v_exp_f32 v137, v137
  v_exp_f32 v138, v138
  v_mfma_f32_32x32x16_bf16 v[72:87], v[220:223], v[172:175], v[72:87]
  v_exp_f32 v139, v139
  v_exp_f32 v140, v140
  v_exp_f32 v141, v141
  v_smfmac_f32_16x16x64_bf16 v[124:127], v[16:19], v[168:175], v20
  global_load_dwordx4 v[192:195], v3, s[22:23] offset:0
  global_load_dwordx4 v[196:199], v3, s[22:23] offset:1024
  global_load_dwordx4 v[200:203], v3, s[22:23] offset:2048
  global_load_dwordx4 v[204:207], v3, s[22:23] offset:3072
  v_exp_f32 v142, v142
  v_exp_f32 v143, v143
  v_mfma_f32_32x32x16_bf16 v[152:167], v[212:215], v[52:55], v[152:167]
  v_cvt_pk_bf16_f32 v168, v136, v137
  v_cvt_pk_bf16_f32 v169, v138, v139
  v_cvt_pk_bf16_f32 v170, v140, v141
  v_cvt_pk_bf16_f32 v171, v142, v143
  v_exp_f32 v144, v144
  v_exp_f32 v145, v145
  v_exp_f32 v146, v146
  v_exp_f32 v147, v147
  v_mfma_f32_32x32x16_bf16 v[88:103], v[216:219], v[168:171], v[88:103]
  s_waitcnt vmcnt(8)
  v_exp_f32 v148, v148
  v_exp_f32 v149, v149
  v_exp_f32 v150, v150
  v_exp_f32 v151, v151
  v_cvt_pk_bf16_f32 v172, v144, v145
  v_cvt_pk_bf16_f32 v173, v146, v147
  v_cvt_pk_bf16_f32 v174, v148, v149
  v_cvt_pk_bf16_f32 v175, v150, v151
  v_mfma_f32_32x32x16_bf16 v[136:151], v[224:227], v[24:27], 0
  v_exp_f32 v152, v152
  v_exp_f32 v153, v153
  v_exp_f32 v154, v154
  v_mfma_f32_32x32x16_bf16 v[88:103], v[220:223], v[172:175], v[88:103]
  v_exp_f32 v155, v155
  v_exp_f32 v156, v156
  v_exp_f32 v157, v157
  v_smfmac_f32_16x16x64_bf16 v[128:131], v[16:19], v[168:175], v20
  v_exp_f32 v158, v158
  v_exp_f32 v159, v159
  v_mfma_f32_32x32x16_bf16 v[136:151], v[228:231], v[28:31], v[136:151]
  s_and_b32 s28, s32, 3
  v_cvt_pk_bf16_f32 v168, v152, v153
  v_cvt_pk_bf16_f32 v169, v154, v155
  v_cvt_pk_bf16_f32 v170, v156, v157
  v_cvt_pk_bf16_f32 v171, v158, v159
  v_exp_f32 v160, v160
  v_exp_f32 v161, v161
  v_exp_f32 v162, v162
  v_exp_f32 v163, v163
  v_mfma_f32_32x32x16_bf16 v[104:119], v[216:219], v[168:171], v[104:119]
  s_cmp_eq_u32 s28, 3
  v_exp_f32 v164, v164
  v_exp_f32 v165, v165
  v_exp_f32 v166, v166
  v_exp_f32 v167, v167
  v_cvt_pk_bf16_f32 v172, v160, v161
  v_cvt_pk_bf16_f32 v173, v162, v163
  v_cvt_pk_bf16_f32 v174, v164, v165
  v_cvt_pk_bf16_f32 v175, v166, v167
  v_mfma_f32_32x32x16_bf16 v[152:167], v[224:227], v[32:35], 0
  s_cbranch_scc1 .g2_kernel_a_last
  v_exp_f32 v136, v136
  v_exp_f32 v137, v137
  v_exp_f32 v138, v138
  v_mfma_f32_32x32x16_bf16 v[104:119], v[220:223], v[172:175], v[104:119]
  s_andn2_b32 s33, s36, s34
  v_exp_f32 v139, v139
  v_exp_f32 v140, v140
  v_exp_f32 v141, v141
  v_smfmac_f32_16x16x64_bf16 v[132:135], v[16:19], v[168:175], v20
  s_cbranch_scc0 .g2_kernel_a_N3c
.g2_kernel_a_N3b:
  v_exp_f32 v142, v142
  v_exp_f32 v143, v143
  v_mfma_f32_32x32x16_bf16 v[152:167], v[228:231], v[36:39], v[152:167]
  s_ff1_i32_b32 s33, s33
  v_cvt_pk_bf16_f32 v168, v136, v137
  v_cvt_pk_bf16_f32 v169, v138, v139
  v_cvt_pk_bf16_f32 v170, v140, v141
  v_cvt_pk_bf16_f32 v171, v142, v143
  v_exp_f32 v144, v144
  v_exp_f32 v145, v145
  v_exp_f32 v146, v146
  v_exp_f32 v147, v147
  v_mfma_f32_32x32x16_bf16 v[56:71], v[232:235], v[168:171], v[56:71]
  s_bitset1_b32 s34, s33
  v_exp_f32 v148, v148
  v_exp_f32 v149, v149
  v_exp_f32 v150, v150
  v_exp_f32 v151, v151
  v_cvt_pk_bf16_f32 v172, v144, v145
  v_cvt_pk_bf16_f32 v173, v146, v147
  v_cvt_pk_bf16_f32 v174, v148, v149
  v_cvt_pk_bf16_f32 v175, v150, v151
  v_mfma_f32_32x32x16_bf16 v[136:151], v[224:227], v[40:43], 0
  s_xor_b32 s33, s33, s24
  v_exp_f32 v152, v152
  v_exp_f32 v153, v153
  v_exp_f32 v154, v154
  v_mfma_f32_32x32x16_bf16 v[56:71], v[236:239], v[172:175], v[56:71]
  s_lshl_b32 s33, s33, s25
  v_exp_f32 v155, v155
  v_exp_f32 v156, v156
  v_exp_f32 v157, v157
  v_smfmac_f32_16x16x64_bf16 v[120:123], v[16:19], v[168:175], v20
  s_add_u32 s22, s20, s33
  v_exp_f32 v158, v158
  v_exp_f32 v159, v159
  v_mfma_f32_32x32x16_bf16 v[136:151], v[228:231], v[44:47], v[136:151]
  s_addc_u32 s23, s21, 0
  v_cvt_pk_bf16_f32 v168, v152, v153
  v_cvt_pk_bf16_f32 v169, v154, v155
  v_cvt_pk_bf16_f32 v170, v156, v157
  v_cvt_pk_bf16_f32 v171, v158, v159
  v_exp_f32 v160, v160
  v_exp_f32 v161, v161
  v_exp_f32 v162, v162
  v_exp_f32 v163, v163
  v_mfma_f32_32x32x16_bf16 v[72:87], v[232:235], v[168:171], v[72:87]
  v_exp_f32 v164, v164
  v_exp_f32 v165, v165
  v_exp_f32 v166, v166
  v_exp_f32 v167, v167
  v_cvt_pk_bf16_f32 v172, v160, v161
  v_cvt_pk_bf16_f32 v173, v162, v163
  v_cvt_pk_bf16_f32 v174, v164, v165
  v_cvt_pk_bf16_f32 v175, v166, v167
  v_mfma_f32_32x32x16_bf16 v[152:167], v[224:227], v[48:51], 0
  v_exp_f32 v136, v136
  v_exp_f32 v137, v137
  v_exp_f32 v138, v138
  v_mfma_f32_32x32x16_bf16 v[72:87], v[236:239], v[172:175], v[72:87]
  v_exp_f32 v139, v139
  v_exp_f32 v140, v140
  v_exp_f32 v141, v141
  v_smfmac_f32_16x16x64_bf16 v[124:127], v[16:19], v[168:175], v20
  global_load_dwordx4 v[208:211], v3, s[22:23] offset:0
  global_load_dwordx4 v[212:215], v3, s[22:23] offset:1024
  global_load_dwordx4 v[216:219], v3, s[22:23] offset:2048
  global_load_dwordx4 v[220:223], v3, s[22:23] offset:3072
  v_exp_f32 v142, v142
  v_exp_f32 v143, v143
  v_mfma_f32_32x32x16_bf16 v[152:167], v[228:231], v[52:55], v[152:167]
  v_cvt_pk_bf16_f32 v168, v136, v137
  v_cvt_pk_bf16_f32 v169, v138, v139
  v_cvt_pk_bf16_f32 v170, v140, v141
  v_cvt_pk_bf16_f32 v171, v142, v143
  v_exp_f32 v144, v144
  v_exp_f32 v145, v145
  v_exp_f32 v146, v146
  v_exp_f32 v147, v147
  v_mfma_f32_32x32x16_bf16 v[88:103], v[232:235], v[168:171], v[88:103]
  s_waitcnt vmcnt(8)
  v_exp_f32 v148, v148
  v_exp_f32 v149, v149
  v_exp_f32 v150, v150
  v_exp_f32 v151, v151
  v_cvt_pk_bf16_f32 v172, v144, v145
  v_cvt_pk_bf16_f32 v173, v146, v147
  v_cvt_pk_bf16_f32 v174, v148, v149
  v_cvt_pk_bf16_f32 v175, v150, v151
  v_mfma_f32_32x32x16_bf16 v[136:151], v[176:179], v[24:27], 0
  v_exp_f32 v152, v152
  v_exp_f32 v153, v153
  v_exp_f32 v154, v154
  v_mfma_f32_32x32x16_bf16 v[88:103], v[236:239], v[172:175], v[88:103]
  v_exp_f32 v155, v155
  v_exp_f32 v156, v156
  v_exp_f32 v157, v157
  v_smfmac_f32_16x16x64_bf16 v[128:131], v[16:19], v[168:175], v20
  v_exp_f32 v158, v158
  v_exp_f32 v159, v159
  v_mfma_f32_32x32x16_bf16 v[136:151], v[180:183], v[28:31], v[136:151]
  s_add_u32 s32, s32, 1
  v_cvt_pk_bf16_f32 v168, v152, v153
  v_cvt_pk_bf16_f32 v169, v154, v155
  v_cvt_pk_bf16_f32 v170, v156, v157
  v_cvt_pk_bf16_f32 v171, v158, v159
  v_exp_f32 v160, v160
  v_exp_f32 v161, v161
  v_exp_f32 v162, v162
  v_exp_f32 v163, v163
  v_mfma_f32_32x32x16_bf16 v[104:119], v[232:235], v[168:171], v[104:119]
  s_cmp_eq_u32 s35, 0
  v_exp_f32 v164, v164
  v_exp_f32 v165, v165
  v_exp_f32 v166, v166
  v_exp_f32 v167, v167
  v_cvt_pk_bf16_f32 v172, v160, v161
  v_cvt_pk_bf16_f32 v173, v162, v163
  v_cvt_pk_bf16_f32 v174, v164, v165
  v_cvt_pk_bf16_f32 v175, v166, v167
  v_mfma_f32_32x32x16_bf16 v[152:167], v[176:179], v[32:35], 0
  s_cbranch_scc1 .g2_kernel_a_loop
  s_branch .g2_kernel_a_redo
.g2_kernel_a_last:
  ds_read_b32 v21, v13 offset:8
  v_exp_f32 v136, v136
  v_exp_f32 v137, v137
  v_exp_f32 v138, v138
  v_mfma_f32_32x32x16_bf16 v[104:119], v[220:223], v[172:175], v[104:119]
  s_andn2_b32 s33, s36, s34
  v_exp_f32 v139, v139
  v_exp_f32 v140, v140
  v_exp_f32 v141, v141
  v_smfmac_f32_16x16x64_bf16 v[132:135], v[16:19], v[168:175], v20
  s_cbranch_scc0 .g2_kernel_a_L3c
.g2_kernel_a_L3b:
  v_exp_f32 v142, v142
  v_exp_f32 v143, v143
  v_mfma_f32_32x32x16_bf16 v[152:167], v[228:231], v[36:39], v[152:167]
  s_ff1_i32_b32 s33, s33
  ds_read_b128 v[24:27], v14 offset:0
  v_cvt_pk_bf16_f32 v168, v136, v137
  v_cvt_pk_bf16_f32 v169, v138, v139
  v_cvt_pk_bf16_f32 v170, v140, v141
  v_cvt_pk_bf16_f32 v171, v142, v143
  v_exp_f32 v144, v144
  v_exp_f32 v145, v145
  v_exp_f32 v146, v146
  v_exp_f32 v147, v147
  v_mfma_f32_32x32x16_bf16 v[56:71], v[232:235], v[168:171], v[56:71]
  s_bitset1_b32 s34, s33
  ds_read_b128 v[28:31], v14 offset:1024
  v_exp_f32 v148, v148
  v_exp_f32 v149, v149
  v_exp_f32 v150, v150
  v_exp_f32 v151, v151
  v_cvt_pk_bf16_f32 v172, v144, v145
  v_cvt_pk_bf16_f32 v173, v146, v147
  v_cvt_pk_bf16_f32 v174, v148, v149
  v_cvt_pk_bf16_f32 v175, v150, v151
  v_mfma_f32_32x32x16_bf16 v[136:151], v[224:227], v[40:43], 0
  s_waitcnt lgkmcnt(2)
  s_xor_b32 s33, s33, s24
  v_exp_f32 v152, v152
  v_exp_f32 v153, v153
  v_exp_f32 v154, v154
  v_mfma_f32_32x32x16_bf16 v[56:71], v[236:239], v[172:175], v[56:71]
  v_cmp_gt_u32 vcc, s27, v21
  s_lshl_b32 s33, s33, s25
  v_exp_f32 v155, v155
  v_exp_f32 v156, v156
  v_exp_f32 v157, v157
  v_smfmac_f32_16x16x64_bf16 v[120:123], v[16:19], v[168:175], v20
  s_add_u32 s22, s20, s33
  v_exp_f32 v158, v158
  v_exp_f32 v159, v159
  v_mfma_f32_32x32x16_bf16 v[136:151], v[228:231], v[44:47], v[136:151]
  s_addc_u32 s23, s21, 0
  v_cvt_pk_bf16_f32 v168, v152, v153
  v_cvt_pk_bf16_f32 v169, v154, v155
  v_cvt_pk_bf16_f32 v170, v156, v157
  v_cvt_pk_bf16_f32 v171, v158, v159
  v_exp_f32 v160, v160
  v_exp_f32 v161, v161
  v_exp_f32 v162, v162
  v_exp_f32 v163, v163
  v_mfma_f32_32x32x16_bf16 v[72:87], v[232:235], v[168:171], v[72:87]
  s_cbranch_vccnz .g2_kernel_a_L3g
.g2_kernel_a_L3h:
  ds_read_b128 v[32:35], v14 offset:2048
  ds_read_b128 v[36:39], v14 offset:3072
  v_cvt_pk_bf16_f32 v56, v56, v57
  v_cvt_pk_bf16_f32 v57, v58, v59
  v_cvt_pk_bf16_f32 v58, v60, v61
  v_cvt_pk_bf16_f32 v59, v62, v63
  v_add_f32 v6, v120, v121
  v_exp_f32 v164, v164
  v_exp_f32 v165, v165
  v_exp_f32 v166, v166
  v_exp_f32 v167, v167
  v_cvt_pk_bf16_f32 v172, v160, v161
  v_cvt_pk_bf16_f32 v173, v162, v163
  v_cvt_pk_bf16_f32 v174, v164, v165
  v_cvt_pk_bf16_f32 v175, v166, v167
  v_mfma_f32_32x32x16_bf16 v[152:167], v[224:227], v[48:51], 0
  ds_write_b128 v9, v[56:59] offset:0
  v_cvt_pk_bf16_f32 v60, v64, v65
  v_cvt_pk_bf16_f32 v61, v66, v67
  v_cvt_pk_bf16_f32 v62, v68, v69
  v_cvt_pk_bf16_f32 v63, v70, v71
  v_exp_f32 v136, v136
  v_exp_f32 v137, v137
  v_exp_f32 v138, v138
  v_mfma_f32_32x32x16_bf16 v[72:87], v[236:239], v[172:175], v[72:87]
  ds_write_b128 v9, v[60:63] offset:1024
  v_mov_b32 v120, 0
  v_mov_b32 v121, 0
  v_exp_f32 v139, v139
  v_exp_f32 v140, v140
  v_exp_f32 v141, v141
  v_smfmac_f32_16x16x64_bf16 v[124:127], v[16:19], v[168:175], v20
  global_load_dwordx4 v[208:211], v3, s[22:23] offset:0
  global_load_dwordx4 v[212:215], v3, s[22:23] offset:1024
  global_load_dwordx4 v[216:219], v3, s[22:23] offset:2048
  global_load_dwordx4 v[220:223], v3, s[22:23] offset:3072
  ds_write_b32 v10, v6 offset:0
  ds_write_b32 v11, v12 offset:0
  v_exp_f32 v142, v142
  v_exp_f32 v143, v143
  v_mfma_f32_32x32x16_bf16 v[152:167], v[228:231], v[52:55], v[152:167]
  ds_read_b128 v[40:43], v14 offset:4096
  s_wakeup
  v_cvt_pk_bf16_f32 v168, v136, v137
  v_cvt_pk_bf16_f32 v169, v138, v139
  v_cvt_pk_bf16_f32 v170, v140, v141
  v_cvt_pk_bf16_f32 v171, v142, v143
  v_exp_f32 v144, v144
  v_exp_f32 v145, v145
  v_exp_f32 v146, v146
  v_exp_f32 v147, v147
  v_mfma_f32_32x32x16_bf16 v[88:103], v[232:235], v[168:171], v[88:103]
  s_waitcnt vmcnt(8)
  ds_read_b128 v[44:47], v14 offset:5120
  v_cvt_pk_bf16_f32 v72, v72, v73
  v_cvt_pk_bf16_f32 v73, v74, v75
  v_cvt_pk_bf16_f32 v74, v76, v77
  v_cvt_pk_bf16_f32 v75, v78, v79
  v_add_f32 v6, v124, v125
  v_exp_f32 v148, v148
  v_exp_f32 v149, v149
  v_exp_f32 v150, v150
  v_exp_f32 v151, v151
  v_cvt_pk_bf16_f32 v172, v144, v145
  v_cvt_pk_bf16_f32 v173, v146, v147
  v_cvt_pk_bf16_f32 v174, v148, v149
  v_cvt_pk_bf16_f32 v175, v150, v151
  s_waitcnt lgkmcnt(8)
  v_mfma_f32_32x32x16_bf16 v[136:151], v[176:179], v[24:27], 0
  ds_write_b128 v9, v[72:75] offset:8192
  v_cvt_pk_bf16_f32 v76, v80, v81
  v_cvt_pk_bf16_f32 v77, v82, v83
  v_cvt_pk_bf16_f32 v78, v84, v85
  v_cvt_pk_bf16_f32 v79, v86, v87
  v_exp_f32 v152, v152
  v_exp_f32 v153, v153
  v_exp_f32 v154, v154
  v_mfma_f32_32x32x16_bf16 v[88:103], v[236:239], v[172:175], v[88:103]
  ds_write_b128 v9, v[76:79] offset:9216
  v_mov_b32 v124, 0
  v_mov_b32 v125, 0
  v_exp_f32 v155, v155
  v_exp_f32 v156, v156
  v_exp_f32 v157, v157
  v_smfmac_f32_16x16x64_bf16 v[128:131], v[16:19], v[168:175], v20
  ds_write_b32 v10, v6 offset:512
  ds_write_b32 v11, v12 offset:16
  v_exp_f32 v158, v158
  v_exp_f32 v159, v159
  v_mfma_f32_32x32x16_bf16 v[136:151], v[180:183], v[28:31], v[136:151]
  ds_read_b128 v[48:51], v14 offset:6144
  s_wakeup
  v_cvt_pk_bf16_f32 v168, v152, v153
  v_cvt_pk_bf16_f32 v169, v154, v155
  v_cvt_pk_bf16_f32 v170, v156, v157
  v_cvt_pk_bf16_f32 v171, v158, v159
  v_exp_f32 v160, v160
  v_exp_f32 v161, v161
  v_exp_f32 v162, v162
  v_exp_f32 v163, v163
  v_mfma_f32_32x32x16_bf16 v[104:119], v[232:235], v[168:171], v[104:119]
  ds_read_b128 v[52:55], v14 offset:7168
  v_cvt_pk_bf16_f32 v88, v88, v89
  v_cvt_pk_bf16_f32 v89, v90, v91
  v_cvt_pk_bf16_f32 v90, v92, v93
  v_cvt_pk_bf16_f32 v91, v94, v95
  v_add_f32 v6, v128, v129
  ds_write_b128 v9, v[88:91] offset:16384
  v_cvt_pk_bf16_f32 v92, v96, v97
  v_cvt_pk_bf16_f32 v93, v98, v99
  v_cvt_pk_bf16_f32 v94, v100, v101
  v_cvt_pk_bf16_f32 v95, v102, v103
  ds_write_b128 v9, v[92:95] offset:17408
  v_mov_b32 v128, 0
  v_mov_b32 v129, 0
  ds_write_b32 v10, v6 offset:1024
  ds_write_b32 v11, v12 offset:32
  s_add_u32 s32, s32, 1
  v_exp_f32 v164, v164
  v_exp_f32 v165, v165
  v_exp_f32 v166, v166
  v_exp_f32 v167, v167
  v_cvt_pk_bf16_f32 v172, v160, v161
  v_cvt_pk_bf16_f32 v173, v162, v163
  v_cvt_pk_bf16_f32 v174, v164, v165
  v_cvt_pk_bf16_f32 v175, v166, v167
  s_cmp_eq_u32 s32, 8
  s_cbranch_scc1 .g2_kernel_a_end
  s_waitcnt lgkmcnt(15)
  v_mfma_f32_32x32x16_bf16 v[152:167], v[176:179], v[32:35], 0
  s_andn2_b32 s33, s36, s34
  v_exp_f32 v136, v136
  v_exp_f32 v137, v137
  v_exp_f32 v138, v138
  v_mfma_f32_32x32x16_bf16 v[104:119], v[236:239], v[172:175], v[104:119]
  s_cbranch_scc0 .g2_kernel_a_G0c
.g2_kernel_a_G0b:
  v_exp_f32 v139, v139
  v_exp_f32 v140, v140
  v_exp_f32 v141, v141
  v_smfmac_f32_16x16x64_bf16 v[132:135], v[16:19], v[168:175], v20
  s_ff1_i32_b32 s33, s33
  v_exp_f32 v142, v142
  v_exp_f32 v143, v143
  v_mfma_f32_32x32x16_bf16 v[152:167], v[180:183], v[36:39], v[152:167]
  s_bitset1_b32 s34, s33
  v_cvt_pk_bf16_f32 v168, v136, v137
  v_cvt_pk_bf16_f32 v169, v138, v139
  v_cvt_pk_bf16_f32 v170, v140, v141
  v_cvt_pk_bf16_f32 v171, v142, v143
  v_exp_f32 v144, v144
  v_exp_f32 v145, v145
  v_exp_f32 v146, v146
  v_exp_f32 v147, v147
  s_waitcnt lgkmcnt(14)
  v_mfma_f32_32x32x16_bf16 v[56:71], v[184:187], v[168:171], 0
  s_xor_b32 s33, s33, s24
  v_cvt_pk_bf16_f32 v104, v104, v105
  v_cvt_pk_bf16_f32 v105, v106, v107
  v_cvt_pk_bf16_f32 v106, v108, v109
  v_cvt_pk_bf16_f32 v107, v110, v111
  v_add_f32 v6, v132, v133
  v_exp_f32 v148, v148
  v_exp_f32 v149, v149
  v_exp_f32 v150, v150
  v_exp_f32 v151, v151
  v_cvt_pk_bf16_f32 v172, v144, v145
  v_cvt_pk_bf16_f32 v173, v146, v147
  v_cvt_pk_bf16_f32 v174, v148, v149
  v_cvt_pk_bf16_f32 v175, v150, v151
  s_waitcnt lgkmcnt(10)
  v_mfma_f32_32x32x16_bf16 v[136:151], v[176:179], v[40:43], 0
  s_lshl_b32 s33, s33, s25
  ds_write_b128 v9, v[104:107] offset:24576
  v_cvt_pk_bf16_f32 v108, v112, v113
  v_cvt_pk_bf16_f32 v109, v114, v115
  v_cvt_pk_bf16_f32 v110, v116, v117
  v_cvt_pk_bf16_f32 v111, v118, v119
  v_exp_f32 v152, v152
  v_exp_f32 v153, v153
  v_exp_f32 v154, v154
  v_mfma_f32_32x32x16_bf16 v[56:71], v[188:191], v[172:175], v[56:71]
  s_add_u32 s22, s20, s33
  ds_write_b128 v9, v[108:111] offset:25600
  v_mov_b32 v132, 0
  v_mov_b32 v133, 0
  v_exp_f32 v155, v155
  v_exp_f32 v156, v156
  v_exp_f32 v157, v157
  v_smfmac_f32_16x16x64_bf16 v[120:123], v[16:19], v[168:175], v20
  s_addc_u32 s23, s21, 0
  ds_write_b32 v10, v6 offset:1536
  v_exp_f32 v158, v158
  v_exp_f32 v159, v159
  v_mfma_f32_32x32x16_bf16 v[136:151], v[180:183], v[44:47], v[136:151]
  v_cvt_pk_bf16_f32 v168, v152, v153
  v_cvt_pk_bf16_f32 v169, v154, v155
  v_cvt_pk_bf16_f32 v170, v156, v157
  v_cvt_pk_bf16_f32 v171, v158, v159
  v_exp_f32 v160, v160
  v_exp_f32 v161, v161
  v_exp_f32 v162, v162
  v_exp_f32 v163, v163
  s_waitcnt lgkmcnt(11)
  v_mfma_f32_32x32x16_bf16 v[72:87], v[184:187], v[168:171], 0
  ds_write_b32 v11, v12 offset:48
  v_exp_f32 v164, v164
  v_exp_f32 v165, v165
  v_exp_f32 v166, v166
  v_exp_f32 v167, v167
  v_cvt_pk_bf16_f32 v172, v160, v161
  v_cvt_pk_bf16_f32 v173, v162, v163
  v_cvt_pk_bf16_f32 v174, v164, v165
  v_cvt_pk_bf16_f32 v175, v166, v167
  s_waitcnt lgkmcnt(8)
  v_mfma_f32_32x32x16_bf16 v[152:167], v[176:179], v[48:51], 0
  v_add_u32 v12, 1, v12
  v_exp_f32 v136, v136
  v_exp_f32 v137, v137
  v_exp_f32 v138, v138
  v_mfma_f32_32x32x16_bf16 v[72:87], v[188:191], v[172:175], v[72:87]
  v_exp_f32 v139, v139
  v_exp_f32 v140, v140
  v_exp_f32 v141, v141
  v_smfmac_f32_16x16x64_bf16 v[124:127], v[16:19], v[168:175], v20
  global_load_dwordx4 v[224:227], v3, s[22:23] offset:0
  global_load_dwordx4 v[228:231], v3, s[22:23] offset:1024
  global_load_dwordx4 v[232:235], v3, s[22:23] offset:2048
  global_load_dwordx4 v[236:239], v3, s[22:23] offset:3072
  s_add_u32 s27, s27, 4
  v_exp_f32 v142, v142
  v_exp_f32 v143, v143
  v_mfma_f32_32x32x16_bf16 v[152:167], v[180:183], v[52:55], v[152:167]
  v_cvt_pk_bf16_f32 v168, v136, v137
  v_cvt_pk_bf16_f32 v169, v138, v139
  v_cvt_pk_bf16_f32 v170, v140, v141
  v_cvt_pk_bf16_f32 v171, v142, v143
  v_exp_f32 v144, v144
  v_exp_f32 v145, v145
  v_exp_f32 v146, v146
  v_exp_f32 v147, v147
  s_waitcnt lgkmcnt(6)
  v_mfma_f32_32x32x16_bf16 v[88:103], v[184:187], v[168:171], 0
  s_waitcnt vmcnt(8)
  v_exp_f32 v148, v148
  v_exp_f32 v149, v149
  v_exp_f32 v150, v150
  v_exp_f32 v151, v151
  v_cvt_pk_bf16_f32 v172, v144, v145
  v_cvt_pk_bf16_f32 v173, v146, v147
  v_cvt_pk_bf16_f32 v174, v148, v149
  v_cvt_pk_bf16_f32 v175, v150, v151
  v_mfma_f32_32x32x16_bf16 v[136:151], v[192:195], v[24:27], 0
  v_exp_f32 v152, v152
  v_exp_f32 v153, v153
  v_exp_f32 v154, v154
  v_mfma_f32_32x32x16_bf16 v[88:103], v[188:191], v[172:175], v[88:103]
  v_exp_f32 v155, v155
  v_exp_f32 v156, v156
  v_exp_f32 v157, v157
  v_smfmac_f32_16x16x64_bf16 v[128:131], v[16:19], v[168:175], v20
  v_exp_f32 v158, v158
  v_exp_f32 v159, v159
  v_mfma_f32_32x32x16_bf16 v[136:151], v[196:199], v[28:31], v[136:151]
  v_cvt_pk_bf16_f32 v168, v152, v153
  v_cvt_pk_bf16_f32 v169, v154, v155
  v_cvt_pk_bf16_f32 v170, v156, v157
  v_cvt_pk_bf16_f32 v171, v158, v159
  v_exp_f32 v160, v160
  v_exp_f32 v161, v161
  v_exp_f32 v162, v162
  v_exp_f32 v163, v163
  s_waitcnt lgkmcnt(2)
  v_mfma_f32_32x32x16_bf16 v[104:119], v[184:187], v[168:171], 0
  v_exp_f32 v164, v164
  v_exp_f32 v165, v165
  v_exp_f32 v166, v166
  v_exp_f32 v167, v167
  v_cvt_pk_bf16_f32 v172, v160, v161
  v_cvt_pk_bf16_f32 v173, v162, v163
  v_cvt_pk_bf16_f32 v174, v164, v165
  v_cvt_pk_bf16_f32 v175, v166, v167
  s_branch .g2_kernel_a_n1
.g2_kernel_a_end:
  v_mfma_f32_32x32x16_bf16 v[104:119], v[236:239], v[172:175], v[104:119]
  v_smfmac_f32_16x16x64_bf16 v[132:135], v[16:19], v[168:175], v20
  s_wakeup
  s_nop 9
  v_cvt_pk_bf16_f32 v104, v104, v105
  v_cvt_pk_bf16_f32 v105, v106, v107
  v_cvt_pk_bf16_f32 v106, v108, v109
  v_cvt_pk_bf16_f32 v107, v110, v111
  v_add_f32 v6, v132, v133
  ds_write_b128 v9, v[104:107] offset:24576
  v_cvt_pk_bf16_f32 v108, v112, v113
  v_cvt_pk_bf16_f32 v109, v114, v115
  v_cvt_pk_bf16_f32 v110, v116, v117
  v_cvt_pk_bf16_f32 v111, v118, v119
  ds_write_b128 v9, v[108:111] offset:25600
  v_mov_b32 v132, 0
  v_mov_b32 v133, 0
  ds_write_b32 v10, v6 offset:1536
  ds_write_b32 v11, v12 offset:48
  s_waitcnt lgkmcnt(4)
  v_mov_b32 v20, s71
  v_lshrrev_b32 v17, 5, v2
  v_and_b32 v18, 31, v2
  s_lshl_b32 s28, s16, 5
  v_add_u32 v19, s28, v18
  v_lshlrev_b32 v7, 2, v19
  v_add_u32 v7, 155648, v7
  ds_read_b32 v8, v7 offset:3840
  ds_read_b32 v9, v7 offset:4352
  ds_read_b32 v16, v20 offset:24
  ds_read_b32 v6, v20 offset:52
  v_add_u32 v19, 1, v19
  v_bfe_u32 v7, v2, 2, 2
  v_lshl_add_u32 v14, v17, 2, v7
  v_lshlrev_b32 v14, 7, v14
  v_lshrrev_b32 v7, 1, v7
  v_lshl_add_u32 v14, v7, 6, v14
  v_bfe_u32 v7, v2, 4, 1
  v_lshl_add_u32 v14, v7, 5, v14
  v_and_b32 v7, 1, v2
  v_lshl_add_u32 v14, v7, 4, v14
  v_bfe_u32 v7, v2, 1, 1
  v_lshl_add_u32 v14, v7, 3, v14
  v_xor_b32 v15, 64, v14
  v_and_b32 v7, 7, v2
  v_xor_b32 v7, s24, v7
  s_mov_b32 s28, 192
  s_add_u32 s28, s28, 157952
  v_lshl_add_u32 v21, v7, 3, s28
  v_lshlrev_b32 v24, 16, v240
  v_and_b32 v25, 0xffff0000, v240
  v_lshlrev_b32 v26, 16, v241
  v_and_b32 v27, 0xffff0000, v241
  v_lshlrev_b32 v28, 16, v242
  v_and_b32 v29, 0xffff0000, v242
  v_lshlrev_b32 v30, 16, v243
  v_and_b32 v31, 0xffff0000, v243
  v_lshlrev_b32 v32, 16, v244
  v_and_b32 v33, 0xffff0000, v244
  v_lshlrev_b32 v34, 16, v245
  v_and_b32 v35, 0xffff0000, v245
  v_lshlrev_b32 v36, 16, v246
  v_and_b32 v37, 0xffff0000, v246
  v_lshlrev_b32 v38, 16, v247
  v_and_b32 v39, 0xffff0000, v247
  v_lshlrev_b32 v40, 16, v248
  v_and_b32 v41, 0xffff0000, v248
  v_lshlrev_b32 v42, 16, v249
  v_and_b32 v43, 0xffff0000, v249
  v_lshlrev_b32 v44, 16, v250
  v_and_b32 v45, 0xffff0000, v250
  v_lshlrev_b32 v46, 16, v251
  v_and_b32 v47, 0xffff0000, v251
  v_lshlrev_b32 v48, 16, v252
  v_and_b32 v49, 0xffff0000, v252
  v_lshlrev_b32 v50, 16, v253
  v_and_b32 v51, 0xffff0000, v253
  v_lshlrev_b32 v52, 16, v254
  v_and_b32 v53, 0xffff0000, v254
  v_lshlrev_b32 v54, 16, v255
  v_and_b32 v55, 0xffff0000, v255
  s_waitcnt lgkmcnt(0)
  v_cmp_gt_u32 vcc, 4, v6
  s_cbranch_vccnz .g2_kernel_w_aw
.g2_kernel_w_ab:
  s_xor_b32 s28, s24, 0
  s_lshl_b32 s28, s28, 13
  s_add_u32 s28, s28, 65536
  v_add_u32 v10, s28, v14
  v_add_u32 v11, s28, v15
  ds_read_b64_tr_b16 v[104:105], v10 offset:0
  ds_read_b64_tr_b16 v[106:107], v10 offset:1024
  ds_read_b64_tr_b16 v[108:109], v11 offset:0
  ds_read_b64_tr_b16 v[110:111], v11 offset:1024
  ds_read_b64_tr_b16 v[112:113], v10 offset:2048
  ds_read_b64_tr_b16 v[114:115], v10 offset:3072
  ds_read_b64_tr_b16 v[116:117], v11 offset:2048
  ds_read_b64_tr_b16 v[118:119], v11 offset:3072
  ds_read_b64_tr_b16 v[120:121], v10 offset:4096
  ds_read_b64_tr_b16 v[122:123], v10 offset:5120
  ds_read_b64_tr_b16 v[124:125], v11 offset:4096
  ds_read_b64_tr_b16 v[126:127], v11 offset:5120
  s_andn2_b32 s33, s36, s34
  s_ff1_i32_b32 s33, s33
  s_bitset1_b32 s34, s33
  s_xor_b32 s33, s33, s24
  s_lshl_b32 s33, s33, 12
  s_add_u32 s22, s20, s33
  s_addc_u32 s23, s21, 0
  global_load_dwordx4 v[224:227], v3, s[22:23] offset:0
  global_load_dwordx4 v[228:231], v3, s[22:23] offset:1024
  global_load_dwordx4 v[232:235], v3, s[22:23] offset:2048
  global_load_dwordx4 v[236:239], v3, s[22:23] offset:3072
  v_pk_fma_f32 v[24:25], v[24:25], v[8:9], v[8:9] op_sel:[0,0,1] op_sel_hi:[1,0,1]
  v_pk_fma_f32 v[26:27], v[26:27], v[8:9], v[8:9] op_sel:[0,0,1] op_sel_hi:[1,0,1]
  v_pk_fma_f32 v[28:29], v[28:29], v[8:9], v[8:9] op_sel:[0,0,1] op_sel_hi:[1,0,1]
  v_pk_fma_f32 v[30:31], v[30:31], v[8:9], v[8:9] op_sel:[0,0,1] op_sel_hi:[1,0,1]
  v_pk_fma_f32 v[32:33], v[32:33], v[8:9], v[8:9] op_sel:[0,0,1] op_sel_hi:[1,0,1]
  v_pk_fma_f32 v[34:35], v[34:35], v[8:9], v[8:9] op_sel:[0,0,1] op_sel_hi:[1,0,1]
  v_pk_fma_f32 v[36:37], v[36:37], v[8:9], v[8:9] op_sel:[0,0,1] op_sel_hi:[1,0,1]
  v_pk_fma_f32 v[38:39], v[38:39], v[8:9], v[8:9] op_sel:[0,0,1] op_sel_hi:[1,0,1]
  v_pk_fma_f32 v[40:41], v[40:41], v[8:9], v[8:9] op_sel:[0,0,1] op_sel_hi:[1,0,1]
  v_pk_fma_f32 v[42:43], v[42:43], v[8:9], v[8:9] op_sel:[0,0,1] op_sel_hi:[1,0,1]
  v_pk_fma_f32 v[44:45], v[44:45], v[8:9], v[8:9] op_sel:[0,0,1] op_sel_hi:[1,0,1]
  v_pk_fma_f32 v[46:47], v[46:47], v[8:9], v[8:9] op_sel:[0,0,1] op_sel_hi:[1,0,1]
  v_pk_fma_f32 v[48:49], v[48:49], v[8:9], v[8:9] op_sel:[0,0,1] op_sel_hi:[1,0,1]
  v_pk_fma_f32 v[50:51], v[50:51], v[8:9], v[8:9] op_sel:[0,0,1] op_sel_hi:[1,0,1]
  v_pk_fma_f32 v[52:53], v[52:53], v[8:9], v[8:9] op_sel:[0,0,1] op_sel_hi:[1,0,1]
  v_pk_fma_f32 v[54:55], v[54:55], v[8:9], v[8:9] op_sel:[0,0,1] op_sel_hi:[1,0,1]
  v_cmp_eq_u32 vcc, v16, v19
  s_cbranch_vccnz .g2_kernel_w_pt
.g2_kernel_w_pb:
  s_mov_b32 s72, s48
  s_mov_b32 s73, s49
  s_mov_b32 s74, 0x800
  s_mov_b32 s75, 0x00020000
  s_waitcnt vmcnt(15) lgkmcnt(8)
  v_mfma_f32_32x32x16_bf16 v[24:39], v[104:107], v[176:179], v[24:39]
  s_xor_b32 s28, s24, 1
  s_lshl_b32 s28, s28, 13
  s_add_u32 s28, s28, 65536
  ds_read_b64_tr_b16 v[128:129], v10 offset:6144
  ds_read_b64_tr_b16 v[130:131], v10 offset:7168
  v_mfma_f32_32x32x16_bf16 v[40:55], v[108:111], v[176:179], v[40:55]
  v_add_u32 v12, s28, v14
  v_add_u32 v13, s28, v15
  s_andn2_b32 s33, s36, s34
  ds_read_b64_tr_b16 v[132:133], v11 offset:6144
  ds_read_b64_tr_b16 v[134:135], v11 offset:7168
  s_waitcnt vmcnt(14) lgkmcnt(8)
  v_mfma_f32_32x32x16_bf16 v[24:39], v[112:115], v[180:183], v[24:39]
  s_ff1_i32_b32 s33, s33
  s_bitset1_b32 s34, s33
  s_xor_b32 s33, s33, s24
  ds_read_b64_tr_b16 v[104:105], v12 offset:0
  ds_read_b64_tr_b16 v[106:107], v12 offset:1024
  v_mfma_f32_32x32x16_bf16 v[40:55], v[116:119], v[180:183], v[40:55]
  s_lshl_b32 s33, s33, 12
  s_add_u32 s22, s20, s33
  s_addc_u32 s23, s21, 0
  ds_read_b64_tr_b16 v[108:109], v13 offset:0
  ds_read_b64_tr_b16 v[110:111], v13 offset:1024
  s_waitcnt vmcnt(13) lgkmcnt(8)
  v_mfma_f32_32x32x16_bf16 v[24:39], v[120:123], v[184:187], v[24:39]
  global_load_dwordx4 v[136:139], v3, s[22:23] offset:0
  global_load_dwordx4 v[140:143], v3, s[22:23] offset:1024
  global_load_dwordx4 v[144:147], v3, s[22:23] offset:2048
  ds_read_b64_tr_b16 v[112:113], v12 offset:2048
  ds_read_b64_tr_b16 v[114:115], v12 offset:3072
  v_mfma_f32_32x32x16_bf16 v[40:55], v[124:127], v[184:187], v[40:55]
  global_load_dwordx4 v[148:151], v3, s[22:23] offset:3072
  ds_read_b64_tr_b16 v[116:117], v13 offset:2048
  ds_read_b64_tr_b16 v[118:119], v13 offset:3072
  s_waitcnt vmcnt(16) lgkmcnt(8)
  v_mfma_f32_32x32x16_bf16 v[24:39], v[128:131], v[188:191], v[24:39]
  ds_read_b64_tr_b16 v[120:121], v12 offset:4096
  ds_read_b64_tr_b16 v[122:123], v12 offset:5120
  v_mfma_f32_32x32x16_bf16 v[40:55], v[132:135], v[188:191], v[40:55]
  ds_read_b64_tr_b16 v[124:125], v13 offset:4096
  ds_read_b64_tr_b16 v[126:127], v13 offset:5120
  s_waitcnt vmcnt(15) lgkmcnt(8)
  v_mfma_f32_32x32x16_bf16 v[24:39], v[104:107], v[192:195], v[24:39]
  s_xor_b32 s28, s24, 2
  s_lshl_b32 s28, s28, 13
  s_add_u32 s28, s28, 65536
  ds_read_b64_tr_b16 v[128:129], v12 offset:6144
  ds_read_b64_tr_b16 v[130:131], v12 offset:7168
  v_mfma_f32_32x32x16_bf16 v[40:55], v[108:111], v[192:195], v[40:55]
  v_add_u32 v10, s28, v14
  v_add_u32 v11, s28, v15
  s_andn2_b32 s33, s36, s34
  ds_read_b64_tr_b16 v[132:133], v13 offset:6144
  ds_read_b64_tr_b16 v[134:135], v13 offset:7168
  s_waitcnt vmcnt(14) lgkmcnt(8)
  v_mfma_f32_32x32x16_bf16 v[24:39], v[112:115], v[196:199], v[24:39]
  s_ff1_i32_b32 s33, s33
  s_bitset1_b32 s34, s33
  s_xor_b32 s33, s33, s24
  ds_read_b64_tr_b16 v[104:105], v10 offset:0
  ds_read_b64_tr_b16 v[106:107], v10 offset:1024
  v_mfma_f32_32x32x16_bf16 v[40:55], v[116:119], v[196:199], v[40:55]
  s_lshl_b32 s33, s33, 12
  s_add_u32 s22, s20, s33
  s_addc_u32 s23, s21, 0
  ds_read_b64_tr_b16 v[108:109], v11 offset:0
  ds_read_b64_tr_b16 v[110:111], v11 offset:1024
  s_waitcnt vmcnt(13) lgkmcnt(8)
  v_mfma_f32_32x32x16_bf16 v[24:39], v[120:123], v[200:203], v[24:39]
  global_load_dwordx4 v[152:155], v3, s[22:23] offset:0
  global_load_dwordx4 v[156:159], v3, s[22:23] offset:1024
  global_load_dwordx4 v[160:163], v3, s[22:23] offset:2048
  ds_read_b64_tr_b16 v[112:113], v10 offset:2048
  ds_read_b64_tr_b16 v[114:115], v10 offset:3072
  v_mfma_f32_32x32x16_bf16 v[40:55], v[124:127], v[200:203], v[40:55]
  global_load_dwordx4 v[164:167], v3, s[22:23] offset:3072
  ds_read_b64_tr_b16 v[116:117], v11 offset:2048
  ds_read_b64_tr_b16 v[118:119], v11 offset:3072
  s_waitcnt vmcnt(16) lgkmcnt(8)
  v_mfma_f32_32x32x16_bf16 v[24:39], v[128:131], v[204:207], v[24:39]
  ds_read_b64_tr_b16 v[120:121], v10 offset:4096
  ds_read_b64_tr_b16 v[122:123], v10 offset:5120
  v_mfma_f32_32x32x16_bf16 v[40:55], v[132:135], v[204:207], v[40:55]
  ds_read_b64_tr_b16 v[124:125], v11 offset:4096
  ds_read_b64_tr_b16 v[126:127], v11 offset:5120
  s_waitcnt vmcnt(15) lgkmcnt(8)
  v_mfma_f32_32x32x16_bf16 v[24:39], v[104:107], v[208:211], v[24:39]
  s_xor_b32 s28, s24, 3
  s_lshl_b32 s28, s28, 13
  s_add_u32 s28, s28, 65536
  ds_read_b64_tr_b16 v[128:129], v10 offset:6144
  ds_read_b64_tr_b16 v[130:131], v10 offset:7168
  v_mfma_f32_32x32x16_bf16 v[40:55], v[108:111], v[208:211], v[40:55]
  v_add_u32 v12, s28, v14
  v_add_u32 v13, s28, v15
  s_andn2_b32 s33, s36, s34
  ds_read_b64_tr_b16 v[132:133], v11 offset:6144
  ds_read_b64_tr_b16 v[134:135], v11 offset:7168
  s_waitcnt vmcnt(14) lgkmcnt(8)
  v_mfma_f32_32x32x16_bf16 v[24:39], v[112:115], v[212:215], v[24:39]
  s_ff1_i32_b32 s33, s33
  s_bitset1_b32 s34, s33
  s_xor_b32 s33, s33, s24
  ds_read_b64_tr_b16 v[104:105], v12 offset:0
  ds_read_b64_tr_b16 v[106:107], v12 offset:1024
  v_mfma_f32_32x32x16_bf16 v[40:55], v[116:119], v[212:215], v[40:55]
  s_lshl_b32 s33, s33, 12
  s_add_u32 s22, s20, s33
  s_addc_u32 s23, s21, 0
  ds_read_b64_tr_b16 v[108:109], v13 offset:0
  ds_read_b64_tr_b16 v[110:111], v13 offset:1024
  s_waitcnt vmcnt(13) lgkmcnt(8)
  v_mfma_f32_32x32x16_bf16 v[24:39], v[120:123], v[216:219], v[24:39]
  global_load_dwordx4 v[56:59], v3, s[22:23] offset:0
  global_load_dwordx4 v[60:63], v3, s[22:23] offset:1024
  global_load_dwordx4 v[64:67], v3, s[22:23] offset:2048
  ds_read_b64_tr_b16 v[112:113], v12 offset:2048
  ds_read_b64_tr_b16 v[114:115], v12 offset:3072
  v_mfma_f32_32x32x16_bf16 v[40:55], v[124:127], v[216:219], v[40:55]
  global_load_dwordx4 v[68:71], v3, s[22:23] offset:3072
  ds_read_b64_tr_b16 v[116:117], v13 offset:2048
  ds_read_b64_tr_b16 v[118:119], v13 offset:3072
  s_waitcnt vmcnt(16) lgkmcnt(8)
  v_mfma_f32_32x32x16_bf16 v[24:39], v[128:131], v[220:223], v[24:39]
  ds_read_b64_tr_b16 v[120:121], v12 offset:4096
  ds_read_b64_tr_b16 v[122:123], v12 offset:5120
  v_mfma_f32_32x32x16_bf16 v[40:55], v[132:135], v[220:223], v[40:55]
  ds_read_b64_tr_b16 v[124:125], v13 offset:4096
  ds_read_b64_tr_b16 v[126:127], v13 offset:5120
  s_waitcnt vmcnt(15) lgkmcnt(8)
  v_mfma_f32_32x32x16_bf16 v[24:39], v[104:107], v[224:227], v[24:39]
  s_xor_b32 s28, s24, 4
  s_lshl_b32 s28, s28, 13
  s_add_u32 s28, s28, 65536
  ds_read_b64_tr_b16 v[128:129], v12 offset:6144
  ds_read_b64_tr_b16 v[130:131], v12 offset:7168
  v_mfma_f32_32x32x16_bf16 v[40:55], v[108:111], v[224:227], v[40:55]
  v_add_u32 v10, s28, v14
  v_add_u32 v11, s28, v15
  s_andn2_b32 s33, s36, s34
  ds_read_b64_tr_b16 v[132:133], v13 offset:6144
  ds_read_b64_tr_b16 v[134:135], v13 offset:7168
  s_waitcnt vmcnt(14) lgkmcnt(8)
  v_mfma_f32_32x32x16_bf16 v[24:39], v[112:115], v[228:231], v[24:39]
  s_ff1_i32_b32 s33, s33
  s_bitset1_b32 s34, s33
  s_xor_b32 s33, s33, s24
  ds_read_b64_tr_b16 v[104:105], v10 offset:0
  ds_read_b64_tr_b16 v[106:107], v10 offset:1024
  v_mfma_f32_32x32x16_bf16 v[40:55], v[116:119], v[228:231], v[40:55]
  s_lshl_b32 s33, s33, 12
  s_add_u32 s22, s20, s33
  s_addc_u32 s23, s21, 0
  ds_read_b64_tr_b16 v[108:109], v11 offset:0
  ds_read_b64_tr_b16 v[110:111], v11 offset:1024
  s_waitcnt vmcnt(13) lgkmcnt(8)
  v_mfma_f32_32x32x16_bf16 v[24:39], v[120:123], v[232:235], v[24:39]
  global_load_dwordx4 v[72:75], v3, s[22:23] offset:0
  global_load_dwordx4 v[76:79], v3, s[22:23] offset:1024
  global_load_dwordx4 v[80:83], v3, s[22:23] offset:2048
  ds_read_b64_tr_b16 v[112:113], v10 offset:2048
  ds_read_b64_tr_b16 v[114:115], v10 offset:3072
  v_mfma_f32_32x32x16_bf16 v[40:55], v[124:127], v[232:235], v[40:55]
  global_load_dwordx4 v[84:87], v3, s[22:23] offset:3072
  ds_read_b64_tr_b16 v[116:117], v11 offset:2048
  ds_read_b64_tr_b16 v[118:119], v11 offset:3072
  s_waitcnt vmcnt(16) lgkmcnt(8)
  v_mfma_f32_32x32x16_bf16 v[24:39], v[128:131], v[236:239], v[24:39]
  ds_read_b64_tr_b16 v[120:121], v10 offset:4096
  ds_read_b64_tr_b16 v[122:123], v10 offset:5120
  v_mfma_f32_32x32x16_bf16 v[40:55], v[132:135], v[236:239], v[40:55]
  ds_read_b64_tr_b16 v[124:125], v11 offset:4096
  ds_read_b64_tr_b16 v[126:127], v11 offset:5120
  s_waitcnt vmcnt(15) lgkmcnt(8)
  v_mfma_f32_32x32x16_bf16 v[24:39], v[104:107], v[136:139], v[24:39]
  s_xor_b32 s28, s24, 5
  s_lshl_b32 s28, s28, 13
  s_add_u32 s28, s28, 65536
  v_add_u32 v12, s28, v14
  ds_read_b64_tr_b16 v[128:129], v10 offset:6144
  ds_read_b64_tr_b16 v[130:131], v10 offset:7168
  v_mfma_f32_32x32x16_bf16 v[40:55], v[108:111], v[136:139], v[40:55]
  v_add_u32 v13, s28, v15
  s_andn2_b32 s33, s36, s34
  s_cbranch_scc0 .g2_kernel_w_i8c
.g2_kernel_w_i8b:
  s_ff1_i32_b32 s33, s33
  ds_read_b64_tr_b16 v[132:133], v11 offset:6144
  ds_read_b64_tr_b16 v[134:135], v11 offset:7168
  s_waitcnt vmcnt(14) lgkmcnt(8)
  v_mfma_f32_32x32x16_bf16 v[24:39], v[112:115], v[140:143], v[24:39]
  s_bitset1_b32 s34, s33
  s_xor_b32 s33, s33, s24
  s_and_b32 s8, s33, 7
  s_cmp_lt_u32 s8, 2
  ds_read_b64_tr_b16 v[104:105], v12 offset:0
  ds_read_b64_tr_b16 v[106:107], v12 offset:1024
  v_mfma_f32_32x32x16_bf16 v[40:55], v[116:119], v[140:143], v[40:55]
  s_cselect_b32 s28, 139264, 0
  s_lshl_b32 s8, s8, 13
  s_add_u32 s8, s8, s28
  s_lshl_b32 s33, s33, 12
  ds_read_b64_tr_b16 v[108:109], v13 offset:0
  ds_read_b64_tr_b16 v[110:111], v13 offset:1024
  s_waitcnt vmcnt(13) lgkmcnt(8)
  v_mfma_f32_32x32x16_bf16 v[24:39], v[120:123], v[144:147], v[24:39]
  s_add_u32 s22, s20, s33
  s_addc_u32 s23, s21, 0
  global_load_dwordx4 v[88:91], v3, s[22:23] offset:0
  global_load_dwordx4 v[92:95], v3, s[22:23] offset:1024
  ds_read_b64_tr_b16 v[112:113], v12 offset:2048
  ds_read_b64_tr_b16 v[114:115], v12 offset:3072
  v_mfma_f32_32x32x16_bf16 v[40:55], v[124:127], v[144:147], v[40:55]
  global_load_dwordx4 v[96:99], v3, s[22:23] offset:2048
  global_load_dwordx4 v[100:103], v3, s[22:23] offset:3072
  ds_read_b64_tr_b16 v[116:117], v13 offset:2048
  ds_read_b64_tr_b16 v[118:119], v13 offset:3072
  s_waitcnt vmcnt(16) lgkmcnt(8)
  v_mfma_f32_32x32x16_bf16 v[24:39], v[128:131], v[148:151], v[24:39]
  ds_read_b64_tr_b16 v[120:121], v12 offset:4096
  ds_read_b64_tr_b16 v[122:123], v12 offset:5120
  v_mfma_f32_32x32x16_bf16 v[40:55], v[132:135], v[148:151], v[40:55]
  ds_read_b64_tr_b16 v[124:125], v13 offset:4096
  ds_read_b64_tr_b16 v[126:127], v13 offset:5120
  s_waitcnt vmcnt(15) lgkmcnt(8)
  v_mfma_f32_32x32x16_bf16 v[24:39], v[104:107], v[152:155], v[24:39]
  s_xor_b32 s28, s24, 6
  s_lshl_b32 s28, s28, 13
  s_add_u32 s28, s28, 65536
  v_add_u32 v10, s28, v14
  v_add_u32 v11, s28, v15
  ds_read_b64_tr_b16 v[128:129], v12 offset:6144
  ds_read_b64_tr_b16 v[130:131], v12 offset:7168
  v_mfma_f32_32x32x16_bf16 v[40:55], v[108:111], v[152:155], v[40:55]
  s_andn2_b32 s33, s36, s34
  s_cbranch_scc0 .g2_kernel_w_i9c
.g2_kernel_w_i9b:
  s_ff1_i32_b32 s33, s33
  s_bitset1_b32 s34, s33
  s_xor_b32 s33, s33, s24
  ds_read_b64_tr_b16 v[132:133], v13 offset:6144
  ds_read_b64_tr_b16 v[134:135], v13 offset:7168
  s_waitcnt vmcnt(14) lgkmcnt(8)
  v_mfma_f32_32x32x16_bf16 v[24:39], v[112:115], v[156:159], v[24:39]
  s_and_b32 s9, s33, 7
  s_cmp_lt_u32 s9, 2
  s_cselect_b32 s28, 139264, 0
  s_lshl_b32 s9, s9, 13
  s_add_u32 s9, s9, s28
  ds_read_b64_tr_b16 v[104:105], v10 offset:0
  ds_read_b64_tr_b16 v[106:107], v10 offset:1024
  v_mfma_f32_32x32x16_bf16 v[40:55], v[116:119], v[156:159], v[40:55]
  s_lshl_b32 s33, s33, 12
  s_add_u32 s22, s20, s33
  s_addc_u32 s23, s21, 0
  global_load_dwordx4 v[176:179], v3, s[22:23] offset:0
  global_load_dwordx4 v[180:183], v3, s[22:23] offset:1024
  ds_read_b64_tr_b16 v[108:109], v11 offset:0
  ds_read_b64_tr_b16 v[110:111], v11 offset:1024
  s_waitcnt vmcnt(15) lgkmcnt(8)
  v_mfma_f32_32x32x16_bf16 v[24:39], v[120:123], v[160:163], v[24:39]
  global_load_dwordx4 v[184:187], v3, s[22:23] offset:2048
  global_load_dwordx4 v[188:191], v3, s[22:23] offset:3072
  v_lshlrev_b32 v16, 4, v17
  s_lshl_b32 s29, s18, 7
  buffer_load_dwordx4 v[240:243], v16, s[72:75], s29 offen offset:0
  ds_read_b64_tr_b16 v[112:113], v10 offset:2048
  ds_read_b64_tr_b16 v[114:115], v10 offset:3072
  v_mfma_f32_32x32x16_bf16 v[40:55], v[124:127], v[160:163], v[40:55]
  buffer_load_dwordx4 v[244:247], v16, s[72:75], s29 offen offset:32
  buffer_load_dwordx4 v[248:251], v16, s[72:75], s29 offen offset:64
  buffer_load_dwordx4 v[252:255], v16, s[72:75], s29 offen offset:96
  ds_read_b64_tr_b16 v[116:117], v11 offset:2048
  ds_read_b64_tr_b16 v[118:119], v11 offset:3072
  s_waitcnt vmcnt(20) lgkmcnt(8)
  v_mfma_f32_32x32x16_bf16 v[24:39], v[128:131], v[164:167], v[24:39]
  ds_read_b64_tr_b16 v[120:121], v10 offset:4096
  ds_read_b64_tr_b16 v[122:123], v10 offset:5120
  v_mfma_f32_32x32x16_bf16 v[40:55], v[132:135], v[164:167], v[40:55]
  ds_read_b64_tr_b16 v[124:125], v11 offset:4096
  ds_read_b64_tr_b16 v[126:127], v11 offset:5120
  s_waitcnt vmcnt(19) lgkmcnt(8)
  v_mfma_f32_32x32x16_bf16 v[24:39], v[104:107], v[56:59], v[24:39]
  s_xor_b32 s28, s24, 7
  s_lshl_b32 s28, s28, 13
  s_add_u32 s28, s28, 65536
  v_add_u32 v12, s28, v14
  ds_read_b64_tr_b16 v[128:129], v10 offset:6144
  ds_read_b64_tr_b16 v[130:131], v10 offset:7168
  v_mfma_f32_32x32x16_bf16 v[40:55], v[108:111], v[56:59], v[40:55]
  v_add_u32 v13, s28, v15
  s_andn2_b32 s33, s36, s34
  s_cbranch_scc0 .g2_kernel_w_i10c
.g2_kernel_w_i10b:
  s_ff1_i32_b32 s33, s33
  ds_read_b64_tr_b16 v[132:133], v11 offset:6144
  ds_read_b64_tr_b16 v[134:135], v11 offset:7168
  s_waitcnt vmcnt(18) lgkmcnt(8)
  v_mfma_f32_32x32x16_bf16 v[24:39], v[112:115], v[60:63], v[24:39]
  s_bitset1_b32 s34, s33
  s_xor_b32 s33, s33, s24
  s_and_b32 s10, s33, 7
  s_cmp_lt_u32 s10, 2
  ds_read_b64_tr_b16 v[104:105], v12 offset:0
  ds_read_b64_tr_b16 v[106:107], v12 offset:1024
  v_mfma_f32_32x32x16_bf16 v[40:55], v[116:119], v[60:63], v[40:55]
  s_cselect_b32 s28, 139264, 0
  s_lshl_b32 s10, s10, 13
  s_add_u32 s10, s10, s28
  s_lshl_b32 s33, s33, 12
  ds_read_b64_tr_b16 v[108:109], v13 offset:0
  ds_read_b64_tr_b16 v[110:111], v13 offset:1024
  s_waitcnt vmcnt(17) lgkmcnt(8)
  v_mfma_f32_32x32x16_bf16 v[24:39], v[120:123], v[64:67], v[24:39]
  s_add_u32 s22, s20, s33
  s_addc_u32 s23, s21, 0
  global_load_dwordx4 v[192:195], v3, s[22:23] offset:0
  global_load_dwordx4 v[196:199], v3, s[22:23] offset:1024
  ds_read_b64_tr_b16 v[112:113], v12 offset:2048
  ds_read_b64_tr_b16 v[114:115], v12 offset:3072
  v_mfma_f32_32x32x16_bf16 v[40:55], v[124:127], v[64:67], v[40:55]
  global_load_dwordx4 v[200:203], v3, s[22:23] offset:2048
  global_load_dwordx4 v[204:207], v3, s[22:23] offset:3072
  ds_read_b64_tr_b16 v[116:117], v13 offset:2048
  ds_read_b64_tr_b16 v[118:119], v13 offset:3072
  s_waitcnt vmcnt(20) lgkmcnt(8)
  v_mfma_f32_32x32x16_bf16 v[24:39], v[128:131], v[68:71], v[24:39]
  ds_read_b64_tr_b16 v[120:121], v12 offset:4096
  ds_read_b64_tr_b16 v[122:123], v12 offset:5120
  v_mfma_f32_32x32x16_bf16 v[40:55], v[132:135], v[68:71], v[40:55]
  ds_read_b64_tr_b16 v[124:125], v13 offset:4096
  ds_read_b64_tr_b16 v[126:127], v13 offset:5120
  s_waitcnt vmcnt(19) lgkmcnt(8)
  v_mfma_f32_32x32x16_bf16 v[24:39], v[104:107], v[72:75], v[24:39]
  s_andn2_b32 s33, s36, s34
  s_cbranch_scc0 .g2_kernel_w_i11c
.g2_kernel_w_i11b:
  s_ff1_i32_b32 s33, s33
  ds_read_b64_tr_b16 v[128:129], v12 offset:6144
  ds_read_b64_tr_b16 v[130:131], v12 offset:7168
  v_mfma_f32_32x32x16_bf16 v[40:55], v[108:111], v[72:75], v[40:55]
  s_bitset1_b32 s34, s33
  s_xor_b32 s33, s33, s24
  s_and_b32 s11, s33, 7
  ds_read_b64_tr_b16 v[132:133], v13 offset:6144
  ds_read_b64_tr_b16 v[134:135], v13 offset:7168
  s_waitcnt vmcnt(18) lgkmcnt(8)
  v_mfma_f32_32x32x16_bf16 v[24:39], v[112:115], v[76:79], v[24:39]
  s_cmp_lt_u32 s11, 2
  s_cselect_b32 s28, 139264, 0
  s_lshl_b32 s11, s11, 13
  v_mfma_f32_32x32x16_bf16 v[40:55], v[116:119], v[76:79], v[40:55]
  s_add_u32 s11, s11, s28
  s_lshl_b32 s33, s33, 12
  s_add_u32 s22, s20, s33
  s_waitcnt vmcnt(17) lgkmcnt(4)
  v_mfma_f32_32x32x16_bf16 v[24:39], v[120:123], v[80:83], v[24:39]
  s_addc_u32 s23, s21, 0
  global_load_dwordx4 v[208:211], v3, s[22:23] offset:0
  global_load_dwordx4 v[212:215], v3, s[22:23] offset:1024
  v_mfma_f32_32x32x16_bf16 v[40:55], v[124:127], v[80:83], v[40:55]
  global_load_dwordx4 v[216:219], v3, s[22:23] offset:2048
  global_load_dwordx4 v[220:223], v3, s[22:23] offset:3072
  s_waitcnt vmcnt(20) lgkmcnt(0)
  v_mfma_f32_32x32x16_bf16 v[24:39], v[128:131], v[84:87], v[24:39]
  v_mfma_f32_32x32x16_bf16 v[40:55], v[132:135], v[84:87], v[40:55]
  ds_read_b32 v16, v20 offset:12
  v_add_u32 v10, s8, v14
  v_add_u32 v11, s8, v15
  s_waitcnt lgkmcnt(0)
  v_cmp_gt_u32 vcc, 4, v16
  s_cbranch_vccnz .g2_kernel_w_bw
.g2_kernel_w_bb:
  ds_read_b64_tr_b16 v[104:105], v10 offset:0
  ds_read_b64_tr_b16 v[106:107], v10 offset:1024
  ds_read_b64_tr_b16 v[108:109], v11 offset:0
  ds_read_b64_tr_b16 v[110:111], v11 offset:1024
  ds_read_b64_tr_b16 v[112:113], v10 offset:2048
  ds_read_b64_tr_b16 v[114:115], v10 offset:3072
  ds_read_b64_tr_b16 v[116:117], v11 offset:2048
  ds_read_b64_tr_b16 v[118:119], v11 offset:3072
  ds_read_b64_tr_b16 v[120:121], v10 offset:4096
  ds_read_b64_tr_b16 v[122:123], v10 offset:5120
  ds_read_b64_tr_b16 v[124:125], v11 offset:4096
  ds_read_b64_tr_b16 v[126:127], v11 offset:5120
  s_waitcnt vmcnt(16)
  v_min3_u32 v6, v88, v90, v92
  v_min3_u32 v7, v94, v96, v98
  v_min3_u32 v6, v6, v100, v102
  v_min_u32 v6, v6, v7
  v_cmp_eq_u32 vcc, 0, v6
  s_cbranch_vccnz .g2_kernel_w_v8
.g2_kernel_w_vb8:
  s_waitcnt lgkmcnt(8)
  v_mfma_f32_32x32x16_bf16 v[24:39], v[104:107], v[88:91], v[24:39]
  v_add_u32 v12, s9, v14
  v_add_u32 v13, s9, v15
  s_andn2_b32 s33, s36, s34
  s_cbranch_scc0 .g2_kernel_w_i12c
.g2_kernel_w_i12b:
  ds_read_b64_tr_b16 v[128:129], v10 offset:6144
  ds_read_b64_tr_b16 v[130:131], v10 offset:7168
  v_mfma_f32_32x32x16_bf16 v[40:55], v[108:111], v[88:91], v[40:55]
  s_ff1_i32_b32 s33, s33
  s_bitset1_b32 s34, s33
  s_xor_b32 s33, s33, s24
  s_and_b32 s12, s33, 7
  ds_read_b64_tr_b16 v[132:133], v11 offset:6144
  ds_read_b64_tr_b16 v[134:135], v11 offset:7168
  s_waitcnt lgkmcnt(8)
  v_mfma_f32_32x32x16_bf16 v[24:39], v[112:115], v[92:95], v[24:39]
  s_cmp_lt_u32 s12, 2
  s_cselect_b32 s28, 139264, 0
  s_lshl_b32 s12, s12, 13
  s_add_u32 s12, s12, s28
  ds_read_b64_tr_b16 v[104:105], v12 offset:0
  ds_read_b64_tr_b16 v[106:107], v12 offset:1024
  v_mfma_f32_32x32x16_bf16 v[40:55], v[116:119], v[92:95], v[40:55]
  s_lshl_b32 s33, s33, 12
  s_add_u32 s22, s20, s33
  s_addc_u32 s23, s21, 0
  global_load_dwordx4 v[224:227], v3, s[22:23] offset:0
  ds_read_b64_tr_b16 v[108:109], v13 offset:0
  ds_read_b64_tr_b16 v[110:111], v13 offset:1024
  s_waitcnt lgkmcnt(8)
  v_mfma_f32_32x32x16_bf16 v[24:39], v[120:123], v[96:99], v[24:39]
  global_load_dwordx4 v[228:231], v3, s[22:23] offset:1024
  global_load_dwordx4 v[232:235], v3, s[22:23] offset:2048
  global_load_dwordx4 v[236:239], v3, s[22:23] offset:3072
  ds_read_b64_tr_b16 v[112:113], v12 offset:2048
  ds_read_b64_tr_b16 v[114:115], v12 offset:3072
  v_mfma_f32_32x32x16_bf16 v[40:55], v[124:127], v[96:99], v[40:55]
  ds_read_b64_tr_b16 v[116:117], v13 offset:2048
  ds_read_b64_tr_b16 v[118:119], v13 offset:3072
  s_waitcnt lgkmcnt(8)
  v_mfma_f32_32x32x16_bf16 v[24:39], v[128:131], v[100:103], v[24:39]
  ds_read_b64_tr_b16 v[120:121], v12 offset:4096
  ds_read_b64_tr_b16 v[122:123], v12 offset:5120
  s_waitcnt vmcnt(16)
  v_min3_u32 v6, v176, v178, v180
  v_min3_u32 v7, v182, v184, v186
  v_min3_u32 v6, v6, v188, v190
  v_min_u32 v6, v6, v7
  v_cmp_eq_u32 vcc, 0, v6
  v_mfma_f32_32x32x16_bf16 v[40:55], v[132:135], v[100:103], v[40:55]
  ds_read_b64_tr_b16 v[124:125], v13 offset:4096
  ds_read_b64_tr_b16 v[126:127], v13 offset:5120
  s_cbranch_vccnz .g2_kernel_w_v9
.g2_kernel_w_vb9:
  s_waitcnt lgkmcnt(8)
  v_mfma_f32_32x32x16_bf16 v[24:39], v[104:107], v[176:179], v[24:39]
  v_add_u32 v10, s10, v14
  v_add_u32 v11, s10, v15
  s_andn2_b32 s33, s36, s34
  s_cbranch_scc0 .g2_kernel_w_i13c
.g2_kernel_w_i13b:
  ds_read_b64_tr_b16 v[128:129], v12 offset:6144
  ds_read_b64_tr_b16 v[130:131], v12 offset:7168
  v_mfma_f32_32x32x16_bf16 v[40:55], v[108:111], v[176:179], v[40:55]
  s_ff1_i32_b32 s33, s33
  s_bitset1_b32 s34, s33
  s_xor_b32 s33, s33, s24
  s_and_b32 s13, s33, 7
  ds_read_b64_tr_b16 v[132:133], v13 offset:6144
  ds_read_b64_tr_b16 v[134:135], v13 offset:7168
  s_waitcnt lgkmcnt(8)
  v_mfma_f32_32x32x16_bf16 v[24:39], v[112:115], v[180:183], v[24:39]
  s_cmp_lt_u32 s13, 2
  s_cselect_b32 s28, 139264, 0
  s_lshl_b32 s13, s13, 13
  s_add_u32 s13, s13, s28
  ds_read_b64_tr_b16 v[104:105], v10 offset:0
  ds_read_b64_tr_b16 v[106:107], v10 offset:1024
  v_mfma_f32_32x32x16_bf16 v[40:55], v[116:119], v[180:183], v[40:55]
  s_lshl_b32 s33, s33, 12
  s_add_u32 s22, s20, s33
  s_addc_u32 s23, s21, 0
  global_load_dwordx4 v[136:139], v3, s[22:23] offset:0
  ds_read_b64_tr_b16 v[108:109], v11 offset:0
  ds_read_b64_tr_b16 v[110:111], v11 offset:1024
  s_waitcnt lgkmcnt(8)
  v_mfma_f32_32x32x16_bf16 v[24:39], v[120:123], v[184:187], v[24:39]
  global_load_dwordx4 v[140:143], v3, s[22:23] offset:1024
  global_load_dwordx4 v[144:147], v3, s[22:23] offset:2048
  global_load_dwordx4 v[148:151], v3, s[22:23] offset:3072
  ds_read_b64_tr_b16 v[112:113], v10 offset:2048
  ds_read_b64_tr_b16 v[114:115], v10 offset:3072
  v_mfma_f32_32x32x16_bf16 v[40:55], v[124:127], v[184:187], v[40:55]
  ds_read_b64_tr_b16 v[116:117], v11 offset:2048
  ds_read_b64_tr_b16 v[118:119], v11 offset:3072
  s_waitcnt lgkmcnt(8)
  v_mfma_f32_32x32x16_bf16 v[24:39], v[128:131], v[188:191], v[24:39]
  ds_read_b64_tr_b16 v[120:121], v10 offset:4096
  ds_read_b64_tr_b16 v[122:123], v10 offset:5120
  s_waitcnt vmcnt(12)
  v_min3_u32 v6, v192, v194, v196
  v_min3_u32 v7, v198, v200, v202
  v_min3_u32 v6, v6, v204, v206
  v_min_u32 v6, v6, v7
  v_cmp_eq_u32 vcc, 0, v6
  v_mfma_f32_32x32x16_bf16 v[40:55], v[132:135], v[188:191], v[40:55]
  ds_read_b64_tr_b16 v[124:125], v11 offset:4096
  ds_read_b64_tr_b16 v[126:127], v11 offset:5120
  s_cbranch_vccnz .g2_kernel_w_v10
.g2_kernel_w_vb10:
  s_waitcnt lgkmcnt(8)
  v_mfma_f32_32x32x16_bf16 v[24:39], v[104:107], v[192:195], v[24:39]
  v_add_u32 v12, s11, v14
  v_add_u32 v13, s11, v15
  s_andn2_b32 s33, s36, s34
  s_cbranch_scc0 .g2_kernel_w_i14c
.g2_kernel_w_i14b:
  ds_read_b64_tr_b16 v[128:129], v10 offset:6144
  ds_read_b64_tr_b16 v[130:131], v10 offset:7168
  v_mfma_f32_32x32x16_bf16 v[40:55], v[108:111], v[192:195], v[40:55]
  s_ff1_i32_b32 s33, s33
  s_bitset1_b32 s34, s33
  s_xor_b32 s33, s33, s24
  s_and_b32 s14, s33, 7
  ds_read_b64_tr_b16 v[132:133], v11 offset:6144
  ds_read_b64_tr_b16 v[134:135], v11 offset:7168
  s_waitcnt lgkmcnt(8)
  v_mfma_f32_32x32x16_bf16 v[24:39], v[112:115], v[196:199], v[24:39]
  s_cmp_lt_u32 s14, 2
  s_cselect_b32 s28, 139264, 0
  s_lshl_b32 s14, s14, 13
  s_add_u32 s14, s14, s28
  ds_read_b64_tr_b16 v[104:105], v12 offset:0
  ds_read_b64_tr_b16 v[106:107], v12 offset:1024
  v_mfma_f32_32x32x16_bf16 v[40:55], v[116:119], v[196:199], v[40:55]
  s_lshl_b32 s33, s33, 12
  s_add_u32 s22, s20, s33
  s_addc_u32 s23, s21, 0
  global_load_dwordx4 v[152:155], v3, s[22:23] offset:0 sc1
  ds_read_b64_tr_b16 v[108:109], v13 offset:0
  ds_read_b64_tr_b16 v[110:111], v13 offset:1024
  s_waitcnt lgkmcnt(8)
  v_mfma_f32_32x32x16_bf16 v[24:39], v[120:123], v[200:203], v[24:39]
  global_load_dwordx4 v[156:159], v3, s[22:23] offset:1024 sc1
  global_load_dwordx4 v[160:163], v3, s[22:23] offset:2048 sc1
  global_load_dwordx4 v[164:167], v3, s[22:23] offset:3072 sc1
  ds_read_b64_tr_b16 v[112:113], v12 offset:2048
  ds_read_b64_tr_b16 v[114:115], v12 offset:3072
  v_mfma_f32_32x32x16_bf16 v[40:55], v[124:127], v[200:203], v[40:55]
  ds_read_b64_tr_b16 v[116:117], v13 offset:2048
  ds_read_b64_tr_b16 v[118:119], v13 offset:3072
  s_waitcnt lgkmcnt(8)
  v_mfma_f32_32x32x16_bf16 v[24:39], v[128:131], v[204:207], v[24:39]
  ds_read_b64_tr_b16 v[120:121], v12 offset:4096
  ds_read_b64_tr_b16 v[122:123], v12 offset:5120
  s_waitcnt vmcnt(12)
  v_min3_u32 v6, v208, v210, v212
  v_min3_u32 v7, v214, v216, v218
  v_min3_u32 v6, v6, v220, v222
  v_min_u32 v6, v6, v7
  v_cmp_eq_u32 vcc, 0, v6
  v_mfma_f32_32x32x16_bf16 v[40:55], v[132:135], v[204:207], v[40:55]
  ds_read_b64_tr_b16 v[124:125], v13 offset:4096
  ds_read_b64_tr_b16 v[126:127], v13 offset:5120
  s_cbranch_vccnz .g2_kernel_w_v11
.g2_kernel_w_vb11:
  s_mov_b64 exec, 1
  ds_add_u32 v20, v5 offset:16
  s_mov_b64 exec, -1
  s_waitcnt lgkmcnt(8)
  v_mfma_f32_32x32x16_bf16 v[24:39], v[104:107], v[208:211], v[24:39]
  v_add_u32 v10, s12, v14
  v_add_u32 v11, s12, v15
  s_andn2_b32 s33, s36, s34
  s_cbranch_scc0 .g2_kernel_w_i15c
.g2_kernel_w_i15b:
  ds_read_b64_tr_b16 v[128:129], v12 offset:6144
  ds_read_b64_tr_b16 v[130:131], v12 offset:7168
  v_mfma_f32_32x32x16_bf16 v[40:55], v[108:111], v[208:211], v[40:55]
  s_ff1_i32_b32 s33, s33
  s_bitset1_b32 s34, s33
  s_xor_b32 s33, s33, s24
  s_and_b32 s15, s33, 7
  ds_read_b64_tr_b16 v[132:133], v13 offset:6144
  ds_read_b64_tr_b16 v[134:135], v13 offset:7168
  s_waitcnt lgkmcnt(8)
  v_mfma_f32_32x32x16_bf16 v[24:39], v[112:115], v[212:215], v[24:39]
  s_cmp_lt_u32 s15, 2
  s_cselect_b32 s28, 139264, 0
  s_lshl_b32 s15, s15, 13
  s_add_u32 s15, s15, s28
  ds_read_b64_tr_b16 v[104:105], v10 offset:0
  ds_read_b64_tr_b16 v[106:107], v10 offset:1024
  v_mfma_f32_32x32x16_bf16 v[40:55], v[116:119], v[212:215], v[40:55]
  s_lshl_b32 s33, s33, 12
  s_add_u32 s22, s20, s33
  s_addc_u32 s23, s21, 0
  global_load_dwordx4 v[56:59], v3, s[22:23] offset:0 sc1
  ds_read_b64_tr_b16 v[108:109], v11 offset:0
  ds_read_b64_tr_b16 v[110:111], v11 offset:1024
  s_waitcnt lgkmcnt(8)
  v_mfma_f32_32x32x16_bf16 v[24:39], v[120:123], v[216:219], v[24:39]
  global_load_dwordx4 v[60:63], v3, s[22:23] offset:1024 sc1
  global_load_dwordx4 v[64:67], v3, s[22:23] offset:2048 sc1
  global_load_dwordx4 v[68:71], v3, s[22:23] offset:3072 sc1
  ds_read_b64_tr_b16 v[112:113], v10 offset:2048
  ds_read_b64_tr_b16 v[114:115], v10 offset:3072
  v_mfma_f32_32x32x16_bf16 v[40:55], v[124:127], v[216:219], v[40:55]
  ds_read_b64_tr_b16 v[116:117], v11 offset:2048
  ds_read_b64_tr_b16 v[118:119], v11 offset:3072
  s_waitcnt lgkmcnt(8)
  v_mfma_f32_32x32x16_bf16 v[24:39], v[128:131], v[220:223], v[24:39]
  ds_read_b64_tr_b16 v[120:121], v10 offset:4096
  ds_read_b64_tr_b16 v[122:123], v10 offset:5120
  s_waitcnt vmcnt(12)
  v_min3_u32 v6, v224, v226, v228
  v_min3_u32 v7, v230, v232, v234
  v_min3_u32 v6, v6, v236, v238
  v_min_u32 v6, v6, v7
  v_cmp_eq_u32 vcc, 0, v6
  v_mfma_f32_32x32x16_bf16 v[40:55], v[132:135], v[220:223], v[40:55]
  ds_read_b64_tr_b16 v[124:125], v11 offset:4096
  ds_read_b64_tr_b16 v[126:127], v11 offset:5120
  s_cbranch_vccnz .g2_kernel_w_v12
.g2_kernel_w_vb12:
  s_waitcnt lgkmcnt(8)
  v_mfma_f32_32x32x16_bf16 v[24:39], v[104:107], v[224:227], v[24:39]
  v_add_u32 v12, s13, v14
  v_add_u32 v13, s13, v15
  ds_read_b64_tr_b16 v[128:129], v10 offset:6144
  ds_read_b64_tr_b16 v[130:131], v10 offset:7168
  v_mfma_f32_32x32x16_bf16 v[40:55], v[108:111], v[224:227], v[40:55]
  ds_read_b64_tr_b16 v[132:133], v11 offset:6144
  ds_read_b64_tr_b16 v[134:135], v11 offset:7168
  s_waitcnt lgkmcnt(8)
  v_mfma_f32_32x32x16_bf16 v[24:39], v[112:115], v[228:231], v[24:39]
  ds_read_b64_tr_b16 v[104:105], v12 offset:0
  ds_read_b64_tr_b16 v[106:107], v12 offset:1024
  v_mfma_f32_32x32x16_bf16 v[40:55], v[116:119], v[228:231], v[40:55]
  ds_read_b64_tr_b16 v[108:109], v13 offset:0
  ds_read_b64_tr_b16 v[110:111], v13 offset:1024
  s_waitcnt lgkmcnt(8)
  v_mfma_f32_32x32x16_bf16 v[24:39], v[120:123], v[232:235], v[24:39]
  ds_read_b64_tr_b16 v[112:113], v12 offset:2048
  ds_read_b64_tr_b16 v[114:115], v12 offset:3072
  v_mfma_f32_32x32x16_bf16 v[40:55], v[124:127], v[232:235], v[40:55]
  ds_read_b64_tr_b16 v[116:117], v13 offset:2048
  ds_read_b64_tr_b16 v[118:119], v13 offset:3072
  s_waitcnt lgkmcnt(8)
  v_mfma_f32_32x32x16_bf16 v[24:39], v[128:131], v[236:239], v[24:39]
  ds_read_b64_tr_b16 v[120:121], v12 offset:4096
  ds_read_b64_tr_b16 v[122:123], v12 offset:5120
  s_waitcnt vmcnt(8)
  v_min3_u32 v6, v136, v138, v140
  v_min3_u32 v7, v142, v144, v146
  v_min3_u32 v6, v6, v148, v150
  v_min_u32 v6, v6, v7
  v_cmp_eq_u32 vcc, 0, v6
  v_mfma_f32_32x32x16_bf16 v[40:55], v[132:135], v[236:239], v[40:55]
  ds_read_b64_tr_b16 v[124:125], v13 offset:4096
  ds_read_b64_tr_b16 v[126:127], v13 offset:5120
  s_cbranch_vccnz .g2_kernel_w_v13
.g2_kernel_w_vb13:
  s_waitcnt lgkmcnt(8)
  v_mfma_f32_32x32x16_bf16 v[24:39], v[104:107], v[136:139], v[24:39]
  v_add_u32 v10, s14, v14
  v_add_u32 v11, s14, v15
  ds_read_b64_tr_b16 v[128:129], v12 offset:6144
  ds_read_b64_tr_b16 v[130:131], v12 offset:7168
  v_mfma_f32_32x32x16_bf16 v[40:55], v[108:111], v[136:139], v[40:55]
  ds_read_b64_tr_b16 v[132:133], v13 offset:6144
  ds_read_b64_tr_b16 v[134:135], v13 offset:7168
  s_waitcnt lgkmcnt(8)
  v_mfma_f32_32x32x16_bf16 v[24:39], v[112:115], v[140:143], v[24:39]
  ds_read_b64_tr_b16 v[104:105], v10 offset:0
  ds_read_b64_tr_b16 v[106:107], v10 offset:1024
  v_mfma_f32_32x32x16_bf16 v[40:55], v[116:119], v[140:143], v[40:55]
  ds_read_b64_tr_b16 v[108:109], v11 offset:0
  ds_read_b64_tr_b16 v[110:111], v11 offset:1024
  s_waitcnt lgkmcnt(8)
  v_mfma_f32_32x32x16_bf16 v[24:39], v[120:123], v[144:147], v[24:39]
  ds_read_b64_tr_b16 v[112:113], v10 offset:2048
  ds_read_b64_tr_b16 v[114:115], v10 offset:3072
  v_mfma_f32_32x32x16_bf16 v[40:55], v[124:127], v[144:147], v[40:55]
  ds_read_b64_tr_b16 v[116:117], v11 offset:2048
  ds_read_b64_tr_b16 v[118:119], v11 offset:3072
  s_waitcnt lgkmcnt(8)
  v_mfma_f32_32x32x16_bf16 v[24:39], v[128:131], v[148:151], v[24:39]
  ds_read_b64_tr_b16 v[120:121], v10 offset:4096
  ds_read_b64_tr_b16 v[122:123], v10 offset:5120
  s_waitcnt vmcnt(4)
  v_min3_u32 v6, v152, v154, v156
  v_min3_u32 v7, v158, v160, v162
  v_min3_u32 v6, v6, v164, v166
  v_min_u32 v6, v6, v7
  v_cmp_eq_u32 vcc, 0, v6
  v_mfma_f32_32x32x16_bf16 v[40:55], v[132:135], v[148:151], v[40:55]
  ds_read_b64_tr_b16 v[124:125], v11 offset:4096
  ds_read_b64_tr_b16 v[126:127], v11 offset:5120
  s_cbranch_vccnz .g2_kernel_w_v14
.g2_kernel_w_vb14:
  s_waitcnt lgkmcnt(8)
  v_mfma_f32_32x32x16_bf16 v[24:39], v[104:107], v[152:155], v[24:39]
  v_add_u32 v12, s15, v14
  v_add_u32 v13, s15, v15
  ds_read_b64_tr_b16 v[128:129], v10 offset:6144
  ds_read_b64_tr_b16 v[130:131], v10 offset:7168
  v_mfma_f32_32x32x16_bf16 v[40:55], v[108:111], v[152:155], v[40:55]
  ds_read_b64_tr_b16 v[132:133], v11 offset:6144
  ds_read_b64_tr_b16 v[134:135], v11 offset:7168
  s_waitcnt lgkmcnt(8)
  v_mfma_f32_32x32x16_bf16 v[24:39], v[112:115], v[156:159], v[24:39]
  ds_read_b64_tr_b16 v[104:105], v12 offset:0
  ds_read_b64_tr_b16 v[106:107], v12 offset:1024
  v_mfma_f32_32x32x16_bf16 v[40:55], v[116:119], v[156:159], v[40:55]
  ds_read_b64_tr_b16 v[108:109], v13 offset:0
  ds_read_b64_tr_b16 v[110:111], v13 offset:1024
  s_waitcnt lgkmcnt(8)
  v_mfma_f32_32x32x16_bf16 v[24:39], v[120:123], v[160:163], v[24:39]
  ds_read_b64_tr_b16 v[112:113], v12 offset:2048
  ds_read_b64_tr_b16 v[114:115], v12 offset:3072
  v_mfma_f32_32x32x16_bf16 v[40:55], v[124:127], v[160:163], v[40:55]
  ds_read_b64_tr_b16 v[116:117], v13 offset:2048
  ds_read_b64_tr_b16 v[118:119], v13 offset:3072
  s_waitcnt lgkmcnt(8)
  v_mfma_f32_32x32x16_bf16 v[24:39], v[128:131], v[164:167], v[24:39]
  ds_read_b64_tr_b16 v[120:121], v12 offset:4096
  ds_read_b64_tr_b16 v[122:123], v12 offset:5120
  s_waitcnt vmcnt(0)
  v_min3_u32 v6, v56, v58, v60
  v_min3_u32 v7, v62, v64, v66
  v_min3_u32 v6, v6, v68, v70
  v_min_u32 v6, v6, v7
  v_cmp_eq_u32 vcc, 0, v6
  v_mfma_f32_32x32x16_bf16 v[40:55], v[132:135], v[164:167], v[40:55]
  ds_read_b64_tr_b16 v[124:125], v13 offset:4096
  ds_read_b64_tr_b16 v[126:127], v13 offset:5120
  s_cbranch_vccnz .g2_kernel_w_v15
.g2_kernel_w_vb15:
  s_waitcnt lgkmcnt(8)
  v_mfma_f32_32x32x16_bf16 v[24:39], v[104:107], v[56:59], v[24:39]
  ds_read_b64_tr_b16 v[128:129], v12 offset:6144
  ds_read_b64_tr_b16 v[130:131], v12 offset:7168
  v_mfma_f32_32x32x16_bf16 v[40:55], v[108:111], v[56:59], v[40:55]
  ds_read_b64_tr_b16 v[132:133], v13 offset:6144
  ds_read_b64_tr_b16 v[134:135], v13 offset:7168
  s_waitcnt lgkmcnt(8)
  v_mfma_f32_32x32x16_bf16 v[24:39], v[112:115], v[60:63], v[24:39]
  v_mfma_f32_32x32x16_bf16 v[40:55], v[116:119], v[60:63], v[40:55]
  s_waitcnt lgkmcnt(4)
  v_mfma_f32_32x32x16_bf16 v[24:39], v[120:123], v[64:67], v[24:39]
  v_mfma_f32_32x32x16_bf16 v[40:55], v[124:127], v[64:67], v[40:55]
  s_waitcnt lgkmcnt(0)
  v_mfma_f32_32x32x16_bf16 v[24:39], v[128:131], v[68:71], v[24:39]
  v_mfma_f32_32x32x16_bf16 v[40:55], v[132:135], v[68:71], v[40:55]
  s_lshl_b32 s28, s17, 4
  s_add_u32 s28, s28, s18
  s_lshl_b32 s28, s28, 2
  s_add_u32 s28, s28, s16
  s_lshl_b32 s28, s28, 12
  s_add_u32 s28, s28, s63
  s_add_u32 s28, s28, 0xc00000
  s_lshl_b32 s29, s16, 12
  v_add_u32 v6, s29, v22
  s_mov_b32 s36, 0x3f803f80
  v_mov_b32 v8, 0
  v_mov_b32 v9, 0
  v_mov_b32 v10, 0
  v_cvt_pk_bf16_f32 v56, v24, v25
  v_cvt_pk_bf16_f32 v57, v26, v27
  v_cvt_pk_bf16_f32 v58, v28, v29
  v_cvt_pk_bf16_f32 v59, v30, v31
  buffer_store_dwordx4 v[56:59], v22, s[4:7], s28 offen offset:0 sc1
  v_cvt_pk_bf16_f32 v60, v32, v33
  v_cvt_pk_bf16_f32 v61, v34, v35
  v_cvt_pk_bf16_f32 v62, v36, v37
  v_cvt_pk_bf16_f32 v63, v38, v39
  buffer_store_dwordx4 v[60:63], v22, s[4:7], s28 offen offset:512 sc1
  v_cvt_pk_bf16_f32 v64, v40, v41
  v_cvt_pk_bf16_f32 v65, v42, v43
  v_cvt_pk_bf16_f32 v66, v44, v45
  v_cvt_pk_bf16_f32 v67, v46, v47
  buffer_store_dwordx4 v[64:67], v22, s[4:7], s28 offen offset:1024 sc1
  v_cvt_pk_bf16_f32 v68, v48, v49
  v_cvt_pk_bf16_f32 v69, v50, v51
  v_cvt_pk_bf16_f32 v70, v52, v53
  v_cvt_pk_bf16_f32 v71, v54, v55
  buffer_store_dwordx4 v[68:71], v22, s[4:7], s28 offen offset:1536 sc1
  ds_write_b128 v6, v[56:59] offset:0
  ds_write_b128 v6, v[60:63] offset:512
  ds_write_b128 v6, v[64:67] offset:1024
  ds_write_b128 v6, v[68:71] offset:1536
  s_mov_b64 exec, 1
  ds_add_u32 v20, v5 offset:20
  s_mov_b64 exec, -1
  s_lshl_b32 s28, s17, 2
  s_add_u32 s28, s28, s16
  s_lshl_b32 s28, s28, 13
  s_lshl_b32 s29, s18, 9
  s_add_u32 s28, s28, s29
  s_add_u32 s28, s28, s63
  s_add_u32 s28, s28, 0x1000000
  v_dot2c_f32_bf16 v8, s36, v56
  v_dot2c_f32_bf16 v9, v56, v56
  v_dot2c_f32_bf16 v10, v56, v240
  v_dot2c_f32_bf16 v8, s36, v57
  v_dot2c_f32_bf16 v9, v57, v57
  v_dot2c_f32_bf16 v10, v57, v241
  v_dot2c_f32_bf16 v8, s36, v58
  v_dot2c_f32_bf16 v9, v58, v58
  v_dot2c_f32_bf16 v10, v58, v242
  v_dot2c_f32_bf16 v8, s36, v59
  v_dot2c_f32_bf16 v9, v59, v59
  v_dot2c_f32_bf16 v10, v59, v243
  v_dot2c_f32_bf16 v8, s36, v60
  v_dot2c_f32_bf16 v9, v60, v60
  v_dot2c_f32_bf16 v10, v60, v244
  v_dot2c_f32_bf16 v8, s36, v61
  v_dot2c_f32_bf16 v9, v61, v61
  v_dot2c_f32_bf16 v10, v61, v245
  v_dot2c_f32_bf16 v8, s36, v62
  v_dot2c_f32_bf16 v9, v62, v62
  v_dot2c_f32_bf16 v10, v62, v246
  v_dot2c_f32_bf16 v8, s36, v63
  v_dot2c_f32_bf16 v9, v63, v63
  v_dot2c_f32_bf16 v10, v63, v247
  v_dot2c_f32_bf16 v8, s36, v64
  v_dot2c_f32_bf16 v9, v64, v64
  v_dot2c_f32_bf16 v10, v64, v248
  v_dot2c_f32_bf16 v8, s36, v65
  v_dot2c_f32_bf16 v9, v65, v65
  v_dot2c_f32_bf16 v10, v65, v249
  v_dot2c_f32_bf16 v8, s36, v66
  v_dot2c_f32_bf16 v9, v66, v66
  v_dot2c_f32_bf16 v10, v66, v250
  v_dot2c_f32_bf16 v8, s36, v67
  v_dot2c_f32_bf16 v9, v67, v67
  v_dot2c_f32_bf16 v10, v67, v251
  v_dot2c_f32_bf16 v8, s36, v68
  v_dot2c_f32_bf16 v9, v68, v68
  v_dot2c_f32_bf16 v10, v68, v252
  v_dot2c_f32_bf16 v8, s36, v69
  v_dot2c_f32_bf16 v9, v69, v69
  v_dot2c_f32_bf16 v10, v69, v253
  v_dot2c_f32_bf16 v8, s36, v70
  v_dot2c_f32_bf16 v9, v70, v70
  v_dot2c_f32_bf16 v10, v70, v254
  v_dot2c_f32_bf16 v8, s36, v71
  v_dot2c_f32_bf16 v9, v71, v71
  v_dot2c_f32_bf16 v10, v71, v255
  s_lshl_b32 s29, s16, 7
  s_add_u32 s37, s19, s29
  v_mov_b32 v24, v8
  v_mov_b32 v25, v9
  v_mov_b32 v26, v10
  v_mov_b32 v11, 1
  v_permlane32_swap_b32 v8, v24
  v_permlane32_swap_b32 v9, v25
  v_permlane32_swap_b32 v10, v26
  v_add_f32 v8, v8, v24
  v_add_f32 v9, v9, v25
  v_add_f32 v10, v10, v26
  v_or_b32 v8, 1, v8
  v_mov_b32 v16, s70
  s_mov_b32 exec_hi, 0
  s_waitcnt vmcnt(0)
  buffer_store_dwordx4 v[8:11], v3, s[4:7], s28 offen sc1
  s_mov_b64 exec, 1
  buffer_store_dword v16, v4, s[4:7], s37 offen offset:8 sc1
  s_mov_b64 exec, -1
  s_cmp_lg_u32 s62, 0
  s_cbranch_scc1 .g2_kernel_tail
  s_mov_b32 s62, 1
  s_mov_b32 s63, 0x1800000
  s_mov_b32 s70, 2
  s_mov_b32 s71, 155776
  s_branch .g2_kernel_q_cons2
.g2_kernel_tail:
  s_mov_b32 s28, s56
  s_mov_b32 s29, s57
  s_mov_b32 s30, 0x400000
  s_mov_b32 s31, 0x00020000
  v_lshrrev_b32 v8, 3, v2
  v_and_b32 v9, 7, v2
  v_lshlrev_b32 v10, 8, v9
  v_lshl_add_u32 v10, v8, 4, v10
  s_lshl_b32 s32, s16, 12
  v_add_u32 v10, s32, v10
  ds_read_b128 v[56:59], v10 offset:0
  ds_read_b128 v[60:63], v10 offset:128
  ds_read_b128 v[64:67], v10 offset:2048
  ds_read_b128 v[68:71], v10 offset:2176
  v_lshlrev_b32 v23, 11, v8
  v_lshl_add_u32 v23, v9, 4, v23
  s_lshl_b32 s32, s16, 5
  v_add_u32 v19, s32, v8
  v_lshlrev_b32 v10, 2, v19
  v_add_u32 v10, 155648, v10
  s_lshl_b32 s32, s17, 2
  s_add_u32 s32, s32, s16
  s_lshl_b32 s32, s32, 16
  s_lshl_b32 s33, s18, 7
  s_add_u32 s32, s32, s33
  s_waitcnt lgkmcnt(0)
  v_lshlrev_b32 v24, 16, v56
  v_and_b32 v25, 0xffff0000, v56
  v_lshlrev_b32 v26, 16, v57
  v_and_b32 v27, 0xffff0000, v57
  v_lshlrev_b32 v28, 16, v58
  v_and_b32 v29, 0xffff0000, v58
  v_lshlrev_b32 v30, 16, v59
  v_and_b32 v31, 0xffff0000, v59
  v_lshlrev_b32 v32, 16, v60
  v_and_b32 v33, 0xffff0000, v60
  v_lshlrev_b32 v34, 16, v61
  v_and_b32 v35, 0xffff0000, v61
  v_lshlrev_b32 v36, 16, v62
  v_and_b32 v37, 0xffff0000, v62
  v_lshlrev_b32 v38, 16, v63
  v_and_b32 v39, 0xffff0000, v63
  v_lshlrev_b32 v40, 16, v64
  v_and_b32 v41, 0xffff0000, v64
  v_lshlrev_b32 v42, 16, v65
  v_and_b32 v43, 0xffff0000, v65
  v_lshlrev_b32 v44, 16, v66
  v_and_b32 v45, 0xffff0000, v66
  v_lshlrev_b32 v46, 16, v67
  v_and_b32 v47, 0xffff0000, v67
  v_lshlrev_b32 v48, 16, v68
  v_and_b32 v49, 0xffff0000, v68
  v_lshlrev_b32 v50, 16, v69
  v_and_b32 v51, 0xffff0000, v69
  v_lshlrev_b32 v52, 16, v70
  v_and_b32 v53, 0xffff0000, v70
  v_lshlrev_b32 v54, 16, v71
  v_and_b32 v55, 0xffff0000, v71
  s_lshl_b32 s33, s16, 2
  s_add_u32 s33, s33, 155920
  v_mov_b32 v17, s33
  v_mov_b32 v6, s71
  s_mov_b32 s38, 0
.g2_kernel_wg7:
  ds_read_b32 v7, v6 offset:28
  s_add_u32 s38, s38, 1
  s_waitcnt lgkmcnt(0)
  v_cmp_gt_u32 vcc, 1, v7
  s_cbranch_vccz .g2_kernel_wg7d
  s_sleep 2
  s_cmp_lt_u32 s38, 524288
  s_cbranch_scc1 .g2_kernel_wg7
.g2_kernel_wg7d:
  ds_read_b32 v17, v20 offset:32
  ds_read_b32 v72, v10 offset:3840
  ds_read_b32 v73, v10 offset:4352
  ds_read_b32 v74, v10 offset:3872
  ds_read_b32 v75, v10 offset:4384
  ds_read_b32 v76, v10 offset:3904
  ds_read_b32 v77, v10 offset:4416
  ds_read_b32 v78, v10 offset:3936
  ds_read_b32 v79, v10 offset:4448
  s_waitcnt lgkmcnt(0)
  v_sub_u32 v16, v17, v19
  v_pk_fma_f32 v[24:25], v[24:25], v[72:73], v[72:73] op_sel:[0,0,1] op_sel_hi:[1,0,1]
  v_pk_fma_f32 v[26:27], v[26:27], v[72:73], v[72:73] op_sel:[0,0,1] op_sel_hi:[1,0,1]
  v_pk_fma_f32 v[28:29], v[28:29], v[72:73], v[72:73] op_sel:[0,0,1] op_sel_hi:[1,0,1]
  v_pk_fma_f32 v[30:31], v[30:31], v[72:73], v[72:73] op_sel:[0,0,1] op_sel_hi:[1,0,1]
  v_cvt_pk_bf16_f32 v56, v24, v25
  v_cvt_pk_bf16_f32 v57, v26, v27
  v_cvt_pk_bf16_f32 v58, v28, v29
  v_cvt_pk_bf16_f32 v59, v30, v31
  v_cmp_ne_u32 vcc, 1, v16
  s_mov_b64 exec, vcc
  buffer_store_dwordx4 v[56:59], v23, s[28:31], s32 offen sc1
  s_mov_b64 exec, -1
  s_add_u32 s32, s32, 16384
  v_pk_fma_f32 v[32:33], v[32:33], v[74:75], v[74:75] op_sel:[0,0,1] op_sel_hi:[1,0,1]
  v_pk_fma_f32 v[34:35], v[34:35], v[74:75], v[74:75] op_sel:[0,0,1] op_sel_hi:[1,0,1]
  v_pk_fma_f32 v[36:37], v[36:37], v[74:75], v[74:75] op_sel:[0,0,1] op_sel_hi:[1,0,1]
  v_pk_fma_f32 v[38:39], v[38:39], v[74:75], v[74:75] op_sel:[0,0,1] op_sel_hi:[1,0,1]
  v_cvt_pk_bf16_f32 v60, v32, v33
  v_cvt_pk_bf16_f32 v61, v34, v35
  v_cvt_pk_bf16_f32 v62, v36, v37
  v_cvt_pk_bf16_f32 v63, v38, v39
  v_cmp_ne_u32 vcc, 9, v16
  s_mov_b64 exec, vcc
  buffer_store_dwordx4 v[60:63], v23, s[28:31], s32 offen sc1
  s_mov_b64 exec, -1
  s_add_u32 s32, s32, 16384
  v_pk_fma_f32 v[40:41], v[40:41], v[76:77], v[76:77] op_sel:[0,0,1] op_sel_hi:[1,0,1]
  v_pk_fma_f32 v[42:43], v[42:43], v[76:77], v[76:77] op_sel:[0,0,1] op_sel_hi:[1,0,1]
  v_pk_fma_f32 v[44:45], v[44:45], v[76:77], v[76:77] op_sel:[0,0,1] op_sel_hi:[1,0,1]
  v_pk_fma_f32 v[46:47], v[46:47], v[76:77], v[76:77] op_sel:[0,0,1] op_sel_hi:[1,0,1]
  v_cvt_pk_bf16_f32 v64, v40, v41
  v_cvt_pk_bf16_f32 v65, v42, v43
  v_cvt_pk_bf16_f32 v66, v44, v45
  v_cvt_pk_bf16_f32 v67, v46, v47
  v_cmp_ne_u32 vcc, 17, v16
  s_mov_b64 exec, vcc
  buffer_store_dwordx4 v[64:67], v23, s[28:31], s32 offen sc1
  s_mov_b64 exec, -1
  s_add_u32 s32, s32, 16384
  v_pk_fma_f32 v[48:49], v[48:49], v[78:79], v[78:79] op_sel:[0,0,1] op_sel_hi:[1,0,1]
  v_pk_fma_f32 v[50:51], v[50:51], v[78:79], v[78:79] op_sel:[0,0,1] op_sel_hi:[1,0,1]
  v_pk_fma_f32 v[52:53], v[52:53], v[78:79], v[78:79] op_sel:[0,0,1] op_sel_hi:[1,0,1]
  v_pk_fma_f32 v[54:55], v[54:55], v[78:79], v[78:79] op_sel:[0,0,1] op_sel_hi:[1,0,1]
  v_cvt_pk_bf16_f32 v68, v48, v49
  v_cvt_pk_bf16_f32 v69, v50, v51
  v_cvt_pk_bf16_f32 v70, v52, v53
  v_cvt_pk_bf16_f32 v71, v54, v55
  v_cmp_ne_u32 vcc, 25, v16
  s_mov_b64 exec, vcc
  buffer_store_dwordx4 v[68:71], v23, s[28:31], s32 offen sc1
  s_mov_b64 exec, -1
  s_add_u32 s32, s32, 16384
  s_branch .g2_kernel_fin
.g2_kernel_svc:
  s_cmp_eq_u32 s16, 5
  s_cbranch_scc1 .g2_kernel_s1
  s_cmp_eq_u32 s16, 6
  s_cbranch_scc1 .g2_kernel_s2
  s_cmp_eq_u32 s16, 7
  s_cbranch_scc1 .g2_kernel_s3
  s_mov_b32 s8, s40
  s_mov_b32 s9, s41
  s_mov_b32 s10, 0x400000
  s_mov_b32 s11, 0x00020000
  s_setprio 3
  v_lshrrev_b32 v20, 3, v2
  v_and_b32 v21, 7, v2
  v_lshrrev_b32 v22, 4, v2
  v_xor_b32 v23, v21, v22
  v_lshlrev_b32 v23, 4, v23
  v_lshl_add_u32 v24, v20, 11, v23
  v_xor_b32 v25, 64, v24
  s_lshl_b32 s32, s17, 18
  v_add_u32 v32, 0, v24
  v_add_u32 v33, 15360, v25
  v_add_u32 v34, 30720, v24
  v_add_u32 v35, 46080, v25
  v_add_u32 v36, 65536, v24
  v_add_u32 v37, 80896, v25
  v_add_u32 v38, 96256, v24
  v_add_u32 v39, 111616, v25
  v_add_u32 v40, 131072, v24
  v_add_u32 v41, 146432, v25
  v_add_u32 v42, 161792, v24
  v_add_u32 v43, 177152, v25
  v_add_u32 v44, 196608, v24
  v_add_u32 v45, 211968, v25
  v_add_u32 v46, 227328, v24
  v_add_u32 v47, 242688, v25
  s_mov_b32 s29, 0
  s_add_u32 m0, s29, 0
  s_waitcnt vmcnt(63)
  buffer_load_dwordx4 v32, s[8:11], s32 offen offset:0 lds
  buffer_load_dwordx4 v33, s[8:11], s32 offen offset:1024 lds
  buffer_load_dwordx4 v34, s[8:11], s32 offen offset:2048 lds
  buffer_load_dwordx4 v35, s[8:11], s32 offen offset:3072 lds
  s_add_u32 m0, s29, 4096
  s_waitcnt vmcnt(63)
  buffer_load_dwordx4 v36, s[8:11], s32 offen offset:0 lds
  buffer_load_dwordx4 v37, s[8:11], s32 offen offset:1024 lds
  buffer_load_dwordx4 v38, s[8:11], s32 offen offset:2048 lds
  buffer_load_dwordx4 v39, s[8:11], s32 offen offset:3072 lds
  s_add_u32 m0, s29, 8192
  s_waitcnt vmcnt(63)
  buffer_load_dwordx4 v40, s[8:11], s32 offen offset:0 lds
  buffer_load_dwordx4 v41, s[8:11], s32 offen offset:1024 lds
  buffer_load_dwordx4 v42, s[8:11], s32 offen offset:2048 lds
  buffer_load_dwordx4 v43, s[8:11], s32 offen offset:3072 lds
  s_add_u32 m0, s29, 12288
  s_waitcnt vmcnt(63)
  buffer_load_dwordx4 v44, s[8:11], s32 offen offset:0 lds
  buffer_load_dwordx4 v45, s[8:11], s32 offen offset:1024 lds
  buffer_load_dwordx4 v46, s[8:11], s32 offen offset:2048 lds
  buffer_load_dwordx4 v47, s[8:11], s32 offen offset:3072 lds
  s_add_u32 s32, s32, 128
  s_mov_b32 s12, s42
  s_mov_b32 s13, s43
  s_mov_b32 s14, 0x600000
  s_mov_b32 s15, 0x00020000
  v_lshrrev_b32 v28, 3, v2
  v_and_b32 v29, 7, v2
  v_bfe_u32 v30, v2, 4, 1
  v_lshlrev_b32 v30, 1, v30
  v_xor_b32 v31, v29, v30
  v_lshlrev_b32 v31, 4, v31
  v_mul_u32_u24 v28, 6144, v28
  v_add_u32 v28, v28, v31
  v_xor_b32 v29, 64, v28
  v_lshlrev_b32 v9, 2, v2
  v_and_b32 v9, 12, v9
  v_add_u32 v9, 156416, v9
  v_add_u32 v48, 0, v28
  v_add_u32 v49, 48128, v29
  v_add_u32 v50, 96256, v28
  v_add_u32 v51, 144384, v29
  v_add_u32 v52, 2048, v28
  v_add_u32 v53, 50176, v29
  v_add_u32 v54, 98304, v28
  v_add_u32 v55, 146432, v29
  v_add_u32 v56, 4096, v29
  v_add_u32 v57, 52224, v28
  v_add_u32 v58, 100352, v29
  v_add_u32 v59, 148480, v28
  s_lshl_b32 s36, s18, 7
  s_mov_b32 s30, 0
  s_add_u32 m0, s30, 65536
  s_waitcnt vmcnt(63)
  buffer_load_dwordx4 v48, s[12:15], s36 offen offset:0 lds
  buffer_load_dwordx4 v49, s[12:15], s36 offen offset:1024 lds
  buffer_load_dwordx4 v50, s[12:15], s36 offen offset:2048 lds
  buffer_load_dwordx4 v51, s[12:15], s36 offen offset:3072 lds
  s_add_u32 m0, s30, 69632
  s_waitcnt vmcnt(63)
  buffer_load_dwordx4 v52, s[12:15], s36 offen offset:0 lds
  buffer_load_dwordx4 v53, s[12:15], s36 offen offset:1024 lds
  buffer_load_dwordx4 v54, s[12:15], s36 offen offset:2048 lds
  buffer_load_dwordx4 v55, s[12:15], s36 offen offset:3072 lds
  s_add_u32 m0, s30, 73728
  s_waitcnt vmcnt(63)
  buffer_load_dwordx4 v56, s[12:15], s36 offen offset:0 lds
  buffer_load_dwordx4 v57, s[12:15], s36 offen offset:1024 lds
  buffer_load_dwordx4 v58, s[12:15], s36 offen offset:2048 lds
  buffer_load_dwordx4 v59, s[12:15], s36 offen offset:3072 lds
  s_add_u32 s30, s30, 12288
  s_cmp_eq_u32 s30, 86016
  s_cselect_b32 s30, 0, s30
  s_barrier
  s_mov_b32 s35, .g2_kernel_tab-.g2_kernel_pc+4
  s_mov_b32 s34, -5
  v_mov_b32 v10, 0
  s_mov_b32 m0, 156160
  s_add_u32 s36, s36, 196608
  s_mov_b64 exec, 1
  buffer_load_dword off, s[64:67], s35 lds
  s_mov_b64 exec, -1
  s_add_u32 s35, s35, 4
  s_branch .g2_kernel_p1_o
  .p2align 6
.g2_kernel_p1_l:
  s_waitcnt lgkmcnt(0)
  v_cmp_gt_i32 vcc, s34, v10
  s_cbranch_vccnz .g2_kernel_p1_aw
.g2_kernel_p1_ai:
  s_add_u32 s29, s29, 16384
  s_and_b32 s29, s29, 0xffff
  s_add_u32 m0, s29, 0
  s_waitcnt vmcnt(63)
  buffer_load_dwordx4 v32, s[8:11], s32 offen offset:0 lds
  buffer_load_dwordx4 v33, s[8:11], s32 offen offset:1024 lds
  buffer_load_dwordx4 v34, s[8:11], s32 offen offset:2048 lds
  buffer_load_dwordx4 v35, s[8:11], s32 offen offset:3072 lds
  s_add_u32 m0, s29, 4096
  s_waitcnt vmcnt(63)
  buffer_load_dwordx4 v36, s[8:11], s32 offen offset:0 lds
  buffer_load_dwordx4 v37, s[8:11], s32 offen offset:1024 lds
  buffer_load_dwordx4 v38, s[8:11], s32 offen offset:2048 lds
  buffer_load_dwordx4 v39, s[8:11], s32 offen offset:3072 lds
  s_add_u32 m0, s29, 8192
  s_waitcnt vmcnt(63)
  buffer_load_dwordx4 v40, s[8:11], s32 offen offset:0 lds
  buffer_load_dwordx4 v41, s[8:11], s32 offen offset:1024 lds
  buffer_load_dwordx4 v42, s[8:11], s32 offen offset:2048 lds
  buffer_load_dwordx4 v43, s[8:11], s32 offen offset:3072 lds
  s_add_u32 m0, s29, 12288
  s_waitcnt vmcnt(63)
  buffer_load_dwordx4 v44, s[8:11], s32 offen offset:0 lds
  buffer_load_dwordx4 v45, s[8:11], s32 offen offset:1024 lds
  buffer_load_dwordx4 v46, s[8:11], s32 offen offset:2048 lds
  buffer_load_dwordx4 v47, s[8:11], s32 offen offset:3072 lds
  s_add_u32 s32, s32, 128
  s_add_u32 m0, s30, 65536
  s_waitcnt vmcnt(63)
  buffer_load_dwordx4 v48, s[12:15], s36 offen offset:0 lds
  buffer_load_dwordx4 v49, s[12:15], s36 offen offset:1024 lds
  buffer_load_dwordx4 v50, s[12:15], s36 offen offset:2048 lds
  buffer_load_dwordx4 v51, s[12:15], s36 offen offset:3072 lds
  s_add_u32 m0, s30, 69632
  s_waitcnt vmcnt(63)
  buffer_load_dwordx4 v52, s[12:15], s36 offen offset:0 lds
  buffer_load_dwordx4 v53, s[12:15], s36 offen offset:1024 lds
  buffer_load_dwordx4 v54, s[12:15], s36 offen offset:2048 lds
  buffer_load_dwordx4 v55, s[12:15], s36 offen offset:3072 lds
  s_add_u32 m0, s30, 73728
  s_waitcnt vmcnt(63)
  buffer_load_dwordx4 v56, s[12:15], s36 offen offset:0 lds
  buffer_load_dwordx4 v57, s[12:15], s36 offen offset:1024 lds
  buffer_load_dwordx4 v58, s[12:15], s36 offen offset:2048 lds
  buffer_load_dwordx4 v59, s[12:15], s36 offen offset:3072 lds
  s_add_u32 s30, s30, 12288
  s_cmp_eq_u32 s30, 86016
  s_cselect_b32 s30, 0, s30
  ds_read_b32 v10, v9
  s_mov_b32 m0, 156160
  s_add_u32 s34, s34, 1
  s_mov_b64 exec, 1
  buffer_load_dword off, s[64:67], s35 lds
  s_mov_b64 exec, -1
  s_add_u32 s35, s35, 4
  s_add_u32 s36, s36, 196608
.g2_kernel_p1_o:
  s_waitcnt lgkmcnt(0)
  v_cmp_gt_i32 vcc, s34, v10
  s_cbranch_vccnz .g2_kernel_p1_bw
.g2_kernel_p1_bi:
  s_add_u32 m0, s30, 65536
  s_waitcnt vmcnt(63)
  buffer_load_dwordx4 v48, s[12:15], s36 offen offset:0 lds
  buffer_load_dwordx4 v49, s[12:15], s36 offen offset:1024 lds
  buffer_load_dwordx4 v50, s[12:15], s36 offen offset:2048 lds
  buffer_load_dwordx4 v51, s[12:15], s36 offen offset:3072 lds
  s_add_u32 m0, s30, 69632
  s_waitcnt vmcnt(63)
  buffer_load_dwordx4 v52, s[12:15], s36 offen offset:0 lds
  buffer_load_dwordx4 v53, s[12:15], s36 offen offset:1024 lds
  buffer_load_dwordx4 v54, s[12:15], s36 offen offset:2048 lds
  buffer_load_dwordx4 v55, s[12:15], s36 offen offset:3072 lds
  s_add_u32 m0, s30, 73728
  s_waitcnt vmcnt(63)
  buffer_load_dwordx4 v56, s[12:15], s36 offen offset:0 lds
  buffer_load_dwordx4 v57, s[12:15], s36 offen offset:1024 lds
  buffer_load_dwordx4 v58, s[12:15], s36 offen offset:2048 lds
  buffer_load_dwordx4 v59, s[12:15], s36 offen offset:3072 lds
  s_add_u32 s30, s30, 12288
  s_cmp_eq_u32 s30, 86016
  s_cselect_b32 s30, 0, s30
  ds_read_b32 v10, v9
  s_mov_b32 m0, 156160
  s_add_u32 s34, s34, 1
  s_mov_b64 exec, 1
  buffer_load_dword off, s[64:67], s35 lds
  s_mov_b64 exec, -1
  s_add_u32 s35, s35, 4
  s_add_u32 s36, s36, 196608
  s_cmp_lt_i32 s34, 26
  s_cbranch_scc1 .g2_kernel_p1_l
  s_branch .g2_kernel_v
.g2_kernel_s1:
  s_mov_b32 s8, s40
  s_mov_b32 s9, s41
  s_mov_b32 s10, 0x400000
  s_mov_b32 s11, 0x00020000
  v_lshrrev_b32 v20, 3, v2
  v_and_b32 v21, 7, v2
  v_lshlrev_b32 v21, 4, v21
  v_lshl_add_u32 v21, v20, 11, v21
  s_lshl_b32 s30, s17, 4
  s_add_u32 s30, s30, s18
  s_lshl_b32 s33, s30, 5
  s_lshl_b32 s30, s30, 14
  s_barrier
  s_sleep 30
  buffer_load_dwordx4 v[64:67], v21, s[8:11], s30 offen offset:0
  buffer_load_dwordx4 v[68:71], v21, s[8:11], s30 offen offset:128
  buffer_load_dwordx4 v[72:75], v21, s[8:11], s30 offen offset:256
  buffer_load_dwordx4 v[76:79], v21, s[8:11], s30 offen offset:384
  buffer_load_dwordx4 v[80:83], v21, s[8:11], s30 offen offset:512
  buffer_load_dwordx4 v[84:87], v21, s[8:11], s30 offen offset:640
  buffer_load_dwordx4 v[88:91], v21, s[8:11], s30 offen offset:768
  buffer_load_dwordx4 v[92:95], v21, s[8:11], s30 offen offset:896
  buffer_load_dwordx4 v[96:99], v21, s[8:11], s30 offen offset:1024
  buffer_load_dwordx4 v[100:103], v21, s[8:11], s30 offen offset:1152
  buffer_load_dwordx4 v[104:107], v21, s[8:11], s30 offen offset:1280
  buffer_load_dwordx4 v[108:111], v21, s[8:11], s30 offen offset:1408
  buffer_load_dwordx4 v[112:115], v21, s[8:11], s30 offen offset:1536
  buffer_load_dwordx4 v[116:119], v21, s[8:11], s30 offen offset:1664
  buffer_load_dwordx4 v[120:123], v21, s[8:11], s30 offen offset:1792
  buffer_load_dwordx4 v[124:127], v21, s[8:11], s30 offen offset:1920
  v_mov_b32 v24, 0
  v_mov_b32 v25, 0
  v_mov_b32 v26, 0
  v_mov_b32 v27, 0
  s_waitcnt vmcnt(15)
  v_lshlrev_b32 v22, 16, v64
  v_and_b32 v64, 0xffff0000, v64
  v_add_f32 v24, v24, v22
  v_fmac_f32 v25, v22, v22
  v_add_f32 v26, v26, v64
  v_fmac_f32 v27, v64, v64
  v_lshlrev_b32 v22, 16, v65
  v_and_b32 v65, 0xffff0000, v65
  v_add_f32 v24, v24, v22
  v_fmac_f32 v25, v22, v22
  v_add_f32 v26, v26, v65
  v_fmac_f32 v27, v65, v65
  v_lshlrev_b32 v22, 16, v66
  v_and_b32 v66, 0xffff0000, v66
  v_add_f32 v24, v24, v22
  v_fmac_f32 v25, v22, v22
  v_add_f32 v26, v26, v66
  v_fmac_f32 v27, v66, v66
  v_lshlrev_b32 v22, 16, v67
  v_and_b32 v67, 0xffff0000, v67
  v_add_f32 v24, v24, v22
  v_fmac_f32 v25, v22, v22
  v_add_f32 v26, v26, v67
  v_fmac_f32 v27, v67, v67
  s_waitcnt vmcnt(14)
  v_lshlrev_b32 v22, 16, v68
  v_and_b32 v68, 0xffff0000, v68
  v_add_f32 v24, v24, v22
  v_fmac_f32 v25, v22, v22
  v_add_f32 v26, v26, v68
  v_fmac_f32 v27, v68, v68
  v_lshlrev_b32 v22, 16, v69
  v_and_b32 v69, 0xffff0000, v69
  v_add_f32 v24, v24, v22
  v_fmac_f32 v25, v22, v22
  v_add_f32 v26, v26, v69
  v_fmac_f32 v27, v69, v69
  v_lshlrev_b32 v22, 16, v70
  v_and_b32 v70, 0xffff0000, v70
  v_add_f32 v24, v24, v22
  v_fmac_f32 v25, v22, v22
  v_add_f32 v26, v26, v70
  v_fmac_f32 v27, v70, v70
  v_lshlrev_b32 v22, 16, v71
  v_and_b32 v71, 0xffff0000, v71
  v_add_f32 v24, v24, v22
  v_fmac_f32 v25, v22, v22
  v_add_f32 v26, v26, v71
  v_fmac_f32 v27, v71, v71
  s_waitcnt vmcnt(13)
  v_lshlrev_b32 v22, 16, v72
  v_and_b32 v72, 0xffff0000, v72
  v_add_f32 v24, v24, v22
  v_fmac_f32 v25, v22, v22
  v_add_f32 v26, v26, v72
  v_fmac_f32 v27, v72, v72
  v_lshlrev_b32 v22, 16, v73
  v_and_b32 v73, 0xffff0000, v73
  v_add_f32 v24, v24, v22
  v_fmac_f32 v25, v22, v22
  v_add_f32 v26, v26, v73
  v_fmac_f32 v27, v73, v73
  v_lshlrev_b32 v22, 16, v74
  v_and_b32 v74, 0xffff0000, v74
  v_add_f32 v24, v24, v22
  v_fmac_f32 v25, v22, v22
  v_add_f32 v26, v26, v74
  v_fmac_f32 v27, v74, v74
  v_lshlrev_b32 v22, 16, v75
  v_and_b32 v75, 0xffff0000, v75
  v_add_f32 v24, v24, v22
  v_fmac_f32 v25, v22, v22
  v_add_f32 v26, v26, v75
  v_fmac_f32 v27, v75, v75
  s_waitcnt vmcnt(12)
  v_lshlrev_b32 v22, 16, v76
  v_and_b32 v76, 0xffff0000, v76
  v_add_f32 v24, v24, v22
  v_fmac_f32 v25, v22, v22
  v_add_f32 v26, v26, v76
  v_fmac_f32 v27, v76, v76
  v_lshlrev_b32 v22, 16, v77
  v_and_b32 v77, 0xffff0000, v77
  v_add_f32 v24, v24, v22
  v_fmac_f32 v25, v22, v22
  v_add_f32 v26, v26, v77
  v_fmac_f32 v27, v77, v77
  v_lshlrev_b32 v22, 16, v78
  v_and_b32 v78, 0xffff0000, v78
  v_add_f32 v24, v24, v22
  v_fmac_f32 v25, v22, v22
  v_add_f32 v26, v26, v78
  v_fmac_f32 v27, v78, v78
  v_lshlrev_b32 v22, 16, v79
  v_and_b32 v79, 0xffff0000, v79
  v_add_f32 v24, v24, v22
  v_fmac_f32 v25, v22, v22
  v_add_f32 v26, v26, v79
  v_fmac_f32 v27, v79, v79
  s_waitcnt vmcnt(11)
  v_lshlrev_b32 v22, 16, v80
  v_and_b32 v80, 0xffff0000, v80
  v_add_f32 v24, v24, v22
  v_fmac_f32 v25, v22, v22
  v_add_f32 v26, v26, v80
  v_fmac_f32 v27, v80, v80
  v_lshlrev_b32 v22, 16, v81
  v_and_b32 v81, 0xffff0000, v81
  v_add_f32 v24, v24, v22
  v_fmac_f32 v25, v22, v22
  v_add_f32 v26, v26, v81
  v_fmac_f32 v27, v81, v81
  v_lshlrev_b32 v22, 16, v82
  v_and_b32 v82, 0xffff0000, v82
  v_add_f32 v24, v24, v22
  v_fmac_f32 v25, v22, v22
  v_add_f32 v26, v26, v82
  v_fmac_f32 v27, v82, v82
  v_lshlrev_b32 v22, 16, v83
  v_and_b32 v83, 0xffff0000, v83
  v_add_f32 v24, v24, v22
  v_fmac_f32 v25, v22, v22
  v_add_f32 v26, v26, v83
  v_fmac_f32 v27, v83, v83
  s_waitcnt vmcnt(10)
  v_lshlrev_b32 v22, 16, v84
  v_and_b32 v84, 0xffff0000, v84
  v_add_f32 v24, v24, v22
  v_fmac_f32 v25, v22, v22
  v_add_f32 v26, v26, v84
  v_fmac_f32 v27, v84, v84
  v_lshlrev_b32 v22, 16, v85
  v_and_b32 v85, 0xffff0000, v85
  v_add_f32 v24, v24, v22
  v_fmac_f32 v25, v22, v22
  v_add_f32 v26, v26, v85
  v_fmac_f32 v27, v85, v85
  v_lshlrev_b32 v22, 16, v86
  v_and_b32 v86, 0xffff0000, v86
  v_add_f32 v24, v24, v22
  v_fmac_f32 v25, v22, v22
  v_add_f32 v26, v26, v86
  v_fmac_f32 v27, v86, v86
  v_lshlrev_b32 v22, 16, v87
  v_and_b32 v87, 0xffff0000, v87
  v_add_f32 v24, v24, v22
  v_fmac_f32 v25, v22, v22
  v_add_f32 v26, v26, v87
  v_fmac_f32 v27, v87, v87
  s_waitcnt vmcnt(9)
  v_lshlrev_b32 v22, 16, v88
  v_and_b32 v88, 0xffff0000, v88
  v_add_f32 v24, v24, v22
  v_fmac_f32 v25, v22, v22
  v_add_f32 v26, v26, v88
  v_fmac_f32 v27, v88, v88
  v_lshlrev_b32 v22, 16, v89
  v_and_b32 v89, 0xffff0000, v89
  v_add_f32 v24, v24, v22
  v_fmac_f32 v25, v22, v22
  v_add_f32 v26, v26, v89
  v_fmac_f32 v27, v89, v89
  v_lshlrev_b32 v22, 16, v90
  v_and_b32 v90, 0xffff0000, v90
  v_add_f32 v24, v24, v22
  v_fmac_f32 v25, v22, v22
  v_add_f32 v26, v26, v90
  v_fmac_f32 v27, v90, v90
  v_lshlrev_b32 v22, 16, v91
  v_and_b32 v91, 0xffff0000, v91
  v_add_f32 v24, v24, v22
  v_fmac_f32 v25, v22, v22
  v_add_f32 v26, v26, v91
  v_fmac_f32 v27, v91, v91
  s_waitcnt vmcnt(8)
  v_lshlrev_b32 v22, 16, v92
  v_and_b32 v92, 0xffff0000, v92
  v_add_f32 v24, v24, v22
  v_fmac_f32 v25, v22, v22
  v_add_f32 v26, v26, v92
  v_fmac_f32 v27, v92, v92
  v_lshlrev_b32 v22, 16, v93
  v_and_b32 v93, 0xffff0000, v93
  v_add_f32 v24, v24, v22
  v_fmac_f32 v25, v22, v22
  v_add_f32 v26, v26, v93
  v_fmac_f32 v27, v93, v93
  v_lshlrev_b32 v22, 16, v94
  v_and_b32 v94, 0xffff0000, v94
  v_add_f32 v24, v24, v22
  v_fmac_f32 v25, v22, v22
  v_add_f32 v26, v26, v94
  v_fmac_f32 v27, v94, v94
  v_lshlrev_b32 v22, 16, v95
  v_and_b32 v95, 0xffff0000, v95
  v_add_f32 v24, v24, v22
  v_fmac_f32 v25, v22, v22
  v_add_f32 v26, v26, v95
  v_fmac_f32 v27, v95, v95
  s_waitcnt vmcnt(7)
  v_lshlrev_b32 v22, 16, v96
  v_and_b32 v96, 0xffff0000, v96
  v_add_f32 v24, v24, v22
  v_fmac_f32 v25, v22, v22
  v_add_f32 v26, v26, v96
  v_fmac_f32 v27, v96, v96
  v_lshlrev_b32 v22, 16, v97
  v_and_b32 v97, 0xffff0000, v97
  v_add_f32 v24, v24, v22
  v_fmac_f32 v25, v22, v22
  v_add_f32 v26, v26, v97
  v_fmac_f32 v27, v97, v97
  v_lshlrev_b32 v22, 16, v98
  v_and_b32 v98, 0xffff0000, v98
  v_add_f32 v24, v24, v22
  v_fmac_f32 v25, v22, v22
  v_add_f32 v26, v26, v98
  v_fmac_f32 v27, v98, v98
  v_lshlrev_b32 v22, 16, v99
  v_and_b32 v99, 0xffff0000, v99
  v_add_f32 v24, v24, v22
  v_fmac_f32 v25, v22, v22
  v_add_f32 v26, v26, v99
  v_fmac_f32 v27, v99, v99
  s_waitcnt vmcnt(6)
  v_lshlrev_b32 v22, 16, v100
  v_and_b32 v100, 0xffff0000, v100
  v_add_f32 v24, v24, v22
  v_fmac_f32 v25, v22, v22
  v_add_f32 v26, v26, v100
  v_fmac_f32 v27, v100, v100
  v_lshlrev_b32 v22, 16, v101
  v_and_b32 v101, 0xffff0000, v101
  v_add_f32 v24, v24, v22
  v_fmac_f32 v25, v22, v22
  v_add_f32 v26, v26, v101
  v_fmac_f32 v27, v101, v101
  v_lshlrev_b32 v22, 16, v102
  v_and_b32 v102, 0xffff0000, v102
  v_add_f32 v24, v24, v22
  v_fmac_f32 v25, v22, v22
  v_add_f32 v26, v26, v102
  v_fmac_f32 v27, v102, v102
  v_lshlrev_b32 v22, 16, v103
  v_and_b32 v103, 0xffff0000, v103
  v_add_f32 v24, v24, v22
  v_fmac_f32 v25, v22, v22
  v_add_f32 v26, v26, v103
  v_fmac_f32 v27, v103, v103
  s_waitcnt vmcnt(5)
  v_lshlrev_b32 v22, 16, v104
  v_and_b32 v104, 0xffff0000, v104
  v_add_f32 v24, v24, v22
  v_fmac_f32 v25, v22, v22
  v_add_f32 v26, v26, v104
  v_fmac_f32 v27, v104, v104
  v_lshlrev_b32 v22, 16, v105
  v_and_b32 v105, 0xffff0000, v105
  v_add_f32 v24, v24, v22
  v_fmac_f32 v25, v22, v22
  v_add_f32 v26, v26, v105
  v_fmac_f32 v27, v105, v105
  v_lshlrev_b32 v22, 16, v106
  v_and_b32 v106, 0xffff0000, v106
  v_add_f32 v24, v24, v22
  v_fmac_f32 v25, v22, v22
  v_add_f32 v26, v26, v106
  v_fmac_f32 v27, v106, v106
  v_lshlrev_b32 v22, 16, v107
  v_and_b32 v107, 0xffff0000, v107
  v_add_f32 v24, v24, v22
  v_fmac_f32 v25, v22, v22
  v_add_f32 v26, v26, v107
  v_fmac_f32 v27, v107, v107
  s_waitcnt vmcnt(4)
  v_lshlrev_b32 v22, 16, v108
  v_and_b32 v108, 0xffff0000, v108
  v_add_f32 v24, v24, v22
  v_fmac_f32 v25, v22, v22
  v_add_f32 v26, v26, v108
  v_fmac_f32 v27, v108, v108
  v_lshlrev_b32 v22, 16, v109
  v_and_b32 v109, 0xffff0000, v109
  v_add_f32 v24, v24, v22
  v_fmac_f32 v25, v22, v22
  v_add_f32 v26, v26, v109
  v_fmac_f32 v27, v109, v109
  v_lshlrev_b32 v22, 16, v110
  v_and_b32 v110, 0xffff0000, v110
  v_add_f32 v24, v24, v22
  v_fmac_f32 v25, v22, v22
  v_add_f32 v26, v26, v110
  v_fmac_f32 v27, v110, v110
  v_lshlrev_b32 v22, 16, v111
  v_and_b32 v111, 0xffff0000, v111
  v_add_f32 v24, v24, v22
  v_fmac_f32 v25, v22, v22
  v_add_f32 v26, v26, v111
  v_fmac_f32 v27, v111, v111
  s_waitcnt vmcnt(3)
  v_lshlrev_b32 v22, 16, v112
  v_and_b32 v112, 0xffff0000, v112
  v_add_f32 v24, v24, v22
  v_fmac_f32 v25, v22, v22
  v_add_f32 v26, v26, v112
  v_fmac_f32 v27, v112, v112
  v_lshlrev_b32 v22, 16, v113
  v_and_b32 v113, 0xffff0000, v113
  v_add_f32 v24, v24, v22
  v_fmac_f32 v25, v22, v22
  v_add_f32 v26, v26, v113
  v_fmac_f32 v27, v113, v113
  v_lshlrev_b32 v22, 16, v114
  v_and_b32 v114, 0xffff0000, v114
  v_add_f32 v24, v24, v22
  v_fmac_f32 v25, v22, v22
  v_add_f32 v26, v26, v114
  v_fmac_f32 v27, v114, v114
  v_lshlrev_b32 v22, 16, v115
  v_and_b32 v115, 0xffff0000, v115
  v_add_f32 v24, v24, v22
  v_fmac_f32 v25, v22, v22
  v_add_f32 v26, v26, v115
  v_fmac_f32 v27, v115, v115
  s_waitcnt vmcnt(2)
  v_lshlrev_b32 v22, 16, v116
  v_and_b32 v116, 0xffff0000, v116
  v_add_f32 v24, v24, v22
  v_fmac_f32 v25, v22, v22
  v_add_f32 v26, v26, v116
  v_fmac_f32 v27, v116, v116
  v_lshlrev_b32 v22, 16, v117
  v_and_b32 v117, 0xffff0000, v117
  v_add_f32 v24, v24, v22
  v_fmac_f32 v25, v22, v22
  v_add_f32 v26, v26, v117
  v_fmac_f32 v27, v117, v117
  v_lshlrev_b32 v22, 16, v118
  v_and_b32 v118, 0xffff0000, v118
  v_add_f32 v24, v24, v22
  v_fmac_f32 v25, v22, v22
  v_add_f32 v26, v26, v118
  v_fmac_f32 v27, v118, v118
  v_lshlrev_b32 v22, 16, v119
  v_and_b32 v119, 0xffff0000, v119
  v_add_f32 v24, v24, v22
  v_fmac_f32 v25, v22, v22
  v_add_f32 v26, v26, v119
  v_fmac_f32 v27, v119, v119
  s_waitcnt vmcnt(1)
  v_lshlrev_b32 v22, 16, v120
  v_and_b32 v120, 0xffff0000, v120
  v_add_f32 v24, v24, v22
  v_fmac_f32 v25, v22, v22
  v_add_f32 v26, v26, v120
  v_fmac_f32 v27, v120, v120
  v_lshlrev_b32 v22, 16, v121
  v_and_b32 v121, 0xffff0000, v121
  v_add_f32 v24, v24, v22
  v_fmac_f32 v25, v22, v22
  v_add_f32 v26, v26, v121
  v_fmac_f32 v27, v121, v121
  v_lshlrev_b32 v22, 16, v122
  v_and_b32 v122, 0xffff0000, v122
  v_add_f32 v24, v24, v22
  v_fmac_f32 v25, v22, v22
  v_add_f32 v26, v26, v122
  v_fmac_f32 v27, v122, v122
  v_lshlrev_b32 v22, 16, v123
  v_and_b32 v123, 0xffff0000, v123
  v_add_f32 v24, v24, v22
  v_fmac_f32 v25, v22, v22
  v_add_f32 v26, v26, v123
  v_fmac_f32 v27, v123, v123
  s_waitcnt vmcnt(0)
  v_lshlrev_b32 v22, 16, v124
  v_and_b32 v124, 0xffff0000, v124
  v_add_f32 v24, v24, v22
  v_fmac_f32 v25, v22, v22
  v_add_f32 v26, v26, v124
  v_fmac_f32 v27, v124, v124
  v_lshlrev_b32 v22, 16, v125
  v_and_b32 v125, 0xffff0000, v125
  v_add_f32 v24, v24, v22
  v_fmac_f32 v25, v22, v22
  v_add_f32 v26, v26, v125
  v_fmac_f32 v27, v125, v125
  v_lshlrev_b32 v22, 16, v126
  v_and_b32 v126, 0xffff0000, v126
  v_add_f32 v24, v24, v22
  v_fmac_f32 v25, v22, v22
  v_add_f32 v26, v26, v126
  v_fmac_f32 v27, v126, v126
  v_lshlrev_b32 v22, 16, v127
  v_and_b32 v127, 0xffff0000, v127
  v_add_f32 v24, v24, v22
  v_fmac_f32 v25, v22, v22
  v_add_f32 v26, v26, v127
  v_fmac_f32 v27, v127, v127
  v_add_f32 v24, v24, v26
  v_add_f32 v25, v25, v27
  s_nop 0
  v_add_f32 v24, v24, v24 quad_perm:[1,0,3,2] row_mask:0xf bank_mask:0xf
  v_add_f32 v25, v25, v25 quad_perm:[1,0,3,2] row_mask:0xf bank_mask:0xf
  s_nop 0
  v_add_f32 v24, v24, v24 quad_perm:[2,3,0,1] row_mask:0xf bank_mask:0xf
  v_add_f32 v25, v25, v25 quad_perm:[2,3,0,1] row_mask:0xf bank_mask:0xf
  s_nop 0
  v_add_f32 v24, v24, v24 row_half_mirror row_mask:0xf bank_mask:0xf
  v_add_f32 v25, v25, v25 row_half_mirror row_mask:0xf bank_mask:0xf
  v_mov_b32 v26, 0.0009765625
  v_mul_f32 v24, v26, v24
  v_mul_f32 v27, v24, v24
  v_fma_f32 v25, v25, v26, -v27
  v_max_f32 v25, 0, v25
  v_add_f32 v25, 1e-05, v25
  v_rsq_f32 v25, v25
  v_lshlrev_b32 v20, 2, v20
  v_mul_f32 v24, v24, v25
  v_sub_f32 v24, 0, v24
  s_add_u32 s33, s33, 0x3070000
  s_add_u32 s34, s33, 0x2000
  s_mov_b32 exec_lo, 0x01010101
  s_mov_b32 exec_hi, 0x01010101
  buffer_store_dword v25, v20, s[4:7], s33 offen sc1
  buffer_store_dword v24, v20, s[4:7], s34 offen sc1
  s_mov_b64 exec, -1
  s_mov_b32 s12, s58
  s_mov_b32 s13, s59
  s_mov_b32 s14, 0x100
  s_mov_b32 s15, 0x00020000
  s_mov_b32 s38, 0
  s_mov_b64 exec, 1
.g2_kernel_gt8:
  buffer_load_dword v6, v4, s[12:15], 0 offen sc1
  s_add_u32 s38, s38, 1
  s_waitcnt vmcnt(0)
  v_cmp_eq_u32 vcc, 0x60, v6
  s_cbranch_vccnz .g2_kernel_gt8d
  s_sleep 8
  s_cmp_lt_u32 s38, 131072
  s_cbranch_scc1 .g2_kernel_gt8
.g2_kernel_gt8d:
  s_mov_b64 exec, -1
  v_mov_b32 v6, s70
  s_mov_b64 exec, 1
  buffer_store_dword v6, v4, s[4:7], s19 offen offset:12 sc1
  s_mov_b64 exec, -1
  v_mov_b32 v6, 155648
  s_mov_b32 s38, 0
.g2_kernel_wg9:
  ds_read_b32 v7, v6 offset:512
  s_add_u32 s38, s38, 1
  s_waitcnt lgkmcnt(0)
  v_cmp_gt_u32 vcc, 22, v7
  s_cbranch_vccz .g2_kernel_wg9d
  s_sleep 4
  s_cmp_lt_u32 s38, 524288
  s_cbranch_scc1 .g2_kernel_wg9
.g2_kernel_wg9d:
  s_and_b32 s31, s19, 0xffffe000
  s_add_u32 s31, s31, 12
  v_and_b32 v6, 15, v2
  v_lshlrev_b32 v6, 9, v6
  v_lshrrev_b32 v7, 4, v2
  v_lshl_add_u32 v6, v7, 7, v6
  v_lshlrev_b32 v7, 2, v2
  v_add_u32 v7, 157952, v7
  s_mov_b32 m0, 157952
  s_mov_b32 s38, 0
  s_bfm_b64 exec, 16, 0
.g2_kernel_pa10:
  buffer_load_dword v6, s[4:7], s31 offen sc1 lds
  s_add_u32 s38, s38, 1
  s_waitcnt vmcnt(0)
  ds_read_b32 v8, v7
  s_waitcnt lgkmcnt(0)
  v_cmp_ge_u32 vcc, s62, v8
  s_cbranch_vccz .g2_kernel_pa10d
  s_mov_b64 exec, vcc
  s_sleep 16
  s_cmp_lt_u32 s38, 131072
  s_cbranch_scc1 .g2_kernel_pa10
.g2_kernel_pa10d:
  s_mov_b64 exec, -1
  s_lshl_b32 s33, s17, 9
  s_add_u32 s33, s33, 0x3070000
  s_add_u32 s34, s33, 0x2000
  s_mov_b32 exec_hi, 0
  s_mov_b32 m0, 158464
  s_nop 0
  buffer_load_dwordx4 v3, s[4:7], s33 offen sc1 lds
  s_mov_b32 m0, 158976
  s_nop 0
  buffer_load_dwordx4 v3, s[4:7], s34 offen sc1 lds
  s_mov_b64 exec, -1
  v_mov_b32 v20, 1.0
  v_mov_b32 v21, 1.0
  v_mov_b32 v22, 0
  v_mov_b32 v23, 0
  v_lshlrev_b32 v24, 3, v2
  v_add_u32 v24, 155648, v24
  v_mov_b32 v6, 155648
  s_mov_b32 s38, 0
.g2_kernel_wg11:
  ds_read_b32 v7, v6 offset:512
  s_add_u32 s38, s38, 1
  s_waitcnt lgkmcnt(0)
  v_cmp_gt_u32 vcc, 32, v7
  s_cbranch_vccz .g2_kernel_wg11d
  s_sleep 2
  s_cmp_lt_u32 s38, 524288
  s_cbranch_scc1 .g2_kernel_wg11
.g2_kernel_wg11d:
  ds_write_b64 v24, v[20:21] offset:3840
  ds_write_b64 v24, v[22:23] offset:4352
  v_lshlrev_b32 v24, 2, v2
  v_add_u32 v24, 155648, v24
  ds_write_b32 v24, v4 offset:2304
  s_waitcnt vmcnt(0)
  v_mov_b32 v6, s71
  s_mov_b64 exec, 1
  ds_add_u32 v6, v5 offset:0
  s_mov_b64 exec, -1
  s_branch .g2_kernel_v
.g2_kernel_s2:
  s_mov_b32 s8, s42
  s_mov_b32 s9, s43
  s_mov_b32 s10, 0x600000
  s_mov_b32 s11, 0x00020000
  v_lshrrev_b32 v20, 3, v2
  v_and_b32 v21, 7, v2
  v_mul_u32_u24 v20, 6144, v20
  v_lshl_add_u32 v20, v21, 4, v20
  s_mul_i32 s30, s17, 393216
  s_lshl_b32 s31, s18, 7
  s_add_u32 s30, s30, s31
  s_add_u32 s31, s30, 4096
  s_barrier
  s_sleep 30
  buffer_load_dwordx4 v[64:67], v20, s[8:11], s30 offen
  buffer_load_dwordx4 v[68:71], v20, s[8:11], s30 offen offset:2048
  buffer_load_dwordx4 v[72:75], v20, s[8:11], s31 offen
  s_add_u32 s30, s30, 49152
  s_add_u32 s31, s31, 49152
  buffer_load_dwordx4 v[76:79], v20, s[8:11], s30 offen
  buffer_load_dwordx4 v[80:83], v20, s[8:11], s30 offen offset:2048
  buffer_load_dwordx4 v[84:87], v20, s[8:11], s31 offen
  s_add_u32 s30, s30, 49152
  s_add_u32 s31, s31, 49152
  buffer_load_dwordx4 v[88:91], v20, s[8:11], s30 offen
  buffer_load_dwordx4 v[92:95], v20, s[8:11], s30 offen offset:2048
  buffer_load_dwordx4 v[96:99], v20, s[8:11], s31 offen
  s_add_u32 s30, s30, 49152
  s_add_u32 s31, s31, 49152
  buffer_load_dwordx4 v[100:103], v20, s[8:11], s30 offen
  buffer_load_dwordx4 v[104:107], v20, s[8:11], s30 offen offset:2048
  buffer_load_dwordx4 v[108:111], v20, s[8:11], s31 offen
  s_add_u32 s30, s30, 49152
  s_add_u32 s31, s31, 49152
  buffer_load_dwordx4 v[112:115], v20, s[8:11], s30 offen
  buffer_load_dwordx4 v[116:119], v20, s[8:11], s30 offen offset:2048
  buffer_load_dwordx4 v[120:123], v20, s[8:11], s31 offen
  s_add_u32 s30, s30, 49152
  s_add_u32 s31, s31, 49152
  buffer_load_dwordx4 v[124:127], v20, s[8:11], s30 offen
  buffer_load_dwordx4 v[128:131], v20, s[8:11], s30 offen offset:2048
  buffer_load_dwordx4 v[132:135], v20, s[8:11], s31 offen
  s_add_u32 s30, s30, 49152
  s_add_u32 s31, s31, 49152
  buffer_load_dwordx4 v[136:139], v20, s[8:11], s30 offen
  buffer_load_dwordx4 v[140:143], v20, s[8:11], s30 offen offset:2048
  buffer_load_dwordx4 v[144:147], v20, s[8:11], s31 offen
  s_add_u32 s30, s30, 49152
  s_add_u32 s31, s31, 49152
  buffer_load_dwordx4 v[148:151], v20, s[8:11], s30 offen
  buffer_load_dwordx4 v[152:155], v20, s[8:11], s30 offen offset:2048
  buffer_load_dwordx4 v[156:159], v20, s[8:11], s31 offen
  s_add_u32 s30, s30, 49152
  s_add_u32 s31, s31, 49152
  v_lshlrev_b32 v21, 5, v21
  v_lshrrev_b32 v22, 5, v2
  v_lshl_add_u32 v21, v22, 4, v21
  v_bfe_u32 v22, v2, 4, 1
  v_lshl_add_u32 v21, v22, 3, v21
  s_lshl_b32 s30, s18, 4
  s_add_u32 s30, s30, s17
  s_mul_i32 s30, s30, 768
  s_add_u32 s30, s30, 0x3080000
  s_waitcnt vmcnt(23)
  v_lshlrev_b32 v160, 16, v64
  v_and_b32 v161, 0xffff0000, v64
  v_lshlrev_b32 v162, 16, v65
  v_and_b32 v163, 0xffff0000, v65
  v_lshlrev_b32 v164, 16, v66
  v_and_b32 v165, 0xffff0000, v66
  v_lshlrev_b32 v166, 16, v67
  v_and_b32 v167, 0xffff0000, v67
  s_waitcnt vmcnt(22)
  v_lshlrev_b32 v168, 16, v68
  v_and_b32 v169, 0xffff0000, v68
  v_lshlrev_b32 v170, 16, v69
  v_and_b32 v171, 0xffff0000, v69
  v_lshlrev_b32 v172, 16, v70
  v_and_b32 v173, 0xffff0000, v70
  v_lshlrev_b32 v174, 16, v71
  v_and_b32 v175, 0xffff0000, v71
  s_waitcnt vmcnt(21)
  v_lshlrev_b32 v176, 16, v72
  v_and_b32 v177, 0xffff0000, v72
  v_lshlrev_b32 v178, 16, v73
  v_and_b32 v179, 0xffff0000, v73
  v_lshlrev_b32 v180, 16, v74
  v_and_b32 v181, 0xffff0000, v74
  v_lshlrev_b32 v182, 16, v75
  v_and_b32 v183, 0xffff0000, v75
  s_waitcnt vmcnt(20)
  v_lshlrev_b32 v184, 16, v76
  v_and_b32 v185, 0xffff0000, v76
  v_lshlrev_b32 v186, 16, v77
  v_and_b32 v187, 0xffff0000, v77
  v_lshlrev_b32 v188, 16, v78
  v_and_b32 v189, 0xffff0000, v78
  v_lshlrev_b32 v190, 16, v79
  v_and_b32 v191, 0xffff0000, v79
  v_add_f32 v160, v160, v184
  v_add_f32 v161, v161, v185
  v_add_f32 v162, v162, v186
  v_add_f32 v163, v163, v187
  v_add_f32 v164, v164, v188
  v_add_f32 v165, v165, v189
  v_add_f32 v166, v166, v190
  v_add_f32 v167, v167, v191
  s_waitcnt vmcnt(19)
  v_lshlrev_b32 v184, 16, v80
  v_and_b32 v185, 0xffff0000, v80
  v_lshlrev_b32 v186, 16, v81
  v_and_b32 v187, 0xffff0000, v81
  v_lshlrev_b32 v188, 16, v82
  v_and_b32 v189, 0xffff0000, v82
  v_lshlrev_b32 v190, 16, v83
  v_and_b32 v191, 0xffff0000, v83
  v_add_f32 v168, v168, v184
  v_add_f32 v169, v169, v185
  v_add_f32 v170, v170, v186
  v_add_f32 v171, v171, v187
  v_add_f32 v172, v172, v188
  v_add_f32 v173, v173, v189
  v_add_f32 v174, v174, v190
  v_add_f32 v175, v175, v191
  s_waitcnt vmcnt(18)
  v_lshlrev_b32 v184, 16, v84
  v_and_b32 v185, 0xffff0000, v84
  v_lshlrev_b32 v186, 16, v85
  v_and_b32 v187, 0xffff0000, v85
  v_lshlrev_b32 v188, 16, v86
  v_and_b32 v189, 0xffff0000, v86
  v_lshlrev_b32 v190, 16, v87
  v_and_b32 v191, 0xffff0000, v87
  v_add_f32 v176, v176, v184
  v_add_f32 v177, v177, v185
  v_add_f32 v178, v178, v186
  v_add_f32 v179, v179, v187
  v_add_f32 v180, v180, v188
  v_add_f32 v181, v181, v189
  v_add_f32 v182, v182, v190
  v_add_f32 v183, v183, v191
  s_waitcnt vmcnt(17)
  v_lshlrev_b32 v184, 16, v88
  v_and_b32 v185, 0xffff0000, v88
  v_lshlrev_b32 v186, 16, v89
  v_and_b32 v187, 0xffff0000, v89
  v_lshlrev_b32 v188, 16, v90
  v_and_b32 v189, 0xffff0000, v90
  v_lshlrev_b32 v190, 16, v91
  v_and_b32 v191, 0xffff0000, v91
  v_add_f32 v160, v160, v184
  v_add_f32 v161, v161, v185
  v_add_f32 v162, v162, v186
  v_add_f32 v163, v163, v187
  v_add_f32 v164, v164, v188
  v_add_f32 v165, v165, v189
  v_add_f32 v166, v166, v190
  v_add_f32 v167, v167, v191
  s_waitcnt vmcnt(16)
  v_lshlrev_b32 v184, 16, v92
  v_and_b32 v185, 0xffff0000, v92
  v_lshlrev_b32 v186, 16, v93
  v_and_b32 v187, 0xffff0000, v93
  v_lshlrev_b32 v188, 16, v94
  v_and_b32 v189, 0xffff0000, v94
  v_lshlrev_b32 v190, 16, v95
  v_and_b32 v191, 0xffff0000, v95
  v_add_f32 v168, v168, v184
  v_add_f32 v169, v169, v185
  v_add_f32 v170, v170, v186
  v_add_f32 v171, v171, v187
  v_add_f32 v172, v172, v188
  v_add_f32 v173, v173, v189
  v_add_f32 v174, v174, v190
  v_add_f32 v175, v175, v191
  s_waitcnt vmcnt(15)
  v_lshlrev_b32 v184, 16, v96
  v_and_b32 v185, 0xffff0000, v96
  v_lshlrev_b32 v186, 16, v97
  v_and_b32 v187, 0xffff0000, v97
  v_lshlrev_b32 v188, 16, v98
  v_and_b32 v189, 0xffff0000, v98
  v_lshlrev_b32 v190, 16, v99
  v_and_b32 v191, 0xffff0000, v99
  v_add_f32 v176, v176, v184
  v_add_f32 v177, v177, v185
  v_add_f32 v178, v178, v186
  v_add_f32 v179, v179, v187
  v_add_f32 v180, v180, v188
  v_add_f32 v181, v181, v189
  v_add_f32 v182, v182, v190
  v_add_f32 v183, v183, v191
  s_waitcnt vmcnt(14)
  v_lshlrev_b32 v184, 16, v100
  v_and_b32 v185, 0xffff0000, v100
  v_lshlrev_b32 v186, 16, v101
  v_and_b32 v187, 0xffff0000, v101
  v_lshlrev_b32 v188, 16, v102
  v_and_b32 v189, 0xffff0000, v102
  v_lshlrev_b32 v190, 16, v103
  v_and_b32 v191, 0xffff0000, v103
  v_add_f32 v160, v160, v184
  v_add_f32 v161, v161, v185
  v_add_f32 v162, v162, v186
  v_add_f32 v163, v163, v187
  v_add_f32 v164, v164, v188
  v_add_f32 v165, v165, v189
  v_add_f32 v166, v166, v190
  v_add_f32 v167, v167, v191
  s_waitcnt vmcnt(13)
  v_lshlrev_b32 v184, 16, v104
  v_and_b32 v185, 0xffff0000, v104
  v_lshlrev_b32 v186, 16, v105
  v_and_b32 v187, 0xffff0000, v105
  v_lshlrev_b32 v188, 16, v106
  v_and_b32 v189, 0xffff0000, v106
  v_lshlrev_b32 v190, 16, v107
  v_and_b32 v191, 0xffff0000, v107
  v_add_f32 v168, v168, v184
  v_add_f32 v169, v169, v185
  v_add_f32 v170, v170, v186
  v_add_f32 v171, v171, v187
  v_add_f32 v172, v172, v188
  v_add_f32 v173, v173, v189
  v_add_f32 v174, v174, v190
  v_add_f32 v175, v175, v191
  s_waitcnt vmcnt(12)
  v_lshlrev_b32 v184, 16, v108
  v_and_b32 v185, 0xffff0000, v108
  v_lshlrev_b32 v186, 16, v109
  v_and_b32 v187, 0xffff0000, v109
  v_lshlrev_b32 v188, 16, v110
  v_and_b32 v189, 0xffff0000, v110
  v_lshlrev_b32 v190, 16, v111
  v_and_b32 v191, 0xffff0000, v111
  v_add_f32 v176, v176, v184
  v_add_f32 v177, v177, v185
  v_add_f32 v178, v178, v186
  v_add_f32 v179, v179, v187
  v_add_f32 v180, v180, v188
  v_add_f32 v181, v181, v189
  v_add_f32 v182, v182, v190
  v_add_f32 v183, v183, v191
  s_waitcnt vmcnt(11)
  v_lshlrev_b32 v184, 16, v112
  v_and_b32 v185, 0xffff0000, v112
  v_lshlrev_b32 v186, 16, v113
  v_and_b32 v187, 0xffff0000, v113
  v_lshlrev_b32 v188, 16, v114
  v_and_b32 v189, 0xffff0000, v114
  v_lshlrev_b32 v190, 16, v115
  v_and_b32 v191, 0xffff0000, v115
  v_add_f32 v160, v160, v184
  v_add_f32 v161, v161, v185
  v_add_f32 v162, v162, v186
  v_add_f32 v163, v163, v187
  v_add_f32 v164, v164, v188
  v_add_f32 v165, v165, v189
  v_add_f32 v166, v166, v190
  v_add_f32 v167, v167, v191
  s_waitcnt vmcnt(10)
  v_lshlrev_b32 v184, 16, v116
  v_and_b32 v185, 0xffff0000, v116
  v_lshlrev_b32 v186, 16, v117
  v_and_b32 v187, 0xffff0000, v117
  v_lshlrev_b32 v188, 16, v118
  v_and_b32 v189, 0xffff0000, v118
  v_lshlrev_b32 v190, 16, v119
  v_and_b32 v191, 0xffff0000, v119
  v_add_f32 v168, v168, v184
  v_add_f32 v169, v169, v185
  v_add_f32 v170, v170, v186
  v_add_f32 v171, v171, v187
  v_add_f32 v172, v172, v188
  v_add_f32 v173, v173, v189
  v_add_f32 v174, v174, v190
  v_add_f32 v175, v175, v191
  s_waitcnt vmcnt(9)
  v_lshlrev_b32 v184, 16, v120
  v_and_b32 v185, 0xffff0000, v120
  v_lshlrev_b32 v186, 16, v121
  v_and_b32 v187, 0xffff0000, v121
  v_lshlrev_b32 v188, 16, v122
  v_and_b32 v189, 0xffff0000, v122
  v_lshlrev_b32 v190, 16, v123
  v_and_b32 v191, 0xffff0000, v123
  v_add_f32 v176, v176, v184
  v_add_f32 v177, v177, v185
  v_add_f32 v178, v178, v186
  v_add_f32 v179, v179, v187
  v_add_f32 v180, v180, v188
  v_add_f32 v181, v181, v189
  v_add_f32 v182, v182, v190
  v_add_f32 v183, v183, v191
  s_waitcnt vmcnt(8)
  v_lshlrev_b32 v184, 16, v124
  v_and_b32 v185, 0xffff0000, v124
  v_lshlrev_b32 v186, 16, v125
  v_and_b32 v187, 0xffff0000, v125
  v_lshlrev_b32 v188, 16, v126
  v_and_b32 v189, 0xffff0000, v126
  v_lshlrev_b32 v190, 16, v127
  v_and_b32 v191, 0xffff0000, v127
  v_add_f32 v160, v160, v184
  v_add_f32 v161, v161, v185
  v_add_f32 v162, v162, v186
  v_add_f32 v163, v163, v187
  v_add_f32 v164, v164, v188
  v_add_f32 v165, v165, v189
  v_add_f32 v166, v166, v190
  v_add_f32 v167, v167, v191
  s_waitcnt vmcnt(7)
  v_lshlrev_b32 v184, 16, v128
  v_and_b32 v185, 0xffff0000, v128
  v_lshlrev_b32 v186, 16, v129
  v_and_b32 v187, 0xffff0000, v129
  v_lshlrev_b32 v188, 16, v130
  v_and_b32 v189, 0xffff0000, v130
  v_lshlrev_b32 v190, 16, v131
  v_and_b32 v191, 0xffff0000, v131
  v_add_f32 v168, v168, v184
  v_add_f32 v169, v169, v185
  v_add_f32 v170, v170, v186
  v_add_f32 v171, v171, v187
  v_add_f32 v172, v172, v188
  v_add_f32 v173, v173, v189
  v_add_f32 v174, v174, v190
  v_add_f32 v175, v175, v191
  s_waitcnt vmcnt(6)
  v_lshlrev_b32 v184, 16, v132
  v_and_b32 v185, 0xffff0000, v132
  v_lshlrev_b32 v186, 16, v133
  v_and_b32 v187, 0xffff0000, v133
  v_lshlrev_b32 v188, 16, v134
  v_and_b32 v189, 0xffff0000, v134
  v_lshlrev_b32 v190, 16, v135
  v_and_b32 v191, 0xffff0000, v135
  v_add_f32 v176, v176, v184
  v_add_f32 v177, v177, v185
  v_add_f32 v178, v178, v186
  v_add_f32 v179, v179, v187
  v_add_f32 v180, v180, v188
  v_add_f32 v181, v181, v189
  v_add_f32 v182, v182, v190
  v_add_f32 v183, v183, v191
  s_waitcnt vmcnt(5)
  v_lshlrev_b32 v184, 16, v136
  v_and_b32 v185, 0xffff0000, v136
  v_lshlrev_b32 v186, 16, v137
  v_and_b32 v187, 0xffff0000, v137
  v_lshlrev_b32 v188, 16, v138
  v_and_b32 v189, 0xffff0000, v138
  v_lshlrev_b32 v190, 16, v139
  v_and_b32 v191, 0xffff0000, v139
  v_add_f32 v160, v160, v184
  v_add_f32 v161, v161, v185
  v_add_f32 v162, v162, v186
  v_add_f32 v163, v163, v187
  v_add_f32 v164, v164, v188
  v_add_f32 v165, v165, v189
  v_add_f32 v166, v166, v190
  v_add_f32 v167, v167, v191
  s_waitcnt vmcnt(4)
  v_lshlrev_b32 v184, 16, v140
  v_and_b32 v185, 0xffff0000, v140
  v_lshlrev_b32 v186, 16, v141
  v_and_b32 v187, 0xffff0000, v141
  v_lshlrev_b32 v188, 16, v142
  v_and_b32 v189, 0xffff0000, v142
  v_lshlrev_b32 v190, 16, v143
  v_and_b32 v191, 0xffff0000, v143
  v_add_f32 v168, v168, v184
  v_add_f32 v169, v169, v185
  v_add_f32 v170, v170, v186
  v_add_f32 v171, v171, v187
  v_add_f32 v172, v172, v188
  v_add_f32 v173, v173, v189
  v_add_f32 v174, v174, v190
  v_add_f32 v175, v175, v191
  s_waitcnt vmcnt(3)
  v_lshlrev_b32 v184, 16, v144
  v_and_b32 v185, 0xffff0000, v144
  v_lshlrev_b32 v186, 16, v145
  v_and_b32 v187, 0xffff0000, v145
  v_lshlrev_b32 v188, 16, v146
  v_and_b32 v189, 0xffff0000, v146
  v_lshlrev_b32 v190, 16, v147
  v_and_b32 v191, 0xffff0000, v147
  v_add_f32 v176, v176, v184
  v_add_f32 v177, v177, v185
  v_add_f32 v178, v178, v186
  v_add_f32 v179, v179, v187
  v_add_f32 v180, v180, v188
  v_add_f32 v181, v181, v189
  v_add_f32 v182, v182, v190
  v_add_f32 v183, v183, v191
  s_waitcnt vmcnt(2)
  v_lshlrev_b32 v184, 16, v148
  v_and_b32 v185, 0xffff0000, v148
  v_lshlrev_b32 v186, 16, v149
  v_and_b32 v187, 0xffff0000, v149
  v_lshlrev_b32 v188, 16, v150
  v_and_b32 v189, 0xffff0000, v150
  v_lshlrev_b32 v190, 16, v151
  v_and_b32 v191, 0xffff0000, v151
  v_add_f32 v160, v160, v184
  v_add_f32 v161, v161, v185
  v_add_f32 v162, v162, v186
  v_add_f32 v163, v163, v187
  v_add_f32 v164, v164, v188
  v_add_f32 v165, v165, v189
  v_add_f32 v166, v166, v190
  v_add_f32 v167, v167, v191
  s_waitcnt vmcnt(1)
  v_lshlrev_b32 v184, 16, v152
  v_and_b32 v185, 0xffff0000, v152
  v_lshlrev_b32 v186, 16, v153
  v_and_b32 v187, 0xffff0000, v153
  v_lshlrev_b32 v188, 16, v154
  v_and_b32 v189, 0xffff0000, v154
  v_lshlrev_b32 v190, 16, v155
  v_and_b32 v191, 0xffff0000, v155
  v_add_f32 v168, v168, v184
  v_add_f32 v169, v169, v185
  v_add_f32 v170, v170, v186
  v_add_f32 v171, v171, v187
  v_add_f32 v172, v172, v188
  v_add_f32 v173, v173, v189
  v_add_f32 v174, v174, v190
  v_add_f32 v175, v175, v191
  s_waitcnt vmcnt(0)
  v_lshlrev_b32 v184, 16, v156
  v_and_b32 v185, 0xffff0000, v156
  v_lshlrev_b32 v186, 16, v157
  v_and_b32 v187, 0xffff0000, v157
  v_lshlrev_b32 v188, 16, v158
  v_and_b32 v189, 0xffff0000, v158
  v_lshlrev_b32 v190, 16, v159
  v_and_b32 v191, 0xffff0000, v159
  v_add_f32 v176, v176, v184
  v_add_f32 v177, v177, v185
  v_add_f32 v178, v178, v186
  v_add_f32 v179, v179, v187
  v_add_f32 v180, v180, v188
  v_add_f32 v181, v181, v189
  v_add_f32 v182, v182, v190
  v_add_f32 v183, v183, v191
  v_permlane32_swap_b32 v160, v164
  v_permlane32_swap_b32 v161, v165
  v_permlane32_swap_b32 v162, v166
  v_permlane32_swap_b32 v163, v167
  v_add_f32 v160, v160, v164
  v_add_f32 v161, v161, v165
  v_add_f32 v162, v162, v166
  v_add_f32 v163, v163, v167
  s_nop 0
  v_permlane16_swap_b32 v160, v162
  v_permlane16_swap_b32 v161, v163
  v_add_f32 v160, v160, v162
  v_add_f32 v161, v161, v163
  s_nop 0
  v_add_f32 v160, v160, v160 row_ror:8 row_mask:0xf bank_mask:0xf
  v_add_f32 v161, v161, v161 row_ror:8 row_mask:0xf bank_mask:0xf
  v_permlane32_swap_b32 v168, v172
  v_permlane32_swap_b32 v169, v173
  v_permlane32_swap_b32 v170, v174
  v_permlane32_swap_b32 v171, v175
  v_add_f32 v168, v168, v172
  v_add_f32 v169, v169, v173
  v_add_f32 v170, v170, v174
  v_add_f32 v171, v171, v175
  s_nop 0
  v_permlane16_swap_b32 v168, v170
  v_permlane16_swap_b32 v169, v171
  v_add_f32 v168, v168, v170
  v_add_f32 v169, v169, v171
  s_nop 0
  v_add_f32 v168, v168, v168 row_ror:8 row_mask:0xf bank_mask:0xf
  v_add_f32 v169, v169, v169 row_ror:8 row_mask:0xf bank_mask:0xf
  v_permlane32_swap_b32 v176, v180
  v_permlane32_swap_b32 v177, v181
  v_permlane32_swap_b32 v178, v182
  v_permlane32_swap_b32 v179, v183
  v_add_f32 v176, v176, v180
  v_add_f32 v177, v177, v181
  v_add_f32 v178, v178, v182
  v_add_f32 v179, v179, v183
  s_nop 0
  v_permlane16_swap_b32 v176, v178
  v_permlane16_swap_b32 v177, v179
  v_add_f32 v176, v176, v178
  v_add_f32 v177, v177, v179
  s_nop 0
  v_add_f32 v176, v176, v176 row_ror:8 row_mask:0xf bank_mask:0xf
  v_add_f32 v177, v177, v177 row_ror:8 row_mask:0xf bank_mask:0xf
  s_mov_b32 exec_lo, 0x00ff00ff
  s_mov_b32 exec_hi, 0x00ff00ff
  buffer_store_dwordx2 v[160:161], v21, s[4:7], s30 offen offset:0 sc1
  buffer_store_dwordx2 v[168:169], v21, s[4:7], s30 offen offset:256 sc1
  buffer_store_dwordx2 v[176:177], v21, s[4:7], s30 offen offset:512 sc1
  s_mov_b64 exec, -1
  s_mov_b32 s12, s58
  s_mov_b32 s13, s59
  s_mov_b32 s14, 0x100
  s_mov_b32 s15, 0x00020000
  s_mov_b32 s38, 0
  s_mov_b64 exec, 1
.g2_kernel_gt12:
  buffer_load_dword v6, v4, s[12:15], 0 offen sc1
  s_add_u32 s38, s38, 1
  s_waitcnt vmcnt(0)
  v_cmp_eq_u32 vcc, 0x60, v6
  s_cbranch_vccnz .g2_kernel_gt12d
  s_sleep 8
  s_cmp_lt_u32 s38, 131072
  s_cbranch_scc1 .g2_kernel_gt12
.g2_kernel_gt12d:
  s_mov_b64 exec, -1
  v_mov_b32 v6, s70
  s_mov_b64 exec, 1
  buffer_store_dword v6, v4, s[4:7], s76 offen offset:4 sc1
  s_mov_b64 exec, -1
  v_mov_b32 v6, 155648
  s_mov_b32 s38, 0
.g2_kernel_wg13:
  ds_read_b32 v7, v6 offset:512
  s_add_u32 s38, s38, 1
  s_waitcnt lgkmcnt(0)
  v_cmp_gt_u32 vcc, 22, v7
  s_cbranch_vccz .g2_kernel_wg13d
  s_sleep 4
  s_cmp_lt_u32 s38, 524288
  s_cbranch_scc1 .g2_kernel_wg13
.g2_kernel_wg13d:
  s_and_b32 s31, s76, 0xffffe000
  s_add_u32 s31, s31, 4
  v_and_b32 v6, 15, v2
  v_lshlrev_b32 v6, 9, v6
  v_lshrrev_b32 v7, 4, v2
  v_lshl_add_u32 v6, v7, 7, v6
  v_lshlrev_b32 v7, 2, v2
  v_add_u32 v7, 157696, v7
  s_mov_b32 m0, 157696
  s_mov_b32 s38, 0
  s_bfm_b64 exec, 16, 0
.g2_kernel_pa14:
  buffer_load_dword v6, s[4:7], s31 offen sc1 lds
  s_add_u32 s38, s38, 1
  s_waitcnt vmcnt(0)
  ds_read_b32 v8, v7
  s_waitcnt lgkmcnt(0)
  v_cmp_ge_u32 vcc, s62, v8
  s_cbranch_vccz .g2_kernel_pa14d
  s_mov_b64 exec, vcc
  s_sleep 16
  s_cmp_lt_u32 s38, 131072
  s_cbranch_scc1 .g2_kernel_pa14
.g2_kernel_pa14d:
  s_mov_b64 exec, -1
  s_mul_i32 s30, s18, 12288
  s_add_u32 s30, s30, 0x3080000
  s_mov_b32 exec_hi, 0xffff
  buffer_load_dwordx4 v[64:67], v3, s[4:7], s30 offen offset:0 sc1
  buffer_load_dwordx4 v[68:71], v3, s[4:7], s30 offen offset:768 sc1
  buffer_load_dwordx4 v[72:75], v3, s[4:7], s30 offen offset:1536 sc1
  buffer_load_dwordx4 v[76:79], v3, s[4:7], s30 offen offset:2304 sc1
  s_add_u32 s30, s30, 3072
  buffer_load_dwordx4 v[80:83], v3, s[4:7], s30 offen offset:0 sc1
  buffer_load_dwordx4 v[84:87], v3, s[4:7], s30 offen offset:768 sc1
  buffer_load_dwordx4 v[88:91], v3, s[4:7], s30 offen offset:1536 sc1
  buffer_load_dwordx4 v[92:95], v3, s[4:7], s30 offen offset:2304 sc1
  s_add_u32 s30, s30, 3072
  buffer_load_dwordx4 v[96:99], v3, s[4:7], s30 offen offset:0 sc1
  buffer_load_dwordx4 v[100:103], v3, s[4:7], s30 offen offset:768 sc1
  buffer_load_dwordx4 v[104:107], v3, s[4:7], s30 offen offset:1536 sc1
  buffer_load_dwordx4 v[108:111], v3, s[4:7], s30 offen offset:2304 sc1
  s_add_u32 s30, s30, 3072
  buffer_load_dwordx4 v[112:115], v3, s[4:7], s30 offen offset:0 sc1
  buffer_load_dwordx4 v[116:119], v3, s[4:7], s30 offen offset:768 sc1
  buffer_load_dwordx4 v[120:123], v3, s[4:7], s30 offen offset:1536 sc1
  buffer_load_dwordx4 v[124:127], v3, s[4:7], s30 offen offset:2304 sc1
  s_add_u32 s30, s30, 3072
  s_waitcnt vmcnt(14)
  v_add_f32 v64, v64, v68
  v_add_f32 v65, v65, v69
  v_add_f32 v66, v66, v70
  v_add_f32 v67, v67, v71
  s_waitcnt vmcnt(13)
  v_add_f32 v64, v64, v72
  v_add_f32 v65, v65, v73
  v_add_f32 v66, v66, v74
  v_add_f32 v67, v67, v75
  s_waitcnt vmcnt(12)
  v_add_f32 v64, v64, v76
  v_add_f32 v65, v65, v77
  v_add_f32 v66, v66, v78
  v_add_f32 v67, v67, v79
  s_waitcnt vmcnt(11)
  v_add_f32 v64, v64, v80
  v_add_f32 v65, v65, v81
  v_add_f32 v66, v66, v82
  v_add_f32 v67, v67, v83
  s_waitcnt vmcnt(10)
  v_add_f32 v64, v64, v84
  v_add_f32 v65, v65, v85
  v_add_f32 v66, v66, v86
  v_add_f32 v67, v67, v87
  s_waitcnt vmcnt(9)
  v_add_f32 v64, v64, v88
  v_add_f32 v65, v65, v89
  v_add_f32 v66, v66, v90
  v_add_f32 v67, v67, v91
  s_waitcnt vmcnt(8)
  v_add_f32 v64, v64, v92
  v_add_f32 v65, v65, v93
  v_add_f32 v66, v66, v94
  v_add_f32 v67, v67, v95
  s_waitcnt vmcnt(7)
  v_add_f32 v64, v64, v96
  v_add_f32 v65, v65, v97
  v_add_f32 v66, v66, v98
  v_add_f32 v67, v67, v99
  s_waitcnt vmcnt(6)
  v_add_f32 v64, v64, v100
  v_add_f32 v65, v65, v101
  v_add_f32 v66, v66, v102
  v_add_f32 v67, v67, v103
  s_waitcnt vmcnt(5)
  v_add_f32 v64, v64, v104
  v_add_f32 v65, v65, v105
  v_add_f32 v66, v66, v106
  v_add_f32 v67, v67, v107
  s_waitcnt vmcnt(4)
  v_add_f32 v64, v64, v108
  v_add_f32 v65, v65, v109
  v_add_f32 v66, v66, v110
  v_add_f32 v67, v67, v111
  s_waitcnt vmcnt(3)
  v_add_f32 v64, v64, v112
  v_add_f32 v65, v65, v113
  v_add_f32 v66, v66, v114
  v_add_f32 v67, v67, v115
  s_waitcnt vmcnt(2)
  v_add_f32 v64, v64, v116
  v_add_f32 v65, v65, v117
  v_add_f32 v66, v66, v118
  v_add_f32 v67, v67, v119
  s_waitcnt vmcnt(1)
  v_add_f32 v64, v64, v120
  v_add_f32 v65, v65, v121
  v_add_f32 v66, v66, v122
  v_add_f32 v67, v67, v123
  s_waitcnt vmcnt(0)
  v_add_f32 v64, v64, v124
  v_add_f32 v65, v65, v125
  v_add_f32 v66, v66, v126
  v_add_f32 v67, v67, v127
  s_mov_b64 exec, -1
  v_mov_b32 v6, 155648
  s_mov_b32 s38, 0
.g2_kernel_wg15:
  ds_read_b32 v7, v6 offset:512
  s_add_u32 s38, s38, 1
  s_waitcnt lgkmcnt(0)
  v_cmp_gt_u32 vcc, 32, v7
  s_cbranch_vccz .g2_kernel_wg15d
  s_sleep 2
  s_cmp_lt_u32 s38, 524288
  s_cbranch_scc1 .g2_kernel_wg15
.g2_kernel_wg15d:
  v_lshlrev_b32 v24, 2, v2
  v_add_u32 v24, 155648, v24
  ds_write_b32 v24, v4 offset:2048
  v_add_u32 v24, 155648, v3
  s_mov_b32 exec_hi, 0xffff
  ds_write_b128 v24, v[64:67] offset:4864
  s_mov_b64 exec, -1
  v_mov_b32 v6, s71
  s_mov_b64 exec, 1
  ds_add_u32 v6, v5 offset:0
  s_mov_b64 exec, -1
  s_branch .g2_kernel_v
.g2_kernel_s3:
  s_mov_b32 s12, s58
  s_mov_b32 s13, s59
  s_mov_b32 s14, 0x100
  s_mov_b32 s15, 0x00020000
  s_mov_b32 s20, s48
  s_mov_b32 s21, s49
  s_mov_b32 s22, 0x800
  s_mov_b32 s23, 0x00020000
  v_mov_b32 v12, 0
  v_mov_b32 v13, 0
  v_mov_b32 v14, 0
  v_mov_b32 v15, 0
  s_cmp_ge_u32 s2, 96
  s_cbranch_scc1 .g2_kernel_zm16
  s_lshl_b32 s36, s2, 12
  s_add_u32 s36, s36, 0x3000000
  buffer_store_dwordx4 v[12:15], v3, s[4:7], s36 offen sc1
  buffer_store_dwordx4 v[12:15], v3, s[4:7], s36 offen offset:1024 sc1
  buffer_store_dwordx4 v[12:15], v3, s[4:7], s36 offen offset:2048 sc1
  buffer_store_dwordx4 v[12:15], v3, s[4:7], s36 offen offset:3072 sc1
.g2_kernel_zm16:
  s_barrier
  s_cbranch_scc1 .g2_kernel_zm16b
  s_mov_b64 exec, 1
  s_waitcnt vmcnt(0)
  buffer_atomic_add v5, v4, s[12:15], 0 offen sc1
  s_mov_b64 exec, -1
.g2_kernel_zm16b:
  s_and_b32 s36, s18, 7
  s_cmp_ge_u32 s36, 3
  s_cbranch_scc1 .g2_kernel_c317
  s_mov_b32 s24, s42
  s_mov_b32 s25, s43
  s_mov_b32 s26, 0x600000
  s_mov_b32 s27, 0x00020000
  v_mul_u32_u24 v7, 6144, v2
  s_lshl_b32 s36, s36, 11
  s_or_b32 s37, s18, 3
  s_lshl_b32 s37, s37, 7
  s_add_u32 s36, s36, s37
  s_and_b32 s37, s17, 7
  s_mul_i32 s37, s37, 393216
  s_add_u32 s36, s36, s37
  s_add_u32 s37, s36, 3145728
  s_sleep 0
  buffer_load_dword v1, v7, s[24:27], s36 offen
  s_sleep 30
  buffer_load_dword v1, v7, s[24:27], s37 offen
.g2_kernel_c317:
  v_lshlrev_b32 v20, 5, v2
  buffer_load_dwordx4 v[24:27], v20, s[20:23], 0 offen
  buffer_load_dwordx4 v[28:31], v20, s[20:23], 0 offen offset:16
  v_mov_b32 v20, 0
  s_waitcnt vmcnt(0)
  v_lshlrev_b32 v21, 16, v24
  v_and_b32 v22, 0xffff0000, v24
  v_add_f32 v20, v20, v21
  v_add_f32 v20, v20, v22
  v_lshlrev_b32 v21, 16, v25
  v_and_b32 v22, 0xffff0000, v25
  v_add_f32 v20, v20, v21
  v_add_f32 v20, v20, v22
  v_lshlrev_b32 v21, 16, v26
  v_and_b32 v22, 0xffff0000, v26
  v_add_f32 v20, v20, v21
  v_add_f32 v20, v20, v22
  v_lshlrev_b32 v21, 16, v27
  v_and_b32 v22, 0xffff0000, v27
  v_add_f32 v20, v20, v21
  v_add_f32 v20, v20, v22
  v_lshlrev_b32 v21, 16, v28
  v_and_b32 v22, 0xffff0000, v28
  v_add_f32 v20, v20, v21
  v_add_f32 v20, v20, v22
  v_lshlrev_b32 v21, 16, v29
  v_and_b32 v22, 0xffff0000, v29
  v_add_f32 v20, v20, v21
  v_add_f32 v20, v20, v22
  v_lshlrev_b32 v21, 16, v30
  v_and_b32 v22, 0xffff0000, v30
  v_add_f32 v20, v20, v21
  v_add_f32 v20, v20, v22
  v_lshlrev_b32 v21, 16, v31
  v_and_b32 v22, 0xffff0000, v31
  v_add_f32 v20, v20, v21
  v_add_f32 v20, v20, v22
  s_nop 1
  v_add_f32 v20, v20, v20 quad_perm:[1,0,3,2] row_mask:0xf bank_mask:0xf
  s_nop 1
  v_add_f32 v20, v20, v20 quad_perm:[2,3,0,1] row_mask:0xf bank_mask:0xf
  s_nop 1
  v_add_f32 v20, v20, v20 row_half_mirror row_mask:0xf bank_mask:0xf
  s_nop 1
  v_add_f32 v20, v20, v20 row_mirror row_mask:0xf bank_mask:0xf
  s_nop 0
  v_readlane_b32 s20, v20, 16
  v_readlane_b32 s21, v20, 32
  v_readlane_b32 s22, v20, 48
  v_add_f32 v20, s20, v20
  v_add_f32 v20, s21, v20
  v_add_f32 v20, s22, v20
  v_mul_f32 v20, 0x3a800000, v20
  v_mov_b32 v6, 155648
  s_mov_b32 s38, 0
.g2_kernel_wg18:
  ds_read_b32 v7, v6 offset:512
  s_add_u32 s38, s38, 1
  s_waitcnt lgkmcnt(0)
  v_cmp_gt_u32 vcc, 32, v7
  s_cbranch_vccz .g2_kernel_wg18d
  s_sleep 2
  s_cmp_lt_u32 s38, 524288
  s_cbranch_scc1 .g2_kernel_wg18
.g2_kernel_wg18d:
  v_mov_b32 v21, 155648
  s_mov_b64 exec, 1
  ds_write_b32 v21, v20 offset:256
  s_mov_b64 exec, -1
.g2_kernel_v:
  s_setprio 3
  s_cmp_lg_u32 s16, 4
  s_cbranch_scc1 .g2_kernel_v_1
  v_mov_b32 v6, s71
  s_mov_b32 s38, 0
.g2_kernel_wg19:
  ds_read_b32 v7, v6 offset:120
  s_add_u32 s38, s38, 1
  s_waitcnt lgkmcnt(0)
  v_cmp_gt_u32 vcc, 2, v7
  s_cbranch_vccz .g2_kernel_wg19d
  s_sleep 1
  s_cmp_lt_u32 s38, 524288
  s_cbranch_scc1 .g2_kernel_wg19
.g2_kernel_wg19d:
  s_sleep 4
  s_and_b32 s31, s76, 0xffffe000
  s_add_u32 s31, s31, 0
  v_and_b32 v6, 15, v2
  v_lshlrev_b32 v6, 9, v6
  v_lshrrev_b32 v7, 4, v2
  v_lshl_add_u32 v6, v7, 7, v6
  v_lshlrev_b32 v7, 2, v2
  v_add_u32 v7, 157440, v7
  s_mov_b32 m0, 157440
  s_mov_b32 s38, 0
  s_mov_b32 exec_lo, 0xffff
  s_mov_b32 exec_hi, 0xffff
.g2_kernel_pa20:
  buffer_load_dword v6, s[4:7], s31 offen sc1 lds
  s_add_u32 s38, s38, 1
  s_waitcnt vmcnt(0)
  ds_read_b32 v8, v7
  s_waitcnt lgkmcnt(0)
  v_cmp_ge_u32 vcc, s62, v8
  s_cbranch_vccz .g2_kernel_pa20d
  s_mov_b64 exec, vcc
  s_sleep 2
  s_cmp_lt_u32 s38, 131072
  s_cbranch_scc1 .g2_kernel_pa20
.g2_kernel_pa20d:
  s_mov_b64 exec, -1
  v_mov_b32 v6, s71
  s_mov_b32 s38, 0
.g2_kernel_wg21:
  ds_read_b32 v7, v6 offset:4
  s_add_u32 s38, s38, 1
  s_waitcnt lgkmcnt(0)
  v_cmp_gt_u32 vcc, 4, v7
  s_cbranch_vccz .g2_kernel_wg21d
  s_sleep 2
  s_cmp_lt_u32 s38, 524288
  s_cbranch_scc1 .g2_kernel_wg21
.g2_kernel_wg21d:
  v_mov_b32 v6, s71
  s_mov_b64 exec, 1
  ds_add_u32 v6, v5 offset:80
  s_mov_b64 exec, -1
.g2_kernel_v_1:
  s_cmp_lt_u32 s16, 6
  s_cbranch_scc1 .g2_kernel_v_2
  v_mov_b32 v6, s71
  s_mov_b32 s38, 0
.g2_kernel_wg22:
  ds_read_b32 v7, v6 offset:4
  s_add_u32 s38, s38, 1
  s_waitcnt lgkmcnt(0)
  v_cmp_gt_u32 vcc, 4, v7
  s_cbranch_vccz .g2_kernel_wg22d
  s_sleep 4
  s_cmp_lt_u32 s38, 524288
  s_cbranch_scc1 .g2_kernel_wg22
.g2_kernel_wg22d:
  s_and_b32 s28, s16, 1
  s_lshl_b32 s30, s28, 13
  s_add_u32 s31, s30, 16384
  v_add_u32 v8, s31, v3
  ds_read_b32 v9, v6 offset:24
  ds_read_b128 v[16:19], v8 offset:0
  ds_read_b128 v[20:23], v8 offset:1024
  ds_read_b128 v[24:27], v8 offset:2048
  ds_read_b128 v[28:31], v8 offset:3072
  ds_read_b128 v[32:35], v8 offset:4096
  ds_read_b128 v[36:39], v8 offset:5120
  ds_read_b128 v[40:43], v8 offset:6144
  ds_read_b128 v[44:47], v8 offset:7168
  s_lshl_b32 s31, s18, 5
  s_add_u32 s31, s31, s17
  s_add_u32 s31, s31, 16
  s_lshl_b32 s31, s31, 14
  s_add_u32 s30, s30, s31
  s_add_u32 s30, s30, s63
  s_add_u32 s31, s30, 4096
  s_lshl_b32 s33, s28, 8
  s_add_u32 s33, s33, 128
  s_waitcnt lgkmcnt(0)
  v_readfirstlane_b32 s29, v9
  v_mov_b32 v6, s71
  s_mov_b64 exec, 1
  ds_add_u32 v6, v5 offset:8
  s_mov_b64 exec, -1
  s_sleep 40
  buffer_store_dwordx4 v[16:19], v3, s[4:7], s30 offen offset:0 sc1
  s_sleep 4
  buffer_store_dwordx4 v[20:23], v3, s[4:7], s30 offen offset:1024 sc1
  s_sleep 4
  buffer_store_dwordx4 v[24:27], v3, s[4:7], s30 offen offset:2048 sc1
  s_sleep 4
  buffer_store_dwordx4 v[28:31], v3, s[4:7], s30 offen offset:3072 sc1
  s_sleep 4
  buffer_store_dwordx4 v[32:35], v3, s[4:7], s31 offen offset:0 sc1
  s_sleep 4
  buffer_store_dwordx4 v[36:39], v3, s[4:7], s31 offen offset:1024 sc1
  s_sleep 4
  buffer_store_dwordx4 v[40:43], v3, s[4:7], s31 offen offset:2048 sc1
  s_sleep 4
  buffer_store_dwordx4 v[44:47], v3, s[4:7], s31 offen offset:3072 sc1
  s_sleep 4
  s_sub_u32 s29, s29, 1
  s_lshr_b32 s29, s29, 6
  s_waitcnt vmcnt(0)
  s_cmp_eq_u32 s29, s28
  s_cbranch_scc1 .g2_kernel_v_1h
  s_add_u32 s31, s76, s33
  v_mov_b32 v6, s70
  s_mov_b64 exec, 1
  buffer_store_dword v6, v4, s[4:7], s31 offen offset:0 sc1
  s_mov_b64 exec, -1
  s_branch .g2_kernel_v_2
.g2_kernel_v_1h:
  v_mov_b32 v6, s71
  s_mov_b64 exec, 1
  ds_add_u32 v6, v5 offset:56
  s_mov_b64 exec, -1
.g2_kernel_v_2:
  v_mov_b32 v6, s71
  s_mov_b32 s38, 0
.g2_kernel_wg23:
  ds_read_b32 v7, v6 offset:80
  s_add_u32 s38, s38, 1
  s_waitcnt lgkmcnt(0)
  v_cmp_gt_u32 vcc, 1, v7
  s_cbranch_vccz .g2_kernel_wg23d
  s_sleep 8
  s_cmp_lt_u32 s38, 524288
  s_cbranch_scc1 .g2_kernel_wg23
.g2_kernel_wg23d:
  s_sleep 20
  s_mov_b32 s39, 0
  v_mov_b32 v12, 0
  v_mov_b32 v13, 0
  v_mov_b32 v14, 0
  v_mov_b32 v15, 0
  s_lshl_b32 s30, s17, 2
  s_and_b32 s31, s16, 3
  s_add_u32 s30, s30, s31
  s_lshl_b32 s30, s30, 4
  s_add_u32 s30, s30, s18
  s_lshl_b32 s30, s30, 9
  s_add_u32 s30, s30, s63
  s_add_u32 s30, s30, 0x1000000
  s_mov_b32 exec_hi, 0
  s_sleep 6
  buffer_store_dwordx4 v[12:15], v3, s[4:7], s30 offen sc1
  s_mov_b64 exec, -1
  s_lshl_b32 s30, s17, 2
  s_add_u32 s30, s30, s31
  s_lshl_b32 s30, s30, 5
  s_add_u32 s30, s30, s18
  s_lshl_b32 s30, s30, 11
  s_add_u32 s30, s30, s63
  s_add_u32 s30, s30, 0x808000
  s_sleep 6
  buffer_store_dwordx4 v[12:15], v3, s[4:7], s30 offen sc1
  s_sleep 6
  buffer_store_dwordx4 v[12:15], v3, s[4:7], s30 offen offset:1024 sc1
  s_cmp_lg_u32 s62, 5
  s_cbranch_scc1 .g2_kernel_zs24k
  s_lshl_b32 s30, s18, 4
  s_add_u32 s30, s30, s17
  s_lshl_b32 s30, s30, 2
  s_add_u32 s30, s30, s31
  s_lshl_b32 s30, s30, 12
  s_add_u32 s30, s30, 0x2c00000
  s_sleep 6
  buffer_store_dwordx4 v[12:15], v3, s[4:7], s30 offen sc1
  s_sleep 6
  buffer_store_dwordx4 v[12:15], v3, s[4:7], s30 offen offset:1024 sc1
  s_sleep 6
  buffer_store_dwordx4 v[12:15], v3, s[4:7], s30 offen offset:2048 sc1
  s_sleep 6
  buffer_store_dwordx4 v[12:15], v3, s[4:7], s30 offen offset:3072 sc1
.g2_kernel_zs24k:
  s_lshl_b32 s30, s17, 4
  s_add_u32 s30, s30, s18
  s_cmp_gt_u32 s16, 5
  s_cbranch_scc1 .g2_kernel_zs24
  s_cmp_eq_u32 s16, 5
  s_cbranch_scc1 .g2_kernel_zs24a
  s_cmp_lg_u32 s62, 0
  s_cbranch_scc1 .g2_kernel_zs24
  s_lshl_b32 s30, s30, 12
  s_add_u32 s31, s30, 0x1090000
  s_sleep 6
  buffer_store_dwordx4 v[12:15], v3, s[4:7], s31 offen offset:0 sc1
  s_sleep 6
  buffer_store_dwordx4 v[12:15], v3, s[4:7], s31 offen offset:1024 sc1
  s_sleep 6
  buffer_store_dwordx4 v[12:15], v3, s[4:7], s31 offen offset:2048 sc1
  s_sleep 6
  buffer_store_dwordx4 v[12:15], v3, s[4:7], s31 offen offset:3072 sc1
  s_add_u32 s31, s30, 0x2890000
  s_sleep 6
  buffer_store_dwordx4 v[12:15], v3, s[4:7], s31 offen offset:0 sc1
  s_sleep 6
  buffer_store_dwordx4 v[12:15], v3, s[4:7], s31 offen offset:1024 sc1
  s_sleep 6
  buffer_store_dwordx4 v[12:15], v3, s[4:7], s31 offen offset:2048 sc1
  s_sleep 6
  buffer_store_dwordx4 v[12:15], v3, s[4:7], s31 offen offset:3072 sc1
  s_add_u32 s31, s30, 0x2b00000
  s_sleep 6
  buffer_store_dwordx4 v[12:15], v3, s[4:7], s31 offen offset:0 sc1
  s_sleep 6
  buffer_store_dwordx4 v[12:15], v3, s[4:7], s31 offen offset:1024 sc1
  s_sleep 6
  buffer_store_dwordx4 v[12:15], v3, s[4:7], s31 offen offset:2048 sc1
  s_sleep 6
  buffer_store_dwordx4 v[12:15], v3, s[4:7], s31 offen offset:3072 sc1
  s_branch .g2_kernel_zs24
.g2_kernel_zs24a:
  s_xor_b32 s31, s17, s18
  s_and_b32 s31, s31, 3
  s_cbranch_scc1 .g2_kernel_zs24b
  s_lshr_b32 s30, s30, 2
  s_lshl_b32 s30, s30, 8
  s_add_u32 s30, s30, s63
  s_add_u32 s30, s30, 0x1080000
  s_mov_b64 exec, 0xffff
  s_sleep 6
  buffer_store_dwordx4 v[12:15], v3, s[4:7], s30 offen sc1
  s_mov_b64 exec, -1
.g2_kernel_zs24b:
  s_and_b32 s30, s18, 14
  s_lshl_b32 s30, s30, 4
  s_add_u32 s30, s30, s17
  s_lshl_b32 s30, s30, 1
  s_and_b32 s31, s18, 1
  s_add_u32 s30, s30, s31
  s_lshl_b32 s30, s30, 10
  s_add_u32 s30, s30, s63
  s_add_u32 s30, s30, 0x1190000
  s_add_u32 s31, s30, 32768
  s_sleep 6
  buffer_store_dwordx4 v[12:15], v3, s[4:7], s30 offen sc1
  s_sleep 6
  buffer_store_dwordx4 v[12:15], v3, s[4:7], s31 offen sc1
.g2_kernel_zs24:
  s_cmp_eq_u32 s16, 4
  s_cbranch_scc1 .g2_kernel_v_3a
  s_cmp_lg_u32 s62, 0
  s_cbranch_scc1 .g2_kernel_g_e
  s_and_b32 s22, s16, 3
  s_lshl_b32 s22, s22, 14
  s_cmp_eq_u32 s16, 5
  s_cselect_b32 s28, 65536, 0
  s_add_u32 s22, s22, s28
  v_bfe_u32 v8, v2, 2, 2
  v_lshrrev_b32 v9, 4, v2
  v_and_b32 v10, 3, v2
  v_lshlrev_b32 v10, 3, v10
  v_add_u32 v10, s22, v10
  s_cmp_eq_u32 s16, 5
  s_cbranch_scc1 .g2_kernel_g_p
  s_lshl_b32 s74, s17, 4
  s_add_u32 s74, s74, s18
  s_cmp_ge_u32 s74, 224
  s_cbranch_scc1 .g2_kernel_g_e
  v_lshrrev_b32 v6, 1, v2
  v_mul_u32_u24 v6, 7168, v6
  v_and_b32 v7, 1, v2
  v_lshl_add_u32 v250, v7, 4, v6
  v_lshl_add_u32 v11, v9, 3, v8
  v_lshl_add_u32 v251, v11, 5, v10
  v_and_b32 v11, 1, v9
  v_lshl_add_u32 v11, v11, 3, v8
  v_lshl_add_u32 v11, v11, 10, v10
  v_lshrrev_b32 v7, 1, v9
  v_lshl_add_u32 v252, v7, 7, v11
  s_mov_b32 s24, s74
  s_and_b32 s25, s16, 1
  s_mov_b32 s12, s50
  s_mov_b32 s13, s51
  s_mov_b32 s14, 0x700000
  s_mov_b32 s15, 0x00020000
  s_mul_i32 s20, s25, 3670016
  s_lshl_b32 s31, s24, 5
  s_add_u32 s20, s20, s31
  s_lshl_b32 s31, s18, 2
  s_mov_b32 s23, s31
  s_mov_b32 s21, 16
.g2_kernel_gl26:
  s_and_b32 s30, s21, 3
  s_cbranch_scc1 .g2_kernel_gl26m
  s_call_b64 s[26:27], .g2_kernel_v_may
.g2_kernel_gl26m:
  s_and_b32 s23, s23, 15
  s_lshl_b32 s30, s23, 10
  s_add_u32 s30, s30, 0
  s_add_u32 m0, s30, s22
  s_mul_i32 s30, s23, 229376
  s_add_u32 s30, s30, s20
  buffer_load_dwordx4 v250, s[12:15], s30 offen lds
  s_add_u32 s23, s23, 1
  s_sub_u32 s21, s21, 1
  s_sleep 4
  s_waitcnt vmcnt(3)
  s_cmp_lg_u32 s21, 0
  s_cbranch_scc1 .g2_kernel_gl26
  s_waitcnt vmcnt(0)
  ds_read_b64_tr_b16 v[64:65], v251 offset:0
  ds_read_b64_tr_b16 v[66:67], v251 offset:128
  ds_read_b64_tr_b16 v[68:69], v251 offset:1024
  ds_read_b64_tr_b16 v[70:71], v251 offset:1152
  ds_read_b64_tr_b16 v[72:73], v251 offset:2048
  ds_read_b64_tr_b16 v[74:75], v251 offset:2176
  ds_read_b64_tr_b16 v[76:77], v251 offset:3072
  ds_read_b64_tr_b16 v[78:79], v251 offset:3200
  ds_read_b64_tr_b16 v[80:81], v251 offset:4096
  ds_read_b64_tr_b16 v[82:83], v251 offset:4224
  ds_read_b64_tr_b16 v[84:85], v251 offset:5120
  ds_read_b64_tr_b16 v[86:87], v251 offset:5248
  ds_read_b64_tr_b16 v[88:89], v251 offset:6144
  ds_read_b64_tr_b16 v[90:91], v251 offset:6272
  ds_read_b64_tr_b16 v[92:93], v251 offset:7168
  ds_read_b64_tr_b16 v[94:95], v251 offset:7296
  ds_read_b64_tr_b16 v[96:97], v251 offset:8192
  ds_read_b64_tr_b16 v[98:99], v251 offset:8320
  ds_read_b64_tr_b16 v[100:101], v251 offset:9216
  ds_read_b64_tr_b16 v[102:103], v251 offset:9344
  ds_read_b64_tr_b16 v[104:105], v251 offset:10240
  ds_read_b64_tr_b16 v[106:107], v251 offset:10368
  ds_read_b64_tr_b16 v[108:109], v251 offset:11264
  ds_read_b64_tr_b16 v[110:111], v251 offset:11392
  ds_read_b64_tr_b16 v[112:113], v251 offset:12288
  ds_read_b64_tr_b16 v[114:115], v251 offset:12416
  ds_read_b64_tr_b16 v[116:117], v251 offset:13312
  ds_read_b64_tr_b16 v[118:119], v251 offset:13440
  ds_read_b64_tr_b16 v[120:121], v251 offset:14336
  ds_read_b64_tr_b16 v[122:123], v251 offset:14464
  ds_read_b64_tr_b16 v[124:125], v251 offset:15360
  ds_read_b64_tr_b16 v[126:127], v251 offset:15488
  s_waitcnt lgkmcnt(0)
  s_mov_b32 s12, s52
  s_mov_b32 s13, s53
  s_mov_b32 s14, 0x700000
  s_mov_b32 s15, 0x00020000
  s_mul_i32 s20, s25, 3670016
  s_lshl_b32 s31, s24, 5
  s_add_u32 s20, s20, s31
  s_lshl_b32 s31, s18, 2
  s_mov_b32 s23, s31
  s_mov_b32 s21, 16
.g2_kernel_gl27:
  s_and_b32 s30, s21, 3
  s_cbranch_scc1 .g2_kernel_gl27m
  s_call_b64 s[26:27], .g2_kernel_v_may
.g2_kernel_gl27m:
  s_and_b32 s23, s23, 15
  s_lshl_b32 s30, s23, 10
  s_add_u32 s30, s30, 0
  s_add_u32 m0, s30, s22
  s_mul_i32 s30, s23, 229376
  s_add_u32 s30, s30, s20
  buffer_load_dwordx4 v250, s[12:15], s30 offen lds
  s_add_u32 s23, s23, 1
  s_sub_u32 s21, s21, 1
  s_sleep 4
  s_waitcnt vmcnt(3)
  s_cmp_lg_u32 s21, 0
  s_cbranch_scc1 .g2_kernel_gl27
  s_waitcnt vmcnt(0)
  ds_read_b64_tr_b16 v[128:129], v251 offset:0
  ds_read_b64_tr_b16 v[130:131], v251 offset:128
  ds_read_b64_tr_b16 v[132:133], v251 offset:1024
  ds_read_b64_tr_b16 v[134:135], v251 offset:1152
  ds_read_b64_tr_b16 v[136:137], v251 offset:2048
  ds_read_b64_tr_b16 v[138:139], v251 offset:2176
  ds_read_b64_tr_b16 v[140:141], v251 offset:3072
  ds_read_b64_tr_b16 v[142:143], v251 offset:3200
  ds_read_b64_tr_b16 v[144:145], v251 offset:4096
  ds_read_b64_tr_b16 v[146:147], v251 offset:4224
  ds_read_b64_tr_b16 v[148:149], v251 offset:5120
  ds_read_b64_tr_b16 v[150:151], v251 offset:5248
  ds_read_b64_tr_b16 v[152:153], v251 offset:6144
  ds_read_b64_tr_b16 v[154:155], v251 offset:6272
  ds_read_b64_tr_b16 v[156:157], v251 offset:7168
  ds_read_b64_tr_b16 v[158:159], v251 offset:7296
  ds_read_b64_tr_b16 v[160:161], v251 offset:8192
  ds_read_b64_tr_b16 v[162:163], v251 offset:8320
  ds_read_b64_tr_b16 v[164:165], v251 offset:9216
  ds_read_b64_tr_b16 v[166:167], v251 offset:9344
  ds_read_b64_tr_b16 v[168:169], v251 offset:10240
  ds_read_b64_tr_b16 v[170:171], v251 offset:10368
  ds_read_b64_tr_b16 v[172:173], v251 offset:11264
  ds_read_b64_tr_b16 v[174:175], v251 offset:11392
  ds_read_b64_tr_b16 v[176:177], v251 offset:12288
  ds_read_b64_tr_b16 v[178:179], v251 offset:12416
  ds_read_b64_tr_b16 v[180:181], v251 offset:13312
  ds_read_b64_tr_b16 v[182:183], v251 offset:13440
  ds_read_b64_tr_b16 v[184:185], v251 offset:14336
  ds_read_b64_tr_b16 v[186:187], v251 offset:14464
  ds_read_b64_tr_b16 v[188:189], v251 offset:15360
  ds_read_b64_tr_b16 v[190:191], v251 offset:15488
  s_waitcnt lgkmcnt(0)
  s_mov_b32 s12, s54
  s_mov_b32 s13, s55
  s_mov_b32 s14, 0x700000
  s_mov_b32 s15, 0x00020000
  s_lshl_b32 s20, s24, 15
  s_lshl_b32 s31, s25, 10
  s_add_u32 s20, s20, s31
  s_mov_b32 s23, 0
  s_mov_b32 s21, 16
.g2_kernel_gl28:
  s_and_b32 s30, s21, 3
  s_cbranch_scc1 .g2_kernel_gl28m
  s_call_b64 s[26:27], .g2_kernel_v_may
.g2_kernel_gl28m:
  s_and_b32 s23, s23, 15
  s_lshl_b32 s30, s23, 10
  s_add_u32 s30, s30, 0
  s_add_u32 m0, s30, s22
  s_mul_i32 s30, s23, 2048
  s_add_u32 s30, s30, s20
  buffer_load_dwordx4 v3, s[12:15], s30 offen lds
  s_add_u32 s23, s23, 1
  s_sub_u32 s21, s21, 1
  s_sleep 2
  s_waitcnt vmcnt(8)
  s_cmp_lg_u32 s21, 0
  s_cbranch_scc1 .g2_kernel_gl28
  v_mov_b32 v11, v252
  s_waitcnt vmcnt(0)
  ds_read_b64_tr_b16 v[192:193], v11 offset:0
  ds_read_b64_tr_b16 v[194:195], v11 offset:4096
  ds_read_b64_tr_b16 v[196:197], v11 offset:32
  ds_read_b64_tr_b16 v[198:199], v11 offset:4128
  ds_read_b64_tr_b16 v[200:201], v11 offset:64
  ds_read_b64_tr_b16 v[202:203], v11 offset:4160
  ds_read_b64_tr_b16 v[204:205], v11 offset:96
  ds_read_b64_tr_b16 v[206:207], v11 offset:4192
  ds_read_b64_tr_b16 v[208:209], v11 offset:256
  ds_read_b64_tr_b16 v[210:211], v11 offset:4352
  ds_read_b64_tr_b16 v[212:213], v11 offset:288
  ds_read_b64_tr_b16 v[214:215], v11 offset:4384
  ds_read_b64_tr_b16 v[216:217], v11 offset:320
  ds_read_b64_tr_b16 v[218:219], v11 offset:4416
  ds_read_b64_tr_b16 v[220:221], v11 offset:352
  ds_read_b64_tr_b16 v[222:223], v11 offset:4448
  ds_read_b64_tr_b16 v[224:225], v11 offset:512
  ds_read_b64_tr_b16 v[226:227], v11 offset:4608
  ds_read_b64_tr_b16 v[228:229], v11 offset:544
  ds_read_b64_tr_b16 v[230:231], v11 offset:4640
  ds_read_b64_tr_b16 v[232:233], v11 offset:576
  ds_read_b64_tr_b16 v[234:235], v11 offset:4672
  ds_read_b64_tr_b16 v[236:237], v11 offset:608
  ds_read_b64_tr_b16 v[238:239], v11 offset:4704
  ds_read_b64_tr_b16 v[240:241], v11 offset:768
  ds_read_b64_tr_b16 v[242:243], v11 offset:4864
  ds_read_b64_tr_b16 v[244:245], v11 offset:800
  ds_read_b64_tr_b16 v[246:247], v11 offset:4896
  ds_read_b64_tr_b16 v[248:249], v11 offset:832
  ds_read_b64_tr_b16 v[250:251], v11 offset:4928
  ds_read_b64_tr_b16 v[252:253], v11 offset:864
  ds_read_b64_tr_b16 v[254:255], v11 offset:4960
  s_waitcnt lgkmcnt(0)
  s_branch .g2_kernel_g_e
.g2_kernel_g_p:
  s_mov_b32 s12, s42
  s_mov_b32 s13, s43
  s_mov_b32 s14, 0x600000
  s_mov_b32 s15, 0x00020000
  v_mul_u32_u24 v6, 6144, v9
  v_and_b32 v7, 15, v2
  v_lshl_add_u32 v250, v7, 4, v6
  v_lshl_add_u32 v11, v8, 2, v9
  v_lshl_add_u32 v251, v11, 9, v10
  s_lshl_b32 s20, s17, 3
  s_and_b32 s31, s18, 1
  s_add_u32 s20, s20, s31
  s_mul_i32 s20, s20, 49152
  s_and_b32 s31, s18, 14
  s_lshl_b32 s31, s31, 7
  s_add_u32 s20, s20, s31
  s_mov_b32 s23, 0
  s_mov_b32 s21, 8
.g2_kernel_gl29:
  s_and_b32 s30, s21, 3
  s_cbranch_scc1 .g2_kernel_gl29m
  s_call_b64 s[26:27], .g2_kernel_v_may
.g2_kernel_gl29m:
  s_and_b32 s23, s23, 7
  s_lshl_b32 s30, s23, 10
  s_add_u32 s30, s30, 0
  s_add_u32 m0, s30, s22
  s_mul_i32 s30, s23, 49152
  s_add_u32 s30, s30, s20
  s_and_b32 s31, s23, 1
  s_mul_i32 s31, s31, -24576
  s_add_u32 s30, s30, s31
  buffer_load_dwordx4 v250, s[12:15], s30 offen lds
  s_add_u32 s23, s23, 1
  s_sub_u32 s21, s21, 1
  s_sleep 2
  s_waitcnt vmcnt(3)
  s_cmp_lg_u32 s21, 0
  s_cbranch_scc1 .g2_kernel_gl29
  s_add_u32 s20, s20, 2048
  s_mov_b32 s23, 0
  s_mov_b32 s21, 8
.g2_kernel_gl30:
  s_and_b32 s30, s21, 3
  s_cbranch_scc1 .g2_kernel_gl30m
  s_call_b64 s[26:27], .g2_kernel_v_may
.g2_kernel_gl30m:
  s_and_b32 s23, s23, 7
  s_lshl_b32 s30, s23, 10
  s_add_u32 s30, s30, 8192
  s_add_u32 m0, s30, s22
  s_mul_i32 s30, s23, 49152
  s_add_u32 s30, s30, s20
  s_and_b32 s31, s23, 1
  s_mul_i32 s31, s31, -24576
  s_add_u32 s30, s30, s31
  buffer_load_dwordx4 v250, s[12:15], s30 offen lds
  s_add_u32 s23, s23, 1
  s_sub_u32 s21, s21, 1
  s_sleep 2
  s_waitcnt vmcnt(3)
  s_cmp_lg_u32 s21, 0
  s_cbranch_scc1 .g2_kernel_gl30
  s_add_u32 s20, s20, 2048
  s_waitcnt vmcnt(0)
  ds_read_b64_tr_b16 v[64:65], v251 offset:0
  ds_read_b64_tr_b16 v[66:67], v251 offset:256
  ds_read_b64_tr_b16 v[68:69], v251 offset:32
  ds_read_b64_tr_b16 v[70:71], v251 offset:288
  ds_read_b64_tr_b16 v[72:73], v251 offset:64
  ds_read_b64_tr_b16 v[74:75], v251 offset:320
  ds_read_b64_tr_b16 v[76:77], v251 offset:96
  ds_read_b64_tr_b16 v[78:79], v251 offset:352
  ds_read_b64_tr_b16 v[80:81], v251 offset:128
  ds_read_b64_tr_b16 v[82:83], v251 offset:384
  ds_read_b64_tr_b16 v[84:85], v251 offset:160
  ds_read_b64_tr_b16 v[86:87], v251 offset:416
  ds_read_b64_tr_b16 v[88:89], v251 offset:192
  ds_read_b64_tr_b16 v[90:91], v251 offset:448
  ds_read_b64_tr_b16 v[92:93], v251 offset:224
  ds_read_b64_tr_b16 v[94:95], v251 offset:480
  ds_read_b64_tr_b16 v[96:97], v251 offset:8192
  ds_read_b64_tr_b16 v[98:99], v251 offset:8448
  ds_read_b64_tr_b16 v[100:101], v251 offset:8224
  ds_read_b64_tr_b16 v[102:103], v251 offset:8480
  ds_read_b64_tr_b16 v[104:105], v251 offset:8256
  ds_read_b64_tr_b16 v[106:107], v251 offset:8512
  ds_read_b64_tr_b16 v[108:109], v251 offset:8288
  ds_read_b64_tr_b16 v[110:111], v251 offset:8544
  ds_read_b64_tr_b16 v[112:113], v251 offset:8320
  ds_read_b64_tr_b16 v[114:115], v251 offset:8576
  ds_read_b64_tr_b16 v[116:117], v251 offset:8352
  ds_read_b64_tr_b16 v[118:119], v251 offset:8608
  ds_read_b64_tr_b16 v[120:121], v251 offset:8384
  ds_read_b64_tr_b16 v[122:123], v251 offset:8640
  ds_read_b64_tr_b16 v[124:125], v251 offset:8416
  ds_read_b64_tr_b16 v[126:127], v251 offset:8672
  s_waitcnt lgkmcnt(0)
  s_mov_b32 s23, 0
  s_mov_b32 s21, 8
.g2_kernel_gl31:
  s_and_b32 s30, s21, 3
  s_cbranch_scc1 .g2_kernel_gl31m
  s_call_b64 s[26:27], .g2_kernel_v_may
.g2_kernel_gl31m:
  s_and_b32 s23, s23, 7
  s_lshl_b32 s30, s23, 10
  s_add_u32 s30, s30, 0
  s_add_u32 m0, s30, s22
  s_mul_i32 s30, s23, 49152
  s_add_u32 s30, s30, s20
  s_and_b32 s31, s23, 1
  s_mul_i32 s31, s31, -24576
  s_add_u32 s30, s30, s31
  buffer_load_dwordx4 v250, s[12:15], s30 offen lds
  s_add_u32 s23, s23, 1
  s_sub_u32 s21, s21, 1
  s_sleep 2
  s_waitcnt vmcnt(3)
  s_cmp_lg_u32 s21, 0
  s_cbranch_scc1 .g2_kernel_gl31
  s_add_u32 s20, s20, 2048
  s_waitcnt vmcnt(0)
  ds_read_b64_tr_b16 v[128:129], v251 offset:0
  ds_read_b64_tr_b16 v[130:131], v251 offset:256
  ds_read_b64_tr_b16 v[132:133], v251 offset:32
  ds_read_b64_tr_b16 v[134:135], v251 offset:288
  ds_read_b64_tr_b16 v[136:137], v251 offset:64
  ds_read_b64_tr_b16 v[138:139], v251 offset:320
  ds_read_b64_tr_b16 v[140:141], v251 offset:96
  ds_read_b64_tr_b16 v[142:143], v251 offset:352
  ds_read_b64_tr_b16 v[144:145], v251 offset:128
  ds_read_b64_tr_b16 v[146:147], v251 offset:384
  ds_read_b64_tr_b16 v[148:149], v251 offset:160
  ds_read_b64_tr_b16 v[150:151], v251 offset:416
  ds_read_b64_tr_b16 v[152:153], v251 offset:192
  ds_read_b64_tr_b16 v[154:155], v251 offset:448
  ds_read_b64_tr_b16 v[156:157], v251 offset:224
  ds_read_b64_tr_b16 v[158:159], v251 offset:480
  s_waitcnt lgkmcnt(0)
.g2_kernel_g_e:
  s_cmp_lt_u32 s16, 6
  s_cbranch_scc1 .g2_kernel_v_3
  v_mov_b32 v6, s71
  s_mov_b64 exec, 1
  ds_add_u32 v6, v5 offset:116
  s_mov_b64 exec, -1
  s_branch .g2_kernel_v_3c
.g2_kernel_v_3:
  s_mov_b32 s29, 0
  s_and_b32 s32, s16, 3
  s_lshl_b32 s30, s32, 14
  s_add_u32 s30, s30, 65536
  s_call_b64 s[68:69], .g2_kernel_v_wo
  s_cmp_lg_u32 s16, 4
  s_cbranch_scc1 .g2_kernel_v_3d
  s_mov_b32 s32, 2
  s_mov_b32 s30, 98304
  s_call_b64 s[68:69], .g2_kernel_v_wo
  s_mov_b32 s32, 3
  s_mov_b32 s30, 114688
  s_call_b64 s[68:69], .g2_kernel_v_wo
.g2_kernel_v_3d:
  s_waitcnt vmcnt(0)
  v_mov_b32 v8, 2
  v_mov_b32 v6, s71
  s_mov_b64 exec, 1
  ds_add_u32 v6, v8 offset:52
  s_mov_b64 exec, -1
.g2_kernel_v_3c:
  s_cmp_lg_u32 s39, 0
  s_cbranch_scc1 .g2_kernel_v_3b
  s_call_b64 s[26:27], .g2_kernel_v_do
.g2_kernel_v_3b:
  s_cmp_lg_u32 s16, 4
  s_cbranch_scc1 .g2_kernel_v_4
  v_mov_b32 v6, s71
  s_mov_b32 s38, 0
.g2_kernel_wg32:
  ds_read_b32 v7, v6 offset:8
  s_add_u32 s38, s38, 1
  s_waitcnt lgkmcnt(0)
  v_cmp_gt_u32 vcc, 10, v7
  s_cbranch_vccz .g2_kernel_wg32d
  s_sleep 8
  s_cmp_lt_u32 s38, 524288
  s_cbranch_scc1 .g2_kernel_wg32
.g2_kernel_wg32d:
  s_mov_b32 s29, 1
  s_mov_b32 s32, 0
  s_mov_b32 s30, 139264
  s_call_b64 s[68:69], .g2_kernel_v_wo
  s_add_u32 s31, s31, 81920
  s_sleep 6
  s_waitcnt vmcnt(4)
  buffer_load_dwordx4 v[64:67], v6, s[8:11], s31 offen
  s_add_u32 s31, s31, 16384
  buffer_load_dwordx4 v[68:71], v6, s[8:11], s31 offen
  s_add_u32 s31, s31, 16384
  buffer_load_dwordx4 v[72:75], v6, s[8:11], s31 offen
  s_add_u32 s31, s31, 16384
  buffer_load_dwordx4 v[76:79], v6, s[8:11], s31 offen
  s_add_u32 s31, s31, 81920
  s_sleep 6
  s_waitcnt vmcnt(4)
  buffer_load_dwordx4 v[80:83], v6, s[8:11], s31 offen
  s_add_u32 s31, s31, 16384
  buffer_load_dwordx4 v[84:87], v6, s[8:11], s31 offen
  s_add_u32 s31, s31, 16384
  buffer_load_dwordx4 v[88:91], v6, s[8:11], s31 offen
  s_add_u32 s31, s31, 16384
  buffer_load_dwordx4 v[92:95], v6, s[8:11], s31 offen
  s_add_u32 s31, s31, 81920
  s_sleep 6
  s_waitcnt vmcnt(4)
  buffer_load_dwordx4 v[96:99], v6, s[8:11], s31 offen
  s_add_u32 s31, s31, 16384
  buffer_load_dwordx4 v[100:103], v6, s[8:11], s31 offen
  s_add_u32 s31, s31, 16384
  buffer_load_dwordx4 v[104:107], v6, s[8:11], s31 offen
  s_add_u32 s31, s31, 16384
  buffer_load_dwordx4 v[108:111], v6, s[8:11], s31 offen
  s_add_u32 s31, s31, 81920
  s_sleep 6
  s_waitcnt vmcnt(4)
  buffer_load_dwordx4 v[112:115], v6, s[8:11], s31 offen
  s_add_u32 s31, s31, 16384
  buffer_load_dwordx4 v[116:119], v6, s[8:11], s31 offen
  s_add_u32 s31, s31, 16384
  buffer_load_dwordx4 v[120:123], v6, s[8:11], s31 offen
  s_add_u32 s31, s31, 16384
  buffer_load_dwordx4 v[124:127], v6, s[8:11], s31 offen
  s_add_u32 s31, s31, 81920
  s_sleep 6
  s_waitcnt vmcnt(4)
  buffer_load_dwordx4 v[128:131], v6, s[8:11], s31 offen
  s_add_u32 s31, s31, 16384
  buffer_load_dwordx4 v[132:135], v6, s[8:11], s31 offen
  s_add_u32 s31, s31, 16384
  buffer_load_dwordx4 v[136:139], v6, s[8:11], s31 offen
  s_add_u32 s31, s31, 16384
  buffer_load_dwordx4 v[140:143], v6, s[8:11], s31 offen
  s_add_u32 s31, s31, 81920
  s_sleep 6
  s_waitcnt vmcnt(4)
  buffer_load_dwordx4 v[144:147], v6, s[8:11], s31 offen
  s_add_u32 s31, s31, 16384
  buffer_load_dwordx4 v[148:151], v6, s[8:11], s31 offen
  s_add_u32 s31, s31, 16384
  buffer_load_dwordx4 v[152:155], v6, s[8:11], s31 offen
  s_add_u32 s31, s31, 16384
  buffer_load_dwordx4 v[156:159], v6, s[8:11], s31 offen
  s_add_u32 s31, s31, 81920
  s_sleep 6
  s_waitcnt vmcnt(4)
  buffer_load_dwordx4 v[160:163], v6, s[8:11], s31 offen
  s_add_u32 s31, s31, 16384
  buffer_load_dwordx4 v[164:167], v6, s[8:11], s31 offen
  s_add_u32 s31, s31, 16384
  buffer_load_dwordx4 v[168:171], v6, s[8:11], s31 offen
  s_add_u32 s31, s31, 16384
  buffer_load_dwordx4 v[172:175], v6, s[8:11], s31 offen
  s_add_u32 s31, s31, 81920
  s_sleep 6
  s_waitcnt vmcnt(4)
  buffer_load_dwordx4 v[176:179], v6, s[8:11], s31 offen
  s_add_u32 s31, s31, 16384
  buffer_load_dwordx4 v[180:183], v6, s[8:11], s31 offen
  s_add_u32 s31, s31, 16384
  buffer_load_dwordx4 v[184:187], v6, s[8:11], s31 offen
  s_add_u32 s31, s31, 16384
  buffer_load_dwordx4 v[188:191], v6, s[8:11], s31 offen
  s_add_u32 s31, s31, 81920
  s_sleep 6
  s_waitcnt vmcnt(4)
  buffer_load_dwordx4 v[192:195], v6, s[8:11], s31 offen
  s_add_u32 s31, s31, 16384
  buffer_load_dwordx4 v[196:199], v6, s[8:11], s31 offen
  s_add_u32 s31, s31, 16384
  buffer_load_dwordx4 v[200:203], v6, s[8:11], s31 offen
  s_add_u32 s31, s31, 16384
  buffer_load_dwordx4 v[204:207], v6, s[8:11], s31 offen
  s_add_u32 s31, s31, 81920
  s_sleep 6
  s_waitcnt vmcnt(4)
  buffer_load_dwordx4 v[208:211], v6, s[8:11], s31 offen
  s_add_u32 s31, s31, 16384
  buffer_load_dwordx4 v[212:215], v6, s[8:11], s31 offen
  s_add_u32 s31, s31, 16384
  buffer_load_dwordx4 v[216:219], v6, s[8:11], s31 offen
  s_add_u32 s31, s31, 16384
  buffer_load_dwordx4 v[220:223], v6, s[8:11], s31 offen
  s_add_u32 s31, s31, 81920
  s_sleep 6
  s_waitcnt vmcnt(4)
  buffer_load_dwordx4 v[224:227], v6, s[8:11], s31 offen
  s_add_u32 s31, s31, 16384
  buffer_load_dwordx4 v[228:231], v6, s[8:11], s31 offen
  s_add_u32 s31, s31, 16384
  buffer_load_dwordx4 v[232:235], v6, s[8:11], s31 offen
  s_add_u32 s31, s31, 16384
  buffer_load_dwordx4 v[236:239], v6, s[8:11], s31 offen
  s_add_u32 s31, s31, 81920
  s_sleep 6
  s_waitcnt vmcnt(4)
  buffer_load_dwordx4 v[240:243], v6, s[8:11], s31 offen
  s_add_u32 s31, s31, 16384
  buffer_load_dwordx4 v[244:247], v6, s[8:11], s31 offen
  s_add_u32 s31, s31, 16384
  buffer_load_dwordx4 v[248:251], v6, s[8:11], s31 offen
  s_add_u32 s31, s31, 16384
  buffer_load_dwordx4 v[252:255], v6, s[8:11], s31 offen
  s_cmp_eq_u32 s62, 0
  s_cbranch_scc1 .g2_kernel_v_4
  v_mov_b32 v8, s71
  s_mov_b32 s38, 0
.g2_kernel_wg33:
  ds_read_b32 v9, v8 offset:116
  s_add_u32 s38, s38, 1
  s_waitcnt lgkmcnt(0)
  v_cmp_gt_u32 vcc, 2, v9
  s_cbranch_vccz .g2_kernel_wg33d
  s_sleep 4
  s_cmp_lt_u32 s38, 524288
  s_cbranch_scc1 .g2_kernel_wg33
.g2_kernel_wg33d:
  s_waitcnt vmcnt(0)
  s_call_b64 s[68:69], .g2_kernel_v_w23
.g2_kernel_v_4:
  s_cmp_lg_u32 s16, 5
  s_cbranch_scc1 .g2_kernel_v_5
  s_sleep 48
  s_and_b32 s31, s19, 0xffffe000
  s_add_u32 s31, s31, 0
  v_and_b32 v6, 15, v2
  v_lshlrev_b32 v6, 9, v6
  v_lshrrev_b32 v7, 4, v2
  v_lshl_add_u32 v6, v7, 7, v6
  v_lshlrev_b32 v7, 2, v2
  v_add_u32 v7, 157696, v7
  s_mov_b32 m0, 157696
  s_mov_b32 s38, 0
.g2_kernel_pa34:
  buffer_load_dword v6, s[4:7], s31 offen sc1 lds
  s_add_u32 s38, s38, 1
  s_waitcnt vmcnt(0)
  ds_read_b32 v8, v7
  s_waitcnt lgkmcnt(0)
  v_cmp_ge_u32 vcc, s62, v8
  s_cbranch_vccz .g2_kernel_pa34d
  s_mov_b64 exec, vcc
  s_sleep 32
  s_cmp_lt_u32 s38, 131072
  s_cbranch_scc1 .g2_kernel_pa34
.g2_kernel_pa34d:
  s_mov_b64 exec, -1
  s_lshl_b32 s28, s2, 10
  s_and_b32 s28, s28, 0xe000
  v_lshlrev_b32 v7, 7, v2
  buffer_load_dword v1, v7, s[64:67], s28 offen
.g2_kernel_v_5:
  s_mov_b32 s29, 1
  s_call_b64 s[68:69], .g2_kernel_v_cmb
  s_cmp_lg_u32 s16, 7
  s_cbranch_scc1 .g2_kernel_v_7
  s_and_b32 s33, s16, 3
  s_lshl_b32 s33, s33, 7
  s_lshl_b32 s28, s29, 2
  s_add_u32 s33, s33, s28
  s_add_u32 s31, s19, s33
  v_mov_b32 v6, s70
  s_mov_b64 exec, 1
  buffer_store_dword v6, v4, s[4:7], s31 offen offset:0 sc1
  s_mov_b64 exec, -1
.g2_kernel_v_7:
  s_cmp_lg_u32 s16, 4
  s_cbranch_scc1 .g2_kernel_v_8
  s_waitcnt vmcnt(2)
  v_mov_b32 v6, s71
  s_mov_b32 s38, 0
.g2_kernel_wg35:
  ds_read_b32 v7, v6 offset:76
  s_add_u32 s38, s38, 1
  s_waitcnt lgkmcnt(0)
  v_cmp_gt_u32 vcc, 1, v7
  s_cbranch_vccz .g2_kernel_wg35d
  s_sleep 1
  s_cmp_lt_u32 s38, 524288
  s_cbranch_scc1 .g2_kernel_wg35
.g2_kernel_wg35d:
  v_mov_b32 v6, s71
  s_mov_b32 s38, 0
.g2_kernel_wg36:
  ds_read_b32 v7, v6 offset:72
  s_add_u32 s38, s38, 1
  s_waitcnt lgkmcnt(0)
  v_cmp_gt_u32 vcc, 1, v7
  s_cbranch_vccz .g2_kernel_wg36d
  s_sleep 1
  s_cmp_lt_u32 s38, 524288
  s_cbranch_scc1 .g2_kernel_wg36
.g2_kernel_wg36d:
  v_mov_b32 v6, s71
  s_mov_b32 s38, 0
.g2_kernel_wg37:
  ds_read_b32 v7, v6 offset:68
  s_add_u32 s38, s38, 1
  s_waitcnt lgkmcnt(0)
  v_cmp_gt_u32 vcc, 1, v7
  s_cbranch_vccz .g2_kernel_wg37d
  s_sleep 1
  s_cmp_lt_u32 s38, 524288
  s_cbranch_scc1 .g2_kernel_wg37
.g2_kernel_wg37d:
  ds_write_b128 v3, v[64:67] offset:16384
  ds_write_b128 v3, v[68:71] offset:17408
  ds_write_b128 v3, v[72:75] offset:18432
  ds_write_b128 v3, v[76:79] offset:19456
  ds_write_b128 v3, v[80:83] offset:20480
  ds_write_b128 v3, v[84:87] offset:21504
  ds_write_b128 v3, v[88:91] offset:22528
  ds_write_b128 v3, v[92:95] offset:23552
  ds_write_b128 v3, v[96:99] offset:24576
  ds_write_b128 v3, v[100:103] offset:25600
  ds_write_b128 v3, v[104:107] offset:26624
  ds_write_b128 v3, v[108:111] offset:27648
  ds_write_b128 v3, v[112:115] offset:28672
  ds_write_b128 v3, v[116:119] offset:29696
  ds_write_b128 v3, v[120:123] offset:30720
  ds_write_b128 v3, v[124:127] offset:31744
  s_cmp_lg_u32 s62, 0
  s_cbranch_scc1 .g2_kernel_v_9
  s_call_b64 s[68:69], .g2_kernel_v_w23
.g2_kernel_v_9:
  v_mov_b32 v8, 4
  ds_write_b32 v6, v8 offset:12
.g2_kernel_v_8:
  s_cmp_eq_u32 s16, 5
  s_cbranch_scc1 .g2_kernel_c1
  s_cmp_lg_u32 s16, 4
  s_cbranch_scc1 .g2_kernel_c2
  s_cmp_lg_u32 s62, 0
  s_cbranch_scc1 .g2_kernel_fin1
  s_setprio 3
  s_mov_b32 s12, s42
  s_mov_b32 s13, s43
  s_mov_b32 s14, 0x600000
  s_mov_b32 s15, 0x00020000
  v_lshrrev_b32 v28, 3, v2
  v_and_b32 v29, 7, v2
  v_bfe_u32 v30, v2, 4, 1
  v_lshlrev_b32 v30, 1, v30
  v_xor_b32 v31, v29, v30
  v_lshlrev_b32 v31, 4, v31
  v_mul_u32_u24 v28, 6144, v28
  v_add_u32 v28, v28, v31
  v_xor_b32 v29, 64, v28
  v_lshlrev_b32 v9, 2, v2
  v_and_b32 v9, 12, v9
  v_add_u32 v9, 156416, v9
  v_add_u32 v48, 0, v28
  v_add_u32 v49, 48128, v29
  v_add_u32 v50, 96256, v28
  v_add_u32 v51, 144384, v29
  v_add_u32 v52, 2048, v28
  v_add_u32 v53, 50176, v29
  v_add_u32 v54, 98304, v28
  v_add_u32 v55, 146432, v29
  v_add_u32 v56, 4096, v29
  v_add_u32 v57, 52224, v28
  v_add_u32 v58, 100352, v29
  v_add_u32 v59, 148480, v28
  v_and_b32 v11, 15, v2
  v_xor_b32 v11, s18, v11
  v_and_b32 v12, 48, v2
  v_add_u32 v11, v11, v12
  v_lshlrev_b32 v11, 2, v11
  v_add_u32 v11, 158208, v11
  s_lshl_b32 s39, s18, 7
  s_lshl_b32 s32, s17, 18
  s_add_u32 s32, s32, 0xc00000
  s_mov_b32 s30, 0
  s_mov_b32 s29, 0
  s_mov_b32 s37, 0
  v_mov_b32 v6, s71
  s_mov_b32 s38, 0
.g2_kernel_wg38:
  ds_read_b32 v7, v6 offset:16
  s_add_u32 s38, s38, 1
  s_waitcnt lgkmcnt(0)
  v_cmp_gt_u32 vcc, 4, v7
  s_cbranch_vccz .g2_kernel_wg38d
  s_sleep 2
  s_cmp_lt_u32 s38, 524288
  s_cbranch_scc1 .g2_kernel_wg38
.g2_kernel_wg38d:
  s_xor_b32 s36, s18, 0
  s_mul_i32 s36, s36, 393216
  s_add_u32 s36, s36, s39
  s_add_u32 m0, s30, 65536
  s_waitcnt vmcnt(63)
  buffer_load_dwordx4 v48, s[12:15], s36 offen offset:0 lds
  buffer_load_dwordx4 v49, s[12:15], s36 offen offset:1024 lds
  buffer_load_dwordx4 v50, s[12:15], s36 offen offset:2048 lds
  buffer_load_dwordx4 v51, s[12:15], s36 offen offset:3072 lds
  s_add_u32 m0, s30, 69632
  s_waitcnt vmcnt(63)
  buffer_load_dwordx4 v52, s[12:15], s36 offen offset:0 lds
  buffer_load_dwordx4 v53, s[12:15], s36 offen offset:1024 lds
  buffer_load_dwordx4 v54, s[12:15], s36 offen offset:2048 lds
  buffer_load_dwordx4 v55, s[12:15], s36 offen offset:3072 lds
  s_add_u32 m0, s30, 73728
  s_waitcnt vmcnt(63)
  buffer_load_dwordx4 v56, s[12:15], s36 offen offset:0 lds
  buffer_load_dwordx4 v57, s[12:15], s36 offen offset:1024 lds
  buffer_load_dwordx4 v58, s[12:15], s36 offen offset:2048 lds
  buffer_load_dwordx4 v59, s[12:15], s36 offen offset:3072 lds
  s_add_u32 s30, s30, 12288
  s_cmp_eq_u32 s30, 86016
  s_cselect_b32 s30, 0, s30
  s_xor_b32 s36, s18, 0
  s_mul_i32 s36, s36, 393216
  s_add_u32 s36, s36, s39
  s_add_u32 s36, s36, 196608
  s_add_u32 m0, s30, 65536
  s_waitcnt vmcnt(63)
  buffer_load_dwordx4 v48, s[12:15], s36 offen offset:0 lds
  buffer_load_dwordx4 v49, s[12:15], s36 offen offset:1024 lds
  buffer_load_dwordx4 v50, s[12:15], s36 offen offset:2048 lds
  buffer_load_dwordx4 v51, s[12:15], s36 offen offset:3072 lds
  s_add_u32 m0, s30, 69632
  s_waitcnt vmcnt(63)
  buffer_load_dwordx4 v52, s[12:15], s36 offen offset:0 lds
  buffer_load_dwordx4 v53, s[12:15], s36 offen offset:1024 lds
  buffer_load_dwordx4 v54, s[12:15], s36 offen offset:2048 lds
  buffer_load_dwordx4 v55, s[12:15], s36 offen offset:3072 lds
  s_add_u32 m0, s30, 73728
  s_waitcnt vmcnt(63)
  buffer_load_dwordx4 v56, s[12:15], s36 offen offset:0 lds
  buffer_load_dwordx4 v57, s[12:15], s36 offen offset:1024 lds
  buffer_load_dwordx4 v58, s[12:15], s36 offen offset:2048 lds
  buffer_load_dwordx4 v59, s[12:15], s36 offen offset:3072 lds
  s_add_u32 s30, s30, 12288
  s_cmp_eq_u32 s30, 86016
  s_cselect_b32 s30, 0, s30
  s_mov_b32 m0, 156160
  s_mov_b32 s35, .g2_kernel_tab-.g2_kernel_pc+136
  s_mov_b64 exec, 1
  buffer_load_dword off, s[64:67], s35 lds
  s_mov_b64 exec, -1
  s_xor_b32 s36, s18, 1
  s_mul_i32 s36, s36, 393216
  s_add_u32 s36, s36, s39
  s_add_u32 m0, s30, 65536
  s_waitcnt vmcnt(63)
  buffer_load_dwordx4 v48, s[12:15], s36 offen offset:0 lds
  buffer_load_dwordx4 v49, s[12:15], s36 offen offset:1024 lds
  buffer_load_dwordx4 v50, s[12:15], s36 offen offset:2048 lds
  buffer_load_dwordx4 v51, s[12:15], s36 offen offset:3072 lds
  s_add_u32 m0, s30, 69632
  s_waitcnt vmcnt(63)
  buffer_load_dwordx4 v52, s[12:15], s36 offen offset:0 lds
  buffer_load_dwordx4 v53, s[12:15], s36 offen offset:1024 lds
  buffer_load_dwordx4 v54, s[12:15], s36 offen offset:2048 lds
  buffer_load_dwordx4 v55, s[12:15], s36 offen offset:3072 lds
  s_add_u32 m0, s30, 73728
  s_waitcnt vmcnt(63)
  buffer_load_dwordx4 v56, s[12:15], s36 offen offset:0 lds
  buffer_load_dwordx4 v57, s[12:15], s36 offen offset:1024 lds
  buffer_load_dwordx4 v58, s[12:15], s36 offen offset:2048 lds
  buffer_load_dwordx4 v59, s[12:15], s36 offen offset:3072 lds
  s_add_u32 s30, s30, 12288
  s_cmp_eq_u32 s30, 86016
  s_cselect_b32 s30, 0, s30
  s_xor_b32 s36, s18, 1
  s_mul_i32 s36, s36, 393216
  s_add_u32 s36, s36, s39
  s_add_u32 s36, s36, 196608
  s_add_u32 m0, s30, 65536
  s_waitcnt vmcnt(63)
  buffer_load_dwordx4 v48, s[12:15], s36 offen offset:0 lds
  buffer_load_dwordx4 v49, s[12:15], s36 offen offset:1024 lds
  buffer_load_dwordx4 v50, s[12:15], s36 offen offset:2048 lds
  buffer_load_dwordx4 v51, s[12:15], s36 offen offset:3072 lds
  s_add_u32 m0, s30, 69632
  s_waitcnt vmcnt(63)
  buffer_load_dwordx4 v52, s[12:15], s36 offen offset:0 lds
  buffer_load_dwordx4 v53, s[12:15], s36 offen offset:1024 lds
  buffer_load_dwordx4 v54, s[12:15], s36 offen offset:2048 lds
  buffer_load_dwordx4 v55, s[12:15], s36 offen offset:3072 lds
  s_add_u32 m0, s30, 73728
  s_waitcnt vmcnt(63)
  buffer_load_dwordx4 v56, s[12:15], s36 offen offset:0 lds
  buffer_load_dwordx4 v57, s[12:15], s36 offen offset:1024 lds
  buffer_load_dwordx4 v58, s[12:15], s36 offen offset:2048 lds
  buffer_load_dwordx4 v59, s[12:15], s36 offen offset:3072 lds
  s_add_u32 s30, s30, 12288
  s_cmp_eq_u32 s30, 86016
  s_cselect_b32 s30, 0, s30
  s_xor_b32 s36, s18, 2
  s_mul_i32 s36, s36, 393216
  s_add_u32 s36, s36, s39
  s_add_u32 m0, s30, 65536
  s_waitcnt vmcnt(63)
  buffer_load_dwordx4 v48, s[12:15], s36 offen offset:0 lds
  buffer_load_dwordx4 v49, s[12:15], s36 offen offset:1024 lds
  buffer_load_dwordx4 v50, s[12:15], s36 offen offset:2048 lds
  buffer_load_dwordx4 v51, s[12:15], s36 offen offset:3072 lds
  s_add_u32 m0, s30, 69632
  s_waitcnt vmcnt(63)
  buffer_load_dwordx4 v52, s[12:15], s36 offen offset:0 lds
  buffer_load_dwordx4 v53, s[12:15], s36 offen offset:1024 lds
  buffer_load_dwordx4 v54, s[12:15], s36 offen offset:2048 lds
  buffer_load_dwordx4 v55, s[12:15], s36 offen offset:3072 lds
  s_add_u32 m0, s30, 73728
  s_waitcnt vmcnt(63)
  buffer_load_dwordx4 v56, s[12:15], s36 offen offset:0 lds
  buffer_load_dwordx4 v57, s[12:15], s36 offen offset:1024 lds
  buffer_load_dwordx4 v58, s[12:15], s36 offen offset:2048 lds
  buffer_load_dwordx4 v59, s[12:15], s36 offen offset:3072 lds
  s_add_u32 s30, s30, 12288
  s_cmp_eq_u32 s30, 86016
  s_cselect_b32 s30, 0, s30
  v_mov_b32 v6, s71
  s_mov_b32 s38, 0
.g2_kernel_wg39:
  ds_read_b32 v7, v6 offset:20
  s_add_u32 s38, s38, 1
  s_waitcnt lgkmcnt(0)
  v_cmp_gt_u32 vcc, 4, v7
  s_cbranch_vccz .g2_kernel_wg39d
  s_sleep 1
  s_cmp_lt_u32 s38, 524288
  s_cbranch_scc1 .g2_kernel_wg39
.g2_kernel_wg39d:
  s_mov_b32 s62, 1
  s_mov_b32 s63, 0x1800000
  s_mov_b32 s70, 2
  s_mov_b32 s71, 155776
  s_xor_b32 s36, s18, 2
  s_mul_i32 s36, s36, 393216
  s_add_u32 s36, s36, s39
  s_add_u32 s36, s36, 196608
  s_add_u32 m0, s30, 65536
  s_waitcnt vmcnt(63)
  buffer_load_dwordx4 v48, s[12:15], s36 offen offset:0 lds
  buffer_load_dwordx4 v49, s[12:15], s36 offen offset:1024 lds
  buffer_load_dwordx4 v50, s[12:15], s36 offen offset:2048 lds
  buffer_load_dwordx4 v51, s[12:15], s36 offen offset:3072 lds
  s_add_u32 m0, s30, 69632
  s_waitcnt vmcnt(63)
  buffer_load_dwordx4 v52, s[12:15], s36 offen offset:0 lds
  buffer_load_dwordx4 v53, s[12:15], s36 offen offset:1024 lds
  buffer_load_dwordx4 v54, s[12:15], s36 offen offset:2048 lds
  buffer_load_dwordx4 v55, s[12:15], s36 offen offset:3072 lds
  s_add_u32 m0, s30, 73728
  s_waitcnt vmcnt(63)
  buffer_load_dwordx4 v56, s[12:15], s36 offen offset:0 lds
  buffer_load_dwordx4 v57, s[12:15], s36 offen offset:1024 lds
  buffer_load_dwordx4 v58, s[12:15], s36 offen offset:2048 lds
  buffer_load_dwordx4 v59, s[12:15], s36 offen offset:3072 lds
  s_add_u32 s30, s30, 12288
  s_cmp_eq_u32 s30, 86016
  s_cselect_b32 s30, 0, s30
  s_xor_b32 s36, s18, 3
  s_mul_i32 s36, s36, 393216
  s_add_u32 s36, s36, s39
  s_add_u32 m0, s30, 65536
  s_waitcnt vmcnt(63)
  buffer_load_dwordx4 v48, s[12:15], s36 offen offset:0 lds
  buffer_load_dwordx4 v49, s[12:15], s36 offen offset:1024 lds
  buffer_load_dwordx4 v50, s[12:15], s36 offen offset:2048 lds
  buffer_load_dwordx4 v51, s[12:15], s36 offen offset:3072 lds
  s_add_u32 m0, s30, 69632
  s_waitcnt vmcnt(63)
  buffer_load_dwordx4 v52, s[12:15], s36 offen offset:0 lds
  buffer_load_dwordx4 v53, s[12:15], s36 offen offset:1024 lds
  buffer_load_dwordx4 v54, s[12:15], s36 offen offset:2048 lds
  buffer_load_dwordx4 v55, s[12:15], s36 offen offset:3072 lds
  s_add_u32 m0, s30, 73728
  s_waitcnt vmcnt(63)
  buffer_load_dwordx4 v56, s[12:15], s36 offen offset:0 lds
  buffer_load_dwordx4 v57, s[12:15], s36 offen offset:1024 lds
  buffer_load_dwordx4 v58, s[12:15], s36 offen offset:2048 lds
  buffer_load_dwordx4 v59, s[12:15], s36 offen offset:3072 lds
  s_add_u32 s30, s30, 12288
  s_cmp_eq_u32 s30, 86016
  s_cselect_b32 s30, 0, s30
  s_mov_b32 s28, 1
  s_mov_b32 s29, 16384
  s_bitcmp1_b32 s37, s28
  s_cbranch_scc0 .g2_kernel_p2_x0w
.g2_kernel_p2_x0b:
  s_xor_b32 s33, s28, s18
  s_lshl_b32 s33, s33, 14
  s_add_u32 s33, s33, s32
  s_add_u32 m0, s29, 0
  s_waitcnt vmcnt(63)
  buffer_load_dwordx4 v3, s[4:7], s33 offen offset:0 lds
  buffer_load_dwordx4 v3, s[4:7], s33 offen offset:1024 lds
  buffer_load_dwordx4 v3, s[4:7], s33 offen offset:2048 lds
  buffer_load_dwordx4 v3, s[4:7], s33 offen offset:3072 lds
  s_add_u32 m0, s29, 4096
  s_waitcnt vmcnt(63)
  s_add_u32 s33, s33, 4096
  buffer_load_dwordx4 v3, s[4:7], s33 offen offset:0 lds
  buffer_load_dwordx4 v3, s[4:7], s33 offen offset:1024 lds
  buffer_load_dwordx4 v3, s[4:7], s33 offen offset:2048 lds
  buffer_load_dwordx4 v3, s[4:7], s33 offen offset:3072 lds
  s_add_u32 m0, s29, 8192
  s_waitcnt vmcnt(63)
  s_add_u32 s33, s33, 4096
  buffer_load_dwordx4 v3, s[4:7], s33 offen offset:0 lds
  buffer_load_dwordx4 v3, s[4:7], s33 offen offset:1024 lds
  buffer_load_dwordx4 v3, s[4:7], s33 offen offset:2048 lds
  buffer_load_dwordx4 v3, s[4:7], s33 offen offset:3072 lds
  s_add_u32 m0, s29, 12288
  s_waitcnt vmcnt(63)
  s_add_u32 s33, s33, 4096
  buffer_load_dwordx4 v3, s[4:7], s33 offen offset:0 lds
  buffer_load_dwordx4 v3, s[4:7], s33 offen offset:1024 lds
  buffer_load_dwordx4 v3, s[4:7], s33 offen offset:2048 lds
  buffer_load_dwordx4 v3, s[4:7], s33 offen offset:3072 lds
  s_mov_b32 m0, 156160
  s_mov_b32 s35, .g2_kernel_tab-.g2_kernel_pc+144
  s_mov_b64 exec, 1
  buffer_load_dword off, s[64:67], s35 lds
  s_mov_b64 exec, -1
  s_mov_b32 s28, 2
  s_mov_b32 s29, 32768
  s_bitcmp1_b32 s37, s28
  s_cbranch_scc0 .g2_kernel_p2_x1w
.g2_kernel_p2_x1b:
  s_xor_b32 s33, s28, s18
  s_lshl_b32 s33, s33, 14
  s_add_u32 s33, s33, s32
  s_add_u32 m0, s29, 0
  s_waitcnt vmcnt(63)
  buffer_load_dwordx4 v3, s[4:7], s33 offen offset:0 lds
  buffer_load_dwordx4 v3, s[4:7], s33 offen offset:1024 lds
  buffer_load_dwordx4 v3, s[4:7], s33 offen offset:2048 lds
  buffer_load_dwordx4 v3, s[4:7], s33 offen offset:3072 lds
  s_add_u32 m0, s29, 4096
  s_waitcnt vmcnt(63)
  s_add_u32 s33, s33, 4096
  buffer_load_dwordx4 v3, s[4:7], s33 offen offset:0 lds
  buffer_load_dwordx4 v3, s[4:7], s33 offen offset:1024 lds
  buffer_load_dwordx4 v3, s[4:7], s33 offen offset:2048 lds
  buffer_load_dwordx4 v3, s[4:7], s33 offen offset:3072 lds
  s_add_u32 m0, s29, 8192
  s_waitcnt vmcnt(63)
  s_add_u32 s33, s33, 4096
  buffer_load_dwordx4 v3, s[4:7], s33 offen offset:0 lds
  buffer_load_dwordx4 v3, s[4:7], s33 offen offset:1024 lds
  buffer_load_dwordx4 v3, s[4:7], s33 offen offset:2048 lds
  buffer_load_dwordx4 v3, s[4:7], s33 offen offset:3072 lds
  s_add_u32 m0, s29, 12288
  s_waitcnt vmcnt(63)
  s_add_u32 s33, s33, 4096
  buffer_load_dwordx4 v3, s[4:7], s33 offen offset:0 lds
  buffer_load_dwordx4 v3, s[4:7], s33 offen offset:1024 lds
  buffer_load_dwordx4 v3, s[4:7], s33 offen offset:2048 lds
  buffer_load_dwordx4 v3, s[4:7], s33 offen offset:3072 lds
  s_mov_b32 m0, 156160
  s_mov_b32 s35, .g2_kernel_tab-.g2_kernel_pc+152
  s_mov_b64 exec, 1
  buffer_load_dword off, s[64:67], s35 lds
  s_mov_b64 exec, -1
  s_mov_b32 s28, 3
  s_mov_b32 s29, 49152
  s_bitcmp1_b32 s37, s28
  s_cbranch_scc0 .g2_kernel_p2_x2w
.g2_kernel_p2_x2b:
  s_xor_b32 s33, s28, s18
  s_lshl_b32 s33, s33, 14
  s_add_u32 s33, s33, s32
  s_add_u32 m0, s29, 0
  s_waitcnt vmcnt(63)
  buffer_load_dwordx4 v3, s[4:7], s33 offen offset:0 lds
  buffer_load_dwordx4 v3, s[4:7], s33 offen offset:1024 lds
  buffer_load_dwordx4 v3, s[4:7], s33 offen offset:2048 lds
  buffer_load_dwordx4 v3, s[4:7], s33 offen offset:3072 lds
  s_add_u32 m0, s29, 4096
  s_waitcnt vmcnt(63)
  s_add_u32 s33, s33, 4096
  buffer_load_dwordx4 v3, s[4:7], s33 offen offset:0 lds
  buffer_load_dwordx4 v3, s[4:7], s33 offen offset:1024 lds
  buffer_load_dwordx4 v3, s[4:7], s33 offen offset:2048 lds
  buffer_load_dwordx4 v3, s[4:7], s33 offen offset:3072 lds
  s_add_u32 m0, s29, 8192
  s_waitcnt vmcnt(63)
  s_add_u32 s33, s33, 4096
  buffer_load_dwordx4 v3, s[4:7], s33 offen offset:0 lds
  buffer_load_dwordx4 v3, s[4:7], s33 offen offset:1024 lds
  buffer_load_dwordx4 v3, s[4:7], s33 offen offset:2048 lds
  buffer_load_dwordx4 v3, s[4:7], s33 offen offset:3072 lds
  s_add_u32 m0, s29, 12288
  s_waitcnt vmcnt(63)
  s_add_u32 s33, s33, 4096
  buffer_load_dwordx4 v3, s[4:7], s33 offen offset:0 lds
  buffer_load_dwordx4 v3, s[4:7], s33 offen offset:1024 lds
  buffer_load_dwordx4 v3, s[4:7], s33 offen offset:2048 lds
  buffer_load_dwordx4 v3, s[4:7], s33 offen offset:3072 lds
  s_mov_b32 m0, 156160
  s_mov_b32 s35, .g2_kernel_tab-.g2_kernel_pc+156
  s_mov_b64 exec, 1
  buffer_load_dword off, s[64:67], s35 lds
  s_mov_b64 exec, -1
  s_xor_b32 s36, s18, 3
  s_mul_i32 s36, s36, 393216
  s_add_u32 s36, s36, s39
  s_add_u32 s36, s36, 196608
  ds_read_b32 v10, v9
  s_mov_b32 s34, 33
  s_mov_b32 s35, .g2_kernel_tab-.g2_kernel_pc+160
  s_branch .g2_kernel_p2_o
  .p2align 6
.g2_kernel_p2_l:
  s_waitcnt lgkmcnt(0)
  v_cmp_gt_i32 vcc, s34, v10
  s_cbranch_vccnz .g2_kernel_p2_aw
.g2_kernel_p2_ai:
  s_add_u32 s29, s29, 16384
  s_and_b32 s29, s29, 0xffff
  s_bitcmp1_b32 s37, s28
  s_cbranch_scc0 .g2_kernel_p2_x3w
.g2_kernel_p2_x3b:
  s_xor_b32 s33, s28, s18
  s_lshl_b32 s33, s33, 14
  s_add_u32 s33, s33, s32
  s_add_u32 m0, s29, 0
  s_waitcnt vmcnt(63)
  buffer_load_dwordx4 v3, s[4:7], s33 offen offset:0 lds
  buffer_load_dwordx4 v3, s[4:7], s33 offen offset:1024 lds
  buffer_load_dwordx4 v3, s[4:7], s33 offen offset:2048 lds
  buffer_load_dwordx4 v3, s[4:7], s33 offen offset:3072 lds
  s_add_u32 m0, s29, 4096
  s_waitcnt vmcnt(63)
  s_add_u32 s33, s33, 4096
  buffer_load_dwordx4 v3, s[4:7], s33 offen offset:0 lds
  buffer_load_dwordx4 v3, s[4:7], s33 offen offset:1024 lds
  buffer_load_dwordx4 v3, s[4:7], s33 offen offset:2048 lds
  buffer_load_dwordx4 v3, s[4:7], s33 offen offset:3072 lds
  s_add_u32 m0, s29, 8192
  s_waitcnt vmcnt(63)
  s_add_u32 s33, s33, 4096
  buffer_load_dwordx4 v3, s[4:7], s33 offen offset:0 lds
  buffer_load_dwordx4 v3, s[4:7], s33 offen offset:1024 lds
  buffer_load_dwordx4 v3, s[4:7], s33 offen offset:2048 lds
  buffer_load_dwordx4 v3, s[4:7], s33 offen offset:3072 lds
  s_add_u32 m0, s29, 12288
  s_waitcnt vmcnt(63)
  s_add_u32 s33, s33, 4096
  buffer_load_dwordx4 v3, s[4:7], s33 offen offset:0 lds
  buffer_load_dwordx4 v3, s[4:7], s33 offen offset:1024 lds
  buffer_load_dwordx4 v3, s[4:7], s33 offen offset:2048 lds
  buffer_load_dwordx4 v3, s[4:7], s33 offen offset:3072 lds
  s_add_u32 m0, s30, 65536
  s_waitcnt vmcnt(63)
  buffer_load_dwordx4 v48, s[12:15], s36 offen offset:0 lds
  buffer_load_dwordx4 v49, s[12:15], s36 offen offset:1024 lds
  buffer_load_dwordx4 v50, s[12:15], s36 offen offset:2048 lds
  buffer_load_dwordx4 v51, s[12:15], s36 offen offset:3072 lds
  s_add_u32 m0, s30, 69632
  s_waitcnt vmcnt(63)
  buffer_load_dwordx4 v52, s[12:15], s36 offen offset:0 lds
  buffer_load_dwordx4 v53, s[12:15], s36 offen offset:1024 lds
  buffer_load_dwordx4 v54, s[12:15], s36 offen offset:2048 lds
  buffer_load_dwordx4 v55, s[12:15], s36 offen offset:3072 lds
  s_add_u32 m0, s30, 73728
  s_waitcnt vmcnt(63)
  buffer_load_dwordx4 v56, s[12:15], s36 offen offset:0 lds
  buffer_load_dwordx4 v57, s[12:15], s36 offen offset:1024 lds
  buffer_load_dwordx4 v58, s[12:15], s36 offen offset:2048 lds
  buffer_load_dwordx4 v59, s[12:15], s36 offen offset:3072 lds
  s_add_u32 s30, s30, 12288
  s_cmp_eq_u32 s30, 86016
  s_cselect_b32 s30, 0, s30
  ds_read_b32 v10, v9
  s_mov_b32 m0, 156160
  s_add_u32 s34, s34, 1
  s_mov_b64 exec, 1
  buffer_load_dword off, s[64:67], s35 lds
  s_mov_b64 exec, -1
  s_add_u32 s35, s35, 4
  s_add_u32 s36, s36, 196608
.g2_kernel_p2_o:
  s_waitcnt lgkmcnt(0)
  v_cmp_gt_i32 vcc, s34, v10
  s_cbranch_vccnz .g2_kernel_p2_bw
.g2_kernel_p2_bi:
  s_add_u32 m0, s30, 65536
  s_waitcnt vmcnt(63)
  buffer_load_dwordx4 v48, s[12:15], s36 offen offset:0 lds
  buffer_load_dwordx4 v49, s[12:15], s36 offen offset:1024 lds
  buffer_load_dwordx4 v50, s[12:15], s36 offen offset:2048 lds
  buffer_load_dwordx4 v51, s[12:15], s36 offen offset:3072 lds
  s_add_u32 m0, s30, 69632
  s_waitcnt vmcnt(63)
  buffer_load_dwordx4 v52, s[12:15], s36 offen offset:0 lds
  buffer_load_dwordx4 v53, s[12:15], s36 offen offset:1024 lds
  buffer_load_dwordx4 v54, s[12:15], s36 offen offset:2048 lds
  buffer_load_dwordx4 v55, s[12:15], s36 offen offset:3072 lds
  s_add_u32 m0, s30, 73728
  s_waitcnt vmcnt(63)
  buffer_load_dwordx4 v56, s[12:15], s36 offen offset:0 lds
  buffer_load_dwordx4 v57, s[12:15], s36 offen offset:1024 lds
  buffer_load_dwordx4 v58, s[12:15], s36 offen offset:2048 lds
  buffer_load_dwordx4 v59, s[12:15], s36 offen offset:3072 lds
  s_add_u32 s30, s30, 12288
  s_cmp_eq_u32 s30, 86016
  s_cselect_b32 s30, 0, s30
  ds_read_b32 v10, v9
  s_mov_b32 m0, 156160
  s_add_u32 s34, s34, 1
  s_mov_b64 exec, 1
  buffer_load_dword off, s[64:67], s35 lds
  s_mov_b64 exec, -1
  s_add_u32 s35, s35, 4
  s_add_u32 s28, s28, 1
  s_xor_b32 s36, s18, s28
  s_mul_i32 s36, s36, 393216
  s_add_u32 s36, s36, s39
  s_cmp_lt_i32 s34, 58
  s_cbranch_scc1 .g2_kernel_p2_l
  s_branch .g2_kernel_v
.g2_kernel_c1:
  v_mov_b32 v6, s71
  s_mov_b32 s38, 0
.g2_kernel_wg40:
  ds_read_b32 v7, v6 offset:76
  s_add_u32 s38, s38, 1
  s_waitcnt lgkmcnt(0)
  v_cmp_gt_u32 vcc, 1, v7
  s_cbranch_vccz .g2_kernel_wg40d
  s_sleep 1
  s_cmp_lt_u32 s38, 524288
  s_cbranch_scc1 .g2_kernel_wg40
.g2_kernel_wg40d:
  s_sleep 4
  s_and_b32 s31, s19, 0xffffe000
  s_add_u32 s31, s31, 4
  v_and_b32 v6, 15, v2
  v_lshlrev_b32 v6, 9, v6
  v_lshrrev_b32 v7, 4, v2
  v_lshl_add_u32 v6, v7, 7, v6
  v_lshlrev_b32 v7, 2, v2
  v_add_u32 v7, 157952, v7
  s_mov_b32 m0, 157952
  s_mov_b32 s38, 0
  s_bfm_b64 exec, 16, 48
.g2_kernel_pa41:
  buffer_load_dword v6, s[4:7], s31 offen sc1 lds
  s_add_u32 s38, s38, 1
  s_waitcnt vmcnt(0)
  ds_read_b32 v8, v7
  s_waitcnt lgkmcnt(0)
  v_cmp_ge_u32 vcc, s62, v8
  s_cbranch_vccz .g2_kernel_pa41d
  s_mov_b64 exec, vcc
  s_sleep 4
  s_cmp_lt_u32 s38, 131072
  s_cbranch_scc1 .g2_kernel_pa41
.g2_kernel_pa41d:
  s_mov_b64 exec, -1
  s_setprio 2
  s_mov_b32 s39, 0
  s_lshl_b32 s30, s17, 2
  s_lshr_b32 s28, s18, 2
  s_add_u32 s30, s30, s28
  s_lshl_b32 s20, s30, 13
  s_add_u32 s20, s20, s63
  s_add_u32 s20, s20, 0x1000000
  s_add_u32 s24, s20, 4096
  s_lshl_b32 s21, s30, 8
  s_add_u32 s21, s21, s63
  s_add_u32 s21, s21, 0x1080000
  s_lshl_b32 s23, s62, 16
  s_add_u32 s23, s23, 0x3040000
  s_lshl_b32 s22, s30, 7
  s_add_u32 s22, s22, s23
  s_and_b32 s28, s2, 7
  s_lshl_b32 s28, s28, 13
  s_add_u32 s23, s23, s28
  v_mov_b32 v9, 155648
  ds_read_b32 v26, v9 offset:256
  v_and_b32 v24, 31, v2
  v_lshlrev_b32 v25, 3, v2
  v_lshlrev_b32 v27, 13, v2
  v_mov_b32 v28, 0.0009765625
  v_mov_b32 v30, 1e-05
  v_mov_b32 v6, s71
  s_mov_b32 s38, 0
.g2_kernel_wg43:
  ds_read_b32 v7, v6 offset:20
  s_add_u32 s38, s38, 1
  s_waitcnt lgkmcnt(0)
  v_cmp_gt_u32 vcc, 4, v7
  s_cbranch_vccz .g2_kernel_wg43d
  s_sleep 1
  s_cmp_lt_u32 s38, 524288
  s_cbranch_scc1 .g2_kernel_wg43
.g2_kernel_wg43d:
  s_sleep 12
  s_cmp_lg_u32 s62, 0
  s_cbranch_scc1 .g2_kernel_nap44
  s_sleep 12
.g2_kernel_nap44:
  s_xor_b32 s28, s17, s18
  s_and_b32 s28, s28, 3
  s_cbranch_scc1 .g2_kernel_c_l1
  s_mov_b32 s38, 0
.g2_kernel_gx45:
  buffer_load_dwordx4 v[32:35], v3, s[4:7], s20 offen offset:0 sc1
  buffer_load_dwordx4 v[36:39], v3, s[4:7], s20 offen offset:1024 sc1
  buffer_load_dwordx4 v[40:43], v3, s[4:7], s20 offen offset:2048 sc1
  buffer_load_dwordx4 v[44:47], v3, s[4:7], s20 offen offset:3072 sc1
  buffer_load_dwordx4 v[48:51], v3, s[4:7], s24 offen offset:0 sc1
  buffer_load_dwordx4 v[52:55], v3, s[4:7], s24 offen offset:1024 sc1
  buffer_load_dwordx4 v[56:59], v3, s[4:7], s24 offen offset:2048 sc1
  buffer_load_dwordx4 v[60:63], v3, s[4:7], s24 offen offset:3072 sc1
  s_add_u32 s38, s38, 1
  s_waitcnt vmcnt(0)
  v_min3_u32 v6, v32, v35, v36
  v_min3_u32 v6, v6, v39, v40
  v_min3_u32 v6, v6, v43, v44
  v_min3_u32 v6, v6, v47, v48
  v_min3_u32 v6, v6, v51, v52
  v_min3_u32 v6, v6, v55, v56
  v_min3_u32 v6, v6, v59, v60
  v_min_u32 v6, v6, v63
  v_cmp_eq_u32 vcc, 0, v6
  s_cbranch_vccz .g2_kernel_gx45d
  s_mov_b64 exec, vcc
  s_sleep 1
  s_cmp_lg_u32 s62, 0
  s_cbranch_scc1 .g2_kernel_nap46
  s_sleep 9
.g2_kernel_nap46:
  s_cmp_lt_u32 s38, 131072
  s_cbranch_scc1 .g2_kernel_gx45
.g2_kernel_gx45d:
  s_mov_b64 exec, -1
  v_add_f32 v32, v32, v48
  v_add_f32 v33, v33, v49
  v_add_f32 v34, v34, v50
  v_add_f32 v36, v36, v52
  v_add_f32 v37, v37, v53
  v_add_f32 v38, v38, v54
  v_add_f32 v40, v40, v56
  v_add_f32 v41, v41, v57
  v_add_f32 v42, v42, v58
  v_add_f32 v44, v44, v60
  v_add_f32 v45, v45, v61
  v_add_f32 v46, v46, v62
  v_add_f32 v32, v32, v40
  v_add_f32 v33, v33, v41
  v_add_f32 v34, v34, v42
  v_add_f32 v36, v36, v44
  v_add_f32 v37, v37, v45
  v_add_f32 v38, v38, v46
  v_add_f32 v32, v32, v36
  v_add_f32 v33, v33, v37
  v_add_f32 v34, v34, v38
  v_mov_b32 v16, v32
  v_mov_b32 v17, v33
  v_mov_b32 v18, v34
  s_mov_b32 s28, -32
  v_permlane32_swap_b32 v16, v32
  v_permlane32_swap_b32 v17, v33
  v_permlane32_swap_b32 v18, v34
  v_add_f32 v16, v16, v32
  v_add_f32 v17, v17, v33
  v_add_f32 v18, v18, v34
  v_fma_f32 v18, -v16, v26, v18
  v_mul_f32 v16, v28, v16
  v_mul_f32 v19, v16, v16
  v_fma_f32 v17, v17, v28, -v19
  v_max_f32 v17, 0, v17
  v_add_f32 v17, v30, v17
  v_rsq_f32 v19, v17
  v_mov_b32 v11, 1
  v_mul_f32 v18, v18, v19
  v_and_or_b32 v10, v18, s28, v24
  s_nop 1
  v_max_f32 v10, v10, v10 row_ror:8 row_mask:0xf bank_mask:0xf
  s_nop 1
  v_max_f32 v10, v10, v10 row_ror:4 row_mask:0xf bank_mask:0xf
  s_nop 1
  v_max_f32 v10, v10, v10 row_ror:2 row_mask:0xf bank_mask:0xf
  s_nop 1
  v_max_f32 v10, v10, v10 row_ror:1 row_mask:0xf bank_mask:0xf
  s_nop 1
  v_max_f32 v10, v10, v10 row_bcast:15 row_mask:0xa bank_mask:0xf
  s_nop 0
  v_readlane_b32 s28, v10, 31
  s_nop 1
  v_mov_b32 v10, s28
  s_mov_b64 exec, 0xff
  buffer_store_dwordx2 v[10:11], v27, s[4:7], s22 offen sc1
  s_mov_b32 exec_lo, -1
  buffer_store_dwordx2 v[16:17], v25, s[4:7], s21 offen sc1
  s_mov_b64 exec, -1
.g2_kernel_c_l1:
  s_cmp_lg_u32 s62, 0
  s_cbranch_scc1 .g2_kernel_c_t3
  s_sleep 30
  s_mov_b64 s[8:9], -1
  s_call_b64 s[68:69], .g2_kernel_amax
  s_lshr_b32 s28, s77, 5
  s_add_u32 m0, s71, 104
  s_lshl_b32 s29, s28, 2
  s_add_u32 s29, s29, .g2_kernel_tab-.g2_kernel_pc
  s_mov_b64 exec, 1
  buffer_load_dword off, s[64:67], s29 lds
  s_mov_b64 exec, -1
  s_and_b32 s28, s77, 31
  s_add_u32 s28, s28, 1
  s_add_u32 m0, s71, 36
  s_lshl_b32 s29, s28, 2
  s_add_u32 s29, s29, .g2_kernel_tab-.g2_kernel_pc
  s_mov_b64 exec, 1
  buffer_load_dword off, s[64:67], s29 lds
  s_mov_b64 exec, -1
  s_lshr_b32 s24, s77, 7
  s_lshl_b32 s24, s24, 18
  s_bfe_u32 s28, s77, 0x30004
  s_lshl_b32 s28, s28, 11
  s_add_u32 s24, s24, s28
  s_and_b32 s28, s77, 15
  s_lshl_b32 s28, s28, 4
  s_add_u32 s24, s24, s28
  s_add_u32 s24, s24, s63
  s_add_u32 s24, s24, 0xc00000
  s_lshl_b32 s28, s17, 14
  s_add_u32 s24, s24, s28
  s_and_b32 s28, s18, 1
  s_lshl_b32 s28, s28, 8
  s_add_u32 s24, s24, s28
  v_lshrrev_b32 v12, 3, v2
  v_lshlrev_b32 v13, 1, v12
  buffer_load_ushort v56, v13, s[4:7], s24 offen offset:0
  buffer_load_ushort v57, v13, s[4:7], s24 offen offset:512
  buffer_load_ushort v58, v13, s[4:7], s24 offen offset:1024
  buffer_load_ushort v59, v13, s[4:7], s24 offen offset:1536
  s_lshl_b32 s25, s77, 3
  s_add_u32 s25, s25, s63
  s_add_u32 s25, s25, 0x1080000
  s_lshl_b32 s21, s17, 10
  s_add_u32 s21, s21, s63
  s_add_u32 s21, s21, 0x1080000
  s_mov_b32 s38, 0
.g2_kernel_gx47:
  buffer_load_dwordx4 v[16:19], v3, s[4:7], s21 offen sc1
  buffer_load_dwordx2 v[20:21], v4, s[4:7], s25 offen sc1
  s_add_u32 s38, s38, 1
  s_waitcnt vmcnt(0)
  v_min3_u32 v6, v17, v19, v21
  v_cmp_eq_u32 vcc, 0, v6
  s_cbranch_vccz .g2_kernel_gx47d
  s_mov_b64 exec, vcc
  s_sleep 1
  s_cmp_lt_u32 s38, 131072
  s_cbranch_scc1 .g2_kernel_gx47
.g2_kernel_gx47d:
  s_mov_b64 exec, -1
  s_lshr_b32 s28, s77, 7
  s_and_b32 s79, s77, 127
  s_add_u32 s79, s79, 1
  s_cmp_eq_u32 s28, s17
  s_cselect_b32 s79, s79, 0
  v_rsq_f32 v22, v17
  v_rsq_f32 v23, v19
  v_rsq_f32 v21, v21
  v_mov_b32 v62, -1.4426950408889634
  v_mul_f32 v62, s27, v62
  v_exp_f32 v62, v62
  v_lshlrev_b32 v14, 3, v2
  v_add_u32 v14, 155648, v14
  v_mov_b32 v15, s79
  v_add_f32 v52, 1.0, v22
  v_mul_f32 v54, v16, v22
  v_sub_f32 v54, 0, v54
  v_add_f32 v53, 1.0, v23
  v_mul_f32 v55, v18, v23
  v_sub_f32 v55, 0, v55
  v_add_f32 v62, 1.0, v62
  v_rcp_f32 v62, v62
  v_add_f32 v60, 1.0, v21
  v_mul_f32 v61, v20, v21
  v_sub_f32 v61, 0, v61
  v_sub_f32 v17, v17, v30
  v_mul_f32 v48, v52, v52
  v_fma_f32 v48, v48, v17, v30
  v_rsq_f32 v48, v48
  s_nop 0
  v_mul_f32 v48, v48, v52
  v_mul_f32 v50, v48, v16
  v_sub_f32 v50, 0, v50
  v_sub_f32 v19, v19, v30
  v_mul_f32 v49, v53, v53
  v_fma_f32 v49, v49, v19, v30
  v_rsq_f32 v49, v49
  s_nop 0
  v_mul_f32 v49, v49, v53
  v_mul_f32 v51, v49, v18
  v_sub_f32 v51, 0, v51
  v_lshlrev_b32 v56, 16, v56
  v_fma_f32 v56, v56, v60, v61
  v_lshlrev_b32 v57, 16, v57
  v_fma_f32 v57, v57, v60, v61
  v_lshlrev_b32 v58, 16, v58
  v_fma_f32 v58, v58, v60, v61
  v_lshlrev_b32 v59, 16, v59
  v_fma_f32 v59, v59, v60, v61
  v_and_b32 v10, 7, v2
  v_lshlrev_b32 v10, 12, v10
  v_lshl_add_u32 v10, v12, 4, v10
  s_lshl_b32 s20, s17, 1
  s_and_b32 s28, s18, 1
  s_add_u32 s20, s20, s28
  s_lshl_b32 s20, s20, 7
  s_add_u32 s20, s20, s63
  s_add_u32 s20, s20, 0x1090000
  s_and_b32 s26, s18, 14
  s_lshl_b32 s26, s26, 4
  s_add_u32 s26, s26, s17
  s_lshl_b32 s26, s26, 1
  s_and_b32 s28, s18, 1
  s_add_u32 s26, s26, s28
  s_lshl_b32 s26, s26, 10
  s_add_u32 s26, s26, s63
  s_add_u32 s26, s26, 0x1190000
  s_add_u32 s25, s26, 32768
  s_lshl_b32 s21, s2, 12
  s_add_u32 s21, s21, 0x3200000
  v_lshlrev_b32 v14, 3, v2
  buffer_store_dwordx2 v[48:49], v14, s[4:7], s21 offen
  buffer_store_dwordx2 v[50:51], v14, s[4:7], s21 offen offset:512
  buffer_store_dwordx2 v[52:53], v14, s[4:7], s21 offen offset:1024
  buffer_store_dwordx2 v[54:55], v14, s[4:7], s21 offen offset:1536
  buffer_store_dword v15, v4, s[4:7], s21 offen offset:2048
  s_mov_b32 m0, 158464
  s_add_u32 s22, s21, 2048
  s_waitcnt vmcnt(0)
  buffer_load_dwordx4 v3, s[4:7], s21 offen lds
  buffer_load_dwordx4 v3, s[4:7], s21 offen offset:1024 lds
  s_mov_b32 m0, 155800
  s_mov_b64 exec, 1
  buffer_load_dword v4, s[4:7], s22 offen lds
  s_mov_b64 exec, -1
  s_add_u32 m0, s71, 128
  s_mov_b32 s29, .g2_kernel_tab-.g2_kernel_pc+8
  s_mov_b64 exec, 1
  buffer_load_dword off, s[64:67], s29 lds
  s_mov_b64 exec, -1
  s_lshl_b32 s28, s2, 10
  s_and_b32 s28, s28, 0xe000
  v_lshlrev_b32 v7, 7, v2
  buffer_load_dword v1, v7, s[64:67], s28 offen
  v_mov_b32 v6, s71
  s_mov_b32 s38, 0
.g2_kernel_wg48:
  ds_read_b32 v7, v6 offset:112
  s_add_u32 s38, s38, 1
  s_waitcnt lgkmcnt(0)
  v_cmp_gt_u32 vcc, 1, v7
  s_cbranch_vccz .g2_kernel_wg48d
  s_sleep 2
  s_cmp_lt_u32 s38, 524288
  s_cbranch_scc1 .g2_kernel_wg48
.g2_kernel_wg48d:
  s_sleep 8
  s_cmp_lg_u32 s62, 0
  s_cbranch_scc1 .g2_kernel_nap49
  s_sleep 22
.g2_kernel_nap49:
  s_mov_b32 s38, 0
.g2_kernel_gx50:
  s_mov_b32 s21, s20
  buffer_load_dwordx4 v[160:163], v10, s[4:7], s21 offen sc1
  s_add_u32 s21, s21, 32768
  buffer_load_dwordx4 v[164:167], v10, s[4:7], s21 offen sc1
  s_add_u32 s21, s21, 32768
  buffer_load_dwordx4 v[168:171], v10, s[4:7], s21 offen sc1
  s_add_u32 s21, s21, 32768
  buffer_load_dwordx4 v[172:175], v10, s[4:7], s21 offen sc1
  s_add_u32 s21, s21, 32768
  buffer_load_dwordx4 v[176:179], v10, s[4:7], s21 offen sc1
  s_add_u32 s21, s21, 32768
  buffer_load_dwordx4 v[180:183], v10, s[4:7], s21 offen sc1
  s_add_u32 s21, s21, 32768
  buffer_load_dwordx4 v[184:187], v10, s[4:7], s21 offen sc1
  s_add_u32 s21, s21, 32768
  buffer_load_dwordx4 v[188:191], v10, s[4:7], s21 offen sc1
  s_add_u32 s21, s21, 32768
  buffer_load_dwordx4 v[192:195], v10, s[4:7], s21 offen sc1
  s_add_u32 s21, s21, 32768
  buffer_load_dwordx4 v[196:199], v10, s[4:7], s21 offen sc1
  s_add_u32 s21, s21, 32768
  buffer_load_dwordx4 v[200:203], v10, s[4:7], s21 offen sc1
  s_add_u32 s21, s21, 32768
  buffer_load_dwordx4 v[204:207], v10, s[4:7], s21 offen sc1
  s_add_u32 s21, s21, 32768
  buffer_load_dwordx4 v[208:211], v10, s[4:7], s21 offen sc1
  s_add_u32 s21, s21, 32768
  buffer_load_dwordx4 v[212:215], v10, s[4:7], s21 offen sc1
  s_add_u32 s21, s21, 32768
  buffer_load_dwordx4 v[216:219], v10, s[4:7], s21 offen sc1
  s_add_u32 s21, s21, 32768
  buffer_load_dwordx4 v[220:223], v10, s[4:7], s21 offen sc1
  s_add_u32 s21, s21, 32768
  buffer_load_dwordx4 v[224:227], v10, s[4:7], s21 offen sc1
  s_add_u32 s21, s21, 32768
  buffer_load_dwordx4 v[228:231], v10, s[4:7], s21 offen sc1
  s_add_u32 s21, s21, 32768
  buffer_load_dwordx4 v[232:235], v10, s[4:7], s21 offen sc1
  s_add_u32 s21, s21, 32768
  buffer_load_dwordx4 v[236:239], v10, s[4:7], s21 offen sc1
  s_add_u32 s21, s21, 32768
  buffer_load_dwordx4 v[240:243], v10, s[4:7], s21 offen sc1
  s_add_u32 s21, s21, 32768
  buffer_load_dwordx4 v[244:247], v10, s[4:7], s21 offen sc1
  s_add_u32 s21, s21, 32768
  buffer_load_dwordx4 v[248:251], v10, s[4:7], s21 offen sc1
  s_add_u32 s21, s21, 32768
  buffer_load_dwordx4 v[252:255], v10, s[4:7], s21 offen sc1
  s_add_u32 s21, s21, 32768
  buffer_load_dwordx4 v[16:19], v10, s[4:7], s21 offen sc1
  s_add_u32 s21, s21, 32768
  buffer_load_dwordx4 v[20:23], v10, s[4:7], s21 offen sc1
  s_add_u32 s21, s21, 32768
  buffer_load_dwordx4 v[24:27], v10, s[4:7], s21 offen sc1
  s_add_u32 s21, s21, 32768
  buffer_load_dwordx4 v[28:31], v10, s[4:7], s21 offen sc1
  s_add_u32 s21, s21, 32768
  s_add_u32 s38, s38, 1
  s_waitcnt vmcnt(0)
  v_min3_u32 v6, v160, v162, v164
  v_min3_u32 v6, v6, v166, v168
  v_min3_u32 v6, v6, v170, v172
  v_min3_u32 v6, v6, v174, v176
  v_min3_u32 v6, v6, v178, v180
  v_min3_u32 v6, v6, v182, v184
  v_min3_u32 v6, v6, v186, v188
  v_min3_u32 v6, v6, v190, v192
  v_min3_u32 v6, v6, v194, v196
  v_min3_u32 v6, v6, v198, v200
  v_min3_u32 v6, v6, v202, v204
  v_min3_u32 v6, v6, v206, v208
  v_min3_u32 v6, v6, v210, v212
  v_min3_u32 v6, v6, v214, v216
  v_min3_u32 v6, v6, v218, v220
  v_min3_u32 v6, v6, v222, v224
  v_min3_u32 v6, v6, v226, v228
  v_min3_u32 v6, v6, v230, v232
  v_min3_u32 v6, v6, v234, v236
  v_min3_u32 v6, v6, v238, v240
  v_min3_u32 v6, v6, v242, v244
  v_min3_u32 v6, v6, v246, v248
  v_min3_u32 v6, v6, v250, v252
  v_min3_u32 v6, v6, v254, v16
  v_min3_u32 v6, v6, v18, v20
  v_min3_u32 v6, v6, v22, v24
  v_min3_u32 v6, v6, v26, v28
  v_min_u32 v6, v6, v30
  v_cmp_eq_u32 vcc, 0, v6
  s_cbranch_vccz .g2_kernel_gx50d
  s_mov_b64 exec, vcc
  s_sleep 1
  s_cmp_lg_u32 s62, 0
  s_cbranch_scc1 .g2_kernel_nap51
  s_sleep 11
.g2_kernel_nap51:
  s_cmp_lt_u32 s38, 131072
  s_cbranch_scc1 .g2_kernel_gx50
.g2_kernel_gx50d:
  s_mov_b64 exec, -1
  v_add_f32 v164, v164, v160
  v_add_f32 v165, v165, v161
  v_add_f32 v166, v166, v162
  v_add_f32 v167, v167, v163
  v_add_f32 v172, v172, v168
  v_add_f32 v173, v173, v169
  v_add_f32 v174, v174, v170
  v_add_f32 v175, v175, v171
  v_add_f32 v180, v180, v176
  v_add_f32 v181, v181, v177
  v_add_f32 v182, v182, v178
  v_add_f32 v183, v183, v179
  v_add_f32 v188, v188, v184
  v_add_f32 v189, v189, v185
  v_add_f32 v190, v190, v186
  v_add_f32 v191, v191, v187
  v_add_f32 v196, v196, v192
  v_add_f32 v197, v197, v193
  v_add_f32 v198, v198, v194
  v_add_f32 v199, v199, v195
  v_add_f32 v204, v204, v200
  v_add_f32 v205, v205, v201
  v_add_f32 v206, v206, v202
  v_add_f32 v207, v207, v203
  v_add_f32 v212, v212, v208
  v_add_f32 v213, v213, v209
  v_add_f32 v214, v214, v210
  v_add_f32 v215, v215, v211
  v_add_f32 v220, v220, v216
  v_add_f32 v221, v221, v217
  v_add_f32 v222, v222, v218
  v_add_f32 v223, v223, v219
  v_add_f32 v228, v228, v224
  v_add_f32 v229, v229, v225
  v_add_f32 v230, v230, v226
  v_add_f32 v231, v231, v227
  v_add_f32 v236, v236, v232
  v_add_f32 v237, v237, v233
  v_add_f32 v238, v238, v234
  v_add_f32 v239, v239, v235
  v_add_f32 v244, v244, v240
  v_add_f32 v245, v245, v241
  v_add_f32 v246, v246, v242
  v_add_f32 v247, v247, v243
  v_add_f32 v252, v252, v248
  v_add_f32 v253, v253, v249
  v_add_f32 v254, v254, v250
  v_add_f32 v255, v255, v251
  v_add_f32 v20, v20, v16
  v_add_f32 v21, v21, v17
  v_add_f32 v22, v22, v18
  v_add_f32 v23, v23, v19
  v_add_f32 v28, v28, v24
  v_add_f32 v29, v29, v25
  v_add_f32 v30, v30, v26
  v_add_f32 v31, v31, v27
  v_add_f32 v172, v172, v164
  v_add_f32 v173, v173, v165
  v_add_f32 v174, v174, v166
  v_add_f32 v175, v175, v167
  v_add_f32 v188, v188, v180
  v_add_f32 v189, v189, v181
  v_add_f32 v190, v190, v182
  v_add_f32 v191, v191, v183
  v_add_f32 v204, v204, v196
  v_add_f32 v205, v205, v197
  v_add_f32 v206, v206, v198
  v_add_f32 v207, v207, v199
  v_add_f32 v220, v220, v212
  v_add_f32 v221, v221, v213
  v_add_f32 v222, v222, v214
  v_add_f32 v223, v223, v215
  v_add_f32 v236, v236, v228
  v_add_f32 v237, v237, v229
  v_add_f32 v238, v238, v230
  v_add_f32 v239, v239, v231
  v_add_f32 v252, v252, v244
  v_add_f32 v253, v253, v245
  v_add_f32 v254, v254, v246
  v_add_f32 v255, v255, v247
  v_add_f32 v28, v28, v20
  v_add_f32 v29, v29, v21
  v_add_f32 v30, v30, v22
  v_add_f32 v31, v31, v23
  v_add_f32 v188, v188, v172
  v_add_f32 v189, v189, v173
  v_add_f32 v190, v190, v174
  v_add_f32 v191, v191, v175
  v_add_f32 v220, v220, v204
  v_add_f32 v221, v221, v205
  v_add_f32 v222, v222, v206
  v_add_f32 v223, v223, v207
  v_add_f32 v252, v252, v236
  v_add_f32 v253, v253, v237
  v_add_f32 v254, v254, v238
  v_add_f32 v255, v255, v239
  v_add_f32 v220, v220, v188
  v_add_f32 v221, v221, v189
  v_add_f32 v222, v222, v190
  v_add_f32 v223, v223, v191
  v_add_f32 v28, v28, v252
  v_add_f32 v29, v29, v253
  v_add_f32 v30, v30, v254
  v_add_f32 v31, v31, v255
  v_add_f32 v28, v28, v220
  v_add_f32 v29, v29, v221
  v_add_f32 v30, v30, v222
  v_add_f32 v31, v31, v223
  v_add_f32 v28, v28, v28 quad_perm:[1,0,3,2] row_mask:0xf bank_mask:0xf
  v_add_f32 v29, v29, v29 quad_perm:[1,0,3,2] row_mask:0xf bank_mask:0xf
  v_add_f32 v30, v30, v30 quad_perm:[1,0,3,2] row_mask:0xf bank_mask:0xf
  v_add_f32 v31, v31, v31 quad_perm:[1,0,3,2] row_mask:0xf bank_mask:0xf
  v_add_f32 v28, v28, v28 quad_perm:[2,3,0,1] row_mask:0xf bank_mask:0xf
  v_add_f32 v29, v29, v29 quad_perm:[2,3,0,1] row_mask:0xf bank_mask:0xf
  v_add_f32 v30, v30, v30 quad_perm:[2,3,0,1] row_mask:0xf bank_mask:0xf
  v_add_f32 v31, v31, v31 quad_perm:[2,3,0,1] row_mask:0xf bank_mask:0xf
  v_add_f32 v28, v28, v28 row_half_mirror row_mask:0xf bank_mask:0xf
  v_add_f32 v29, v29, v29 row_half_mirror row_mask:0xf bank_mask:0xf
  v_add_f32 v30, v30, v30 row_half_mirror row_mask:0xf bank_mask:0xf
  v_add_f32 v31, v31, v31 row_half_mirror row_mask:0xf bank_mask:0xf
  v_mul_f32 v28, v28, v62
  v_mul_f32 v29, v29, v62
  v_mul_f32 v30, v30, v62
  v_mul_f32 v31, v31, v62
  v_cvt_pk_bf16_f32 v16, v28, v29
  v_cvt_pk_bf16_f32 v17, v30, v31
  s_mov_b32 s28, 0x00010001
  s_mov_b32 s29, 0x00010001
  v_mov_b32 v18, v16 row_ror:8 row_mask:0xf bank_mask:0xf
  v_mov_b32 v19, v17 row_ror:8 row_mask:0xf bank_mask:0xf
  v_lshlrev_b32 v28, 16, v16
  v_and_b32 v29, 0xffff0000, v16
  v_lshlrev_b32 v30, 16, v17
  v_and_b32 v31, 0xffff0000, v17
  v_cndmask_b32 v32, 0, v16, s[28:29]
  v_cndmask_b32 v33, 0, v17, s[28:29]
  v_cndmask_b32 v34, 0, v18, s[28:29]
  v_cndmask_b32 v35, 0, v19, s[28:29]
  s_lshl_b64 s[28:29], s[28:29], 1
  s_nop 0
  v_mfma_f32_16x16x32_bf16 v[160:163], v[32:35], v[64:67], 0
  v_mfma_f32_16x16x32_bf16 v[164:167], v[32:35], v[80:83], 0
  v_mfma_f32_16x16x32_bf16 v[168:171], v[32:35], v[96:99], 0
  v_mfma_f32_16x16x32_bf16 v[172:175], v[32:35], v[112:115], 0
  v_mfma_f32_16x16x32_bf16 v[176:179], v[32:35], v[128:131], 0
  v_mfma_f32_16x16x32_bf16 v[180:183], v[32:35], v[144:147], 0
  v_cndmask_b32 v36, 0, v16, s[28:29]
  v_cndmask_b32 v37, 0, v17, s[28:29]
  v_cndmask_b32 v38, 0, v18, s[28:29]
  v_cndmask_b32 v39, 0, v19, s[28:29]
  s_lshl_b64 s[28:29], s[28:29], 1
  s_nop 0
  v_mfma_f32_16x16x32_bf16 v[160:163], v[36:39], v[68:71], v[160:163]
  v_mfma_f32_16x16x32_bf16 v[164:167], v[36:39], v[84:87], v[164:167]
  v_mfma_f32_16x16x32_bf16 v[168:171], v[36:39], v[100:103], v[168:171]
  v_mfma_f32_16x16x32_bf16 v[172:175], v[36:39], v[116:119], v[172:175]
  v_mfma_f32_16x16x32_bf16 v[176:179], v[36:39], v[132:135], v[176:179]
  v_mfma_f32_16x16x32_bf16 v[180:183], v[36:39], v[148:151], v[180:183]
  v_cndmask_b32 v40, 0, v16, s[28:29]
  v_cndmask_b32 v41, 0, v17, s[28:29]
  v_cndmask_b32 v42, 0, v18, s[28:29]
  v_cndmask_b32 v43, 0, v19, s[28:29]
  s_lshl_b64 s[28:29], s[28:29], 1
  s_nop 0
  v_mfma_f32_16x16x32_bf16 v[160:163], v[40:43], v[72:75], v[160:163]
  v_mfma_f32_16x16x32_bf16 v[164:167], v[40:43], v[88:91], v[164:167]
  v_mfma_f32_16x16x32_bf16 v[168:171], v[40:43], v[104:107], v[168:171]
  v_mfma_f32_16x16x32_bf16 v[172:175], v[40:43], v[120:123], v[172:175]
  v_mfma_f32_16x16x32_bf16 v[176:179], v[40:43], v[136:139], v[176:179]
  v_mfma_f32_16x16x32_bf16 v[180:183], v[40:43], v[152:155], v[180:183]
  v_cndmask_b32 v44, 0, v16, s[28:29]
  v_cndmask_b32 v45, 0, v17, s[28:29]
  v_cndmask_b32 v46, 0, v18, s[28:29]
  v_cndmask_b32 v47, 0, v19, s[28:29]
  s_lshl_b64 s[28:29], s[28:29], 1
  s_nop 0
  v_mfma_f32_16x16x32_bf16 v[160:163], v[44:47], v[76:79], v[160:163]
  v_mfma_f32_16x16x32_bf16 v[164:167], v[44:47], v[92:95], v[164:167]
  v_mfma_f32_16x16x32_bf16 v[168:171], v[44:47], v[108:111], v[168:171]
  v_mfma_f32_16x16x32_bf16 v[172:175], v[44:47], v[124:127], v[172:175]
  v_mfma_f32_16x16x32_bf16 v[176:179], v[44:47], v[140:143], v[176:179]
  v_mfma_f32_16x16x32_bf16 v[180:183], v[44:47], v[156:159], v[180:183]
  v_add_f32 v56, v56, v28
  v_add_f32 v57, v57, v29
  v_add_f32 v58, v58, v30
  v_add_f32 v59, v59, v31
  v_add_f32 v20, v56, v57
  v_mul_f32 v22, v56, v56
  v_add_f32 v21, v58, v59
  v_fmac_f32 v22, v57, v57
  v_add_f32 v20, v20, v21
  v_fmac_f32 v22, v58, v58
  v_fmac_f32 v22, v59, v59
  v_or_b32 v28, 1, v28
  v_or_b32 v30, 1, v30
  v_add_f32 v20, v20, v20 row_ror:8 row_mask:0xf bank_mask:0xf
  v_add_f32 v22, v22, v22 row_ror:8 row_mask:0xf bank_mask:0xf
  v_lshlrev_b32 v11, 4, v12
  v_add_f32 v20, v20, v20 row_bcast:15 row_mask:0xa bank_mask:0xf
  v_add_f32 v22, v22, v22 row_bcast:15 row_mask:0xa bank_mask:0xf
  s_mov_b32 exec_lo, 0x01010101
  s_mov_b32 exec_hi, 0x01010101
  buffer_store_dwordx4 v[28:31], v11, s[4:7], s26 offen offset:768 sc1
  buffer_store_dwordx4 v[28:31], v11, s[4:7], s25 offen offset:768 sc1
  s_mov_b64 exec, -1
  v_add_f32 v20, v20, v20 row_bcast:31 row_mask:0xc bank_mask:0xf
  v_add_f32 v22, v22, v22 row_bcast:31 row_mask:0xc bank_mask:0xf
  v_or_b32 v20, 1, v20
  v_or_b32 v22, 1, v22
  s_mov_b32 exec_lo, 0
  s_mov_b32 exec_hi, 0x80000000
  buffer_store_dwordx4 v[20:23], v4, s[4:7], s26 offen offset:896 sc1
  buffer_store_dwordx4 v[20:23], v4, s[4:7], s25 offen offset:896 sc1
  s_mov_b64 exec, 0xffff
  v_or_b32 v160, 1, v160
  v_or_b32 v162, 1, v162
  buffer_store_dwordx4 v[160:163], v3, s[4:7], s26 offen offset:0 sc1
  v_or_b32 v164, 1, v164
  v_or_b32 v166, 1, v166
  buffer_store_dwordx4 v[164:167], v3, s[4:7], s25 offen offset:0 sc1
  v_or_b32 v168, 1, v168
  v_or_b32 v170, 1, v170
  buffer_store_dwordx4 v[168:171], v3, s[4:7], s26 offen offset:256 sc1
  v_or_b32 v172, 1, v172
  v_or_b32 v174, 1, v174
  buffer_store_dwordx4 v[172:175], v3, s[4:7], s25 offen offset:256 sc1
  v_or_b32 v176, 1, v176
  v_or_b32 v178, 1, v178
  buffer_store_dwordx4 v[176:179], v3, s[4:7], s26 offen offset:512 sc1
  v_or_b32 v180, 1, v180
  v_or_b32 v182, 1, v182
  buffer_store_dwordx4 v[180:183], v3, s[4:7], s25 offen offset:512 sc1
  s_mov_b64 exec, -1
  s_cmp_eq_u32 s79, 0
  s_cbranch_scc1 .g2_kernel_c_no
  s_lshl_b32 s20, s18, 15
  s_add_u32 s20, s20, 0x1190000
  s_lshl_b32 s22, s18, 11
  s_add_u32 s22, s22, s20
  v_lshlrev_b32 v16, 10, v2
  s_sleep 16
  s_mov_b32 s38, 0
  s_mov_b32 exec_hi, 0
.g2_kernel_gx52:
  buffer_load_dword v17, v16, s[4:7], s20 offen offset:752 sc1
  s_add_u32 s38, s38, 1
  s_waitcnt vmcnt(0)
  v_min_u32 v6, v17, v17
  v_cmp_eq_u32 vcc, 0, v6
  s_cbranch_vccz .g2_kernel_gx52d
  s_mov_b64 exec, vcc
  s_sleep 6
  s_cmp_lt_u32 s38, 131072
  s_cbranch_scc1 .g2_kernel_gx52
.g2_kernel_gx52d:
  s_mov_b64 exec, -1
  s_mov_b32 s38, 0
  s_bfm_b64 exec, 57, 0
.g2_kernel_gx53:
  s_mov_b32 s21, s20
  buffer_load_dwordx4 v[64:67], v3, s[4:7], s21 offen offset:0 sc1
  buffer_load_dwordx4 v[68:71], v3, s[4:7], s21 offen offset:1024 sc1
  buffer_load_dwordx4 v[72:75], v3, s[4:7], s21 offen offset:2048 sc1
  buffer_load_dwordx4 v[76:79], v3, s[4:7], s21 offen offset:3072 sc1
  s_add_u32 s21, s21, 4096
  buffer_load_dwordx4 v[80:83], v3, s[4:7], s21 offen offset:0 sc1
  buffer_load_dwordx4 v[84:87], v3, s[4:7], s21 offen offset:1024 sc1
  buffer_load_dwordx4 v[88:91], v3, s[4:7], s21 offen offset:2048 sc1
  buffer_load_dwordx4 v[92:95], v3, s[4:7], s21 offen offset:3072 sc1
  s_add_u32 s21, s21, 4096
  buffer_load_dwordx4 v[96:99], v3, s[4:7], s21 offen offset:0 sc1
  buffer_load_dwordx4 v[100:103], v3, s[4:7], s21 offen offset:1024 sc1
  buffer_load_dwordx4 v[104:107], v3, s[4:7], s21 offen offset:2048 sc1
  buffer_load_dwordx4 v[108:111], v3, s[4:7], s21 offen offset:3072 sc1
  s_add_u32 s21, s21, 4096
  buffer_load_dwordx4 v[112:115], v3, s[4:7], s21 offen offset:0 sc1
  buffer_load_dwordx4 v[116:119], v3, s[4:7], s21 offen offset:1024 sc1
  buffer_load_dwordx4 v[120:123], v3, s[4:7], s21 offen offset:2048 sc1
  buffer_load_dwordx4 v[124:127], v3, s[4:7], s21 offen offset:3072 sc1
  s_add_u32 s21, s21, 4096
  buffer_load_dwordx4 v[128:131], v3, s[4:7], s21 offen offset:0 sc1
  buffer_load_dwordx4 v[132:135], v3, s[4:7], s21 offen offset:1024 sc1
  buffer_load_dwordx4 v[136:139], v3, s[4:7], s21 offen offset:2048 sc1
  buffer_load_dwordx4 v[140:143], v3, s[4:7], s21 offen offset:3072 sc1
  s_add_u32 s21, s21, 4096
  buffer_load_dwordx4 v[144:147], v3, s[4:7], s21 offen offset:0 sc1
  buffer_load_dwordx4 v[148:151], v3, s[4:7], s21 offen offset:1024 sc1
  buffer_load_dwordx4 v[152:155], v3, s[4:7], s21 offen offset:2048 sc1
  buffer_load_dwordx4 v[156:159], v3, s[4:7], s21 offen offset:3072 sc1
  s_add_u32 s21, s21, 4096
  buffer_load_dwordx4 v[160:163], v3, s[4:7], s21 offen offset:0 sc1
  buffer_load_dwordx4 v[164:167], v3, s[4:7], s21 offen offset:1024 sc1
  buffer_load_dwordx4 v[168:171], v3, s[4:7], s21 offen offset:2048 sc1
  buffer_load_dwordx4 v[172:175], v3, s[4:7], s21 offen offset:3072 sc1
  s_add_u32 s21, s21, 4096
  buffer_load_dwordx4 v[176:179], v3, s[4:7], s21 offen offset:0 sc1
  buffer_load_dwordx4 v[180:183], v3, s[4:7], s21 offen offset:1024 sc1
  buffer_load_dwordx4 v[184:187], v3, s[4:7], s21 offen offset:2048 sc1
  buffer_load_dwordx4 v[188:191], v3, s[4:7], s21 offen offset:3072 sc1
  s_add_u32 s21, s21, 4096
  buffer_load_dwordx4 v[192:195], v3, s[4:7], s22 offen offset:0 sc1
  buffer_load_dwordx4 v[196:199], v3, s[4:7], s22 offen offset:1024 sc1
  s_add_u32 s38, s38, 1
  s_waitcnt vmcnt(0)
  v_min3_u32 v6, v64, v66, v68
  v_min3_u32 v6, v6, v70, v72
  v_min3_u32 v6, v6, v74, v76
  v_min3_u32 v6, v6, v78, v80
  v_min3_u32 v6, v6, v82, v84
  v_min3_u32 v6, v6, v86, v88
  v_min3_u32 v6, v6, v90, v92
  v_min3_u32 v6, v6, v94, v96
  v_min3_u32 v6, v6, v98, v100
  v_min3_u32 v6, v6, v102, v104
  v_min3_u32 v6, v6, v106, v108
  v_min3_u32 v6, v6, v110, v112
  v_min3_u32 v6, v6, v114, v116
  v_min3_u32 v6, v6, v118, v120
  v_min3_u32 v6, v6, v122, v124
  v_min3_u32 v6, v6, v126, v128
  v_min3_u32 v6, v6, v130, v132
  v_min3_u32 v6, v6, v134, v136
  v_min3_u32 v6, v6, v138, v140
  v_min3_u32 v6, v6, v142, v144
  v_min3_u32 v6, v6, v146, v148
  v_min3_u32 v6, v6, v150, v152
  v_min3_u32 v6, v6, v154, v156
  v_min3_u32 v6, v6, v158, v160
  v_min3_u32 v6, v6, v162, v164
  v_min3_u32 v6, v6, v166, v168
  v_min3_u32 v6, v6, v170, v172
  v_min3_u32 v6, v6, v174, v176
  v_min3_u32 v6, v6, v178, v180
  v_min3_u32 v6, v6, v182, v184
  v_min3_u32 v6, v6, v186, v188
  v_min3_u32 v6, v6, v190, v192
  v_min3_u32 v6, v6, v194, v196
  v_min_u32 v6, v6, v198
  v_cmp_eq_u32 vcc, 0, v6
  s_cbranch_vccz .g2_kernel_gx53d
  s_mov_b64 exec, vcc
  s_sleep 2
  s_cmp_lt_u32 s38, 131072
  s_cbranch_scc1 .g2_kernel_gx53
.g2_kernel_gx53d:
  s_mov_b64 exec, -1
  v_add_f32 v64, v64, v128
  v_add_f32 v65, v65, v129
  v_add_f32 v66, v66, v130
  v_add_f32 v67, v67, v131
  v_add_f32 v68, v68, v132
  v_add_f32 v69, v69, v133
  v_add_f32 v70, v70, v134
  v_add_f32 v71, v71, v135
  v_add_f32 v72, v72, v136
  v_add_f32 v73, v73, v137
  v_add_f32 v74, v74, v138
  v_add_f32 v75, v75, v139
  v_add_f32 v76, v76, v140
  v_add_f32 v77, v77, v141
  v_add_f32 v78, v78, v142
  v_add_f32 v79, v79, v143
  v_add_f32 v80, v80, v144
  v_add_f32 v81, v81, v145
  v_add_f32 v82, v82, v146
  v_add_f32 v83, v83, v147
  v_add_f32 v84, v84, v148
  v_add_f32 v85, v85, v149
  v_add_f32 v86, v86, v150
  v_add_f32 v87, v87, v151
  v_add_f32 v88, v88, v152
  v_add_f32 v89, v89, v153
  v_add_f32 v90, v90, v154
  v_add_f32 v91, v91, v155
  v_add_f32 v92, v92, v156
  v_add_f32 v93, v93, v157
  v_add_f32 v94, v94, v158
  v_add_f32 v95, v95, v159
  v_add_f32 v96, v96, v160
  v_add_f32 v97, v97, v161
  v_add_f32 v98, v98, v162
  v_add_f32 v99, v99, v163
  v_add_f32 v100, v100, v164
  v_add_f32 v101, v101, v165
  v_add_f32 v102, v102, v166
  v_add_f32 v103, v103, v167
  v_add_f32 v104, v104, v168
  v_add_f32 v105, v105, v169
  v_add_f32 v106, v106, v170
  v_add_f32 v107, v107, v171
  v_add_f32 v108, v108, v172
  v_add_f32 v109, v109, v173
  v_add_f32 v110, v110, v174
  v_add_f32 v111, v111, v175
  v_add_f32 v112, v112, v176
  v_add_f32 v113, v113, v177
  v_add_f32 v114, v114, v178
  v_add_f32 v115, v115, v179
  v_add_f32 v116, v116, v180
  v_add_f32 v117, v117, v181
  v_add_f32 v118, v118, v182
  v_add_f32 v119, v119, v183
  v_add_f32 v120, v120, v184
  v_add_f32 v121, v121, v185
  v_add_f32 v122, v122, v186
  v_add_f32 v123, v123, v187
  v_add_f32 v124, v124, v188
  v_add_f32 v125, v125, v189
  v_add_f32 v126, v126, v190
  v_add_f32 v127, v127, v191
  v_add_f32 v64, v64, v96
  v_add_f32 v65, v65, v97
  v_add_f32 v66, v66, v98
  v_add_f32 v67, v67, v99
  v_add_f32 v68, v68, v100
  v_add_f32 v69, v69, v101
  v_add_f32 v70, v70, v102
  v_add_f32 v71, v71, v103
  v_add_f32 v72, v72, v104
  v_add_f32 v73, v73, v105
  v_add_f32 v74, v74, v106
  v_add_f32 v75, v75, v107
  v_add_f32 v76, v76, v108
  v_add_f32 v77, v77, v109
  v_add_f32 v78, v78, v110
  v_add_f32 v79, v79, v111
  v_add_f32 v80, v80, v112
  v_add_f32 v81, v81, v113
  v_add_f32 v82, v82, v114
  v_add_f32 v83, v83, v115
  v_add_f32 v84, v84, v116
  v_add_f32 v85, v85, v117
  v_add_f32 v86, v86, v118
  v_add_f32 v87, v87, v119
  v_add_f32 v88, v88, v120
  v_add_f32 v89, v89, v121
  v_add_f32 v90, v90, v122
  v_add_f32 v91, v91, v123
  v_add_f32 v92, v92, v124
  v_add_f32 v93, v93, v125
  v_add_f32 v94, v94, v126
  v_add_f32 v95, v95, v127
  v_add_f32 v64, v64, v80
  v_add_f32 v65, v65, v81
  v_add_f32 v66, v66, v82
  v_add_f32 v67, v67, v83
  v_add_f32 v68, v68, v84
  v_add_f32 v69, v69, v85
  v_add_f32 v70, v70, v86
  v_add_f32 v71, v71, v87
  v_add_f32 v72, v72, v88
  v_add_f32 v73, v73, v89
  v_add_f32 v74, v74, v90
  v_add_f32 v75, v75, v91
  v_add_f32 v76, v76, v92
  v_add_f32 v77, v77, v93
  v_add_f32 v78, v78, v94
  v_add_f32 v79, v79, v95
  v_add_f32 v64, v64, v72
  v_add_f32 v65, v65, v73
  v_add_f32 v66, v66, v74
  v_add_f32 v67, v67, v75
  v_add_f32 v68, v68, v76
  v_add_f32 v69, v69, v77
  v_add_f32 v70, v70, v78
  v_add_f32 v71, v71, v79
  v_add_f32 v64, v64, v68
  v_add_f32 v65, v65, v69
  v_add_f32 v66, v66, v70
  v_add_f32 v67, v67, v71
  v_mov_b32 v28, 0.0009765625
  v_mov_b32 v30, 1e-05
  v_readlane_b32 s21, v64, 56
  v_readlane_b32 s22, v66, 56
  s_nop 0
  v_mul_f32 v20, s21, v28
  v_fma_f32 v21, s22, v28, v30
  v_fma_f32 v21, -v20, v20, v21
  v_rsq_f32 v21, abs(v21)
  v_sub_f32 v20, v61, v20
  v_mul_f32 v22, v21, v60
  v_mul_f32 v23, v21, v20
  v_and_b32 v10, 15, v2
  v_lshrrev_b32 v11, 4, v2
  v_lshlrev_b32 v16, 2, v10
  v_lshl_add_u32 v16, v11, 8, v16
  v_add_u32 v16, 155648, v16
  s_sub_u32 s20, s79, 1
  s_and_b32 s21, s20, 3
  s_lshl_b32 s21, s21, 2
  s_add_u32 s21, s21, 156160
  v_lshl_add_u32 v17, v10, 4, s21
  v_cmp_eq_u32 vcc, 2, v11
  v_mov_b32 v18, 64
  v_mov_b32 v19, 256
  v_cndmask_b32 v17, v16, v17, vcc
  v_cndmask_b32 v18, v18, v19, vcc
  v_lshrrev_b32 v24, 2, v10
  v_lshlrev_b32 v24, 9, v24
  v_and_b32 v25, 3, v10
  v_lshl_add_u32 v24, v25, 1, v24
  s_and_b32 s21, s20, 31
  s_lshl_b32 s22, s21, 4
  s_lshr_b32 s23, s20, 5
  s_lshl_b32 s24, s23, 11
  s_add_u32 s22, s22, s24
  s_add_u32 s22, s22, 131072
  v_add_u32 v26, s22, v24
  s_and_b32 s22, s21, 7
  s_and_b32 s24, s21, 8
  s_lshl_b32 s24, s24, 1
  s_add_u32 s22, s22, s24
  s_and_b32 s24, s21, 16
  s_lshr_b32 s24, s24, 1
  s_add_u32 s22, s22, s24
  s_lshl_b32 s22, s22, 4
  v_add_u32 v24, s22, v24
  s_bfe_u32 s22, s21, 0x20002
  s_lshl_b32 s22, s22, 9
  s_add_u32 s22, s22, s24
  s_and_b32 s24, s21, 3
  s_lshl_b32 s24, s24, 1
  s_add_u32 s22, s22, s24
  s_add_u32 s22, s22, 2048
  v_lshl_add_u32 v25, v10, 4, s22
  v_cndmask_b32 v24, v24, v25, vcc
  v_cndmask_b32 v19, 8, v19, vcc
  v_add_u32 v25, v24, v19
  s_lshl_b32 s22, s18, 7
  s_lshl_b32 s24, s17, 2
  s_add_u32 s22, s22, s24
  s_add_u32 s22, s22, s23
  s_lshl_b32 s22, s22, 12
  s_add_u32 s22, s22, 0x1800000
  s_add_u32 s23, s22, 262144
  s_lshr_b32 s24, s20, 6
  s_lshl_b32 s24, s24, 8
  s_add_u32 s24, s24, s76
  v_cmp_eq_u32 vcc, 0, v11
  v_mov_b32 v27, 0.25503486164919736
  s_nop 0
  v_cndmask_b32 v27, 1.0, v27, vcc
  v_mul_f32 v21, v21, v27
  v_mul_f32 v22, v22, v27
  v_mul_f32 v23, v23, v27
  s_mov_b32 s62, 1
  s_mov_b32 s63, 0x1800000
  s_mov_b32 s70, 2
  s_mov_b32 s71, 155776
  v_mov_b32 v6, s71
  s_mov_b32 s38, 0
.g2_kernel_wg54:
  ds_read_b32 v7, v6 offset:56
  s_add_u32 s38, s38, 1
  s_waitcnt lgkmcnt(0)
  v_cmp_gt_u32 vcc, 2, v7
  s_cbranch_vccz .g2_kernel_wg54d
  s_sleep 1
  s_cmp_lt_u32 s38, 524288
  s_cbranch_scc1 .g2_kernel_wg54
.g2_kernel_wg54d:
  ds_read_b32 v32, v17 offset:5632
  ds_read_b32 v36, v16 offset:4864
  v_add_u32 v17, v17, v18
  ds_read_b32 v33, v17 offset:5632
  ds_read_b32 v37, v16 offset:4928
  v_add_u32 v17, v17, v18
  ds_read_b32 v34, v17 offset:5632
  ds_read_b32 v38, v16 offset:4992
  v_add_u32 v17, v17, v18
  ds_read_b32 v35, v17 offset:5632
  ds_read_b32 v39, v16 offset:5056
  s_waitcnt lgkmcnt(0)
  v_mul_f32 v32, v32, v22
  v_fmac_f32 v32, v64, v21
  v_fmac_f32 v32, v36, v23
  v_mul_f32 v33, v33, v22
  v_fmac_f32 v33, v65, v21
  v_fmac_f32 v33, v37, v23
  v_mul_f32 v34, v34, v22
  v_fmac_f32 v34, v66, v21
  v_fmac_f32 v34, v38, v23
  v_mul_f32 v35, v35, v22
  v_fmac_f32 v35, v67, v21
  v_fmac_f32 v35, v39, v23
  v_cvt_pk_bf16_f32 v32, v32, v33
  v_cvt_pk_bf16_f32 v34, v34, v35
  v_mov_b32 v9, s71
  v_mov_b32 v8, 2
  s_mov_b32 exec_lo, 0xffff0000
  s_mov_b32 exec_hi, 0xffff
  buffer_store_short v32, v24, s[4:7], s22 offen sc1
  buffer_store_short_d16_hi v32, v25, s[4:7], s22 offen sc1
  buffer_store_short v34, v24, s[4:7], s23 offen sc1
  buffer_store_short_d16_hi v34, v25, s[4:7], s23 offen sc1
  s_mov_b64 exec, 0xffff
  ds_write_b16 v26, v32 offset:8192
  ds_write_b16_d16_hi v26, v32 offset:8200
  ds_write_b16 v26, v34
  ds_write_b16_d16_hi v26, v34 offset:8
  ds_write_b32 v9, v5 offset:60
  s_mov_b32 exec_lo, 0
  s_mov_b32 exec_hi, 0xff0000
  ds_write_b32 v16, v192 offset:6912
  ds_write_b32 v16, v193 offset:6976
  ds_write_b32 v16, v194 offset:7040
  ds_write_b32 v16, v195 offset:7104
  ds_write_b32 v16, v196 offset:6944
  ds_write_b32 v16, v197 offset:7008
  ds_write_b32 v16, v198 offset:7072
  ds_write_b32 v16, v199 offset:7136
  s_mov_b64 exec, 1
  s_waitcnt vmcnt(0)
  buffer_store_dword v8, v4, s[4:7], s24 offen sc1
  buffer_store_dword v8, v4, s[4:7], s24 offen offset:128 sc1
  s_mov_b64 exec, -1
  s_branch .g2_kernel_v
.g2_kernel_c_no:
  s_mov_b32 s62, 1
  s_mov_b32 s63, 0x1800000
  s_mov_b32 s70, 2
  s_mov_b32 s71, 155776
  s_branch .g2_kernel_v
.g2_kernel_c_t3:
  s_lshr_b32 s33, s77, 7
  s_lshl_b32 s28, s33, 2
  s_lshl_b64 s[8:9], 15, s28
  s_lshl_b32 s21, s17, 10
  s_add_u32 s21, s21, 0x2880000
  v_lshlrev_b32 v14, 3, v2
  v_add_u32 v14, 155648, v14
  v_mov_b32 v9, s71
  s_cmp_eq_u32 s33, s17
  s_cbranch_scc0 .g2_kernel_c_u1
  s_sleep 6
  s_call_b64 s[72:73], .g2_kernel_c_ph2
  s_branch .g2_kernel_c_u2
.g2_kernel_c_u1:
  v_mov_b32 v6, s71
  s_mov_b32 s38, 0
.g2_kernel_wg55:
  ds_read_b32 v7, v6 offset:36
  s_add_u32 s38, s38, 1
  s_waitcnt lgkmcnt(0)
  v_cmp_gt_u32 vcc, 1, v7
  s_cbranch_vccz .g2_kernel_wg55d
  s_sleep 1
  s_cmp_lt_u32 s38, 524288
  s_cbranch_scc1 .g2_kernel_wg55
.g2_kernel_wg55d:
  ds_read_b32 v7, v6 offset:36
  ds_read_b32 v6, v6 offset:104
  s_waitcnt lgkmcnt(0)
  v_readfirstlane_b32 s77, v7
  v_readfirstlane_b32 s29, v6
  s_lshl_b32 s29, s29, 5
  s_add_u32 s77, s77, s29
  s_sub_u32 s77, s77, 1
.g2_kernel_c_u2:
  s_mov_b32 s38, 0
.g2_kernel_gx56:
  buffer_load_dwordx4 v[16:19], v3, s[4:7], s21 offen sc1
  s_add_u32 s38, s38, 1
  s_waitcnt vmcnt(0)
  v_min_u32 v6, v17, v19
  v_cmp_eq_u32 vcc, 0, v6
  s_cbranch_vccz .g2_kernel_gx56d
  s_mov_b64 exec, vcc
  s_cmp_lt_u32 s38, 131072
  s_cbranch_scc1 .g2_kernel_gx56
.g2_kernel_gx56d:
  s_mov_b64 exec, -1
  v_rsq_f32 v22, v17
  v_rsq_f32 v23, v19
  v_add_f32 v52, 1.0, v22
  v_mul_f32 v54, v16, v22
  v_sub_f32 v54, 0, v54
  v_add_f32 v53, 1.0, v23
  v_mul_f32 v55, v18, v23
  v_sub_f32 v55, 0, v55
  ds_write_b64 v14, v[52:53] offset:3840
  ds_write_b64 v14, v[54:55] offset:4352
  s_lshr_b32 s28, s77, 7
  s_and_b32 s79, s77, 127
  s_add_u32 s79, s79, 1
  s_cmp_eq_u32 s28, s17
  s_cselect_b32 s79, s79, 0
  v_mov_b32 v15, s79
  v_mov_b32 v8, 2
  ds_write_b32 v9, v15 offset:32
  ds_write_b32 v9, v8 offset:28
  s_cmp_eq_u32 s33, s17
  s_cbranch_scc1 .g2_kernel_fin
  s_sleep 28
  s_mov_b32 s39, 1
  s_call_b64 s[72:73], .g2_kernel_c_ph2
  s_branch .g2_kernel_fin
.g2_kernel_c_ph2:
  s_call_b64 s[68:69], .g2_kernel_amax
  v_mov_b32 v6, s71
  s_mov_b32 s38, 0
.g2_kernel_wg57:
  ds_read_b32 v7, v6 offset:36
  s_add_u32 s38, s38, 1
  s_waitcnt lgkmcnt(0)
  v_cmp_gt_u32 vcc, 1, v7
  s_cbranch_vccz .g2_kernel_wg57d
  s_cmp_lt_u32 s38, 524288
  s_cbranch_scc1 .g2_kernel_wg57
.g2_kernel_wg57d:
  ds_read_b32 v8, v9 offset:96
  ds_read_b32 v7, v6 offset:36
  ds_read_b32 v6, v6 offset:104
  s_waitcnt lgkmcnt(0)
  v_readfirstlane_b32 s28, v7
  v_readfirstlane_b32 s29, v6
  s_lshl_b32 s29, s29, 5
  s_add_u32 s28, s28, s29
  s_sub_u32 s28, s28, 1
  s_add_u32 s29, s77, 2
  s_waitcnt lgkmcnt(0)
  v_cmp_gt_f32 vcc, s27, v8
  s_cmp_lg_u64 vcc, 0
  s_cselect_b32 s77, s77, s28
  s_cselect_b32 s29, s29, 1
  v_mov_b32 v10, s29
  v_mov_b32 v11, s27
  ds_write_b64 v9, v[10:11] offset:88
  s_setpc_b64 s[72:73]
.g2_kernel_c2:
  s_cmp_lg_u32 s62, 0
  s_cbranch_scc1 .g2_kernel_d_a
  s_cmp_lg_u32 s16, 7
  s_cbranch_scc1 .g2_kernel_d_a
  v_mov_b32 v6, s71
  s_mov_b32 s38, 0
.g2_kernel_wg60:
  ds_read_b32 v7, v6 offset:20
  s_add_u32 s38, s38, 1
  s_waitcnt lgkmcnt(0)
  v_cmp_gt_u32 vcc, 4, v7
  s_cbranch_vccz .g2_kernel_wg60d
  s_sleep 2
  s_cmp_lt_u32 s38, 524288
  s_cbranch_scc1 .g2_kernel_wg60
.g2_kernel_wg60d:
  s_sleep 20
  s_and_b32 s31, s19, 0xffffe000
  s_add_u32 s31, s31, 8
  v_and_b32 v6, 15, v2
  v_lshlrev_b32 v6, 9, v6
  v_lshrrev_b32 v7, 4, v2
  v_lshl_add_u32 v6, v7, 7, v6
  v_lshlrev_b32 v7, 2, v2
  v_add_u32 v7, 158208, v7
  s_mov_b32 m0, 158208
  s_mov_b32 s38, 0
.g2_kernel_pa61:
  buffer_load_dword v6, s[4:7], s31 offen sc1 lds
  s_add_u32 s38, s38, 1
  s_waitcnt vmcnt(0)
  ds_read_b32 v8, v7
  s_waitcnt lgkmcnt(0)
  v_cmp_ge_u32 vcc, s62, v8
  s_cbranch_vccz .g2_kernel_pa61d
  s_mov_b64 exec, vcc
  s_sleep 10
  s_cmp_lt_u32 s38, 131072
  s_cbranch_scc1 .g2_kernel_pa61
.g2_kernel_pa61d:
  s_mov_b64 exec, -1
.g2_kernel_d_a:
  s_setprio 2
  s_and_b32 s20, s16, 1
  v_bfe_u32 v8, v2, 1, 3
  v_lshlrev_b32 v8, 14, v8
  v_and_b32 v9, 1, v2
  v_lshl_add_u32 v8, v9, 10, v8
  v_lshrrev_b32 v9, 4, v2
  v_lshl_add_u32 v8, v9, 8, v8
  v_and_b32 v9, 15, v2
  v_lshlrev_b32 v9, 4, v9
  s_lshl_b32 s28, s20, 8
  s_add_u32 s28, s28, 156672
  v_add_u32 v10, s28, v9
  v_xor_b32 v11, 256, v10
  s_lshl_b32 s28, s20, 2
  s_add_u32 s28, s28, s71
  v_mov_b32 v12, s28
  v_xor_b32 v13, 4, v12
  s_lshl_b32 s26, s74, 1
  s_add_u32 s26, s26, s20
  s_lshl_b32 s26, s26, 11
  s_add_u32 s26, s26, s63
  s_add_u32 s26, s26, 0x1090000
  s_mov_b32 s32, 0
  s_mov_b32 s39, 0
  s_lshl_b32 s28, s62, 3
  s_add_u32 s28, s28, s16
  s_cmp_lg_u32 s28, 14
  s_cbranch_scc1 .g2_kernel_d_w
  s_lshr_b32 s33, s77, 7
  s_lshl_b32 s28, s33, 2
  s_lshl_b64 s[8:9], 15, s28
  s_not_b64 s[8:9], s[8:9]
  s_and_b32 s28, s2, 7
  s_lshl_b32 s28, s28, 13
  s_add_u32 s23, s28, 0x3050000
  s_cmp_eq_u32 s33, s17
  s_cbranch_scc1 .g2_kernel_d_v
  v_mov_b32 v6, s71
  s_mov_b32 s38, 0
.g2_kernel_wg62:
  ds_read_b32 v7, v6 offset:20
  s_add_u32 s38, s38, 1
  s_waitcnt lgkmcnt(0)
  v_cmp_gt_u32 vcc, 4, v7
  s_cbranch_vccz .g2_kernel_wg62d
  s_sleep 1
  s_cmp_lt_u32 s38, 524288
  s_cbranch_scc1 .g2_kernel_wg62
.g2_kernel_wg62d:
.g2_kernel_d_v:
  s_sleep 60
  s_call_b64 s[68:69], .g2_kernel_amax
  s_add_u32 s28, s77, 1
  v_mov_b32 v6, s27
  v_mov_b32 v7, s28
  ds_write_b32 v12, v6 offset:96
  ds_write_b32 v12, v7 offset:36
  s_waitcnt lgkmcnt(0)
  s_wakeup
  s_branch .g2_kernel_d_r
.g2_kernel_d_w:
  v_mov_b32 v6, s71
  s_mov_b32 s38, 0
.g2_kernel_wg63:
  ds_read_b32 v7, v6 offset:36
  s_add_u32 s38, s38, 1
  s_waitcnt lgkmcnt(0)
  v_cmp_gt_u32 vcc, 1, v7
  s_cbranch_vccz .g2_kernel_wg63d
  s_sleep 4
  s_cmp_lt_u32 s38, 524288
  s_cbranch_scc1 .g2_kernel_wg63
.g2_kernel_wg63d:
  ds_read_b32 v7, v6 offset:36
  ds_read_b32 v6, v6 offset:104
  s_waitcnt lgkmcnt(0)
  v_readfirstlane_b32 s77, v7
  v_readfirstlane_b32 s29, v6
  s_lshl_b32 s29, s29, 5
  s_add_u32 s77, s77, s29
  s_sub_u32 s77, s77, 1
.g2_kernel_d_r:
  s_and_b32 s77, s77, 2047
  s_lshr_b32 s24, s77, 7
  s_lshl_b32 s24, s24, 18
  s_bfe_u32 s28, s77, 0x30004
  s_lshl_b32 s28, s28, 11
  s_add_u32 s24, s24, s28
  s_and_b32 s28, s77, 15
  s_lshl_b32 s28, s28, 4
  s_add_u32 s24, s24, s28
  s_add_u32 s24, s24, s63
  s_add_u32 s24, s24, 0xc00000
  s_lshl_b32 s28, s17, 14
  s_add_u32 s21, s24, s28
  s_and_b32 s28, s18, 8
  s_lshl_b32 s28, s28, 5
  s_add_u32 s21, s21, s28
  s_and_b32 s28, s18, 7
  s_lshl_b32 s28, s28, 1
  s_add_u32 s21, s21, s28
  s_lshl_b32 s28, s20, 17
  s_add_u32 s24, s24, s28
  buffer_load_dwordx4 v[16:19], v8, s[4:7], s24 offen
  buffer_load_ushort v56, v4, s[4:7], s21 offen
  buffer_load_ushort v57, v4, s[4:7], s21 offen offset:512
  buffer_load_ushort v58, v4, s[4:7], s21 offen offset:1024
  buffer_load_ushort v59, v4, s[4:7], s21 offen offset:1536
  s_lshl_b32 s25, s77, 3
  s_add_u32 s25, s25, s63
  s_add_u32 s25, s25, 0x1080000
  s_mov_b32 s38, 0
.g2_kernel_gx64:
  buffer_load_dwordx2 v[20:21], v4, s[4:7], s25 offen sc1
  s_add_u32 s38, s38, 1
  s_waitcnt vmcnt(0)
  v_min_u32 v6, v21, v21
  v_cmp_eq_u32 vcc, 0, v6
  s_cbranch_vccz .g2_kernel_gx64d
  s_mov_b64 exec, vcc
  s_sleep 1
  s_cmp_lt_u32 s38, 131072
  s_cbranch_scc1 .g2_kernel_gx64
.g2_kernel_gx64d:
  s_mov_b64 exec, -1
  v_rsq_f32 v21, v21
  v_lshlrev_b32 v24, 16, v16
  v_and_b32 v25, 0xffff0000, v16
  v_lshlrev_b32 v26, 16, v17
  v_and_b32 v27, 0xffff0000, v17
  v_lshlrev_b32 v28, 16, v18
  v_and_b32 v29, 0xffff0000, v18
  v_lshlrev_b32 v30, 16, v19
  v_and_b32 v31, 0xffff0000, v19
  v_mul_f32 v20, v20, v21
  v_mov_b32 v60, v20
  v_add_f32 v61, 1.0, v21
  s_cmp_ge_u32 s74, 224
  s_cbranch_scc1 .g2_kernel_d_none
  v_fma_f32 v24, v24, v21, -v20
  v_fma_f32 v25, v25, v21, -v20
  v_fma_f32 v26, v26, v21, -v20
  v_fma_f32 v27, v27, v21, -v20
  v_fma_f32 v28, v28, v21, -v20
  v_fma_f32 v29, v29, v21, -v20
  v_fma_f32 v30, v30, v21, -v20
  v_fma_f32 v31, v31, v21, -v20
  v_cvt_pk_bf16_f32 v16, v24, v25
  v_cvt_pk_bf16_f32 v17, v26, v27
  v_cvt_pk_bf16_f32 v18, v28, v29
  v_cvt_pk_bf16_f32 v19, v30, v31
  v_mov_b32 v24, v16 row_newbcast:0 row_mask:0xf bank_mask:0xf
  v_mov_b32 v25, v17 row_newbcast:0 row_mask:0xf bank_mask:0xf
  v_mov_b32 v26, v18 row_newbcast:0 row_mask:0xf bank_mask:0xf
  v_mov_b32 v27, v19 row_newbcast:0 row_mask:0xf bank_mask:0xf
  v_mov_b32 v28, v16 row_newbcast:1 row_mask:0xf bank_mask:0xf
  v_mov_b32 v29, v17 row_newbcast:1 row_mask:0xf bank_mask:0xf
  v_mov_b32 v30, v18 row_newbcast:1 row_mask:0xf bank_mask:0xf
  v_mov_b32 v31, v19 row_newbcast:1 row_mask:0xf bank_mask:0xf
  v_mfma_f32_16x16x32_bf16 v[32:35], v[24:27], v[64:67], 0
  v_mfma_f32_16x16x32_bf16 v[36:39], v[24:27], v[128:131], 0
  v_mov_b32 v24, v16 row_newbcast:2 row_mask:0xf bank_mask:0xf
  v_mov_b32 v25, v17 row_newbcast:2 row_mask:0xf bank_mask:0xf
  v_mov_b32 v26, v18 row_newbcast:2 row_mask:0xf bank_mask:0xf
  v_mov_b32 v27, v19 row_newbcast:2 row_mask:0xf bank_mask:0xf
  v_mfma_f32_16x16x32_bf16 v[32:35], v[28:31], v[68:71], v[32:35]
  v_mfma_f32_16x16x32_bf16 v[36:39], v[28:31], v[132:135], v[36:39]
  v_mov_b32 v28, v16 row_newbcast:3 row_mask:0xf bank_mask:0xf
  v_mov_b32 v29, v17 row_newbcast:3 row_mask:0xf bank_mask:0xf
  v_mov_b32 v30, v18 row_newbcast:3 row_mask:0xf bank_mask:0xf
  v_mov_b32 v31, v19 row_newbcast:3 row_mask:0xf bank_mask:0xf
  v_mfma_f32_16x16x32_bf16 v[32:35], v[24:27], v[72:75], v[32:35]
  v_mfma_f32_16x16x32_bf16 v[36:39], v[24:27], v[136:139], v[36:39]
  v_mov_b32 v24, v16 row_newbcast:4 row_mask:0xf bank_mask:0xf
  v_mov_b32 v25, v17 row_newbcast:4 row_mask:0xf bank_mask:0xf
  v_mov_b32 v26, v18 row_newbcast:4 row_mask:0xf bank_mask:0xf
  v_mov_b32 v27, v19 row_newbcast:4 row_mask:0xf bank_mask:0xf
  v_mfma_f32_16x16x32_bf16 v[32:35], v[28:31], v[76:79], v[32:35]
  v_mfma_f32_16x16x32_bf16 v[36:39], v[28:31], v[140:143], v[36:39]
  v_mov_b32 v28, v16 row_newbcast:5 row_mask:0xf bank_mask:0xf
  v_mov_b32 v29, v17 row_newbcast:5 row_mask:0xf bank_mask:0xf
  v_mov_b32 v30, v18 row_newbcast:5 row_mask:0xf bank_mask:0xf
  v_mov_b32 v31, v19 row_newbcast:5 row_mask:0xf bank_mask:0xf
  v_mfma_f32_16x16x32_bf16 v[32:35], v[24:27], v[80:83], v[32:35]
  v_mfma_f32_16x16x32_bf16 v[36:39], v[24:27], v[144:147], v[36:39]
  v_mov_b32 v24, v16 row_newbcast:6 row_mask:0xf bank_mask:0xf
  v_mov_b32 v25, v17 row_newbcast:6 row_mask:0xf bank_mask:0xf
  v_mov_b32 v26, v18 row_newbcast:6 row_mask:0xf bank_mask:0xf
  v_mov_b32 v27, v19 row_newbcast:6 row_mask:0xf bank_mask:0xf
  v_mfma_f32_16x16x32_bf16 v[32:35], v[28:31], v[84:87], v[32:35]
  v_mfma_f32_16x16x32_bf16 v[36:39], v[28:31], v[148:151], v[36:39]
  v_mov_b32 v28, v16 row_newbcast:7 row_mask:0xf bank_mask:0xf
  v_mov_b32 v29, v17 row_newbcast:7 row_mask:0xf bank_mask:0xf
  v_mov_b32 v30, v18 row_newbcast:7 row_mask:0xf bank_mask:0xf
  v_mov_b32 v31, v19 row_newbcast:7 row_mask:0xf bank_mask:0xf
  v_mfma_f32_16x16x32_bf16 v[32:35], v[24:27], v[88:91], v[32:35]
  v_mfma_f32_16x16x32_bf16 v[36:39], v[24:27], v[152:155], v[36:39]
  v_mov_b32 v24, v16 row_newbcast:8 row_mask:0xf bank_mask:0xf
  v_mov_b32 v25, v17 row_newbcast:8 row_mask:0xf bank_mask:0xf
  v_mov_b32 v26, v18 row_newbcast:8 row_mask:0xf bank_mask:0xf
  v_mov_b32 v27, v19 row_newbcast:8 row_mask:0xf bank_mask:0xf
  v_mfma_f32_16x16x32_bf16 v[32:35], v[28:31], v[92:95], v[32:35]
  v_mfma_f32_16x16x32_bf16 v[36:39], v[28:31], v[156:159], v[36:39]
  v_mov_b32 v28, v16 row_newbcast:9 row_mask:0xf bank_mask:0xf
  v_mov_b32 v29, v17 row_newbcast:9 row_mask:0xf bank_mask:0xf
  v_mov_b32 v30, v18 row_newbcast:9 row_mask:0xf bank_mask:0xf
  v_mov_b32 v31, v19 row_newbcast:9 row_mask:0xf bank_mask:0xf
  v_mfma_f32_16x16x32_bf16 v[32:35], v[24:27], v[96:99], v[32:35]
  v_mfma_f32_16x16x32_bf16 v[36:39], v[24:27], v[160:163], v[36:39]
  v_mov_b32 v24, v16 row_newbcast:10 row_mask:0xf bank_mask:0xf
  v_mov_b32 v25, v17 row_newbcast:10 row_mask:0xf bank_mask:0xf
  v_mov_b32 v26, v18 row_newbcast:10 row_mask:0xf bank_mask:0xf
  v_mov_b32 v27, v19 row_newbcast:10 row_mask:0xf bank_mask:0xf
  v_mfma_f32_16x16x32_bf16 v[32:35], v[28:31], v[100:103], v[32:35]
  v_mfma_f32_16x16x32_bf16 v[36:39], v[28:31], v[164:167], v[36:39]
  v_mov_b32 v28, v16 row_newbcast:11 row_mask:0xf bank_mask:0xf
  v_mov_b32 v29, v17 row_newbcast:11 row_mask:0xf bank_mask:0xf
  v_mov_b32 v30, v18 row_newbcast:11 row_mask:0xf bank_mask:0xf
  v_mov_b32 v31, v19 row_newbcast:11 row_mask:0xf bank_mask:0xf
  v_mfma_f32_16x16x32_bf16 v[32:35], v[24:27], v[104:107], v[32:35]
  v_mfma_f32_16x16x32_bf16 v[36:39], v[24:27], v[168:171], v[36:39]
  v_mov_b32 v24, v16 row_newbcast:12 row_mask:0xf bank_mask:0xf
  v_mov_b32 v25, v17 row_newbcast:12 row_mask:0xf bank_mask:0xf
  v_mov_b32 v26, v18 row_newbcast:12 row_mask:0xf bank_mask:0xf
  v_mov_b32 v27, v19 row_newbcast:12 row_mask:0xf bank_mask:0xf
  v_mfma_f32_16x16x32_bf16 v[32:35], v[28:31], v[108:111], v[32:35]
  v_mfma_f32_16x16x32_bf16 v[36:39], v[28:31], v[172:175], v[36:39]
  v_mov_b32 v28, v16 row_newbcast:13 row_mask:0xf bank_mask:0xf
  v_mov_b32 v29, v17 row_newbcast:13 row_mask:0xf bank_mask:0xf
  v_mov_b32 v30, v18 row_newbcast:13 row_mask:0xf bank_mask:0xf
  v_mov_b32 v31, v19 row_newbcast:13 row_mask:0xf bank_mask:0xf
  v_mfma_f32_16x16x32_bf16 v[32:35], v[24:27], v[112:115], v[32:35]
  v_mfma_f32_16x16x32_bf16 v[36:39], v[24:27], v[176:179], v[36:39]
  v_mov_b32 v24, v16 row_newbcast:14 row_mask:0xf bank_mask:0xf
  v_mov_b32 v25, v17 row_newbcast:14 row_mask:0xf bank_mask:0xf
  v_mov_b32 v26, v18 row_newbcast:14 row_mask:0xf bank_mask:0xf
  v_mov_b32 v27, v19 row_newbcast:14 row_mask:0xf bank_mask:0xf
  v_mfma_f32_16x16x32_bf16 v[32:35], v[28:31], v[116:119], v[32:35]
  v_mfma_f32_16x16x32_bf16 v[36:39], v[28:31], v[180:183], v[36:39]
  v_mov_b32 v28, v16 row_newbcast:15 row_mask:0xf bank_mask:0xf
  v_mov_b32 v29, v17 row_newbcast:15 row_mask:0xf bank_mask:0xf
  v_mov_b32 v30, v18 row_newbcast:15 row_mask:0xf bank_mask:0xf
  v_mov_b32 v31, v19 row_newbcast:15 row_mask:0xf bank_mask:0xf
  v_mfma_f32_16x16x32_bf16 v[32:35], v[24:27], v[120:123], v[32:35]
  v_mfma_f32_16x16x32_bf16 v[36:39], v[24:27], v[184:187], v[36:39]
  v_mfma_f32_16x16x32_bf16 v[32:35], v[28:31], v[124:127], v[32:35]
  v_mfma_f32_16x16x32_bf16 v[36:39], v[28:31], v[188:191], v[36:39]
  s_mov_b32 s38, 0
  s_add_u32 s36, s32, s62
  s_add_u32 s28, s36, 1
  v_mov_b32 v18, s28
  s_mov_b32 s28, 0x00010001
  s_mov_b32 s29, 0x00100010
  s_nop 0
  v_and_or_b32 v14, v32, -4, v18
  v_and_or_b32 v15, v36, -4, v18
  ds_write_b64 v10, v[14:15]
.g2_kernel_d_x:
  ds_read_b64 v[16:17], v11
  s_add_u32 s38, s38, 1
  s_waitcnt lgkmcnt(0)
  v_and_b32 v18, 3, v16
  v_and_b32 v19, 3, v17
  v_min_u32 v18, v18, v19
  v_cmp_ge_u32 vcc, s36, v18
  s_cbranch_vccz .g2_kernel_d_xd
  s_cmp_lt_u32 s38, 524288
  s_cbranch_scc1 .g2_kernel_d_x
.g2_kernel_d_xd:
  v_add_f32 v16, v16, v14
  v_add_f32 v17, v17, v15
  v_mul_f32 v18, -1.4426950408889634, v16
  v_exp_f32 v18, v18
  v_mul_f32 v16, v16, v17
  v_add_f32 v18, 1.0, v18
  v_rcp_f32 v18, v18
  s_nop 0
  v_mul_f32 v16, v16, v18
  s_nop 1
  v_mov_b32 v17, v16 quad_perm:[1,0,3,2] row_mask:0xf bank_mask:0xf
  v_cvt_pk_bf16_f32 v16, v16, v17
  s_nop 1
  v_mov_b32 v20, v16 row_newbcast:0 row_mask:0x5 bank_mask:0xf
  v_mov_b32 v21, v16 row_newbcast:2 row_mask:0x5 bank_mask:0xf
  v_mov_b32 v22, v16 row_newbcast:4 row_mask:0x5 bank_mask:0xf
  v_mov_b32 v23, v16 row_newbcast:6 row_mask:0x5 bank_mask:0xf
  v_mov_b32 v20, v16 row_newbcast:8 row_mask:0xa bank_mask:0xf
  v_mov_b32 v21, v16 row_newbcast:10 row_mask:0xa bank_mask:0xf
  v_mov_b32 v22, v16 row_newbcast:12 row_mask:0xa bank_mask:0xf
  v_mov_b32 v23, v16 row_newbcast:14 row_mask:0xa bank_mask:0xf
  v_cndmask_b32 v24, 0, v20, s[28:29]
  v_cndmask_b32 v25, 0, v21, s[28:29]
  v_cndmask_b32 v26, 0, v22, s[28:29]
  v_cndmask_b32 v27, 0, v23, s[28:29]
  s_lshl_b64 s[28:29], s[28:29], 1
  s_nop 0
  v_mfma_f32_16x16x32_bf16 v[40:43], v[24:27], v[192:195], 0
  v_mfma_f32_16x16x32_bf16 v[44:47], v[24:27], v[208:211], 0
  v_mfma_f32_16x16x32_bf16 v[48:51], v[24:27], v[224:227], 0
  v_mfma_f32_16x16x32_bf16 v[52:55], v[24:27], v[240:243], 0
  v_cndmask_b32 v28, 0, v20, s[28:29]
  v_cndmask_b32 v29, 0, v21, s[28:29]
  v_cndmask_b32 v30, 0, v22, s[28:29]
  v_cndmask_b32 v31, 0, v23, s[28:29]
  s_lshl_b64 s[28:29], s[28:29], 1
  s_nop 0
  v_mfma_f32_16x16x32_bf16 v[40:43], v[28:31], v[196:199], v[40:43]
  v_mfma_f32_16x16x32_bf16 v[44:47], v[28:31], v[212:215], v[44:47]
  v_mfma_f32_16x16x32_bf16 v[48:51], v[28:31], v[228:231], v[48:51]
  v_mfma_f32_16x16x32_bf16 v[52:55], v[28:31], v[244:247], v[52:55]
  v_cndmask_b32 v32, 0, v20, s[28:29]
  v_cndmask_b32 v33, 0, v21, s[28:29]
  v_cndmask_b32 v34, 0, v22, s[28:29]
  v_cndmask_b32 v35, 0, v23, s[28:29]
  s_lshl_b64 s[28:29], s[28:29], 1
  s_nop 0
  v_mfma_f32_16x16x32_bf16 v[40:43], v[32:35], v[200:203], v[40:43]
  v_mfma_f32_16x16x32_bf16 v[44:47], v[32:35], v[216:219], v[44:47]
  v_mfma_f32_16x16x32_bf16 v[48:51], v[32:35], v[232:235], v[48:51]
  v_mfma_f32_16x16x32_bf16 v[52:55], v[32:35], v[248:251], v[52:55]
  v_cndmask_b32 v36, 0, v20, s[28:29]
  v_cndmask_b32 v37, 0, v21, s[28:29]
  v_cndmask_b32 v38, 0, v22, s[28:29]
  v_cndmask_b32 v39, 0, v23, s[28:29]
  s_lshl_b64 s[28:29], s[28:29], 1
  s_nop 0
  v_mfma_f32_16x16x32_bf16 v[40:43], v[36:39], v[204:207], v[40:43]
  v_mfma_f32_16x16x32_bf16 v[44:47], v[36:39], v[220:223], v[44:47]
  v_mfma_f32_16x16x32_bf16 v[48:51], v[36:39], v[236:239], v[48:51]
  v_mfma_f32_16x16x32_bf16 v[52:55], v[36:39], v[252:255], v[52:55]
  s_mov_b32 exec_hi, 0
  s_nop 3
  v_or_b32 v40, 1, v40
  v_or_b32 v42, 1, v42
  buffer_store_dwordx4 v[40:43], v3, s[4:7], s26 offen offset:0 sc1
  v_or_b32 v44, 1, v44
  v_or_b32 v46, 1, v46
  buffer_store_dwordx4 v[44:47], v3, s[4:7], s26 offen offset:512 sc1
  v_or_b32 v48, 1, v48
  v_or_b32 v50, 1, v50
  buffer_store_dwordx4 v[48:51], v3, s[4:7], s26 offen offset:1024 sc1
  v_or_b32 v52, 1, v52
  v_or_b32 v54, 1, v54
  buffer_store_dwordx4 v[52:55], v3, s[4:7], s26 offen offset:1536 sc1
  s_mov_b64 exec, -1
  s_branch .g2_kernel_d_e
.g2_kernel_d_none:
  s_sleep 24
.g2_kernel_d_e:
  s_add_u32 m0, s71, 112
  s_mov_b32 s29, .g2_kernel_tab-.g2_kernel_pc+4
  s_mov_b64 exec, 1
  buffer_load_dword off, s[64:67], s29 lds
  s_mov_b64 exec, -1
  s_cmp_lg_u32 s62, 0
  s_cbranch_scc1 .g2_kernel_d_t
  s_mov_b32 s62, 1
  s_mov_b32 s63, 0x1800000
  s_mov_b32 s70, 2
  s_mov_b32 s71, 155776
  s_branch .g2_kernel_v
.g2_kernel_d_t:
  s_cmp_lg_u32 s20, 0
  s_cbranch_scc1 .g2_kernel_d_t1
  v_mov_b32 v62, -1.4426950408889634
  v_mul_f32 v62, s27, v62
  v_exp_f32 v62, v62
  v_lshlrev_b32 v14, 12, v2
  v_min_u32 v15, 126976, v14
  s_lshl_b32 s21, s17, 4
  s_add_u32 s21, s21, s18
  s_lshl_b32 s21, s21, 4
  s_mul_i32 s22, s32, 0x270000
  s_add_u32 s21, s21, s22
  s_add_u32 s21, s21, 0x2890000
  s_add_u32 s22, s21, 262144
  s_add_u32 s24, s21, 524288
  s_add_u32 s25, s21, 786432
  v_add_f32 v62, 1.0, v62
  v_rcp_f32 v62, v62
  v_lshlrev_b32 v56, 16, v56
  v_fma_f32 v56, v56, v61, -v60
  v_lshlrev_b32 v57, 16, v57
  v_fma_f32 v57, v57, v61, -v60
  v_lshlrev_b32 v58, 16, v58
  v_fma_f32 v58, v58, v61, -v60
  v_lshlrev_b32 v59, 16, v59
  v_fma_f32 v59, v59, v61, -v60
  s_sleep 8
  s_mov_b32 s38, 0
.g2_kernel_gx65:
  buffer_load_dwordx4 v[16:19], v14, s[4:7], s21 offen sc1
  buffer_load_dwordx4 v[20:23], v14, s[4:7], s22 offen sc1
  buffer_load_dwordx4 v[24:27], v14, s[4:7], s24 offen sc1
  buffer_load_dwordx4 v[28:31], v15, s[4:7], s25 offen sc1
  s_add_u32 s38, s38, 1
  s_waitcnt vmcnt(0)
  v_min3_u32 v6, v16, v18, v20
  v_min3_u32 v6, v6, v22, v24
  v_min3_u32 v6, v6, v26, v28
  v_min_u32 v6, v6, v30
  v_cmp_eq_u32 vcc, 0, v6
  s_cbranch_vccz .g2_kernel_gx65d
  s_mov_b64 exec, vcc
  s_cmp_lt_u32 s38, 131072
  s_cbranch_scc1 .g2_kernel_gx65
.g2_kernel_gx65d:
  s_mov_b64 exec, -1
  v_add_f32 v16, v16, v20
  v_add_f32 v17, v17, v21
  v_add_f32 v18, v18, v22
  v_add_f32 v19, v19, v23
  s_mov_b32 exec_hi, 0
  v_add_f32 v24, v24, v28
  v_add_f32 v25, v25, v29
  v_add_f32 v26, v26, v30
  v_add_f32 v27, v27, v31
  s_mov_b64 exec, -1
  v_add_f32 v16, v16, v24
  v_add_f32 v17, v17, v25
  v_add_f32 v18, v18, v26
  v_add_f32 v19, v19, v27
  v_add_f32 v16, v16, v16 row_ror:8 row_mask:0xf bank_mask:0xf
  v_add_f32 v17, v17, v17 row_ror:8 row_mask:0xf bank_mask:0xf
  v_add_f32 v18, v18, v18 row_ror:8 row_mask:0xf bank_mask:0xf
  v_add_f32 v19, v19, v19 row_ror:8 row_mask:0xf bank_mask:0xf
  v_add_f32 v16, v16, v16 row_ror:4 row_mask:0xf bank_mask:0xf
  v_add_f32 v17, v17, v17 row_ror:4 row_mask:0xf bank_mask:0xf
  v_add_f32 v18, v18, v18 row_ror:4 row_mask:0xf bank_mask:0xf
  v_add_f32 v19, v19, v19 row_ror:4 row_mask:0xf bank_mask:0xf
  v_add_f32 v16, v16, v16 row_ror:2 row_mask:0xf bank_mask:0xf
  v_add_f32 v17, v17, v17 row_ror:2 row_mask:0xf bank_mask:0xf
  v_add_f32 v18, v18, v18 row_ror:2 row_mask:0xf bank_mask:0xf
  v_add_f32 v19, v19, v19 row_ror:2 row_mask:0xf bank_mask:0xf
  v_add_f32 v16, v16, v16 row_ror:1 row_mask:0xf bank_mask:0xf
  v_add_f32 v17, v17, v17 row_ror:1 row_mask:0xf bank_mask:0xf
  v_add_f32 v18, v18, v18 row_ror:1 row_mask:0xf bank_mask:0xf
  v_add_f32 v19, v19, v19 row_ror:1 row_mask:0xf bank_mask:0xf
  v_add_f32 v16, v16, v16 row_bcast:15 row_mask:0xa bank_mask:0xf
  v_add_f32 v17, v17, v17 row_bcast:15 row_mask:0xa bank_mask:0xf
  v_add_f32 v18, v18, v18 row_bcast:15 row_mask:0xa bank_mask:0xf
  v_add_f32 v19, v19, v19 row_bcast:15 row_mask:0xa bank_mask:0xf
  v_add_f32 v16, v16, v16 row_bcast:31 row_mask:0xc bank_mask:0xf
  v_add_f32 v17, v17, v17 row_bcast:31 row_mask:0xc bank_mask:0xf
  v_add_f32 v18, v18, v18 row_bcast:31 row_mask:0xc bank_mask:0xf
  v_add_f32 v19, v19, v19 row_bcast:31 row_mask:0xc bank_mask:0xf
  s_lshl_b32 s24, s77, 11
  s_lshl_b32 s25, s17, 7
  s_add_u32 s24, s24, s25
  s_lshl_b32 s25, s18, 1
  s_add_u32 s24, s24, s25
.g2_kernel_d_t1:
  v_mov_b32 v6, s71
  s_mov_b32 s38, 0
.g2_kernel_wg66:
  ds_read_b32 v7, v6 offset:88
  s_add_u32 s38, s38, 1
  s_waitcnt lgkmcnt(0)
  v_cmp_gt_u32 vcc, 1, v7
  s_cbranch_vccz .g2_kernel_wg66d
  s_cmp_lt_u32 s38, 524288
  s_cbranch_scc1 .g2_kernel_wg66
.g2_kernel_wg66d:
  ds_read_b32 v6, v6 offset:92
  v_readfirstlane_b32 s33, v7
  s_cmp_lg_u32 s32, 0
  s_cselect_b32 s33, 1, s33
  s_cmp_lg_u32 s20, 0
  s_cbranch_scc1 .g2_kernel_d_t2
  s_cmp_lg_u32 s33, 1
  s_cbranch_scc1 .g2_kernel_d_t4
  v_fmac_f32 v56, v16, v62
  v_fmac_f32 v57, v17, v62
  v_fmac_f32 v58, v18, v62
  v_fmac_f32 v59, v19, v62
.g2_kernel_d_t4:
  s_mov_b32 s28, s56
  s_mov_b32 s29, s57
  s_mov_b32 s30, 0x400000
  s_mov_b32 s31, 0x00020000
  v_cvt_pk_bf16_f32 v56, v56, v57
  v_cvt_pk_bf16_f32 v58, v58, v59
  s_mov_b32 exec_lo, 0
  s_mov_b32 exec_hi, 0x80000000
  buffer_store_short v56, v4, s[28:31], s24 offen
  buffer_store_short_d16_hi v56, v4, s[28:31], s24 offen offset:32
  buffer_store_short v58, v4, s[28:31], s24 offen offset:64
  buffer_store_short_d16_hi v58, v4, s[28:31], s24 offen offset:96
  s_mov_b64 exec, -1
.g2_kernel_d_t2:
  s_cmp_eq_u32 s33, 1
  s_cbranch_scc1 .g2_kernel_fin
  s_waitcnt vmcnt(0) lgkmcnt(0)
  v_readfirstlane_b32 s27, v6
  s_sub_u32 s77, s33, 2
  s_mov_b32 s32, 1
  s_add_u32 s26, s26, 0x270000
  s_branch .g2_kernel_d_r
.g2_kernel_fin1:
.g2_kernel_fin:
.g2_kernel_end:
  s_endpgm
.g2_kernel_q_i2:
  v_mov_b32 v6, 155648
  s_mov_b32 s38, 0
.g2_kernel_wg1:
  ds_read_b32 v7, v6 offset:20
  s_add_u32 s38, s38, 1
  s_waitcnt lgkmcnt(0)
  v_cmp_gt_u32 vcc, 4, v7
  s_cbranch_vccz .g2_kernel_wg1d
  s_cmp_lt_u32 s38, 524288
  s_cbranch_scc1 .g2_kernel_wg1
.g2_kernel_wg1d:
  s_branch .g2_kernel_q_i3
.g2_kernel_q_spin:
  s_mov_b32 s38, 0
.g2_kernel_q_spinl:
  ds_read_b32 v151, v150
  s_add_u32 s38, s38, 1
  s_waitcnt lgkmcnt(0)
  v_cmp_lt_i32 vcc, s33, v151
  s_cbranch_vccnz .g2_kernel_q_spinr
  s_cmp_lt_u32 s38, 524288
  s_cbranch_scc1 .g2_kernel_q_spinl
.g2_kernel_q_spinr:
  s_setpc_b64 s[68:69]
.g2_kernel_q_wf:
  s_call_b64 s[68:69], .g2_kernel_q_spin
  s_branch .g2_kernel_q_backf
.g2_kernel_q_w7:
  s_call_b64 s[68:69], .g2_kernel_q_spin
  s_branch .g2_kernel_q_back7
.g2_kernel_q_w0:
  s_call_b64 s[68:69], .g2_kernel_q_spin
  s_branch .g2_kernel_q_back0
.g2_kernel_q_w1:
  s_call_b64 s[68:69], .g2_kernel_q_spin
  s_branch .g2_kernel_q_back1
.g2_kernel_q_w2:
  s_call_b64 s[68:69], .g2_kernel_q_spin
  s_branch .g2_kernel_q_back2
.g2_kernel_q_w3:
  s_call_b64 s[68:69], .g2_kernel_q_spin
  s_branch .g2_kernel_q_back3
.g2_kernel_q_w4:
  s_call_b64 s[68:69], .g2_kernel_q_spin
  s_branch .g2_kernel_q_back4
.g2_kernel_q_w5:
  s_call_b64 s[68:69], .g2_kernel_q_spin
  s_branch .g2_kernel_q_back5
.g2_kernel_q_w6:
  s_call_b64 s[68:69], .g2_kernel_q_spin
  s_branch .g2_kernel_q_back6
.g2_kernel_q_cons2:
  s_lshr_b32 s26, s16, 1
  s_lshl_b32 s26, s26, 13
  v_add_u32 v144, s26, v3
  v_add_u32 v145, 1024, v144
  s_branch .g2_kernel_q_cs
.g2_kernel_q_wl:
  s_call_b64 s[68:69], .g2_kernel_q_spin
  s_branch .g2_kernel_q_bl
.g2_kernel_q_v0ew:
  v_mov_b32 v6, s71
  s_mov_b32 s38, 0
.g2_kernel_wg2:
  ds_read_b32 v7, v6 offset:0
  s_add_u32 s38, s38, 1
  s_waitcnt lgkmcnt(0)
  v_cmp_gt_u32 vcc, 2, v7
  s_cbranch_vccz .g2_kernel_wg2d
  s_cmp_lt_u32 s38, 524288
  s_cbranch_scc1 .g2_kernel_wg2
.g2_kernel_wg2d:
  ds_read_b32 v57, v13 offset:24
  ds_read_b128 v[40:43], v52 offset:5120
  ds_read_b128 v[44:47], v52 offset:5184
  ds_read_b32 v24, v50 offset:2816
  ds_read_b32 v25, v50 offset:3328
  ds_read_b32 v26, v50 offset:2880
  ds_read_b32 v27, v50 offset:3392
  ds_read_b32 v28, v50 offset:2944
  ds_read_b32 v29, v50 offset:3456
  ds_read_b32 v30, v50 offset:3008
  ds_read_b32 v31, v50 offset:3520
  s_waitcnt lgkmcnt(0)
  s_branch .g2_kernel_q_v0eb
.g2_kernel_q_v0p:
  v_readfirstlane_b32 s35, v57
  s_sub_u32 s28, s35, 1
  s_lshr_b32 s29, s28, 6
  s_lshr_b32 s30, s16, 1
  s_add_u32 s35, s35, 0x100
  s_cmp_lg_u32 s29, s30
  s_cbranch_scc1 .g2_kernel_q_v0pb
  s_add_u32 s35, s35, 0x100
  s_and_b32 s29, s28, 15
  s_mov_b32 s14, 0x00010001
  s_mov_b32 s15, 0x00010001
  s_lshl_b64 s[14:15], s[14:15], s29
  s_and_b32 s29, s28, 12
  s_lshl_b32 s29, s29, 2
  s_lshl_b64 s[30:31], 0xffff, s29
  s_bfe_u32 s29, s28, 0x20004
  s_branch .g2_kernel_q_v0s
.g2_kernel_q_v0s:
  v_subrev_u32 v6, 155648, v53
  v_lshlrev_b32 v6, 2, v6
  v_add_u32 v6, 155648, v6
  s_cmp_lg_u32 s29, 0
  s_cbranch_scc1 .g2_kernel_q_v0s1
  s_mov_b64 exec, s[14:15]
  ds_write_b128 v52, v[192:195] offset:5888
  ds_write_b128 v52, v[208:211] offset:5952
  s_mov_b64 exec, -1
  s_waitcnt lgkmcnt(0)
  s_branch .g2_kernel_q_v0pb
.g2_kernel_q_v0s1:
  s_cmp_lg_u32 s29, 1
  s_cbranch_scc1 .g2_kernel_q_v0s2
  s_mov_b64 exec, s[14:15]
  ds_write_b128 v52, v[196:199] offset:5888
  ds_write_b128 v52, v[212:215] offset:5952
  s_mov_b64 exec, -1
  s_waitcnt lgkmcnt(0)
  s_branch .g2_kernel_q_v0pb
.g2_kernel_q_v0s2:
  s_cmp_lg_u32 s29, 2
  s_cbranch_scc1 .g2_kernel_q_v0s3
  s_mov_b64 exec, s[14:15]
  ds_write_b128 v52, v[200:203] offset:5888
  ds_write_b128 v52, v[216:219] offset:5952
  s_mov_b64 exec, -1
  s_waitcnt lgkmcnt(0)
  s_branch .g2_kernel_q_v0pb
.g2_kernel_q_v0s3:
  s_mov_b64 exec, s[14:15]
  ds_write_b128 v52, v[204:207] offset:5888
  ds_write_b128 v52, v[220:223] offset:5952
  s_mov_b64 exec, -1
  s_waitcnt lgkmcnt(0)
  s_branch .g2_kernel_q_v0pb
.g2_kernel_q_v0f:
  s_mov_b64 exec, 1
  s_cmp_ge_u32 s35, 0x200
  s_cbranch_scc1 .g2_kernel_q_v0f1
  buffer_store_dword v15, v4, s[4:7], s37 offen sc1
  s_mov_b64 exec, -1
  s_branch .g2_kernel_q_v0fb
.g2_kernel_q_v0f1:
  ds_add_u32 v13, v5 offset:56
  s_mov_b64 exec, -1
  s_branch .g2_kernel_q_v0fb
.g2_kernel_q_v0fw:
  s_mov_b32 s38, 0
.g2_kernel_q_v0fl:
  ds_read_b32 v63, v58
  s_add_u32 s38, s38, 1
  s_waitcnt lgkmcnt(0)
  v_cmp_gt_u32 vcc, s12, v63
  s_cbranch_vccz .g2_kernel_q_v0fc
  s_cmp_lt_u32 s38, 524288
  s_cbranch_scc1 .g2_kernel_q_v0fl
  s_branch .g2_kernel_q_v0fc
.g2_kernel_q_v0r:
  v_subrev_u32 v6, 155648, v53
  v_lshlrev_b32 v6, 2, v6
  v_add_u32 v6, 155648, v6
  s_cmp_lg_u32 s29, 0
  s_cbranch_scc1 .g2_kernel_q_v0r1
  s_mov_b64 exec, s[14:15]
  ds_write_b128 v52, v[160:163] offset:5632
  ds_write_b128 v52, v[176:179] offset:5696
  s_mov_b64 exec, s[30:31]
  ds_write_b128 v6, v[224:227] offset:6144
  ds_write_b128 v6, v[240:243] offset:6400
  s_mov_b64 exec, -1
  s_waitcnt lgkmcnt(0)
  s_branch .g2_kernel_q_v0rb
.g2_kernel_q_v0r1:
  s_cmp_lg_u32 s29, 1
  s_cbranch_scc1 .g2_kernel_q_v0r2
  s_mov_b64 exec, s[14:15]
  ds_write_b128 v52, v[164:167] offset:5632
  ds_write_b128 v52, v[180:183] offset:5696
  s_mov_b64 exec, s[30:31]
  ds_write_b128 v6, v[228:231] offset:6144
  ds_write_b128 v6, v[244:247] offset:6400
  s_mov_b64 exec, -1
  s_waitcnt lgkmcnt(0)
  s_branch .g2_kernel_q_v0rb
.g2_kernel_q_v0r2:
  s_cmp_lg_u32 s29, 2
  s_cbranch_scc1 .g2_kernel_q_v0r3
  s_mov_b64 exec, s[14:15]
  ds_write_b128 v52, v[168:171] offset:5632
  ds_write_b128 v52, v[184:187] offset:5696
  s_mov_b64 exec, s[30:31]
  ds_write_b128 v6, v[232:235] offset:6144
  ds_write_b128 v6, v[248:251] offset:6400
  s_mov_b64 exec, -1
  s_waitcnt lgkmcnt(0)
  s_branch .g2_kernel_q_v0rb
.g2_kernel_q_v0r3:
  s_mov_b64 exec, s[14:15]
  ds_write_b128 v52, v[172:175] offset:5632
  ds_write_b128 v52, v[188:191] offset:5696
  s_mov_b64 exec, s[30:31]
  ds_write_b128 v6, v[236:239] offset:6144
  ds_write_b128 v6, v[252:255] offset:6400
  s_mov_b64 exec, -1
  s_waitcnt lgkmcnt(0)
  s_branch .g2_kernel_q_v0rb
.g2_kernel_q_v1ew:
  v_mov_b32 v6, s71
  s_mov_b32 s38, 0
.g2_kernel_wg3:
  ds_read_b32 v7, v6 offset:0
  s_add_u32 s38, s38, 1
  s_waitcnt lgkmcnt(0)
  v_cmp_gt_u32 vcc, 2, v7
  s_cbranch_vccz .g2_kernel_wg3d
  s_cmp_lt_u32 s38, 524288
  s_cbranch_scc1 .g2_kernel_wg3
.g2_kernel_wg3d:
  ds_read_b32 v57, v13 offset:24
  ds_read_b128 v[24:27], v51 offset:2816
  ds_read_b128 v[32:35], v51 offset:3328
  ds_read_b128 v[28:31], v51 offset:2880
  ds_read_b128 v[36:39], v51 offset:3392
  ds_read_b128 v[40:43], v51 offset:2944
  ds_read_b128 v[88:91], v51 offset:3456
  ds_read_b128 v[44:47], v51 offset:3008
  ds_read_b128 v[92:95], v51 offset:3520
  ds_read_b32 v48, v53 offset:5376
  ds_read_b32 v49, v53 offset:5440
  s_waitcnt lgkmcnt(0)
  s_branch .g2_kernel_q_v1eb
.g2_kernel_q_v1p:
  v_readfirstlane_b32 s35, v57
  s_sub_u32 s28, s35, 1
  s_lshr_b32 s29, s28, 6
  s_lshr_b32 s30, s16, 1
  s_add_u32 s35, s35, 0x100
  s_cmp_lg_u32 s29, s30
  s_cbranch_scc1 .g2_kernel_q_v1pb
  s_add_u32 s35, s35, 0x100
  s_and_b32 s29, s28, 15
  s_mov_b32 s14, 0x00010001
  s_mov_b32 s15, 0x00010001
  s_lshl_b64 s[14:15], s[14:15], s29
  s_and_b32 s29, s28, 12
  s_lshl_b32 s29, s29, 2
  s_lshl_b64 s[30:31], 0xffff, s29
  s_bfe_u32 s29, s28, 0x20004
  s_branch .g2_kernel_q_v1s
.g2_kernel_q_v1s:
  v_subrev_u32 v6, 155648, v53
  v_lshlrev_b32 v6, 2, v6
  v_add_u32 v6, 155648, v6
  s_cmp_lg_u32 s29, 0
  s_cbranch_scc1 .g2_kernel_q_v1s1
  s_mov_b64 exec, s[30:31]
  ds_write_b128 v6, v[224:227] offset:6144
  ds_write_b128 v6, v[240:243] offset:6400
  s_mov_b64 exec, -1
  s_waitcnt lgkmcnt(0)
  s_branch .g2_kernel_q_v1pb
.g2_kernel_q_v1s1:
  s_cmp_lg_u32 s29, 1
  s_cbranch_scc1 .g2_kernel_q_v1s2
  s_mov_b64 exec, s[30:31]
  ds_write_b128 v6, v[228:231] offset:6144
  ds_write_b128 v6, v[244:247] offset:6400
  s_mov_b64 exec, -1
  s_waitcnt lgkmcnt(0)
  s_branch .g2_kernel_q_v1pb
.g2_kernel_q_v1s2:
  s_cmp_lg_u32 s29, 2
  s_cbranch_scc1 .g2_kernel_q_v1s3
  s_mov_b64 exec, s[30:31]
  ds_write_b128 v6, v[232:235] offset:6144
  ds_write_b128 v6, v[248:251] offset:6400
  s_mov_b64 exec, -1
  s_waitcnt lgkmcnt(0)
  s_branch .g2_kernel_q_v1pb
.g2_kernel_q_v1s3:
  s_mov_b64 exec, s[30:31]
  ds_write_b128 v6, v[236:239] offset:6144
  ds_write_b128 v6, v[252:255] offset:6400
  s_mov_b64 exec, -1
  s_waitcnt lgkmcnt(0)
  s_branch .g2_kernel_q_v1pb
.g2_kernel_q_v1f:
  s_mov_b64 exec, 1
  s_cmp_ge_u32 s35, 0x200
  s_cbranch_scc1 .g2_kernel_q_v1f1
  buffer_store_dword v15, v4, s[4:7], s37 offen sc1
  s_mov_b64 exec, -1
  s_branch .g2_kernel_q_v1fb
.g2_kernel_q_v1f1:
  ds_add_u32 v13, v5 offset:56
  s_mov_b64 exec, -1
  s_branch .g2_kernel_q_v1fb
.g2_kernel_q_v1fw:
  s_mov_b32 s38, 0
.g2_kernel_q_v1fl:
  ds_read_b32 v63, v58
  s_add_u32 s38, s38, 1
  s_waitcnt lgkmcnt(0)
  v_cmp_gt_u32 vcc, s12, v63
  s_cbranch_vccz .g2_kernel_q_v1fc
  s_cmp_lt_u32 s38, 524288
  s_cbranch_scc1 .g2_kernel_q_v1fl
  s_branch .g2_kernel_q_v1fc
.g2_kernel_q_v1r:
  v_subrev_u32 v6, 155648, v53
  v_lshlrev_b32 v6, 2, v6
  v_add_u32 v6, 155648, v6
  s_cmp_lg_u32 s29, 0
  s_cbranch_scc1 .g2_kernel_q_v1r1
  s_mov_b64 exec, s[14:15]
  ds_write_b128 v52, v[160:163] offset:5632
  ds_write_b128 v52, v[176:179] offset:5696
  s_mov_b64 exec, s[14:15]
  ds_write_b128 v52, v[192:195] offset:5888
  ds_write_b128 v52, v[208:211] offset:5952
  s_mov_b64 exec, -1
  s_waitcnt lgkmcnt(0)
  s_branch .g2_kernel_q_v1rb
.g2_kernel_q_v1r1:
  s_cmp_lg_u32 s29, 1
  s_cbranch_scc1 .g2_kernel_q_v1r2
  s_mov_b64 exec, s[14:15]
  ds_write_b128 v52, v[164:167] offset:5632
  ds_write_b128 v52, v[180:183] offset:5696
  s_mov_b64 exec, s[14:15]
  ds_write_b128 v52, v[196:199] offset:5888
  ds_write_b128 v52, v[212:215] offset:5952
  s_mov_b64 exec, -1
  s_waitcnt lgkmcnt(0)
  s_branch .g2_kernel_q_v1rb
.g2_kernel_q_v1r2:
  s_cmp_lg_u32 s29, 2
  s_cbranch_scc1 .g2_kernel_q_v1r3
  s_mov_b64 exec, s[14:15]
  ds_write_b128 v52, v[168:171] offset:5632
  ds_write_b128 v52, v[184:187] offset:5696
  s_mov_b64 exec, s[14:15]
  ds_write_b128 v52, v[200:203] offset:5888
  ds_write_b128 v52, v[216:219] offset:5952
  s_mov_b64 exec, -1
  s_waitcnt lgkmcnt(0)
  s_branch .g2_kernel_q_v1rb
.g2_kernel_q_v1r3:
  s_mov_b64 exec, s[14:15]
  ds_write_b128 v52, v[172:175] offset:5632
  ds_write_b128 v52, v[188:191] offset:5696
  s_mov_b64 exec, s[14:15]
  ds_write_b128 v52, v[204:207] offset:5888
  ds_write_b128 v52, v[220:223] offset:5952
  s_mov_b64 exec, -1
  s_waitcnt lgkmcnt(0)
  s_branch .g2_kernel_q_v1rb
.g2_kernel_q_v1:
  v_mfma_f32_16x16x32_bf16 v[224:227], v[64:67], v[96:99], v[224:227]
  ds_read_b64_tr_b16 v[80:81], v148 offset:45056
  ds_read_b64_tr_b16 v[82:83], v148 offset:45568
  ds_read_b128 v[128:131], v145 offset:49152
  v_mfma_f32_16x16x32_bf16 v[228:231], v[68:71], v[96:99], v[228:231]
  ds_read_b128 v[132:135], v145 offset:51200
  ds_read_b128 v[136:139], v145 offset:53248
  ds_read_b128 v[140:143], v145 offset:55296
  v_mfma_f32_16x16x32_bf16 v[232:235], v[72:75], v[96:99], v[232:235]
  ds_read_b64_tr_b16 v[84:85], v149 offset:45056
  ds_read_b64_tr_b16 v[86:87], v149 offset:45568
  ds_read_b32 v63, v13 offset:0
  v_mfma_f32_16x16x32_bf16 v[236:239], v[76:79], v[96:99], v[236:239]
  ds_read_b32 v57, v13 offset:24
  ds_read_b128 v[24:27], v51 offset:2816
  ds_read_b128 v[32:35], v51 offset:3328
  v_mfma_f32_16x16x32_bf16 v[252:255], v[76:79], v[100:103], v[252:255]
  ds_read_b128 v[28:31], v51 offset:2880
  ds_read_b128 v[36:39], v51 offset:3392
  ds_read_b128 v[40:43], v51 offset:2944
  v_mfma_f32_16x16x32_bf16 v[248:251], v[72:75], v[100:103], v[248:251]
  ds_read_b128 v[88:91], v51 offset:3456
  ds_read_b128 v[44:47], v51 offset:3008
  ds_read_b128 v[92:95], v51 offset:3520
  v_mfma_f32_16x16x32_bf16 v[244:247], v[68:71], v[100:103], v[244:247]
  ds_read_b32 v48, v53 offset:5376
  ds_read_b32 v49, v53 offset:5440
  v_mfma_f32_16x16x32_bf16 v[240:243], v[64:67], v[100:103], v[240:243]
  s_waitcnt lgkmcnt(12)
  v_mfma_f32_16x16x32_bf16 v[224:227], v[128:131], v[80:83], v[224:227]
  v_mfma_f32_16x16x32_bf16 v[228:231], v[132:135], v[80:83], v[228:231]
  v_mfma_f32_16x16x32_bf16 v[232:235], v[136:139], v[80:83], v[232:235]
  v_mfma_f32_16x16x32_bf16 v[236:239], v[140:143], v[80:83], v[236:239]
  v_mfma_f32_16x16x32_bf16 v[252:255], v[140:143], v[84:87], v[252:255]
  v_mfma_f32_16x16x32_bf16 v[248:251], v[136:139], v[84:87], v[248:251]
  v_mfma_f32_16x16x32_bf16 v[244:247], v[132:135], v[84:87], v[244:247]
  v_mfma_f32_16x16x32_bf16 v[240:243], v[128:131], v[84:87], v[240:243]
  s_waitcnt lgkmcnt(0)
  v_cmp_gt_u32 vcc, 2, v63
  s_cbranch_vccnz .g2_kernel_q_v1ew
.g2_kernel_q_v1eb:
  ds_read_b64_tr_b16 v[120:121], v148 offset:24576
  ds_read_b64_tr_b16 v[122:123], v148 offset:25088
  ds_read_b128 v[104:107], v144 offset:49152
  ds_read_b128 v[108:111], v144 offset:51200
  ds_read_b128 v[112:115], v144 offset:53248
  ds_read_b128 v[116:119], v144 offset:55296
  ds_read_b64_tr_b16 v[124:125], v149 offset:24576
  ds_read_b64_tr_b16 v[126:127], v149 offset:25088
  ds_read_b64_tr_b16 v[128:129], v148 offset:28672
  ds_read_b64_tr_b16 v[130:131], v148 offset:29184
  ds_read_b64_tr_b16 v[132:133], v149 offset:28672
  ds_read_b64_tr_b16 v[134:135], v149 offset:29184
  v_cmp_ne_u32 vcc, 0, v57
  s_cbranch_vccnz .g2_kernel_q_v1p
.g2_kernel_q_v1pb:
  v_pk_mul_f32 v[152:153], v[32:33], v[48:49] op_sel:[0,0] op_sel_hi:[1,0]
  v_pk_mul_f32 v[154:155], v[34:35], v[48:49] op_sel:[0,0] op_sel_hi:[1,0]
  v_pk_mul_f32 v[156:157], v[36:37], v[48:49] op_sel:[0,0] op_sel_hi:[1,0]
  v_pk_mul_f32 v[158:159], v[38:39], v[48:49] op_sel:[0,0] op_sel_hi:[1,0]
  v_pk_fma_f32 v[224:225], v[224:225], v[24:25], v[152:153]
  v_pk_fma_f32 v[226:227], v[226:227], v[26:27], v[154:155]
  v_pk_fma_f32 v[228:229], v[228:229], v[28:29], v[156:157]
  v_pk_fma_f32 v[230:231], v[230:231], v[30:31], v[158:159]
  v_cvt_pk_bf16_f32 v224, v224, v225
  v_cvt_pk_bf16_f32 v225, v226, v227
  v_cvt_pk_bf16_f32 v226, v228, v229
  v_cvt_pk_bf16_f32 v227, v230, v231
  buffer_store_dwordx4 v[224:227], v55, s[4:7], s8 offen offset:2048 sc1
  v_pk_mul_f32 v[152:153], v[32:33], v[48:49] op_sel:[0,1] op_sel_hi:[1,1]
  v_pk_mul_f32 v[154:155], v[34:35], v[48:49] op_sel:[0,1] op_sel_hi:[1,1]
  v_pk_mul_f32 v[156:157], v[36:37], v[48:49] op_sel:[0,1] op_sel_hi:[1,1]
  v_pk_mul_f32 v[158:159], v[38:39], v[48:49] op_sel:[0,1] op_sel_hi:[1,1]
  v_pk_fma_f32 v[240:241], v[240:241], v[24:25], v[152:153]
  v_pk_fma_f32 v[242:243], v[242:243], v[26:27], v[154:155]
  v_pk_fma_f32 v[244:245], v[244:245], v[28:29], v[156:157]
  v_pk_fma_f32 v[246:247], v[246:247], v[30:31], v[158:159]
  v_cvt_pk_bf16_f32 v240, v240, v241
  v_cvt_pk_bf16_f32 v241, v242, v243
  v_cvt_pk_bf16_f32 v242, v244, v245
  v_cvt_pk_bf16_f32 v243, v246, v247
  buffer_store_dwordx4 v[240:243], v55, s[4:7], s8 offen offset:2304 sc1
  v_pk_mul_f32 v[152:153], v[88:89], v[48:49] op_sel:[0,0] op_sel_hi:[1,0]
  v_pk_mul_f32 v[154:155], v[90:91], v[48:49] op_sel:[0,0] op_sel_hi:[1,0]
  v_pk_mul_f32 v[156:157], v[92:93], v[48:49] op_sel:[0,0] op_sel_hi:[1,0]
  v_pk_mul_f32 v[158:159], v[94:95], v[48:49] op_sel:[0,0] op_sel_hi:[1,0]
  v_pk_fma_f32 v[232:233], v[232:233], v[40:41], v[152:153]
  v_pk_fma_f32 v[234:235], v[234:235], v[42:43], v[154:155]
  v_pk_fma_f32 v[236:237], v[236:237], v[44:45], v[156:157]
  v_pk_fma_f32 v[238:239], v[238:239], v[46:47], v[158:159]
  v_cvt_pk_bf16_f32 v232, v232, v233
  v_cvt_pk_bf16_f32 v233, v234, v235
  v_cvt_pk_bf16_f32 v234, v236, v237
  v_cvt_pk_bf16_f32 v235, v238, v239
  buffer_store_dwordx4 v[232:235], v55, s[4:7], s9 offen offset:2048 sc1
  v_pk_mul_f32 v[152:153], v[88:89], v[48:49] op_sel:[0,1] op_sel_hi:[1,1]
  v_pk_mul_f32 v[154:155], v[90:91], v[48:49] op_sel:[0,1] op_sel_hi:[1,1]
  v_pk_mul_f32 v[156:157], v[92:93], v[48:49] op_sel:[0,1] op_sel_hi:[1,1]
  v_pk_mul_f32 v[158:159], v[94:95], v[48:49] op_sel:[0,1] op_sel_hi:[1,1]
  v_pk_fma_f32 v[248:249], v[248:249], v[40:41], v[152:153]
  v_pk_fma_f32 v[250:251], v[250:251], v[42:43], v[154:155]
  v_pk_fma_f32 v[252:253], v[252:253], v[44:45], v[156:157]
  v_pk_fma_f32 v[254:255], v[254:255], v[46:47], v[158:159]
  v_cvt_pk_bf16_f32 v248, v248, v249
  v_cvt_pk_bf16_f32 v249, v250, v251
  v_cvt_pk_bf16_f32 v250, v252, v253
  v_cvt_pk_bf16_f32 v251, v254, v255
  buffer_store_dwordx4 v[248:251], v55, s[4:7], s9 offen offset:2304 sc1
  s_waitcnt lgkmcnt(0)
  v_mfma_f32_16x16x32_bf16 v[160:163], v[120:123], v[104:107], v[160:163]
  ds_read_b64_tr_b16 v[80:81], v148 offset:36864
  ds_read_b64_tr_b16 v[82:83], v148 offset:37376
  v_mfma_f32_16x16x32_bf16 v[164:167], v[120:123], v[108:111], v[164:167]
  ds_read_b128 v[64:67], v145 offset:49152
  ds_read_b128 v[68:71], v145 offset:51200
  v_mfma_f32_16x16x32_bf16 v[168:171], v[120:123], v[112:115], v[168:171]
  ds_read_b128 v[72:75], v145 offset:53248
  ds_read_b128 v[76:79], v145 offset:55296
  v_mfma_f32_16x16x32_bf16 v[172:175], v[120:123], v[116:119], v[172:175]
  ds_read_b64_tr_b16 v[84:85], v149 offset:36864
  ds_read_b64_tr_b16 v[86:87], v149 offset:37376
  v_mfma_f32_16x16x32_bf16 v[188:191], v[124:127], v[116:119], v[188:191]
  ds_read_b64_tr_b16 v[88:89], v148 offset:40960
  ds_read_b64_tr_b16 v[90:91], v148 offset:41472
  v_mfma_f32_16x16x32_bf16 v[184:187], v[124:127], v[112:115], v[184:187]
  ds_read_b64_tr_b16 v[92:93], v149 offset:40960
  ds_read_b64_tr_b16 v[94:95], v149 offset:41472
  v_mfma_f32_16x16x32_bf16 v[180:183], v[124:127], v[108:111], v[180:183]
  ds_read_b128 v[32:35], v52 offset:4864
  ds_read_b128 v[36:39], v52 offset:4928
  v_mfma_f32_16x16x32_bf16 v[176:179], v[124:127], v[104:107], v[176:179]
  ds_read_b128 v[40:43], v52 offset:5120
  ds_read_b128 v[44:47], v52 offset:5184
  v_mfma_f32_16x16x32_bf16 v[192:195], v[128:131], v[104:107], v[192:195]
  v_mfma_f32_16x16x32_bf16 v[196:199], v[128:131], v[108:111], v[196:199]
  v_mfma_f32_16x16x32_bf16 v[200:203], v[128:131], v[112:115], v[200:203]
  v_mfma_f32_16x16x32_bf16 v[204:207], v[128:131], v[116:119], v[204:207]
  v_mfma_f32_16x16x32_bf16 v[220:223], v[132:135], v[116:119], v[220:223]
  v_mfma_f32_16x16x32_bf16 v[216:219], v[132:135], v[112:115], v[216:219]
  v_mfma_f32_16x16x32_bf16 v[212:215], v[132:135], v[108:111], v[212:215]
  v_mfma_f32_16x16x32_bf16 v[208:211], v[132:135], v[104:107], v[208:211]
  s_waitcnt lgkmcnt(0)
  v_mfma_f32_16x16x32_bf16 v[160:163], v[80:83], v[64:67], v[160:163]
  ds_read_b32 v63, v58
  ds_read_b32 v24, v50 offset:2816
  v_mfma_f32_16x16x32_bf16 v[164:167], v[80:83], v[68:71], v[164:167]
  ds_read_b32 v25, v50 offset:3328
  ds_read_b32 v26, v50 offset:2880
  v_mfma_f32_16x16x32_bf16 v[168:171], v[80:83], v[72:75], v[168:171]
  ds_read_b32 v27, v50 offset:3392
  ds_read_b32 v28, v50 offset:2944
  v_mfma_f32_16x16x32_bf16 v[172:175], v[80:83], v[76:79], v[172:175]
  ds_read_b32 v29, v50 offset:3456
  ds_read_b32 v30, v50 offset:3008
  v_mfma_f32_16x16x32_bf16 v[188:191], v[84:87], v[76:79], v[188:191]
  ds_read_b32 v31, v50 offset:3520
  v_mfma_f32_16x16x32_bf16 v[184:187], v[84:87], v[72:75], v[184:187]
  v_mfma_f32_16x16x32_bf16 v[180:183], v[84:87], v[68:71], v[180:183]
  v_mfma_f32_16x16x32_bf16 v[176:179], v[84:87], v[64:67], v[176:179]
  v_mfma_f32_16x16x32_bf16 v[192:195], v[88:91], v[64:67], v[192:195]
  v_mfma_f32_16x16x32_bf16 v[196:199], v[88:91], v[68:71], v[196:199]
  v_mfma_f32_16x16x32_bf16 v[200:203], v[88:91], v[72:75], v[200:203]
  v_mfma_f32_16x16x32_bf16 v[204:207], v[88:91], v[76:79], v[204:207]
  v_mfma_f32_16x16x32_bf16 v[220:223], v[92:95], v[76:79], v[220:223]
  v_mfma_f32_16x16x32_bf16 v[216:219], v[92:95], v[72:75], v[216:219]
  v_mfma_f32_16x16x32_bf16 v[212:215], v[92:95], v[68:71], v[212:215]
  v_mfma_f32_16x16x32_bf16 v[208:211], v[92:95], v[64:67], v[208:211]
  s_waitcnt lgkmcnt(0)
  v_cmp_gt_u32 vcc, s12, v63
  s_cbranch_vccnz .g2_kernel_q_v1fw
.g2_kernel_q_v1fc:
  s_cmp_ge_u32 s35, 0x200
  s_cbranch_scc1 .g2_kernel_q_v1r
.g2_kernel_q_v1rb:
  ds_write_b128 v60, v[224:227] offset:2048
  v_pk_mul_f32 v[152:153], v[40:41], v[24:25] op_sel:[0,1] op_sel_hi:[1,1]
  v_pk_mul_f32 v[154:155], v[42:43], v[24:25] op_sel:[0,1] op_sel_hi:[1,1]
  v_pk_mul_f32 v[156:157], v[44:45], v[24:25] op_sel:[0,1] op_sel_hi:[1,1]
  v_pk_mul_f32 v[158:159], v[46:47], v[24:25] op_sel:[0,1] op_sel_hi:[1,1]
  v_pk_fma_f32 v[192:193], v[192:193], v[24:25], v[152:153] op_sel_hi:[1,0,1]
  v_pk_fma_f32 v[194:195], v[194:195], v[24:25], v[154:155] op_sel_hi:[1,0,1]
  v_pk_fma_f32 v[208:209], v[208:209], v[24:25], v[156:157] op_sel_hi:[1,0,1]
  v_pk_fma_f32 v[210:211], v[210:211], v[24:25], v[158:159] op_sel_hi:[1,0,1]
  v_cvt_pk_bf16_f32 v192, v192, v193
  v_cvt_pk_bf16_f32 v193, v194, v195
  v_cvt_pk_bf16_f32 v194, v208, v209
  v_cvt_pk_bf16_f32 v195, v210, v211
  ds_write_b128 v59, v[192:195] offset:0
  ds_write_b128 v60, v[240:243] offset:2304
  v_pk_mul_f32 v[152:153], v[40:41], v[26:27] op_sel:[0,1] op_sel_hi:[1,1]
  v_pk_mul_f32 v[154:155], v[42:43], v[26:27] op_sel:[0,1] op_sel_hi:[1,1]
  v_pk_mul_f32 v[156:157], v[44:45], v[26:27] op_sel:[0,1] op_sel_hi:[1,1]
  v_pk_mul_f32 v[158:159], v[46:47], v[26:27] op_sel:[0,1] op_sel_hi:[1,1]
  v_pk_fma_f32 v[196:197], v[196:197], v[26:27], v[152:153] op_sel_hi:[1,0,1]
  v_pk_fma_f32 v[198:199], v[198:199], v[26:27], v[154:155] op_sel_hi:[1,0,1]
  v_pk_fma_f32 v[212:213], v[212:213], v[26:27], v[156:157] op_sel_hi:[1,0,1]
  v_pk_fma_f32 v[214:215], v[214:215], v[26:27], v[158:159] op_sel_hi:[1,0,1]
  v_cvt_pk_bf16_f32 v196, v196, v197
  v_cvt_pk_bf16_f32 v197, v198, v199
  v_cvt_pk_bf16_f32 v198, v212, v213
  v_cvt_pk_bf16_f32 v199, v214, v215
  ds_write_b128 v59, v[196:199] offset:128
  ds_write_b128 v60, v[232:235] offset:6144
  v_pk_mul_f32 v[152:153], v[40:41], v[28:29] op_sel:[0,1] op_sel_hi:[1,1]
  v_pk_mul_f32 v[154:155], v[42:43], v[28:29] op_sel:[0,1] op_sel_hi:[1,1]
  v_pk_mul_f32 v[156:157], v[44:45], v[28:29] op_sel:[0,1] op_sel_hi:[1,1]
  v_pk_mul_f32 v[158:159], v[46:47], v[28:29] op_sel:[0,1] op_sel_hi:[1,1]
  v_pk_fma_f32 v[200:201], v[200:201], v[28:29], v[152:153] op_sel_hi:[1,0,1]
  v_pk_fma_f32 v[202:203], v[202:203], v[28:29], v[154:155] op_sel_hi:[1,0,1]
  v_pk_fma_f32 v[216:217], v[216:217], v[28:29], v[156:157] op_sel_hi:[1,0,1]
  v_pk_fma_f32 v[218:219], v[218:219], v[28:29], v[158:159] op_sel_hi:[1,0,1]
  v_cvt_pk_bf16_f32 v200, v200, v201
  v_cvt_pk_bf16_f32 v201, v202, v203
  v_cvt_pk_bf16_f32 v202, v216, v217
  v_cvt_pk_bf16_f32 v203, v218, v219
  ds_write_b128 v59, v[200:203] offset:4096
  s_waitcnt vmcnt(0)
  s_mov_b64 exec, 1
  ds_add_rtn_u32 v7, v62, v5 offset:120
  s_mov_b64 exec, -1
  ds_write_b128 v60, v[248:251] offset:6400
  v_pk_mul_f32 v[152:153], v[40:41], v[30:31] op_sel:[0,1] op_sel_hi:[1,1]
  v_pk_mul_f32 v[154:155], v[42:43], v[30:31] op_sel:[0,1] op_sel_hi:[1,1]
  v_pk_mul_f32 v[156:157], v[44:45], v[30:31] op_sel:[0,1] op_sel_hi:[1,1]
  v_pk_mul_f32 v[158:159], v[46:47], v[30:31] op_sel:[0,1] op_sel_hi:[1,1]
  v_pk_fma_f32 v[204:205], v[204:205], v[30:31], v[152:153] op_sel_hi:[1,0,1]
  v_pk_fma_f32 v[206:207], v[206:207], v[30:31], v[154:155] op_sel_hi:[1,0,1]
  v_pk_fma_f32 v[220:221], v[220:221], v[30:31], v[156:157] op_sel_hi:[1,0,1]
  v_pk_fma_f32 v[222:223], v[222:223], v[30:31], v[158:159] op_sel_hi:[1,0,1]
  v_cvt_pk_bf16_f32 v204, v204, v205
  v_cvt_pk_bf16_f32 v205, v206, v207
  v_cvt_pk_bf16_f32 v206, v220, v221
  v_cvt_pk_bf16_f32 v207, v222, v223
  s_waitcnt lgkmcnt(1)
  v_readfirstlane_b32 s28, v7
  s_cmp_eq_u32 s28, 1
  s_cbranch_scc1 .g2_kernel_q_v1f
.g2_kernel_q_v1fb:
  ds_write_b128 v59, v[204:207] offset:4224
  v_pk_mul_f32 v[24:25], v[24:25], v[56:57] op_sel_hi:[1,0]
  v_pk_mul_f32 v[26:27], v[26:27], v[56:57] op_sel_hi:[1,0]
  v_pk_mul_f32 v[28:29], v[28:29], v[56:57] op_sel_hi:[1,0]
  v_pk_mul_f32 v[30:31], v[30:31], v[56:57] op_sel_hi:[1,0]
  v_pk_mul_f32 v[152:153], v[32:33], v[24:25] op_sel:[0,1] op_sel_hi:[1,1]
  v_pk_mul_f32 v[154:155], v[34:35], v[24:25] op_sel:[0,1] op_sel_hi:[1,1]
  v_pk_mul_f32 v[156:157], v[36:37], v[24:25] op_sel:[0,1] op_sel_hi:[1,1]
  v_pk_mul_f32 v[158:159], v[38:39], v[24:25] op_sel:[0,1] op_sel_hi:[1,1]
  v_pk_fma_f32 v[160:161], v[160:161], v[24:25], v[152:153] op_sel_hi:[1,0,1]
  v_pk_fma_f32 v[162:163], v[162:163], v[24:25], v[154:155] op_sel_hi:[1,0,1]
  v_pk_fma_f32 v[176:177], v[176:177], v[24:25], v[156:157] op_sel_hi:[1,0,1]
  v_pk_fma_f32 v[178:179], v[178:179], v[24:25], v[158:159] op_sel_hi:[1,0,1]
  v_cvt_pk_bf16_f32 v160, v160, v161
  v_cvt_pk_bf16_f32 v161, v162, v163
  v_cvt_pk_bf16_f32 v162, v176, v177
  v_cvt_pk_bf16_f32 v163, v178, v179
  ds_write_b128 v61, v[160:163] offset:0
  v_pk_mul_f32 v[152:153], v[32:33], v[26:27] op_sel:[0,1] op_sel_hi:[1,1]
  v_pk_mul_f32 v[154:155], v[34:35], v[26:27] op_sel:[0,1] op_sel_hi:[1,1]
  v_pk_mul_f32 v[156:157], v[36:37], v[26:27] op_sel:[0,1] op_sel_hi:[1,1]
  v_pk_mul_f32 v[158:159], v[38:39], v[26:27] op_sel:[0,1] op_sel_hi:[1,1]
  v_pk_fma_f32 v[164:165], v[164:165], v[26:27], v[152:153] op_sel_hi:[1,0,1]
  v_pk_fma_f32 v[166:167], v[166:167], v[26:27], v[154:155] op_sel_hi:[1,0,1]
  v_pk_fma_f32 v[180:181], v[180:181], v[26:27], v[156:157] op_sel_hi:[1,0,1]
  v_pk_fma_f32 v[182:183], v[182:183], v[26:27], v[158:159] op_sel_hi:[1,0,1]
  v_cvt_pk_bf16_f32 v164, v164, v165
  v_cvt_pk_bf16_f32 v165, v166, v167
  v_cvt_pk_bf16_f32 v166, v180, v181
  v_cvt_pk_bf16_f32 v167, v182, v183
  ds_write_b128 v61, v[164:167] offset:256
  v_pk_mul_f32 v[152:153], v[32:33], v[28:29] op_sel:[0,1] op_sel_hi:[1,1]
  v_pk_mul_f32 v[154:155], v[34:35], v[28:29] op_sel:[0,1] op_sel_hi:[1,1]
  v_pk_mul_f32 v[156:157], v[36:37], v[28:29] op_sel:[0,1] op_sel_hi:[1,1]
  v_pk_mul_f32 v[158:159], v[38:39], v[28:29] op_sel:[0,1] op_sel_hi:[1,1]
  v_pk_fma_f32 v[168:169], v[168:169], v[28:29], v[152:153] op_sel_hi:[1,0,1]
  v_pk_fma_f32 v[170:171], v[170:171], v[28:29], v[154:155] op_sel_hi:[1,0,1]
  v_pk_fma_f32 v[184:185], v[184:185], v[28:29], v[156:157] op_sel_hi:[1,0,1]
  v_pk_fma_f32 v[186:187], v[186:187], v[28:29], v[158:159] op_sel_hi:[1,0,1]
  v_cvt_pk_bf16_f32 v168, v168, v169
  v_cvt_pk_bf16_f32 v169, v170, v171
  v_cvt_pk_bf16_f32 v170, v184, v185
  v_cvt_pk_bf16_f32 v171, v186, v187
  ds_write_b128 v61, v[168:171] offset:2048
  v_pk_mul_f32 v[152:153], v[32:33], v[30:31] op_sel:[0,1] op_sel_hi:[1,1]
  v_pk_mul_f32 v[154:155], v[34:35], v[30:31] op_sel:[0,1] op_sel_hi:[1,1]
  v_pk_mul_f32 v[156:157], v[36:37], v[30:31] op_sel:[0,1] op_sel_hi:[1,1]
  v_pk_mul_f32 v[158:159], v[38:39], v[30:31] op_sel:[0,1] op_sel_hi:[1,1]
  v_pk_fma_f32 v[172:173], v[172:173], v[30:31], v[152:153] op_sel_hi:[1,0,1]
  v_pk_fma_f32 v[174:175], v[174:175], v[30:31], v[154:155] op_sel_hi:[1,0,1]
  v_pk_fma_f32 v[188:189], v[188:189], v[30:31], v[156:157] op_sel_hi:[1,0,1]
  v_pk_fma_f32 v[190:191], v[190:191], v[30:31], v[158:159] op_sel_hi:[1,0,1]
  v_cvt_pk_bf16_f32 v172, v172, v173
  v_cvt_pk_bf16_f32 v173, v174, v175
  v_cvt_pk_bf16_f32 v174, v188, v189
  v_cvt_pk_bf16_f32 v175, v190, v191
  ds_write_b128 v61, v[172:175] offset:2304
  s_branch .g2_kernel_q_kd
.g2_kernel_r2:
  buffer_load_dwordx4 v[240:243], v22, s[4:7], s13 offen offset:0
  buffer_load_dwordx4 v[244:247], v22, s[4:7], s13 offen offset:512
  buffer_load_dwordx4 v[248:251], v22, s[4:7], s13 offen offset:1024
  buffer_load_dwordx4 v[252:255], v22, s[4:7], s13 offen offset:1536
  s_branch .g2_kernel_r3
.g2_kernel_a_t1c:
  s_call_b64 s[68:69], .g2_kernel_a_pick
  s_branch .g2_kernel_a_t1b
.g2_kernel_a_t2c:
  s_call_b64 s[68:69], .g2_kernel_a_pick
  s_branch .g2_kernel_a_t2b
.g2_kernel_a_t3c:
  s_call_b64 s[68:69], .g2_kernel_a_pick
  s_branch .g2_kernel_a_t3b
.g2_kernel_a_three:
  s_andn2_b32 s33, s36, s34
  s_cbranch_scc0 .g2_kernel_a_t1c
.g2_kernel_a_t1b:
  s_ff1_i32_b32 s33, s33
  s_bitset1_b32 s34, s33
  s_xor_b32 s33, s33, s24
  s_lshl_b32 s33, s33, s25
  s_add_u32 s22, s20, s33
  s_addc_u32 s23, s21, 0
  global_load_dwordx4 v[192:195], v3, s[22:23] offset:0
  global_load_dwordx4 v[196:199], v3, s[22:23] offset:1024
  global_load_dwordx4 v[200:203], v3, s[22:23] offset:2048
  global_load_dwordx4 v[204:207], v3, s[22:23] offset:3072
  s_andn2_b32 s33, s36, s34
  s_cbranch_scc0 .g2_kernel_a_t2c
.g2_kernel_a_t2b:
  s_ff1_i32_b32 s33, s33
  s_bitset1_b32 s34, s33
  s_xor_b32 s33, s33, s24
  s_lshl_b32 s33, s33, s25
  s_add_u32 s22, s20, s33
  s_addc_u32 s23, s21, 0
  global_load_dwordx4 v[208:211], v3, s[22:23] offset:0
  global_load_dwordx4 v[212:215], v3, s[22:23] offset:1024
  global_load_dwordx4 v[216:219], v3, s[22:23] offset:2048
  global_load_dwordx4 v[220:223], v3, s[22:23] offset:3072
  s_andn2_b32 s33, s36, s34
  s_cbranch_scc0 .g2_kernel_a_t3c
.g2_kernel_a_t3b:
  s_ff1_i32_b32 s33, s33
  s_bitset1_b32 s34, s33
  s_xor_b32 s33, s33, s24
  s_lshl_b32 s33, s33, s25
  s_add_u32 s22, s20, s33
  s_addc_u32 s23, s21, 0
  global_load_dwordx4 v[224:227], v3, s[22:23] offset:0
  global_load_dwordx4 v[228:231], v3, s[22:23] offset:1024
  global_load_dwordx4 v[232:235], v3, s[22:23] offset:2048
  global_load_dwordx4 v[236:239], v3, s[22:23] offset:3072
  s_setpc_b64 s[72:73]
.g2_kernel_a_o0c:
  s_call_b64 s[68:69], .g2_kernel_a_pick
  s_branch .g2_kernel_a_o0b
.g2_kernel_a_o1c:
  s_call_b64 s[68:69], .g2_kernel_a_pick
  s_branch .g2_kernel_a_o1b
.g2_kernel_a_o2c:
  s_call_b64 s[68:69], .g2_kernel_a_pick
  s_branch .g2_kernel_a_o2b
.g2_kernel_a_o3c:
  s_call_b64 s[68:69], .g2_kernel_a_pick
  s_branch .g2_kernel_a_o3b
.g2_kernel_a_r0c:
  s_call_b64 s[68:69], .g2_kernel_a_pick
  s_branch .g2_kernel_a_r0b
.g2_kernel_a_r1c:
  s_call_b64 s[68:69], .g2_kernel_a_pick
  s_branch .g2_kernel_a_r1b
.g2_kernel_a_r2c:
  s_call_b64 s[68:69], .g2_kernel_a_pick
  s_branch .g2_kernel_a_r2b
.g2_kernel_a_own:
  s_waitcnt lgkmcnt(0)
  s_mov_b32 s14, 0
  s_andn2_b32 s33, s36, s34
  s_cbranch_scc0 .g2_kernel_a_o0c
.g2_kernel_a_o0b:
  s_ff1_i32_b32 s33, s33
  s_bitset1_b32 s34, s33
  s_lshl_b32 s28, s33, 0
  s_or_b32 s14, s14, s28
  s_xor_b32 s33, s33, s24
  s_lshl_b32 s33, s33, s25
  s_add_u32 s22, s20, s33
  s_addc_u32 s23, s21, 0
  global_load_dwordx4 v[176:179], v3, s[22:23] offset:0
  global_load_dwordx4 v[180:183], v3, s[22:23] offset:1024
  global_load_dwordx4 v[184:187], v3, s[22:23] offset:2048
  global_load_dwordx4 v[188:191], v3, s[22:23] offset:3072
  s_andn2_b32 s33, s36, s34
  s_cbranch_scc0 .g2_kernel_a_o1c
.g2_kernel_a_o1b:
  s_ff1_i32_b32 s33, s33
  s_bitset1_b32 s34, s33
  s_lshl_b32 s28, s33, 8
  s_or_b32 s14, s14, s28
  s_xor_b32 s33, s33, s24
  s_lshl_b32 s33, s33, s25
  s_add_u32 s22, s20, s33
  s_addc_u32 s23, s21, 0
  global_load_dwordx4 v[192:195], v3, s[22:23] offset:0
  global_load_dwordx4 v[196:199], v3, s[22:23] offset:1024
  global_load_dwordx4 v[200:203], v3, s[22:23] offset:2048
  global_load_dwordx4 v[204:207], v3, s[22:23] offset:3072
  s_andn2_b32 s33, s36, s34
  s_cbranch_scc0 .g2_kernel_a_o2c
.g2_kernel_a_o2b:
  s_ff1_i32_b32 s33, s33
  s_bitset1_b32 s34, s33
  s_lshl_b32 s28, s33, 16
  s_or_b32 s14, s14, s28
  s_xor_b32 s33, s33, s24
  s_lshl_b32 s33, s33, s25
  s_add_u32 s22, s20, s33
  s_addc_u32 s23, s21, 0
  global_load_dwordx4 v[208:211], v3, s[22:23] offset:0
  global_load_dwordx4 v[212:215], v3, s[22:23] offset:1024
  global_load_dwordx4 v[216:219], v3, s[22:23] offset:2048
  global_load_dwordx4 v[220:223], v3, s[22:23] offset:3072
  s_andn2_b32 s33, s36, s34
  s_cbranch_scc0 .g2_kernel_a_o3c
.g2_kernel_a_o3b:
  s_ff1_i32_b32 s33, s33
  s_bitset1_b32 s34, s33
  s_lshl_b32 s28, s33, 24
  s_or_b32 s14, s14, s28
  s_xor_b32 s33, s33, s24
  s_lshl_b32 s33, s33, s25
  s_add_u32 s22, s20, s33
  s_addc_u32 s23, s21, 0
  global_load_dwordx4 v[224:227], v3, s[22:23] offset:0
  global_load_dwordx4 v[228:231], v3, s[22:23] offset:1024
  global_load_dwordx4 v[232:235], v3, s[22:23] offset:2048
  global_load_dwordx4 v[236:239], v3, s[22:23] offset:3072
  s_and_b32 s15, s34, -2
  s_mov_b32 s34, -1
  s_mov_b32 s26, -1
  s_waitcnt vmcnt(12)
  s_branch .g2_kernel_a_ob
.g2_kernel_a_redo:
  v_mfma_f32_32x32x16_bf16 v[104:119], v[236:239], v[172:175], v[104:119]
  v_smfmac_f32_16x16x64_bf16 v[132:135], v[16:19], v[168:175], v20
  v_mov_b32 v6, s71
  s_mov_b32 s38, 0
.g2_kernel_wg5:
  ds_read_b32 v7, v6 offset:60
  s_add_u32 s38, s38, 1
  s_waitcnt lgkmcnt(0)
  v_cmp_gt_u32 vcc, 1, v7
  s_cbranch_vccz .g2_kernel_wg5d
  s_sleep 1
  s_cmp_lt_u32 s38, 524288
  s_cbranch_scc1 .g2_kernel_wg5
.g2_kernel_wg5d:
  ds_read_b32 v7, v8
  s_mov_b32 s34, s15
  s_mov_b32 s26, 0
  s_waitcnt lgkmcnt(0)
  v_cmp_lt_u32 vcc, s62, v7
  s_mov_b32 s36, vcc_lo
  s_sub_u32 s28, s35, 1
  s_bfe_u32 s28, s28, 0x20005
  s_mov_b32 s35, 0
  s_waitcnt vmcnt(0)
  s_cmp_lg_u32 s28, 0
  s_cbranch_scc1 .g2_kernel_a_rd1
  ds_read_b128 v[24:27], v14 offset:8192
  ds_read_b128 v[28:31], v14 offset:9216
  v_mov_b32 v120, 0
  v_mov_b32 v121, 0
  s_waitcnt lgkmcnt(0)
  v_mfma_f32_32x32x16_bf16 v[136:151], v[176:179], v[24:27], 0
  v_mfma_f32_32x32x16_bf16 v[136:151], v[180:183], v[28:31], v[136:151]
  v_mfma_f32_32x32x16_bf16 v[152:167], v[192:195], v[24:27], 0
  s_nop 10
  v_exp_f32 v136, v136
  v_exp_f32 v137, v137
  v_exp_f32 v138, v138
  v_exp_f32 v139, v139
  v_exp_f32 v140, v140
  v_exp_f32 v141, v141
  v_exp_f32 v142, v142
  v_exp_f32 v143, v143
  v_mfma_f32_32x32x16_bf16 v[152:167], v[196:199], v[28:31], v[152:167]
  v_cvt_pk_bf16_f32 v168, v136, v137
  v_cvt_pk_bf16_f32 v169, v138, v139
  v_cvt_pk_bf16_f32 v170, v140, v141
  v_cvt_pk_bf16_f32 v171, v142, v143
  v_exp_f32 v144, v144
  v_exp_f32 v145, v145
  v_exp_f32 v146, v146
  v_exp_f32 v147, v147
  v_mfma_f32_32x32x16_bf16 v[56:71], v[184:187], v[168:171], 0
  v_exp_f32 v148, v148
  v_exp_f32 v149, v149
  v_exp_f32 v150, v150
  v_exp_f32 v151, v151
  v_cvt_pk_bf16_f32 v172, v144, v145
  v_cvt_pk_bf16_f32 v173, v146, v147
  v_cvt_pk_bf16_f32 v174, v148, v149
  v_cvt_pk_bf16_f32 v175, v150, v151
  v_mfma_f32_32x32x16_bf16 v[136:151], v[208:211], v[24:27], 0
  v_exp_f32 v152, v152
  v_exp_f32 v153, v153
  v_exp_f32 v154, v154
  v_mfma_f32_32x32x16_bf16 v[56:71], v[188:191], v[172:175], v[56:71]
  s_call_b64 s[72:73], .g2_kernel_a_ld0
  v_exp_f32 v155, v155
  v_exp_f32 v156, v156
  v_exp_f32 v157, v157
  v_smfmac_f32_16x16x64_bf16 v[120:123], v[16:19], v[168:175], v20
  v_exp_f32 v158, v158
  v_exp_f32 v159, v159
  v_mfma_f32_32x32x16_bf16 v[136:151], v[212:215], v[28:31], v[136:151]
  v_cvt_pk_bf16_f32 v168, v152, v153
  v_cvt_pk_bf16_f32 v169, v154, v155
  v_cvt_pk_bf16_f32 v170, v156, v157
  v_cvt_pk_bf16_f32 v171, v158, v159
  v_exp_f32 v160, v160
  v_exp_f32 v161, v161
  v_exp_f32 v162, v162
  v_exp_f32 v163, v163
  v_mfma_f32_32x32x16_bf16 v[56:71], v[200:203], v[168:171], v[56:71]
  v_exp_f32 v164, v164
  v_exp_f32 v165, v165
  v_exp_f32 v166, v166
  v_exp_f32 v167, v167
  v_cvt_pk_bf16_f32 v172, v160, v161
  v_cvt_pk_bf16_f32 v173, v162, v163
  v_cvt_pk_bf16_f32 v174, v164, v165
  v_cvt_pk_bf16_f32 v175, v166, v167
  v_mfma_f32_32x32x16_bf16 v[152:167], v[224:227], v[24:27], 0
  v_exp_f32 v136, v136
  v_exp_f32 v137, v137
  v_exp_f32 v138, v138
  v_mfma_f32_32x32x16_bf16 v[56:71], v[204:207], v[172:175], v[56:71]
  s_call_b64 s[72:73], .g2_kernel_a_ld1
  v_exp_f32 v139, v139
  v_exp_f32 v140, v140
  v_exp_f32 v141, v141
  v_smfmac_f32_16x16x64_bf16 v[120:123], v[16:19], v[168:175], v20
  v_exp_f32 v142, v142
  v_exp_f32 v143, v143
  v_mfma_f32_32x32x16_bf16 v[152:167], v[228:231], v[28:31], v[152:167]
  v_cvt_pk_bf16_f32 v168, v136, v137
  v_cvt_pk_bf16_f32 v169, v138, v139
  v_cvt_pk_bf16_f32 v170, v140, v141
  v_cvt_pk_bf16_f32 v171, v142, v143
  v_exp_f32 v144, v144
  v_exp_f32 v145, v145
  v_exp_f32 v146, v146
  v_exp_f32 v147, v147
  v_mfma_f32_32x32x16_bf16 v[56:71], v[216:219], v[168:171], v[56:71]
  v_exp_f32 v148, v148
  v_exp_f32 v149, v149
  v_exp_f32 v150, v150
  v_exp_f32 v151, v151
  v_cvt_pk_bf16_f32 v172, v144, v145
  v_cvt_pk_bf16_f32 v173, v146, v147
  v_cvt_pk_bf16_f32 v174, v148, v149
  v_cvt_pk_bf16_f32 v175, v150, v151
  v_exp_f32 v152, v152
  v_exp_f32 v153, v153
  v_exp_f32 v154, v154
  v_mfma_f32_32x32x16_bf16 v[56:71], v[220:223], v[172:175], v[56:71]
  s_call_b64 s[72:73], .g2_kernel_a_ld2
  v_exp_f32 v155, v155
  v_exp_f32 v156, v156
  v_exp_f32 v157, v157
  v_smfmac_f32_16x16x64_bf16 v[120:123], v[16:19], v[168:175], v20
  v_exp_f32 v158, v158
  v_exp_f32 v159, v159
  v_cvt_pk_bf16_f32 v168, v152, v153
  v_cvt_pk_bf16_f32 v169, v154, v155
  v_cvt_pk_bf16_f32 v170, v156, v157
  v_cvt_pk_bf16_f32 v171, v158, v159
  v_exp_f32 v160, v160
  v_exp_f32 v161, v161
  v_exp_f32 v162, v162
  v_exp_f32 v163, v163
  v_mfma_f32_32x32x16_bf16 v[56:71], v[232:235], v[168:171], v[56:71]
  v_exp_f32 v164, v164
  v_exp_f32 v165, v165
  v_exp_f32 v166, v166
  v_exp_f32 v167, v167
  v_cvt_pk_bf16_f32 v172, v160, v161
  v_cvt_pk_bf16_f32 v173, v162, v163
  v_cvt_pk_bf16_f32 v174, v164, v165
  v_cvt_pk_bf16_f32 v175, v166, v167
  s_nop 1
  v_mfma_f32_32x32x16_bf16 v[56:71], v[236:239], v[172:175], v[56:71]
  v_smfmac_f32_16x16x64_bf16 v[120:123], v[16:19], v[168:175], v20
  s_branch .g2_kernel_a_rde
.g2_kernel_a_rd1:
  s_cmp_lg_u32 s28, 1
  s_cbranch_scc1 .g2_kernel_a_rd2
  ds_read_b128 v[32:35], v14 offset:10240
  ds_read_b128 v[36:39], v14 offset:11264
  v_mov_b32 v124, 0
  v_mov_b32 v125, 0
  s_waitcnt lgkmcnt(0)
  v_mfma_f32_32x32x16_bf16 v[136:151], v[176:179], v[32:35], 0
  v_mfma_f32_32x32x16_bf16 v[136:151], v[180:183], v[36:39], v[136:151]
  v_mfma_f32_32x32x16_bf16 v[152:167], v[192:195], v[32:35], 0
  s_nop 10
  v_exp_f32 v136, v136
  v_exp_f32 v137, v137
  v_exp_f32 v138, v138
  v_exp_f32 v139, v139
  v_exp_f32 v140, v140
  v_exp_f32 v141, v141
  v_exp_f32 v142, v142
  v_exp_f32 v143, v143
  v_mfma_f32_32x32x16_bf16 v[152:167], v[196:199], v[36:39], v[152:167]
  v_cvt_pk_bf16_f32 v168, v136, v137
  v_cvt_pk_bf16_f32 v169, v138, v139
  v_cvt_pk_bf16_f32 v170, v140, v141
  v_cvt_pk_bf16_f32 v171, v142, v143
  v_exp_f32 v144, v144
  v_exp_f32 v145, v145
  v_exp_f32 v146, v146
  v_exp_f32 v147, v147
  v_mfma_f32_32x32x16_bf16 v[72:87], v[184:187], v[168:171], 0
  v_exp_f32 v148, v148
  v_exp_f32 v149, v149
  v_exp_f32 v150, v150
  v_exp_f32 v151, v151
  v_cvt_pk_bf16_f32 v172, v144, v145
  v_cvt_pk_bf16_f32 v173, v146, v147
  v_cvt_pk_bf16_f32 v174, v148, v149
  v_cvt_pk_bf16_f32 v175, v150, v151
  v_mfma_f32_32x32x16_bf16 v[136:151], v[208:211], v[32:35], 0
  v_exp_f32 v152, v152
  v_exp_f32 v153, v153
  v_exp_f32 v154, v154
  v_mfma_f32_32x32x16_bf16 v[72:87], v[188:191], v[172:175], v[72:87]
  s_call_b64 s[72:73], .g2_kernel_a_ld0
  v_exp_f32 v155, v155
  v_exp_f32 v156, v156
  v_exp_f32 v157, v157
  v_smfmac_f32_16x16x64_bf16 v[124:127], v[16:19], v[168:175], v20
  v_exp_f32 v158, v158
  v_exp_f32 v159, v159
  v_mfma_f32_32x32x16_bf16 v[136:151], v[212:215], v[36:39], v[136:151]
  v_cvt_pk_bf16_f32 v168, v152, v153
  v_cvt_pk_bf16_f32 v169, v154, v155
  v_cvt_pk_bf16_f32 v170, v156, v157
  v_cvt_pk_bf16_f32 v171, v158, v159
  v_exp_f32 v160, v160
  v_exp_f32 v161, v161
  v_exp_f32 v162, v162
  v_exp_f32 v163, v163
  v_mfma_f32_32x32x16_bf16 v[72:87], v[200:203], v[168:171], v[72:87]
  v_exp_f32 v164, v164
  v_exp_f32 v165, v165
  v_exp_f32 v166, v166
  v_exp_f32 v167, v167
  v_cvt_pk_bf16_f32 v172, v160, v161
  v_cvt_pk_bf16_f32 v173, v162, v163
  v_cvt_pk_bf16_f32 v174, v164, v165
  v_cvt_pk_bf16_f32 v175, v166, v167
  v_mfma_f32_32x32x16_bf16 v[152:167], v[224:227], v[32:35], 0
  v_exp_f32 v136, v136
  v_exp_f32 v137, v137
  v_exp_f32 v138, v138
  v_mfma_f32_32x32x16_bf16 v[72:87], v[204:207], v[172:175], v[72:87]
  s_call_b64 s[72:73], .g2_kernel_a_ld1
  v_exp_f32 v139, v139
  v_exp_f32 v140, v140
  v_exp_f32 v141, v141
  v_smfmac_f32_16x16x64_bf16 v[124:127], v[16:19], v[168:175], v20
  v_exp_f32 v142, v142
  v_exp_f32 v143, v143
  v_mfma_f32_32x32x16_bf16 v[152:167], v[228:231], v[36:39], v[152:167]
  v_cvt_pk_bf16_f32 v168, v136, v137
  v_cvt_pk_bf16_f32 v169, v138, v139
  v_cvt_pk_bf16_f32 v170, v140, v141
  v_cvt_pk_bf16_f32 v171, v142, v143
  v_exp_f32 v144, v144
  v_exp_f32 v145, v145
  v_exp_f32 v146, v146
  v_exp_f32 v147, v147
  v_mfma_f32_32x32x16_bf16 v[72:87], v[216:219], v[168:171], v[72:87]
  v_exp_f32 v148, v148
  v_exp_f32 v149, v149
  v_exp_f32 v150, v150
  v_exp_f32 v151, v151
  v_cvt_pk_bf16_f32 v172, v144, v145
  v_cvt_pk_bf16_f32 v173, v146, v147
  v_cvt_pk_bf16_f32 v174, v148, v149
  v_cvt_pk_bf16_f32 v175, v150, v151
  v_exp_f32 v152, v152
  v_exp_f32 v153, v153
  v_exp_f32 v154, v154
  v_mfma_f32_32x32x16_bf16 v[72:87], v[220:223], v[172:175], v[72:87]
  s_call_b64 s[72:73], .g2_kernel_a_ld2
  v_exp_f32 v155, v155
  v_exp_f32 v156, v156
  v_exp_f32 v157, v157
  v_smfmac_f32_16x16x64_bf16 v[124:127], v[16:19], v[168:175], v20
  v_exp_f32 v158, v158
  v_exp_f32 v159, v159
  v_cvt_pk_bf16_f32 v168, v152, v153
  v_cvt_pk_bf16_f32 v169, v154, v155
  v_cvt_pk_bf16_f32 v170, v156, v157
  v_cvt_pk_bf16_f32 v171, v158, v159
  v_exp_f32 v160, v160
  v_exp_f32 v161, v161
  v_exp_f32 v162, v162
  v_exp_f32 v163, v163
  v_mfma_f32_32x32x16_bf16 v[72:87], v[232:235], v[168:171], v[72:87]
  v_exp_f32 v164, v164
  v_exp_f32 v165, v165
  v_exp_f32 v166, v166
  v_exp_f32 v167, v167
  v_cvt_pk_bf16_f32 v172, v160, v161
  v_cvt_pk_bf16_f32 v173, v162, v163
  v_cvt_pk_bf16_f32 v174, v164, v165
  v_cvt_pk_bf16_f32 v175, v166, v167
  s_nop 1
  v_mfma_f32_32x32x16_bf16 v[72:87], v[236:239], v[172:175], v[72:87]
  v_smfmac_f32_16x16x64_bf16 v[124:127], v[16:19], v[168:175], v20
  s_branch .g2_kernel_a_rde
.g2_kernel_a_rd2:
  s_cmp_lg_u32 s28, 2
  s_cbranch_scc1 .g2_kernel_a_rd3
  ds_read_b128 v[40:43], v14 offset:12288
  ds_read_b128 v[44:47], v14 offset:13312
  v_mov_b32 v128, 0
  v_mov_b32 v129, 0
  s_waitcnt lgkmcnt(0)
  v_mfma_f32_32x32x16_bf16 v[136:151], v[176:179], v[40:43], 0
  v_mfma_f32_32x32x16_bf16 v[136:151], v[180:183], v[44:47], v[136:151]
  v_mfma_f32_32x32x16_bf16 v[152:167], v[192:195], v[40:43], 0
  s_nop 10
  v_exp_f32 v136, v136
  v_exp_f32 v137, v137
  v_exp_f32 v138, v138
  v_exp_f32 v139, v139
  v_exp_f32 v140, v140
  v_exp_f32 v141, v141
  v_exp_f32 v142, v142
  v_exp_f32 v143, v143
  v_mfma_f32_32x32x16_bf16 v[152:167], v[196:199], v[44:47], v[152:167]
  v_cvt_pk_bf16_f32 v168, v136, v137
  v_cvt_pk_bf16_f32 v169, v138, v139
  v_cvt_pk_bf16_f32 v170, v140, v141
  v_cvt_pk_bf16_f32 v171, v142, v143
  v_exp_f32 v144, v144
  v_exp_f32 v145, v145
  v_exp_f32 v146, v146
  v_exp_f32 v147, v147
  v_mfma_f32_32x32x16_bf16 v[88:103], v[184:187], v[168:171], 0
  v_exp_f32 v148, v148
  v_exp_f32 v149, v149
  v_exp_f32 v150, v150
  v_exp_f32 v151, v151
  v_cvt_pk_bf16_f32 v172, v144, v145
  v_cvt_pk_bf16_f32 v173, v146, v147
  v_cvt_pk_bf16_f32 v174, v148, v149
  v_cvt_pk_bf16_f32 v175, v150, v151
  v_mfma_f32_32x32x16_bf16 v[136:151], v[208:211], v[40:43], 0
  v_exp_f32 v152, v152
  v_exp_f32 v153, v153
  v_exp_f32 v154, v154
  v_mfma_f32_32x32x16_bf16 v[88:103], v[188:191], v[172:175], v[88:103]
  s_call_b64 s[72:73], .g2_kernel_a_ld0
  v_exp_f32 v155, v155
  v_exp_f32 v156, v156
  v_exp_f32 v157, v157
  v_smfmac_f32_16x16x64_bf16 v[128:131], v[16:19], v[168:175], v20
  v_exp_f32 v158, v158
  v_exp_f32 v159, v159
  v_mfma_f32_32x32x16_bf16 v[136:151], v[212:215], v[44:47], v[136:151]
  v_cvt_pk_bf16_f32 v168, v152, v153
  v_cvt_pk_bf16_f32 v169, v154, v155
  v_cvt_pk_bf16_f32 v170, v156, v157
  v_cvt_pk_bf16_f32 v171, v158, v159
  v_exp_f32 v160, v160
  v_exp_f32 v161, v161
  v_exp_f32 v162, v162
  v_exp_f32 v163, v163
  v_mfma_f32_32x32x16_bf16 v[88:103], v[200:203], v[168:171], v[88:103]
  v_exp_f32 v164, v164
  v_exp_f32 v165, v165
  v_exp_f32 v166, v166
  v_exp_f32 v167, v167
  v_cvt_pk_bf16_f32 v172, v160, v161
  v_cvt_pk_bf16_f32 v173, v162, v163
  v_cvt_pk_bf16_f32 v174, v164, v165
  v_cvt_pk_bf16_f32 v175, v166, v167
  v_mfma_f32_32x32x16_bf16 v[152:167], v[224:227], v[40:43], 0
  v_exp_f32 v136, v136
  v_exp_f32 v137, v137
  v_exp_f32 v138, v138
  v_mfma_f32_32x32x16_bf16 v[88:103], v[204:207], v[172:175], v[88:103]
  s_call_b64 s[72:73], .g2_kernel_a_ld1
  v_exp_f32 v139, v139
  v_exp_f32 v140, v140
  v_exp_f32 v141, v141
  v_smfmac_f32_16x16x64_bf16 v[128:131], v[16:19], v[168:175], v20
  v_exp_f32 v142, v142
  v_exp_f32 v143, v143
  v_mfma_f32_32x32x16_bf16 v[152:167], v[228:231], v[44:47], v[152:167]
  v_cvt_pk_bf16_f32 v168, v136, v137
  v_cvt_pk_bf16_f32 v169, v138, v139
  v_cvt_pk_bf16_f32 v170, v140, v141
  v_cvt_pk_bf16_f32 v171, v142, v143
  v_exp_f32 v144, v144
  v_exp_f32 v145, v145
  v_exp_f32 v146, v146
  v_exp_f32 v147, v147
  v_mfma_f32_32x32x16_bf16 v[88:103], v[216:219], v[168:171], v[88:103]
  v_exp_f32 v148, v148
  v_exp_f32 v149, v149
  v_exp_f32 v150, v150
  v_exp_f32 v151, v151
  v_cvt_pk_bf16_f32 v172, v144, v145
  v_cvt_pk_bf16_f32 v173, v146, v147
  v_cvt_pk_bf16_f32 v174, v148, v149
  v_cvt_pk_bf16_f32 v175, v150, v151
  v_exp_f32 v152, v152
  v_exp_f32 v153, v153
  v_exp_f32 v154, v154
  v_mfma_f32_32x32x16_bf16 v[88:103], v[220:223], v[172:175], v[88:103]
  s_call_b64 s[72:73], .g2_kernel_a_ld2
  v_exp_f32 v155, v155
  v_exp_f32 v156, v156
  v_exp_f32 v157, v157
  v_smfmac_f32_16x16x64_bf16 v[128:131], v[16:19], v[168:175], v20
  v_exp_f32 v158, v158
  v_exp_f32 v159, v159
  v_cvt_pk_bf16_f32 v168, v152, v153
  v_cvt_pk_bf16_f32 v169, v154, v155
  v_cvt_pk_bf16_f32 v170, v156, v157
  v_cvt_pk_bf16_f32 v171, v158, v159
  v_exp_f32 v160, v160
  v_exp_f32 v161, v161
  v_exp_f32 v162, v162
  v_exp_f32 v163, v163
  v_mfma_f32_32x32x16_bf16 v[88:103], v[232:235], v[168:171], v[88:103]
  v_exp_f32 v164, v164
  v_exp_f32 v165, v165
  v_exp_f32 v166, v166
  v_exp_f32 v167, v167
  v_cvt_pk_bf16_f32 v172, v160, v161
  v_cvt_pk_bf16_f32 v173, v162, v163
  v_cvt_pk_bf16_f32 v174, v164, v165
  v_cvt_pk_bf16_f32 v175, v166, v167
  s_nop 1
  v_mfma_f32_32x32x16_bf16 v[88:103], v[236:239], v[172:175], v[88:103]
  v_smfmac_f32_16x16x64_bf16 v[128:131], v[16:19], v[168:175], v20
  s_branch .g2_kernel_a_rde
.g2_kernel_a_rd3:
  ds_read_b128 v[48:51], v14 offset:14336
  ds_read_b128 v[52:55], v14 offset:15360
  v_mov_b32 v132, 0
  v_mov_b32 v133, 0
  s_waitcnt lgkmcnt(0)
  v_mfma_f32_32x32x16_bf16 v[136:151], v[176:179], v[48:51], 0
  v_mfma_f32_32x32x16_bf16 v[136:151], v[180:183], v[52:55], v[136:151]
  v_mfma_f32_32x32x16_bf16 v[152:167], v[192:195], v[48:51], 0
  s_nop 10
  v_exp_f32 v136, v136
  v_exp_f32 v137, v137
  v_exp_f32 v138, v138
  v_exp_f32 v139, v139
  v_exp_f32 v140, v140
  v_exp_f32 v141, v141
  v_exp_f32 v142, v142
  v_exp_f32 v143, v143
  v_mfma_f32_32x32x16_bf16 v[152:167], v[196:199], v[52:55], v[152:167]
  v_cvt_pk_bf16_f32 v168, v136, v137
  v_cvt_pk_bf16_f32 v169, v138, v139
  v_cvt_pk_bf16_f32 v170, v140, v141
  v_cvt_pk_bf16_f32 v171, v142, v143
  v_exp_f32 v144, v144
  v_exp_f32 v145, v145
  v_exp_f32 v146, v146
  v_exp_f32 v147, v147
  v_mfma_f32_32x32x16_bf16 v[104:119], v[184:187], v[168:171], 0
  v_exp_f32 v148, v148
  v_exp_f32 v149, v149
  v_exp_f32 v150, v150
  v_exp_f32 v151, v151
  v_cvt_pk_bf16_f32 v172, v144, v145
  v_cvt_pk_bf16_f32 v173, v146, v147
  v_cvt_pk_bf16_f32 v174, v148, v149
  v_cvt_pk_bf16_f32 v175, v150, v151
  v_mfma_f32_32x32x16_bf16 v[136:151], v[208:211], v[48:51], 0
  v_exp_f32 v152, v152
  v_exp_f32 v153, v153
  v_exp_f32 v154, v154
  v_mfma_f32_32x32x16_bf16 v[104:119], v[188:191], v[172:175], v[104:119]
  s_call_b64 s[72:73], .g2_kernel_a_ld0
  v_exp_f32 v155, v155
  v_exp_f32 v156, v156
  v_exp_f32 v157, v157
  v_smfmac_f32_16x16x64_bf16 v[132:135], v[16:19], v[168:175], v20
  v_exp_f32 v158, v158
  v_exp_f32 v159, v159
  v_mfma_f32_32x32x16_bf16 v[136:151], v[212:215], v[52:55], v[136:151]
  v_cvt_pk_bf16_f32 v168, v152, v153
  v_cvt_pk_bf16_f32 v169, v154, v155
  v_cvt_pk_bf16_f32 v170, v156, v157
  v_cvt_pk_bf16_f32 v171, v158, v159
  v_exp_f32 v160, v160
  v_exp_f32 v161, v161
  v_exp_f32 v162, v162
  v_exp_f32 v163, v163
  v_mfma_f32_32x32x16_bf16 v[104:119], v[200:203], v[168:171], v[104:119]
  v_exp_f32 v164, v164
  v_exp_f32 v165, v165
  v_exp_f32 v166, v166
  v_exp_f32 v167, v167
  v_cvt_pk_bf16_f32 v172, v160, v161
  v_cvt_pk_bf16_f32 v173, v162, v163
  v_cvt_pk_bf16_f32 v174, v164, v165
  v_cvt_pk_bf16_f32 v175, v166, v167
  v_mfma_f32_32x32x16_bf16 v[152:167], v[224:227], v[48:51], 0
  v_exp_f32 v136, v136
  v_exp_f32 v137, v137
  v_exp_f32 v138, v138
  v_mfma_f32_32x32x16_bf16 v[104:119], v[204:207], v[172:175], v[104:119]
  s_call_b64 s[72:73], .g2_kernel_a_ld1
  v_exp_f32 v139, v139
  v_exp_f32 v140, v140
  v_exp_f32 v141, v141
  v_smfmac_f32_16x16x64_bf16 v[132:135], v[16:19], v[168:175], v20
  v_exp_f32 v142, v142
  v_exp_f32 v143, v143
  v_mfma_f32_32x32x16_bf16 v[152:167], v[228:231], v[52:55], v[152:167]
  v_cvt_pk_bf16_f32 v168, v136, v137
  v_cvt_pk_bf16_f32 v169, v138, v139
  v_cvt_pk_bf16_f32 v170, v140, v141
  v_cvt_pk_bf16_f32 v171, v142, v143
  v_exp_f32 v144, v144
  v_exp_f32 v145, v145
  v_exp_f32 v146, v146
  v_exp_f32 v147, v147
  v_mfma_f32_32x32x16_bf16 v[104:119], v[216:219], v[168:171], v[104:119]
  v_exp_f32 v148, v148
  v_exp_f32 v149, v149
  v_exp_f32 v150, v150
  v_exp_f32 v151, v151
  v_cvt_pk_bf16_f32 v172, v144, v145
  v_cvt_pk_bf16_f32 v173, v146, v147
  v_cvt_pk_bf16_f32 v174, v148, v149
  v_cvt_pk_bf16_f32 v175, v150, v151
  v_exp_f32 v152, v152
  v_exp_f32 v153, v153
  v_exp_f32 v154, v154
  v_mfma_f32_32x32x16_bf16 v[104:119], v[220:223], v[172:175], v[104:119]
  s_call_b64 s[72:73], .g2_kernel_a_ld2
  v_exp_f32 v155, v155
  v_exp_f32 v156, v156
  v_exp_f32 v157, v157
  v_smfmac_f32_16x16x64_bf16 v[132:135], v[16:19], v[168:175], v20
  v_exp_f32 v158, v158
  v_exp_f32 v159, v159
  v_cvt_pk_bf16_f32 v168, v152, v153
  v_cvt_pk_bf16_f32 v169, v154, v155
  v_cvt_pk_bf16_f32 v170, v156, v157
  v_cvt_pk_bf16_f32 v171, v158, v159
  v_exp_f32 v160, v160
  v_exp_f32 v161, v161
  v_exp_f32 v162, v162
  v_exp_f32 v163, v163
  v_mfma_f32_32x32x16_bf16 v[104:119], v[232:235], v[168:171], v[104:119]
  v_exp_f32 v164, v164
  v_exp_f32 v165, v165
  v_exp_f32 v166, v166
  v_exp_f32 v167, v167
  v_cvt_pk_bf16_f32 v172, v160, v161
  v_cvt_pk_bf16_f32 v173, v162, v163
  v_cvt_pk_bf16_f32 v174, v164, v165
  v_cvt_pk_bf16_f32 v175, v166, v167
  s_nop 1
  v_mfma_f32_32x32x16_bf16 v[104:119], v[236:239], v[172:175], v[104:119]
  v_smfmac_f32_16x16x64_bf16 v[132:135], v[16:19], v[168:175], v20
  s_branch .g2_kernel_a_rde
.g2_kernel_a_rd4:
.g2_kernel_a_rde:
  v_mov_b32 v168, 0
  v_mov_b32 v169, 0
  v_mov_b32 v170, 0
  v_mov_b32 v171, 0
  v_mov_b32 v172, 0
  v_mov_b32 v173, 0
  v_mov_b32 v174, 0
  v_mov_b32 v175, 0
  s_waitcnt vmcnt(8)
  v_mfma_f32_32x32x16_bf16 v[136:151], v[176:179], v[24:27], 0
  v_mfma_f32_32x32x16_bf16 v[136:151], v[180:183], v[28:31], v[136:151]
  v_mfma_f32_32x32x16_bf16 v[152:167], v[176:179], v[32:35], 0
  s_nop 10
  s_branch .g2_kernel_a_loop
.g2_kernel_a_ld0:
  s_andn2_b32 s33, s36, s34
  s_cbranch_scc0 .g2_kernel_a_r0c
.g2_kernel_a_r0b:
  s_ff1_i32_b32 s33, s33
  s_bitset1_b32 s34, s33
  s_xor_b32 s33, s33, s24
  s_lshl_b32 s33, s33, s25
  s_add_u32 s22, s20, s33
  s_addc_u32 s23, s21, 0
  global_load_dwordx4 v[176:179], v3, s[22:23] offset:0
  global_load_dwordx4 v[180:183], v3, s[22:23] offset:1024
  global_load_dwordx4 v[184:187], v3, s[22:23] offset:2048
  global_load_dwordx4 v[188:191], v3, s[22:23] offset:3072
  s_setpc_b64 s[72:73]
.g2_kernel_a_ld1:
  s_andn2_b32 s33, s36, s34
  s_cbranch_scc0 .g2_kernel_a_r1c
.g2_kernel_a_r1b:
  s_ff1_i32_b32 s33, s33
  s_bitset1_b32 s34, s33
  s_xor_b32 s33, s33, s24
  s_lshl_b32 s33, s33, s25
  s_add_u32 s22, s20, s33
  s_addc_u32 s23, s21, 0
  global_load_dwordx4 v[192:195], v3, s[22:23] offset:0
  global_load_dwordx4 v[196:199], v3, s[22:23] offset:1024
  global_load_dwordx4 v[200:203], v3, s[22:23] offset:2048
  global_load_dwordx4 v[204:207], v3, s[22:23] offset:3072
  s_setpc_b64 s[72:73]
.g2_kernel_a_ld2:
  s_andn2_b32 s33, s36, s34
  s_cbranch_scc0 .g2_kernel_a_r2c
.g2_kernel_a_r2b:
  s_ff1_i32_b32 s33, s33
  s_bitset1_b32 s34, s33
  s_xor_b32 s33, s33, s24
  s_lshl_b32 s33, s33, s25
  s_add_u32 s22, s20, s33
  s_addc_u32 s23, s21, 0
  global_load_dwordx4 v[208:211], v3, s[22:23] offset:0
  global_load_dwordx4 v[212:215], v3, s[22:23] offset:1024
  global_load_dwordx4 v[216:219], v3, s[22:23] offset:2048
  global_load_dwordx4 v[220:223], v3, s[22:23] offset:3072
  s_setpc_b64 s[72:73]
.g2_kernel_a_N0c:
  s_call_b64 s[68:69], .g2_kernel_a_pick
  s_branch .g2_kernel_a_N0b
.g2_kernel_a_N1c:
  s_call_b64 s[68:69], .g2_kernel_a_pick
  s_branch .g2_kernel_a_N1b
.g2_kernel_a_N2c:
  s_call_b64 s[68:69], .g2_kernel_a_pick
  s_branch .g2_kernel_a_N2b
.g2_kernel_a_N3c:
  s_call_b64 s[68:69], .g2_kernel_a_pick
  s_branch .g2_kernel_a_N3b
.g2_kernel_a_L3c:
  s_call_b64 s[68:69], .g2_kernel_a_pick
  s_branch .g2_kernel_a_L3b
.g2_kernel_a_G0c:
  s_call_b64 s[68:69], .g2_kernel_a_pick
  s_branch .g2_kernel_a_G0b
.g2_kernel_a_L3g:
  s_mov_b32 s38, 0
.g2_kernel_a_L3gl:
  ds_read_b32 v7, v13 offset:8
  s_add_u32 s38, s38, 1
  s_waitcnt lgkmcnt(0)
  v_cmp_gt_u32 vcc, s27, v7
  s_cbranch_vccz .g2_kernel_a_L3h
  s_cmp_lt_u32 s38, 524288
  s_cbranch_scc1 .g2_kernel_a_L3gl
  s_branch .g2_kernel_a_L3h
.g2_kernel_a_hold:
  s_lshl_b32 s33, 1, s14
  s_lshr_b32 s14, s14, 8
  s_setpc_b64 s[68:69]
.g2_kernel_a_pick:
  s_cmp_lg_u32 s34, -1
  s_cbranch_scc1 .g2_kernel_a_pk1
  s_cmp_eq_u32 s26, -1
  s_cbranch_scc1 .g2_kernel_a_hold
  s_add_u32 s26, s26, 1
  s_mov_b32 s34, 0xffff
  s_cmp_eq_u32 s26, 1
  s_cbranch_scc1 .g2_kernel_a_pk0
  v_and_b32 v8, 15, v2
  s_lshl_b32 s28, s16, 6
  s_add_u32 s28, s28, 157696
  v_lshl_add_u32 v8, v8, 2, s28
  s_lshl_b32 s28, s17, 2
  s_add_u32 s28, s28, s16
  s_lshl_b32 s28, s28, 16
  s_add_u32 s28, s28, s63
  s_add_u32 s28, s28, 0x800000
  s_add_u32 s20, s60, s28
  s_addc_u32 s21, s61, 0
  s_lshl_b32 s24, s18, 1
  s_and_b32 s24, s24, 6
  s_mov_b32 s25, 12
  s_mov_b32 s34, 0
  s_mov_b32 s36, 0xff
  s_mov_b32 s33, 0xff
  s_mov_b32 s38, 0
.g2_kernel_a_pk2:
  ds_read_b32 v7, v8
  s_add_u32 s38, s38, 1
  s_waitcnt lgkmcnt(0)
  v_cmp_ge_u32 vcc, s62, v7
  s_cbranch_vccz .g2_kernel_a_pkr
  s_cmp_lt_u32 s38, 524288
  s_cbranch_scc1 .g2_kernel_a_pk2
  s_branch .g2_kernel_a_pkr
.g2_kernel_a_pk0:
  s_andn2_b32 s33, s36, s34
  s_cbranch_scc1 .g2_kernel_a_pkr
.g2_kernel_a_pk1:
  s_mov_b32 s38, 0
.g2_kernel_a_pkl:
  ds_read_b32 v7, v8
  s_add_u32 s38, s38, 1
  s_waitcnt lgkmcnt(0)
  v_cmp_lt_u32 vcc, s62, v7
  s_mov_b32 s36, vcc_lo
  s_andn2_b32 s33, s36, s34
  s_cbranch_scc1 .g2_kernel_a_pkr
  s_cmp_lt_u32 s38, 524288
  s_cbranch_scc1 .g2_kernel_a_pkl
  s_not_b32 s33, s34
.g2_kernel_a_pkr:
  s_setpc_b64 s[68:69]
.g2_kernel_w_aw:
  v_mov_b32 v6, s71
  s_mov_b32 s38, 0
.g2_kernel_wg6:
  ds_read_b32 v7, v6 offset:52
  s_add_u32 s38, s38, 1
  s_waitcnt lgkmcnt(0)
  v_cmp_gt_u32 vcc, 4, v7
  s_cbranch_vccz .g2_kernel_wg6d
  s_sleep 1
  s_cmp_lt_u32 s38, 524288
  s_cbranch_scc1 .g2_kernel_wg6
.g2_kernel_wg6d:
  s_branch .g2_kernel_w_ab
.g2_kernel_w_pt:
  v_lshlrev_b32 v7, 5, v17
  v_add_u32 v7, 155648, v7
  s_mov_b64 exec, vcc
  ds_read_b128 v[240:243], v7 offset:7680
  ds_read_b128 v[244:247], v7 offset:7696
  ds_read_b128 v[248:251], v7 offset:7744
  ds_read_b128 v[252:255], v7 offset:7760
  s_waitcnt lgkmcnt(0)
  v_pk_add_f32 v[24:25], v[24:25], v[240:241]
  v_pk_add_f32 v[26:27], v[26:27], v[242:243]
  v_pk_add_f32 v[28:29], v[28:29], v[244:245]
  v_pk_add_f32 v[30:31], v[30:31], v[246:247]
  v_pk_add_f32 v[32:33], v[32:33], v[248:249]
  v_pk_add_f32 v[34:35], v[34:35], v[250:251]
  v_pk_add_f32 v[36:37], v[36:37], v[252:253]
  v_pk_add_f32 v[38:39], v[38:39], v[254:255]
  ds_read_b128 v[240:243], v7 offset:7808
  ds_read_b128 v[244:247], v7 offset:7824
  ds_read_b128 v[248:251], v7 offset:7872
  ds_read_b128 v[252:255], v7 offset:7888
  s_waitcnt lgkmcnt(0)
  v_pk_add_f32 v[40:41], v[40:41], v[240:241]
  v_pk_add_f32 v[42:43], v[42:43], v[242:243]
  v_pk_add_f32 v[44:45], v[44:45], v[244:245]
  v_pk_add_f32 v[46:47], v[46:47], v[246:247]
  v_pk_add_f32 v[48:49], v[48:49], v[248:249]
  v_pk_add_f32 v[50:51], v[50:51], v[250:251]
  v_pk_add_f32 v[52:53], v[52:53], v[252:253]
  v_pk_add_f32 v[54:55], v[54:55], v[254:255]
  s_mov_b64 exec, -1
  s_branch .g2_kernel_w_pb
.g2_kernel_w_i8c:
  s_mov_b32 s38, 0
  s_call_b64 s[68:69], .g2_kernel_w_pkl
  s_branch .g2_kernel_w_i8b
.g2_kernel_w_i9c:
  s_mov_b32 s38, 0
  s_call_b64 s[68:69], .g2_kernel_w_pkl
  s_branch .g2_kernel_w_i9b
.g2_kernel_w_i10c:
  s_mov_b32 s38, 0
  s_call_b64 s[68:69], .g2_kernel_w_pkl
  s_branch .g2_kernel_w_i10b
.g2_kernel_w_i11c:
  s_mov_b32 s38, 0
  s_call_b64 s[68:69], .g2_kernel_w_pkl
  s_branch .g2_kernel_w_i11b
.g2_kernel_w_v8:
  s_cmp_ge_u32 s8, 139264
  s_cselect_b32 s28, 139264, 0
  s_sub_u32 s28, s8, s28
  s_lshr_b32 s28, s28, 1
  s_add_u32 s28, s28, 32768
  s_add_u32 s22, s20, s28
  s_addc_u32 s23, s21, 0
  s_mov_b32 s38, 0
.g2_kernel_w_vl8:
  global_load_dwordx4 v[88:91], v3, s[22:23] offset:0 sc1
  global_load_dwordx4 v[92:95], v3, s[22:23] offset:1024 sc1
  global_load_dwordx4 v[96:99], v3, s[22:23] offset:2048 sc1
  global_load_dwordx4 v[100:103], v3, s[22:23] offset:3072 sc1
  s_add_u32 s38, s38, 1
  s_waitcnt vmcnt(0)
  v_min3_u32 v6, v88, v90, v92
  v_min3_u32 v7, v94, v96, v98
  v_min3_u32 v6, v6, v100, v102
  v_min_u32 v6, v6, v7
  v_cmp_eq_u32 vcc, 0, v6
  s_cbranch_vccz .g2_kernel_w_vb8
  s_cmp_lt_u32 s38, 131072
  s_cbranch_scc1 .g2_kernel_w_vl8
  s_branch .g2_kernel_w_vb8
.g2_kernel_w_i12c:
  s_mov_b32 s38, 0
  s_call_b64 s[68:69], .g2_kernel_w_pkl
  s_branch .g2_kernel_w_i12b
.g2_kernel_w_v9:
  s_cmp_ge_u32 s9, 139264
  s_cselect_b32 s28, 139264, 0
  s_sub_u32 s28, s9, s28
  s_lshr_b32 s28, s28, 1
  s_add_u32 s28, s28, 32768
  s_add_u32 s22, s20, s28
  s_addc_u32 s23, s21, 0
  s_mov_b32 s38, 0
.g2_kernel_w_vl9:
  global_load_dwordx4 v[176:179], v3, s[22:23] offset:0 sc1
  global_load_dwordx4 v[180:183], v3, s[22:23] offset:1024 sc1
  global_load_dwordx4 v[184:187], v3, s[22:23] offset:2048 sc1
  global_load_dwordx4 v[188:191], v3, s[22:23] offset:3072 sc1
  s_add_u32 s38, s38, 1
  s_waitcnt vmcnt(0)
  v_min3_u32 v6, v176, v178, v180
  v_min3_u32 v7, v182, v184, v186
  v_min3_u32 v6, v6, v188, v190
  v_min_u32 v6, v6, v7
  v_cmp_eq_u32 vcc, 0, v6
  s_cbranch_vccz .g2_kernel_w_vb9
  s_cmp_lt_u32 s38, 131072
  s_cbranch_scc1 .g2_kernel_w_vl9
  s_branch .g2_kernel_w_vb9
.g2_kernel_w_i13c:
  s_mov_b32 s38, 0
  s_call_b64 s[68:69], .g2_kernel_w_pkl
  s_branch .g2_kernel_w_i13b
.g2_kernel_w_v10:
  s_cmp_ge_u32 s10, 139264
  s_cselect_b32 s28, 139264, 0
  s_sub_u32 s28, s10, s28
  s_lshr_b32 s28, s28, 1
  s_add_u32 s28, s28, 32768
  s_add_u32 s22, s20, s28
  s_addc_u32 s23, s21, 0
  s_mov_b32 s38, 0
.g2_kernel_w_vl10:
  global_load_dwordx4 v[192:195], v3, s[22:23] offset:0 sc1
  global_load_dwordx4 v[196:199], v3, s[22:23] offset:1024 sc1
  global_load_dwordx4 v[200:203], v3, s[22:23] offset:2048 sc1
  global_load_dwordx4 v[204:207], v3, s[22:23] offset:3072 sc1
  s_add_u32 s38, s38, 1
  s_waitcnt vmcnt(0)
  v_min3_u32 v6, v192, v194, v196
  v_min3_u32 v7, v198, v200, v202
  v_min3_u32 v6, v6, v204, v206
  v_min_u32 v6, v6, v7
  v_cmp_eq_u32 vcc, 0, v6
  s_cbranch_vccz .g2_kernel_w_vb10
  s_cmp_lt_u32 s38, 131072
  s_cbranch_scc1 .g2_kernel_w_vl10
  s_branch .g2_kernel_w_vb10
.g2_kernel_w_i14c:
  s_mov_b32 s38, 524288
  s_call_b64 s[68:69], .g2_kernel_w_pkl
  s_branch .g2_kernel_w_i14b
.g2_kernel_w_v11:
  s_cmp_ge_u32 s11, 139264
  s_cselect_b32 s28, 139264, 0
  s_sub_u32 s28, s11, s28
  s_lshr_b32 s28, s28, 1
  s_add_u32 s28, s28, 32768
  s_add_u32 s22, s20, s28
  s_addc_u32 s23, s21, 0
  s_mov_b32 s38, 0
.g2_kernel_w_vl11:
  global_load_dwordx4 v[208:211], v3, s[22:23] offset:0 sc1
  global_load_dwordx4 v[212:215], v3, s[22:23] offset:1024 sc1
  global_load_dwordx4 v[216:219], v3, s[22:23] offset:2048 sc1
  global_load_dwordx4 v[220:223], v3, s[22:23] offset:3072 sc1
  s_add_u32 s38, s38, 1
  s_waitcnt vmcnt(0)
  v_min3_u32 v6, v208, v210, v212
  v_min3_u32 v7, v214, v216, v218
  v_min3_u32 v6, v6, v220, v222
  v_min_u32 v6, v6, v7
  v_cmp_eq_u32 vcc, 0, v6
  s_cbranch_vccz .g2_kernel_w_vb11
  s_cmp_lt_u32 s38, 131072
  s_cbranch_scc1 .g2_kernel_w_vl11
  s_branch .g2_kernel_w_vb11
.g2_kernel_w_i15c:
  s_mov_b32 s38, 524288
  s_call_b64 s[68:69], .g2_kernel_w_pkl
  s_branch .g2_kernel_w_i15b
.g2_kernel_w_v12:
  s_cmp_ge_u32 s12, 139264
  s_cselect_b32 s28, 139264, 0
  s_sub_u32 s28, s12, s28
  s_lshr_b32 s28, s28, 1
  s_add_u32 s28, s28, 32768
  s_add_u32 s22, s20, s28
  s_addc_u32 s23, s21, 0
  s_mov_b32 s38, 0
.g2_kernel_w_vl12:
  global_load_dwordx4 v[224:227], v3, s[22:23] offset:0 sc1
  global_load_dwordx4 v[228:231], v3, s[22:23] offset:1024 sc1
  global_load_dwordx4 v[232:235], v3, s[22:23] offset:2048 sc1
  global_load_dwordx4 v[236:239], v3, s[22:23] offset:3072 sc1
  s_add_u32 s38, s38, 1
  s_waitcnt vmcnt(0)
  v_min3_u32 v6, v224, v226, v228
  v_min3_u32 v7, v230, v232, v234
  v_min3_u32 v6, v6, v236, v238
  v_min_u32 v6, v6, v7
  v_cmp_eq_u32 vcc, 0, v6
  s_cbranch_vccz .g2_kernel_w_vb12
  s_cmp_lt_u32 s38, 131072
  s_cbranch_scc1 .g2_kernel_w_vl12
  s_branch .g2_kernel_w_vb12
.g2_kernel_w_v13:
  s_cmp_ge_u32 s13, 139264
  s_cselect_b32 s28, 139264, 0
  s_sub_u32 s28, s13, s28
  s_lshr_b32 s28, s28, 1
  s_add_u32 s28, s28, 32768
  s_add_u32 s22, s20, s28
  s_addc_u32 s23, s21, 0
  s_mov_b32 s38, 0
.g2_kernel_w_vl13:
  global_load_dwordx4 v[136:139], v3, s[22:23] offset:0 sc1
  global_load_dwordx4 v[140:143], v3, s[22:23] offset:1024 sc1
  global_load_dwordx4 v[144:147], v3, s[22:23] offset:2048 sc1
  global_load_dwordx4 v[148:151], v3, s[22:23] offset:3072 sc1
  s_add_u32 s38, s38, 1
  s_waitcnt vmcnt(0)
  v_min3_u32 v6, v136, v138, v140
  v_min3_u32 v7, v142, v144, v146
  v_min3_u32 v6, v6, v148, v150
  v_min_u32 v6, v6, v7
  v_cmp_eq_u32 vcc, 0, v6
  s_cbranch_vccz .g2_kernel_w_vb13
  s_cmp_lt_u32 s38, 131072
  s_cbranch_scc1 .g2_kernel_w_vl13
  s_branch .g2_kernel_w_vb13
.g2_kernel_w_v14:
  s_cmp_ge_u32 s14, 139264
  s_cselect_b32 s28, 139264, 0
  s_sub_u32 s28, s14, s28
  s_lshr_b32 s28, s28, 1
  s_add_u32 s28, s28, 32768
  s_add_u32 s22, s20, s28
  s_addc_u32 s23, s21, 0
  s_mov_b32 s38, 0
.g2_kernel_w_vl14:
  global_load_dwordx4 v[152:155], v3, s[22:23] offset:0 sc1
  global_load_dwordx4 v[156:159], v3, s[22:23] offset:1024 sc1
  global_load_dwordx4 v[160:163], v3, s[22:23] offset:2048 sc1
  global_load_dwordx4 v[164:167], v3, s[22:23] offset:3072 sc1
  s_add_u32 s38, s38, 1
  s_waitcnt vmcnt(0)
  v_min3_u32 v6, v152, v154, v156
  v_min3_u32 v7, v158, v160, v162
  v_min3_u32 v6, v6, v164, v166
  v_min_u32 v6, v6, v7
  v_cmp_eq_u32 vcc, 0, v6
  s_cbranch_vccz .g2_kernel_w_vb14
  s_cmp_lt_u32 s38, 131072
  s_cbranch_scc1 .g2_kernel_w_vl14
  s_branch .g2_kernel_w_vb14
.g2_kernel_w_v15:
  s_cmp_ge_u32 s15, 139264
  s_cselect_b32 s28, 139264, 0
  s_sub_u32 s28, s15, s28
  s_lshr_b32 s28, s28, 1
  s_add_u32 s28, s28, 32768
  s_add_u32 s22, s20, s28
  s_addc_u32 s23, s21, 0
  s_mov_b32 s38, 0
.g2_kernel_w_vl15:
  global_load_dwordx4 v[56:59], v3, s[22:23] offset:0 sc1
  global_load_dwordx4 v[60:63], v3, s[22:23] offset:1024 sc1
  global_load_dwordx4 v[64:67], v3, s[22:23] offset:2048 sc1
  global_load_dwordx4 v[68:71], v3, s[22:23] offset:3072 sc1
  s_add_u32 s38, s38, 1
  s_waitcnt vmcnt(0)
  v_min3_u32 v6, v56, v58, v60
  v_min3_u32 v7, v62, v64, v66
  v_min3_u32 v6, v6, v68, v70
  v_min_u32 v6, v6, v7
  v_cmp_eq_u32 vcc, 0, v6
  s_cbranch_vccz .g2_kernel_w_vb15
  s_cmp_lt_u32 s38, 131072
  s_cbranch_scc1 .g2_kernel_w_vl15
  s_branch .g2_kernel_w_vb15
.g2_kernel_w_bw:
  s_mov_b32 s38, 0
.g2_kernel_w_bwl:
  ds_read_b32 v16, v20 offset:12
  s_add_u32 s38, s38, 1
  s_waitcnt lgkmcnt(0)
  v_cmp_gt_u32 vcc, 4, v16
  s_cbranch_vccz .g2_kernel_w_bb
  s_cmp_lt_u32 s38, 524288
  s_cbranch_scc1 .g2_kernel_w_bwl
  s_branch .g2_kernel_w_bb
.g2_kernel_w_pick:
  s_mov_b32 s38, 0
.g2_kernel_w_pkl:
  ds_read_b64 v[6:7], v21
  s_add_u32 s38, s38, 1
  s_waitcnt lgkmcnt(0)
  v_min_u32 v6, v6, v7
  v_cmp_lt_u32 vcc, s62, v6
  s_and_b32 s36, vcc_lo, 0xff00
  s_andn2_b32 s33, s36, s34
  s_cbranch_scc1 .g2_kernel_w_pkr
  s_cmp_lt_u32 s38, 524288
  s_cbranch_scc1 .g2_kernel_w_pkl
  s_andn2_b32 s33, 0xff00, s34
.g2_kernel_w_pkr:
  s_setpc_b64 s[68:69]
.g2_kernel_p_spin:
  s_mov_b32 s38, 0
.g2_kernel_p_spinl:
  ds_read_b32 v10, v9
  s_add_u32 s38, s38, 1
  s_waitcnt lgkmcnt(0)
  v_cmp_gt_i32 vcc, s34, v10
  s_cbranch_vccz .g2_kernel_p_spinr
  s_sleep 1
  s_cmp_lt_u32 s38, 524288
  s_cbranch_scc1 .g2_kernel_p_spinl
.g2_kernel_p_spinr:
  s_setpc_b64 s[68:69]
.g2_kernel_p1_aw:
  s_call_b64 s[68:69], .g2_kernel_p_spin
  s_branch .g2_kernel_p1_ai
.g2_kernel_p1_bw:
  s_call_b64 s[68:69], .g2_kernel_p_spin
  s_branch .g2_kernel_p1_bi
.g2_kernel_v_3a:
  s_and_b32 s31, s76, 0xffffe000
  s_add_u32 s31, s31, 0
  v_and_b32 v6, 15, v2
  v_lshlrev_b32 v6, 9, v6
  v_lshrrev_b32 v7, 4, v2
  v_lshl_add_u32 v6, v7, 7, v6
  v_lshlrev_b32 v7, 2, v2
  v_add_u32 v7, 157440, v7
  s_mov_b32 m0, 157440
  s_mov_b32 s38, 0
  s_mov_b32 exec_lo, 0xffff0000
  s_mov_b32 exec_hi, 0xffff0000
.g2_kernel_pa25:
  buffer_load_dword v6, s[4:7], s31 offen sc1 lds
  s_add_u32 s38, s38, 1
  s_waitcnt vmcnt(0)
  ds_read_b32 v8, v7
  s_waitcnt lgkmcnt(0)
  v_cmp_ge_u32 vcc, s62, v8
  s_cbranch_vccz .g2_kernel_pa25d
  s_mov_b64 exec, vcc
  s_sleep 16
  s_cmp_lt_u32 s38, 131072
  s_cbranch_scc1 .g2_kernel_pa25
.g2_kernel_pa25d:
  s_mov_b64 exec, -1
  s_branch .g2_kernel_v_3
.g2_kernel_v_may:
  s_cmp_lg_u32 s39, 0
  s_cbranch_scc1 .g2_kernel_v_mr
  s_and_b32 s28, s16, 3
  s_lshl_b32 s28, s28, 4
  s_add_u32 s28, s28, 155968
  v_mov_b32 v6, s28
  ds_read_b32 v7, v6
  s_waitcnt lgkmcnt(0)
  v_cmp_ne_u32 vcc, 0, v7
  s_cbranch_vccz .g2_kernel_v_mr
.g2_kernel_v_do:
  s_mov_b32 s39, 1
  s_mov_b32 s29, 0
  s_call_b64 s[68:69], .g2_kernel_v_cmb
  s_waitcnt vmcnt(0)
  v_mov_b32 v6, s71
  s_mov_b64 exec, 1
  ds_add_u32 v6, v5 offset:8
  s_mov_b64 exec, -1
  s_and_b32 s33, s16, 3
  s_lshl_b32 s33, s33, 7
  s_lshl_b32 s28, s29, 2
  s_add_u32 s33, s33, s28
  s_add_u32 s31, s19, s33
  v_mov_b32 v6, s70
  s_mov_b64 exec, 1
  buffer_store_dword v6, v4, s[4:7], s31 offen offset:0 sc1
  s_mov_b64 exec, -1
.g2_kernel_v_mr:
  s_setpc_b64 s[26:27]
.g2_kernel_v_w23:
  ds_write_b128 v3, v[128:131] offset:32768
  ds_write_b128 v3, v[132:135] offset:33792
  ds_write_b128 v3, v[136:139] offset:34816
  ds_write_b128 v3, v[140:143] offset:35840
  ds_write_b128 v3, v[144:147] offset:36864
  ds_write_b128 v3, v[148:151] offset:37888
  ds_write_b128 v3, v[152:155] offset:38912
  ds_write_b128 v3, v[156:159] offset:39936
  ds_write_b128 v3, v[160:163] offset:40960
  ds_write_b128 v3, v[164:167] offset:41984
  ds_write_b128 v3, v[168:171] offset:43008
  ds_write_b128 v3, v[172:175] offset:44032
  ds_write_b128 v3, v[176:179] offset:45056
  ds_write_b128 v3, v[180:183] offset:46080
  ds_write_b128 v3, v[184:187] offset:47104
  ds_write_b128 v3, v[188:191] offset:48128
  ds_write_b128 v3, v[192:195] offset:49152
  ds_write_b128 v3, v[196:199] offset:50176
  ds_write_b128 v3, v[200:203] offset:51200
  ds_write_b128 v3, v[204:207] offset:52224
  ds_write_b128 v3, v[208:211] offset:53248
  ds_write_b128 v3, v[212:215] offset:54272
  ds_write_b128 v3, v[216:219] offset:55296
  ds_write_b128 v3, v[220:223] offset:56320
  ds_write_b128 v3, v[224:227] offset:57344
  ds_write_b128 v3, v[228:231] offset:58368
  ds_write_b128 v3, v[232:235] offset:59392
  ds_write_b128 v3, v[236:239] offset:60416
  ds_write_b128 v3, v[240:243] offset:61440
  ds_write_b128 v3, v[244:247] offset:62464
  ds_write_b128 v3, v[248:251] offset:63488
  ds_write_b128 v3, v[252:255] offset:64512
  s_setpc_b64 s[68:69]
.g2_kernel_v_wo:
  s_mov_b32 s8, s44
  s_mov_b32 s9, s45
  s_mov_b32 s10, 0x200000
  s_mov_b32 s11, 0x00020000
  v_lshrrev_b32 v6, 3, v2
  v_and_b32 v7, 7, v2
  v_bfe_u32 v8, v2, 4, 1
  v_lshlrev_b32 v8, 2, v8
  v_xor_b32 v7, v7, v8
  v_lshlrev_b32 v7, 4, v7
  v_lshl_add_u32 v6, v6, 11, v7
  s_lshl_b32 s31, s32, 3
  s_add_u32 s31, s31, s29
  s_lshl_b32 s31, s31, 16
  s_lshl_b32 s33, s18, 7
  s_add_u32 s31, s31, s33
  s_mov_b32 m0, s30
  s_nop 0
  buffer_load_dwordx4 v6, s[8:11], s31 offen lds
  s_add_u32 m0, m0, 1024
  s_add_u32 s31, s31, 16384
  s_sleep 1
  buffer_load_dwordx4 v6, s[8:11], s31 offen lds
  s_add_u32 m0, m0, 1024
  s_add_u32 s31, s31, 16384
  s_sleep 1
  buffer_load_dwordx4 v6, s[8:11], s31 offen lds
  s_add_u32 m0, m0, 1024
  s_add_u32 s31, s31, 16384
  s_sleep 1
  buffer_load_dwordx4 v6, s[8:11], s31 offen lds
  s_add_u32 m0, m0, 1024
  s_add_u32 s31, s31, 81920
  s_sleep 1
  buffer_load_dwordx4 v6, s[8:11], s31 offen lds
  s_add_u32 m0, m0, 1024
  s_add_u32 s31, s31, 16384
  s_sleep 1
  buffer_load_dwordx4 v6, s[8:11], s31 offen lds
  s_add_u32 m0, m0, 1024
  s_add_u32 s31, s31, 16384
  s_sleep 1
  buffer_load_dwordx4 v6, s[8:11], s31 offen lds
  s_add_u32 m0, m0, 1024
  s_add_u32 s31, s31, 16384
  s_sleep 1
  buffer_load_dwordx4 v6, s[8:11], s31 offen lds
  s_add_u32 m0, m0, 1024
  s_add_u32 s31, s31, 81920
  s_sleep 1
  buffer_load_dwordx4 v6, s[8:11], s31 offen lds
  s_add_u32 m0, m0, 1024
  s_add_u32 s31, s31, 16384
  s_sleep 1
  buffer_load_dwordx4 v6, s[8:11], s31 offen lds
  s_add_u32 m0, m0, 1024
  s_add_u32 s31, s31, 16384
  s_sleep 1
  buffer_load_dwordx4 v6, s[8:11], s31 offen lds
  s_add_u32 m0, m0, 1024
  s_add_u32 s31, s31, 16384
  s_sleep 1
  buffer_load_dwordx4 v6, s[8:11], s31 offen lds
  s_add_u32 m0, m0, 1024
  s_add_u32 s31, s31, 81920
  s_sleep 1
  buffer_load_dwordx4 v6, s[8:11], s31 offen lds
  s_add_u32 m0, m0, 1024
  s_add_u32 s31, s31, 16384
  s_sleep 1
  buffer_load_dwordx4 v6, s[8:11], s31 offen lds
  s_add_u32 m0, m0, 1024
  s_add_u32 s31, s31, 16384
  s_sleep 1
  buffer_load_dwordx4 v6, s[8:11], s31 offen lds
  s_add_u32 m0, m0, 1024
  s_add_u32 s31, s31, 16384
  s_sleep 1
  buffer_load_dwordx4 v6, s[8:11], s31 offen lds
  s_setpc_b64 s[68:69]
.g2_kernel_v_cmb:
  s_and_b32 s28, s16, 3
  s_lshl_b32 s30, s28, 2
  s_lshl_b32 s34, 15, s30
  s_lshr_b32 s32, s34, 4
  s_or_b32 s32, s32, s34
  s_mul_i32 s32, s32, s29
  v_and_b32 v6, 15, v2
  v_lshlrev_b32 v6, 2, v6
  v_add_u32 v6, 155968, v6
  s_mov_b32 s30, .g2_kernel_sel-.g2_kernel_pc
  buffer_load_dwordx4 v[8:11], v3, s[64:67], s30 offen
  buffer_load_dwordx4 v[12:15], v3, s[64:67], s30 offen offset:1024
  s_lshl_b32 s30, s28, 13
  v_add_u32 v0, s30, v3
  v_and_b32 v4, 31, v2
  s_lshl_b32 s31, s28, 9
  s_add_u32 s31, s31, 161280
  v_lshl_add_u32 v4, v4, 2, s31
  s_lshl_b32 s33, s62, 1
  s_add_u32 s33, s33, s29
  s_lshl_b32 s31, s17, 2
  s_add_u32 s31, s31, s28
  s_lshl_b32 s31, s31, 1
  s_add_u32 s31, s31, s29
  s_lshl_b32 s31, s31, 4
  s_add_u32 s31, s31, s18
  s_lshl_b32 s31, s31, 11
  s_add_u32 s31, s31, s63
  s_add_u32 s35, s31, 0x800000
  s_mov_b32 s38, 0
  s_waitcnt vmcnt(0)
.g2_kernel_v_cmbw:
  ds_read_b32 v7, v6
  s_add_u32 s38, s38, 1
  s_waitcnt lgkmcnt(0)
  v_cmp_ge_u32 vcc, s33, v7
  s_and_b32 s30, vcc_lo, s34
  s_cbranch_scc0 .g2_kernel_v_cmbd
  s_orn2_b32 s30, vcc_lo, s32
  s_cmp_lg_u32 s30, -1
  s_cbranch_scc1 .g2_kernel_v_cmbq
  s_sleep 6
.g2_kernel_v_cmbq:
  s_sleep 1
  s_cmp_lt_u32 s38, 524288
  s_cbranch_scc1 .g2_kernel_v_cmbw
.g2_kernel_v_cmbd:
  s_setprio 3
  ds_read_b128 v[32:35], v0 offset:0
  ds_read_b128 v[36:39], v0 offset:1024
  ds_read_b128 v[40:43], v0 offset:2048
  ds_read_b128 v[44:47], v0 offset:3072
  ds_read_b128 v[48:51], v0 offset:4096
  ds_read_b128 v[52:55], v0 offset:5120
  ds_read_b128 v[56:59], v0 offset:6144
  ds_read_b128 v[60:63], v0 offset:7168
  ds_read2_b32 v[6:7], v4 offset0:64 offset1:96
  ds_read2_b32 v[4:5], v4 offset0:0 offset1:32
  s_lshl_b32 s30, s28, 2
  s_add_u32 s30, s30, s71
  s_waitcnt lgkmcnt(9)
  v_mfma_f32_32x32x16_bf16 v[16:31], v[8:11], v[32:35], 0
  s_waitcnt lgkmcnt(8)
  v_mfma_f32_32x32x16_bf16 v[16:31], v[12:15], v[36:39], v[16:31]
  s_waitcnt lgkmcnt(7)
  v_mfma_f32_32x32x16_bf16 v[16:31], v[8:11], v[40:43], v[16:31]
  s_waitcnt lgkmcnt(6)
  v_mfma_f32_32x32x16_bf16 v[16:31], v[12:15], v[44:47], v[16:31]
  s_waitcnt lgkmcnt(5)
  v_mfma_f32_32x32x16_bf16 v[16:31], v[8:11], v[48:51], v[16:31]
  s_waitcnt lgkmcnt(4)
  v_mfma_f32_32x32x16_bf16 v[16:31], v[12:15], v[52:55], v[16:31]
  s_waitcnt lgkmcnt(3)
  v_mfma_f32_32x32x16_bf16 v[16:31], v[8:11], v[56:59], v[16:31]
  s_waitcnt lgkmcnt(2)
  v_mfma_f32_32x32x16_bf16 v[16:31], v[12:15], v[60:63], v[16:31]
  v_mov_b32 v0, s30
  s_waitcnt lgkmcnt(0)
  v_add_f32 v6, v6, v4
  v_add_f32 v7, v7, v5
  v_mov_b32 v4, 0
  v_mov_b32 v5, s29
  ds_write_b32 v0, v5 offset:64
  v_add_f32 v9, v6, v7
  s_mov_b32 s30, 8.673617379884035e-19
  s_mov_b32 s31, 1.152921504606847e+18
  v_rcp_f32 v10, v9
  v_cmp_le_f32 vcc, s30, v9
  v_cmp_ge_f32 s[36:37], s31, v9
  v_mov_b32 v5, 1
  v_mul_f32 v10, 4.0, v10
  s_and_b64 s[36:37], s[36:37], vcc
  v_cmp_o_f32 vcc, v16, v16
  s_and_b64 vcc, vcc, s[36:37]
  s_cmp_eq_u64 vcc, -1
  s_cbranch_scc0 .g2_kernel_v_cmbslow
.g2_kernel_v_cmbfin:
  v_mul_f32 v16, v16, v10
  v_mul_f32 v17, v17, v10
  v_mul_f32 v18, v18, v10
  v_mul_f32 v19, v19, v10
  v_mul_f32 v20, v20, v10
  v_mul_f32 v21, v21, v10
  v_mul_f32 v22, v22, v10
  v_mul_f32 v23, v23, v10
  v_cvt_pk_bf16_f32 v32, v16, v17
  v_cvt_pk_bf16_f32 v33, v18, v19
  v_cvt_pk_bf16_f32 v34, v20, v21
  v_cvt_pk_bf16_f32 v35, v22, v23
  v_max_u32 v32, 1, v32
  v_max_u32 v34, 1, v34
  buffer_store_dwordx4 v[32:35], v3, s[4:7], s35 offen offset:0 sc1
  v_mul_f32 v24, v24, v10
  v_mul_f32 v25, v25, v10
  v_mul_f32 v26, v26, v10
  v_mul_f32 v27, v27, v10
  v_mul_f32 v28, v28, v10
  v_mul_f32 v29, v29, v10
  v_mul_f32 v30, v30, v10
  v_mul_f32 v31, v31, v10
  v_cvt_pk_bf16_f32 v36, v24, v25
  v_cvt_pk_bf16_f32 v37, v26, v27
  v_cvt_pk_bf16_f32 v38, v28, v29
  v_cvt_pk_bf16_f32 v39, v30, v31
  v_max_u32 v36, 1, v36
  v_max_u32 v38, 1, v38
  buffer_store_dwordx4 v[36:39], v3, s[4:7], s35 offen offset:1024 sc1
  s_setprio 3
  s_setpc_b64 s[68:69]
.g2_kernel_v_cmbslow:
  s_setprio 0
  s_lshl_b32 s30, s28, 11
  s_mul_i32 s31, s29, -8192
  s_add_u32 s30, s30, s31
  s_add_u32 s30, s30, 139264
  v_add_u32 v6, s30, v3
  ds_read_b128 v[48:51], v6
  ds_read_b128 v[52:55], v6 offset:1024
  s_lshl_b32 s36, s18, 1
  s_add_u32 s36, s36, s29
  s_lshl_b32 s36, s36, 18
  s_add_u32 s36, s36, s63
  s_mov_b32 s30, s36
  s_mov_b32 s33, 64
  v_mov_b32 v10, 0xff800000
  s_waitcnt lgkmcnt(0)
.g2_kernel_v_cmbs1:
  buffer_load_dwordx4 v[56:59], v3, s[4:7], s30 offen offset:0
  buffer_load_dwordx4 v[60:63], v3, s[4:7], s30 offen offset:1024
  s_waitcnt vmcnt(0)
  v_mfma_f32_32x32x16_bf16 v[32:47], v[56:59], v[48:51], 0
  v_mfma_f32_32x32x16_bf16 v[32:47], v[60:63], v[52:55], v[32:47]
  s_nop 11
  v_max3_f32 v10, v10, v32, v33
  v_max3_f32 v10, v10, v34, v35
  v_max3_f32 v10, v10, v36, v37
  v_max3_f32 v10, v10, v38, v39
  v_max3_f32 v10, v10, v40, v41
  v_max3_f32 v10, v10, v42, v43
  v_max3_f32 v10, v10, v44, v45
  v_max3_f32 v10, v10, v46, v47
  s_add_u32 s30, s30, 4096
  s_sub_u32 s33, s33, 1
  s_cmp_lg_u32 s33, 0
  s_cbranch_scc1 .g2_kernel_v_cmbs1
  v_mov_b32 v11, v10
  s_nop 1
  v_permlane32_swap_b32 v11, v10
  v_max_f32 v10, v10, v11
  v_mov_b32 v9, 0
  v_mov_b32 v16, 0
  v_mov_b32 v17, 0
  v_mov_b32 v18, 0
  v_mov_b32 v19, 0
  v_mov_b32 v20, 0
  v_mov_b32 v21, 0
  v_mov_b32 v22, 0
  v_mov_b32 v23, 0
  v_mov_b32 v24, 0
  v_mov_b32 v25, 0
  v_mov_b32 v26, 0
  v_mov_b32 v27, 0
  v_mov_b32 v28, 0
  v_mov_b32 v29, 0
  v_mov_b32 v30, 0
  v_mov_b32 v31, 0
  s_mov_b32 s30, s36
  s_mov_b32 s33, 64
.g2_kernel_v_cmbs2:
  buffer_load_dwordx4 v[56:59], v3, s[4:7], s30 offen offset:0
  buffer_load_dwordx4 v[60:63], v3, s[4:7], s30 offen offset:1024
  s_waitcnt vmcnt(0)
  v_mfma_f32_32x32x16_bf16 v[32:47], v[56:59], v[48:51], 0
  v_mfma_f32_32x32x16_bf16 v[32:47], v[60:63], v[52:55], v[32:47]
  s_nop 11
  v_sub_f32 v32, v32, v10
  v_sub_f32 v33, v33, v10
  v_sub_f32 v34, v34, v10
  v_sub_f32 v35, v35, v10
  v_sub_f32 v36, v36, v10
  v_sub_f32 v37, v37, v10
  v_sub_f32 v38, v38, v10
  v_sub_f32 v39, v39, v10
  v_sub_f32 v40, v40, v10
  v_sub_f32 v41, v41, v10
  v_sub_f32 v42, v42, v10
  v_sub_f32 v43, v43, v10
  v_sub_f32 v44, v44, v10
  v_sub_f32 v45, v45, v10
  v_sub_f32 v46, v46, v10
  v_sub_f32 v47, v47, v10
  buffer_load_dwordx4 v[56:59], v3, s[4:7], s30 offen offset:2048
  buffer_load_dwordx4 v[60:63], v3, s[4:7], s30 offen offset:3072
  v_exp_f32 v32, v32
  v_exp_f32 v33, v33
  v_exp_f32 v34, v34
  v_exp_f32 v35, v35
  v_exp_f32 v36, v36
  v_exp_f32 v37, v37
  v_exp_f32 v38, v38
  v_exp_f32 v39, v39
  v_exp_f32 v40, v40
  v_exp_f32 v41, v41
  v_exp_f32 v42, v42
  v_exp_f32 v43, v43
  v_exp_f32 v44, v44
  v_exp_f32 v45, v45
  v_exp_f32 v46, v46
  v_exp_f32 v47, v47
  v_add_f32 v9, v9, v32
  v_add_f32 v9, v9, v33
  v_add_f32 v9, v9, v34
  v_add_f32 v9, v9, v35
  v_add_f32 v9, v9, v36
  v_add_f32 v9, v9, v37
  v_add_f32 v9, v9, v38
  v_add_f32 v9, v9, v39
  v_add_f32 v9, v9, v40
  v_add_f32 v9, v9, v41
  v_add_f32 v9, v9, v42
  v_add_f32 v9, v9, v43
  v_add_f32 v9, v9, v44
  v_add_f32 v9, v9, v45
  v_add_f32 v9, v9, v46
  v_add_f32 v9, v9, v47
  v_cvt_pk_bf16_f32 v32, v32, v33
  v_cvt_pk_bf16_f32 v33, v34, v35
  v_cvt_pk_bf16_f32 v34, v36, v37
  v_cvt_pk_bf16_f32 v35, v38, v39
  v_cvt_pk_bf16_f32 v36, v40, v41
  v_cvt_pk_bf16_f32 v37, v42, v43
  v_cvt_pk_bf16_f32 v38, v44, v45
  v_cvt_pk_bf16_f32 v39, v46, v47
  s_waitcnt vmcnt(0)
  v_mfma_f32_32x32x16_bf16 v[16:31], v[56:59], v[32:35], v[16:31]
  v_mfma_f32_32x32x16_bf16 v[16:31], v[60:63], v[36:39], v[16:31]
  s_nop 15
  s_add_u32 s30, s30, 4096
  s_sub_u32 s33, s33, 1
  s_cmp_lg_u32 s33, 0
  s_cbranch_scc1 .g2_kernel_v_cmbs2
  v_mov_b32 v11, v9
  s_nop 1
  v_permlane32_swap_b32 v11, v9
  v_add_f32 v9, v9, v11
  v_rcp_f32 v10, v9
  s_branch .g2_kernel_v_cmbfin
.g2_kernel_p2_xw:
  s_mov_b32 s38, 0
.g2_kernel_p2_xwl:
  ds_read_b32 v12, v11
  s_add_u32 s38, s38, 1
  s_waitcnt lgkmcnt(0)
  v_cmp_ne_u32 vcc, 0, v12
  s_and_b32 s37, vcc_lo, vcc_hi
  s_lshr_b32 s33, s37, 16
  s_and_b32 s37, s37, s33
  s_bitcmp1_b32 s37, s28
  s_cbranch_scc1 .g2_kernel_p2_xwr
  s_sleep 1
  s_cmp_lt_u32 s38, 524288
  s_cbranch_scc1 .g2_kernel_p2_xwl
.g2_kernel_p2_xwr:
  s_setpc_b64 s[68:69]
.g2_kernel_p2_x0w:
  s_call_b64 s[68:69], .g2_kernel_p2_xw
  s_branch .g2_kernel_p2_x0b
.g2_kernel_p2_x1w:
  s_call_b64 s[68:69], .g2_kernel_p2_xw
  s_branch .g2_kernel_p2_x1b
.g2_kernel_p2_x2w:
  s_call_b64 s[68:69], .g2_kernel_p2_xw
  s_branch .g2_kernel_p2_x2b
.g2_kernel_p2_aw:
  s_call_b64 s[68:69], .g2_kernel_p_spin
  s_branch .g2_kernel_p2_ai
.g2_kernel_p2_x3w:
  s_call_b64 s[68:69], .g2_kernel_p2_xw
  s_branch .g2_kernel_p2_x3b
.g2_kernel_p2_bw:
  s_call_b64 s[68:69], .g2_kernel_p_spin
  s_branch .g2_kernel_p2_bi
.g2_kernel_amax:
  v_mov_b32 v16, 0xff7fffff
  v_lshlrev_b32 v7, 7, v2
  s_mov_b32 s38, 0
  s_mov_b64 exec, s[8:9]
.g2_kernel_amaxl:
  buffer_load_dwordx2 v[16:17], v7, s[4:7], s23 offen sc1
  s_add_u32 s38, s38, 1
  s_waitcnt vmcnt(0)
  v_cmp_eq_u32 vcc, 0, v17
  s_cbranch_vccz .g2_kernel_amaxd
  s_mov_b64 exec, vcc
  s_sleep 4
  s_cmp_lg_u32 s62, 0
  s_cbranch_scc1 .g2_kernel_nap58
  s_sleep 8
.g2_kernel_nap58:
  s_cmp_eq_u32 s39, 1
  s_cbranch_scc0 .g2_kernel_amaxz
  s_sleep 8
.g2_kernel_amaxz:
  s_cmp_lt_u32 s38, 131072
  s_cbranch_scc1 .g2_kernel_amaxl
.g2_kernel_amaxd:
  s_mov_b64 exec, -1
  v_mov_b32 v6, v16
  s_nop 1
  v_max_f32 v7, v6, v6 row_ror:8 row_mask:0xf bank_mask:0xf
  s_nop 1
  v_max_f32 v7, v7, v7 row_ror:4 row_mask:0xf bank_mask:0xf
  s_nop 1
  v_max_f32 v7, v7, v7 row_ror:2 row_mask:0xf bank_mask:0xf
  s_nop 1
  v_max_f32 v7, v7, v7 row_ror:1 row_mask:0xf bank_mask:0xf
  s_nop 1
  v_max_f32 v7, v7, v7 row_bcast:15 row_mask:0xa bank_mask:0xf
  s_nop 1
  v_max_f32 v7, v7, v7 row_bcast:31 row_mask:0xc bank_mask:0xf
  s_nop 0
  v_readlane_b32 s27, v7, 63
  s_nop 1
  v_cmp_eq_u32 vcc, s27, v6
  s_ff1_i32_b64 s77, vcc
  s_lshl_b32 s77, s77, 5
  s_and_b32 s28, s27, 31
  s_add_u32 s77, s77, s28
  s_and_b32 s77, s77, 2047
  s_setpc_b64 s[68:69]
  .p2align 8
.g2_kernel_tab:
  .long 0, 1, 2, 3, 4, 5, 6, 7
  .long 8, 9, 10, 11, 12, 13, 14, 15
  .long 16, 17, 18, 19, 20, 21, 22, 23
  .long 24, 25, 26, 27, 28, 29, 30, 31
  .long 32, 33, 34, 35, 36, 37, 38, 39
  .long 40, 41, 42, 43, 44, 45, 46, 47
  .long 48, 49, 50, 51, 52, 53, 54, 55
  .long 56, 57, 58, 59, 60, 61, 62, 63
  .long 64, 65, 66, 67, 68, 69, 70, 71
  .p2align 4
.g2_kernel_sel:
  .long 0x3e80, 0x0, 0x0, 0x0
  .long 0x3e800000, 0x0, 0x0, 0x0
  .long 0x0, 0x3e80, 0x0, 0x0
  .long 0x0, 0x3e800000, 0x0, 0x0
  .long 0x0, 0x0, 0x0, 0x0
  .long 0x0, 0x0, 0x0, 0x0
  .long 0x0, 0x0, 0x0, 0x0
  .long 0x0, 0x0, 0x0, 0x0
  .long 0x0, 0x0, 0x3e80, 0x0
  .long 0x0, 0x0, 0x3e800000, 0x0
  .long 0x0, 0x0, 0x0, 0x3e80
  .long 0x0, 0x0, 0x0, 0x3e800000
  .long 0x0, 0x0, 0x0, 0x0
  .long 0x0, 0x0, 0x0, 0x0
  .long 0x0, 0x0, 0x0, 0x0
  .long 0x0, 0x0, 0x0, 0x0
  .long 0x0, 0x0, 0x0, 0x0
  .long 0x0, 0x0, 0x0, 0x0
  .long 0x0, 0x0, 0x0, 0x0
  .long 0x0, 0x0, 0x0, 0x0
  .long 0x0, 0x0, 0x0, 0x0
  .long 0x0, 0x0, 0x0, 0x0
  .long 0x0, 0x0, 0x0, 0x0
  .long 0x0, 0x0, 0x0, 0x0
  .long 0x0, 0x0, 0x0, 0x0
  .long 0x0, 0x0, 0x0, 0x0
  .long 0x0, 0x0, 0x0, 0x0
  .long 0x0, 0x0, 0x0, 0x0
  .long 0x0, 0x0, 0x0, 0x0
  .long 0x0, 0x0, 0x0, 0x0
  .long 0x0, 0x0, 0x0, 0x0
  .long 0x0, 0x0, 0x0, 0x0
  .long 0x0, 0x0, 0x0, 0x0
  .long 0x0, 0x0, 0x0, 0x0
  .long 0x0, 0x0, 0x0, 0x0
  .long 0x0, 0x0, 0x0, 0x0
  .long 0x3e80, 0x0, 0x0, 0x0
  .long 0x3e800000, 0x0, 0x0, 0x0
  .long 0x0, 0x3e80, 0x0, 0x0
  .long 0x0, 0x3e800000, 0x0, 0x0
  .long 0x0, 0x0, 0x0, 0x0
  .long 0x0, 0x0, 0x0, 0x0
  .long 0x0, 0x0, 0x0, 0x0
  .long 0x0, 0x0, 0x0, 0x0
  .long 0x0, 0x0, 0x3e80, 0x0
  .long 0x0, 0x0, 0x3e800000, 0x0
  .long 0x0, 0x0, 0x0, 0x3e80
  .long 0x0, 0x0, 0x0, 0x3e800000
  .long 0x0, 0x0, 0x0, 0x0
  .long 0x0, 0x0, 0x0, 0x0
  .long 0x0, 0x0, 0x0, 0x0
  .long 0x0, 0x0, 0x0, 0x0
  .long 0x0, 0x0, 0x0, 0x0
  .long 0x0, 0x0, 0x0, 0x0
  .long 0x0, 0x0, 0x0, 0x0
  .long 0x0, 0x0, 0x0, 0x0
  .long 0x0, 0x0, 0x0, 0x0
  .long 0x0, 0x0, 0x0, 0x0
  .long 0x0, 0x0, 0x0, 0x0
  .long 0x0, 0x0, 0x0, 0x0
  .long 0x0, 0x0, 0x0, 0x0
  .long 0x0, 0x0, 0x0, 0x0
  .long 0x0, 0x0, 0x0, 0x0
  .long 0x0, 0x0, 0x0, 0x0
  .long 0x0, 0x0, 0x0, 0x0
  .long 0x0, 0x0, 0x0, 0x0
  .long 0x0, 0x0, 0x0, 0x0
  .long 0x0, 0x0, 0x0, 0x0
  .long 0x0, 0x0, 0x0, 0x0
  .long 0x0, 0x0, 0x0, 0x0
  .long 0x0, 0x0, 0x0, 0x0
  .long 0x0, 0x0, 0x0, 0x0
  .long 0x0, 0x0, 0x0, 0x0
  .long 0x0, 0x0, 0x0, 0x0
  .long 0x0, 0x0, 0x0, 0x0
  .long 0x0, 0x0, 0x0, 0x0
  .long 0x0, 0x0, 0x0, 0x0
  .long 0x0, 0x0, 0x0, 0x0
  .long 0x0, 0x0, 0x0, 0x0
  .long 0x0, 0x0, 0x0, 0x0
  .long 0x3e80, 0x0, 0x0, 0x0
  .long 0x3e800000, 0x0, 0x0, 0x0
  .long 0x0, 0x3e80, 0x0, 0x0
  .long 0x0, 0x3e800000, 0x0, 0x0
  .long 0x0, 0x0, 0x0, 0x0
  .long 0x0, 0x0, 0x0, 0x0
  .long 0x0, 0x0, 0x0, 0x0
  .long 0x0, 0x0, 0x0, 0x0
  .long 0x0, 0x0, 0x3e80, 0x0
  .long 0x0, 0x0, 0x3e800000, 0x0
  .long 0x0, 0x0, 0x0, 0x3e80
  .long 0x0, 0x0, 0x0, 0x3e800000
  .long 0x0, 0x0, 0x0, 0x0
  .long 0x0, 0x0, 0x0, 0x0
  .long 0x0, 0x0, 0x0, 0x0
  .long 0x0, 0x0, 0x0, 0x0
  .long 0x0, 0x0, 0x0, 0x0
  .long 0x0, 0x0, 0x0, 0x0
  .long 0x0, 0x0, 0x0, 0x0
  .long 0x0, 0x0, 0x0, 0x0
  .long 0x0, 0x0, 0x0, 0x0
  .long 0x0, 0x0, 0x0, 0x0
  .long 0x0, 0x0, 0x0, 0x0
  .long 0x0, 0x0, 0x0, 0x0
  .long 0x0, 0x0, 0x0, 0x0
  .long 0x0, 0x0, 0x0, 0x0
  .long 0x0, 0x0, 0x0, 0x0
  .long 0x0, 0x0, 0x0, 0x0
  .long 0x0, 0x0, 0x0, 0x0
  .long 0x0, 0x0, 0x0, 0x0
  .long 0x0, 0x0, 0x0, 0x0
  .long 0x0, 0x0, 0x0, 0x0
  .long 0x0, 0x0, 0x0, 0x0
  .long 0x0, 0x0, 0x0, 0x0
  .long 0x0, 0x0, 0x0, 0x0
  .long 0x0, 0x0, 0x0, 0x0
  .long 0x3e80, 0x0, 0x0, 0x0
  .long 0x3e800000, 0x0, 0x0, 0x0
  .long 0x0, 0x3e80, 0x0, 0x0
  .long 0x0, 0x3e800000, 0x0, 0x0
  .long 0x0, 0x0, 0x0, 0x0
  .long 0x0, 0x0, 0x0, 0x0
  .long 0x0, 0x0, 0x0, 0x0
  .long 0x0, 0x0, 0x0, 0x0
  .long 0x0, 0x0, 0x3e80, 0x0
  .long 0x0, 0x0, 0x3e800000, 0x0
  .long 0x0, 0x0, 0x0, 0x3e80
  .long 0x0, 0x0, 0x0, 0x3e800000
.g2_kernel_cend:

.section .rodata,"a"
.p2align 6
.amdhsa_kernel g2_kernel
  .amdhsa_next_free_vgpr 256
  .amdhsa_next_free_sgpr 102
  .amdhsa_accum_offset 256
  .amdhsa_group_segment_fixed_size 0
  .amdhsa_kernarg_size 88
  .amdhsa_user_sgpr_count 2
  .amdhsa_user_sgpr_kernarg_segment_ptr 1
  .amdhsa_system_sgpr_workgroup_id_x 1
.end_amdhsa_kernel
```

```asm
; @launch kernel=g2_kernel grid=(256,1,1) block=(512,1,1) lds=163840
.amdgcn_target "amdgcn-amd-amdhsa--gfx950"
.text
.globl g2_kernel
.p2align 8
.type g2_kernel,@function
g2_kernel:
  s_cmp_ge_u32 s2, 256
  s_cbranch_scc1 .g2_kernel_end
  s_load_dwordx16 s[40:55], s[0:1], 0
  s_load_dwordx4 s[56:59], s[0:1], 64
  s_load_dwordx2 s[60:61], s[0:1], 80
  s_getpc_b64 s[64:65]
.g2_kernel_pc:
  s_mov_b32 s66, .g2_kernel_cend-.g2_kernel_pc
  s_mov_b32 s67, 0x00020000
  s_lshl_b32 s12, s2, 10
  s_and_b32 s12, s12, 0xe000
  v_lshrrev_b32 v3, 3, v0
  v_and_b32 v2, 7, v0
  v_and_b32 v3, 0x38, v3
  v_add_lshl_u32 v3, v3, v2, 7
  s_mov_b64 exec, 0xff
  buffer_load_dword v1, v3, s[64:67], s12 offen
  s_mov_b64 exec, -1
  v_lshrrev_b32 v3, 6, v0
  v_and_b32 v2, 63, v0
  v_readfirstlane_b32 s16, v3
  s_and_b32 s21, s2, 7
  s_lshr_b32 s22, s2, 3
  s_and_b32 s23, s21, 3
  s_lshl_b32 s23, s23, 2
  s_and_b32 s24, s22, 3
  s_add_u32 s18, s23, s24
  s_lshr_b32 s24, s21, 2
  s_lshl_b32 s24, s24, 3
  s_lshr_b32 s25, s22, 2
  s_add_u32 s17, s24, s25
  s_lshl_b32 s19, s17, 4
  s_add_u32 s19, s19, s18
  s_lshl_b32 s19, s19, 9
  s_add_u32 s19, s19, 0x3000000
  s_lshl_b32 s76, s18, 4
  s_add_u32 s76, s76, s17
  s_lshl_b32 s76, s76, 9
  s_add_u32 s76, s76, 0x3020000
  v_lshlrev_b32 v3, 4, v2
  v_mov_b32 v4, 0
  v_mov_b32 v5, 1
  s_mov_b32 s62, 0
  s_mov_b32 s63, 0
  s_mov_b32 s70, 1
  s_mov_b32 s71, 155648
  s_waitcnt lgkmcnt(0)
  s_mov_b32 s4, s60
  s_mov_b32 s5, s61
  s_mov_b32 s6, 0x3300000
  s_mov_b32 s7, 0x00020000
  s_cmp_ge_u32 s16, 4
  s_cbranch_scc1 .g2_kernel_svc
  v_mov_b32 v20, 0
  v_mov_b32 v21, 0
  v_mov_b32 v22, 0
  v_mov_b32 v23, 0
  v_lshlrev_b32 v24, 4, v0
  v_cmp_gt_u32 vcc, 2816, v24
  v_add_u32 v24, 155648, v24
  s_and_saveexec_b64 s[20:21], vcc
  s_cbranch_execz .g2_kernel_q_nz
  ds_write_b128 v24, v[20:23]
.g2_kernel_q_nz:
  s_mov_b64 exec, -1
  v_and_b32 v20, 15, v2
  v_lshrrev_b32 v21, 4, v2
  v_lshrrev_b32 v22, 1, v20
  v_xor_b32 v22, v22, v21
  v_lshlrev_b32 v22, 4, v22
  v_lshl_add_u32 v22, v20, 7, v22
  s_lshr_b32 s26, s16, 1
  s_lshl_b32 s26, s26, 13
  v_add_u32 v144, s26, v22
  v_xor_b32 v145, 64, v144
.g2_kernel_q_cs:
  s_and_b32 s27, s16, 1
  s_lshr_b32 s26, s16, 1
  v_bfe_u32 v20, v2, 2, 2
  v_lshrrev_b32 v49, 4, v2
  v_lshl_add_u32 v22, v49, 3, v20
  v_lshlrev_b32 v22, 7, v22
  v_lshrrev_b32 v23, 1, v20
  v_and_b32 v21, 1, v49
  v_xor_b32 v21, s27, v21
  v_lshl_add_u32 v23, v21, 1, v23
  v_lshl_add_u32 v22, v23, 5, v22
  v_and_b32 v23, 3, v2
  v_lshl_add_u32 v22, v23, 3, v22
  v_add_u32 v148, 65536, v22
  v_xor_b32 v149, 32, v148
  v_mov_b32 v146, v148
  v_mov_b32 v147, v149
  v_mov_b32 v150, 156160
  v_and_b32 v48, 15, v2
  s_lshl_b32 s28, s26, 8
  s_add_u32 s28, s28, 155648
  v_lshl_add_u32 v50, v48, 2, s28
  v_lshl_add_u32 v51, v49, 4, s28
  s_lshl_b32 s28, s27, 7
  s_add_u32 s28, s28, 155648
  v_lshl_add_u32 v52, v49, 4, s28
  s_xor_b32 s28, s28, 128
  v_lshl_add_u32 v53, v48, 2, s28
  v_lshlrev_b32 v54, 9, v49
  v_lshl_add_u32 v55, v48, 4, v54
  v_and_b32 v56, 8, v48
  v_lshl_add_u32 v54, v56, 4, v55
  v_mov_b32 v56, 0.25503486164919736
  v_lshlrev_b32 v58, 2, v2
  v_and_b32 v58, 12, v58
  v_add_u32 v58, 156416, v58
  s_lshl_b32 s8, s18, 7
  s_lshl_b32 s9, s17, 2
  s_add_u32 s8, s8, s9
  s_lshl_b32 s9, s26, 1
  s_add_u32 s8, s8, s9
  s_lshl_b32 s8, s8, 12
  s_add_u32 s8, s8, s63
  s_add_u32 s9, s8, 4096
  s_lshl_b32 s28, s26, 13
  s_lshl_b32 s10, s27, 14
  s_add_u32 s28, s28, s10
  v_add_u32 v59, s28, v54
  s_xor_b32 s28, s28, 16384
  v_add_u32 v60, s28, v55
  s_lshl_b32 s28, s26, 12
  s_mul_i32 s10, s27, -8192
  s_add_u32 s28, s28, s10
  s_add_u32 s28, s28, 139264
  v_add_u32 v61, s28, v55
  s_mov_b32 s10, s27
  s_lshl_b32 s28, s26, 2
  s_add_u32 s28, s28, s71
  v_mov_b32 v62, s28
  s_lshl_b32 s12, s62, 5
  s_add_u32 s12, s12, 28
  v_and_b32 v6, 15, v2
  v_xor_b32 v6, s17, v6
  v_and_b32 v7, 16, v2
  v_add_u32 v6, v6, v7
  s_lshr_b32 s28, s16, 1
  s_lshl_b32 s28, s28, 7
  s_add_u32 s28, s28, 157440
  v_lshl_add_u32 v8, v6, 2, s28
  s_lshl_b32 s28, s16, 12
  v_add_u32 v9, s28, v3
  v_and_b32 v6, 31, v2
  s_lshl_b32 s28, s16, 7
  s_add_u32 s28, s28, 161280
  v_lshl_add_u32 v10, v6, 2, s28
  s_lshl_b32 s28, s16, 2
  s_add_u32 s28, s28, 155968
  v_mov_b32 v11, s28
  s_lshl_b32 s28, s62, 1
  s_add_u32 s28, s28, 1
  v_mov_b32 v12, s28
  v_mov_b32 v13, s71
  v_add_u32 v14, 131072, v3
  v_and_b32 v6, 4, v2
  v_cmp_eq_u32 vcc, 0, v6
  v_mov_b32 v7, 0x3f803f80
  v_and_b32 v6, 1, v2
  v_cndmask_b32 v16, 0, v7, vcc
  v_cndmask_b32 v17, 0, v7, vcc
  v_cndmask_b32 v18, v7, 0, vcc
  v_cndmask_b32 v19, v7, 0, vcc
  v_mul_u32_u24 v20, 0xaaaa, v6
  v_add_u32 v20, 0x4444, v20
  s_lshl_b32 s28, s18, 7
  s_add_u32 s28, s28, s16
  s_lshl_b32 s28, s28, 12
  s_add_u32 s28, s28, s63
  s_add_u32 s20, s60, s28
  s_addc_u32 s21, s61, 0
  s_mov_b32 s24, s17
  s_mov_b32 s25, 14
  s_mov_b32 s26, 0
  s_mov_b32 s27, 6
  s_mov_b32 s34, 0xffff0001
  s_mov_b32 s35, 0
  s_mov_b32 s36, 0
  s_mov_b32 s39, 0
  s_and_b32 s28, s16, 2
  s_lshl_b32 s28, s28, 7
  s_add_u32 s37, s76, s28
  v_mov_b32 v15, s70
  v_lshrrev_b32 v6, 5, v2
  v_and_b32 v7, 15, v2
  v_lshlrev_b32 v22, 4, v7
  v_lshl_add_u32 v22, v6, 8, v22
  v_and_b32 v7, 16, v2
  v_lshl_add_u32 v22, v7, 7, v22
  v_and_b32 v7, 31, v2
  v_lshlrev_b32 v23, 4, v6
  v_lshl_add_u32 v23, v7, 11, v23
  s_lshl_b32 s28, s17, 2
  s_add_u32 s28, s28, s16
  s_lshl_b32 s28, s28, 16
  s_lshl_b32 s29, s18, 7
  s_add_u32 s28, s28, s29
  s_add_u32 s74, s40, s28
  s_addc_u32 s75, s41, 0
  s_lshl_b32 s13, s17, 4
  s_add_u32 s13, s13, s18
  s_lshl_b32 s13, s13, 2
  s_add_u32 s13, s13, s16
  s_lshl_b32 s13, s13, 12
  s_add_u32 s13, s13, 0xc00000
  s_lshl_b32 s28, s16, 2
  s_add_u32 m0, s28, 156416
  s_lshl_b32 s33, s62, 5
  s_lshl_b32 s31, s33, 2
  s_add_u32 s31, s31, .g2_kernel_tab-.g2_kernel_pc+4
  s_mov_b32 s29, 0
  s_cmp_lg_u32 s62, 0
  s_cbranch_scc1 .g2_kernel_q_i2
  s_waitcnt lgkmcnt(0)
  s_barrier
.g2_kernel_q_i3:
  s_call_b64 s[68:69], .g2_kernel_q_spin
  ds_read_b64_tr_b16 v[80:81], v146 offset:0
  ds_read_b64_tr_b16 v[82:83], v146 offset:512
  ds_read_b128 v[64:67], v144 offset:0
  ds_read_b128 v[68:71], v144 offset:2048
  ds_read_b128 v[72:75], v144 offset:4096
  ds_read_b128 v[76:79], v144 offset:6144
  ds_read_b64_tr_b16 v[84:85], v147 offset:0
  ds_read_b64_tr_b16 v[86:87], v147 offset:512
  ds_read_b64_tr_b16 v[88:89], v146 offset:4096
  ds_read_b64_tr_b16 v[90:91], v146 offset:4608
  ds_read_b64_tr_b16 v[92:93], v147 offset:4096
  ds_read_b64_tr_b16 v[94:95], v147 offset:4608
  ds_read_b64_tr_b16 v[96:97], v146 offset:8192
  ds_read_b64_tr_b16 v[98:99], v146 offset:8704
  ds_read_b64_tr_b16 v[100:101], v147 offset:8192
  ds_read_b64_tr_b16 v[102:103], v147 offset:8704
  s_mov_b32 s30, 12288
  s_add_u32 s33, s33, 1
  v_add_u32 v146, s30, v148
  v_add_u32 v147, s30, v149
  s_waitcnt lgkmcnt(0)
  v_mfma_f32_16x16x32_bf16 v[160:163], v[80:83], v[64:67], 0
  v_cmp_lt_i32 vcc, s33, v151
  v_mfma_f32_16x16x32_bf16 v[164:167], v[80:83], v[68:71], 0
  s_cbranch_vccz .g2_kernel_q_wf
.g2_kernel_q_backf:
  v_mfma_f32_16x16x32_bf16 v[168:171], v[80:83], v[72:75], 0
  ds_read_b64_tr_b16 v[120:121], v146 offset:0
  v_mfma_f32_16x16x32_bf16 v[172:175], v[80:83], v[76:79], 0
  ds_read_b64_tr_b16 v[122:123], v146 offset:512
  v_mfma_f32_16x16x32_bf16 v[188:191], v[84:87], v[76:79], 0
  ds_read_b128 v[104:107], v145 offset:0
  v_mfma_f32_16x16x32_bf16 v[184:187], v[84:87], v[72:75], 0
  ds_read_b128 v[108:111], v145 offset:2048
  v_mfma_f32_16x16x32_bf16 v[180:183], v[84:87], v[68:71], 0
  ds_read_b128 v[112:115], v145 offset:4096
  v_mfma_f32_16x16x32_bf16 v[176:179], v[84:87], v[64:67], 0
  ds_read_b128 v[116:119], v145 offset:6144
  v_mfma_f32_16x16x32_bf16 v[192:195], v[88:91], v[64:67], 0
  ds_read_b64_tr_b16 v[124:125], v147 offset:0
  v_mfma_f32_16x16x32_bf16 v[196:199], v[88:91], v[68:71], 0
  ds_read_b64_tr_b16 v[126:127], v147 offset:512
  v_mfma_f32_16x16x32_bf16 v[200:203], v[88:91], v[72:75], 0
  ds_read_b64_tr_b16 v[128:129], v146 offset:4096
  v_mfma_f32_16x16x32_bf16 v[204:207], v[88:91], v[76:79], 0
  ds_read_b64_tr_b16 v[130:131], v146 offset:4608
  v_mfma_f32_16x16x32_bf16 v[220:223], v[92:95], v[76:79], 0
  ds_read_b64_tr_b16 v[132:133], v147 offset:4096
  v_mfma_f32_16x16x32_bf16 v[216:219], v[92:95], v[72:75], 0
  ds_read_b64_tr_b16 v[134:135], v147 offset:4608
  v_mfma_f32_16x16x32_bf16 v[212:215], v[92:95], v[68:71], 0
  ds_read_b64_tr_b16 v[136:137], v146 offset:8192
  v_mfma_f32_16x16x32_bf16 v[208:211], v[92:95], v[64:67], 0
  ds_read_b64_tr_b16 v[138:139], v146 offset:8704
  v_mfma_f32_16x16x32_bf16 v[224:227], v[64:67], v[96:99], 0
  ds_read_b64_tr_b16 v[140:141], v147 offset:8192
  v_mfma_f32_16x16x32_bf16 v[228:231], v[68:71], v[96:99], 0
  ds_read_b64_tr_b16 v[142:143], v147 offset:8704
  v_mfma_f32_16x16x32_bf16 v[232:235], v[72:75], v[96:99], 0
  ds_read_b32 v151, v150
  s_add_u32 s30, s30, 12288
  v_mfma_f32_16x16x32_bf16 v[236:239], v[76:79], v[96:99], 0
  s_mov_b64 exec, 1
  buffer_load_dword off, s[64:67], s31 lds
  s_mov_b64 exec, -1
  s_cmp_eq_u32 s30, 86016
  v_mfma_f32_16x16x32_bf16 v[252:255], v[76:79], v[100:103], 0
  s_cselect_b32 s30, 0, s30
  s_add_u32 s31, s31, 4
  v_mfma_f32_16x16x32_bf16 v[248:251], v[72:75], v[100:103], 0
  v_add_u32 v146, s30, v148
  s_add_u32 s33, s33, 1
  v_mfma_f32_16x16x32_bf16 v[244:247], v[68:71], v[100:103], 0
  v_add_u32 v147, s30, v149
  v_mfma_f32_16x16x32_bf16 v[240:243], v[64:67], v[100:103], 0
  s_branch .g2_kernel_q_s1
  .p2align 6
.g2_kernel_q_loop:
  s_waitcnt lgkmcnt(0)
  v_mfma_f32_16x16x32_bf16 v[160:163], v[120:123], v[104:107], v[160:163]
  v_cmp_lt_i32 vcc, s33, v151
  v_mfma_f32_16x16x32_bf16 v[164:167], v[120:123], v[108:111], v[164:167]
  s_cbranch_vccz .g2_kernel_q_w7
.g2_kernel_q_back7:
  v_mfma_f32_16x16x32_bf16 v[168:171], v[120:123], v[112:115], v[168:171]
  ds_read_b64_tr_b16 v[80:81], v146 offset:0
  v_mfma_f32_16x16x32_bf16 v[172:175], v[120:123], v[116:119], v[172:175]
  ds_read_b64_tr_b16 v[82:83], v146 offset:512
  v_mfma_f32_16x16x32_bf16 v[188:191], v[124:127], v[116:119], v[188:191]
  ds_read_b128 v[64:67], v144 offset:0
  v_mfma_f32_16x16x32_bf16 v[184:187], v[124:127], v[112:115], v[184:187]
  ds_read_b128 v[68:71], v144 offset:2048
  v_mfma_f32_16x16x32_bf16 v[180:183], v[124:127], v[108:111], v[180:183]
  ds_read_b128 v[72:75], v144 offset:4096
  v_mfma_f32_16x16x32_bf16 v[176:179], v[124:127], v[104:107], v[176:179]
  ds_read_b128 v[76:79], v144 offset:6144
  v_mfma_f32_16x16x32_bf16 v[192:195], v[128:131], v[104:107], v[192:195]
  ds_read_b64_tr_b16 v[84:85], v147 offset:0
  v_mfma_f32_16x16x32_bf16 v[196:199], v[128:131], v[108:111], v[196:199]
  ds_read_b64_tr_b16 v[86:87], v147 offset:512
  v_mfma_f32_16x16x32_bf16 v[200:203], v[128:131], v[112:115], v[200:203]
  ds_read_b64_tr_b16 v[88:89], v146 offset:4096
  v_mfma_f32_16x16x32_bf16 v[204:207], v[128:131], v[116:119], v[204:207]
  ds_read_b64_tr_b16 v[90:91], v146 offset:4608
  v_mfma_f32_16x16x32_bf16 v[220:223], v[132:135], v[116:119], v[220:223]
  ds_read_b64_tr_b16 v[92:93], v147 offset:4096
  v_mfma_f32_16x16x32_bf16 v[216:219], v[132:135], v[112:115], v[216:219]
  ds_read_b64_tr_b16 v[94:95], v147 offset:4608
  v_mfma_f32_16x16x32_bf16 v[212:215], v[132:135], v[108:111], v[212:215]
  ds_read_b64_tr_b16 v[96:97], v146 offset:8192
  v_mfma_f32_16x16x32_bf16 v[208:211], v[132:135], v[104:107], v[208:211]
  ds_read_b64_tr_b16 v[98:99], v146 offset:8704
  v_mfma_f32_16x16x32_bf16 v[224:227], v[104:107], v[136:139], v[224:227]
  ds_read_b64_tr_b16 v[100:101], v147 offset:8192
  v_mfma_f32_16x16x32_bf16 v[228:231], v[108:111], v[136:139], v[228:231]
  ds_read_b64_tr_b16 v[102:103], v147 offset:8704
  v_mfma_f32_16x16x32_bf16 v[232:235], v[112:115], v[136:139], v[232:235]
  ds_read_b32 v151, v150
  s_add_u32 s30, s30, 12288
  v_mfma_f32_16x16x32_bf16 v[236:239], v[116:119], v[136:139], v[236:239]
  s_mov_b64 exec, 1
  buffer_load_dword off, s[64:67], s31 lds
  s_mov_b64 exec, -1
  s_cmp_eq_u32 s30, 86016
  v_mfma_f32_16x16x32_bf16 v[252:255], v[116:119], v[140:143], v[252:255]
  s_cselect_b32 s30, 0, s30
  s_add_u32 s31, s31, 4
  v_mfma_f32_16x16x32_bf16 v[248:251], v[112:115], v[140:143], v[248:251]
  v_add_u32 v146, s30, v148
  s_add_u32 s33, s33, 1
  v_mfma_f32_16x16x32_bf16 v[244:247], v[108:111], v[140:143], v[244:247]
  v_add_u32 v147, s30, v149
  v_mfma_f32_16x16x32_bf16 v[240:243], v[104:107], v[140:143], v[240:243]
  s_waitcnt lgkmcnt(0)
  v_mfma_f32_16x16x32_bf16 v[160:163], v[80:83], v[64:67], v[160:163]
  v_cmp_lt_i32 vcc, s33, v151
  v_mfma_f32_16x16x32_bf16 v[164:167], v[80:83], v[68:71], v[164:167]
  s_cbranch_vccz .g2_kernel_q_w0
.g2_kernel_q_back0:
  v_mfma_f32_16x16x32_bf16 v[168:171], v[80:83], v[72:75], v[168:171]
  ds_read_b64_tr_b16 v[120:121], v146 offset:0
  v_mfma_f32_16x16x32_bf16 v[172:175], v[80:83], v[76:79], v[172:175]
  ds_read_b64_tr_b16 v[122:123], v146 offset:512
  v_mfma_f32_16x16x32_bf16 v[188:191], v[84:87], v[76:79], v[188:191]
  ds_read_b128 v[104:107], v145 offset:0
  v_mfma_f32_16x16x32_bf16 v[184:187], v[84:87], v[72:75], v[184:187]
  ds_read_b128 v[108:111], v145 offset:2048
  v_mfma_f32_16x16x32_bf16 v[180:183], v[84:87], v[68:71], v[180:183]
  ds_read_b128 v[112:115], v145 offset:4096
  v_mfma_f32_16x16x32_bf16 v[176:179], v[84:87], v[64:67], v[176:179]
  ds_read_b128 v[116:119], v145 offset:6144
  v_mfma_f32_16x16x32_bf16 v[192:195], v[88:91], v[64:67], v[192:195]
  ds_read_b64_tr_b16 v[124:125], v147 offset:0
  v_mfma_f32_16x16x32_bf16 v[196:199], v[88:91], v[68:71], v[196:199]
  ds_read_b64_tr_b16 v[126:127], v147 offset:512
  v_mfma_f32_16x16x32_bf16 v[200:203], v[88:91], v[72:75], v[200:203]
  ds_read_b64_tr_b16 v[128:129], v146 offset:4096
  v_mfma_f32_16x16x32_bf16 v[204:207], v[88:91], v[76:79], v[204:207]
  ds_read_b64_tr_b16 v[130:131], v146 offset:4608
  v_mfma_f32_16x16x32_bf16 v[220:223], v[92:95], v[76:79], v[220:223]
  ds_read_b64_tr_b16 v[132:133], v147 offset:4096
  v_mfma_f32_16x16x32_bf16 v[216:219], v[92:95], v[72:75], v[216:219]
  ds_read_b64_tr_b16 v[134:135], v147 offset:4608
  v_mfma_f32_16x16x32_bf16 v[212:215], v[92:95], v[68:71], v[212:215]
  ds_read_b64_tr_b16 v[136:137], v146 offset:8192
  v_mfma_f32_16x16x32_bf16 v[208:211], v[92:95], v[64:67], v[208:211]
  ds_read_b64_tr_b16 v[138:139], v146 offset:8704
  v_mfma_f32_16x16x32_bf16 v[224:227], v[64:67], v[96:99], v[224:227]
  ds_read_b64_tr_b16 v[140:141], v147 offset:8192
  v_mfma_f32_16x16x32_bf16 v[228:231], v[68:71], v[96:99], v[228:231]
  ds_read_b64_tr_b16 v[142:143], v147 offset:8704
  v_mfma_f32_16x16x32_bf16 v[232:235], v[72:75], v[96:99], v[232:235]
  ds_read_b32 v151, v150
  s_add_u32 s30, s30, 12288
  v_mfma_f32_16x16x32_bf16 v[236:239], v[76:79], v[96:99], v[236:239]
  s_mov_b64 exec, 1
  buffer_load_dword off, s[64:67], s31 lds
  s_mov_b64 exec, -1
  s_cmp_eq_u32 s30, 86016
  v_mfma_f32_16x16x32_bf16 v[252:255], v[76:79], v[100:103], v[252:255]
  s_cselect_b32 s30, 0, s30
  s_add_u32 s31, s31, 4
  v_mfma_f32_16x16x32_bf16 v[248:251], v[72:75], v[100:103], v[248:251]
  v_add_u32 v146, s30, v148
  s_add_u32 s33, s33, 1
  v_mfma_f32_16x16x32_bf16 v[244:247], v[68:71], v[100:103], v[244:247]
  v_add_u32 v147, s30, v149
  v_mfma_f32_16x16x32_bf16 v[240:243], v[64:67], v[100:103], v[240:243]
.g2_kernel_q_s1:
  s_waitcnt lgkmcnt(0)
  v_mfma_f32_16x16x32_bf16 v[160:163], v[120:123], v[104:107], v[160:163]
  v_cmp_lt_i32 vcc, s33, v151
  v_mfma_f32_16x16x32_bf16 v[164:167], v[120:123], v[108:111], v[164:167]
  s_cbranch_vccz .g2_kernel_q_w1
.g2_kernel_q_back1:
  v_mfma_f32_16x16x32_bf16 v[168:171], v[120:123], v[112:115], v[168:171]
  ds_read_b64_tr_b16 v[80:81], v146 offset:0
  v_mfma_f32_16x16x32_bf16 v[172:175], v[120:123], v[116:119], v[172:175]
  ds_read_b64_tr_b16 v[82:83], v146 offset:512
  v_mfma_f32_16x16x32_bf16 v[188:191], v[124:127], v[116:119], v[188:191]
  ds_read_b128 v[64:67], v144 offset:16384
  v_mfma_f32_16x16x32_bf16 v[184:187], v[124:127], v[112:115], v[184:187]
  ds_read_b128 v[68:71], v144 offset:18432
  v_mfma_f32_16x16x32_bf16 v[180:183], v[124:127], v[108:111], v[180:183]
  ds_read_b128 v[72:75], v144 offset:20480
  v_mfma_f32_16x16x32_bf16 v[176:179], v[124:127], v[104:107], v[176:179]
  ds_read_b128 v[76:79], v144 offset:22528
  v_mfma_f32_16x16x32_bf16 v[192:195], v[128:131], v[104:107], v[192:195]
  ds_read_b64_tr_b16 v[84:85], v147 offset:0
  v_mfma_f32_16x16x32_bf16 v[196:199], v[128:131], v[108:111], v[196:199]
  ds_read_b64_tr_b16 v[86:87], v147 offset:512
  v_mfma_f32_16x16x32_bf16 v[200:203], v[128:131], v[112:115], v[200:203]
  ds_read_b64_tr_b16 v[88:89], v146 offset:4096
  v_mfma_f32_16x16x32_bf16 v[204:207], v[128:131], v[116:119], v[204:207]
  ds_read_b64_tr_b16 v[90:91], v146 offset:4608
  v_mfma_f32_16x16x32_bf16 v[220:223], v[132:135], v[116:119], v[220:223]
  ds_read_b64_tr_b16 v[92:93], v147 offset:4096
  v_mfma_f32_16x16x32_bf16 v[216:219], v[132:135], v[112:115], v[216:219]
  ds_read_b64_tr_b16 v[94:95], v147 offset:4608
  v_mfma_f32_16x16x32_bf16 v[212:215], v[132:135], v[108:111], v[212:215]
  ds_read_b64_tr_b16 v[96:97], v146 offset:8192
  v_mfma_f32_16x16x32_bf16 v[208:211], v[132:135], v[104:107], v[208:211]
  ds_read_b64_tr_b16 v[98:99], v146 offset:8704
  v_mfma_f32_16x16x32_bf16 v[224:227], v[104:107], v[136:139], v[224:227]
  ds_read_b64_tr_b16 v[100:101], v147 offset:8192
  v_mfma_f32_16x16x32_bf16 v[228:231], v[108:111], v[136:139], v[228:231]
  ds_read_b64_tr_b16 v[102:103], v147 offset:8704
  v_mfma_f32_16x16x32_bf16 v[232:235], v[112:115], v[136:139], v[232:235]
  ds_read_b32 v151, v150
  s_add_u32 s30, s30, 12288
  v_mfma_f32_16x16x32_bf16 v[236:239], v[116:119], v[136:139], v[236:239]
  s_mov_b64 exec, 1
  buffer_load_dword off, s[64:67], s31 lds
  s_mov_b64 exec, -1
  s_cmp_eq_u32 s30, 86016
  v_mfma_f32_16x16x32_bf16 v[252:255], v[116:119], v[140:143], v[252:255]
  s_cselect_b32 s30, 0, s30
  s_add_u32 s31, s31, 4
  v_mfma_f32_16x16x32_bf16 v[248:251], v[112:115], v[140:143], v[248:251]
  v_add_u32 v146, s30, v148
  s_add_u32 s33, s33, 1
  v_mfma_f32_16x16x32_bf16 v[244:247], v[108:111], v[140:143], v[244:247]
  v_add_u32 v147, s30, v149
  v_mfma_f32_16x16x32_bf16 v[240:243], v[104:107], v[140:143], v[240:243]
  s_waitcnt lgkmcnt(0)
  v_mfma_f32_16x16x32_bf16 v[160:163], v[80:83], v[64:67], v[160:163]
  v_cmp_lt_i32 vcc, s33, v151
  v_mfma_f32_16x16x32_bf16 v[164:167], v[80:83], v[68:71], v[164:167]
  s_cbranch_vccz .g2_kernel_q_w2
.g2_kernel_q_back2:
  v_mfma_f32_16x16x32_bf16 v[168:171], v[80:83], v[72:75], v[168:171]
  ds_read_b64_tr_b16 v[120:121], v146 offset:0
  v_mfma_f32_16x16x32_bf16 v[172:175], v[80:83], v[76:79], v[172:175]
  ds_read_b64_tr_b16 v[122:123], v146 offset:512
  v_mfma_f32_16x16x32_bf16 v[188:191], v[84:87], v[76:79], v[188:191]
  ds_read_b128 v[104:107], v145 offset:16384
  v_mfma_f32_16x16x32_bf16 v[184:187], v[84:87], v[72:75], v[184:187]
  ds_read_b128 v[108:111], v145 offset:18432
  v_mfma_f32_16x16x32_bf16 v[180:183], v[84:87], v[68:71], v[180:183]
  ds_read_b128 v[112:115], v145 offset:20480
  v_mfma_f32_16x16x32_bf16 v[176:179], v[84:87], v[64:67], v[176:179]
  ds_read_b128 v[116:119], v145 offset:22528
  v_mfma_f32_16x16x32_bf16 v[192:195], v[88:91], v[64:67], v[192:195]
  ds_read_b64_tr_b16 v[124:125], v147 offset:0
  v_mfma_f32_16x16x32_bf16 v[196:199], v[88:91], v[68:71], v[196:199]
  ds_read_b64_tr_b16 v[126:127], v147 offset:512
  v_mfma_f32_16x16x32_bf16 v[200:203], v[88:91], v[72:75], v[200:203]
  ds_read_b64_tr_b16 v[128:129], v146 offset:4096
  v_mfma_f32_16x16x32_bf16 v[204:207], v[88:91], v[76:79], v[204:207]
  ds_read_b64_tr_b16 v[130:131], v146 offset:4608
  v_mfma_f32_16x16x32_bf16 v[220:223], v[92:95], v[76:79], v[220:223]
  ds_read_b64_tr_b16 v[132:133], v147 offset:4096
  v_mfma_f32_16x16x32_bf16 v[216:219], v[92:95], v[72:75], v[216:219]
  ds_read_b64_tr_b16 v[134:135], v147 offset:4608
  v_mfma_f32_16x16x32_bf16 v[212:215], v[92:95], v[68:71], v[212:215]
  ds_read_b64_tr_b16 v[136:137], v146 offset:8192
  v_mfma_f32_16x16x32_bf16 v[208:211], v[92:95], v[64:67], v[208:211]
  ds_read_b64_tr_b16 v[138:139], v146 offset:8704
  v_mfma_f32_16x16x32_bf16 v[224:227], v[64:67], v[96:99], v[224:227]
  ds_read_b64_tr_b16 v[140:141], v147 offset:8192
  v_mfma_f32_16x16x32_bf16 v[228:231], v[68:71], v[96:99], v[228:231]
  ds_read_b64_tr_b16 v[142:143], v147 offset:8704
  v_mfma_f32_16x16x32_bf16 v[232:235], v[72:75], v[96:99], v[232:235]
  ds_read_b32 v151, v150
  s_add_u32 s30, s30, 12288
  v_mfma_f32_16x16x32_bf16 v[236:239], v[76:79], v[96:99], v[236:239]
  s_mov_b64 exec, 1
  buffer_load_dword off, s[64:67], s31 lds
  s_mov_b64 exec, -1
  s_cmp_eq_u32 s30, 86016
  v_mfma_f32_16x16x32_bf16 v[252:255], v[76:79], v[100:103], v[252:255]
  s_cselect_b32 s30, 0, s30
  s_add_u32 s31, s31, 4
  v_mfma_f32_16x16x32_bf16 v[248:251], v[72:75], v[100:103], v[248:251]
  v_add_u32 v146, s30, v148
  s_add_u32 s33, s33, 1
  v_mfma_f32_16x16x32_bf16 v[244:247], v[68:71], v[100:103], v[244:247]
  v_add_u32 v147, s30, v149
  v_mfma_f32_16x16x32_bf16 v[240:243], v[64:67], v[100:103], v[240:243]
  s_waitcnt lgkmcnt(0)
  v_mfma_f32_16x16x32_bf16 v[160:163], v[120:123], v[104:107], v[160:163]
  v_cmp_lt_i32 vcc, s33, v151
  v_mfma_f32_16x16x32_bf16 v[164:167], v[120:123], v[108:111], v[164:167]
  s_cbranch_vccz .g2_kernel_q_w3
.g2_kernel_q_back3:
  v_mfma_f32_16x16x32_bf16 v[168:171], v[120:123], v[112:115], v[168:171]
  ds_read_b64_tr_b16 v[80:81], v146 offset:0
  v_mfma_f32_16x16x32_bf16 v[172:175], v[120:123], v[116:119], v[172:175]
  ds_read_b64_tr_b16 v[82:83], v146 offset:512
  v_mfma_f32_16x16x32_bf16 v[188:191], v[124:127], v[116:119], v[188:191]
  ds_read_b128 v[64:67], v144 offset:32768
  v_mfma_f32_16x16x32_bf16 v[184:187], v[124:127], v[112:115], v[184:187]
  ds_read_b128 v[68:71], v144 offset:34816
  v_mfma_f32_16x16x32_bf16 v[180:183], v[124:127], v[108:111], v[180:183]
  ds_read_b128 v[72:75], v144 offset:36864
  v_mfma_f32_16x16x32_bf16 v[176:179], v[124:127], v[104:107], v[176:179]
  ds_read_b128 v[76:79], v144 offset:38912
  v_mfma_f32_16x16x32_bf16 v[192:195], v[128:131], v[104:107], v[192:195]
  ds_read_b64_tr_b16 v[84:85], v147 offset:0
  v_mfma_f32_16x16x32_bf16 v[196:199], v[128:131], v[108:111], v[196:199]
  ds_read_b64_tr_b16 v[86:87], v147 offset:512
  v_mfma_f32_16x16x32_bf16 v[200:203], v[128:131], v[112:115], v[200:203]
  ds_read_b64_tr_b16 v[88:89], v146 offset:4096
  v_mfma_f32_16x16x32_bf16 v[204:207], v[128:131], v[116:119], v[204:207]
  ds_read_b64_tr_b16 v[90:91], v146 offset:4608
  v_mfma_f32_16x16x32_bf16 v[220:223], v[132:135], v[116:119], v[220:223]
  ds_read_b64_tr_b16 v[92:93], v147 offset:4096
  v_mfma_f32_16x16x32_bf16 v[216:219], v[132:135], v[112:115], v[216:219]
  ds_read_b64_tr_b16 v[94:95], v147 offset:4608
  v_mfma_f32_16x16x32_bf16 v[212:215], v[132:135], v[108:111], v[212:215]
  ds_read_b64_tr_b16 v[96:97], v146 offset:8192
  v_mfma_f32_16x16x32_bf16 v[208:211], v[132:135], v[104:107], v[208:211]
  ds_read_b64_tr_b16 v[98:99], v146 offset:8704
  v_mfma_f32_16x16x32_bf16 v[224:227], v[104:107], v[136:139], v[224:227]
  ds_read_b64_tr_b16 v[100:101], v147 offset:8192
  v_mfma_f32_16x16x32_bf16 v[228:231], v[108:111], v[136:139], v[228:231]
  ds_read_b64_tr_b16 v[102:103], v147 offset:8704
  v_mfma_f32_16x16x32_bf16 v[232:235], v[112:115], v[136:139], v[232:235]
  ds_read_b32 v151, v150
  s_add_u32 s30, s30, 12288
  v_mfma_f32_16x16x32_bf16 v[236:239], v[116:119], v[136:139], v[236:239]
  s_mov_b64 exec, 1
  buffer_load_dword off, s[64:67], s31 lds
  s_mov_b64 exec, -1
  s_cmp_eq_u32 s30, 86016
  v_mfma_f32_16x16x32_bf16 v[252:255], v[116:119], v[140:143], v[252:255]
  s_cselect_b32 s30, 0, s30
  s_add_u32 s31, s31, 4
  v_mfma_f32_16x16x32_bf16 v[248:251], v[112:115], v[140:143], v[248:251]
  v_add_u32 v146, s30, v148
  s_add_u32 s33, s33, 1
  v_mfma_f32_16x16x32_bf16 v[244:247], v[108:111], v[140:143], v[244:247]
  v_add_u32 v147, s30, v149
  v_mfma_f32_16x16x32_bf16 v[240:243], v[104:107], v[140:143], v[240:243]
  s_waitcnt lgkmcnt(0)
  v_mfma_f32_16x16x32_bf16 v[160:163], v[80:83], v[64:67], v[160:163]
  v_cmp_lt_i32 vcc, s33, v151
  v_mfma_f32_16x16x32_bf16 v[164:167], v[80:83], v[68:71], v[164:167]
  s_cbranch_vccz .g2_kernel_q_w4
.g2_kernel_q_back4:
  v_mfma_f32_16x16x32_bf16 v[168:171], v[80:83], v[72:75], v[168:171]
  ds_read_b64_tr_b16 v[120:121], v146 offset:0
  v_mfma_f32_16x16x32_bf16 v[172:175], v[80:83], v[76:79], v[172:175]
  ds_read_b64_tr_b16 v[122:123], v146 offset:512
  v_mfma_f32_16x16x32_bf16 v[188:191], v[84:87], v[76:79], v[188:191]
  ds_read_b128 v[104:107], v145 offset:32768
  v_mfma_f32_16x16x32_bf16 v[184:187], v[84:87], v[72:75], v[184:187]
  ds_read_b128 v[108:111], v145 offset:34816
  v_mfma_f32_16x16x32_bf16 v[180:183], v[84:87], v[68:71], v[180:183]
  ds_read_b128 v[112:115], v145 offset:36864
  v_mfma_f32_16x16x32_bf16 v[176:179], v[84:87], v[64:67], v[176:179]
  ds_read_b128 v[116:119], v145 offset:38912
  v_mfma_f32_16x16x32_bf16 v[192:195], v[88:91], v[64:67], v[192:195]
  ds_read_b64_tr_b16 v[124:125], v147 offset:0
  v_mfma_f32_16x16x32_bf16 v[196:199], v[88:91], v[68:71], v[196:199]
  ds_read_b64_tr_b16 v[126:127], v147 offset:512
  v_mfma_f32_16x16x32_bf16 v[200:203], v[88:91], v[72:75], v[200:203]
  ds_read_b64_tr_b16 v[128:129], v146 offset:4096
  v_mfma_f32_16x16x32_bf16 v[204:207], v[88:91], v[76:79], v[204:207]
  ds_read_b64_tr_b16 v[130:131], v146 offset:4608
  v_mfma_f32_16x16x32_bf16 v[220:223], v[92:95], v[76:79], v[220:223]
  ds_read_b64_tr_b16 v[132:133], v147 offset:4096
  v_mfma_f32_16x16x32_bf16 v[216:219], v[92:95], v[72:75], v[216:219]
  ds_read_b64_tr_b16 v[134:135], v147 offset:4608
  v_mfma_f32_16x16x32_bf16 v[212:215], v[92:95], v[68:71], v[212:215]
  ds_read_b64_tr_b16 v[136:137], v146 offset:8192
  v_mfma_f32_16x16x32_bf16 v[208:211], v[92:95], v[64:67], v[208:211]
  ds_read_b64_tr_b16 v[138:139], v146 offset:8704
  v_mfma_f32_16x16x32_bf16 v[224:227], v[64:67], v[96:99], v[224:227]
  ds_read_b64_tr_b16 v[140:141], v147 offset:8192
  v_mfma_f32_16x16x32_bf16 v[228:231], v[68:71], v[96:99], v[228:231]
  ds_read_b64_tr_b16 v[142:143], v147 offset:8704
  v_mfma_f32_16x16x32_bf16 v[232:235], v[72:75], v[96:99], v[232:235]
  ds_read_b32 v151, v150
  s_add_u32 s30, s30, 12288
  v_mfma_f32_16x16x32_bf16 v[236:239], v[76:79], v[96:99], v[236:239]
  s_mov_b64 exec, 1
  buffer_load_dword off, s[64:67], s31 lds
  s_mov_b64 exec, -1
  s_cmp_eq_u32 s30, 86016
  v_mfma_f32_16x16x32_bf16 v[252:255], v[76:79], v[100:103], v[252:255]
  s_cselect_b32 s30, 0, s30
  s_add_u32 s31, s31, 4
  v_mfma_f32_16x16x32_bf16 v[248:251], v[72:75], v[100:103], v[248:251]
  v_add_u32 v146, s30, v148
  s_add_u32 s33, s33, 1
  v_mfma_f32_16x16x32_bf16 v[244:247], v[68:71], v[100:103], v[244:247]
  v_add_u32 v147, s30, v149
  v_mfma_f32_16x16x32_bf16 v[240:243], v[64:67], v[100:103], v[240:243]
  s_waitcnt lgkmcnt(0)
  v_mfma_f32_16x16x32_bf16 v[160:163], v[120:123], v[104:107], v[160:163]
  v_cmp_lt_i32 vcc, s33, v151
  v_mfma_f32_16x16x32_bf16 v[164:167], v[120:123], v[108:111], v[164:167]
  s_cbranch_vccz .g2_kernel_q_w5
.g2_kernel_q_back5:
  v_mfma_f32_16x16x32_bf16 v[168:171], v[120:123], v[112:115], v[168:171]
  ds_read_b64_tr_b16 v[80:81], v146 offset:0
  v_mfma_f32_16x16x32_bf16 v[172:175], v[120:123], v[116:119], v[172:175]
  ds_read_b64_tr_b16 v[82:83], v146 offset:512
  v_mfma_f32_16x16x32_bf16 v[188:191], v[124:127], v[116:119], v[188:191]
  ds_read_b128 v[64:67], v144 offset:49152
  v_mfma_f32_16x16x32_bf16 v[184:187], v[124:127], v[112:115], v[184:187]
  ds_read_b128 v[68:71], v144 offset:51200
  v_mfma_f32_16x16x32_bf16 v[180:183], v[124:127], v[108:111], v[180:183]
  ds_read_b128 v[72:75], v144 offset:53248
  v_mfma_f32_16x16x32_bf16 v[176:179], v[124:127], v[104:107], v[176:179]
  ds_read_b128 v[76:79], v144 offset:55296
  v_mfma_f32_16x16x32_bf16 v[192:195], v[128:131], v[104:107], v[192:195]
  ds_read_b64_tr_b16 v[84:85], v147 offset:0
  v_mfma_f32_16x16x32_bf16 v[196:199], v[128:131], v[108:111], v[196:199]
  ds_read_b64_tr_b16 v[86:87], v147 offset:512
  v_mfma_f32_16x16x32_bf16 v[200:203], v[128:131], v[112:115], v[200:203]
  ds_read_b64_tr_b16 v[88:89], v146 offset:4096
  v_mfma_f32_16x16x32_bf16 v[204:207], v[128:131], v[116:119], v[204:207]
  ds_read_b64_tr_b16 v[90:91], v146 offset:4608
  v_mfma_f32_16x16x32_bf16 v[220:223], v[132:135], v[116:119], v[220:223]
  ds_read_b64_tr_b16 v[92:93], v147 offset:4096
  v_mfma_f32_16x16x32_bf16 v[216:219], v[132:135], v[112:115], v[216:219]
  ds_read_b64_tr_b16 v[94:95], v147 offset:4608
  v_mfma_f32_16x16x32_bf16 v[212:215], v[132:135], v[108:111], v[212:215]
  ds_read_b64_tr_b16 v[96:97], v146 offset:8192
  v_mfma_f32_16x16x32_bf16 v[208:211], v[132:135], v[104:107], v[208:211]
  ds_read_b64_tr_b16 v[98:99], v146 offset:8704
  v_mfma_f32_16x16x32_bf16 v[224:227], v[104:107], v[136:139], v[224:227]
  ds_read_b64_tr_b16 v[100:101], v147 offset:8192
  v_mfma_f32_16x16x32_bf16 v[228:231], v[108:111], v[136:139], v[228:231]
  ds_read_b64_tr_b16 v[102:103], v147 offset:8704
  v_mfma_f32_16x16x32_bf16 v[232:235], v[112:115], v[136:139], v[232:235]
  ds_read_b32 v151, v150
  s_add_u32 s30, s30, 12288
  v_mfma_f32_16x16x32_bf16 v[236:239], v[116:119], v[136:139], v[236:239]
  s_mov_b64 exec, 1
  buffer_load_dword off, s[64:67], s31 lds
  s_mov_b64 exec, -1
  s_cmp_eq_u32 s30, 86016
  v_mfma_f32_16x16x32_bf16 v[252:255], v[116:119], v[140:143], v[252:255]
  s_cselect_b32 s30, 0, s30
  s_add_u32 s31, s31, 4
  v_mfma_f32_16x16x32_bf16 v[248:251], v[112:115], v[140:143], v[248:251]
  v_add_u32 v146, s30, v148
  s_add_u32 s33, s33, 1
  v_mfma_f32_16x16x32_bf16 v[244:247], v[108:111], v[140:143], v[244:247]
  v_add_u32 v147, s30, v149
  v_mfma_f32_16x16x32_bf16 v[240:243], v[104:107], v[140:143], v[240:243]
  s_cmp_eq_u32 s29, 3
  s_cbranch_scc1 .g2_kernel_q_out
  s_waitcnt lgkmcnt(0)
  v_mfma_f32_16x16x32_bf16 v[160:163], v[80:83], v[64:67], v[160:163]
  v_cmp_lt_i32 vcc, s33, v151
  v_mfma_f32_16x16x32_bf16 v[164:167], v[80:83], v[68:71], v[164:167]
  s_cbranch_vccz .g2_kernel_q_w6
.g2_kernel_q_back6:
  v_mfma_f32_16x16x32_bf16 v[168:171], v[80:83], v[72:75], v[168:171]
  ds_read_b64_tr_b16 v[120:121], v146 offset:0
  v_mfma_f32_16x16x32_bf16 v[172:175], v[80:83], v[76:79], v[172:175]
  ds_read_b64_tr_b16 v[122:123], v146 offset:512
  v_mfma_f32_16x16x32_bf16 v[188:191], v[84:87], v[76:79], v[188:191]
  ds_read_b128 v[104:107], v145 offset:49152
  v_mfma_f32_16x16x32_bf16 v[184:187], v[84:87], v[72:75], v[184:187]
  ds_read_b128 v[108:111], v145 offset:51200
  v_mfma_f32_16x16x32_bf16 v[180:183], v[84:87], v[68:71], v[180:183]
  ds_read_b128 v[112:115], v145 offset:53248
  v_mfma_f32_16x16x32_bf16 v[176:179], v[84:87], v[64:67], v[176:179]
  ds_read_b128 v[116:119], v145 offset:55296
  v_mfma_f32_16x16x32_bf16 v[192:195], v[88:91], v[64:67], v[192:195]
  ds_read_b64_tr_b16 v[124:125], v147 offset:0
  v_mfma_f32_16x16x32_bf16 v[196:199], v[88:91], v[68:71], v[196:199]
  ds_read_b64_tr_b16 v[126:127], v147 offset:512
  v_mfma_f32_16x16x32_bf16 v[200:203], v[88:91], v[72:75], v[200:203]
  ds_read_b64_tr_b16 v[128:129], v146 offset:4096
  v_mfma_f32_16x16x32_bf16 v[204:207], v[88:91], v[76:79], v[204:207]
  ds_read_b64_tr_b16 v[130:131], v146 offset:4608
  v_mfma_f32_16x16x32_bf16 v[220:223], v[92:95], v[76:79], v[220:223]
  ds_read_b64_tr_b16 v[132:133], v147 offset:4096
  v_mfma_f32_16x16x32_bf16 v[216:219], v[92:95], v[72:75], v[216:219]
  ds_read_b64_tr_b16 v[134:135], v147 offset:4608
  v_mfma_f32_16x16x32_bf16 v[212:215], v[92:95], v[68:71], v[212:215]
  ds_read_b64_tr_b16 v[136:137], v146 offset:8192
  v_mfma_f32_16x16x32_bf16 v[208:211], v[92:95], v[64:67], v[208:211]
  ds_read_b64_tr_b16 v[138:139], v146 offset:8704
  v_mfma_f32_16x16x32_bf16 v[224:227], v[64:67], v[96:99], v[224:227]
  ds_read_b64_tr_b16 v[140:141], v147 offset:8192
  v_mfma_f32_16x16x32_bf16 v[228:231], v[68:71], v[96:99], v[228:231]
  ds_read_b64_tr_b16 v[142:143], v147 offset:8704
  v_mfma_f32_16x16x32_bf16 v[232:235], v[72:75], v[96:99], v[232:235]
  ds_read_b32 v151, v150
  s_add_u32 s30, s30, 12288
  v_mfma_f32_16x16x32_bf16 v[236:239], v[76:79], v[96:99], v[236:239]
  s_mov_b64 exec, 1
  buffer_load_dword off, s[64:67], s31 lds
  s_mov_b64 exec, -1
  s_cmp_eq_u32 s30, 86016
  v_mfma_f32_16x16x32_bf16 v[252:255], v[76:79], v[100:103], v[252:255]
  s_cselect_b32 s30, 0, s30
  s_add_u32 s31, s31, 4
  v_mfma_f32_16x16x32_bf16 v[248:251], v[72:75], v[100:103], v[248:251]
  v_add_u32 v146, s30, v148
  s_add_u32 s33, s33, 1
  v_mfma_f32_16x16x32_bf16 v[244:247], v[68:71], v[100:103], v[244:247]
  v_add_u32 v147, s30, v149
  s_add_u32 s29, s29, 1
  v_mfma_f32_16x16x32_bf16 v[240:243], v[64:67], v[100:103], v[240:243]
  s_branch .g2_kernel_q_loop
.g2_kernel_q_out:
  s_add_u32 s33, s33, 0
  s_waitcnt lgkmcnt(0)
  v_cmp_lt_i32 vcc, s33, v151
  s_cbranch_vccz .g2_kernel_q_wl
.g2_kernel_q_bl:
  s_cmp_lg_u32 s10, 0
  s_cbranch_scc1 .g2_kernel_q_v1
  v_mfma_f32_16x16x32_bf16 v[192:195], v[88:91], v[64:67], v[192:195]
  ds_read_b64_tr_b16 v[80:81], v148 offset:40960
  ds_read_b64_tr_b16 v[82:83], v148 offset:41472
  ds_read_b128 v[128:131], v145 offset:49152
  v_mfma_f32_16x16x32_bf16 v[196:199], v[88:91], v[68:71], v[196:199]
  ds_read_b128 v[132:135], v145 offset:51200
  ds_read_b128 v[136:139], v145 offset:53248
  ds_read_b128 v[140:143], v145 offset:55296
  v_mfma_f32_16x16x32_bf16 v[200:203], v[88:91], v[72:75], v[200:203]
  ds_read_b64_tr_b16 v[84:85], v149 offset:40960
  ds_read_b64_tr_b16 v[86:87], v149 offset:41472
  ds_read_b32 v63, v13 offset:0
  v_mfma_f32_16x16x32_bf16 v[204:207], v[88:91], v[76:79], v[204:207]
  ds_read_b32 v57, v13 offset:24
  ds_read_b128 v[40:43], v52 offset:5120
  ds_read_b128 v[44:47], v52 offset:5184
  v_mfma_f32_16x16x32_bf16 v[220:223], v[92:95], v[76:79], v[220:223]
  ds_read_b32 v24, v50 offset:2816
  ds_read_b32 v25, v50 offset:3328
  ds_read_b32 v26, v50 offset:2880
  v_mfma_f32_16x16x32_bf16 v[216:219], v[92:95], v[72:75], v[216:219]
  ds_read_b32 v27, v50 offset:3392
  ds_read_b32 v28, v50 offset:2944
  ds_read_b32 v29, v50 offset:3456
  v_mfma_f32_16x16x32_bf16 v[212:215], v[92:95], v[68:71], v[212:215]
  ds_read_b32 v30, v50 offset:3008
  ds_read_b32 v31, v50 offset:3520
  v_mfma_f32_16x16x32_bf16 v[208:211], v[92:95], v[64:67], v[208:211]
  s_waitcnt lgkmcnt(12)
  v_mfma_f32_16x16x32_bf16 v[192:195], v[80:83], v[128:131], v[192:195]
  v_mfma_f32_16x16x32_bf16 v[196:199], v[80:83], v[132:135], v[196:199]
  v_mfma_f32_16x16x32_bf16 v[200:203], v[80:83], v[136:139], v[200:203]
  v_mfma_f32_16x16x32_bf16 v[204:207], v[80:83], v[140:143], v[204:207]
  v_mfma_f32_16x16x32_bf16 v[220:223], v[84:87], v[140:143], v[220:223]
  v_mfma_f32_16x16x32_bf16 v[216:219], v[84:87], v[136:139], v[216:219]
  v_mfma_f32_16x16x32_bf16 v[212:215], v[84:87], v[132:135], v[212:215]
  v_mfma_f32_16x16x32_bf16 v[208:211], v[84:87], v[128:131], v[208:211]
  s_waitcnt lgkmcnt(0)
  v_cmp_gt_u32 vcc, 2, v63
  s_cbranch_vccnz .g2_kernel_q_v0ew
.g2_kernel_q_v0eb:
  ds_read_b64_tr_b16 v[120:121], v148 offset:24576
  ds_read_b64_tr_b16 v[122:123], v148 offset:25088
  ds_read_b128 v[104:107], v144 offset:49152
  ds_read_b128 v[108:111], v144 offset:51200
  ds_read_b128 v[112:115], v144 offset:53248
  ds_read_b128 v[116:119], v144 offset:55296
  ds_read_b64_tr_b16 v[124:125], v149 offset:24576
  ds_read_b64_tr_b16 v[126:127], v149 offset:25088
  ds_read_b64_tr_b16 v[128:129], v148 offset:32768
  ds_read_b64_tr_b16 v[130:131], v148 offset:33280
  ds_read_b64_tr_b16 v[132:133], v149 offset:32768
  ds_read_b64_tr_b16 v[134:135], v149 offset:33280
  v_cmp_ne_u32 vcc, 0, v57
  s_cbranch_vccnz .g2_kernel_q_v0p
.g2_kernel_q_v0pb:
  v_pk_mul_f32 v[152:153], v[40:41], v[24:25] op_sel:[0,1] op_sel_hi:[1,1]
  v_pk_mul_f32 v[154:155], v[42:43], v[24:25] op_sel:[0,1] op_sel_hi:[1,1]
  v_pk_mul_f32 v[156:157], v[44:45], v[24:25] op_sel:[0,1] op_sel_hi:[1,1]
  v_pk_mul_f32 v[158:159], v[46:47], v[24:25] op_sel:[0,1] op_sel_hi:[1,1]
  v_pk_fma_f32 v[192:193], v[192:193], v[24:25], v[152:153] op_sel_hi:[1,0,1]
  v_pk_fma_f32 v[194:195], v[194:195], v[24:25], v[154:155] op_sel_hi:[1,0,1]
  v_pk_fma_f32 v[208:209], v[208:209], v[24:25], v[156:157] op_sel_hi:[1,0,1]
  v_pk_fma_f32 v[210:211], v[210:211], v[24:25], v[158:159] op_sel_hi:[1,0,1]
  v_cvt_pk_bf16_f32 v192, v192, v193
  v_cvt_pk_bf16_f32 v193, v194, v195
  v_cvt_pk_bf16_f32 v194, v208, v209
  v_cvt_pk_bf16_f32 v195, v210, v211
  buffer_store_dwordx4 v[192:195], v54, s[4:7], s8 offen offset:0 sc1
  v_pk_mul_f32 v[152:153], v[40:41], v[26:27] op_sel:[0,1] op_sel_hi:[1,1]
  v_pk_mul_f32 v[154:155], v[42:43], v[26:27] op_sel:[0,1] op_sel_hi:[1,1]
  v_pk_mul_f32 v[156:157], v[44:45], v[26:27] op_sel:[0,1] op_sel_hi:[1,1]
  v_pk_mul_f32 v[158:159], v[46:47], v[26:27] op_sel:[0,1] op_sel_hi:[1,1]
  v_pk_fma_f32 v[196:197], v[196:197], v[26:27], v[152:153] op_sel_hi:[1,0,1]
  v_pk_fma_f32 v[198:199], v[198:199], v[26:27], v[154:155] op_sel_hi:[1,0,1]
  v_pk_fma_f32 v[212:213], v[212:213], v[26:27], v[156:157] op_sel_hi:[1,0,1]
  v_pk_fma_f32 v[214:215], v[214:215], v[26:27], v[158:159] op_sel_hi:[1,0,1]
  v_cvt_pk_bf16_f32 v196, v196, v197
  v_cvt_pk_bf16_f32 v197, v198, v199
  v_cvt_pk_bf16_f32 v198, v212, v213
  v_cvt_pk_bf16_f32 v199, v214, v215
  buffer_store_dwordx4 v[196:199], v54, s[4:7], s8 offen offset:128 sc1
  v_pk_mul_f32 v[152:153], v[40:41], v[28:29] op_sel:[0,1] op_sel_hi:[1,1]
  v_pk_mul_f32 v[154:155], v[42:43], v[28:29] op_sel:[0,1] op_sel_hi:[1,1]
  v_pk_mul_f32 v[156:157], v[44:45], v[28:29] op_sel:[0,1] op_sel_hi:[1,1]
  v_pk_mul_f32 v[158:159], v[46:47], v[28:29] op_sel:[0,1] op_sel_hi:[1,1]
  v_pk_fma_f32 v[200:201], v[200:201], v[28:29], v[152:153] op_sel_hi:[1,0,1]
  v_pk_fma_f32 v[202:203], v[202:203], v[28:29], v[154:155] op_sel_hi:[1,0,1]
  v_pk_fma_f32 v[216:217], v[216:217], v[28:29], v[156:157] op_sel_hi:[1,0,1]
  v_pk_fma_f32 v[218:219], v[218:219], v[28:29], v[158:159] op_sel_hi:[1,0,1]
  v_cvt_pk_bf16_f32 v200, v200, v201
  v_cvt_pk_bf16_f32 v201, v202, v203
  v_cvt_pk_bf16_f32 v202, v216, v217
  v_cvt_pk_bf16_f32 v203, v218, v219
  buffer_store_dwordx4 v[200:203], v54, s[4:7], s9 offen offset:0 sc1
  v_pk_mul_f32 v[152:153], v[40:41], v[30:31] op_sel:[0,1] op_sel_hi:[1,1]
  v_pk_mul_f32 v[154:155], v[42:43], v[30:31] op_sel:[0,1] op_sel_hi:[1,1]
  v_pk_mul_f32 v[156:157], v[44:45], v[30:31] op_sel:[0,1] op_sel_hi:[1,1]
  v_pk_mul_f32 v[158:159], v[46:47], v[30:31] op_sel:[0,1] op_sel_hi:[1,1]
  v_pk_fma_f32 v[204:205], v[204:205], v[30:31], v[152:153] op_sel_hi:[1,0,1]
  v_pk_fma_f32 v[206:207], v[206:207], v[30:31], v[154:155] op_sel_hi:[1,0,1]
  v_pk_fma_f32 v[220:221], v[220:221], v[30:31], v[156:157] op_sel_hi:[1,0,1]
  v_pk_fma_f32 v[222:223], v[222:223], v[30:31], v[158:159] op_sel_hi:[1,0,1]
  v_cvt_pk_bf16_f32 v204, v204, v205
  v_cvt_pk_bf16_f32 v205, v206, v207
  v_cvt_pk_bf16_f32 v206, v220, v221
  v_cvt_pk_bf16_f32 v207, v222, v223
  buffer_store_dwordx4 v[204:207], v54, s[4:7], s9 offen offset:128 sc1
  s_waitcnt lgkmcnt(0)
  v_mfma_f32_16x16x32_bf16 v[160:163], v[120:123], v[104:107], v[160:163]
  ds_read_b64_tr_b16 v[80:81], v148 offset:36864
  ds_read_b64_tr_b16 v[82:83], v148 offset:37376
  v_mfma_f32_16x16x32_bf16 v[164:167], v[120:123], v[108:111], v[164:167]
  ds_read_b128 v[64:67], v145 offset:49152
  ds_read_b128 v[68:71], v145 offset:51200
  v_mfma_f32_16x16x32_bf16 v[168:171], v[120:123], v[112:115], v[168:171]
  ds_read_b128 v[72:75], v145 offset:53248
  ds_read_b128 v[76:79], v145 offset:55296
  v_mfma_f32_16x16x32_bf16 v[172:175], v[120:123], v[116:119], v[172:175]
  ds_read_b64_tr_b16 v[84:85], v149 offset:36864
  ds_read_b64_tr_b16 v[86:87], v149 offset:37376
  v_mfma_f32_16x16x32_bf16 v[188:191], v[124:127], v[116:119], v[188:191]
  ds_read_b64_tr_b16 v[88:89], v148 offset:45056
  ds_read_b64_tr_b16 v[90:91], v148 offset:45568
  v_mfma_f32_16x16x32_bf16 v[184:187], v[124:127], v[112:115], v[184:187]
  ds_read_b64_tr_b16 v[92:93], v149 offset:45056
  ds_read_b64_tr_b16 v[94:95], v149 offset:45568
  v_mfma_f32_16x16x32_bf16 v[180:183], v[124:127], v[108:111], v[180:183]
  v_mfma_f32_16x16x32_bf16 v[176:179], v[124:127], v[104:107], v[176:179]
  v_mfma_f32_16x16x32_bf16 v[224:227], v[104:107], v[128:131], v[224:227]
  v_mfma_f32_16x16x32_bf16 v[228:231], v[108:111], v[128:131], v[228:231]
  v_mfma_f32_16x16x32_bf16 v[232:235], v[112:115], v[128:131], v[232:235]
  v_mfma_f32_16x16x32_bf16 v[236:239], v[116:119], v[128:131], v[236:239]
  v_mfma_f32_16x16x32_bf16 v[252:255], v[116:119], v[132:135], v[252:255]
  v_mfma_f32_16x16x32_bf16 v[248:251], v[112:115], v[132:135], v[248:251]
  v_mfma_f32_16x16x32_bf16 v[244:247], v[108:111], v[132:135], v[244:247]
  v_mfma_f32_16x16x32_bf16 v[240:243], v[104:107], v[132:135], v[240:243]
  s_waitcnt lgkmcnt(0)
  v_mfma_f32_16x16x32_bf16 v[160:163], v[80:83], v[64:67], v[160:163]
  ds_read_b32 v63, v58
  ds_read_b128 v[32:35], v52 offset:4864
  v_mfma_f32_16x16x32_bf16 v[164:167], v[80:83], v[68:71], v[164:167]
  ds_read_b128 v[36:39], v52 offset:4928
  ds_read_b128 v[104:107], v51 offset:2816
  v_mfma_f32_16x16x32_bf16 v[168:171], v[80:83], v[72:75], v[168:171]
  ds_read_b128 v[120:123], v51 offset:3328
  ds_read_b128 v[108:111], v51 offset:2880
  v_mfma_f32_16x16x32_bf16 v[172:175], v[80:83], v[76:79], v[172:175]
  ds_read_b128 v[124:127], v51 offset:3392
  ds_read_b128 v[112:115], v51 offset:2944
  v_mfma_f32_16x16x32_bf16 v[188:191], v[84:87], v[76:79], v[188:191]
  ds_read_b128 v[128:131], v51 offset:3456
  ds_read_b128 v[116:119], v51 offset:3008
  v_mfma_f32_16x16x32_bf16 v[184:187], v[84:87], v[72:75], v[184:187]
  ds_read_b128 v[132:135], v51 offset:3520
  ds_read_b32 v48, v53 offset:5376
  v_mfma_f32_16x16x32_bf16 v[180:183], v[84:87], v[68:71], v[180:183]
  ds_read_b32 v49, v53 offset:5440
  v_mfma_f32_16x16x32_bf16 v[176:179], v[84:87], v[64:67], v[176:179]
  v_mfma_f32_16x16x32_bf16 v[224:227], v[64:67], v[88:91], v[224:227]
  v_mfma_f32_16x16x32_bf16 v[228:231], v[68:71], v[88:91], v[228:231]
  v_mfma_f32_16x16x32_bf16 v[232:235], v[72:75], v[88:91], v[232:235]
  v_mfma_f32_16x16x32_bf16 v[236:239], v[76:79], v[88:91], v[236:239]
  v_mfma_f32_16x16x32_bf16 v[252:255], v[76:79], v[92:95], v[252:255]
  v_mfma_f32_16x16x32_bf16 v[248:251], v[72:75], v[92:95], v[248:251]
  v_mfma_f32_16x16x32_bf16 v[244:247], v[68:71], v[92:95], v[244:247]
  v_mfma_f32_16x16x32_bf16 v[240:243], v[64:67], v[92:95], v[240:243]
  s_waitcnt lgkmcnt(0)
  v_cmp_gt_u32 vcc, s12, v63
  s_cbranch_vccnz .g2_kernel_q_v0fw
.g2_kernel_q_v0fc:
  s_cmp_ge_u32 s35, 0x200
  s_cbranch_scc1 .g2_kernel_q_v0r
.g2_kernel_q_v0rb:
  v_pk_mul_f32 v[24:25], v[24:25], v[56:57] op_sel_hi:[1,0]
  v_pk_mul_f32 v[26:27], v[26:27], v[56:57] op_sel_hi:[1,0]
  v_pk_mul_f32 v[28:29], v[28:29], v[56:57] op_sel_hi:[1,0]
  v_pk_mul_f32 v[30:31], v[30:31], v[56:57] op_sel_hi:[1,0]
  ds_write_b128 v59, v[192:195] offset:0
  v_pk_mul_f32 v[152:153], v[32:33], v[24:25] op_sel:[0,1] op_sel_hi:[1,1]
  v_pk_mul_f32 v[154:155], v[34:35], v[24:25] op_sel:[0,1] op_sel_hi:[1,1]
  v_pk_mul_f32 v[156:157], v[36:37], v[24:25] op_sel:[0,1] op_sel_hi:[1,1]
  v_pk_mul_f32 v[158:159], v[38:39], v[24:25] op_sel:[0,1] op_sel_hi:[1,1]
  v_pk_fma_f32 v[160:161], v[160:161], v[24:25], v[152:153] op_sel_hi:[1,0,1]
  v_pk_fma_f32 v[162:163], v[162:163], v[24:25], v[154:155] op_sel_hi:[1,0,1]
  v_pk_fma_f32 v[176:177], v[176:177], v[24:25], v[156:157] op_sel_hi:[1,0,1]
  v_pk_fma_f32 v[178:179], v[178:179], v[24:25], v[158:159] op_sel_hi:[1,0,1]
  v_cvt_pk_bf16_f32 v160, v160, v161
  v_cvt_pk_bf16_f32 v161, v162, v163
  v_cvt_pk_bf16_f32 v162, v176, v177
  v_cvt_pk_bf16_f32 v163, v178, v179
  ds_write_b128 v61, v[160:163] offset:0
  ds_write_b128 v59, v[196:199] offset:128
  v_pk_mul_f32 v[152:153], v[32:33], v[26:27] op_sel:[0,1] op_sel_hi:[1,1]
  v_pk_mul_f32 v[154:155], v[34:35], v[26:27] op_sel:[0,1] op_sel_hi:[1,1]
  v_pk_mul_f32 v[156:157], v[36:37], v[26:27] op_sel:[0,1] op_sel_hi:[1,1]
  v_pk_mul_f32 v[158:159], v[38:39], v[26:27] op_sel:[0,1] op_sel_hi:[1,1]
  v_pk_fma_f32 v[164:165], v[164:165], v[26:27], v[152:153] op_sel_hi:[1,0,1]
  v_pk_fma_f32 v[166:167], v[166:167], v[26:27], v[154:155] op_sel_hi:[1,0,1]
  v_pk_fma_f32 v[180:181], v[180:181], v[26:27], v[156:157] op_sel_hi:[1,0,1]
  v_pk_fma_f32 v[182:183], v[182:183], v[26:27], v[158:159] op_sel_hi:[1,0,1]
  v_cvt_pk_bf16_f32 v164, v164, v165
  v_cvt_pk_bf16_f32 v165, v166, v167
  v_cvt_pk_bf16_f32 v166, v180, v181
  v_cvt_pk_bf16_f32 v167, v182, v183
  ds_write_b128 v61, v[164:167] offset:256
  ds_write_b128 v59, v[200:203] offset:4096
  v_pk_mul_f32 v[152:153], v[32:33], v[28:29] op_sel:[0,1] op_sel_hi:[1,1]
  v_pk_mul_f32 v[154:155], v[34:35], v[28:29] op_sel:[0,1] op_sel_hi:[1,1]
  v_pk_mul_f32 v[156:157], v[36:37], v[28:29] op_sel:[0,1] op_sel_hi:[1,1]
  v_pk_mul_f32 v[158:159], v[38:39], v[28:29] op_sel:[0,1] op_sel_hi:[1,1]
  v_pk_fma_f32 v[168:169], v[168:169], v[28:29], v[152:153] op_sel_hi:[1,0,1]
  v_pk_fma_f32 v[170:171], v[170:171], v[28:29], v[154:155] op_sel_hi:[1,0,1]
  v_pk_fma_f32 v[184:185], v[184:185], v[28:29], v[156:157] op_sel_hi:[1,0,1]
  v_pk_fma_f32 v[186:187], v[186:187], v[28:29], v[158:159] op_sel_hi:[1,0,1]
  v_cvt_pk_bf16_f32 v168, v168, v169
  v_cvt_pk_bf16_f32 v169, v170, v171
  v_cvt_pk_bf16_f32 v170, v184, v185
  v_cvt_pk_bf16_f32 v171, v186, v187
  ds_write_b128 v61, v[168:171] offset:2048
  s_waitcnt vmcnt(0)
  s_mov_b64 exec, 1
  ds_add_rtn_u32 v7, v62, v5 offset:120
  s_mov_b64 exec, -1
  ds_write_b128 v59, v[204:207] offset:4224
  v_pk_mul_f32 v[152:153], v[32:33], v[30:31] op_sel:[0,1] op_sel_hi:[1,1]
  v_pk_mul_f32 v[154:155], v[34:35], v[30:31] op_sel:[0,1] op_sel_hi:[1,1]
  v_pk_mul_f32 v[156:157], v[36:37], v[30:31] op_sel:[0,1] op_sel_hi:[1,1]
  v_pk_mul_f32 v[158:159], v[38:39], v[30:31] op_sel:[0,1] op_sel_hi:[1,1]
  v_pk_fma_f32 v[172:173], v[172:173], v[30:31], v[152:153] op_sel_hi:[1,0,1]
  v_pk_fma_f32 v[174:175], v[174:175], v[30:31], v[154:155] op_sel_hi:[1,0,1]
  v_pk_fma_f32 v[188:189], v[188:189], v[30:31], v[156:157] op_sel_hi:[1,0,1]
  v_pk_fma_f32 v[190:191], v[190:191], v[30:31], v[158:159] op_sel_hi:[1,0,1]
  v_cvt_pk_bf16_f32 v172, v172, v173
  v_cvt_pk_bf16_f32 v173, v174, v175
  v_cvt_pk_bf16_f32 v174, v188, v189
  v_cvt_pk_bf16_f32 v175, v190, v191
  s_waitcnt lgkmcnt(1)
  v_readfirstlane_b32 s28, v7
  s_cmp_eq_u32 s28, 1
  s_cbranch_scc1 .g2_kernel_q_v0f
.g2_kernel_q_v0fb:
  ds_write_b128 v61, v[172:175] offset:2304
  v_pk_mul_f32 v[152:153], v[120:121], v[48:49] op_sel:[0,0] op_sel_hi:[1,0]
  v_pk_mul_f32 v[154:155], v[122:123], v[48:49] op_sel:[0,0] op_sel_hi:[1,0]
  v_pk_mul_f32 v[156:157], v[124:125], v[48:49] op_sel:[0,0] op_sel_hi:[1,0]
  v_pk_mul_f32 v[158:159], v[126:127], v[48:49] op_sel:[0,0] op_sel_hi:[1,0]
  v_pk_fma_f32 v[224:225], v[224:225], v[104:105], v[152:153]
  v_pk_fma_f32 v[226:227], v[226:227], v[106:107], v[154:155]
  v_pk_fma_f32 v[228:229], v[228:229], v[108:109], v[156:157]
  v_pk_fma_f32 v[230:231], v[230:231], v[110:111], v[158:159]
  v_cvt_pk_bf16_f32 v224, v224, v225
  v_cvt_pk_bf16_f32 v225, v226, v227
  v_cvt_pk_bf16_f32 v226, v228, v229
  v_cvt_pk_bf16_f32 v227, v230, v231
  ds_write_b128 v60, v[224:227] offset:2048
  v_pk_mul_f32 v[152:153], v[120:121], v[48:49] op_sel:[0,1] op_sel_hi:[1,1]
  v_pk_mul_f32 v[154:155], v[122:123], v[48:49] op_sel:[0,1] op_sel_hi:[1,1]
  v_pk_mul_f32 v[156:157], v[124:125], v[48:49] op_sel:[0,1] op_sel_hi:[1,1]
  v_pk_mul_f32 v[158:159], v[126:127], v[48:49] op_sel:[0,1] op_sel_hi:[1,1]
  v_pk_fma_f32 v[240:241], v[240:241], v[104:105], v[152:153]
  v_pk_fma_f32 v[242:243], v[242:243], v[106:107], v[154:155]
  v_pk_fma_f32 v[244:245], v[244:245], v[108:109], v[156:157]
  v_pk_fma_f32 v[246:247], v[246:247], v[110:111], v[158:159]
  v_cvt_pk_bf16_f32 v240, v240, v241
  v_cvt_pk_bf16_f32 v241, v242, v243
  v_cvt_pk_bf16_f32 v242, v244, v245
  v_cvt_pk_bf16_f32 v243, v246, v247
  ds_write_b128 v60, v[240:243] offset:2304
  v_pk_mul_f32 v[152:153], v[128:129], v[48:49] op_sel:[0,0] op_sel_hi:[1,0]
  v_pk_mul_f32 v[154:155], v[130:131], v[48:49] op_sel:[0,0] op_sel_hi:[1,0]
  v_pk_mul_f32 v[156:157], v[132:133], v[48:49] op_sel:[0,0] op_sel_hi:[1,0]
  v_pk_mul_f32 v[158:159], v[134:135], v[48:49] op_sel:[0,0] op_sel_hi:[1,0]
  v_pk_fma_f32 v[232:233], v[232:233], v[112:113], v[152:153]
  v_pk_fma_f32 v[234:235], v[234:235], v[114:115], v[154:155]
  v_pk_fma_f32 v[236:237], v[236:237], v[116:117], v[156:157]
  v_pk_fma_f32 v[238:239], v[238:239], v[118:119], v[158:159]
  v_cvt_pk_bf16_f32 v232, v232, v233
  v_cvt_pk_bf16_f32 v233, v234, v235
  v_cvt_pk_bf16_f32 v234, v236, v237
  v_cvt_pk_bf16_f32 v235, v238, v239
  ds_write_b128 v60, v[232:235] offset:6144
  v_pk_mul_f32 v[152:153], v[128:129], v[48:49] op_sel:[0,1] op_sel_hi:[1,1]
  v_pk_mul_f32 v[154:155], v[130:131], v[48:49] op_sel:[0,1] op_sel_hi:[1,1]
  v_pk_mul_f32 v[156:157], v[132:133], v[48:49] op_sel:[0,1] op_sel_hi:[1,1]
  v_pk_mul_f32 v[158:159], v[134:135], v[48:49] op_sel:[0,1] op_sel_hi:[1,1]
  v_pk_fma_f32 v[248:249], v[248:249], v[112:113], v[152:153]
  v_pk_fma_f32 v[250:251], v[250:251], v[114:115], v[154:155]
  v_pk_fma_f32 v[252:253], v[252:253], v[116:117], v[156:157]
  v_pk_fma_f32 v[254:255], v[254:255], v[118:119], v[158:159]
  v_cvt_pk_bf16_f32 v248, v248, v249
  v_cvt_pk_bf16_f32 v249, v250, v251
  v_cvt_pk_bf16_f32 v250, v252, v253
  v_cvt_pk_bf16_f32 v251, v254, v255
  ds_write_b128 v60, v[248:251] offset:6400
.g2_kernel_q_kd:
  s_mov_b64 exec, 1
  ds_add_u32 v13, v5 offset:4
  s_mov_b64 exec, -1
  v_mov_b32 v120, 0
  v_mov_b32 v121, 0
  v_mov_b32 v124, 0
  v_mov_b32 v125, 0
  v_mov_b32 v128, 0
  v_mov_b32 v129, 0
  v_mov_b32 v132, 0
  v_mov_b32 v133, 0
  s_cmp_lg_u32 s62, 0
  s_cbranch_scc1 .g2_kernel_r2
  global_load_dwordx4 v[240:243], v23, s[74:75] offset:0
  global_load_dwordx4 v[244:247], v23, s[74:75] offset:32
  global_load_dwordx4 v[248:251], v23, s[74:75] offset:64
  global_load_dwordx4 v[252:255], v23, s[74:75] offset:96
.g2_kernel_r3:
  v_mov_b32 v6, s71
  s_mov_b32 s38, 0
.g2_kernel_wg4:
  ds_read_b32 v7, v6 offset:4
  s_add_u32 s38, s38, 1
  s_waitcnt lgkmcnt(0)
  v_cmp_gt_u32 vcc, 4, v7
  s_cbranch_vccz .g2_kernel_wg4d
  s_cmp_lt_u32 s38, 524288
  s_cbranch_scc1 .g2_kernel_wg4
.g2_kernel_wg4d:
  ds_read_b128 v[176:179], v9 offset:0
  ds_read_b128 v[180:183], v9 offset:1024
  ds_read_b128 v[24:27], v14 offset:8192
  ds_read_b128 v[28:31], v14 offset:9216
  ds_read_b128 v[184:187], v9 offset:2048
  ds_read_b128 v[188:191], v9 offset:3072
  ds_read_b128 v[32:35], v14 offset:10240
  ds_read_b128 v[36:39], v14 offset:11264
  ds_read_b128 v[40:43], v14 offset:12288
  ds_read_b128 v[44:47], v14 offset:13312
  ds_read_b128 v[48:51], v14 offset:14336
  ds_read_b128 v[52:55], v14 offset:15360
  s_cmp_lg_u32 s35, 0
  s_cbranch_scc1 .g2_kernel_a_own
  s_waitcnt lgkmcnt(8)
.g2_kernel_a_ob:
  v_mfma_f32_32x32x16_bf16 v[136:151], v[176:179], v[24:27], 0
  v_mfma_f32_32x32x16_bf16 v[136:151], v[180:183], v[28:31], v[136:151]
  s_waitcnt lgkmcnt(0)
  s_nop 7
  v_mfma_f32_32x32x16_bf16 v[152:167], v[176:179], v[32:35], 0
  ds_read_b32 v7, v8
  s_nop 0
  v_exp_f32 v136, v136
  v_exp_f32 v137, v137
  v_exp_f32 v138, v138
  v_exp_f32 v139, v139
  v_exp_f32 v140, v140
  v_exp_f32 v141, v141
  v_exp_f32 v142, v142
  v_exp_f32 v143, v143
  v_mfma_f32_32x32x16_bf16 v[152:167], v[180:183], v[36:39], v[152:167]
  s_mov_b64 exec, 1
  ds_add_u32 v13, v5 offset:8
  s_mov_b64 exec, -1
  s_waitcnt lgkmcnt(0)
  v_cmp_lt_u32 vcc, s62, v7
  v_cvt_pk_bf16_f32 v168, v136, v137
  v_cvt_pk_bf16_f32 v169, v138, v139
  v_cvt_pk_bf16_f32 v170, v140, v141
  v_cvt_pk_bf16_f32 v171, v142, v143
  v_exp_f32 v144, v144
  v_exp_f32 v145, v145
  v_exp_f32 v146, v146
  v_exp_f32 v147, v147
  v_mfma_f32_32x32x16_bf16 v[56:71], v[184:187], v[168:171], 0
  s_mov_b32 s36, vcc_lo
  s_andn2_b32 s33, s36, s34
  v_exp_f32 v148, v148
  v_exp_f32 v149, v149
  v_exp_f32 v150, v150
  v_exp_f32 v151, v151
  v_cvt_pk_bf16_f32 v172, v144, v145
  v_cvt_pk_bf16_f32 v173, v146, v147
  v_cvt_pk_bf16_f32 v174, v148, v149
  v_cvt_pk_bf16_f32 v175, v150, v151
  v_mfma_f32_32x32x16_bf16 v[136:151], v[176:179], v[40:43], 0
  v_exp_f32 v152, v152
  v_exp_f32 v153, v153
  v_exp_f32 v154, v154
  v_mfma_f32_32x32x16_bf16 v[56:71], v[188:191], v[172:175], v[56:71]
  s_bcnt1_i32_b32 s33, s33
  s_sub_u32 s33, s33, s39
  s_cmp_lt_i32 s33, 3
  v_exp_f32 v155, v155
  v_exp_f32 v156, v156
  v_exp_f32 v157, v157
  v_smfmac_f32_16x16x64_bf16 v[120:123], v[16:19], v[168:175], v20
  s_cbranch_scc1 .g2_kernel_a_F0n0
  s_mov_b32 s39, 64
  s_call_b64 s[72:73], .g2_kernel_a_three
.g2_kernel_a_F0n0:
  v_exp_f32 v158, v158
  v_exp_f32 v159, v159
  v_mfma_f32_32x32x16_bf16 v[136:151], v[180:183], v[44:47], v[136:151]
  v_cvt_pk_bf16_f32 v168, v152, v153
  v_cvt_pk_bf16_f32 v169, v154, v155
  v_cvt_pk_bf16_f32 v170, v156, v157
  v_cvt_pk_bf16_f32 v171, v158, v159
  v_exp_f32 v160, v160
  v_exp_f32 v161, v161
  v_exp_f32 v162, v162
  v_exp_f32 v163, v163
  v_mfma_f32_32x32x16_bf16 v[72:87], v[184:187], v[168:171], 0
  v_exp_f32 v164, v164
  v_exp_f32 v165, v165
  v_exp_f32 v166, v166
  v_exp_f32 v167, v167
  v_cvt_pk_bf16_f32 v172, v160, v161
  v_cvt_pk_bf16_f32 v173, v162, v163
  v_cvt_pk_bf16_f32 v174, v164, v165
  v_cvt_pk_bf16_f32 v175, v166, v167
  v_mfma_f32_32x32x16_bf16 v[152:167], v[176:179], v[48:51], 0
  ds_read_b32 v7, v8
  v_exp_f32 v136, v136
  v_exp_f32 v137, v137
  v_exp_f32 v138, v138
  v_mfma_f32_32x32x16_bf16 v[72:87], v[188:191], v[172:175], v[72:87]
  s_lshl_b32 s28, s16, 11
  v_exp_f32 v139, v139
  v_exp_f32 v140, v140
  v_exp_f32 v141, v141
  v_smfmac_f32_16x16x64_bf16 v[124:127], v[16:19], v[168:175], v20
  v_add_u32 v9, s28, v3
  v_exp_f32 v142, v142
  v_exp_f32 v143, v143
  v_mfma_f32_32x32x16_bf16 v[152:167], v[180:183], v[52:55], v[152:167]
  s_waitcnt lgkmcnt(0)
  v_cmp_lt_u32 vcc, s62, v7
  v_cvt_pk_bf16_f32 v168, v136, v137
  v_cvt_pk_bf16_f32 v169, v138, v139
  v_cvt_pk_bf16_f32 v170, v140, v141
  v_cvt_pk_bf16_f32 v171, v142, v143
  v_exp_f32 v144, v144
  v_exp_f32 v145, v145
  v_exp_f32 v146, v146
  v_exp_f32 v147, v147
  v_mfma_f32_32x32x16_bf16 v[88:103], v[184:187], v[168:171], 0
  s_mov_b32 s36, vcc_lo
  s_andn2_b32 s33, s36, s34
  v_exp_f32 v148, v148
  v_exp_f32 v149, v149
  v_exp_f32 v150, v150
  v_exp_f32 v151, v151
  v_cvt_pk_bf16_f32 v172, v144, v145
  v_cvt_pk_bf16_f32 v173, v146, v147
  v_cvt_pk_bf16_f32 v174, v148, v149
  v_cvt_pk_bf16_f32 v175, v150, v151
  v_exp_f32 v152, v152
  v_exp_f32 v153, v153
  v_exp_f32 v154, v154
  v_mfma_f32_32x32x16_bf16 v[88:103], v[188:191], v[172:175], v[88:103]
  s_bcnt1_i32_b32 s33, s33
  s_sub_u32 s33, s33, s39
  s_cmp_lt_i32 s33, 3
  v_exp_f32 v155, v155
  v_exp_f32 v156, v156
  v_exp_f32 v157, v157
  v_smfmac_f32_16x16x64_bf16 v[128:131], v[16:19], v[168:175], v20
  s_cbranch_scc1 .g2_kernel_a_F0n2
  s_mov_b32 s39, 64
  s_call_b64 s[72:73], .g2_kernel_a_three
.g2_kernel_a_F0n2:
  v_exp_f32 v158, v158
  v_exp_f32 v159, v159
  v_cvt_pk_bf16_f32 v168, v152, v153
  v_cvt_pk_bf16_f32 v169, v154, v155
  v_cvt_pk_bf16_f32 v170, v156, v157
  v_cvt_pk_bf16_f32 v171, v158, v159
  v_exp_f32 v160, v160
  v_exp_f32 v161, v161
  v_exp_f32 v162, v162
  v_exp_f32 v163, v163
  v_mfma_f32_32x32x16_bf16 v[104:119], v[184:187], v[168:171], 0
  v_exp_f32 v164, v164
  v_exp_f32 v165, v165
  v_exp_f32 v166, v166
  v_exp_f32 v167, v167
  v_cvt_pk_bf16_f32 v172, v160, v161
  v_cvt_pk_bf16_f32 v173, v162, v163
  v_cvt_pk_bf16_f32 v174, v164, v165
  v_cvt_pk_bf16_f32 v175, v166, v167
  s_add_u32 s39, s39, s35
  s_cmp_ge_u32 s39, 3
  s_cbranch_scc1 .g2_kernel_a_p1
  s_call_b64 s[72:73], .g2_kernel_a_three
.g2_kernel_a_p1:
  s_waitcnt vmcnt(10)
  v_mfma_f32_32x32x16_bf16 v[136:151], v[192:195], v[24:27], 0
  v_mfma_f32_32x32x16_bf16 v[136:151], v[196:199], v[28:31], v[136:151]
  s_waitcnt vmcnt(8)
  s_mov_b32 s32, 0
  s_nop 8
  s_branch .g2_kernel_a_n1
  .p2align 6
.g2_kernel_a_loop:
  v_exp_f32 v136, v136
  v_exp_f32 v137, v137
  v_exp_f32 v138, v138
  v_mfma_f32_32x32x16_bf16 v[104:119], v[236:239], v[172:175], v[104:119]
  s_andn2_b32 s33, s36, s34
  v_exp_f32 v139, v139
  v_exp_f32 v140, v140
  v_exp_f32 v141, v141
  v_smfmac_f32_16x16x64_bf16 v[132:135], v[16:19], v[168:175], v20
  s_cbranch_scc0 .g2_kernel_a_N0c
.g2_kernel_a_N0b:
  v_exp_f32 v142, v142
  v_exp_f32 v143, v143
  v_mfma_f32_32x32x16_bf16 v[152:167], v[180:183], v[36:39], v[152:167]
  s_ff1_i32_b32 s33, s33
  v_cvt_pk_bf16_f32 v168, v136, v137
  v_cvt_pk_bf16_f32 v169, v138, v139
  v_cvt_pk_bf16_f32 v170, v140, v141
  v_cvt_pk_bf16_f32 v171, v142, v143
  v_exp_f32 v144, v144
  v_exp_f32 v145, v145
  v_exp_f32 v146, v146
  v_exp_f32 v147, v147
  v_mfma_f32_32x32x16_bf16 v[56:71], v[184:187], v[168:171], v[56:71]
  s_bitset1_b32 s34, s33
  v_exp_f32 v148, v148
  v_exp_f32 v149, v149
  v_exp_f32 v150, v150
  v_exp_f32 v151, v151
  v_cvt_pk_bf16_f32 v172, v144, v145
  v_cvt_pk_bf16_f32 v173, v146, v147
  v_cvt_pk_bf16_f32 v174, v148, v149
  v_cvt_pk_bf16_f32 v175, v150, v151
  v_mfma_f32_32x32x16_bf16 v[136:151], v[176:179], v[40:43], 0
  s_xor_b32 s33, s33, s24
  v_exp_f32 v152, v152
  v_exp_f32 v153, v153
  v_exp_f32 v154, v154
  v_mfma_f32_32x32x16_bf16 v[56:71], v[188:191], v[172:175], v[56:71]
  s_lshl_b32 s33, s33, s25
  v_exp_f32 v155, v155
  v_exp_f32 v156, v156
  v_exp_f32 v157, v157
  v_smfmac_f32_16x16x64_bf16 v[120:123], v[16:19], v[168:175], v20
  s_add_u32 s22, s20, s33
  v_exp_f32 v158, v158
  v_exp_f32 v159, v159
  v_mfma_f32_32x32x16_bf16 v[136:151], v[180:183], v[44:47], v[136:151]
  s_addc_u32 s23, s21, 0
  v_cvt_pk_bf16_f32 v168, v152, v153
  v_cvt_pk_bf16_f32 v169, v154, v155
  v_cvt_pk_bf16_f32 v170, v156, v157
  v_cvt_pk_bf16_f32 v171, v158, v159
  v_exp_f32 v160, v160
  v_exp_f32 v161, v161
  v_exp_f32 v162, v162
  v_exp_f32 v163, v163
  v_mfma_f32_32x32x16_bf16 v[72:87], v[184:187], v[168:171], v[72:87]
  v_exp_f32 v164, v164
  v_exp_f32 v165, v165
  v_exp_f32 v166, v166
  v_exp_f32 v167, v167
  v_cvt_pk_bf16_f32 v172, v160, v161
  v_cvt_pk_bf16_f32 v173, v162, v163
  v_cvt_pk_bf16_f32 v174, v164, v165
  v_cvt_pk_bf16_f32 v175, v166, v167
  v_mfma_f32_32x32x16_bf16 v[152:167], v[176:179], v[48:51], 0
  ds_read_b32 v7, v8
  v_exp_f32 v136, v136
  v_exp_f32 v137, v137
  v_exp_f32 v138, v138
  v_mfma_f32_32x32x16_bf16 v[72:87], v[188:191], v[172:175], v[72:87]
  v_exp_f32 v139, v139
  v_exp_f32 v140, v140
  v_exp_f32 v141, v141
  v_smfmac_f32_16x16x64_bf16 v[124:127], v[16:19], v[168:175], v20
  global_load_dwordx4 v[224:227], v3, s[22:23] offset:0
  global_load_dwordx4 v[228:231], v3, s[22:23] offset:1024
  global_load_dwordx4 v[232:235], v3, s[22:23] offset:2048
  global_load_dwordx4 v[236:239], v3, s[22:23] offset:3072
  v_exp_f32 v142, v142
  v_exp_f32 v143, v143
  v_mfma_f32_32x32x16_bf16 v[152:167], v[180:183], v[52:55], v[152:167]
  v_cvt_pk_bf16_f32 v168, v136, v137
  v_cvt_pk_bf16_f32 v169, v138, v139
  v_cvt_pk_bf16_f32 v170, v140, v141
  v_cvt_pk_bf16_f32 v171, v142, v143
  v_exp_f32 v144, v144
  v_exp_f32 v145, v145
  v_exp_f32 v146, v146
  v_exp_f32 v147, v147
  v_mfma_f32_32x32x16_bf16 v[88:103], v[184:187], v[168:171], v[88:103]
  s_waitcnt vmcnt(8)
  v_exp_f32 v148, v148
  v_exp_f32 v149, v149
  v_exp_f32 v150, v150
  v_exp_f32 v151, v151
  v_cvt_pk_bf16_f32 v172, v144, v145
  v_cvt_pk_bf16_f32 v173, v146, v147
  v_cvt_pk_bf16_f32 v174, v148, v149
  v_cvt_pk_bf16_f32 v175, v150, v151
  v_mfma_f32_32x32x16_bf16 v[136:151], v[192:195], v[24:27], 0
  s_waitcnt lgkmcnt(0)
  v_cmp_lt_u32 vcc, s62, v7
  v_exp_f32 v152, v152
  v_exp_f32 v153, v153
  v_exp_f32 v154, v154
  v_mfma_f32_32x32x16_bf16 v[88:103], v[188:191], v[172:175], v[88:103]
  s_mov_b32 s36, vcc_lo
  v_exp_f32 v155, v155
  v_exp_f32 v156, v156
  v_exp_f32 v157, v157
  v_smfmac_f32_16x16x64_bf16 v[128:131], v[16:19], v[168:175], v20
  v_exp_f32 v158, v158
  v_exp_f32 v159, v159
  v_mfma_f32_32x32x16_bf16 v[136:151], v[196:199], v[28:31], v[136:151]
  v_cvt_pk_bf16_f32 v168, v152, v153
  v_cvt_pk_bf16_f32 v169, v154, v155
  v_cvt_pk_bf16_f32 v170, v156, v157
  v_cvt_pk_bf16_f32 v171, v158, v159
  v_exp_f32 v160, v160
  v_exp_f32 v161, v161
  v_exp_f32 v162, v162
  v_exp_f32 v163, v163
  v_mfma_f32_32x32x16_bf16 v[104:119], v[184:187], v[168:171], v[104:119]
  v_exp_f32 v164, v164
  v_exp_f32 v165, v165
  v_exp_f32 v166, v166
  v_exp_f32 v167, v167
  v_cvt_pk_bf16_f32 v172, v160, v161
  v_cvt_pk_bf16_f32 v173, v162, v163
  v_cvt_pk_bf16_f32 v174, v164, v165
  v_cvt_pk_bf16_f32 v175, v166, v167
.g2_kernel_a_n1:
  v_mfma_f32_32x32x16_bf16 v[152:167], v[192:195], v[32:35], 0
  s_andn2_b32 s33, s36, s34
  v_exp_f32 v136, v136
  v_exp_f32 v137, v137
  v_exp_f32 v138, v138
  v_mfma_f32_32x32x16_bf16 v[104:119], v[188:191], v[172:175], v[104:119]
  s_cbranch_scc0 .g2_kernel_a_N1c
.g2_kernel_a_N1b:
  v_exp_f32 v139, v139
  v_exp_f32 v140, v140
  v_exp_f32 v141, v141
  v_smfmac_f32_16x16x64_bf16 v[132:135], v[16:19], v[168:175], v20
  s_ff1_i32_b32 s33, s33
  v_exp_f32 v142, v142
  v_exp_f32 v143, v143
  v_mfma_f32_32x32x16_bf16 v[152:167], v[196:199], v[36:39], v[152:167]
  s_bitset1_b32 s34, s33
  v_cvt_pk_bf16_f32 v168, v136, v137
  v_cvt_pk_bf16_f32 v169, v138, v139
  v_cvt_pk_bf16_f32 v170, v140, v141
  v_cvt_pk_bf16_f32 v171, v142, v143
  v_exp_f32 v144, v144
  v_exp_f32 v145, v145
  v_exp_f32 v146, v146
  v_exp_f32 v147, v147
  v_mfma_f32_32x32x16_bf16 v[56:71], v[200:203], v[168:171], v[56:71]
  s_xor_b32 s33, s33, s24
  v_exp_f32 v148, v148
  v_exp_f32 v149, v149
  v_exp_f32 v150, v150
  v_exp_f32 v151, v151
  v_cvt_pk_bf16_f32 v172, v144, v145
  v_cvt_pk_bf16_f32 v173, v146, v147
  v_cvt_pk_bf16_f32 v174, v148, v149
  v_cvt_pk_bf16_f32 v175, v150, v151
  v_mfma_f32_32x32x16_bf16 v[136:151], v[192:195], v[40:43], 0
  s_lshl_b32 s33, s33, s25
  v_exp_f32 v152, v152
  v_exp_f32 v153, v153
  v_exp_f32 v154, v154
  v_mfma_f32_32x32x16_bf16 v[56:71], v[204:207], v[172:175], v[56:71]
  s_add_u32 s22, s20, s33
  v_exp_f32 v155, v155
  v_exp_f32 v156, v156
  v_exp_f32 v157, v157
  v_smfmac_f32_16x16x64_bf16 v[120:123], v[16:19], v[168:175], v20
  s_addc_u32 s23, s21, 0
  v_exp_f32 v158, v158
  v_exp_f32 v159, v159
  v_mfma_f32_32x32x16_bf16 v[136:151], v[196:199], v[44:47], v[136:151]
  v_cvt_pk_bf16_f32 v168, v152, v153
  v_cvt_pk_bf16_f32 v169, v154, v155
  v_cvt_pk_bf16_f32 v170, v156, v157
  v_cvt_pk_bf16_f32 v171, v158, v159
  v_exp_f32 v160, v160
  v_exp_f32 v161, v161
  v_exp_f32 v162, v162
  v_exp_f32 v163, v163
  v_mfma_f32_32x32x16_bf16 v[72:87], v[200:203], v[168:171], v[72:87]
  v_exp_f32 v164, v164
  v_exp_f32 v165, v165
  v_exp_f32 v166, v166
  v_exp_f32 v167, v167
  v_cvt_pk_bf16_f32 v172, v160, v161
  v_cvt_pk_bf16_f32 v173, v162, v163
  v_cvt_pk_bf16_f32 v174, v164, v165
  v_cvt_pk_bf16_f32 v175, v166, v167
  v_mfma_f32_32x32x16_bf16 v[152:167], v[192:195], v[48:51], 0
  v_exp_f32 v136, v136
  v_exp_f32 v137, v137
  v_exp_f32 v138, v138
  v_mfma_f32_32x32x16_bf16 v[72:87], v[204:207], v[172:175], v[72:87]
  v_exp_f32 v139, v139
  v_exp_f32 v140, v140
  v_exp_f32 v141, v141
  v_smfmac_f32_16x16x64_bf16 v[124:127], v[16:19], v[168:175], v20
  global_load_dwordx4 v[176:179], v3, s[22:23] offset:0
  global_load_dwordx4 v[180:183], v3, s[22:23] offset:1024
  global_load_dwordx4 v[184:187], v3, s[22:23] offset:2048
  global_load_dwordx4 v[188:191], v3, s[22:23] offset:3072
  v_exp_f32 v142, v142
  v_exp_f32 v143, v143
  v_mfma_f32_32x32x16_bf16 v[152:167], v[196:199], v[52:55], v[152:167]
  v_cvt_pk_bf16_f32 v168, v136, v137
  v_cvt_pk_bf16_f32 v169, v138, v139
  v_cvt_pk_bf16_f32 v170, v140, v141
  v_cvt_pk_bf16_f32 v171, v142, v143
  v_exp_f32 v144, v144
  v_exp_f32 v145, v145
  v_exp_f32 v146, v146
  v_exp_f32 v147, v147
  v_mfma_f32_32x32x16_bf16 v[88:103], v[200:203], v[168:171], v[88:103]
  s_waitcnt vmcnt(8)
  v_exp_f32 v148, v148
  v_exp_f32 v149, v149
  v_exp_f32 v150, v150
  v_exp_f32 v151, v151
  v_cvt_pk_bf16_f32 v172, v144, v145
  v_cvt_pk_bf16_f32 v173, v146, v147
  v_cvt_pk_bf16_f32 v174, v148, v149
  v_cvt_pk_bf16_f32 v175, v150, v151
  v_mfma_f32_32x32x16_bf16 v[136:151], v[208:211], v[24:27], 0
  v_exp_f32 v152, v152
  v_exp_f32 v153, v153
  v_exp_f32 v154, v154
  v_mfma_f32_32x32x16_bf16 v[88:103], v[204:207], v[172:175], v[88:103]
  v_exp_f32 v155, v155
  v_exp_f32 v156, v156
  v_exp_f32 v157, v157
  v_smfmac_f32_16x16x64_bf16 v[128:131], v[16:19], v[168:175], v20
  v_exp_f32 v158, v158
  v_exp_f32 v159, v159
  v_mfma_f32_32x32x16_bf16 v[136:151], v[212:215], v[28:31], v[136:151]
  v_cvt_pk_bf16_f32 v168, v152, v153
  v_cvt_pk_bf16_f32 v169, v154, v155
  v_cvt_pk_bf16_f32 v170, v156, v157
  v_cvt_pk_bf16_f32 v171, v158, v159
  v_exp_f32 v160, v160
  v_exp_f32 v161, v161
  v_exp_f32 v162, v162
  v_exp_f32 v163, v163
  v_mfma_f32_32x32x16_bf16 v[104:119], v[200:203], v[168:171], v[104:119]
  v_exp_f32 v164, v164
  v_exp_f32 v165, v165
  v_exp_f32 v166, v166
  v_exp_f32 v167, v167
  v_cvt_pk_bf16_f32 v172, v160, v161
  v_cvt_pk_bf16_f32 v173, v162, v163
  v_cvt_pk_bf16_f32 v174, v164, v165
  v_cvt_pk_bf16_f32 v175, v166, v167
  v_mfma_f32_32x32x16_bf16 v[152:167], v[208:211], v[32:35], 0
  s_andn2_b32 s33, s36, s34
  v_exp_f32 v136, v136
  v_exp_f32 v137, v137
  v_exp_f32 v138, v138
  v_mfma_f32_32x32x16_bf16 v[104:119], v[204:207], v[172:175], v[104:119]
  s_cbranch_scc0 .g2_kernel_a_N2c
.g2_kernel_a_N2b:
  v_exp_f32 v139, v139
  v_exp_f32 v140, v140
  v_exp_f32 v141, v141
  v_smfmac_f32_16x16x64_bf16 v[132:135], v[16:19], v[168:175], v20
  s_ff1_i32_b32 s33, s33
  v_exp_f32 v142, v142
  v_exp_f32 v143, v143
  v_mfma_f32_32x32x16_bf16 v[152:167], v[212:215], v[36:39], v[152:167]
  s_bitset1_b32 s34, s33
  v_cvt_pk_bf16_f32 v168, v136, v137
  v_cvt_pk_bf16_f32 v169, v138, v139
  v_cvt_pk_bf16_f32 v170, v140, v141
  v_cvt_pk_bf16_f32 v171, v142, v143
  v_exp_f32 v144, v144
  v_exp_f32 v145, v145
  v_exp_f32 v146, v146
  v_exp_f32 v147, v147
  v_mfma_f32_32x32x16_bf16 v[56:71], v[216:219], v[168:171], v[56:71]
  s_xor_b32 s33, s33, s24
  v_exp_f32 v148, v148
  v_exp_f32 v149, v149
  v_exp_f32 v150, v150
  v_exp_f32 v151, v151
  v_cvt_pk_bf16_f32 v172, v144, v145
  v_cvt_pk_bf16_f32 v173, v146, v147
  v_cvt_pk_bf16_f32 v174, v148, v149
  v_cvt_pk_bf16_f32 v175, v150, v151
  v_mfma_f32_32x32x16_bf16 v[136:151], v[208:211], v[40:43], 0
  s_lshl_b32 s33, s33, s25
  v_exp_f32 v152, v152
  v_exp_f32 v153, v153
  v_exp_f32 v154, v154
  v_mfma_f32_32x32x16_bf16 v[56:71], v[220:223], v[172:175], v[56:71]
  s_add_u32 s22, s20, s33
  v_exp_f32 v155, v155
  v_exp_f32 v156, v156
  v_exp_f32 v157, v157
  v_smfmac_f32_16x16x64_bf16 v[120:123], v[16:19], v[168:175], v20
  s_addc_u32 s23, s21, 0
  v_exp_f32 v158, v158
  v_exp_f32 v159, v159
  v_mfma_f32_32x32x16_bf16 v[136:151], v[212:215], v[44:47], v[136:151]
  v_cvt_pk_bf16_f32 v168, v152, v153
  v_cvt_pk_bf16_f32 v169, v154, v155
  v_cvt_pk_bf16_f32 v170, v156, v157
  v_cvt_pk_bf16_f32 v171, v158, v159
  v_exp_f32 v160, v160
  v_exp_f32 v161, v161
  v_exp_f32 v162, v162
  v_exp_f32 v163, v163
  v_mfma_f32_32x32x16_bf16 v[72:87], v[216:219], v[168:171], v[72:87]
  v_exp_f32 v164, v164
  v_exp_f32 v165, v165
  v_exp_f32 v166, v166
  v_exp_f32 v167, v167
  v_cvt_pk_bf16_f32 v172, v160, v161
  v_cvt_pk_bf16_f32 v173, v162, v163
  v_cvt_pk_bf16_f32 v174, v164, v165
  v_cvt_pk_bf16_f32 v175, v166, v167
  v_mfma_f32_32x32x16_bf16 v[152:167], v[208:211], v[48:51], 0
  v_exp_f32 v136, v136
  v_exp_f32 v137, v137
  v_exp_f32 v138, v138
  v_mfma_f32_32x32x16_bf16 v[72:87], v[220:223], v[172:175], v[72:87]
  v_exp_f32 v139, v139
  v_exp_f32 v140, v140
  v_exp_f32 v141, v141
  v_smfmac_f32_16x16x64_bf16 v[124:127], v[16:19], v[168:175], v20
  global_load_dwordx4 v[192:195], v3, s[22:23] offset:0
  global_load_dwordx4 v[196:199], v3, s[22:23] offset:1024
  global_load_dwordx4 v[200:203], v3, s[22:23] offset:2048
  global_load_dwordx4 v[204:207], v3, s[22:23] offset:3072
  v_exp_f32 v142, v142
  v_exp_f32 v143, v143
  v_mfma_f32_32x32x16_bf16 v[152:167], v[212:215], v[52:55], v[152:167]
  v_cvt_pk_bf16_f32 v168, v136, v137
  v_cvt_pk_bf16_f32 v169, v138, v139
  v_cvt_pk_bf16_f32 v170, v140, v141
  v_cvt_pk_bf16_f32 v171, v142, v143
  v_exp_f32 v144, v144
  v_exp_f32 v145, v145
  v_exp_f32 v146, v146
  v_exp_f32 v147, v147
  v_mfma_f32_32x32x16_bf16 v[88:103], v[216:219], v[168:171], v[88:103]
  s_waitcnt vmcnt(8)
  v_exp_f32 v148, v148
  v_exp_f32 v149, v149
  v_exp_f32 v150, v150
  v_exp_f32 v151, v151
  v_cvt_pk_bf16_f32 v172, v144, v145
  v_cvt_pk_bf16_f32 v173, v146, v147
  v_cvt_pk_bf16_f32 v174, v148, v149
  v_cvt_pk_bf16_f32 v175, v150, v151
  v_mfma_f32_32x32x16_bf16 v[136:151], v[224:227], v[24:27], 0
  v_exp_f32 v152, v152
  v_exp_f32 v153, v153
  v_exp_f32 v154, v154
  v_mfma_f32_32x32x16_bf16 v[88:103], v[220:223], v[172:175], v[88:103]
  v_exp_f32 v155, v155
  v_exp_f32 v156, v156
  v_exp_f32 v157, v157
  v_smfmac_f32_16x16x64_bf16 v[128:131], v[16:19], v[168:175], v20
  v_exp_f32 v158, v158
  v_exp_f32 v159, v159
  v_mfma_f32_32x32x16_bf16 v[136:151], v[228:231], v[28:31], v[136:151]
  s_and_b32 s28, s32, 3
  v_cvt_pk_bf16_f32 v168, v152, v153
  v_cvt_pk_bf16_f32 v169, v154, v155
  v_cvt_pk_bf16_f32 v170, v156, v157
  v_cvt_pk_bf16_f32 v171, v158, v159
  v_exp_f32 v160, v160
  v_exp_f32 v161, v161
  v_exp_f32 v162, v162
  v_exp_f32 v163, v163
  v_mfma_f32_32x32x16_bf16 v[104:119], v[216:219], v[168:171], v[104:119]
  s_cmp_eq_u32 s28, 3
  v_exp_f32 v164, v164
  v_exp_f32 v165, v165
  v_exp_f32 v166, v166
  v_exp_f32 v167, v167
  v_cvt_pk_bf16_f32 v172, v160, v161
  v_cvt_pk_bf16_f32 v173, v162, v163
  v_cvt_pk_bf16_f32 v174, v164, v165
  v_cvt_pk_bf16_f32 v175, v166, v167
  v_mfma_f32_32x32x16_bf16 v[152:167], v[224:227], v[32:35], 0
  s_cbranch_scc1 .g2_kernel_a_last
  v_exp_f32 v136, v136
  v_exp_f32 v137, v137
  v_exp_f32 v138, v138
  v_mfma_f32_32x32x16_bf16 v[104:119], v[220:223], v[172:175], v[104:119]
  s_andn2_b32 s33, s36, s34
  v_exp_f32 v139, v139
  v_exp_f32 v140, v140
  v_exp_f32 v141, v141
  v_smfmac_f32_16x16x64_bf16 v[132:135], v[16:19], v[168:175], v20
  s_cbranch_scc0 .g2_kernel_a_N3c
.g2_kernel_a_N3b:
  v_exp_f32 v142, v142
  v_exp_f32 v143, v143
  v_mfma_f32_32x32x16_bf16 v[152:167], v[228:231], v[36:39], v[152:167]
  s_ff1_i32_b32 s33, s33
  v_cvt_pk_bf16_f32 v168, v136, v137
  v_cvt_pk_bf16_f32 v169, v138, v139
  v_cvt_pk_bf16_f32 v170, v140, v141
  v_cvt_pk_bf16_f32 v171, v142, v143
  v_exp_f32 v144, v144
  v_exp_f32 v145, v145
  v_exp_f32 v146, v146
  v_exp_f32 v147, v147
  v_mfma_f32_32x32x16_bf16 v[56:71], v[232:235], v[168:171], v[56:71]
  s_bitset1_b32 s34, s33
  v_exp_f32 v148, v148
  v_exp_f32 v149, v149
  v_exp_f32 v150, v150
  v_exp_f32 v151, v151
  v_cvt_pk_bf16_f32 v172, v144, v145
  v_cvt_pk_bf16_f32 v173, v146, v147
  v_cvt_pk_bf16_f32 v174, v148, v149
  v_cvt_pk_bf16_f32 v175, v150, v151
  v_mfma_f32_32x32x16_bf16 v[136:151], v[224:227], v[40:43], 0
  s_xor_b32 s33, s33, s24
  v_exp_f32 v152, v152
  v_exp_f32 v153, v153
  v_exp_f32 v154, v154
  v_mfma_f32_32x32x16_bf16 v[56:71], v[236:239], v[172:175], v[56:71]
  s_lshl_b32 s33, s33, s25
  v_exp_f32 v155, v155
  v_exp_f32 v156, v156
  v_exp_f32 v157, v157
  v_smfmac_f32_16x16x64_bf16 v[120:123], v[16:19], v[168:175], v20
  s_add_u32 s22, s20, s33
  v_exp_f32 v158, v158
  v_exp_f32 v159, v159
  v_mfma_f32_32x32x16_bf16 v[136:151], v[228:231], v[44:47], v[136:151]
  s_addc_u32 s23, s21, 0
  v_cvt_pk_bf16_f32 v168, v152, v153
  v_cvt_pk_bf16_f32 v169, v154, v155
  v_cvt_pk_bf16_f32 v170, v156, v157
  v_cvt_pk_bf16_f32 v171, v158, v159
  v_exp_f32 v160, v160
  v_exp_f32 v161, v161
  v_exp_f32 v162, v162
  v_exp_f32 v163, v163
  v_mfma_f32_32x32x16_bf16 v[72:87], v[232:235], v[168:171], v[72:87]
  v_exp_f32 v164, v164
  v_exp_f32 v165, v165
  v_exp_f32 v166, v166
  v_exp_f32 v167, v167
  v_cvt_pk_bf16_f32 v172, v160, v161
  v_cvt_pk_bf16_f32 v173, v162, v163
  v_cvt_pk_bf16_f32 v174, v164, v165
  v_cvt_pk_bf16_f32 v175, v166, v167
  v_mfma_f32_32x32x16_bf16 v[152:167], v[224:227], v[48:51], 0
  v_exp_f32 v136, v136
  v_exp_f32 v137, v137
  v_exp_f32 v138, v138
  v_mfma_f32_32x32x16_bf16 v[72:87], v[236:239], v[172:175], v[72:87]
  v_exp_f32 v139, v139
  v_exp_f32 v140, v140
  v_exp_f32 v141, v141
  v_smfmac_f32_16x16x64_bf16 v[124:127], v[16:19], v[168:175], v20
  global_load_dwordx4 v[208:211], v3, s[22:23] offset:0
  global_load_dwordx4 v[212:215], v3, s[22:23] offset:1024
  global_load_dwordx4 v[216:219], v3, s[22:23] offset:2048
  global_load_dwordx4 v[220:223], v3, s[22:23] offset:3072
  v_exp_f32 v142, v142
  v_exp_f32 v143, v143
  v_mfma_f32_32x32x16_bf16 v[152:167], v[228:231], v[52:55], v[152:167]
  v_cvt_pk_bf16_f32 v168, v136, v137
  v_cvt_pk_bf16_f32 v169, v138, v139
  v_cvt_pk_bf16_f32 v170, v140, v141
  v_cvt_pk_bf16_f32 v171, v142, v143
  v_exp_f32 v144, v144
  v_exp_f32 v145, v145
  v_exp_f32 v146, v146
  v_exp_f32 v147, v147
  v_mfma_f32_32x32x16_bf16 v[88:103], v[232:235], v[168:171], v[88:103]
  s_waitcnt vmcnt(8)
  v_exp_f32 v148, v148
  v_exp_f32 v149, v149
  v_exp_f32 v150, v150
  v_exp_f32 v151, v151
  v_cvt_pk_bf16_f32 v172, v144, v145
  v_cvt_pk_bf16_f32 v173, v146, v147
  v_cvt_pk_bf16_f32 v174, v148, v149
  v_cvt_pk_bf16_f32 v175, v150, v151
  v_mfma_f32_32x32x16_bf16 v[136:151], v[176:179], v[24:27], 0
  v_exp_f32 v152, v152
  v_exp_f32 v153, v153
  v_exp_f32 v154, v154
  v_mfma_f32_32x32x16_bf16 v[88:103], v[236:239], v[172:175], v[88:103]
  v_exp_f32 v155, v155
  v_exp_f32 v156, v156
  v_exp_f32 v157, v157
  v_smfmac_f32_16x16x64_bf16 v[128:131], v[16:19], v[168:175], v20
  v_exp_f32 v158, v158
  v_exp_f32 v159, v159
  v_mfma_f32_32x32x16_bf16 v[136:151], v[180:183], v[28:31], v[136:151]
  s_add_u32 s32, s32, 1
  v_cvt_pk_bf16_f32 v168, v152, v153
  v_cvt_pk_bf16_f32 v169, v154, v155
  v_cvt_pk_bf16_f32 v170, v156, v157
  v_cvt_pk_bf16_f32 v171, v158, v159
  v_exp_f32 v160, v160
  v_exp_f32 v161, v161
  v_exp_f32 v162, v162
  v_exp_f32 v163, v163
  v_mfma_f32_32x32x16_bf16 v[104:119], v[232:235], v[168:171], v[104:119]
  s_cmp_eq_u32 s35, 0
  v_exp_f32 v164, v164
  v_exp_f32 v165, v165
  v_exp_f32 v166, v166
  v_exp_f32 v167, v167
  v_cvt_pk_bf16_f32 v172, v160, v161
  v_cvt_pk_bf16_f32 v173, v162, v163
  v_cvt_pk_bf16_f32 v174, v164, v165
  v_cvt_pk_bf16_f32 v175, v166, v167
  v_mfma_f32_32x32x16_bf16 v[152:167], v[176:179], v[32:35], 0
  s_cbranch_scc1 .g2_kernel_a_loop
  s_branch .g2_kernel_a_redo
.g2_kernel_a_last:
  ds_read_b32 v21, v13 offset:8
  v_exp_f32 v136, v136
  v_exp_f32 v137, v137
  v_exp_f32 v138, v138
  v_mfma_f32_32x32x16_bf16 v[104:119], v[220:223], v[172:175], v[104:119]
  s_andn2_b32 s33, s36, s34
  v_exp_f32 v139, v139
  v_exp_f32 v140, v140
  v_exp_f32 v141, v141
  v_smfmac_f32_16x16x64_bf16 v[132:135], v[16:19], v[168:175], v20
  s_cbranch_scc0 .g2_kernel_a_L3c
.g2_kernel_a_L3b:
  v_exp_f32 v142, v142
  v_exp_f32 v143, v143
  v_mfma_f32_32x32x16_bf16 v[152:167], v[228:231], v[36:39], v[152:167]
  s_ff1_i32_b32 s33, s33
  ds_read_b128 v[24:27], v14 offset:0
  v_cvt_pk_bf16_f32 v168, v136, v137
  v_cvt_pk_bf16_f32 v169, v138, v139
  v_cvt_pk_bf16_f32 v170, v140, v141
  v_cvt_pk_bf16_f32 v171, v142, v143
  v_exp_f32 v144, v144
  v_exp_f32 v145, v145
  v_exp_f32 v146, v146
  v_exp_f32 v147, v147
  v_mfma_f32_32x32x16_bf16 v[56:71], v[232:235], v[168:171], v[56:71]
  s_bitset1_b32 s34, s33
  ds_read_b128 v[28:31], v14 offset:1024
  v_exp_f32 v148, v148
  v_exp_f32 v149, v149
  v_exp_f32 v150, v150
  v_exp_f32 v151, v151
  v_cvt_pk_bf16_f32 v172, v144, v145
  v_cvt_pk_bf16_f32 v173, v146, v147
  v_cvt_pk_bf16_f32 v174, v148, v149
  v_cvt_pk_bf16_f32 v175, v150, v151
  v_mfma_f32_32x32x16_bf16 v[136:151], v[224:227], v[40:43], 0
  s_waitcnt lgkmcnt(2)
  s_xor_b32 s33, s33, s24
  v_exp_f32 v152, v152
  v_exp_f32 v153, v153
  v_exp_f32 v154, v154
  v_mfma_f32_32x32x16_bf16 v[56:71], v[236:239], v[172:175], v[56:71]
  v_cmp_gt_u32 vcc, s27, v21
  s_lshl_b32 s33, s33, s25
  v_exp_f32 v155, v155
  v_exp_f32 v156, v156
  v_exp_f32 v157, v157
  v_smfmac_f32_16x16x64_bf16 v[120:123], v[16:19], v[168:175], v20
  s_add_u32 s22, s20, s33
  v_exp_f32 v158, v158
  v_exp_f32 v159, v159
  v_mfma_f32_32x32x16_bf16 v[136:151], v[228:231], v[44:47], v[136:151]
  s_addc_u32 s23, s21, 0
  v_cvt_pk_bf16_f32 v168, v152, v153
  v_cvt_pk_bf16_f32 v169, v154, v155
  v_cvt_pk_bf16_f32 v170, v156, v157
  v_cvt_pk_bf16_f32 v171, v158, v159
  v_exp_f32 v160, v160
  v_exp_f32 v161, v161
  v_exp_f32 v162, v162
  v_exp_f32 v163, v163
  v_mfma_f32_32x32x16_bf16 v[72:87], v[232:235], v[168:171], v[72:87]
  s_cbranch_vccnz .g2_kernel_a_L3g
.g2_kernel_a_L3h:
  ds_read_b128 v[32:35], v14 offset:2048
  ds_read_b128 v[36:39], v14 offset:3072
  v_cvt_pk_bf16_f32 v56, v56, v57
  v_cvt_pk_bf16_f32 v57, v58, v59
  v_cvt_pk_bf16_f32 v58, v60, v61
  v_cvt_pk_bf16_f32 v59, v62, v63
  v_add_f32 v6, v120, v121
  v_exp_f32 v164, v164
  v_exp_f32 v165, v165
  v_exp_f32 v166, v166
  v_exp_f32 v167, v167
  v_cvt_pk_bf16_f32 v172, v160, v161
  v_cvt_pk_bf16_f32 v173, v162, v163
  v_cvt_pk_bf16_f32 v174, v164, v165
  v_cvt_pk_bf16_f32 v175, v166, v167
  v_mfma_f32_32x32x16_bf16 v[152:167], v[224:227], v[48:51], 0
  ds_write_b128 v9, v[56:59] offset:0
  v_cvt_pk_bf16_f32 v60, v64, v65
  v_cvt_pk_bf16_f32 v61, v66, v67
  v_cvt_pk_bf16_f32 v62, v68, v69
  v_cvt_pk_bf16_f32 v63, v70, v71
  v_exp_f32 v136, v136
  v_exp_f32 v137, v137
  v_exp_f32 v138, v138
  v_mfma_f32_32x32x16_bf16 v[72:87], v[236:239], v[172:175], v[72:87]
  ds_write_b128 v9, v[60:63] offset:1024
  v_mov_b32 v120, 0
  v_mov_b32 v121, 0
  v_exp_f32 v139, v139
  v_exp_f32 v140, v140
  v_exp_f32 v141, v141
  v_smfmac_f32_16x16x64_bf16 v[124:127], v[16:19], v[168:175], v20
  global_load_dwordx4 v[208:211], v3, s[22:23] offset:0
  global_load_dwordx4 v[212:215], v3, s[22:23] offset:1024
  global_load_dwordx4 v[216:219], v3, s[22:23] offset:2048
  global_load_dwordx4 v[220:223], v3, s[22:23] offset:3072
  ds_write_b32 v10, v6 offset:0
  ds_write_b32 v11, v12 offset:0
  v_exp_f32 v142, v142
  v_exp_f32 v143, v143
  v_mfma_f32_32x32x16_bf16 v[152:167], v[228:231], v[52:55], v[152:167]
  ds_read_b128 v[40:43], v14 offset:4096
  s_wakeup
  v_cvt_pk_bf16_f32 v168, v136, v137
  v_cvt_pk_bf16_f32 v169, v138, v139
  v_cvt_pk_bf16_f32 v170, v140, v141
  v_cvt_pk_bf16_f32 v171, v142, v143
  v_exp_f32 v144, v144
  v_exp_f32 v145, v145
  v_exp_f32 v146, v146
  v_exp_f32 v147, v147
  v_mfma_f32_32x32x16_bf16 v[88:103], v[232:235], v[168:171], v[88:103]
  s_waitcnt vmcnt(8)
  ds_read_b128 v[44:47], v14 offset:5120
  v_cvt_pk_bf16_f32 v72, v72, v73
  v_cvt_pk_bf16_f32 v73, v74, v75
  v_cvt_pk_bf16_f32 v74, v76, v77
  v_cvt_pk_bf16_f32 v75, v78, v79
  v_add_f32 v6, v124, v125
  v_exp_f32 v148, v148
  v_exp_f32 v149, v149
  v_exp_f32 v150, v150
  v_exp_f32 v151, v151
  v_cvt_pk_bf16_f32 v172, v144, v145
  v_cvt_pk_bf16_f32 v173, v146, v147
  v_cvt_pk_bf16_f32 v174, v148, v149
  v_cvt_pk_bf16_f32 v175, v150, v151
  s_waitcnt lgkmcnt(8)
  v_mfma_f32_32x32x16_bf16 v[136:151], v[176:179], v[24:27], 0
  ds_write_b128 v9, v[72:75] offset:8192
  v_cvt_pk_bf16_f32 v76, v80, v81
  v_cvt_pk_bf16_f32 v77, v82, v83
  v_cvt_pk_bf16_f32 v78, v84, v85
  v_cvt_pk_bf16_f32 v79, v86, v87
  v_exp_f32 v152, v152
  v_exp_f32 v153, v153
  v_exp_f32 v154, v154
  v_mfma_f32_32x32x16_bf16 v[88:103], v[236:239], v[172:175], v[88:103]
  ds_write_b128 v9, v[76:79] offset:9216
  v_mov_b32 v124, 0
  v_mov_b32 v125, 0
  v_exp_f32 v155, v155
  v_exp_f32 v156, v156
  v_exp_f32 v157, v157
  v_smfmac_f32_16x16x64_bf16 v[128:131], v[16:19], v[168:175], v20
  ds_write_b32 v10, v6 offset:512
  ds_write_b32 v11, v12 offset:16
  v_exp_f32 v158, v158
  v_exp_f32 v159, v159
  v_mfma_f32_32x32x16_bf16 v[136:151], v[180:183], v[28:31], v[136:151]
  ds_read_b128 v[48:51], v14 offset:6144
  s_wakeup
  v_cvt_pk_bf16_f32 v168, v152, v153
  v_cvt_pk_bf16_f32 v169, v154, v155
  v_cvt_pk_bf16_f32 v170, v156, v157
  v_cvt_pk_bf16_f32 v171, v158, v159
  v_exp_f32 v160, v160
  v_exp_f32 v161, v161
  v_exp_f32 v162, v162
  v_exp_f32 v163, v163
  v_mfma_f32_32x32x16_bf16 v[104:119], v[232:235], v[168:171], v[104:119]
  ds_read_b128 v[52:55], v14 offset:7168
  v_cvt_pk_bf16_f32 v88, v88, v89
  v_cvt_pk_bf16_f32 v89, v90, v91
  v_cvt_pk_bf16_f32 v90, v92, v93
  v_cvt_pk_bf16_f32 v91, v94, v95
  v_add_f32 v6, v128, v129
  ds_write_b128 v9, v[88:91] offset:16384
  v_cvt_pk_bf16_f32 v92, v96, v97
  v_cvt_pk_bf16_f32 v93, v98, v99
  v_cvt_pk_bf16_f32 v94, v100, v101
  v_cvt_pk_bf16_f32 v95, v102, v103
  ds_write_b128 v9, v[92:95] offset:17408
  v_mov_b32 v128, 0
  v_mov_b32 v129, 0
  ds_write_b32 v10, v6 offset:1024
  ds_write_b32 v11, v12 offset:32
  s_add_u32 s32, s32, 1
  v_exp_f32 v164, v164
  v_exp_f32 v165, v165
  v_exp_f32 v166, v166
  v_exp_f32 v167, v167
  v_cvt_pk_bf16_f32 v172, v160, v161
  v_cvt_pk_bf16_f32 v173, v162, v163
  v_cvt_pk_bf16_f32 v174, v164, v165
  v_cvt_pk_bf16_f32 v175, v166, v167
  s_cmp_eq_u32 s32, 8
  s_cbranch_scc1 .g2_kernel_a_end
  s_waitcnt lgkmcnt(15)
  v_mfma_f32_32x32x16_bf16 v[152:167], v[176:179], v[32:35], 0
  s_andn2_b32 s33, s36, s34
  v_exp_f32 v136, v136
  v_exp_f32 v137, v137
  v_exp_f32 v138, v138
  v_mfma_f32_32x32x16_bf16 v[104:119], v[236:239], v[172:175], v[104:119]
  s_cbranch_scc0 .g2_kernel_a_G0c
.g2_kernel_a_G0b:
  v_exp_f32 v139, v139
  v_exp_f32 v140, v140
  v_exp_f32 v141, v141
  v_smfmac_f32_16x16x64_bf16 v[132:135], v[16:19], v[168:175], v20
  s_ff1_i32_b32 s33, s33
  v_exp_f32 v142, v142
  v_exp_f32 v143, v143
  v_mfma_f32_32x32x16_bf16 v[152:167], v[180:183], v[36:39], v[152:167]
  s_bitset1_b32 s34, s33
  v_cvt_pk_bf16_f32 v168, v136, v137
  v_cvt_pk_bf16_f32 v169, v138, v139
  v_cvt_pk_bf16_f32 v170, v140, v141
  v_cvt_pk_bf16_f32 v171, v142, v143
  v_exp_f32 v144, v144
  v_exp_f32 v145, v145
  v_exp_f32 v146, v146
  v_exp_f32 v147, v147
  s_waitcnt lgkmcnt(14)
  v_mfma_f32_32x32x16_bf16 v[56:71], v[184:187], v[168:171], 0
  s_xor_b32 s33, s33, s24
  v_cvt_pk_bf16_f32 v104, v104, v105
  v_cvt_pk_bf16_f32 v105, v106, v107
  v_cvt_pk_bf16_f32 v106, v108, v109
  v_cvt_pk_bf16_f32 v107, v110, v111
  v_add_f32 v6, v132, v133
  v_exp_f32 v148, v148
  v_exp_f32 v149, v149
  v_exp_f32 v150, v150
  v_exp_f32 v151, v151
  v_cvt_pk_bf16_f32 v172, v144, v145
  v_cvt_pk_bf16_f32 v173, v146, v147
  v_cvt_pk_bf16_f32 v174, v148, v149
  v_cvt_pk_bf16_f32 v175, v150, v151
  s_waitcnt lgkmcnt(10)
  v_mfma_f32_32x32x16_bf16 v[136:151], v[176:179], v[40:43], 0
  s_lshl_b32 s33, s33, s25
  ds_write_b128 v9, v[104:107] offset:24576
  v_cvt_pk_bf16_f32 v108, v112, v113
  v_cvt_pk_bf16_f32 v109, v114, v115
  v_cvt_pk_bf16_f32 v110, v116, v117
  v_cvt_pk_bf16_f32 v111, v118, v119
  v_exp_f32 v152, v152
  v_exp_f32 v153, v153
  v_exp_f32 v154, v154
  v_mfma_f32_32x32x16_bf16 v[56:71], v[188:191], v[172:175], v[56:71]
  s_add_u32 s22, s20, s33
  ds_write_b128 v9, v[108:111] offset:25600
  v_mov_b32 v132, 0
  v_mov_b32 v133, 0
  v_exp_f32 v155, v155
  v_exp_f32 v156, v156
  v_exp_f32 v157, v157
  v_smfmac_f32_16x16x64_bf16 v[120:123], v[16:19], v[168:175], v20
  s_addc_u32 s23, s21, 0
  ds_write_b32 v10, v6 offset:1536
  v_exp_f32 v158, v158
  v_exp_f32 v159, v159
  v_mfma_f32_32x32x16_bf16 v[136:151], v[180:183], v[44:47], v[136:151]
  v_cvt_pk_bf16_f32 v168, v152, v153
  v_cvt_pk_bf16_f32 v169, v154, v155
  v_cvt_pk_bf16_f32 v170, v156, v157
  v_cvt_pk_bf16_f32 v171, v158, v159
  v_exp_f32 v160, v160
  v_exp_f32 v161, v161
  v_exp_f32 v162, v162
  v_exp_f32 v163, v163
  s_waitcnt lgkmcnt(11)
  v_mfma_f32_32x32x16_bf16 v[72:87], v[184:187], v[168:171], 0
  ds_write_b32 v11, v12 offset:48
  v_exp_f32 v164, v164
  v_exp_f32 v165, v165
  v_exp_f32 v166, v166
  v_exp_f32 v167, v167
  v_cvt_pk_bf16_f32 v172, v160, v161
  v_cvt_pk_bf16_f32 v173, v162, v163
  v_cvt_pk_bf16_f32 v174, v164, v165
  v_cvt_pk_bf16_f32 v175, v166, v167
  s_waitcnt lgkmcnt(8)
  v_mfma_f32_32x32x16_bf16 v[152:167], v[176:179], v[48:51], 0
  v_add_u32 v12, 1, v12
  v_exp_f32 v136, v136
  v_exp_f32 v137, v137
  v_exp_f32 v138, v138
  v_mfma_f32_32x32x16_bf16 v[72:87], v[188:191], v[172:175], v[72:87]
  v_exp_f32 v139, v139
  v_exp_f32 v140, v140
  v_exp_f32 v141, v141
  v_smfmac_f32_16x16x64_bf16 v[124:127], v[16:19], v[168:175], v20
  global_load_dwordx4 v[224:227], v3, s[22:23] offset:0
  global_load_dwordx4 v[228:231], v3, s[22:23] offset:1024
  global_load_dwordx4 v[232:235], v3, s[22:23] offset:2048
  global_load_dwordx4 v[236:239], v3, s[22:23] offset:3072
  s_add_u32 s27, s27, 4
  v_exp_f32 v142, v142
  v_exp_f32 v143, v143
  v_mfma_f32_32x32x16_bf16 v[152:167], v[180:183], v[52:55], v[152:167]
  v_cvt_pk_bf16_f32 v168, v136, v137
  v_cvt_pk_bf16_f32 v169, v138, v139
  v_cvt_pk_bf16_f32 v170, v140, v141
  v_cvt_pk_bf16_f32 v171, v142, v143
  v_exp_f32 v144, v144
  v_exp_f32 v145, v145
  v_exp_f32 v146, v146
  v_exp_f32 v147, v147
  s_waitcnt lgkmcnt(6)
  v_mfma_f32_32x32x16_bf16 v[88:103], v[184:187], v[168:171], 0
  s_waitcnt vmcnt(8)
  v_exp_f32 v148, v148
  v_exp_f32 v149, v149
  v_exp_f32 v150, v150
  v_exp_f32 v151, v151
  v_cvt_pk_bf16_f32 v172, v144, v145
  v_cvt_pk_bf16_f32 v173, v146, v147
  v_cvt_pk_bf16_f32 v174, v148, v149
  v_cvt_pk_bf16_f32 v175, v150, v151
  v_mfma_f32_32x32x16_bf16 v[136:151], v[192:195], v[24:27], 0
  v_exp_f32 v152, v152
  v_exp_f32 v153, v153
  v_exp_f32 v154, v154
  v_mfma_f32_32x32x16_bf16 v[88:103], v[188:191], v[172:175], v[88:103]
  v_exp_f32 v155, v155
  v_exp_f32 v156, v156
  v_exp_f32 v157, v157
  v_smfmac_f32_16x16x64_bf16 v[128:131], v[16:19], v[168:175], v20
  v_exp_f32 v158, v158
  v_exp_f32 v159, v159
  v_mfma_f32_32x32x16_bf16 v[136:151], v[196:199], v[28:31], v[136:151]
  v_cvt_pk_bf16_f32 v168, v152, v153
  v_cvt_pk_bf16_f32 v169, v154, v155
  v_cvt_pk_bf16_f32 v170, v156, v157
  v_cvt_pk_bf16_f32 v171, v158, v159
  v_exp_f32 v160, v160
  v_exp_f32 v161, v161
  v_exp_f32 v162, v162
  v_exp_f32 v163, v163
  s_waitcnt lgkmcnt(2)
  v_mfma_f32_32x32x16_bf16 v[104:119], v[184:187], v[168:171], 0
  v_exp_f32 v164, v164
  v_exp_f32 v165, v165
  v_exp_f32 v166, v166
  v_exp_f32 v167, v167
  v_cvt_pk_bf16_f32 v172, v160, v161
  v_cvt_pk_bf16_f32 v173, v162, v163
  v_cvt_pk_bf16_f32 v174, v164, v165
  v_cvt_pk_bf16_f32 v175, v166, v167
  s_branch .g2_kernel_a_n1
.g2_kernel_a_end:
  v_mfma_f32_32x32x16_bf16 v[104:119], v[236:239], v[172:175], v[104:119]
  v_smfmac_f32_16x16x64_bf16 v[132:135], v[16:19], v[168:175], v20
  s_wakeup
  s_nop 9
  v_cvt_pk_bf16_f32 v104, v104, v105
  v_cvt_pk_bf16_f32 v105, v106, v107
  v_cvt_pk_bf16_f32 v106, v108, v109
  v_cvt_pk_bf16_f32 v107, v110, v111
  v_add_f32 v6, v132, v133
  ds_write_b128 v9, v[104:107] offset:24576
  v_cvt_pk_bf16_f32 v108, v112, v113
  v_cvt_pk_bf16_f32 v109, v114, v115
  v_cvt_pk_bf16_f32 v110, v116, v117
  v_cvt_pk_bf16_f32 v111, v118, v119
  ds_write_b128 v9, v[108:111] offset:25600
  v_mov_b32 v132, 0
  v_mov_b32 v133, 0
  ds_write_b32 v10, v6 offset:1536
  ds_write_b32 v11, v12 offset:48
  s_waitcnt lgkmcnt(4)
  v_mov_b32 v20, s71
  v_lshrrev_b32 v17, 5, v2
  v_and_b32 v18, 31, v2
  s_lshl_b32 s28, s16, 5
  v_add_u32 v19, s28, v18
  v_lshlrev_b32 v7, 2, v19
  v_add_u32 v7, 155648, v7
  ds_read_b32 v8, v7 offset:3840
  ds_read_b32 v9, v7 offset:4352
  ds_read_b32 v16, v20 offset:24
  ds_read_b32 v6, v20 offset:52
  v_add_u32 v19, 1, v19
  v_bfe_u32 v7, v2, 2, 2
  v_lshl_add_u32 v14, v17, 2, v7
  v_lshlrev_b32 v14, 7, v14
  v_lshrrev_b32 v7, 1, v7
  v_lshl_add_u32 v14, v7, 6, v14
  v_bfe_u32 v7, v2, 4, 1
  v_lshl_add_u32 v14, v7, 5, v14
  v_and_b32 v7, 1, v2
  v_lshl_add_u32 v14, v7, 4, v14
  v_bfe_u32 v7, v2, 1, 1
  v_lshl_add_u32 v14, v7, 3, v14
  v_xor_b32 v15, 64, v14
  v_and_b32 v7, 7, v2
  v_xor_b32 v7, s24, v7
  s_mov_b32 s28, 192
  s_add_u32 s28, s28, 157952
  v_lshl_add_u32 v21, v7, 3, s28
  v_lshlrev_b32 v24, 16, v240
  v_and_b32 v25, 0xffff0000, v240
  v_lshlrev_b32 v26, 16, v241
  v_and_b32 v27, 0xffff0000, v241
  v_lshlrev_b32 v28, 16, v242
  v_and_b32 v29, 0xffff0000, v242
  v_lshlrev_b32 v30, 16, v243
  v_and_b32 v31, 0xffff0000, v243
  v_lshlrev_b32 v32, 16, v244
  v_and_b32 v33, 0xffff0000, v244
  v_lshlrev_b32 v34, 16, v245
  v_and_b32 v35, 0xffff0000, v245
  v_lshlrev_b32 v36, 16, v246
  v_and_b32 v37, 0xffff0000, v246
  v_lshlrev_b32 v38, 16, v247
  v_and_b32 v39, 0xffff0000, v247
  v_lshlrev_b32 v40, 16, v248
  v_and_b32 v41, 0xffff0000, v248
  v_lshlrev_b32 v42, 16, v249
  v_and_b32 v43, 0xffff0000, v249
  v_lshlrev_b32 v44, 16, v250
  v_and_b32 v45, 0xffff0000, v250
  v_lshlrev_b32 v46, 16, v251
  v_and_b32 v47, 0xffff0000, v251
  v_lshlrev_b32 v48, 16, v252
  v_and_b32 v49, 0xffff0000, v252
  v_lshlrev_b32 v50, 16, v253
  v_and_b32 v51, 0xffff0000, v253
  v_lshlrev_b32 v52, 16, v254
  v_and_b32 v53, 0xffff0000, v254
  v_lshlrev_b32 v54, 16, v255
  v_and_b32 v55, 0xffff0000, v255
  s_waitcnt lgkmcnt(0)
  v_cmp_gt_u32 vcc, 4, v6
  s_cbranch_vccnz .g2_kernel_w_aw
.g2_kernel_w_ab:
  s_xor_b32 s28, s24, 0
  s_lshl_b32 s28, s28, 13
  s_add_u32 s28, s28, 65536
  v_add_u32 v10, s28, v14
  v_add_u32 v11, s28, v15
  ds_read_b64_tr_b16 v[104:105], v10 offset:0
  ds_read_b64_tr_b16 v[106:107], v10 offset:1024
  ds_read_b64_tr_b16 v[108:109], v11 offset:0
  ds_read_b64_tr_b16 v[110:111], v11 offset:1024
  ds_read_b64_tr_b16 v[112:113], v10 offset:2048
  ds_read_b64_tr_b16 v[114:115], v10 offset:3072
  ds_read_b64_tr_b16 v[116:117], v11 offset:2048
  ds_read_b64_tr_b16 v[118:119], v11 offset:3072
  ds_read_b64_tr_b16 v[120:121], v10 offset:4096
  ds_read_b64_tr_b16 v[122:123], v10 offset:5120
  ds_read_b64_tr_b16 v[124:125], v11 offset:4096
  ds_read_b64_tr_b16 v[126:127], v11 offset:5120
  s_andn2_b32 s33, s36, s34
  s_ff1_i32_b32 s33, s33
  s_bitset1_b32 s34, s33
  s_xor_b32 s33, s33, s24
  s_lshl_b32 s33, s33, 12
  s_add_u32 s22, s20, s33
  s_addc_u32 s23, s21, 0
  global_load_dwordx4 v[224:227], v3, s[22:23] offset:0
  global_load_dwordx4 v[228:231], v3, s[22:23] offset:1024
  global_load_dwordx4 v[232:235], v3, s[22:23] offset:2048
  global_load_dwordx4 v[236:239], v3, s[22:23] offset:3072
  v_pk_fma_f32 v[24:25], v[24:25], v[8:9], v[8:9] op_sel:[0,0,1] op_sel_hi:[1,0,1]
  v_pk_fma_f32 v[26:27], v[26:27], v[8:9], v[8:9] op_sel:[0,0,1] op_sel_hi:[1,0,1]
  v_pk_fma_f32 v[28:29], v[28:29], v[8:9], v[8:9] op_sel:[0,0,1] op_sel_hi:[1,0,1]
  v_pk_fma_f32 v[30:31], v[30:31], v[8:9], v[8:9] op_sel:[0,0,1] op_sel_hi:[1,0,1]
  v_pk_fma_f32 v[32:33], v[32:33], v[8:9], v[8:9] op_sel:[0,0,1] op_sel_hi:[1,0,1]
  v_pk_fma_f32 v[34:35], v[34:35], v[8:9], v[8:9] op_sel:[0,0,1] op_sel_hi:[1,0,1]
  v_pk_fma_f32 v[36:37], v[36:37], v[8:9], v[8:9] op_sel:[0,0,1] op_sel_hi:[1,0,1]
  v_pk_fma_f32 v[38:39], v[38:39], v[8:9], v[8:9] op_sel:[0,0,1] op_sel_hi:[1,0,1]
  v_pk_fma_f32 v[40:41], v[40:41], v[8:9], v[8:9] op_sel:[0,0,1] op_sel_hi:[1,0,1]
  v_pk_fma_f32 v[42:43], v[42:43], v[8:9], v[8:9] op_sel:[0,0,1] op_sel_hi:[1,0,1]
  v_pk_fma_f32 v[44:45], v[44:45], v[8:9], v[8:9] op_sel:[0,0,1] op_sel_hi:[1,0,1]
  v_pk_fma_f32 v[46:47], v[46:47], v[8:9], v[8:9] op_sel:[0,0,1] op_sel_hi:[1,0,1]
  v_pk_fma_f32 v[48:49], v[48:49], v[8:9], v[8:9] op_sel:[0,0,1] op_sel_hi:[1,0,1]
  v_pk_fma_f32 v[50:51], v[50:51], v[8:9], v[8:9] op_sel:[0,0,1] op_sel_hi:[1,0,1]
  v_pk_fma_f32 v[52:53], v[52:53], v[8:9], v[8:9] op_sel:[0,0,1] op_sel_hi:[1,0,1]
  v_pk_fma_f32 v[54:55], v[54:55], v[8:9], v[8:9] op_sel:[0,0,1] op_sel_hi:[1,0,1]
  v_cmp_eq_u32 vcc, v16, v19
  s_cbranch_vccnz .g2_kernel_w_pt
.g2_kernel_w_pb:
  s_mov_b32 s72, s48
  s_mov_b32 s73, s49
  s_mov_b32 s74, 0x800
  s_mov_b32 s75, 0x00020000
  s_waitcnt vmcnt(15) lgkmcnt(8)
  v_mfma_f32_32x32x16_bf16 v[24:39], v[104:107], v[176:179], v[24:39]
  s_xor_b32 s28, s24, 1
  s_lshl_b32 s28, s28, 13
  s_add_u32 s28, s28, 65536
  ds_read_b64_tr_b16 v[128:129], v10 offset:6144
  ds_read_b64_tr_b16 v[130:131], v10 offset:7168
  v_mfma_f32_32x32x16_bf16 v[40:55], v[108:111], v[176:179], v[40:55]
  v_add_u32 v12, s28, v14
  v_add_u32 v13, s28, v15
  s_andn2_b32 s33, s36, s34
  ds_read_b64_tr_b16 v[132:133], v11 offset:6144
  ds_read_b64_tr_b16 v[134:135], v11 offset:7168
  s_waitcnt vmcnt(14) lgkmcnt(8)
  v_mfma_f32_32x32x16_bf16 v[24:39], v[112:115], v[180:183], v[24:39]
  s_ff1_i32_b32 s33, s33
  s_bitset1_b32 s34, s33
  s_xor_b32 s33, s33, s24
  ds_read_b64_tr_b16 v[104:105], v12 offset:0
  ds_read_b64_tr_b16 v[106:107], v12 offset:1024
  v_mfma_f32_32x32x16_bf16 v[40:55], v[116:119], v[180:183], v[40:55]
  s_lshl_b32 s33, s33, 12
  s_add_u32 s22, s20, s33
  s_addc_u32 s23, s21, 0
  ds_read_b64_tr_b16 v[108:109], v13 offset:0
  ds_read_b64_tr_b16 v[110:111], v13 offset:1024
  s_waitcnt vmcnt(13) lgkmcnt(8)
  v_mfma_f32_32x32x16_bf16 v[24:39], v[120:123], v[184:187], v[24:39]
  global_load_dwordx4 v[136:139], v3, s[22:23] offset:0
  global_load_dwordx4 v[140:143], v3, s[22:23] offset:1024
  global_load_dwordx4 v[144:147], v3, s[22:23] offset:2048
  ds_read_b64_tr_b16 v[112:113], v12 offset:2048
  ds_read_b64_tr_b16 v[114:115], v12 offset:3072
  v_mfma_f32_32x32x16_bf16 v[40:55], v[124:127], v[184:187], v[40:55]
  global_load_dwordx4 v[148:151], v3, s[22:23] offset:3072
  ds_read_b64_tr_b16 v[116:117], v13 offset:2048
  ds_read_b64_tr_b16 v[118:119], v13 offset:3072
  s_waitcnt vmcnt(16) lgkmcnt(8)
  v_mfma_f32_32x32x16_bf16 v[24:39], v[128:131], v[188:191], v[24:39]
  ds_read_b64_tr_b16 v[120:121], v12 offset:4096
  ds_read_b64_tr_b16 v[122:123], v12 offset:5120
  v_mfma_f32_32x32x16_bf16 v[40:55], v[132:135], v[188:191], v[40:55]
  ds_read_b64_tr_b16 v[124:125], v13 offset:4096
  ds_read_b64_tr_b16 v[126:127], v13 offset:5120
  s_waitcnt vmcnt(15) lgkmcnt(8)
  v_mfma_f32_32x32x16_bf16 v[24:39], v[104:107], v[192:195], v[24:39]
  s_xor_b32 s28, s24, 2
  s_lshl_b32 s28, s28, 13
  s_add_u32 s28, s28, 65536
  ds_read_b64_tr_b16 v[128:129], v12 offset:6144
  ds_read_b64_tr_b16 v[130:131], v12 offset:7168
  v_mfma_f32_32x32x16_bf16 v[40:55], v[108:111], v[192:195], v[40:55]
  v_add_u32 v10, s28, v14
  v_add_u32 v11, s28, v15
  s_andn2_b32 s33, s36, s34
  ds_read_b64_tr_b16 v[132:133], v13 offset:6144
  ds_read_b64_tr_b16 v[134:135], v13 offset:7168
  s_waitcnt vmcnt(14) lgkmcnt(8)
  v_mfma_f32_32x32x16_bf16 v[24:39], v[112:115], v[196:199], v[24:39]
  s_ff1_i32_b32 s33, s33
  s_bitset1_b32 s34, s33
  s_xor_b32 s33, s33, s24
  ds_read_b64_tr_b16 v[104:105], v10 offset:0
  ds_read_b64_tr_b16 v[106:107], v10 offset:1024
  v_mfma_f32_32x32x16_bf16 v[40:55], v[116:119], v[196:199], v[40:55]
  s_lshl_b32 s33, s33, 12
  s_add_u32 s22, s20, s33
  s_addc_u32 s23, s21, 0
  ds_read_b64_tr_b16 v[108:109], v11 offset:0
  ds_read_b64_tr_b16 v[110:111], v11 offset:1024
  s_waitcnt vmcnt(13) lgkmcnt(8)
  v_mfma_f32_32x32x16_bf16 v[24:39], v[120:123], v[200:203], v[24:39]
  global_load_dwordx4 v[152:155], v3, s[22:23] offset:0
  global_load_dwordx4 v[156:159], v3, s[22:23] offset:1024
  global_load_dwordx4 v[160:163], v3, s[22:23] offset:2048
  ds_read_b64_tr_b16 v[112:113], v10 offset:2048
  ds_read_b64_tr_b16 v[114:115], v10 offset:3072
  v_mfma_f32_32x32x16_bf16 v[40:55], v[124:127], v[200:203], v[40:55]
  global_load_dwordx4 v[164:167], v3, s[22:23] offset:3072
  ds_read_b64_tr_b16 v[116:117], v11 offset:2048
  ds_read_b64_tr_b16 v[118:119], v11 offset:3072
  s_waitcnt vmcnt(16) lgkmcnt(8)
  v_mfma_f32_32x32x16_bf16 v[24:39], v[128:131], v[204:207], v[24:39]
  ds_read_b64_tr_b16 v[120:121], v10 offset:4096
  ds_read_b64_tr_b16 v[122:123], v10 offset:5120
  v_mfma_f32_32x32x16_bf16 v[40:55], v[132:135], v[204:207], v[40:55]
  ds_read_b64_tr_b16 v[124:125], v11 offset:4096
  ds_read_b64_tr_b16 v[126:127], v11 offset:5120
  s_waitcnt vmcnt(15) lgkmcnt(8)
  v_mfma_f32_32x32x16_bf16 v[24:39], v[104:107], v[208:211], v[24:39]
  s_xor_b32 s28, s24, 3
  s_lshl_b32 s28, s28, 13
  s_add_u32 s28, s28, 65536
  ds_read_b64_tr_b16 v[128:129], v10 offset:6144
  ds_read_b64_tr_b16 v[130:131], v10 offset:7168
  v_mfma_f32_32x32x16_bf16 v[40:55], v[108:111], v[208:211], v[40:55]
  v_add_u32 v12, s28, v14
  v_add_u32 v13, s28, v15
  s_andn2_b32 s33, s36, s34
  ds_read_b64_tr_b16 v[132:133], v11 offset:6144
  ds_read_b64_tr_b16 v[134:135], v11 offset:7168
  s_waitcnt vmcnt(14) lgkmcnt(8)
  v_mfma_f32_32x32x16_bf16 v[24:39], v[112:115], v[212:215], v[24:39]
  s_ff1_i32_b32 s33, s33
  s_bitset1_b32 s34, s33
  s_xor_b32 s33, s33, s24
  ds_read_b64_tr_b16 v[104:105], v12 offset:0
  ds_read_b64_tr_b16 v[106:107], v12 offset:1024
  v_mfma_f32_32x32x16_bf16 v[40:55], v[116:119], v[212:215], v[40:55]
  s_lshl_b32 s33, s33, 12
  s_add_u32 s22, s20, s33
  s_addc_u32 s23, s21, 0
  ds_read_b64_tr_b16 v[108:109], v13 offset:0
  ds_read_b64_tr_b16 v[110:111], v13 offset:1024
  s_waitcnt vmcnt(13) lgkmcnt(8)
  v_mfma_f32_32x32x16_bf16 v[24:39], v[120:123], v[216:219], v[24:39]
  global_load_dwordx4 v[56:59], v3, s[22:23] offset:0
  global_load_dwordx4 v[60:63], v3, s[22:23] offset:1024
  global_load_dwordx4 v[64:67], v3, s[22:23] offset:2048
  ds_read_b64_tr_b16 v[112:113], v12 offset:2048
  ds_read_b64_tr_b16 v[114:115], v12 offset:3072
  v_mfma_f32_32x32x16_bf16 v[40:55], v[124:127], v[216:219], v[40:55]
  global_load_dwordx4 v[68:71], v3, s[22:23] offset:3072
  ds_read_b64_tr_b16 v[116:117], v13 offset:2048
  ds_read_b64_tr_b16 v[118:119], v13 offset:3072
  s_waitcnt vmcnt(16) lgkmcnt(8)
  v_mfma_f32_32x32x16_bf16 v[24:39], v[128:131], v[220:223], v[24:39]
  ds_read_b64_tr_b16 v[120:121], v12 offset:4096
  ds_read_b64_tr_b16 v[122:123], v12 offset:5120
  v_mfma_f32_32x32x16_bf16 v[40:55], v[132:135], v[220:223], v[40:55]
  ds_read_b64_tr_b16 v[124:125], v13 offset:4096
  ds_read_b64_tr_b16 v[126:127], v13 offset:5120
  s_waitcnt vmcnt(15) lgkmcnt(8)
  v_mfma_f32_32x32x16_bf16 v[24:39], v[104:107], v[224:227], v[24:39]
  s_xor_b32 s28, s24, 4
  s_lshl_b32 s28, s28, 13
  s_add_u32 s28, s28, 65536
  ds_read_b64_tr_b16 v[128:129], v12 offset:6144
  ds_read_b64_tr_b16 v[130:131], v12 offset:7168
  v_mfma_f32_32x32x16_bf16 v[40:55], v[108:111], v[224:227], v[40:55]
  v_add_u32 v10, s28, v14
  v_add_u32 v11, s28, v15
  s_andn2_b32 s33, s36, s34
  ds_read_b64_tr_b16 v[132:133], v13 offset:6144
  ds_read_b64_tr_b16 v[134:135], v13 offset:7168
  s_waitcnt vmcnt(14) lgkmcnt(8)
  v_mfma_f32_32x32x16_bf16 v[24:39], v[112:115], v[228:231], v[24:39]
  s_ff1_i32_b32 s33, s33
  s_bitset1_b32 s34, s33
  s_xor_b32 s33, s33, s24
  ds_read_b64_tr_b16 v[104:105], v10 offset:0
  ds_read_b64_tr_b16 v[106:107], v10 offset:1024
  v_mfma_f32_32x32x16_bf16 v[40:55], v[116:119], v[228:231], v[40:55]
  s_lshl_b32 s33, s33, 12
  s_add_u32 s22, s20, s33
  s_addc_u32 s23, s21, 0
  ds_read_b64_tr_b16 v[108:109], v11 offset:0
  ds_read_b64_tr_b16 v[110:111], v11 offset:1024
  s_waitcnt vmcnt(13) lgkmcnt(8)
  v_mfma_f32_32x32x16_bf16 v[24:39], v[120:123], v[232:235], v[24:39]
  global_load_dwordx4 v[72:75], v3, s[22:23] offset:0
  global_load_dwordx4 v[76:79], v3, s[22:23] offset:1024
  global_load_dwordx4 v[80:83], v3, s[22:23] offset:2048
  ds_read_b64_tr_b16 v[112:113], v10 offset:2048
  ds_read_b64_tr_b16 v[114:115], v10 offset:3072
  v_mfma_f32_32x32x16_bf16 v[40:55], v[124:127], v[232:235], v[40:55]
  global_load_dwordx4 v[84:87], v3, s[22:23] offset:3072
  ds_read_b64_tr_b16 v[116:117], v11 offset:2048
  ds_read_b64_tr_b16 v[118:119], v11 offset:3072
  s_waitcnt vmcnt(16) lgkmcnt(8)
  v_mfma_f32_32x32x16_bf16 v[24:39], v[128:131], v[236:239], v[24:39]
  ds_read_b64_tr_b16 v[120:121], v10 offset:4096
  ds_read_b64_tr_b16 v[122:123], v10 offset:5120
  v_mfma_f32_32x32x16_bf16 v[40:55], v[132:135], v[236:239], v[40:55]
  ds_read_b64_tr_b16 v[124:125], v11 offset:4096
  ds_read_b64_tr_b16 v[126:127], v11 offset:5120
  s_waitcnt vmcnt(15) lgkmcnt(8)
  v_mfma_f32_32x32x16_bf16 v[24:39], v[104:107], v[136:139], v[24:39]
  s_xor_b32 s28, s24, 5
  s_lshl_b32 s28, s28, 13
  s_add_u32 s28, s28, 65536
  v_add_u32 v12, s28, v14
  ds_read_b64_tr_b16 v[128:129], v10 offset:6144
  ds_read_b64_tr_b16 v[130:131], v10 offset:7168
  v_mfma_f32_32x32x16_bf16 v[40:55], v[108:111], v[136:139], v[40:55]
  v_add_u32 v13, s28, v15
  s_andn2_b32 s33, s36, s34
  s_cbranch_scc0 .g2_kernel_w_i8c
.g2_kernel_w_i8b:
  s_ff1_i32_b32 s33, s33
  ds_read_b64_tr_b16 v[132:133], v11 offset:6144
  ds_read_b64_tr_b16 v[134:135], v11 offset:7168
  s_waitcnt vmcnt(14) lgkmcnt(8)
  v_mfma_f32_32x32x16_bf16 v[24:39], v[112:115], v[140:143], v[24:39]
  s_bitset1_b32 s34, s33
  s_xor_b32 s33, s33, s24
  s_and_b32 s8, s33, 7
  s_cmp_lt_u32 s8, 2
  ds_read_b64_tr_b16 v[104:105], v12 offset:0
  ds_read_b64_tr_b16 v[106:107], v12 offset:1024
  v_mfma_f32_32x32x16_bf16 v[40:55], v[116:119], v[140:143], v[40:55]
  s_cselect_b32 s28, 139264, 0
  s_lshl_b32 s8, s8, 13
  s_add_u32 s8, s8, s28
  s_lshl_b32 s33, s33, 12
  ds_read_b64_tr_b16 v[108:109], v13 offset:0
  ds_read_b64_tr_b16 v[110:111], v13 offset:1024
  s_waitcnt vmcnt(13) lgkmcnt(8)
  v_mfma_f32_32x32x16_bf16 v[24:39], v[120:123], v[144:147], v[24:39]
  s_add_u32 s22, s20, s33
  s_addc_u32 s23, s21, 0
  global_load_dwordx4 v[88:91], v3, s[22:23] offset:0
  global_load_dwordx4 v[92:95], v3, s[22:23] offset:1024
  ds_read_b64_tr_b16 v[112:113], v12 offset:2048
  ds_read_b64_tr_b16 v[114:115], v12 offset:3072
  v_mfma_f32_32x32x16_bf16 v[40:55], v[124:127], v[144:147], v[40:55]
  global_load_dwordx4 v[96:99], v3, s[22:23] offset:2048
  global_load_dwordx4 v[100:103], v3, s[22:23] offset:3072
  ds_read_b64_tr_b16 v[116:117], v13 offset:2048
  ds_read_b64_tr_b16 v[118:119], v13 offset:3072
  s_waitcnt vmcnt(16) lgkmcnt(8)
  v_mfma_f32_32x32x16_bf16 v[24:39], v[128:131], v[148:151], v[24:39]
  ds_read_b64_tr_b16 v[120:121], v12 offset:4096
  ds_read_b64_tr_b16 v[122:123], v12 offset:5120
  v_mfma_f32_32x32x16_bf16 v[40:55], v[132:135], v[148:151], v[40:55]
  ds_read_b64_tr_b16 v[124:125], v13 offset:4096
  ds_read_b64_tr_b16 v[126:127], v13 offset:5120
  s_waitcnt vmcnt(15) lgkmcnt(8)
  v_mfma_f32_32x32x16_bf16 v[24:39], v[104:107], v[152:155], v[24:39]
  s_xor_b32 s28, s24, 6
  s_lshl_b32 s28, s28, 13
  s_add_u32 s28, s28, 65536
  v_add_u32 v10, s28, v14
  v_add_u32 v11, s28, v15
  ds_read_b64_tr_b16 v[128:129], v12 offset:6144
  ds_read_b64_tr_b16 v[130:131], v12 offset:7168
  v_mfma_f32_32x32x16_bf16 v[40:55], v[108:111], v[152:155], v[40:55]
  s_andn2_b32 s33, s36, s34
  s_cbranch_scc0 .g2_kernel_w_i9c
.g2_kernel_w_i9b:
  s_ff1_i32_b32 s33, s33
  s_bitset1_b32 s34, s33
  s_xor_b32 s33, s33, s24
  ds_read_b64_tr_b16 v[132:133], v13 offset:6144
  ds_read_b64_tr_b16 v[134:135], v13 offset:7168
  s_waitcnt vmcnt(14) lgkmcnt(8)
  v_mfma_f32_32x32x16_bf16 v[24:39], v[112:115], v[156:159], v[24:39]
  s_and_b32 s9, s33, 7
  s_cmp_lt_u32 s9, 2
  s_cselect_b32 s28, 139264, 0
  s_lshl_b32 s9, s9, 13
  s_add_u32 s9, s9, s28
  ds_read_b64_tr_b16 v[104:105], v10 offset:0
  ds_read_b64_tr_b16 v[106:107], v10 offset:1024
  v_mfma_f32_32x32x16_bf16 v[40:55], v[116:119], v[156:159], v[40:55]
  s_lshl_b32 s33, s33, 12
  s_add_u32 s22, s20, s33
  s_addc_u32 s23, s21, 0
  global_load_dwordx4 v[176:179], v3, s[22:23] offset:0
  global_load_dwordx4 v[180:183], v3, s[22:23] offset:1024
  ds_read_b64_tr_b16 v[108:109], v11 offset:0
  ds_read_b64_tr_b16 v[110:111], v11 offset:1024
  s_waitcnt vmcnt(15) lgkmcnt(8)
  v_mfma_f32_32x32x16_bf16 v[24:39], v[120:123], v[160:163], v[24:39]
  global_load_dwordx4 v[184:187], v3, s[22:23] offset:2048
  global_load_dwordx4 v[188:191], v3, s[22:23] offset:3072
  v_lshlrev_b32 v16, 4, v17
  s_lshl_b32 s29, s18, 7
  buffer_load_dwordx4 v[240:243], v16, s[72:75], s29 offen offset:0
  ds_read_b64_tr_b16 v[112:113], v10 offset:2048
  ds_read_b64_tr_b16 v[114:115], v10 offset:3072
  v_mfma_f32_32x32x16_bf16 v[40:55], v[124:127], v[160:163], v[40:55]
  buffer_load_dwordx4 v[244:247], v16, s[72:75], s29 offen offset:32
  buffer_load_dwordx4 v[248:251], v16, s[72:75], s29 offen offset:64
  buffer_load_dwordx4 v[252:255], v16, s[72:75], s29 offen offset:96
  ds_read_b64_tr_b16 v[116:117], v11 offset:2048
  ds_read_b64_tr_b16 v[118:119], v11 offset:3072
  s_waitcnt vmcnt(20) lgkmcnt(8)
  v_mfma_f32_32x32x16_bf16 v[24:39], v[128:131], v[164:167], v[24:39]
  ds_read_b64_tr_b16 v[120:121], v10 offset:4096
  ds_read_b64_tr_b16 v[122:123], v10 offset:5120
  v_mfma_f32_32x32x16_bf16 v[40:55], v[132:135], v[164:167], v[40:55]
  ds_read_b64_tr_b16 v[124:125], v11 offset:4096
  ds_read_b64_tr_b16 v[126:127], v11 offset:5120
  s_waitcnt vmcnt(19) lgkmcnt(8)
  v_mfma_f32_32x32x16_bf16 v[24:39], v[104:107], v[56:59], v[24:39]
  s_xor_b32 s28, s24, 7
  s_lshl_b32 s28, s28, 13
  s_add_u32 s28, s28, 65536
  v_add_u32 v12, s28, v14
  ds_read_b64_tr_b16 v[128:129], v10 offset:6144
  ds_read_b64_tr_b16 v[130:131], v10 offset:7168
  v_mfma_f32_32x32x16_bf16 v[40:55], v[108:111], v[56:59], v[40:55]
  v_add_u32 v13, s28, v15
  s_andn2_b32 s33, s36, s34
  s_cbranch_scc0 .g2_kernel_w_i10c
.g2_kernel_w_i10b:
  s_ff1_i32_b32 s33, s33
  ds_read_b64_tr_b16 v[132:133], v11 offset:6144
  ds_read_b64_tr_b16 v[134:135], v11 offset:7168
  s_waitcnt vmcnt(18) lgkmcnt(8)
  v_mfma_f32_32x32x16_bf16 v[24:39], v[112:115], v[60:63], v[24:39]
  s_bitset1_b32 s34, s33
  s_xor_b32 s33, s33, s24
  s_and_b32 s10, s33, 7
  s_cmp_lt_u32 s10, 2
  ds_read_b64_tr_b16 v[104:105], v12 offset:0
  ds_read_b64_tr_b16 v[106:107], v12 offset:1024
  v_mfma_f32_32x32x16_bf16 v[40:55], v[116:119], v[60:63], v[40:55]
  s_cselect_b32 s28, 139264, 0
  s_lshl_b32 s10, s10, 13
  s_add_u32 s10, s10, s28
  s_lshl_b32 s33, s33, 12
  ds_read_b64_tr_b16 v[108:109], v13 offset:0
  ds_read_b64_tr_b16 v[110:111], v13 offset:1024
  s_waitcnt vmcnt(17) lgkmcnt(8)
  v_mfma_f32_32x32x16_bf16 v[24:39], v[120:123], v[64:67], v[24:39]
  s_add_u32 s22, s20, s33
  s_addc_u32 s23, s21, 0
  global_load_dwordx4 v[192:195], v3, s[22:23] offset:0
  global_load_dwordx4 v[196:199], v3, s[22:23] offset:1024
  ds_read_b64_tr_b16 v[112:113], v12 offset:2048
  ds_read_b64_tr_b16 v[114:115], v12 offset:3072
  v_mfma_f32_32x32x16_bf16 v[40:55], v[124:127], v[64:67], v[40:55]
  global_load_dwordx4 v[200:203], v3, s[22:23] offset:2048
  global_load_dwordx4 v[204:207], v3, s[22:23] offset:3072
  ds_read_b64_tr_b16 v[116:117], v13 offset:2048
  ds_read_b64_tr_b16 v[118:119], v13 offset:3072
  s_waitcnt vmcnt(20) lgkmcnt(8)
  v_mfma_f32_32x32x16_bf16 v[24:39], v[128:131], v[68:71], v[24:39]
  ds_read_b64_tr_b16 v[120:121], v12 offset:4096
  ds_read_b64_tr_b16 v[122:123], v12 offset:5120
  v_mfma_f32_32x32x16_bf16 v[40:55], v[132:135], v[68:71], v[40:55]
  ds_read_b64_tr_b16 v[124:125], v13 offset:4096
  ds_read_b64_tr_b16 v[126:127], v13 offset:5120
  s_waitcnt vmcnt(19) lgkmcnt(8)
  v_mfma_f32_32x32x16_bf16 v[24:39], v[104:107], v[72:75], v[24:39]
  s_andn2_b32 s33, s36, s34
  s_cbranch_scc0 .g2_kernel_w_i11c
.g2_kernel_w_i11b:
  s_ff1_i32_b32 s33, s33
  ds_read_b64_tr_b16 v[128:129], v12 offset:6144
  ds_read_b64_tr_b16 v[130:131], v12 offset:7168
  v_mfma_f32_32x32x16_bf16 v[40:55], v[108:111], v[72:75], v[40:55]
  s_bitset1_b32 s34, s33
  s_xor_b32 s33, s33, s24
  s_and_b32 s11, s33, 7
  ds_read_b64_tr_b16 v[132:133], v13 offset:6144
  ds_read_b64_tr_b16 v[134:135], v13 offset:7168
  s_waitcnt vmcnt(18) lgkmcnt(8)
  v_mfma_f32_32x32x16_bf16 v[24:39], v[112:115], v[76:79], v[24:39]
  s_cmp_lt_u32 s11, 2
  s_cselect_b32 s28, 139264, 0
  s_lshl_b32 s11, s11, 13
  v_mfma_f32_32x32x16_bf16 v[40:55], v[116:119], v[76:79], v[40:55]
  s_add_u32 s11, s11, s28
  s_lshl_b32 s33, s33, 12
  s_add_u32 s22, s20, s33
  s_waitcnt vmcnt(17) lgkmcnt(4)
  v_mfma_f32_32x32x16_bf16 v[24:39], v[120:123], v[80:83], v[24:39]
  s_addc_u32 s23, s21, 0
  global_load_dwordx4 v[208:211], v3, s[22:23] offset:0
  global_load_dwordx4 v[212:215], v3, s[22:23] offset:1024
  v_mfma_f32_32x32x16_bf16 v[40:55], v[124:127], v[80:83], v[40:55]
  global_load_dwordx4 v[216:219], v3, s[22:23] offset:2048
  global_load_dwordx4 v[220:223], v3, s[22:23] offset:3072
  s_waitcnt vmcnt(20) lgkmcnt(0)
  v_mfma_f32_32x32x16_bf16 v[24:39], v[128:131], v[84:87], v[24:39]
  v_mfma_f32_32x32x16_bf16 v[40:55], v[132:135], v[84:87], v[40:55]
  ds_read_b32 v16, v20 offset:12
  v_add_u32 v10, s8, v14
  v_add_u32 v11, s8, v15
  s_waitcnt lgkmcnt(0)
  v_cmp_gt_u32 vcc, 4, v16
  s_cbranch_vccnz .g2_kernel_w_bw
.g2_kernel_w_bb:
  ds_read_b64_tr_b16 v[104:105], v10 offset:0
  ds_read_b64_tr_b16 v[106:107], v10 offset:1024
  ds_read_b64_tr_b16 v[108:109], v11 offset:0
  ds_read_b64_tr_b16 v[110:111], v11 offset:1024
  ds_read_b64_tr_b16 v[112:113], v10 offset:2048
  ds_read_b64_tr_b16 v[114:115], v10 offset:3072
  ds_read_b64_tr_b16 v[116:117], v11 offset:2048
  ds_read_b64_tr_b16 v[118:119], v11 offset:3072
  ds_read_b64_tr_b16 v[120:121], v10 offset:4096
  ds_read_b64_tr_b16 v[122:123], v10 offset:5120
  ds_read_b64_tr_b16 v[124:125], v11 offset:4096
  ds_read_b64_tr_b16 v[126:127], v11 offset:5120
  s_waitcnt vmcnt(16)
  v_min3_u32 v6, v88, v90, v92
  v_min3_u32 v7, v94, v96, v98
  v_min3_u32 v6, v6, v100, v102
  v_min_u32 v6, v6, v7
  v_cmp_eq_u32 vcc, 0, v6
  s_cbranch_vccnz .g2_kernel_w_v8
.g2_kernel_w_vb8:
  s_waitcnt lgkmcnt(8)
  v_mfma_f32_32x32x16_bf16 v[24:39], v[104:107], v[88:91], v[24:39]
  v_add_u32 v12, s9, v14
  v_add_u32 v13, s9, v15
  s_andn2_b32 s33, s36, s34
  s_cbranch_scc0 .g2_kernel_w_i12c
.g2_kernel_w_i12b:
  ds_read_b64_tr_b16 v[128:129], v10 offset:6144
  ds_read_b64_tr_b16 v[130:131], v10 offset:7168
  v_mfma_f32_32x32x16_bf16 v[40:55], v[108:111], v[88:91], v[40:55]
  s_ff1_i32_b32 s33, s33
  s_bitset1_b32 s34, s33
  s_xor_b32 s33, s33, s24
  s_and_b32 s12, s33, 7
  ds_read_b64_tr_b16 v[132:133], v11 offset:6144
  ds_read_b64_tr_b16 v[134:135], v11 offset:7168
  s_waitcnt lgkmcnt(8)
  v_mfma_f32_32x32x16_bf16 v[24:39], v[112:115], v[92:95], v[24:39]
  s_cmp_lt_u32 s12, 2
  s_cselect_b32 s28, 139264, 0
  s_lshl_b32 s12, s12, 13
  s_add_u32 s12, s12, s28
  ds_read_b64_tr_b16 v[104:105], v12 offset:0
  ds_read_b64_tr_b16 v[106:107], v12 offset:1024
  v_mfma_f32_32x32x16_bf16 v[40:55], v[116:119], v[92:95], v[40:55]
  s_lshl_b32 s33, s33, 12
  s_add_u32 s22, s20, s33
  s_addc_u32 s23, s21, 0
  global_load_dwordx4 v[224:227], v3, s[22:23] offset:0
  ds_read_b64_tr_b16 v[108:109], v13 offset:0
  ds_read_b64_tr_b16 v[110:111], v13 offset:1024
  s_waitcnt lgkmcnt(8)
  v_mfma_f32_32x32x16_bf16 v[24:39], v[120:123], v[96:99], v[24:39]
  global_load_dwordx4 v[228:231], v3, s[22:23] offset:1024
  global_load_dwordx4 v[232:235], v3, s[22:23] offset:2048
  global_load_dwordx4 v[236:239], v3, s[22:23] offset:3072
  ds_read_b64_tr_b16 v[112:113], v12 offset:2048
  ds_read_b64_tr_b16 v[114:115], v12 offset:3072
  v_mfma_f32_32x32x16_bf16 v[40:55], v[124:127], v[96:99], v[40:55]
  ds_read_b64_tr_b16 v[116:117], v13 offset:2048
  ds_read_b64_tr_b16 v[118:119], v13 offset:3072
  s_waitcnt lgkmcnt(8)
  v_mfma_f32_32x32x16_bf16 v[24:39], v[128:131], v[100:103], v[24:39]
  ds_read_b64_tr_b16 v[120:121], v12 offset:4096
  ds_read_b64_tr_b16 v[122:123], v12 offset:5120
  s_waitcnt vmcnt(16)
  v_min3_u32 v6, v176, v178, v180
  v_min3_u32 v7, v182, v184, v186
  v_min3_u32 v6, v6, v188, v190
  v_min_u32 v6, v6, v7
  v_cmp_eq_u32 vcc, 0, v6
  v_mfma_f32_32x32x16_bf16 v[40:55], v[132:135], v[100:103], v[40:55]
  ds_read_b64_tr_b16 v[124:125], v13 offset:4096
  ds_read_b64_tr_b16 v[126:127], v13 offset:5120
  s_cbranch_vccnz .g2_kernel_w_v9
.g2_kernel_w_vb9:
  s_waitcnt lgkmcnt(8)
  v_mfma_f32_32x32x16_bf16 v[24:39], v[104:107], v[176:179], v[24:39]
  v_add_u32 v10, s10, v14
  v_add_u32 v11, s10, v15
  s_andn2_b32 s33, s36, s34
  s_cbranch_scc0 .g2_kernel_w_i13c
.g2_kernel_w_i13b:
  ds_read_b64_tr_b16 v[128:129], v12 offset:6144
  ds_read_b64_tr_b16 v[130:131], v12 offset:7168
  v_mfma_f32_32x32x16_bf16 v[40:55], v[108:111], v[176:179], v[40:55]
  s_ff1_i32_b32 s33, s33
  s_bitset1_b32 s34, s33
  s_xor_b32 s33, s33, s24
  s_and_b32 s13, s33, 7
  ds_read_b64_tr_b16 v[132:133], v13 offset:6144
  ds_read_b64_tr_b16 v[134:135], v13 offset:7168
  s_waitcnt lgkmcnt(8)
  v_mfma_f32_32x32x16_bf16 v[24:39], v[112:115], v[180:183], v[24:39]
  s_cmp_lt_u32 s13, 2
  s_cselect_b32 s28, 139264, 0
  s_lshl_b32 s13, s13, 13
  s_add_u32 s13, s13, s28
  ds_read_b64_tr_b16 v[104:105], v10 offset:0
  ds_read_b64_tr_b16 v[106:107], v10 offset:1024
  v_mfma_f32_32x32x16_bf16 v[40:55], v[116:119], v[180:183], v[40:55]
  s_lshl_b32 s33, s33, 12
  s_add_u32 s22, s20, s33
  s_addc_u32 s23, s21, 0
  global_load_dwordx4 v[136:139], v3, s[22:23] offset:0
  ds_read_b64_tr_b16 v[108:109], v11 offset:0
  ds_read_b64_tr_b16 v[110:111], v11 offset:1024
  s_waitcnt lgkmcnt(8)
  v_mfma_f32_32x32x16_bf16 v[24:39], v[120:123], v[184:187], v[24:39]
  global_load_dwordx4 v[140:143], v3, s[22:23] offset:1024
  global_load_dwordx4 v[144:147], v3, s[22:23] offset:2048
  global_load_dwordx4 v[148:151], v3, s[22:23] offset:3072
  ds_read_b64_tr_b16 v[112:113], v10 offset:2048
  ds_read_b64_tr_b16 v[114:115], v10 offset:3072
  v_mfma_f32_32x32x16_bf16 v[40:55], v[124:127], v[184:187], v[40:55]
  ds_read_b64_tr_b16 v[116:117], v11 offset:2048
  ds_read_b64_tr_b16 v[118:119], v11 offset:3072
  s_waitcnt lgkmcnt(8)
  v_mfma_f32_32x32x16_bf16 v[24:39], v[128:131], v[188:191], v[24:39]
  ds_read_b64_tr_b16 v[120:121], v10 offset:4096
  ds_read_b64_tr_b16 v[122:123], v10 offset:5120
  s_waitcnt vmcnt(12)
  v_min3_u32 v6, v192, v194, v196
  v_min3_u32 v7, v198, v200, v202
  v_min3_u32 v6, v6, v204, v206
  v_min_u32 v6, v6, v7
  v_cmp_eq_u32 vcc, 0, v6
  v_mfma_f32_32x32x16_bf16 v[40:55], v[132:135], v[188:191], v[40:55]
  ds_read_b64_tr_b16 v[124:125], v11 offset:4096
  ds_read_b64_tr_b16 v[126:127], v11 offset:5120
  s_cbranch_vccnz .g2_kernel_w_v10
.g2_kernel_w_vb10:
  s_waitcnt lgkmcnt(8)
  v_mfma_f32_32x32x16_bf16 v[24:39], v[104:107], v[192:195], v[24:39]
  v_add_u32 v12, s11, v14
  v_add_u32 v13, s11, v15
  s_andn2_b32 s33, s36, s34
  s_cbranch_scc0 .g2_kernel_w_i14c
.g2_kernel_w_i14b:
  ds_read_b64_tr_b16 v[128:129], v10 offset:6144
  ds_read_b64_tr_b16 v[130:131], v10 offset:7168
  v_mfma_f32_32x32x16_bf16 v[40:55], v[108:111], v[192:195], v[40:55]
  s_ff1_i32_b32 s33, s33
  s_bitset1_b32 s34, s33
  s_xor_b32 s33, s33, s24
  s_and_b32 s14, s33, 7
  ds_read_b64_tr_b16 v[132:133], v11 offset:6144
  ds_read_b64_tr_b16 v[134:135], v11 offset:7168
  s_waitcnt lgkmcnt(8)
  v_mfma_f32_32x32x16_bf16 v[24:39], v[112:115], v[196:199], v[24:39]
  s_cmp_lt_u32 s14, 2
  s_cselect_b32 s28, 139264, 0
  s_lshl_b32 s14, s14, 13
  s_add_u32 s14, s14, s28
  ds_read_b64_tr_b16 v[104:105], v12 offset:0
  ds_read_b64_tr_b16 v[106:107], v12 offset:1024
  v_mfma_f32_32x32x16_bf16 v[40:55], v[116:119], v[196:199], v[40:55]
  s_lshl_b32 s33, s33, 12
  s_add_u32 s22, s20, s33
  s_addc_u32 s23, s21, 0
  global_load_dwordx4 v[152:155], v3, s[22:23] offset:0 sc1
  ds_read_b64_tr_b16 v[108:109], v13 offset:0
  ds_read_b64_tr_b16 v[110:111], v13 offset:1024
  s_waitcnt lgkmcnt(8)
  v_mfma_f32_32x32x16_bf16 v[24:39], v[120:123], v[200:203], v[24:39]
  global_load_dwordx4 v[156:159], v3, s[22:23] offset:1024 sc1
  global_load_dwordx4 v[160:163], v3, s[22:23] offset:2048 sc1
  global_load_dwordx4 v[164:167], v3, s[22:23] offset:3072 sc1
  ds_read_b64_tr_b16 v[112:113], v12 offset:2048
  ds_read_b64_tr_b16 v[114:115], v12 offset:3072
  v_mfma_f32_32x32x16_bf16 v[40:55], v[124:127], v[200:203], v[40:55]
  ds_read_b64_tr_b16 v[116:117], v13 offset:2048
  ds_read_b64_tr_b16 v[118:119], v13 offset:3072
  s_waitcnt lgkmcnt(8)
  v_mfma_f32_32x32x16_bf16 v[24:39], v[128:131], v[204:207], v[24:39]
  ds_read_b64_tr_b16 v[120:121], v12 offset:4096
  ds_read_b64_tr_b16 v[122:123], v12 offset:5120
  s_waitcnt vmcnt(12)
  v_min3_u32 v6, v208, v210, v212
  v_min3_u32 v7, v214, v216, v218
  v_min3_u32 v6, v6, v220, v222
  v_min_u32 v6, v6, v7
  v_cmp_eq_u32 vcc, 0, v6
  v_mfma_f32_32x32x16_bf16 v[40:55], v[132:135], v[204:207], v[40:55]
  ds_read_b64_tr_b16 v[124:125], v13 offset:4096
  ds_read_b64_tr_b16 v[126:127], v13 offset:5120
  s_cbranch_vccnz .g2_kernel_w_v11
.g2_kernel_w_vb11:
  s_mov_b64 exec, 1
  ds_add_u32 v20, v5 offset:16
  s_mov_b64 exec, -1
  s_waitcnt lgkmcnt(8)
  v_mfma_f32_32x32x16_bf16 v[24:39], v[104:107], v[208:211], v[24:39]
  v_add_u32 v10, s12, v14
  v_add_u32 v11, s12, v15
  s_andn2_b32 s33, s36, s34
  s_cbranch_scc0 .g2_kernel_w_i15c
.g2_kernel_w_i15b:
  ds_read_b64_tr_b16 v[128:129], v12 offset:6144
  ds_read_b64_tr_b16 v[130:131], v12 offset:7168
  v_mfma_f32_32x32x16_bf16 v[40:55], v[108:111], v[208:211], v[40:55]
  s_ff1_i32_b32 s33, s33
  s_bitset1_b32 s34, s33
  s_xor_b32 s33, s33, s24
  s_and_b32 s15, s33, 7
  ds_read_b64_tr_b16 v[132:133], v13 offset:6144
  ds_read_b64_tr_b16 v[134:135], v13 offset:7168
  s_waitcnt lgkmcnt(8)
  v_mfma_f32_32x32x16_bf16 v[24:39], v[112:115], v[212:215], v[24:39]
  s_cmp_lt_u32 s15, 2
  s_cselect_b32 s28, 139264, 0
  s_lshl_b32 s15, s15, 13
  s_add_u32 s15, s15, s28
  ds_read_b64_tr_b16 v[104:105], v10 offset:0
  ds_read_b64_tr_b16 v[106:107], v10 offset:1024
  v_mfma_f32_32x32x16_bf16 v[40:55], v[116:119], v[212:215], v[40:55]
  s_lshl_b32 s33, s33, 12
  s_add_u32 s22, s20, s33
  s_addc_u32 s23, s21, 0
  global_load_dwordx4 v[56:59], v3, s[22:23] offset:0 sc1
  ds_read_b64_tr_b16 v[108:109], v11 offset:0
  ds_read_b64_tr_b16 v[110:111], v11 offset:1024
  s_waitcnt lgkmcnt(8)
  v_mfma_f32_32x32x16_bf16 v[24:39], v[120:123], v[216:219], v[24:39]
  global_load_dwordx4 v[60:63], v3, s[22:23] offset:1024 sc1
  global_load_dwordx4 v[64:67], v3, s[22:23] offset:2048 sc1
  global_load_dwordx4 v[68:71], v3, s[22:23] offset:3072 sc1
  ds_read_b64_tr_b16 v[112:113], v10 offset:2048
  ds_read_b64_tr_b16 v[114:115], v10 offset:3072
  v_mfma_f32_32x32x16_bf16 v[40:55], v[124:127], v[216:219], v[40:55]
  ds_read_b64_tr_b16 v[116:117], v11 offset:2048
  ds_read_b64_tr_b16 v[118:119], v11 offset:3072
  s_waitcnt lgkmcnt(8)
  v_mfma_f32_32x32x16_bf16 v[24:39], v[128:131], v[220:223], v[24:39]
  ds_read_b64_tr_b16 v[120:121], v10 offset:4096
  ds_read_b64_tr_b16 v[122:123], v10 offset:5120
  s_waitcnt vmcnt(12)
  v_min3_u32 v6, v224, v226, v228
  v_min3_u32 v7, v230, v232, v234
  v_min3_u32 v6, v6, v236, v238
  v_min_u32 v6, v6, v7
  v_cmp_eq_u32 vcc, 0, v6
  v_mfma_f32_32x32x16_bf16 v[40:55], v[132:135], v[220:223], v[40:55]
  ds_read_b64_tr_b16 v[124:125], v11 offset:4096
  ds_read_b64_tr_b16 v[126:127], v11 offset:5120
  s_cbranch_vccnz .g2_kernel_w_v12
.g2_kernel_w_vb12:
  s_waitcnt lgkmcnt(8)
  v_mfma_f32_32x32x16_bf16 v[24:39], v[104:107], v[224:227], v[24:39]
  v_add_u32 v12, s13, v14
  v_add_u32 v13, s13, v15
  ds_read_b64_tr_b16 v[128:129], v10 offset:6144
  ds_read_b64_tr_b16 v[130:131], v10 offset:7168
  v_mfma_f32_32x32x16_bf16 v[40:55], v[108:111], v[224:227], v[40:55]
  ds_read_b64_tr_b16 v[132:133], v11 offset:6144
  ds_read_b64_tr_b16 v[134:135], v11 offset:7168
  s_waitcnt lgkmcnt(8)
  v_mfma_f32_32x32x16_bf16 v[24:39], v[112:115], v[228:231], v[24:39]
  ds_read_b64_tr_b16 v[104:105], v12 offset:0
  ds_read_b64_tr_b16 v[106:107], v12 offset:1024
  v_mfma_f32_32x32x16_bf16 v[40:55], v[116:119], v[228:231], v[40:55]
  ds_read_b64_tr_b16 v[108:109], v13 offset:0
  ds_read_b64_tr_b16 v[110:111], v13 offset:1024
  s_waitcnt lgkmcnt(8)
  v_mfma_f32_32x32x16_bf16 v[24:39], v[120:123], v[232:235], v[24:39]
  ds_read_b64_tr_b16 v[112:113], v12 offset:2048
  ds_read_b64_tr_b16 v[114:115], v12 offset:3072
  v_mfma_f32_32x32x16_bf16 v[40:55], v[124:127], v[232:235], v[40:55]
  ds_read_b64_tr_b16 v[116:117], v13 offset:2048
  ds_read_b64_tr_b16 v[118:119], v13 offset:3072
  s_waitcnt lgkmcnt(8)
  v_mfma_f32_32x32x16_bf16 v[24:39], v[128:131], v[236:239], v[24:39]
  ds_read_b64_tr_b16 v[120:121], v12 offset:4096
  ds_read_b64_tr_b16 v[122:123], v12 offset:5120
  s_waitcnt vmcnt(8)
  v_min3_u32 v6, v136, v138, v140
  v_min3_u32 v7, v142, v144, v146
  v_min3_u32 v6, v6, v148, v150
  v_min_u32 v6, v6, v7
  v_cmp_eq_u32 vcc, 0, v6
  v_mfma_f32_32x32x16_bf16 v[40:55], v[132:135], v[236:239], v[40:55]
  ds_read_b64_tr_b16 v[124:125], v13 offset:4096
  ds_read_b64_tr_b16 v[126:127], v13 offset:5120
  s_cbranch_vccnz .g2_kernel_w_v13
.g2_kernel_w_vb13:
  s_waitcnt lgkmcnt(8)
  v_mfma_f32_32x32x16_bf16 v[24:39], v[104:107], v[136:139], v[24:39]
  v_add_u32 v10, s14, v14
  v_add_u32 v11, s14, v15
  ds_read_b64_tr_b16 v[128:129], v12 offset:6144
  ds_read_b64_tr_b16 v[130:131], v12 offset:7168
  v_mfma_f32_32x32x16_bf16 v[40:55], v[108:111], v[136:139], v[40:55]
  ds_read_b64_tr_b16 v[132:133], v13 offset:6144
  ds_read_b64_tr_b16 v[134:135], v13 offset:7168
  s_waitcnt lgkmcnt(8)
  v_mfma_f32_32x32x16_bf16 v[24:39], v[112:115], v[140:143], v[24:39]
  ds_read_b64_tr_b16 v[104:105], v10 offset:0
  ds_read_b64_tr_b16 v[106:107], v10 offset:1024
  v_mfma_f32_32x32x16_bf16 v[40:55], v[116:119], v[140:143], v[40:55]
  ds_read_b64_tr_b16 v[108:109], v11 offset:0
  ds_read_b64_tr_b16 v[110:111], v11 offset:1024
  s_waitcnt lgkmcnt(8)
  v_mfma_f32_32x32x16_bf16 v[24:39], v[120:123], v[144:147], v[24:39]
  ds_read_b64_tr_b16 v[112:113], v10 offset:2048
  ds_read_b64_tr_b16 v[114:115], v10 offset:3072
  v_mfma_f32_32x32x16_bf16 v[40:55], v[124:127], v[144:147], v[40:55]
  ds_read_b64_tr_b16 v[116:117], v11 offset:2048
  ds_read_b64_tr_b16 v[118:119], v11 offset:3072
  s_waitcnt lgkmcnt(8)
  v_mfma_f32_32x32x16_bf16 v[24:39], v[128:131], v[148:151], v[24:39]
  ds_read_b64_tr_b16 v[120:121], v10 offset:4096
  ds_read_b64_tr_b16 v[122:123], v10 offset:5120
  s_waitcnt vmcnt(4)
  v_min3_u32 v6, v152, v154, v156
  v_min3_u32 v7, v158, v160, v162
  v_min3_u32 v6, v6, v164, v166
  v_min_u32 v6, v6, v7
  v_cmp_eq_u32 vcc, 0, v6
  v_mfma_f32_32x32x16_bf16 v[40:55], v[132:135], v[148:151], v[40:55]
  ds_read_b64_tr_b16 v[124:125], v11 offset:4096
  ds_read_b64_tr_b16 v[126:127], v11 offset:5120
  s_cbranch_vccnz .g2_kernel_w_v14
.g2_kernel_w_vb14:
  s_waitcnt lgkmcnt(8)
  v_mfma_f32_32x32x16_bf16 v[24:39], v[104:107], v[152:155], v[24:39]
  v_add_u32 v12, s15, v14
  v_add_u32 v13, s15, v15
  ds_read_b64_tr_b16 v[128:129], v10 offset:6144
  ds_read_b64_tr_b16 v[130:131], v10 offset:7168
  v_mfma_f32_32x32x16_bf16 v[40:55], v[108:111], v[152:155], v[40:55]
  ds_read_b64_tr_b16 v[132:133], v11 offset:6144
  ds_read_b64_tr_b16 v[134:135], v11 offset:7168
  s_waitcnt lgkmcnt(8)
  v_mfma_f32_32x32x16_bf16 v[24:39], v[112:115], v[156:159], v[24:39]
  ds_read_b64_tr_b16 v[104:105], v12 offset:0
  ds_read_b64_tr_b16 v[106:107], v12 offset:1024
  v_mfma_f32_32x32x16_bf16 v[40:55], v[116:119], v[156:159], v[40:55]
  ds_read_b64_tr_b16 v[108:109], v13 offset:0
  ds_read_b64_tr_b16 v[110:111], v13 offset:1024
  s_waitcnt lgkmcnt(8)
  v_mfma_f32_32x32x16_bf16 v[24:39], v[120:123], v[160:163], v[24:39]
  ds_read_b64_tr_b16 v[112:113], v12 offset:2048
  ds_read_b64_tr_b16 v[114:115], v12 offset:3072
  v_mfma_f32_32x32x16_bf16 v[40:55], v[124:127], v[160:163], v[40:55]
  ds_read_b64_tr_b16 v[116:117], v13 offset:2048
  ds_read_b64_tr_b16 v[118:119], v13 offset:3072
  s_waitcnt lgkmcnt(8)
  v_mfma_f32_32x32x16_bf16 v[24:39], v[128:131], v[164:167], v[24:39]
  ds_read_b64_tr_b16 v[120:121], v12 offset:4096
  ds_read_b64_tr_b16 v[122:123], v12 offset:5120
  s_waitcnt vmcnt(0)
  v_min3_u32 v6, v56, v58, v60
  v_min3_u32 v7, v62, v64, v66
  v_min3_u32 v6, v6, v68, v70
  v_min_u32 v6, v6, v7
  v_cmp_eq_u32 vcc, 0, v6
  v_mfma_f32_32x32x16_bf16 v[40:55], v[132:135], v[164:167], v[40:55]
  ds_read_b64_tr_b16 v[124:125], v13 offset:4096
  ds_read_b64_tr_b16 v[126:127], v13 offset:5120
  s_cbranch_vccnz .g2_kernel_w_v15
.g2_kernel_w_vb15:
  s_waitcnt lgkmcnt(8)
  v_mfma_f32_32x32x16_bf16 v[24:39], v[104:107], v[56:59], v[24:39]
  ds_read_b64_tr_b16 v[128:129], v12 offset:6144
  ds_read_b64_tr_b16 v[130:131], v12 offset:7168
  v_mfma_f32_32x32x16_bf16 v[40:55], v[108:111], v[56:59], v[40:55]
  ds_read_b64_tr_b16 v[132:133], v13 offset:6144
  ds_read_b64_tr_b16 v[134:135], v13 offset:7168
  s_waitcnt lgkmcnt(8)
  v_mfma_f32_32x32x16_bf16 v[24:39], v[112:115], v[60:63], v[24:39]
  v_mfma_f32_32x32x16_bf16 v[40:55], v[116:119], v[60:63], v[40:55]
  s_waitcnt lgkmcnt(4)
  v_mfma_f32_32x32x16_bf16 v[24:39], v[120:123], v[64:67], v[24:39]
  v_mfma_f32_32x32x16_bf16 v[40:55], v[124:127], v[64:67], v[40:55]
  s_waitcnt lgkmcnt(0)
  v_mfma_f32_32x32x16_bf16 v[24:39], v[128:131], v[68:71], v[24:39]
  v_mfma_f32_32x32x16_bf16 v[40:55], v[132:135], v[68:71], v[40:55]
  s_lshl_b32 s28, s17, 4
  s_add_u32 s28, s28, s18
  s_lshl_b32 s28, s28, 2
  s_add_u32 s28, s28, s16
  s_lshl_b32 s28, s28, 12
  s_add_u32 s28, s28, s63
  s_add_u32 s28, s28, 0xc00000
  s_lshl_b32 s29, s16, 12
  v_add_u32 v6, s29, v22
  s_mov_b32 s36, 0x3f803f80
  v_mov_b32 v8, 0
  v_mov_b32 v9, 0
  v_mov_b32 v10, 0
  v_cvt_pk_bf16_f32 v56, v24, v25
  v_cvt_pk_bf16_f32 v57, v26, v27
  v_cvt_pk_bf16_f32 v58, v28, v29
  v_cvt_pk_bf16_f32 v59, v30, v31
  buffer_store_dwordx4 v[56:59], v22, s[4:7], s28 offen offset:0 sc1
  v_cvt_pk_bf16_f32 v60, v32, v33
  v_cvt_pk_bf16_f32 v61, v34, v35
  v_cvt_pk_bf16_f32 v62, v36, v37
  v_cvt_pk_bf16_f32 v63, v38, v39
  buffer_store_dwordx4 v[60:63], v22, s[4:7], s28 offen offset:512 sc1
  v_cvt_pk_bf16_f32 v64, v40, v41
  v_cvt_pk_bf16_f32 v65, v42, v43
  v_cvt_pk_bf16_f32 v66, v44, v45
  v_cvt_pk_bf16_f32 v67, v46, v47
  buffer_store_dwordx4 v[64:67], v22, s[4:7], s28 offen offset:1024 sc1
  v_cvt_pk_bf16_f32 v68, v48, v49
  v_cvt_pk_bf16_f32 v69, v50, v51
  v_cvt_pk_bf16_f32 v70, v52, v53
  v_cvt_pk_bf16_f32 v71, v54, v55
  buffer_store_dwordx4 v[68:71], v22, s[4:7], s28 offen offset:1536 sc1
  ds_write_b128 v6, v[56:59] offset:0
  ds_write_b128 v6, v[60:63] offset:512
  ds_write_b128 v6, v[64:67] offset:1024
  ds_write_b128 v6, v[68:71] offset:1536
  s_mov_b64 exec, 1
  ds_add_u32 v20, v5 offset:20
  s_mov_b64 exec, -1
  s_lshl_b32 s28, s17, 2
  s_add_u32 s28, s28, s16
  s_lshl_b32 s28, s28, 13
  s_lshl_b32 s29, s18, 9
  s_add_u32 s28, s28, s29
  s_add_u32 s28, s28, s63
  s_add_u32 s28, s28, 0x1000000
  v_dot2c_f32_bf16 v8, s36, v56
  v_dot2c_f32_bf16 v9, v56, v56
  v_dot2c_f32_bf16 v10, v56, v240
  v_dot2c_f32_bf16 v8, s36, v57
  v_dot2c_f32_bf16 v9, v57, v57
  v_dot2c_f32_bf16 v10, v57, v241
  v_dot2c_f32_bf16 v8, s36, v58
  v_dot2c_f32_bf16 v9, v58, v58
  v_dot2c_f32_bf16 v10, v58, v242
  v_dot2c_f32_bf16 v8, s36, v59
  v_dot2c_f32_bf16 v9, v59, v59
  v_dot2c_f32_bf16 v10, v59, v243
  v_dot2c_f32_bf16 v8, s36, v60
  v_dot2c_f32_bf16 v9, v60, v60
  v_dot2c_f32_bf16 v10, v60, v244
  v_dot2c_f32_bf16 v8, s36, v61
  v_dot2c_f32_bf16 v9, v61, v61
  v_dot2c_f32_bf16 v10, v61, v245
  v_dot2c_f32_bf16 v8, s36, v62
  v_dot2c_f32_bf16 v9, v62, v62
  v_dot2c_f32_bf16 v10, v62, v246
  v_dot2c_f32_bf16 v8, s36, v63
  v_dot2c_f32_bf16 v9, v63, v63
  v_dot2c_f32_bf16 v10, v63, v247
  v_dot2c_f32_bf16 v8, s36, v64
  v_dot2c_f32_bf16 v9, v64, v64
  v_dot2c_f32_bf16 v10, v64, v248
  v_dot2c_f32_bf16 v8, s36, v65
  v_dot2c_f32_bf16 v9, v65, v65
  v_dot2c_f32_bf16 v10, v65, v249
  v_dot2c_f32_bf16 v8, s36, v66
  v_dot2c_f32_bf16 v9, v66, v66
  v_dot2c_f32_bf16 v10, v66, v250
  v_dot2c_f32_bf16 v8, s36, v67
  v_dot2c_f32_bf16 v9, v67, v67
  v_dot2c_f32_bf16 v10, v67, v251
  v_dot2c_f32_bf16 v8, s36, v68
  v_dot2c_f32_bf16 v9, v68, v68
  v_dot2c_f32_bf16 v10, v68, v252
  v_dot2c_f32_bf16 v8, s36, v69
  v_dot2c_f32_bf16 v9, v69, v69
  v_dot2c_f32_bf16 v10, v69, v253
  v_dot2c_f32_bf16 v8, s36, v70
  v_dot2c_f32_bf16 v9, v70, v70
  v_dot2c_f32_bf16 v10, v70, v254
  v_dot2c_f32_bf16 v8, s36, v71
  v_dot2c_f32_bf16 v9, v71, v71
  v_dot2c_f32_bf16 v10, v71, v255
  s_lshl_b32 s29, s16, 7
  s_add_u32 s37, s19, s29
  v_mov_b32 v24, v8
  v_mov_b32 v25, v9
  v_mov_b32 v26, v10
  v_mov_b32 v11, 1
  v_permlane32_swap_b32 v8, v24
  v_permlane32_swap_b32 v9, v25
  v_permlane32_swap_b32 v10, v26
  v_add_f32 v8, v8, v24
  v_add_f32 v9, v9, v25
  v_add_f32 v10, v10, v26
  v_or_b32 v8, 1, v8
  v_mov_b32 v16, s70
  s_mov_b32 exec_hi, 0
  s_waitcnt vmcnt(0)
  buffer_store_dwordx4 v[8:11], v3, s[4:7], s28 offen sc1
  s_mov_b64 exec, 1
  buffer_store_dword v16, v4, s[4:7], s37 offen offset:8 sc1
  s_mov_b64 exec, -1
  s_cmp_lg_u32 s62, 0
  s_cbranch_scc1 .g2_kernel_tail
  s_mov_b32 s62, 1
  s_mov_b32 s63, 0x1800000
  s_mov_b32 s70, 2
  s_mov_b32 s71, 155776
  s_branch .g2_kernel_q_cons2
.g2_kernel_tail:
  s_mov_b32 s28, s56
  s_mov_b32 s29, s57
  s_mov_b32 s30, 0x400000
  s_mov_b32 s31, 0x00020000
  v_lshrrev_b32 v8, 3, v2
  v_and_b32 v9, 7, v2
  v_lshlrev_b32 v10, 8, v9
  v_lshl_add_u32 v10, v8, 4, v10
  s_lshl_b32 s32, s16, 12
  v_add_u32 v10, s32, v10
  ds_read_b128 v[56:59], v10 offset:0
  ds_read_b128 v[60:63], v10 offset:128
  ds_read_b128 v[64:67], v10 offset:2048
  ds_read_b128 v[68:71], v10 offset:2176
  v_lshlrev_b32 v23, 11, v8
  v_lshl_add_u32 v23, v9, 4, v23
  s_lshl_b32 s32, s16, 5
  v_add_u32 v19, s32, v8
  v_lshlrev_b32 v10, 2, v19
  v_add_u32 v10, 155648, v10
  s_lshl_b32 s32, s17, 2
  s_add_u32 s32, s32, s16
  s_lshl_b32 s32, s32, 16
  s_lshl_b32 s33, s18, 7
  s_add_u32 s32, s32, s33
  s_waitcnt lgkmcnt(0)
  v_lshlrev_b32 v24, 16, v56
  v_and_b32 v25, 0xffff0000, v56
  v_lshlrev_b32 v26, 16, v57
  v_and_b32 v27, 0xffff0000, v57
  v_lshlrev_b32 v28, 16, v58
  v_and_b32 v29, 0xffff0000, v58
  v_lshlrev_b32 v30, 16, v59
  v_and_b32 v31, 0xffff0000, v59
  v_lshlrev_b32 v32, 16, v60
  v_and_b32 v33, 0xffff0000, v60
  v_lshlrev_b32 v34, 16, v61
  v_and_b32 v35, 0xffff0000, v61
  v_lshlrev_b32 v36, 16, v62
  v_and_b32 v37, 0xffff0000, v62
  v_lshlrev_b32 v38, 16, v63
  v_and_b32 v39, 0xffff0000, v63
  v_lshlrev_b32 v40, 16, v64
  v_and_b32 v41, 0xffff0000, v64
  v_lshlrev_b32 v42, 16, v65
  v_and_b32 v43, 0xffff0000, v65
  v_lshlrev_b32 v44, 16, v66
  v_and_b32 v45, 0xffff0000, v66
  v_lshlrev_b32 v46, 16, v67
  v_and_b32 v47, 0xffff0000, v67
  v_lshlrev_b32 v48, 16, v68
  v_and_b32 v49, 0xffff0000, v68
  v_lshlrev_b32 v50, 16, v69
  v_and_b32 v51, 0xffff0000, v69
  v_lshlrev_b32 v52, 16, v70
  v_and_b32 v53, 0xffff0000, v70
  v_lshlrev_b32 v54, 16, v71
  v_and_b32 v55, 0xffff0000, v71
  s_lshl_b32 s33, s16, 2
  s_add_u32 s33, s33, 155920
  v_mov_b32 v17, s33
  v_mov_b32 v6, s71
  s_mov_b32 s38, 0
.g2_kernel_wg7:
  ds_read_b32 v7, v6 offset:28
  s_add_u32 s38, s38, 1
  s_waitcnt lgkmcnt(0)
  v_cmp_gt_u32 vcc, 1, v7
  s_cbranch_vccz .g2_kernel_wg7d
  s_sleep 2
  s_cmp_lt_u32 s38, 524288
  s_cbranch_scc1 .g2_kernel_wg7
.g2_kernel_wg7d:
  ds_read_b32 v17, v20 offset:32
  ds_read_b32 v72, v10 offset:3840
  ds_read_b32 v73, v10 offset:4352
  ds_read_b32 v74, v10 offset:3872
  ds_read_b32 v75, v10 offset:4384
  ds_read_b32 v76, v10 offset:3904
  ds_read_b32 v77, v10 offset:4416
  ds_read_b32 v78, v10 offset:3936
  ds_read_b32 v79, v10 offset:4448
  s_waitcnt lgkmcnt(0)
  v_sub_u32 v16, v17, v19
  v_pk_fma_f32 v[24:25], v[24:25], v[72:73], v[72:73] op_sel:[0,0,1] op_sel_hi:[1,0,1]
  v_pk_fma_f32 v[26:27], v[26:27], v[72:73], v[72:73] op_sel:[0,0,1] op_sel_hi:[1,0,1]
  v_pk_fma_f32 v[28:29], v[28:29], v[72:73], v[72:73] op_sel:[0,0,1] op_sel_hi:[1,0,1]
  v_pk_fma_f32 v[30:31], v[30:31], v[72:73], v[72:73] op_sel:[0,0,1] op_sel_hi:[1,0,1]
  v_cvt_pk_bf16_f32 v56, v24, v25
  v_cvt_pk_bf16_f32 v57, v26, v27
  v_cvt_pk_bf16_f32 v58, v28, v29
  v_cvt_pk_bf16_f32 v59, v30, v31
  v_cmp_ne_u32 vcc, 1, v16
  s_mov_b64 exec, vcc
  buffer_store_dwordx4 v[56:59], v23, s[28:31], s32 offen sc1
  s_mov_b64 exec, -1
  s_add_u32 s32, s32, 16384
  v_pk_fma_f32 v[32:33], v[32:33], v[74:75], v[74:75] op_sel:[0,0,1] op_sel_hi:[1,0,1]
  v_pk_fma_f32 v[34:35], v[34:35], v[74:75], v[74:75] op_sel:[0,0,1] op_sel_hi:[1,0,1]
  v_pk_fma_f32 v[36:37], v[36:37], v[74:75], v[74:75] op_sel:[0,0,1] op_sel_hi:[1,0,1]
  v_pk_fma_f32 v[38:39], v[38:39], v[74:75], v[74:75] op_sel:[0,0,1] op_sel_hi:[1,0,1]
  v_cvt_pk_bf16_f32 v60, v32, v33
  v_cvt_pk_bf16_f32 v61, v34, v35
  v_cvt_pk_bf16_f32 v62, v36, v37
  v_cvt_pk_bf16_f32 v63, v38, v39
  v_cmp_ne_u32 vcc, 9, v16
  s_mov_b64 exec, vcc
  buffer_store_dwordx4 v[60:63], v23, s[28:31], s32 offen sc1
  s_mov_b64 exec, -1
  s_add_u32 s32, s32, 16384
  v_pk_fma_f32 v[40:41], v[40:41], v[76:77], v[76:77] op_sel:[0,0,1] op_sel_hi:[1,0,1]
  v_pk_fma_f32 v[42:43], v[42:43], v[76:77], v[76:77] op_sel:[0,0,1] op_sel_hi:[1,0,1]
  v_pk_fma_f32 v[44:45], v[44:45], v[76:77], v[76:77] op_sel:[0,0,1] op_sel_hi:[1,0,1]
  v_pk_fma_f32 v[46:47], v[46:47], v[76:77], v[76:77] op_sel:[0,0,1] op_sel_hi:[1,0,1]
  v_cvt_pk_bf16_f32 v64, v40, v41
  v_cvt_pk_bf16_f32 v65, v42, v43
  v_cvt_pk_bf16_f32 v66, v44, v45
  v_cvt_pk_bf16_f32 v67, v46, v47
  v_cmp_ne_u32 vcc, 17, v16
  s_mov_b64 exec, vcc
  buffer_store_dwordx4 v[64:67], v23, s[28:31], s32 offen sc1
  s_mov_b64 exec, -1
  s_add_u32 s32, s32, 16384
  v_pk_fma_f32 v[48:49], v[48:49], v[78:79], v[78:79] op_sel:[0,0,1] op_sel_hi:[1,0,1]
  v_pk_fma_f32 v[50:51], v[50:51], v[78:79], v[78:79] op_sel:[0,0,1] op_sel_hi:[1,0,1]
  v_pk_fma_f32 v[52:53], v[52:53], v[78:79], v[78:79] op_sel:[0,0,1] op_sel_hi:[1,0,1]
  v_pk_fma_f32 v[54:55], v[54:55], v[78:79], v[78:79] op_sel:[0,0,1] op_sel_hi:[1,0,1]
  v_cvt_pk_bf16_f32 v68, v48, v49
  v_cvt_pk_bf16_f32 v69, v50, v51
  v_cvt_pk_bf16_f32 v70, v52, v53
  v_cvt_pk_bf16_f32 v71, v54, v55
  v_cmp_ne_u32 vcc, 25, v16
  s_mov_b64 exec, vcc
  buffer_store_dwordx4 v[68:71], v23, s[28:31], s32 offen sc1
  s_mov_b64 exec, -1
  s_add_u32 s32, s32, 16384
  s_branch .g2_kernel_fin
.g2_kernel_svc:
  s_cmp_eq_u32 s16, 5
  s_cbranch_scc1 .g2_kernel_s1
  s_cmp_eq_u32 s16, 6
  s_cbranch_scc1 .g2_kernel_s2
  s_cmp_eq_u32 s16, 7
  s_cbranch_scc1 .g2_kernel_s3
  s_mov_b32 s8, s40
  s_mov_b32 s9, s41
  s_mov_b32 s10, 0x400000
  s_mov_b32 s11, 0x00020000
  s_setprio 3
  v_lshrrev_b32 v20, 3, v2
  v_and_b32 v21, 7, v2
  v_lshrrev_b32 v22, 4, v2
  v_xor_b32 v23, v21, v22
  v_lshlrev_b32 v23, 4, v23
  v_lshl_add_u32 v24, v20, 11, v23
  v_xor_b32 v25, 64, v24
  s_lshl_b32 s32, s17, 18
  v_add_u32 v32, 0, v24
  v_add_u32 v33, 15360, v25
  v_add_u32 v34, 30720, v24
  v_add_u32 v35, 46080, v25
  v_add_u32 v36, 65536, v24
  v_add_u32 v37, 80896, v25
  v_add_u32 v38, 96256, v24
  v_add_u32 v39, 111616, v25
  v_add_u32 v40, 131072, v24
  v_add_u32 v41, 146432, v25
  v_add_u32 v42, 161792, v24
  v_add_u32 v43, 177152, v25
  v_add_u32 v44, 196608, v24
  v_add_u32 v45, 211968, v25
  v_add_u32 v46, 227328, v24
  v_add_u32 v47, 242688, v25
  s_mov_b32 s29, 0
  s_add_u32 m0, s29, 0
  s_waitcnt vmcnt(63)
  buffer_load_dwordx4 v32, s[8:11], s32 offen offset:0 lds
  buffer_load_dwordx4 v33, s[8:11], s32 offen offset:1024 lds
  buffer_load_dwordx4 v34, s[8:11], s32 offen offset:2048 lds
  buffer_load_dwordx4 v35, s[8:11], s32 offen offset:3072 lds
  s_add_u32 m0, s29, 4096
  s_waitcnt vmcnt(63)
  buffer_load_dwordx4 v36, s[8:11], s32 offen offset:0 lds
  buffer_load_dwordx4 v37, s[8:11], s32 offen offset:1024 lds
  buffer_load_dwordx4 v38, s[8:11], s32 offen offset:2048 lds
  buffer_load_dwordx4 v39, s[8:11], s32 offen offset:3072 lds
  s_add_u32 m0, s29, 8192
  s_waitcnt vmcnt(63)
  buffer_load_dwordx4 v40, s[8:11], s32 offen offset:0 lds
  buffer_load_dwordx4 v41, s[8:11], s32 offen offset:1024 lds
  buffer_load_dwordx4 v42, s[8:11], s32 offen offset:2048 lds
  buffer_load_dwordx4 v43, s[8:11], s32 offen offset:3072 lds
  s_add_u32 m0, s29, 12288
  s_waitcnt vmcnt(63)
  buffer_load_dwordx4 v44, s[8:11], s32 offen offset:0 lds
  buffer_load_dwordx4 v45, s[8:11], s32 offen offset:1024 lds
  buffer_load_dwordx4 v46, s[8:11], s32 offen offset:2048 lds
  buffer_load_dwordx4 v47, s[8:11], s32 offen offset:3072 lds
  s_add_u32 s32, s32, 128
  s_mov_b32 s12, s42
  s_mov_b32 s13, s43
  s_mov_b32 s14, 0x600000
  s_mov_b32 s15, 0x00020000
  v_lshrrev_b32 v28, 3, v2
  v_and_b32 v29, 7, v2
  v_bfe_u32 v30, v2, 4, 1
  v_lshlrev_b32 v30, 1, v30
  v_xor_b32 v31, v29, v30
  v_lshlrev_b32 v31, 4, v31
  v_mul_u32_u24 v28, 6144, v28
  v_add_u32 v28, v28, v31
  v_xor_b32 v29, 64, v28
  v_lshlrev_b32 v9, 2, v2
  v_and_b32 v9, 12, v9
  v_add_u32 v9, 156416, v9
  v_add_u32 v48, 0, v28
  v_add_u32 v49, 48128, v29
  v_add_u32 v50, 96256, v28
  v_add_u32 v51, 144384, v29
  v_add_u32 v52, 2048, v28
  v_add_u32 v53, 50176, v29
  v_add_u32 v54, 98304, v28
  v_add_u32 v55, 146432, v29
  v_add_u32 v56, 4096, v29
  v_add_u32 v57, 52224, v28
  v_add_u32 v58, 100352, v29
  v_add_u32 v59, 148480, v28
  s_lshl_b32 s36, s18, 7
  s_mov_b32 s30, 0
  s_add_u32 m0, s30, 65536
  s_waitcnt vmcnt(63)
  buffer_load_dwordx4 v48, s[12:15], s36 offen offset:0 lds
  buffer_load_dwordx4 v49, s[12:15], s36 offen offset:1024 lds
  buffer_load_dwordx4 v50, s[12:15], s36 offen offset:2048 lds
  buffer_load_dwordx4 v51, s[12:15], s36 offen offset:3072 lds
  s_add_u32 m0, s30, 69632
  s_waitcnt vmcnt(63)
  buffer_load_dwordx4 v52, s[12:15], s36 offen offset:0 lds
  buffer_load_dwordx4 v53, s[12:15], s36 offen offset:1024 lds
  buffer_load_dwordx4 v54, s[12:15], s36 offen offset:2048 lds
  buffer_load_dwordx4 v55, s[12:15], s36 offen offset:3072 lds
  s_add_u32 m0, s30, 73728
  s_waitcnt vmcnt(63)
  buffer_load_dwordx4 v56, s[12:15], s36 offen offset:0 lds
  buffer_load_dwordx4 v57, s[12:15], s36 offen offset:1024 lds
  buffer_load_dwordx4 v58, s[12:15], s36 offen offset:2048 lds
  buffer_load_dwordx4 v59, s[12:15], s36 offen offset:3072 lds
  s_add_u32 s30, s30, 12288
  s_cmp_eq_u32 s30, 86016
  s_cselect_b32 s30, 0, s30
  s_barrier
  s_mov_b32 s35, .g2_kernel_tab-.g2_kernel_pc+4
  s_mov_b32 s34, -5
  v_mov_b32 v10, 0
  s_mov_b32 m0, 156160
  s_add_u32 s36, s36, 196608
  s_mov_b64 exec, 1
  buffer_load_dword off, s[64:67], s35 lds
  s_mov_b64 exec, -1
  s_add_u32 s35, s35, 4
  s_branch .g2_kernel_p1_o
  .p2align 6
.g2_kernel_p1_l:
  s_waitcnt lgkmcnt(0)
  v_cmp_gt_i32 vcc, s34, v10
  s_cbranch_vccnz .g2_kernel_p1_aw
.g2_kernel_p1_ai:
  s_add_u32 s29, s29, 16384
  s_and_b32 s29, s29, 0xffff
  s_add_u32 m0, s29, 0
  s_waitcnt vmcnt(63)
  buffer_load_dwordx4 v32, s[8:11], s32 offen offset:0 lds
  buffer_load_dwordx4 v33, s[8:11], s32 offen offset:1024 lds
  buffer_load_dwordx4 v34, s[8:11], s32 offen offset:2048 lds
  buffer_load_dwordx4 v35, s[8:11], s32 offen offset:3072 lds
  s_add_u32 m0, s29, 4096
  s_waitcnt vmcnt(63)
  buffer_load_dwordx4 v36, s[8:11], s32 offen offset:0 lds
  buffer_load_dwordx4 v37, s[8:11], s32 offen offset:1024 lds
  buffer_load_dwordx4 v38, s[8:11], s32 offen offset:2048 lds
  buffer_load_dwordx4 v39, s[8:11], s32 offen offset:3072 lds
  s_add_u32 m0, s29, 8192
  s_waitcnt vmcnt(63)
  buffer_load_dwordx4 v40, s[8:11], s32 offen offset:0 lds
  buffer_load_dwordx4 v41, s[8:11], s32 offen offset:1024 lds
  buffer_load_dwordx4 v42, s[8:11], s32 offen offset:2048 lds
  buffer_load_dwordx4 v43, s[8:11], s32 offen offset:3072 lds
  s_add_u32 m0, s29, 12288
  s_waitcnt vmcnt(63)
  buffer_load_dwordx4 v44, s[8:11], s32 offen offset:0 lds
  buffer_load_dwordx4 v45, s[8:11], s32 offen offset:1024 lds
  buffer_load_dwordx4 v46, s[8:11], s32 offen offset:2048 lds
  buffer_load_dwordx4 v47, s[8:11], s32 offen offset:3072 lds
  s_add_u32 s32, s32, 128
  s_add_u32 m0, s30, 65536
  s_waitcnt vmcnt(63)
  buffer_load_dwordx4 v48, s[12:15], s36 offen offset:0 lds
  buffer_load_dwordx4 v49, s[12:15], s36 offen offset:1024 lds
  buffer_load_dwordx4 v50, s[12:15], s36 offen offset:2048 lds
  buffer_load_dwordx4 v51, s[12:15], s36 offen offset:3072 lds
  s_add_u32 m0, s30, 69632
  s_waitcnt vmcnt(63)
  buffer_load_dwordx4 v52, s[12:15], s36 offen offset:0 lds
  buffer_load_dwordx4 v53, s[12:15], s36 offen offset:1024 lds
  buffer_load_dwordx4 v54, s[12:15], s36 offen offset:2048 lds
  buffer_load_dwordx4 v55, s[12:15], s36 offen offset:3072 lds
  s_add_u32 m0, s30, 73728
  s_waitcnt vmcnt(63)
  buffer_load_dwordx4 v56, s[12:15], s36 offen offset:0 lds
  buffer_load_dwordx4 v57, s[12:15], s36 offen offset:1024 lds
  buffer_load_dwordx4 v58, s[12:15], s36 offen offset:2048 lds
  buffer_load_dwordx4 v59, s[12:15], s36 offen offset:3072 lds
  s_add_u32 s30, s30, 12288
  s_cmp_eq_u32 s30, 86016
  s_cselect_b32 s30, 0, s30
  ds_read_b32 v10, v9
  s_mov_b32 m0, 156160
  s_add_u32 s34, s34, 1
  s_mov_b64 exec, 1
  buffer_load_dword off, s[64:67], s35 lds
  s_mov_b64 exec, -1
  s_add_u32 s35, s35, 4
  s_add_u32 s36, s36, 196608
.g2_kernel_p1_o:
  s_waitcnt lgkmcnt(0)
  v_cmp_gt_i32 vcc, s34, v10
  s_cbranch_vccnz .g2_kernel_p1_bw
.g2_kernel_p1_bi:
  s_add_u32 m0, s30, 65536
  s_waitcnt vmcnt(63)
  buffer_load_dwordx4 v48, s[12:15], s36 offen offset:0 lds
  buffer_load_dwordx4 v49, s[12:15], s36 offen offset:1024 lds
  buffer_load_dwordx4 v50, s[12:15], s36 offen offset:2048 lds
  buffer_load_dwordx4 v51, s[12:15], s36 offen offset:3072 lds
  s_add_u32 m0, s30, 69632
  s_waitcnt vmcnt(63)
  buffer_load_dwordx4 v52, s[12:15], s36 offen offset:0 lds
  buffer_load_dwordx4 v53, s[12:15], s36 offen offset:1024 lds
  buffer_load_dwordx4 v54, s[12:15], s36 offen offset:2048 lds
  buffer_load_dwordx4 v55, s[12:15], s36 offen offset:3072 lds
  s_add_u32 m0, s30, 73728
  s_waitcnt vmcnt(63)
  buffer_load_dwordx4 v56, s[12:15], s36 offen offset:0 lds
  buffer_load_dwordx4 v57, s[12:15], s36 offen offset:1024 lds
  buffer_load_dwordx4 v58, s[12:15], s36 offen offset:2048 lds
  buffer_load_dwordx4 v59, s[12:15], s36 offen offset:3072 lds
  s_add_u32 s30, s30, 12288
  s_cmp_eq_u32 s30, 86016
  s_cselect_b32 s30, 0, s30
  ds_read_b32 v10, v9
  s_mov_b32 m0, 156160
  s_add_u32 s34, s34, 1
  s_mov_b64 exec, 1
  buffer_load_dword off, s[64:67], s35 lds
  s_mov_b64 exec, -1
  s_add_u32 s35, s35, 4
  s_add_u32 s36, s36, 196608
  s_cmp_lt_i32 s34, 26
  s_cbranch_scc1 .g2_kernel_p1_l
  s_branch .g2_kernel_v
.g2_kernel_s1:
  s_mov_b32 s8, s40
  s_mov_b32 s9, s41
  s_mov_b32 s10, 0x400000
  s_mov_b32 s11, 0x00020000
  v_lshrrev_b32 v20, 3, v2
  v_and_b32 v21, 7, v2
  v_lshlrev_b32 v21, 4, v21
  v_lshl_add_u32 v21, v20, 11, v21
  s_lshl_b32 s30, s17, 4
  s_add_u32 s30, s30, s18
  s_lshl_b32 s33, s30, 5
  s_lshl_b32 s30, s30, 14
  s_barrier
  s_sleep 30
  buffer_load_dwordx4 v[64:67], v21, s[8:11], s30 offen offset:0
  buffer_load_dwordx4 v[68:71], v21, s[8:11], s30 offen offset:128
  buffer_load_dwordx4 v[72:75], v21, s[8:11], s30 offen offset:256
  buffer_load_dwordx4 v[76:79], v21, s[8:11], s30 offen offset:384
  buffer_load_dwordx4 v[80:83], v21, s[8:11], s30 offen offset:512
  buffer_load_dwordx4 v[84:87], v21, s[8:11], s30 offen offset:640
  buffer_load_dwordx4 v[88:91], v21, s[8:11], s30 offen offset:768
  buffer_load_dwordx4 v[92:95], v21, s[8:11], s30 offen offset:896
  buffer_load_dwordx4 v[96:99], v21, s[8:11], s30 offen offset:1024
  buffer_load_dwordx4 v[100:103], v21, s[8:11], s30 offen offset:1152
  buffer_load_dwordx4 v[104:107], v21, s[8:11], s30 offen offset:1280
  buffer_load_dwordx4 v[108:111], v21, s[8:11], s30 offen offset:1408
  buffer_load_dwordx4 v[112:115], v21, s[8:11], s30 offen offset:1536
  buffer_load_dwordx4 v[116:119], v21, s[8:11], s30 offen offset:1664
  buffer_load_dwordx4 v[120:123], v21, s[8:11], s30 offen offset:1792
  buffer_load_dwordx4 v[124:127], v21, s[8:11], s30 offen offset:1920
  v_mov_b32 v24, 0
  v_mov_b32 v25, 0
  v_mov_b32 v26, 0
  v_mov_b32 v27, 0
  s_waitcnt vmcnt(15)
  v_lshlrev_b32 v22, 16, v64
  v_and_b32 v64, 0xffff0000, v64
  v_add_f32 v24, v24, v22
  v_fmac_f32 v25, v22, v22
  v_add_f32 v26, v26, v64
  v_fmac_f32 v27, v64, v64
  v_lshlrev_b32 v22, 16, v65
  v_and_b32 v65, 0xffff0000, v65
  v_add_f32 v24, v24, v22
  v_fmac_f32 v25, v22, v22
  v_add_f32 v26, v26, v65
  v_fmac_f32 v27, v65, v65
  v_lshlrev_b32 v22, 16, v66
  v_and_b32 v66, 0xffff0000, v66
  v_add_f32 v24, v24, v22
  v_fmac_f32 v25, v22, v22
  v_add_f32 v26, v26, v66
  v_fmac_f32 v27, v66, v66
  v_lshlrev_b32 v22, 16, v67
  v_and_b32 v67, 0xffff0000, v67
  v_add_f32 v24, v24, v22
  v_fmac_f32 v25, v22, v22
  v_add_f32 v26, v26, v67
  v_fmac_f32 v27, v67, v67
  s_waitcnt vmcnt(14)
  v_lshlrev_b32 v22, 16, v68
  v_and_b32 v68, 0xffff0000, v68
  v_add_f32 v24, v24, v22
  v_fmac_f32 v25, v22, v22
  v_add_f32 v26, v26, v68
  v_fmac_f32 v27, v68, v68
  v_lshlrev_b32 v22, 16, v69
  v_and_b32 v69, 0xffff0000, v69
  v_add_f32 v24, v24, v22
  v_fmac_f32 v25, v22, v22
  v_add_f32 v26, v26, v69
  v_fmac_f32 v27, v69, v69
  v_lshlrev_b32 v22, 16, v70
  v_and_b32 v70, 0xffff0000, v70
  v_add_f32 v24, v24, v22
  v_fmac_f32 v25, v22, v22
  v_add_f32 v26, v26, v70
  v_fmac_f32 v27, v70, v70
  v_lshlrev_b32 v22, 16, v71
  v_and_b32 v71, 0xffff0000, v71
  v_add_f32 v24, v24, v22
  v_fmac_f32 v25, v22, v22
  v_add_f32 v26, v26, v71
  v_fmac_f32 v27, v71, v71
  s_waitcnt vmcnt(13)
  v_lshlrev_b32 v22, 16, v72
  v_and_b32 v72, 0xffff0000, v72
  v_add_f32 v24, v24, v22
  v_fmac_f32 v25, v22, v22
  v_add_f32 v26, v26, v72
  v_fmac_f32 v27, v72, v72
  v_lshlrev_b32 v22, 16, v73
  v_and_b32 v73, 0xffff0000, v73
  v_add_f32 v24, v24, v22
  v_fmac_f32 v25, v22, v22
  v_add_f32 v26, v26, v73
  v_fmac_f32 v27, v73, v73
  v_lshlrev_b32 v22, 16, v74
  v_and_b32 v74, 0xffff0000, v74
  v_add_f32 v24, v24, v22
  v_fmac_f32 v25, v22, v22
  v_add_f32 v26, v26, v74
  v_fmac_f32 v27, v74, v74
  v_lshlrev_b32 v22, 16, v75
  v_and_b32 v75, 0xffff0000, v75
  v_add_f32 v24, v24, v22
  v_fmac_f32 v25, v22, v22
  v_add_f32 v26, v26, v75
  v_fmac_f32 v27, v75, v75
  s_waitcnt vmcnt(12)
  v_lshlrev_b32 v22, 16, v76
  v_and_b32 v76, 0xffff0000, v76
  v_add_f32 v24, v24, v22
  v_fmac_f32 v25, v22, v22
  v_add_f32 v26, v26, v76
  v_fmac_f32 v27, v76, v76
  v_lshlrev_b32 v22, 16, v77
  v_and_b32 v77, 0xffff0000, v77
  v_add_f32 v24, v24, v22
  v_fmac_f32 v25, v22, v22
  v_add_f32 v26, v26, v77
  v_fmac_f32 v27, v77, v77
  v_lshlrev_b32 v22, 16, v78
  v_and_b32 v78, 0xffff0000, v78
  v_add_f32 v24, v24, v22
  v_fmac_f32 v25, v22, v22
  v_add_f32 v26, v26, v78
  v_fmac_f32 v27, v78, v78
  v_lshlrev_b32 v22, 16, v79
  v_and_b32 v79, 0xffff0000, v79
  v_add_f32 v24, v24, v22
  v_fmac_f32 v25, v22, v22
  v_add_f32 v26, v26, v79
  v_fmac_f32 v27, v79, v79
  s_waitcnt vmcnt(11)
  v_lshlrev_b32 v22, 16, v80
  v_and_b32 v80, 0xffff0000, v80
  v_add_f32 v24, v24, v22
  v_fmac_f32 v25, v22, v22
  v_add_f32 v26, v26, v80
  v_fmac_f32 v27, v80, v80
  v_lshlrev_b32 v22, 16, v81
  v_and_b32 v81, 0xffff0000, v81
  v_add_f32 v24, v24, v22
  v_fmac_f32 v25, v22, v22
  v_add_f32 v26, v26, v81
  v_fmac_f32 v27, v81, v81
  v_lshlrev_b32 v22, 16, v82
  v_and_b32 v82, 0xffff0000, v82
  v_add_f32 v24, v24, v22
  v_fmac_f32 v25, v22, v22
  v_add_f32 v26, v26, v82
  v_fmac_f32 v27, v82, v82
  v_lshlrev_b32 v22, 16, v83
  v_and_b32 v83, 0xffff0000, v83
  v_add_f32 v24, v24, v22
  v_fmac_f32 v25, v22, v22
  v_add_f32 v26, v26, v83
  v_fmac_f32 v27, v83, v83
  s_waitcnt vmcnt(10)
  v_lshlrev_b32 v22, 16, v84
  v_and_b32 v84, 0xffff0000, v84
  v_add_f32 v24, v24, v22
  v_fmac_f32 v25, v22, v22
  v_add_f32 v26, v26, v84
  v_fmac_f32 v27, v84, v84
  v_lshlrev_b32 v22, 16, v85
  v_and_b32 v85, 0xffff0000, v85
  v_add_f32 v24, v24, v22
  v_fmac_f32 v25, v22, v22
  v_add_f32 v26, v26, v85
  v_fmac_f32 v27, v85, v85
  v_lshlrev_b32 v22, 16, v86
  v_and_b32 v86, 0xffff0000, v86
  v_add_f32 v24, v24, v22
  v_fmac_f32 v25, v22, v22
  v_add_f32 v26, v26, v86
  v_fmac_f32 v27, v86, v86
  v_lshlrev_b32 v22, 16, v87
  v_and_b32 v87, 0xffff0000, v87
  v_add_f32 v24, v24, v22
  v_fmac_f32 v25, v22, v22
  v_add_f32 v26, v26, v87
  v_fmac_f32 v27, v87, v87
  s_waitcnt vmcnt(9)
  v_lshlrev_b32 v22, 16, v88
  v_and_b32 v88, 0xffff0000, v88
  v_add_f32 v24, v24, v22
  v_fmac_f32 v25, v22, v22
  v_add_f32 v26, v26, v88
  v_fmac_f32 v27, v88, v88
  v_lshlrev_b32 v22, 16, v89
  v_and_b32 v89, 0xffff0000, v89
  v_add_f32 v24, v24, v22
  v_fmac_f32 v25, v22, v22
  v_add_f32 v26, v26, v89
  v_fmac_f32 v27, v89, v89
  v_lshlrev_b32 v22, 16, v90
  v_and_b32 v90, 0xffff0000, v90
  v_add_f32 v24, v24, v22
  v_fmac_f32 v25, v22, v22
  v_add_f32 v26, v26, v90
  v_fmac_f32 v27, v90, v90
  v_lshlrev_b32 v22, 16, v91
  v_and_b32 v91, 0xffff0000, v91
  v_add_f32 v24, v24, v22
  v_fmac_f32 v25, v22, v22
  v_add_f32 v26, v26, v91
  v_fmac_f32 v27, v91, v91
  s_waitcnt vmcnt(8)
  v_lshlrev_b32 v22, 16, v92
  v_and_b32 v92, 0xffff0000, v92
  v_add_f32 v24, v24, v22
  v_fmac_f32 v25, v22, v22
  v_add_f32 v26, v26, v92
  v_fmac_f32 v27, v92, v92
  v_lshlrev_b32 v22, 16, v93
  v_and_b32 v93, 0xffff0000, v93
  v_add_f32 v24, v24, v22
  v_fmac_f32 v25, v22, v22
  v_add_f32 v26, v26, v93
  v_fmac_f32 v27, v93, v93
  v_lshlrev_b32 v22, 16, v94
  v_and_b32 v94, 0xffff0000, v94
  v_add_f32 v24, v24, v22
  v_fmac_f32 v25, v22, v22
  v_add_f32 v26, v26, v94
  v_fmac_f32 v27, v94, v94
  v_lshlrev_b32 v22, 16, v95
  v_and_b32 v95, 0xffff0000, v95
  v_add_f32 v24, v24, v22
  v_fmac_f32 v25, v22, v22
  v_add_f32 v26, v26, v95
  v_fmac_f32 v27, v95, v95
  s_waitcnt vmcnt(7)
  v_lshlrev_b32 v22, 16, v96
  v_and_b32 v96, 0xffff0000, v96
  v_add_f32 v24, v24, v22
  v_fmac_f32 v25, v22, v22
  v_add_f32 v26, v26, v96
  v_fmac_f32 v27, v96, v96
  v_lshlrev_b32 v22, 16, v97
  v_and_b32 v97, 0xffff0000, v97
  v_add_f32 v24, v24, v22
  v_fmac_f32 v25, v22, v22
  v_add_f32 v26, v26, v97
  v_fmac_f32 v27, v97, v97
  v_lshlrev_b32 v22, 16, v98
  v_and_b32 v98, 0xffff0000, v98
  v_add_f32 v24, v24, v22
  v_fmac_f32 v25, v22, v22
  v_add_f32 v26, v26, v98
  v_fmac_f32 v27, v98, v98
  v_lshlrev_b32 v22, 16, v99
  v_and_b32 v99, 0xffff0000, v99
  v_add_f32 v24, v24, v22
  v_fmac_f32 v25, v22, v22
  v_add_f32 v26, v26, v99
  v_fmac_f32 v27, v99, v99
  s_waitcnt vmcnt(6)
  v_lshlrev_b32 v22, 16, v100
  v_and_b32 v100, 0xffff0000, v100
  v_add_f32 v24, v24, v22
  v_fmac_f32 v25, v22, v22
  v_add_f32 v26, v26, v100
  v_fmac_f32 v27, v100, v100
  v_lshlrev_b32 v22, 16, v101
  v_and_b32 v101, 0xffff0000, v101
  v_add_f32 v24, v24, v22
  v_fmac_f32 v25, v22, v22
  v_add_f32 v26, v26, v101
  v_fmac_f32 v27, v101, v101
  v_lshlrev_b32 v22, 16, v102
  v_and_b32 v102, 0xffff0000, v102
  v_add_f32 v24, v24, v22
  v_fmac_f32 v25, v22, v22
  v_add_f32 v26, v26, v102
  v_fmac_f32 v27, v102, v102
  v_lshlrev_b32 v22, 16, v103
  v_and_b32 v103, 0xffff0000, v103
  v_add_f32 v24, v24, v22
  v_fmac_f32 v25, v22, v22
  v_add_f32 v26, v26, v103
  v_fmac_f32 v27, v103, v103
  s_waitcnt vmcnt(5)
  v_lshlrev_b32 v22, 16, v104
  v_and_b32 v104, 0xffff0000, v104
  v_add_f32 v24, v24, v22
  v_fmac_f32 v25, v22, v22
  v_add_f32 v26, v26, v104
  v_fmac_f32 v27, v104, v104
  v_lshlrev_b32 v22, 16, v105
  v_and_b32 v105, 0xffff0000, v105
  v_add_f32 v24, v24, v22
  v_fmac_f32 v25, v22, v22
  v_add_f32 v26, v26, v105
  v_fmac_f32 v27, v105, v105
  v_lshlrev_b32 v22, 16, v106
  v_and_b32 v106, 0xffff0000, v106
  v_add_f32 v24, v24, v22
  v_fmac_f32 v25, v22, v22
  v_add_f32 v26, v26, v106
  v_fmac_f32 v27, v106, v106
  v_lshlrev_b32 v22, 16, v107
  v_and_b32 v107, 0xffff0000, v107
  v_add_f32 v24, v24, v22
  v_fmac_f32 v25, v22, v22
  v_add_f32 v26, v26, v107
  v_fmac_f32 v27, v107, v107
  s_waitcnt vmcnt(4)
  v_lshlrev_b32 v22, 16, v108
  v_and_b32 v108, 0xffff0000, v108
  v_add_f32 v24, v24, v22
  v_fmac_f32 v25, v22, v22
  v_add_f32 v26, v26, v108
  v_fmac_f32 v27, v108, v108
  v_lshlrev_b32 v22, 16, v109
  v_and_b32 v109, 0xffff0000, v109
  v_add_f32 v24, v24, v22
  v_fmac_f32 v25, v22, v22
  v_add_f32 v26, v26, v109
  v_fmac_f32 v27, v109, v109
  v_lshlrev_b32 v22, 16, v110
  v_and_b32 v110, 0xffff0000, v110
  v_add_f32 v24, v24, v22
  v_fmac_f32 v25, v22, v22
  v_add_f32 v26, v26, v110
  v_fmac_f32 v27, v110, v110
  v_lshlrev_b32 v22, 16, v111
  v_and_b32 v111, 0xffff0000, v111
  v_add_f32 v24, v24, v22
  v_fmac_f32 v25, v22, v22
  v_add_f32 v26, v26, v111
  v_fmac_f32 v27, v111, v111
  s_waitcnt vmcnt(3)
  v_lshlrev_b32 v22, 16, v112
  v_and_b32 v112, 0xffff0000, v112
  v_add_f32 v24, v24, v22
  v_fmac_f32 v25, v22, v22
  v_add_f32 v26, v26, v112
  v_fmac_f32 v27, v112, v112
  v_lshlrev_b32 v22, 16, v113
  v_and_b32 v113, 0xffff0000, v113
  v_add_f32 v24, v24, v22
  v_fmac_f32 v25, v22, v22
  v_add_f32 v26, v26, v113
  v_fmac_f32 v27, v113, v113
  v_lshlrev_b32 v22, 16, v114
  v_and_b32 v114, 0xffff0000, v114
  v_add_f32 v24, v24, v22
  v_fmac_f32 v25, v22, v22
  v_add_f32 v26, v26, v114
  v_fmac_f32 v27, v114, v114
  v_lshlrev_b32 v22, 16, v115
  v_and_b32 v115, 0xffff0000, v115
  v_add_f32 v24, v24, v22
  v_fmac_f32 v25, v22, v22
  v_add_f32 v26, v26, v115
  v_fmac_f32 v27, v115, v115
  s_waitcnt vmcnt(2)
  v_lshlrev_b32 v22, 16, v116
  v_and_b32 v116, 0xffff0000, v116
  v_add_f32 v24, v24, v22
  v_fmac_f32 v25, v22, v22
  v_add_f32 v26, v26, v116
  v_fmac_f32 v27, v116, v116
  v_lshlrev_b32 v22, 16, v117
  v_and_b32 v117, 0xffff0000, v117
  v_add_f32 v24, v24, v22
  v_fmac_f32 v25, v22, v22
  v_add_f32 v26, v26, v117
  v_fmac_f32 v27, v117, v117
  v_lshlrev_b32 v22, 16, v118
  v_and_b32 v118, 0xffff0000, v118
  v_add_f32 v24, v24, v22
  v_fmac_f32 v25, v22, v22
  v_add_f32 v26, v26, v118
  v_fmac_f32 v27, v118, v118
  v_lshlrev_b32 v22, 16, v119
  v_and_b32 v119, 0xffff0000, v119
  v_add_f32 v24, v24, v22
  v_fmac_f32 v25, v22, v22
  v_add_f32 v26, v26, v119
  v_fmac_f32 v27, v119, v119
  s_waitcnt vmcnt(1)
  v_lshlrev_b32 v22, 16, v120
  v_and_b32 v120, 0xffff0000, v120
  v_add_f32 v24, v24, v22
  v_fmac_f32 v25, v22, v22
  v_add_f32 v26, v26, v120
  v_fmac_f32 v27, v120, v120
  v_lshlrev_b32 v22, 16, v121
  v_and_b32 v121, 0xffff0000, v121
  v_add_f32 v24, v24, v22
  v_fmac_f32 v25, v22, v22
  v_add_f32 v26, v26, v121
  v_fmac_f32 v27, v121, v121
  v_lshlrev_b32 v22, 16, v122
  v_and_b32 v122, 0xffff0000, v122
  v_add_f32 v24, v24, v22
  v_fmac_f32 v25, v22, v22
  v_add_f32 v26, v26, v122
  v_fmac_f32 v27, v122, v122
  v_lshlrev_b32 v22, 16, v123
  v_and_b32 v123, 0xffff0000, v123
  v_add_f32 v24, v24, v22
  v_fmac_f32 v25, v22, v22
  v_add_f32 v26, v26, v123
  v_fmac_f32 v27, v123, v123
  s_waitcnt vmcnt(0)
  v_lshlrev_b32 v22, 16, v124
  v_and_b32 v124, 0xffff0000, v124
  v_add_f32 v24, v24, v22
  v_fmac_f32 v25, v22, v22
  v_add_f32 v26, v26, v124
  v_fmac_f32 v27, v124, v124
  v_lshlrev_b32 v22, 16, v125
  v_and_b32 v125, 0xffff0000, v125
  v_add_f32 v24, v24, v22
  v_fmac_f32 v25, v22, v22
  v_add_f32 v26, v26, v125
  v_fmac_f32 v27, v125, v125
  v_lshlrev_b32 v22, 16, v126
  v_and_b32 v126, 0xffff0000, v126
  v_add_f32 v24, v24, v22
  v_fmac_f32 v25, v22, v22
  v_add_f32 v26, v26, v126
  v_fmac_f32 v27, v126, v126
  v_lshlrev_b32 v22, 16, v127
  v_and_b32 v127, 0xffff0000, v127
  v_add_f32 v24, v24, v22
  v_fmac_f32 v25, v22, v22
  v_add_f32 v26, v26, v127
  v_fmac_f32 v27, v127, v127
  v_add_f32 v24, v24, v26
  v_add_f32 v25, v25, v27
  s_nop 0
  v_add_f32 v24, v24, v24 quad_perm:[1,0,3,2] row_mask:0xf bank_mask:0xf
  v_add_f32 v25, v25, v25 quad_perm:[1,0,3,2] row_mask:0xf bank_mask:0xf
  s_nop 0
  v_add_f32 v24, v24, v24 quad_perm:[2,3,0,1] row_mask:0xf bank_mask:0xf
  v_add_f32 v25, v25, v25 quad_perm:[2,3,0,1] row_mask:0xf bank_mask:0xf
  s_nop 0
  v_add_f32 v24, v24, v24 row_half_mirror row_mask:0xf bank_mask:0xf
  v_add_f32 v25, v25, v25 row_half_mirror row_mask:0xf bank_mask:0xf
  v_mov_b32 v26, 0.0009765625
  v_mul_f32 v24, v26, v24
  v_mul_f32 v27, v24, v24
  v_fma_f32 v25, v25, v26, -v27
  v_max_f32 v25, 0, v25
  v_add_f32 v25, 1e-05, v25
  v_rsq_f32 v25, v25
  v_lshlrev_b32 v20, 2, v20
  v_mul_f32 v24, v24, v25
  v_sub_f32 v24, 0, v24
  s_add_u32 s33, s33, 0x3070000
  s_add_u32 s34, s33, 0x2000
  s_mov_b32 exec_lo, 0x01010101
  s_mov_b32 exec_hi, 0x01010101
  buffer_store_dword v25, v20, s[4:7], s33 offen sc1
  buffer_store_dword v24, v20, s[4:7], s34 offen sc1
  s_mov_b64 exec, -1
  s_mov_b32 s12, s58
  s_mov_b32 s13, s59
  s_mov_b32 s14, 0x100
  s_mov_b32 s15, 0x00020000
  s_mov_b32 s38, 0
  s_mov_b64 exec, 1
.g2_kernel_gt8:
  buffer_load_dword v6, v4, s[12:15], 0 offen sc1
  s_add_u32 s38, s38, 1
  s_waitcnt vmcnt(0)
  v_cmp_eq_u32 vcc, 0x60, v6
  s_cbranch_vccnz .g2_kernel_gt8d
  s_sleep 8
  s_cmp_lt_u32 s38, 131072
  s_cbranch_scc1 .g2_kernel_gt8
.g2_kernel_gt8d:
  s_mov_b64 exec, -1
  v_mov_b32 v6, s70
  s_mov_b64 exec, 1
  buffer_store_dword v6, v4, s[4:7], s19 offen offset:12 sc1
  s_mov_b64 exec, -1
  v_mov_b32 v6, 155648
  s_mov_b32 s38, 0
.g2_kernel_wg9:
  ds_read_b32 v7, v6 offset:512
  s_add_u32 s38, s38, 1
  s_waitcnt lgkmcnt(0)
  v_cmp_gt_u32 vcc, 22, v7
  s_cbranch_vccz .g2_kernel_wg9d
  s_sleep 4
  s_cmp_lt_u32 s38, 524288
  s_cbranch_scc1 .g2_kernel_wg9
.g2_kernel_wg9d:
  s_and_b32 s31, s19, 0xffffe000
  s_add_u32 s31, s31, 12
  v_and_b32 v6, 15, v2
  v_lshlrev_b32 v6, 9, v6
  v_lshrrev_b32 v7, 4, v2
  v_lshl_add_u32 v6, v7, 7, v6
  v_lshlrev_b32 v7, 2, v2
  v_add_u32 v7, 157952, v7
  s_mov_b32 m0, 157952
  s_mov_b32 s38, 0
  s_bfm_b64 exec, 16, 0
.g2_kernel_pa10:
  buffer_load_dword v6, s[4:7], s31 offen sc1 lds
  s_add_u32 s38, s38, 1
  s_waitcnt vmcnt(0)
  ds_read_b32 v8, v7
  s_waitcnt lgkmcnt(0)
  v_cmp_ge_u32 vcc, s62, v8
  s_cbranch_vccz .g2_kernel_pa10d
  s_mov_b64 exec, vcc
  s_sleep 16
  s_cmp_lt_u32 s38, 131072
  s_cbranch_scc1 .g2_kernel_pa10
.g2_kernel_pa10d:
  s_mov_b64 exec, -1
  s_lshl_b32 s33, s17, 9
  s_add_u32 s33, s33, 0x3070000
  s_add_u32 s34, s33, 0x2000
  s_mov_b32 exec_hi, 0
  s_mov_b32 m0, 158464
  s_nop 0
  buffer_load_dwordx4 v3, s[4:7], s33 offen sc1 lds
  s_mov_b32 m0, 158976
  s_nop 0
  buffer_load_dwordx4 v3, s[4:7], s34 offen sc1 lds
  s_mov_b64 exec, -1
  v_mov_b32 v20, 1.0
  v_mov_b32 v21, 1.0
  v_mov_b32 v22, 0
  v_mov_b32 v23, 0
  v_lshlrev_b32 v24, 3, v2
  v_add_u32 v24, 155648, v24
  v_mov_b32 v6, 155648
  s_mov_b32 s38, 0
.g2_kernel_wg11:
  ds_read_b32 v7, v6 offset:512
  s_add_u32 s38, s38, 1
  s_waitcnt lgkmcnt(0)
  v_cmp_gt_u32 vcc, 32, v7
  s_cbranch_vccz .g2_kernel_wg11d
  s_sleep 2
  s_cmp_lt_u32 s38, 524288
  s_cbranch_scc1 .g2_kernel_wg11
.g2_kernel_wg11d:
  ds_write_b64 v24, v[20:21] offset:3840
  ds_write_b64 v24, v[22:23] offset:4352
  v_lshlrev_b32 v24, 2, v2
  v_add_u32 v24, 155648, v24
  ds_write_b32 v24, v4 offset:2304
  s_waitcnt vmcnt(0)
  v_mov_b32 v6, s71
  s_mov_b64 exec, 1
  ds_add_u32 v6, v5 offset:0
  s_mov_b64 exec, -1
  s_branch .g2_kernel_v
.g2_kernel_s2:
  s_mov_b32 s8, s42
  s_mov_b32 s9, s43
  s_mov_b32 s10, 0x600000
  s_mov_b32 s11, 0x00020000
  v_lshrrev_b32 v20, 3, v2
  v_and_b32 v21, 7, v2
  v_mul_u32_u24 v20, 6144, v20
  v_lshl_add_u32 v20, v21, 4, v20
  s_mul_i32 s30, s17, 393216
  s_lshl_b32 s31, s18, 7
  s_add_u32 s30, s30, s31
  s_add_u32 s31, s30, 4096
  s_barrier
  s_sleep 30
  buffer_load_dwordx4 v[64:67], v20, s[8:11], s30 offen
  buffer_load_dwordx4 v[68:71], v20, s[8:11], s30 offen offset:2048
  buffer_load_dwordx4 v[72:75], v20, s[8:11], s31 offen
  s_add_u32 s30, s30, 49152
  s_add_u32 s31, s31, 49152
  buffer_load_dwordx4 v[76:79], v20, s[8:11], s30 offen
  buffer_load_dwordx4 v[80:83], v20, s[8:11], s30 offen offset:2048
  buffer_load_dwordx4 v[84:87], v20, s[8:11], s31 offen
  s_add_u32 s30, s30, 49152
  s_add_u32 s31, s31, 49152
  buffer_load_dwordx4 v[88:91], v20, s[8:11], s30 offen
  buffer_load_dwordx4 v[92:95], v20, s[8:11], s30 offen offset:2048
  buffer_load_dwordx4 v[96:99], v20, s[8:11], s31 offen
  s_add_u32 s30, s30, 49152
  s_add_u32 s31, s31, 49152
  buffer_load_dwordx4 v[100:103], v20, s[8:11], s30 offen
  buffer_load_dwordx4 v[104:107], v20, s[8:11], s30 offen offset:2048
  buffer_load_dwordx4 v[108:111], v20, s[8:11], s31 offen
  s_add_u32 s30, s30, 49152
  s_add_u32 s31, s31, 49152
  buffer_load_dwordx4 v[112:115], v20, s[8:11], s30 offen
  buffer_load_dwordx4 v[116:119], v20, s[8:11], s30 offen offset:2048
  buffer_load_dwordx4 v[120:123], v20, s[8:11], s31 offen
  s_add_u32 s30, s30, 49152
  s_add_u32 s31, s31, 49152
  buffer_load_dwordx4 v[124:127], v20, s[8:11], s30 offen
  buffer_load_dwordx4 v[128:131], v20, s[8:11], s30 offen offset:2048
  buffer_load_dwordx4 v[132:135], v20, s[8:11], s31 offen
  s_add_u32 s30, s30, 49152
  s_add_u32 s31, s31, 49152
  buffer_load_dwordx4 v[136:139], v20, s[8:11], s30 offen
  buffer_load_dwordx4 v[140:143], v20, s[8:11], s30 offen offset:2048
  buffer_load_dwordx4 v[144:147], v20, s[8:11], s31 offen
  s_add_u32 s30, s30, 49152
  s_add_u32 s31, s31, 49152
  buffer_load_dwordx4 v[148:151], v20, s[8:11], s30 offen
  buffer_load_dwordx4 v[152:155], v20, s[8:11], s30 offen offset:2048
  buffer_load_dwordx4 v[156:159], v20, s[8:11], s31 offen
  s_add_u32 s30, s30, 49152
  s_add_u32 s31, s31, 49152
  v_lshlrev_b32 v21, 5, v21
  v_lshrrev_b32 v22, 5, v2
  v_lshl_add_u32 v21, v22, 4, v21
  v_bfe_u32 v22, v2, 4, 1
  v_lshl_add_u32 v21, v22, 3, v21
  s_lshl_b32 s30, s18, 4
  s_add_u32 s30, s30, s17
  s_mul_i32 s30, s30, 768
  s_add_u32 s30, s30, 0x3080000
  s_waitcnt vmcnt(23)
  v_lshlrev_b32 v160, 16, v64
  v_and_b32 v161, 0xffff0000, v64
  v_lshlrev_b32 v162, 16, v65
  v_and_b32 v163, 0xffff0000, v65
  v_lshlrev_b32 v164, 16, v66
  v_and_b32 v165, 0xffff0000, v66
  v_lshlrev_b32 v166, 16, v67
  v_and_b32 v167, 0xffff0000, v67
  s_waitcnt vmcnt(22)
  v_lshlrev_b32 v168, 16, v68
  v_and_b32 v169, 0xffff0000, v68
  v_lshlrev_b32 v170, 16, v69
  v_and_b32 v171, 0xffff0000, v69
  v_lshlrev_b32 v172, 16, v70
  v_and_b32 v173, 0xffff0000, v70
  v_lshlrev_b32 v174, 16, v71
  v_and_b32 v175, 0xffff0000, v71
  s_waitcnt vmcnt(21)
  v_lshlrev_b32 v176, 16, v72
  v_and_b32 v177, 0xffff0000, v72
  v_lshlrev_b32 v178, 16, v73
  v_and_b32 v179, 0xffff0000, v73
  v_lshlrev_b32 v180, 16, v74
  v_and_b32 v181, 0xffff0000, v74
  v_lshlrev_b32 v182, 16, v75
  v_and_b32 v183, 0xffff0000, v75
  s_waitcnt vmcnt(20)
  v_lshlrev_b32 v184, 16, v76
  v_and_b32 v185, 0xffff0000, v76
  v_lshlrev_b32 v186, 16, v77
  v_and_b32 v187, 0xffff0000, v77
  v_lshlrev_b32 v188, 16, v78
  v_and_b32 v189, 0xffff0000, v78
  v_lshlrev_b32 v190, 16, v79
  v_and_b32 v191, 0xffff0000, v79
  v_add_f32 v160, v160, v184
  v_add_f32 v161, v161, v185
  v_add_f32 v162, v162, v186
  v_add_f32 v163, v163, v187
  v_add_f32 v164, v164, v188
  v_add_f32 v165, v165, v189
  v_add_f32 v166, v166, v190
  v_add_f32 v167, v167, v191
  s_waitcnt vmcnt(19)
  v_lshlrev_b32 v184, 16, v80
  v_and_b32 v185, 0xffff0000, v80
  v_lshlrev_b32 v186, 16, v81
  v_and_b32 v187, 0xffff0000, v81
  v_lshlrev_b32 v188, 16, v82
  v_and_b32 v189, 0xffff0000, v82
  v_lshlrev_b32 v190, 16, v83
  v_and_b32 v191, 0xffff0000, v83
  v_add_f32 v168, v168, v184
  v_add_f32 v169, v169, v185
  v_add_f32 v170, v170, v186
  v_add_f32 v171, v171, v187
  v_add_f32 v172, v172, v188
  v_add_f32 v173, v173, v189
  v_add_f32 v174, v174, v190
  v_add_f32 v175, v175, v191
  s_waitcnt vmcnt(18)
  v_lshlrev_b32 v184, 16, v84
  v_and_b32 v185, 0xffff0000, v84
  v_lshlrev_b32 v186, 16, v85
  v_and_b32 v187, 0xffff0000, v85
  v_lshlrev_b32 v188, 16, v86
  v_and_b32 v189, 0xffff0000, v86
  v_lshlrev_b32 v190, 16, v87
  v_and_b32 v191, 0xffff0000, v87
  v_add_f32 v176, v176, v184
  v_add_f32 v177, v177, v185
  v_add_f32 v178, v178, v186
  v_add_f32 v179, v179, v187
  v_add_f32 v180, v180, v188
  v_add_f32 v181, v181, v189
  v_add_f32 v182, v182, v190
  v_add_f32 v183, v183, v191
  s_waitcnt vmcnt(17)
  v_lshlrev_b32 v184, 16, v88
  v_and_b32 v185, 0xffff0000, v88
  v_lshlrev_b32 v186, 16, v89
  v_and_b32 v187, 0xffff0000, v89
  v_lshlrev_b32 v188, 16, v90
  v_and_b32 v189, 0xffff0000, v90
  v_lshlrev_b32 v190, 16, v91
  v_and_b32 v191, 0xffff0000, v91
  v_add_f32 v160, v160, v184
  v_add_f32 v161, v161, v185
  v_add_f32 v162, v162, v186
  v_add_f32 v163, v163, v187
  v_add_f32 v164, v164, v188
  v_add_f32 v165, v165, v189
  v_add_f32 v166, v166, v190
  v_add_f32 v167, v167, v191
  s_waitcnt vmcnt(16)
  v_lshlrev_b32 v184, 16, v92
  v_and_b32 v185, 0xffff0000, v92
  v_lshlrev_b32 v186, 16, v93
  v_and_b32 v187, 0xffff0000, v93
  v_lshlrev_b32 v188, 16, v94
  v_and_b32 v189, 0xffff0000, v94
  v_lshlrev_b32 v190, 16, v95
  v_and_b32 v191, 0xffff0000, v95
  v_add_f32 v168, v168, v184
  v_add_f32 v169, v169, v185
  v_add_f32 v170, v170, v186
  v_add_f32 v171, v171, v187
  v_add_f32 v172, v172, v188
  v_add_f32 v173, v173, v189
  v_add_f32 v174, v174, v190
  v_add_f32 v175, v175, v191
  s_waitcnt vmcnt(15)
  v_lshlrev_b32 v184, 16, v96
  v_and_b32 v185, 0xffff0000, v96
  v_lshlrev_b32 v186, 16, v97
  v_and_b32 v187, 0xffff0000, v97
  v_lshlrev_b32 v188, 16, v98
  v_and_b32 v189, 0xffff0000, v98
  v_lshlrev_b32 v190, 16, v99
  v_and_b32 v191, 0xffff0000, v99
  v_add_f32 v176, v176, v184
  v_add_f32 v177, v177, v185
  v_add_f32 v178, v178, v186
  v_add_f32 v179, v179, v187
  v_add_f32 v180, v180, v188
  v_add_f32 v181, v181, v189
  v_add_f32 v182, v182, v190
  v_add_f32 v183, v183, v191
  s_waitcnt vmcnt(14)
  v_lshlrev_b32 v184, 16, v100
  v_and_b32 v185, 0xffff0000, v100
  v_lshlrev_b32 v186, 16, v101
  v_and_b32 v187, 0xffff0000, v101
  v_lshlrev_b32 v188, 16, v102
  v_and_b32 v189, 0xffff0000, v102
  v_lshlrev_b32 v190, 16, v103
  v_and_b32 v191, 0xffff0000, v103
  v_add_f32 v160, v160, v184
  v_add_f32 v161, v161, v185
  v_add_f32 v162, v162, v186
  v_add_f32 v163, v163, v187
  v_add_f32 v164, v164, v188
  v_add_f32 v165, v165, v189
  v_add_f32 v166, v166, v190
  v_add_f32 v167, v167, v191
  s_waitcnt vmcnt(13)
  v_lshlrev_b32 v184, 16, v104
  v_and_b32 v185, 0xffff0000, v104
  v_lshlrev_b32 v186, 16, v105
  v_and_b32 v187, 0xffff0000, v105
  v_lshlrev_b32 v188, 16, v106
  v_and_b32 v189, 0xffff0000, v106
  v_lshlrev_b32 v190, 16, v107
  v_and_b32 v191, 0xffff0000, v107
  v_add_f32 v168, v168, v184
  v_add_f32 v169, v169, v185
  v_add_f32 v170, v170, v186
  v_add_f32 v171, v171, v187
  v_add_f32 v172, v172, v188
  v_add_f32 v173, v173, v189
  v_add_f32 v174, v174, v190
  v_add_f32 v175, v175, v191
  s_waitcnt vmcnt(12)
  v_lshlrev_b32 v184, 16, v108
  v_and_b32 v185, 0xffff0000, v108
  v_lshlrev_b32 v186, 16, v109
  v_and_b32 v187, 0xffff0000, v109
  v_lshlrev_b32 v188, 16, v110
  v_and_b32 v189, 0xffff0000, v110
  v_lshlrev_b32 v190, 16, v111
  v_and_b32 v191, 0xffff0000, v111
  v_add_f32 v176, v176, v184
  v_add_f32 v177, v177, v185
  v_add_f32 v178, v178, v186
  v_add_f32 v179, v179, v187
  v_add_f32 v180, v180, v188
  v_add_f32 v181, v181, v189
  v_add_f32 v182, v182, v190
  v_add_f32 v183, v183, v191
  s_waitcnt vmcnt(11)
  v_lshlrev_b32 v184, 16, v112
  v_and_b32 v185, 0xffff0000, v112
  v_lshlrev_b32 v186, 16, v113
  v_and_b32 v187, 0xffff0000, v113
  v_lshlrev_b32 v188, 16, v114
  v_and_b32 v189, 0xffff0000, v114
  v_lshlrev_b32 v190, 16, v115
  v_and_b32 v191, 0xffff0000, v115
  v_add_f32 v160, v160, v184
  v_add_f32 v161, v161, v185
  v_add_f32 v162, v162, v186
  v_add_f32 v163, v163, v187
  v_add_f32 v164, v164, v188
  v_add_f32 v165, v165, v189
  v_add_f32 v166, v166, v190
  v_add_f32 v167, v167, v191
  s_waitcnt vmcnt(10)
  v_lshlrev_b32 v184, 16, v116
  v_and_b32 v185, 0xffff0000, v116
  v_lshlrev_b32 v186, 16, v117
  v_and_b32 v187, 0xffff0000, v117
  v_lshlrev_b32 v188, 16, v118
  v_and_b32 v189, 0xffff0000, v118
  v_lshlrev_b32 v190, 16, v119
  v_and_b32 v191, 0xffff0000, v119
  v_add_f32 v168, v168, v184
  v_add_f32 v169, v169, v185
  v_add_f32 v170, v170, v186
  v_add_f32 v171, v171, v187
  v_add_f32 v172, v172, v188
  v_add_f32 v173, v173, v189
  v_add_f32 v174, v174, v190
  v_add_f32 v175, v175, v191
  s_waitcnt vmcnt(9)
  v_lshlrev_b32 v184, 16, v120
  v_and_b32 v185, 0xffff0000, v120
  v_lshlrev_b32 v186, 16, v121
  v_and_b32 v187, 0xffff0000, v121
  v_lshlrev_b32 v188, 16, v122
  v_and_b32 v189, 0xffff0000, v122
  v_lshlrev_b32 v190, 16, v123
  v_and_b32 v191, 0xffff0000, v123
  v_add_f32 v176, v176, v184
  v_add_f32 v177, v177, v185
  v_add_f32 v178, v178, v186
  v_add_f32 v179, v179, v187
  v_add_f32 v180, v180, v188
  v_add_f32 v181, v181, v189
  v_add_f32 v182, v182, v190
  v_add_f32 v183, v183, v191
  s_waitcnt vmcnt(8)
  v_lshlrev_b32 v184, 16, v124
  v_and_b32 v185, 0xffff0000, v124
  v_lshlrev_b32 v186, 16, v125
  v_and_b32 v187, 0xffff0000, v125
  v_lshlrev_b32 v188, 16, v126
  v_and_b32 v189, 0xffff0000, v126
  v_lshlrev_b32 v190, 16, v127
  v_and_b32 v191, 0xffff0000, v127
  v_add_f32 v160, v160, v184
  v_add_f32 v161, v161, v185
  v_add_f32 v162, v162, v186
  v_add_f32 v163, v163, v187
  v_add_f32 v164, v164, v188
  v_add_f32 v165, v165, v189
  v_add_f32 v166, v166, v190
  v_add_f32 v167, v167, v191
  s_waitcnt vmcnt(7)
  v_lshlrev_b32 v184, 16, v128
  v_and_b32 v185, 0xffff0000, v128
  v_lshlrev_b32 v186, 16, v129
  v_and_b32 v187, 0xffff0000, v129
  v_lshlrev_b32 v188, 16, v130
  v_and_b32 v189, 0xffff0000, v130
  v_lshlrev_b32 v190, 16, v131
  v_and_b32 v191, 0xffff0000, v131
  v_add_f32 v168, v168, v184
  v_add_f32 v169, v169, v185
  v_add_f32 v170, v170, v186
  v_add_f32 v171, v171, v187
  v_add_f32 v172, v172, v188
  v_add_f32 v173, v173, v189
  v_add_f32 v174, v174, v190
  v_add_f32 v175, v175, v191
  s_waitcnt vmcnt(6)
  v_lshlrev_b32 v184, 16, v132
  v_and_b32 v185, 0xffff0000, v132
  v_lshlrev_b32 v186, 16, v133
  v_and_b32 v187, 0xffff0000, v133
  v_lshlrev_b32 v188, 16, v134
  v_and_b32 v189, 0xffff0000, v134
  v_lshlrev_b32 v190, 16, v135
  v_and_b32 v191, 0xffff0000, v135
  v_add_f32 v176, v176, v184
  v_add_f32 v177, v177, v185
  v_add_f32 v178, v178, v186
  v_add_f32 v179, v179, v187
  v_add_f32 v180, v180, v188
  v_add_f32 v181, v181, v189
  v_add_f32 v182, v182, v190
  v_add_f32 v183, v183, v191
  s_waitcnt vmcnt(5)
  v_lshlrev_b32 v184, 16, v136
  v_and_b32 v185, 0xffff0000, v136
  v_lshlrev_b32 v186, 16, v137
  v_and_b32 v187, 0xffff0000, v137
  v_lshlrev_b32 v188, 16, v138
  v_and_b32 v189, 0xffff0000, v138
  v_lshlrev_b32 v190, 16, v139
  v_and_b32 v191, 0xffff0000, v139
  v_add_f32 v160, v160, v184
  v_add_f32 v161, v161, v185
  v_add_f32 v162, v162, v186
  v_add_f32 v163, v163, v187
  v_add_f32 v164, v164, v188
  v_add_f32 v165, v165, v189
  v_add_f32 v166, v166, v190
  v_add_f32 v167, v167, v191
  s_waitcnt vmcnt(4)
  v_lshlrev_b32 v184, 16, v140
  v_and_b32 v185, 0xffff0000, v140
  v_lshlrev_b32 v186, 16, v141
  v_and_b32 v187, 0xffff0000, v141
  v_lshlrev_b32 v188, 16, v142
  v_and_b32 v189, 0xffff0000, v142
  v_lshlrev_b32 v190, 16, v143
  v_and_b32 v191, 0xffff0000, v143
  v_add_f32 v168, v168, v184
  v_add_f32 v169, v169, v185
  v_add_f32 v170, v170, v186
  v_add_f32 v171, v171, v187
  v_add_f32 v172, v172, v188
  v_add_f32 v173, v173, v189
  v_add_f32 v174, v174, v190
  v_add_f32 v175, v175, v191
  s_waitcnt vmcnt(3)
  v_lshlrev_b32 v184, 16, v144
  v_and_b32 v185, 0xffff0000, v144
  v_lshlrev_b32 v186, 16, v145
  v_and_b32 v187, 0xffff0000, v145
  v_lshlrev_b32 v188, 16, v146
  v_and_b32 v189, 0xffff0000, v146
  v_lshlrev_b32 v190, 16, v147
  v_and_b32 v191, 0xffff0000, v147
  v_add_f32 v176, v176, v184
  v_add_f32 v177, v177, v185
  v_add_f32 v178, v178, v186
  v_add_f32 v179, v179, v187
  v_add_f32 v180, v180, v188
  v_add_f32 v181, v181, v189
  v_add_f32 v182, v182, v190
  v_add_f32 v183, v183, v191
  s_waitcnt vmcnt(2)
  v_lshlrev_b32 v184, 16, v148
  v_and_b32 v185, 0xffff0000, v148
  v_lshlrev_b32 v186, 16, v149
  v_and_b32 v187, 0xffff0000, v149
  v_lshlrev_b32 v188, 16, v150
  v_and_b32 v189, 0xffff0000, v150
  v_lshlrev_b32 v190, 16, v151
  v_and_b32 v191, 0xffff0000, v151
  v_add_f32 v160, v160, v184
  v_add_f32 v161, v161, v185
  v_add_f32 v162, v162, v186
  v_add_f32 v163, v163, v187
  v_add_f32 v164, v164, v188
  v_add_f32 v165, v165, v189
  v_add_f32 v166, v166, v190
  v_add_f32 v167, v167, v191
  s_waitcnt vmcnt(1)
  v_lshlrev_b32 v184, 16, v152
  v_and_b32 v185, 0xffff0000, v152
  v_lshlrev_b32 v186, 16, v153
  v_and_b32 v187, 0xffff0000, v153
  v_lshlrev_b32 v188, 16, v154
  v_and_b32 v189, 0xffff0000, v154
  v_lshlrev_b32 v190, 16, v155
  v_and_b32 v191, 0xffff0000, v155
  v_add_f32 v168, v168, v184
  v_add_f32 v169, v169, v185
  v_add_f32 v170, v170, v186
  v_add_f32 v171, v171, v187
  v_add_f32 v172, v172, v188
  v_add_f32 v173, v173, v189
  v_add_f32 v174, v174, v190
  v_add_f32 v175, v175, v191
  s_waitcnt vmcnt(0)
  v_lshlrev_b32 v184, 16, v156
  v_and_b32 v185, 0xffff0000, v156
  v_lshlrev_b32 v186, 16, v157
  v_and_b32 v187, 0xffff0000, v157
  v_lshlrev_b32 v188, 16, v158
  v_and_b32 v189, 0xffff0000, v158
  v_lshlrev_b32 v190, 16, v159
  v_and_b32 v191, 0xffff0000, v159
  v_add_f32 v176, v176, v184
  v_add_f32 v177, v177, v185
  v_add_f32 v178, v178, v186
  v_add_f32 v179, v179, v187
  v_add_f32 v180, v180, v188
  v_add_f32 v181, v181, v189
  v_add_f32 v182, v182, v190
  v_add_f32 v183, v183, v191
  v_permlane32_swap_b32 v160, v164
  v_permlane32_swap_b32 v161, v165
  v_permlane32_swap_b32 v162, v166
  v_permlane32_swap_b32 v163, v167
  v_add_f32 v160, v160, v164
  v_add_f32 v161, v161, v165
  v_add_f32 v162, v162, v166
  v_add_f32 v163, v163, v167
  s_nop 0
  v_permlane16_swap_b32 v160, v162
  v_permlane16_swap_b32 v161, v163
  v_add_f32 v160, v160, v162
  v_add_f32 v161, v161, v163
  s_nop 0
  v_add_f32 v160, v160, v160 row_ror:8 row_mask:0xf bank_mask:0xf
  v_add_f32 v161, v161, v161 row_ror:8 row_mask:0xf bank_mask:0xf
  v_permlane32_swap_b32 v168, v172
  v_permlane32_swap_b32 v169, v173
  v_permlane32_swap_b32 v170, v174
  v_permlane32_swap_b32 v171, v175
  v_add_f32 v168, v168, v172
  v_add_f32 v169, v169, v173
  v_add_f32 v170, v170, v174
  v_add_f32 v171, v171, v175
  s_nop 0
  v_permlane16_swap_b32 v168, v170
  v_permlane16_swap_b32 v169, v171
  v_add_f32 v168, v168, v170
  v_add_f32 v169, v169, v171
  s_nop 0
  v_add_f32 v168, v168, v168 row_ror:8 row_mask:0xf bank_mask:0xf
  v_add_f32 v169, v169, v169 row_ror:8 row_mask:0xf bank_mask:0xf
  v_permlane32_swap_b32 v176, v180
  v_permlane32_swap_b32 v177, v181
  v_permlane32_swap_b32 v178, v182
  v_permlane32_swap_b32 v179, v183
  v_add_f32 v176, v176, v180
  v_add_f32 v177, v177, v181
  v_add_f32 v178, v178, v182
  v_add_f32 v179, v179, v183
  s_nop 0
  v_permlane16_swap_b32 v176, v178
  v_permlane16_swap_b32 v177, v179
  v_add_f32 v176, v176, v178
  v_add_f32 v177, v177, v179
  s_nop 0
  v_add_f32 v176, v176, v176 row_ror:8 row_mask:0xf bank_mask:0xf
  v_add_f32 v177, v177, v177 row_ror:8 row_mask:0xf bank_mask:0xf
  s_mov_b32 exec_lo, 0x00ff00ff
  s_mov_b32 exec_hi, 0x00ff00ff
  buffer_store_dwordx2 v[160:161], v21, s[4:7], s30 offen offset:0 sc1
  buffer_store_dwordx2 v[168:169], v21, s[4:7], s30 offen offset:256 sc1
  buffer_store_dwordx2 v[176:177], v21, s[4:7], s30 offen offset:512 sc1
  s_mov_b64 exec, -1
  s_mov_b32 s12, s58
  s_mov_b32 s13, s59
  s_mov_b32 s14, 0x100
  s_mov_b32 s15, 0x00020000
  s_mov_b32 s38, 0
  s_mov_b64 exec, 1
.g2_kernel_gt12:
  buffer_load_dword v6, v4, s[12:15], 0 offen sc1
  s_add_u32 s38, s38, 1
  s_waitcnt vmcnt(0)
  v_cmp_eq_u32 vcc, 0x60, v6
  s_cbranch_vccnz .g2_kernel_gt12d
  s_sleep 8
  s_cmp_lt_u32 s38, 131072
  s_cbranch_scc1 .g2_kernel_gt12
.g2_kernel_gt12d:
  s_mov_b64 exec, -1
  v_mov_b32 v6, s70
  s_mov_b64 exec, 1
  buffer_store_dword v6, v4, s[4:7], s76 offen offset:4 sc1
  s_mov_b64 exec, -1
  v_mov_b32 v6, 155648
  s_mov_b32 s38, 0
.g2_kernel_wg13:
  ds_read_b32 v7, v6 offset:512
  s_add_u32 s38, s38, 1
  s_waitcnt lgkmcnt(0)
  v_cmp_gt_u32 vcc, 22, v7
  s_cbranch_vccz .g2_kernel_wg13d
  s_sleep 4
  s_cmp_lt_u32 s38, 524288
  s_cbranch_scc1 .g2_kernel_wg13
.g2_kernel_wg13d:
  s_and_b32 s31, s76, 0xffffe000
  s_add_u32 s31, s31, 4
  v_and_b32 v6, 15, v2
  v_lshlrev_b32 v6, 9, v6
  v_lshrrev_b32 v7, 4, v2
  v_lshl_add_u32 v6, v7, 7, v6
  v_lshlrev_b32 v7, 2, v2
  v_add_u32 v7, 157696, v7
  s_mov_b32 m0, 157696
  s_mov_b32 s38, 0
  s_bfm_b64 exec, 16, 0
.g2_kernel_pa14:
  buffer_load_dword v6, s[4:7], s31 offen sc1 lds
  s_add_u32 s38, s38, 1
  s_waitcnt vmcnt(0)
  ds_read_b32 v8, v7
  s_waitcnt lgkmcnt(0)
  v_cmp_ge_u32 vcc, s62, v8
  s_cbranch_vccz .g2_kernel_pa14d
  s_mov_b64 exec, vcc
  s_sleep 16
  s_cmp_lt_u32 s38, 131072
  s_cbranch_scc1 .g2_kernel_pa14
.g2_kernel_pa14d:
  s_mov_b64 exec, -1
  s_mul_i32 s30, s18, 12288
  s_add_u32 s30, s30, 0x3080000
  s_mov_b32 exec_hi, 0xffff
  buffer_load_dwordx4 v[64:67], v3, s[4:7], s30 offen offset:0 sc1
  buffer_load_dwordx4 v[68:71], v3, s[4:7], s30 offen offset:768 sc1
  buffer_load_dwordx4 v[72:75], v3, s[4:7], s30 offen offset:1536 sc1
  buffer_load_dwordx4 v[76:79], v3, s[4:7], s30 offen offset:2304 sc1
  s_add_u32 s30, s30, 3072
  buffer_load_dwordx4 v[80:83], v3, s[4:7], s30 offen offset:0 sc1
  buffer_load_dwordx4 v[84:87], v3, s[4:7], s30 offen offset:768 sc1
  buffer_load_dwordx4 v[88:91], v3, s[4:7], s30 offen offset:1536 sc1
  buffer_load_dwordx4 v[92:95], v3, s[4:7], s30 offen offset:2304 sc1
  s_add_u32 s30, s30, 3072
  buffer_load_dwordx4 v[96:99], v3, s[4:7], s30 offen offset:0 sc1
  buffer_load_dwordx4 v[100:103], v3, s[4:7], s30 offen offset:768 sc1
  buffer_load_dwordx4 v[104:107], v3, s[4:7], s30 offen offset:1536 sc1
  buffer_load_dwordx4 v[108:111], v3, s[4:7], s30 offen offset:2304 sc1
  s_add_u32 s30, s30, 3072
  buffer_load_dwordx4 v[112:115], v3, s[4:7], s30 offen offset:0 sc1
  buffer_load_dwordx4 v[116:119], v3, s[4:7], s30 offen offset:768 sc1
  buffer_load_dwordx4 v[120:123], v3, s[4:7], s30 offen offset:1536 sc1
  buffer_load_dwordx4 v[124:127], v3, s[4:7], s30 offen offset:2304 sc1
  s_add_u32 s30, s30, 3072
  s_waitcnt vmcnt(14)
  v_add_f32 v64, v64, v68
  v_add_f32 v65, v65, v69
  v_add_f32 v66, v66, v70
  v_add_f32 v67, v67, v71
  s_waitcnt vmcnt(13)
  v_add_f32 v64, v64, v72
  v_add_f32 v65, v65, v73
  v_add_f32 v66, v66, v74
  v_add_f32 v67, v67, v75
  s_waitcnt vmcnt(12)
  v_add_f32 v64, v64, v76
  v_add_f32 v65, v65, v77
  v_add_f32 v66, v66, v78
  v_add_f32 v67, v67, v79
  s_waitcnt vmcnt(11)
  v_add_f32 v64, v64, v80
  v_add_f32 v65, v65, v81
  v_add_f32 v66, v66, v82
  v_add_f32 v67, v67, v83
  s_waitcnt vmcnt(10)
  v_add_f32 v64, v64, v84
  v_add_f32 v65, v65, v85
  v_add_f32 v66, v66, v86
  v_add_f32 v67, v67, v87
  s_waitcnt vmcnt(9)
  v_add_f32 v64, v64, v88
  v_add_f32 v65, v65, v89
  v_add_f32 v66, v66, v90
  v_add_f32 v67, v67, v91
  s_waitcnt vmcnt(8)
  v_add_f32 v64, v64, v92
  v_add_f32 v65, v65, v93
  v_add_f32 v66, v66, v94
  v_add_f32 v67, v67, v95
  s_waitcnt vmcnt(7)
  v_add_f32 v64, v64, v96
  v_add_f32 v65, v65, v97
  v_add_f32 v66, v66, v98
  v_add_f32 v67, v67, v99
  s_waitcnt vmcnt(6)
  v_add_f32 v64, v64, v100
  v_add_f32 v65, v65, v101
  v_add_f32 v66, v66, v102
  v_add_f32 v67, v67, v103
  s_waitcnt vmcnt(5)
  v_add_f32 v64, v64, v104
  v_add_f32 v65, v65, v105
  v_add_f32 v66, v66, v106
  v_add_f32 v67, v67, v107
  s_waitcnt vmcnt(4)
  v_add_f32 v64, v64, v108
  v_add_f32 v65, v65, v109
  v_add_f32 v66, v66, v110
  v_add_f32 v67, v67, v111
  s_waitcnt vmcnt(3)
  v_add_f32 v64, v64, v112
  v_add_f32 v65, v65, v113
  v_add_f32 v66, v66, v114
  v_add_f32 v67, v67, v115
  s_waitcnt vmcnt(2)
  v_add_f32 v64, v64, v116
  v_add_f32 v65, v65, v117
  v_add_f32 v66, v66, v118
  v_add_f32 v67, v67, v119
  s_waitcnt vmcnt(1)
  v_add_f32 v64, v64, v120
  v_add_f32 v65, v65, v121
  v_add_f32 v66, v66, v122
  v_add_f32 v67, v67, v123
  s_waitcnt vmcnt(0)
  v_add_f32 v64, v64, v124
  v_add_f32 v65, v65, v125
  v_add_f32 v66, v66, v126
  v_add_f32 v67, v67, v127
  s_mov_b64 exec, -1
  v_mov_b32 v6, 155648
  s_mov_b32 s38, 0
.g2_kernel_wg15:
  ds_read_b32 v7, v6 offset:512
  s_add_u32 s38, s38, 1
  s_waitcnt lgkmcnt(0)
  v_cmp_gt_u32 vcc, 32, v7
  s_cbranch_vccz .g2_kernel_wg15d
  s_sleep 2
  s_cmp_lt_u32 s38, 524288
  s_cbranch_scc1 .g2_kernel_wg15
.g2_kernel_wg15d:
  v_lshlrev_b32 v24, 2, v2
  v_add_u32 v24, 155648, v24
  ds_write_b32 v24, v4 offset:2048
  v_add_u32 v24, 155648, v3
  s_mov_b32 exec_hi, 0xffff
  ds_write_b128 v24, v[64:67] offset:4864
  s_mov_b64 exec, -1
  v_mov_b32 v6, s71
  s_mov_b64 exec, 1
  ds_add_u32 v6, v5 offset:0
  s_mov_b64 exec, -1
  s_branch .g2_kernel_v
.g2_kernel_s3:
  s_mov_b32 s12, s58
  s_mov_b32 s13, s59
  s_mov_b32 s14, 0x100
  s_mov_b32 s15, 0x00020000
  s_mov_b32 s20, s48
  s_mov_b32 s21, s49
  s_mov_b32 s22, 0x800
  s_mov_b32 s23, 0x00020000
  v_mov_b32 v12, 0
  v_mov_b32 v13, 0
  v_mov_b32 v14, 0
  v_mov_b32 v15, 0
  s_cmp_ge_u32 s2, 96
  s_cbranch_scc1 .g2_kernel_zm16
  s_lshl_b32 s36, s2, 12
  s_add_u32 s36, s36, 0x3000000
  buffer_store_dwordx4 v[12:15], v3, s[4:7], s36 offen sc1
  buffer_store_dwordx4 v[12:15], v3, s[4:7], s36 offen offset:1024 sc1
  buffer_store_dwordx4 v[12:15], v3, s[4:7], s36 offen offset:2048 sc1
  buffer_store_dwordx4 v[12:15], v3, s[4:7], s36 offen offset:3072 sc1
.g2_kernel_zm16:
  s_barrier
  s_cbranch_scc1 .g2_kernel_zm16b
  s_mov_b64 exec, 1
  s_waitcnt vmcnt(0)
  buffer_atomic_add v5, v4, s[12:15], 0 offen sc1
  s_mov_b64 exec, -1
.g2_kernel_zm16b:
  s_and_b32 s36, s18, 7
  s_cmp_ge_u32 s36, 3
  s_cbranch_scc1 .g2_kernel_c317
  s_mov_b32 s24, s42
  s_mov_b32 s25, s43
  s_mov_b32 s26, 0x600000
  s_mov_b32 s27, 0x00020000
  v_mul_u32_u24 v7, 6144, v2
  s_lshl_b32 s36, s36, 11
  s_or_b32 s37, s18, 3
  s_lshl_b32 s37, s37, 7
  s_add_u32 s36, s36, s37
  s_and_b32 s37, s17, 7
  s_mul_i32 s37, s37, 393216
  s_add_u32 s36, s36, s37
  s_add_u32 s37, s36, 3145728
  s_sleep 0
  buffer_load_dword v1, v7, s[24:27], s36 offen
  s_sleep 30
  buffer_load_dword v1, v7, s[24:27], s37 offen
.g2_kernel_c317:
  v_lshlrev_b32 v20, 5, v2
  buffer_load_dwordx4 v[24:27], v20, s[20:23], 0 offen
  buffer_load_dwordx4 v[28:31], v20, s[20:23], 0 offen offset:16
  v_mov_b32 v20, 0
  s_waitcnt vmcnt(0)
  v_lshlrev_b32 v21, 16, v24
  v_and_b32 v22, 0xffff0000, v24
  v_add_f32 v20, v20, v21
  v_add_f32 v20, v20, v22
  v_lshlrev_b32 v21, 16, v25
  v_and_b32 v22, 0xffff0000, v25
  v_add_f32 v20, v20, v21
  v_add_f32 v20, v20, v22
  v_lshlrev_b32 v21, 16, v26
  v_and_b32 v22, 0xffff0000, v26
  v_add_f32 v20, v20, v21
  v_add_f32 v20, v20, v22
  v_lshlrev_b32 v21, 16, v27
  v_and_b32 v22, 0xffff0000, v27
  v_add_f32 v20, v20, v21
  v_add_f32 v20, v20, v22
  v_lshlrev_b32 v21, 16, v28
  v_and_b32 v22, 0xffff0000, v28
  v_add_f32 v20, v20, v21
  v_add_f32 v20, v20, v22
  v_lshlrev_b32 v21, 16, v29
  v_and_b32 v22, 0xffff0000, v29
  v_add_f32 v20, v20, v21
  v_add_f32 v20, v20, v22
  v_lshlrev_b32 v21, 16, v30
  v_and_b32 v22, 0xffff0000, v30
  v_add_f32 v20, v20, v21
  v_add_f32 v20, v20, v22
  v_lshlrev_b32 v21, 16, v31
  v_and_b32 v22, 0xffff0000, v31
  v_add_f32 v20, v20, v21
  v_add_f32 v20, v20, v22
  s_nop 1
  v_add_f32 v20, v20, v20 quad_perm:[1,0,3,2] row_mask:0xf bank_mask:0xf
  s_nop 1
  v_add_f32 v20, v20, v20 quad_perm:[2,3,0,1] row_mask:0xf bank_mask:0xf
  s_nop 1
  v_add_f32 v20, v20, v20 row_half_mirror row_mask:0xf bank_mask:0xf
  s_nop 1
  v_add_f32 v20, v20, v20 row_mirror row_mask:0xf bank_mask:0xf
  s_nop 0
  v_readlane_b32 s20, v20, 16
  v_readlane_b32 s21, v20, 32
  v_readlane_b32 s22, v20, 48
  v_add_f32 v20, s20, v20
  v_add_f32 v20, s21, v20
  v_add_f32 v20, s22, v20
  v_mul_f32 v20, 0x3a800000, v20
  v_mov_b32 v6, 155648
  s_mov_b32 s38, 0
.g2_kernel_wg18:
  ds_read_b32 v7, v6 offset:512
  s_add_u32 s38, s38, 1
  s_waitcnt lgkmcnt(0)
  v_cmp_gt_u32 vcc, 32, v7
  s_cbranch_vccz .g2_kernel_wg18d
  s_sleep 2
  s_cmp_lt_u32 s38, 524288
  s_cbranch_scc1 .g2_kernel_wg18
.g2_kernel_wg18d:
  v_mov_b32 v21, 155648
  s_mov_b64 exec, 1
  ds_write_b32 v21, v20 offset:256
  s_mov_b64 exec, -1
.g2_kernel_v:
  s_setprio 3
  s_cmp_lg_u32 s16, 4
  s_cbranch_scc1 .g2_kernel_v_1
  v_mov_b32 v6, s71
  s_mov_b32 s38, 0
.g2_kernel_wg19:
  ds_read_b32 v7, v6 offset:120
  s_add_u32 s38, s38, 1
  s_waitcnt lgkmcnt(0)
  v_cmp_gt_u32 vcc, 2, v7
  s_cbranch_vccz .g2_kernel_wg19d
  s_sleep 1
  s_cmp_lt_u32 s38, 524288
  s_cbranch_scc1 .g2_kernel_wg19
.g2_kernel_wg19d:
  s_sleep 4
  s_and_b32 s31, s76, 0xffffe000
  s_add_u32 s31, s31, 0
  v_and_b32 v6, 15, v2
  v_lshlrev_b32 v6, 9, v6
  v_lshrrev_b32 v7, 4, v2
  v_lshl_add_u32 v6, v7, 7, v6
  v_lshlrev_b32 v7, 2, v2
  v_add_u32 v7, 157440, v7
  s_mov_b32 m0, 157440
  s_mov_b32 s38, 0
  s_mov_b32 exec_lo, 0xffff
  s_mov_b32 exec_hi, 0xffff
.g2_kernel_pa20:
  buffer_load_dword v6, s[4:7], s31 offen sc1 lds
  s_add_u32 s38, s38, 1
  s_waitcnt vmcnt(0)
  ds_read_b32 v8, v7
  s_waitcnt lgkmcnt(0)
  v_cmp_ge_u32 vcc, s62, v8
  s_cbranch_vccz .g2_kernel_pa20d
  s_mov_b64 exec, vcc
  s_sleep 2
  s_cmp_lt_u32 s38, 131072
  s_cbranch_scc1 .g2_kernel_pa20
.g2_kernel_pa20d:
  s_mov_b64 exec, -1
  v_mov_b32 v6, s71
  s_mov_b32 s38, 0
.g2_kernel_wg21:
  ds_read_b32 v7, v6 offset:4
  s_add_u32 s38, s38, 1
  s_waitcnt lgkmcnt(0)
  v_cmp_gt_u32 vcc, 4, v7
  s_cbranch_vccz .g2_kernel_wg21d
  s_sleep 2
  s_cmp_lt_u32 s38, 524288
  s_cbranch_scc1 .g2_kernel_wg21
.g2_kernel_wg21d:
  v_mov_b32 v6, s71
  s_mov_b64 exec, 1
  ds_add_u32 v6, v5 offset:80
  s_mov_b64 exec, -1
.g2_kernel_v_1:
  s_cmp_lt_u32 s16, 6
  s_cbranch_scc1 .g2_kernel_v_2
  v_mov_b32 v6, s71
  s_mov_b32 s38, 0
.g2_kernel_wg22:
  ds_read_b32 v7, v6 offset:4
  s_add_u32 s38, s38, 1
  s_waitcnt lgkmcnt(0)
  v_cmp_gt_u32 vcc, 4, v7
  s_cbranch_vccz .g2_kernel_wg22d
  s_sleep 4
  s_cmp_lt_u32 s38, 524288
  s_cbranch_scc1 .g2_kernel_wg22
.g2_kernel_wg22d:
  s_and_b32 s28, s16, 1
  s_lshl_b32 s30, s28, 13
  s_add_u32 s31, s30, 16384
  v_add_u32 v8, s31, v3
  ds_read_b32 v9, v6 offset:24
  ds_read_b128 v[16:19], v8 offset:0
  ds_read_b128 v[20:23], v8 offset:1024
  ds_read_b128 v[24:27], v8 offset:2048
  ds_read_b128 v[28:31], v8 offset:3072
  ds_read_b128 v[32:35], v8 offset:4096
  ds_read_b128 v[36:39], v8 offset:5120
  ds_read_b128 v[40:43], v8 offset:6144
  ds_read_b128 v[44:47], v8 offset:7168
  s_lshl_b32 s31, s18, 5
  s_add_u32 s31, s31, s17
  s_add_u32 s31, s31, 16
  s_lshl_b32 s31, s31, 14
  s_add_u32 s30, s30, s31
  s_add_u32 s30, s30, s63
  s_add_u32 s31, s30, 4096
  s_lshl_b32 s33, s28, 8
  s_add_u32 s33, s33, 128
  s_waitcnt lgkmcnt(0)
  v_readfirstlane_b32 s29, v9
  v_mov_b32 v6, s71
  s_mov_b64 exec, 1
  ds_add_u32 v6, v5 offset:8
  s_mov_b64 exec, -1
  s_sleep 40
  buffer_store_dwordx4 v[16:19], v3, s[4:7], s30 offen offset:0 sc1
  s_sleep 4
  buffer_store_dwordx4 v[20:23], v3, s[4:7], s30 offen offset:1024 sc1
  s_sleep 4
  buffer_store_dwordx4 v[24:27], v3, s[4:7], s30 offen offset:2048 sc1
  s_sleep 4
  buffer_store_dwordx4 v[28:31], v3, s[4:7], s30 offen offset:3072 sc1
  s_sleep 4
  buffer_store_dwordx4 v[32:35], v3, s[4:7], s31 offen offset:0 sc1
  s_sleep 4
  buffer_store_dwordx4 v[36:39], v3, s[4:7], s31 offen offset:1024 sc1
  s_sleep 4
  buffer_store_dwordx4 v[40:43], v3, s[4:7], s31 offen offset:2048 sc1
  s_sleep 4
  buffer_store_dwordx4 v[44:47], v3, s[4:7], s31 offen offset:3072 sc1
  s_sleep 4
  s_sub_u32 s29, s29, 1
  s_lshr_b32 s29, s29, 6
  s_waitcnt vmcnt(0)
  s_cmp_eq_u32 s29, s28
  s_cbranch_scc1 .g2_kernel_v_1h
  s_add_u32 s31, s76, s33
  v_mov_b32 v6, s70
  s_mov_b64 exec, 1
  buffer_store_dword v6, v4, s[4:7], s31 offen offset:0 sc1
  s_mov_b64 exec, -1
  s_branch .g2_kernel_v_2
.g2_kernel_v_1h:
  v_mov_b32 v6, s71
  s_mov_b64 exec, 1
  ds_add_u32 v6, v5 offset:56
  s_mov_b64 exec, -1
.g2_kernel_v_2:
  v_mov_b32 v6, s71
  s_mov_b32 s38, 0
.g2_kernel_wg23:
  ds_read_b32 v7, v6 offset:80
  s_add_u32 s38, s38, 1
  s_waitcnt lgkmcnt(0)
  v_cmp_gt_u32 vcc, 1, v7
  s_cbranch_vccz .g2_kernel_wg23d
  s_sleep 8
  s_cmp_lt_u32 s38, 524288
  s_cbranch_scc1 .g2_kernel_wg23
.g2_kernel_wg23d:
  s_sleep 20
  s_mov_b32 s39, 0
  v_mov_b32 v12, 0
  v_mov_b32 v13, 0
  v_mov_b32 v14, 0
  v_mov_b32 v15, 0
  s_lshl_b32 s30, s17, 2
  s_and_b32 s31, s16, 3
  s_add_u32 s30, s30, s31
  s_lshl_b32 s30, s30, 4
  s_add_u32 s30, s30, s18
  s_lshl_b32 s30, s30, 9
  s_add_u32 s30, s30, s63
  s_add_u32 s30, s30, 0x1000000
  s_mov_b32 exec_hi, 0
  s_sleep 6
  buffer_store_dwordx4 v[12:15], v3, s[4:7], s30 offen sc1
  s_mov_b64 exec, -1
  s_lshl_b32 s30, s17, 2
  s_add_u32 s30, s30, s31
  s_lshl_b32 s30, s30, 5
  s_add_u32 s30, s30, s18
  s_lshl_b32 s30, s30, 11
  s_add_u32 s30, s30, s63
  s_add_u32 s30, s30, 0x808000
  s_sleep 6
  buffer_store_dwordx4 v[12:15], v3, s[4:7], s30 offen sc1
  s_sleep 6
  buffer_store_dwordx4 v[12:15], v3, s[4:7], s30 offen offset:1024 sc1
  s_cmp_lg_u32 s62, 5
  s_cbranch_scc1 .g2_kernel_zs24k
  s_lshl_b32 s30, s18, 4
  s_add_u32 s30, s30, s17
  s_lshl_b32 s30, s30, 2
  s_add_u32 s30, s30, s31
  s_lshl_b32 s30, s30, 12
  s_add_u32 s30, s30, 0x2c00000
  s_sleep 6
  buffer_store_dwordx4 v[12:15], v3, s[4:7], s30 offen sc1
  s_sleep 6
  buffer_store_dwordx4 v[12:15], v3, s[4:7], s30 offen offset:1024 sc1
  s_sleep 6
  buffer_store_dwordx4 v[12:15], v3, s[4:7], s30 offen offset:2048 sc1
  s_sleep 6
  buffer_store_dwordx4 v[12:15], v3, s[4:7], s30 offen offset:3072 sc1
.g2_kernel_zs24k:
  s_lshl_b32 s30, s17, 4
  s_add_u32 s30, s30, s18
  s_cmp_gt_u32 s16, 5
  s_cbranch_scc1 .g2_kernel_zs24
  s_cmp_eq_u32 s16, 5
  s_cbranch_scc1 .g2_kernel_zs24a
  s_cmp_lg_u32 s62, 0
  s_cbranch_scc1 .g2_kernel_zs24
  s_lshl_b32 s30, s30, 12
  s_add_u32 s31, s30, 0x1090000
  s_sleep 6
  buffer_store_dwordx4 v[12:15], v3, s[4:7], s31 offen offset:0 sc1
  s_sleep 6
  buffer_store_dwordx4 v[12:15], v3, s[4:7], s31 offen offset:1024 sc1
  s_sleep 6
  buffer_store_dwordx4 v[12:15], v3, s[4:7], s31 offen offset:2048 sc1
  s_sleep 6
  buffer_store_dwordx4 v[12:15], v3, s[4:7], s31 offen offset:3072 sc1
  s_branch .g2_kernel_zs24
.g2_kernel_zs24a:
  s_xor_b32 s31, s17, s18
  s_and_b32 s31, s31, 3
  s_cbranch_scc1 .g2_kernel_zs24b
  s_lshr_b32 s30, s30, 2
  s_lshl_b32 s30, s30, 8
  s_add_u32 s30, s30, s63
  s_add_u32 s30, s30, 0x1080000
  s_mov_b64 exec, 0xffff
  s_sleep 6
  buffer_store_dwordx4 v[12:15], v3, s[4:7], s30 offen sc1
  s_mov_b64 exec, -1
.g2_kernel_zs24b:
  s_cmp_lg_u32 s62, 0
  s_cbranch_scc1 .g2_kernel_zs24
  s_and_b32 s30, s18, 14
  s_lshl_b32 s30, s30, 4
  s_add_u32 s30, s30, s17
  s_lshl_b32 s30, s30, 1
  s_and_b32 s31, s18, 1
  s_add_u32 s30, s30, s31
  s_lshl_b32 s30, s30, 10
  s_add_u32 s30, s30, s63
  s_add_u32 s30, s30, 0x1190000
  s_add_u32 s31, s30, 32768
  s_sleep 6
  buffer_store_dwordx4 v[12:15], v3, s[4:7], s30 offen sc1
  s_sleep 6
  buffer_store_dwordx4 v[12:15], v3, s[4:7], s31 offen sc1
.g2_kernel_zs24:
  s_cmp_eq_u32 s16, 4
  s_cbranch_scc1 .g2_kernel_v_3a
  s_cmp_lg_u32 s62, 0
  s_cbranch_scc1 .g2_kernel_g_e
  s_and_b32 s22, s16, 3
  s_lshl_b32 s22, s22, 14
  s_cmp_eq_u32 s16, 5
  s_cselect_b32 s28, 65536, 0
  s_add_u32 s22, s22, s28
  v_bfe_u32 v8, v2, 2, 2
  v_lshrrev_b32 v9, 4, v2
  v_and_b32 v10, 3, v2
  v_lshlrev_b32 v10, 3, v10
  v_add_u32 v10, s22, v10
  s_cmp_eq_u32 s16, 5
  s_cbranch_scc1 .g2_kernel_g_p
  s_lshl_b32 s74, s17, 4
  s_add_u32 s74, s74, s18
  s_cmp_ge_u32 s74, 224
  s_cbranch_scc1 .g2_kernel_g_e
  v_lshrrev_b32 v6, 1, v2
  v_mul_u32_u24 v6, 7168, v6
  v_and_b32 v7, 1, v2
  v_lshl_add_u32 v250, v7, 4, v6
  v_lshl_add_u32 v11, v9, 3, v8
  v_lshl_add_u32 v251, v11, 5, v10
  v_and_b32 v11, 1, v9
  v_lshl_add_u32 v11, v11, 3, v8
  v_lshl_add_u32 v11, v11, 10, v10
  v_lshrrev_b32 v7, 1, v9
  v_lshl_add_u32 v252, v7, 7, v11
  s_mov_b32 s24, s74
  s_and_b32 s25, s16, 1
  s_mov_b32 s12, s50
  s_mov_b32 s13, s51
  s_mov_b32 s14, 0x700000
  s_mov_b32 s15, 0x00020000
  s_mul_i32 s20, s25, 3670016
  s_lshl_b32 s31, s24, 5
  s_add_u32 s20, s20, s31
  s_lshl_b32 s31, s18, 2
  s_mov_b32 s23, s31
  s_mov_b32 s21, 16
.g2_kernel_gl28:
  s_and_b32 s30, s21, 3
  s_cbranch_scc1 .g2_kernel_gl28m
  s_call_b64 s[26:27], .g2_kernel_v_may
.g2_kernel_gl28m:
  s_and_b32 s23, s23, 15
  s_lshl_b32 s30, s23, 10
  s_add_u32 s30, s30, 0
  s_add_u32 m0, s30, s22
  s_mul_i32 s30, s23, 229376
  s_add_u32 s30, s30, s20
  buffer_load_dwordx4 v250, s[12:15], s30 offen  lds
  s_add_u32 s23, s23, 1
  s_sub_u32 s21, s21, 1
  s_sleep 2
  s_cmp_lt_u32 s21, 12
  s_cbranch_scc1 .g2_kernel_gl28x
  s_sleep 8
.g2_kernel_gl28x:
  s_waitcnt vmcnt(3)
  s_cmp_lg_u32 s21, 0
  s_cbranch_scc1 .g2_kernel_gl28
  s_waitcnt vmcnt(0)
  ds_read_b64_tr_b16 v[64:65], v251 offset:0
  ds_read_b64_tr_b16 v[66:67], v251 offset:128
  ds_read_b64_tr_b16 v[68:69], v251 offset:1024
  ds_read_b64_tr_b16 v[70:71], v251 offset:1152
  ds_read_b64_tr_b16 v[72:73], v251 offset:2048
  ds_read_b64_tr_b16 v[74:75], v251 offset:2176
  ds_read_b64_tr_b16 v[76:77], v251 offset:3072
  ds_read_b64_tr_b16 v[78:79], v251 offset:3200
  ds_read_b64_tr_b16 v[80:81], v251 offset:4096
  ds_read_b64_tr_b16 v[82:83], v251 offset:4224
  ds_read_b64_tr_b16 v[84:85], v251 offset:5120
  ds_read_b64_tr_b16 v[86:87], v251 offset:5248
  ds_read_b64_tr_b16 v[88:89], v251 offset:6144
  ds_read_b64_tr_b16 v[90:91], v251 offset:6272
  ds_read_b64_tr_b16 v[92:93], v251 offset:7168
  ds_read_b64_tr_b16 v[94:95], v251 offset:7296
  ds_read_b64_tr_b16 v[96:97], v251 offset:8192
  ds_read_b64_tr_b16 v[98:99], v251 offset:8320
  ds_read_b64_tr_b16 v[100:101], v251 offset:9216
  ds_read_b64_tr_b16 v[102:103], v251 offset:9344
  ds_read_b64_tr_b16 v[104:105], v251 offset:10240
  ds_read_b64_tr_b16 v[106:107], v251 offset:10368
  ds_read_b64_tr_b16 v[108:109], v251 offset:11264
  ds_read_b64_tr_b16 v[110:111], v251 offset:11392
  ds_read_b64_tr_b16 v[112:113], v251 offset:12288
  ds_read_b64_tr_b16 v[114:115], v251 offset:12416
  ds_read_b64_tr_b16 v[116:117], v251 offset:13312
  ds_read_b64_tr_b16 v[118:119], v251 offset:13440
  ds_read_b64_tr_b16 v[120:121], v251 offset:14336
  ds_read_b64_tr_b16 v[122:123], v251 offset:14464
  ds_read_b64_tr_b16 v[124:125], v251 offset:15360
  ds_read_b64_tr_b16 v[126:127], v251 offset:15488
  s_waitcnt lgkmcnt(0)
  s_mov_b32 s12, s52
  s_mov_b32 s13, s53
  s_mov_b32 s14, 0x700000
  s_mov_b32 s15, 0x00020000
  s_mul_i32 s20, s25, 3670016
  s_lshl_b32 s31, s24, 5
  s_add_u32 s20, s20, s31
  s_lshl_b32 s31, s18, 2
  s_mov_b32 s23, s31
  s_mov_b32 s21, 16
.g2_kernel_gl29:
  s_and_b32 s30, s21, 3
  s_cbranch_scc1 .g2_kernel_gl29m
  s_call_b64 s[26:27], .g2_kernel_v_may
.g2_kernel_gl29m:
  s_and_b32 s23, s23, 15
  s_lshl_b32 s30, s23, 10
  s_add_u32 s30, s30, 0
  s_add_u32 m0, s30, s22
  s_mul_i32 s30, s23, 229376
  s_add_u32 s30, s30, s20
  buffer_load_dwordx4 v250, s[12:15], s30 offen  lds
  s_add_u32 s23, s23, 1
  s_sub_u32 s21, s21, 1
  s_sleep 2
  s_cmp_lt_u32 s21, 12
  s_cbranch_scc1 .g2_kernel_gl29x
  s_sleep 8
.g2_kernel_gl29x:
  s_waitcnt vmcnt(3)
  s_cmp_lg_u32 s21, 0
  s_cbranch_scc1 .g2_kernel_gl29
  s_waitcnt vmcnt(0)
  ds_read_b64_tr_b16 v[128:129], v251 offset:0
  ds_read_b64_tr_b16 v[130:131], v251 offset:128
  ds_read_b64_tr_b16 v[132:133], v251 offset:1024
  ds_read_b64_tr_b16 v[134:135], v251 offset:1152
  ds_read_b64_tr_b16 v[136:137], v251 offset:2048
  ds_read_b64_tr_b16 v[138:139], v251 offset:2176
  ds_read_b64_tr_b16 v[140:141], v251 offset:3072
  ds_read_b64_tr_b16 v[142:143], v251 offset:3200
  ds_read_b64_tr_b16 v[144:145], v251 offset:4096
  ds_read_b64_tr_b16 v[146:147], v251 offset:4224
  ds_read_b64_tr_b16 v[148:149], v251 offset:5120
  ds_read_b64_tr_b16 v[150:151], v251 offset:5248
  ds_read_b64_tr_b16 v[152:153], v251 offset:6144
  ds_read_b64_tr_b16 v[154:155], v251 offset:6272
  ds_read_b64_tr_b16 v[156:157], v251 offset:7168
  ds_read_b64_tr_b16 v[158:159], v251 offset:7296
  ds_read_b64_tr_b16 v[160:161], v251 offset:8192
  ds_read_b64_tr_b16 v[162:163], v251 offset:8320
  ds_read_b64_tr_b16 v[164:165], v251 offset:9216
  ds_read_b64_tr_b16 v[166:167], v251 offset:9344
  ds_read_b64_tr_b16 v[168:169], v251 offset:10240
  ds_read_b64_tr_b16 v[170:171], v251 offset:10368
  ds_read_b64_tr_b16 v[172:173], v251 offset:11264
  ds_read_b64_tr_b16 v[174:175], v251 offset:11392
  ds_read_b64_tr_b16 v[176:177], v251 offset:12288
  ds_read_b64_tr_b16 v[178:179], v251 offset:12416
  ds_read_b64_tr_b16 v[180:181], v251 offset:13312
  ds_read_b64_tr_b16 v[182:183], v251 offset:13440
  ds_read_b64_tr_b16 v[184:185], v251 offset:14336
  ds_read_b64_tr_b16 v[186:187], v251 offset:14464
  ds_read_b64_tr_b16 v[188:189], v251 offset:15360
  ds_read_b64_tr_b16 v[190:191], v251 offset:15488
  s_waitcnt lgkmcnt(0)
  s_mov_b32 s12, s54
  s_mov_b32 s13, s55
  s_mov_b32 s14, 0x700000
  s_mov_b32 s15, 0x00020000
  s_lshl_b32 s20, s24, 15
  s_lshl_b32 s31, s25, 10
  s_add_u32 s20, s20, s31
  s_mov_b32 s23, 0
  s_mov_b32 s21, 16
.g2_kernel_gl30:
  s_and_b32 s30, s21, 3
  s_cbranch_scc1 .g2_kernel_gl30m
  s_call_b64 s[26:27], .g2_kernel_v_may
.g2_kernel_gl30m:
  s_and_b32 s23, s23, 15
  s_lshl_b32 s30, s23, 10
  s_add_u32 s30, s30, 0
  s_add_u32 m0, s30, s22
  s_mul_i32 s30, s23, 2048
  s_add_u32 s30, s30, s20
  buffer_load_dwordx4 v3, s[12:15], s30 offen nt lds
  s_add_u32 s23, s23, 1
  s_sub_u32 s21, s21, 1
  s_sleep 2
  s_waitcnt vmcnt(8)
  s_cmp_lg_u32 s21, 0
  s_cbranch_scc1 .g2_kernel_gl30
  v_mov_b32 v11, v252
  s_waitcnt vmcnt(0)
  ds_read_b64_tr_b16 v[192:193], v11 offset:0
  ds_read_b64_tr_b16 v[194:195], v11 offset:4096
  ds_read_b64_tr_b16 v[196:197], v11 offset:32
  ds_read_b64_tr_b16 v[198:199], v11 offset:4128
  ds_read_b64_tr_b16 v[200:201], v11 offset:64
  ds_read_b64_tr_b16 v[202:203], v11 offset:4160
  ds_read_b64_tr_b16 v[204:205], v11 offset:96
  ds_read_b64_tr_b16 v[206:207], v11 offset:4192
  ds_read_b64_tr_b16 v[208:209], v11 offset:256
  ds_read_b64_tr_b16 v[210:211], v11 offset:4352
  ds_read_b64_tr_b16 v[212:213], v11 offset:288
  ds_read_b64_tr_b16 v[214:215], v11 offset:4384
  ds_read_b64_tr_b16 v[216:217], v11 offset:320
  ds_read_b64_tr_b16 v[218:219], v11 offset:4416
  ds_read_b64_tr_b16 v[220:221], v11 offset:352
  ds_read_b64_tr_b16 v[222:223], v11 offset:4448
  ds_read_b64_tr_b16 v[224:225], v11 offset:512
  ds_read_b64_tr_b16 v[226:227], v11 offset:4608
  ds_read_b64_tr_b16 v[228:229], v11 offset:544
  ds_read_b64_tr_b16 v[230:231], v11 offset:4640
  ds_read_b64_tr_b16 v[232:233], v11 offset:576
  ds_read_b64_tr_b16 v[234:235], v11 offset:4672
  ds_read_b64_tr_b16 v[236:237], v11 offset:608
  ds_read_b64_tr_b16 v[238:239], v11 offset:4704
  ds_read_b64_tr_b16 v[240:241], v11 offset:768
  ds_read_b64_tr_b16 v[242:243], v11 offset:4864
  ds_read_b64_tr_b16 v[244:245], v11 offset:800
  ds_read_b64_tr_b16 v[246:247], v11 offset:4896
  ds_read_b64_tr_b16 v[248:249], v11 offset:832
  ds_read_b64_tr_b16 v[250:251], v11 offset:4928
  ds_read_b64_tr_b16 v[252:253], v11 offset:864
  ds_read_b64_tr_b16 v[254:255], v11 offset:4960
  s_waitcnt lgkmcnt(0)
  s_branch .g2_kernel_g_e
.g2_kernel_g_p:
  s_sleep 0
  s_mov_b32 s12, s42
  s_mov_b32 s13, s43
  s_mov_b32 s14, 0x600000
  s_mov_b32 s15, 0x00020000
  v_mul_u32_u24 v6, 6144, v9
  v_and_b32 v7, 15, v2
  v_lshl_add_u32 v250, v7, 4, v6
  v_lshl_add_u32 v11, v8, 2, v9
  v_lshl_add_u32 v251, v11, 9, v10
  s_lshl_b32 s20, s17, 3
  s_and_b32 s31, s18, 1
  s_add_u32 s20, s20, s31
  s_mul_i32 s20, s20, 49152
  s_and_b32 s31, s18, 14
  s_lshl_b32 s31, s31, 7
  s_add_u32 s20, s20, s31
  s_mov_b32 s23, 0
  s_mov_b32 s21, 8
.g2_kernel_gl31:
  s_and_b32 s30, s21, 3
  s_cbranch_scc1 .g2_kernel_gl31m
  s_call_b64 s[26:27], .g2_kernel_v_may
.g2_kernel_gl31m:
  s_and_b32 s23, s23, 7
  s_lshl_b32 s30, s23, 10
  s_add_u32 s30, s30, 0
  s_add_u32 m0, s30, s22
  s_mul_i32 s30, s23, 49152
  s_add_u32 s30, s30, s20
  s_and_b32 s31, s23, 1
  s_mul_i32 s31, s31, -24576
  s_add_u32 s30, s30, s31
  buffer_load_dwordx4 v250, s[12:15], s30 offen  lds
  s_add_u32 s23, s23, 1
  s_sub_u32 s21, s21, 1
  s_sleep 1
  s_waitcnt vmcnt(3)
  s_cmp_lg_u32 s21, 0
  s_cbranch_scc1 .g2_kernel_gl31
  s_add_u32 s20, s20, 2048
  s_mov_b32 s23, 0
  s_mov_b32 s21, 8
.g2_kernel_gl32:
  s_and_b32 s30, s21, 3
  s_cbranch_scc1 .g2_kernel_gl32m
  s_call_b64 s[26:27], .g2_kernel_v_may
.g2_kernel_gl32m:
  s_and_b32 s23, s23, 7
  s_lshl_b32 s30, s23, 10
  s_add_u32 s30, s30, 8192
  s_add_u32 m0, s30, s22
  s_mul_i32 s30, s23, 49152
  s_add_u32 s30, s30, s20
  s_and_b32 s31, s23, 1
  s_mul_i32 s31, s31, -24576
  s_add_u32 s30, s30, s31
  buffer_load_dwordx4 v250, s[12:15], s30 offen  lds
  s_add_u32 s23, s23, 1
  s_sub_u32 s21, s21, 1
  s_sleep 1
  s_waitcnt vmcnt(3)
  s_cmp_lg_u32 s21, 0
  s_cbranch_scc1 .g2_kernel_gl32
  s_add_u32 s20, s20, 2048
  s_waitcnt vmcnt(0)
  ds_read_b64_tr_b16 v[64:65], v251 offset:0
  ds_read_b64_tr_b16 v[66:67], v251 offset:256
  ds_read_b64_tr_b16 v[68:69], v251 offset:32
  ds_read_b64_tr_b16 v[70:71], v251 offset:288
  ds_read_b64_tr_b16 v[72:73], v251 offset:64
  ds_read_b64_tr_b16 v[74:75], v251 offset:320
  ds_read_b64_tr_b16 v[76:77], v251 offset:96
  ds_read_b64_tr_b16 v[78:79], v251 offset:352
  ds_read_b64_tr_b16 v[80:81], v251 offset:128
  ds_read_b64_tr_b16 v[82:83], v251 offset:384
  ds_read_b64_tr_b16 v[84:85], v251 offset:160
  ds_read_b64_tr_b16 v[86:87], v251 offset:416
  ds_read_b64_tr_b16 v[88:89], v251 offset:192
  ds_read_b64_tr_b16 v[90:91], v251 offset:448
  ds_read_b64_tr_b16 v[92:93], v251 offset:224
  ds_read_b64_tr_b16 v[94:95], v251 offset:480
  ds_read_b64_tr_b16 v[96:97], v251 offset:8192
  ds_read_b64_tr_b16 v[98:99], v251 offset:8448
  ds_read_b64_tr_b16 v[100:101], v251 offset:8224
  ds_read_b64_tr_b16 v[102:103], v251 offset:8480
  ds_read_b64_tr_b16 v[104:105], v251 offset:8256
  ds_read_b64_tr_b16 v[106:107], v251 offset:8512
  ds_read_b64_tr_b16 v[108:109], v251 offset:8288
  ds_read_b64_tr_b16 v[110:111], v251 offset:8544
  ds_read_b64_tr_b16 v[112:113], v251 offset:8320
  ds_read_b64_tr_b16 v[114:115], v251 offset:8576
  ds_read_b64_tr_b16 v[116:117], v251 offset:8352
  ds_read_b64_tr_b16 v[118:119], v251 offset:8608
  ds_read_b64_tr_b16 v[120:121], v251 offset:8384
  ds_read_b64_tr_b16 v[122:123], v251 offset:8640
  ds_read_b64_tr_b16 v[124:125], v251 offset:8416
  ds_read_b64_tr_b16 v[126:127], v251 offset:8672
  s_waitcnt lgkmcnt(0)
  s_mov_b32 s23, 0
  s_mov_b32 s21, 8
.g2_kernel_gl33:
  s_and_b32 s30, s21, 3
  s_cbranch_scc1 .g2_kernel_gl33m
  s_call_b64 s[26:27], .g2_kernel_v_may
.g2_kernel_gl33m:
  s_and_b32 s23, s23, 7
  s_lshl_b32 s30, s23, 10
  s_add_u32 s30, s30, 0
  s_add_u32 m0, s30, s22
  s_mul_i32 s30, s23, 49152
  s_add_u32 s30, s30, s20
  s_and_b32 s31, s23, 1
  s_mul_i32 s31, s31, -24576
  s_add_u32 s30, s30, s31
  buffer_load_dwordx4 v250, s[12:15], s30 offen  lds
  s_add_u32 s23, s23, 1
  s_sub_u32 s21, s21, 1
  s_sleep 1
  s_waitcnt vmcnt(3)
  s_cmp_lg_u32 s21, 0
  s_cbranch_scc1 .g2_kernel_gl33
  s_add_u32 s20, s20, 2048
  s_waitcnt vmcnt(0)
  ds_read_b64_tr_b16 v[128:129], v251 offset:0
  ds_read_b64_tr_b16 v[130:131], v251 offset:256
  ds_read_b64_tr_b16 v[132:133], v251 offset:32
  ds_read_b64_tr_b16 v[134:135], v251 offset:288
  ds_read_b64_tr_b16 v[136:137], v251 offset:64
  ds_read_b64_tr_b16 v[138:139], v251 offset:320
  ds_read_b64_tr_b16 v[140:141], v251 offset:96
  ds_read_b64_tr_b16 v[142:143], v251 offset:352
  ds_read_b64_tr_b16 v[144:145], v251 offset:128
  ds_read_b64_tr_b16 v[146:147], v251 offset:384
  ds_read_b64_tr_b16 v[148:149], v251 offset:160
  ds_read_b64_tr_b16 v[150:151], v251 offset:416
  ds_read_b64_tr_b16 v[152:153], v251 offset:192
  ds_read_b64_tr_b16 v[154:155], v251 offset:448
  ds_read_b64_tr_b16 v[156:157], v251 offset:224
  ds_read_b64_tr_b16 v[158:159], v251 offset:480
  s_waitcnt lgkmcnt(0)
.g2_kernel_g_e:
  s_cmp_lt_u32 s16, 6
  s_cbranch_scc1 .g2_kernel_v_3
  v_mov_b32 v6, s71
  s_mov_b64 exec, 1
  ds_add_u32 v6, v5 offset:116
  s_mov_b64 exec, -1
  s_branch .g2_kernel_v_3c
.g2_kernel_v_3:
  s_mov_b32 s29, 0
  s_and_b32 s32, s16, 3
  s_lshl_b32 s30, s32, 14
  s_add_u32 s30, s30, 65536
  s_call_b64 s[68:69], .g2_kernel_v_wo
  s_cmp_lg_u32 s16, 4
  s_cbranch_scc1 .g2_kernel_v_3d
  s_mov_b32 s32, 2
  s_mov_b32 s30, 98304
  s_call_b64 s[68:69], .g2_kernel_v_wo
  s_mov_b32 s32, 3
  s_mov_b32 s30, 114688
  s_call_b64 s[68:69], .g2_kernel_v_wo
.g2_kernel_v_3d:
  s_waitcnt vmcnt(0)
  v_mov_b32 v8, 2
  v_mov_b32 v6, s71
  s_mov_b64 exec, 1
  ds_add_u32 v6, v8 offset:52
  s_mov_b64 exec, -1
.g2_kernel_v_3c:
  s_cmp_lg_u32 s39, 0
  s_cbranch_scc1 .g2_kernel_v_3b
  s_call_b64 s[26:27], .g2_kernel_v_do
.g2_kernel_v_3b:
  s_cmp_lg_u32 s16, 4
  s_cbranch_scc1 .g2_kernel_v_4
  v_mov_b32 v6, s71
  s_mov_b32 s38, 0
.g2_kernel_wg34:
  ds_read_b32 v7, v6 offset:8
  s_add_u32 s38, s38, 1
  s_waitcnt lgkmcnt(0)
  v_cmp_gt_u32 vcc, 10, v7
  s_cbranch_vccz .g2_kernel_wg34d
  s_sleep 8
  s_cmp_lt_u32 s38, 524288
  s_cbranch_scc1 .g2_kernel_wg34
.g2_kernel_wg34d:
  s_mov_b32 s29, 1
  s_mov_b32 s32, 0
  s_mov_b32 s30, 139264
  s_call_b64 s[68:69], .g2_kernel_v_wo
  s_add_u32 s31, s31, 81920
  s_sleep 6
  s_waitcnt vmcnt(4)
  buffer_load_dwordx4 v[64:67], v6, s[8:11], s31 offen
  s_add_u32 s31, s31, 16384
  buffer_load_dwordx4 v[68:71], v6, s[8:11], s31 offen
  s_add_u32 s31, s31, 16384
  buffer_load_dwordx4 v[72:75], v6, s[8:11], s31 offen
  s_add_u32 s31, s31, 16384
  buffer_load_dwordx4 v[76:79], v6, s[8:11], s31 offen
  s_add_u32 s31, s31, 81920
  s_sleep 6
  s_waitcnt vmcnt(4)
  buffer_load_dwordx4 v[80:83], v6, s[8:11], s31 offen
  s_add_u32 s31, s31, 16384
  buffer_load_dwordx4 v[84:87], v6, s[8:11], s31 offen
  s_add_u32 s31, s31, 16384
  buffer_load_dwordx4 v[88:91], v6, s[8:11], s31 offen
  s_add_u32 s31, s31, 16384
  buffer_load_dwordx4 v[92:95], v6, s[8:11], s31 offen
  s_add_u32 s31, s31, 81920
  s_sleep 6
  s_waitcnt vmcnt(4)
  buffer_load_dwordx4 v[96:99], v6, s[8:11], s31 offen
  s_add_u32 s31, s31, 16384
  buffer_load_dwordx4 v[100:103], v6, s[8:11], s31 offen
  s_add_u32 s31, s31, 16384
  buffer_load_dwordx4 v[104:107], v6, s[8:11], s31 offen
  s_add_u32 s31, s31, 16384
  buffer_load_dwordx4 v[108:111], v6, s[8:11], s31 offen
  s_add_u32 s31, s31, 81920
  s_sleep 6
  s_waitcnt vmcnt(4)
  buffer_load_dwordx4 v[112:115], v6, s[8:11], s31 offen
  s_add_u32 s31, s31, 16384
  buffer_load_dwordx4 v[116:119], v6, s[8:11], s31 offen
  s_add_u32 s31, s31, 16384
  buffer_load_dwordx4 v[120:123], v6, s[8:11], s31 offen
  s_add_u32 s31, s31, 16384
  buffer_load_dwordx4 v[124:127], v6, s[8:11], s31 offen
  s_add_u32 s31, s31, 81920
  s_sleep 6
  s_waitcnt vmcnt(4)
  buffer_load_dwordx4 v[128:131], v6, s[8:11], s31 offen
  s_add_u32 s31, s31, 16384
  buffer_load_dwordx4 v[132:135], v6, s[8:11], s31 offen
  s_add_u32 s31, s31, 16384
  buffer_load_dwordx4 v[136:139], v6, s[8:11], s31 offen
  s_add_u32 s31, s31, 16384
  buffer_load_dwordx4 v[140:143], v6, s[8:11], s31 offen
  s_add_u32 s31, s31, 81920
  s_sleep 6
  s_waitcnt vmcnt(4)
  buffer_load_dwordx4 v[144:147], v6, s[8:11], s31 offen
  s_add_u32 s31, s31, 16384
  buffer_load_dwordx4 v[148:151], v6, s[8:11], s31 offen
  s_add_u32 s31, s31, 16384
  buffer_load_dwordx4 v[152:155], v6, s[8:11], s31 offen
  s_add_u32 s31, s31, 16384
  buffer_load_dwordx4 v[156:159], v6, s[8:11], s31 offen
  s_add_u32 s31, s31, 81920
  s_sleep 6
  s_waitcnt vmcnt(4)
  buffer_load_dwordx4 v[160:163], v6, s[8:11], s31 offen
  s_add_u32 s31, s31, 16384
  buffer_load_dwordx4 v[164:167], v6, s[8:11], s31 offen
  s_add_u32 s31, s31, 16384
  buffer_load_dwordx4 v[168:171], v6, s[8:11], s31 offen
  s_add_u32 s31, s31, 16384
  buffer_load_dwordx4 v[172:175], v6, s[8:11], s31 offen
  s_add_u32 s31, s31, 81920
  s_sleep 6
  s_waitcnt vmcnt(4)
  buffer_load_dwordx4 v[176:179], v6, s[8:11], s31 offen
  s_add_u32 s31, s31, 16384
  buffer_load_dwordx4 v[180:183], v6, s[8:11], s31 offen
  s_add_u32 s31, s31, 16384
  buffer_load_dwordx4 v[184:187], v6, s[8:11], s31 offen
  s_add_u32 s31, s31, 16384
  buffer_load_dwordx4 v[188:191], v6, s[8:11], s31 offen
  s_add_u32 s31, s31, 81920
  s_sleep 6
  s_waitcnt vmcnt(4)
  buffer_load_dwordx4 v[192:195], v6, s[8:11], s31 offen
  s_add_u32 s31, s31, 16384
  buffer_load_dwordx4 v[196:199], v6, s[8:11], s31 offen
  s_add_u32 s31, s31, 16384
  buffer_load_dwordx4 v[200:203], v6, s[8:11], s31 offen
  s_add_u32 s31, s31, 16384
  buffer_load_dwordx4 v[204:207], v6, s[8:11], s31 offen
  s_add_u32 s31, s31, 81920
  s_sleep 6
  s_waitcnt vmcnt(4)
  buffer_load_dwordx4 v[208:211], v6, s[8:11], s31 offen
  s_add_u32 s31, s31, 16384
  buffer_load_dwordx4 v[212:215], v6, s[8:11], s31 offen
  s_add_u32 s31, s31, 16384
  buffer_load_dwordx4 v[216:219], v6, s[8:11], s31 offen
  s_add_u32 s31, s31, 16384
  buffer_load_dwordx4 v[220:223], v6, s[8:11], s31 offen
  s_add_u32 s31, s31, 81920
  s_sleep 6
  s_waitcnt vmcnt(4)
  buffer_load_dwordx4 v[224:227], v6, s[8:11], s31 offen
  s_add_u32 s31, s31, 16384
  buffer_load_dwordx4 v[228:231], v6, s[8:11], s31 offen
  s_add_u32 s31, s31, 16384
  buffer_load_dwordx4 v[232:235], v6, s[8:11], s31 offen
  s_add_u32 s31, s31, 16384
  buffer_load_dwordx4 v[236:239], v6, s[8:11], s31 offen
  s_add_u32 s31, s31, 81920
  s_sleep 6
  s_waitcnt vmcnt(4)
  buffer_load_dwordx4 v[240:243], v6, s[8:11], s31 offen
  s_add_u32 s31, s31, 16384
  buffer_load_dwordx4 v[244:247], v6, s[8:11], s31 offen
  s_add_u32 s31, s31, 16384
  buffer_load_dwordx4 v[248:251], v6, s[8:11], s31 offen
  s_add_u32 s31, s31, 16384
  buffer_load_dwordx4 v[252:255], v6, s[8:11], s31 offen
  s_cmp_eq_u32 s62, 0
  s_cbranch_scc1 .g2_kernel_v_4
  v_mov_b32 v8, s71
  s_mov_b32 s38, 0
.g2_kernel_wg35:
  ds_read_b32 v9, v8 offset:116
  s_add_u32 s38, s38, 1
  s_waitcnt lgkmcnt(0)
  v_cmp_gt_u32 vcc, 2, v9
  s_cbranch_vccz .g2_kernel_wg35d
  s_sleep 4
  s_cmp_lt_u32 s38, 524288
  s_cbranch_scc1 .g2_kernel_wg35
.g2_kernel_wg35d:
  s_waitcnt vmcnt(0)
  s_call_b64 s[68:69], .g2_kernel_v_w23
.g2_kernel_v_4:
  s_cmp_lg_u32 s16, 5
  s_cbranch_scc1 .g2_kernel_v_5
  s_sleep 48
  s_and_b32 s31, s19, 0xffffe000
  s_add_u32 s31, s31, 0
  v_and_b32 v6, 15, v2
  v_lshlrev_b32 v6, 9, v6
  v_lshrrev_b32 v7, 4, v2
  v_lshl_add_u32 v6, v7, 7, v6
  v_lshlrev_b32 v7, 2, v2
  v_add_u32 v7, 157696, v7
  s_mov_b32 m0, 157696
  s_mov_b32 s38, 0
.g2_kernel_pa36:
  buffer_load_dword v6, s[4:7], s31 offen sc1 lds
  s_add_u32 s38, s38, 1
  s_waitcnt vmcnt(0)
  ds_read_b32 v8, v7
  s_waitcnt lgkmcnt(0)
  v_cmp_ge_u32 vcc, s62, v8
  s_cbranch_vccz .g2_kernel_pa36d
  s_mov_b64 exec, vcc
  s_sleep 32
  s_cmp_lt_u32 s38, 131072
  s_cbranch_scc1 .g2_kernel_pa36
.g2_kernel_pa36d:
  s_mov_b64 exec, -1
  s_lshl_b32 s28, s2, 10
  s_and_b32 s28, s28, 0xe000
  v_lshlrev_b32 v7, 7, v2
  buffer_load_dword v1, v7, s[64:67], s28 offen
.g2_kernel_v_5:
  s_mov_b32 s29, 1
  s_call_b64 s[68:69], .g2_kernel_v_cmb
  s_cmp_lg_u32 s16, 7
  s_cbranch_scc1 .g2_kernel_v_7
  s_and_b32 s33, s16, 3
  s_lshl_b32 s33, s33, 7
  s_lshl_b32 s28, s29, 2
  s_add_u32 s33, s33, s28
  s_add_u32 s31, s19, s33
  v_mov_b32 v6, s70
  s_mov_b64 exec, 1
  buffer_store_dword v6, v4, s[4:7], s31 offen offset:0 sc1
  s_mov_b64 exec, -1
.g2_kernel_v_7:
  s_cmp_lg_u32 s16, 4
  s_cbranch_scc1 .g2_kernel_v_8
  s_waitcnt vmcnt(2)
  v_mov_b32 v6, s71
  s_mov_b32 s38, 0
.g2_kernel_wg37:
  ds_read_b32 v7, v6 offset:76
  s_add_u32 s38, s38, 1
  s_waitcnt lgkmcnt(0)
  v_cmp_gt_u32 vcc, 1, v7
  s_cbranch_vccz .g2_kernel_wg37d
  s_sleep 1
  s_cmp_lt_u32 s38, 524288
  s_cbranch_scc1 .g2_kernel_wg37
.g2_kernel_wg37d:
  v_mov_b32 v6, s71
  s_mov_b32 s38, 0
.g2_kernel_wg38:
  ds_read_b32 v7, v6 offset:72
  s_add_u32 s38, s38, 1
  s_waitcnt lgkmcnt(0)
  v_cmp_gt_u32 vcc, 1, v7
  s_cbranch_vccz .g2_kernel_wg38d
  s_sleep 1
  s_cmp_lt_u32 s38, 524288
  s_cbranch_scc1 .g2_kernel_wg38
.g2_kernel_wg38d:
  v_mov_b32 v6, s71
  s_mov_b32 s38, 0
.g2_kernel_wg39:
  ds_read_b32 v7, v6 offset:68
  s_add_u32 s38, s38, 1
  s_waitcnt lgkmcnt(0)
  v_cmp_gt_u32 vcc, 1, v7
  s_cbranch_vccz .g2_kernel_wg39d
  s_sleep 1
  s_cmp_lt_u32 s38, 524288
  s_cbranch_scc1 .g2_kernel_wg39
.g2_kernel_wg39d:
  ds_write_b128 v3, v[64:67] offset:16384
  ds_write_b128 v3, v[68:71] offset:17408
  ds_write_b128 v3, v[72:75] offset:18432
  ds_write_b128 v3, v[76:79] offset:19456
  ds_write_b128 v3, v[80:83] offset:20480
  ds_write_b128 v3, v[84:87] offset:21504
  ds_write_b128 v3, v[88:91] offset:22528
  ds_write_b128 v3, v[92:95] offset:23552
  ds_write_b128 v3, v[96:99] offset:24576
  ds_write_b128 v3, v[100:103] offset:25600
  ds_write_b128 v3, v[104:107] offset:26624
  ds_write_b128 v3, v[108:111] offset:27648
  ds_write_b128 v3, v[112:115] offset:28672
  ds_write_b128 v3, v[116:119] offset:29696
  ds_write_b128 v3, v[120:123] offset:30720
  ds_write_b128 v3, v[124:127] offset:31744
  s_cmp_lg_u32 s62, 0
  s_cbranch_scc1 .g2_kernel_v_9
  s_call_b64 s[68:69], .g2_kernel_v_w23
.g2_kernel_v_9:
  v_mov_b32 v8, 4
  ds_write_b32 v6, v8 offset:12
.g2_kernel_v_8:
  s_cmp_eq_u32 s16, 5
  s_cbranch_scc1 .g2_kernel_c1
  s_cmp_lg_u32 s16, 4
  s_cbranch_scc1 .g2_kernel_c2
  s_cmp_lg_u32 s62, 0
  s_cbranch_scc1 .g2_kernel_fin1
  s_setprio 3
  s_mov_b32 s12, s42
  s_mov_b32 s13, s43
  s_mov_b32 s14, 0x600000
  s_mov_b32 s15, 0x00020000
  v_lshrrev_b32 v28, 3, v2
  v_and_b32 v29, 7, v2
  v_bfe_u32 v30, v2, 4, 1
  v_lshlrev_b32 v30, 1, v30
  v_xor_b32 v31, v29, v30
  v_lshlrev_b32 v31, 4, v31
  v_mul_u32_u24 v28, 6144, v28
  v_add_u32 v28, v28, v31
  v_xor_b32 v29, 64, v28
  v_lshlrev_b32 v9, 2, v2
  v_and_b32 v9, 12, v9
  v_add_u32 v9, 156416, v9
  v_add_u32 v48, 0, v28
  v_add_u32 v49, 48128, v29
  v_add_u32 v50, 96256, v28
  v_add_u32 v51, 144384, v29
  v_add_u32 v52, 2048, v28
  v_add_u32 v53, 50176, v29
  v_add_u32 v54, 98304, v28
  v_add_u32 v55, 146432, v29
  v_add_u32 v56, 4096, v29
  v_add_u32 v57, 52224, v28
  v_add_u32 v58, 100352, v29
  v_add_u32 v59, 148480, v28
  v_and_b32 v11, 15, v2
  v_xor_b32 v11, s18, v11
  v_and_b32 v12, 48, v2
  v_add_u32 v11, v11, v12
  v_lshlrev_b32 v11, 2, v11
  v_add_u32 v11, 158208, v11
  s_lshl_b32 s39, s18, 7
  s_lshl_b32 s32, s17, 18
  s_add_u32 s32, s32, 0xc00000
  s_mov_b32 s30, 0
  s_mov_b32 s29, 0
  s_mov_b32 s37, 0
  v_mov_b32 v6, s71
  s_mov_b32 s38, 0
.g2_kernel_wg40:
  ds_read_b32 v7, v6 offset:16
  s_add_u32 s38, s38, 1
  s_waitcnt lgkmcnt(0)
  v_cmp_gt_u32 vcc, 4, v7
  s_cbranch_vccz .g2_kernel_wg40d
  s_sleep 2
  s_cmp_lt_u32 s38, 524288
  s_cbranch_scc1 .g2_kernel_wg40
.g2_kernel_wg40d:
  s_xor_b32 s36, s18, 0
  s_mul_i32 s36, s36, 393216
  s_add_u32 s36, s36, s39
  s_add_u32 m0, s30, 65536
  s_waitcnt vmcnt(63)
  buffer_load_dwordx4 v48, s[12:15], s36 offen offset:0 lds
  buffer_load_dwordx4 v49, s[12:15], s36 offen offset:1024 lds
  buffer_load_dwordx4 v50, s[12:15], s36 offen offset:2048 lds
  buffer_load_dwordx4 v51, s[12:15], s36 offen offset:3072 lds
  s_add_u32 m0, s30, 69632
  s_waitcnt vmcnt(63)
  buffer_load_dwordx4 v52, s[12:15], s36 offen offset:0 lds
  buffer_load_dwordx4 v53, s[12:15], s36 offen offset:1024 lds
  buffer_load_dwordx4 v54, s[12:15], s36 offen offset:2048 lds
  buffer_load_dwordx4 v55, s[12:15], s36 offen offset:3072 lds
  s_add_u32 m0, s30, 73728
  s_waitcnt vmcnt(63)
  buffer_load_dwordx4 v56, s[12:15], s36 offen offset:0 lds
  buffer_load_dwordx4 v57, s[12:15], s36 offen offset:1024 lds
  buffer_load_dwordx4 v58, s[12:15], s36 offen offset:2048 lds
  buffer_load_dwordx4 v59, s[12:15], s36 offen offset:3072 lds
  s_add_u32 s30, s30, 12288
  s_cmp_eq_u32 s30, 86016
  s_cselect_b32 s30, 0, s30
  s_xor_b32 s36, s18, 0
  s_mul_i32 s36, s36, 393216
  s_add_u32 s36, s36, s39
  s_add_u32 s36, s36, 196608
  s_add_u32 m0, s30, 65536
  s_waitcnt vmcnt(63)
  buffer_load_dwordx4 v48, s[12:15], s36 offen offset:0 lds
  buffer_load_dwordx4 v49, s[12:15], s36 offen offset:1024 lds
  buffer_load_dwordx4 v50, s[12:15], s36 offen offset:2048 lds
  buffer_load_dwordx4 v51, s[12:15], s36 offen offset:3072 lds
  s_add_u32 m0, s30, 69632
  s_waitcnt vmcnt(63)
  buffer_load_dwordx4 v52, s[12:15], s36 offen offset:0 lds
  buffer_load_dwordx4 v53, s[12:15], s36 offen offset:1024 lds
  buffer_load_dwordx4 v54, s[12:15], s36 offen offset:2048 lds
  buffer_load_dwordx4 v55, s[12:15], s36 offen offset:3072 lds
  s_add_u32 m0, s30, 73728
  s_waitcnt vmcnt(63)
  buffer_load_dwordx4 v56, s[12:15], s36 offen offset:0 lds
  buffer_load_dwordx4 v57, s[12:15], s36 offen offset:1024 lds
  buffer_load_dwordx4 v58, s[12:15], s36 offen offset:2048 lds
  buffer_load_dwordx4 v59, s[12:15], s36 offen offset:3072 lds
  s_add_u32 s30, s30, 12288
  s_cmp_eq_u32 s30, 86016
  s_cselect_b32 s30, 0, s30
  s_mov_b32 m0, 156160
  s_mov_b32 s35, .g2_kernel_tab-.g2_kernel_pc+136
  s_mov_b64 exec, 1
  buffer_load_dword off, s[64:67], s35 lds
  s_mov_b64 exec, -1
  s_xor_b32 s36, s18, 1
  s_mul_i32 s36, s36, 393216
  s_add_u32 s36, s36, s39
  s_add_u32 m0, s30, 65536
  s_waitcnt vmcnt(63)
  buffer_load_dwordx4 v48, s[12:15], s36 offen offset:0 lds
  buffer_load_dwordx4 v49, s[12:15], s36 offen offset:1024 lds
  buffer_load_dwordx4 v50, s[12:15], s36 offen offset:2048 lds
  buffer_load_dwordx4 v51, s[12:15], s36 offen offset:3072 lds
  s_add_u32 m0, s30, 69632
  s_waitcnt vmcnt(63)
  buffer_load_dwordx4 v52, s[12:15], s36 offen offset:0 lds
  buffer_load_dwordx4 v53, s[12:15], s36 offen offset:1024 lds
  buffer_load_dwordx4 v54, s[12:15], s36 offen offset:2048 lds
  buffer_load_dwordx4 v55, s[12:15], s36 offen offset:3072 lds
  s_add_u32 m0, s30, 73728
  s_waitcnt vmcnt(63)
  buffer_load_dwordx4 v56, s[12:15], s36 offen offset:0 lds
  buffer_load_dwordx4 v57, s[12:15], s36 offen offset:1024 lds
  buffer_load_dwordx4 v58, s[12:15], s36 offen offset:2048 lds
  buffer_load_dwordx4 v59, s[12:15], s36 offen offset:3072 lds
  s_add_u32 s30, s30, 12288
  s_cmp_eq_u32 s30, 86016
  s_cselect_b32 s30, 0, s30
  s_xor_b32 s36, s18, 1
  s_mul_i32 s36, s36, 393216
  s_add_u32 s36, s36, s39
  s_add_u32 s36, s36, 196608
  s_add_u32 m0, s30, 65536
  s_waitcnt vmcnt(63)
  buffer_load_dwordx4 v48, s[12:15], s36 offen offset:0 lds
  buffer_load_dwordx4 v49, s[12:15], s36 offen offset:1024 lds
  buffer_load_dwordx4 v50, s[12:15], s36 offen offset:2048 lds
  buffer_load_dwordx4 v51, s[12:15], s36 offen offset:3072 lds
  s_add_u32 m0, s30, 69632
  s_waitcnt vmcnt(63)
  buffer_load_dwordx4 v52, s[12:15], s36 offen offset:0 lds
  buffer_load_dwordx4 v53, s[12:15], s36 offen offset:1024 lds
  buffer_load_dwordx4 v54, s[12:15], s36 offen offset:2048 lds
  buffer_load_dwordx4 v55, s[12:15], s36 offen offset:3072 lds
  s_add_u32 m0, s30, 73728
  s_waitcnt vmcnt(63)
  buffer_load_dwordx4 v56, s[12:15], s36 offen offset:0 lds
  buffer_load_dwordx4 v57, s[12:15], s36 offen offset:1024 lds
  buffer_load_dwordx4 v58, s[12:15], s36 offen offset:2048 lds
  buffer_load_dwordx4 v59, s[12:15], s36 offen offset:3072 lds
  s_add_u32 s30, s30, 12288
  s_cmp_eq_u32 s30, 86016
  s_cselect_b32 s30, 0, s30
  s_xor_b32 s36, s18, 2
  s_mul_i32 s36, s36, 393216
  s_add_u32 s36, s36, s39
  s_add_u32 m0, s30, 65536
  s_waitcnt vmcnt(63)
  buffer_load_dwordx4 v48, s[12:15], s36 offen offset:0 lds
  buffer_load_dwordx4 v49, s[12:15], s36 offen offset:1024 lds
  buffer_load_dwordx4 v50, s[12:15], s36 offen offset:2048 lds
  buffer_load_dwordx4 v51, s[12:15], s36 offen offset:3072 lds
  s_add_u32 m0, s30, 69632
  s_waitcnt vmcnt(63)
  buffer_load_dwordx4 v52, s[12:15], s36 offen offset:0 lds
  buffer_load_dwordx4 v53, s[12:15], s36 offen offset:1024 lds
  buffer_load_dwordx4 v54, s[12:15], s36 offen offset:2048 lds
  buffer_load_dwordx4 v55, s[12:15], s36 offen offset:3072 lds
  s_add_u32 m0, s30, 73728
  s_waitcnt vmcnt(63)
  buffer_load_dwordx4 v56, s[12:15], s36 offen offset:0 lds
  buffer_load_dwordx4 v57, s[12:15], s36 offen offset:1024 lds
  buffer_load_dwordx4 v58, s[12:15], s36 offen offset:2048 lds
  buffer_load_dwordx4 v59, s[12:15], s36 offen offset:3072 lds
  s_add_u32 s30, s30, 12288
  s_cmp_eq_u32 s30, 86016
  s_cselect_b32 s30, 0, s30
  v_mov_b32 v6, s71
  s_mov_b32 s38, 0
.g2_kernel_wg41:
  ds_read_b32 v7, v6 offset:20
  s_add_u32 s38, s38, 1
  s_waitcnt lgkmcnt(0)
  v_cmp_gt_u32 vcc, 4, v7
  s_cbranch_vccz .g2_kernel_wg41d
  s_sleep 1
  s_cmp_lt_u32 s38, 524288
  s_cbranch_scc1 .g2_kernel_wg41
.g2_kernel_wg41d:
  s_mov_b32 s62, 1
  s_mov_b32 s63, 0x1800000
  s_mov_b32 s70, 2
  s_mov_b32 s71, 155776
  s_xor_b32 s36, s18, 2
  s_mul_i32 s36, s36, 393216
  s_add_u32 s36, s36, s39
  s_add_u32 s36, s36, 196608
  s_add_u32 m0, s30, 65536
  s_waitcnt vmcnt(63)
  buffer_load_dwordx4 v48, s[12:15], s36 offen offset:0 lds
  buffer_load_dwordx4 v49, s[12:15], s36 offen offset:1024 lds
  buffer_load_dwordx4 v50, s[12:15], s36 offen offset:2048 lds
  buffer_load_dwordx4 v51, s[12:15], s36 offen offset:3072 lds
  s_add_u32 m0, s30, 69632
  s_waitcnt vmcnt(63)
  buffer_load_dwordx4 v52, s[12:15], s36 offen offset:0 lds
  buffer_load_dwordx4 v53, s[12:15], s36 offen offset:1024 lds
  buffer_load_dwordx4 v54, s[12:15], s36 offen offset:2048 lds
  buffer_load_dwordx4 v55, s[12:15], s36 offen offset:3072 lds
  s_add_u32 m0, s30, 73728
  s_waitcnt vmcnt(63)
  buffer_load_dwordx4 v56, s[12:15], s36 offen offset:0 lds
  buffer_load_dwordx4 v57, s[12:15], s36 offen offset:1024 lds
  buffer_load_dwordx4 v58, s[12:15], s36 offen offset:2048 lds
  buffer_load_dwordx4 v59, s[12:15], s36 offen offset:3072 lds
  s_add_u32 s30, s30, 12288
  s_cmp_eq_u32 s30, 86016
  s_cselect_b32 s30, 0, s30
  s_xor_b32 s36, s18, 3
  s_mul_i32 s36, s36, 393216
  s_add_u32 s36, s36, s39
  s_add_u32 m0, s30, 65536
  s_waitcnt vmcnt(63)
  buffer_load_dwordx4 v48, s[12:15], s36 offen offset:0 lds
  buffer_load_dwordx4 v49, s[12:15], s36 offen offset:1024 lds
  buffer_load_dwordx4 v50, s[12:15], s36 offen offset:2048 lds
  buffer_load_dwordx4 v51, s[12:15], s36 offen offset:3072 lds
  s_add_u32 m0, s30, 69632
  s_waitcnt vmcnt(63)
  buffer_load_dwordx4 v52, s[12:15], s36 offen offset:0 lds
  buffer_load_dwordx4 v53, s[12:15], s36 offen offset:1024 lds
  buffer_load_dwordx4 v54, s[12:15], s36 offen offset:2048 lds
  buffer_load_dwordx4 v55, s[12:15], s36 offen offset:3072 lds
  s_add_u32 m0, s30, 73728
  s_waitcnt vmcnt(63)
  buffer_load_dwordx4 v56, s[12:15], s36 offen offset:0 lds
  buffer_load_dwordx4 v57, s[12:15], s36 offen offset:1024 lds
  buffer_load_dwordx4 v58, s[12:15], s36 offen offset:2048 lds
  buffer_load_dwordx4 v59, s[12:15], s36 offen offset:3072 lds
  s_add_u32 s30, s30, 12288
  s_cmp_eq_u32 s30, 86016
  s_cselect_b32 s30, 0, s30
  s_mov_b32 s28, 1
  s_mov_b32 s29, 16384
  s_bitcmp1_b32 s37, s28
  s_cbranch_scc0 .g2_kernel_p2_x0w
.g2_kernel_p2_x0b:
  s_xor_b32 s33, s28, s18
  s_lshl_b32 s33, s33, 14
  s_add_u32 s33, s33, s32
  s_add_u32 m0, s29, 0
  s_waitcnt vmcnt(63)
  buffer_load_dwordx4 v3, s[4:7], s33 offen offset:0 lds
  buffer_load_dwordx4 v3, s[4:7], s33 offen offset:1024 lds
  buffer_load_dwordx4 v3, s[4:7], s33 offen offset:2048 lds
  buffer_load_dwordx4 v3, s[4:7], s33 offen offset:3072 lds
  s_add_u32 m0, s29, 4096
  s_waitcnt vmcnt(63)
  s_add_u32 s33, s33, 4096
  buffer_load_dwordx4 v3, s[4:7], s33 offen offset:0 lds
  buffer_load_dwordx4 v3, s[4:7], s33 offen offset:1024 lds
  buffer_load_dwordx4 v3, s[4:7], s33 offen offset:2048 lds
  buffer_load_dwordx4 v3, s[4:7], s33 offen offset:3072 lds
  s_add_u32 m0, s29, 8192
  s_waitcnt vmcnt(63)
  s_add_u32 s33, s33, 4096
  buffer_load_dwordx4 v3, s[4:7], s33 offen offset:0 lds
  buffer_load_dwordx4 v3, s[4:7], s33 offen offset:1024 lds
  buffer_load_dwordx4 v3, s[4:7], s33 offen offset:2048 lds
  buffer_load_dwordx4 v3, s[4:7], s33 offen offset:3072 lds
  s_add_u32 m0, s29, 12288
  s_waitcnt vmcnt(63)
  s_add_u32 s33, s33, 4096
  buffer_load_dwordx4 v3, s[4:7], s33 offen offset:0 lds
  buffer_load_dwordx4 v3, s[4:7], s33 offen offset:1024 lds
  buffer_load_dwordx4 v3, s[4:7], s33 offen offset:2048 lds
  buffer_load_dwordx4 v3, s[4:7], s33 offen offset:3072 lds
  s_mov_b32 m0, 156160
  s_mov_b32 s35, .g2_kernel_tab-.g2_kernel_pc+144
  s_mov_b64 exec, 1
  buffer_load_dword off, s[64:67], s35 lds
  s_mov_b64 exec, -1
  s_mov_b32 s28, 2
  s_mov_b32 s29, 32768
  s_bitcmp1_b32 s37, s28
  s_cbranch_scc0 .g2_kernel_p2_x1w
.g2_kernel_p2_x1b:
  s_xor_b32 s33, s28, s18
  s_lshl_b32 s33, s33, 14
  s_add_u32 s33, s33, s32
  s_add_u32 m0, s29, 0
  s_waitcnt vmcnt(63)
  buffer_load_dwordx4 v3, s[4:7], s33 offen offset:0 lds
  buffer_load_dwordx4 v3, s[4:7], s33 offen offset:1024 lds
  buffer_load_dwordx4 v3, s[4:7], s33 offen offset:2048 lds
  buffer_load_dwordx4 v3, s[4:7], s33 offen offset:3072 lds
  s_add_u32 m0, s29, 4096
  s_waitcnt vmcnt(63)
  s_add_u32 s33, s33, 4096
  buffer_load_dwordx4 v3, s[4:7], s33 offen offset:0 lds
  buffer_load_dwordx4 v3, s[4:7], s33 offen offset:1024 lds
  buffer_load_dwordx4 v3, s[4:7], s33 offen offset:2048 lds
  buffer_load_dwordx4 v3, s[4:7], s33 offen offset:3072 lds
  s_add_u32 m0, s29, 8192
  s_waitcnt vmcnt(63)
  s_add_u32 s33, s33, 4096
  buffer_load_dwordx4 v3, s[4:7], s33 offen offset:0 lds
  buffer_load_dwordx4 v3, s[4:7], s33 offen offset:1024 lds
  buffer_load_dwordx4 v3, s[4:7], s33 offen offset:2048 lds
  buffer_load_dwordx4 v3, s[4:7], s33 offen offset:3072 lds
  s_add_u32 m0, s29, 12288
  s_waitcnt vmcnt(63)
  s_add_u32 s33, s33, 4096
  buffer_load_dwordx4 v3, s[4:7], s33 offen offset:0 lds
  buffer_load_dwordx4 v3, s[4:7], s33 offen offset:1024 lds
  buffer_load_dwordx4 v3, s[4:7], s33 offen offset:2048 lds
  buffer_load_dwordx4 v3, s[4:7], s33 offen offset:3072 lds
  s_mov_b32 m0, 156160
  s_mov_b32 s35, .g2_kernel_tab-.g2_kernel_pc+152
  s_mov_b64 exec, 1
  buffer_load_dword off, s[64:67], s35 lds
  s_mov_b64 exec, -1
  s_mov_b32 s28, 3
  s_mov_b32 s29, 49152
  s_bitcmp1_b32 s37, s28
  s_cbranch_scc0 .g2_kernel_p2_x2w
.g2_kernel_p2_x2b:
  s_xor_b32 s33, s28, s18
  s_lshl_b32 s33, s33, 14
  s_add_u32 s33, s33, s32
  s_add_u32 m0, s29, 0
  s_waitcnt vmcnt(63)
  buffer_load_dwordx4 v3, s[4:7], s33 offen offset:0 lds
  buffer_load_dwordx4 v3, s[4:7], s33 offen offset:1024 lds
  buffer_load_dwordx4 v3, s[4:7], s33 offen offset:2048 lds
  buffer_load_dwordx4 v3, s[4:7], s33 offen offset:3072 lds
  s_add_u32 m0, s29, 4096
  s_waitcnt vmcnt(63)
  s_add_u32 s33, s33, 4096
  buffer_load_dwordx4 v3, s[4:7], s33 offen offset:0 lds
  buffer_load_dwordx4 v3, s[4:7], s33 offen offset:1024 lds
  buffer_load_dwordx4 v3, s[4:7], s33 offen offset:2048 lds
  buffer_load_dwordx4 v3, s[4:7], s33 offen offset:3072 lds
  s_add_u32 m0, s29, 8192
  s_waitcnt vmcnt(63)
  s_add_u32 s33, s33, 4096
  buffer_load_dwordx4 v3, s[4:7], s33 offen offset:0 lds
  buffer_load_dwordx4 v3, s[4:7], s33 offen offset:1024 lds
  buffer_load_dwordx4 v3, s[4:7], s33 offen offset:2048 lds
  buffer_load_dwordx4 v3, s[4:7], s33 offen offset:3072 lds
  s_add_u32 m0, s29, 12288
  s_waitcnt vmcnt(63)
  s_add_u32 s33, s33, 4096
  buffer_load_dwordx4 v3, s[4:7], s33 offen offset:0 lds
  buffer_load_dwordx4 v3, s[4:7], s33 offen offset:1024 lds
  buffer_load_dwordx4 v3, s[4:7], s33 offen offset:2048 lds
  buffer_load_dwordx4 v3, s[4:7], s33 offen offset:3072 lds
  s_mov_b32 m0, 156160
  s_mov_b32 s35, .g2_kernel_tab-.g2_kernel_pc+156
  s_mov_b64 exec, 1
  buffer_load_dword off, s[64:67], s35 lds
  s_mov_b64 exec, -1
  s_xor_b32 s36, s18, 3
  s_mul_i32 s36, s36, 393216
  s_add_u32 s36, s36, s39
  s_add_u32 s36, s36, 196608
  ds_read_b32 v10, v9
  s_mov_b32 s34, 33
  s_mov_b32 s35, .g2_kernel_tab-.g2_kernel_pc+160
  s_branch .g2_kernel_p2_o
  .p2align 6
.g2_kernel_p2_l:
  s_waitcnt lgkmcnt(0)
  v_cmp_gt_i32 vcc, s34, v10
  s_cbranch_vccnz .g2_kernel_p2_aw
.g2_kernel_p2_ai:
  s_add_u32 s29, s29, 16384
  s_and_b32 s29, s29, 0xffff
  s_bitcmp1_b32 s37, s28
  s_cbranch_scc0 .g2_kernel_p2_x3w
.g2_kernel_p2_x3b:
  s_xor_b32 s33, s28, s18
  s_lshl_b32 s33, s33, 14
  s_add_u32 s33, s33, s32
  s_add_u32 m0, s29, 0
  s_waitcnt vmcnt(63)
  buffer_load_dwordx4 v3, s[4:7], s33 offen offset:0 lds
  buffer_load_dwordx4 v3, s[4:7], s33 offen offset:1024 lds
  buffer_load_dwordx4 v3, s[4:7], s33 offen offset:2048 lds
  buffer_load_dwordx4 v3, s[4:7], s33 offen offset:3072 lds
  s_add_u32 m0, s29, 4096
  s_waitcnt vmcnt(63)
  s_add_u32 s33, s33, 4096
  buffer_load_dwordx4 v3, s[4:7], s33 offen offset:0 lds
  buffer_load_dwordx4 v3, s[4:7], s33 offen offset:1024 lds
  buffer_load_dwordx4 v3, s[4:7], s33 offen offset:2048 lds
  buffer_load_dwordx4 v3, s[4:7], s33 offen offset:3072 lds
  s_add_u32 m0, s29, 8192
  s_waitcnt vmcnt(63)
  s_add_u32 s33, s33, 4096
  buffer_load_dwordx4 v3, s[4:7], s33 offen offset:0 lds
  buffer_load_dwordx4 v3, s[4:7], s33 offen offset:1024 lds
  buffer_load_dwordx4 v3, s[4:7], s33 offen offset:2048 lds
  buffer_load_dwordx4 v3, s[4:7], s33 offen offset:3072 lds
  s_add_u32 m0, s29, 12288
  s_waitcnt vmcnt(63)
  s_add_u32 s33, s33, 4096
  buffer_load_dwordx4 v3, s[4:7], s33 offen offset:0 lds
  buffer_load_dwordx4 v3, s[4:7], s33 offen offset:1024 lds
  buffer_load_dwordx4 v3, s[4:7], s33 offen offset:2048 lds
  buffer_load_dwordx4 v3, s[4:7], s33 offen offset:3072 lds
  s_add_u32 m0, s30, 65536
  s_waitcnt vmcnt(63)
  buffer_load_dwordx4 v48, s[12:15], s36 offen offset:0 lds
  buffer_load_dwordx4 v49, s[12:15], s36 offen offset:1024 lds
  buffer_load_dwordx4 v50, s[12:15], s36 offen offset:2048 lds
  buffer_load_dwordx4 v51, s[12:15], s36 offen offset:3072 lds
  s_add_u32 m0, s30, 69632
  s_waitcnt vmcnt(63)
  buffer_load_dwordx4 v52, s[12:15], s36 offen offset:0 lds
  buffer_load_dwordx4 v53, s[12:15], s36 offen offset:1024 lds
  buffer_load_dwordx4 v54, s[12:15], s36 offen offset:2048 lds
  buffer_load_dwordx4 v55, s[12:15], s36 offen offset:3072 lds
  s_add_u32 m0, s30, 73728
  s_waitcnt vmcnt(63)
  buffer_load_dwordx4 v56, s[12:15], s36 offen offset:0 lds
  buffer_load_dwordx4 v57, s[12:15], s36 offen offset:1024 lds
  buffer_load_dwordx4 v58, s[12:15], s36 offen offset:2048 lds
  buffer_load_dwordx4 v59, s[12:15], s36 offen offset:3072 lds
  s_add_u32 s30, s30, 12288
  s_cmp_eq_u32 s30, 86016
  s_cselect_b32 s30, 0, s30
  ds_read_b32 v10, v9
  s_mov_b32 m0, 156160
  s_add_u32 s34, s34, 1
  s_mov_b64 exec, 1
  buffer_load_dword off, s[64:67], s35 lds
  s_mov_b64 exec, -1
  s_add_u32 s35, s35, 4
  s_add_u32 s36, s36, 196608
.g2_kernel_p2_o:
  s_waitcnt lgkmcnt(0)
  v_cmp_gt_i32 vcc, s34, v10
  s_cbranch_vccnz .g2_kernel_p2_bw
.g2_kernel_p2_bi:
  s_add_u32 m0, s30, 65536
  s_waitcnt vmcnt(63)
  buffer_load_dwordx4 v48, s[12:15], s36 offen offset:0 lds
  buffer_load_dwordx4 v49, s[12:15], s36 offen offset:1024 lds
  buffer_load_dwordx4 v50, s[12:15], s36 offen offset:2048 lds
  buffer_load_dwordx4 v51, s[12:15], s36 offen offset:3072 lds
  s_add_u32 m0, s30, 69632
  s_waitcnt vmcnt(63)
  buffer_load_dwordx4 v52, s[12:15], s36 offen offset:0 lds
  buffer_load_dwordx4 v53, s[12:15], s36 offen offset:1024 lds
  buffer_load_dwordx4 v54, s[12:15], s36 offen offset:2048 lds
  buffer_load_dwordx4 v55, s[12:15], s36 offen offset:3072 lds
  s_add_u32 m0, s30, 73728
  s_waitcnt vmcnt(63)
  buffer_load_dwordx4 v56, s[12:15], s36 offen offset:0 lds
  buffer_load_dwordx4 v57, s[12:15], s36 offen offset:1024 lds
  buffer_load_dwordx4 v58, s[12:15], s36 offen offset:2048 lds
  buffer_load_dwordx4 v59, s[12:15], s36 offen offset:3072 lds
  s_add_u32 s30, s30, 12288
  s_cmp_eq_u32 s30, 86016
  s_cselect_b32 s30, 0, s30
  ds_read_b32 v10, v9
  s_mov_b32 m0, 156160
  s_add_u32 s34, s34, 1
  s_mov_b64 exec, 1
  buffer_load_dword off, s[64:67], s35 lds
  s_mov_b64 exec, -1
  s_add_u32 s35, s35, 4
  s_add_u32 s28, s28, 1
  s_xor_b32 s36, s18, s28
  s_mul_i32 s36, s36, 393216
  s_add_u32 s36, s36, s39
  s_cmp_lt_i32 s34, 58
  s_cbranch_scc1 .g2_kernel_p2_l
  s_branch .g2_kernel_v
.g2_kernel_c1:
  v_mov_b32 v6, s71
  s_mov_b32 s38, 0
.g2_kernel_wg42:
  ds_read_b32 v7, v6 offset:76
  s_add_u32 s38, s38, 1
  s_waitcnt lgkmcnt(0)
  v_cmp_gt_u32 vcc, 1, v7
  s_cbranch_vccz .g2_kernel_wg42d
  s_sleep 1
  s_cmp_lt_u32 s38, 524288
  s_cbranch_scc1 .g2_kernel_wg42
.g2_kernel_wg42d:
  s_sleep 4
  s_and_b32 s31, s19, 0xffffe000
  s_add_u32 s31, s31, 4
  v_and_b32 v6, 15, v2
  v_lshlrev_b32 v6, 9, v6
  v_lshrrev_b32 v7, 4, v2
  v_lshl_add_u32 v6, v7, 7, v6
  v_lshlrev_b32 v7, 2, v2
  v_add_u32 v7, 157952, v7
  s_mov_b32 m0, 157952
  s_mov_b32 s38, 0
  s_bfm_b64 exec, 16, 48
.g2_kernel_pa43:
  buffer_load_dword v6, s[4:7], s31 offen sc1 lds
  s_add_u32 s38, s38, 1
  s_waitcnt vmcnt(0)
  ds_read_b32 v8, v7
  s_waitcnt lgkmcnt(0)
  v_cmp_ge_u32 vcc, s62, v8
  s_cbranch_vccz .g2_kernel_pa43d
  s_mov_b64 exec, vcc
  s_sleep 4
  s_cmp_lt_u32 s38, 131072
  s_cbranch_scc1 .g2_kernel_pa43
.g2_kernel_pa43d:
  s_mov_b64 exec, -1
  s_setprio 2
  s_mov_b32 s39, 0
  s_lshl_b32 s30, s17, 2
  s_lshr_b32 s28, s18, 2
  s_add_u32 s30, s30, s28
  s_lshl_b32 s20, s30, 13
  s_add_u32 s20, s20, s63
  s_add_u32 s20, s20, 0x1000000
  s_add_u32 s24, s20, 4096
  s_lshl_b32 s21, s30, 8
  s_add_u32 s21, s21, s63
  s_add_u32 s21, s21, 0x1080000
  s_lshl_b32 s23, s62, 16
  s_add_u32 s23, s23, 0x3040000
  s_lshl_b32 s22, s30, 7
  s_add_u32 s22, s22, s23
  s_and_b32 s28, s2, 7
  s_lshl_b32 s28, s28, 13
  s_add_u32 s23, s23, s28
  v_mov_b32 v9, 155648
  ds_read_b32 v26, v9 offset:256
  v_and_b32 v24, 31, v2
  v_lshlrev_b32 v25, 3, v2
  v_lshlrev_b32 v27, 13, v2
  v_mov_b32 v28, 0.0009765625
  v_mov_b32 v30, 1e-05
  v_mov_b32 v6, s71
  s_mov_b32 s38, 0
.g2_kernel_wg45:
  ds_read_b32 v7, v6 offset:20
  s_add_u32 s38, s38, 1
  s_waitcnt lgkmcnt(0)
  v_cmp_gt_u32 vcc, 4, v7
  s_cbranch_vccz .g2_kernel_wg45d
  s_sleep 1
  s_cmp_lt_u32 s38, 524288
  s_cbranch_scc1 .g2_kernel_wg45
.g2_kernel_wg45d:
  s_sleep 12
  s_cmp_lg_u32 s62, 0
  s_cbranch_scc1 .g2_kernel_nap46
  s_sleep 12
.g2_kernel_nap46:
  s_xor_b32 s28, s17, s18
  s_and_b32 s28, s28, 3
  s_cbranch_scc1 .g2_kernel_c_l1
  s_mov_b32 s38, 0
.g2_kernel_gx47:
  buffer_load_dwordx4 v[32:35], v3, s[4:7], s20 offen offset:0 sc1
  buffer_load_dwordx4 v[36:39], v3, s[4:7], s20 offen offset:1024 sc1
  buffer_load_dwordx4 v[40:43], v3, s[4:7], s20 offen offset:2048 sc1
  buffer_load_dwordx4 v[44:47], v3, s[4:7], s20 offen offset:3072 sc1
  buffer_load_dwordx4 v[48:51], v3, s[4:7], s24 offen offset:0 sc1
  buffer_load_dwordx4 v[52:55], v3, s[4:7], s24 offen offset:1024 sc1
  buffer_load_dwordx4 v[56:59], v3, s[4:7], s24 offen offset:2048 sc1
  buffer_load_dwordx4 v[60:63], v3, s[4:7], s24 offen offset:3072 sc1
  s_add_u32 s38, s38, 1
  s_waitcnt vmcnt(0)
  v_min3_u32 v6, v32, v35, v36
  v_min3_u32 v6, v6, v39, v40
  v_min3_u32 v6, v6, v43, v44
  v_min3_u32 v6, v6, v47, v48
  v_min3_u32 v6, v6, v51, v52
  v_min3_u32 v6, v6, v55, v56
  v_min3_u32 v6, v6, v59, v60
  v_min_u32 v6, v6, v63
  v_cmp_eq_u32 vcc, 0, v6
  s_cbranch_vccz .g2_kernel_gx47d
  s_mov_b64 exec, vcc
  s_sleep 1
  s_cmp_lg_u32 s62, 0
  s_cbranch_scc1 .g2_kernel_nap48
  s_sleep 9
.g2_kernel_nap48:
  s_cmp_lt_u32 s38, 131072
  s_cbranch_scc1 .g2_kernel_gx47
.g2_kernel_gx47d:
  s_mov_b64 exec, -1
  v_add_f32 v32, v32, v48
  v_add_f32 v33, v33, v49
  v_add_f32 v34, v34, v50
  v_add_f32 v36, v36, v52
  v_add_f32 v37, v37, v53
  v_add_f32 v38, v38, v54
  v_add_f32 v40, v40, v56
  v_add_f32 v41, v41, v57
  v_add_f32 v42, v42, v58
  v_add_f32 v44, v44, v60
  v_add_f32 v45, v45, v61
  v_add_f32 v46, v46, v62
  v_add_f32 v32, v32, v40
  v_add_f32 v33, v33, v41
  v_add_f32 v34, v34, v42
  v_add_f32 v36, v36, v44
  v_add_f32 v37, v37, v45
  v_add_f32 v38, v38, v46
  v_add_f32 v32, v32, v36
  v_add_f32 v33, v33, v37
  v_add_f32 v34, v34, v38
  v_mov_b32 v16, v32
  v_mov_b32 v17, v33
  v_mov_b32 v18, v34
  s_mov_b32 s28, -32
  v_permlane32_swap_b32 v16, v32
  v_permlane32_swap_b32 v17, v33
  v_permlane32_swap_b32 v18, v34
  v_add_f32 v16, v16, v32
  v_add_f32 v17, v17, v33
  v_add_f32 v18, v18, v34
  v_fma_f32 v18, -v16, v26, v18
  v_mul_f32 v16, v28, v16
  v_mul_f32 v19, v16, v16
  v_fma_f32 v17, v17, v28, -v19
  v_max_f32 v17, 0, v17
  v_add_f32 v17, v30, v17
  v_rsq_f32 v19, v17
  v_mov_b32 v11, 1
  v_mul_f32 v18, v18, v19
  v_and_or_b32 v10, v18, s28, v24
  s_nop 1
  v_max_f32 v10, v10, v10 row_ror:8 row_mask:0xf bank_mask:0xf
  s_nop 1
  v_max_f32 v10, v10, v10 row_ror:4 row_mask:0xf bank_mask:0xf
  s_nop 1
  v_max_f32 v10, v10, v10 row_ror:2 row_mask:0xf bank_mask:0xf
  s_nop 1
  v_max_f32 v10, v10, v10 row_ror:1 row_mask:0xf bank_mask:0xf
  s_nop 1
  v_max_f32 v10, v10, v10 row_bcast:15 row_mask:0xa bank_mask:0xf
  s_nop 0
  v_readlane_b32 s28, v10, 31
  s_nop 1
  v_mov_b32 v10, s28
  s_mov_b64 exec, 0xff
  buffer_store_dwordx2 v[10:11], v27, s[4:7], s22 offen sc1
  s_mov_b32 exec_lo, -1
  buffer_store_dwordx2 v[16:17], v25, s[4:7], s21 offen sc1
  s_mov_b64 exec, -1
.g2_kernel_c_l1:
  s_cmp_lg_u32 s62, 0
  s_cbranch_scc1 .g2_kernel_c_t3
  s_sleep 30
  s_mov_b64 s[8:9], -1
  s_call_b64 s[68:69], .g2_kernel_amax
  s_lshr_b32 s28, s77, 5
  s_add_u32 m0, s71, 104
  s_lshl_b32 s29, s28, 2
  s_add_u32 s29, s29, .g2_kernel_tab-.g2_kernel_pc
  s_mov_b64 exec, 1
  buffer_load_dword off, s[64:67], s29 lds
  s_mov_b64 exec, -1
  s_and_b32 s28, s77, 31
  s_add_u32 s28, s28, 1
  s_add_u32 m0, s71, 36
  s_lshl_b32 s29, s28, 2
  s_add_u32 s29, s29, .g2_kernel_tab-.g2_kernel_pc
  s_mov_b64 exec, 1
  buffer_load_dword off, s[64:67], s29 lds
  s_mov_b64 exec, -1
  s_lshr_b32 s24, s77, 7
  s_lshl_b32 s24, s24, 18
  s_bfe_u32 s28, s77, 0x30004
  s_lshl_b32 s28, s28, 11
  s_add_u32 s24, s24, s28
  s_and_b32 s28, s77, 15
  s_lshl_b32 s28, s28, 4
  s_add_u32 s24, s24, s28
  s_add_u32 s24, s24, s63
  s_add_u32 s24, s24, 0xc00000
  s_lshl_b32 s28, s17, 14
  s_add_u32 s24, s24, s28
  s_and_b32 s28, s18, 1
  s_lshl_b32 s28, s28, 8
  s_add_u32 s24, s24, s28
  v_lshrrev_b32 v12, 3, v2
  v_lshlrev_b32 v13, 1, v12
  buffer_load_ushort v56, v13, s[4:7], s24 offen offset:0
  buffer_load_ushort v57, v13, s[4:7], s24 offen offset:512
  buffer_load_ushort v58, v13, s[4:7], s24 offen offset:1024
  buffer_load_ushort v59, v13, s[4:7], s24 offen offset:1536
  s_lshl_b32 s25, s77, 3
  s_add_u32 s25, s25, s63
  s_add_u32 s25, s25, 0x1080000
  s_lshl_b32 s21, s17, 10
  s_add_u32 s21, s21, s63
  s_add_u32 s21, s21, 0x1080000
  s_mov_b32 s38, 0
.g2_kernel_gx49:
  buffer_load_dwordx4 v[16:19], v3, s[4:7], s21 offen sc1
  buffer_load_dwordx2 v[20:21], v4, s[4:7], s25 offen sc1
  s_add_u32 s38, s38, 1
  s_waitcnt vmcnt(0)
  v_min3_u32 v6, v17, v19, v21
  v_cmp_eq_u32 vcc, 0, v6
  s_cbranch_vccz .g2_kernel_gx49d
  s_mov_b64 exec, vcc
  s_sleep 1
  s_cmp_lt_u32 s38, 131072
  s_cbranch_scc1 .g2_kernel_gx49
.g2_kernel_gx49d:
  s_mov_b64 exec, -1
  s_lshr_b32 s28, s77, 7
  s_and_b32 s79, s77, 127
  s_add_u32 s79, s79, 1
  s_cmp_eq_u32 s28, s17
  s_cselect_b32 s79, s79, 0
  v_rsq_f32 v22, v17
  v_rsq_f32 v23, v19
  v_rsq_f32 v21, v21
  v_mov_b32 v62, -1.4426950408889634
  v_mul_f32 v62, s27, v62
  v_exp_f32 v62, v62
  v_lshlrev_b32 v14, 3, v2
  v_add_u32 v14, 155648, v14
  v_mov_b32 v15, s79
  v_add_f32 v52, 1.0, v22
  v_mul_f32 v54, v16, v22
  v_sub_f32 v54, 0, v54
  v_add_f32 v53, 1.0, v23
  v_mul_f32 v55, v18, v23
  v_sub_f32 v55, 0, v55
  v_add_f32 v62, 1.0, v62
  v_rcp_f32 v62, v62
  v_add_f32 v60, 1.0, v21
  v_mul_f32 v61, v20, v21
  v_sub_f32 v61, 0, v61
  v_sub_f32 v17, v17, v30
  v_mul_f32 v48, v52, v52
  v_fma_f32 v48, v48, v17, v30
  v_rsq_f32 v48, v48
  s_nop 0
  v_mul_f32 v48, v48, v52
  v_mul_f32 v50, v48, v16
  v_sub_f32 v50, 0, v50
  v_sub_f32 v19, v19, v30
  v_mul_f32 v49, v53, v53
  v_fma_f32 v49, v49, v19, v30
  v_rsq_f32 v49, v49
  s_nop 0
  v_mul_f32 v49, v49, v53
  v_mul_f32 v51, v49, v18
  v_sub_f32 v51, 0, v51
  v_lshlrev_b32 v56, 16, v56
  v_fma_f32 v56, v56, v60, v61
  v_lshlrev_b32 v57, 16, v57
  v_fma_f32 v57, v57, v60, v61
  v_lshlrev_b32 v58, 16, v58
  v_fma_f32 v58, v58, v60, v61
  v_lshlrev_b32 v59, 16, v59
  v_fma_f32 v59, v59, v60, v61
  v_and_b32 v10, 7, v2
  v_lshlrev_b32 v10, 12, v10
  v_lshl_add_u32 v10, v12, 4, v10
  s_lshl_b32 s20, s17, 1
  s_and_b32 s28, s18, 1
  s_add_u32 s20, s20, s28
  s_lshl_b32 s20, s20, 7
  s_add_u32 s20, s20, s63
  s_add_u32 s20, s20, 0x1090000
  s_and_b32 s26, s18, 14
  s_lshl_b32 s26, s26, 4
  s_add_u32 s26, s26, s17
  s_lshl_b32 s26, s26, 1
  s_and_b32 s28, s18, 1
  s_add_u32 s26, s26, s28
  s_lshl_b32 s26, s26, 10
  s_add_u32 s26, s26, s63
  s_add_u32 s26, s26, 0x1190000
  s_add_u32 s25, s26, 32768
  s_lshl_b32 s21, s2, 12
  s_add_u32 s21, s21, 0x3200000
  v_lshlrev_b32 v14, 3, v2
  buffer_store_dwordx2 v[48:49], v14, s[4:7], s21 offen
  buffer_store_dwordx2 v[50:51], v14, s[4:7], s21 offen offset:512
  buffer_store_dwordx2 v[52:53], v14, s[4:7], s21 offen offset:1024
  buffer_store_dwordx2 v[54:55], v14, s[4:7], s21 offen offset:1536
  buffer_store_dword v15, v4, s[4:7], s21 offen offset:2048
  s_mov_b32 m0, 158464
  s_add_u32 s22, s21, 2048
  s_waitcnt vmcnt(0)
  buffer_load_dwordx4 v3, s[4:7], s21 offen lds
  buffer_load_dwordx4 v3, s[4:7], s21 offen offset:1024 lds
  s_mov_b32 m0, 155800
  s_mov_b64 exec, 1
  buffer_load_dword v4, s[4:7], s22 offen lds
  s_mov_b64 exec, -1
  s_add_u32 m0, s71, 128
  s_mov_b32 s29, .g2_kernel_tab-.g2_kernel_pc+8
  s_mov_b64 exec, 1
  buffer_load_dword off, s[64:67], s29 lds
  s_mov_b64 exec, -1
  s_lshl_b32 s28, s2, 10
  s_and_b32 s28, s28, 0xe000
  v_lshlrev_b32 v7, 7, v2
  buffer_load_dword v1, v7, s[64:67], s28 offen
  v_mov_b32 v6, s71
  s_mov_b32 s38, 0
.g2_kernel_wg50:
  ds_read_b32 v7, v6 offset:112
  s_add_u32 s38, s38, 1
  s_waitcnt lgkmcnt(0)
  v_cmp_gt_u32 vcc, 1, v7
  s_cbranch_vccz .g2_kernel_wg50d
  s_sleep 2
  s_cmp_lt_u32 s38, 524288
  s_cbranch_scc1 .g2_kernel_wg50
.g2_kernel_wg50d:
  s_sleep 8
  s_cmp_lg_u32 s62, 0
  s_cbranch_scc1 .g2_kernel_nap51
  s_sleep 22
.g2_kernel_nap51:
  s_mov_b32 s38, 0
.g2_kernel_gx52:
  s_mov_b32 s21, s20
  buffer_load_dwordx4 v[160:163], v10, s[4:7], s21 offen sc1
  s_add_u32 s21, s21, 32768
  buffer_load_dwordx4 v[164:167], v10, s[4:7], s21 offen sc1
  s_add_u32 s21, s21, 32768
  buffer_load_dwordx4 v[168:171], v10, s[4:7], s21 offen sc1
  s_add_u32 s21, s21, 32768
  buffer_load_dwordx4 v[172:175], v10, s[4:7], s21 offen sc1
  s_add_u32 s21, s21, 32768
  buffer_load_dwordx4 v[176:179], v10, s[4:7], s21 offen sc1
  s_add_u32 s21, s21, 32768
  buffer_load_dwordx4 v[180:183], v10, s[4:7], s21 offen sc1
  s_add_u32 s21, s21, 32768
  buffer_load_dwordx4 v[184:187], v10, s[4:7], s21 offen sc1
  s_add_u32 s21, s21, 32768
  buffer_load_dwordx4 v[188:191], v10, s[4:7], s21 offen sc1
  s_add_u32 s21, s21, 32768
  buffer_load_dwordx4 v[192:195], v10, s[4:7], s21 offen sc1
  s_add_u32 s21, s21, 32768
  buffer_load_dwordx4 v[196:199], v10, s[4:7], s21 offen sc1
  s_add_u32 s21, s21, 32768
  buffer_load_dwordx4 v[200:203], v10, s[4:7], s21 offen sc1
  s_add_u32 s21, s21, 32768
  buffer_load_dwordx4 v[204:207], v10, s[4:7], s21 offen sc1
  s_add_u32 s21, s21, 32768
  buffer_load_dwordx4 v[208:211], v10, s[4:7], s21 offen sc1
  s_add_u32 s21, s21, 32768
  buffer_load_dwordx4 v[212:215], v10, s[4:7], s21 offen sc1
  s_add_u32 s21, s21, 32768
  buffer_load_dwordx4 v[216:219], v10, s[4:7], s21 offen sc1
  s_add_u32 s21, s21, 32768
  buffer_load_dwordx4 v[220:223], v10, s[4:7], s21 offen sc1
  s_add_u32 s21, s21, 32768
  buffer_load_dwordx4 v[224:227], v10, s[4:7], s21 offen sc1
  s_add_u32 s21, s21, 32768
  buffer_load_dwordx4 v[228:231], v10, s[4:7], s21 offen sc1
  s_add_u32 s21, s21, 32768
  buffer_load_dwordx4 v[232:235], v10, s[4:7], s21 offen sc1
  s_add_u32 s21, s21, 32768
  buffer_load_dwordx4 v[236:239], v10, s[4:7], s21 offen sc1
  s_add_u32 s21, s21, 32768
  buffer_load_dwordx4 v[240:243], v10, s[4:7], s21 offen sc1
  s_add_u32 s21, s21, 32768
  buffer_load_dwordx4 v[244:247], v10, s[4:7], s21 offen sc1
  s_add_u32 s21, s21, 32768
  buffer_load_dwordx4 v[248:251], v10, s[4:7], s21 offen sc1
  s_add_u32 s21, s21, 32768
  buffer_load_dwordx4 v[252:255], v10, s[4:7], s21 offen sc1
  s_add_u32 s21, s21, 32768
  buffer_load_dwordx4 v[16:19], v10, s[4:7], s21 offen sc1
  s_add_u32 s21, s21, 32768
  buffer_load_dwordx4 v[20:23], v10, s[4:7], s21 offen sc1
  s_add_u32 s21, s21, 32768
  buffer_load_dwordx4 v[24:27], v10, s[4:7], s21 offen sc1
  s_add_u32 s21, s21, 32768
  buffer_load_dwordx4 v[28:31], v10, s[4:7], s21 offen sc1
  s_add_u32 s21, s21, 32768
  s_add_u32 s38, s38, 1
  s_waitcnt vmcnt(0)
  v_min3_u32 v6, v160, v162, v164
  v_min3_u32 v6, v6, v166, v168
  v_min3_u32 v6, v6, v170, v172
  v_min3_u32 v6, v6, v174, v176
  v_min3_u32 v6, v6, v178, v180
  v_min3_u32 v6, v6, v182, v184
  v_min3_u32 v6, v6, v186, v188
  v_min3_u32 v6, v6, v190, v192
  v_min3_u32 v6, v6, v194, v196
  v_min3_u32 v6, v6, v198, v200
  v_min3_u32 v6, v6, v202, v204
  v_min3_u32 v6, v6, v206, v208
  v_min3_u32 v6, v6, v210, v212
  v_min3_u32 v6, v6, v214, v216
  v_min3_u32 v6, v6, v218, v220
  v_min3_u32 v6, v6, v222, v224
  v_min3_u32 v6, v6, v226, v228
  v_min3_u32 v6, v6, v230, v232
  v_min3_u32 v6, v6, v234, v236
  v_min3_u32 v6, v6, v238, v240
  v_min3_u32 v6, v6, v242, v244
  v_min3_u32 v6, v6, v246, v248
  v_min3_u32 v6, v6, v250, v252
  v_min3_u32 v6, v6, v254, v16
  v_min3_u32 v6, v6, v18, v20
  v_min3_u32 v6, v6, v22, v24
  v_min3_u32 v6, v6, v26, v28
  v_min_u32 v6, v6, v30
  v_cmp_eq_u32 vcc, 0, v6
  s_cbranch_vccz .g2_kernel_gx52d
  s_mov_b64 exec, vcc
  s_sleep 1
  s_cmp_lg_u32 s62, 0
  s_cbranch_scc1 .g2_kernel_nap53
  s_sleep 11
.g2_kernel_nap53:
  s_cmp_lt_u32 s38, 131072
  s_cbranch_scc1 .g2_kernel_gx52
.g2_kernel_gx52d:
  s_mov_b64 exec, -1
  v_add_f32 v164, v164, v160
  v_add_f32 v165, v165, v161
  v_add_f32 v166, v166, v162
  v_add_f32 v167, v167, v163
  v_add_f32 v172, v172, v168
  v_add_f32 v173, v173, v169
  v_add_f32 v174, v174, v170
  v_add_f32 v175, v175, v171
  v_add_f32 v180, v180, v176
  v_add_f32 v181, v181, v177
  v_add_f32 v182, v182, v178
  v_add_f32 v183, v183, v179
  v_add_f32 v188, v188, v184
  v_add_f32 v189, v189, v185
  v_add_f32 v190, v190, v186
  v_add_f32 v191, v191, v187
  v_add_f32 v196, v196, v192
  v_add_f32 v197, v197, v193
  v_add_f32 v198, v198, v194
  v_add_f32 v199, v199, v195
  v_add_f32 v204, v204, v200
  v_add_f32 v205, v205, v201
  v_add_f32 v206, v206, v202
  v_add_f32 v207, v207, v203
  v_add_f32 v212, v212, v208
  v_add_f32 v213, v213, v209
  v_add_f32 v214, v214, v210
  v_add_f32 v215, v215, v211
  v_add_f32 v220, v220, v216
  v_add_f32 v221, v221, v217
  v_add_f32 v222, v222, v218
  v_add_f32 v223, v223, v219
  v_add_f32 v228, v228, v224
  v_add_f32 v229, v229, v225
  v_add_f32 v230, v230, v226
  v_add_f32 v231, v231, v227
  v_add_f32 v236, v236, v232
  v_add_f32 v237, v237, v233
  v_add_f32 v238, v238, v234
  v_add_f32 v239, v239, v235
  v_add_f32 v244, v244, v240
  v_add_f32 v245, v245, v241
  v_add_f32 v246, v246, v242
  v_add_f32 v247, v247, v243
  v_add_f32 v252, v252, v248
  v_add_f32 v253, v253, v249
  v_add_f32 v254, v254, v250
  v_add_f32 v255, v255, v251
  v_add_f32 v20, v20, v16
  v_add_f32 v21, v21, v17
  v_add_f32 v22, v22, v18
  v_add_f32 v23, v23, v19
  v_add_f32 v28, v28, v24
  v_add_f32 v29, v29, v25
  v_add_f32 v30, v30, v26
  v_add_f32 v31, v31, v27
  v_add_f32 v172, v172, v164
  v_add_f32 v173, v173, v165
  v_add_f32 v174, v174, v166
  v_add_f32 v175, v175, v167
  v_add_f32 v188, v188, v180
  v_add_f32 v189, v189, v181
  v_add_f32 v190, v190, v182
  v_add_f32 v191, v191, v183
  v_add_f32 v204, v204, v196
  v_add_f32 v205, v205, v197
  v_add_f32 v206, v206, v198
  v_add_f32 v207, v207, v199
  v_add_f32 v220, v220, v212
  v_add_f32 v221, v221, v213
  v_add_f32 v222, v222, v214
  v_add_f32 v223, v223, v215
  v_add_f32 v236, v236, v228
  v_add_f32 v237, v237, v229
  v_add_f32 v238, v238, v230
  v_add_f32 v239, v239, v231
  v_add_f32 v252, v252, v244
  v_add_f32 v253, v253, v245
  v_add_f32 v254, v254, v246
  v_add_f32 v255, v255, v247
  v_add_f32 v28, v28, v20
  v_add_f32 v29, v29, v21
  v_add_f32 v30, v30, v22
  v_add_f32 v31, v31, v23
  v_add_f32 v188, v188, v172
  v_add_f32 v189, v189, v173
  v_add_f32 v190, v190, v174
  v_add_f32 v191, v191, v175
  v_add_f32 v220, v220, v204
  v_add_f32 v221, v221, v205
  v_add_f32 v222, v222, v206
  v_add_f32 v223, v223, v207
  v_add_f32 v252, v252, v236
  v_add_f32 v253, v253, v237
  v_add_f32 v254, v254, v238
  v_add_f32 v255, v255, v239
  v_add_f32 v220, v220, v188
  v_add_f32 v221, v221, v189
  v_add_f32 v222, v222, v190
  v_add_f32 v223, v223, v191
  v_add_f32 v28, v28, v252
  v_add_f32 v29, v29, v253
  v_add_f32 v30, v30, v254
  v_add_f32 v31, v31, v255
  v_add_f32 v28, v28, v220
  v_add_f32 v29, v29, v221
  v_add_f32 v30, v30, v222
  v_add_f32 v31, v31, v223
  v_add_f32 v28, v28, v28 quad_perm:[1,0,3,2] row_mask:0xf bank_mask:0xf
  v_add_f32 v29, v29, v29 quad_perm:[1,0,3,2] row_mask:0xf bank_mask:0xf
  v_add_f32 v30, v30, v30 quad_perm:[1,0,3,2] row_mask:0xf bank_mask:0xf
  v_add_f32 v31, v31, v31 quad_perm:[1,0,3,2] row_mask:0xf bank_mask:0xf
  v_add_f32 v28, v28, v28 quad_perm:[2,3,0,1] row_mask:0xf bank_mask:0xf
  v_add_f32 v29, v29, v29 quad_perm:[2,3,0,1] row_mask:0xf bank_mask:0xf
  v_add_f32 v30, v30, v30 quad_perm:[2,3,0,1] row_mask:0xf bank_mask:0xf
  v_add_f32 v31, v31, v31 quad_perm:[2,3,0,1] row_mask:0xf bank_mask:0xf
  v_add_f32 v28, v28, v28 row_half_mirror row_mask:0xf bank_mask:0xf
  v_add_f32 v29, v29, v29 row_half_mirror row_mask:0xf bank_mask:0xf
  v_add_f32 v30, v30, v30 row_half_mirror row_mask:0xf bank_mask:0xf
  v_add_f32 v31, v31, v31 row_half_mirror row_mask:0xf bank_mask:0xf
  v_mul_f32 v28, v28, v62
  v_mul_f32 v29, v29, v62
  v_mul_f32 v30, v30, v62
  v_mul_f32 v31, v31, v62
  v_cvt_pk_bf16_f32 v16, v28, v29
  v_cvt_pk_bf16_f32 v17, v30, v31
  s_mov_b32 s28, 0x00010001
  s_mov_b32 s29, 0x00010001
  v_mov_b32 v18, v16 row_ror:8 row_mask:0xf bank_mask:0xf
  v_mov_b32 v19, v17 row_ror:8 row_mask:0xf bank_mask:0xf
  v_lshlrev_b32 v28, 16, v16
  v_and_b32 v29, 0xffff0000, v16
  v_lshlrev_b32 v30, 16, v17
  v_and_b32 v31, 0xffff0000, v17
  v_cndmask_b32 v32, 0, v16, s[28:29]
  v_cndmask_b32 v33, 0, v17, s[28:29]
  v_cndmask_b32 v34, 0, v18, s[28:29]
  v_cndmask_b32 v35, 0, v19, s[28:29]
  s_lshl_b64 s[28:29], s[28:29], 1
  s_nop 0
  v_mfma_f32_16x16x32_bf16 v[160:163], v[32:35], v[64:67], 0
  v_mfma_f32_16x16x32_bf16 v[164:167], v[32:35], v[80:83], 0
  v_mfma_f32_16x16x32_bf16 v[168:171], v[32:35], v[96:99], 0
  v_mfma_f32_16x16x32_bf16 v[172:175], v[32:35], v[112:115], 0
  v_mfma_f32_16x16x32_bf16 v[176:179], v[32:35], v[128:131], 0
  v_mfma_f32_16x16x32_bf16 v[180:183], v[32:35], v[144:147], 0
  v_cndmask_b32 v36, 0, v16, s[28:29]
  v_cndmask_b32 v37, 0, v17, s[28:29]
  v_cndmask_b32 v38, 0, v18, s[28:29]
  v_cndmask_b32 v39, 0, v19, s[28:29]
  s_lshl_b64 s[28:29], s[28:29], 1
  s_nop 0
  v_mfma_f32_16x16x32_bf16 v[160:163], v[36:39], v[68:71], v[160:163]
  v_mfma_f32_16x16x32_bf16 v[164:167], v[36:39], v[84:87], v[164:167]
  v_mfma_f32_16x16x32_bf16 v[168:171], v[36:39], v[100:103], v[168:171]
  v_mfma_f32_16x16x32_bf16 v[172:175], v[36:39], v[116:119], v[172:175]
  v_mfma_f32_16x16x32_bf16 v[176:179], v[36:39], v[132:135], v[176:179]
  v_mfma_f32_16x16x32_bf16 v[180:183], v[36:39], v[148:151], v[180:183]
  v_cndmask_b32 v40, 0, v16, s[28:29]
  v_cndmask_b32 v41, 0, v17, s[28:29]
  v_cndmask_b32 v42, 0, v18, s[28:29]
  v_cndmask_b32 v43, 0, v19, s[28:29]
  s_lshl_b64 s[28:29], s[28:29], 1
  s_nop 0
  v_mfma_f32_16x16x32_bf16 v[160:163], v[40:43], v[72:75], v[160:163]
  v_mfma_f32_16x16x32_bf16 v[164:167], v[40:43], v[88:91], v[164:167]
  v_mfma_f32_16x16x32_bf16 v[168:171], v[40:43], v[104:107], v[168:171]
  v_mfma_f32_16x16x32_bf16 v[172:175], v[40:43], v[120:123], v[172:175]
  v_mfma_f32_16x16x32_bf16 v[176:179], v[40:43], v[136:139], v[176:179]
  v_mfma_f32_16x16x32_bf16 v[180:183], v[40:43], v[152:155], v[180:183]
  v_cndmask_b32 v44, 0, v16, s[28:29]
  v_cndmask_b32 v45, 0, v17, s[28:29]
  v_cndmask_b32 v46, 0, v18, s[28:29]
  v_cndmask_b32 v47, 0, v19, s[28:29]
  s_lshl_b64 s[28:29], s[28:29], 1
  s_nop 0
  v_mfma_f32_16x16x32_bf16 v[160:163], v[44:47], v[76:79], v[160:163]
  v_mfma_f32_16x16x32_bf16 v[164:167], v[44:47], v[92:95], v[164:167]
  v_mfma_f32_16x16x32_bf16 v[168:171], v[44:47], v[108:111], v[168:171]
  v_mfma_f32_16x16x32_bf16 v[172:175], v[44:47], v[124:127], v[172:175]
  v_mfma_f32_16x16x32_bf16 v[176:179], v[44:47], v[140:143], v[176:179]
  v_mfma_f32_16x16x32_bf16 v[180:183], v[44:47], v[156:159], v[180:183]
  v_add_f32 v56, v56, v28
  v_add_f32 v57, v57, v29
  v_add_f32 v58, v58, v30
  v_add_f32 v59, v59, v31
  v_add_f32 v20, v56, v57
  v_mul_f32 v22, v56, v56
  v_add_f32 v21, v58, v59
  v_fmac_f32 v22, v57, v57
  v_add_f32 v20, v20, v21
  v_fmac_f32 v22, v58, v58
  v_fmac_f32 v22, v59, v59
  v_or_b32 v28, 1, v28
  v_or_b32 v30, 1, v30
  v_add_f32 v20, v20, v20 row_ror:8 row_mask:0xf bank_mask:0xf
  v_add_f32 v22, v22, v22 row_ror:8 row_mask:0xf bank_mask:0xf
  v_lshlrev_b32 v11, 4, v12
  v_add_f32 v20, v20, v20 row_bcast:15 row_mask:0xa bank_mask:0xf
  v_add_f32 v22, v22, v22 row_bcast:15 row_mask:0xa bank_mask:0xf
  s_mov_b32 exec_lo, 0x01010101
  s_mov_b32 exec_hi, 0x01010101
  buffer_store_dwordx4 v[28:31], v11, s[4:7], s26 offen offset:768 sc1
  buffer_store_dwordx4 v[28:31], v11, s[4:7], s25 offen offset:768 sc1
  s_mov_b64 exec, -1
  v_add_f32 v20, v20, v20 row_bcast:31 row_mask:0xc bank_mask:0xf
  v_add_f32 v22, v22, v22 row_bcast:31 row_mask:0xc bank_mask:0xf
  v_or_b32 v20, 1, v20
  v_or_b32 v22, 1, v22
  s_mov_b32 exec_lo, 0
  s_mov_b32 exec_hi, 0x80000000
  buffer_store_dwordx4 v[20:23], v4, s[4:7], s26 offen offset:896 sc1
  buffer_store_dwordx4 v[20:23], v4, s[4:7], s25 offen offset:896 sc1
  s_mov_b64 exec, 0xffff
  v_or_b32 v160, 1, v160
  v_or_b32 v162, 1, v162
  buffer_store_dwordx4 v[160:163], v3, s[4:7], s26 offen offset:0 sc1
  v_or_b32 v164, 1, v164
  v_or_b32 v166, 1, v166
  buffer_store_dwordx4 v[164:167], v3, s[4:7], s25 offen offset:0 sc1
  v_or_b32 v168, 1, v168
  v_or_b32 v170, 1, v170
  buffer_store_dwordx4 v[168:171], v3, s[4:7], s26 offen offset:256 sc1
  v_or_b32 v172, 1, v172
  v_or_b32 v174, 1, v174
  buffer_store_dwordx4 v[172:175], v3, s[4:7], s25 offen offset:256 sc1
  v_or_b32 v176, 1, v176
  v_or_b32 v178, 1, v178
  buffer_store_dwordx4 v[176:179], v3, s[4:7], s26 offen offset:512 sc1
  v_or_b32 v180, 1, v180
  v_or_b32 v182, 1, v182
  buffer_store_dwordx4 v[180:183], v3, s[4:7], s25 offen offset:512 sc1
  s_mov_b64 exec, -1
  s_cmp_eq_u32 s79, 0
  s_cbranch_scc1 .g2_kernel_c_no
  s_lshl_b32 s20, s18, 15
  s_add_u32 s20, s20, 0x1190000
  s_lshl_b32 s22, s18, 11
  s_add_u32 s22, s22, s20
  v_lshlrev_b32 v16, 10, v2
  s_sleep 16
  s_mov_b32 s38, 0
  s_mov_b32 exec_hi, 0
.g2_kernel_gx54:
  buffer_load_dword v17, v16, s[4:7], s20 offen offset:752 sc1
  s_add_u32 s38, s38, 1
  s_waitcnt vmcnt(0)
  v_min_u32 v6, v17, v17
  v_cmp_eq_u32 vcc, 0, v6
  s_cbranch_vccz .g2_kernel_gx54d
  s_mov_b64 exec, vcc
  s_sleep 6
  s_cmp_lt_u32 s38, 131072
  s_cbranch_scc1 .g2_kernel_gx54
.g2_kernel_gx54d:
  s_mov_b64 exec, -1
  s_mov_b32 s38, 0
  s_bfm_b64 exec, 57, 0
.g2_kernel_gx55:
  s_mov_b32 s21, s20
  buffer_load_dwordx4 v[64:67], v3, s[4:7], s21 offen offset:0 sc1
  buffer_load_dwordx4 v[68:71], v3, s[4:7], s21 offen offset:1024 sc1
  buffer_load_dwordx4 v[72:75], v3, s[4:7], s21 offen offset:2048 sc1
  buffer_load_dwordx4 v[76:79], v3, s[4:7], s21 offen offset:3072 sc1
  s_add_u32 s21, s21, 4096
  buffer_load_dwordx4 v[80:83], v3, s[4:7], s21 offen offset:0 sc1
  buffer_load_dwordx4 v[84:87], v3, s[4:7], s21 offen offset:1024 sc1
  buffer_load_dwordx4 v[88:91], v3, s[4:7], s21 offen offset:2048 sc1
  buffer_load_dwordx4 v[92:95], v3, s[4:7], s21 offen offset:3072 sc1
  s_add_u32 s21, s21, 4096
  buffer_load_dwordx4 v[96:99], v3, s[4:7], s21 offen offset:0 sc1
  buffer_load_dwordx4 v[100:103], v3, s[4:7], s21 offen offset:1024 sc1
  buffer_load_dwordx4 v[104:107], v3, s[4:7], s21 offen offset:2048 sc1
  buffer_load_dwordx4 v[108:111], v3, s[4:7], s21 offen offset:3072 sc1
  s_add_u32 s21, s21, 4096
  buffer_load_dwordx4 v[112:115], v3, s[4:7], s21 offen offset:0 sc1
  buffer_load_dwordx4 v[116:119], v3, s[4:7], s21 offen offset:1024 sc1
  buffer_load_dwordx4 v[120:123], v3, s[4:7], s21 offen offset:2048 sc1
  buffer_load_dwordx4 v[124:127], v3, s[4:7], s21 offen offset:3072 sc1
  s_add_u32 s21, s21, 4096
  buffer_load_dwordx4 v[128:131], v3, s[4:7], s21 offen offset:0 sc1
  buffer_load_dwordx4 v[132:135], v3, s[4:7], s21 offen offset:1024 sc1
  buffer_load_dwordx4 v[136:139], v3, s[4:7], s21 offen offset:2048 sc1
  buffer_load_dwordx4 v[140:143], v3, s[4:7], s21 offen offset:3072 sc1
  s_add_u32 s21, s21, 4096
  buffer_load_dwordx4 v[144:147], v3, s[4:7], s21 offen offset:0 sc1
  buffer_load_dwordx4 v[148:151], v3, s[4:7], s21 offen offset:1024 sc1
  buffer_load_dwordx4 v[152:155], v3, s[4:7], s21 offen offset:2048 sc1
  buffer_load_dwordx4 v[156:159], v3, s[4:7], s21 offen offset:3072 sc1
  s_add_u32 s21, s21, 4096
  buffer_load_dwordx4 v[160:163], v3, s[4:7], s21 offen offset:0 sc1
  buffer_load_dwordx4 v[164:167], v3, s[4:7], s21 offen offset:1024 sc1
  buffer_load_dwordx4 v[168:171], v3, s[4:7], s21 offen offset:2048 sc1
  buffer_load_dwordx4 v[172:175], v3, s[4:7], s21 offen offset:3072 sc1
  s_add_u32 s21, s21, 4096
  buffer_load_dwordx4 v[176:179], v3, s[4:7], s21 offen offset:0 sc1
  buffer_load_dwordx4 v[180:183], v3, s[4:7], s21 offen offset:1024 sc1
  buffer_load_dwordx4 v[184:187], v3, s[4:7], s21 offen offset:2048 sc1
  buffer_load_dwordx4 v[188:191], v3, s[4:7], s21 offen offset:3072 sc1
  s_add_u32 s21, s21, 4096
  buffer_load_dwordx4 v[192:195], v3, s[4:7], s22 offen offset:0 sc1
  buffer_load_dwordx4 v[196:199], v3, s[4:7], s22 offen offset:1024 sc1
  s_add_u32 s38, s38, 1
  s_waitcnt vmcnt(0)
  v_min3_u32 v6, v64, v66, v68
  v_min3_u32 v6, v6, v70, v72
  v_min3_u32 v6, v6, v74, v76
  v_min3_u32 v6, v6, v78, v80
  v_min3_u32 v6, v6, v82, v84
  v_min3_u32 v6, v6, v86, v88
  v_min3_u32 v6, v6, v90, v92
  v_min3_u32 v6, v6, v94, v96
  v_min3_u32 v6, v6, v98, v100
  v_min3_u32 v6, v6, v102, v104
  v_min3_u32 v6, v6, v106, v108
  v_min3_u32 v6, v6, v110, v112
  v_min3_u32 v6, v6, v114, v116
  v_min3_u32 v6, v6, v118, v120
  v_min3_u32 v6, v6, v122, v124
  v_min3_u32 v6, v6, v126, v128
  v_min3_u32 v6, v6, v130, v132
  v_min3_u32 v6, v6, v134, v136
  v_min3_u32 v6, v6, v138, v140
  v_min3_u32 v6, v6, v142, v144
  v_min3_u32 v6, v6, v146, v148
  v_min3_u32 v6, v6, v150, v152
  v_min3_u32 v6, v6, v154, v156
  v_min3_u32 v6, v6, v158, v160
  v_min3_u32 v6, v6, v162, v164
  v_min3_u32 v6, v6, v166, v168
  v_min3_u32 v6, v6, v170, v172
  v_min3_u32 v6, v6, v174, v176
  v_min3_u32 v6, v6, v178, v180
  v_min3_u32 v6, v6, v182, v184
  v_min3_u32 v6, v6, v186, v188
  v_min3_u32 v6, v6, v190, v192
  v_min3_u32 v6, v6, v194, v196
  v_min_u32 v6, v6, v198
  v_cmp_eq_u32 vcc, 0, v6
  s_cbranch_vccz .g2_kernel_gx55d
  s_mov_b64 exec, vcc
  s_sleep 2
  s_cmp_lt_u32 s38, 131072
  s_cbranch_scc1 .g2_kernel_gx55
.g2_kernel_gx55d:
  s_mov_b64 exec, -1
  v_add_f32 v64, v64, v128
  v_add_f32 v65, v65, v129
  v_add_f32 v66, v66, v130
  v_add_f32 v67, v67, v131
  v_add_f32 v68, v68, v132
  v_add_f32 v69, v69, v133
  v_add_f32 v70, v70, v134
  v_add_f32 v71, v71, v135
  v_add_f32 v72, v72, v136
  v_add_f32 v73, v73, v137
  v_add_f32 v74, v74, v138
  v_add_f32 v75, v75, v139
  v_add_f32 v76, v76, v140
  v_add_f32 v77, v77, v141
  v_add_f32 v78, v78, v142
  v_add_f32 v79, v79, v143
  v_add_f32 v80, v80, v144
  v_add_f32 v81, v81, v145
  v_add_f32 v82, v82, v146
  v_add_f32 v83, v83, v147
  v_add_f32 v84, v84, v148
  v_add_f32 v85, v85, v149
  v_add_f32 v86, v86, v150
  v_add_f32 v87, v87, v151
  v_add_f32 v88, v88, v152
  v_add_f32 v89, v89, v153
  v_add_f32 v90, v90, v154
  v_add_f32 v91, v91, v155
  v_add_f32 v92, v92, v156
  v_add_f32 v93, v93, v157
  v_add_f32 v94, v94, v158
  v_add_f32 v95, v95, v159
  v_add_f32 v96, v96, v160
  v_add_f32 v97, v97, v161
  v_add_f32 v98, v98, v162
  v_add_f32 v99, v99, v163
  v_add_f32 v100, v100, v164
  v_add_f32 v101, v101, v165
  v_add_f32 v102, v102, v166
  v_add_f32 v103, v103, v167
  v_add_f32 v104, v104, v168
  v_add_f32 v105, v105, v169
  v_add_f32 v106, v106, v170
  v_add_f32 v107, v107, v171
  v_add_f32 v108, v108, v172
  v_add_f32 v109, v109, v173
  v_add_f32 v110, v110, v174
  v_add_f32 v111, v111, v175
  v_add_f32 v112, v112, v176
  v_add_f32 v113, v113, v177
  v_add_f32 v114, v114, v178
  v_add_f32 v115, v115, v179
  v_add_f32 v116, v116, v180
  v_add_f32 v117, v117, v181
  v_add_f32 v118, v118, v182
  v_add_f32 v119, v119, v183
  v_add_f32 v120, v120, v184
  v_add_f32 v121, v121, v185
  v_add_f32 v122, v122, v186
  v_add_f32 v123, v123, v187
  v_add_f32 v124, v124, v188
  v_add_f32 v125, v125, v189
  v_add_f32 v126, v126, v190
  v_add_f32 v127, v127, v191
  v_add_f32 v64, v64, v96
  v_add_f32 v65, v65, v97
  v_add_f32 v66, v66, v98
  v_add_f32 v67, v67, v99
  v_add_f32 v68, v68, v100
  v_add_f32 v69, v69, v101
  v_add_f32 v70, v70, v102
  v_add_f32 v71, v71, v103
  v_add_f32 v72, v72, v104
  v_add_f32 v73, v73, v105
  v_add_f32 v74, v74, v106
  v_add_f32 v75, v75, v107
  v_add_f32 v76, v76, v108
  v_add_f32 v77, v77, v109
  v_add_f32 v78, v78, v110
  v_add_f32 v79, v79, v111
  v_add_f32 v80, v80, v112
  v_add_f32 v81, v81, v113
  v_add_f32 v82, v82, v114
  v_add_f32 v83, v83, v115
  v_add_f32 v84, v84, v116
  v_add_f32 v85, v85, v117
  v_add_f32 v86, v86, v118
  v_add_f32 v87, v87, v119
  v_add_f32 v88, v88, v120
  v_add_f32 v89, v89, v121
  v_add_f32 v90, v90, v122
  v_add_f32 v91, v91, v123
  v_add_f32 v92, v92, v124
  v_add_f32 v93, v93, v125
  v_add_f32 v94, v94, v126
  v_add_f32 v95, v95, v127
  v_add_f32 v64, v64, v80
  v_add_f32 v65, v65, v81
  v_add_f32 v66, v66, v82
  v_add_f32 v67, v67, v83
  v_add_f32 v68, v68, v84
  v_add_f32 v69, v69, v85
  v_add_f32 v70, v70, v86
  v_add_f32 v71, v71, v87
  v_add_f32 v72, v72, v88
  v_add_f32 v73, v73, v89
  v_add_f32 v74, v74, v90
  v_add_f32 v75, v75, v91
  v_add_f32 v76, v76, v92
  v_add_f32 v77, v77, v93
  v_add_f32 v78, v78, v94
  v_add_f32 v79, v79, v95
  v_add_f32 v64, v64, v72
  v_add_f32 v65, v65, v73
  v_add_f32 v66, v66, v74
  v_add_f32 v67, v67, v75
  v_add_f32 v68, v68, v76
  v_add_f32 v69, v69, v77
  v_add_f32 v70, v70, v78
  v_add_f32 v71, v71, v79
  v_add_f32 v64, v64, v68
  v_add_f32 v65, v65, v69
  v_add_f32 v66, v66, v70
  v_add_f32 v67, v67, v71
  v_mov_b32 v28, 0.0009765625
  v_mov_b32 v30, 1e-05
  v_readlane_b32 s21, v64, 56
  v_readlane_b32 s22, v66, 56
  s_nop 0
  v_mul_f32 v20, s21, v28
  v_fma_f32 v21, s22, v28, v30
  v_fma_f32 v21, -v20, v20, v21
  v_rsq_f32 v21, abs(v21)
  v_sub_f32 v20, v61, v20
  v_mul_f32 v22, v21, v60
  v_mul_f32 v23, v21, v20
  v_and_b32 v10, 15, v2
  v_lshrrev_b32 v11, 4, v2
  v_lshlrev_b32 v16, 2, v10
  v_lshl_add_u32 v16, v11, 8, v16
  v_add_u32 v16, 155648, v16
  s_sub_u32 s20, s79, 1
  s_and_b32 s21, s20, 3
  s_lshl_b32 s21, s21, 2
  s_add_u32 s21, s21, 156160
  v_lshl_add_u32 v17, v10, 4, s21
  v_cmp_eq_u32 vcc, 2, v11
  v_mov_b32 v18, 64
  v_mov_b32 v19, 256
  v_cndmask_b32 v17, v16, v17, vcc
  v_cndmask_b32 v18, v18, v19, vcc
  v_lshrrev_b32 v24, 2, v10
  v_lshlrev_b32 v24, 9, v24
  v_and_b32 v25, 3, v10
  v_lshl_add_u32 v24, v25, 1, v24
  s_and_b32 s21, s20, 31
  s_lshl_b32 s22, s21, 4
  s_lshr_b32 s23, s20, 5
  s_lshl_b32 s24, s23, 11
  s_add_u32 s22, s22, s24
  s_add_u32 s22, s22, 131072
  v_add_u32 v26, s22, v24
  s_and_b32 s22, s21, 7
  s_and_b32 s24, s21, 8
  s_lshl_b32 s24, s24, 1
  s_add_u32 s22, s22, s24
  s_and_b32 s24, s21, 16
  s_lshr_b32 s24, s24, 1
  s_add_u32 s22, s22, s24
  s_lshl_b32 s22, s22, 4
  v_add_u32 v24, s22, v24
  s_bfe_u32 s22, s21, 0x20002
  s_lshl_b32 s22, s22, 9
  s_add_u32 s22, s22, s24
  s_and_b32 s24, s21, 3
  s_lshl_b32 s24, s24, 1
  s_add_u32 s22, s22, s24
  s_add_u32 s22, s22, 2048
  v_lshl_add_u32 v25, v10, 4, s22
  v_cndmask_b32 v24, v24, v25, vcc
  v_cndmask_b32 v19, 8, v19, vcc
  v_add_u32 v25, v24, v19
  s_lshl_b32 s22, s18, 7
  s_lshl_b32 s24, s17, 2
  s_add_u32 s22, s22, s24
  s_add_u32 s22, s22, s23
  s_lshl_b32 s22, s22, 12
  s_add_u32 s22, s22, 0x1800000
  s_add_u32 s23, s22, 262144
  s_lshr_b32 s24, s20, 6
  s_lshl_b32 s24, s24, 8
  s_add_u32 s24, s24, s76
  v_cmp_eq_u32 vcc, 0, v11
  v_mov_b32 v27, 0.25503486164919736
  s_nop 0
  v_cndmask_b32 v27, 1.0, v27, vcc
  v_mul_f32 v21, v21, v27
  v_mul_f32 v22, v22, v27
  v_mul_f32 v23, v23, v27
  s_mov_b32 s62, 1
  s_mov_b32 s63, 0x1800000
  s_mov_b32 s70, 2
  s_mov_b32 s71, 155776
  v_mov_b32 v6, s71
  s_mov_b32 s38, 0
.g2_kernel_wg56:
  ds_read_b32 v7, v6 offset:56
  s_add_u32 s38, s38, 1
  s_waitcnt lgkmcnt(0)
  v_cmp_gt_u32 vcc, 2, v7
  s_cbranch_vccz .g2_kernel_wg56d
  s_sleep 1
  s_cmp_lt_u32 s38, 524288
  s_cbranch_scc1 .g2_kernel_wg56
.g2_kernel_wg56d:
  ds_read_b32 v32, v17 offset:5632
  ds_read_b32 v36, v16 offset:4864
  v_add_u32 v17, v17, v18
  ds_read_b32 v33, v17 offset:5632
  ds_read_b32 v37, v16 offset:4928
  v_add_u32 v17, v17, v18
  ds_read_b32 v34, v17 offset:5632
  ds_read_b32 v38, v16 offset:4992
  v_add_u32 v17, v17, v18
  ds_read_b32 v35, v17 offset:5632
  ds_read_b32 v39, v16 offset:5056
  s_waitcnt lgkmcnt(0)
  v_mul_f32 v32, v32, v22
  v_fmac_f32 v32, v64, v21
  v_fmac_f32 v32, v36, v23
  v_mul_f32 v33, v33, v22
  v_fmac_f32 v33, v65, v21
  v_fmac_f32 v33, v37, v23
  v_mul_f32 v34, v34, v22
  v_fmac_f32 v34, v66, v21
  v_fmac_f32 v34, v38, v23
  v_mul_f32 v35, v35, v22
  v_fmac_f32 v35, v67, v21
  v_fmac_f32 v35, v39, v23
  v_cvt_pk_bf16_f32 v32, v32, v33
  v_cvt_pk_bf16_f32 v34, v34, v35
  v_mov_b32 v9, s71
  v_mov_b32 v8, 2
  s_mov_b32 exec_lo, 0xffff0000
  s_mov_b32 exec_hi, 0xffff
  buffer_store_short v32, v24, s[4:7], s22 offen sc1
  buffer_store_short_d16_hi v32, v25, s[4:7], s22 offen sc1
  buffer_store_short v34, v24, s[4:7], s23 offen sc1
  buffer_store_short_d16_hi v34, v25, s[4:7], s23 offen sc1
  s_mov_b64 exec, 0xffff
  ds_write_b16 v26, v32 offset:8192
  ds_write_b16_d16_hi v26, v32 offset:8200
  ds_write_b16 v26, v34
  ds_write_b16_d16_hi v26, v34 offset:8
  ds_write_b32 v9, v5 offset:60
  s_mov_b32 exec_lo, 0
  s_mov_b32 exec_hi, 0xff0000
  ds_write_b32 v16, v192 offset:6912
  ds_write_b32 v16, v193 offset:6976
  ds_write_b32 v16, v194 offset:7040
  ds_write_b32 v16, v195 offset:7104
  ds_write_b32 v16, v196 offset:6944
  ds_write_b32 v16, v197 offset:7008
  ds_write_b32 v16, v198 offset:7072
  ds_write_b32 v16, v199 offset:7136
  s_mov_b64 exec, 1
  s_waitcnt vmcnt(0)
  buffer_store_dword v8, v4, s[4:7], s24 offen sc1
  buffer_store_dword v8, v4, s[4:7], s24 offen offset:128 sc1
  s_mov_b64 exec, -1
  s_branch .g2_kernel_v
.g2_kernel_c_no:
  s_mov_b32 s62, 1
  s_mov_b32 s63, 0x1800000
  s_mov_b32 s70, 2
  s_mov_b32 s71, 155776
  s_branch .g2_kernel_v
.g2_kernel_c_t3:
  s_lshr_b32 s33, s77, 7
  s_lshl_b32 s28, s33, 2
  s_lshl_b64 s[8:9], 15, s28
  s_lshl_b32 s21, s17, 10
  s_add_u32 s21, s21, 0x2880000
  v_lshlrev_b32 v14, 3, v2
  v_add_u32 v14, 155648, v14
  v_mov_b32 v9, s71
  s_cmp_eq_u32 s33, s17
  s_cbranch_scc0 .g2_kernel_c_u1
  s_sleep 6
  s_call_b64 s[72:73], .g2_kernel_c_ph2
  s_branch .g2_kernel_c_u2
.g2_kernel_c_u1:
  v_mov_b32 v6, s71
  s_mov_b32 s38, 0
.g2_kernel_wg57:
  ds_read_b32 v7, v6 offset:36
  s_add_u32 s38, s38, 1
  s_waitcnt lgkmcnt(0)
  v_cmp_gt_u32 vcc, 1, v7
  s_cbranch_vccz .g2_kernel_wg57d
  s_sleep 1
  s_cmp_lt_u32 s38, 524288
  s_cbranch_scc1 .g2_kernel_wg57
.g2_kernel_wg57d:
  ds_read_b32 v7, v6 offset:36
  ds_read_b32 v6, v6 offset:104
  s_waitcnt lgkmcnt(0)
  v_readfirstlane_b32 s77, v7
  v_readfirstlane_b32 s29, v6
  s_lshl_b32 s29, s29, 5
  s_add_u32 s77, s77, s29
  s_sub_u32 s77, s77, 1
.g2_kernel_c_u2:
  s_mov_b32 s38, 0
.g2_kernel_gx58:
  buffer_load_dwordx4 v[16:19], v3, s[4:7], s21 offen sc1
  s_add_u32 s38, s38, 1
  s_waitcnt vmcnt(0)
  v_min_u32 v6, v17, v19
  v_cmp_eq_u32 vcc, 0, v6
  s_cbranch_vccz .g2_kernel_gx58d
  s_mov_b64 exec, vcc
  s_cmp_lt_u32 s38, 131072
  s_cbranch_scc1 .g2_kernel_gx58
.g2_kernel_gx58d:
  s_mov_b64 exec, -1
  v_rsq_f32 v22, v17
  v_rsq_f32 v23, v19
  v_add_f32 v52, 1.0, v22
  v_mul_f32 v54, v16, v22
  v_sub_f32 v54, 0, v54
  v_add_f32 v53, 1.0, v23
  v_mul_f32 v55, v18, v23
  v_sub_f32 v55, 0, v55
  ds_write_b64 v14, v[52:53] offset:3840
  ds_write_b64 v14, v[54:55] offset:4352
  s_lshr_b32 s28, s77, 7
  s_and_b32 s79, s77, 127
  s_add_u32 s79, s79, 1
  s_cmp_eq_u32 s28, s17
  s_cselect_b32 s79, s79, 0
  v_mov_b32 v15, s79
  v_mov_b32 v8, 2
  ds_write_b32 v9, v15 offset:32
  ds_write_b32 v9, v8 offset:28
  s_cmp_eq_u32 s33, s17
  s_cbranch_scc1 .g2_kernel_fin
  s_sleep 28
  s_mov_b32 s39, 1
  s_call_b64 s[72:73], .g2_kernel_c_ph2
  s_branch .g2_kernel_fin
.g2_kernel_c_ph2:
  s_call_b64 s[68:69], .g2_kernel_amax
  v_mov_b32 v6, s71
  s_mov_b32 s38, 0
.g2_kernel_wg59:
  ds_read_b32 v7, v6 offset:36
  s_add_u32 s38, s38, 1
  s_waitcnt lgkmcnt(0)
  v_cmp_gt_u32 vcc, 1, v7
  s_cbranch_vccz .g2_kernel_wg59d
  s_cmp_lt_u32 s38, 524288
  s_cbranch_scc1 .g2_kernel_wg59
.g2_kernel_wg59d:
  ds_read_b32 v8, v9 offset:96
  ds_read_b32 v7, v6 offset:36
  ds_read_b32 v6, v6 offset:104
  s_waitcnt lgkmcnt(0)
  v_readfirstlane_b32 s28, v7
  v_readfirstlane_b32 s29, v6
  s_lshl_b32 s29, s29, 5
  s_add_u32 s28, s28, s29
  s_sub_u32 s28, s28, 1
  s_add_u32 s29, s77, 2
  s_waitcnt lgkmcnt(0)
  v_cmp_gt_f32 vcc, s27, v8
  s_cmp_lg_u64 vcc, 0
  s_cselect_b32 s77, s77, s28
  s_cselect_b32 s29, s29, 1
  v_mov_b32 v10, s29
  v_mov_b32 v11, s27
  ds_write_b64 v9, v[10:11] offset:88
  s_setpc_b64 s[72:73]
.g2_kernel_c2:
  s_cmp_lg_u32 s62, 0
  s_cbranch_scc1 .g2_kernel_d_a
  s_cmp_lg_u32 s16, 7
  s_cbranch_scc1 .g2_kernel_d_a
  v_mov_b32 v6, s71
  s_mov_b32 s38, 0
.g2_kernel_wg62:
  ds_read_b32 v7, v6 offset:20
  s_add_u32 s38, s38, 1
  s_waitcnt lgkmcnt(0)
  v_cmp_gt_u32 vcc, 4, v7
  s_cbranch_vccz .g2_kernel_wg62d
  s_sleep 2
  s_cmp_lt_u32 s38, 524288
  s_cbranch_scc1 .g2_kernel_wg62
.g2_kernel_wg62d:
  s_sleep 20
  s_and_b32 s31, s19, 0xffffe000
  s_add_u32 s31, s31, 8
  v_and_b32 v6, 15, v2
  v_lshlrev_b32 v6, 9, v6
  v_lshrrev_b32 v7, 4, v2
  v_lshl_add_u32 v6, v7, 7, v6
  v_lshlrev_b32 v7, 2, v2
  v_add_u32 v7, 158208, v7
  s_mov_b32 m0, 158208
  s_mov_b32 s38, 0
.g2_kernel_pa63:
  buffer_load_dword v6, s[4:7], s31 offen sc1 lds
  s_add_u32 s38, s38, 1
  s_waitcnt vmcnt(0)
  ds_read_b32 v8, v7
  s_waitcnt lgkmcnt(0)
  v_cmp_ge_u32 vcc, s62, v8
  s_cbranch_vccz .g2_kernel_pa63d
  s_mov_b64 exec, vcc
  s_sleep 10
  s_cmp_lt_u32 s38, 131072
  s_cbranch_scc1 .g2_kernel_pa63
.g2_kernel_pa63d:
  s_mov_b64 exec, -1
.g2_kernel_d_a:
  s_setprio 2
  s_and_b32 s20, s16, 1
  v_bfe_u32 v8, v2, 1, 3
  v_lshlrev_b32 v8, 14, v8
  v_and_b32 v9, 1, v2
  v_lshl_add_u32 v8, v9, 10, v8
  v_lshrrev_b32 v9, 4, v2
  v_lshl_add_u32 v8, v9, 8, v8
  v_and_b32 v9, 15, v2
  v_lshlrev_b32 v9, 4, v9
  s_lshl_b32 s28, s20, 8
  s_add_u32 s28, s28, 156672
  v_add_u32 v10, s28, v9
  v_xor_b32 v11, 256, v10
  s_lshl_b32 s28, s20, 2
  s_add_u32 s28, s28, s71
  v_mov_b32 v12, s28
  v_xor_b32 v13, 4, v12
  s_lshl_b32 s26, s74, 1
  s_add_u32 s26, s26, s20
  s_lshl_b32 s26, s26, 11
  s_add_u32 s26, s26, 0x1090000
  s_mov_b32 s32, 0
  s_mov_b32 s39, 0
  s_lshl_b32 s28, s62, 3
  s_add_u32 s28, s28, s16
  s_cmp_lg_u32 s28, 14
  s_cbranch_scc1 .g2_kernel_d_w
  s_lshr_b32 s33, s77, 7
  s_lshl_b32 s28, s33, 2
  s_lshl_b64 s[8:9], 15, s28
  s_not_b64 s[8:9], s[8:9]
  s_and_b32 s28, s2, 7
  s_lshl_b32 s28, s28, 13
  s_add_u32 s23, s28, 0x3050000
  s_cmp_eq_u32 s33, s17
  s_cbranch_scc1 .g2_kernel_d_v
  v_mov_b32 v6, s71
  s_mov_b32 s38, 0
.g2_kernel_wg64:
  ds_read_b32 v7, v6 offset:20
  s_add_u32 s38, s38, 1
  s_waitcnt lgkmcnt(0)
  v_cmp_gt_u32 vcc, 4, v7
  s_cbranch_vccz .g2_kernel_wg64d
  s_sleep 1
  s_cmp_lt_u32 s38, 524288
  s_cbranch_scc1 .g2_kernel_wg64
.g2_kernel_wg64d:
.g2_kernel_d_v:
  s_sleep 60
  s_call_b64 s[68:69], .g2_kernel_amax
  s_add_u32 s28, s77, 1
  v_mov_b32 v6, s27
  v_mov_b32 v7, s28
  ds_write_b32 v12, v6 offset:96
  ds_write_b32 v12, v7 offset:36
  s_waitcnt lgkmcnt(0)
  s_wakeup
  s_branch .g2_kernel_d_r
.g2_kernel_d_w:
  v_mov_b32 v6, s71
  s_mov_b32 s38, 0
.g2_kernel_wg65:
  ds_read_b32 v7, v6 offset:36
  s_add_u32 s38, s38, 1
  s_waitcnt lgkmcnt(0)
  v_cmp_gt_u32 vcc, 1, v7
  s_cbranch_vccz .g2_kernel_wg65d
  s_sleep 4
  s_cmp_lt_u32 s38, 524288
  s_cbranch_scc1 .g2_kernel_wg65
.g2_kernel_wg65d:
  ds_read_b32 v7, v6 offset:36
  ds_read_b32 v6, v6 offset:104
  s_waitcnt lgkmcnt(0)
  v_readfirstlane_b32 s77, v7
  v_readfirstlane_b32 s29, v6
  s_lshl_b32 s29, s29, 5
  s_add_u32 s77, s77, s29
  s_sub_u32 s77, s77, 1
.g2_kernel_d_r:
  s_and_b32 s77, s77, 2047
  s_lshr_b32 s24, s77, 7
  s_lshl_b32 s24, s24, 18
  s_bfe_u32 s28, s77, 0x30004
  s_lshl_b32 s28, s28, 11
  s_add_u32 s24, s24, s28
  s_and_b32 s28, s77, 15
  s_lshl_b32 s28, s28, 4
  s_add_u32 s24, s24, s28
  s_add_u32 s24, s24, s63
  s_add_u32 s24, s24, 0xc00000
  s_lshl_b32 s28, s17, 14
  s_add_u32 s21, s24, s28
  s_and_b32 s28, s18, 8
  s_lshl_b32 s28, s28, 5
  s_add_u32 s21, s21, s28
  s_and_b32 s28, s18, 7
  s_lshl_b32 s28, s28, 1
  s_add_u32 s21, s21, s28
  s_lshl_b32 s28, s20, 17
  s_add_u32 s24, s24, s28
  buffer_load_dwordx4 v[16:19], v8, s[4:7], s24 offen
  buffer_load_ushort v56, v4, s[4:7], s21 offen
  buffer_load_ushort v57, v4, s[4:7], s21 offen offset:512
  buffer_load_ushort v58, v4, s[4:7], s21 offen offset:1024
  buffer_load_ushort v59, v4, s[4:7], s21 offen offset:1536
  s_lshl_b32 s25, s77, 3
  s_add_u32 s25, s25, s63
  s_add_u32 s25, s25, 0x1080000
  s_mov_b32 s38, 0
.g2_kernel_gx66:
  buffer_load_dwordx2 v[20:21], v4, s[4:7], s25 offen sc1
  s_add_u32 s38, s38, 1
  s_waitcnt vmcnt(0)
  v_min_u32 v6, v21, v21
  v_cmp_eq_u32 vcc, 0, v6
  s_cbranch_vccz .g2_kernel_gx66d
  s_mov_b64 exec, vcc
  s_sleep 1
  s_cmp_lt_u32 s38, 131072
  s_cbranch_scc1 .g2_kernel_gx66
.g2_kernel_gx66d:
  s_mov_b64 exec, -1
  v_rsq_f32 v21, v21
  v_lshlrev_b32 v24, 16, v16
  v_and_b32 v25, 0xffff0000, v16
  v_lshlrev_b32 v26, 16, v17
  v_and_b32 v27, 0xffff0000, v17
  v_lshlrev_b32 v28, 16, v18
  v_and_b32 v29, 0xffff0000, v18
  v_lshlrev_b32 v30, 16, v19
  v_and_b32 v31, 0xffff0000, v19
  v_mul_f32 v20, v20, v21
  v_mov_b32 v60, v20
  v_add_f32 v61, 1.0, v21
  s_cmp_ge_u32 s74, 224
  s_cbranch_scc1 .g2_kernel_d_none
  v_fma_f32 v24, v24, v21, -v20
  v_fma_f32 v25, v25, v21, -v20
  v_fma_f32 v26, v26, v21, -v20
  v_fma_f32 v27, v27, v21, -v20
  v_fma_f32 v28, v28, v21, -v20
  v_fma_f32 v29, v29, v21, -v20
  v_fma_f32 v30, v30, v21, -v20
  v_fma_f32 v31, v31, v21, -v20
  v_cvt_pk_bf16_f32 v16, v24, v25
  v_cvt_pk_bf16_f32 v17, v26, v27
  v_cvt_pk_bf16_f32 v18, v28, v29
  v_cvt_pk_bf16_f32 v19, v30, v31
  v_mov_b32 v24, v16 row_newbcast:0 row_mask:0xf bank_mask:0xf
  v_mov_b32 v25, v17 row_newbcast:0 row_mask:0xf bank_mask:0xf
  v_mov_b32 v26, v18 row_newbcast:0 row_mask:0xf bank_mask:0xf
  v_mov_b32 v27, v19 row_newbcast:0 row_mask:0xf bank_mask:0xf
  v_mov_b32 v28, v16 row_newbcast:1 row_mask:0xf bank_mask:0xf
  v_mov_b32 v29, v17 row_newbcast:1 row_mask:0xf bank_mask:0xf
  v_mov_b32 v30, v18 row_newbcast:1 row_mask:0xf bank_mask:0xf
  v_mov_b32 v31, v19 row_newbcast:1 row_mask:0xf bank_mask:0xf
  v_mfma_f32_16x16x32_bf16 v[32:35], v[24:27], v[64:67], 0
  v_mfma_f32_16x16x32_bf16 v[36:39], v[24:27], v[128:131], 0
  v_mov_b32 v24, v16 row_newbcast:2 row_mask:0xf bank_mask:0xf
  v_mov_b32 v25, v17 row_newbcast:2 row_mask:0xf bank_mask:0xf
  v_mov_b32 v26, v18 row_newbcast:2 row_mask:0xf bank_mask:0xf
  v_mov_b32 v27, v19 row_newbcast:2 row_mask:0xf bank_mask:0xf
  v_mfma_f32_16x16x32_bf16 v[32:35], v[28:31], v[68:71], v[32:35]
  v_mfma_f32_16x16x32_bf16 v[36:39], v[28:31], v[132:135], v[36:39]
  v_mov_b32 v28, v16 row_newbcast:3 row_mask:0xf bank_mask:0xf
  v_mov_b32 v29, v17 row_newbcast:3 row_mask:0xf bank_mask:0xf
  v_mov_b32 v30, v18 row_newbcast:3 row_mask:0xf bank_mask:0xf
  v_mov_b32 v31, v19 row_newbcast:3 row_mask:0xf bank_mask:0xf
  v_mfma_f32_16x16x32_bf16 v[32:35], v[24:27], v[72:75], v[32:35]
  v_mfma_f32_16x16x32_bf16 v[36:39], v[24:27], v[136:139], v[36:39]
  v_mov_b32 v24, v16 row_newbcast:4 row_mask:0xf bank_mask:0xf
  v_mov_b32 v25, v17 row_newbcast:4 row_mask:0xf bank_mask:0xf
  v_mov_b32 v26, v18 row_newbcast:4 row_mask:0xf bank_mask:0xf
  v_mov_b32 v27, v19 row_newbcast:4 row_mask:0xf bank_mask:0xf
  v_mfma_f32_16x16x32_bf16 v[32:35], v[28:31], v[76:79], v[32:35]
  v_mfma_f32_16x16x32_bf16 v[36:39], v[28:31], v[140:143], v[36:39]
  v_mov_b32 v28, v16 row_newbcast:5 row_mask:0xf bank_mask:0xf
  v_mov_b32 v29, v17 row_newbcast:5 row_mask:0xf bank_mask:0xf
  v_mov_b32 v30, v18 row_newbcast:5 row_mask:0xf bank_mask:0xf
  v_mov_b32 v31, v19 row_newbcast:5 row_mask:0xf bank_mask:0xf
  v_mfma_f32_16x16x32_bf16 v[32:35], v[24:27], v[80:83], v[32:35]
  v_mfma_f32_16x16x32_bf16 v[36:39], v[24:27], v[144:147], v[36:39]
  v_mov_b32 v24, v16 row_newbcast:6 row_mask:0xf bank_mask:0xf
  v_mov_b32 v25, v17 row_newbcast:6 row_mask:0xf bank_mask:0xf
  v_mov_b32 v26, v18 row_newbcast:6 row_mask:0xf bank_mask:0xf
  v_mov_b32 v27, v19 row_newbcast:6 row_mask:0xf bank_mask:0xf
  v_mfma_f32_16x16x32_bf16 v[32:35], v[28:31], v[84:87], v[32:35]
  v_mfma_f32_16x16x32_bf16 v[36:39], v[28:31], v[148:151], v[36:39]
  v_mov_b32 v28, v16 row_newbcast:7 row_mask:0xf bank_mask:0xf
  v_mov_b32 v29, v17 row_newbcast:7 row_mask:0xf bank_mask:0xf
  v_mov_b32 v30, v18 row_newbcast:7 row_mask:0xf bank_mask:0xf
  v_mov_b32 v31, v19 row_newbcast:7 row_mask:0xf bank_mask:0xf
  v_mfma_f32_16x16x32_bf16 v[32:35], v[24:27], v[88:91], v[32:35]
  v_mfma_f32_16x16x32_bf16 v[36:39], v[24:27], v[152:155], v[36:39]
  v_mov_b32 v24, v16 row_newbcast:8 row_mask:0xf bank_mask:0xf
  v_mov_b32 v25, v17 row_newbcast:8 row_mask:0xf bank_mask:0xf
  v_mov_b32 v26, v18 row_newbcast:8 row_mask:0xf bank_mask:0xf
  v_mov_b32 v27, v19 row_newbcast:8 row_mask:0xf bank_mask:0xf
  v_mfma_f32_16x16x32_bf16 v[32:35], v[28:31], v[92:95], v[32:35]
  v_mfma_f32_16x16x32_bf16 v[36:39], v[28:31], v[156:159], v[36:39]
  v_mov_b32 v28, v16 row_newbcast:9 row_mask:0xf bank_mask:0xf
  v_mov_b32 v29, v17 row_newbcast:9 row_mask:0xf bank_mask:0xf
  v_mov_b32 v30, v18 row_newbcast:9 row_mask:0xf bank_mask:0xf
  v_mov_b32 v31, v19 row_newbcast:9 row_mask:0xf bank_mask:0xf
  v_mfma_f32_16x16x32_bf16 v[32:35], v[24:27], v[96:99], v[32:35]
  v_mfma_f32_16x16x32_bf16 v[36:39], v[24:27], v[160:163], v[36:39]
  v_mov_b32 v24, v16 row_newbcast:10 row_mask:0xf bank_mask:0xf
  v_mov_b32 v25, v17 row_newbcast:10 row_mask:0xf bank_mask:0xf
  v_mov_b32 v26, v18 row_newbcast:10 row_mask:0xf bank_mask:0xf
  v_mov_b32 v27, v19 row_newbcast:10 row_mask:0xf bank_mask:0xf
  v_mfma_f32_16x16x32_bf16 v[32:35], v[28:31], v[100:103], v[32:35]
  v_mfma_f32_16x16x32_bf16 v[36:39], v[28:31], v[164:167], v[36:39]
  v_mov_b32 v28, v16 row_newbcast:11 row_mask:0xf bank_mask:0xf
  v_mov_b32 v29, v17 row_newbcast:11 row_mask:0xf bank_mask:0xf
  v_mov_b32 v30, v18 row_newbcast:11 row_mask:0xf bank_mask:0xf
  v_mov_b32 v31, v19 row_newbcast:11 row_mask:0xf bank_mask:0xf
  v_mfma_f32_16x16x32_bf16 v[32:35], v[24:27], v[104:107], v[32:35]
  v_mfma_f32_16x16x32_bf16 v[36:39], v[24:27], v[168:171], v[36:39]
  v_mov_b32 v24, v16 row_newbcast:12 row_mask:0xf bank_mask:0xf
  v_mov_b32 v25, v17 row_newbcast:12 row_mask:0xf bank_mask:0xf
  v_mov_b32 v26, v18 row_newbcast:12 row_mask:0xf bank_mask:0xf
  v_mov_b32 v27, v19 row_newbcast:12 row_mask:0xf bank_mask:0xf
  v_mfma_f32_16x16x32_bf16 v[32:35], v[28:31], v[108:111], v[32:35]
  v_mfma_f32_16x16x32_bf16 v[36:39], v[28:31], v[172:175], v[36:39]
  v_mov_b32 v28, v16 row_newbcast:13 row_mask:0xf bank_mask:0xf
  v_mov_b32 v29, v17 row_newbcast:13 row_mask:0xf bank_mask:0xf
  v_mov_b32 v30, v18 row_newbcast:13 row_mask:0xf bank_mask:0xf
  v_mov_b32 v31, v19 row_newbcast:13 row_mask:0xf bank_mask:0xf
  v_mfma_f32_16x16x32_bf16 v[32:35], v[24:27], v[112:115], v[32:35]
  v_mfma_f32_16x16x32_bf16 v[36:39], v[24:27], v[176:179], v[36:39]
  v_mov_b32 v24, v16 row_newbcast:14 row_mask:0xf bank_mask:0xf
  v_mov_b32 v25, v17 row_newbcast:14 row_mask:0xf bank_mask:0xf
  v_mov_b32 v26, v18 row_newbcast:14 row_mask:0xf bank_mask:0xf
  v_mov_b32 v27, v19 row_newbcast:14 row_mask:0xf bank_mask:0xf
  v_mfma_f32_16x16x32_bf16 v[32:35], v[28:31], v[116:119], v[32:35]
  v_mfma_f32_16x16x32_bf16 v[36:39], v[28:31], v[180:183], v[36:39]
  v_mov_b32 v28, v16 row_newbcast:15 row_mask:0xf bank_mask:0xf
  v_mov_b32 v29, v17 row_newbcast:15 row_mask:0xf bank_mask:0xf
  v_mov_b32 v30, v18 row_newbcast:15 row_mask:0xf bank_mask:0xf
  v_mov_b32 v31, v19 row_newbcast:15 row_mask:0xf bank_mask:0xf
  v_mfma_f32_16x16x32_bf16 v[32:35], v[24:27], v[120:123], v[32:35]
  v_mfma_f32_16x16x32_bf16 v[36:39], v[24:27], v[184:187], v[36:39]
  v_mfma_f32_16x16x32_bf16 v[32:35], v[28:31], v[124:127], v[32:35]
  v_mfma_f32_16x16x32_bf16 v[36:39], v[28:31], v[188:191], v[36:39]
  s_mov_b32 s38, 0
  s_add_u32 s36, s32, s62
  s_add_u32 s28, s36, 1
  v_mov_b32 v18, s28
  s_mov_b32 s28, 0x00010001
  s_mov_b32 s29, 0x00100010
  s_nop 0
  v_and_or_b32 v14, v32, -4, v18
  v_and_or_b32 v15, v36, -4, v18
  ds_write_b64 v10, v[14:15]
.g2_kernel_d_x:
  ds_read_b64 v[16:17], v11
  s_add_u32 s38, s38, 1
  s_waitcnt lgkmcnt(0)
  v_and_b32 v18, 3, v16
  v_and_b32 v19, 3, v17
  v_min_u32 v18, v18, v19
  v_cmp_ge_u32 vcc, s36, v18
  s_cbranch_vccz .g2_kernel_d_xd
  s_cmp_lt_u32 s38, 524288
  s_cbranch_scc1 .g2_kernel_d_x
.g2_kernel_d_xd:
  v_add_f32 v16, v16, v14
  v_add_f32 v17, v17, v15
  v_mul_f32 v18, -1.4426950408889634, v16
  v_exp_f32 v18, v18
  v_mul_f32 v16, v16, v17
  v_add_f32 v18, 1.0, v18
  v_rcp_f32 v18, v18
  s_nop 0
  v_mul_f32 v16, v16, v18
  s_nop 1
  v_mov_b32 v17, v16 quad_perm:[1,0,3,2] row_mask:0xf bank_mask:0xf
  v_cvt_pk_bf16_f32 v16, v16, v17
  s_nop 1
  v_mov_b32 v20, v16 row_newbcast:0 row_mask:0x5 bank_mask:0xf
  v_mov_b32 v21, v16 row_newbcast:2 row_mask:0x5 bank_mask:0xf
  v_mov_b32 v22, v16 row_newbcast:4 row_mask:0x5 bank_mask:0xf
  v_mov_b32 v23, v16 row_newbcast:6 row_mask:0x5 bank_mask:0xf
  v_mov_b32 v20, v16 row_newbcast:8 row_mask:0xa bank_mask:0xf
  v_mov_b32 v21, v16 row_newbcast:10 row_mask:0xa bank_mask:0xf
  v_mov_b32 v22, v16 row_newbcast:12 row_mask:0xa bank_mask:0xf
  v_mov_b32 v23, v16 row_newbcast:14 row_mask:0xa bank_mask:0xf
  v_cndmask_b32 v24, 0, v20, s[28:29]
  v_cndmask_b32 v25, 0, v21, s[28:29]
  v_cndmask_b32 v26, 0, v22, s[28:29]
  v_cndmask_b32 v27, 0, v23, s[28:29]
  s_lshl_b64 s[28:29], s[28:29], 1
  s_nop 0
  v_mfma_f32_16x16x32_bf16 v[40:43], v[24:27], v[192:195], 0
  v_mfma_f32_16x16x32_bf16 v[44:47], v[24:27], v[208:211], 0
  v_mfma_f32_16x16x32_bf16 v[48:51], v[24:27], v[224:227], 0
  v_mfma_f32_16x16x32_bf16 v[52:55], v[24:27], v[240:243], 0
  v_cndmask_b32 v28, 0, v20, s[28:29]
  v_cndmask_b32 v29, 0, v21, s[28:29]
  v_cndmask_b32 v30, 0, v22, s[28:29]
  v_cndmask_b32 v31, 0, v23, s[28:29]
  s_lshl_b64 s[28:29], s[28:29], 1
  s_nop 0
  v_mfma_f32_16x16x32_bf16 v[40:43], v[28:31], v[196:199], v[40:43]
  v_mfma_f32_16x16x32_bf16 v[44:47], v[28:31], v[212:215], v[44:47]
  v_mfma_f32_16x16x32_bf16 v[48:51], v[28:31], v[228:231], v[48:51]
  v_mfma_f32_16x16x32_bf16 v[52:55], v[28:31], v[244:247], v[52:55]
  v_cndmask_b32 v32, 0, v20, s[28:29]
  v_cndmask_b32 v33, 0, v21, s[28:29]
  v_cndmask_b32 v34, 0, v22, s[28:29]
  v_cndmask_b32 v35, 0, v23, s[28:29]
  s_lshl_b64 s[28:29], s[28:29], 1
  s_nop 0
  v_mfma_f32_16x16x32_bf16 v[40:43], v[32:35], v[200:203], v[40:43]
  v_mfma_f32_16x16x32_bf16 v[44:47], v[32:35], v[216:219], v[44:47]
  v_mfma_f32_16x16x32_bf16 v[48:51], v[32:35], v[232:235], v[48:51]
  v_mfma_f32_16x16x32_bf16 v[52:55], v[32:35], v[248:251], v[52:55]
  v_cndmask_b32 v36, 0, v20, s[28:29]
  v_cndmask_b32 v37, 0, v21, s[28:29]
  v_cndmask_b32 v38, 0, v22, s[28:29]
  v_cndmask_b32 v39, 0, v23, s[28:29]
  s_lshl_b64 s[28:29], s[28:29], 1
  s_nop 0
  v_mfma_f32_16x16x32_bf16 v[40:43], v[36:39], v[204:207], v[40:43]
  v_mfma_f32_16x16x32_bf16 v[44:47], v[36:39], v[220:223], v[44:47]
  v_mfma_f32_16x16x32_bf16 v[48:51], v[36:39], v[236:239], v[48:51]
  v_mfma_f32_16x16x32_bf16 v[52:55], v[36:39], v[252:255], v[52:55]
  s_mov_b32 exec_hi, 0
  s_add_u32 s28, s36, 1
  s_nop 2
  v_and_or_b32 v40, v40, -4, s28
  v_and_or_b32 v42, v42, -4, s28
  buffer_store_dwordx4 v[40:43], v3, s[4:7], s26 offen offset:0 sc1
  v_and_or_b32 v44, v44, -4, s28
  v_and_or_b32 v46, v46, -4, s28
  buffer_store_dwordx4 v[44:47], v3, s[4:7], s26 offen offset:512 sc1
  v_and_or_b32 v48, v48, -4, s28
  v_and_or_b32 v50, v50, -4, s28
  buffer_store_dwordx4 v[48:51], v3, s[4:7], s26 offen offset:1024 sc1
  v_and_or_b32 v52, v52, -4, s28
  v_and_or_b32 v54, v54, -4, s28
  buffer_store_dwordx4 v[52:55], v3, s[4:7], s26 offen offset:1536 sc1
  s_mov_b64 exec, -1
  s_branch .g2_kernel_d_e
.g2_kernel_d_none:
  s_sleep 24
.g2_kernel_d_e:
  s_add_u32 m0, s71, 112
  s_mov_b32 s29, .g2_kernel_tab-.g2_kernel_pc+4
  s_mov_b64 exec, 1
  buffer_load_dword off, s[64:67], s29 lds
  s_mov_b64 exec, -1
  s_cmp_lg_u32 s62, 0
  s_cbranch_scc1 .g2_kernel_d_t
  s_mov_b32 s62, 1
  s_mov_b32 s63, 0x1800000
  s_mov_b32 s70, 2
  s_mov_b32 s71, 155776
  s_branch .g2_kernel_v
.g2_kernel_d_t:
  s_cmp_lg_u32 s20, 0
  s_cbranch_scc1 .g2_kernel_d_t1
  v_mov_b32 v62, -1.4426950408889634
  v_mul_f32 v62, s27, v62
  v_exp_f32 v62, v62
  v_lshlrev_b32 v14, 12, v2
  v_min_u32 v15, 126976, v14
  s_lshl_b32 s21, s17, 4
  s_add_u32 s21, s21, s18
  s_lshl_b32 s21, s21, 4
  s_add_u32 s37, s32, 2
  s_add_u32 s21, s21, 0x1090000
  s_add_u32 s22, s21, 262144
  s_add_u32 s24, s21, 524288
  s_add_u32 s25, s21, 786432
  v_add_f32 v62, 1.0, v62
  v_rcp_f32 v62, v62
  v_lshlrev_b32 v56, 16, v56
  v_fma_f32 v56, v56, v61, -v60
  v_lshlrev_b32 v57, 16, v57
  v_fma_f32 v57, v57, v61, -v60
  v_lshlrev_b32 v58, 16, v58
  v_fma_f32 v58, v58, v61, -v60
  v_lshlrev_b32 v59, 16, v59
  v_fma_f32 v59, v59, v61, -v60
  s_sleep 8
  s_mov_b32 s38, 0
.g2_kernel_gx67:
  buffer_load_dwordx4 v[16:19], v14, s[4:7], s21 offen sc1
  buffer_load_dwordx4 v[20:23], v14, s[4:7], s22 offen sc1
  buffer_load_dwordx4 v[24:27], v14, s[4:7], s24 offen sc1
  buffer_load_dwordx4 v[28:31], v15, s[4:7], s25 offen sc1
  s_add_u32 s38, s38, 1
  s_waitcnt vmcnt(0)
  v_bitop3_b32 v6, s37, v16, v18 bitop3:0x80
  v_bitop3_b32 v6, v6, v20, v22 bitop3:0x80
  v_bitop3_b32 v6, v6, v24, v26 bitop3:0x80
  v_bitop3_b32 v6, v6, v28, v30 bitop3:0x80
  v_cmp_ne_u32 vcc, s37, v6
  s_cbranch_vccz .g2_kernel_gx67d
  s_mov_b64 exec, vcc
  s_cmp_lt_u32 s38, 131072
  s_cbranch_scc1 .g2_kernel_gx67
.g2_kernel_gx67d:
  s_mov_b64 exec, -1
  v_add_f32 v16, v16, v20
  v_add_f32 v17, v17, v21
  v_add_f32 v18, v18, v22
  v_add_f32 v19, v19, v23
  s_mov_b32 exec_hi, 0
  v_add_f32 v24, v24, v28
  v_add_f32 v25, v25, v29
  v_add_f32 v26, v26, v30
  v_add_f32 v27, v27, v31
  s_mov_b64 exec, -1
  v_add_f32 v16, v16, v24
  v_add_f32 v17, v17, v25
  v_add_f32 v18, v18, v26
  v_add_f32 v19, v19, v27
  v_add_f32 v16, v16, v16 row_ror:8 row_mask:0xf bank_mask:0xf
  v_add_f32 v17, v17, v17 row_ror:8 row_mask:0xf bank_mask:0xf
  v_add_f32 v18, v18, v18 row_ror:8 row_mask:0xf bank_mask:0xf
  v_add_f32 v19, v19, v19 row_ror:8 row_mask:0xf bank_mask:0xf
  v_add_f32 v16, v16, v16 row_ror:4 row_mask:0xf bank_mask:0xf
  v_add_f32 v17, v17, v17 row_ror:4 row_mask:0xf bank_mask:0xf
  v_add_f32 v18, v18, v18 row_ror:4 row_mask:0xf bank_mask:0xf
  v_add_f32 v19, v19, v19 row_ror:4 row_mask:0xf bank_mask:0xf
  v_add_f32 v16, v16, v16 row_ror:2 row_mask:0xf bank_mask:0xf
  v_add_f32 v17, v17, v17 row_ror:2 row_mask:0xf bank_mask:0xf
  v_add_f32 v18, v18, v18 row_ror:2 row_mask:0xf bank_mask:0xf
  v_add_f32 v19, v19, v19 row_ror:2 row_mask:0xf bank_mask:0xf
  v_add_f32 v16, v16, v16 row_ror:1 row_mask:0xf bank_mask:0xf
  v_add_f32 v17, v17, v17 row_ror:1 row_mask:0xf bank_mask:0xf
  v_add_f32 v18, v18, v18 row_ror:1 row_mask:0xf bank_mask:0xf
  v_add_f32 v19, v19, v19 row_ror:1 row_mask:0xf bank_mask:0xf
  v_add_f32 v16, v16, v16 row_bcast:15 row_mask:0xa bank_mask:0xf
  v_add_f32 v17, v17, v17 row_bcast:15 row_mask:0xa bank_mask:0xf
  v_add_f32 v18, v18, v18 row_bcast:15 row_mask:0xa bank_mask:0xf
  v_add_f32 v19, v19, v19 row_bcast:15 row_mask:0xa bank_mask:0xf
  v_add_f32 v16, v16, v16 row_bcast:31 row_mask:0xc bank_mask:0xf
  v_add_f32 v17, v17, v17 row_bcast:31 row_mask:0xc bank_mask:0xf
  v_add_f32 v18, v18, v18 row_bcast:31 row_mask:0xc bank_mask:0xf
  v_add_f32 v19, v19, v19 row_bcast:31 row_mask:0xc bank_mask:0xf
  s_lshl_b32 s24, s77, 11
  s_lshl_b32 s25, s17, 7
  s_add_u32 s24, s24, s25
  s_lshl_b32 s25, s18, 1
  s_add_u32 s24, s24, s25
.g2_kernel_d_t1:
  v_mov_b32 v6, s71
  s_mov_b32 s38, 0
.g2_kernel_wg68:
  ds_read_b32 v7, v6 offset:88
  s_add_u32 s38, s38, 1
  s_waitcnt lgkmcnt(0)
  v_cmp_gt_u32 vcc, 1, v7
  s_cbranch_vccz .g2_kernel_wg68d
  s_cmp_lt_u32 s38, 524288
  s_cbranch_scc1 .g2_kernel_wg68
.g2_kernel_wg68d:
  ds_read_b32 v6, v6 offset:92
  v_readfirstlane_b32 s33, v7
  s_cmp_lg_u32 s32, 0
  s_cselect_b32 s33, 1, s33
  s_cmp_lg_u32 s20, 0
  s_cbranch_scc1 .g2_kernel_d_t2
  s_cmp_lg_u32 s33, 1
  s_cbranch_scc1 .g2_kernel_d_t4
  v_fmac_f32 v56, v16, v62
  v_fmac_f32 v57, v17, v62
  v_fmac_f32 v58, v18, v62
  v_fmac_f32 v59, v19, v62
.g2_kernel_d_t4:
  s_mov_b32 s28, s56
  s_mov_b32 s29, s57
  s_mov_b32 s30, 0x400000
  s_mov_b32 s31, 0x00020000
  v_cvt_pk_bf16_f32 v56, v56, v57
  v_cvt_pk_bf16_f32 v58, v58, v59
  s_mov_b32 exec_lo, 0
  s_mov_b32 exec_hi, 0x80000000
  buffer_store_short v56, v4, s[28:31], s24 offen
  buffer_store_short_d16_hi v56, v4, s[28:31], s24 offen offset:32
  buffer_store_short v58, v4, s[28:31], s24 offen offset:64
  buffer_store_short_d16_hi v58, v4, s[28:31], s24 offen offset:96
  s_mov_b64 exec, -1
.g2_kernel_d_t2:
  s_cmp_eq_u32 s33, 1
  s_cbranch_scc1 .g2_kernel_fin
  s_waitcnt vmcnt(0) lgkmcnt(0)
  v_readfirstlane_b32 s27, v6
  s_sub_u32 s77, s33, 2
  s_mov_b32 s32, 1
  s_branch .g2_kernel_d_r
.g2_kernel_fin1:
.g2_kernel_fin:
.g2_kernel_end:
  s_endpgm
.g2_kernel_q_i2:
  v_mov_b32 v6, 155648
  s_mov_b32 s38, 0
.g2_kernel_wg1:
  ds_read_b32 v7, v6 offset:20
  s_add_u32 s38, s38, 1
  s_waitcnt lgkmcnt(0)
  v_cmp_gt_u32 vcc, 4, v7
  s_cbranch_vccz .g2_kernel_wg1d
  s_cmp_lt_u32 s38, 524288
  s_cbranch_scc1 .g2_kernel_wg1
.g2_kernel_wg1d:
  s_branch .g2_kernel_q_i3
.g2_kernel_q_spin:
  s_mov_b32 s38, 0
.g2_kernel_q_spinl:
  ds_read_b32 v151, v150
  s_add_u32 s38, s38, 1
  s_waitcnt lgkmcnt(0)
  v_cmp_lt_i32 vcc, s33, v151
  s_cbranch_vccnz .g2_kernel_q_spinr
  s_cmp_lt_u32 s38, 524288
  s_cbranch_scc1 .g2_kernel_q_spinl
.g2_kernel_q_spinr:
  s_setpc_b64 s[68:69]
.g2_kernel_q_wf:
  s_call_b64 s[68:69], .g2_kernel_q_spin
  s_branch .g2_kernel_q_backf
.g2_kernel_q_w7:
  s_call_b64 s[68:69], .g2_kernel_q_spin
  s_branch .g2_kernel_q_back7
.g2_kernel_q_w0:
  s_call_b64 s[68:69], .g2_kernel_q_spin
  s_branch .g2_kernel_q_back0
.g2_kernel_q_w1:
  s_call_b64 s[68:69], .g2_kernel_q_spin
  s_branch .g2_kernel_q_back1
.g2_kernel_q_w2:
  s_call_b64 s[68:69], .g2_kernel_q_spin
  s_branch .g2_kernel_q_back2
.g2_kernel_q_w3:
  s_call_b64 s[68:69], .g2_kernel_q_spin
  s_branch .g2_kernel_q_back3
.g2_kernel_q_w4:
  s_call_b64 s[68:69], .g2_kernel_q_spin
  s_branch .g2_kernel_q_back4
.g2_kernel_q_w5:
  s_call_b64 s[68:69], .g2_kernel_q_spin
  s_branch .g2_kernel_q_back5
.g2_kernel_q_w6:
  s_call_b64 s[68:69], .g2_kernel_q_spin
  s_branch .g2_kernel_q_back6
.g2_kernel_q_cons2:
  s_lshr_b32 s26, s16, 1
  s_lshl_b32 s26, s26, 13
  v_add_u32 v144, s26, v3
  v_add_u32 v145, 1024, v144
  s_branch .g2_kernel_q_cs
.g2_kernel_q_wl:
  s_call_b64 s[68:69], .g2_kernel_q_spin
  s_branch .g2_kernel_q_bl
.g2_kernel_q_v0ew:
  v_mov_b32 v6, s71
  s_mov_b32 s38, 0
.g2_kernel_wg2:
  ds_read_b32 v7, v6 offset:0
  s_add_u32 s38, s38, 1
  s_waitcnt lgkmcnt(0)
  v_cmp_gt_u32 vcc, 2, v7
  s_cbranch_vccz .g2_kernel_wg2d
  s_cmp_lt_u32 s38, 524288
  s_cbranch_scc1 .g2_kernel_wg2
.g2_kernel_wg2d:
  ds_read_b32 v57, v13 offset:24
  ds_read_b128 v[40:43], v52 offset:5120
  ds_read_b128 v[44:47], v52 offset:5184
  ds_read_b32 v24, v50 offset:2816
  ds_read_b32 v25, v50 offset:3328
  ds_read_b32 v26, v50 offset:2880
  ds_read_b32 v27, v50 offset:3392
  ds_read_b32 v28, v50 offset:2944
  ds_read_b32 v29, v50 offset:3456
  ds_read_b32 v30, v50 offset:3008
  ds_read_b32 v31, v50 offset:3520
  s_waitcnt lgkmcnt(0)
  s_branch .g2_kernel_q_v0eb
.g2_kernel_q_v0p:
  v_readfirstlane_b32 s35, v57
  s_sub_u32 s28, s35, 1
  s_lshr_b32 s29, s28, 6
  s_lshr_b32 s30, s16, 1
  s_add_u32 s35, s35, 0x100
  s_cmp_lg_u32 s29, s30
  s_cbranch_scc1 .g2_kernel_q_v0pb
  s_add_u32 s35, s35, 0x100
  s_and_b32 s29, s28, 15
  s_mov_b32 s14, 0x00010001
  s_mov_b32 s15, 0x00010001
  s_lshl_b64 s[14:15], s[14:15], s29
  s_and_b32 s29, s28, 12
  s_lshl_b32 s29, s29, 2
  s_lshl_b64 s[30:31], 0xffff, s29
  s_bfe_u32 s29, s28, 0x20004
  s_branch .g2_kernel_q_v0s
.g2_kernel_q_v0s:
  v_subrev_u32 v6, 155648, v53
  v_lshlrev_b32 v6, 2, v6
  v_add_u32 v6, 155648, v6
  s_cmp_lg_u32 s29, 0
  s_cbranch_scc1 .g2_kernel_q_v0s1
  s_mov_b64 exec, s[14:15]
  ds_write_b128 v52, v[192:195] offset:5888
  ds_write_b128 v52, v[208:211] offset:5952
  s_mov_b64 exec, -1
  s_waitcnt lgkmcnt(0)
  s_branch .g2_kernel_q_v0pb
.g2_kernel_q_v0s1:
  s_cmp_lg_u32 s29, 1
  s_cbranch_scc1 .g2_kernel_q_v0s2
  s_mov_b64 exec, s[14:15]
  ds_write_b128 v52, v[196:199] offset:5888
  ds_write_b128 v52, v[212:215] offset:5952
  s_mov_b64 exec, -1
  s_waitcnt lgkmcnt(0)
  s_branch .g2_kernel_q_v0pb
.g2_kernel_q_v0s2:
  s_cmp_lg_u32 s29, 2
  s_cbranch_scc1 .g2_kernel_q_v0s3
  s_mov_b64 exec, s[14:15]
  ds_write_b128 v52, v[200:203] offset:5888
  ds_write_b128 v52, v[216:219] offset:5952
  s_mov_b64 exec, -1
  s_waitcnt lgkmcnt(0)
  s_branch .g2_kernel_q_v0pb
.g2_kernel_q_v0s3:
  s_mov_b64 exec, s[14:15]
  ds_write_b128 v52, v[204:207] offset:5888
  ds_write_b128 v52, v[220:223] offset:5952
  s_mov_b64 exec, -1
  s_waitcnt lgkmcnt(0)
  s_branch .g2_kernel_q_v0pb
.g2_kernel_q_v0f:
  s_mov_b64 exec, 1
  s_cmp_ge_u32 s35, 0x200
  s_cbranch_scc1 .g2_kernel_q_v0f1
  buffer_store_dword v15, v4, s[4:7], s37 offen sc1
  s_mov_b64 exec, -1
  s_branch .g2_kernel_q_v0fb
.g2_kernel_q_v0f1:
  ds_add_u32 v13, v5 offset:56
  s_mov_b64 exec, -1
  s_branch .g2_kernel_q_v0fb
.g2_kernel_q_v0fw:
  s_mov_b32 s38, 0
.g2_kernel_q_v0fl:
  ds_read_b32 v63, v58
  s_add_u32 s38, s38, 1
  s_waitcnt lgkmcnt(0)
  v_cmp_gt_u32 vcc, s12, v63
  s_cbranch_vccz .g2_kernel_q_v0fc
  s_cmp_lt_u32 s38, 524288
  s_cbranch_scc1 .g2_kernel_q_v0fl
  s_branch .g2_kernel_q_v0fc
.g2_kernel_q_v0r:
  v_subrev_u32 v6, 155648, v53
  v_lshlrev_b32 v6, 2, v6
  v_add_u32 v6, 155648, v6
  s_cmp_lg_u32 s29, 0
  s_cbranch_scc1 .g2_kernel_q_v0r1
  s_mov_b64 exec, s[14:15]
  ds_write_b128 v52, v[160:163] offset:5632
  ds_write_b128 v52, v[176:179] offset:5696
  s_mov_b64 exec, s[30:31]
  ds_write_b128 v6, v[224:227] offset:6144
  ds_write_b128 v6, v[240:243] offset:6400
  s_mov_b64 exec, -1
  s_waitcnt lgkmcnt(0)
  s_branch .g2_kernel_q_v0rb
.g2_kernel_q_v0r1:
  s_cmp_lg_u32 s29, 1
  s_cbranch_scc1 .g2_kernel_q_v0r2
  s_mov_b64 exec, s[14:15]
  ds_write_b128 v52, v[164:167] offset:5632
  ds_write_b128 v52, v[180:183] offset:5696
  s_mov_b64 exec, s[30:31]
  ds_write_b128 v6, v[228:231] offset:6144
  ds_write_b128 v6, v[244:247] offset:6400
  s_mov_b64 exec, -1
  s_waitcnt lgkmcnt(0)
  s_branch .g2_kernel_q_v0rb
.g2_kernel_q_v0r2:
  s_cmp_lg_u32 s29, 2
  s_cbranch_scc1 .g2_kernel_q_v0r3
  s_mov_b64 exec, s[14:15]
  ds_write_b128 v52, v[168:171] offset:5632
  ds_write_b128 v52, v[184:187] offset:5696
  s_mov_b64 exec, s[30:31]
  ds_write_b128 v6, v[232:235] offset:6144
  ds_write_b128 v6, v[248:251] offset:6400
  s_mov_b64 exec, -1
  s_waitcnt lgkmcnt(0)
  s_branch .g2_kernel_q_v0rb
.g2_kernel_q_v0r3:
  s_mov_b64 exec, s[14:15]
  ds_write_b128 v52, v[172:175] offset:5632
  ds_write_b128 v52, v[188:191] offset:5696
  s_mov_b64 exec, s[30:31]
  ds_write_b128 v6, v[236:239] offset:6144
  ds_write_b128 v6, v[252:255] offset:6400
  s_mov_b64 exec, -1
  s_waitcnt lgkmcnt(0)
  s_branch .g2_kernel_q_v0rb
.g2_kernel_q_v1ew:
  v_mov_b32 v6, s71
  s_mov_b32 s38, 0
.g2_kernel_wg3:
  ds_read_b32 v7, v6 offset:0
  s_add_u32 s38, s38, 1
  s_waitcnt lgkmcnt(0)
  v_cmp_gt_u32 vcc, 2, v7
  s_cbranch_vccz .g2_kernel_wg3d
  s_cmp_lt_u32 s38, 524288
  s_cbranch_scc1 .g2_kernel_wg3
.g2_kernel_wg3d:
  ds_read_b32 v57, v13 offset:24
  ds_read_b128 v[24:27], v51 offset:2816
  ds_read_b128 v[32:35], v51 offset:3328
  ds_read_b128 v[28:31], v51 offset:2880
  ds_read_b128 v[36:39], v51 offset:3392
  ds_read_b128 v[40:43], v51 offset:2944
  ds_read_b128 v[88:91], v51 offset:3456
  ds_read_b128 v[44:47], v51 offset:3008
  ds_read_b128 v[92:95], v51 offset:3520
  ds_read_b32 v48, v53 offset:5376
  ds_read_b32 v49, v53 offset:5440
  s_waitcnt lgkmcnt(0)
  s_branch .g2_kernel_q_v1eb
.g2_kernel_q_v1p:
  v_readfirstlane_b32 s35, v57
  s_sub_u32 s28, s35, 1
  s_lshr_b32 s29, s28, 6
  s_lshr_b32 s30, s16, 1
  s_add_u32 s35, s35, 0x100
  s_cmp_lg_u32 s29, s30
  s_cbranch_scc1 .g2_kernel_q_v1pb
  s_add_u32 s35, s35, 0x100
  s_and_b32 s29, s28, 15
  s_mov_b32 s14, 0x00010001
  s_mov_b32 s15, 0x00010001
  s_lshl_b64 s[14:15], s[14:15], s29
  s_and_b32 s29, s28, 12
  s_lshl_b32 s29, s29, 2
  s_lshl_b64 s[30:31], 0xffff, s29
  s_bfe_u32 s29, s28, 0x20004
  s_branch .g2_kernel_q_v1s
.g2_kernel_q_v1s:
  v_subrev_u32 v6, 155648, v53
  v_lshlrev_b32 v6, 2, v6
  v_add_u32 v6, 155648, v6
  s_cmp_lg_u32 s29, 0
  s_cbranch_scc1 .g2_kernel_q_v1s1
  s_mov_b64 exec, s[30:31]
  ds_write_b128 v6, v[224:227] offset:6144
  ds_write_b128 v6, v[240:243] offset:6400
  s_mov_b64 exec, -1
  s_waitcnt lgkmcnt(0)
  s_branch .g2_kernel_q_v1pb
.g2_kernel_q_v1s1:
  s_cmp_lg_u32 s29, 1
  s_cbranch_scc1 .g2_kernel_q_v1s2
  s_mov_b64 exec, s[30:31]
  ds_write_b128 v6, v[228:231] offset:6144
  ds_write_b128 v6, v[244:247] offset:6400
  s_mov_b64 exec, -1
  s_waitcnt lgkmcnt(0)
  s_branch .g2_kernel_q_v1pb
.g2_kernel_q_v1s2:
  s_cmp_lg_u32 s29, 2
  s_cbranch_scc1 .g2_kernel_q_v1s3
  s_mov_b64 exec, s[30:31]
  ds_write_b128 v6, v[232:235] offset:6144
  ds_write_b128 v6, v[248:251] offset:6400
  s_mov_b64 exec, -1
  s_waitcnt lgkmcnt(0)
  s_branch .g2_kernel_q_v1pb
.g2_kernel_q_v1s3:
  s_mov_b64 exec, s[30:31]
  ds_write_b128 v6, v[236:239] offset:6144
  ds_write_b128 v6, v[252:255] offset:6400
  s_mov_b64 exec, -1
  s_waitcnt lgkmcnt(0)
  s_branch .g2_kernel_q_v1pb
.g2_kernel_q_v1f:
  s_mov_b64 exec, 1
  s_cmp_ge_u32 s35, 0x200
  s_cbranch_scc1 .g2_kernel_q_v1f1
  buffer_store_dword v15, v4, s[4:7], s37 offen sc1
  s_mov_b64 exec, -1
  s_branch .g2_kernel_q_v1fb
.g2_kernel_q_v1f1:
  ds_add_u32 v13, v5 offset:56
  s_mov_b64 exec, -1
  s_branch .g2_kernel_q_v1fb
.g2_kernel_q_v1fw:
  s_mov_b32 s38, 0
.g2_kernel_q_v1fl:
  ds_read_b32 v63, v58
  s_add_u32 s38, s38, 1
  s_waitcnt lgkmcnt(0)
  v_cmp_gt_u32 vcc, s12, v63
  s_cbranch_vccz .g2_kernel_q_v1fc
  s_cmp_lt_u32 s38, 524288
  s_cbranch_scc1 .g2_kernel_q_v1fl
  s_branch .g2_kernel_q_v1fc
.g2_kernel_q_v1r:
  v_subrev_u32 v6, 155648, v53
  v_lshlrev_b32 v6, 2, v6
  v_add_u32 v6, 155648, v6
  s_cmp_lg_u32 s29, 0
  s_cbranch_scc1 .g2_kernel_q_v1r1
  s_mov_b64 exec, s[14:15]
  ds_write_b128 v52, v[160:163] offset:5632
  ds_write_b128 v52, v[176:179] offset:5696
  s_mov_b64 exec, s[14:15]
  ds_write_b128 v52, v[192:195] offset:5888
  ds_write_b128 v52, v[208:211] offset:5952
  s_mov_b64 exec, -1
  s_waitcnt lgkmcnt(0)
  s_branch .g2_kernel_q_v1rb
.g2_kernel_q_v1r1:
  s_cmp_lg_u32 s29, 1
  s_cbranch_scc1 .g2_kernel_q_v1r2
  s_mov_b64 exec, s[14:15]
  ds_write_b128 v52, v[164:167] offset:5632
  ds_write_b128 v52, v[180:183] offset:5696
  s_mov_b64 exec, s[14:15]
  ds_write_b128 v52, v[196:199] offset:5888
  ds_write_b128 v52, v[212:215] offset:5952
  s_mov_b64 exec, -1
  s_waitcnt lgkmcnt(0)
  s_branch .g2_kernel_q_v1rb
.g2_kernel_q_v1r2:
  s_cmp_lg_u32 s29, 2
  s_cbranch_scc1 .g2_kernel_q_v1r3
  s_mov_b64 exec, s[14:15]
  ds_write_b128 v52, v[168:171] offset:5632
  ds_write_b128 v52, v[184:187] offset:5696
  s_mov_b64 exec, s[14:15]
  ds_write_b128 v52, v[200:203] offset:5888
  ds_write_b128 v52, v[216:219] offset:5952
  s_mov_b64 exec, -1
  s_waitcnt lgkmcnt(0)
  s_branch .g2_kernel_q_v1rb
.g2_kernel_q_v1r3:
  s_mov_b64 exec, s[14:15]
  ds_write_b128 v52, v[172:175] offset:5632
  ds_write_b128 v52, v[188:191] offset:5696
  s_mov_b64 exec, s[14:15]
  ds_write_b128 v52, v[204:207] offset:5888
  ds_write_b128 v52, v[220:223] offset:5952
  s_mov_b64 exec, -1
  s_waitcnt lgkmcnt(0)
  s_branch .g2_kernel_q_v1rb
.g2_kernel_q_v1:
  v_mfma_f32_16x16x32_bf16 v[224:227], v[64:67], v[96:99], v[224:227]
  ds_read_b64_tr_b16 v[80:81], v148 offset:45056
  ds_read_b64_tr_b16 v[82:83], v148 offset:45568
  ds_read_b128 v[128:131], v145 offset:49152
  v_mfma_f32_16x16x32_bf16 v[228:231], v[68:71], v[96:99], v[228:231]
  ds_read_b128 v[132:135], v145 offset:51200
  ds_read_b128 v[136:139], v145 offset:53248
  ds_read_b128 v[140:143], v145 offset:55296
  v_mfma_f32_16x16x32_bf16 v[232:235], v[72:75], v[96:99], v[232:235]
  ds_read_b64_tr_b16 v[84:85], v149 offset:45056
  ds_read_b64_tr_b16 v[86:87], v149 offset:45568
  ds_read_b32 v63, v13 offset:0
  v_mfma_f32_16x16x32_bf16 v[236:239], v[76:79], v[96:99], v[236:239]
  ds_read_b32 v57, v13 offset:24
  ds_read_b128 v[24:27], v51 offset:2816
  ds_read_b128 v[32:35], v51 offset:3328
  v_mfma_f32_16x16x32_bf16 v[252:255], v[76:79], v[100:103], v[252:255]
  ds_read_b128 v[28:31], v51 offset:2880
  ds_read_b128 v[36:39], v51 offset:3392
  ds_read_b128 v[40:43], v51 offset:2944
  v_mfma_f32_16x16x32_bf16 v[248:251], v[72:75], v[100:103], v[248:251]
  ds_read_b128 v[88:91], v51 offset:3456
  ds_read_b128 v[44:47], v51 offset:3008
  ds_read_b128 v[92:95], v51 offset:3520
  v_mfma_f32_16x16x32_bf16 v[244:247], v[68:71], v[100:103], v[244:247]
  ds_read_b32 v48, v53 offset:5376
  ds_read_b32 v49, v53 offset:5440
  v_mfma_f32_16x16x32_bf16 v[240:243], v[64:67], v[100:103], v[240:243]
  s_waitcnt lgkmcnt(12)
  v_mfma_f32_16x16x32_bf16 v[224:227], v[128:131], v[80:83], v[224:227]
  v_mfma_f32_16x16x32_bf16 v[228:231], v[132:135], v[80:83], v[228:231]
  v_mfma_f32_16x16x32_bf16 v[232:235], v[136:139], v[80:83], v[232:235]
  v_mfma_f32_16x16x32_bf16 v[236:239], v[140:143], v[80:83], v[236:239]
  v_mfma_f32_16x16x32_bf16 v[252:255], v[140:143], v[84:87], v[252:255]
  v_mfma_f32_16x16x32_bf16 v[248:251], v[136:139], v[84:87], v[248:251]
  v_mfma_f32_16x16x32_bf16 v[244:247], v[132:135], v[84:87], v[244:247]
  v_mfma_f32_16x16x32_bf16 v[240:243], v[128:131], v[84:87], v[240:243]
  s_waitcnt lgkmcnt(0)
  v_cmp_gt_u32 vcc, 2, v63
  s_cbranch_vccnz .g2_kernel_q_v1ew
.g2_kernel_q_v1eb:
  ds_read_b64_tr_b16 v[120:121], v148 offset:24576
  ds_read_b64_tr_b16 v[122:123], v148 offset:25088
  ds_read_b128 v[104:107], v144 offset:49152
  ds_read_b128 v[108:111], v144 offset:51200
  ds_read_b128 v[112:115], v144 offset:53248
  ds_read_b128 v[116:119], v144 offset:55296
  ds_read_b64_tr_b16 v[124:125], v149 offset:24576
  ds_read_b64_tr_b16 v[126:127], v149 offset:25088
  ds_read_b64_tr_b16 v[128:129], v148 offset:28672
  ds_read_b64_tr_b16 v[130:131], v148 offset:29184
  ds_read_b64_tr_b16 v[132:133], v149 offset:28672
  ds_read_b64_tr_b16 v[134:135], v149 offset:29184
  v_cmp_ne_u32 vcc, 0, v57
  s_cbranch_vccnz .g2_kernel_q_v1p
.g2_kernel_q_v1pb:
  v_pk_mul_f32 v[152:153], v[32:33], v[48:49] op_sel:[0,0] op_sel_hi:[1,0]
  v_pk_mul_f32 v[154:155], v[34:35], v[48:49] op_sel:[0,0] op_sel_hi:[1,0]
  v_pk_mul_f32 v[156:157], v[36:37], v[48:49] op_sel:[0,0] op_sel_hi:[1,0]
  v_pk_mul_f32 v[158:159], v[38:39], v[48:49] op_sel:[0,0] op_sel_hi:[1,0]
  v_pk_fma_f32 v[224:225], v[224:225], v[24:25], v[152:153]
  v_pk_fma_f32 v[226:227], v[226:227], v[26:27], v[154:155]
  v_pk_fma_f32 v[228:229], v[228:229], v[28:29], v[156:157]
  v_pk_fma_f32 v[230:231], v[230:231], v[30:31], v[158:159]
  v_cvt_pk_bf16_f32 v224, v224, v225
  v_cvt_pk_bf16_f32 v225, v226, v227
  v_cvt_pk_bf16_f32 v226, v228, v229
  v_cvt_pk_bf16_f32 v227, v230, v231
  buffer_store_dwordx4 v[224:227], v55, s[4:7], s8 offen offset:2048 sc1
  v_pk_mul_f32 v[152:153], v[32:33], v[48:49] op_sel:[0,1] op_sel_hi:[1,1]
  v_pk_mul_f32 v[154:155], v[34:35], v[48:49] op_sel:[0,1] op_sel_hi:[1,1]
  v_pk_mul_f32 v[156:157], v[36:37], v[48:49] op_sel:[0,1] op_sel_hi:[1,1]
  v_pk_mul_f32 v[158:159], v[38:39], v[48:49] op_sel:[0,1] op_sel_hi:[1,1]
  v_pk_fma_f32 v[240:241], v[240:241], v[24:25], v[152:153]
  v_pk_fma_f32 v[242:243], v[242:243], v[26:27], v[154:155]
  v_pk_fma_f32 v[244:245], v[244:245], v[28:29], v[156:157]
  v_pk_fma_f32 v[246:247], v[246:247], v[30:31], v[158:159]
  v_cvt_pk_bf16_f32 v240, v240, v241
  v_cvt_pk_bf16_f32 v241, v242, v243
  v_cvt_pk_bf16_f32 v242, v244, v245
  v_cvt_pk_bf16_f32 v243, v246, v247
  buffer_store_dwordx4 v[240:243], v55, s[4:7], s8 offen offset:2304 sc1
  v_pk_mul_f32 v[152:153], v[88:89], v[48:49] op_sel:[0,0] op_sel_hi:[1,0]
  v_pk_mul_f32 v[154:155], v[90:91], v[48:49] op_sel:[0,0] op_sel_hi:[1,0]
  v_pk_mul_f32 v[156:157], v[92:93], v[48:49] op_sel:[0,0] op_sel_hi:[1,0]
  v_pk_mul_f32 v[158:159], v[94:95], v[48:49] op_sel:[0,0] op_sel_hi:[1,0]
  v_pk_fma_f32 v[232:233], v[232:233], v[40:41], v[152:153]
  v_pk_fma_f32 v[234:235], v[234:235], v[42:43], v[154:155]
  v_pk_fma_f32 v[236:237], v[236:237], v[44:45], v[156:157]
  v_pk_fma_f32 v[238:239], v[238:239], v[46:47], v[158:159]
  v_cvt_pk_bf16_f32 v232, v232, v233
  v_cvt_pk_bf16_f32 v233, v234, v235
  v_cvt_pk_bf16_f32 v234, v236, v237
  v_cvt_pk_bf16_f32 v235, v238, v239
  buffer_store_dwordx4 v[232:235], v55, s[4:7], s9 offen offset:2048 sc1
  v_pk_mul_f32 v[152:153], v[88:89], v[48:49] op_sel:[0,1] op_sel_hi:[1,1]
  v_pk_mul_f32 v[154:155], v[90:91], v[48:49] op_sel:[0,1] op_sel_hi:[1,1]
  v_pk_mul_f32 v[156:157], v[92:93], v[48:49] op_sel:[0,1] op_sel_hi:[1,1]
  v_pk_mul_f32 v[158:159], v[94:95], v[48:49] op_sel:[0,1] op_sel_hi:[1,1]
  v_pk_fma_f32 v[248:249], v[248:249], v[40:41], v[152:153]
  v_pk_fma_f32 v[250:251], v[250:251], v[42:43], v[154:155]
  v_pk_fma_f32 v[252:253], v[252:253], v[44:45], v[156:157]
  v_pk_fma_f32 v[254:255], v[254:255], v[46:47], v[158:159]
  v_cvt_pk_bf16_f32 v248, v248, v249
  v_cvt_pk_bf16_f32 v249, v250, v251
  v_cvt_pk_bf16_f32 v250, v252, v253
  v_cvt_pk_bf16_f32 v251, v254, v255
  buffer_store_dwordx4 v[248:251], v55, s[4:7], s9 offen offset:2304 sc1
  s_waitcnt lgkmcnt(0)
  v_mfma_f32_16x16x32_bf16 v[160:163], v[120:123], v[104:107], v[160:163]
  ds_read_b64_tr_b16 v[80:81], v148 offset:36864
  ds_read_b64_tr_b16 v[82:83], v148 offset:37376
  v_mfma_f32_16x16x32_bf16 v[164:167], v[120:123], v[108:111], v[164:167]
  ds_read_b128 v[64:67], v145 offset:49152
  ds_read_b128 v[68:71], v145 offset:51200
  v_mfma_f32_16x16x32_bf16 v[168:171], v[120:123], v[112:115], v[168:171]
  ds_read_b128 v[72:75], v145 offset:53248
  ds_read_b128 v[76:79], v145 offset:55296
  v_mfma_f32_16x16x32_bf16 v[172:175], v[120:123], v[116:119], v[172:175]
  ds_read_b64_tr_b16 v[84:85], v149 offset:36864
  ds_read_b64_tr_b16 v[86:87], v149 offset:37376
  v_mfma_f32_16x16x32_bf16 v[188:191], v[124:127], v[116:119], v[188:191]
  ds_read_b64_tr_b16 v[88:89], v148 offset:40960
  ds_read_b64_tr_b16 v[90:91], v148 offset:41472
  v_mfma_f32_16x16x32_bf16 v[184:187], v[124:127], v[112:115], v[184:187]
  ds_read_b64_tr_b16 v[92:93], v149 offset:40960
  ds_read_b64_tr_b16 v[94:95], v149 offset:41472
  v_mfma_f32_16x16x32_bf16 v[180:183], v[124:127], v[108:111], v[180:183]
  ds_read_b128 v[32:35], v52 offset:4864
  ds_read_b128 v[36:39], v52 offset:4928
  v_mfma_f32_16x16x32_bf16 v[176:179], v[124:127], v[104:107], v[176:179]
  ds_read_b128 v[40:43], v52 offset:5120
  ds_read_b128 v[44:47], v52 offset:5184
  v_mfma_f32_16x16x32_bf16 v[192:195], v[128:131], v[104:107], v[192:195]
  v_mfma_f32_16x16x32_bf16 v[196:199], v[128:131], v[108:111], v[196:199]
  v_mfma_f32_16x16x32_bf16 v[200:203], v[128:131], v[112:115], v[200:203]
  v_mfma_f32_16x16x32_bf16 v[204:207], v[128:131], v[116:119], v[204:207]
  v_mfma_f32_16x16x32_bf16 v[220:223], v[132:135], v[116:119], v[220:223]
  v_mfma_f32_16x16x32_bf16 v[216:219], v[132:135], v[112:115], v[216:219]
  v_mfma_f32_16x16x32_bf16 v[212:215], v[132:135], v[108:111], v[212:215]
  v_mfma_f32_16x16x32_bf16 v[208:211], v[132:135], v[104:107], v[208:211]
  s_waitcnt lgkmcnt(0)
  v_mfma_f32_16x16x32_bf16 v[160:163], v[80:83], v[64:67], v[160:163]
  ds_read_b32 v63, v58
  ds_read_b32 v24, v50 offset:2816
  v_mfma_f32_16x16x32_bf16 v[164:167], v[80:83], v[68:71], v[164:167]
  ds_read_b32 v25, v50 offset:3328
  ds_read_b32 v26, v50 offset:2880
  v_mfma_f32_16x16x32_bf16 v[168:171], v[80:83], v[72:75], v[168:171]
  ds_read_b32 v27, v50 offset:3392
  ds_read_b32 v28, v50 offset:2944
  v_mfma_f32_16x16x32_bf16 v[172:175], v[80:83], v[76:79], v[172:175]
  ds_read_b32 v29, v50 offset:3456
  ds_read_b32 v30, v50 offset:3008
  v_mfma_f32_16x16x32_bf16 v[188:191], v[84:87], v[76:79], v[188:191]
  ds_read_b32 v31, v50 offset:3520
  v_mfma_f32_16x16x32_bf16 v[184:187], v[84:87], v[72:75], v[184:187]
  v_mfma_f32_16x16x32_bf16 v[180:183], v[84:87], v[68:71], v[180:183]
  v_mfma_f32_16x16x32_bf16 v[176:179], v[84:87], v[64:67], v[176:179]
  v_mfma_f32_16x16x32_bf16 v[192:195], v[88:91], v[64:67], v[192:195]
  v_mfma_f32_16x16x32_bf16 v[196:199], v[88:91], v[68:71], v[196:199]
  v_mfma_f32_16x16x32_bf16 v[200:203], v[88:91], v[72:75], v[200:203]
  v_mfma_f32_16x16x32_bf16 v[204:207], v[88:91], v[76:79], v[204:207]
  v_mfma_f32_16x16x32_bf16 v[220:223], v[92:95], v[76:79], v[220:223]
  v_mfma_f32_16x16x32_bf16 v[216:219], v[92:95], v[72:75], v[216:219]
  v_mfma_f32_16x16x32_bf16 v[212:215], v[92:95], v[68:71], v[212:215]
  v_mfma_f32_16x16x32_bf16 v[208:211], v[92:95], v[64:67], v[208:211]
  s_waitcnt lgkmcnt(0)
  v_cmp_gt_u32 vcc, s12, v63
  s_cbranch_vccnz .g2_kernel_q_v1fw
.g2_kernel_q_v1fc:
  s_cmp_ge_u32 s35, 0x200
  s_cbranch_scc1 .g2_kernel_q_v1r
.g2_kernel_q_v1rb:
  ds_write_b128 v60, v[224:227] offset:2048
  v_pk_mul_f32 v[152:153], v[40:41], v[24:25] op_sel:[0,1] op_sel_hi:[1,1]
  v_pk_mul_f32 v[154:155], v[42:43], v[24:25] op_sel:[0,1] op_sel_hi:[1,1]
  v_pk_mul_f32 v[156:157], v[44:45], v[24:25] op_sel:[0,1] op_sel_hi:[1,1]
  v_pk_mul_f32 v[158:159], v[46:47], v[24:25] op_sel:[0,1] op_sel_hi:[1,1]
  v_pk_fma_f32 v[192:193], v[192:193], v[24:25], v[152:153] op_sel_hi:[1,0,1]
  v_pk_fma_f32 v[194:195], v[194:195], v[24:25], v[154:155] op_sel_hi:[1,0,1]
  v_pk_fma_f32 v[208:209], v[208:209], v[24:25], v[156:157] op_sel_hi:[1,0,1]
  v_pk_fma_f32 v[210:211], v[210:211], v[24:25], v[158:159] op_sel_hi:[1,0,1]
  v_cvt_pk_bf16_f32 v192, v192, v193
  v_cvt_pk_bf16_f32 v193, v194, v195
  v_cvt_pk_bf16_f32 v194, v208, v209
  v_cvt_pk_bf16_f32 v195, v210, v211
  ds_write_b128 v59, v[192:195] offset:0
  ds_write_b128 v60, v[240:243] offset:2304
  v_pk_mul_f32 v[152:153], v[40:41], v[26:27] op_sel:[0,1] op_sel_hi:[1,1]
  v_pk_mul_f32 v[154:155], v[42:43], v[26:27] op_sel:[0,1] op_sel_hi:[1,1]
  v_pk_mul_f32 v[156:157], v[44:45], v[26:27] op_sel:[0,1] op_sel_hi:[1,1]
  v_pk_mul_f32 v[158:159], v[46:47], v[26:27] op_sel:[0,1] op_sel_hi:[1,1]
  v_pk_fma_f32 v[196:197], v[196:197], v[26:27], v[152:153] op_sel_hi:[1,0,1]
  v_pk_fma_f32 v[198:199], v[198:199], v[26:27], v[154:155] op_sel_hi:[1,0,1]
  v_pk_fma_f32 v[212:213], v[212:213], v[26:27], v[156:157] op_sel_hi:[1,0,1]
  v_pk_fma_f32 v[214:215], v[214:215], v[26:27], v[158:159] op_sel_hi:[1,0,1]
  v_cvt_pk_bf16_f32 v196, v196, v197
  v_cvt_pk_bf16_f32 v197, v198, v199
  v_cvt_pk_bf16_f32 v198, v212, v213
  v_cvt_pk_bf16_f32 v199, v214, v215
  ds_write_b128 v59, v[196:199] offset:128
  ds_write_b128 v60, v[232:235] offset:6144
  v_pk_mul_f32 v[152:153], v[40:41], v[28:29] op_sel:[0,1] op_sel_hi:[1,1]
  v_pk_mul_f32 v[154:155], v[42:43], v[28:29] op_sel:[0,1] op_sel_hi:[1,1]
  v_pk_mul_f32 v[156:157], v[44:45], v[28:29] op_sel:[0,1] op_sel_hi:[1,1]
  v_pk_mul_f32 v[158:159], v[46:47], v[28:29] op_sel:[0,1] op_sel_hi:[1,1]
  v_pk_fma_f32 v[200:201], v[200:201], v[28:29], v[152:153] op_sel_hi:[1,0,1]
  v_pk_fma_f32 v[202:203], v[202:203], v[28:29], v[154:155] op_sel_hi:[1,0,1]
  v_pk_fma_f32 v[216:217], v[216:217], v[28:29], v[156:157] op_sel_hi:[1,0,1]
  v_pk_fma_f32 v[218:219], v[218:219], v[28:29], v[158:159] op_sel_hi:[1,0,1]
  v_cvt_pk_bf16_f32 v200, v200, v201
  v_cvt_pk_bf16_f32 v201, v202, v203
  v_cvt_pk_bf16_f32 v202, v216, v217
  v_cvt_pk_bf16_f32 v203, v218, v219
  ds_write_b128 v59, v[200:203] offset:4096
  s_waitcnt vmcnt(0)
  s_mov_b64 exec, 1
  ds_add_rtn_u32 v7, v62, v5 offset:120
  s_mov_b64 exec, -1
  ds_write_b128 v60, v[248:251] offset:6400
  v_pk_mul_f32 v[152:153], v[40:41], v[30:31] op_sel:[0,1] op_sel_hi:[1,1]
  v_pk_mul_f32 v[154:155], v[42:43], v[30:31] op_sel:[0,1] op_sel_hi:[1,1]
  v_pk_mul_f32 v[156:157], v[44:45], v[30:31] op_sel:[0,1] op_sel_hi:[1,1]
  v_pk_mul_f32 v[158:159], v[46:47], v[30:31] op_sel:[0,1] op_sel_hi:[1,1]
  v_pk_fma_f32 v[204:205], v[204:205], v[30:31], v[152:153] op_sel_hi:[1,0,1]
  v_pk_fma_f32 v[206:207], v[206:207], v[30:31], v[154:155] op_sel_hi:[1,0,1]
  v_pk_fma_f32 v[220:221], v[220:221], v[30:31], v[156:157] op_sel_hi:[1,0,1]
  v_pk_fma_f32 v[222:223], v[222:223], v[30:31], v[158:159] op_sel_hi:[1,0,1]
  v_cvt_pk_bf16_f32 v204, v204, v205
  v_cvt_pk_bf16_f32 v205, v206, v207
  v_cvt_pk_bf16_f32 v206, v220, v221
  v_cvt_pk_bf16_f32 v207, v222, v223
  s_waitcnt lgkmcnt(1)
  v_readfirstlane_b32 s28, v7
  s_cmp_eq_u32 s28, 1
  s_cbranch_scc1 .g2_kernel_q_v1f
.g2_kernel_q_v1fb:
  ds_write_b128 v59, v[204:207] offset:4224
  v_pk_mul_f32 v[24:25], v[24:25], v[56:57] op_sel_hi:[1,0]
  v_pk_mul_f32 v[26:27], v[26:27], v[56:57] op_sel_hi:[1,0]
  v_pk_mul_f32 v[28:29], v[28:29], v[56:57] op_sel_hi:[1,0]
  v_pk_mul_f32 v[30:31], v[30:31], v[56:57] op_sel_hi:[1,0]
  v_pk_mul_f32 v[152:153], v[32:33], v[24:25] op_sel:[0,1] op_sel_hi:[1,1]
  v_pk_mul_f32 v[154:155], v[34:35], v[24:25] op_sel:[0,1] op_sel_hi:[1,1]
  v_pk_mul_f32 v[156:157], v[36:37], v[24:25] op_sel:[0,1] op_sel_hi:[1,1]
  v_pk_mul_f32 v[158:159], v[38:39], v[24:25] op_sel:[0,1] op_sel_hi:[1,1]
  v_pk_fma_f32 v[160:161], v[160:161], v[24:25], v[152:153] op_sel_hi:[1,0,1]
  v_pk_fma_f32 v[162:163], v[162:163], v[24:25], v[154:155] op_sel_hi:[1,0,1]
  v_pk_fma_f32 v[176:177], v[176:177], v[24:25], v[156:157] op_sel_hi:[1,0,1]
  v_pk_fma_f32 v[178:179], v[178:179], v[24:25], v[158:159] op_sel_hi:[1,0,1]
  v_cvt_pk_bf16_f32 v160, v160, v161
  v_cvt_pk_bf16_f32 v161, v162, v163
  v_cvt_pk_bf16_f32 v162, v176, v177
  v_cvt_pk_bf16_f32 v163, v178, v179
  ds_write_b128 v61, v[160:163] offset:0
  v_pk_mul_f32 v[152:153], v[32:33], v[26:27] op_sel:[0,1] op_sel_hi:[1,1]
  v_pk_mul_f32 v[154:155], v[34:35], v[26:27] op_sel:[0,1] op_sel_hi:[1,1]
  v_pk_mul_f32 v[156:157], v[36:37], v[26:27] op_sel:[0,1] op_sel_hi:[1,1]
  v_pk_mul_f32 v[158:159], v[38:39], v[26:27] op_sel:[0,1] op_sel_hi:[1,1]
  v_pk_fma_f32 v[164:165], v[164:165], v[26:27], v[152:153] op_sel_hi:[1,0,1]
  v_pk_fma_f32 v[166:167], v[166:167], v[26:27], v[154:155] op_sel_hi:[1,0,1]
  v_pk_fma_f32 v[180:181], v[180:181], v[26:27], v[156:157] op_sel_hi:[1,0,1]
  v_pk_fma_f32 v[182:183], v[182:183], v[26:27], v[158:159] op_sel_hi:[1,0,1]
  v_cvt_pk_bf16_f32 v164, v164, v165
  v_cvt_pk_bf16_f32 v165, v166, v167
  v_cvt_pk_bf16_f32 v166, v180, v181
  v_cvt_pk_bf16_f32 v167, v182, v183
  ds_write_b128 v61, v[164:167] offset:256
  v_pk_mul_f32 v[152:153], v[32:33], v[28:29] op_sel:[0,1] op_sel_hi:[1,1]
  v_pk_mul_f32 v[154:155], v[34:35], v[28:29] op_sel:[0,1] op_sel_hi:[1,1]
  v_pk_mul_f32 v[156:157], v[36:37], v[28:29] op_sel:[0,1] op_sel_hi:[1,1]
  v_pk_mul_f32 v[158:159], v[38:39], v[28:29] op_sel:[0,1] op_sel_hi:[1,1]
  v_pk_fma_f32 v[168:169], v[168:169], v[28:29], v[152:153] op_sel_hi:[1,0,1]
  v_pk_fma_f32 v[170:171], v[170:171], v[28:29], v[154:155] op_sel_hi:[1,0,1]
  v_pk_fma_f32 v[184:185], v[184:185], v[28:29], v[156:157] op_sel_hi:[1,0,1]
  v_pk_fma_f32 v[186:187], v[186:187], v[28:29], v[158:159] op_sel_hi:[1,0,1]
  v_cvt_pk_bf16_f32 v168, v168, v169
  v_cvt_pk_bf16_f32 v169, v170, v171
  v_cvt_pk_bf16_f32 v170, v184, v185
  v_cvt_pk_bf16_f32 v171, v186, v187
  ds_write_b128 v61, v[168:171] offset:2048
  v_pk_mul_f32 v[152:153], v[32:33], v[30:31] op_sel:[0,1] op_sel_hi:[1,1]
  v_pk_mul_f32 v[154:155], v[34:35], v[30:31] op_sel:[0,1] op_sel_hi:[1,1]
  v_pk_mul_f32 v[156:157], v[36:37], v[30:31] op_sel:[0,1] op_sel_hi:[1,1]
  v_pk_mul_f32 v[158:159], v[38:39], v[30:31] op_sel:[0,1] op_sel_hi:[1,1]
  v_pk_fma_f32 v[172:173], v[172:173], v[30:31], v[152:153] op_sel_hi:[1,0,1]
  v_pk_fma_f32 v[174:175], v[174:175], v[30:31], v[154:155] op_sel_hi:[1,0,1]
  v_pk_fma_f32 v[188:189], v[188:189], v[30:31], v[156:157] op_sel_hi:[1,0,1]
  v_pk_fma_f32 v[190:191], v[190:191], v[30:31], v[158:159] op_sel_hi:[1,0,1]
  v_cvt_pk_bf16_f32 v172, v172, v173
  v_cvt_pk_bf16_f32 v173, v174, v175
  v_cvt_pk_bf16_f32 v174, v188, v189
  v_cvt_pk_bf16_f32 v175, v190, v191
  ds_write_b128 v61, v[172:175] offset:2304
  s_branch .g2_kernel_q_kd
.g2_kernel_r2:
  buffer_load_dwordx4 v[240:243], v22, s[4:7], s13 offen offset:0
  buffer_load_dwordx4 v[244:247], v22, s[4:7], s13 offen offset:512
  buffer_load_dwordx4 v[248:251], v22, s[4:7], s13 offen offset:1024
  buffer_load_dwordx4 v[252:255], v22, s[4:7], s13 offen offset:1536
  s_branch .g2_kernel_r3
.g2_kernel_a_t1c:
  s_call_b64 s[68:69], .g2_kernel_a_pick
  s_branch .g2_kernel_a_t1b
.g2_kernel_a_t2c:
  s_call_b64 s[68:69], .g2_kernel_a_pick
  s_branch .g2_kernel_a_t2b
.g2_kernel_a_t3c:
  s_call_b64 s[68:69], .g2_kernel_a_pick
  s_branch .g2_kernel_a_t3b
.g2_kernel_a_three:
  s_andn2_b32 s33, s36, s34
  s_cbranch_scc0 .g2_kernel_a_t1c
.g2_kernel_a_t1b:
  s_ff1_i32_b32 s33, s33
  s_bitset1_b32 s34, s33
  s_xor_b32 s33, s33, s24
  s_lshl_b32 s33, s33, s25
  s_add_u32 s22, s20, s33
  s_addc_u32 s23, s21, 0
  global_load_dwordx4 v[192:195], v3, s[22:23] offset:0
  global_load_dwordx4 v[196:199], v3, s[22:23] offset:1024
  global_load_dwordx4 v[200:203], v3, s[22:23] offset:2048
  global_load_dwordx4 v[204:207], v3, s[22:23] offset:3072
  s_andn2_b32 s33, s36, s34
  s_cbranch_scc0 .g2_kernel_a_t2c
.g2_kernel_a_t2b:
  s_ff1_i32_b32 s33, s33
  s_bitset1_b32 s34, s33
  s_xor_b32 s33, s33, s24
  s_lshl_b32 s33, s33, s25
  s_add_u32 s22, s20, s33
  s_addc_u32 s23, s21, 0
  global_load_dwordx4 v[208:211], v3, s[22:23] offset:0
  global_load_dwordx4 v[212:215], v3, s[22:23] offset:1024
  global_load_dwordx4 v[216:219], v3, s[22:23] offset:2048
  global_load_dwordx4 v[220:223], v3, s[22:23] offset:3072
  s_andn2_b32 s33, s36, s34
  s_cbranch_scc0 .g2_kernel_a_t3c
.g2_kernel_a_t3b:
  s_ff1_i32_b32 s33, s33
  s_bitset1_b32 s34, s33
  s_xor_b32 s33, s33, s24
  s_lshl_b32 s33, s33, s25
  s_add_u32 s22, s20, s33
  s_addc_u32 s23, s21, 0
  global_load_dwordx4 v[224:227], v3, s[22:23] offset:0
  global_load_dwordx4 v[228:231], v3, s[22:23] offset:1024
  global_load_dwordx4 v[232:235], v3, s[22:23] offset:2048
  global_load_dwordx4 v[236:239], v3, s[22:23] offset:3072
  s_setpc_b64 s[72:73]
.g2_kernel_a_o0c:
  s_call_b64 s[68:69], .g2_kernel_a_pick
  s_branch .g2_kernel_a_o0b
.g2_kernel_a_o1c:
  s_call_b64 s[68:69], .g2_kernel_a_pick
  s_branch .g2_kernel_a_o1b
.g2_kernel_a_o2c:
  s_call_b64 s[68:69], .g2_kernel_a_pick
  s_branch .g2_kernel_a_o2b
.g2_kernel_a_o3c:
  s_call_b64 s[68:69], .g2_kernel_a_pick
  s_branch .g2_kernel_a_o3b
.g2_kernel_a_r0c:
  s_call_b64 s[68:69], .g2_kernel_a_pick
  s_branch .g2_kernel_a_r0b
.g2_kernel_a_r1c:
  s_call_b64 s[68:69], .g2_kernel_a_pick
  s_branch .g2_kernel_a_r1b
.g2_kernel_a_r2c:
  s_call_b64 s[68:69], .g2_kernel_a_pick
  s_branch .g2_kernel_a_r2b
.g2_kernel_a_own:
  s_waitcnt lgkmcnt(0)
  s_mov_b32 s14, 0
  s_andn2_b32 s33, s36, s34
  s_cbranch_scc0 .g2_kernel_a_o0c
.g2_kernel_a_o0b:
  s_ff1_i32_b32 s33, s33
  s_bitset1_b32 s34, s33
  s_lshl_b32 s28, s33, 0
  s_or_b32 s14, s14, s28
  s_xor_b32 s33, s33, s24
  s_lshl_b32 s33, s33, s25
  s_add_u32 s22, s20, s33
  s_addc_u32 s23, s21, 0
  global_load_dwordx4 v[176:179], v3, s[22:23] offset:0
  global_load_dwordx4 v[180:183], v3, s[22:23] offset:1024
  global_load_dwordx4 v[184:187], v3, s[22:23] offset:2048
  global_load_dwordx4 v[188:191], v3, s[22:23] offset:3072
  s_andn2_b32 s33, s36, s34
  s_cbranch_scc0 .g2_kernel_a_o1c
.g2_kernel_a_o1b:
  s_ff1_i32_b32 s33, s33
  s_bitset1_b32 s34, s33
  s_lshl_b32 s28, s33, 8
  s_or_b32 s14, s14, s28
  s_xor_b32 s33, s33, s24
  s_lshl_b32 s33, s33, s25
  s_add_u32 s22, s20, s33
  s_addc_u32 s23, s21, 0
  global_load_dwordx4 v[192:195], v3, s[22:23] offset:0
  global_load_dwordx4 v[196:199], v3, s[22:23] offset:1024
  global_load_dwordx4 v[200:203], v3, s[22:23] offset:2048
  global_load_dwordx4 v[204:207], v3, s[22:23] offset:3072
  s_andn2_b32 s33, s36, s34
  s_cbranch_scc0 .g2_kernel_a_o2c
.g2_kernel_a_o2b:
  s_ff1_i32_b32 s33, s33
  s_bitset1_b32 s34, s33
  s_lshl_b32 s28, s33, 16
  s_or_b32 s14, s14, s28
  s_xor_b32 s33, s33, s24
  s_lshl_b32 s33, s33, s25
  s_add_u32 s22, s20, s33
  s_addc_u32 s23, s21, 0
  global_load_dwordx4 v[208:211], v3, s[22:23] offset:0
  global_load_dwordx4 v[212:215], v3, s[22:23] offset:1024
  global_load_dwordx4 v[216:219], v3, s[22:23] offset:2048
  global_load_dwordx4 v[220:223], v3, s[22:23] offset:3072
  s_andn2_b32 s33, s36, s34
  s_cbranch_scc0 .g2_kernel_a_o3c
.g2_kernel_a_o3b:
  s_ff1_i32_b32 s33, s33
  s_bitset1_b32 s34, s33
  s_lshl_b32 s28, s33, 24
  s_or_b32 s14, s14, s28
  s_xor_b32 s33, s33, s24
  s_lshl_b32 s33, s33, s25
  s_add_u32 s22, s20, s33
  s_addc_u32 s23, s21, 0
  global_load_dwordx4 v[224:227], v3, s[22:23] offset:0
  global_load_dwordx4 v[228:231], v3, s[22:23] offset:1024
  global_load_dwordx4 v[232:235], v3, s[22:23] offset:2048
  global_load_dwordx4 v[236:239], v3, s[22:23] offset:3072
  s_and_b32 s15, s34, -2
  s_mov_b32 s34, -1
  s_mov_b32 s26, -1
  s_waitcnt vmcnt(12)
  s_branch .g2_kernel_a_ob
.g2_kernel_a_redo:
  v_mfma_f32_32x32x16_bf16 v[104:119], v[236:239], v[172:175], v[104:119]
  v_smfmac_f32_16x16x64_bf16 v[132:135], v[16:19], v[168:175], v20
  v_mov_b32 v6, s71
  s_mov_b32 s38, 0
.g2_kernel_wg5:
  ds_read_b32 v7, v6 offset:60
  s_add_u32 s38, s38, 1
  s_waitcnt lgkmcnt(0)
  v_cmp_gt_u32 vcc, 1, v7
  s_cbranch_vccz .g2_kernel_wg5d
  s_sleep 1
  s_cmp_lt_u32 s38, 524288
  s_cbranch_scc1 .g2_kernel_wg5
.g2_kernel_wg5d:
  ds_read_b32 v7, v8
  s_mov_b32 s34, s15
  s_mov_b32 s26, 0
  s_waitcnt lgkmcnt(0)
  v_cmp_lt_u32 vcc, s62, v7
  s_mov_b32 s36, vcc_lo
  s_sub_u32 s28, s35, 1
  s_bfe_u32 s28, s28, 0x20005
  s_mov_b32 s35, 0
  s_waitcnt vmcnt(0)
  s_cmp_lg_u32 s28, 0
  s_cbranch_scc1 .g2_kernel_a_rd1
  ds_read_b128 v[24:27], v14 offset:8192
  ds_read_b128 v[28:31], v14 offset:9216
  v_mov_b32 v120, 0
  v_mov_b32 v121, 0
  s_waitcnt lgkmcnt(0)
  v_mfma_f32_32x32x16_bf16 v[136:151], v[176:179], v[24:27], 0
  v_mfma_f32_32x32x16_bf16 v[136:151], v[180:183], v[28:31], v[136:151]
  v_mfma_f32_32x32x16_bf16 v[152:167], v[192:195], v[24:27], 0
  s_nop 10
  v_exp_f32 v136, v136
  v_exp_f32 v137, v137
  v_exp_f32 v138, v138
  v_exp_f32 v139, v139
  v_exp_f32 v140, v140
  v_exp_f32 v141, v141
  v_exp_f32 v142, v142
  v_exp_f32 v143, v143
  v_mfma_f32_32x32x16_bf16 v[152:167], v[196:199], v[28:31], v[152:167]
  v_cvt_pk_bf16_f32 v168, v136, v137
  v_cvt_pk_bf16_f32 v169, v138, v139
  v_cvt_pk_bf16_f32 v170, v140, v141
  v_cvt_pk_bf16_f32 v171, v142, v143
  v_exp_f32 v144, v144
  v_exp_f32 v145, v145
  v_exp_f32 v146, v146
  v_exp_f32 v147, v147
  v_mfma_f32_32x32x16_bf16 v[56:71], v[184:187], v[168:171], 0
  v_exp_f32 v148, v148
  v_exp_f32 v149, v149
  v_exp_f32 v150, v150
  v_exp_f32 v151, v151
  v_cvt_pk_bf16_f32 v172, v144, v145
  v_cvt_pk_bf16_f32 v173, v146, v147
  v_cvt_pk_bf16_f32 v174, v148, v149
  v_cvt_pk_bf16_f32 v175, v150, v151
  v_mfma_f32_32x32x16_bf16 v[136:151], v[208:211], v[24:27], 0
  v_exp_f32 v152, v152
  v_exp_f32 v153, v153
  v_exp_f32 v154, v154
  v_mfma_f32_32x32x16_bf16 v[56:71], v[188:191], v[172:175], v[56:71]
  s_call_b64 s[72:73], .g2_kernel_a_ld0
  v_exp_f32 v155, v155
  v_exp_f32 v156, v156
  v_exp_f32 v157, v157
  v_smfmac_f32_16x16x64_bf16 v[120:123], v[16:19], v[168:175], v20
  v_exp_f32 v158, v158
  v_exp_f32 v159, v159
  v_mfma_f32_32x32x16_bf16 v[136:151], v[212:215], v[28:31], v[136:151]
  v_cvt_pk_bf16_f32 v168, v152, v153
  v_cvt_pk_bf16_f32 v169, v154, v155
  v_cvt_pk_bf16_f32 v170, v156, v157
  v_cvt_pk_bf16_f32 v171, v158, v159
  v_exp_f32 v160, v160
  v_exp_f32 v161, v161
  v_exp_f32 v162, v162
  v_exp_f32 v163, v163
  v_mfma_f32_32x32x16_bf16 v[56:71], v[200:203], v[168:171], v[56:71]
  v_exp_f32 v164, v164
  v_exp_f32 v165, v165
  v_exp_f32 v166, v166
  v_exp_f32 v167, v167
  v_cvt_pk_bf16_f32 v172, v160, v161
  v_cvt_pk_bf16_f32 v173, v162, v163
  v_cvt_pk_bf16_f32 v174, v164, v165
  v_cvt_pk_bf16_f32 v175, v166, v167
  v_mfma_f32_32x32x16_bf16 v[152:167], v[224:227], v[24:27], 0
  v_exp_f32 v136, v136
  v_exp_f32 v137, v137
  v_exp_f32 v138, v138
  v_mfma_f32_32x32x16_bf16 v[56:71], v[204:207], v[172:175], v[56:71]
  s_call_b64 s[72:73], .g2_kernel_a_ld1
  v_exp_f32 v139, v139
  v_exp_f32 v140, v140
  v_exp_f32 v141, v141
  v_smfmac_f32_16x16x64_bf16 v[120:123], v[16:19], v[168:175], v20
  v_exp_f32 v142, v142
  v_exp_f32 v143, v143
  v_mfma_f32_32x32x16_bf16 v[152:167], v[228:231], v[28:31], v[152:167]
  v_cvt_pk_bf16_f32 v168, v136, v137
  v_cvt_pk_bf16_f32 v169, v138, v139
  v_cvt_pk_bf16_f32 v170, v140, v141
  v_cvt_pk_bf16_f32 v171, v142, v143
  v_exp_f32 v144, v144
  v_exp_f32 v145, v145
  v_exp_f32 v146, v146
  v_exp_f32 v147, v147
  v_mfma_f32_32x32x16_bf16 v[56:71], v[216:219], v[168:171], v[56:71]
  v_exp_f32 v148, v148
  v_exp_f32 v149, v149
  v_exp_f32 v150, v150
  v_exp_f32 v151, v151
  v_cvt_pk_bf16_f32 v172, v144, v145
  v_cvt_pk_bf16_f32 v173, v146, v147
  v_cvt_pk_bf16_f32 v174, v148, v149
  v_cvt_pk_bf16_f32 v175, v150, v151
  v_exp_f32 v152, v152
  v_exp_f32 v153, v153
  v_exp_f32 v154, v154
  v_mfma_f32_32x32x16_bf16 v[56:71], v[220:223], v[172:175], v[56:71]
  s_call_b64 s[72:73], .g2_kernel_a_ld2
  v_exp_f32 v155, v155
  v_exp_f32 v156, v156
  v_exp_f32 v157, v157
  v_smfmac_f32_16x16x64_bf16 v[120:123], v[16:19], v[168:175], v20
  v_exp_f32 v158, v158
  v_exp_f32 v159, v159
  v_cvt_pk_bf16_f32 v168, v152, v153
  v_cvt_pk_bf16_f32 v169, v154, v155
  v_cvt_pk_bf16_f32 v170, v156, v157
  v_cvt_pk_bf16_f32 v171, v158, v159
  v_exp_f32 v160, v160
  v_exp_f32 v161, v161
  v_exp_f32 v162, v162
  v_exp_f32 v163, v163
  v_mfma_f32_32x32x16_bf16 v[56:71], v[232:235], v[168:171], v[56:71]
  v_exp_f32 v164, v164
  v_exp_f32 v165, v165
  v_exp_f32 v166, v166
  v_exp_f32 v167, v167
  v_cvt_pk_bf16_f32 v172, v160, v161
  v_cvt_pk_bf16_f32 v173, v162, v163
  v_cvt_pk_bf16_f32 v174, v164, v165
  v_cvt_pk_bf16_f32 v175, v166, v167
  s_nop 1
  v_mfma_f32_32x32x16_bf16 v[56:71], v[236:239], v[172:175], v[56:71]
  v_smfmac_f32_16x16x64_bf16 v[120:123], v[16:19], v[168:175], v20
  s_branch .g2_kernel_a_rde
.g2_kernel_a_rd1:
  s_cmp_lg_u32 s28, 1
  s_cbranch_scc1 .g2_kernel_a_rd2
  ds_read_b128 v[32:35], v14 offset:10240
  ds_read_b128 v[36:39], v14 offset:11264
  v_mov_b32 v124, 0
  v_mov_b32 v125, 0
  s_waitcnt lgkmcnt(0)
  v_mfma_f32_32x32x16_bf16 v[136:151], v[176:179], v[32:35], 0
  v_mfma_f32_32x32x16_bf16 v[136:151], v[180:183], v[36:39], v[136:151]
  v_mfma_f32_32x32x16_bf16 v[152:167], v[192:195], v[32:35], 0
  s_nop 10
  v_exp_f32 v136, v136
  v_exp_f32 v137, v137
  v_exp_f32 v138, v138
  v_exp_f32 v139, v139
  v_exp_f32 v140, v140
  v_exp_f32 v141, v141
  v_exp_f32 v142, v142
  v_exp_f32 v143, v143
  v_mfma_f32_32x32x16_bf16 v[152:167], v[196:199], v[36:39], v[152:167]
  v_cvt_pk_bf16_f32 v168, v136, v137
  v_cvt_pk_bf16_f32 v169, v138, v139
  v_cvt_pk_bf16_f32 v170, v140, v141
  v_cvt_pk_bf16_f32 v171, v142, v143
  v_exp_f32 v144, v144
  v_exp_f32 v145, v145
  v_exp_f32 v146, v146
  v_exp_f32 v147, v147
  v_mfma_f32_32x32x16_bf16 v[72:87], v[184:187], v[168:171], 0
  v_exp_f32 v148, v148
  v_exp_f32 v149, v149
  v_exp_f32 v150, v150
  v_exp_f32 v151, v151
  v_cvt_pk_bf16_f32 v172, v144, v145
  v_cvt_pk_bf16_f32 v173, v146, v147
  v_cvt_pk_bf16_f32 v174, v148, v149
  v_cvt_pk_bf16_f32 v175, v150, v151
  v_mfma_f32_32x32x16_bf16 v[136:151], v[208:211], v[32:35], 0
  v_exp_f32 v152, v152
  v_exp_f32 v153, v153
  v_exp_f32 v154, v154
  v_mfma_f32_32x32x16_bf16 v[72:87], v[188:191], v[172:175], v[72:87]
  s_call_b64 s[72:73], .g2_kernel_a_ld0
  v_exp_f32 v155, v155
  v_exp_f32 v156, v156
  v_exp_f32 v157, v157
  v_smfmac_f32_16x16x64_bf16 v[124:127], v[16:19], v[168:175], v20
  v_exp_f32 v158, v158
  v_exp_f32 v159, v159
  v_mfma_f32_32x32x16_bf16 v[136:151], v[212:215], v[36:39], v[136:151]
  v_cvt_pk_bf16_f32 v168, v152, v153
  v_cvt_pk_bf16_f32 v169, v154, v155
  v_cvt_pk_bf16_f32 v170, v156, v157
  v_cvt_pk_bf16_f32 v171, v158, v159
  v_exp_f32 v160, v160
  v_exp_f32 v161, v161
  v_exp_f32 v162, v162
  v_exp_f32 v163, v163
  v_mfma_f32_32x32x16_bf16 v[72:87], v[200:203], v[168:171], v[72:87]
  v_exp_f32 v164, v164
  v_exp_f32 v165, v165
  v_exp_f32 v166, v166
  v_exp_f32 v167, v167
  v_cvt_pk_bf16_f32 v172, v160, v161
  v_cvt_pk_bf16_f32 v173, v162, v163
  v_cvt_pk_bf16_f32 v174, v164, v165
  v_cvt_pk_bf16_f32 v175, v166, v167
  v_mfma_f32_32x32x16_bf16 v[152:167], v[224:227], v[32:35], 0
  v_exp_f32 v136, v136
  v_exp_f32 v137, v137
  v_exp_f32 v138, v138
  v_mfma_f32_32x32x16_bf16 v[72:87], v[204:207], v[172:175], v[72:87]
  s_call_b64 s[72:73], .g2_kernel_a_ld1
  v_exp_f32 v139, v139
  v_exp_f32 v140, v140
  v_exp_f32 v141, v141
  v_smfmac_f32_16x16x64_bf16 v[124:127], v[16:19], v[168:175], v20
  v_exp_f32 v142, v142
  v_exp_f32 v143, v143
  v_mfma_f32_32x32x16_bf16 v[152:167], v[228:231], v[36:39], v[152:167]
  v_cvt_pk_bf16_f32 v168, v136, v137
  v_cvt_pk_bf16_f32 v169, v138, v139
  v_cvt_pk_bf16_f32 v170, v140, v141
  v_cvt_pk_bf16_f32 v171, v142, v143
  v_exp_f32 v144, v144
  v_exp_f32 v145, v145
  v_exp_f32 v146, v146
  v_exp_f32 v147, v147
  v_mfma_f32_32x32x16_bf16 v[72:87], v[216:219], v[168:171], v[72:87]
  v_exp_f32 v148, v148
  v_exp_f32 v149, v149
  v_exp_f32 v150, v150
  v_exp_f32 v151, v151
  v_cvt_pk_bf16_f32 v172, v144, v145
  v_cvt_pk_bf16_f32 v173, v146, v147
  v_cvt_pk_bf16_f32 v174, v148, v149
  v_cvt_pk_bf16_f32 v175, v150, v151
  v_exp_f32 v152, v152
  v_exp_f32 v153, v153
  v_exp_f32 v154, v154
  v_mfma_f32_32x32x16_bf16 v[72:87], v[220:223], v[172:175], v[72:87]
  s_call_b64 s[72:73], .g2_kernel_a_ld2
  v_exp_f32 v155, v155
  v_exp_f32 v156, v156
  v_exp_f32 v157, v157
  v_smfmac_f32_16x16x64_bf16 v[124:127], v[16:19], v[168:175], v20
  v_exp_f32 v158, v158
  v_exp_f32 v159, v159
  v_cvt_pk_bf16_f32 v168, v152, v153
  v_cvt_pk_bf16_f32 v169, v154, v155
  v_cvt_pk_bf16_f32 v170, v156, v157
  v_cvt_pk_bf16_f32 v171, v158, v159
  v_exp_f32 v160, v160
  v_exp_f32 v161, v161
  v_exp_f32 v162, v162
  v_exp_f32 v163, v163
  v_mfma_f32_32x32x16_bf16 v[72:87], v[232:235], v[168:171], v[72:87]
  v_exp_f32 v164, v164
  v_exp_f32 v165, v165
  v_exp_f32 v166, v166
  v_exp_f32 v167, v167
  v_cvt_pk_bf16_f32 v172, v160, v161
  v_cvt_pk_bf16_f32 v173, v162, v163
  v_cvt_pk_bf16_f32 v174, v164, v165
  v_cvt_pk_bf16_f32 v175, v166, v167
  s_nop 1
  v_mfma_f32_32x32x16_bf16 v[72:87], v[236:239], v[172:175], v[72:87]
  v_smfmac_f32_16x16x64_bf16 v[124:127], v[16:19], v[168:175], v20
  s_branch .g2_kernel_a_rde
.g2_kernel_a_rd2:
  s_cmp_lg_u32 s28, 2
  s_cbranch_scc1 .g2_kernel_a_rd3
  ds_read_b128 v[40:43], v14 offset:12288
  ds_read_b128 v[44:47], v14 offset:13312
  v_mov_b32 v128, 0
  v_mov_b32 v129, 0
  s_waitcnt lgkmcnt(0)
  v_mfma_f32_32x32x16_bf16 v[136:151], v[176:179], v[40:43], 0
  v_mfma_f32_32x32x16_bf16 v[136:151], v[180:183], v[44:47], v[136:151]
  v_mfma_f32_32x32x16_bf16 v[152:167], v[192:195], v[40:43], 0
  s_nop 10
  v_exp_f32 v136, v136
  v_exp_f32 v137, v137
  v_exp_f32 v138, v138
  v_exp_f32 v139, v139
  v_exp_f32 v140, v140
  v_exp_f32 v141, v141
  v_exp_f32 v142, v142
  v_exp_f32 v143, v143
  v_mfma_f32_32x32x16_bf16 v[152:167], v[196:199], v[44:47], v[152:167]
  v_cvt_pk_bf16_f32 v168, v136, v137
  v_cvt_pk_bf16_f32 v169, v138, v139
  v_cvt_pk_bf16_f32 v170, v140, v141
  v_cvt_pk_bf16_f32 v171, v142, v143
  v_exp_f32 v144, v144
  v_exp_f32 v145, v145
  v_exp_f32 v146, v146
  v_exp_f32 v147, v147
  v_mfma_f32_32x32x16_bf16 v[88:103], v[184:187], v[168:171], 0
  v_exp_f32 v148, v148
  v_exp_f32 v149, v149
  v_exp_f32 v150, v150
  v_exp_f32 v151, v151
  v_cvt_pk_bf16_f32 v172, v144, v145
  v_cvt_pk_bf16_f32 v173, v146, v147
  v_cvt_pk_bf16_f32 v174, v148, v149
  v_cvt_pk_bf16_f32 v175, v150, v151
  v_mfma_f32_32x32x16_bf16 v[136:151], v[208:211], v[40:43], 0
  v_exp_f32 v152, v152
  v_exp_f32 v153, v153
  v_exp_f32 v154, v154
  v_mfma_f32_32x32x16_bf16 v[88:103], v[188:191], v[172:175], v[88:103]
  s_call_b64 s[72:73], .g2_kernel_a_ld0
  v_exp_f32 v155, v155
  v_exp_f32 v156, v156
  v_exp_f32 v157, v157
  v_smfmac_f32_16x16x64_bf16 v[128:131], v[16:19], v[168:175], v20
  v_exp_f32 v158, v158
  v_exp_f32 v159, v159
  v_mfma_f32_32x32x16_bf16 v[136:151], v[212:215], v[44:47], v[136:151]
  v_cvt_pk_bf16_f32 v168, v152, v153
  v_cvt_pk_bf16_f32 v169, v154, v155
  v_cvt_pk_bf16_f32 v170, v156, v157
  v_cvt_pk_bf16_f32 v171, v158, v159
  v_exp_f32 v160, v160
  v_exp_f32 v161, v161
  v_exp_f32 v162, v162
  v_exp_f32 v163, v163
  v_mfma_f32_32x32x16_bf16 v[88:103], v[200:203], v[168:171], v[88:103]
  v_exp_f32 v164, v164
  v_exp_f32 v165, v165
  v_exp_f32 v166, v166
  v_exp_f32 v167, v167
  v_cvt_pk_bf16_f32 v172, v160, v161
  v_cvt_pk_bf16_f32 v173, v162, v163
  v_cvt_pk_bf16_f32 v174, v164, v165
  v_cvt_pk_bf16_f32 v175, v166, v167
  v_mfma_f32_32x32x16_bf16 v[152:167], v[224:227], v[40:43], 0
  v_exp_f32 v136, v136
  v_exp_f32 v137, v137
  v_exp_f32 v138, v138
  v_mfma_f32_32x32x16_bf16 v[88:103], v[204:207], v[172:175], v[88:103]
  s_call_b64 s[72:73], .g2_kernel_a_ld1
  v_exp_f32 v139, v139
  v_exp_f32 v140, v140
  v_exp_f32 v141, v141
  v_smfmac_f32_16x16x64_bf16 v[128:131], v[16:19], v[168:175], v20
  v_exp_f32 v142, v142
  v_exp_f32 v143, v143
  v_mfma_f32_32x32x16_bf16 v[152:167], v[228:231], v[44:47], v[152:167]
  v_cvt_pk_bf16_f32 v168, v136, v137
  v_cvt_pk_bf16_f32 v169, v138, v139
  v_cvt_pk_bf16_f32 v170, v140, v141
  v_cvt_pk_bf16_f32 v171, v142, v143
  v_exp_f32 v144, v144
  v_exp_f32 v145, v145
  v_exp_f32 v146, v146
  v_exp_f32 v147, v147
  v_mfma_f32_32x32x16_bf16 v[88:103], v[216:219], v[168:171], v[88:103]
  v_exp_f32 v148, v148
  v_exp_f32 v149, v149
  v_exp_f32 v150, v150
  v_exp_f32 v151, v151
  v_cvt_pk_bf16_f32 v172, v144, v145
  v_cvt_pk_bf16_f32 v173, v146, v147
  v_cvt_pk_bf16_f32 v174, v148, v149
  v_cvt_pk_bf16_f32 v175, v150, v151
  v_exp_f32 v152, v152
  v_exp_f32 v153, v153
  v_exp_f32 v154, v154
  v_mfma_f32_32x32x16_bf16 v[88:103], v[220:223], v[172:175], v[88:103]
  s_call_b64 s[72:73], .g2_kernel_a_ld2
  v_exp_f32 v155, v155
  v_exp_f32 v156, v156
  v_exp_f32 v157, v157
  v_smfmac_f32_16x16x64_bf16 v[128:131], v[16:19], v[168:175], v20
  v_exp_f32 v158, v158
  v_exp_f32 v159, v159
  v_cvt_pk_bf16_f32 v168, v152, v153
  v_cvt_pk_bf16_f32 v169, v154, v155
  v_cvt_pk_bf16_f32 v170, v156, v157
  v_cvt_pk_bf16_f32 v171, v158, v159
  v_exp_f32 v160, v160
  v_exp_f32 v161, v161
  v_exp_f32 v162, v162
  v_exp_f32 v163, v163
  v_mfma_f32_32x32x16_bf16 v[88:103], v[232:235], v[168:171], v[88:103]
  v_exp_f32 v164, v164
  v_exp_f32 v165, v165
  v_exp_f32 v166, v166
  v_exp_f32 v167, v167
  v_cvt_pk_bf16_f32 v172, v160, v161
  v_cvt_pk_bf16_f32 v173, v162, v163
  v_cvt_pk_bf16_f32 v174, v164, v165
  v_cvt_pk_bf16_f32 v175, v166, v167
  s_nop 1
  v_mfma_f32_32x32x16_bf16 v[88:103], v[236:239], v[172:175], v[88:103]
  v_smfmac_f32_16x16x64_bf16 v[128:131], v[16:19], v[168:175], v20
  s_branch .g2_kernel_a_rde
.g2_kernel_a_rd3:
  ds_read_b128 v[48:51], v14 offset:14336
  ds_read_b128 v[52:55], v14 offset:15360
  v_mov_b32 v132, 0
  v_mov_b32 v133, 0
  s_waitcnt lgkmcnt(0)
  v_mfma_f32_32x32x16_bf16 v[136:151], v[176:179], v[48:51], 0
  v_mfma_f32_32x32x16_bf16 v[136:151], v[180:183], v[52:55], v[136:151]
  v_mfma_f32_32x32x16_bf16 v[152:167], v[192:195], v[48:51], 0
  s_nop 10
  v_exp_f32 v136, v136
  v_exp_f32 v137, v137
  v_exp_f32 v138, v138
  v_exp_f32 v139, v139
  v_exp_f32 v140, v140
  v_exp_f32 v141, v141
  v_exp_f32 v142, v142
  v_exp_f32 v143, v143
  v_mfma_f32_32x32x16_bf16 v[152:167], v[196:199], v[52:55], v[152:167]
  v_cvt_pk_bf16_f32 v168, v136, v137
  v_cvt_pk_bf16_f32 v169, v138, v139
  v_cvt_pk_bf16_f32 v170, v140, v141
  v_cvt_pk_bf16_f32 v171, v142, v143
  v_exp_f32 v144, v144
  v_exp_f32 v145, v145
  v_exp_f32 v146, v146
  v_exp_f32 v147, v147
  v_mfma_f32_32x32x16_bf16 v[104:119], v[184:187], v[168:171], 0
  v_exp_f32 v148, v148
  v_exp_f32 v149, v149
  v_exp_f32 v150, v150
  v_exp_f32 v151, v151
  v_cvt_pk_bf16_f32 v172, v144, v145
  v_cvt_pk_bf16_f32 v173, v146, v147
  v_cvt_pk_bf16_f32 v174, v148, v149
  v_cvt_pk_bf16_f32 v175, v150, v151
  v_mfma_f32_32x32x16_bf16 v[136:151], v[208:211], v[48:51], 0
  v_exp_f32 v152, v152
  v_exp_f32 v153, v153
  v_exp_f32 v154, v154
  v_mfma_f32_32x32x16_bf16 v[104:119], v[188:191], v[172:175], v[104:119]
  s_call_b64 s[72:73], .g2_kernel_a_ld0
  v_exp_f32 v155, v155
  v_exp_f32 v156, v156
  v_exp_f32 v157, v157
  v_smfmac_f32_16x16x64_bf16 v[132:135], v[16:19], v[168:175], v20
  v_exp_f32 v158, v158
  v_exp_f32 v159, v159
  v_mfma_f32_32x32x16_bf16 v[136:151], v[212:215], v[52:55], v[136:151]
  v_cvt_pk_bf16_f32 v168, v152, v153
  v_cvt_pk_bf16_f32 v169, v154, v155
  v_cvt_pk_bf16_f32 v170, v156, v157
  v_cvt_pk_bf16_f32 v171, v158, v159
  v_exp_f32 v160, v160
  v_exp_f32 v161, v161
  v_exp_f32 v162, v162
  v_exp_f32 v163, v163
  v_mfma_f32_32x32x16_bf16 v[104:119], v[200:203], v[168:171], v[104:119]
  v_exp_f32 v164, v164
  v_exp_f32 v165, v165
  v_exp_f32 v166, v166
  v_exp_f32 v167, v167
  v_cvt_pk_bf16_f32 v172, v160, v161
  v_cvt_pk_bf16_f32 v173, v162, v163
  v_cvt_pk_bf16_f32 v174, v164, v165
  v_cvt_pk_bf16_f32 v175, v166, v167
  v_mfma_f32_32x32x16_bf16 v[152:167], v[224:227], v[48:51], 0
  v_exp_f32 v136, v136
  v_exp_f32 v137, v137
  v_exp_f32 v138, v138
  v_mfma_f32_32x32x16_bf16 v[104:119], v[204:207], v[172:175], v[104:119]
  s_call_b64 s[72:73], .g2_kernel_a_ld1
  v_exp_f32 v139, v139
  v_exp_f32 v140, v140
  v_exp_f32 v141, v141
  v_smfmac_f32_16x16x64_bf16 v[132:135], v[16:19], v[168:175], v20
  v_exp_f32 v142, v142
  v_exp_f32 v143, v143
  v_mfma_f32_32x32x16_bf16 v[152:167], v[228:231], v[52:55], v[152:167]
  v_cvt_pk_bf16_f32 v168, v136, v137
  v_cvt_pk_bf16_f32 v169, v138, v139
  v_cvt_pk_bf16_f32 v170, v140, v141
  v_cvt_pk_bf16_f32 v171, v142, v143
  v_exp_f32 v144, v144
  v_exp_f32 v145, v145
  v_exp_f32 v146, v146
  v_exp_f32 v147, v147
  v_mfma_f32_32x32x16_bf16 v[104:119], v[216:219], v[168:171], v[104:119]
  v_exp_f32 v148, v148
  v_exp_f32 v149, v149
  v_exp_f32 v150, v150
  v_exp_f32 v151, v151
  v_cvt_pk_bf16_f32 v172, v144, v145
  v_cvt_pk_bf16_f32 v173, v146, v147
  v_cvt_pk_bf16_f32 v174, v148, v149
  v_cvt_pk_bf16_f32 v175, v150, v151
  v_exp_f32 v152, v152
  v_exp_f32 v153, v153
  v_exp_f32 v154, v154
  v_mfma_f32_32x32x16_bf16 v[104:119], v[220:223], v[172:175], v[104:119]
  s_call_b64 s[72:73], .g2_kernel_a_ld2
  v_exp_f32 v155, v155
  v_exp_f32 v156, v156
  v_exp_f32 v157, v157
  v_smfmac_f32_16x16x64_bf16 v[132:135], v[16:19], v[168:175], v20
  v_exp_f32 v158, v158
  v_exp_f32 v159, v159
  v_cvt_pk_bf16_f32 v168, v152, v153
  v_cvt_pk_bf16_f32 v169, v154, v155
  v_cvt_pk_bf16_f32 v170, v156, v157
  v_cvt_pk_bf16_f32 v171, v158, v159
  v_exp_f32 v160, v160
  v_exp_f32 v161, v161
  v_exp_f32 v162, v162
  v_exp_f32 v163, v163
  v_mfma_f32_32x32x16_bf16 v[104:119], v[232:235], v[168:171], v[104:119]
  v_exp_f32 v164, v164
  v_exp_f32 v165, v165
  v_exp_f32 v166, v166
  v_exp_f32 v167, v167
  v_cvt_pk_bf16_f32 v172, v160, v161
  v_cvt_pk_bf16_f32 v173, v162, v163
  v_cvt_pk_bf16_f32 v174, v164, v165
  v_cvt_pk_bf16_f32 v175, v166, v167
  s_nop 1
  v_mfma_f32_32x32x16_bf16 v[104:119], v[236:239], v[172:175], v[104:119]
  v_smfmac_f32_16x16x64_bf16 v[132:135], v[16:19], v[168:175], v20
  s_branch .g2_kernel_a_rde
.g2_kernel_a_rd4:
.g2_kernel_a_rde:
  v_mov_b32 v168, 0
  v_mov_b32 v169, 0
  v_mov_b32 v170, 0
  v_mov_b32 v171, 0
  v_mov_b32 v172, 0
  v_mov_b32 v173, 0
  v_mov_b32 v174, 0
  v_mov_b32 v175, 0
  s_waitcnt vmcnt(8)
  v_mfma_f32_32x32x16_bf16 v[136:151], v[176:179], v[24:27], 0
  v_mfma_f32_32x32x16_bf16 v[136:151], v[180:183], v[28:31], v[136:151]
  v_mfma_f32_32x32x16_bf16 v[152:167], v[176:179], v[32:35], 0
  s_nop 10
  s_branch .g2_kernel_a_loop
.g2_kernel_a_ld0:
  s_andn2_b32 s33, s36, s34
  s_cbranch_scc0 .g2_kernel_a_r0c
.g2_kernel_a_r0b:
  s_ff1_i32_b32 s33, s33
  s_bitset1_b32 s34, s33
  s_xor_b32 s33, s33, s24
  s_lshl_b32 s33, s33, s25
  s_add_u32 s22, s20, s33
  s_addc_u32 s23, s21, 0
  global_load_dwordx4 v[176:179], v3, s[22:23] offset:0
  global_load_dwordx4 v[180:183], v3, s[22:23] offset:1024
  global_load_dwordx4 v[184:187], v3, s[22:23] offset:2048
  global_load_dwordx4 v[188:191], v3, s[22:23] offset:3072
  s_setpc_b64 s[72:73]
.g2_kernel_a_ld1:
  s_andn2_b32 s33, s36, s34
  s_cbranch_scc0 .g2_kernel_a_r1c
.g2_kernel_a_r1b:
  s_ff1_i32_b32 s33, s33
  s_bitset1_b32 s34, s33
  s_xor_b32 s33, s33, s24
  s_lshl_b32 s33, s33, s25
  s_add_u32 s22, s20, s33
  s_addc_u32 s23, s21, 0
  global_load_dwordx4 v[192:195], v3, s[22:23] offset:0
  global_load_dwordx4 v[196:199], v3, s[22:23] offset:1024
  global_load_dwordx4 v[200:203], v3, s[22:23] offset:2048
  global_load_dwordx4 v[204:207], v3, s[22:23] offset:3072
  s_setpc_b64 s[72:73]
.g2_kernel_a_ld2:
  s_andn2_b32 s33, s36, s34
  s_cbranch_scc0 .g2_kernel_a_r2c
.g2_kernel_a_r2b:
  s_ff1_i32_b32 s33, s33
  s_bitset1_b32 s34, s33
  s_xor_b32 s33, s33, s24
  s_lshl_b32 s33, s33, s25
  s_add_u32 s22, s20, s33
  s_addc_u32 s23, s21, 0
  global_load_dwordx4 v[208:211], v3, s[22:23] offset:0
  global_load_dwordx4 v[212:215], v3, s[22:23] offset:1024
  global_load_dwordx4 v[216:219], v3, s[22:23] offset:2048
  global_load_dwordx4 v[220:223], v3, s[22:23] offset:3072
  s_setpc_b64 s[72:73]
.g2_kernel_a_N0c:
  s_call_b64 s[68:69], .g2_kernel_a_pick
  s_branch .g2_kernel_a_N0b
.g2_kernel_a_N1c:
  s_call_b64 s[68:69], .g2_kernel_a_pick
  s_branch .g2_kernel_a_N1b
.g2_kernel_a_N2c:
  s_call_b64 s[68:69], .g2_kernel_a_pick
  s_branch .g2_kernel_a_N2b
.g2_kernel_a_N3c:
  s_call_b64 s[68:69], .g2_kernel_a_pick
  s_branch .g2_kernel_a_N3b
.g2_kernel_a_L3c:
  s_call_b64 s[68:69], .g2_kernel_a_pick
  s_branch .g2_kernel_a_L3b
.g2_kernel_a_G0c:
  s_call_b64 s[68:69], .g2_kernel_a_pick
  s_branch .g2_kernel_a_G0b
.g2_kernel_a_L3g:
  s_mov_b32 s38, 0
.g2_kernel_a_L3gl:
  ds_read_b32 v7, v13 offset:8
  s_add_u32 s38, s38, 1
  s_waitcnt lgkmcnt(0)
  v_cmp_gt_u32 vcc, s27, v7
  s_cbranch_vccz .g2_kernel_a_L3h
  s_cmp_lt_u32 s38, 524288
  s_cbranch_scc1 .g2_kernel_a_L3gl
  s_branch .g2_kernel_a_L3h
.g2_kernel_a_hold:
  s_lshl_b32 s33, 1, s14
  s_lshr_b32 s14, s14, 8
  s_setpc_b64 s[68:69]
.g2_kernel_a_pick:
  s_cmp_lg_u32 s34, -1
  s_cbranch_scc1 .g2_kernel_a_pk1
  s_cmp_eq_u32 s26, -1
  s_cbranch_scc1 .g2_kernel_a_hold
  s_add_u32 s26, s26, 1
  s_mov_b32 s34, 0xffff
  s_cmp_eq_u32 s26, 1
  s_cbranch_scc1 .g2_kernel_a_pk0
  v_and_b32 v8, 15, v2
  s_lshl_b32 s28, s16, 6
  s_add_u32 s28, s28, 157696
  v_lshl_add_u32 v8, v8, 2, s28
  s_lshl_b32 s28, s17, 2
  s_add_u32 s28, s28, s16
  s_lshl_b32 s28, s28, 16
  s_add_u32 s28, s28, s63
  s_add_u32 s28, s28, 0x800000
  s_add_u32 s20, s60, s28
  s_addc_u32 s21, s61, 0
  s_lshl_b32 s24, s18, 1
  s_and_b32 s24, s24, 6
  s_mov_b32 s25, 12
  s_mov_b32 s34, 0
  s_mov_b32 s36, 0xff
  s_mov_b32 s33, 0xff
  s_mov_b32 s38, 0
.g2_kernel_a_pk2:
  ds_read_b32 v7, v8
  s_add_u32 s38, s38, 1
  s_waitcnt lgkmcnt(0)
  v_cmp_ge_u32 vcc, s62, v7
  s_cbranch_vccz .g2_kernel_a_pkr
  s_cmp_lt_u32 s38, 524288
  s_cbranch_scc1 .g2_kernel_a_pk2
  s_branch .g2_kernel_a_pkr
.g2_kernel_a_pk0:
  s_andn2_b32 s33, s36, s34
  s_cbranch_scc1 .g2_kernel_a_pkr
.g2_kernel_a_pk1:
  s_mov_b32 s38, 0
.g2_kernel_a_pkl:
  ds_read_b32 v7, v8
  s_add_u32 s38, s38, 1
  s_waitcnt lgkmcnt(0)
  v_cmp_lt_u32 vcc, s62, v7
  s_mov_b32 s36, vcc_lo
  s_andn2_b32 s33, s36, s34
  s_cbranch_scc1 .g2_kernel_a_pkr
  s_cmp_lt_u32 s38, 524288
  s_cbranch_scc1 .g2_kernel_a_pkl
  s_not_b32 s33, s34
.g2_kernel_a_pkr:
  s_setpc_b64 s[68:69]
.g2_kernel_w_aw:
  v_mov_b32 v6, s71
  s_mov_b32 s38, 0
.g2_kernel_wg6:
  ds_read_b32 v7, v6 offset:52
  s_add_u32 s38, s38, 1
  s_waitcnt lgkmcnt(0)
  v_cmp_gt_u32 vcc, 4, v7
  s_cbranch_vccz .g2_kernel_wg6d
  s_sleep 1
  s_cmp_lt_u32 s38, 524288
  s_cbranch_scc1 .g2_kernel_wg6
.g2_kernel_wg6d:
  s_branch .g2_kernel_w_ab
.g2_kernel_w_pt:
  v_lshlrev_b32 v7, 5, v17
  v_add_u32 v7, 155648, v7
  s_mov_b64 exec, vcc
  ds_read_b128 v[240:243], v7 offset:7680
  ds_read_b128 v[244:247], v7 offset:7696
  ds_read_b128 v[248:251], v7 offset:7744
  ds_read_b128 v[252:255], v7 offset:7760
  s_waitcnt lgkmcnt(0)
  v_pk_add_f32 v[24:25], v[24:25], v[240:241]
  v_pk_add_f32 v[26:27], v[26:27], v[242:243]
  v_pk_add_f32 v[28:29], v[28:29], v[244:245]
  v_pk_add_f32 v[30:31], v[30:31], v[246:247]
  v_pk_add_f32 v[32:33], v[32:33], v[248:249]
  v_pk_add_f32 v[34:35], v[34:35], v[250:251]
  v_pk_add_f32 v[36:37], v[36:37], v[252:253]
  v_pk_add_f32 v[38:39], v[38:39], v[254:255]
  ds_read_b128 v[240:243], v7 offset:7808
  ds_read_b128 v[244:247], v7 offset:7824
  ds_read_b128 v[248:251], v7 offset:7872
  ds_read_b128 v[252:255], v7 offset:7888
  s_waitcnt lgkmcnt(0)
  v_pk_add_f32 v[40:41], v[40:41], v[240:241]
  v_pk_add_f32 v[42:43], v[42:43], v[242:243]
  v_pk_add_f32 v[44:45], v[44:45], v[244:245]
  v_pk_add_f32 v[46:47], v[46:47], v[246:247]
  v_pk_add_f32 v[48:49], v[48:49], v[248:249]
  v_pk_add_f32 v[50:51], v[50:51], v[250:251]
  v_pk_add_f32 v[52:53], v[52:53], v[252:253]
  v_pk_add_f32 v[54:55], v[54:55], v[254:255]
  s_mov_b64 exec, -1
  s_branch .g2_kernel_w_pb
.g2_kernel_w_i8c:
  s_mov_b32 s38, 0
  s_call_b64 s[68:69], .g2_kernel_w_pkl
  s_branch .g2_kernel_w_i8b
.g2_kernel_w_i9c:
  s_mov_b32 s38, 0
  s_call_b64 s[68:69], .g2_kernel_w_pkl
  s_branch .g2_kernel_w_i9b
.g2_kernel_w_i10c:
  s_mov_b32 s38, 0
  s_call_b64 s[68:69], .g2_kernel_w_pkl
  s_branch .g2_kernel_w_i10b
.g2_kernel_w_i11c:
  s_mov_b32 s38, 0
  s_call_b64 s[68:69], .g2_kernel_w_pkl
  s_branch .g2_kernel_w_i11b
.g2_kernel_w_v8:
  s_cmp_ge_u32 s8, 139264
  s_cselect_b32 s28, 139264, 0
  s_sub_u32 s28, s8, s28
  s_lshr_b32 s28, s28, 1
  s_add_u32 s28, s28, 32768
  s_add_u32 s22, s20, s28
  s_addc_u32 s23, s21, 0
  s_mov_b32 s38, 0
.g2_kernel_w_vl8:
  global_load_dwordx4 v[88:91], v3, s[22:23] offset:0 sc1
  global_load_dwordx4 v[92:95], v3, s[22:23] offset:1024 sc1
  global_load_dwordx4 v[96:99], v3, s[22:23] offset:2048 sc1
  global_load_dwordx4 v[100:103], v3, s[22:23] offset:3072 sc1
  s_add_u32 s38, s38, 1
  s_waitcnt vmcnt(0)
  v_min3_u32 v6, v88, v90, v92
  v_min3_u32 v7, v94, v96, v98
  v_min3_u32 v6, v6, v100, v102
  v_min_u32 v6, v6, v7
  v_cmp_eq_u32 vcc, 0, v6
  s_cbranch_vccz .g2_kernel_w_vb8
  s_cmp_lt_u32 s38, 131072
  s_cbranch_scc1 .g2_kernel_w_vl8
  s_branch .g2_kernel_w_vb8
.g2_kernel_w_i12c:
  s_mov_b32 s38, 0
  s_call_b64 s[68:69], .g2_kernel_w_pkl
  s_branch .g2_kernel_w_i12b
.g2_kernel_w_v9:
  s_cmp_ge_u32 s9, 139264
  s_cselect_b32 s28, 139264, 0
  s_sub_u32 s28, s9, s28
  s_lshr_b32 s28, s28, 1
  s_add_u32 s28, s28, 32768
  s_add_u32 s22, s20, s28
  s_addc_u32 s23, s21, 0
  s_mov_b32 s38, 0
.g2_kernel_w_vl9:
  global_load_dwordx4 v[176:179], v3, s[22:23] offset:0 sc1
  global_load_dwordx4 v[180:183], v3, s[22:23] offset:1024 sc1
  global_load_dwordx4 v[184:187], v3, s[22:23] offset:2048 sc1
  global_load_dwordx4 v[188:191], v3, s[22:23] offset:3072 sc1
  s_add_u32 s38, s38, 1
  s_waitcnt vmcnt(0)
  v_min3_u32 v6, v176, v178, v180
  v_min3_u32 v7, v182, v184, v186
  v_min3_u32 v6, v6, v188, v190
  v_min_u32 v6, v6, v7
  v_cmp_eq_u32 vcc, 0, v6
  s_cbranch_vccz .g2_kernel_w_vb9
  s_cmp_lt_u32 s38, 131072
  s_cbranch_scc1 .g2_kernel_w_vl9
  s_branch .g2_kernel_w_vb9
.g2_kernel_w_i13c:
  s_mov_b32 s38, 0
  s_call_b64 s[68:69], .g2_kernel_w_pkl
  s_branch .g2_kernel_w_i13b
.g2_kernel_w_v10:
  s_cmp_ge_u32 s10, 139264
  s_cselect_b32 s28, 139264, 0
  s_sub_u32 s28, s10, s28
  s_lshr_b32 s28, s28, 1
  s_add_u32 s28, s28, 32768
  s_add_u32 s22, s20, s28
  s_addc_u32 s23, s21, 0
  s_mov_b32 s38, 0
.g2_kernel_w_vl10:
  global_load_dwordx4 v[192:195], v3, s[22:23] offset:0 sc1
  global_load_dwordx4 v[196:199], v3, s[22:23] offset:1024 sc1
  global_load_dwordx4 v[200:203], v3, s[22:23] offset:2048 sc1
  global_load_dwordx4 v[204:207], v3, s[22:23] offset:3072 sc1
  s_add_u32 s38, s38, 1
  s_waitcnt vmcnt(0)
  v_min3_u32 v6, v192, v194, v196
  v_min3_u32 v7, v198, v200, v202
  v_min3_u32 v6, v6, v204, v206
  v_min_u32 v6, v6, v7
  v_cmp_eq_u32 vcc, 0, v6
  s_cbranch_vccz .g2_kernel_w_vb10
  s_cmp_lt_u32 s38, 131072
  s_cbranch_scc1 .g2_kernel_w_vl10
  s_branch .g2_kernel_w_vb10
.g2_kernel_w_i14c:
  s_mov_b32 s38, 524288
  s_call_b64 s[68:69], .g2_kernel_w_pkl
  s_branch .g2_kernel_w_i14b
.g2_kernel_w_v11:
  s_cmp_ge_u32 s11, 139264
  s_cselect_b32 s28, 139264, 0
  s_sub_u32 s28, s11, s28
  s_lshr_b32 s28, s28, 1
  s_add_u32 s28, s28, 32768
  s_add_u32 s22, s20, s28
  s_addc_u32 s23, s21, 0
  s_mov_b32 s38, 0
.g2_kernel_w_vl11:
  global_load_dwordx4 v[208:211], v3, s[22:23] offset:0 sc1
  global_load_dwordx4 v[212:215], v3, s[22:23] offset:1024 sc1
  global_load_dwordx4 v[216:219], v3, s[22:23] offset:2048 sc1
  global_load_dwordx4 v[220:223], v3, s[22:23] offset:3072 sc1
  s_add_u32 s38, s38, 1
  s_waitcnt vmcnt(0)
  v_min3_u32 v6, v208, v210, v212
  v_min3_u32 v7, v214, v216, v218
  v_min3_u32 v6, v6, v220, v222
  v_min_u32 v6, v6, v7
  v_cmp_eq_u32 vcc, 0, v6
  s_cbranch_vccz .g2_kernel_w_vb11
  s_cmp_lt_u32 s38, 131072
  s_cbranch_scc1 .g2_kernel_w_vl11
  s_branch .g2_kernel_w_vb11
.g2_kernel_w_i15c:
  s_mov_b32 s38, 524288
  s_call_b64 s[68:69], .g2_kernel_w_pkl
  s_branch .g2_kernel_w_i15b
.g2_kernel_w_v12:
  s_cmp_ge_u32 s12, 139264
  s_cselect_b32 s28, 139264, 0
  s_sub_u32 s28, s12, s28
  s_lshr_b32 s28, s28, 1
  s_add_u32 s28, s28, 32768
  s_add_u32 s22, s20, s28
  s_addc_u32 s23, s21, 0
  s_mov_b32 s38, 0
.g2_kernel_w_vl12:
  global_load_dwordx4 v[224:227], v3, s[22:23] offset:0 sc1
  global_load_dwordx4 v[228:231], v3, s[22:23] offset:1024 sc1
  global_load_dwordx4 v[232:235], v3, s[22:23] offset:2048 sc1
  global_load_dwordx4 v[236:239], v3, s[22:23] offset:3072 sc1
  s_add_u32 s38, s38, 1
  s_waitcnt vmcnt(0)
  v_min3_u32 v6, v224, v226, v228
  v_min3_u32 v7, v230, v232, v234
  v_min3_u32 v6, v6, v236, v238
  v_min_u32 v6, v6, v7
  v_cmp_eq_u32 vcc, 0, v6
  s_cbranch_vccz .g2_kernel_w_vb12
  s_cmp_lt_u32 s38, 131072
  s_cbranch_scc1 .g2_kernel_w_vl12
  s_branch .g2_kernel_w_vb12
.g2_kernel_w_v13:
  s_cmp_ge_u32 s13, 139264
  s_cselect_b32 s28, 139264, 0
  s_sub_u32 s28, s13, s28
  s_lshr_b32 s28, s28, 1
  s_add_u32 s28, s28, 32768
  s_add_u32 s22, s20, s28
  s_addc_u32 s23, s21, 0
  s_mov_b32 s38, 0
.g2_kernel_w_vl13:
  global_load_dwordx4 v[136:139], v3, s[22:23] offset:0 sc1
  global_load_dwordx4 v[140:143], v3, s[22:23] offset:1024 sc1
  global_load_dwordx4 v[144:147], v3, s[22:23] offset:2048 sc1
  global_load_dwordx4 v[148:151], v3, s[22:23] offset:3072 sc1
  s_add_u32 s38, s38, 1
  s_waitcnt vmcnt(0)
  v_min3_u32 v6, v136, v138, v140
  v_min3_u32 v7, v142, v144, v146
  v_min3_u32 v6, v6, v148, v150
  v_min_u32 v6, v6, v7
  v_cmp_eq_u32 vcc, 0, v6
  s_cbranch_vccz .g2_kernel_w_vb13
  s_cmp_lt_u32 s38, 131072
  s_cbranch_scc1 .g2_kernel_w_vl13
  s_branch .g2_kernel_w_vb13
.g2_kernel_w_v14:
  s_cmp_ge_u32 s14, 139264
  s_cselect_b32 s28, 139264, 0
  s_sub_u32 s28, s14, s28
  s_lshr_b32 s28, s28, 1
  s_add_u32 s28, s28, 32768
  s_add_u32 s22, s20, s28
  s_addc_u32 s23, s21, 0
  s_mov_b32 s38, 0
.g2_kernel_w_vl14:
  global_load_dwordx4 v[152:155], v3, s[22:23] offset:0 sc1
  global_load_dwordx4 v[156:159], v3, s[22:23] offset:1024 sc1
  global_load_dwordx4 v[160:163], v3, s[22:23] offset:2048 sc1
  global_load_dwordx4 v[164:167], v3, s[22:23] offset:3072 sc1
  s_add_u32 s38, s38, 1
  s_waitcnt vmcnt(0)
  v_min3_u32 v6, v152, v154, v156
  v_min3_u32 v7, v158, v160, v162
  v_min3_u32 v6, v6, v164, v166
  v_min_u32 v6, v6, v7
  v_cmp_eq_u32 vcc, 0, v6
  s_cbranch_vccz .g2_kernel_w_vb14
  s_cmp_lt_u32 s38, 131072
  s_cbranch_scc1 .g2_kernel_w_vl14
  s_branch .g2_kernel_w_vb14
.g2_kernel_w_v15:
  s_cmp_ge_u32 s15, 139264
  s_cselect_b32 s28, 139264, 0
  s_sub_u32 s28, s15, s28
  s_lshr_b32 s28, s28, 1
  s_add_u32 s28, s28, 32768
  s_add_u32 s22, s20, s28
  s_addc_u32 s23, s21, 0
  s_mov_b32 s38, 0
.g2_kernel_w_vl15:
  global_load_dwordx4 v[56:59], v3, s[22:23] offset:0 sc1
  global_load_dwordx4 v[60:63], v3, s[22:23] offset:1024 sc1
  global_load_dwordx4 v[64:67], v3, s[22:23] offset:2048 sc1
  global_load_dwordx4 v[68:71], v3, s[22:23] offset:3072 sc1
  s_add_u32 s38, s38, 1
  s_waitcnt vmcnt(0)
  v_min3_u32 v6, v56, v58, v60
  v_min3_u32 v7, v62, v64, v66
  v_min3_u32 v6, v6, v68, v70
  v_min_u32 v6, v6, v7
  v_cmp_eq_u32 vcc, 0, v6
  s_cbranch_vccz .g2_kernel_w_vb15
  s_cmp_lt_u32 s38, 131072
  s_cbranch_scc1 .g2_kernel_w_vl15
  s_branch .g2_kernel_w_vb15
.g2_kernel_w_bw:
  s_mov_b32 s38, 0
.g2_kernel_w_bwl:
  ds_read_b32 v16, v20 offset:12
  s_add_u32 s38, s38, 1
  s_waitcnt lgkmcnt(0)
  v_cmp_gt_u32 vcc, 4, v16
  s_cbranch_vccz .g2_kernel_w_bb
  s_cmp_lt_u32 s38, 524288
  s_cbranch_scc1 .g2_kernel_w_bwl
  s_branch .g2_kernel_w_bb
.g2_kernel_w_pick:
  s_mov_b32 s38, 0
.g2_kernel_w_pkl:
  ds_read_b64 v[6:7], v21
  s_add_u32 s38, s38, 1
  s_waitcnt lgkmcnt(0)
  v_min_u32 v6, v6, v7
  v_cmp_lt_u32 vcc, s62, v6
  s_and_b32 s36, vcc_lo, 0xff00
  s_andn2_b32 s33, s36, s34
  s_cbranch_scc1 .g2_kernel_w_pkr
  s_cmp_lt_u32 s38, 524288
  s_cbranch_scc1 .g2_kernel_w_pkl
  s_andn2_b32 s33, 0xff00, s34
.g2_kernel_w_pkr:
  s_setpc_b64 s[68:69]
.g2_kernel_p_spin:
  s_mov_b32 s38, 0
.g2_kernel_p_spinl:
  ds_read_b32 v10, v9
  s_add_u32 s38, s38, 1
  s_waitcnt lgkmcnt(0)
  v_cmp_gt_i32 vcc, s34, v10
  s_cbranch_vccz .g2_kernel_p_spinr
  s_sleep 1
  s_cmp_lt_u32 s38, 524288
  s_cbranch_scc1 .g2_kernel_p_spinl
.g2_kernel_p_spinr:
  s_setpc_b64 s[68:69]
.g2_kernel_p1_aw:
  s_call_b64 s[68:69], .g2_kernel_p_spin
  s_branch .g2_kernel_p1_ai
.g2_kernel_p1_bw:
  s_call_b64 s[68:69], .g2_kernel_p_spin
  s_branch .g2_kernel_p1_bi
.g2_kernel_v_3a:
  s_sleep 0
  s_cmp_lg_u32 s62, 0
  s_cbranch_scc1 .g2_kernel_nap25
  s_sleep 80
.g2_kernel_nap25:
  s_and_b32 s31, s76, 0xffffe000
  s_add_u32 s31, s31, 0
  v_and_b32 v6, 15, v2
  v_lshlrev_b32 v6, 9, v6
  v_lshrrev_b32 v7, 4, v2
  v_lshl_add_u32 v6, v7, 7, v6
  v_lshlrev_b32 v7, 2, v2
  v_add_u32 v7, 157440, v7
  s_mov_b32 m0, 157440
  s_mov_b32 s38, 0
  s_mov_b32 exec_lo, 0xffff0000
  s_mov_b32 exec_hi, 0xffff0000
.g2_kernel_pa26:
  buffer_load_dword v6, s[4:7], s31 offen sc1 lds
  s_add_u32 s38, s38, 1
  s_waitcnt vmcnt(0)
  ds_read_b32 v8, v7
  s_waitcnt lgkmcnt(0)
  v_cmp_ge_u32 vcc, s62, v8
  s_cbranch_vccz .g2_kernel_pa26d
  s_mov_b64 exec, vcc
  s_sleep 16
  s_cmp_lt_u32 s38, 131072
  s_cbranch_scc1 .g2_kernel_pa26
.g2_kernel_pa26d:
  s_mov_b64 exec, -1
  s_sleep 0
  s_cmp_lg_u32 s62, 0
  s_cbranch_scc1 .g2_kernel_nap27
  s_sleep 0
.g2_kernel_nap27:
  s_branch .g2_kernel_v_3
.g2_kernel_v_may:
  s_cmp_lg_u32 s39, 0
  s_cbranch_scc1 .g2_kernel_v_mr
  s_and_b32 s28, s16, 3
  s_lshl_b32 s28, s28, 4
  s_add_u32 s28, s28, 155968
  v_mov_b32 v6, s28
  ds_read_b32 v7, v6
  s_waitcnt lgkmcnt(0)
  v_cmp_ne_u32 vcc, 0, v7
  s_cbranch_vccz .g2_kernel_v_mr
.g2_kernel_v_do:
  s_mov_b32 s39, 1
  s_mov_b32 s29, 0
  s_call_b64 s[68:69], .g2_kernel_v_cmb
  s_waitcnt vmcnt(0)
  v_mov_b32 v6, s71
  s_mov_b64 exec, 1
  ds_add_u32 v6, v5 offset:8
  s_mov_b64 exec, -1
  s_and_b32 s33, s16, 3
  s_lshl_b32 s33, s33, 7
  s_lshl_b32 s28, s29, 2
  s_add_u32 s33, s33, s28
  s_add_u32 s31, s19, s33
  v_mov_b32 v6, s70
  s_mov_b64 exec, 1
  buffer_store_dword v6, v4, s[4:7], s31 offen offset:0 sc1
  s_mov_b64 exec, -1
.g2_kernel_v_mr:
  s_setpc_b64 s[26:27]
.g2_kernel_v_w23:
  ds_write_b128 v3, v[128:131] offset:32768
  ds_write_b128 v3, v[132:135] offset:33792
  ds_write_b128 v3, v[136:139] offset:34816
  ds_write_b128 v3, v[140:143] offset:35840
  ds_write_b128 v3, v[144:147] offset:36864
  ds_write_b128 v3, v[148:151] offset:37888
  ds_write_b128 v3, v[152:155] offset:38912
  ds_write_b128 v3, v[156:159] offset:39936
  ds_write_b128 v3, v[160:163] offset:40960
  ds_write_b128 v3, v[164:167] offset:41984
  ds_write_b128 v3, v[168:171] offset:43008
  ds_write_b128 v3, v[172:175] offset:44032
  ds_write_b128 v3, v[176:179] offset:45056
  ds_write_b128 v3, v[180:183] offset:46080
  ds_write_b128 v3, v[184:187] offset:47104
  ds_write_b128 v3, v[188:191] offset:48128
  ds_write_b128 v3, v[192:195] offset:49152
  ds_write_b128 v3, v[196:199] offset:50176
  ds_write_b128 v3, v[200:203] offset:51200
  ds_write_b128 v3, v[204:207] offset:52224
  ds_write_b128 v3, v[208:211] offset:53248
  ds_write_b128 v3, v[212:215] offset:54272
  ds_write_b128 v3, v[216:219] offset:55296
  ds_write_b128 v3, v[220:223] offset:56320
  ds_write_b128 v3, v[224:227] offset:57344
  ds_write_b128 v3, v[228:231] offset:58368
  ds_write_b128 v3, v[232:235] offset:59392
  ds_write_b128 v3, v[236:239] offset:60416
  ds_write_b128 v3, v[240:243] offset:61440
  ds_write_b128 v3, v[244:247] offset:62464
  ds_write_b128 v3, v[248:251] offset:63488
  ds_write_b128 v3, v[252:255] offset:64512
  s_setpc_b64 s[68:69]
.g2_kernel_v_wo:
  s_mov_b32 s8, s44
  s_mov_b32 s9, s45
  s_mov_b32 s10, 0x200000
  s_mov_b32 s11, 0x00020000
  v_lshrrev_b32 v6, 3, v2
  v_and_b32 v7, 7, v2
  v_bfe_u32 v8, v2, 4, 1
  v_lshlrev_b32 v8, 2, v8
  v_xor_b32 v7, v7, v8
  v_lshlrev_b32 v7, 4, v7
  v_lshl_add_u32 v6, v6, 11, v7
  s_lshl_b32 s31, s32, 3
  s_add_u32 s31, s31, s29
  s_lshl_b32 s31, s31, 16
  s_lshl_b32 s33, s18, 7
  s_add_u32 s31, s31, s33
  s_mov_b32 m0, s30
  s_nop 0
  buffer_load_dwordx4 v6, s[8:11], s31 offen lds
  s_add_u32 m0, m0, 1024
  s_add_u32 s31, s31, 16384
  s_sleep 1
  buffer_load_dwordx4 v6, s[8:11], s31 offen lds
  s_add_u32 m0, m0, 1024
  s_add_u32 s31, s31, 16384
  s_sleep 1
  buffer_load_dwordx4 v6, s[8:11], s31 offen lds
  s_add_u32 m0, m0, 1024
  s_add_u32 s31, s31, 16384
  s_sleep 1
  buffer_load_dwordx4 v6, s[8:11], s31 offen lds
  s_add_u32 m0, m0, 1024
  s_add_u32 s31, s31, 81920
  s_sleep 1
  buffer_load_dwordx4 v6, s[8:11], s31 offen lds
  s_add_u32 m0, m0, 1024
  s_add_u32 s31, s31, 16384
  s_sleep 1
  buffer_load_dwordx4 v6, s[8:11], s31 offen lds
  s_add_u32 m0, m0, 1024
  s_add_u32 s31, s31, 16384
  s_sleep 1
  buffer_load_dwordx4 v6, s[8:11], s31 offen lds
  s_add_u32 m0, m0, 1024
  s_add_u32 s31, s31, 16384
  s_sleep 1
  buffer_load_dwordx4 v6, s[8:11], s31 offen lds
  s_add_u32 m0, m0, 1024
  s_add_u32 s31, s31, 81920
  s_sleep 1
  buffer_load_dwordx4 v6, s[8:11], s31 offen lds
  s_add_u32 m0, m0, 1024
  s_add_u32 s31, s31, 16384
  s_sleep 1
  buffer_load_dwordx4 v6, s[8:11], s31 offen lds
  s_add_u32 m0, m0, 1024
  s_add_u32 s31, s31, 16384
  s_sleep 1
  buffer_load_dwordx4 v6, s[8:11], s31 offen lds
  s_add_u32 m0, m0, 1024
  s_add_u32 s31, s31, 16384
  s_sleep 1
  buffer_load_dwordx4 v6, s[8:11], s31 offen lds
  s_add_u32 m0, m0, 1024
  s_add_u32 s31, s31, 81920
  s_sleep 1
  buffer_load_dwordx4 v6, s[8:11], s31 offen lds
  s_add_u32 m0, m0, 1024
  s_add_u32 s31, s31, 16384
  s_sleep 1
  buffer_load_dwordx4 v6, s[8:11], s31 offen lds
  s_add_u32 m0, m0, 1024
  s_add_u32 s31, s31, 16384
  s_sleep 1
  buffer_load_dwordx4 v6, s[8:11], s31 offen lds
  s_add_u32 m0, m0, 1024
  s_add_u32 s31, s31, 16384
  s_sleep 1
  buffer_load_dwordx4 v6, s[8:11], s31 offen lds
  s_setpc_b64 s[68:69]
.g2_kernel_v_cmb:
  s_and_b32 s28, s16, 3
  s_lshl_b32 s30, s28, 2
  s_lshl_b32 s34, 15, s30
  s_lshr_b32 s32, s34, 4
  s_or_b32 s32, s32, s34
  s_mul_i32 s32, s32, s29
  v_and_b32 v6, 15, v2
  v_lshlrev_b32 v6, 2, v6
  v_add_u32 v6, 155968, v6
  s_mov_b32 s30, .g2_kernel_sel-.g2_kernel_pc
  buffer_load_dwordx4 v[8:11], v3, s[64:67], s30 offen
  buffer_load_dwordx4 v[12:15], v3, s[64:67], s30 offen offset:1024
  s_lshl_b32 s30, s28, 13
  v_add_u32 v0, s30, v3
  v_and_b32 v4, 31, v2
  s_lshl_b32 s31, s28, 9
  s_add_u32 s31, s31, 161280
  v_lshl_add_u32 v4, v4, 2, s31
  s_lshl_b32 s33, s62, 1
  s_add_u32 s33, s33, s29
  s_lshl_b32 s31, s17, 2
  s_add_u32 s31, s31, s28
  s_lshl_b32 s31, s31, 1
  s_add_u32 s31, s31, s29
  s_lshl_b32 s31, s31, 4
  s_add_u32 s31, s31, s18
  s_lshl_b32 s31, s31, 11
  s_add_u32 s31, s31, s63
  s_add_u32 s35, s31, 0x800000
  s_mov_b32 s38, 0
  s_waitcnt vmcnt(0)
.g2_kernel_v_cmbw:
  ds_read_b32 v7, v6
  s_add_u32 s38, s38, 1
  s_waitcnt lgkmcnt(0)
  v_cmp_ge_u32 vcc, s33, v7
  s_and_b32 s30, vcc_lo, s34
  s_cbranch_scc0 .g2_kernel_v_cmbd
  s_orn2_b32 s30, vcc_lo, s32
  s_cmp_lg_u32 s30, -1
  s_cbranch_scc1 .g2_kernel_v_cmbq
  s_sleep 6
.g2_kernel_v_cmbq:
  s_sleep 1
  s_cmp_lt_u32 s38, 524288
  s_cbranch_scc1 .g2_kernel_v_cmbw
.g2_kernel_v_cmbd:
  s_setprio 3
  ds_read_b128 v[32:35], v0 offset:0
  ds_read_b128 v[36:39], v0 offset:1024
  ds_read_b128 v[40:43], v0 offset:2048
  ds_read_b128 v[44:47], v0 offset:3072
  ds_read_b128 v[48:51], v0 offset:4096
  ds_read_b128 v[52:55], v0 offset:5120
  ds_read_b128 v[56:59], v0 offset:6144
  ds_read_b128 v[60:63], v0 offset:7168
  ds_read2_b32 v[6:7], v4 offset0:64 offset1:96
  ds_read2_b32 v[4:5], v4 offset0:0 offset1:32
  s_lshl_b32 s30, s28, 2
  s_add_u32 s30, s30, s71
  s_waitcnt lgkmcnt(9)
  v_mfma_f32_32x32x16_bf16 v[16:31], v[8:11], v[32:35], 0
  s_waitcnt lgkmcnt(8)
  v_mfma_f32_32x32x16_bf16 v[16:31], v[12:15], v[36:39], v[16:31]
  s_waitcnt lgkmcnt(7)
  v_mfma_f32_32x32x16_bf16 v[16:31], v[8:11], v[40:43], v[16:31]
  s_waitcnt lgkmcnt(6)
  v_mfma_f32_32x32x16_bf16 v[16:31], v[12:15], v[44:47], v[16:31]
  s_waitcnt lgkmcnt(5)
  v_mfma_f32_32x32x16_bf16 v[16:31], v[8:11], v[48:51], v[16:31]
  s_waitcnt lgkmcnt(4)
  v_mfma_f32_32x32x16_bf16 v[16:31], v[12:15], v[52:55], v[16:31]
  s_waitcnt lgkmcnt(3)
  v_mfma_f32_32x32x16_bf16 v[16:31], v[8:11], v[56:59], v[16:31]
  s_waitcnt lgkmcnt(2)
  v_mfma_f32_32x32x16_bf16 v[16:31], v[12:15], v[60:63], v[16:31]
  v_mov_b32 v0, s30
  s_waitcnt lgkmcnt(0)
  v_add_f32 v6, v6, v4
  v_add_f32 v7, v7, v5
  v_mov_b32 v4, 0
  v_mov_b32 v5, s29
  ds_write_b32 v0, v5 offset:64
  v_add_f32 v9, v6, v7
  s_mov_b32 s30, 8.673617379884035e-19
  s_mov_b32 s31, 1.152921504606847e+18
  v_rcp_f32 v10, v9
  v_cmp_le_f32 vcc, s30, v9
  v_cmp_ge_f32 s[36:37], s31, v9
  v_mov_b32 v5, 1
  v_mul_f32 v10, 4.0, v10
  s_and_b64 s[36:37], s[36:37], vcc
  v_cmp_o_f32 vcc, v16, v16
  s_and_b64 vcc, vcc, s[36:37]
  s_cmp_eq_u64 vcc, -1
  s_cbranch_scc0 .g2_kernel_v_cmbslow
.g2_kernel_v_cmbfin:
  v_mul_f32 v16, v16, v10
  v_mul_f32 v17, v17, v10
  v_mul_f32 v18, v18, v10
  v_mul_f32 v19, v19, v10
  v_mul_f32 v20, v20, v10
  v_mul_f32 v21, v21, v10
  v_mul_f32 v22, v22, v10
  v_mul_f32 v23, v23, v10
  v_cvt_pk_bf16_f32 v32, v16, v17
  v_cvt_pk_bf16_f32 v33, v18, v19
  v_cvt_pk_bf16_f32 v34, v20, v21
  v_cvt_pk_bf16_f32 v35, v22, v23
  v_max_u32 v32, 1, v32
  v_max_u32 v34, 1, v34
  buffer_store_dwordx4 v[32:35], v3, s[4:7], s35 offen offset:0 sc1
  v_mul_f32 v24, v24, v10
  v_mul_f32 v25, v25, v10
  v_mul_f32 v26, v26, v10
  v_mul_f32 v27, v27, v10
  v_mul_f32 v28, v28, v10
  v_mul_f32 v29, v29, v10
  v_mul_f32 v30, v30, v10
  v_mul_f32 v31, v31, v10
  v_cvt_pk_bf16_f32 v36, v24, v25
  v_cvt_pk_bf16_f32 v37, v26, v27
  v_cvt_pk_bf16_f32 v38, v28, v29
  v_cvt_pk_bf16_f32 v39, v30, v31
  v_max_u32 v36, 1, v36
  v_max_u32 v38, 1, v38
  buffer_store_dwordx4 v[36:39], v3, s[4:7], s35 offen offset:1024 sc1
  s_setprio 3
  s_setpc_b64 s[68:69]
.g2_kernel_v_cmbslow:
  s_setprio 0
  s_lshl_b32 s30, s28, 11
  s_mul_i32 s31, s29, -8192
  s_add_u32 s30, s30, s31
  s_add_u32 s30, s30, 139264
  v_add_u32 v6, s30, v3
  ds_read_b128 v[48:51], v6
  ds_read_b128 v[52:55], v6 offset:1024
  s_lshl_b32 s36, s18, 1
  s_add_u32 s36, s36, s29
  s_lshl_b32 s36, s36, 18
  s_add_u32 s36, s36, s63
  s_mov_b32 s30, s36
  s_mov_b32 s33, 64
  v_mov_b32 v10, 0xff800000
  s_waitcnt lgkmcnt(0)
.g2_kernel_v_cmbs1:
  buffer_load_dwordx4 v[56:59], v3, s[4:7], s30 offen offset:0
  buffer_load_dwordx4 v[60:63], v3, s[4:7], s30 offen offset:1024
  s_waitcnt vmcnt(0)
  v_mfma_f32_32x32x16_bf16 v[32:47], v[56:59], v[48:51], 0
  v_mfma_f32_32x32x16_bf16 v[32:47], v[60:63], v[52:55], v[32:47]
  s_nop 11
  v_max3_f32 v10, v10, v32, v33
  v_max3_f32 v10, v10, v34, v35
  v_max3_f32 v10, v10, v36, v37
  v_max3_f32 v10, v10, v38, v39
  v_max3_f32 v10, v10, v40, v41
  v_max3_f32 v10, v10, v42, v43
  v_max3_f32 v10, v10, v44, v45
  v_max3_f32 v10, v10, v46, v47
  s_add_u32 s30, s30, 4096
  s_sub_u32 s33, s33, 1
  s_cmp_lg_u32 s33, 0
  s_cbranch_scc1 .g2_kernel_v_cmbs1
  v_mov_b32 v11, v10
  s_nop 1
  v_permlane32_swap_b32 v11, v10
  v_max_f32 v10, v10, v11
  v_mov_b32 v9, 0
  v_mov_b32 v16, 0
  v_mov_b32 v17, 0
  v_mov_b32 v18, 0
  v_mov_b32 v19, 0
  v_mov_b32 v20, 0
  v_mov_b32 v21, 0
  v_mov_b32 v22, 0
  v_mov_b32 v23, 0
  v_mov_b32 v24, 0
  v_mov_b32 v25, 0
  v_mov_b32 v26, 0
  v_mov_b32 v27, 0
  v_mov_b32 v28, 0
  v_mov_b32 v29, 0
  v_mov_b32 v30, 0
  v_mov_b32 v31, 0
  s_mov_b32 s30, s36
  s_mov_b32 s33, 64
.g2_kernel_v_cmbs2:
  buffer_load_dwordx4 v[56:59], v3, s[4:7], s30 offen offset:0
  buffer_load_dwordx4 v[60:63], v3, s[4:7], s30 offen offset:1024
  s_waitcnt vmcnt(0)
  v_mfma_f32_32x32x16_bf16 v[32:47], v[56:59], v[48:51], 0
  v_mfma_f32_32x32x16_bf16 v[32:47], v[60:63], v[52:55], v[32:47]
  s_nop 11
  v_sub_f32 v32, v32, v10
  v_sub_f32 v33, v33, v10
  v_sub_f32 v34, v34, v10
  v_sub_f32 v35, v35, v10
  v_sub_f32 v36, v36, v10
  v_sub_f32 v37, v37, v10
  v_sub_f32 v38, v38, v10
  v_sub_f32 v39, v39, v10
  v_sub_f32 v40, v40, v10
  v_sub_f32 v41, v41, v10
  v_sub_f32 v42, v42, v10
  v_sub_f32 v43, v43, v10
  v_sub_f32 v44, v44, v10
  v_sub_f32 v45, v45, v10
  v_sub_f32 v46, v46, v10
  v_sub_f32 v47, v47, v10
  buffer_load_dwordx4 v[56:59], v3, s[4:7], s30 offen offset:2048
  buffer_load_dwordx4 v[60:63], v3, s[4:7], s30 offen offset:3072
  v_exp_f32 v32, v32
  v_exp_f32 v33, v33
  v_exp_f32 v34, v34
  v_exp_f32 v35, v35
  v_exp_f32 v36, v36
  v_exp_f32 v37, v37
  v_exp_f32 v38, v38
  v_exp_f32 v39, v39
  v_exp_f32 v40, v40
  v_exp_f32 v41, v41
  v_exp_f32 v42, v42
  v_exp_f32 v43, v43
  v_exp_f32 v44, v44
  v_exp_f32 v45, v45
  v_exp_f32 v46, v46
  v_exp_f32 v47, v47
  v_add_f32 v9, v9, v32
  v_add_f32 v9, v9, v33
  v_add_f32 v9, v9, v34
  v_add_f32 v9, v9, v35
  v_add_f32 v9, v9, v36
  v_add_f32 v9, v9, v37
  v_add_f32 v9, v9, v38
  v_add_f32 v9, v9, v39
  v_add_f32 v9, v9, v40
  v_add_f32 v9, v9, v41
  v_add_f32 v9, v9, v42
  v_add_f32 v9, v9, v43
  v_add_f32 v9, v9, v44
  v_add_f32 v9, v9, v45
  v_add_f32 v9, v9, v46
  v_add_f32 v9, v9, v47
  v_cvt_pk_bf16_f32 v32, v32, v33
  v_cvt_pk_bf16_f32 v33, v34, v35
  v_cvt_pk_bf16_f32 v34, v36, v37
  v_cvt_pk_bf16_f32 v35, v38, v39
  v_cvt_pk_bf16_f32 v36, v40, v41
  v_cvt_pk_bf16_f32 v37, v42, v43
  v_cvt_pk_bf16_f32 v38, v44, v45
  v_cvt_pk_bf16_f32 v39, v46, v47
  s_waitcnt vmcnt(0)
  v_mfma_f32_32x32x16_bf16 v[16:31], v[56:59], v[32:35], v[16:31]
  v_mfma_f32_32x32x16_bf16 v[16:31], v[60:63], v[36:39], v[16:31]
  s_nop 15
  s_add_u32 s30, s30, 4096
  s_sub_u32 s33, s33, 1
  s_cmp_lg_u32 s33, 0
  s_cbranch_scc1 .g2_kernel_v_cmbs2
  v_mov_b32 v11, v9
  s_nop 1
  v_permlane32_swap_b32 v11, v9
  v_add_f32 v9, v9, v11
  v_rcp_f32 v10, v9
  s_branch .g2_kernel_v_cmbfin
.g2_kernel_p2_xw:
  s_mov_b32 s38, 0
.g2_kernel_p2_xwl:
  ds_read_b32 v12, v11
  s_add_u32 s38, s38, 1
  s_waitcnt lgkmcnt(0)
  v_cmp_ne_u32 vcc, 0, v12
  s_and_b32 s37, vcc_lo, vcc_hi
  s_lshr_b32 s33, s37, 16
  s_and_b32 s37, s37, s33
  s_bitcmp1_b32 s37, s28
  s_cbranch_scc1 .g2_kernel_p2_xwr
  s_sleep 1
  s_cmp_lt_u32 s38, 524288
  s_cbranch_scc1 .g2_kernel_p2_xwl
.g2_kernel_p2_xwr:
  s_setpc_b64 s[68:69]
.g2_kernel_p2_x0w:
  s_call_b64 s[68:69], .g2_kernel_p2_xw
  s_branch .g2_kernel_p2_x0b
.g2_kernel_p2_x1w:
  s_call_b64 s[68:69], .g2_kernel_p2_xw
  s_branch .g2_kernel_p2_x1b
.g2_kernel_p2_x2w:
  s_call_b64 s[68:69], .g2_kernel_p2_xw
  s_branch .g2_kernel_p2_x2b
.g2_kernel_p2_aw:
  s_call_b64 s[68:69], .g2_kernel_p_spin
  s_branch .g2_kernel_p2_ai
.g2_kernel_p2_x3w:
  s_call_b64 s[68:69], .g2_kernel_p2_xw
  s_branch .g2_kernel_p2_x3b
.g2_kernel_p2_bw:
  s_call_b64 s[68:69], .g2_kernel_p_spin
  s_branch .g2_kernel_p2_bi
.g2_kernel_amax:
  v_mov_b32 v16, 0xff7fffff
  v_lshlrev_b32 v7, 7, v2
  s_mov_b32 s38, 0
  s_mov_b64 exec, s[8:9]
.g2_kernel_amaxl:
  buffer_load_dwordx2 v[16:17], v7, s[4:7], s23 offen sc1
  s_add_u32 s38, s38, 1
  s_waitcnt vmcnt(0)
  v_cmp_eq_u32 vcc, 0, v17
  s_cbranch_vccz .g2_kernel_amaxd
  s_mov_b64 exec, vcc
  s_sleep 4
  s_cmp_lg_u32 s62, 0
  s_cbranch_scc1 .g2_kernel_nap60
  s_sleep 8
.g2_kernel_nap60:
  s_cmp_eq_u32 s39, 1
  s_cbranch_scc0 .g2_kernel_amaxz
  s_sleep 8
.g2_kernel_amaxz:
  s_cmp_lt_u32 s38, 131072
  s_cbranch_scc1 .g2_kernel_amaxl
.g2_kernel_amaxd:
  s_mov_b64 exec, -1
  v_mov_b32 v6, v16
  s_nop 1
  v_max_f32 v7, v6, v6 row_ror:8 row_mask:0xf bank_mask:0xf
  s_nop 1
  v_max_f32 v7, v7, v7 row_ror:4 row_mask:0xf bank_mask:0xf
  s_nop 1
  v_max_f32 v7, v7, v7 row_ror:2 row_mask:0xf bank_mask:0xf
  s_nop 1
  v_max_f32 v7, v7, v7 row_ror:1 row_mask:0xf bank_mask:0xf
  s_nop 1
  v_max_f32 v7, v7, v7 row_bcast:15 row_mask:0xa bank_mask:0xf
  s_nop 1
  v_max_f32 v7, v7, v7 row_bcast:31 row_mask:0xc bank_mask:0xf
  s_nop 0
  v_readlane_b32 s27, v7, 63
  s_nop 1
  v_cmp_eq_u32 vcc, s27, v6
  s_ff1_i32_b64 s77, vcc
  s_lshl_b32 s77, s77, 5
  s_and_b32 s28, s27, 31
  s_add_u32 s77, s77, s28
  s_and_b32 s77, s77, 2047
  s_setpc_b64 s[68:69]
  .p2align 8
.g2_kernel_tab:
  .long 0, 1, 2, 3, 4, 5, 6, 7
  .long 8, 9, 10, 11, 12, 13, 14, 15
  .long 16, 17, 18, 19, 20, 21, 22, 23
  .long 24, 25, 26, 27, 28, 29, 30, 31
  .long 32, 33, 34, 35, 36, 37, 38, 39
  .long 40, 41, 42, 43, 44, 45, 46, 47
  .long 48, 49, 50, 51, 52, 53, 54, 55
  .long 56, 57, 58, 59, 60, 61, 62, 63
  .long 64, 65, 66, 67, 68, 69, 70, 71
  .p2align 4
.g2_kernel_sel:
  .long 0x3e80, 0x0, 0x0, 0x0
  .long 0x3e800000, 0x0, 0x0, 0x0
  .long 0x0, 0x3e80, 0x0, 0x0
  .long 0x0, 0x3e800000, 0x0, 0x0
  .long 0x0, 0x0, 0x0, 0x0
  .long 0x0, 0x0, 0x0, 0x0
  .long 0x0, 0x0, 0x0, 0x0
  .long 0x0, 0x0, 0x0, 0x0
  .long 0x0, 0x0, 0x3e80, 0x0
  .long 0x0, 0x0, 0x3e800000, 0x0
  .long 0x0, 0x0, 0x0, 0x3e80
  .long 0x0, 0x0, 0x0, 0x3e800000
  .long 0x0, 0x0, 0x0, 0x0
  .long 0x0, 0x0, 0x0, 0x0
  .long 0x0, 0x0, 0x0, 0x0
  .long 0x0, 0x0, 0x0, 0x0
  .long 0x0, 0x0, 0x0, 0x0
  .long 0x0, 0x0, 0x0, 0x0
  .long 0x0, 0x0, 0x0, 0x0
  .long 0x0, 0x0, 0x0, 0x0
  .long 0x0, 0x0, 0x0, 0x0
  .long 0x0, 0x0, 0x0, 0x0
  .long 0x0, 0x0, 0x0, 0x0
  .long 0x0, 0x0, 0x0, 0x0
  .long 0x0, 0x0, 0x0, 0x0
  .long 0x0, 0x0, 0x0, 0x0
  .long 0x0, 0x0, 0x0, 0x0
  .long 0x0, 0x0, 0x0, 0x0
  .long 0x0, 0x0, 0x0, 0x0
  .long 0x0, 0x0, 0x0, 0x0
  .long 0x0, 0x0, 0x0, 0x0
  .long 0x0, 0x0, 0x0, 0x0
  .long 0x0, 0x0, 0x0, 0x0
  .long 0x0, 0x0, 0x0, 0x0
  .long 0x0, 0x0, 0x0, 0x0
  .long 0x0, 0x0, 0x0, 0x0
  .long 0x3e80, 0x0, 0x0, 0x0
  .long 0x3e800000, 0x0, 0x0, 0x0
  .long 0x0, 0x3e80, 0x0, 0x0
  .long 0x0, 0x3e800000, 0x0, 0x0
  .long 0x0, 0x0, 0x0, 0x0
  .long 0x0, 0x0, 0x0, 0x0
  .long 0x0, 0x0, 0x0, 0x0
  .long 0x0, 0x0, 0x0, 0x0
  .long 0x0, 0x0, 0x3e80, 0x0
  .long 0x0, 0x0, 0x3e800000, 0x0
  .long 0x0, 0x0, 0x0, 0x3e80
  .long 0x0, 0x0, 0x0, 0x3e800000
  .long 0x0, 0x0, 0x0, 0x0
  .long 0x0, 0x0, 0x0, 0x0
  .long 0x0, 0x0, 0x0, 0x0
  .long 0x0, 0x0, 0x0, 0x0
  .long 0x0, 0x0, 0x0, 0x0
  .long 0x0, 0x0, 0x0, 0x0
  .long 0x0, 0x0, 0x0, 0x0
  .long 0x0, 0x0, 0x0, 0x0
  .long 0x0, 0x0, 0x0, 0x0
  .long 0x0, 0x0, 0x0, 0x0
  .long 0x0, 0x0, 0x0, 0x0
  .long 0x0, 0x0, 0x0, 0x0
  .long 0x0, 0x0, 0x0, 0x0
  .long 0x0, 0x0, 0x0, 0x0
  .long 0x0, 0x0, 0x0, 0x0
  .long 0x0, 0x0, 0x0, 0x0
  .long 0x0, 0x0, 0x0, 0x0
  .long 0x0, 0x0, 0x0, 0x0
  .long 0x0, 0x0, 0x0, 0x0
  .long 0x0, 0x0, 0x0, 0x0
  .long 0x0, 0x0, 0x0, 0x0
  .long 0x0, 0x0, 0x0, 0x0
  .long 0x0, 0x0, 0x0, 0x0
  .long 0x0, 0x0, 0x0, 0x0
  .long 0x0, 0x0, 0x0, 0x0
  .long 0x0, 0x0, 0x0, 0x0
  .long 0x0, 0x0, 0x0, 0x0
  .long 0x0, 0x0, 0x0, 0x0
  .long 0x0, 0x0, 0x0, 0x0
  .long 0x0, 0x0, 0x0, 0x0
  .long 0x0, 0x0, 0x0, 0x0
  .long 0x0, 0x0, 0x0, 0x0
  .long 0x3e80, 0x0, 0x0, 0x0
  .long 0x3e800000, 0x0, 0x0, 0x0
  .long 0x0, 0x3e80, 0x0, 0x0
  .long 0x0, 0x3e800000, 0x0, 0x0
  .long 0x0, 0x0, 0x0, 0x0
  .long 0x0, 0x0, 0x0, 0x0
  .long 0x0, 0x0, 0x0, 0x0
  .long 0x0, 0x0, 0x0, 0x0
  .long 0x0, 0x0, 0x3e80, 0x0
  .long 0x0, 0x0, 0x3e800000, 0x0
  .long 0x0, 0x0, 0x0, 0x3e80
  .long 0x0, 0x0, 0x0, 0x3e800000
  .long 0x0, 0x0, 0x0, 0x0
  .long 0x0, 0x0, 0x0, 0x0
  .long 0x0, 0x0, 0x0, 0x0
  .long 0x0, 0x0, 0x0, 0x0
  .long 0x0, 0x0, 0x0, 0x0
  .long 0x0, 0x0, 0x0, 0x0
  .long 0x0, 0x0, 0x0, 0x0
  .long 0x0, 0x0, 0x0, 0x0
  .long 0x0, 0x0, 0x0, 0x0
  .long 0x0, 0x0, 0x0, 0x0
  .long 0x0, 0x0, 0x0, 0x0
  .long 0x0, 0x0, 0x0, 0x0
  .long 0x0, 0x0, 0x0, 0x0
  .long 0x0, 0x0, 0x0, 0x0
  .long 0x0, 0x0, 0x0, 0x0
  .long 0x0, 0x0, 0x0, 0x0
  .long 0x0, 0x0, 0x0, 0x0
  .long 0x0, 0x0, 0x0, 0x0
  .long 0x0, 0x0, 0x0, 0x0
  .long 0x0, 0x0, 0x0, 0x0
  .long 0x0, 0x0, 0x0, 0x0
  .long 0x0, 0x0, 0x0, 0x0
  .long 0x0, 0x0, 0x0, 0x0
  .long 0x0, 0x0, 0x0, 0x0
  .long 0x3e80, 0x0, 0x0, 0x0
  .long 0x3e800000, 0x0, 0x0, 0x0
  .long 0x0, 0x3e80, 0x0, 0x0
  .long 0x0, 0x3e800000, 0x0, 0x0
  .long 0x0, 0x0, 0x0, 0x0
  .long 0x0, 0x0, 0x0, 0x0
  .long 0x0, 0x0, 0x0, 0x0
  .long 0x0, 0x0, 0x0, 0x0
  .long 0x0, 0x0, 0x3e80, 0x0
  .long 0x0, 0x0, 0x3e800000, 0x0
  .long 0x0, 0x0, 0x0, 0x3e80
  .long 0x0, 0x0, 0x0, 0x3e800000
.g2_kernel_cend:

.section .rodata,"a"
.p2align 6
.amdhsa_kernel g2_kernel
  .amdhsa_next_free_vgpr 256
  .amdhsa_next_free_sgpr 102
  .amdhsa_accum_offset 256
  .amdhsa_group_segment_fixed_size 0
  .amdhsa_kernarg_size 88
  .amdhsa_user_sgpr_count 2
  .amdhsa_user_sgpr_kernarg_segment_ptr 1
  .amdhsa_system_sgpr_workgroup_id_x 1
.end_amdhsa_kernel
```
